```python
import torch

def _softmax(x, axis=-1):
    return torch.softmax(x, dim=axis)

def _gelu(x):
    return torch.nn.functional.gelu(x, approximate='tanh')

def _silu(x):
    return torch.nn.functional.silu(x)

def _sigmoid(x):
    return torch.sigmoid(x)

def _layernorm(x, axis=-1, eps=1e-05):
    m = x.mean(dim=axis, keepdim=True)
    v = x.var(dim=axis, keepdim=True, unbiased=False)
    return (x - m) / torch.sqrt(v + eps)

def _scatter_add(tgt, idx, src, axis=0):
    return tgt.clone().index_add_(axis, idx, src)

def _segment_sum(src, seg, n):
    out = torch.zeros((n,) + src.shape[1:], dtype=src.dtype)
    return out.index_add_(0, seg, src)

def _pad(x, pw):
    flat = tuple((v for pair in reversed(pw) for v in pair))
    return torch.nn.functional.pad(x, flat)
kernel_name = 'interleave_layers__sliding_local_dilated__memory_aug_recurrent_mem_tr__prompt'

def setup_inputs():

    _w = lambda a: (lambda t: t.to(torch.bfloat16) if t.is_floating_point() else t)(torch.as_tensor(a))

    def _A_setup():
        B, S, D = (1, 2048, 576)
        return {'x': _w((lambda *s: torch.randn(*s, dtype=torch.bfloat16) * 0.05)(B, S, D)), 'wqkv': _w((lambda *s: torch.randn(*s, dtype=torch.bfloat16) * 0.05)(D, 3 * D)), 'wo': _w((lambda *s: torch.randn(*s, dtype=torch.bfloat16) * 0.05)(D, D))}
    _A_in = _A_setup()

    def _B_setup():
        B, S, Dm = (1, 2048, 576)
        H, Dh = (32, 128)
        M, seg = (8, 32)
        seg = min(seg, S)
        S = S // seg * seg
        return {'x': _w((lambda *s: torch.randn(*s, dtype=torch.bfloat16) * 0.05)(B, S, Dm)), 'mem0': _w((lambda *s: torch.randn(*s, dtype=torch.bfloat16) * 0.8)(B, M, Dm)), 'Wq': _w((lambda *s: torch.randn(*s, dtype=torch.bfloat16) * 1.6)(Dm, H, Dh) * Dm ** (-0.5)), 'Wk': _w((lambda *s: torch.randn(*s, dtype=torch.bfloat16) * 1.6)(Dm, H, Dh) * Dm ** (-0.5)), 'Wv': _w((lambda *s: torch.randn(*s, dtype=torch.bfloat16) * 0.8)(Dm, H, Dh) * Dm ** (-0.5)), 'Wo': _w((lambda *s: torch.randn(*s, dtype=torch.bfloat16) * 0.8)(H, Dh, Dm) * (H * Dh) ** (-0.5)), 'seg_len': seg}
    _B_in = _B_setup()
    return {'A_x': _A_in['x'], 'A_wqkv': _A_in['wqkv'], 'A_wo': _A_in['wo'], 'B_x': _B_in['x'], 'B_mem0': _B_in['mem0'], 'B_Wq': _B_in['Wq'], 'B_Wk': _B_in['Wk'], 'B_Wv': _B_in['Wv'], 'B_Wo': _B_in['Wo'], 'B_seg_len': _B_in['seg_len']}

def reference(A_x, A_wqkv, A_wo, B_x, B_mem0, B_Wq, B_Wk, B_Wv, B_Wo, B_seg_len):

    def _A_ref(x, wqkv, wo):
        B, S, D = x.shape
        H = 32
        Dh = D // H
        W, dil = (8, 2)
        qkv = (lambda x, *d: x.permute(*d))((x @ wqkv).reshape(B, S, 3, H, Dh), 2, 0, 3, 1, 4)
        q, k, v = (qkv[0], qkv[1], qkv[2])
        scale = Dh ** (-0.5)
        pos = torch.arange(S)
        off = torch.arange(W) * dil
        idx = pos[:, None] - off[None, :]
        mask = idx >= 0
        idx_c = torch.where(mask, idx, 0).reshape(-1)
        kg = k[:, :, idx_c, :].reshape(B, H, S, W, Dh)
        vg = v[:, :, idx_c, :].reshape(B, H, S, W, Dh)
        logits = torch.einsum('bhsd,bhswd->bhsw', q, kg) * scale
        logits = torch.where(mask[None, None, :, :], logits, -1000000000.0)
        attn = _softmax(logits, axis=-1)
        o = torch.einsum('bhsw,bhswd->bhsd', attn, vg)
        return (lambda x, *d: x.permute(*d))(o, 0, 2, 1, 3).reshape(B, S, D) @ wo

    def _B_ref(x, mem0, Wq, Wk, Wv, Wo, seg_len):
        B, S, Dm = x.shape
        H, Dh = (Wq.shape[1], Wq.shape[2])
        M = mem0.shape[1]
        scale = Dh ** (-0.5)
        n_seg = S // seg_len
        L = M + seg_len
        idx = torch.arange(L)
        mask = (idx[:, None] < M) | (idx[:, None] >= idx[None, :])
        mem = mem0
        outs = []
        for s in range(n_seg):
            xs = x[:, s * seg_len:(s + 1) * seg_len, :].clone()
            h = torch.concatenate([mem, xs], axis=1)
            q = torch.einsum('btd,dhe->bhte', h, Wq)
            k = torch.einsum('btd,dhe->bhte', h, Wk)
            v = torch.einsum('btd,dhe->bhte', h, Wv)
            scores = torch.einsum('bhqe,bhke->bhqk', q, k) * scale
            scores = torch.where(mask[None, None], scores, -1000000000.0)
            p = _softmax(scores, axis=-1)
            o = torch.einsum('bhqk,bhke->bhqe', p, v)
            o = torch.einsum('bhte,hed->btd', o, Wo)
            mem = o[:, :M, :].clone()
            outs.append(o[:, M:, :])
        return torch.concatenate(outs, axis=1)
    x = A_x
    x = x + _A_ref(_layernorm(x, axis=-1), A_wqkv, A_wo)
    x = x + _B_ref(_layernorm(x, axis=-1), B_mem0, B_Wq, B_Wk, B_Wv, B_Wo, B_seg_len)
    x = x + _A_ref(_layernorm(x, axis=-1), A_wqkv, A_wo)
    x = x + _B_ref(_layernorm(x, axis=-1), B_mem0, B_Wq, B_Wk, B_Wv, B_Wo, B_seg_len)
    return x
```

```asm
; @launch grid=(256,1,1) block=(256,1,1) lds=163840
.amdgcn_target "amdgcn-amd-amdhsa--gfx950"
.text
.globl interleave_layers__sliding_local_dilated__memory_aug_recurrent_mem_tr__prompt_kernel
.p2align 8
.type interleave_layers__sliding_local_dilated__memory_aug_recurrent_mem_tr__prompt_kernel,@function
interleave_layers__sliding_local_dilated__memory_aug_recurrent_mem_tr__prompt_kernel:
    s_cmp_ge_u32 s2, 256
    s_cbranch_scc1 L_exit
    s_load_dwordx2 s[8:9], s[0:1], 96
    s_mov_b32 s10, 268435456
    s_mov_b32 s11, 0x00020000
    s_waitcnt lgkmcnt(0)
    s_and_b32 s9, s9, 0xffff
    s_load_dwordx2 s[12:13], s[0:1], 88
    v_lshrrev_b32 v1, 6, v0
    s_getreg_b32 s3, hwreg(HW_REG_XCC_ID)
    v_readfirstlane_b32 s14, v1
    s_and_b32 s3, s3, 7
    s_and_b32 s17, s3, 1
    s_lshl_b32 s17, s17, 7
    s_lshl_b32 s18, s3, 1
    s_and_b32 s18, s18, 12
    s_add_u32 s17, s17, s18
    v_mov_b32 v2, 0
    v_mov_b32 v3, 1
    v_mov_b32 v4, s17
    s_mov_b32 s33, 0
    s_waitcnt lgkmcnt(0)
    s_cmp_lg_u32 s14, 0
    s_cbranch_scc1 L_tk_wait
    s_mov_b64 exec, 1
    global_atomic_add v3, v4, v3, s[12:13] sc0
    s_waitcnt vmcnt(0)
    v_readfirstlane_b32 s4, v3
    s_nop 0
    s_cmp_lt_u32 s4, 32
    s_cbranch_scc1 L_tk_have
    v_mov_b32 v3, 1
    v_mov_b32 v4, 32
    global_atomic_add v3, v4, v3, s[12:13] sc0
    s_waitcnt vmcnt(0)
    v_readfirstlane_b32 s5, v3
    s_mov_b64 exec, 0xff
    v_and_b32 v4, 1, v0
    v_lshlrev_b32 v4, 7, v4
    v_lshlrev_b32 v5, 1, v0
    v_and_or_b32 v4, v5, 12, v4
    s_mov_b32 s16, 0
L_hl_poll:
    global_load_dword v5, v4, s[12:13] sc1
    s_add_u32 s16, s16, 1
    s_cmp_gt_u32 s16, 100000
    s_cbranch_scc1 L_abort
    s_mov_b32 s6, 0
    s_waitcnt vmcnt(0)
    v_readlane_b32 s40, v5, 0
    s_nop 0
    s_add_u32 s6, s6, s40
    v_readlane_b32 s41, v5, 1
    s_nop 0
    s_add_u32 s6, s6, s41
    v_readlane_b32 s42, v5, 2
    s_nop 0
    s_add_u32 s6, s6, s42
    v_readlane_b32 s43, v5, 3
    s_nop 0
    s_add_u32 s6, s6, s43
    v_readlane_b32 s44, v5, 4
    s_nop 0
    s_add_u32 s6, s6, s44
    v_readlane_b32 s45, v5, 5
    s_nop 0
    s_add_u32 s6, s6, s45
    v_readlane_b32 s46, v5, 6
    s_nop 0
    s_add_u32 s6, s6, s46
    v_readlane_b32 s47, v5, 7
    s_nop 0
    s_add_u32 s6, s6, s47
    s_cmp_lt_u32 s6, 256
    s_cbranch_scc1 L_hl_poll
    s_mov_b32 s3, 0
    s_mov_b32 s4, 0
    s_min_u32 s6, s47, 32
    s_sub_u32 s7, 32, s6
    s_cmp_lt_u32 s5, s7
    s_cselect_b32 s3, 7, s3
    s_add_u32 s6, s6, s5
    s_cmp_lt_u32 s5, s7
    s_cselect_b32 s4, s6, s4
    s_sub_u32 s5, s5, s7
    s_min_u32 s6, s46, 32
    s_sub_u32 s7, 32, s6
    s_cmp_lt_u32 s5, s7
    s_cselect_b32 s3, 6, s3
    s_add_u32 s6, s6, s5
    s_cmp_lt_u32 s5, s7
    s_cselect_b32 s4, s6, s4
    s_sub_u32 s5, s5, s7
    s_min_u32 s6, s45, 32
    s_sub_u32 s7, 32, s6
    s_cmp_lt_u32 s5, s7
    s_cselect_b32 s3, 5, s3
    s_add_u32 s6, s6, s5
    s_cmp_lt_u32 s5, s7
    s_cselect_b32 s4, s6, s4
    s_sub_u32 s5, s5, s7
    s_min_u32 s6, s44, 32
    s_sub_u32 s7, 32, s6
    s_cmp_lt_u32 s5, s7
    s_cselect_b32 s3, 4, s3
    s_add_u32 s6, s6, s5
    s_cmp_lt_u32 s5, s7
    s_cselect_b32 s4, s6, s4
    s_sub_u32 s5, s5, s7
    s_min_u32 s6, s43, 32
    s_sub_u32 s7, 32, s6
    s_cmp_lt_u32 s5, s7
    s_cselect_b32 s3, 3, s3
    s_add_u32 s6, s6, s5
    s_cmp_lt_u32 s5, s7
    s_cselect_b32 s4, s6, s4
    s_sub_u32 s5, s5, s7
    s_min_u32 s6, s42, 32
    s_sub_u32 s7, 32, s6
    s_cmp_lt_u32 s5, s7
    s_cselect_b32 s3, 2, s3
    s_add_u32 s6, s6, s5
    s_cmp_lt_u32 s5, s7
    s_cselect_b32 s4, s6, s4
    s_sub_u32 s5, s5, s7
    s_min_u32 s6, s41, 32
    s_sub_u32 s7, 32, s6
    s_cmp_lt_u32 s5, s7
    s_cselect_b32 s3, 1, s3
    s_add_u32 s6, s6, s5
    s_cmp_lt_u32 s5, s7
    s_cselect_b32 s4, s6, s4
    s_sub_u32 s5, s5, s7
    s_min_u32 s6, s40, 32
    s_sub_u32 s7, 32, s6
    s_cmp_lt_u32 s5, s7
    s_cselect_b32 s3, 0, s3
    s_add_u32 s6, s6, s5
    s_cmp_lt_u32 s5, s7
    s_cselect_b32 s4, s6, s4
    s_sub_u32 s5, s5, s7
L_tk_have:
    s_lshl_b32 s5, s3, 8
    s_or_b32 s5, s5, s4
    v_mov_b32 v3, s5
    s_mov_b64 exec, 1
    ds_write_b32 v2, v3
    s_mov_b64 exec, -1
L_tk_wait:
    s_waitcnt vmcnt(0) lgkmcnt(0)
    s_barrier
    ds_read_b32 v3, v2
    s_waitcnt lgkmcnt(0)
    v_readfirstlane_b32 s5, v3
    s_nop 0
    s_lshr_b32 s3, s5, 8
    s_and_b32 s4, s5, 255
    s_barrier
    s_cmp_lt_u32 s3, 2
    s_cbranch_scc1 L_role_r
    s_sub_u32 s6, s3, 2
    s_lshl_b32 s6, s6, 5
    s_add_u32 s6, s6, s4
    s_load_dwordx2 s[20:21], s[0:1], 0
    s_mov_b32 s22, 2359296
    s_mov_b32 s23, 0x00020000
    s_waitcnt lgkmcnt(0)
    s_and_b32 s21, s21, 0xffff
    s_load_dwordx2 s[24:25], s[0:1], 8
    s_mov_b32 s26, 1990656
    s_mov_b32 s27, 0x00020000
    s_waitcnt lgkmcnt(0)
    s_and_b32 s25, s25, 0xffff
    v_and_b32 v2, 15, v0
    v_bfe_u32 v3, v0, 4, 2
    v_mul_u32_u24 v3, 27648, v3
    v_and_b32 v4, 63, v0
    v_lshlrev_b32 v4, 4, v4
    v_lshl_add_u32 v16, v2, 1, v3
    v_add_u32 v17, 1152, v16
    v_add_u32 v19, 2304, v16
    v_mov_b32 v5, 0x7f000000
    v_add_u32 v18, 32, v16
    v_add_u32 v6, 1180, v16
    v_cmp_gt_u32 vcc, 2, v2
    s_nop 1
    v_cndmask_b32 v18, v6, v18, vcc
    v_add_u32 v20, 2336, v16
    v_cndmask_b32 v20, v5, v20, vcc
    v_cmp_gt_u32 vcc, 4, v2
    s_nop 1
    v_cndmask_b32 v18, v5, v18, vcc
    s_mul_i32 s42, s6, 13108
    s_lshr_b32 s42, s42, 16
    s_mul_i32 s43, s42, 5
    s_sub_u32 s44, s6, s43
    s_mul_i32 s42, s42, 36
    s_mul_i32 s43, s14, 110592
    s_add_u32 s42, s42, s43
    s_mul_i32 s46, s6, 18432
    s_lshl_b32 s43, s14, 10
    s_add_u32 s46, s46, s43
    s_add_u32 s46, s46, 22020096
    s_cmp_ge_u32 s6, 160
    s_cselect_b32 s42, 0x7f000000, s42
    s_cselect_b32 s46, 0x7f000000, s46
    s_cmp_lt_u32 s14, 2
    s_cselect_b32 s47, s46, 0x7f000000
    s_add_u32 s47, s47, 16384
    v_mov_b32 v21, v16
    s_cmp_eq_u32 s44, 1
    s_cselect_b64 vcc, -1, 0
    v_cndmask_b32 v21, v21, v17, vcc
    s_cmp_eq_u32 s44, 2
    s_cselect_b64 vcc, -1, 0
    v_cndmask_b32 v21, v21, v18, vcc
    s_cmp_eq_u32 s44, 3
    s_cselect_b64 vcc, -1, 0
    v_cndmask_b32 v21, v21, v19, vcc
    s_cmp_eq_u32 s44, 4
    s_cselect_b64 vcc, -1, 0
    v_cndmask_b32 v21, v21, v20, vcc
    buffer_load_ushort v100, v21, s[24:27], s42 offen
    s_add_u32 s42, s42, 3456
    buffer_load_ushort v101, v21, s[24:27], s42 offen
    s_add_u32 s42, s42, 3456
    buffer_load_ushort v102, v21, s[24:27], s42 offen
    s_add_u32 s42, s42, 3456
    buffer_load_ushort v103, v21, s[24:27], s42 offen
    s_add_u32 s42, s42, 3456
    buffer_load_ushort v104, v21, s[24:27], s42 offen
    s_add_u32 s42, s42, 3456
    buffer_load_ushort v105, v21, s[24:27], s42 offen
    s_add_u32 s42, s42, 3456
    buffer_load_ushort v106, v21, s[24:27], s42 offen
    s_add_u32 s42, s42, 3456
    buffer_load_ushort v107, v21, s[24:27], s42 offen
    s_add_u32 s42, s42, 418176
    buffer_load_ushort v108, v21, s[24:27], s42 offen
    s_add_u32 s42, s42, 3456
    buffer_load_ushort v109, v21, s[24:27], s42 offen
    s_add_u32 s42, s42, 3456
    buffer_load_ushort v110, v21, s[24:27], s42 offen
    s_add_u32 s42, s42, 3456
    buffer_load_ushort v111, v21, s[24:27], s42 offen
    s_add_u32 s42, s42, 3456
    buffer_load_ushort v112, v21, s[24:27], s42 offen
    s_add_u32 s42, s42, 3456
    buffer_load_ushort v113, v21, s[24:27], s42 offen
    s_add_u32 s42, s42, 3456
    buffer_load_ushort v114, v21, s[24:27], s42 offen
    s_add_u32 s42, s42, 3456
    buffer_load_ushort v115, v21, s[24:27], s42 offen
    s_add_u32 s42, s42, 418176
    buffer_load_ushort v116, v21, s[24:27], s42 offen
    s_add_u32 s42, s42, 3456
    buffer_load_ushort v117, v21, s[24:27], s42 offen
    s_add_u32 s42, s42, 3456
    buffer_load_ushort v118, v21, s[24:27], s42 offen
    s_add_u32 s42, s42, 3456
    buffer_load_ushort v119, v21, s[24:27], s42 offen
    s_add_u32 s42, s42, 3456
    buffer_load_ushort v120, v21, s[24:27], s42 offen
    s_add_u32 s42, s42, 3456
    buffer_load_ushort v121, v21, s[24:27], s42 offen
    s_add_u32 s42, s42, 3456
    buffer_load_ushort v122, v21, s[24:27], s42 offen
    s_add_u32 s42, s42, 3456
    buffer_load_ushort v123, v21, s[24:27], s42 offen
    s_add_u32 s42, s42, 418176
    buffer_load_ushort v124, v21, s[24:27], s42 offen
    s_add_u32 s42, s42, 3456
    buffer_load_ushort v125, v21, s[24:27], s42 offen
    s_add_u32 s42, s42, 3456
    buffer_load_ushort v126, v21, s[24:27], s42 offen
    s_add_u32 s42, s42, 3456
    buffer_load_ushort v127, v21, s[24:27], s42 offen
    s_add_u32 s42, s42, 3456
    buffer_load_ushort v128, v21, s[24:27], s42 offen
    s_add_u32 s42, s42, 3456
    buffer_load_ushort v129, v21, s[24:27], s42 offen
    s_add_u32 s42, s42, 3456
    buffer_load_ushort v130, v21, s[24:27], s42 offen
    s_add_u32 s42, s42, 3456
    buffer_load_ushort v131, v21, s[24:27], s42 offen
    s_add_u32 s42, s42, 418176
    buffer_load_ushort v132, v21, s[24:27], s42 offen
    s_add_u32 s42, s42, 3456
    buffer_load_ushort v133, v21, s[24:27], s42 offen
    s_add_u32 s42, s42, 3456
    buffer_load_ushort v134, v21, s[24:27], s42 offen
    s_add_u32 s42, s42, 3456
    buffer_load_ushort v135, v21, s[24:27], s42 offen
    s_add_u32 s42, s42, 3456
    buffer_load_ushort v136, v21, s[24:27], s42 offen
    s_add_u32 s42, s42, 3456
    buffer_load_ushort v137, v21, s[24:27], s42 offen
    s_add_u32 s42, s42, 3456
    buffer_load_ushort v138, v21, s[24:27], s42 offen
    s_add_u32 s42, s42, 3456
    buffer_load_ushort v139, v21, s[24:27], s42 offen
    s_add_u32 s42, s42, 418176
    v_and_b32 v1, 31, v0
    v_lshrrev_b32 v2, 5, v0
    v_mul_u32_u24 v3, 1152, v1
    v_mul_u32_u24 v5, 144, v2
    v_add_u32 v3, v3, v5
    s_mul_i32 s41, s6, 36864
    buffer_load_dwordx4 v[64:67], v3, s[20:23], s41 offen offset:0
    buffer_load_dwordx4 v[68:71], v3, s[20:23], s41 offen offset:16
    buffer_load_dwordx4 v[72:75], v3, s[20:23], s41 offen offset:32
    buffer_load_dwordx4 v[76:79], v3, s[20:23], s41 offen offset:48
    buffer_load_dwordx4 v[80:83], v3, s[20:23], s41 offen offset:64
    buffer_load_dwordx4 v[84:87], v3, s[20:23], s41 offen offset:80
    buffer_load_dwordx4 v[88:91], v3, s[20:23], s41 offen offset:96
    buffer_load_dwordx4 v[92:95], v3, s[20:23], s41 offen offset:112
    buffer_load_dwordx4 v[96:99], v3, s[20:23], s41 offen offset:128
    v_lshlrev_b32 v7, 4, v0
    v_mov_b32 v12, 0
    v_mov_b32 v13, 0
    v_mov_b32 v14, 0
    v_mov_b32 v15, 0
    s_waitcnt vmcnt(47)
    v_lshl_or_b32 v56, v101, 16, v100
    s_waitcnt vmcnt(45)
    v_lshl_or_b32 v57, v103, 16, v102
    s_waitcnt vmcnt(43)
    v_lshl_or_b32 v58, v105, 16, v104
    s_waitcnt vmcnt(41)
    v_lshl_or_b32 v59, v107, 16, v106
    buffer_store_dwordx4 v[56:59], v4, s[8:11], s46 offen sc1
    s_add_u32 s46, s46, 4096
    s_waitcnt vmcnt(40)
    v_lshl_or_b32 v56, v109, 16, v108
    s_waitcnt vmcnt(38)
    v_lshl_or_b32 v57, v111, 16, v110
    s_waitcnt vmcnt(36)
    v_lshl_or_b32 v58, v113, 16, v112
    s_waitcnt vmcnt(34)
    v_lshl_or_b32 v59, v115, 16, v114
    buffer_store_dwordx4 v[56:59], v4, s[8:11], s46 offen sc1
    s_add_u32 s46, s46, 4096
    s_waitcnt vmcnt(33)
    v_lshl_or_b32 v56, v117, 16, v116
    s_waitcnt vmcnt(31)
    v_lshl_or_b32 v57, v119, 16, v118
    s_waitcnt vmcnt(29)
    v_lshl_or_b32 v58, v121, 16, v120
    s_waitcnt vmcnt(27)
    v_lshl_or_b32 v59, v123, 16, v122
    buffer_store_dwordx4 v[56:59], v4, s[8:11], s46 offen sc1
    s_add_u32 s46, s46, 4096
    s_waitcnt vmcnt(26)
    v_lshl_or_b32 v56, v125, 16, v124
    s_waitcnt vmcnt(24)
    v_lshl_or_b32 v57, v127, 16, v126
    s_waitcnt vmcnt(22)
    v_lshl_or_b32 v58, v129, 16, v128
    s_waitcnt vmcnt(20)
    v_lshl_or_b32 v59, v131, 16, v130
    buffer_store_dwordx4 v[56:59], v4, s[8:11], s46 offen sc1
    s_add_u32 s46, s46, 4096
    s_waitcnt vmcnt(19)
    v_lshl_or_b32 v56, v133, 16, v132
    s_waitcnt vmcnt(17)
    v_lshl_or_b32 v57, v135, 16, v134
    s_waitcnt vmcnt(15)
    v_lshl_or_b32 v58, v137, 16, v136
    s_waitcnt vmcnt(13)
    v_lshl_or_b32 v59, v139, 16, v138
    buffer_store_dwordx4 v[56:59], v4, s[8:11], s47 offen sc1
    s_add_u32 s46, s46, 4096
    s_cmp_ge_u32 s6, 64
    s_cbranch_scc1 Li_rest
    v_mul_u32_u24 v4, 4608, v2
    v_lshl_add_u32 v4, v1, 4, v4
    s_mul_i32 s41, s6, 36864
    s_add_u32 s41, s41, 6291456
    s_mul_i32 s42, s6, 6144
    s_add_u32 s42, s42, 15728640
    s_add_u32 s43, s42, 2048
    v_mov_b32 v60, 0
    v_mov_b32 v61, 0
    s_waitcnt vmcnt(13)
    buffer_store_dwordx4 v[64:67], v4, s[8:11], s41 offen offset:0 sc1
    s_waitcnt vmcnt(13)
    buffer_store_dwordx4 v[68:71], v4, s[8:11], s41 offen offset:512 sc1
    s_waitcnt vmcnt(13)
    buffer_store_dwordx4 v[72:75], v4, s[8:11], s41 offen offset:1024 sc1
    s_waitcnt vmcnt(13)
    buffer_store_dwordx4 v[76:79], v4, s[8:11], s41 offen offset:1536 sc1
    s_waitcnt vmcnt(13)
    buffer_store_dwordx4 v[80:83], v4, s[8:11], s41 offen offset:2048 sc1
    s_waitcnt vmcnt(13)
    buffer_store_dwordx4 v[84:87], v4, s[8:11], s41 offen offset:2560 sc1
    s_waitcnt vmcnt(13)
    buffer_store_dwordx4 v[88:91], v4, s[8:11], s41 offen offset:3072 sc1
    s_waitcnt vmcnt(13)
    buffer_store_dwordx4 v[92:95], v4, s[8:11], s41 offen offset:3584 sc1
    v_add_u32 v4, 4096, v4
    s_waitcnt vmcnt(13)
    buffer_store_dwordx4 v[96:99], v4, s[8:11], s41 offen offset:0 sc1
    buffer_store_dwordx4 v[12:15], v7, s[8:11], s43 offen sc1
    v_mov_b32 v62, 0x3f803f80
    v_dot2c_f32_bf16 v60, v64, v62
    v_dot2c_f32_bf16 v61, v64, v64
    v_dot2c_f32_bf16 v60, v65, v62
    v_dot2c_f32_bf16 v61, v65, v65
    v_dot2c_f32_bf16 v60, v66, v62
    v_dot2c_f32_bf16 v61, v66, v66
    v_dot2c_f32_bf16 v60, v67, v62
    v_dot2c_f32_bf16 v61, v67, v67
    v_dot2c_f32_bf16 v60, v68, v62
    v_dot2c_f32_bf16 v61, v68, v68
    v_dot2c_f32_bf16 v60, v69, v62
    v_dot2c_f32_bf16 v61, v69, v69
    v_dot2c_f32_bf16 v60, v70, v62
    v_dot2c_f32_bf16 v61, v70, v70
    v_dot2c_f32_bf16 v60, v71, v62
    v_dot2c_f32_bf16 v61, v71, v71
    v_dot2c_f32_bf16 v60, v72, v62
    v_dot2c_f32_bf16 v61, v72, v72
    v_dot2c_f32_bf16 v60, v73, v62
    v_dot2c_f32_bf16 v61, v73, v73
    v_dot2c_f32_bf16 v60, v74, v62
    v_dot2c_f32_bf16 v61, v74, v74
    v_dot2c_f32_bf16 v60, v75, v62
    v_dot2c_f32_bf16 v61, v75, v75
    v_dot2c_f32_bf16 v60, v76, v62
    v_dot2c_f32_bf16 v61, v76, v76
    v_dot2c_f32_bf16 v60, v77, v62
    v_dot2c_f32_bf16 v61, v77, v77
    v_dot2c_f32_bf16 v60, v78, v62
    v_dot2c_f32_bf16 v61, v78, v78
    v_dot2c_f32_bf16 v60, v79, v62
    v_dot2c_f32_bf16 v61, v79, v79
    v_dot2c_f32_bf16 v60, v80, v62
    v_dot2c_f32_bf16 v61, v80, v80
    v_dot2c_f32_bf16 v60, v81, v62
    v_dot2c_f32_bf16 v61, v81, v81
    v_dot2c_f32_bf16 v60, v82, v62
    v_dot2c_f32_bf16 v61, v82, v82
    v_dot2c_f32_bf16 v60, v83, v62
    v_dot2c_f32_bf16 v61, v83, v83
    v_dot2c_f32_bf16 v60, v84, v62
    v_dot2c_f32_bf16 v61, v84, v84
    v_dot2c_f32_bf16 v60, v85, v62
    v_dot2c_f32_bf16 v61, v85, v85
    v_dot2c_f32_bf16 v60, v86, v62
    v_dot2c_f32_bf16 v61, v86, v86
    v_dot2c_f32_bf16 v60, v87, v62
    v_dot2c_f32_bf16 v61, v87, v87
    v_dot2c_f32_bf16 v60, v88, v62
    v_dot2c_f32_bf16 v61, v88, v88
    v_dot2c_f32_bf16 v60, v89, v62
    v_dot2c_f32_bf16 v61, v89, v89
    v_dot2c_f32_bf16 v60, v90, v62
    v_dot2c_f32_bf16 v61, v90, v90
    v_dot2c_f32_bf16 v60, v91, v62
    v_dot2c_f32_bf16 v61, v91, v91
    v_dot2c_f32_bf16 v60, v92, v62
    v_dot2c_f32_bf16 v61, v92, v92
    v_dot2c_f32_bf16 v60, v93, v62
    v_dot2c_f32_bf16 v61, v93, v93
    v_dot2c_f32_bf16 v60, v94, v62
    v_dot2c_f32_bf16 v61, v94, v94
    v_dot2c_f32_bf16 v60, v95, v62
    v_dot2c_f32_bf16 v61, v95, v95
    v_dot2c_f32_bf16 v60, v96, v62
    v_dot2c_f32_bf16 v61, v96, v96
    v_dot2c_f32_bf16 v60, v97, v62
    v_dot2c_f32_bf16 v61, v97, v97
    v_dot2c_f32_bf16 v60, v98, v62
    v_dot2c_f32_bf16 v61, v98, v98
    v_dot2c_f32_bf16 v60, v99, v62
    v_dot2c_f32_bf16 v61, v99, v99
    s_nop 3
    v_lshrrev_b32 v5, 1, v2
    v_lshlrev_b32 v5, 9, v5
    v_lshl_add_u32 v5, v1, 4, v5
    v_and_b32 v6, 1, v2
    v_lshl_add_u32 v5, v6, 3, v5
    buffer_store_dwordx2 v[60:61], v5, s[8:11], s42 offen sc1
    s_branch Li_done
Li_rest:
    s_sub_u32 s41, s6, 64
    s_lshr_b32 s42, s41, 6
    s_and_b32 s41, s41, 63
    s_mul_i32 s42, s42, 786432
    s_mul_i32 s41, s41, 6144
    s_add_u32 s41, s41, s42
    s_add_u32 s41, s41, 16126464
    v_cmp_gt_u32 vcc, 96, v0
    s_nop 0
    s_and_saveexec_b64 s[42:43], vcc
    s_cbranch_execz Li_rest2
    buffer_store_dwordx4 v[12:15], v7, s[8:11], s41 offen sc1
Li_rest2:
    s_mov_b64 exec, s[42:43]
Li_done:
    s_waitcnt vmcnt(0)
    s_barrier
    s_cmp_lg_u32 s14, 0
    s_cbranch_scc1 Li_mid
    v_mov_b32 v2, 40
    v_mov_b32 v3, 1
    s_mov_b64 exec, 1
    global_atomic_add v2, v3, s[12:13]
    s_mov_b64 exec, -1
Li_mid:
    v_lshlrev_b32 v7, 4, v0
    v_cmp_gt_u32 vcc, 96, v0
    s_cmp_lt_u32 s6, 64
    s_cselect_b64 s[42:43], -1, 0
    s_and_b64 vcc, vcc, s[42:43]
    s_cmp_lt_u32 s6, 128
    s_cselect_b32 s44, 0, 0
    v_mov_b32 v12, s44
    v_mov_b32 v13, s44
    v_mov_b32 v14, s44
    v_mov_b32 v15, s44
    v_mov_b32 v9, 1
    v_cndmask_b32 v8, v12, v9, vcc
    v_mov_b32 v9, v8
    v_mov_b32 v10, v8
    v_mov_b32 v11, v8
    s_cmp_ge_u32 s6, 136
    s_cbranch_scc1 Li_nofl
    s_mul_i32 s41, s6, 22528
    s_sub_u32 s42, s6, 128
    s_lshl_b32 s42, s42, 12
    s_add_u32 s42, s42, 2883584
    s_cmp_ge_u32 s6, 128
    s_cselect_b32 s41, s42, s41
    buffer_store_dwordx4 v[8:11], v7, s[8:11], s41 offen sc1
    s_cbranch_scc1 Li_nofl
    s_add_u32 s41, s41, 4096
    buffer_store_dwordx4 v[12:15], v7, s[8:11], s41 offen sc1
    s_add_u32 s41, s41, 4096
    buffer_store_dwordx4 v[12:15], v7, s[8:11], s41 offen sc1
    s_add_u32 s41, s41, 4096
    buffer_store_dwordx4 v[12:15], v7, s[8:11], s41 offen sc1
    s_add_u32 s41, s41, 4096
    buffer_store_dwordx4 v[12:15], v7, s[8:11], s41 offen sc1
    s_add_u32 s41, s41, 4096
    v_cmp_gt_u32 vcc, 128, v0
    s_nop 0
    s_and_saveexec_b64 s[42:43], vcc
    s_cbranch_execz Li_fl5
    buffer_store_dwordx4 v[12:15], v7, s[8:11], s41 offen sc1
Li_fl5:
    s_mov_b64 exec, s[42:43]
Li_nofl:
    s_waitcnt vmcnt(0)
    s_barrier
    s_cmp_lg_u32 s14, 0
    s_cbranch_scc1 Li_end
    v_mov_b32 v2, 160
    v_mov_b32 v3, 1
    s_mov_b64 exec, 1
    global_atomic_add v2, v3, s[12:13]
    s_mov_b64 exec, -1
Li_end:
    s_cmp_lg_u32 s3, 2
    s_cbranch_scc1 L_cls2_no
    s_add_u32 s15, s4, 0
    s_cmp_lt_u32 s4, 24
    s_cbranch_scc1 L_role_tw
    s_add_u32 s15, s4, 4294967272
    s_cmp_lt_u32 s4, 32
    s_cbranch_scc1 L_role_p
    s_endpgm
L_cls2_no:
    s_cmp_lg_u32 s3, 3
    s_cbranch_scc1 L_cls3_no
    s_add_u32 s15, s4, 24
    s_cmp_lt_u32 s4, 12
    s_cbranch_scc1 L_role_tw
    s_add_u32 s15, s4, 4294967292
    s_cmp_lt_u32 s4, 32
    s_cbranch_scc1 L_role_p
    s_endpgm
L_cls3_no:
    s_cmp_lg_u32 s3, 4
    s_cbranch_scc1 L_cls4_no
    s_add_u32 s15, s4, 0
    s_cmp_lt_u32 s4, 16
    s_cbranch_scc1 L_role_aq
    s_add_u32 s15, s4, 4294967280
    s_cmp_lt_u32 s4, 21
    s_cbranch_scc1 L_role_awo
    s_add_u32 s15, s4, 7
    s_cmp_lt_u32 s4, 32
    s_cbranch_scc1 L_role_p
    s_endpgm
L_cls4_no:
    s_cmp_lg_u32 s3, 5
    s_cbranch_scc1 L_cls5_no
    s_add_u32 s15, s4, 16
    s_cmp_lt_u32 s4, 16
    s_cbranch_scc1 L_role_aq
    s_add_u32 s15, s4, 4294967285
    s_cmp_lt_u32 s4, 21
    s_cbranch_scc1 L_role_awo
    s_add_u32 s15, s4, 18
    s_cmp_lt_u32 s4, 32
    s_cbranch_scc1 L_role_p
    s_endpgm
L_cls5_no:
    s_cmp_lg_u32 s3, 6
    s_cbranch_scc1 L_cls6_no
    s_add_u32 s15, s4, 0
    s_cmp_lt_u32 s4, 8
    s_cbranch_scc1 L_role_ta
    s_add_u32 s15, s4, 42
    s_cmp_lt_u32 s4, 31
    s_cbranch_scc1 L_role_p
    s_endpgm
L_cls6_no:
    s_cmp_lg_u32 s3, 7
    s_cbranch_scc1 L_cls7_no
    s_add_u32 s15, s4, 8
    s_cmp_lt_u32 s4, 8
    s_cbranch_scc1 L_role_ta
    s_add_u32 s15, s4, 65
    s_cmp_lt_u32 s4, 31
    s_cbranch_scc1 L_role_p
    s_endpgm
L_cls7_no:
L_exit:
    s_endpgm
L_abort:
    s_waitcnt lgkmcnt(0)
    s_mov_b64 exec, -1
    v_mov_b32 v0, 60
    s_lshl_b32 s5, s3, 8
    s_or_b32 s5, s5, s4
    s_or_b32 s5, s5, 0x10000
    v_mov_b32 v1, s5
    global_store_dword v0, v1, s[12:13]
    s_endpgm
.p2align 6
L_role_p:
    v_and_b32 v5, 63, v0
    v_lshlrev_b32 v0, 4, v5
    v_and_b32 v7, 15, v5
    v_lshrrev_b32 v8, 4, v5
    v_min_u32 v1, 17, v5
    v_lshrrev_b32 v6, 2, v1
    v_and_b32 v1, 3, v1
    v_lshlrev_b32 v1, 2, v1
    v_lshl_add_u32 v1, v6, 7, v1
    v_mov_b32 v3, 1
    v_mov_b32 v4, 0
    s_mov_b32 s44, 0x05040100
    s_mov_b32 s45, 0x07060302
    s_lshr_b32 s50, s15, 5
    s_and_b32 s51, s15, 31
    s_lshl_b32 s17, s50, 3
    s_add_u32 s17, s17, 40
    s_load_dwordx2 s[20:21], s[0:1], s17
    s_mov_b32 s22, 4718592
    s_mov_b32 s23, 0x00020000
    s_lshl_b32 s49, s51, 8
    s_lshl_b32 s17, s14, 6
    s_add_u32 s49, s49, s17
    v_bfe_u32 v10, v0, 4, 5
    v_and_b32 v14, 19, v10
    v_bfe_u32 v5, v10, 2, 1
    v_lshl_add_u32 v14, v5, 3, v14
    v_bfe_u32 v5, v10, 3, 1
    v_lshl_add_u32 v14, v5, 2, v14
    v_and_b32 v5, 1, v14
    v_lshrrev_b32 v14, 1, v14
    v_lshl_add_u32 v14, v5, 4, v14
    v_bfe_u32 v5, v0, 8, 1
    v_lshl_add_u32 v6, v5, 4, v7
    s_cmp_eq_u32 s50, 2
    s_cselect_b64 vcc, -1, 0
    v_cndmask_b32 v14, v14, v6, vcc
    v_and_b32 v5, 1, v14
    v_mov_b32 v11, s44
    v_mov_b32 v6, s45
    v_cmp_eq_u32 vcc, 1, v5
    s_nop 1
    v_cndmask_b32 v11, v11, v6, vcc
    v_and_b32 v14, 30, v14
    v_lshrrev_b32 v5, 9, v0
    v_lshlrev_b32 v12, 16, v5
    v_lshl_add_u32 v12, v14, 1, v12
    v_add_u32 v13, 8192, v12
    v_lshlrev_b32 v10, 4, v10
    v_mul_u32_u24 v6, 2560, v5
    v_add_u32 v10, v10, v6
    v_add_u32 v10, 114688, v10
    s_lshl_b32 s67, s14, 10
    v_bfe_u32 v6, v0, 8, 1
    v_lshlrev_b32 v14, 10, v6
    v_lshl_add_u32 v14, v7, 4, v14
    v_lshl_add_u32 v14, v5, 8, v14
    s_waitcnt lgkmcnt(0)
    s_and_b32 s21, s21, 0xffff
    s_add_u32 s17, s49, 0
    buffer_load_dword v16, v12, s[20:23], s17 offen
    buffer_load_dword v17, v13, s[20:23], s17 offen
    s_add_u32 s17, s49, 16384
    buffer_load_dword v18, v12, s[20:23], s17 offen
    buffer_load_dword v19, v13, s[20:23], s17 offen
    s_add_u32 s17, s49, 32768
    buffer_load_dword v20, v12, s[20:23], s17 offen
    buffer_load_dword v21, v13, s[20:23], s17 offen
    s_add_u32 s17, s49, 49152
    buffer_load_dword v22, v12, s[20:23], s17 offen
    buffer_load_dword v23, v13, s[20:23], s17 offen
    s_add_u32 s17, s49, 131072
    buffer_load_dword v24, v12, s[20:23], s17 offen
    buffer_load_dword v25, v13, s[20:23], s17 offen
    s_add_u32 s17, s49, 147456
    buffer_load_dword v26, v12, s[20:23], s17 offen
    buffer_load_dword v27, v13, s[20:23], s17 offen
    s_add_u32 s17, s49, 163840
    buffer_load_dword v28, v12, s[20:23], s17 offen
    buffer_load_dword v29, v13, s[20:23], s17 offen
    s_add_u32 s17, s49, 180224
    buffer_load_dword v30, v12, s[20:23], s17 offen
    buffer_load_dword v31, v13, s[20:23], s17 offen
    s_add_u32 s17, s49, 262144
    buffer_load_dword v32, v12, s[20:23], s17 offen
    buffer_load_dword v33, v13, s[20:23], s17 offen
    s_add_u32 s17, s49, 278528
    buffer_load_dword v34, v12, s[20:23], s17 offen
    buffer_load_dword v35, v13, s[20:23], s17 offen
    s_add_u32 s17, s49, 294912
    buffer_load_dword v36, v12, s[20:23], s17 offen
    buffer_load_dword v37, v13, s[20:23], s17 offen
    s_add_u32 s17, s49, 311296
    buffer_load_dword v38, v12, s[20:23], s17 offen
    buffer_load_dword v39, v13, s[20:23], s17 offen
    s_add_u32 s17, s49, 393216
    buffer_load_dword v40, v12, s[20:23], s17 offen
    buffer_load_dword v41, v13, s[20:23], s17 offen
    s_add_u32 s17, s49, 409600
    buffer_load_dword v42, v12, s[20:23], s17 offen
    buffer_load_dword v43, v13, s[20:23], s17 offen
    s_add_u32 s17, s49, 425984
    buffer_load_dword v44, v12, s[20:23], s17 offen
    buffer_load_dword v45, v13, s[20:23], s17 offen
    s_add_u32 s17, s49, 442368
    buffer_load_dword v46, v12, s[20:23], s17 offen
    buffer_load_dword v47, v13, s[20:23], s17 offen
    s_add_u32 s17, s49, 524288
    buffer_load_dword v48, v12, s[20:23], s17 offen
    buffer_load_dword v49, v13, s[20:23], s17 offen
    s_add_u32 s17, s49, 540672
    buffer_load_dword v50, v12, s[20:23], s17 offen
    buffer_load_dword v51, v13, s[20:23], s17 offen
    s_add_u32 s17, s49, 557056
    buffer_load_dword v52, v12, s[20:23], s17 offen
    buffer_load_dword v53, v13, s[20:23], s17 offen
    s_add_u32 s17, s49, 573440
    buffer_load_dword v54, v12, s[20:23], s17 offen
    buffer_load_dword v55, v13, s[20:23], s17 offen
    s_add_u32 s17, s49, 655360
    buffer_load_dword v56, v12, s[20:23], s17 offen
    buffer_load_dword v57, v13, s[20:23], s17 offen
    s_add_u32 s17, s49, 671744
    buffer_load_dword v58, v12, s[20:23], s17 offen
    buffer_load_dword v59, v13, s[20:23], s17 offen
    s_add_u32 s17, s49, 688128
    buffer_load_dword v60, v12, s[20:23], s17 offen
    buffer_load_dword v61, v13, s[20:23], s17 offen
    s_add_u32 s17, s49, 704512
    buffer_load_dword v62, v12, s[20:23], s17 offen
    buffer_load_dword v63, v13, s[20:23], s17 offen
    s_add_u32 s17, s49, 786432
    buffer_load_dword v64, v12, s[20:23], s17 offen
    buffer_load_dword v65, v13, s[20:23], s17 offen
    s_add_u32 s17, s49, 802816
    buffer_load_dword v66, v12, s[20:23], s17 offen
    buffer_load_dword v67, v13, s[20:23], s17 offen
    s_add_u32 s17, s49, 819200
    buffer_load_dword v68, v12, s[20:23], s17 offen
    buffer_load_dword v69, v13, s[20:23], s17 offen
    s_add_u32 s17, s49, 835584
    buffer_load_dword v70, v12, s[20:23], s17 offen
    buffer_load_dword v71, v13, s[20:23], s17 offen
    s_add_u32 s17, s49, 917504
    buffer_load_dword v72, v12, s[20:23], s17 offen
    buffer_load_dword v73, v13, s[20:23], s17 offen
    s_waitcnt vmcnt(56)
    v_perm_b32 v112, v17, v16, v11
    s_add_u32 s17, s49, 933888
    buffer_load_dword v74, v12, s[20:23], s17 offen
    buffer_load_dword v75, v13, s[20:23], s17 offen
    s_waitcnt vmcnt(56)
    v_perm_b32 v113, v19, v18, v11
    s_add_u32 s17, s49, 950272
    buffer_load_dword v76, v12, s[20:23], s17 offen
    buffer_load_dword v77, v13, s[20:23], s17 offen
    s_waitcnt vmcnt(56)
    v_perm_b32 v114, v21, v20, v11
    s_add_u32 s17, s49, 966656
    buffer_load_dword v78, v12, s[20:23], s17 offen
    buffer_load_dword v79, v13, s[20:23], s17 offen
    s_waitcnt vmcnt(56)
    v_perm_b32 v115, v23, v22, v11
    s_add_u32 s17, s49, 1048576
    buffer_load_dword v80, v12, s[20:23], s17 offen
    buffer_load_dword v81, v13, s[20:23], s17 offen
    s_waitcnt vmcnt(56)
    v_perm_b32 v116, v25, v24, v11
    s_add_u32 s17, s49, 1064960
    buffer_load_dword v82, v12, s[20:23], s17 offen
    buffer_load_dword v83, v13, s[20:23], s17 offen
    s_waitcnt vmcnt(56)
    v_perm_b32 v117, v27, v26, v11
    s_add_u32 s17, s49, 1081344
    buffer_load_dword v84, v12, s[20:23], s17 offen
    buffer_load_dword v85, v13, s[20:23], s17 offen
    s_waitcnt vmcnt(56)
    v_perm_b32 v118, v29, v28, v11
    s_add_u32 s17, s49, 1097728
    buffer_load_dword v86, v12, s[20:23], s17 offen
    buffer_load_dword v87, v13, s[20:23], s17 offen
    s_waitcnt vmcnt(56)
    v_perm_b32 v119, v31, v30, v11
    s_add_u32 s17, s49, 1179648
    buffer_load_dword v88, v12, s[20:23], s17 offen
    buffer_load_dword v89, v13, s[20:23], s17 offen
    s_waitcnt vmcnt(56)
    v_perm_b32 v120, v33, v32, v11
    s_add_u32 s17, s49, 1196032
    buffer_load_dword v90, v12, s[20:23], s17 offen
    buffer_load_dword v91, v13, s[20:23], s17 offen
    s_waitcnt vmcnt(56)
    v_perm_b32 v121, v35, v34, v11
    s_add_u32 s17, s49, 1212416
    buffer_load_dword v92, v12, s[20:23], s17 offen
    buffer_load_dword v93, v13, s[20:23], s17 offen
    s_waitcnt vmcnt(56)
    v_perm_b32 v122, v37, v36, v11
    s_add_u32 s17, s49, 1228800
    buffer_load_dword v94, v12, s[20:23], s17 offen
    buffer_load_dword v95, v13, s[20:23], s17 offen
    s_waitcnt vmcnt(56)
    v_perm_b32 v123, v39, v38, v11
    s_add_u32 s17, s49, 1310720
    buffer_load_dword v96, v12, s[20:23], s17 offen
    buffer_load_dword v97, v13, s[20:23], s17 offen
    s_waitcnt vmcnt(56)
    v_perm_b32 v124, v41, v40, v11
    s_add_u32 s17, s49, 1327104
    buffer_load_dword v98, v12, s[20:23], s17 offen
    buffer_load_dword v99, v13, s[20:23], s17 offen
    s_waitcnt vmcnt(56)
    v_perm_b32 v125, v43, v42, v11
    s_add_u32 s17, s49, 1343488
    buffer_load_dword v100, v12, s[20:23], s17 offen
    buffer_load_dword v101, v13, s[20:23], s17 offen
    s_waitcnt vmcnt(56)
    v_perm_b32 v126, v45, v44, v11
    s_add_u32 s17, s49, 1359872
    buffer_load_dword v102, v12, s[20:23], s17 offen
    buffer_load_dword v103, v13, s[20:23], s17 offen
    s_waitcnt vmcnt(56)
    v_perm_b32 v127, v47, v46, v11
    s_add_u32 s17, s49, 1441792
    buffer_load_dword v104, v12, s[20:23], s17 offen
    buffer_load_dword v105, v13, s[20:23], s17 offen
    s_waitcnt vmcnt(56)
    v_perm_b32 v128, v49, v48, v11
    s_add_u32 s17, s49, 1458176
    buffer_load_dword v106, v12, s[20:23], s17 offen
    buffer_load_dword v107, v13, s[20:23], s17 offen
    s_waitcnt vmcnt(56)
    v_perm_b32 v129, v51, v50, v11
    s_add_u32 s17, s49, 1474560
    buffer_load_dword v108, v12, s[20:23], s17 offen
    buffer_load_dword v109, v13, s[20:23], s17 offen
    s_waitcnt vmcnt(56)
    v_perm_b32 v130, v53, v52, v11
    s_add_u32 s17, s49, 1490944
    buffer_load_dword v110, v12, s[20:23], s17 offen
    buffer_load_dword v111, v13, s[20:23], s17 offen
    s_waitcnt vmcnt(56)
    v_perm_b32 v131, v55, v54, v11
    s_add_u32 s17, s49, 1572864
    buffer_load_dword v16, v12, s[20:23], s17 offen
    buffer_load_dword v17, v13, s[20:23], s17 offen
    s_waitcnt vmcnt(56)
    v_perm_b32 v132, v57, v56, v11
    s_add_u32 s17, s49, 1589248
    buffer_load_dword v18, v12, s[20:23], s17 offen
    buffer_load_dword v19, v13, s[20:23], s17 offen
    s_waitcnt vmcnt(56)
    v_perm_b32 v133, v59, v58, v11
    s_add_u32 s17, s49, 1605632
    buffer_load_dword v20, v12, s[20:23], s17 offen
    buffer_load_dword v21, v13, s[20:23], s17 offen
    s_waitcnt vmcnt(56)
    v_perm_b32 v134, v61, v60, v11
    s_add_u32 s17, s49, 1622016
    buffer_load_dword v22, v12, s[20:23], s17 offen
    buffer_load_dword v23, v13, s[20:23], s17 offen
    s_waitcnt vmcnt(56)
    v_perm_b32 v135, v63, v62, v11
    s_add_u32 s17, s49, 1703936
    buffer_load_dword v24, v12, s[20:23], s17 offen
    buffer_load_dword v25, v13, s[20:23], s17 offen
    s_waitcnt vmcnt(56)
    v_perm_b32 v136, v65, v64, v11
    s_add_u32 s17, s49, 1720320
    buffer_load_dword v26, v12, s[20:23], s17 offen
    buffer_load_dword v27, v13, s[20:23], s17 offen
    s_waitcnt vmcnt(56)
    v_perm_b32 v137, v67, v66, v11
    s_add_u32 s17, s49, 1736704
    buffer_load_dword v28, v12, s[20:23], s17 offen
    buffer_load_dword v29, v13, s[20:23], s17 offen
    s_waitcnt vmcnt(56)
    v_perm_b32 v138, v69, v68, v11
    s_add_u32 s17, s49, 1753088
    buffer_load_dword v30, v12, s[20:23], s17 offen
    buffer_load_dword v31, v13, s[20:23], s17 offen
    s_waitcnt vmcnt(56)
    v_perm_b32 v139, v71, v70, v11
    s_add_u32 s17, s49, 1835008
    buffer_load_dword v32, v12, s[20:23], s17 offen
    buffer_load_dword v33, v13, s[20:23], s17 offen
    s_waitcnt vmcnt(56)
    v_perm_b32 v140, v73, v72, v11
    s_add_u32 s17, s49, 1851392
    buffer_load_dword v34, v12, s[20:23], s17 offen
    buffer_load_dword v35, v13, s[20:23], s17 offen
    s_waitcnt vmcnt(56)
    v_perm_b32 v141, v75, v74, v11
    s_add_u32 s17, s49, 1867776
    buffer_load_dword v36, v12, s[20:23], s17 offen
    buffer_load_dword v37, v13, s[20:23], s17 offen
    s_waitcnt vmcnt(56)
    v_perm_b32 v142, v77, v76, v11
    s_add_u32 s17, s49, 1884160
    buffer_load_dword v38, v12, s[20:23], s17 offen
    buffer_load_dword v39, v13, s[20:23], s17 offen
    s_waitcnt vmcnt(56)
    v_perm_b32 v143, v79, v78, v11
    s_add_u32 s17, s49, 1966080
    buffer_load_dword v40, v12, s[20:23], s17 offen
    buffer_load_dword v41, v13, s[20:23], s17 offen
    s_waitcnt vmcnt(56)
    v_perm_b32 v144, v81, v80, v11
    s_add_u32 s17, s49, 1982464
    buffer_load_dword v42, v12, s[20:23], s17 offen
    buffer_load_dword v43, v13, s[20:23], s17 offen
    s_waitcnt vmcnt(56)
    v_perm_b32 v145, v83, v82, v11
    s_add_u32 s17, s49, 1998848
    buffer_load_dword v44, v12, s[20:23], s17 offen
    buffer_load_dword v45, v13, s[20:23], s17 offen
    s_waitcnt vmcnt(56)
    v_perm_b32 v146, v85, v84, v11
    s_add_u32 s17, s49, 2015232
    buffer_load_dword v46, v12, s[20:23], s17 offen
    buffer_load_dword v47, v13, s[20:23], s17 offen
    s_waitcnt vmcnt(56)
    v_perm_b32 v147, v87, v86, v11
    s_add_u32 s17, s49, 2097152
    buffer_load_dword v48, v12, s[20:23], s17 offen
    buffer_load_dword v49, v13, s[20:23], s17 offen
    s_waitcnt vmcnt(56)
    v_perm_b32 v148, v89, v88, v11
    s_add_u32 s17, s49, 2113536
    buffer_load_dword v50, v12, s[20:23], s17 offen
    buffer_load_dword v51, v13, s[20:23], s17 offen
    s_waitcnt vmcnt(56)
    v_perm_b32 v149, v91, v90, v11
    s_add_u32 s17, s49, 2129920
    buffer_load_dword v52, v12, s[20:23], s17 offen
    buffer_load_dword v53, v13, s[20:23], s17 offen
    s_waitcnt vmcnt(56)
    v_perm_b32 v150, v93, v92, v11
    s_add_u32 s17, s49, 2146304
    buffer_load_dword v54, v12, s[20:23], s17 offen
    buffer_load_dword v55, v13, s[20:23], s17 offen
    s_waitcnt vmcnt(56)
    v_perm_b32 v151, v95, v94, v11
    s_add_u32 s17, s49, 2228224
    buffer_load_dword v56, v12, s[20:23], s17 offen
    buffer_load_dword v57, v13, s[20:23], s17 offen
    s_waitcnt vmcnt(56)
    v_perm_b32 v152, v97, v96, v11
    s_add_u32 s17, s49, 2244608
    buffer_load_dword v58, v12, s[20:23], s17 offen
    buffer_load_dword v59, v13, s[20:23], s17 offen
    s_waitcnt vmcnt(56)
    v_perm_b32 v153, v99, v98, v11
    s_add_u32 s17, s49, 2260992
    buffer_load_dword v60, v12, s[20:23], s17 offen
    buffer_load_dword v61, v13, s[20:23], s17 offen
    s_waitcnt vmcnt(56)
    v_perm_b32 v154, v101, v100, v11
    s_add_u32 s17, s49, 2277376
    buffer_load_dword v62, v12, s[20:23], s17 offen
    buffer_load_dword v63, v13, s[20:23], s17 offen
    s_waitcnt vmcnt(56)
    v_perm_b32 v155, v103, v102, v11
    s_add_u32 s17, s49, 2359296
    buffer_load_dword v64, v12, s[20:23], s17 offen
    buffer_load_dword v65, v13, s[20:23], s17 offen
    s_waitcnt vmcnt(56)
    v_perm_b32 v156, v105, v104, v11
    s_add_u32 s17, s49, 2375680
    buffer_load_dword v66, v12, s[20:23], s17 offen
    buffer_load_dword v67, v13, s[20:23], s17 offen
    s_waitcnt vmcnt(56)
    v_perm_b32 v157, v107, v106, v11
    s_add_u32 s17, s49, 2392064
    buffer_load_dword v68, v12, s[20:23], s17 offen
    buffer_load_dword v69, v13, s[20:23], s17 offen
    s_waitcnt vmcnt(56)
    v_perm_b32 v158, v109, v108, v11
    s_add_u32 s17, s49, 2408448
    buffer_load_dword v70, v12, s[20:23], s17 offen
    buffer_load_dword v71, v13, s[20:23], s17 offen
    s_waitcnt vmcnt(56)
    v_perm_b32 v159, v111, v110, v11
    s_add_u32 s17, s49, 2490368
    buffer_load_dword v72, v12, s[20:23], s17 offen
    buffer_load_dword v73, v13, s[20:23], s17 offen
    s_waitcnt vmcnt(56)
    v_perm_b32 v160, v17, v16, v11
    s_add_u32 s17, s49, 2506752
    buffer_load_dword v74, v12, s[20:23], s17 offen
    buffer_load_dword v75, v13, s[20:23], s17 offen
    s_waitcnt vmcnt(56)
    v_perm_b32 v161, v19, v18, v11
    s_add_u32 s17, s49, 2523136
    buffer_load_dword v76, v12, s[20:23], s17 offen
    buffer_load_dword v77, v13, s[20:23], s17 offen
    s_waitcnt vmcnt(56)
    v_perm_b32 v162, v21, v20, v11
    s_add_u32 s17, s49, 2539520
    buffer_load_dword v78, v12, s[20:23], s17 offen
    buffer_load_dword v79, v13, s[20:23], s17 offen
    s_waitcnt vmcnt(56)
    v_perm_b32 v163, v23, v22, v11
    s_add_u32 s17, s49, 2621440
    buffer_load_dword v80, v12, s[20:23], s17 offen
    buffer_load_dword v81, v13, s[20:23], s17 offen
    s_waitcnt vmcnt(56)
    v_perm_b32 v164, v25, v24, v11
    s_add_u32 s17, s49, 2637824
    buffer_load_dword v82, v12, s[20:23], s17 offen
    buffer_load_dword v83, v13, s[20:23], s17 offen
    s_waitcnt vmcnt(56)
    v_perm_b32 v165, v27, v26, v11
    s_add_u32 s17, s49, 2654208
    buffer_load_dword v84, v12, s[20:23], s17 offen
    buffer_load_dword v85, v13, s[20:23], s17 offen
    s_waitcnt vmcnt(56)
    v_perm_b32 v166, v29, v28, v11
    s_add_u32 s17, s49, 2670592
    buffer_load_dword v86, v12, s[20:23], s17 offen
    buffer_load_dword v87, v13, s[20:23], s17 offen
    s_waitcnt vmcnt(56)
    v_perm_b32 v167, v31, v30, v11
    s_add_u32 s17, s49, 2752512
    buffer_load_dword v88, v12, s[20:23], s17 offen
    buffer_load_dword v89, v13, s[20:23], s17 offen
    s_waitcnt vmcnt(56)
    v_perm_b32 v168, v33, v32, v11
    s_add_u32 s17, s49, 2768896
    buffer_load_dword v90, v12, s[20:23], s17 offen
    buffer_load_dword v91, v13, s[20:23], s17 offen
    s_waitcnt vmcnt(56)
    v_perm_b32 v169, v35, v34, v11
    s_add_u32 s17, s49, 2785280
    buffer_load_dword v92, v12, s[20:23], s17 offen
    buffer_load_dword v93, v13, s[20:23], s17 offen
    s_waitcnt vmcnt(56)
    v_perm_b32 v170, v37, v36, v11
    s_add_u32 s17, s49, 2801664
    buffer_load_dword v94, v12, s[20:23], s17 offen
    buffer_load_dword v95, v13, s[20:23], s17 offen
    s_waitcnt vmcnt(56)
    v_perm_b32 v171, v39, v38, v11
    s_add_u32 s17, s49, 2883584
    buffer_load_dword v96, v12, s[20:23], s17 offen
    buffer_load_dword v97, v13, s[20:23], s17 offen
    s_waitcnt vmcnt(56)
    v_perm_b32 v172, v41, v40, v11
    s_add_u32 s17, s49, 2899968
    buffer_load_dword v98, v12, s[20:23], s17 offen
    buffer_load_dword v99, v13, s[20:23], s17 offen
    s_waitcnt vmcnt(56)
    v_perm_b32 v173, v43, v42, v11
    s_add_u32 s17, s49, 2916352
    buffer_load_dword v100, v12, s[20:23], s17 offen
    buffer_load_dword v101, v13, s[20:23], s17 offen
    s_waitcnt vmcnt(56)
    v_perm_b32 v174, v45, v44, v11
    s_add_u32 s17, s49, 2932736
    buffer_load_dword v102, v12, s[20:23], s17 offen
    buffer_load_dword v103, v13, s[20:23], s17 offen
    s_waitcnt vmcnt(56)
    v_perm_b32 v175, v47, v46, v11
    s_add_u32 s17, s49, 3014656
    buffer_load_dword v104, v12, s[20:23], s17 offen
    buffer_load_dword v105, v13, s[20:23], s17 offen
    s_waitcnt vmcnt(56)
    v_perm_b32 v176, v49, v48, v11
    s_add_u32 s17, s49, 3031040
    buffer_load_dword v106, v12, s[20:23], s17 offen
    buffer_load_dword v107, v13, s[20:23], s17 offen
    s_waitcnt vmcnt(56)
    v_perm_b32 v177, v51, v50, v11
    s_add_u32 s17, s49, 3047424
    buffer_load_dword v108, v12, s[20:23], s17 offen
    buffer_load_dword v109, v13, s[20:23], s17 offen
    s_waitcnt vmcnt(56)
    v_perm_b32 v178, v53, v52, v11
    s_add_u32 s17, s49, 3063808
    buffer_load_dword v110, v12, s[20:23], s17 offen
    buffer_load_dword v111, v13, s[20:23], s17 offen
    s_waitcnt vmcnt(56)
    v_perm_b32 v179, v55, v54, v11
    s_add_u32 s17, s49, 3145728
    buffer_load_dword v16, v12, s[20:23], s17 offen
    buffer_load_dword v17, v13, s[20:23], s17 offen
    s_waitcnt vmcnt(56)
    v_perm_b32 v180, v57, v56, v11
    s_add_u32 s17, s49, 3162112
    buffer_load_dword v18, v12, s[20:23], s17 offen
    buffer_load_dword v19, v13, s[20:23], s17 offen
    s_waitcnt vmcnt(56)
    v_perm_b32 v181, v59, v58, v11
    s_add_u32 s17, s49, 3178496
    buffer_load_dword v20, v12, s[20:23], s17 offen
    buffer_load_dword v21, v13, s[20:23], s17 offen
    s_waitcnt vmcnt(56)
    v_perm_b32 v182, v61, v60, v11
    s_add_u32 s17, s49, 3194880
    buffer_load_dword v22, v12, s[20:23], s17 offen
    buffer_load_dword v23, v13, s[20:23], s17 offen
    s_waitcnt vmcnt(56)
    v_perm_b32 v183, v63, v62, v11
    s_add_u32 s17, s49, 3276800
    buffer_load_dword v24, v12, s[20:23], s17 offen
    buffer_load_dword v25, v13, s[20:23], s17 offen
    s_waitcnt vmcnt(56)
    v_perm_b32 v184, v65, v64, v11
    s_add_u32 s17, s49, 3293184
    buffer_load_dword v26, v12, s[20:23], s17 offen
    buffer_load_dword v27, v13, s[20:23], s17 offen
    s_waitcnt vmcnt(56)
    v_perm_b32 v185, v67, v66, v11
    s_add_u32 s17, s49, 3309568
    buffer_load_dword v28, v12, s[20:23], s17 offen
    buffer_load_dword v29, v13, s[20:23], s17 offen
    s_waitcnt vmcnt(56)
    v_perm_b32 v186, v69, v68, v11
    s_add_u32 s17, s49, 3325952
    buffer_load_dword v30, v12, s[20:23], s17 offen
    buffer_load_dword v31, v13, s[20:23], s17 offen
    s_waitcnt vmcnt(56)
    v_perm_b32 v187, v71, v70, v11
    s_add_u32 s17, s49, 3407872
    buffer_load_dword v32, v12, s[20:23], s17 offen
    buffer_load_dword v33, v13, s[20:23], s17 offen
    s_waitcnt vmcnt(56)
    v_perm_b32 v188, v73, v72, v11
    s_add_u32 s17, s49, 3424256
    buffer_load_dword v34, v12, s[20:23], s17 offen
    buffer_load_dword v35, v13, s[20:23], s17 offen
    s_waitcnt vmcnt(56)
    v_perm_b32 v189, v75, v74, v11
    s_add_u32 s17, s49, 3440640
    buffer_load_dword v36, v12, s[20:23], s17 offen
    buffer_load_dword v37, v13, s[20:23], s17 offen
    s_waitcnt vmcnt(56)
    v_perm_b32 v190, v77, v76, v11
    s_add_u32 s17, s49, 3457024
    buffer_load_dword v38, v12, s[20:23], s17 offen
    buffer_load_dword v39, v13, s[20:23], s17 offen
    s_waitcnt vmcnt(56)
    v_perm_b32 v191, v79, v78, v11
    s_add_u32 s17, s49, 3538944
    buffer_load_dword v40, v12, s[20:23], s17 offen
    buffer_load_dword v41, v13, s[20:23], s17 offen
    s_waitcnt vmcnt(56)
    v_perm_b32 v192, v81, v80, v11
    s_add_u32 s17, s49, 3555328
    buffer_load_dword v42, v12, s[20:23], s17 offen
    buffer_load_dword v43, v13, s[20:23], s17 offen
    s_waitcnt vmcnt(56)
    v_perm_b32 v193, v83, v82, v11
    s_add_u32 s17, s49, 3571712
    buffer_load_dword v44, v12, s[20:23], s17 offen
    buffer_load_dword v45, v13, s[20:23], s17 offen
    s_waitcnt vmcnt(56)
    v_perm_b32 v194, v85, v84, v11
    s_add_u32 s17, s49, 3588096
    buffer_load_dword v46, v12, s[20:23], s17 offen
    buffer_load_dword v47, v13, s[20:23], s17 offen
    s_waitcnt vmcnt(56)
    v_perm_b32 v195, v87, v86, v11
    s_add_u32 s17, s49, 3670016
    buffer_load_dword v48, v12, s[20:23], s17 offen
    buffer_load_dword v49, v13, s[20:23], s17 offen
    s_waitcnt vmcnt(56)
    v_perm_b32 v196, v89, v88, v11
    s_add_u32 s17, s49, 3686400
    buffer_load_dword v50, v12, s[20:23], s17 offen
    buffer_load_dword v51, v13, s[20:23], s17 offen
    s_waitcnt vmcnt(56)
    v_perm_b32 v197, v91, v90, v11
    s_add_u32 s17, s49, 3702784
    buffer_load_dword v52, v12, s[20:23], s17 offen
    buffer_load_dword v53, v13, s[20:23], s17 offen
    s_waitcnt vmcnt(56)
    v_perm_b32 v198, v93, v92, v11
    s_add_u32 s17, s49, 3719168
    buffer_load_dword v54, v12, s[20:23], s17 offen
    buffer_load_dword v55, v13, s[20:23], s17 offen
    s_waitcnt vmcnt(56)
    v_perm_b32 v199, v95, v94, v11
    s_add_u32 s17, s49, 3801088
    buffer_load_dword v56, v12, s[20:23], s17 offen
    buffer_load_dword v57, v13, s[20:23], s17 offen
    s_waitcnt vmcnt(56)
    v_perm_b32 v200, v97, v96, v11
    s_add_u32 s17, s49, 3817472
    buffer_load_dword v58, v12, s[20:23], s17 offen
    buffer_load_dword v59, v13, s[20:23], s17 offen
    s_waitcnt vmcnt(56)
    v_perm_b32 v201, v99, v98, v11
    s_add_u32 s17, s49, 3833856
    buffer_load_dword v60, v12, s[20:23], s17 offen
    buffer_load_dword v61, v13, s[20:23], s17 offen
    s_waitcnt vmcnt(56)
    v_perm_b32 v202, v101, v100, v11
    s_add_u32 s17, s49, 3850240
    buffer_load_dword v62, v12, s[20:23], s17 offen
    buffer_load_dword v63, v13, s[20:23], s17 offen
    s_waitcnt vmcnt(56)
    v_perm_b32 v203, v103, v102, v11
    s_add_u32 s17, s49, 3932160
    buffer_load_dword v64, v12, s[20:23], s17 offen
    buffer_load_dword v65, v13, s[20:23], s17 offen
    s_waitcnt vmcnt(56)
    v_perm_b32 v204, v105, v104, v11
    s_add_u32 s17, s49, 3948544
    buffer_load_dword v66, v12, s[20:23], s17 offen
    buffer_load_dword v67, v13, s[20:23], s17 offen
    s_waitcnt vmcnt(56)
    v_perm_b32 v205, v107, v106, v11
    s_add_u32 s17, s49, 3964928
    buffer_load_dword v68, v12, s[20:23], s17 offen
    buffer_load_dword v69, v13, s[20:23], s17 offen
    s_waitcnt vmcnt(56)
    v_perm_b32 v206, v109, v108, v11
    s_add_u32 s17, s49, 3981312
    buffer_load_dword v70, v12, s[20:23], s17 offen
    buffer_load_dword v71, v13, s[20:23], s17 offen
    s_waitcnt vmcnt(56)
    v_perm_b32 v207, v111, v110, v11
    s_add_u32 s17, s49, 4063232
    buffer_load_dword v72, v12, s[20:23], s17 offen
    buffer_load_dword v73, v13, s[20:23], s17 offen
    s_waitcnt vmcnt(56)
    v_perm_b32 v208, v17, v16, v11
    s_add_u32 s17, s49, 4079616
    buffer_load_dword v74, v12, s[20:23], s17 offen
    buffer_load_dword v75, v13, s[20:23], s17 offen
    s_waitcnt vmcnt(56)
    v_perm_b32 v209, v19, v18, v11
    s_add_u32 s17, s49, 4096000
    buffer_load_dword v76, v12, s[20:23], s17 offen
    buffer_load_dword v77, v13, s[20:23], s17 offen
    s_waitcnt vmcnt(56)
    v_perm_b32 v210, v21, v20, v11
    s_add_u32 s17, s49, 4112384
    buffer_load_dword v78, v12, s[20:23], s17 offen
    buffer_load_dword v79, v13, s[20:23], s17 offen
    s_waitcnt vmcnt(56)
    v_perm_b32 v211, v23, v22, v11
    s_add_u32 s17, s49, 4194304
    buffer_load_dword v80, v12, s[20:23], s17 offen
    buffer_load_dword v81, v13, s[20:23], s17 offen
    s_waitcnt vmcnt(56)
    v_perm_b32 v212, v25, v24, v11
    s_add_u32 s17, s49, 4210688
    buffer_load_dword v82, v12, s[20:23], s17 offen
    buffer_load_dword v83, v13, s[20:23], s17 offen
    s_waitcnt vmcnt(56)
    v_perm_b32 v213, v27, v26, v11
    s_add_u32 s17, s49, 4227072
    buffer_load_dword v84, v12, s[20:23], s17 offen
    buffer_load_dword v85, v13, s[20:23], s17 offen
    s_waitcnt vmcnt(56)
    v_perm_b32 v214, v29, v28, v11
    s_add_u32 s17, s49, 4243456
    buffer_load_dword v86, v12, s[20:23], s17 offen
    buffer_load_dword v87, v13, s[20:23], s17 offen
    s_waitcnt vmcnt(56)
    v_perm_b32 v215, v31, v30, v11
    s_add_u32 s17, s49, 4325376
    buffer_load_dword v88, v12, s[20:23], s17 offen
    buffer_load_dword v89, v13, s[20:23], s17 offen
    s_waitcnt vmcnt(56)
    v_perm_b32 v216, v33, v32, v11
    s_add_u32 s17, s49, 4341760
    buffer_load_dword v90, v12, s[20:23], s17 offen
    buffer_load_dword v91, v13, s[20:23], s17 offen
    s_waitcnt vmcnt(56)
    v_perm_b32 v217, v35, v34, v11
    s_add_u32 s17, s49, 4358144
    buffer_load_dword v92, v12, s[20:23], s17 offen
    buffer_load_dword v93, v13, s[20:23], s17 offen
    s_waitcnt vmcnt(56)
    v_perm_b32 v218, v37, v36, v11
    s_add_u32 s17, s49, 4374528
    buffer_load_dword v94, v12, s[20:23], s17 offen
    buffer_load_dword v95, v13, s[20:23], s17 offen
    s_waitcnt vmcnt(56)
    v_perm_b32 v219, v39, v38, v11
    s_add_u32 s17, s49, 4456448
    buffer_load_dword v96, v12, s[20:23], s17 offen
    buffer_load_dword v97, v13, s[20:23], s17 offen
    s_waitcnt vmcnt(56)
    v_perm_b32 v220, v41, v40, v11
    s_add_u32 s17, s49, 4472832
    buffer_load_dword v98, v12, s[20:23], s17 offen
    buffer_load_dword v99, v13, s[20:23], s17 offen
    s_waitcnt vmcnt(56)
    v_perm_b32 v221, v43, v42, v11
    s_add_u32 s17, s49, 4489216
    buffer_load_dword v100, v12, s[20:23], s17 offen
    buffer_load_dword v101, v13, s[20:23], s17 offen
    s_waitcnt vmcnt(56)
    v_perm_b32 v222, v45, v44, v11
    s_add_u32 s17, s49, 4505600
    buffer_load_dword v102, v12, s[20:23], s17 offen
    buffer_load_dword v103, v13, s[20:23], s17 offen
    s_waitcnt vmcnt(56)
    v_perm_b32 v223, v47, v46, v11
    s_add_u32 s17, s49, 4587520
    buffer_load_dword v104, v12, s[20:23], s17 offen
    buffer_load_dword v105, v13, s[20:23], s17 offen
    s_waitcnt vmcnt(56)
    v_perm_b32 v224, v49, v48, v11
    s_add_u32 s17, s49, 4603904
    buffer_load_dword v106, v12, s[20:23], s17 offen
    buffer_load_dword v107, v13, s[20:23], s17 offen
    s_waitcnt vmcnt(56)
    v_perm_b32 v225, v51, v50, v11
    s_add_u32 s17, s49, 4620288
    buffer_load_dword v108, v12, s[20:23], s17 offen
    buffer_load_dword v109, v13, s[20:23], s17 offen
    s_waitcnt vmcnt(56)
    v_perm_b32 v226, v53, v52, v11
    s_add_u32 s17, s49, 4636672
    buffer_load_dword v110, v12, s[20:23], s17 offen
    buffer_load_dword v111, v13, s[20:23], s17 offen
    s_waitcnt vmcnt(56)
    v_perm_b32 v227, v55, v54, v11
    s_waitcnt vmcnt(54)
    v_perm_b32 v228, v57, v56, v11
    s_waitcnt vmcnt(52)
    v_perm_b32 v229, v59, v58, v11
    s_waitcnt vmcnt(50)
    v_perm_b32 v230, v61, v60, v11
    s_waitcnt vmcnt(48)
    v_perm_b32 v231, v63, v62, v11
    s_waitcnt vmcnt(46)
    v_perm_b32 v232, v65, v64, v11
    s_waitcnt vmcnt(44)
    v_perm_b32 v233, v67, v66, v11
    s_waitcnt vmcnt(42)
    v_perm_b32 v234, v69, v68, v11
    s_waitcnt vmcnt(40)
    v_perm_b32 v235, v71, v70, v11
    s_waitcnt vmcnt(38)
    v_perm_b32 v236, v73, v72, v11
    s_waitcnt vmcnt(36)
    v_perm_b32 v237, v75, v74, v11
    s_waitcnt vmcnt(34)
    v_perm_b32 v238, v77, v76, v11
    s_waitcnt vmcnt(32)
    v_perm_b32 v239, v79, v78, v11
    s_waitcnt vmcnt(30)
    v_perm_b32 v240, v81, v80, v11
    s_waitcnt vmcnt(28)
    v_perm_b32 v241, v83, v82, v11
    s_waitcnt vmcnt(26)
    v_perm_b32 v242, v85, v84, v11
    s_waitcnt vmcnt(24)
    v_perm_b32 v243, v87, v86, v11
    s_waitcnt vmcnt(22)
    v_perm_b32 v244, v89, v88, v11
    s_waitcnt vmcnt(20)
    v_perm_b32 v245, v91, v90, v11
    s_waitcnt vmcnt(18)
    v_perm_b32 v246, v93, v92, v11
    s_waitcnt vmcnt(16)
    v_perm_b32 v247, v95, v94, v11
    s_waitcnt vmcnt(14)
    v_perm_b32 v248, v97, v96, v11
    s_waitcnt vmcnt(12)
    v_perm_b32 v249, v99, v98, v11
    s_waitcnt vmcnt(10)
    v_perm_b32 v250, v101, v100, v11
    s_waitcnt vmcnt(8)
    v_perm_b32 v251, v103, v102, v11
    s_waitcnt vmcnt(6)
    v_perm_b32 v252, v105, v104, v11
    s_waitcnt vmcnt(4)
    v_perm_b32 v253, v107, v106, v11
    s_waitcnt vmcnt(2)
    v_perm_b32 v254, v109, v108, v11
    s_waitcnt vmcnt(0)
    v_perm_b32 v255, v111, v110, v11
    s_mul_i32 s52, s50, 16777216
    s_lshl_b32 s17, s51, 13
    s_add_u32 s52, s52, s17
    s_lshl_b32 s17, s14, 11
    s_add_u32 s52, s52, s17
    s_add_u32 s52, s52, 44040192
    s_lshl_b32 s49, s51, 9
    s_lshl_b32 s17, s50, 7
    s_add_u32 s49, s49, s17
    s_lshl_b32 s17, s14, 2
    s_add_u32 s49, s49, s17
    s_add_u32 s49, s49, 5376
    v_mov_b32 v32, 0x3f803f80
    v_mov_b32 v33, 0x3f803f80
    v_mov_b32 v34, 0x3f803f80
    v_mov_b32 v35, 0x3f803f80
    s_lshl_b32 s17, s14, 8
    s_add_u32 s17, s17, 110592
    v_bfe_u32 v5, v0, 4, 5
    v_lshl_add_u32 v12, v5, 2, s17
    v_lshrrev_b32 v5, 9, v0
    v_lshl_add_u32 v13, v5, 4, s17
    s_cmp_eq_u32 s50, 2
    s_cbranch_scc1 Lp_v
    v_mfma_f32_32x32x16_bf16 v[80:95], v[112:115], v[32:35], 0
    v_mfma_f32_32x32x16_bf16 v[80:95], v[116:119], v[32:35], v[80:95]
    v_mfma_f32_32x32x16_bf16 v[80:95], v[120:123], v[32:35], v[80:95]
    v_mfma_f32_32x32x16_bf16 v[80:95], v[124:127], v[32:35], v[80:95]
    v_mfma_f32_32x32x16_bf16 v[80:95], v[128:131], v[32:35], v[80:95]
    v_mfma_f32_32x32x16_bf16 v[80:95], v[132:135], v[32:35], v[80:95]
    v_mfma_f32_32x32x16_bf16 v[80:95], v[136:139], v[32:35], v[80:95]
    v_mfma_f32_32x32x16_bf16 v[80:95], v[140:143], v[32:35], v[80:95]
    v_mfma_f32_32x32x16_bf16 v[80:95], v[144:147], v[32:35], v[80:95]
    v_mfma_f32_32x32x16_bf16 v[80:95], v[148:151], v[32:35], v[80:95]
    v_mfma_f32_32x32x16_bf16 v[80:95], v[152:155], v[32:35], v[80:95]
    v_mfma_f32_32x32x16_bf16 v[80:95], v[156:159], v[32:35], v[80:95]
    v_mfma_f32_32x32x16_bf16 v[80:95], v[160:163], v[32:35], v[80:95]
    v_mfma_f32_32x32x16_bf16 v[80:95], v[164:167], v[32:35], v[80:95]
    v_mfma_f32_32x32x16_bf16 v[80:95], v[168:171], v[32:35], v[80:95]
    v_mfma_f32_32x32x16_bf16 v[80:95], v[172:175], v[32:35], v[80:95]
    v_mfma_f32_32x32x16_bf16 v[80:95], v[176:179], v[32:35], v[80:95]
    v_mfma_f32_32x32x16_bf16 v[80:95], v[180:183], v[32:35], v[80:95]
    v_mfma_f32_32x32x16_bf16 v[80:95], v[184:187], v[32:35], v[80:95]
    v_mfma_f32_32x32x16_bf16 v[80:95], v[188:191], v[32:35], v[80:95]
    v_mfma_f32_32x32x16_bf16 v[80:95], v[192:195], v[32:35], v[80:95]
    v_mfma_f32_32x32x16_bf16 v[80:95], v[196:199], v[32:35], v[80:95]
    v_mfma_f32_32x32x16_bf16 v[80:95], v[200:203], v[32:35], v[80:95]
    v_mfma_f32_32x32x16_bf16 v[80:95], v[204:207], v[32:35], v[80:95]
    v_mfma_f32_32x32x16_bf16 v[80:95], v[208:211], v[32:35], v[80:95]
    v_mfma_f32_32x32x16_bf16 v[80:95], v[212:215], v[32:35], v[80:95]
    v_mfma_f32_32x32x16_bf16 v[80:95], v[216:219], v[32:35], v[80:95]
    v_mfma_f32_32x32x16_bf16 v[80:95], v[220:223], v[32:35], v[80:95]
    v_mfma_f32_32x32x16_bf16 v[80:95], v[224:227], v[32:35], v[80:95]
    v_mfma_f32_32x32x16_bf16 v[80:95], v[228:231], v[32:35], v[80:95]
    v_mfma_f32_32x32x16_bf16 v[80:95], v[232:235], v[32:35], v[80:95]
    v_mfma_f32_32x32x16_bf16 v[80:95], v[236:239], v[32:35], v[80:95]
    v_mfma_f32_32x32x16_bf16 v[80:95], v[240:243], v[32:35], v[80:95]
    v_mfma_f32_32x32x16_bf16 v[80:95], v[244:247], v[32:35], v[80:95]
    v_mfma_f32_32x32x16_bf16 v[80:95], v[248:251], v[32:35], v[80:95]
    v_mfma_f32_32x32x16_bf16 v[80:95], v[252:255], v[32:35], v[80:95]
    s_mov_b32 s66, 114688
    s_mov_b32 s71, 0x2000
    s_mov_b32 s32, 0
    s_mov_b32 s33, 0
    s_mov_b32 s38, 128
    s_mul_i32 s58, s14, 9216
    s_mov_b32 s40, 36864
    s_mov_b32 s59, s58
    s_mov_b32 s43, 0
    s_mov_b32 s28, s8
    s_mov_b32 s29, s9
    s_mov_b32 s30, 0
    s_mov_b32 s31, 0x00020000
    v_mov_b32 v78, 74752
    s_add_u32 s64, s58, 8650752
    s_add_u32 s65, s58, 13369344
    ds_write2_b32 v78, v4, v4 offset0:0 offset1:1
    s_waitcnt lgkmcnt(0)
    s_cmp_lg_u32 s14, 0
    s_cbranch_scc1 LpQ_ini_d
    v_mov_b32 v5, 160
    s_mov_b32 s16, 0
LpQ_ini:
    global_load_dword v6, v5, s[12:13] sc1
    s_add_u32 s16, s16, 1
    s_cmp_gt_u32 s16, 100000
    s_cbranch_scc1 L_role_p_abort
    s_waitcnt vmcnt(0)
    v_cmp_gt_u32 vcc, 192, v6
    s_nop 0
    s_cbranch_vccz LpQ_ini_d
    s_sleep 8
    s_branch LpQ_ini
LpQ_ini_d:
    s_barrier
    s_branch LpQ_idle0
LpQ_item:
    s_waitcnt vmcnt(2)
LpQ_defer:
    s_cmp_lg_u32 s14, 0
    s_cbranch_scc1 LpQ_nw0
    v_cmp_eq_u32 vcc, 0, v2
    v_cmp_eq_u32 s[54:55], 0, v15
    s_cmp_eq_u64 vcc, 0
    s_cselect_b32 s62, 1, 0
    s_cmp_eq_u64 s[54:55], 0
    s_cselect_b32 s62, 2, s62
    v_mov_b32 v5, s62
    ds_write_b32 v78, v5
    s_waitcnt lgkmcnt(0)
LpQ_nw0:
    s_barrier
    ds_read_b32 v6, v78
    v_xor_b32 v78, 4, v78
    s_xor_b32 s40, s40, 36864
    s_xor_b32 s59, s59, 36864
    s_xor_b32 s66, s66, 0x2000
    s_xor_b32 s71, s71, 0x2000
    s_sub_u32 s38, s38, 1
    v_add_u32 v9, s40, v0
    v_add_u32 v5, s71, v10
    ds_read_b128 v[32:35], v9 offset:0
    ds_read_b128 v[36:39], v9 offset:1024
    ds_read_b128 v[40:43], v9 offset:2048
    ds_read_b128 v[56:59], v5 offset:0
    ds_read_b128 v[60:63], v5 offset:512
    ds_read_b128 v[64:67], v5 offset:1024
    ds_read_b128 v[68:71], v5 offset:1536
    ds_read_b128 v[72:75], v5 offset:2048
    s_waitcnt lgkmcnt(7)
    v_mfma_f32_32x32x16_bf16 v[16:31], v[112:115], v[32:35], 0
    ds_read_b128 v[44:47], v9 offset:3072
    s_waitcnt lgkmcnt(7)
    v_mfma_f32_32x32x16_bf16 v[16:31], v[116:119], v[36:39], v[16:31]
    ds_read_b128 v[32:35], v9 offset:4096
    v_readfirstlane_b32 s62, v6
    s_nop 0
    s_cmp_eq_u32 s62, 2
    s_cselect_b32 s41, s65, s64
    s_cmp_lg_u32 s62, 0
    s_cselect_b32 s30, 268435456, 0
    s_waitcnt lgkmcnt(7)
    v_mfma_f32_32x32x16_bf16 v[16:31], v[120:123], v[40:43], v[16:31]
    ds_read_b128 v[36:39], v9 offset:5120
    s_add_u32 m0, s59, 0
    s_add_u32 s47, s41, 0
    buffer_load_dwordx4 v0, s[28:31], s47 offen offset:0 lds
    s_waitcnt lgkmcnt(6)
    v_add_f32 v56, v56, v60
    s_waitcnt lgkmcnt(2)
    v_mfma_f32_32x32x16_bf16 v[16:31], v[124:127], v[44:47], v[16:31]
    ds_read_b128 v[40:43], v9 offset:6144
    s_cmp_eq_u32 s62, 2
    s_cselect_b32 s36, 1, 0
    s_cselect_b32 s37, s33, s32
    s_cselect_b32 s17, 1, 0
    s_add_u32 s33, s33, s17
    s_waitcnt lgkmcnt(2)
    v_mfma_f32_32x32x16_bf16 v[16:31], v[128:131], v[32:35], v[16:31]
    ds_read_b128 v[44:47], v9 offset:7168
    buffer_load_dwordx4 v0, s[28:31], s47 offen offset:1024 lds
    v_add_f32 v57, v57, v61
    s_waitcnt lgkmcnt(2)
    v_mfma_f32_32x32x16_bf16 v[16:31], v[132:135], v[36:39], v[16:31]
    ds_read_b128 v[32:35], v9 offset:8192
    s_cmp_eq_u32 s62, 1
    s_cselect_b32 s17, 1, 0
    s_add_u32 s32, s32, s17
    s_lshl_b32 s56, s36, 6
    s_add_u32 s56, s56, s37
    s_waitcnt lgkmcnt(2)
    v_mfma_f32_32x32x16_bf16 v[16:31], v[136:139], v[40:43], v[16:31]
    ds_read_b128 v[36:39], v9 offset:9216
    buffer_load_dwordx4 v0, s[28:31], s47 offen offset:2048 lds
    v_add_f32 v58, v58, v62
    s_waitcnt lgkmcnt(2)
    v_mfma_f32_32x32x16_bf16 v[16:31], v[140:143], v[44:47], v[16:31]
    ds_read_b128 v[40:43], v9 offset:10240
    s_mul_i32 s48, s36, 786432
    s_mul_i32 s18, s37, 6144
    s_add_u32 s48, s48, s18
    s_add_u32 s48, s48, 16125952
    v_add_f32 v59, v59, v63
    s_waitcnt lgkmcnt(2)
    v_mfma_f32_32x32x16_bf16 v[16:31], v[144:147], v[32:35], v[16:31]
    ds_read_b128 v[44:47], v9 offset:11264
    buffer_load_dwordx4 v0, s[28:31], s47 offen offset:3072 lds
    v_add_f32 v56, v56, v64
    s_waitcnt lgkmcnt(2)
    v_mfma_f32_32x32x16_bf16 v[16:31], v[148:151], v[36:39], v[16:31]
    ds_read_b128 v[32:35], v9 offset:12288
    s_cmp_eq_u32 s62, 2
    s_cselect_b32 s17, 36864, 0
    s_add_u32 s65, s65, s17
    v_add_f32 v57, v57, v65
    v_add_f32 v58, v58, v66
    s_waitcnt lgkmcnt(2)
    v_mfma_f32_32x32x16_bf16 v[16:31], v[152:155], v[40:43], v[16:31]
    ds_read_b128 v[36:39], v9 offset:13312
    s_add_u32 m0, s59, 4096
    s_add_u32 s47, s41, 4096
    buffer_load_dwordx4 v0, s[28:31], s47 offen offset:0 lds
    v_add_f32 v59, v59, v67
    s_waitcnt vmcnt(5)
    s_cmp_lg_u32 s43, 0
    s_cselect_b64 exec, 1, 0
    buffer_store_dword v3, v4, s[8:11], s43 offen sc1
    s_mov_b64 exec, -1
    s_mov_b32 s43, 0
    s_waitcnt lgkmcnt(2)
    v_mfma_f32_32x32x16_bf16 v[16:31], v[156:159], v[44:47], v[16:31]
    ds_read_b128 v[40:43], v9 offset:14336
    s_cmp_eq_u32 s62, 1
    s_cselect_b32 s17, 36864, 0
    s_add_u32 s64, s64, s17
    v_add_f32 v56, v56, v68
    v_add_f32 v57, v57, v69
    s_waitcnt lgkmcnt(2)
    v_mfma_f32_32x32x16_bf16 v[16:31], v[160:163], v[32:35], v[16:31]
    ds_read_b128 v[44:47], v9 offset:15360
    buffer_load_dwordx4 v0, s[28:31], s47 offen offset:1024 lds
    v_add_f32 v58, v58, v70
    s_waitcnt lgkmcnt(2)
    v_mfma_f32_32x32x16_bf16 v[16:31], v[164:167], v[36:39], v[16:31]
    ds_read_b128 v[32:35], v9 offset:16384
    buffer_load_dwordx4 v0, s[28:31], s47 offen offset:2048 lds
    v_add_f32 v59, v59, v71
    s_waitcnt lgkmcnt(2)
    v_mfma_f32_32x32x16_bf16 v[16:31], v[168:171], v[40:43], v[16:31]
    ds_read_b128 v[36:39], v9 offset:17408
    buffer_load_dwordx4 v0, s[28:31], s47 offen offset:3072 lds
    v_add_f32 v56, v56, v72
    s_waitcnt lgkmcnt(2)
    v_mfma_f32_32x32x16_bf16 v[16:31], v[172:175], v[44:47], v[16:31]
    ds_read_b128 v[40:43], v9 offset:18432
    s_add_u32 m0, s59, 8192
    s_add_u32 s47, s41, 8192
    buffer_load_dwordx4 v0, s[28:31], s47 offen offset:0 lds
    v_add_f32 v57, v57, v73
    s_waitcnt lgkmcnt(2)
    v_mfma_f32_32x32x16_bf16 v[16:31], v[176:179], v[32:35], v[16:31]
    ds_read_b128 v[44:47], v9 offset:19456
    s_add_u32 m0, s66, 4096
    s_nop 0
    buffer_load_dwordx4 v0, s[28:31], s48 offen lds
    v_add_f32 v58, v58, v74
    v_add_f32 v59, v59, v75
    s_cmp_lg_u32 s14, 0
    s_cbranch_scc1 LpQ_ns_1
    s_mul_i32 s60, s32, 22528
    s_add_u32 s60, s60, 3584
    s_cmp_lt_u32 s32, 64
    s_cselect_b32 s60, s60, 2883584
    s_mul_i32 s61, s33, 22528
    s_add_u32 s61, s61, 1445376
    s_cmp_lt_u32 s33, 64
    s_cselect_b32 s61, s61, 2883584
    buffer_load_dword v2, v1, s[8:11], s60 offen sc1
    buffer_load_dword v15, v1, s[8:11], s61 offen sc1
LpQ_ns_1:
    s_waitcnt lgkmcnt(2)
    v_mfma_f32_32x32x16_bf16 v[16:31], v[180:183], v[36:39], v[16:31]
    ds_read_b128 v[32:35], v9 offset:20480
    s_add_u32 m0, s66, s67
    s_sub_u32 s48, s48, 4096
    s_add_u32 s48, s48, s67
    buffer_load_dwordx4 v0, s[28:31], s48 offen lds
    v_add_f32 v56, v56, v58
    v_add_f32 v57, v57, v59
    s_waitcnt lgkmcnt(2)
    v_mfma_f32_32x32x16_bf16 v[16:31], v[184:187], v[40:43], v[16:31]
    ds_read_b128 v[36:39], v9 offset:21504
    v_mov_b32 v58, v56
    v_mov_b32 v59, v57
    s_nop 0
    v_permlane32_swap_b32 v56, v58
    v_permlane32_swap_b32 v57, v59
    s_waitcnt lgkmcnt(2)
    v_mfma_f32_32x32x16_bf16 v[16:31], v[188:191], v[44:47], v[16:31]
    ds_read_b128 v[40:43], v9 offset:22528
    v_add_f32 v56, v56, v58
    v_add_f32 v57, v57, v59
    v_mul_f32 v56, 0x3ae38e39, v56
    v_mul_f32 v57, 0x3ae38e39, v57
    s_waitcnt lgkmcnt(2)
    v_mfma_f32_32x32x16_bf16 v[16:31], v[192:195], v[32:35], v[16:31]
    ds_read_b128 v[44:47], v9 offset:23552
    v_fma_f32 v57, -v56, v56, v57
    v_max_f32 v57, 0, v57
    v_add_f32 v57, 0x3727c5ac, v57
    v_rsq_f32 v76, v57
    s_waitcnt lgkmcnt(2)
    v_mfma_f32_32x32x16_bf16 v[16:31], v[196:199], v[36:39], v[16:31]
    ds_read_b128 v[32:35], v9 offset:24576
    v_mul_f32 v77, v56, v76
    v_mul_f32 v96, v77, v80
    v_mul_f32 v97, v77, v81
    v_mul_f32 v98, v77, v82
    s_waitcnt lgkmcnt(2)
    v_mfma_f32_32x32x16_bf16 v[16:31], v[200:203], v[40:43], v[16:31]
    ds_read_b128 v[36:39], v9 offset:25600
    v_mul_f32 v99, v77, v83
    v_mul_f32 v100, v77, v84
    v_mul_f32 v101, v77, v85
    v_mul_f32 v102, v77, v86
    s_waitcnt lgkmcnt(2)
    v_mfma_f32_32x32x16_bf16 v[16:31], v[204:207], v[44:47], v[16:31]
    ds_read_b128 v[40:43], v9 offset:26624
    v_mul_f32 v103, v77, v87
    v_mul_f32 v104, v77, v88
    v_mul_f32 v105, v77, v89
    v_mul_f32 v106, v77, v90
    s_waitcnt lgkmcnt(2)
    v_mfma_f32_32x32x16_bf16 v[16:31], v[208:211], v[32:35], v[16:31]
    ds_read_b128 v[44:47], v9 offset:27648
    v_mul_f32 v107, v77, v91
    v_mul_f32 v108, v77, v92
    v_mul_f32 v109, v77, v93
    v_mul_f32 v110, v77, v94
    s_waitcnt lgkmcnt(2)
    v_mfma_f32_32x32x16_bf16 v[16:31], v[212:215], v[36:39], v[16:31]
    ds_read_b128 v[32:35], v9 offset:28672
    v_mul_f32 v111, v77, v95
    s_mul_i32 s46, s34, 50331648
    s_lshl_b32 s51, s35, 18
    s_add_u32 s46, s46, s51
    s_waitcnt lgkmcnt(2)
    v_mfma_f32_32x32x16_bf16 v[16:31], v[216:219], v[40:43], v[16:31]
    ds_read_b128 v[36:39], v9 offset:29696
    s_add_u32 s46, s46, s52
    s_waitcnt lgkmcnt(2)
    v_mfma_f32_32x32x16_bf16 v[16:31], v[220:223], v[44:47], v[16:31]
    ds_read_b128 v[40:43], v9 offset:30720
    s_waitcnt lgkmcnt(2)
    v_mfma_f32_32x32x16_bf16 v[16:31], v[224:227], v[32:35], v[16:31]
    ds_read_b128 v[44:47], v9 offset:31744
    s_waitcnt lgkmcnt(2)
    v_mfma_f32_32x32x16_bf16 v[16:31], v[228:231], v[36:39], v[16:31]
    ds_read_b128 v[32:35], v9 offset:32768
    s_waitcnt lgkmcnt(2)
    v_mfma_f32_32x32x16_bf16 v[16:31], v[232:235], v[40:43], v[16:31]
    ds_read_b128 v[36:39], v9 offset:33792
    s_waitcnt lgkmcnt(2)
    v_mfma_f32_32x32x16_bf16 v[16:31], v[236:239], v[44:47], v[16:31]
    ds_read_b128 v[40:43], v9 offset:34816
    s_waitcnt lgkmcnt(2)
    v_mfma_f32_32x32x16_bf16 v[16:31], v[240:243], v[32:35], v[16:31]
    ds_read_b128 v[44:47], v9 offset:35840
    s_waitcnt lgkmcnt(2)
    v_mfma_f32_32x32x16_bf16 v[16:31], v[244:247], v[36:39], v[16:31]
    s_waitcnt lgkmcnt(1)
    v_mfma_f32_32x32x16_bf16 v[16:31], v[248:251], v[40:43], v[16:31]
    s_waitcnt lgkmcnt(0)
    v_mfma_f32_32x32x16_bf16 v[16:31], v[252:255], v[44:47], v[16:31]
    s_nop 11
    v_pk_fma_f32 v[16:17], v[16:17], v[76:77], v[96:97] op_sel_hi:[1,0,1] neg_lo:[0,0,1] neg_hi:[0,0,1]
    v_pk_fma_f32 v[18:19], v[18:19], v[76:77], v[98:99] op_sel_hi:[1,0,1] neg_lo:[0,0,1] neg_hi:[0,0,1]
    v_pk_fma_f32 v[20:21], v[20:21], v[76:77], v[100:101] op_sel_hi:[1,0,1] neg_lo:[0,0,1] neg_hi:[0,0,1]
    v_pk_fma_f32 v[22:23], v[22:23], v[76:77], v[102:103] op_sel_hi:[1,0,1] neg_lo:[0,0,1] neg_hi:[0,0,1]
    v_cvt_pk_bf16_f32 v48, v16, v17
    v_cvt_pk_bf16_f32 v49, v18, v19
    v_cvt_pk_bf16_f32 v50, v20, v21
    v_cvt_pk_bf16_f32 v51, v22, v23
    buffer_store_dwordx4 v[48:51], v14, s[8:11], s46 offen offset:0 sc1
    v_pk_fma_f32 v[24:25], v[24:25], v[76:77], v[104:105] op_sel_hi:[1,0,1] neg_lo:[0,0,1] neg_hi:[0,0,1]
    v_pk_fma_f32 v[26:27], v[26:27], v[76:77], v[106:107] op_sel_hi:[1,0,1] neg_lo:[0,0,1] neg_hi:[0,0,1]
    v_pk_fma_f32 v[28:29], v[28:29], v[76:77], v[108:109] op_sel_hi:[1,0,1] neg_lo:[0,0,1] neg_hi:[0,0,1]
    v_pk_fma_f32 v[30:31], v[30:31], v[76:77], v[110:111] op_sel_hi:[1,0,1] neg_lo:[0,0,1] neg_hi:[0,0,1]
    v_cvt_pk_bf16_f32 v52, v24, v25
    v_cvt_pk_bf16_f32 v53, v26, v27
    v_cvt_pk_bf16_f32 v54, v28, v29
    v_cvt_pk_bf16_f32 v55, v30, v31
    buffer_store_dwordx4 v[52:55], v14, s[8:11], s46 offen offset:512 sc1
    s_mul_i32 s43, s57, 22528
    s_add_u32 s43, s43, s49
    s_mov_b32 s34, s36
    s_mov_b32 s35, s37
    s_mov_b32 s57, s56
    s_min_u32 s62, s62, s38
    s_cmp_lg_u32 s62, 0
    s_cbranch_scc1 LpQ_item
    s_cmp_lg_u32 s14, 0
    s_cbranch_scc1 LpQ_ns_2
    s_mul_i32 s60, s32, 22528
    s_add_u32 s60, s60, 3584
    s_cmp_lt_u32 s32, 64
    s_cselect_b32 s60, s60, 2883584
    s_mul_i32 s61, s33, 22528
    s_add_u32 s61, s61, 1445376
    s_cmp_lt_u32 s33, 64
    s_cselect_b32 s61, s61, 2883584
    buffer_load_dword v2, v1, s[8:11], s60 offen sc1
    buffer_load_dword v15, v1, s[8:11], s61 offen sc1
LpQ_ns_2:
    s_waitcnt vmcnt(0)
    s_cmp_lg_u32 s43, 0
    s_cselect_b64 exec, 1, 0
    buffer_store_dword v3, v4, s[8:11], s43 offen sc1
    s_mov_b64 exec, -1
    s_mov_b32 s43, 0
    s_cmp_eq_u32 s38, 0
    s_cbranch_scc1 LpQ_end
    s_cmp_lg_u32 s14, 0
    s_cbranch_scc1 LpQ_nw1
    v_cmp_eq_u32 vcc, 0, v2
    v_cmp_eq_u32 s[54:55], 0, v15
    s_cmp_eq_u64 vcc, 0
    s_cselect_b32 s62, 1, 0
    s_cmp_eq_u64 s[54:55], 0
    s_cselect_b32 s62, 2, s62
    s_cmp_lg_u32 s62, 0
    s_cbranch_scc1 LpQ_got
LpQ_idle0:
    s_cmp_lg_u32 s14, 0
    s_cbranch_scc1 LpQ_nw1
    s_mul_i32 s60, s32, 22528
    s_add_u32 s60, s60, 3584
    s_cmp_lt_u32 s32, 64
    s_cselect_b32 s60, s60, 2883584
    s_mul_i32 s61, s33, 22528
    s_add_u32 s61, s61, 1445376
    s_cmp_lt_u32 s33, 64
    s_cselect_b32 s61, s61, 2883584
    s_mov_b32 s16, 0
LpQ_pl_3:
    buffer_load_dword v2, v1, s[8:11], s60 offen sc1
    buffer_load_dword v15, v1, s[8:11], s61 offen sc1
    s_add_u32 s16, s16, 1
    s_cmp_gt_u32 s16, 100000
    s_cbranch_scc1 L_role_p_abort
    s_waitcnt vmcnt(1)
    v_cmp_eq_u32 vcc, 0, v2
    s_waitcnt vmcnt(0)
    v_cmp_eq_u32 s[54:55], 0, v15
    s_cmp_eq_u64 vcc, 0
    s_cselect_b32 s62, 1, 0
    s_cmp_eq_u64 s[54:55], 0
    s_cselect_b32 s62, 2, s62
    s_cmp_lg_u32 s62, 0
    s_cbranch_scc1 LpQ_pl_3d
    s_sleep 4
    s_branch LpQ_pl_3
LpQ_pl_3d:
LpQ_got:
    v_mov_b32 v5, s62
    ds_write_b32 v78, v5
    s_waitcnt lgkmcnt(0)
LpQ_nw1:
    s_barrier
    ds_read_b32 v6, v78
    v_xor_b32 v78, 4, v78
    s_waitcnt lgkmcnt(0)
    v_readfirstlane_b32 s62, v6
    s_nop 0
    s_cmp_eq_u32 s62, 0
    s_cbranch_scc1 L_role_p_abort
    s_cmp_eq_u32 s62, 2
    s_cselect_b32 s41, s65, s64
    s_cmp_lg_u32 s62, 0
    s_cselect_b32 s30, 268435456, 0
    s_cmp_eq_u32 s62, 2
    s_cselect_b32 s36, 1, 0
    s_cselect_b32 s37, s33, s32
    s_cselect_b32 s17, 1, 0
    s_add_u32 s33, s33, s17
    s_cmp_eq_u32 s62, 1
    s_cselect_b32 s17, 1, 0
    s_add_u32 s32, s32, s17
    s_lshl_b32 s56, s36, 6
    s_add_u32 s56, s56, s37
    s_cmp_eq_u32 s62, 2
    s_cselect_b32 s17, 36864, 0
    s_add_u32 s65, s65, s17
    s_cmp_eq_u32 s62, 1
    s_cselect_b32 s17, 36864, 0
    s_add_u32 s64, s64, s17
    s_add_u32 m0, s59, 0
    s_add_u32 s47, s41, 0
    buffer_load_dwordx4 v0, s[8:11], s47 offen offset:0 lds
    buffer_load_dwordx4 v0, s[8:11], s47 offen offset:1024 lds
    buffer_load_dwordx4 v0, s[8:11], s47 offen offset:2048 lds
    buffer_load_dwordx4 v0, s[8:11], s47 offen offset:3072 lds
    s_add_u32 m0, s59, 4096
    s_add_u32 s47, s41, 4096
    buffer_load_dwordx4 v0, s[8:11], s47 offen offset:0 lds
    buffer_load_dwordx4 v0, s[8:11], s47 offen offset:1024 lds
    buffer_load_dwordx4 v0, s[8:11], s47 offen offset:2048 lds
    buffer_load_dwordx4 v0, s[8:11], s47 offen offset:3072 lds
    s_add_u32 m0, s59, 8192
    s_add_u32 s47, s41, 8192
    buffer_load_dwordx4 v0, s[8:11], s47 offen offset:0 lds
    s_mul_i32 s48, s36, 786432
    s_mul_i32 s18, s37, 6144
    s_add_u32 s48, s48, s18
    s_add_u32 s48, s48, 16125952
    s_add_u32 m0, s66, 4096
    s_nop 0
    buffer_load_dwordx4 v0, s[8:11], s48 offen lds
    s_add_u32 m0, s66, s67
    s_sub_u32 s48, s48, 4096
    s_add_u32 s48, s48, s67
    buffer_load_dwordx4 v0, s[8:11], s48 offen lds
    s_mov_b32 s34, s36
    s_mov_b32 s35, s37
    s_mov_b32 s57, s56
    s_cmp_lg_u32 s14, 0
    s_cbranch_scc1 LpQ_ns_4
    s_mul_i32 s60, s32, 22528
    s_add_u32 s60, s60, 3584
    s_cmp_lt_u32 s32, 64
    s_cselect_b32 s60, s60, 2883584
    s_mul_i32 s61, s33, 22528
    s_add_u32 s61, s61, 1445376
    s_cmp_lt_u32 s33, 64
    s_cselect_b32 s61, s61, 2883584
    buffer_load_dword v2, v1, s[8:11], s60 offen sc1
    buffer_load_dword v15, v1, s[8:11], s61 offen sc1
LpQ_ns_4:
    s_waitcnt vmcnt(0)
    s_branch LpQ_item
LpQ_end:
    s_branch L_role_p_exit
Lp_v:
    v_mfma_f32_32x32x16_bf16 v[16:31], v[32:35], v[112:115], 0
    v_mfma_f32_32x32x16_bf16 v[16:31], v[32:35], v[116:119], v[16:31]
    v_mfma_f32_32x32x16_bf16 v[16:31], v[32:35], v[120:123], v[16:31]
    v_mfma_f32_32x32x16_bf16 v[16:31], v[32:35], v[124:127], v[16:31]
    v_mfma_f32_32x32x16_bf16 v[16:31], v[32:35], v[128:131], v[16:31]
    v_mfma_f32_32x32x16_bf16 v[16:31], v[32:35], v[132:135], v[16:31]
    v_mfma_f32_32x32x16_bf16 v[16:31], v[32:35], v[136:139], v[16:31]
    v_mfma_f32_32x32x16_bf16 v[16:31], v[32:35], v[140:143], v[16:31]
    v_mfma_f32_32x32x16_bf16 v[16:31], v[32:35], v[144:147], v[16:31]
    v_mfma_f32_32x32x16_bf16 v[16:31], v[32:35], v[148:151], v[16:31]
    v_mfma_f32_32x32x16_bf16 v[16:31], v[32:35], v[152:155], v[16:31]
    v_mfma_f32_32x32x16_bf16 v[16:31], v[32:35], v[156:159], v[16:31]
    v_mfma_f32_32x32x16_bf16 v[16:31], v[32:35], v[160:163], v[16:31]
    v_mfma_f32_32x32x16_bf16 v[16:31], v[32:35], v[164:167], v[16:31]
    v_mfma_f32_32x32x16_bf16 v[16:31], v[32:35], v[168:171], v[16:31]
    v_mfma_f32_32x32x16_bf16 v[16:31], v[32:35], v[172:175], v[16:31]
    v_mfma_f32_32x32x16_bf16 v[16:31], v[32:35], v[176:179], v[16:31]
    v_mfma_f32_32x32x16_bf16 v[16:31], v[32:35], v[180:183], v[16:31]
    v_mfma_f32_32x32x16_bf16 v[16:31], v[32:35], v[184:187], v[16:31]
    v_mfma_f32_32x32x16_bf16 v[16:31], v[32:35], v[188:191], v[16:31]
    v_mfma_f32_32x32x16_bf16 v[16:31], v[32:35], v[192:195], v[16:31]
    v_mfma_f32_32x32x16_bf16 v[16:31], v[32:35], v[196:199], v[16:31]
    v_mfma_f32_32x32x16_bf16 v[16:31], v[32:35], v[200:203], v[16:31]
    v_mfma_f32_32x32x16_bf16 v[16:31], v[32:35], v[204:207], v[16:31]
    v_mfma_f32_32x32x16_bf16 v[16:31], v[32:35], v[208:211], v[16:31]
    v_mfma_f32_32x32x16_bf16 v[16:31], v[32:35], v[212:215], v[16:31]
    v_mfma_f32_32x32x16_bf16 v[16:31], v[32:35], v[216:219], v[16:31]
    v_mfma_f32_32x32x16_bf16 v[16:31], v[32:35], v[220:223], v[16:31]
    v_mfma_f32_32x32x16_bf16 v[16:31], v[32:35], v[224:227], v[16:31]
    v_mfma_f32_32x32x16_bf16 v[16:31], v[32:35], v[228:231], v[16:31]
    v_mfma_f32_32x32x16_bf16 v[16:31], v[32:35], v[232:235], v[16:31]
    v_mfma_f32_32x32x16_bf16 v[16:31], v[32:35], v[236:239], v[16:31]
    v_mfma_f32_32x32x16_bf16 v[16:31], v[32:35], v[240:243], v[16:31]
    v_mfma_f32_32x32x16_bf16 v[16:31], v[32:35], v[244:247], v[16:31]
    v_mfma_f32_32x32x16_bf16 v[16:31], v[32:35], v[248:251], v[16:31]
    v_mfma_f32_32x32x16_bf16 v[16:31], v[32:35], v[252:255], v[16:31]
    s_nop 11
    v_mov_b32 v11, v16
    s_mov_b32 s66, 114688
    s_mov_b32 s71, 0x2000
    s_mov_b32 s32, 0
    s_mov_b32 s33, 0
    s_mov_b32 s38, 128
    s_mul_i32 s58, s14, 9216
    s_mov_b32 s40, 36864
    s_mov_b32 s59, s58
    s_mov_b32 s43, 0
    s_mov_b32 s28, s8
    s_mov_b32 s29, s9
    s_mov_b32 s30, 0
    s_mov_b32 s31, 0x00020000
    v_mov_b32 v108, 74752
    s_add_u32 s64, s58, 8650752
    s_add_u32 s65, s58, 13369344
    ds_write2_b32 v108, v4, v4 offset0:0 offset1:1
    s_waitcnt lgkmcnt(0)
    s_cmp_lg_u32 s14, 0
    s_cbranch_scc1 LpV_ini_d
    v_mov_b32 v5, 160
    s_mov_b32 s16, 0
LpV_ini:
    global_load_dword v6, v5, s[12:13] sc1
    s_add_u32 s16, s16, 1
    s_cmp_gt_u32 s16, 100000
    s_cbranch_scc1 L_role_p_abort
    s_waitcnt vmcnt(0)
    v_cmp_gt_u32 vcc, 192, v6
    s_nop 0
    s_cbranch_vccz LpV_ini_d
    s_sleep 8
    s_branch LpV_ini
LpV_ini_d:
    s_barrier
    s_branch LpV_idle0
LpV_item:
    s_waitcnt vmcnt(2)
LpV_defer:
    s_cmp_lg_u32 s14, 0
    s_cbranch_scc1 LpV_nw0
    v_cmp_eq_u32 vcc, 0, v2
    v_cmp_eq_u32 s[54:55], 0, v15
    s_cmp_eq_u64 vcc, 0
    s_cselect_b32 s62, 1, 0
    s_cmp_eq_u64 s[54:55], 0
    s_cselect_b32 s62, 2, s62
    v_mov_b32 v5, s62
    ds_write_b32 v108, v5
    s_waitcnt lgkmcnt(0)
LpV_nw0:
    s_barrier
    ds_read_b32 v6, v108
    v_xor_b32 v108, 4, v108
    s_xor_b32 s40, s40, 36864
    s_xor_b32 s59, s59, 36864
    s_xor_b32 s66, s66, 0x2000
    s_xor_b32 s71, s71, 0x2000
    s_sub_u32 s38, s38, 1
    v_add_u32 v9, s40, v0
    v_add_u32 v5, s71, v10
    ds_read_b128 v[32:35], v9 offset:0
    ds_read_b128 v[36:39], v9 offset:1024
    ds_read_b128 v[40:43], v9 offset:2048
    ds_read_b128 v[56:59], v5 offset:0
    ds_read_b128 v[60:63], v5 offset:512
    ds_read_b128 v[64:67], v5 offset:1024
    ds_read_b128 v[68:71], v5 offset:1536
    ds_read_b128 v[72:75], v5 offset:2048
    s_waitcnt lgkmcnt(7)
    v_mfma_f32_32x32x16_bf16 v[16:31], v[32:35], v[112:115], 0
    ds_read_b128 v[44:47], v9 offset:3072
    s_waitcnt lgkmcnt(7)
    v_mfma_f32_32x32x16_bf16 v[16:31], v[36:39], v[116:119], v[16:31]
    ds_read_b128 v[32:35], v9 offset:4096
    v_readfirstlane_b32 s62, v6
    s_nop 0
    s_cmp_eq_u32 s62, 2
    s_cselect_b32 s41, s65, s64
    s_cmp_lg_u32 s62, 0
    s_cselect_b32 s30, 268435456, 0
    s_waitcnt lgkmcnt(7)
    v_mfma_f32_32x32x16_bf16 v[16:31], v[40:43], v[120:123], v[16:31]
    ds_read_b128 v[36:39], v9 offset:5120
    s_add_u32 m0, s59, 0
    s_add_u32 s47, s41, 0
    buffer_load_dwordx4 v0, s[28:31], s47 offen offset:0 lds
    s_waitcnt lgkmcnt(6)
    v_add_f32 v56, v56, v60
    s_waitcnt lgkmcnt(2)
    v_mfma_f32_32x32x16_bf16 v[16:31], v[44:47], v[124:127], v[16:31]
    ds_read_b128 v[40:43], v9 offset:6144
    s_cmp_eq_u32 s62, 2
    s_cselect_b32 s36, 1, 0
    s_cselect_b32 s37, s33, s32
    s_cselect_b32 s17, 1, 0
    s_add_u32 s33, s33, s17
    s_waitcnt lgkmcnt(2)
    v_mfma_f32_32x32x16_bf16 v[16:31], v[32:35], v[128:131], v[16:31]
    ds_read_b128 v[44:47], v9 offset:7168
    buffer_load_dwordx4 v0, s[28:31], s47 offen offset:1024 lds
    v_add_f32 v57, v57, v61
    s_waitcnt lgkmcnt(2)
    v_mfma_f32_32x32x16_bf16 v[16:31], v[36:39], v[132:135], v[16:31]
    ds_read_b128 v[32:35], v9 offset:8192
    s_cmp_eq_u32 s62, 1
    s_cselect_b32 s17, 1, 0
    s_add_u32 s32, s32, s17
    s_lshl_b32 s56, s36, 6
    s_add_u32 s56, s56, s37
    s_waitcnt lgkmcnt(2)
    v_mfma_f32_32x32x16_bf16 v[16:31], v[40:43], v[136:139], v[16:31]
    ds_read_b128 v[36:39], v9 offset:9216
    buffer_load_dwordx4 v0, s[28:31], s47 offen offset:2048 lds
    v_add_f32 v58, v58, v62
    s_waitcnt lgkmcnt(2)
    v_mfma_f32_32x32x16_bf16 v[16:31], v[44:47], v[140:143], v[16:31]
    ds_read_b128 v[40:43], v9 offset:10240
    s_mul_i32 s48, s36, 786432
    s_mul_i32 s18, s37, 6144
    s_add_u32 s48, s48, s18
    s_add_u32 s48, s48, 16125952
    v_add_f32 v59, v59, v63
    s_waitcnt lgkmcnt(2)
    v_mfma_f32_32x32x16_bf16 v[16:31], v[32:35], v[144:147], v[16:31]
    ds_read_b128 v[44:47], v9 offset:11264
    buffer_load_dwordx4 v0, s[28:31], s47 offen offset:3072 lds
    v_add_f32 v56, v56, v64
    s_waitcnt lgkmcnt(2)
    v_mfma_f32_32x32x16_bf16 v[16:31], v[36:39], v[148:151], v[16:31]
    ds_read_b128 v[32:35], v9 offset:12288
    s_cmp_eq_u32 s62, 2
    s_cselect_b32 s17, 36864, 0
    s_add_u32 s65, s65, s17
    v_add_f32 v57, v57, v65
    v_add_f32 v58, v58, v66
    s_waitcnt lgkmcnt(2)
    v_mfma_f32_32x32x16_bf16 v[16:31], v[40:43], v[152:155], v[16:31]
    ds_read_b128 v[36:39], v9 offset:13312
    s_add_u32 m0, s59, 4096
    s_add_u32 s47, s41, 4096
    buffer_load_dwordx4 v0, s[28:31], s47 offen offset:0 lds
    v_add_f32 v59, v59, v67
    s_waitcnt vmcnt(5)
    s_cmp_lg_u32 s43, 0
    s_cselect_b64 exec, 1, 0
    buffer_store_dword v3, v4, s[8:11], s43 offen sc1
    s_mov_b64 exec, -1
    s_mov_b32 s43, 0
    s_waitcnt lgkmcnt(2)
    v_mfma_f32_32x32x16_bf16 v[16:31], v[44:47], v[156:159], v[16:31]
    ds_read_b128 v[40:43], v9 offset:14336
    s_cmp_eq_u32 s62, 1
    s_cselect_b32 s17, 36864, 0
    s_add_u32 s64, s64, s17
    v_add_f32 v56, v56, v68
    v_add_f32 v57, v57, v69
    s_waitcnt lgkmcnt(2)
    v_mfma_f32_32x32x16_bf16 v[16:31], v[32:35], v[160:163], v[16:31]
    ds_read_b128 v[44:47], v9 offset:15360
    buffer_load_dwordx4 v0, s[28:31], s47 offen offset:1024 lds
    v_add_f32 v58, v58, v70
    s_waitcnt lgkmcnt(2)
    v_mfma_f32_32x32x16_bf16 v[16:31], v[36:39], v[164:167], v[16:31]
    ds_read_b128 v[32:35], v9 offset:16384
    buffer_load_dwordx4 v0, s[28:31], s47 offen offset:2048 lds
    v_add_f32 v59, v59, v71
    s_waitcnt lgkmcnt(2)
    v_mfma_f32_32x32x16_bf16 v[16:31], v[40:43], v[168:171], v[16:31]
    ds_read_b128 v[36:39], v9 offset:17408
    buffer_load_dwordx4 v0, s[28:31], s47 offen offset:3072 lds
    v_add_f32 v56, v56, v72
    s_waitcnt lgkmcnt(2)
    v_mfma_f32_32x32x16_bf16 v[16:31], v[44:47], v[172:175], v[16:31]
    ds_read_b128 v[40:43], v9 offset:18432
    s_add_u32 m0, s59, 8192
    s_add_u32 s47, s41, 8192
    buffer_load_dwordx4 v0, s[28:31], s47 offen offset:0 lds
    v_add_f32 v57, v57, v73
    s_waitcnt lgkmcnt(2)
    v_mfma_f32_32x32x16_bf16 v[16:31], v[32:35], v[176:179], v[16:31]
    ds_read_b128 v[44:47], v9 offset:19456
    s_add_u32 m0, s66, 4096
    s_nop 0
    buffer_load_dwordx4 v0, s[28:31], s48 offen lds
    v_add_f32 v58, v58, v74
    v_add_f32 v59, v59, v75
    s_cmp_lg_u32 s14, 0
    s_cbranch_scc1 LpV_ns_5
    s_mul_i32 s60, s32, 22528
    s_add_u32 s60, s60, 3584
    s_cmp_lt_u32 s32, 64
    s_cselect_b32 s60, s60, 2883584
    s_mul_i32 s61, s33, 22528
    s_add_u32 s61, s61, 1445376
    s_cmp_lt_u32 s33, 64
    s_cselect_b32 s61, s61, 2883584
    buffer_load_dword v2, v1, s[8:11], s60 offen sc1
    buffer_load_dword v15, v1, s[8:11], s61 offen sc1
LpV_ns_5:
    s_waitcnt lgkmcnt(2)
    v_mfma_f32_32x32x16_bf16 v[16:31], v[36:39], v[180:183], v[16:31]
    ds_read_b128 v[32:35], v9 offset:20480
    s_add_u32 m0, s66, s67
    s_sub_u32 s48, s48, 4096
    s_add_u32 s48, s48, s67
    buffer_load_dwordx4 v0, s[28:31], s48 offen lds
    v_add_f32 v56, v56, v58
    v_add_f32 v57, v57, v59
    s_waitcnt lgkmcnt(2)
    v_mfma_f32_32x32x16_bf16 v[16:31], v[40:43], v[184:187], v[16:31]
    ds_read_b128 v[36:39], v9 offset:21504
    v_mov_b32 v58, v56
    v_mov_b32 v59, v57
    s_nop 0
    v_permlane32_swap_b32 v56, v58
    v_permlane32_swap_b32 v57, v59
    s_waitcnt lgkmcnt(2)
    v_mfma_f32_32x32x16_bf16 v[16:31], v[44:47], v[188:191], v[16:31]
    ds_read_b128 v[40:43], v9 offset:22528
    v_add_f32 v56, v56, v58
    v_add_f32 v57, v57, v59
    v_mul_f32 v56, 0x3ae38e39, v56
    v_mul_f32 v57, 0x3ae38e39, v57
    s_waitcnt lgkmcnt(2)
    v_mfma_f32_32x32x16_bf16 v[16:31], v[32:35], v[192:195], v[16:31]
    ds_read_b128 v[44:47], v9 offset:23552
    v_fma_f32 v57, -v56, v56, v57
    v_max_f32 v57, 0, v57
    v_add_f32 v57, 0x3727c5ac, v57
    v_rsq_f32 v76, v57
    s_waitcnt lgkmcnt(2)
    v_mfma_f32_32x32x16_bf16 v[16:31], v[36:39], v[196:199], v[16:31]
    ds_read_b128 v[32:35], v9 offset:24576
    v_mul_f32 v77, v56, v76
    ds_write2_b32 v12, v76, v77 offset0:0 offset1:32
    ds_read_b128 v[76:79], v13 offset:0
    ds_read_b128 v[80:83], v13 offset:32
    s_waitcnt lgkmcnt(5)
    v_mfma_f32_32x32x16_bf16 v[16:31], v[40:43], v[200:203], v[16:31]
    ds_read_b128 v[36:39], v9 offset:25600
    ds_read_b128 v[84:87], v13 offset:64
    ds_read_b128 v[88:91], v13 offset:96
    ds_read_b128 v[92:95], v13 offset:128
    ds_read_b128 v[96:99], v13 offset:160
    s_waitcnt lgkmcnt(9)
    v_mfma_f32_32x32x16_bf16 v[16:31], v[44:47], v[204:207], v[16:31]
    ds_read_b128 v[40:43], v9 offset:26624
    ds_read_b128 v[100:103], v13 offset:192
    ds_read_b128 v[104:107], v13 offset:224
    s_waitcnt lgkmcnt(11)
    v_mfma_f32_32x32x16_bf16 v[16:31], v[32:35], v[208:211], v[16:31]
    ds_read_b128 v[44:47], v9 offset:27648
    s_waitcnt lgkmcnt(8)
    v_mfma_f32_32x32x16_bf16 v[16:31], v[36:39], v[212:215], v[16:31]
    ds_read_b128 v[32:35], v9 offset:28672
    s_waitcnt lgkmcnt(6)
    v_mul_f32 v92, v11, v92
    s_waitcnt lgkmcnt(4)
    v_mfma_f32_32x32x16_bf16 v[16:31], v[40:43], v[216:219], v[16:31]
    ds_read_b128 v[36:39], v9 offset:29696
    v_mul_f32 v93, v11, v93
    v_mul_f32 v94, v11, v94
    v_mul_f32 v95, v11, v95
    v_mul_f32 v96, v11, v96
    s_waitcnt lgkmcnt(2)
    v_mfma_f32_32x32x16_bf16 v[16:31], v[44:47], v[220:223], v[16:31]
    ds_read_b128 v[40:43], v9 offset:30720
    v_mul_f32 v97, v11, v97
    v_mul_f32 v98, v11, v98
    v_mul_f32 v99, v11, v99
    v_mul_f32 v100, v11, v100
    s_waitcnt lgkmcnt(2)
    v_mfma_f32_32x32x16_bf16 v[16:31], v[32:35], v[224:227], v[16:31]
    ds_read_b128 v[44:47], v9 offset:31744
    v_mul_f32 v101, v11, v101
    v_mul_f32 v102, v11, v102
    v_mul_f32 v103, v11, v103
    v_mul_f32 v104, v11, v104
    s_waitcnt lgkmcnt(2)
    v_mfma_f32_32x32x16_bf16 v[16:31], v[36:39], v[228:231], v[16:31]
    ds_read_b128 v[32:35], v9 offset:32768
    v_mul_f32 v105, v11, v105
    v_mul_f32 v106, v11, v106
    v_mul_f32 v107, v11, v107
    s_mul_i32 s46, s34, 50331648
    s_waitcnt lgkmcnt(2)
    v_mfma_f32_32x32x16_bf16 v[16:31], v[40:43], v[232:235], v[16:31]
    ds_read_b128 v[36:39], v9 offset:33792
    s_lshl_b32 s51, s35, 18
    s_add_u32 s46, s46, s51
    s_add_u32 s46, s46, s52
    s_waitcnt lgkmcnt(2)
    v_mfma_f32_32x32x16_bf16 v[16:31], v[44:47], v[236:239], v[16:31]
    ds_read_b128 v[40:43], v9 offset:34816
    s_waitcnt lgkmcnt(2)
    v_mfma_f32_32x32x16_bf16 v[16:31], v[32:35], v[240:243], v[16:31]
    ds_read_b128 v[44:47], v9 offset:35840
    s_waitcnt lgkmcnt(2)
    v_mfma_f32_32x32x16_bf16 v[16:31], v[36:39], v[244:247], v[16:31]
    s_waitcnt lgkmcnt(1)
    v_mfma_f32_32x32x16_bf16 v[16:31], v[40:43], v[248:251], v[16:31]
    s_waitcnt lgkmcnt(0)
    v_mfma_f32_32x32x16_bf16 v[16:31], v[44:47], v[252:255], v[16:31]
    s_nop 11
    v_pk_fma_f32 v[16:17], v[16:17], v[76:77], v[92:93] neg_lo:[0,0,1] neg_hi:[0,0,1]
    v_pk_fma_f32 v[18:19], v[18:19], v[78:79], v[94:95] neg_lo:[0,0,1] neg_hi:[0,0,1]
    v_pk_fma_f32 v[24:25], v[24:25], v[84:85], v[100:101] neg_lo:[0,0,1] neg_hi:[0,0,1]
    v_pk_fma_f32 v[26:27], v[26:27], v[86:87], v[102:103] neg_lo:[0,0,1] neg_hi:[0,0,1]
    v_cvt_pk_bf16_f32 v48, v16, v17
    v_cvt_pk_bf16_f32 v49, v18, v19
    v_cvt_pk_bf16_f32 v50, v24, v25
    v_cvt_pk_bf16_f32 v51, v26, v27
    buffer_store_dwordx4 v[48:51], v14, s[8:11], s46 offen offset:0 sc1
    v_pk_fma_f32 v[20:21], v[20:21], v[80:81], v[96:97] neg_lo:[0,0,1] neg_hi:[0,0,1]
    v_pk_fma_f32 v[22:23], v[22:23], v[82:83], v[98:99] neg_lo:[0,0,1] neg_hi:[0,0,1]
    v_pk_fma_f32 v[28:29], v[28:29], v[88:89], v[104:105] neg_lo:[0,0,1] neg_hi:[0,0,1]
    v_pk_fma_f32 v[30:31], v[30:31], v[90:91], v[106:107] neg_lo:[0,0,1] neg_hi:[0,0,1]
    v_cvt_pk_bf16_f32 v52, v20, v21
    v_cvt_pk_bf16_f32 v53, v22, v23
    v_cvt_pk_bf16_f32 v54, v28, v29
    v_cvt_pk_bf16_f32 v55, v30, v31
    buffer_store_dwordx4 v[52:55], v14, s[8:11], s46 offen offset:512 sc1
    s_mul_i32 s43, s57, 22528
    s_add_u32 s43, s43, s49
    s_mov_b32 s34, s36
    s_mov_b32 s35, s37
    s_mov_b32 s57, s56
    s_min_u32 s62, s62, s38
    s_cmp_lg_u32 s62, 0
    s_cbranch_scc1 LpV_item
    s_cmp_lg_u32 s14, 0
    s_cbranch_scc1 LpV_ns_6
    s_mul_i32 s60, s32, 22528
    s_add_u32 s60, s60, 3584
    s_cmp_lt_u32 s32, 64
    s_cselect_b32 s60, s60, 2883584
    s_mul_i32 s61, s33, 22528
    s_add_u32 s61, s61, 1445376
    s_cmp_lt_u32 s33, 64
    s_cselect_b32 s61, s61, 2883584
    buffer_load_dword v2, v1, s[8:11], s60 offen sc1
    buffer_load_dword v15, v1, s[8:11], s61 offen sc1
LpV_ns_6:
    s_waitcnt vmcnt(0)
    s_cmp_lg_u32 s43, 0
    s_cselect_b64 exec, 1, 0
    buffer_store_dword v3, v4, s[8:11], s43 offen sc1
    s_mov_b64 exec, -1
    s_mov_b32 s43, 0
    s_cmp_eq_u32 s38, 0
    s_cbranch_scc1 LpV_end
    s_cmp_lg_u32 s14, 0
    s_cbranch_scc1 LpV_nw1
    v_cmp_eq_u32 vcc, 0, v2
    v_cmp_eq_u32 s[54:55], 0, v15
    s_cmp_eq_u64 vcc, 0
    s_cselect_b32 s62, 1, 0
    s_cmp_eq_u64 s[54:55], 0
    s_cselect_b32 s62, 2, s62
    s_cmp_lg_u32 s62, 0
    s_cbranch_scc1 LpV_got
LpV_idle0:
    s_cmp_lg_u32 s14, 0
    s_cbranch_scc1 LpV_nw1
    s_mul_i32 s60, s32, 22528
    s_add_u32 s60, s60, 3584
    s_cmp_lt_u32 s32, 64
    s_cselect_b32 s60, s60, 2883584
    s_mul_i32 s61, s33, 22528
    s_add_u32 s61, s61, 1445376
    s_cmp_lt_u32 s33, 64
    s_cselect_b32 s61, s61, 2883584
    s_mov_b32 s16, 0
LpV_pl_7:
    buffer_load_dword v2, v1, s[8:11], s60 offen sc1
    buffer_load_dword v15, v1, s[8:11], s61 offen sc1
    s_add_u32 s16, s16, 1
    s_cmp_gt_u32 s16, 100000
    s_cbranch_scc1 L_role_p_abort
    s_waitcnt vmcnt(1)
    v_cmp_eq_u32 vcc, 0, v2
    s_waitcnt vmcnt(0)
    v_cmp_eq_u32 s[54:55], 0, v15
    s_cmp_eq_u64 vcc, 0
    s_cselect_b32 s62, 1, 0
    s_cmp_eq_u64 s[54:55], 0
    s_cselect_b32 s62, 2, s62
    s_cmp_lg_u32 s62, 0
    s_cbranch_scc1 LpV_pl_7d
    s_sleep 4
    s_branch LpV_pl_7
LpV_pl_7d:
LpV_got:
    v_mov_b32 v5, s62
    ds_write_b32 v108, v5
    s_waitcnt lgkmcnt(0)
LpV_nw1:
    s_barrier
    ds_read_b32 v6, v108
    v_xor_b32 v108, 4, v108
    s_waitcnt lgkmcnt(0)
    v_readfirstlane_b32 s62, v6
    s_nop 0
    s_cmp_eq_u32 s62, 0
    s_cbranch_scc1 L_role_p_abort
    s_cmp_eq_u32 s62, 2
    s_cselect_b32 s41, s65, s64
    s_cmp_lg_u32 s62, 0
    s_cselect_b32 s30, 268435456, 0
    s_cmp_eq_u32 s62, 2
    s_cselect_b32 s36, 1, 0
    s_cselect_b32 s37, s33, s32
    s_cselect_b32 s17, 1, 0
    s_add_u32 s33, s33, s17
    s_cmp_eq_u32 s62, 1
    s_cselect_b32 s17, 1, 0
    s_add_u32 s32, s32, s17
    s_lshl_b32 s56, s36, 6
    s_add_u32 s56, s56, s37
    s_cmp_eq_u32 s62, 2
    s_cselect_b32 s17, 36864, 0
    s_add_u32 s65, s65, s17
    s_cmp_eq_u32 s62, 1
    s_cselect_b32 s17, 36864, 0
    s_add_u32 s64, s64, s17
    s_add_u32 m0, s59, 0
    s_add_u32 s47, s41, 0
    buffer_load_dwordx4 v0, s[8:11], s47 offen offset:0 lds
    buffer_load_dwordx4 v0, s[8:11], s47 offen offset:1024 lds
    buffer_load_dwordx4 v0, s[8:11], s47 offen offset:2048 lds
    buffer_load_dwordx4 v0, s[8:11], s47 offen offset:3072 lds
    s_add_u32 m0, s59, 4096
    s_add_u32 s47, s41, 4096
    buffer_load_dwordx4 v0, s[8:11], s47 offen offset:0 lds
    buffer_load_dwordx4 v0, s[8:11], s47 offen offset:1024 lds
    buffer_load_dwordx4 v0, s[8:11], s47 offen offset:2048 lds
    buffer_load_dwordx4 v0, s[8:11], s47 offen offset:3072 lds
    s_add_u32 m0, s59, 8192
    s_add_u32 s47, s41, 8192
    buffer_load_dwordx4 v0, s[8:11], s47 offen offset:0 lds
    s_mul_i32 s48, s36, 786432
    s_mul_i32 s18, s37, 6144
    s_add_u32 s48, s48, s18
    s_add_u32 s48, s48, 16125952
    s_add_u32 m0, s66, 4096
    s_nop 0
    buffer_load_dwordx4 v0, s[8:11], s48 offen lds
    s_add_u32 m0, s66, s67
    s_sub_u32 s48, s48, 4096
    s_add_u32 s48, s48, s67
    buffer_load_dwordx4 v0, s[8:11], s48 offen lds
    s_mov_b32 s34, s36
    s_mov_b32 s35, s37
    s_mov_b32 s57, s56
    s_cmp_lg_u32 s14, 0
    s_cbranch_scc1 LpV_ns_8
    s_mul_i32 s60, s32, 22528
    s_add_u32 s60, s60, 3584
    s_cmp_lt_u32 s32, 64
    s_cselect_b32 s60, s60, 2883584
    s_mul_i32 s61, s33, 22528
    s_add_u32 s61, s61, 1445376
    s_cmp_lt_u32 s33, 64
    s_cselect_b32 s61, s61, 2883584
    buffer_load_dword v2, v1, s[8:11], s60 offen sc1
    buffer_load_dword v15, v1, s[8:11], s61 offen sc1
LpV_ns_8:
    s_waitcnt vmcnt(0)
    s_branch LpV_item
LpV_end:
    s_branch L_role_p_exit
L_role_p_abort:
    s_waitcnt lgkmcnt(0)
    s_mov_b64 exec, -1
    v_mov_b32 v0, 60
    s_lshl_b32 s5, s3, 8
    s_or_b32 s5, s5, s4
    s_or_b32 s5, s5, 0x10000
    v_mov_b32 v1, s5
    global_store_dword v0, v1, s[12:13]
    s_endpgm
L_role_p_exit:
    s_endpgm
.p2align 6
L_role_awo:
    v_and_b32 v5, 63, v0
    v_lshlrev_b32 v0, 4, v5
    v_and_b32 v7, 15, v5
    v_lshrrev_b32 v8, 4, v5
    v_min_u32 v1, 63, v5
    v_lshrrev_b32 v6, 2, v1
    v_and_b32 v1, 3, v1
    v_lshlrev_b32 v1, 2, v1
    v_lshl_add_u32 v1, v6, 7, v1
    v_mov_b32 v3, 1
    v_mov_b32 v4, 0
    s_mov_b32 s44, 0x05040100
    s_mov_b32 s45, 0x07060302
    s_load_dwordx2 s[20:21], s[0:1], 16
    s_mov_b32 s22, 663552
    s_mov_b32 s23, 0x00020000
    s_waitcnt lgkmcnt(0)
    s_and_b32 s21, s21, 0xffff
    s_cmp_ge_u32 s15, 5
    s_cselect_b32 s63, 1, 0
    s_cselect_b32 s17, 5, 0
    s_sub_u32 s15, s15, s17
    s_lshl_b32 s50, s15, 2
    s_add_u32 s50, s50, s14
    s_min_u32 s50, s50, 17
    s_lshl_b32 s49, s50, 6
    v_bfe_u32 v10, v0, 4, 5
    v_and_b32 v14, 19, v10
    v_bfe_u32 v5, v10, 2, 1
    v_lshl_add_u32 v14, v5, 3, v14
    v_bfe_u32 v5, v10, 3, 1
    v_lshl_add_u32 v14, v5, 2, v14
    v_and_b32 v5, 1, v14
    v_mov_b32 v11, s44
    v_mov_b32 v6, s45
    v_cmp_eq_u32 vcc, 1, v5
    s_nop 1
    v_cndmask_b32 v11, v11, v6, vcc
    v_and_b32 v14, 30, v14
    v_lshlrev_b32 v14, 1, v14
    v_lshrrev_b32 v9, 9, v0
    v_mul_u32_u24 v5, 9216, v9
    v_add_u32 v12, v5, v14
    v_add_u32 v13, 1152, v12
    s_add_u32 s17, s49, 0
    buffer_load_dword v16, v12, s[20:23], s17 offen
    buffer_load_dword v17, v13, s[20:23], s17 offen
    s_add_u32 s17, s49, 2304
    buffer_load_dword v18, v12, s[20:23], s17 offen
    buffer_load_dword v19, v13, s[20:23], s17 offen
    s_add_u32 s17, s49, 4608
    buffer_load_dword v20, v12, s[20:23], s17 offen
    buffer_load_dword v21, v13, s[20:23], s17 offen
    s_add_u32 s17, s49, 6912
    buffer_load_dword v22, v12, s[20:23], s17 offen
    buffer_load_dword v23, v13, s[20:23], s17 offen
    s_add_u32 s17, s49, 20736
    buffer_load_dword v24, v12, s[20:23], s17 offen
    buffer_load_dword v25, v13, s[20:23], s17 offen
    s_add_u32 s17, s49, 23040
    buffer_load_dword v26, v12, s[20:23], s17 offen
    buffer_load_dword v27, v13, s[20:23], s17 offen
    s_add_u32 s17, s49, 25344
    buffer_load_dword v28, v12, s[20:23], s17 offen
    buffer_load_dword v29, v13, s[20:23], s17 offen
    s_add_u32 s17, s49, 27648
    buffer_load_dword v30, v12, s[20:23], s17 offen
    buffer_load_dword v31, v13, s[20:23], s17 offen
    s_add_u32 s17, s49, 41472
    buffer_load_dword v32, v12, s[20:23], s17 offen
    buffer_load_dword v33, v13, s[20:23], s17 offen
    s_add_u32 s17, s49, 43776
    buffer_load_dword v34, v12, s[20:23], s17 offen
    buffer_load_dword v35, v13, s[20:23], s17 offen
    s_add_u32 s17, s49, 46080
    buffer_load_dword v36, v12, s[20:23], s17 offen
    buffer_load_dword v37, v13, s[20:23], s17 offen
    s_add_u32 s17, s49, 48384
    buffer_load_dword v38, v12, s[20:23], s17 offen
    buffer_load_dword v39, v13, s[20:23], s17 offen
    s_add_u32 s17, s49, 62208
    buffer_load_dword v40, v12, s[20:23], s17 offen
    buffer_load_dword v41, v13, s[20:23], s17 offen
    s_add_u32 s17, s49, 64512
    buffer_load_dword v42, v12, s[20:23], s17 offen
    buffer_load_dword v43, v13, s[20:23], s17 offen
    s_add_u32 s17, s49, 66816
    buffer_load_dword v44, v12, s[20:23], s17 offen
    buffer_load_dword v45, v13, s[20:23], s17 offen
    s_add_u32 s17, s49, 69120
    buffer_load_dword v46, v12, s[20:23], s17 offen
    buffer_load_dword v47, v13, s[20:23], s17 offen
    s_add_u32 s17, s49, 82944
    buffer_load_dword v48, v12, s[20:23], s17 offen
    buffer_load_dword v49, v13, s[20:23], s17 offen
    s_add_u32 s17, s49, 85248
    buffer_load_dword v50, v12, s[20:23], s17 offen
    buffer_load_dword v51, v13, s[20:23], s17 offen
    s_add_u32 s17, s49, 87552
    buffer_load_dword v52, v12, s[20:23], s17 offen
    buffer_load_dword v53, v13, s[20:23], s17 offen
    s_add_u32 s17, s49, 89856
    buffer_load_dword v54, v12, s[20:23], s17 offen
    buffer_load_dword v55, v13, s[20:23], s17 offen
    s_add_u32 s17, s49, 103680
    buffer_load_dword v56, v12, s[20:23], s17 offen
    buffer_load_dword v57, v13, s[20:23], s17 offen
    s_add_u32 s17, s49, 105984
    buffer_load_dword v58, v12, s[20:23], s17 offen
    buffer_load_dword v59, v13, s[20:23], s17 offen
    s_add_u32 s17, s49, 108288
    buffer_load_dword v60, v12, s[20:23], s17 offen
    buffer_load_dword v61, v13, s[20:23], s17 offen
    s_add_u32 s17, s49, 110592
    buffer_load_dword v62, v12, s[20:23], s17 offen
    buffer_load_dword v63, v13, s[20:23], s17 offen
    s_add_u32 s17, s49, 124416
    buffer_load_dword v64, v12, s[20:23], s17 offen
    buffer_load_dword v65, v13, s[20:23], s17 offen
    s_add_u32 s17, s49, 126720
    buffer_load_dword v66, v12, s[20:23], s17 offen
    buffer_load_dword v67, v13, s[20:23], s17 offen
    s_add_u32 s17, s49, 129024
    buffer_load_dword v68, v12, s[20:23], s17 offen
    buffer_load_dword v69, v13, s[20:23], s17 offen
    s_add_u32 s17, s49, 131328
    buffer_load_dword v70, v12, s[20:23], s17 offen
    buffer_load_dword v71, v13, s[20:23], s17 offen
    s_add_u32 s17, s49, 145152
    buffer_load_dword v72, v12, s[20:23], s17 offen
    buffer_load_dword v73, v13, s[20:23], s17 offen
    s_waitcnt vmcnt(56)
    v_perm_b32 v112, v17, v16, v11
    s_add_u32 s17, s49, 147456
    buffer_load_dword v74, v12, s[20:23], s17 offen
    buffer_load_dword v75, v13, s[20:23], s17 offen
    s_waitcnt vmcnt(56)
    v_perm_b32 v113, v19, v18, v11
    s_add_u32 s17, s49, 149760
    buffer_load_dword v76, v12, s[20:23], s17 offen
    buffer_load_dword v77, v13, s[20:23], s17 offen
    s_waitcnt vmcnt(56)
    v_perm_b32 v114, v21, v20, v11
    s_add_u32 s17, s49, 152064
    buffer_load_dword v78, v12, s[20:23], s17 offen
    buffer_load_dword v79, v13, s[20:23], s17 offen
    s_waitcnt vmcnt(56)
    v_perm_b32 v115, v23, v22, v11
    s_add_u32 s17, s49, 165888
    buffer_load_dword v80, v12, s[20:23], s17 offen
    buffer_load_dword v81, v13, s[20:23], s17 offen
    s_waitcnt vmcnt(56)
    v_perm_b32 v116, v25, v24, v11
    s_add_u32 s17, s49, 168192
    buffer_load_dword v82, v12, s[20:23], s17 offen
    buffer_load_dword v83, v13, s[20:23], s17 offen
    s_waitcnt vmcnt(56)
    v_perm_b32 v117, v27, v26, v11
    s_add_u32 s17, s49, 170496
    buffer_load_dword v84, v12, s[20:23], s17 offen
    buffer_load_dword v85, v13, s[20:23], s17 offen
    s_waitcnt vmcnt(56)
    v_perm_b32 v118, v29, v28, v11
    s_add_u32 s17, s49, 172800
    buffer_load_dword v86, v12, s[20:23], s17 offen
    buffer_load_dword v87, v13, s[20:23], s17 offen
    s_waitcnt vmcnt(56)
    v_perm_b32 v119, v31, v30, v11
    s_add_u32 s17, s49, 186624
    buffer_load_dword v88, v12, s[20:23], s17 offen
    buffer_load_dword v89, v13, s[20:23], s17 offen
    s_waitcnt vmcnt(56)
    v_perm_b32 v120, v33, v32, v11
    s_add_u32 s17, s49, 188928
    buffer_load_dword v90, v12, s[20:23], s17 offen
    buffer_load_dword v91, v13, s[20:23], s17 offen
    s_waitcnt vmcnt(56)
    v_perm_b32 v121, v35, v34, v11
    s_add_u32 s17, s49, 191232
    buffer_load_dword v92, v12, s[20:23], s17 offen
    buffer_load_dword v93, v13, s[20:23], s17 offen
    s_waitcnt vmcnt(56)
    v_perm_b32 v122, v37, v36, v11
    s_add_u32 s17, s49, 193536
    buffer_load_dword v94, v12, s[20:23], s17 offen
    buffer_load_dword v95, v13, s[20:23], s17 offen
    s_waitcnt vmcnt(56)
    v_perm_b32 v123, v39, v38, v11
    s_add_u32 s17, s49, 207360
    buffer_load_dword v96, v12, s[20:23], s17 offen
    buffer_load_dword v97, v13, s[20:23], s17 offen
    s_waitcnt vmcnt(56)
    v_perm_b32 v124, v41, v40, v11
    s_add_u32 s17, s49, 209664
    buffer_load_dword v98, v12, s[20:23], s17 offen
    buffer_load_dword v99, v13, s[20:23], s17 offen
    s_waitcnt vmcnt(56)
    v_perm_b32 v125, v43, v42, v11
    s_add_u32 s17, s49, 211968
    buffer_load_dword v100, v12, s[20:23], s17 offen
    buffer_load_dword v101, v13, s[20:23], s17 offen
    s_waitcnt vmcnt(56)
    v_perm_b32 v126, v45, v44, v11
    s_add_u32 s17, s49, 214272
    buffer_load_dword v102, v12, s[20:23], s17 offen
    buffer_load_dword v103, v13, s[20:23], s17 offen
    s_waitcnt vmcnt(56)
    v_perm_b32 v127, v47, v46, v11
    s_add_u32 s17, s49, 228096
    buffer_load_dword v104, v12, s[20:23], s17 offen
    buffer_load_dword v105, v13, s[20:23], s17 offen
    s_waitcnt vmcnt(56)
    v_perm_b32 v128, v49, v48, v11
    s_add_u32 s17, s49, 230400
    buffer_load_dword v106, v12, s[20:23], s17 offen
    buffer_load_dword v107, v13, s[20:23], s17 offen
    s_waitcnt vmcnt(56)
    v_perm_b32 v129, v51, v50, v11
    s_add_u32 s17, s49, 232704
    buffer_load_dword v108, v12, s[20:23], s17 offen
    buffer_load_dword v109, v13, s[20:23], s17 offen
    s_waitcnt vmcnt(56)
    v_perm_b32 v130, v53, v52, v11
    s_add_u32 s17, s49, 235008
    buffer_load_dword v110, v12, s[20:23], s17 offen
    buffer_load_dword v111, v13, s[20:23], s17 offen
    s_waitcnt vmcnt(56)
    v_perm_b32 v131, v55, v54, v11
    s_add_u32 s17, s49, 248832
    buffer_load_dword v16, v12, s[20:23], s17 offen
    buffer_load_dword v17, v13, s[20:23], s17 offen
    s_waitcnt vmcnt(56)
    v_perm_b32 v132, v57, v56, v11
    s_add_u32 s17, s49, 251136
    buffer_load_dword v18, v12, s[20:23], s17 offen
    buffer_load_dword v19, v13, s[20:23], s17 offen
    s_waitcnt vmcnt(56)
    v_perm_b32 v133, v59, v58, v11
    s_add_u32 s17, s49, 253440
    buffer_load_dword v20, v12, s[20:23], s17 offen
    buffer_load_dword v21, v13, s[20:23], s17 offen
    s_waitcnt vmcnt(56)
    v_perm_b32 v134, v61, v60, v11
    s_add_u32 s17, s49, 255744
    buffer_load_dword v22, v12, s[20:23], s17 offen
    buffer_load_dword v23, v13, s[20:23], s17 offen
    s_waitcnt vmcnt(56)
    v_perm_b32 v135, v63, v62, v11
    s_add_u32 s17, s49, 269568
    buffer_load_dword v24, v12, s[20:23], s17 offen
    buffer_load_dword v25, v13, s[20:23], s17 offen
    s_waitcnt vmcnt(56)
    v_perm_b32 v136, v65, v64, v11
    s_add_u32 s17, s49, 271872
    buffer_load_dword v26, v12, s[20:23], s17 offen
    buffer_load_dword v27, v13, s[20:23], s17 offen
    s_waitcnt vmcnt(56)
    v_perm_b32 v137, v67, v66, v11
    s_add_u32 s17, s49, 274176
    buffer_load_dword v28, v12, s[20:23], s17 offen
    buffer_load_dword v29, v13, s[20:23], s17 offen
    s_waitcnt vmcnt(56)
    v_perm_b32 v138, v69, v68, v11
    s_add_u32 s17, s49, 276480
    buffer_load_dword v30, v12, s[20:23], s17 offen
    buffer_load_dword v31, v13, s[20:23], s17 offen
    s_waitcnt vmcnt(56)
    v_perm_b32 v139, v71, v70, v11
    s_add_u32 s17, s49, 290304
    buffer_load_dword v32, v12, s[20:23], s17 offen
    buffer_load_dword v33, v13, s[20:23], s17 offen
    s_waitcnt vmcnt(56)
    v_perm_b32 v140, v73, v72, v11
    s_add_u32 s17, s49, 292608
    buffer_load_dword v34, v12, s[20:23], s17 offen
    buffer_load_dword v35, v13, s[20:23], s17 offen
    s_waitcnt vmcnt(56)
    v_perm_b32 v141, v75, v74, v11
    s_add_u32 s17, s49, 294912
    buffer_load_dword v36, v12, s[20:23], s17 offen
    buffer_load_dword v37, v13, s[20:23], s17 offen
    s_waitcnt vmcnt(56)
    v_perm_b32 v142, v77, v76, v11
    s_add_u32 s17, s49, 297216
    buffer_load_dword v38, v12, s[20:23], s17 offen
    buffer_load_dword v39, v13, s[20:23], s17 offen
    s_waitcnt vmcnt(56)
    v_perm_b32 v143, v79, v78, v11
    s_add_u32 s17, s49, 311040
    buffer_load_dword v40, v12, s[20:23], s17 offen
    buffer_load_dword v41, v13, s[20:23], s17 offen
    s_waitcnt vmcnt(56)
    v_perm_b32 v144, v81, v80, v11
    s_add_u32 s17, s49, 313344
    buffer_load_dword v42, v12, s[20:23], s17 offen
    buffer_load_dword v43, v13, s[20:23], s17 offen
    s_waitcnt vmcnt(56)
    v_perm_b32 v145, v83, v82, v11
    s_add_u32 s17, s49, 315648
    buffer_load_dword v44, v12, s[20:23], s17 offen
    buffer_load_dword v45, v13, s[20:23], s17 offen
    s_waitcnt vmcnt(56)
    v_perm_b32 v146, v85, v84, v11
    s_add_u32 s17, s49, 317952
    buffer_load_dword v46, v12, s[20:23], s17 offen
    buffer_load_dword v47, v13, s[20:23], s17 offen
    s_waitcnt vmcnt(56)
    v_perm_b32 v147, v87, v86, v11
    s_add_u32 s17, s49, 331776
    buffer_load_dword v48, v12, s[20:23], s17 offen
    buffer_load_dword v49, v13, s[20:23], s17 offen
    s_waitcnt vmcnt(56)
    v_perm_b32 v148, v89, v88, v11
    s_add_u32 s17, s49, 334080
    buffer_load_dword v50, v12, s[20:23], s17 offen
    buffer_load_dword v51, v13, s[20:23], s17 offen
    s_waitcnt vmcnt(56)
    v_perm_b32 v149, v91, v90, v11
    s_add_u32 s17, s49, 336384
    buffer_load_dword v52, v12, s[20:23], s17 offen
    buffer_load_dword v53, v13, s[20:23], s17 offen
    s_waitcnt vmcnt(56)
    v_perm_b32 v150, v93, v92, v11
    s_add_u32 s17, s49, 338688
    buffer_load_dword v54, v12, s[20:23], s17 offen
    buffer_load_dword v55, v13, s[20:23], s17 offen
    s_waitcnt vmcnt(56)
    v_perm_b32 v151, v95, v94, v11
    s_add_u32 s17, s49, 352512
    buffer_load_dword v56, v12, s[20:23], s17 offen
    buffer_load_dword v57, v13, s[20:23], s17 offen
    s_waitcnt vmcnt(56)
    v_perm_b32 v152, v97, v96, v11
    s_add_u32 s17, s49, 354816
    buffer_load_dword v58, v12, s[20:23], s17 offen
    buffer_load_dword v59, v13, s[20:23], s17 offen
    s_waitcnt vmcnt(56)
    v_perm_b32 v153, v99, v98, v11
    s_add_u32 s17, s49, 357120
    buffer_load_dword v60, v12, s[20:23], s17 offen
    buffer_load_dword v61, v13, s[20:23], s17 offen
    s_waitcnt vmcnt(56)
    v_perm_b32 v154, v101, v100, v11
    s_add_u32 s17, s49, 359424
    buffer_load_dword v62, v12, s[20:23], s17 offen
    buffer_load_dword v63, v13, s[20:23], s17 offen
    s_waitcnt vmcnt(56)
    v_perm_b32 v155, v103, v102, v11
    s_add_u32 s17, s49, 373248
    buffer_load_dword v64, v12, s[20:23], s17 offen
    buffer_load_dword v65, v13, s[20:23], s17 offen
    s_waitcnt vmcnt(56)
    v_perm_b32 v156, v105, v104, v11
    s_add_u32 s17, s49, 375552
    buffer_load_dword v66, v12, s[20:23], s17 offen
    buffer_load_dword v67, v13, s[20:23], s17 offen
    s_waitcnt vmcnt(56)
    v_perm_b32 v157, v107, v106, v11
    s_add_u32 s17, s49, 377856
    buffer_load_dword v68, v12, s[20:23], s17 offen
    buffer_load_dword v69, v13, s[20:23], s17 offen
    s_waitcnt vmcnt(56)
    v_perm_b32 v158, v109, v108, v11
    s_add_u32 s17, s49, 380160
    buffer_load_dword v70, v12, s[20:23], s17 offen
    buffer_load_dword v71, v13, s[20:23], s17 offen
    s_waitcnt vmcnt(56)
    v_perm_b32 v159, v111, v110, v11
    s_add_u32 s17, s49, 393984
    buffer_load_dword v72, v12, s[20:23], s17 offen
    buffer_load_dword v73, v13, s[20:23], s17 offen
    s_waitcnt vmcnt(56)
    v_perm_b32 v160, v17, v16, v11
    s_add_u32 s17, s49, 396288
    buffer_load_dword v74, v12, s[20:23], s17 offen
    buffer_load_dword v75, v13, s[20:23], s17 offen
    s_waitcnt vmcnt(56)
    v_perm_b32 v161, v19, v18, v11
    s_add_u32 s17, s49, 398592
    buffer_load_dword v76, v12, s[20:23], s17 offen
    buffer_load_dword v77, v13, s[20:23], s17 offen
    s_waitcnt vmcnt(56)
    v_perm_b32 v162, v21, v20, v11
    s_add_u32 s17, s49, 400896
    buffer_load_dword v78, v12, s[20:23], s17 offen
    buffer_load_dword v79, v13, s[20:23], s17 offen
    s_waitcnt vmcnt(56)
    v_perm_b32 v163, v23, v22, v11
    s_add_u32 s17, s49, 414720
    buffer_load_dword v80, v12, s[20:23], s17 offen
    buffer_load_dword v81, v13, s[20:23], s17 offen
    s_waitcnt vmcnt(56)
    v_perm_b32 v164, v25, v24, v11
    s_add_u32 s17, s49, 417024
    buffer_load_dword v82, v12, s[20:23], s17 offen
    buffer_load_dword v83, v13, s[20:23], s17 offen
    s_waitcnt vmcnt(56)
    v_perm_b32 v165, v27, v26, v11
    s_add_u32 s17, s49, 419328
    buffer_load_dword v84, v12, s[20:23], s17 offen
    buffer_load_dword v85, v13, s[20:23], s17 offen
    s_waitcnt vmcnt(56)
    v_perm_b32 v166, v29, v28, v11
    s_add_u32 s17, s49, 421632
    buffer_load_dword v86, v12, s[20:23], s17 offen
    buffer_load_dword v87, v13, s[20:23], s17 offen
    s_waitcnt vmcnt(56)
    v_perm_b32 v167, v31, v30, v11
    s_add_u32 s17, s49, 435456
    buffer_load_dword v88, v12, s[20:23], s17 offen
    buffer_load_dword v89, v13, s[20:23], s17 offen
    s_waitcnt vmcnt(56)
    v_perm_b32 v168, v33, v32, v11
    s_add_u32 s17, s49, 437760
    buffer_load_dword v90, v12, s[20:23], s17 offen
    buffer_load_dword v91, v13, s[20:23], s17 offen
    s_waitcnt vmcnt(56)
    v_perm_b32 v169, v35, v34, v11
    s_add_u32 s17, s49, 440064
    buffer_load_dword v92, v12, s[20:23], s17 offen
    buffer_load_dword v93, v13, s[20:23], s17 offen
    s_waitcnt vmcnt(56)
    v_perm_b32 v170, v37, v36, v11
    s_add_u32 s17, s49, 442368
    buffer_load_dword v94, v12, s[20:23], s17 offen
    buffer_load_dword v95, v13, s[20:23], s17 offen
    s_waitcnt vmcnt(56)
    v_perm_b32 v171, v39, v38, v11
    s_add_u32 s17, s49, 456192
    buffer_load_dword v96, v12, s[20:23], s17 offen
    buffer_load_dword v97, v13, s[20:23], s17 offen
    s_waitcnt vmcnt(56)
    v_perm_b32 v172, v41, v40, v11
    s_add_u32 s17, s49, 458496
    buffer_load_dword v98, v12, s[20:23], s17 offen
    buffer_load_dword v99, v13, s[20:23], s17 offen
    s_waitcnt vmcnt(56)
    v_perm_b32 v173, v43, v42, v11
    s_add_u32 s17, s49, 460800
    buffer_load_dword v100, v12, s[20:23], s17 offen
    buffer_load_dword v101, v13, s[20:23], s17 offen
    s_waitcnt vmcnt(56)
    v_perm_b32 v174, v45, v44, v11
    s_add_u32 s17, s49, 463104
    buffer_load_dword v102, v12, s[20:23], s17 offen
    buffer_load_dword v103, v13, s[20:23], s17 offen
    s_waitcnt vmcnt(56)
    v_perm_b32 v175, v47, v46, v11
    s_add_u32 s17, s49, 476928
    buffer_load_dword v104, v12, s[20:23], s17 offen
    buffer_load_dword v105, v13, s[20:23], s17 offen
    s_waitcnt vmcnt(56)
    v_perm_b32 v176, v49, v48, v11
    s_add_u32 s17, s49, 479232
    buffer_load_dword v106, v12, s[20:23], s17 offen
    buffer_load_dword v107, v13, s[20:23], s17 offen
    s_waitcnt vmcnt(56)
    v_perm_b32 v177, v51, v50, v11
    s_add_u32 s17, s49, 481536
    buffer_load_dword v108, v12, s[20:23], s17 offen
    buffer_load_dword v109, v13, s[20:23], s17 offen
    s_waitcnt vmcnt(56)
    v_perm_b32 v178, v53, v52, v11
    s_add_u32 s17, s49, 483840
    buffer_load_dword v110, v12, s[20:23], s17 offen
    buffer_load_dword v111, v13, s[20:23], s17 offen
    s_waitcnt vmcnt(56)
    v_perm_b32 v179, v55, v54, v11
    s_add_u32 s17, s49, 497664
    buffer_load_dword v16, v12, s[20:23], s17 offen
    buffer_load_dword v17, v13, s[20:23], s17 offen
    s_waitcnt vmcnt(56)
    v_perm_b32 v180, v57, v56, v11
    s_add_u32 s17, s49, 499968
    buffer_load_dword v18, v12, s[20:23], s17 offen
    buffer_load_dword v19, v13, s[20:23], s17 offen
    s_waitcnt vmcnt(56)
    v_perm_b32 v181, v59, v58, v11
    s_add_u32 s17, s49, 502272
    buffer_load_dword v20, v12, s[20:23], s17 offen
    buffer_load_dword v21, v13, s[20:23], s17 offen
    s_waitcnt vmcnt(56)
    v_perm_b32 v182, v61, v60, v11
    s_add_u32 s17, s49, 504576
    buffer_load_dword v22, v12, s[20:23], s17 offen
    buffer_load_dword v23, v13, s[20:23], s17 offen
    s_waitcnt vmcnt(56)
    v_perm_b32 v183, v63, v62, v11
    s_add_u32 s17, s49, 518400
    buffer_load_dword v24, v12, s[20:23], s17 offen
    buffer_load_dword v25, v13, s[20:23], s17 offen
    s_waitcnt vmcnt(56)
    v_perm_b32 v184, v65, v64, v11
    s_add_u32 s17, s49, 520704
    buffer_load_dword v26, v12, s[20:23], s17 offen
    buffer_load_dword v27, v13, s[20:23], s17 offen
    s_waitcnt vmcnt(56)
    v_perm_b32 v185, v67, v66, v11
    s_add_u32 s17, s49, 523008
    buffer_load_dword v28, v12, s[20:23], s17 offen
    buffer_load_dword v29, v13, s[20:23], s17 offen
    s_waitcnt vmcnt(56)
    v_perm_b32 v186, v69, v68, v11
    s_add_u32 s17, s49, 525312
    buffer_load_dword v30, v12, s[20:23], s17 offen
    buffer_load_dword v31, v13, s[20:23], s17 offen
    s_waitcnt vmcnt(56)
    v_perm_b32 v187, v71, v70, v11
    s_add_u32 s17, s49, 539136
    buffer_load_dword v32, v12, s[20:23], s17 offen
    buffer_load_dword v33, v13, s[20:23], s17 offen
    s_waitcnt vmcnt(56)
    v_perm_b32 v188, v73, v72, v11
    s_add_u32 s17, s49, 541440
    buffer_load_dword v34, v12, s[20:23], s17 offen
    buffer_load_dword v35, v13, s[20:23], s17 offen
    s_waitcnt vmcnt(56)
    v_perm_b32 v189, v75, v74, v11
    s_add_u32 s17, s49, 543744
    buffer_load_dword v36, v12, s[20:23], s17 offen
    buffer_load_dword v37, v13, s[20:23], s17 offen
    s_waitcnt vmcnt(56)
    v_perm_b32 v190, v77, v76, v11
    s_add_u32 s17, s49, 546048
    buffer_load_dword v38, v12, s[20:23], s17 offen
    buffer_load_dword v39, v13, s[20:23], s17 offen
    s_waitcnt vmcnt(56)
    v_perm_b32 v191, v79, v78, v11
    s_add_u32 s17, s49, 559872
    buffer_load_dword v40, v12, s[20:23], s17 offen
    buffer_load_dword v41, v13, s[20:23], s17 offen
    s_waitcnt vmcnt(56)
    v_perm_b32 v192, v81, v80, v11
    s_add_u32 s17, s49, 562176
    buffer_load_dword v42, v12, s[20:23], s17 offen
    buffer_load_dword v43, v13, s[20:23], s17 offen
    s_waitcnt vmcnt(56)
    v_perm_b32 v193, v83, v82, v11
    s_add_u32 s17, s49, 564480
    buffer_load_dword v44, v12, s[20:23], s17 offen
    buffer_load_dword v45, v13, s[20:23], s17 offen
    s_waitcnt vmcnt(56)
    v_perm_b32 v194, v85, v84, v11
    s_add_u32 s17, s49, 566784
    buffer_load_dword v46, v12, s[20:23], s17 offen
    buffer_load_dword v47, v13, s[20:23], s17 offen
    s_waitcnt vmcnt(56)
    v_perm_b32 v195, v87, v86, v11
    s_add_u32 s17, s49, 580608
    buffer_load_dword v48, v12, s[20:23], s17 offen
    buffer_load_dword v49, v13, s[20:23], s17 offen
    s_waitcnt vmcnt(56)
    v_perm_b32 v196, v89, v88, v11
    s_add_u32 s17, s49, 582912
    buffer_load_dword v50, v12, s[20:23], s17 offen
    buffer_load_dword v51, v13, s[20:23], s17 offen
    s_waitcnt vmcnt(56)
    v_perm_b32 v197, v91, v90, v11
    s_add_u32 s17, s49, 585216
    buffer_load_dword v52, v12, s[20:23], s17 offen
    buffer_load_dword v53, v13, s[20:23], s17 offen
    s_waitcnt vmcnt(56)
    v_perm_b32 v198, v93, v92, v11
    s_add_u32 s17, s49, 587520
    buffer_load_dword v54, v12, s[20:23], s17 offen
    buffer_load_dword v55, v13, s[20:23], s17 offen
    s_waitcnt vmcnt(56)
    v_perm_b32 v199, v95, v94, v11
    s_add_u32 s17, s49, 601344
    buffer_load_dword v56, v12, s[20:23], s17 offen
    buffer_load_dword v57, v13, s[20:23], s17 offen
    s_waitcnt vmcnt(56)
    v_perm_b32 v200, v97, v96, v11
    s_add_u32 s17, s49, 603648
    buffer_load_dword v58, v12, s[20:23], s17 offen
    buffer_load_dword v59, v13, s[20:23], s17 offen
    s_waitcnt vmcnt(56)
    v_perm_b32 v201, v99, v98, v11
    s_add_u32 s17, s49, 605952
    buffer_load_dword v60, v12, s[20:23], s17 offen
    buffer_load_dword v61, v13, s[20:23], s17 offen
    s_waitcnt vmcnt(56)
    v_perm_b32 v202, v101, v100, v11
    s_add_u32 s17, s49, 608256
    buffer_load_dword v62, v12, s[20:23], s17 offen
    buffer_load_dword v63, v13, s[20:23], s17 offen
    s_waitcnt vmcnt(56)
    v_perm_b32 v203, v103, v102, v11
    s_add_u32 s17, s49, 622080
    buffer_load_dword v64, v12, s[20:23], s17 offen
    buffer_load_dword v65, v13, s[20:23], s17 offen
    s_waitcnt vmcnt(56)
    v_perm_b32 v204, v105, v104, v11
    s_add_u32 s17, s49, 624384
    buffer_load_dword v66, v12, s[20:23], s17 offen
    buffer_load_dword v67, v13, s[20:23], s17 offen
    s_waitcnt vmcnt(56)
    v_perm_b32 v205, v107, v106, v11
    s_add_u32 s17, s49, 626688
    buffer_load_dword v68, v12, s[20:23], s17 offen
    buffer_load_dword v69, v13, s[20:23], s17 offen
    s_waitcnt vmcnt(56)
    v_perm_b32 v206, v109, v108, v11
    s_add_u32 s17, s49, 628992
    buffer_load_dword v70, v12, s[20:23], s17 offen
    buffer_load_dword v71, v13, s[20:23], s17 offen
    s_waitcnt vmcnt(56)
    v_perm_b32 v207, v111, v110, v11
    s_add_u32 s17, s49, 642816
    buffer_load_dword v72, v12, s[20:23], s17 offen
    buffer_load_dword v73, v13, s[20:23], s17 offen
    s_waitcnt vmcnt(56)
    v_perm_b32 v208, v17, v16, v11
    s_add_u32 s17, s49, 645120
    buffer_load_dword v74, v12, s[20:23], s17 offen
    buffer_load_dword v75, v13, s[20:23], s17 offen
    s_waitcnt vmcnt(56)
    v_perm_b32 v209, v19, v18, v11
    s_add_u32 s17, s49, 647424
    buffer_load_dword v76, v12, s[20:23], s17 offen
    buffer_load_dword v77, v13, s[20:23], s17 offen
    s_waitcnt vmcnt(56)
    v_perm_b32 v210, v21, v20, v11
    s_add_u32 s17, s49, 649728
    buffer_load_dword v78, v12, s[20:23], s17 offen
    buffer_load_dword v79, v13, s[20:23], s17 offen
    s_waitcnt vmcnt(56)
    v_perm_b32 v211, v23, v22, v11
    s_waitcnt vmcnt(54)
    v_perm_b32 v212, v25, v24, v11
    s_waitcnt vmcnt(52)
    v_perm_b32 v213, v27, v26, v11
    s_waitcnt vmcnt(50)
    v_perm_b32 v214, v29, v28, v11
    s_waitcnt vmcnt(48)
    v_perm_b32 v215, v31, v30, v11
    s_waitcnt vmcnt(46)
    v_perm_b32 v216, v33, v32, v11
    s_waitcnt vmcnt(44)
    v_perm_b32 v217, v35, v34, v11
    s_waitcnt vmcnt(42)
    v_perm_b32 v218, v37, v36, v11
    s_waitcnt vmcnt(40)
    v_perm_b32 v219, v39, v38, v11
    s_waitcnt vmcnt(38)
    v_perm_b32 v220, v41, v40, v11
    s_waitcnt vmcnt(36)
    v_perm_b32 v221, v43, v42, v11
    s_waitcnt vmcnt(34)
    v_perm_b32 v222, v45, v44, v11
    s_waitcnt vmcnt(32)
    v_perm_b32 v223, v47, v46, v11
    s_waitcnt vmcnt(30)
    v_perm_b32 v224, v49, v48, v11
    s_waitcnt vmcnt(28)
    v_perm_b32 v225, v51, v50, v11
    s_waitcnt vmcnt(26)
    v_perm_b32 v226, v53, v52, v11
    s_waitcnt vmcnt(24)
    v_perm_b32 v227, v55, v54, v11
    s_waitcnt vmcnt(22)
    v_perm_b32 v228, v57, v56, v11
    s_waitcnt vmcnt(20)
    v_perm_b32 v229, v59, v58, v11
    s_waitcnt vmcnt(18)
    v_perm_b32 v230, v61, v60, v11
    s_waitcnt vmcnt(16)
    v_perm_b32 v231, v63, v62, v11
    s_waitcnt vmcnt(14)
    v_perm_b32 v232, v65, v64, v11
    s_waitcnt vmcnt(12)
    v_perm_b32 v233, v67, v66, v11
    s_waitcnt vmcnt(10)
    v_perm_b32 v234, v69, v68, v11
    s_waitcnt vmcnt(8)
    v_perm_b32 v235, v71, v70, v11
    s_waitcnt vmcnt(6)
    v_perm_b32 v236, v73, v72, v11
    s_waitcnt vmcnt(4)
    v_perm_b32 v237, v75, v74, v11
    s_waitcnt vmcnt(2)
    v_perm_b32 v238, v77, v76, v11
    s_waitcnt vmcnt(0)
    v_perm_b32 v239, v79, v78, v11
    v_mul_u32_u24 v5, 82944, v9
    v_add_u32 v12, v5, v14
    v_add_u32 v13, 1152, v12
    s_add_u32 s17, s49, 18432
    buffer_load_dword v16, v12, s[20:23], s17 offen
    buffer_load_dword v17, v13, s[20:23], s17 offen
    s_add_u32 s17, s49, 39168
    buffer_load_dword v18, v12, s[20:23], s17 offen
    buffer_load_dword v19, v13, s[20:23], s17 offen
    s_add_u32 s17, s49, 59904
    buffer_load_dword v20, v12, s[20:23], s17 offen
    buffer_load_dword v21, v13, s[20:23], s17 offen
    s_add_u32 s17, s49, 80640
    buffer_load_dword v22, v12, s[20:23], s17 offen
    buffer_load_dword v23, v13, s[20:23], s17 offen
    s_add_u32 s17, s49, 184320
    buffer_load_dword v24, v12, s[20:23], s17 offen
    buffer_load_dword v25, v13, s[20:23], s17 offen
    s_add_u32 s17, s49, 205056
    buffer_load_dword v26, v12, s[20:23], s17 offen
    buffer_load_dword v27, v13, s[20:23], s17 offen
    s_add_u32 s17, s49, 225792
    buffer_load_dword v28, v12, s[20:23], s17 offen
    buffer_load_dword v29, v13, s[20:23], s17 offen
    s_add_u32 s17, s49, 246528
    buffer_load_dword v30, v12, s[20:23], s17 offen
    buffer_load_dword v31, v13, s[20:23], s17 offen
    s_add_u32 s17, s49, 350208
    buffer_load_dword v32, v12, s[20:23], s17 offen
    buffer_load_dword v33, v13, s[20:23], s17 offen
    s_add_u32 s17, s49, 370944
    buffer_load_dword v34, v12, s[20:23], s17 offen
    buffer_load_dword v35, v13, s[20:23], s17 offen
    s_add_u32 s17, s49, 391680
    buffer_load_dword v36, v12, s[20:23], s17 offen
    buffer_load_dword v37, v13, s[20:23], s17 offen
    s_add_u32 s17, s49, 412416
    buffer_load_dword v38, v12, s[20:23], s17 offen
    buffer_load_dword v39, v13, s[20:23], s17 offen
    s_add_u32 s17, s49, 516096
    buffer_load_dword v40, v12, s[20:23], s17 offen
    buffer_load_dword v41, v13, s[20:23], s17 offen
    s_add_u32 s17, s49, 536832
    buffer_load_dword v42, v12, s[20:23], s17 offen
    buffer_load_dword v43, v13, s[20:23], s17 offen
    s_add_u32 s17, s49, 557568
    buffer_load_dword v44, v12, s[20:23], s17 offen
    buffer_load_dword v45, v13, s[20:23], s17 offen
    s_add_u32 s17, s49, 578304
    buffer_load_dword v46, v12, s[20:23], s17 offen
    buffer_load_dword v47, v13, s[20:23], s17 offen
    s_waitcnt vmcnt(30)
    v_perm_b32 v240, v17, v16, v11
    s_waitcnt vmcnt(28)
    v_perm_b32 v241, v19, v18, v11
    s_waitcnt vmcnt(26)
    v_perm_b32 v242, v21, v20, v11
    s_waitcnt vmcnt(24)
    v_perm_b32 v243, v23, v22, v11
    s_waitcnt vmcnt(22)
    v_perm_b32 v244, v25, v24, v11
    s_waitcnt vmcnt(20)
    v_perm_b32 v245, v27, v26, v11
    s_waitcnt vmcnt(18)
    v_perm_b32 v246, v29, v28, v11
    s_waitcnt vmcnt(16)
    v_perm_b32 v247, v31, v30, v11
    s_waitcnt vmcnt(14)
    v_perm_b32 v248, v33, v32, v11
    s_waitcnt vmcnt(12)
    v_perm_b32 v249, v35, v34, v11
    s_waitcnt vmcnt(10)
    v_perm_b32 v250, v37, v36, v11
    s_waitcnt vmcnt(8)
    v_perm_b32 v251, v39, v38, v11
    s_waitcnt vmcnt(6)
    v_perm_b32 v252, v41, v40, v11
    s_waitcnt vmcnt(4)
    v_perm_b32 v253, v43, v42, v11
    s_waitcnt vmcnt(2)
    v_perm_b32 v254, v45, v44, v11
    s_waitcnt vmcnt(0)
    v_perm_b32 v255, v47, v46, v11
    v_lshlrev_b32 v10, 4, v10
    v_lshl_add_u32 v14, v9, 9, v10
    s_lshl_b32 s17, s50, 11
    v_add_u32 v14, s17, v14
    s_lshr_b32 s17, s50, 1
    s_lshl_b32 s17, s17, 9
    s_and_b32 s18, s50, 1
    s_lshl_b32 s18, s18, 3
    s_add_u32 s17, s17, s18
    v_add_u32 v10, s17, v10
    s_lshr_b32 s49, s50, 2
    s_lshl_b32 s49, s49, 7
    s_and_b32 s17, s50, 3
    s_lshl_b32 s17, s17, 2
    s_add_u32 s49, s49, s17
    s_add_u32 s49, s49, 3584
    s_mov_b32 s32, 0
    s_mov_b32 s33, 0
    s_mov_b32 s38, 128
    s_mul_i32 s58, s14, 9216
    s_mov_b32 s40, 36864
    s_mov_b32 s59, s58
    s_mov_b32 s43, 0
    s_mov_b32 s28, s8
    s_mov_b32 s29, s9
    s_mov_b32 s30, 0
    s_mov_b32 s31, 0x00020000
    v_mov_b32 v12, 74752
    s_add_u32 s64, s58, 17301504
    s_add_u32 s65, s58, 19660800
    s_cmp_eq_u32 s63, 0
    s_cselect_b32 s32, 0, 64
    s_cselect_b32 s33, 64, 0
    s_mov_b32 s38, 64
    ds_write2_b32 v12, v4, v4 offset0:0 offset1:1
    s_waitcnt lgkmcnt(0)
    s_cmp_lg_u32 s14, 0
    s_cbranch_scc1 Lawo_ini_d
    v_mov_b32 v5, 160
    s_mov_b32 s16, 0
Lawo_ini:
    global_load_dword v6, v5, s[12:13] sc1
    s_add_u32 s16, s16, 1
    s_cmp_gt_u32 s16, 100000
    s_cbranch_scc1 L_role_awo_abort
    s_waitcnt vmcnt(0)
    v_cmp_gt_u32 vcc, 192, v6
    s_nop 0
    s_cbranch_vccz Lawo_ini_d
    s_sleep 8
    s_branch Lawo_ini
Lawo_ini_d:
    s_barrier
    s_branch Lawo_idle0
Lawo_item:
    s_waitcnt vmcnt(3)
Lawo_defer:
    s_cmp_lg_u32 s14, 0
    s_cbranch_scc1 Lawo_nw0
    v_cmp_eq_u32 vcc, 0, v2
    v_cmp_eq_u32 s[54:55], 0, v15
    s_cmp_eq_u64 vcc, 0
    s_cselect_b32 s62, 1, 0
    s_cmp_eq_u64 s[54:55], 0
    s_cselect_b32 s62, 2, s62
    v_mov_b32 v5, s62
    ds_write_b32 v12, v5
    s_waitcnt lgkmcnt(0)
Lawo_nw0:
    s_barrier
    ds_read_b32 v6, v12
    v_xor_b32 v12, 4, v12
    s_xor_b32 s40, s40, 36864
    s_xor_b32 s59, s59, 36864
    s_xor_b32 s66, s66, 0x2000
    s_xor_b32 s71, s71, 0x2000
    s_sub_u32 s38, s38, 1
    v_add_u32 v9, s40, v0
    v_lshlrev_b32 v16, 16, v64
    v_and_b32 v17, 0xffff0000, v64
    v_lshlrev_b32 v18, 16, v65
    v_and_b32 v19, 0xffff0000, v65
    v_lshlrev_b32 v20, 16, v66
    v_and_b32 v21, 0xffff0000, v66
    v_lshlrev_b32 v22, 16, v67
    v_and_b32 v23, 0xffff0000, v67
    v_lshlrev_b32 v24, 16, v68
    v_and_b32 v25, 0xffff0000, v68
    v_lshlrev_b32 v26, 16, v69
    v_and_b32 v27, 0xffff0000, v69
    v_lshlrev_b32 v28, 16, v70
    v_and_b32 v29, 0xffff0000, v70
    v_lshlrev_b32 v30, 16, v71
    v_and_b32 v31, 0xffff0000, v71
    ds_read_b128 v[32:35], v9 offset:0
    ds_read_b128 v[36:39], v9 offset:1024
    ds_read_b128 v[40:43], v9 offset:2048
    ds_read_b128 v[44:47], v9 offset:3072
    ds_read_b128 v[48:51], v9 offset:4096
    ds_read_b128 v[52:55], v9 offset:5120
    ds_read_b128 v[56:59], v9 offset:6144
    s_waitcnt lgkmcnt(6)
    v_mfma_f32_32x32x16_bf16 v[16:31], v[112:115], v[32:35], v[16:31]
    ds_read_b128 v[60:63], v9 offset:7168
    s_mul_i32 s46, s34, 4718592
    s_mul_i32 s51, s35, 36864
    s_add_u32 s46, s46, s51
    s_waitcnt lgkmcnt(6)
    v_mfma_f32_32x32x16_bf16 v[16:31], v[116:119], v[36:39], v[16:31]
    ds_read_b128 v[32:35], v9 offset:8192
    v_readfirstlane_b32 s62, v6
    s_nop 0
    s_cmp_eq_u32 s62, 2
    s_cselect_b32 s41, s65, s64
    s_cmp_lg_u32 s62, 0
    s_cselect_b32 s30, 268435456, 0
    s_waitcnt lgkmcnt(6)
    v_mfma_f32_32x32x16_bf16 v[16:31], v[120:123], v[40:43], v[16:31]
    ds_read_b128 v[36:39], v9 offset:9216
    s_add_u32 m0, s59, 0
    s_add_u32 s47, s41, 0
    buffer_load_dwordx4 v0, s[28:31], s47 offen offset:0 lds
    s_add_u32 s46, s46, 8650752
    s_waitcnt lgkmcnt(6)
    v_mfma_f32_32x32x16_bf16 v[16:31], v[124:127], v[44:47], v[16:31]
    ds_read_b128 v[40:43], v9 offset:10240
    s_cmp_eq_u32 s62, 2
    s_cselect_b32 s36, 1, 0
    s_cselect_b32 s37, s33, s32
    s_cselect_b32 s17, 1, 0
    s_add_u32 s33, s33, s17
    s_waitcnt lgkmcnt(6)
    v_mfma_f32_32x32x16_bf16 v[16:31], v[128:131], v[48:51], v[16:31]
    ds_read_b128 v[44:47], v9 offset:11264
    buffer_load_dwordx4 v0, s[28:31], s47 offen offset:1024 lds
    s_mul_i32 s52, s34, 786432
    s_waitcnt lgkmcnt(6)
    v_mfma_f32_32x32x16_bf16 v[16:31], v[132:135], v[52:55], v[16:31]
    ds_read_b128 v[48:51], v9 offset:12288
    s_cmp_eq_u32 s62, 1
    s_cselect_b32 s17, 1, 0
    s_add_u32 s32, s32, s17
    s_lshl_b32 s56, s36, 6
    s_add_u32 s56, s56, s37
    s_waitcnt lgkmcnt(6)
    v_mfma_f32_32x32x16_bf16 v[16:31], v[136:139], v[56:59], v[16:31]
    ds_read_b128 v[52:55], v9 offset:13312
    buffer_load_dwordx4 v0, s[28:31], s47 offen offset:2048 lds
    s_mul_i32 s51, s35, 6144
    s_waitcnt lgkmcnt(6)
    v_mfma_f32_32x32x16_bf16 v[16:31], v[140:143], v[60:63], v[16:31]
    ds_read_b128 v[56:59], v9 offset:14336
    s_mul_i32 s48, s36, 4718592
    s_mul_i32 s18, s37, 36864
    s_add_u32 s48, s48, s18
    s_add_u32 s48, s48, 6291456
    s_add_u32 s52, s52, s51
    s_waitcnt lgkmcnt(6)
    v_mfma_f32_32x32x16_bf16 v[16:31], v[144:147], v[32:35], v[16:31]
    ds_read_b128 v[60:63], v9 offset:15360
    buffer_load_dwordx4 v0, s[28:31], s47 offen offset:3072 lds
    s_add_u32 s52, s52, 16121856
    s_waitcnt lgkmcnt(6)
    v_mfma_f32_32x32x16_bf16 v[16:31], v[148:151], v[36:39], v[16:31]
    ds_read_b128 v[32:35], v9 offset:16384
    s_cmp_eq_u32 s62, 2
    s_cselect_b32 s17, 36864, 0
    s_add_u32 s65, s65, s17
    s_waitcnt lgkmcnt(6)
    v_mfma_f32_32x32x16_bf16 v[16:31], v[152:155], v[40:43], v[16:31]
    ds_read_b128 v[36:39], v9 offset:17408
    s_add_u32 m0, s59, 4096
    s_add_u32 s47, s41, 4096
    buffer_load_dwordx4 v0, s[28:31], s47 offen offset:0 lds
    s_waitcnt vmcnt(5)
    s_cmp_lg_u32 s43, 0
    s_cselect_b64 exec, 1, 0
    buffer_store_dword v3, v4, s[8:11], s43 offen sc1
    s_mov_b64 exec, -1
    s_mov_b32 s43, 0
    s_waitcnt lgkmcnt(6)
    v_mfma_f32_32x32x16_bf16 v[16:31], v[156:159], v[44:47], v[16:31]
    ds_read_b128 v[40:43], v9 offset:18432
    s_cmp_eq_u32 s62, 1
    s_cselect_b32 s17, 36864, 0
    s_add_u32 s64, s64, s17
    s_waitcnt lgkmcnt(6)
    v_mfma_f32_32x32x16_bf16 v[16:31], v[160:163], v[48:51], v[16:31]
    ds_read_b128 v[44:47], v9 offset:19456
    buffer_load_dwordx4 v0, s[28:31], s47 offen offset:1024 lds
    s_waitcnt lgkmcnt(6)
    v_mfma_f32_32x32x16_bf16 v[16:31], v[164:167], v[52:55], v[16:31]
    ds_read_b128 v[48:51], v9 offset:20480
    buffer_load_dwordx4 v0, s[28:31], s47 offen offset:2048 lds
    s_waitcnt lgkmcnt(6)
    v_mfma_f32_32x32x16_bf16 v[16:31], v[168:171], v[56:59], v[16:31]
    ds_read_b128 v[52:55], v9 offset:21504
    buffer_load_dwordx4 v0, s[28:31], s47 offen offset:3072 lds
    s_waitcnt lgkmcnt(6)
    v_mfma_f32_32x32x16_bf16 v[16:31], v[172:175], v[60:63], v[16:31]
    ds_read_b128 v[56:59], v9 offset:22528
    s_add_u32 m0, s59, 8192
    s_add_u32 s47, s41, 8192
    buffer_load_dwordx4 v0, s[28:31], s47 offen offset:0 lds
    s_waitcnt lgkmcnt(6)
    v_mfma_f32_32x32x16_bf16 v[16:31], v[176:179], v[32:35], v[16:31]
    ds_read_b128 v[60:63], v9 offset:23552
    buffer_load_dwordx4 v[64:67], v14, s[28:31], s48 offen offset:0
    s_cmp_lg_u32 s14, 0
    s_cbranch_scc1 Lawo_ns_9
    s_mul_i32 s60, s32, 22528
    s_add_u32 s60, s60, 1536
    s_cmp_lt_u32 s32, 64
    s_cselect_b32 s60, s60, 2883584
    s_mul_i32 s61, s33, 22528
    s_add_u32 s61, s61, 1443328
    s_cmp_lt_u32 s33, 64
    s_cselect_b32 s61, s61, 2883584
    buffer_load_dword v2, v1, s[8:11], s60 offen sc1
    buffer_load_dword v15, v1, s[8:11], s61 offen sc1
Lawo_ns_9:
    s_waitcnt lgkmcnt(6)
    v_mfma_f32_32x32x16_bf16 v[16:31], v[180:183], v[36:39], v[16:31]
    ds_read_b128 v[32:35], v9 offset:24576
    buffer_load_dwordx4 v[68:71], v14, s[28:31], s48 offen offset:1024
    s_waitcnt lgkmcnt(6)
    v_mfma_f32_32x32x16_bf16 v[16:31], v[184:187], v[40:43], v[16:31]
    ds_read_b128 v[36:39], v9 offset:25600
    s_waitcnt lgkmcnt(6)
    v_mfma_f32_32x32x16_bf16 v[16:31], v[188:191], v[44:47], v[16:31]
    ds_read_b128 v[40:43], v9 offset:26624
    s_waitcnt lgkmcnt(6)
    v_mfma_f32_32x32x16_bf16 v[16:31], v[192:195], v[48:51], v[16:31]
    ds_read_b128 v[44:47], v9 offset:27648
    s_waitcnt lgkmcnt(6)
    v_mfma_f32_32x32x16_bf16 v[16:31], v[196:199], v[52:55], v[16:31]
    ds_read_b128 v[48:51], v9 offset:28672
    s_waitcnt lgkmcnt(6)
    v_mfma_f32_32x32x16_bf16 v[16:31], v[200:203], v[56:59], v[16:31]
    ds_read_b128 v[52:55], v9 offset:29696
    s_waitcnt lgkmcnt(6)
    v_mfma_f32_32x32x16_bf16 v[16:31], v[204:207], v[60:63], v[16:31]
    ds_read_b128 v[56:59], v9 offset:30720
    s_waitcnt lgkmcnt(6)
    v_mfma_f32_32x32x16_bf16 v[16:31], v[208:211], v[32:35], v[16:31]
    ds_read_b128 v[60:63], v9 offset:31744
    s_waitcnt lgkmcnt(6)
    v_mfma_f32_32x32x16_bf16 v[16:31], v[212:215], v[36:39], v[16:31]
    ds_read_b128 v[32:35], v9 offset:32768
    s_waitcnt lgkmcnt(6)
    v_mfma_f32_32x32x16_bf16 v[16:31], v[216:219], v[40:43], v[16:31]
    ds_read_b128 v[36:39], v9 offset:33792
    s_waitcnt lgkmcnt(6)
    v_mfma_f32_32x32x16_bf16 v[16:31], v[220:223], v[44:47], v[16:31]
    ds_read_b128 v[40:43], v9 offset:34816
    s_waitcnt lgkmcnt(6)
    v_mfma_f32_32x32x16_bf16 v[16:31], v[224:227], v[48:51], v[16:31]
    ds_read_b128 v[44:47], v9 offset:35840
    s_waitcnt lgkmcnt(6)
    v_mfma_f32_32x32x16_bf16 v[16:31], v[228:231], v[52:55], v[16:31]
    s_waitcnt lgkmcnt(5)
    v_mfma_f32_32x32x16_bf16 v[16:31], v[232:235], v[56:59], v[16:31]
    s_waitcnt lgkmcnt(4)
    v_mfma_f32_32x32x16_bf16 v[16:31], v[236:239], v[60:63], v[16:31]
    s_waitcnt lgkmcnt(3)
    v_mfma_f32_32x32x16_bf16 v[16:31], v[240:243], v[32:35], v[16:31]
    s_waitcnt lgkmcnt(2)
    v_mfma_f32_32x32x16_bf16 v[16:31], v[244:247], v[36:39], v[16:31]
    s_waitcnt lgkmcnt(1)
    v_mfma_f32_32x32x16_bf16 v[16:31], v[248:251], v[40:43], v[16:31]
    s_waitcnt lgkmcnt(0)
    v_mfma_f32_32x32x16_bf16 v[16:31], v[252:255], v[44:47], v[16:31]
    s_nop 11
    v_cvt_pk_bf16_f32 v32, v16, v17
    v_cvt_pk_bf16_f32 v33, v18, v19
    v_cvt_pk_bf16_f32 v34, v20, v21
    v_cvt_pk_bf16_f32 v35, v22, v23
    buffer_store_dwordx4 v[32:35], v14, s[8:11], s46 offen offset:0 sc1
    v_cvt_pk_bf16_f32 v36, v24, v25
    v_cvt_pk_bf16_f32 v37, v26, v27
    v_cvt_pk_bf16_f32 v38, v28, v29
    v_cvt_pk_bf16_f32 v39, v30, v31
    buffer_store_dwordx4 v[36:39], v14, s[8:11], s46 offen offset:1024 sc1
    v_add_f32 v72, v16, v17
    v_mul_f32 v73, v16, v16
    v_fmac_f32 v73, v17, v17
    v_add_f32 v72, v72, v18
    v_fmac_f32 v73, v18, v18
    v_add_f32 v72, v72, v19
    v_fmac_f32 v73, v19, v19
    v_add_f32 v72, v72, v20
    v_fmac_f32 v73, v20, v20
    v_add_f32 v72, v72, v21
    v_fmac_f32 v73, v21, v21
    v_add_f32 v72, v72, v22
    v_fmac_f32 v73, v22, v22
    v_add_f32 v72, v72, v23
    v_fmac_f32 v73, v23, v23
    v_add_f32 v72, v72, v24
    v_fmac_f32 v73, v24, v24
    v_add_f32 v72, v72, v25
    v_fmac_f32 v73, v25, v25
    v_add_f32 v72, v72, v26
    v_fmac_f32 v73, v26, v26
    v_add_f32 v72, v72, v27
    v_fmac_f32 v73, v27, v27
    v_add_f32 v72, v72, v28
    v_fmac_f32 v73, v28, v28
    v_add_f32 v72, v72, v29
    v_fmac_f32 v73, v29, v29
    v_add_f32 v72, v72, v30
    v_fmac_f32 v73, v30, v30
    v_add_f32 v72, v72, v31
    v_fmac_f32 v73, v31, v31
    v_mov_b32 v74, v72
    v_mov_b32 v75, v73
    s_nop 0
    v_permlane32_swap_b32 v72, v74
    v_permlane32_swap_b32 v73, v75
    v_add_f32 v72, v72, v74
    v_add_f32 v73, v73, v75
    buffer_store_dwordx2 v[72:73], v10, s[8:11], s52 offen sc1
    s_mul_i32 s43, s57, 22528
    s_add_u32 s43, s43, s49
    s_mov_b32 s34, s36
    s_mov_b32 s35, s37
    s_mov_b32 s57, s56
    s_min_u32 s62, s62, s38
    s_cmp_lg_u32 s62, 0
    s_cbranch_scc1 Lawo_item
    s_cmp_lg_u32 s14, 0
    s_cbranch_scc1 Lawo_ns_10
    s_mul_i32 s60, s32, 22528
    s_add_u32 s60, s60, 1536
    s_cmp_lt_u32 s32, 64
    s_cselect_b32 s60, s60, 2883584
    s_mul_i32 s61, s33, 22528
    s_add_u32 s61, s61, 1443328
    s_cmp_lt_u32 s33, 64
    s_cselect_b32 s61, s61, 2883584
    buffer_load_dword v2, v1, s[8:11], s60 offen sc1
    buffer_load_dword v15, v1, s[8:11], s61 offen sc1
Lawo_ns_10:
    s_waitcnt vmcnt(0)
    s_cmp_lg_u32 s43, 0
    s_cselect_b64 exec, 1, 0
    buffer_store_dword v3, v4, s[8:11], s43 offen sc1
    s_mov_b64 exec, -1
    s_mov_b32 s43, 0
    s_cmp_eq_u32 s38, 0
    s_cbranch_scc1 Lawo_end
    s_cmp_lg_u32 s14, 0
    s_cbranch_scc1 Lawo_nw1
    v_cmp_eq_u32 vcc, 0, v2
    v_cmp_eq_u32 s[54:55], 0, v15
    s_cmp_eq_u64 vcc, 0
    s_cselect_b32 s62, 1, 0
    s_cmp_eq_u64 s[54:55], 0
    s_cselect_b32 s62, 2, s62
    s_cmp_lg_u32 s62, 0
    s_cbranch_scc1 Lawo_got
Lawo_idle0:
    s_cmp_lg_u32 s14, 0
    s_cbranch_scc1 Lawo_nw1
    s_mul_i32 s60, s32, 22528
    s_add_u32 s60, s60, 1536
    s_cmp_lt_u32 s32, 64
    s_cselect_b32 s60, s60, 2883584
    s_mul_i32 s61, s33, 22528
    s_add_u32 s61, s61, 1443328
    s_cmp_lt_u32 s33, 64
    s_cselect_b32 s61, s61, 2883584
    s_mov_b32 s16, 0
Lawo_pl_11:
    buffer_load_dword v2, v1, s[8:11], s60 offen sc1
    buffer_load_dword v15, v1, s[8:11], s61 offen sc1
    s_add_u32 s16, s16, 1
    s_cmp_gt_u32 s16, 100000
    s_cbranch_scc1 L_role_awo_abort
    s_waitcnt vmcnt(1)
    v_cmp_eq_u32 vcc, 0, v2
    s_waitcnt vmcnt(0)
    v_cmp_eq_u32 s[54:55], 0, v15
    s_cmp_eq_u64 vcc, 0
    s_cselect_b32 s62, 1, 0
    s_cmp_eq_u64 s[54:55], 0
    s_cselect_b32 s62, 2, s62
    s_cmp_lg_u32 s62, 0
    s_cbranch_scc1 Lawo_pl_11d
    s_sleep 4
    s_branch Lawo_pl_11
Lawo_pl_11d:
Lawo_got:
    v_mov_b32 v5, s62
    ds_write_b32 v12, v5
    s_waitcnt lgkmcnt(0)
Lawo_nw1:
    s_barrier
    ds_read_b32 v6, v12
    v_xor_b32 v12, 4, v12
    s_waitcnt lgkmcnt(0)
    v_readfirstlane_b32 s62, v6
    s_nop 0
    s_cmp_eq_u32 s62, 0
    s_cbranch_scc1 L_role_awo_abort
    s_cmp_eq_u32 s62, 2
    s_cselect_b32 s41, s65, s64
    s_cmp_lg_u32 s62, 0
    s_cselect_b32 s30, 268435456, 0
    s_cmp_eq_u32 s62, 2
    s_cselect_b32 s36, 1, 0
    s_cselect_b32 s37, s33, s32
    s_cselect_b32 s17, 1, 0
    s_add_u32 s33, s33, s17
    s_cmp_eq_u32 s62, 1
    s_cselect_b32 s17, 1, 0
    s_add_u32 s32, s32, s17
    s_lshl_b32 s56, s36, 6
    s_add_u32 s56, s56, s37
    s_cmp_eq_u32 s62, 2
    s_cselect_b32 s17, 36864, 0
    s_add_u32 s65, s65, s17
    s_cmp_eq_u32 s62, 1
    s_cselect_b32 s17, 36864, 0
    s_add_u32 s64, s64, s17
    s_add_u32 m0, s59, 0
    s_add_u32 s47, s41, 0
    buffer_load_dwordx4 v0, s[8:11], s47 offen offset:0 lds
    buffer_load_dwordx4 v0, s[8:11], s47 offen offset:1024 lds
    buffer_load_dwordx4 v0, s[8:11], s47 offen offset:2048 lds
    buffer_load_dwordx4 v0, s[8:11], s47 offen offset:3072 lds
    s_add_u32 m0, s59, 4096
    s_add_u32 s47, s41, 4096
    buffer_load_dwordx4 v0, s[8:11], s47 offen offset:0 lds
    buffer_load_dwordx4 v0, s[8:11], s47 offen offset:1024 lds
    buffer_load_dwordx4 v0, s[8:11], s47 offen offset:2048 lds
    buffer_load_dwordx4 v0, s[8:11], s47 offen offset:3072 lds
    s_add_u32 m0, s59, 8192
    s_add_u32 s47, s41, 8192
    buffer_load_dwordx4 v0, s[8:11], s47 offen offset:0 lds
    s_mul_i32 s48, s36, 4718592
    s_mul_i32 s18, s37, 36864
    s_add_u32 s48, s48, s18
    s_add_u32 s48, s48, 6291456
    buffer_load_dwordx4 v[64:67], v14, s[8:11], s48 offen offset:0
    buffer_load_dwordx4 v[68:71], v14, s[8:11], s48 offen offset:1024
    s_mov_b32 s34, s36
    s_mov_b32 s35, s37
    s_mov_b32 s57, s56
    s_cmp_lg_u32 s14, 0
    s_cbranch_scc1 Lawo_ns_12
    s_mul_i32 s60, s32, 22528
    s_add_u32 s60, s60, 1536
    s_cmp_lt_u32 s32, 64
    s_cselect_b32 s60, s60, 2883584
    s_mul_i32 s61, s33, 22528
    s_add_u32 s61, s61, 1443328
    s_cmp_lt_u32 s33, 64
    s_cselect_b32 s61, s61, 2883584
    buffer_load_dword v2, v1, s[8:11], s60 offen sc1
    buffer_load_dword v15, v1, s[8:11], s61 offen sc1
Lawo_ns_12:
    s_waitcnt vmcnt(0)
    s_branch Lawo_item
Lawo_end:
    s_branch L_role_awo_exit
L_role_awo_abort:
    s_waitcnt lgkmcnt(0)
    s_mov_b64 exec, -1
    v_mov_b32 v0, 60
    s_lshl_b32 s5, s3, 8
    s_or_b32 s5, s5, s4
    s_or_b32 s5, s5, 0x10000
    v_mov_b32 v1, s5
    global_store_dword v0, v1, s[12:13]
    s_endpgm
L_role_awo_exit:
    s_endpgm
.p2align 6
L_role_aq:
    v_and_b32 v5, 63, v0
    v_lshlrev_b32 v0, 4, v5
    v_and_b32 v7, 15, v5
    v_lshrrev_b32 v8, 4, v5
    v_min_u32 v1, 47, v5
    v_lshrrev_b32 v6, 2, v1
    v_and_b32 v1, 3, v1
    v_lshlrev_b32 v1, 2, v1
    v_lshl_add_u32 v1, v6, 7, v1
    v_mov_b32 v3, 1
    v_mov_b32 v4, 0
    s_mov_b32 s44, 0x05040100
    s_mov_b32 s45, 0x07060302
    s_lshr_b32 s63, s15, 4
    s_and_b32 s15, s15, 15
    s_lshl_b32 s50, s15, 1
    s_lshr_b32 s17, s14, 1
    s_add_u32 s50, s50, s17
    s_and_b32 s51, s14, 1
    s_mul_i32 s49, s50, 92160
    s_add_u32 s49, s49, 22020096
    s_cmp_lg_u32 s14, 0
    s_cbranch_scc1 Laq_inia_d
    v_mov_b32 v5, 40
    s_mov_b32 s16, 0
Laq_inia:
    global_load_dword v6, v5, s[12:13] sc1
    s_add_u32 s16, s16, 1
    s_cmp_gt_u32 s16, 100000
    s_cbranch_scc1 L_role_aq_abort
    s_waitcnt vmcnt(0)
    v_cmp_gt_u32 vcc, 192, v6
    s_nop 0
    s_cbranch_vccz Laq_inia_d
    s_sleep 4
    s_branch Laq_inia
Laq_inia_d:
    s_barrier
    s_add_u32 s17, s49, 0
    buffer_load_dwordx4 v[152:155], v0, s[8:11], s17 offen offset:0
    buffer_load_dwordx4 v[156:159], v0, s[8:11], s17 offen offset:1024
    buffer_load_dwordx4 v[160:163], v0, s[8:11], s17 offen offset:2048
    buffer_load_dwordx4 v[164:167], v0, s[8:11], s17 offen offset:3072
    s_add_u32 s17, s49, 4096
    buffer_load_dwordx4 v[168:171], v0, s[8:11], s17 offen offset:0
    buffer_load_dwordx4 v[172:175], v0, s[8:11], s17 offen offset:1024
    buffer_load_dwordx4 v[176:179], v0, s[8:11], s17 offen offset:2048
    buffer_load_dwordx4 v[180:183], v0, s[8:11], s17 offen offset:3072
    s_add_u32 s17, s49, 8192
    buffer_load_dwordx4 v[184:187], v0, s[8:11], s17 offen offset:0
    buffer_load_dwordx4 v[188:191], v0, s[8:11], s17 offen offset:1024
    buffer_load_dwordx4 v[192:195], v0, s[8:11], s17 offen offset:2048
    buffer_load_dwordx4 v[196:199], v0, s[8:11], s17 offen offset:3072
    s_add_u32 s17, s49, 12288
    buffer_load_dwordx4 v[200:203], v0, s[8:11], s17 offen offset:0
    buffer_load_dwordx4 v[204:207], v0, s[8:11], s17 offen offset:1024
    buffer_load_dwordx4 v[208:211], v0, s[8:11], s17 offen offset:2048
    buffer_load_dwordx4 v[212:215], v0, s[8:11], s17 offen offset:3072
    s_add_u32 s17, s49, 16384
    buffer_load_dwordx4 v[216:219], v0, s[8:11], s17 offen offset:0
    buffer_load_dwordx4 v[220:223], v0, s[8:11], s17 offen offset:1024
    buffer_load_dwordx4 v[224:227], v0, s[8:11], s17 offen offset:2048
    buffer_load_dwordx4 v[228:231], v0, s[8:11], s17 offen offset:3072
    s_add_u32 s17, s49, 20480
    buffer_load_dwordx4 v[232:235], v0, s[8:11], s17 offen offset:0
    buffer_load_dwordx4 v[236:239], v0, s[8:11], s17 offen offset:1024
    buffer_load_dwordx4 v[240:243], v0, s[8:11], s17 offen offset:2048
    buffer_load_dwordx4 v[244:247], v0, s[8:11], s17 offen offset:3072
    s_add_u32 s17, s49, 24576
    buffer_load_dwordx4 v[248:251], v0, s[8:11], s17 offen offset:0
    buffer_load_dwordx4 v[252:255], v0, s[8:11], s17 offen offset:1024
    buffer_load_dwordx4 a[0:3], v0, s[8:11], s17 offen offset:2048
    buffer_load_dwordx4 a[4:7], v0, s[8:11], s17 offen offset:3072
    s_add_u32 s17, s49, 28672
    buffer_load_dwordx4 a[8:11], v0, s[8:11], s17 offen offset:0
    buffer_load_dwordx4 a[12:15], v0, s[8:11], s17 offen offset:1024
    buffer_load_dwordx4 a[16:19], v0, s[8:11], s17 offen offset:2048
    buffer_load_dwordx4 a[20:23], v0, s[8:11], s17 offen offset:3072
    s_add_u32 s17, s49, 32768
    buffer_load_dwordx4 a[24:27], v0, s[8:11], s17 offen offset:0
    buffer_load_dwordx4 a[28:31], v0, s[8:11], s17 offen offset:1024
    buffer_load_dwordx4 a[32:35], v0, s[8:11], s17 offen offset:2048
    buffer_load_dwordx4 a[36:39], v0, s[8:11], s17 offen offset:3072
    s_add_u32 s17, s49, 36864
    buffer_load_dwordx4 a[40:43], v0, s[8:11], s17 offen offset:0
    buffer_load_dwordx4 a[44:47], v0, s[8:11], s17 offen offset:1024
    buffer_load_dwordx4 a[48:51], v0, s[8:11], s17 offen offset:2048
    buffer_load_dwordx4 a[52:55], v0, s[8:11], s17 offen offset:3072
    s_add_u32 s17, s49, 40960
    buffer_load_dwordx4 a[56:59], v0, s[8:11], s17 offen offset:0
    buffer_load_dwordx4 a[60:63], v0, s[8:11], s17 offen offset:1024
    buffer_load_dwordx4 a[64:67], v0, s[8:11], s17 offen offset:2048
    buffer_load_dwordx4 a[68:71], v0, s[8:11], s17 offen offset:3072
    s_add_u32 s17, s49, 45056
    buffer_load_dwordx4 a[72:75], v0, s[8:11], s17 offen offset:0
    buffer_load_dwordx4 a[76:79], v0, s[8:11], s17 offen offset:1024
    buffer_load_dwordx4 a[80:83], v0, s[8:11], s17 offen offset:2048
    buffer_load_dwordx4 a[84:87], v0, s[8:11], s17 offen offset:3072
    s_add_u32 s17, s49, 49152
    buffer_load_dwordx4 a[88:91], v0, s[8:11], s17 offen offset:0
    s_waitcnt vmcnt(48)
    buffer_load_dwordx4 a[92:95], v0, s[8:11], s17 offen offset:1024
    s_waitcnt vmcnt(48)
    buffer_load_dwordx4 a[96:99], v0, s[8:11], s17 offen offset:2048
    s_waitcnt vmcnt(48)
    buffer_load_dwordx4 a[100:103], v0, s[8:11], s17 offen offset:3072
    s_waitcnt vmcnt(48)
    s_add_u32 s17, s49, 53248
    buffer_load_dwordx4 a[104:107], v0, s[8:11], s17 offen offset:0
    s_waitcnt vmcnt(48)
    buffer_load_dwordx4 a[108:111], v0, s[8:11], s17 offen offset:1024
    s_waitcnt vmcnt(48)
    buffer_load_dwordx4 a[112:115], v0, s[8:11], s17 offen offset:2048
    s_waitcnt vmcnt(48)
    buffer_load_dwordx4 a[116:119], v0, s[8:11], s17 offen offset:3072
    s_waitcnt vmcnt(48)
    s_add_u32 s17, s49, 57344
    buffer_load_dwordx4 a[120:123], v0, s[8:11], s17 offen offset:0
    s_waitcnt vmcnt(48)
    buffer_load_dwordx4 a[124:127], v0, s[8:11], s17 offen offset:1024
    s_waitcnt vmcnt(48)
    buffer_load_dwordx4 a[128:131], v0, s[8:11], s17 offen offset:2048
    s_waitcnt vmcnt(48)
    buffer_load_dwordx4 a[132:135], v0, s[8:11], s17 offen offset:3072
    s_waitcnt vmcnt(48)
    s_add_u32 s17, s49, 61440
    buffer_load_dwordx4 a[136:139], v0, s[8:11], s17 offen offset:0
    s_waitcnt vmcnt(48)
    buffer_load_dwordx4 a[140:143], v0, s[8:11], s17 offen offset:1024
    s_waitcnt vmcnt(48)
    buffer_load_dwordx4 a[144:147], v0, s[8:11], s17 offen offset:2048
    s_waitcnt vmcnt(48)
    buffer_load_dwordx4 a[148:151], v0, s[8:11], s17 offen offset:3072
    s_waitcnt vmcnt(48)
    s_add_u32 s17, s49, 65536
    buffer_load_dwordx4 a[152:155], v0, s[8:11], s17 offen offset:0
    s_waitcnt vmcnt(48)
    buffer_load_dwordx4 a[156:159], v0, s[8:11], s17 offen offset:1024
    s_waitcnt vmcnt(48)
    buffer_load_dwordx4 a[160:163], v0, s[8:11], s17 offen offset:2048
    s_waitcnt vmcnt(48)
    buffer_load_dwordx4 a[164:167], v0, s[8:11], s17 offen offset:3072
    s_waitcnt vmcnt(48)
    s_add_u32 s17, s49, 69632
    buffer_load_dwordx4 a[168:171], v0, s[8:11], s17 offen offset:0
    s_waitcnt vmcnt(48)
    buffer_load_dwordx4 a[172:175], v0, s[8:11], s17 offen offset:1024
    s_waitcnt vmcnt(48)
    buffer_load_dwordx4 a[176:179], v0, s[8:11], s17 offen offset:2048
    s_waitcnt vmcnt(48)
    buffer_load_dwordx4 a[180:183], v0, s[8:11], s17 offen offset:3072
    s_waitcnt vmcnt(48)
    s_add_u32 s17, s49, 73728
    buffer_load_dwordx4 a[184:187], v0, s[8:11], s17 offen offset:0
    s_waitcnt vmcnt(48)
    buffer_load_dwordx4 a[188:191], v0, s[8:11], s17 offen offset:1024
    s_waitcnt vmcnt(48)
    buffer_load_dwordx4 a[192:195], v0, s[8:11], s17 offen offset:2048
    s_waitcnt vmcnt(48)
    buffer_load_dwordx4 a[196:199], v0, s[8:11], s17 offen offset:3072
    s_waitcnt vmcnt(48)
    s_add_u32 s17, s49, 77824
    buffer_load_dwordx4 a[200:203], v0, s[8:11], s17 offen offset:0
    s_waitcnt vmcnt(48)
    buffer_load_dwordx4 a[204:207], v0, s[8:11], s17 offen offset:1024
    s_waitcnt vmcnt(48)
    buffer_load_dwordx4 a[208:211], v0, s[8:11], s17 offen offset:2048
    s_waitcnt vmcnt(48)
    buffer_load_dwordx4 a[212:215], v0, s[8:11], s17 offen offset:3072
    s_waitcnt vmcnt(48)
    s_add_u32 s17, s49, 81920
    buffer_load_dwordx4 a[216:219], v0, s[8:11], s17 offen offset:0
    s_waitcnt vmcnt(48)
    buffer_load_dwordx4 a[220:223], v0, s[8:11], s17 offen offset:1024
    s_waitcnt vmcnt(48)
    buffer_load_dwordx4 a[224:227], v0, s[8:11], s17 offen offset:2048
    s_waitcnt vmcnt(48)
    buffer_load_dwordx4 a[228:231], v0, s[8:11], s17 offen offset:3072
    s_waitcnt vmcnt(48)
    s_add_u32 s17, s49, 86016
    buffer_load_dwordx4 a[232:235], v0, s[8:11], s17 offen offset:0
    s_waitcnt vmcnt(48)
    buffer_load_dwordx4 a[236:239], v0, s[8:11], s17 offen offset:1024
    s_waitcnt vmcnt(48)
    buffer_load_dwordx4 a[240:243], v0, s[8:11], s17 offen offset:2048
    s_waitcnt vmcnt(48)
    buffer_load_dwordx4 a[244:247], v0, s[8:11], s17 offen offset:3072
    s_waitcnt vmcnt(48)
    s_add_u32 s17, s49, 90112
    buffer_load_dwordx4 a[248:251], v0, s[8:11], s17 offen offset:0
    s_waitcnt vmcnt(48)
    buffer_load_dwordx4 a[252:255], v0, s[8:11], s17 offen offset:1024
    s_waitcnt vmcnt(48)
    v_mov_b32 v56, 0x3f803f80
    v_mov_b32 v57, 0x3f803f80
    v_mov_b32 v58, 0x3f803f80
    v_mov_b32 v59, 0x3f803f80
    s_nop 1
    v_mfma_f32_16x16x32_bf16 v[36:39], v[152:155], v[56:59], 0
    v_mfma_f32_16x16x32_bf16 v[40:43], v[224:227], v[56:59], 0
    v_mfma_f32_16x16x32_bf16 v[44:47], a[40:43], v[56:59], 0
    s_waitcnt vmcnt(35)
    v_mfma_f32_16x16x32_bf16 v[48:51], v[56:59], a[112:115], 0
    s_waitcnt vmcnt(17)
    v_mfma_f32_16x16x32_bf16 v[52:55], v[56:59], a[184:187], 0
    v_mfma_f32_16x16x32_bf16 v[36:39], v[156:159], v[56:59], v[36:39]
    v_mfma_f32_16x16x32_bf16 v[40:43], v[228:231], v[56:59], v[40:43]
    v_mfma_f32_16x16x32_bf16 v[44:47], a[44:47], v[56:59], v[44:47]
    v_mfma_f32_16x16x32_bf16 v[48:51], v[56:59], a[116:119], v[48:51]
    s_waitcnt vmcnt(16)
    v_mfma_f32_16x16x32_bf16 v[52:55], v[56:59], a[188:191], v[52:55]
    v_mfma_f32_16x16x32_bf16 v[36:39], v[160:163], v[56:59], v[36:39]
    v_mfma_f32_16x16x32_bf16 v[40:43], v[232:235], v[56:59], v[40:43]
    v_mfma_f32_16x16x32_bf16 v[44:47], a[48:51], v[56:59], v[44:47]
    v_mfma_f32_16x16x32_bf16 v[48:51], v[56:59], a[120:123], v[48:51]
    s_waitcnt vmcnt(15)
    v_mfma_f32_16x16x32_bf16 v[52:55], v[56:59], a[192:195], v[52:55]
    v_mfma_f32_16x16x32_bf16 v[36:39], v[164:167], v[56:59], v[36:39]
    v_mfma_f32_16x16x32_bf16 v[40:43], v[236:239], v[56:59], v[40:43]
    v_mfma_f32_16x16x32_bf16 v[44:47], a[52:55], v[56:59], v[44:47]
    v_mfma_f32_16x16x32_bf16 v[48:51], v[56:59], a[124:127], v[48:51]
    s_waitcnt vmcnt(14)
    v_mfma_f32_16x16x32_bf16 v[52:55], v[56:59], a[196:199], v[52:55]
    v_mfma_f32_16x16x32_bf16 v[36:39], v[168:171], v[56:59], v[36:39]
    v_mfma_f32_16x16x32_bf16 v[40:43], v[240:243], v[56:59], v[40:43]
    v_mfma_f32_16x16x32_bf16 v[44:47], a[56:59], v[56:59], v[44:47]
    v_mfma_f32_16x16x32_bf16 v[48:51], v[56:59], a[128:131], v[48:51]
    s_waitcnt vmcnt(13)
    v_mfma_f32_16x16x32_bf16 v[52:55], v[56:59], a[200:203], v[52:55]
    v_mfma_f32_16x16x32_bf16 v[36:39], v[172:175], v[56:59], v[36:39]
    v_mfma_f32_16x16x32_bf16 v[40:43], v[244:247], v[56:59], v[40:43]
    v_mfma_f32_16x16x32_bf16 v[44:47], a[60:63], v[56:59], v[44:47]
    v_mfma_f32_16x16x32_bf16 v[48:51], v[56:59], a[132:135], v[48:51]
    s_waitcnt vmcnt(12)
    v_mfma_f32_16x16x32_bf16 v[52:55], v[56:59], a[204:207], v[52:55]
    v_mfma_f32_16x16x32_bf16 v[36:39], v[176:179], v[56:59], v[36:39]
    v_mfma_f32_16x16x32_bf16 v[40:43], v[248:251], v[56:59], v[40:43]
    v_mfma_f32_16x16x32_bf16 v[44:47], a[64:67], v[56:59], v[44:47]
    v_mfma_f32_16x16x32_bf16 v[48:51], v[56:59], a[136:139], v[48:51]
    s_waitcnt vmcnt(11)
    v_mfma_f32_16x16x32_bf16 v[52:55], v[56:59], a[208:211], v[52:55]
    v_mfma_f32_16x16x32_bf16 v[36:39], v[180:183], v[56:59], v[36:39]
    v_mfma_f32_16x16x32_bf16 v[40:43], v[252:255], v[56:59], v[40:43]
    v_mfma_f32_16x16x32_bf16 v[44:47], a[68:71], v[56:59], v[44:47]
    v_mfma_f32_16x16x32_bf16 v[48:51], v[56:59], a[140:143], v[48:51]
    s_waitcnt vmcnt(10)
    v_mfma_f32_16x16x32_bf16 v[52:55], v[56:59], a[212:215], v[52:55]
    v_mfma_f32_16x16x32_bf16 v[36:39], v[184:187], v[56:59], v[36:39]
    v_mfma_f32_16x16x32_bf16 v[40:43], a[0:3], v[56:59], v[40:43]
    v_mfma_f32_16x16x32_bf16 v[44:47], a[72:75], v[56:59], v[44:47]
    v_mfma_f32_16x16x32_bf16 v[48:51], v[56:59], a[144:147], v[48:51]
    s_waitcnt vmcnt(9)
    v_mfma_f32_16x16x32_bf16 v[52:55], v[56:59], a[216:219], v[52:55]
    v_mfma_f32_16x16x32_bf16 v[36:39], v[188:191], v[56:59], v[36:39]
    v_mfma_f32_16x16x32_bf16 v[40:43], a[4:7], v[56:59], v[40:43]
    v_mfma_f32_16x16x32_bf16 v[44:47], a[76:79], v[56:59], v[44:47]
    v_mfma_f32_16x16x32_bf16 v[48:51], v[56:59], a[148:151], v[48:51]
    s_waitcnt vmcnt(8)
    v_mfma_f32_16x16x32_bf16 v[52:55], v[56:59], a[220:223], v[52:55]
    v_mfma_f32_16x16x32_bf16 v[36:39], v[192:195], v[56:59], v[36:39]
    v_mfma_f32_16x16x32_bf16 v[40:43], a[8:11], v[56:59], v[40:43]
    v_mfma_f32_16x16x32_bf16 v[44:47], a[80:83], v[56:59], v[44:47]
    v_mfma_f32_16x16x32_bf16 v[48:51], v[56:59], a[152:155], v[48:51]
    s_waitcnt vmcnt(7)
    v_mfma_f32_16x16x32_bf16 v[52:55], v[56:59], a[224:227], v[52:55]
    v_mfma_f32_16x16x32_bf16 v[36:39], v[196:199], v[56:59], v[36:39]
    v_mfma_f32_16x16x32_bf16 v[40:43], a[12:15], v[56:59], v[40:43]
    v_mfma_f32_16x16x32_bf16 v[44:47], a[84:87], v[56:59], v[44:47]
    v_mfma_f32_16x16x32_bf16 v[48:51], v[56:59], a[156:159], v[48:51]
    s_waitcnt vmcnt(6)
    v_mfma_f32_16x16x32_bf16 v[52:55], v[56:59], a[228:231], v[52:55]
    v_mfma_f32_16x16x32_bf16 v[36:39], v[200:203], v[56:59], v[36:39]
    v_mfma_f32_16x16x32_bf16 v[40:43], a[16:19], v[56:59], v[40:43]
    v_mfma_f32_16x16x32_bf16 v[44:47], a[88:91], v[56:59], v[44:47]
    v_mfma_f32_16x16x32_bf16 v[48:51], v[56:59], a[160:163], v[48:51]
    s_waitcnt vmcnt(5)
    v_mfma_f32_16x16x32_bf16 v[52:55], v[56:59], a[232:235], v[52:55]
    v_mfma_f32_16x16x32_bf16 v[36:39], v[204:207], v[56:59], v[36:39]
    v_mfma_f32_16x16x32_bf16 v[40:43], a[20:23], v[56:59], v[40:43]
    v_mfma_f32_16x16x32_bf16 v[44:47], a[92:95], v[56:59], v[44:47]
    v_mfma_f32_16x16x32_bf16 v[48:51], v[56:59], a[164:167], v[48:51]
    s_waitcnt vmcnt(4)
    v_mfma_f32_16x16x32_bf16 v[52:55], v[56:59], a[236:239], v[52:55]
    v_mfma_f32_16x16x32_bf16 v[36:39], v[208:211], v[56:59], v[36:39]
    v_mfma_f32_16x16x32_bf16 v[40:43], a[24:27], v[56:59], v[40:43]
    v_mfma_f32_16x16x32_bf16 v[44:47], a[96:99], v[56:59], v[44:47]
    v_mfma_f32_16x16x32_bf16 v[48:51], v[56:59], a[168:171], v[48:51]
    s_waitcnt vmcnt(3)
    v_mfma_f32_16x16x32_bf16 v[52:55], v[56:59], a[240:243], v[52:55]
    v_mfma_f32_16x16x32_bf16 v[36:39], v[212:215], v[56:59], v[36:39]
    v_mfma_f32_16x16x32_bf16 v[40:43], a[28:31], v[56:59], v[40:43]
    v_mfma_f32_16x16x32_bf16 v[44:47], a[100:103], v[56:59], v[44:47]
    v_mfma_f32_16x16x32_bf16 v[48:51], v[56:59], a[172:175], v[48:51]
    s_waitcnt vmcnt(2)
    v_mfma_f32_16x16x32_bf16 v[52:55], v[56:59], a[244:247], v[52:55]
    v_mfma_f32_16x16x32_bf16 v[36:39], v[216:219], v[56:59], v[36:39]
    v_mfma_f32_16x16x32_bf16 v[40:43], a[32:35], v[56:59], v[40:43]
    v_mfma_f32_16x16x32_bf16 v[44:47], a[104:107], v[56:59], v[44:47]
    v_mfma_f32_16x16x32_bf16 v[48:51], v[56:59], a[176:179], v[48:51]
    s_waitcnt vmcnt(1)
    v_mfma_f32_16x16x32_bf16 v[52:55], v[56:59], a[248:251], v[52:55]
    v_mfma_f32_16x16x32_bf16 v[36:39], v[220:223], v[56:59], v[36:39]
    v_mfma_f32_16x16x32_bf16 v[40:43], a[36:39], v[56:59], v[40:43]
    v_mfma_f32_16x16x32_bf16 v[44:47], a[108:111], v[56:59], v[44:47]
    v_mfma_f32_16x16x32_bf16 v[48:51], v[56:59], a[180:183], v[48:51]
    s_waitcnt vmcnt(0)
    v_mfma_f32_16x16x32_bf16 v[52:55], v[56:59], a[252:255], v[52:55]
    v_lshlrev_b32 v10, 5, v7
    s_lshl_b32 s17, s51, 4
    v_add_u32 v10, s17, v10
    v_mul_u32_u24 v6, 1536, v8
    v_add_u32 v10, v10, v6
    s_lshl_b32 s17, s14, 7
    s_add_u32 s17, s17, 73728
    v_lshl_add_u32 v11, v7, 3, s17
    v_lshl_add_u32 v12, v8, 5, s17
    v_lshlrev_b32 v13, 5, v7
    s_lshl_b32 s17, s51, 4
    v_add_u32 v13, s17, v13
    s_lshr_b32 s17, s50, 2
    s_add_u32 s17, s17, 64
    s_lshl_b32 s17, s17, 9
    s_and_b32 s18, s50, 3
    s_lshl_b32 s18, s18, 2
    s_add_u32 s17, s17, s18
    v_add_u32 v14, s17, v13
    v_lshrrev_b32 v5, 1, v8
    v_lshl_add_u32 v13, v5, 9, v13
    v_and_b32 v5, 1, v8
    v_lshl_add_u32 v13, v5, 3, v13
    s_lshl_b32 s17, s50, 10
    v_add_u32 v13, s17, v13
    s_lshl_b32 s49, s15, 7
    s_lshl_b32 s17, s14, 2
    s_add_u32 s49, s49, s17
    s_add_u32 s49, s49, 1536
    s_mov_b32 s52, 0x3eae1a93
    v_mov_b32 v6, 0xf149f2ca
    v_lshl_add_u32 v5, v8, 2, 0
    v_sub_u32 v5, v5, v7
    v_cmp_le_i32 vcc, 9, v5
    s_nop 1
    v_cndmask_b32 v72, v6, v4, vcc
    v_add_u32 v5, 7, v5
    v_cmp_ge_u32 vcc, 7, v5
    s_nop 1
    v_cndmask_b32 v76, v6, v4, vcc
    v_lshl_add_u32 v5, v8, 2, 1
    v_sub_u32 v5, v5, v7
    v_cmp_le_i32 vcc, 9, v5
    s_nop 1
    v_cndmask_b32 v73, v6, v4, vcc
    v_add_u32 v5, 7, v5
    v_cmp_ge_u32 vcc, 7, v5
    s_nop 1
    v_cndmask_b32 v77, v6, v4, vcc
    v_lshl_add_u32 v5, v8, 2, 2
    v_sub_u32 v5, v5, v7
    v_cmp_le_i32 vcc, 9, v5
    s_nop 1
    v_cndmask_b32 v74, v6, v4, vcc
    v_add_u32 v5, 7, v5
    v_cmp_ge_u32 vcc, 7, v5
    s_nop 1
    v_cndmask_b32 v78, v6, v4, vcc
    v_lshl_add_u32 v5, v8, 2, 3
    v_sub_u32 v5, v5, v7
    v_cmp_le_i32 vcc, 9, v5
    s_nop 1
    v_cndmask_b32 v75, v6, v4, vcc
    v_add_u32 v5, 7, v5
    v_cmp_ge_u32 vcc, 7, v5
    s_nop 1
    v_cndmask_b32 v79, v6, v4, vcc
    v_mov_b32 v112, 0
    v_mov_b32 v113, 0
    v_mov_b32 v114, 0
    v_mov_b32 v115, 0
    v_mov_b32 v136, 0
    v_mov_b32 v137, 0
    v_mov_b32 v138, 0
    v_mov_b32 v139, 0
    v_mov_b32 v140, 0
    v_mov_b32 v141, 0
    v_mov_b32 v142, 0
    v_mov_b32 v143, 0
    v_mov_b32 v116, 0x3f803f80
    v_mov_b32 v117, 0x3f803f80
    v_mov_b32 v118, 0x3f803f80
    v_mov_b32 v119, 0x3f803f80
    v_mov_b32 v131, 0
    v_mov_b32 v135, 0
    s_mov_b32 s32, 0
    s_mov_b32 s33, 0
    s_mov_b32 s38, 128
    s_mul_i32 s58, s14, 9216
    s_mov_b32 s40, 36864
    s_mov_b32 s59, s58
    s_mov_b32 s43, 0
    s_mov_b32 s28, s8
    s_mov_b32 s29, s9
    s_mov_b32 s30, 0
    s_mov_b32 s31, 0x00020000
    v_mov_b32 v110, 74752
    s_add_u32 s64, s58, 6291456
    s_add_u32 s65, s58, 11010048
    s_cmp_eq_u32 s63, 0
    s_cselect_b32 s32, 0, 64
    s_cselect_b32 s33, 64, 0
    s_mov_b32 s38, 64
    ds_write2_b32 v110, v4, v4 offset0:0 offset1:1
    s_waitcnt lgkmcnt(0)
    s_cmp_lg_u32 s14, 0
    s_cbranch_scc1 Laq_ini_d
    v_mov_b32 v5, 160
    s_mov_b32 s16, 0
Laq_ini:
    global_load_dword v6, v5, s[12:13] sc1
    s_add_u32 s16, s16, 1
    s_cmp_gt_u32 s16, 100000
    s_cbranch_scc1 L_role_aq_abort
    s_waitcnt vmcnt(0)
    v_cmp_gt_u32 vcc, 192, v6
    s_nop 0
    s_cbranch_vccz Laq_ini_d
    s_sleep 8
    s_branch Laq_ini
Laq_ini_d:
    s_barrier
    s_branch Laq_idle0
Laq_item:
    s_waitcnt vmcnt(2)
Laq_defer:
    s_cmp_lg_u32 s14, 0
    s_cbranch_scc1 Laq_nw0
    v_cmp_eq_u32 vcc, 0, v2
    v_cmp_eq_u32 s[54:55], 0, v15
    s_cmp_eq_u64 vcc, 0
    s_cselect_b32 s62, 1, 0
    s_cmp_eq_u64 s[54:55], 0
    s_cselect_b32 s62, 2, s62
    v_mov_b32 v5, s62
    ds_write_b32 v110, v5
    s_waitcnt lgkmcnt(0)
Laq_nw0:
    s_barrier
    ds_read_b32 v6, v110
    v_xor_b32 v110, 4, v110
    s_xor_b32 s40, s40, 36864
    s_xor_b32 s59, s59, 36864
    s_xor_b32 s66, s66, 0x2000
    s_xor_b32 s71, s71, 0x2000
    s_sub_u32 s38, s38, 1
    v_lshlrev_b32 v9, 9, v8
    v_lshl_add_u32 v9, v7, 5, v9
    s_lshl_b32 s17, s51, 4
    s_add_u32 s17, s17, s40
    v_add_u32 v9, s17, v9
    ds_read_b128 v[56:59], v9 offset:0
    ds_read_b128 v[60:63], v9 offset:2048
    ds_read_b128 v[64:67], v9 offset:4096
    s_waitcnt lgkmcnt(2)
    v_mfma_f32_16x16x32_bf16 v[16:19], v[152:155], v[56:59], 0
    v_add_f32 v80, v80, v84
    v_mfma_f32_16x16x32_bf16 v[20:23], v[224:227], v[56:59], 0
    v_add_f32 v81, v81, v85
    v_mfma_f32_16x16x32_bf16 v[24:27], a[40:43], v[56:59], 0
    v_add_f32 v82, v82, v86
    v_readfirstlane_b32 s62, v6
    s_nop 0
    s_cmp_eq_u32 s62, 2
    s_cselect_b32 s41, s65, s64
    s_cmp_lg_u32 s62, 0
    s_cselect_b32 s30, 268435456, 0
    s_add_u32 m0, s59, 0
    s_add_u32 s47, s41, 0
    buffer_load_dwordx4 v0, s[28:31], s47 offen offset:0 lds
    s_cmp_eq_u32 s62, 2
    s_cselect_b32 s36, 1, 0
    s_cselect_b32 s37, s33, s32
    s_cselect_b32 s17, 1, 0
    s_add_u32 s33, s33, s17
    s_cmp_eq_u32 s62, 1
    s_cselect_b32 s17, 1, 0
    s_add_u32 s32, s32, s17
    s_lshl_b32 s56, s36, 6
    s_add_u32 s56, s56, s37
    s_mul_i32 s48, s36, 786432
    s_mul_i32 s18, s37, 6144
    s_add_u32 s48, s48, s18
    s_add_u32 s48, s48, 15728640
    s_cmp_eq_u32 s62, 2
    s_cselect_b32 s17, 36864, 0
    s_add_u32 s65, s65, s17
    s_cmp_eq_u32 s62, 1
    s_cselect_b32 s17, 36864, 0
    s_add_u32 s64, s64, s17
    ds_read_b128 v[56:59], v9 offset:6144
    s_waitcnt lgkmcnt(2)
    v_mfma_f32_16x16x32_bf16 v[16:19], v[156:159], v[60:63], v[16:19]
    v_add_f32 v83, v83, v87
    v_mfma_f32_16x16x32_bf16 v[20:23], v[228:231], v[60:63], v[20:23]
    v_add_f32 v80, v80, v88
    v_mfma_f32_16x16x32_bf16 v[24:27], a[44:47], v[60:63], v[24:27]
    v_add_f32 v81, v81, v89
    buffer_load_dwordx4 v0, s[28:31], s47 offen offset:1024 lds
    ds_read_b128 v[60:63], v9 offset:8192
    s_waitcnt lgkmcnt(2)
    v_mfma_f32_16x16x32_bf16 v[16:19], v[160:163], v[64:67], v[16:19]
    v_add_f32 v82, v82, v90
    v_mfma_f32_16x16x32_bf16 v[20:23], v[232:235], v[64:67], v[20:23]
    v_add_f32 v83, v83, v91
    v_mfma_f32_16x16x32_bf16 v[24:27], a[48:51], v[64:67], v[24:27]
    v_add_f32 v80, v80, v82
    buffer_load_dwordx4 v0, s[28:31], s47 offen offset:2048 lds
    ds_read_b128 v[64:67], v9 offset:10240
    s_waitcnt lgkmcnt(2)
    v_mfma_f32_16x16x32_bf16 v[16:19], v[164:167], v[56:59], v[16:19]
    v_add_f32 v81, v81, v83
    v_mfma_f32_16x16x32_bf16 v[20:23], v[236:239], v[56:59], v[20:23]
    v_mov_b32 v82, v80
    v_mfma_f32_16x16x32_bf16 v[24:27], a[52:55], v[56:59], v[24:27]
    v_mov_b32 v83, v81
    buffer_load_dwordx4 v0, s[28:31], s47 offen offset:3072 lds
    ds_read_b128 v[56:59], v9 offset:12288
    s_waitcnt lgkmcnt(2)
    v_mfma_f32_16x16x32_bf16 v[16:19], v[168:171], v[60:63], v[16:19]
    v_permlane32_swap_b32 v80, v82
    v_mfma_f32_16x16x32_bf16 v[20:23], v[240:243], v[60:63], v[20:23]
    v_permlane32_swap_b32 v81, v83
    v_mfma_f32_16x16x32_bf16 v[24:27], a[56:59], v[60:63], v[24:27]
    v_add_f32 v80, v80, v82
    s_add_u32 m0, s59, 4096
    s_add_u32 s47, s41, 4096
    buffer_load_dwordx4 v0, s[28:31], s47 offen offset:0 lds
    ds_read_b128 v[60:63], v9 offset:14336
    s_waitcnt lgkmcnt(2)
    v_mfma_f32_16x16x32_bf16 v[16:19], v[172:175], v[64:67], v[16:19]
    v_add_f32 v81, v81, v83
    v_mfma_f32_16x16x32_bf16 v[20:23], v[244:247], v[64:67], v[20:23]
    v_mov_b32 v82, v80
    v_mfma_f32_16x16x32_bf16 v[24:27], a[60:63], v[64:67], v[24:27]
    v_mov_b32 v83, v81
    buffer_load_dwordx4 v0, s[28:31], s47 offen offset:1024 lds
    ds_read_b128 v[64:67], v9 offset:16384
    s_waitcnt lgkmcnt(2)
    v_mfma_f32_16x16x32_bf16 v[16:19], v[176:179], v[56:59], v[16:19]
    v_permlane16_swap_b32 v80, v82
    v_mfma_f32_16x16x32_bf16 v[20:23], v[248:251], v[56:59], v[20:23]
    v_permlane16_swap_b32 v81, v83
    v_mfma_f32_16x16x32_bf16 v[24:27], a[64:67], v[56:59], v[24:27]
    v_add_f32 v80, v80, v82
    buffer_load_dwordx4 v0, s[28:31], s47 offen offset:2048 lds
    ds_read_b128 v[56:59], v9 offset:18432
    s_waitcnt lgkmcnt(2)
    v_mfma_f32_16x16x32_bf16 v[16:19], v[180:183], v[60:63], v[16:19]
    v_add_f32 v81, v81, v83
    v_mfma_f32_16x16x32_bf16 v[20:23], v[252:255], v[60:63], v[20:23]
    v_mul_f32 v80, 0x3ae38e39, v80
    v_mfma_f32_16x16x32_bf16 v[24:27], a[68:71], v[60:63], v[24:27]
    v_mul_f32 v81, 0x3ae38e39, v81
    buffer_load_dwordx4 v0, s[28:31], s47 offen offset:3072 lds
    ds_read_b128 v[60:63], v9 offset:20480
    s_waitcnt lgkmcnt(2)
    v_mfma_f32_16x16x32_bf16 v[16:19], v[184:187], v[64:67], v[16:19]
    v_fma_f32 v81, -v80, v80, v81
    v_mfma_f32_16x16x32_bf16 v[20:23], a[0:3], v[64:67], v[20:23]
    v_max_f32 v81, 0, v81
    v_mfma_f32_16x16x32_bf16 v[24:27], a[72:75], v[64:67], v[24:27]
    v_add_f32 v81, 0x3727c5ac, v81
    s_add_u32 m0, s59, 8192
    s_add_u32 s47, s41, 8192
    buffer_load_dwordx4 v0, s[28:31], s47 offen offset:0 lds
    s_waitcnt vmcnt(9)
    s_cmp_lg_u32 s43, 0
    s_cselect_b64 exec, 1, 0
    buffer_store_dword v3, v4, s[8:11], s43 offen sc1
    s_mov_b64 exec, -1
    s_mov_b32 s43, 0
    ds_read_b128 v[64:67], v9 offset:22528
    s_waitcnt lgkmcnt(2)
    v_mfma_f32_16x16x32_bf16 v[16:19], v[188:191], v[56:59], v[16:19]
    v_rsq_f32 v92, v81
    v_mfma_f32_16x16x32_bf16 v[20:23], a[4:7], v[56:59], v[20:23]
    v_mul_f32 v93, v80, v92
    v_mfma_f32_16x16x32_bf16 v[24:27], a[76:79], v[56:59], v[24:27]
    ds_write_b64 v11, v[92:93]
    ds_read_b128 v[56:59], v9 offset:24576
    s_waitcnt lgkmcnt(3)
    v_mfma_f32_16x16x32_bf16 v[16:19], v[192:195], v[60:63], v[16:19]
    ds_read_b128 v[96:99], v12
    v_mfma_f32_16x16x32_bf16 v[20:23], a[8:11], v[60:63], v[20:23]
    ds_read_b128 v[100:103], v12 offset:16
    v_mfma_f32_16x16x32_bf16 v[24:27], a[80:83], v[60:63], v[24:27]
    buffer_load_dwordx4 v[80:83], v10, s[28:31], s48 offen offset:0
    ds_read_b128 v[60:63], v9 offset:26624
    s_waitcnt lgkmcnt(5)
    v_mfma_f32_16x16x32_bf16 v[16:19], v[196:199], v[64:67], v[16:19]
    v_mfma_f32_16x16x32_bf16 v[20:23], a[12:15], v[64:67], v[20:23]
    v_mfma_f32_16x16x32_bf16 v[24:27], a[84:87], v[64:67], v[24:27]
    buffer_load_dwordx4 v[84:87], v10, s[28:31], s48 offen offset:512
    ds_read_b128 v[64:67], v9 offset:28672
    s_waitcnt lgkmcnt(4)
    v_mfma_f32_16x16x32_bf16 v[16:19], v[200:203], v[56:59], v[16:19]
    v_mfma_f32_16x16x32_bf16 v[20:23], a[16:19], v[56:59], v[20:23]
    v_mfma_f32_16x16x32_bf16 v[24:27], a[88:91], v[56:59], v[24:27]
    buffer_load_dwordx4 v[88:91], v10, s[28:31], s48 offen offset:1024
    ds_read_b128 v[56:59], v9 offset:30720
    s_waitcnt lgkmcnt(2)
    v_mfma_f32_16x16x32_bf16 v[16:19], v[204:207], v[60:63], v[16:19]
    v_mfma_f32_16x16x32_bf16 v[20:23], a[20:23], v[60:63], v[20:23]
    v_mfma_f32_16x16x32_bf16 v[24:27], a[92:95], v[60:63], v[24:27]
    ds_read_b128 v[60:63], v9 offset:32768
    s_waitcnt lgkmcnt(2)
    v_mfma_f32_16x16x32_bf16 v[16:19], v[208:211], v[64:67], v[16:19]
    v_mfma_f32_16x16x32_bf16 v[20:23], a[24:27], v[64:67], v[20:23]
    v_mfma_f32_16x16x32_bf16 v[24:27], a[96:99], v[64:67], v[24:27]
    ds_read_b128 v[64:67], v9 offset:34816
    s_waitcnt lgkmcnt(2)
    v_mfma_f32_16x16x32_bf16 v[16:19], v[212:215], v[56:59], v[16:19]
    v_mfma_f32_16x16x32_bf16 v[20:23], a[28:31], v[56:59], v[20:23]
    v_mfma_f32_16x16x32_bf16 v[24:27], a[100:103], v[56:59], v[24:27]
    ds_read_b128 v[56:59], v9 offset:0
    s_waitcnt lgkmcnt(2)
    v_mfma_f32_16x16x32_bf16 v[16:19], v[216:219], v[60:63], v[16:19]
    v_mfma_f32_16x16x32_bf16 v[20:23], a[32:35], v[60:63], v[20:23]
    v_mfma_f32_16x16x32_bf16 v[24:27], a[104:107], v[60:63], v[24:27]
    ds_read_b128 v[60:63], v9 offset:2048
    s_waitcnt lgkmcnt(2)
    v_mfma_f32_16x16x32_bf16 v[16:19], v[220:223], v[64:67], v[16:19]
    v_mfma_f32_16x16x32_bf16 v[20:23], a[36:39], v[64:67], v[20:23]
    v_mfma_f32_16x16x32_bf16 v[24:27], a[108:111], v[64:67], v[24:27]
    s_cmp_lg_u32 s14, 0
    s_cbranch_scc1 Laq_ns_13
    s_mul_i32 s60, s32, 22528
    s_add_u32 s60, s60, 0
    s_cmp_lt_u32 s32, 64
    s_cselect_b32 s60, s60, 2883584
    s_mul_i32 s61, s33, 22528
    s_add_u32 s61, s61, 1441792
    s_cmp_lt_u32 s33, 64
    s_cselect_b32 s61, s61, 2883584
    buffer_load_dword v2, v1, s[8:11], s60 offen sc1
    buffer_load_dword v15, v1, s[8:11], s61 offen sc1
Laq_ns_13:
    ds_read_b128 v[64:67], v9 offset:4096
    s_waitcnt lgkmcnt(2)
    v_mfma_f32_16x16x32_bf16 v[28:31], v[56:59], a[112:115], 0
    v_mfma_f32_16x16x32_bf16 v[32:35], v[56:59], a[184:187], 0
    ds_read_b128 v[56:59], v9 offset:6144
    s_waitcnt lgkmcnt(2)
    v_mfma_f32_16x16x32_bf16 v[28:31], v[60:63], a[116:119], v[28:31]
    v_mul_f32 v94, v93, v36
    v_fma_f32 v16, v16, v92, -v94
    v_mfma_f32_16x16x32_bf16 v[32:35], v[60:63], a[188:191], v[32:35]
    v_mul_f32 v94, v93, v37
    v_fma_f32 v17, v17, v92, -v94
    ds_read_b128 v[60:63], v9 offset:8192
    s_waitcnt lgkmcnt(2)
    v_mfma_f32_16x16x32_bf16 v[28:31], v[64:67], a[120:123], v[28:31]
    v_mul_f32 v94, v93, v38
    v_fma_f32 v18, v18, v92, -v94
    v_mfma_f32_16x16x32_bf16 v[32:35], v[64:67], a[192:195], v[32:35]
    v_mul_f32 v94, v93, v39
    v_fma_f32 v19, v19, v92, -v94
    ds_read_b128 v[64:67], v9 offset:10240
    s_waitcnt lgkmcnt(2)
    v_mfma_f32_16x16x32_bf16 v[28:31], v[56:59], a[124:127], v[28:31]
    v_mul_f32 v94, v93, v44
    v_fma_f32 v24, v24, v92, -v94
    v_mfma_f32_16x16x32_bf16 v[32:35], v[56:59], a[196:199], v[32:35]
    v_mul_f32 v94, v93, v45
    v_fma_f32 v25, v25, v92, -v94
    ds_read_b128 v[56:59], v9 offset:12288
    s_waitcnt lgkmcnt(2)
    v_mfma_f32_16x16x32_bf16 v[28:31], v[60:63], a[128:131], v[28:31]
    v_mul_f32 v94, v93, v46
    v_fma_f32 v26, v26, v92, -v94
    v_mfma_f32_16x16x32_bf16 v[32:35], v[60:63], a[200:203], v[32:35]
    v_mul_f32 v94, v93, v47
    v_fma_f32 v27, v27, v92, -v94
    ds_read_b128 v[60:63], v9 offset:14336
    s_waitcnt lgkmcnt(2)
    v_mfma_f32_16x16x32_bf16 v[28:31], v[64:67], a[132:135], v[28:31]
    v_mul_f32 v94, v93, v40
    v_fma_f32 v20, v20, v92, -v94
    v_mfma_f32_16x16x32_bf16 v[32:35], v[64:67], a[204:207], v[32:35]
    v_mul_f32 v94, v93, v41
    v_fma_f32 v21, v21, v92, -v94
    ds_read_b128 v[64:67], v9 offset:16384
    s_waitcnt lgkmcnt(2)
    v_mfma_f32_16x16x32_bf16 v[28:31], v[56:59], a[136:139], v[28:31]
    v_mul_f32 v94, v93, v42
    v_fma_f32 v22, v22, v92, -v94
    v_mfma_f32_16x16x32_bf16 v[32:35], v[56:59], a[208:211], v[32:35]
    v_mul_f32 v94, v93, v43
    v_fma_f32 v23, v23, v92, -v94
    ds_read_b128 v[56:59], v9 offset:18432
    s_waitcnt lgkmcnt(2)
    v_mfma_f32_16x16x32_bf16 v[28:31], v[60:63], a[140:143], v[28:31]
    v_cvt_pk_bf16_f32 v128, v16, v17
    v_cvt_pk_bf16_f32 v129, v18, v19
    v_mfma_f32_16x16x32_bf16 v[32:35], v[60:63], a[212:215], v[32:35]
    v_cvt_pk_bf16_f32 v130, v24, v25
    v_cvt_pk_bf16_f32 v132, v20, v21
    ds_read_b128 v[60:63], v9 offset:20480
    s_waitcnt lgkmcnt(2)
    v_mfma_f32_16x16x32_bf16 v[28:31], v[64:67], a[144:147], v[28:31]
    v_cvt_pk_bf16_f32 v133, v22, v23
    v_cvt_pk_bf16_f32 v134, v26, v27
    v_mfma_f32_16x16x32_bf16 v[32:35], v[64:67], a[216:219], v[32:35]
    s_cmp_eq_u32 s35, 0
    s_cselect_b32 s46, 0xf149f2ca, 0
    ds_read_b128 v[64:67], v9 offset:22528
    s_waitcnt lgkmcnt(2)
    v_mfma_f32_16x16x32_bf16 v[28:31], v[56:59], a[148:151], v[28:31]
    v_mfma_f32_16x16x32_bf16 v[144:147], v[112:115], v[128:131], 0
    v_mfma_f32_16x16x32_bf16 v[32:35], v[56:59], a[220:223], v[32:35]
    v_mfma_f32_16x16x32_bf16 v[148:151], v[132:135], v[128:131], 0
    ds_read_b128 v[56:59], v9 offset:24576
    s_waitcnt lgkmcnt(2)
    v_mfma_f32_16x16x32_bf16 v[28:31], v[60:63], a[152:155], v[28:31]
    v_mov_b32 v112, v132
    v_mfma_f32_16x16x32_bf16 v[32:35], v[60:63], a[224:227], v[32:35]
    v_mov_b32 v113, v133
    v_mov_b32 v114, v134
    ds_read_b128 v[60:63], v9 offset:26624
    s_waitcnt lgkmcnt(2)
    v_mfma_f32_16x16x32_bf16 v[28:31], v[64:67], a[156:159], v[28:31]
    v_mfma_f32_16x16x32_bf16 v[32:35], v[64:67], a[228:231], v[32:35]
    v_fma_f32 v144, v144, s52, v72
    ds_read_b128 v[64:67], v9 offset:28672
    s_waitcnt lgkmcnt(2)
    v_mfma_f32_16x16x32_bf16 v[28:31], v[56:59], a[160:163], v[28:31]
    v_fma_f32 v145, v145, s52, v73
    v_fma_f32 v146, v146, s52, v74
    v_fma_f32 v147, v147, s52, v75
    v_mfma_f32_16x16x32_bf16 v[32:35], v[56:59], a[232:235], v[32:35]
    v_fma_f32 v148, v148, s52, v76
    v_fma_f32 v149, v149, s52, v77
    v_fma_f32 v150, v150, s52, v78
    ds_read_b128 v[56:59], v9 offset:30720
    s_waitcnt lgkmcnt(2)
    v_mfma_f32_16x16x32_bf16 v[28:31], v[60:63], a[164:167], v[28:31]
    v_fma_f32 v151, v151, s52, v79
    v_add_f32 v144, s46, v144
    v_add_f32 v145, s46, v145
    v_mfma_f32_16x16x32_bf16 v[32:35], v[60:63], a[236:239], v[32:35]
    v_add_f32 v146, s46, v146
    v_add_f32 v147, s46, v147
    v_max3_f32 v5, v144, v145, v146
    ds_read_b128 v[60:63], v9 offset:32768
    s_waitcnt lgkmcnt(2)
    v_mfma_f32_16x16x32_bf16 v[28:31], v[64:67], a[168:171], v[28:31]
    v_max3_f32 v5, v5, v147, v148
    v_max3_f32 v5, v5, v149, v150
    v_max_f32 v5, v5, v151
    v_mfma_f32_16x16x32_bf16 v[32:35], v[64:67], a[240:243], v[32:35]
    v_mov_b32 v6, v5
    s_nop 1
    v_permlane32_swap_b32 v5, v6
    ds_read_b128 v[64:67], v9 offset:34816
    s_waitcnt lgkmcnt(2)
    v_mfma_f32_16x16x32_bf16 v[28:31], v[56:59], a[172:175], v[28:31]
    v_max_f32 v5, v5, v6
    v_mov_b32 v6, v5
    v_mfma_f32_16x16x32_bf16 v[32:35], v[56:59], a[244:247], v[32:35]
    s_nop 0
    v_permlane16_swap_b32 v5, v6
    v_max_f32 v5, v5, v6
    v_sub_f32 v144, v144, v5
    s_waitcnt lgkmcnt(1)
    v_mfma_f32_16x16x32_bf16 v[28:31], v[60:63], a[176:179], v[28:31]
    v_sub_f32 v145, v145, v5
    v_sub_f32 v146, v146, v5
    v_sub_f32 v147, v147, v5
    v_mfma_f32_16x16x32_bf16 v[32:35], v[60:63], a[248:251], v[32:35]
    v_sub_f32 v148, v148, v5
    v_sub_f32 v149, v149, v5
    v_sub_f32 v150, v150, v5
    s_waitcnt lgkmcnt(0)
    v_mfma_f32_16x16x32_bf16 v[28:31], v[64:67], a[180:183], v[28:31]
    v_sub_f32 v151, v151, v5
    v_exp_f32 v144, v144
    v_exp_f32 v145, v145
    v_mfma_f32_16x16x32_bf16 v[32:35], v[64:67], a[252:255], v[32:35]
    v_exp_f32 v146, v146
    v_exp_f32 v147, v147
    v_exp_f32 v148, v148
    v_exp_f32 v149, v149
    v_exp_f32 v150, v150
    v_exp_f32 v151, v151
    v_cvt_pk_bf16_f32 v68, v144, v145
    v_cvt_pk_bf16_f32 v69, v146, v147
    v_cvt_pk_bf16_f32 v70, v148, v149
    v_cvt_pk_bf16_f32 v71, v150, v151
    s_nop 1
    v_mfma_f32_16x16x32_bf16 v[16:19], v[116:119], v[68:71], 0
    s_mul_i32 s46, s57, 36864
    s_add_u32 s46, s46, 17301504
    s_nop 5
    v_rcp_f32 v6, v16
    v_mul_f32 v94, v97, v48
    v_fma_f32 v28, v28, v96, -v94
    v_mul_f32 v94, v99, v49
    v_fma_f32 v29, v29, v98, -v94
    v_mul_f32 v94, v101, v50
    v_fma_f32 v30, v30, v100, -v94
    v_mul_f32 v94, v103, v51
    v_fma_f32 v31, v31, v102, -v94
    v_cvt_pk_bf16_f32 v138, v28, v29
    v_cvt_pk_bf16_f32 v139, v30, v31
    v_mul_f32 v94, v97, v52
    v_fma_f32 v32, v32, v96, -v94
    v_mfma_f32_16x16x32_bf16 v[20:23], v[136:139], v[68:71], 0
    v_mul_f32 v94, v99, v53
    v_fma_f32 v33, v33, v98, -v94
    v_mul_f32 v94, v101, v54
    v_fma_f32 v34, v34, v100, -v94
    v_mul_f32 v94, v103, v55
    v_fma_f32 v35, v35, v102, -v94
    v_cvt_pk_bf16_f32 v142, v32, v33
    v_cvt_pk_bf16_f32 v143, v34, v35
    v_mov_b32 v136, v138
    v_mov_b32 v137, v139
    v_mfma_f32_16x16x32_bf16 v[24:27], v[140:143], v[68:71], 0
    v_mul_f32 v20, v6, v20
    v_mul_f32 v21, v6, v21
    v_mul_f32 v22, v6, v22
    v_mul_f32 v23, v6, v23
    v_cvt_pk_bf16_f32 v20, v20, v21
    v_cvt_pk_bf16_f32 v21, v22, v23
    buffer_store_dwordx2 v[20:21], v13, s[8:11], s46 offen sc1
    v_mov_b32 v140, v142
    v_mov_b32 v141, v143
    v_mul_f32 v24, v6, v24
    v_mul_f32 v25, v6, v25
    v_cvt_pk_bf16_f32 v24, v24, v25
    s_mov_b64 exec, 0xffff
    buffer_store_dword v24, v14, s[8:11], s46 offen sc1
    s_mov_b64 exec, -1
    s_mul_i32 s43, s57, 22528
    s_add_u32 s43, s43, s49
    s_mov_b32 s34, s36
    s_mov_b32 s35, s37
    s_mov_b32 s57, s56
    s_min_u32 s62, s62, s38
    s_cmp_lg_u32 s62, 0
    s_cbranch_scc1 Laq_item
    s_cmp_lg_u32 s14, 0
    s_cbranch_scc1 Laq_ns_14
    s_mul_i32 s60, s32, 22528
    s_add_u32 s60, s60, 0
    s_cmp_lt_u32 s32, 64
    s_cselect_b32 s60, s60, 2883584
    s_mul_i32 s61, s33, 22528
    s_add_u32 s61, s61, 1441792
    s_cmp_lt_u32 s33, 64
    s_cselect_b32 s61, s61, 2883584
    buffer_load_dword v2, v1, s[8:11], s60 offen sc1
    buffer_load_dword v15, v1, s[8:11], s61 offen sc1
Laq_ns_14:
    s_waitcnt vmcnt(0)
    s_cmp_lg_u32 s43, 0
    s_cselect_b64 exec, 1, 0
    buffer_store_dword v3, v4, s[8:11], s43 offen sc1
    s_mov_b64 exec, -1
    s_mov_b32 s43, 0
    s_cmp_eq_u32 s38, 0
    s_cbranch_scc1 Laq_end
    s_cmp_lg_u32 s14, 0
    s_cbranch_scc1 Laq_nw1
    v_cmp_eq_u32 vcc, 0, v2
    v_cmp_eq_u32 s[54:55], 0, v15
    s_cmp_eq_u64 vcc, 0
    s_cselect_b32 s62, 1, 0
    s_cmp_eq_u64 s[54:55], 0
    s_cselect_b32 s62, 2, s62
    s_cmp_lg_u32 s62, 0
    s_cbranch_scc1 Laq_got
Laq_idle0:
    s_cmp_lg_u32 s14, 0
    s_cbranch_scc1 Laq_nw1
    s_mul_i32 s60, s32, 22528
    s_add_u32 s60, s60, 0
    s_cmp_lt_u32 s32, 64
    s_cselect_b32 s60, s60, 2883584
    s_mul_i32 s61, s33, 22528
    s_add_u32 s61, s61, 1441792
    s_cmp_lt_u32 s33, 64
    s_cselect_b32 s61, s61, 2883584
    s_mov_b32 s16, 0
Laq_pl_15:
    buffer_load_dword v2, v1, s[8:11], s60 offen sc1
    buffer_load_dword v15, v1, s[8:11], s61 offen sc1
    s_add_u32 s16, s16, 1
    s_cmp_gt_u32 s16, 100000
    s_cbranch_scc1 L_role_aq_abort
    s_waitcnt vmcnt(1)
    v_cmp_eq_u32 vcc, 0, v2
    s_waitcnt vmcnt(0)
    v_cmp_eq_u32 s[54:55], 0, v15
    s_cmp_eq_u64 vcc, 0
    s_cselect_b32 s62, 1, 0
    s_cmp_eq_u64 s[54:55], 0
    s_cselect_b32 s62, 2, s62
    s_cmp_lg_u32 s62, 0
    s_cbranch_scc1 Laq_pl_15d
    s_sleep 4
    s_branch Laq_pl_15
Laq_pl_15d:
Laq_got:
    v_mov_b32 v5, s62
    ds_write_b32 v110, v5
    s_waitcnt lgkmcnt(0)
Laq_nw1:
    s_barrier
    ds_read_b32 v6, v110
    v_xor_b32 v110, 4, v110
    s_waitcnt lgkmcnt(0)
    v_readfirstlane_b32 s62, v6
    s_nop 0
    s_cmp_eq_u32 s62, 0
    s_cbranch_scc1 L_role_aq_abort
    s_cmp_eq_u32 s62, 2
    s_cselect_b32 s41, s65, s64
    s_cmp_lg_u32 s62, 0
    s_cselect_b32 s30, 268435456, 0
    s_cmp_eq_u32 s62, 2
    s_cselect_b32 s36, 1, 0
    s_cselect_b32 s37, s33, s32
    s_cselect_b32 s17, 1, 0
    s_add_u32 s33, s33, s17
    s_cmp_eq_u32 s62, 1
    s_cselect_b32 s17, 1, 0
    s_add_u32 s32, s32, s17
    s_lshl_b32 s56, s36, 6
    s_add_u32 s56, s56, s37
    s_cmp_eq_u32 s62, 2
    s_cselect_b32 s17, 36864, 0
    s_add_u32 s65, s65, s17
    s_cmp_eq_u32 s62, 1
    s_cselect_b32 s17, 36864, 0
    s_add_u32 s64, s64, s17
    s_add_u32 m0, s59, 0
    s_add_u32 s47, s41, 0
    buffer_load_dwordx4 v0, s[8:11], s47 offen offset:0 lds
    buffer_load_dwordx4 v0, s[8:11], s47 offen offset:1024 lds
    buffer_load_dwordx4 v0, s[8:11], s47 offen offset:2048 lds
    buffer_load_dwordx4 v0, s[8:11], s47 offen offset:3072 lds
    s_add_u32 m0, s59, 4096
    s_add_u32 s47, s41, 4096
    buffer_load_dwordx4 v0, s[8:11], s47 offen offset:0 lds
    buffer_load_dwordx4 v0, s[8:11], s47 offen offset:1024 lds
    buffer_load_dwordx4 v0, s[8:11], s47 offen offset:2048 lds
    buffer_load_dwordx4 v0, s[8:11], s47 offen offset:3072 lds
    s_add_u32 m0, s59, 8192
    s_add_u32 s47, s41, 8192
    buffer_load_dwordx4 v0, s[8:11], s47 offen offset:0 lds
    s_mul_i32 s48, s36, 786432
    s_mul_i32 s18, s37, 6144
    s_add_u32 s48, s48, s18
    s_add_u32 s48, s48, 15728640
    buffer_load_dwordx4 v[80:83], v10, s[8:11], s48 offen offset:0
    buffer_load_dwordx4 v[84:87], v10, s[8:11], s48 offen offset:512
    buffer_load_dwordx4 v[88:91], v10, s[8:11], s48 offen offset:1024
    s_mov_b32 s34, s36
    s_mov_b32 s35, s37
    s_mov_b32 s57, s56
    s_cmp_lg_u32 s14, 0
    s_cbranch_scc1 Laq_ns_16
    s_mul_i32 s60, s32, 22528
    s_add_u32 s60, s60, 0
    s_cmp_lt_u32 s32, 64
    s_cselect_b32 s60, s60, 2883584
    s_mul_i32 s61, s33, 22528
    s_add_u32 s61, s61, 1441792
    s_cmp_lt_u32 s33, 64
    s_cselect_b32 s61, s61, 2883584
    buffer_load_dword v2, v1, s[8:11], s60 offen sc1
    buffer_load_dword v15, v1, s[8:11], s61 offen sc1
Laq_ns_16:
    s_waitcnt vmcnt(0)
    s_branch Laq_item
Laq_end:
    s_branch L_role_aq_exit
L_role_aq_abort:
    s_waitcnt lgkmcnt(0)
    s_mov_b64 exec, -1
    v_mov_b32 v0, 60
    s_lshl_b32 s5, s3, 8
    s_or_b32 s5, s5, s4
    s_or_b32 s5, s5, 0x10000
    v_mov_b32 v1, s5
    global_store_dword v0, v1, s[12:13]
    s_endpgm
L_role_aq_exit:
    s_endpgm
.p2align 6
L_role_ta:
    v_and_b32 v5, 63, v0
    v_lshlrev_b32 v0, 4, v5
    v_and_b32 v7, 15, v5
    v_lshrrev_b32 v8, 4, v5
    v_min_u32 v1, 11, v5
    v_lshrrev_b32 v6, 2, v1
    v_and_b32 v1, 3, v1
    v_lshlrev_b32 v1, 2, v1
    v_lshl_add_u32 v1, v6, 7, v1
    v_mov_b32 v3, 1
    v_mov_b32 v4, 0
    s_mov_b32 s44, 0x05040100
    s_mov_b32 s45, 0x07060302
    s_lshl_b32 s17, s15, 2
    s_add_u32 s17, s17, s14
    s_lshr_b32 s36, s17, 5
    s_and_b32 s50, s17, 31
    s_mov_b32 s37, 0
    s_mov_b32 s52, 0x3e0293ee
    v_lshrrev_b32 v5, 2, v7
    v_and_b32 v6, 1, v7
    v_lshl_add_u32 v5, v5, 1, v6
    v_lshlrev_b32 v9, 8, v5
    v_lshl_add_u32 v9, v8, 4, v9
    v_lshrrev_b32 v10, 1, v0
    v_mov_b32 v11, 384
    v_mov_b32 v6, 0xf149f2ca
    v_mov_b32 v21, 0
    v_mov_b32 v22, 0
    s_mul_i32 s42, s36, 1441792
    s_lshl_b32 s17, s50, 9
    s_add_u32 s42, s42, s17
    s_add_u32 s42, s42, 5376
    s_mul_i32 s51, s36, 50331648
    s_lshl_b32 s17, s50, 13
    s_add_u32 s51, s51, s17
    s_add_u32 s51, s51, 44040192
    s_lshl_b32 s47, s36, 11
    s_add_u32 s47, s47, s50
    s_lshl_b32 s48, s47, 13
    s_add_u32 s48, s48, 144703488
    s_lshl_b32 s47, s47, 12
    s_add_u32 s47, s47, 27262976
    s_mul_i32 s43, s36, 1441792
    s_lshr_b32 s17, s50, 2
    s_lshl_b32 s17, s17, 7
    s_add_u32 s43, s43, s17
    s_lshl_b32 s17, s14, 2
    s_add_u32 s43, s43, s17
    s_add_u32 s43, s43, 4224
    s_mov_b32 s28, s8
    s_mov_b32 s29, s9
    s_mov_b32 s30, 0
    s_mov_b32 s31, 0x00020000
    s_mov_b32 s39, 0
    s_mov_b32 s49, 0
    v_mov_b32 v16, 0x3f803f80
    v_lshl_add_u32 v5, v8, 2, 0
    v_cmp_le_u32 vcc, v5, v7
    s_nop 1
    v_cndmask_b32 v236, v6, v4, vcc
    v_mov_b32 v17, 0x3f803f80
    v_lshl_add_u32 v5, v8, 2, 1
    v_cmp_le_u32 vcc, v5, v7
    s_nop 1
    v_cndmask_b32 v237, v6, v4, vcc
    v_mov_b32 v18, 0x3f803f80
    v_lshl_add_u32 v5, v8, 2, 2
    v_cmp_le_u32 vcc, v5, v7
    s_nop 1
    v_cndmask_b32 v238, v6, v4, vcc
    v_mov_b32 v19, 0x3f803f80
    v_lshl_add_u32 v5, v8, 2, 3
    v_cmp_le_u32 vcc, v5, v7
    s_nop 1
    v_cndmask_b32 v239, v6, v4, vcc
    s_cmp_lg_u32 s14, 0
    s_cbranch_scc1 Lta_ini_d
    v_mov_b32 v5, 160
    s_mov_b32 s16, 0
Lta_ini:
    global_load_dword v6, v5, s[12:13] sc1
    s_add_u32 s16, s16, 1
    s_cmp_gt_u32 s16, 100000
    s_cbranch_scc1 L_role_ta_abort
    s_waitcnt vmcnt(0)
    v_cmp_gt_u32 vcc, 192, v6
    s_nop 0
    s_cbranch_vccz Lta_ini_d
    s_sleep 64
    s_branch Lta_ini
Lta_ini_d:
    s_barrier
Lta0:
    s_cmp_eq_u32 s39, 1
    s_cbranch_scc1 Lta0_have
    s_waitcnt vmcnt(0)
    s_cmp_lg_u32 s49, 0
    s_cselect_b64 exec, 1, 0
    buffer_store_dword v3, v4, s[8:11], s43 offen sc1
    s_mov_b64 exec, -1
    s_add_u32 s43, s43, s49
    s_mov_b32 s49, 0
    s_mov_b32 s16, 0
Lta0_f_17:
    buffer_load_dword v2, v1, s[8:11], s42 offen sc1
    s_add_u32 s16, s16, 1
    s_cmp_gt_u32 s16, 100000
    s_cbranch_scc1 L_role_ta_abort
    s_waitcnt vmcnt(0)
    v_cmp_eq_u32 vcc, 0, v2
    s_nop 0
    s_cbranch_vccz Lta0_fd_18
    s_sleep 4
    s_branch Lta0_f_17
Lta0_fd_18:
    s_add_u32 s46, s51, 0
    buffer_load_dwordx4 v[140:143], v0, s[8:11], s46 offen offset:0
    buffer_load_dwordx4 v[144:147], v0, s[8:11], s46 offen offset:1024
    buffer_load_dwordx4 v[148:151], v0, s[8:11], s46 offen offset:2048
    buffer_load_dwordx4 v[152:155], v0, s[8:11], s46 offen offset:3072
    s_add_u32 s46, s51, 4096
    buffer_load_dwordx4 v[156:159], v0, s[8:11], s46 offen offset:0
    buffer_load_dwordx4 v[160:163], v0, s[8:11], s46 offen offset:1024
    buffer_load_dwordx4 v[164:167], v0, s[8:11], s46 offen offset:2048
    buffer_load_dwordx4 v[168:171], v0, s[8:11], s46 offen offset:3072
    s_add_u32 s46, s51, 16777216
    buffer_load_dwordx4 v[172:175], v0, s[8:11], s46 offen offset:0
    buffer_load_dwordx4 v[176:179], v0, s[8:11], s46 offen offset:1024
    buffer_load_dwordx4 v[180:183], v0, s[8:11], s46 offen offset:2048
    buffer_load_dwordx4 v[184:187], v0, s[8:11], s46 offen offset:3072
    s_add_u32 s46, s51, 16781312
    buffer_load_dwordx4 v[188:191], v0, s[8:11], s46 offen offset:0
    buffer_load_dwordx4 v[192:195], v0, s[8:11], s46 offen offset:1024
    buffer_load_dwordx4 v[196:199], v0, s[8:11], s46 offen offset:2048
    buffer_load_dwordx4 v[200:203], v0, s[8:11], s46 offen offset:3072
    s_add_u32 s46, s51, 33554432
    buffer_load_dwordx4 v[204:207], v0, s[8:11], s46 offen offset:0
    buffer_load_dwordx4 v[208:211], v0, s[8:11], s46 offen offset:1024
    buffer_load_dwordx4 v[212:215], v0, s[8:11], s46 offen offset:2048
    buffer_load_dwordx4 v[216:219], v0, s[8:11], s46 offen offset:3072
    s_add_u32 s46, s51, 33558528
    buffer_load_dwordx4 v[220:223], v0, s[8:11], s46 offen offset:0
    buffer_load_dwordx4 v[224:227], v0, s[8:11], s46 offen offset:1024
    buffer_load_dwordx4 v[228:231], v0, s[8:11], s46 offen offset:2048
    buffer_load_dwordx4 v[232:235], v0, s[8:11], s46 offen offset:3072
Lta0_have:
    s_add_u32 s17, s42, 22528
    buffer_load_dword v15, v1, s[8:11], s17 offen sc1
    buffer_load_dword v2, v11, s[8:11], s42 offen sc1
    s_waitcnt vmcnt(2)
    s_cmp_lg_u32 s49, 0
    s_cselect_b64 exec, 1, 0
    buffer_store_dword v3, v4, s[8:11], s43 offen sc1
    s_mov_b64 exec, -1
    s_add_u32 s43, s43, s49
    s_mov_b32 s49, 0
    v_mfma_f32_16x16x32_bf16 v[32:35], v[172:175], v[140:143], 0
    v_mfma_f32_16x16x32_bf16 v[36:39], v[172:175], v[144:147], 0
    v_mfma_f32_16x16x32_bf16 v[40:43], v[176:179], v[144:147], 0
    v_mfma_f32_16x16x32_bf16 v[32:35], v[180:183], v[148:151], v[32:35]
    v_mfma_f32_16x16x32_bf16 v[36:39], v[180:183], v[152:155], v[36:39]
    v_mfma_f32_16x16x32_bf16 v[40:43], v[184:187], v[152:155], v[40:43]
    v_mfma_f32_16x16x32_bf16 v[32:35], v[188:191], v[156:159], v[32:35]
    v_mfma_f32_16x16x32_bf16 v[36:39], v[188:191], v[160:163], v[36:39]
    v_mfma_f32_16x16x32_bf16 v[40:43], v[192:195], v[160:163], v[40:43]
    v_mfma_f32_16x16x32_bf16 v[32:35], v[196:199], v[164:167], v[32:35]
    v_mfma_f32_16x16x32_bf16 v[36:39], v[196:199], v[168:171], v[36:39]
    v_mfma_f32_16x16x32_bf16 v[40:43], v[200:203], v[168:171], v[40:43]
    s_waitcnt vmcnt(1)
    v_cmp_eq_u32 vcc, 0, v2
    s_nop 0
    s_cbranch_vccz Lta0_r
    s_mov_b32 s16, 0
Lta0_rp:
    buffer_load_dword v2, v11, s[8:11], s42 offen sc1
    s_add_u32 s16, s16, 1
    s_cmp_gt_u32 s16, 100000
    s_cbranch_scc1 L_role_ta_abort
    s_waitcnt vmcnt(0)
    v_cmp_eq_u32 vcc, 0, v2
    s_nop 0
    s_cbranch_vccnz Lta0_rp
Lta0_r:
    buffer_load_dwordx4 v[52:55], v9, s[8:11], s47 offen offset:0
    buffer_load_dwordx4 v[56:59], v9, s[8:11], s47 offen offset:64
    buffer_load_dwordx4 v[60:63], v9, s[8:11], s47 offen offset:128
    buffer_load_dwordx4 v[64:67], v9, s[8:11], s47 offen offset:192
    buffer_load_dwordx2 v[68:69], v10, s[8:11], s47 offen offset:2048
    buffer_load_dwordx2 v[70:71], v10, s[8:11], s47 offen offset:2560
    buffer_load_dwordx2 v[72:73], v10, s[8:11], s47 offen offset:3072
    buffer_load_dwordx2 v[74:75], v10, s[8:11], s47 offen offset:3584
    v_cmp_eq_u32 vcc, 0, v15
    s_add_u32 s51, s51, 262144
    s_add_u32 s42, s42, 22528
    s_add_u32 s47, s47, 131072
    s_add_u32 s37, s37, 1
    s_cmp_eq_u64 vcc, 0
    s_cselect_b32 s39, 1, 0
    s_cmp_lt_u32 s37, 64
    s_cselect_b32 s39, s39, 0
    s_cmp_eq_u32 s39, 1
    s_cselect_b32 s30, 268435456, 0
    v_fma_f32 v32, v32, s52, v236
    v_fma_f32 v33, v33, s52, v237
    v_fma_f32 v34, v34, s52, v238
    v_fma_f32 v35, v35, s52, v239
    s_add_u32 s46, s51, 0
    buffer_load_dwordx4 a[0:3], v0, s[28:31], s46 offen offset:0
    v_mul_f32 v36, s52, v36
    v_mul_f32 v37, s52, v37
    v_mul_f32 v38, s52, v38
    v_mul_f32 v39, s52, v39
    buffer_load_dwordx4 a[4:7], v0, s[28:31], s46 offen offset:1024
    v_fma_f32 v40, v40, s52, v236
    v_fma_f32 v41, v41, s52, v237
    v_fma_f32 v42, v42, s52, v238
    v_fma_f32 v43, v43, s52, v239
    buffer_load_dwordx4 a[8:11], v0, s[28:31], s46 offen offset:2048
    s_waitcnt vmcnt(10)
    v_mfma_f32_16x16x32_bf16 v[44:47], v[52:55], v[140:143], 0
    v_mfma_f32_16x16x32_bf16 v[48:51], v[52:55], v[144:147], 0
    s_waitcnt vmcnt(9)
    v_mfma_f32_16x16x32_bf16 v[44:47], v[56:59], v[148:151], v[44:47]
    v_mfma_f32_16x16x32_bf16 v[48:51], v[56:59], v[152:155], v[48:51]
    s_waitcnt vmcnt(8)
    v_mfma_f32_16x16x32_bf16 v[44:47], v[60:63], v[156:159], v[44:47]
    v_mfma_f32_16x16x32_bf16 v[48:51], v[60:63], v[160:163], v[48:51]
    s_waitcnt vmcnt(7)
    v_mfma_f32_16x16x32_bf16 v[44:47], v[64:67], v[164:167], v[44:47]
    v_mfma_f32_16x16x32_bf16 v[48:51], v[64:67], v[168:171], v[48:51]
    v_max3_f32 v5, v32, v33, v34
    v_max_f32 v5, v5, v35
    s_nop 1
    v_mul_f32 v44, s52, v44
    v_mul_f32 v45, s52, v45
    v_max3_f32 v5, v5, v44, v45
    v_mov_b32 v6, v5
    buffer_load_dwordx4 a[12:15], v0, s[28:31], s46 offen offset:3072
    s_nop 0
    v_permlane32_swap_b32 v5, v6
    v_max_f32 v5, v5, v6
    v_mov_b32 v6, v5
    s_add_u32 s46, s51, 4096
    buffer_load_dwordx4 a[16:19], v0, s[28:31], s46 offen offset:0
    v_permlane16_swap_b32 v5, v6
    v_max_f32 v5, v5, v6
    v_sub_f32 v32, v32, v5
    v_sub_f32 v33, v33, v5
    v_sub_f32 v34, v34, v5
    v_sub_f32 v35, v35, v5
    v_sub_f32 v44, v44, v5
    v_sub_f32 v45, v45, v5
    v_exp_f32 v32, v32
    v_exp_f32 v33, v33
    v_exp_f32 v34, v34
    v_exp_f32 v35, v35
    v_exp_f32 v44, v44
    v_exp_f32 v45, v45
    v_cvt_pk_bf16_f32 v24, v32, v33
    v_cvt_pk_bf16_f32 v25, v34, v35
    v_mov_b32 v26, 0
    v_mov_b32 v27, 0
    v_cvt_pk_bf16_f32 v20, v44, v45
    v_cvt_pk_bf16_f32 v23, v44, v45
    v_mfma_f32_16x16x32_bf16 v[28:31], v[16:19], v[24:27], 0
    v_mfma_f32_16x16x32_bf16 v[76:79], v[204:207], v[24:27], 0
    v_mfma_f32_16x16x32_bf16 v[80:83], v[208:211], v[24:27], 0
    buffer_load_dwordx4 a[20:23], v0, s[28:31], s46 offen offset:1024
    v_mfma_f32_16x16x32_bf16 v[84:87], v[212:215], v[24:27], 0
    v_mfma_f32_16x16x32_bf16 v[88:91], v[216:219], v[24:27], 0
    buffer_load_dwordx4 a[24:27], v0, s[28:31], s46 offen offset:2048
    v_mfma_f32_16x16x32_bf16 v[92:95], v[220:223], v[24:27], 0
    v_mfma_f32_16x16x32_bf16 v[96:99], v[224:227], v[24:27], 0
    buffer_load_dwordx4 a[28:31], v0, s[28:31], s46 offen offset:3072
    v_mfma_f32_16x16x16_bf16 v[28:31], v[16:17], v[20:21], v[28:31]
    v_mfma_f32_16x16x32_bf16 v[100:103], v[228:231], v[24:27], 0
    v_mfma_f32_16x16x32_bf16 v[104:107], v[232:235], v[24:27], 0
    s_add_u32 s46, s51, 16777216
    buffer_load_dwordx4 a[32:35], v0, s[28:31], s46 offen offset:0
    s_waitcnt vmcnt(12)
    v_mfma_f32_16x16x16_bf16 v[76:79], v[68:69], v[20:21], v[76:79]
    v_mfma_f32_16x16x16_bf16 v[80:83], v[68:69], v[22:23], v[80:83]
    v_rcp_f32 v6, v28
    s_waitcnt vmcnt(11)
    v_mfma_f32_16x16x16_bf16 v[84:87], v[70:71], v[20:21], v[84:87]
    v_mfma_f32_16x16x16_bf16 v[88:91], v[70:71], v[22:23], v[88:91]
    v_mul_f32 v76, v6, v76
    v_mul_f32 v80, v6, v80
    v_cvt_pk_bf16_f32 v108, v76, v80
    v_mul_f32 v77, v6, v77
    v_mul_f32 v81, v6, v81
    v_cvt_pk_bf16_f32 v109, v77, v81
    v_mul_f32 v78, v6, v78
    v_mul_f32 v82, v6, v82
    v_cvt_pk_bf16_f32 v110, v78, v82
    v_mul_f32 v79, v6, v79
    v_mul_f32 v83, v6, v83
    v_cvt_pk_bf16_f32 v111, v79, v83
    s_add_u32 s17, s48, 0
    buffer_store_dwordx4 v[108:111], v0, s[8:11], s17 offen offset:0 sc1
    buffer_load_dwordx4 a[36:39], v0, s[28:31], s46 offen offset:1024
    s_waitcnt vmcnt(12)
    v_mfma_f32_16x16x16_bf16 v[92:95], v[72:73], v[20:21], v[92:95]
    v_mfma_f32_16x16x16_bf16 v[96:99], v[72:73], v[22:23], v[96:99]
    v_mul_f32 v84, v6, v84
    v_mul_f32 v88, v6, v88
    v_cvt_pk_bf16_f32 v112, v84, v88
    v_mul_f32 v85, v6, v85
    v_mul_f32 v89, v6, v89
    v_cvt_pk_bf16_f32 v113, v85, v89
    v_mul_f32 v86, v6, v86
    v_mul_f32 v90, v6, v90
    v_cvt_pk_bf16_f32 v114, v86, v90
    v_mul_f32 v87, v6, v87
    v_mul_f32 v91, v6, v91
    v_cvt_pk_bf16_f32 v115, v87, v91
    buffer_store_dwordx4 v[112:115], v0, s[8:11], s17 offen offset:2048 sc1
    buffer_load_dwordx4 a[40:43], v0, s[28:31], s46 offen offset:2048
    s_waitcnt vmcnt(13)
    v_mfma_f32_16x16x16_bf16 v[100:103], v[74:75], v[20:21], v[100:103]
    v_mfma_f32_16x16x16_bf16 v[104:107], v[74:75], v[22:23], v[104:107]
    v_mul_f32 v92, v6, v92
    v_mul_f32 v96, v6, v96
    v_cvt_pk_bf16_f32 v116, v92, v96
    v_mul_f32 v93, v6, v93
    v_mul_f32 v97, v6, v97
    v_cvt_pk_bf16_f32 v117, v93, v97
    v_mul_f32 v94, v6, v94
    v_mul_f32 v98, v6, v98
    v_cvt_pk_bf16_f32 v118, v94, v98
    v_mul_f32 v95, v6, v95
    v_mul_f32 v99, v6, v99
    v_cvt_pk_bf16_f32 v119, v95, v99
    s_add_u32 s17, s48, 4096
    buffer_store_dwordx4 v[116:119], v0, s[8:11], s17 offen offset:0 sc1
    buffer_load_dwordx4 a[44:47], v0, s[28:31], s46 offen offset:3072
    v_mul_f32 v100, v6, v100
    v_mul_f32 v104, v6, v104
    v_cvt_pk_bf16_f32 v120, v100, v104
    v_mul_f32 v101, v6, v101
    v_mul_f32 v105, v6, v105
    v_cvt_pk_bf16_f32 v121, v101, v105
    v_mul_f32 v102, v6, v102
    v_mul_f32 v106, v6, v106
    v_cvt_pk_bf16_f32 v122, v102, v106
    v_mul_f32 v103, v6, v103
    v_mul_f32 v107, v6, v107
    v_cvt_pk_bf16_f32 v123, v103, v107
    buffer_store_dwordx4 v[120:123], v0, s[8:11], s17 offen offset:2048 sc1
    s_add_u32 s46, s51, 16781312
    buffer_load_dwordx4 a[48:51], v0, s[28:31], s46 offen offset:0
    v_max3_f32 v5, v36, v37, v38
    v_max_f32 v5, v5, v39
    v_max3_f32 v5, v5, v40, v41
    v_max3_f32 v5, v5, v42, v43
    v_mul_f32 v48, s52, v48
    v_mul_f32 v49, s52, v49
    v_max3_f32 v5, v5, v48, v49
    v_mov_b32 v6, v5
    buffer_load_dwordx4 a[52:55], v0, s[28:31], s46 offen offset:1024
    s_nop 0
    v_permlane32_swap_b32 v5, v6
    v_max_f32 v5, v5, v6
    v_mov_b32 v6, v5
    buffer_load_dwordx4 a[56:59], v0, s[28:31], s46 offen offset:2048
    s_nop 0
    v_permlane16_swap_b32 v5, v6
    v_max_f32 v5, v5, v6
    v_sub_f32 v36, v36, v5
    v_sub_f32 v37, v37, v5
    v_sub_f32 v38, v38, v5
    v_sub_f32 v39, v39, v5
    v_sub_f32 v40, v40, v5
    v_sub_f32 v41, v41, v5
    v_sub_f32 v42, v42, v5
    v_sub_f32 v43, v43, v5
    v_sub_f32 v48, v48, v5
    v_sub_f32 v49, v49, v5
    v_exp_f32 v36, v36
    v_exp_f32 v37, v37
    v_exp_f32 v38, v38
    v_exp_f32 v39, v39
    v_exp_f32 v40, v40
    v_exp_f32 v41, v41
    v_exp_f32 v42, v42
    v_exp_f32 v43, v43
    v_exp_f32 v48, v48
    v_exp_f32 v49, v49
    v_cvt_pk_bf16_f32 v24, v36, v37
    v_cvt_pk_bf16_f32 v25, v38, v39
    v_cvt_pk_bf16_f32 v26, v40, v41
    v_cvt_pk_bf16_f32 v27, v42, v43
    v_cvt_pk_bf16_f32 v20, v48, v49
    v_cvt_pk_bf16_f32 v23, v48, v49
    v_mfma_f32_16x16x32_bf16 v[28:31], v[16:19], v[24:27], 0
    v_mfma_f32_16x16x32_bf16 v[76:79], v[204:207], v[24:27], 0
    v_mfma_f32_16x16x32_bf16 v[80:83], v[208:211], v[24:27], 0
    buffer_load_dwordx4 a[60:63], v0, s[28:31], s46 offen offset:3072
    v_mfma_f32_16x16x32_bf16 v[84:87], v[212:215], v[24:27], 0
    v_mfma_f32_16x16x32_bf16 v[88:91], v[216:219], v[24:27], 0
    s_add_u32 s46, s51, 33554432
    buffer_load_dwordx4 a[64:67], v0, s[28:31], s46 offen offset:0
    v_mfma_f32_16x16x32_bf16 v[92:95], v[220:223], v[24:27], 0
    v_mfma_f32_16x16x32_bf16 v[96:99], v[224:227], v[24:27], 0
    buffer_load_dwordx4 a[68:71], v0, s[28:31], s46 offen offset:1024
    v_mfma_f32_16x16x16_bf16 v[28:31], v[16:17], v[20:21], v[28:31]
    v_mfma_f32_16x16x32_bf16 v[100:103], v[228:231], v[24:27], 0
    v_mfma_f32_16x16x32_bf16 v[104:107], v[232:235], v[24:27], 0
    buffer_load_dwordx4 a[72:75], v0, s[28:31], s46 offen offset:2048
    v_mfma_f32_16x16x16_bf16 v[76:79], v[68:69], v[20:21], v[76:79]
    v_mfma_f32_16x16x16_bf16 v[80:83], v[68:69], v[22:23], v[80:83]
    v_rcp_f32 v6, v28
    v_mfma_f32_16x16x16_bf16 v[84:87], v[70:71], v[20:21], v[84:87]
    v_mfma_f32_16x16x16_bf16 v[88:91], v[70:71], v[22:23], v[88:91]
    v_mul_f32 v76, v6, v76
    v_mul_f32 v80, v6, v80
    v_cvt_pk_bf16_f32 v124, v76, v80
    v_mul_f32 v77, v6, v77
    v_mul_f32 v81, v6, v81
    v_cvt_pk_bf16_f32 v125, v77, v81
    v_mul_f32 v78, v6, v78
    v_mul_f32 v82, v6, v82
    v_cvt_pk_bf16_f32 v126, v78, v82
    v_mul_f32 v79, v6, v79
    v_mul_f32 v83, v6, v83
    v_cvt_pk_bf16_f32 v127, v79, v83
    s_add_u32 s17, s48, 0
    buffer_store_dwordx4 v[124:127], v0, s[8:11], s17 offen offset:1024 sc1
    buffer_load_dwordx4 a[76:79], v0, s[28:31], s46 offen offset:3072
    v_mfma_f32_16x16x16_bf16 v[92:95], v[72:73], v[20:21], v[92:95]
    v_mfma_f32_16x16x16_bf16 v[96:99], v[72:73], v[22:23], v[96:99]
    v_mul_f32 v84, v6, v84
    v_mul_f32 v88, v6, v88
    v_cvt_pk_bf16_f32 v128, v84, v88
    v_mul_f32 v85, v6, v85
    v_mul_f32 v89, v6, v89
    v_cvt_pk_bf16_f32 v129, v85, v89
    v_mul_f32 v86, v6, v86
    v_mul_f32 v90, v6, v90
    v_cvt_pk_bf16_f32 v130, v86, v90
    v_mul_f32 v87, v6, v87
    v_mul_f32 v91, v6, v91
    v_cvt_pk_bf16_f32 v131, v87, v91
    buffer_store_dwordx4 v[128:131], v0, s[8:11], s17 offen offset:3072 sc1
    s_add_u32 s46, s51, 33558528
    buffer_load_dwordx4 a[80:83], v0, s[28:31], s46 offen offset:0
    v_mfma_f32_16x16x16_bf16 v[100:103], v[74:75], v[20:21], v[100:103]
    v_mfma_f32_16x16x16_bf16 v[104:107], v[74:75], v[22:23], v[104:107]
    v_mul_f32 v92, v6, v92
    v_mul_f32 v96, v6, v96
    v_cvt_pk_bf16_f32 v132, v92, v96
    v_mul_f32 v93, v6, v93
    v_mul_f32 v97, v6, v97
    v_cvt_pk_bf16_f32 v133, v93, v97
    v_mul_f32 v94, v6, v94
    v_mul_f32 v98, v6, v98
    v_cvt_pk_bf16_f32 v134, v94, v98
    v_mul_f32 v95, v6, v95
    v_mul_f32 v99, v6, v99
    v_cvt_pk_bf16_f32 v135, v95, v99
    s_add_u32 s17, s48, 4096
    buffer_store_dwordx4 v[132:135], v0, s[8:11], s17 offen offset:1024 sc1
    buffer_load_dwordx4 a[84:87], v0, s[28:31], s46 offen offset:1024
    v_mul_f32 v100, v6, v100
    v_mul_f32 v104, v6, v104
    v_cvt_pk_bf16_f32 v136, v100, v104
    v_mul_f32 v101, v6, v101
    v_mul_f32 v105, v6, v105
    v_cvt_pk_bf16_f32 v137, v101, v105
    v_mul_f32 v102, v6, v102
    v_mul_f32 v106, v6, v106
    v_cvt_pk_bf16_f32 v138, v102, v106
    v_mul_f32 v103, v6, v103
    v_mul_f32 v107, v6, v107
    v_cvt_pk_bf16_f32 v139, v103, v107
    buffer_store_dwordx4 v[136:139], v0, s[8:11], s17 offen offset:3072 sc1
    buffer_load_dwordx4 a[88:91], v0, s[28:31], s46 offen offset:2048
    buffer_load_dwordx4 a[92:95], v0, s[28:31], s46 offen offset:3072
    s_add_u32 s48, s48, 262144
    s_mov_b32 s49, 22528
    s_cmp_ge_u32 s37, 64
    s_cbranch_scc1 Lta_end
Lta1:
    s_cmp_eq_u32 s39, 1
    s_cbranch_scc1 Lta1_have
    s_waitcnt vmcnt(0)
    s_cmp_lg_u32 s49, 0
    s_cselect_b64 exec, 1, 0
    buffer_store_dword v3, v4, s[8:11], s43 offen sc1
    s_mov_b64 exec, -1
    s_add_u32 s43, s43, s49
    s_mov_b32 s49, 0
    s_mov_b32 s16, 0
Lta1_f_19:
    buffer_load_dword v2, v1, s[8:11], s42 offen sc1
    s_add_u32 s16, s16, 1
    s_cmp_gt_u32 s16, 100000
    s_cbranch_scc1 L_role_ta_abort
    s_waitcnt vmcnt(0)
    v_cmp_eq_u32 vcc, 0, v2
    s_nop 0
    s_cbranch_vccz Lta1_fd_20
    s_sleep 4
    s_branch Lta1_f_19
Lta1_fd_20:
    s_add_u32 s46, s51, 0
    buffer_load_dwordx4 a[0:3], v0, s[8:11], s46 offen offset:0
    buffer_load_dwordx4 a[4:7], v0, s[8:11], s46 offen offset:1024
    buffer_load_dwordx4 a[8:11], v0, s[8:11], s46 offen offset:2048
    buffer_load_dwordx4 a[12:15], v0, s[8:11], s46 offen offset:3072
    s_add_u32 s46, s51, 4096
    buffer_load_dwordx4 a[16:19], v0, s[8:11], s46 offen offset:0
    buffer_load_dwordx4 a[20:23], v0, s[8:11], s46 offen offset:1024
    buffer_load_dwordx4 a[24:27], v0, s[8:11], s46 offen offset:2048
    buffer_load_dwordx4 a[28:31], v0, s[8:11], s46 offen offset:3072
    s_add_u32 s46, s51, 16777216
    buffer_load_dwordx4 a[32:35], v0, s[8:11], s46 offen offset:0
    buffer_load_dwordx4 a[36:39], v0, s[8:11], s46 offen offset:1024
    buffer_load_dwordx4 a[40:43], v0, s[8:11], s46 offen offset:2048
    buffer_load_dwordx4 a[44:47], v0, s[8:11], s46 offen offset:3072
    s_add_u32 s46, s51, 16781312
    buffer_load_dwordx4 a[48:51], v0, s[8:11], s46 offen offset:0
    buffer_load_dwordx4 a[52:55], v0, s[8:11], s46 offen offset:1024
    buffer_load_dwordx4 a[56:59], v0, s[8:11], s46 offen offset:2048
    buffer_load_dwordx4 a[60:63], v0, s[8:11], s46 offen offset:3072
    s_add_u32 s46, s51, 33554432
    buffer_load_dwordx4 a[64:67], v0, s[8:11], s46 offen offset:0
    buffer_load_dwordx4 a[68:71], v0, s[8:11], s46 offen offset:1024
    buffer_load_dwordx4 a[72:75], v0, s[8:11], s46 offen offset:2048
    buffer_load_dwordx4 a[76:79], v0, s[8:11], s46 offen offset:3072
    s_add_u32 s46, s51, 33558528
    buffer_load_dwordx4 a[80:83], v0, s[8:11], s46 offen offset:0
    buffer_load_dwordx4 a[84:87], v0, s[8:11], s46 offen offset:1024
    buffer_load_dwordx4 a[88:91], v0, s[8:11], s46 offen offset:2048
    buffer_load_dwordx4 a[92:95], v0, s[8:11], s46 offen offset:3072
Lta1_have:
    s_add_u32 s17, s42, 22528
    buffer_load_dword v15, v1, s[8:11], s17 offen sc1
    buffer_load_dword v2, v11, s[8:11], s42 offen sc1
    s_waitcnt vmcnt(2)
    s_cmp_lg_u32 s49, 0
    s_cselect_b64 exec, 1, 0
    buffer_store_dword v3, v4, s[8:11], s43 offen sc1
    s_mov_b64 exec, -1
    s_add_u32 s43, s43, s49
    s_mov_b32 s49, 0
    v_mfma_f32_16x16x32_bf16 v[32:35], a[32:35], a[0:3], 0
    v_mfma_f32_16x16x32_bf16 v[36:39], a[32:35], a[4:7], 0
    v_mfma_f32_16x16x32_bf16 v[40:43], a[36:39], a[4:7], 0
    v_mfma_f32_16x16x32_bf16 v[32:35], a[40:43], a[8:11], v[32:35]
    v_mfma_f32_16x16x32_bf16 v[36:39], a[40:43], a[12:15], v[36:39]
    v_mfma_f32_16x16x32_bf16 v[40:43], a[44:47], a[12:15], v[40:43]
    v_mfma_f32_16x16x32_bf16 v[32:35], a[48:51], a[16:19], v[32:35]
    v_mfma_f32_16x16x32_bf16 v[36:39], a[48:51], a[20:23], v[36:39]
    v_mfma_f32_16x16x32_bf16 v[40:43], a[52:55], a[20:23], v[40:43]
    v_mfma_f32_16x16x32_bf16 v[32:35], a[56:59], a[24:27], v[32:35]
    v_mfma_f32_16x16x32_bf16 v[36:39], a[56:59], a[28:31], v[36:39]
    v_mfma_f32_16x16x32_bf16 v[40:43], a[60:63], a[28:31], v[40:43]
    s_waitcnt vmcnt(1)
    v_cmp_eq_u32 vcc, 0, v2
    s_nop 0
    s_cbranch_vccz Lta1_r
    s_mov_b32 s16, 0
Lta1_rp:
    buffer_load_dword v2, v11, s[8:11], s42 offen sc1
    s_add_u32 s16, s16, 1
    s_cmp_gt_u32 s16, 100000
    s_cbranch_scc1 L_role_ta_abort
    s_waitcnt vmcnt(0)
    v_cmp_eq_u32 vcc, 0, v2
    s_nop 0
    s_cbranch_vccnz Lta1_rp
Lta1_r:
    buffer_load_dwordx4 v[52:55], v9, s[8:11], s47 offen offset:0
    buffer_load_dwordx4 v[56:59], v9, s[8:11], s47 offen offset:64
    buffer_load_dwordx4 v[60:63], v9, s[8:11], s47 offen offset:128
    buffer_load_dwordx4 v[64:67], v9, s[8:11], s47 offen offset:192
    buffer_load_dwordx2 v[68:69], v10, s[8:11], s47 offen offset:2048
    buffer_load_dwordx2 v[70:71], v10, s[8:11], s47 offen offset:2560
    buffer_load_dwordx2 v[72:73], v10, s[8:11], s47 offen offset:3072
    buffer_load_dwordx2 v[74:75], v10, s[8:11], s47 offen offset:3584
    v_cmp_eq_u32 vcc, 0, v15
    s_add_u32 s51, s51, 262144
    s_add_u32 s42, s42, 22528
    s_add_u32 s47, s47, 131072
    s_add_u32 s37, s37, 1
    s_cmp_eq_u64 vcc, 0
    s_cselect_b32 s39, 1, 0
    s_cmp_lt_u32 s37, 64
    s_cselect_b32 s39, s39, 0
    s_cmp_eq_u32 s39, 1
    s_cselect_b32 s30, 268435456, 0
    v_fma_f32 v32, v32, s52, v236
    v_fma_f32 v33, v33, s52, v237
    v_fma_f32 v34, v34, s52, v238
    v_fma_f32 v35, v35, s52, v239
    s_add_u32 s46, s51, 0
    buffer_load_dwordx4 v[140:143], v0, s[28:31], s46 offen offset:0
    v_mul_f32 v36, s52, v36
    v_mul_f32 v37, s52, v37
    v_mul_f32 v38, s52, v38
    v_mul_f32 v39, s52, v39
    buffer_load_dwordx4 v[144:147], v0, s[28:31], s46 offen offset:1024
    v_fma_f32 v40, v40, s52, v236
    v_fma_f32 v41, v41, s52, v237
    v_fma_f32 v42, v42, s52, v238
    v_fma_f32 v43, v43, s52, v239
    buffer_load_dwordx4 v[148:151], v0, s[28:31], s46 offen offset:2048
    s_waitcnt vmcnt(10)
    v_mfma_f32_16x16x32_bf16 v[44:47], v[52:55], a[0:3], 0
    v_mfma_f32_16x16x32_bf16 v[48:51], v[52:55], a[4:7], 0
    s_waitcnt vmcnt(9)
    v_mfma_f32_16x16x32_bf16 v[44:47], v[56:59], a[8:11], v[44:47]
    v_mfma_f32_16x16x32_bf16 v[48:51], v[56:59], a[12:15], v[48:51]
    s_waitcnt vmcnt(8)
    v_mfma_f32_16x16x32_bf16 v[44:47], v[60:63], a[16:19], v[44:47]
    v_mfma_f32_16x16x32_bf16 v[48:51], v[60:63], a[20:23], v[48:51]
    s_waitcnt vmcnt(7)
    v_mfma_f32_16x16x32_bf16 v[44:47], v[64:67], a[24:27], v[44:47]
    v_mfma_f32_16x16x32_bf16 v[48:51], v[64:67], a[28:31], v[48:51]
    v_max3_f32 v5, v32, v33, v34
    v_max_f32 v5, v5, v35
    s_nop 1
    v_mul_f32 v44, s52, v44
    v_mul_f32 v45, s52, v45
    v_max3_f32 v5, v5, v44, v45
    v_mov_b32 v6, v5
    buffer_load_dwordx4 v[152:155], v0, s[28:31], s46 offen offset:3072
    s_nop 0
    v_permlane32_swap_b32 v5, v6
    v_max_f32 v5, v5, v6
    v_mov_b32 v6, v5
    s_add_u32 s46, s51, 4096
    buffer_load_dwordx4 v[156:159], v0, s[28:31], s46 offen offset:0
    v_permlane16_swap_b32 v5, v6
    v_max_f32 v5, v5, v6
    v_sub_f32 v32, v32, v5
    v_sub_f32 v33, v33, v5
    v_sub_f32 v34, v34, v5
    v_sub_f32 v35, v35, v5
    v_sub_f32 v44, v44, v5
    v_sub_f32 v45, v45, v5
    v_exp_f32 v32, v32
    v_exp_f32 v33, v33
    v_exp_f32 v34, v34
    v_exp_f32 v35, v35
    v_exp_f32 v44, v44
    v_exp_f32 v45, v45
    v_cvt_pk_bf16_f32 v24, v32, v33
    v_cvt_pk_bf16_f32 v25, v34, v35
    v_mov_b32 v26, 0
    v_mov_b32 v27, 0
    v_cvt_pk_bf16_f32 v20, v44, v45
    v_cvt_pk_bf16_f32 v23, v44, v45
    v_mfma_f32_16x16x32_bf16 v[28:31], v[16:19], v[24:27], 0
    v_mfma_f32_16x16x32_bf16 v[76:79], a[64:67], v[24:27], 0
    v_mfma_f32_16x16x32_bf16 v[80:83], a[68:71], v[24:27], 0
    buffer_load_dwordx4 v[160:163], v0, s[28:31], s46 offen offset:1024
    v_mfma_f32_16x16x32_bf16 v[84:87], a[72:75], v[24:27], 0
    v_mfma_f32_16x16x32_bf16 v[88:91], a[76:79], v[24:27], 0
    buffer_load_dwordx4 v[164:167], v0, s[28:31], s46 offen offset:2048
    v_mfma_f32_16x16x32_bf16 v[92:95], a[80:83], v[24:27], 0
    v_mfma_f32_16x16x32_bf16 v[96:99], a[84:87], v[24:27], 0
    buffer_load_dwordx4 v[168:171], v0, s[28:31], s46 offen offset:3072
    v_mfma_f32_16x16x16_bf16 v[28:31], v[16:17], v[20:21], v[28:31]
    v_mfma_f32_16x16x32_bf16 v[100:103], a[88:91], v[24:27], 0
    v_mfma_f32_16x16x32_bf16 v[104:107], a[92:95], v[24:27], 0
    s_add_u32 s46, s51, 16777216
    buffer_load_dwordx4 v[172:175], v0, s[28:31], s46 offen offset:0
    s_waitcnt vmcnt(12)
    v_mfma_f32_16x16x16_bf16 v[76:79], v[68:69], v[20:21], v[76:79]
    v_mfma_f32_16x16x16_bf16 v[80:83], v[68:69], v[22:23], v[80:83]
    v_rcp_f32 v6, v28
    s_waitcnt vmcnt(11)
    v_mfma_f32_16x16x16_bf16 v[84:87], v[70:71], v[20:21], v[84:87]
    v_mfma_f32_16x16x16_bf16 v[88:91], v[70:71], v[22:23], v[88:91]
    v_mul_f32 v76, v6, v76
    v_mul_f32 v80, v6, v80
    v_cvt_pk_bf16_f32 v108, v76, v80
    v_mul_f32 v77, v6, v77
    v_mul_f32 v81, v6, v81
    v_cvt_pk_bf16_f32 v109, v77, v81
    v_mul_f32 v78, v6, v78
    v_mul_f32 v82, v6, v82
    v_cvt_pk_bf16_f32 v110, v78, v82
    v_mul_f32 v79, v6, v79
    v_mul_f32 v83, v6, v83
    v_cvt_pk_bf16_f32 v111, v79, v83
    s_add_u32 s17, s48, 0
    buffer_store_dwordx4 v[108:111], v0, s[8:11], s17 offen offset:0 sc1
    buffer_load_dwordx4 v[176:179], v0, s[28:31], s46 offen offset:1024
    s_waitcnt vmcnt(12)
    v_mfma_f32_16x16x16_bf16 v[92:95], v[72:73], v[20:21], v[92:95]
    v_mfma_f32_16x16x16_bf16 v[96:99], v[72:73], v[22:23], v[96:99]
    v_mul_f32 v84, v6, v84
    v_mul_f32 v88, v6, v88
    v_cvt_pk_bf16_f32 v112, v84, v88
    v_mul_f32 v85, v6, v85
    v_mul_f32 v89, v6, v89
    v_cvt_pk_bf16_f32 v113, v85, v89
    v_mul_f32 v86, v6, v86
    v_mul_f32 v90, v6, v90
    v_cvt_pk_bf16_f32 v114, v86, v90
    v_mul_f32 v87, v6, v87
    v_mul_f32 v91, v6, v91
    v_cvt_pk_bf16_f32 v115, v87, v91
    buffer_store_dwordx4 v[112:115], v0, s[8:11], s17 offen offset:2048 sc1
    buffer_load_dwordx4 v[180:183], v0, s[28:31], s46 offen offset:2048
    s_waitcnt vmcnt(13)
    v_mfma_f32_16x16x16_bf16 v[100:103], v[74:75], v[20:21], v[100:103]
    v_mfma_f32_16x16x16_bf16 v[104:107], v[74:75], v[22:23], v[104:107]
    v_mul_f32 v92, v6, v92
    v_mul_f32 v96, v6, v96
    v_cvt_pk_bf16_f32 v116, v92, v96
    v_mul_f32 v93, v6, v93
    v_mul_f32 v97, v6, v97
    v_cvt_pk_bf16_f32 v117, v93, v97
    v_mul_f32 v94, v6, v94
    v_mul_f32 v98, v6, v98
    v_cvt_pk_bf16_f32 v118, v94, v98
    v_mul_f32 v95, v6, v95
    v_mul_f32 v99, v6, v99
    v_cvt_pk_bf16_f32 v119, v95, v99
    s_add_u32 s17, s48, 4096
    buffer_store_dwordx4 v[116:119], v0, s[8:11], s17 offen offset:0 sc1
    buffer_load_dwordx4 v[184:187], v0, s[28:31], s46 offen offset:3072
    v_mul_f32 v100, v6, v100
    v_mul_f32 v104, v6, v104
    v_cvt_pk_bf16_f32 v120, v100, v104
    v_mul_f32 v101, v6, v101
    v_mul_f32 v105, v6, v105
    v_cvt_pk_bf16_f32 v121, v101, v105
    v_mul_f32 v102, v6, v102
    v_mul_f32 v106, v6, v106
    v_cvt_pk_bf16_f32 v122, v102, v106
    v_mul_f32 v103, v6, v103
    v_mul_f32 v107, v6, v107
    v_cvt_pk_bf16_f32 v123, v103, v107
    buffer_store_dwordx4 v[120:123], v0, s[8:11], s17 offen offset:2048 sc1
    s_add_u32 s46, s51, 16781312
    buffer_load_dwordx4 v[188:191], v0, s[28:31], s46 offen offset:0
    v_max3_f32 v5, v36, v37, v38
    v_max_f32 v5, v5, v39
    v_max3_f32 v5, v5, v40, v41
    v_max3_f32 v5, v5, v42, v43
    v_mul_f32 v48, s52, v48
    v_mul_f32 v49, s52, v49
    v_max3_f32 v5, v5, v48, v49
    v_mov_b32 v6, v5
    buffer_load_dwordx4 v[192:195], v0, s[28:31], s46 offen offset:1024
    s_nop 0
    v_permlane32_swap_b32 v5, v6
    v_max_f32 v5, v5, v6
    v_mov_b32 v6, v5
    buffer_load_dwordx4 v[196:199], v0, s[28:31], s46 offen offset:2048
    s_nop 0
    v_permlane16_swap_b32 v5, v6
    v_max_f32 v5, v5, v6
    v_sub_f32 v36, v36, v5
    v_sub_f32 v37, v37, v5
    v_sub_f32 v38, v38, v5
    v_sub_f32 v39, v39, v5
    v_sub_f32 v40, v40, v5
    v_sub_f32 v41, v41, v5
    v_sub_f32 v42, v42, v5
    v_sub_f32 v43, v43, v5
    v_sub_f32 v48, v48, v5
    v_sub_f32 v49, v49, v5
    v_exp_f32 v36, v36
    v_exp_f32 v37, v37
    v_exp_f32 v38, v38
    v_exp_f32 v39, v39
    v_exp_f32 v40, v40
    v_exp_f32 v41, v41
    v_exp_f32 v42, v42
    v_exp_f32 v43, v43
    v_exp_f32 v48, v48
    v_exp_f32 v49, v49
    v_cvt_pk_bf16_f32 v24, v36, v37
    v_cvt_pk_bf16_f32 v25, v38, v39
    v_cvt_pk_bf16_f32 v26, v40, v41
    v_cvt_pk_bf16_f32 v27, v42, v43
    v_cvt_pk_bf16_f32 v20, v48, v49
    v_cvt_pk_bf16_f32 v23, v48, v49
    v_mfma_f32_16x16x32_bf16 v[28:31], v[16:19], v[24:27], 0
    v_mfma_f32_16x16x32_bf16 v[76:79], a[64:67], v[24:27], 0
    v_mfma_f32_16x16x32_bf16 v[80:83], a[68:71], v[24:27], 0
    buffer_load_dwordx4 v[200:203], v0, s[28:31], s46 offen offset:3072
    v_mfma_f32_16x16x32_bf16 v[84:87], a[72:75], v[24:27], 0
    v_mfma_f32_16x16x32_bf16 v[88:91], a[76:79], v[24:27], 0
    s_add_u32 s46, s51, 33554432
    buffer_load_dwordx4 v[204:207], v0, s[28:31], s46 offen offset:0
    v_mfma_f32_16x16x32_bf16 v[92:95], a[80:83], v[24:27], 0
    v_mfma_f32_16x16x32_bf16 v[96:99], a[84:87], v[24:27], 0
    buffer_load_dwordx4 v[208:211], v0, s[28:31], s46 offen offset:1024
    v_mfma_f32_16x16x16_bf16 v[28:31], v[16:17], v[20:21], v[28:31]
    v_mfma_f32_16x16x32_bf16 v[100:103], a[88:91], v[24:27], 0
    v_mfma_f32_16x16x32_bf16 v[104:107], a[92:95], v[24:27], 0
    buffer_load_dwordx4 v[212:215], v0, s[28:31], s46 offen offset:2048
    v_mfma_f32_16x16x16_bf16 v[76:79], v[68:69], v[20:21], v[76:79]
    v_mfma_f32_16x16x16_bf16 v[80:83], v[68:69], v[22:23], v[80:83]
    v_rcp_f32 v6, v28
    v_mfma_f32_16x16x16_bf16 v[84:87], v[70:71], v[20:21], v[84:87]
    v_mfma_f32_16x16x16_bf16 v[88:91], v[70:71], v[22:23], v[88:91]
    v_mul_f32 v76, v6, v76
    v_mul_f32 v80, v6, v80
    v_cvt_pk_bf16_f32 v124, v76, v80
    v_mul_f32 v77, v6, v77
    v_mul_f32 v81, v6, v81
    v_cvt_pk_bf16_f32 v125, v77, v81
    v_mul_f32 v78, v6, v78
    v_mul_f32 v82, v6, v82
    v_cvt_pk_bf16_f32 v126, v78, v82
    v_mul_f32 v79, v6, v79
    v_mul_f32 v83, v6, v83
    v_cvt_pk_bf16_f32 v127, v79, v83
    s_add_u32 s17, s48, 0
    buffer_store_dwordx4 v[124:127], v0, s[8:11], s17 offen offset:1024 sc1
    buffer_load_dwordx4 v[216:219], v0, s[28:31], s46 offen offset:3072
    v_mfma_f32_16x16x16_bf16 v[92:95], v[72:73], v[20:21], v[92:95]
    v_mfma_f32_16x16x16_bf16 v[96:99], v[72:73], v[22:23], v[96:99]
    v_mul_f32 v84, v6, v84
    v_mul_f32 v88, v6, v88
    v_cvt_pk_bf16_f32 v128, v84, v88
    v_mul_f32 v85, v6, v85
    v_mul_f32 v89, v6, v89
    v_cvt_pk_bf16_f32 v129, v85, v89
    v_mul_f32 v86, v6, v86
    v_mul_f32 v90, v6, v90
    v_cvt_pk_bf16_f32 v130, v86, v90
    v_mul_f32 v87, v6, v87
    v_mul_f32 v91, v6, v91
    v_cvt_pk_bf16_f32 v131, v87, v91
    buffer_store_dwordx4 v[128:131], v0, s[8:11], s17 offen offset:3072 sc1
    s_add_u32 s46, s51, 33558528
    buffer_load_dwordx4 v[220:223], v0, s[28:31], s46 offen offset:0
    v_mfma_f32_16x16x16_bf16 v[100:103], v[74:75], v[20:21], v[100:103]
    v_mfma_f32_16x16x16_bf16 v[104:107], v[74:75], v[22:23], v[104:107]
    v_mul_f32 v92, v6, v92
    v_mul_f32 v96, v6, v96
    v_cvt_pk_bf16_f32 v132, v92, v96
    v_mul_f32 v93, v6, v93
    v_mul_f32 v97, v6, v97
    v_cvt_pk_bf16_f32 v133, v93, v97
    v_mul_f32 v94, v6, v94
    v_mul_f32 v98, v6, v98
    v_cvt_pk_bf16_f32 v134, v94, v98
    v_mul_f32 v95, v6, v95
    v_mul_f32 v99, v6, v99
    v_cvt_pk_bf16_f32 v135, v95, v99
    s_add_u32 s17, s48, 4096
    buffer_store_dwordx4 v[132:135], v0, s[8:11], s17 offen offset:1024 sc1
    buffer_load_dwordx4 v[224:227], v0, s[28:31], s46 offen offset:1024
    v_mul_f32 v100, v6, v100
    v_mul_f32 v104, v6, v104
    v_cvt_pk_bf16_f32 v136, v100, v104
    v_mul_f32 v101, v6, v101
    v_mul_f32 v105, v6, v105
    v_cvt_pk_bf16_f32 v137, v101, v105
    v_mul_f32 v102, v6, v102
    v_mul_f32 v106, v6, v106
    v_cvt_pk_bf16_f32 v138, v102, v106
    v_mul_f32 v103, v6, v103
    v_mul_f32 v107, v6, v107
    v_cvt_pk_bf16_f32 v139, v103, v107
    buffer_store_dwordx4 v[136:139], v0, s[8:11], s17 offen offset:3072 sc1
    buffer_load_dwordx4 v[228:231], v0, s[28:31], s46 offen offset:2048
    buffer_load_dwordx4 v[232:235], v0, s[28:31], s46 offen offset:3072
    s_add_u32 s48, s48, 262144
    s_mov_b32 s49, 22528
    s_cmp_ge_u32 s37, 64
    s_cbranch_scc1 Lta_end
    s_branch Lta0
Lta_end:
    s_waitcnt vmcnt(0)
    s_mov_b64 exec, 1
    buffer_store_dword v3, v4, s[8:11], s43 offen sc1
    s_mov_b64 exec, -1
    s_branch L_role_ta_exit
L_role_ta_abort:
    s_waitcnt lgkmcnt(0)
    s_mov_b64 exec, -1
    v_mov_b32 v0, 60
    s_lshl_b32 s5, s3, 8
    s_or_b32 s5, s5, s4
    s_or_b32 s5, s5, 0x10000
    v_mov_b32 v1, s5
    global_store_dword v0, v1, s[12:13]
    s_endpgm
L_role_ta_exit:
    s_endpgm
.p2align 6
L_role_tw:
    v_and_b32 v5, 63, v0
    v_lshlrev_b32 v0, 4, v5
    v_and_b32 v7, 15, v5
    v_lshrrev_b32 v8, 4, v5
    v_min_u32 v1, 31, v5
    v_lshrrev_b32 v6, 2, v1
    v_and_b32 v1, 3, v1
    v_lshlrev_b32 v1, 2, v1
    v_lshl_add_u32 v1, v6, 7, v1
    v_mov_b32 v3, 1
    v_mov_b32 v4, 0
    s_mov_b32 s44, 0x05040100
    s_mov_b32 s45, 0x07060302
    s_load_dwordx2 s[20:21], s[0:1], 64
    s_mov_b32 s22, 4718592
    s_mov_b32 s23, 0x00020000
    s_waitcnt lgkmcnt(0)
    s_and_b32 s21, s21, 0xffff
    s_load_dwordx2 s[24:25], s[0:1], 80
    s_mov_b32 s26, 2359296
    s_mov_b32 s27, 0x00020000
    s_waitcnt lgkmcnt(0)
    s_and_b32 s25, s25, 0xffff
    s_mul_i32 s17, s15, 43
    s_lshr_b32 s32, s17, 9
    s_mul_i32 s17, s32, 12
    s_sub_u32 s50, s15, s17
    s_add_u32 s33, s32, 30
    s_cmp_eq_u32 s32, 2
    s_cselect_b32 s33, 0, s33
    s_cselect_b32 s32, 64, s32
    s_mul_i32 s49, s50, 96
    s_mul_i32 s17, s14, 1179648
    s_add_u32 s49, s49, s17
    v_mul_u32_u24 v5, 4608, v8
    v_lshl_add_u32 v9, v7, 2, v5
    v_add_u32 v10, 18432, v9
    v_and_b32 v6, 14, v7
    v_lshl_add_u32 v12, v6, 1, v5
    v_add_u32 v12, 64, v12
    v_add_u32 v13, 18432, v12
    v_and_b32 v5, 1, v7
    v_mov_b32 v11, s44
    v_mov_b32 v6, s45
    v_cmp_eq_u32 vcc, 1, v5
    s_nop 1
    v_cndmask_b32 v11, v11, v6, vcc
    s_add_u32 s17, s49, 0
    buffer_load_dword v16, v9, s[20:23], s17 offen
    buffer_load_dword v17, v10, s[20:23], s17 offen
    buffer_load_dword v18, v12, s[20:23], s17 offen
    buffer_load_dword v19, v13, s[20:23], s17 offen
    s_add_u32 s17, s49, 1152
    buffer_load_dword v20, v9, s[20:23], s17 offen
    buffer_load_dword v21, v10, s[20:23], s17 offen
    buffer_load_dword v22, v12, s[20:23], s17 offen
    buffer_load_dword v23, v13, s[20:23], s17 offen
    s_add_u32 s17, s49, 2304
    buffer_load_dword v24, v9, s[20:23], s17 offen
    buffer_load_dword v25, v10, s[20:23], s17 offen
    buffer_load_dword v26, v12, s[20:23], s17 offen
    buffer_load_dword v27, v13, s[20:23], s17 offen
    s_add_u32 s17, s49, 3456
    buffer_load_dword v28, v9, s[20:23], s17 offen
    buffer_load_dword v29, v10, s[20:23], s17 offen
    buffer_load_dword v30, v12, s[20:23], s17 offen
    buffer_load_dword v31, v13, s[20:23], s17 offen
    s_add_u32 s17, s49, 36864
    buffer_load_dword v32, v9, s[20:23], s17 offen
    buffer_load_dword v33, v10, s[20:23], s17 offen
    buffer_load_dword v34, v12, s[20:23], s17 offen
    buffer_load_dword v35, v13, s[20:23], s17 offen
    s_add_u32 s17, s49, 38016
    buffer_load_dword v36, v9, s[20:23], s17 offen
    buffer_load_dword v37, v10, s[20:23], s17 offen
    buffer_load_dword v38, v12, s[20:23], s17 offen
    buffer_load_dword v39, v13, s[20:23], s17 offen
    s_add_u32 s17, s49, 39168
    buffer_load_dword v40, v9, s[20:23], s17 offen
    buffer_load_dword v41, v10, s[20:23], s17 offen
    buffer_load_dword v42, v12, s[20:23], s17 offen
    buffer_load_dword v43, v13, s[20:23], s17 offen
    s_add_u32 s17, s49, 40320
    buffer_load_dword v44, v9, s[20:23], s17 offen
    buffer_load_dword v45, v10, s[20:23], s17 offen
    buffer_load_dword v46, v12, s[20:23], s17 offen
    buffer_load_dword v47, v13, s[20:23], s17 offen
    s_add_u32 s17, s49, 73728
    buffer_load_dword v48, v9, s[20:23], s17 offen
    buffer_load_dword v49, v10, s[20:23], s17 offen
    buffer_load_dword v50, v12, s[20:23], s17 offen
    buffer_load_dword v51, v13, s[20:23], s17 offen
    s_add_u32 s17, s49, 74880
    buffer_load_dword v52, v9, s[20:23], s17 offen
    buffer_load_dword v53, v10, s[20:23], s17 offen
    buffer_load_dword v54, v12, s[20:23], s17 offen
    buffer_load_dword v55, v13, s[20:23], s17 offen
    s_add_u32 s17, s49, 76032
    buffer_load_dword v56, v9, s[20:23], s17 offen
    buffer_load_dword v57, v10, s[20:23], s17 offen
    buffer_load_dword v58, v12, s[20:23], s17 offen
    buffer_load_dword v59, v13, s[20:23], s17 offen
    s_add_u32 s17, s49, 77184
    buffer_load_dword v60, v9, s[20:23], s17 offen
    buffer_load_dword v61, v10, s[20:23], s17 offen
    buffer_load_dword v62, v12, s[20:23], s17 offen
    buffer_load_dword v63, v13, s[20:23], s17 offen
    s_add_u32 s17, s49, 110592
    buffer_load_dword v64, v9, s[20:23], s17 offen
    buffer_load_dword v65, v10, s[20:23], s17 offen
    buffer_load_dword v66, v12, s[20:23], s17 offen
    buffer_load_dword v67, v13, s[20:23], s17 offen
    s_add_u32 s17, s49, 111744
    buffer_load_dword v68, v9, s[20:23], s17 offen
    buffer_load_dword v69, v10, s[20:23], s17 offen
    buffer_load_dword v70, v12, s[20:23], s17 offen
    buffer_load_dword v71, v13, s[20:23], s17 offen
    s_add_u32 s17, s49, 112896
    buffer_load_dword v72, v9, s[20:23], s17 offen
    buffer_load_dword v73, v10, s[20:23], s17 offen
    buffer_load_dword v74, v12, s[20:23], s17 offen
    buffer_load_dword v75, v13, s[20:23], s17 offen
    s_waitcnt vmcnt(58)
    v_perm_b32 v5, v17, v16, s44
    v_perm_b32 v6, v17, v16, s45
    s_waitcnt vmcnt(56)
    v_perm_b32 v128, v19, v18, v11
    v_accvgpr_write_b32 a0, v5
    v_accvgpr_write_b32 a4, v6
    s_add_u32 s17, s49, 114048
    buffer_load_dword v76, v9, s[20:23], s17 offen
    buffer_load_dword v77, v10, s[20:23], s17 offen
    buffer_load_dword v78, v12, s[20:23], s17 offen
    buffer_load_dword v79, v13, s[20:23], s17 offen
    s_waitcnt vmcnt(58)
    v_perm_b32 v5, v21, v20, s44
    v_perm_b32 v6, v21, v20, s45
    s_waitcnt vmcnt(56)
    v_perm_b32 v129, v23, v22, v11
    v_accvgpr_write_b32 a1, v5
    v_accvgpr_write_b32 a5, v6
    s_add_u32 s17, s49, 147456
    buffer_load_dword v80, v9, s[20:23], s17 offen
    buffer_load_dword v81, v10, s[20:23], s17 offen
    buffer_load_dword v82, v12, s[20:23], s17 offen
    buffer_load_dword v83, v13, s[20:23], s17 offen
    s_waitcnt vmcnt(58)
    v_perm_b32 v5, v25, v24, s44
    v_perm_b32 v6, v25, v24, s45
    s_waitcnt vmcnt(56)
    v_perm_b32 v130, v27, v26, v11
    v_accvgpr_write_b32 a2, v5
    v_accvgpr_write_b32 a6, v6
    s_add_u32 s17, s49, 148608
    buffer_load_dword v84, v9, s[20:23], s17 offen
    buffer_load_dword v85, v10, s[20:23], s17 offen
    buffer_load_dword v86, v12, s[20:23], s17 offen
    buffer_load_dword v87, v13, s[20:23], s17 offen
    s_waitcnt vmcnt(58)
    v_perm_b32 v5, v29, v28, s44
    v_perm_b32 v6, v29, v28, s45
    s_waitcnt vmcnt(56)
    v_perm_b32 v131, v31, v30, v11
    v_accvgpr_write_b32 a3, v5
    v_accvgpr_write_b32 a7, v6
    s_add_u32 s17, s49, 149760
    buffer_load_dword v88, v9, s[20:23], s17 offen
    buffer_load_dword v89, v10, s[20:23], s17 offen
    buffer_load_dword v90, v12, s[20:23], s17 offen
    buffer_load_dword v91, v13, s[20:23], s17 offen
    s_waitcnt vmcnt(58)
    v_perm_b32 v5, v33, v32, s44
    v_perm_b32 v6, v33, v32, s45
    s_waitcnt vmcnt(56)
    v_perm_b32 v132, v35, v34, v11
    v_accvgpr_write_b32 a8, v5
    v_accvgpr_write_b32 a12, v6
    s_add_u32 s17, s49, 150912
    buffer_load_dword v92, v9, s[20:23], s17 offen
    buffer_load_dword v93, v10, s[20:23], s17 offen
    buffer_load_dword v94, v12, s[20:23], s17 offen
    buffer_load_dword v95, v13, s[20:23], s17 offen
    s_waitcnt vmcnt(58)
    v_perm_b32 v5, v37, v36, s44
    v_perm_b32 v6, v37, v36, s45
    s_waitcnt vmcnt(56)
    v_perm_b32 v133, v39, v38, v11
    v_accvgpr_write_b32 a9, v5
    v_accvgpr_write_b32 a13, v6
    s_add_u32 s17, s49, 184320
    buffer_load_dword v96, v9, s[20:23], s17 offen
    buffer_load_dword v97, v10, s[20:23], s17 offen
    buffer_load_dword v98, v12, s[20:23], s17 offen
    buffer_load_dword v99, v13, s[20:23], s17 offen
    s_waitcnt vmcnt(58)
    v_perm_b32 v5, v41, v40, s44
    v_perm_b32 v6, v41, v40, s45
    s_waitcnt vmcnt(56)
    v_perm_b32 v134, v43, v42, v11
    v_accvgpr_write_b32 a10, v5
    v_accvgpr_write_b32 a14, v6
    s_add_u32 s17, s49, 185472
    buffer_load_dword v100, v9, s[20:23], s17 offen
    buffer_load_dword v101, v10, s[20:23], s17 offen
    buffer_load_dword v102, v12, s[20:23], s17 offen
    buffer_load_dword v103, v13, s[20:23], s17 offen
    s_waitcnt vmcnt(58)
    v_perm_b32 v5, v45, v44, s44
    v_perm_b32 v6, v45, v44, s45
    s_waitcnt vmcnt(56)
    v_perm_b32 v135, v47, v46, v11
    v_accvgpr_write_b32 a11, v5
    v_accvgpr_write_b32 a15, v6
    s_add_u32 s17, s49, 186624
    buffer_load_dword v104, v9, s[20:23], s17 offen
    buffer_load_dword v105, v10, s[20:23], s17 offen
    buffer_load_dword v106, v12, s[20:23], s17 offen
    buffer_load_dword v107, v13, s[20:23], s17 offen
    s_waitcnt vmcnt(58)
    v_perm_b32 v5, v49, v48, s44
    v_perm_b32 v6, v49, v48, s45
    s_waitcnt vmcnt(56)
    v_perm_b32 v136, v51, v50, v11
    v_accvgpr_write_b32 a16, v5
    v_accvgpr_write_b32 a20, v6
    s_add_u32 s17, s49, 187776
    buffer_load_dword v108, v9, s[20:23], s17 offen
    buffer_load_dword v109, v10, s[20:23], s17 offen
    buffer_load_dword v110, v12, s[20:23], s17 offen
    buffer_load_dword v111, v13, s[20:23], s17 offen
    s_waitcnt vmcnt(58)
    v_perm_b32 v5, v53, v52, s44
    v_perm_b32 v6, v53, v52, s45
    s_waitcnt vmcnt(56)
    v_perm_b32 v137, v55, v54, v11
    v_accvgpr_write_b32 a17, v5
    v_accvgpr_write_b32 a21, v6
    s_add_u32 s17, s49, 221184
    buffer_load_dword v112, v9, s[20:23], s17 offen
    buffer_load_dword v113, v10, s[20:23], s17 offen
    buffer_load_dword v114, v12, s[20:23], s17 offen
    buffer_load_dword v115, v13, s[20:23], s17 offen
    s_waitcnt vmcnt(58)
    v_perm_b32 v5, v57, v56, s44
    v_perm_b32 v6, v57, v56, s45
    s_waitcnt vmcnt(56)
    v_perm_b32 v138, v59, v58, v11
    v_accvgpr_write_b32 a18, v5
    v_accvgpr_write_b32 a22, v6
    s_add_u32 s17, s49, 222336
    buffer_load_dword v116, v9, s[20:23], s17 offen
    buffer_load_dword v117, v10, s[20:23], s17 offen
    buffer_load_dword v118, v12, s[20:23], s17 offen
    buffer_load_dword v119, v13, s[20:23], s17 offen
    s_waitcnt vmcnt(58)
    v_perm_b32 v5, v61, v60, s44
    v_perm_b32 v6, v61, v60, s45
    s_waitcnt vmcnt(56)
    v_perm_b32 v139, v63, v62, v11
    v_accvgpr_write_b32 a19, v5
    v_accvgpr_write_b32 a23, v6
    s_add_u32 s17, s49, 223488
    buffer_load_dword v120, v9, s[20:23], s17 offen
    buffer_load_dword v121, v10, s[20:23], s17 offen
    buffer_load_dword v122, v12, s[20:23], s17 offen
    buffer_load_dword v123, v13, s[20:23], s17 offen
    s_waitcnt vmcnt(58)
    v_perm_b32 v5, v65, v64, s44
    v_perm_b32 v6, v65, v64, s45
    s_waitcnt vmcnt(56)
    v_perm_b32 v140, v67, v66, v11
    v_accvgpr_write_b32 a24, v5
    v_accvgpr_write_b32 a28, v6
    s_add_u32 s17, s49, 224640
    buffer_load_dword v124, v9, s[20:23], s17 offen
    buffer_load_dword v125, v10, s[20:23], s17 offen
    buffer_load_dword v126, v12, s[20:23], s17 offen
    buffer_load_dword v127, v13, s[20:23], s17 offen
    s_waitcnt vmcnt(58)
    v_perm_b32 v5, v69, v68, s44
    v_perm_b32 v6, v69, v68, s45
    s_waitcnt vmcnt(56)
    v_perm_b32 v141, v71, v70, v11
    v_accvgpr_write_b32 a25, v5
    v_accvgpr_write_b32 a29, v6
    s_add_u32 s17, s49, 258048
    buffer_load_dword v16, v9, s[20:23], s17 offen
    buffer_load_dword v17, v10, s[20:23], s17 offen
    buffer_load_dword v18, v12, s[20:23], s17 offen
    buffer_load_dword v19, v13, s[20:23], s17 offen
    s_waitcnt vmcnt(58)
    v_perm_b32 v5, v73, v72, s44
    v_perm_b32 v6, v73, v72, s45
    s_waitcnt vmcnt(56)
    v_perm_b32 v142, v75, v74, v11
    v_accvgpr_write_b32 a26, v5
    v_accvgpr_write_b32 a30, v6
    s_add_u32 s17, s49, 259200
    buffer_load_dword v20, v9, s[20:23], s17 offen
    buffer_load_dword v21, v10, s[20:23], s17 offen
    buffer_load_dword v22, v12, s[20:23], s17 offen
    buffer_load_dword v23, v13, s[20:23], s17 offen
    s_waitcnt vmcnt(58)
    v_perm_b32 v5, v77, v76, s44
    v_perm_b32 v6, v77, v76, s45
    s_waitcnt vmcnt(56)
    v_perm_b32 v143, v79, v78, v11
    v_accvgpr_write_b32 a27, v5
    v_accvgpr_write_b32 a31, v6
    s_add_u32 s17, s49, 260352
    buffer_load_dword v24, v9, s[20:23], s17 offen
    buffer_load_dword v25, v10, s[20:23], s17 offen
    buffer_load_dword v26, v12, s[20:23], s17 offen
    buffer_load_dword v27, v13, s[20:23], s17 offen
    s_waitcnt vmcnt(58)
    v_perm_b32 v5, v81, v80, s44
    v_perm_b32 v6, v81, v80, s45
    s_waitcnt vmcnt(56)
    v_perm_b32 v144, v83, v82, v11
    v_accvgpr_write_b32 a32, v5
    v_accvgpr_write_b32 a36, v6
    s_add_u32 s17, s49, 261504
    buffer_load_dword v28, v9, s[20:23], s17 offen
    buffer_load_dword v29, v10, s[20:23], s17 offen
    buffer_load_dword v30, v12, s[20:23], s17 offen
    buffer_load_dword v31, v13, s[20:23], s17 offen
    s_waitcnt vmcnt(58)
    v_perm_b32 v5, v85, v84, s44
    v_perm_b32 v6, v85, v84, s45
    s_waitcnt vmcnt(56)
    v_perm_b32 v145, v87, v86, v11
    v_accvgpr_write_b32 a33, v5
    v_accvgpr_write_b32 a37, v6
    s_add_u32 s17, s49, 294912
    buffer_load_dword v32, v9, s[20:23], s17 offen
    buffer_load_dword v33, v10, s[20:23], s17 offen
    buffer_load_dword v34, v12, s[20:23], s17 offen
    buffer_load_dword v35, v13, s[20:23], s17 offen
    s_waitcnt vmcnt(58)
    v_perm_b32 v5, v89, v88, s44
    v_perm_b32 v6, v89, v88, s45
    s_waitcnt vmcnt(56)
    v_perm_b32 v146, v91, v90, v11
    v_accvgpr_write_b32 a34, v5
    v_accvgpr_write_b32 a38, v6
    s_add_u32 s17, s49, 296064
    buffer_load_dword v36, v9, s[20:23], s17 offen
    buffer_load_dword v37, v10, s[20:23], s17 offen
    buffer_load_dword v38, v12, s[20:23], s17 offen
    buffer_load_dword v39, v13, s[20:23], s17 offen
    s_waitcnt vmcnt(58)
    v_perm_b32 v5, v93, v92, s44
    v_perm_b32 v6, v93, v92, s45
    s_waitcnt vmcnt(56)
    v_perm_b32 v147, v95, v94, v11
    v_accvgpr_write_b32 a35, v5
    v_accvgpr_write_b32 a39, v6
    s_add_u32 s17, s49, 297216
    buffer_load_dword v40, v9, s[20:23], s17 offen
    buffer_load_dword v41, v10, s[20:23], s17 offen
    buffer_load_dword v42, v12, s[20:23], s17 offen
    buffer_load_dword v43, v13, s[20:23], s17 offen
    s_waitcnt vmcnt(58)
    v_perm_b32 v5, v97, v96, s44
    v_perm_b32 v6, v97, v96, s45
    s_waitcnt vmcnt(56)
    v_perm_b32 v148, v99, v98, v11
    v_accvgpr_write_b32 a40, v5
    v_accvgpr_write_b32 a44, v6
    s_add_u32 s17, s49, 298368
    buffer_load_dword v44, v9, s[20:23], s17 offen
    buffer_load_dword v45, v10, s[20:23], s17 offen
    buffer_load_dword v46, v12, s[20:23], s17 offen
    buffer_load_dword v47, v13, s[20:23], s17 offen
    s_waitcnt vmcnt(58)
    v_perm_b32 v5, v101, v100, s44
    v_perm_b32 v6, v101, v100, s45
    s_waitcnt vmcnt(56)
    v_perm_b32 v149, v103, v102, v11
    v_accvgpr_write_b32 a41, v5
    v_accvgpr_write_b32 a45, v6
    s_add_u32 s17, s49, 331776
    buffer_load_dword v48, v9, s[20:23], s17 offen
    buffer_load_dword v49, v10, s[20:23], s17 offen
    buffer_load_dword v50, v12, s[20:23], s17 offen
    buffer_load_dword v51, v13, s[20:23], s17 offen
    s_waitcnt vmcnt(58)
    v_perm_b32 v5, v105, v104, s44
    v_perm_b32 v6, v105, v104, s45
    s_waitcnt vmcnt(56)
    v_perm_b32 v150, v107, v106, v11
    v_accvgpr_write_b32 a42, v5
    v_accvgpr_write_b32 a46, v6
    s_add_u32 s17, s49, 332928
    buffer_load_dword v52, v9, s[20:23], s17 offen
    buffer_load_dword v53, v10, s[20:23], s17 offen
    buffer_load_dword v54, v12, s[20:23], s17 offen
    buffer_load_dword v55, v13, s[20:23], s17 offen
    s_waitcnt vmcnt(58)
    v_perm_b32 v5, v109, v108, s44
    v_perm_b32 v6, v109, v108, s45
    s_waitcnt vmcnt(56)
    v_perm_b32 v151, v111, v110, v11
    v_accvgpr_write_b32 a43, v5
    v_accvgpr_write_b32 a47, v6
    s_add_u32 s17, s49, 334080
    buffer_load_dword v56, v9, s[20:23], s17 offen
    buffer_load_dword v57, v10, s[20:23], s17 offen
    buffer_load_dword v58, v12, s[20:23], s17 offen
    buffer_load_dword v59, v13, s[20:23], s17 offen
    s_waitcnt vmcnt(58)
    v_perm_b32 v5, v113, v112, s44
    v_perm_b32 v6, v113, v112, s45
    s_waitcnt vmcnt(56)
    v_perm_b32 v152, v115, v114, v11
    v_accvgpr_write_b32 a48, v5
    v_accvgpr_write_b32 a52, v6
    s_add_u32 s17, s49, 335232
    buffer_load_dword v60, v9, s[20:23], s17 offen
    buffer_load_dword v61, v10, s[20:23], s17 offen
    buffer_load_dword v62, v12, s[20:23], s17 offen
    buffer_load_dword v63, v13, s[20:23], s17 offen
    s_waitcnt vmcnt(58)
    v_perm_b32 v5, v117, v116, s44
    v_perm_b32 v6, v117, v116, s45
    s_waitcnt vmcnt(56)
    v_perm_b32 v153, v119, v118, v11
    v_accvgpr_write_b32 a49, v5
    v_accvgpr_write_b32 a53, v6
    s_add_u32 s17, s49, 368640
    buffer_load_dword v64, v9, s[20:23], s17 offen
    buffer_load_dword v65, v10, s[20:23], s17 offen
    buffer_load_dword v66, v12, s[20:23], s17 offen
    buffer_load_dword v67, v13, s[20:23], s17 offen
    s_waitcnt vmcnt(58)
    v_perm_b32 v5, v121, v120, s44
    v_perm_b32 v6, v121, v120, s45
    s_waitcnt vmcnt(56)
    v_perm_b32 v154, v123, v122, v11
    v_accvgpr_write_b32 a50, v5
    v_accvgpr_write_b32 a54, v6
    s_add_u32 s17, s49, 369792
    buffer_load_dword v68, v9, s[20:23], s17 offen
    buffer_load_dword v69, v10, s[20:23], s17 offen
    buffer_load_dword v70, v12, s[20:23], s17 offen
    buffer_load_dword v71, v13, s[20:23], s17 offen
    s_waitcnt vmcnt(58)
    v_perm_b32 v5, v125, v124, s44
    v_perm_b32 v6, v125, v124, s45
    s_waitcnt vmcnt(56)
    v_perm_b32 v155, v127, v126, v11
    v_accvgpr_write_b32 a51, v5
    v_accvgpr_write_b32 a55, v6
    s_add_u32 s17, s49, 370944
    buffer_load_dword v72, v9, s[20:23], s17 offen
    buffer_load_dword v73, v10, s[20:23], s17 offen
    buffer_load_dword v74, v12, s[20:23], s17 offen
    buffer_load_dword v75, v13, s[20:23], s17 offen
    s_waitcnt vmcnt(58)
    v_perm_b32 v5, v17, v16, s44
    v_perm_b32 v6, v17, v16, s45
    s_waitcnt vmcnt(56)
    v_perm_b32 v156, v19, v18, v11
    v_accvgpr_write_b32 a56, v5
    v_accvgpr_write_b32 a60, v6
    s_add_u32 s17, s49, 372096
    buffer_load_dword v76, v9, s[20:23], s17 offen
    buffer_load_dword v77, v10, s[20:23], s17 offen
    buffer_load_dword v78, v12, s[20:23], s17 offen
    buffer_load_dword v79, v13, s[20:23], s17 offen
    s_waitcnt vmcnt(58)
    v_perm_b32 v5, v21, v20, s44
    v_perm_b32 v6, v21, v20, s45
    s_waitcnt vmcnt(56)
    v_perm_b32 v157, v23, v22, v11
    v_accvgpr_write_b32 a57, v5
    v_accvgpr_write_b32 a61, v6
    s_add_u32 s17, s49, 405504
    buffer_load_dword v80, v9, s[20:23], s17 offen
    buffer_load_dword v81, v10, s[20:23], s17 offen
    buffer_load_dword v82, v12, s[20:23], s17 offen
    buffer_load_dword v83, v13, s[20:23], s17 offen
    s_waitcnt vmcnt(58)
    v_perm_b32 v5, v25, v24, s44
    v_perm_b32 v6, v25, v24, s45
    s_waitcnt vmcnt(56)
    v_perm_b32 v158, v27, v26, v11
    v_accvgpr_write_b32 a58, v5
    v_accvgpr_write_b32 a62, v6
    s_add_u32 s17, s49, 406656
    buffer_load_dword v84, v9, s[20:23], s17 offen
    buffer_load_dword v85, v10, s[20:23], s17 offen
    buffer_load_dword v86, v12, s[20:23], s17 offen
    buffer_load_dword v87, v13, s[20:23], s17 offen
    s_waitcnt vmcnt(58)
    v_perm_b32 v5, v29, v28, s44
    v_perm_b32 v6, v29, v28, s45
    s_waitcnt vmcnt(56)
    v_perm_b32 v159, v31, v30, v11
    v_accvgpr_write_b32 a59, v5
    v_accvgpr_write_b32 a63, v6
    s_add_u32 s17, s49, 407808
    buffer_load_dword v88, v9, s[20:23], s17 offen
    buffer_load_dword v89, v10, s[20:23], s17 offen
    buffer_load_dword v90, v12, s[20:23], s17 offen
    buffer_load_dword v91, v13, s[20:23], s17 offen
    s_waitcnt vmcnt(58)
    v_perm_b32 v5, v33, v32, s44
    v_perm_b32 v6, v33, v32, s45
    s_waitcnt vmcnt(56)
    v_perm_b32 v160, v35, v34, v11
    v_accvgpr_write_b32 a64, v5
    v_accvgpr_write_b32 a68, v6
    s_add_u32 s17, s49, 408960
    buffer_load_dword v92, v9, s[20:23], s17 offen
    buffer_load_dword v93, v10, s[20:23], s17 offen
    buffer_load_dword v94, v12, s[20:23], s17 offen
    buffer_load_dword v95, v13, s[20:23], s17 offen
    s_waitcnt vmcnt(58)
    v_perm_b32 v5, v37, v36, s44
    v_perm_b32 v6, v37, v36, s45
    s_waitcnt vmcnt(56)
    v_perm_b32 v161, v39, v38, v11
    v_accvgpr_write_b32 a65, v5
    v_accvgpr_write_b32 a69, v6
    s_add_u32 s17, s49, 442368
    buffer_load_dword v96, v9, s[20:23], s17 offen
    buffer_load_dword v97, v10, s[20:23], s17 offen
    buffer_load_dword v98, v12, s[20:23], s17 offen
    buffer_load_dword v99, v13, s[20:23], s17 offen
    s_waitcnt vmcnt(58)
    v_perm_b32 v5, v41, v40, s44
    v_perm_b32 v6, v41, v40, s45
    s_waitcnt vmcnt(56)
    v_perm_b32 v162, v43, v42, v11
    v_accvgpr_write_b32 a66, v5
    v_accvgpr_write_b32 a70, v6
    s_add_u32 s17, s49, 443520
    buffer_load_dword v100, v9, s[20:23], s17 offen
    buffer_load_dword v101, v10, s[20:23], s17 offen
    buffer_load_dword v102, v12, s[20:23], s17 offen
    buffer_load_dword v103, v13, s[20:23], s17 offen
    s_waitcnt vmcnt(58)
    v_perm_b32 v5, v45, v44, s44
    v_perm_b32 v6, v45, v44, s45
    s_waitcnt vmcnt(56)
    v_perm_b32 v163, v47, v46, v11
    v_accvgpr_write_b32 a67, v5
    v_accvgpr_write_b32 a71, v6
    s_add_u32 s17, s49, 444672
    buffer_load_dword v104, v9, s[20:23], s17 offen
    buffer_load_dword v105, v10, s[20:23], s17 offen
    buffer_load_dword v106, v12, s[20:23], s17 offen
    buffer_load_dword v107, v13, s[20:23], s17 offen
    s_waitcnt vmcnt(58)
    v_perm_b32 v5, v49, v48, s44
    v_perm_b32 v6, v49, v48, s45
    s_waitcnt vmcnt(56)
    v_perm_b32 v164, v51, v50, v11
    v_accvgpr_write_b32 a72, v5
    v_accvgpr_write_b32 a76, v6
    s_add_u32 s17, s49, 445824
    buffer_load_dword v108, v9, s[20:23], s17 offen
    buffer_load_dword v109, v10, s[20:23], s17 offen
    buffer_load_dword v110, v12, s[20:23], s17 offen
    buffer_load_dword v111, v13, s[20:23], s17 offen
    s_waitcnt vmcnt(58)
    v_perm_b32 v5, v53, v52, s44
    v_perm_b32 v6, v53, v52, s45
    s_waitcnt vmcnt(56)
    v_perm_b32 v165, v55, v54, v11
    v_accvgpr_write_b32 a73, v5
    v_accvgpr_write_b32 a77, v6
    s_add_u32 s17, s49, 479232
    buffer_load_dword v112, v9, s[20:23], s17 offen
    buffer_load_dword v113, v10, s[20:23], s17 offen
    buffer_load_dword v114, v12, s[20:23], s17 offen
    buffer_load_dword v115, v13, s[20:23], s17 offen
    s_waitcnt vmcnt(58)
    v_perm_b32 v5, v57, v56, s44
    v_perm_b32 v6, v57, v56, s45
    s_waitcnt vmcnt(56)
    v_perm_b32 v166, v59, v58, v11
    v_accvgpr_write_b32 a74, v5
    v_accvgpr_write_b32 a78, v6
    s_add_u32 s17, s49, 480384
    buffer_load_dword v116, v9, s[20:23], s17 offen
    buffer_load_dword v117, v10, s[20:23], s17 offen
    buffer_load_dword v118, v12, s[20:23], s17 offen
    buffer_load_dword v119, v13, s[20:23], s17 offen
    s_waitcnt vmcnt(58)
    v_perm_b32 v5, v61, v60, s44
    v_perm_b32 v6, v61, v60, s45
    s_waitcnt vmcnt(56)
    v_perm_b32 v167, v63, v62, v11
    v_accvgpr_write_b32 a75, v5
    v_accvgpr_write_b32 a79, v6
    s_add_u32 s17, s49, 481536
    buffer_load_dword v120, v9, s[20:23], s17 offen
    buffer_load_dword v121, v10, s[20:23], s17 offen
    buffer_load_dword v122, v12, s[20:23], s17 offen
    buffer_load_dword v123, v13, s[20:23], s17 offen
    s_waitcnt vmcnt(58)
    v_perm_b32 v5, v65, v64, s44
    v_perm_b32 v6, v65, v64, s45
    s_waitcnt vmcnt(56)
    v_perm_b32 v168, v67, v66, v11
    v_accvgpr_write_b32 a80, v5
    v_accvgpr_write_b32 a84, v6
    s_add_u32 s17, s49, 482688
    buffer_load_dword v124, v9, s[20:23], s17 offen
    buffer_load_dword v125, v10, s[20:23], s17 offen
    buffer_load_dword v126, v12, s[20:23], s17 offen
    buffer_load_dword v127, v13, s[20:23], s17 offen
    s_waitcnt vmcnt(58)
    v_perm_b32 v5, v69, v68, s44
    v_perm_b32 v6, v69, v68, s45
    s_waitcnt vmcnt(56)
    v_perm_b32 v169, v71, v70, v11
    v_accvgpr_write_b32 a81, v5
    v_accvgpr_write_b32 a85, v6
    s_add_u32 s17, s49, 516096
    buffer_load_dword v16, v9, s[20:23], s17 offen
    buffer_load_dword v17, v10, s[20:23], s17 offen
    buffer_load_dword v18, v12, s[20:23], s17 offen
    buffer_load_dword v19, v13, s[20:23], s17 offen
    s_waitcnt vmcnt(58)
    v_perm_b32 v5, v73, v72, s44
    v_perm_b32 v6, v73, v72, s45
    s_waitcnt vmcnt(56)
    v_perm_b32 v170, v75, v74, v11
    v_accvgpr_write_b32 a82, v5
    v_accvgpr_write_b32 a86, v6
    s_add_u32 s17, s49, 517248
    buffer_load_dword v20, v9, s[20:23], s17 offen
    buffer_load_dword v21, v10, s[20:23], s17 offen
    buffer_load_dword v22, v12, s[20:23], s17 offen
    buffer_load_dword v23, v13, s[20:23], s17 offen
    s_waitcnt vmcnt(58)
    v_perm_b32 v5, v77, v76, s44
    v_perm_b32 v6, v77, v76, s45
    s_waitcnt vmcnt(56)
    v_perm_b32 v171, v79, v78, v11
    v_accvgpr_write_b32 a83, v5
    v_accvgpr_write_b32 a87, v6
    s_add_u32 s17, s49, 518400
    buffer_load_dword v24, v9, s[20:23], s17 offen
    buffer_load_dword v25, v10, s[20:23], s17 offen
    buffer_load_dword v26, v12, s[20:23], s17 offen
    buffer_load_dword v27, v13, s[20:23], s17 offen
    s_waitcnt vmcnt(58)
    v_perm_b32 v5, v81, v80, s44
    v_perm_b32 v6, v81, v80, s45
    s_waitcnt vmcnt(56)
    v_perm_b32 v172, v83, v82, v11
    v_accvgpr_write_b32 a88, v5
    v_accvgpr_write_b32 a92, v6
    s_add_u32 s17, s49, 519552
    buffer_load_dword v28, v9, s[20:23], s17 offen
    buffer_load_dword v29, v10, s[20:23], s17 offen
    buffer_load_dword v30, v12, s[20:23], s17 offen
    buffer_load_dword v31, v13, s[20:23], s17 offen
    s_waitcnt vmcnt(58)
    v_perm_b32 v5, v85, v84, s44
    v_perm_b32 v6, v85, v84, s45
    s_waitcnt vmcnt(56)
    v_perm_b32 v173, v87, v86, v11
    v_accvgpr_write_b32 a89, v5
    v_accvgpr_write_b32 a93, v6
    s_add_u32 s17, s49, 552960
    buffer_load_dword v32, v9, s[20:23], s17 offen
    buffer_load_dword v33, v10, s[20:23], s17 offen
    buffer_load_dword v34, v12, s[20:23], s17 offen
    buffer_load_dword v35, v13, s[20:23], s17 offen
    s_waitcnt vmcnt(58)
    v_perm_b32 v5, v89, v88, s44
    v_perm_b32 v6, v89, v88, s45
    s_waitcnt vmcnt(56)
    v_perm_b32 v174, v91, v90, v11
    v_accvgpr_write_b32 a90, v5
    v_accvgpr_write_b32 a94, v6
    s_add_u32 s17, s49, 554112
    buffer_load_dword v36, v9, s[20:23], s17 offen
    buffer_load_dword v37, v10, s[20:23], s17 offen
    buffer_load_dword v38, v12, s[20:23], s17 offen
    buffer_load_dword v39, v13, s[20:23], s17 offen
    s_waitcnt vmcnt(58)
    v_perm_b32 v5, v93, v92, s44
    v_perm_b32 v6, v93, v92, s45
    s_waitcnt vmcnt(56)
    v_perm_b32 v175, v95, v94, v11
    v_accvgpr_write_b32 a91, v5
    v_accvgpr_write_b32 a95, v6
    s_add_u32 s17, s49, 555264
    buffer_load_dword v40, v9, s[20:23], s17 offen
    buffer_load_dword v41, v10, s[20:23], s17 offen
    buffer_load_dword v42, v12, s[20:23], s17 offen
    buffer_load_dword v43, v13, s[20:23], s17 offen
    s_waitcnt vmcnt(58)
    v_perm_b32 v5, v97, v96, s44
    v_perm_b32 v6, v97, v96, s45
    s_waitcnt vmcnt(56)
    v_perm_b32 v176, v99, v98, v11
    v_accvgpr_write_b32 a96, v5
    v_accvgpr_write_b32 a100, v6
    s_add_u32 s17, s49, 556416
    buffer_load_dword v44, v9, s[20:23], s17 offen
    buffer_load_dword v45, v10, s[20:23], s17 offen
    buffer_load_dword v46, v12, s[20:23], s17 offen
    buffer_load_dword v47, v13, s[20:23], s17 offen
    s_waitcnt vmcnt(58)
    v_perm_b32 v5, v101, v100, s44
    v_perm_b32 v6, v101, v100, s45
    s_waitcnt vmcnt(56)
    v_perm_b32 v177, v103, v102, v11
    v_accvgpr_write_b32 a97, v5
    v_accvgpr_write_b32 a101, v6
    s_add_u32 s17, s49, 589824
    buffer_load_dword v48, v9, s[20:23], s17 offen
    buffer_load_dword v49, v10, s[20:23], s17 offen
    buffer_load_dword v50, v12, s[20:23], s17 offen
    buffer_load_dword v51, v13, s[20:23], s17 offen
    s_waitcnt vmcnt(58)
    v_perm_b32 v5, v105, v104, s44
    v_perm_b32 v6, v105, v104, s45
    s_waitcnt vmcnt(56)
    v_perm_b32 v178, v107, v106, v11
    v_accvgpr_write_b32 a98, v5
    v_accvgpr_write_b32 a102, v6
    s_add_u32 s17, s49, 590976
    buffer_load_dword v52, v9, s[20:23], s17 offen
    buffer_load_dword v53, v10, s[20:23], s17 offen
    buffer_load_dword v54, v12, s[20:23], s17 offen
    buffer_load_dword v55, v13, s[20:23], s17 offen
    s_waitcnt vmcnt(58)
    v_perm_b32 v5, v109, v108, s44
    v_perm_b32 v6, v109, v108, s45
    s_waitcnt vmcnt(56)
    v_perm_b32 v179, v111, v110, v11
    v_accvgpr_write_b32 a99, v5
    v_accvgpr_write_b32 a103, v6
    s_add_u32 s17, s49, 592128
    buffer_load_dword v56, v9, s[20:23], s17 offen
    buffer_load_dword v57, v10, s[20:23], s17 offen
    buffer_load_dword v58, v12, s[20:23], s17 offen
    buffer_load_dword v59, v13, s[20:23], s17 offen
    s_waitcnt vmcnt(58)
    v_perm_b32 v5, v113, v112, s44
    v_perm_b32 v6, v113, v112, s45
    s_waitcnt vmcnt(56)
    v_perm_b32 v180, v115, v114, v11
    v_accvgpr_write_b32 a104, v5
    v_accvgpr_write_b32 a108, v6
    s_add_u32 s17, s49, 593280
    buffer_load_dword v60, v9, s[20:23], s17 offen
    buffer_load_dword v61, v10, s[20:23], s17 offen
    buffer_load_dword v62, v12, s[20:23], s17 offen
    buffer_load_dword v63, v13, s[20:23], s17 offen
    s_waitcnt vmcnt(58)
    v_perm_b32 v5, v117, v116, s44
    v_perm_b32 v6, v117, v116, s45
    s_waitcnt vmcnt(56)
    v_perm_b32 v181, v119, v118, v11
    v_accvgpr_write_b32 a105, v5
    v_accvgpr_write_b32 a109, v6
    s_add_u32 s17, s49, 626688
    buffer_load_dword v64, v9, s[20:23], s17 offen
    buffer_load_dword v65, v10, s[20:23], s17 offen
    buffer_load_dword v66, v12, s[20:23], s17 offen
    buffer_load_dword v67, v13, s[20:23], s17 offen
    s_waitcnt vmcnt(58)
    v_perm_b32 v5, v121, v120, s44
    v_perm_b32 v6, v121, v120, s45
    s_waitcnt vmcnt(56)
    v_perm_b32 v182, v123, v122, v11
    v_accvgpr_write_b32 a106, v5
    v_accvgpr_write_b32 a110, v6
    s_add_u32 s17, s49, 627840
    buffer_load_dword v68, v9, s[20:23], s17 offen
    buffer_load_dword v69, v10, s[20:23], s17 offen
    buffer_load_dword v70, v12, s[20:23], s17 offen
    buffer_load_dword v71, v13, s[20:23], s17 offen
    s_waitcnt vmcnt(58)
    v_perm_b32 v5, v125, v124, s44
    v_perm_b32 v6, v125, v124, s45
    s_waitcnt vmcnt(56)
    v_perm_b32 v183, v127, v126, v11
    v_accvgpr_write_b32 a107, v5
    v_accvgpr_write_b32 a111, v6
    s_add_u32 s17, s49, 628992
    buffer_load_dword v72, v9, s[20:23], s17 offen
    buffer_load_dword v73, v10, s[20:23], s17 offen
    buffer_load_dword v74, v12, s[20:23], s17 offen
    buffer_load_dword v75, v13, s[20:23], s17 offen
    s_waitcnt vmcnt(58)
    v_perm_b32 v5, v17, v16, s44
    v_perm_b32 v6, v17, v16, s45
    s_waitcnt vmcnt(56)
    v_perm_b32 v184, v19, v18, v11
    v_accvgpr_write_b32 a112, v5
    v_accvgpr_write_b32 a116, v6
    s_add_u32 s17, s49, 630144
    buffer_load_dword v76, v9, s[20:23], s17 offen
    buffer_load_dword v77, v10, s[20:23], s17 offen
    buffer_load_dword v78, v12, s[20:23], s17 offen
    buffer_load_dword v79, v13, s[20:23], s17 offen
    s_waitcnt vmcnt(58)
    v_perm_b32 v5, v21, v20, s44
    v_perm_b32 v6, v21, v20, s45
    s_waitcnt vmcnt(56)
    v_perm_b32 v185, v23, v22, v11
    v_accvgpr_write_b32 a113, v5
    v_accvgpr_write_b32 a117, v6
    s_add_u32 s17, s49, 663552
    buffer_load_dword v80, v9, s[20:23], s17 offen
    buffer_load_dword v81, v10, s[20:23], s17 offen
    buffer_load_dword v82, v12, s[20:23], s17 offen
    buffer_load_dword v83, v13, s[20:23], s17 offen
    s_waitcnt vmcnt(58)
    v_perm_b32 v5, v25, v24, s44
    v_perm_b32 v6, v25, v24, s45
    s_waitcnt vmcnt(56)
    v_perm_b32 v186, v27, v26, v11
    v_accvgpr_write_b32 a114, v5
    v_accvgpr_write_b32 a118, v6
    s_add_u32 s17, s49, 664704
    buffer_load_dword v84, v9, s[20:23], s17 offen
    buffer_load_dword v85, v10, s[20:23], s17 offen
    buffer_load_dword v86, v12, s[20:23], s17 offen
    buffer_load_dword v87, v13, s[20:23], s17 offen
    s_waitcnt vmcnt(58)
    v_perm_b32 v5, v29, v28, s44
    v_perm_b32 v6, v29, v28, s45
    s_waitcnt vmcnt(56)
    v_perm_b32 v187, v31, v30, v11
    v_accvgpr_write_b32 a115, v5
    v_accvgpr_write_b32 a119, v6
    s_add_u32 s17, s49, 665856
    buffer_load_dword v88, v9, s[20:23], s17 offen
    buffer_load_dword v89, v10, s[20:23], s17 offen
    buffer_load_dword v90, v12, s[20:23], s17 offen
    buffer_load_dword v91, v13, s[20:23], s17 offen
    s_waitcnt vmcnt(58)
    v_perm_b32 v5, v33, v32, s44
    v_perm_b32 v6, v33, v32, s45
    s_waitcnt vmcnt(56)
    v_perm_b32 v188, v35, v34, v11
    v_accvgpr_write_b32 a120, v5
    v_accvgpr_write_b32 a124, v6
    s_add_u32 s17, s49, 667008
    buffer_load_dword v92, v9, s[20:23], s17 offen
    buffer_load_dword v93, v10, s[20:23], s17 offen
    buffer_load_dword v94, v12, s[20:23], s17 offen
    buffer_load_dword v95, v13, s[20:23], s17 offen
    s_waitcnt vmcnt(58)
    v_perm_b32 v5, v37, v36, s44
    v_perm_b32 v6, v37, v36, s45
    s_waitcnt vmcnt(56)
    v_perm_b32 v189, v39, v38, v11
    v_accvgpr_write_b32 a121, v5
    v_accvgpr_write_b32 a125, v6
    s_add_u32 s17, s49, 700416
    buffer_load_dword v96, v9, s[20:23], s17 offen
    buffer_load_dword v97, v10, s[20:23], s17 offen
    buffer_load_dword v98, v12, s[20:23], s17 offen
    buffer_load_dword v99, v13, s[20:23], s17 offen
    s_waitcnt vmcnt(58)
    v_perm_b32 v5, v41, v40, s44
    v_perm_b32 v6, v41, v40, s45
    s_waitcnt vmcnt(56)
    v_perm_b32 v190, v43, v42, v11
    v_accvgpr_write_b32 a122, v5
    v_accvgpr_write_b32 a126, v6
    s_add_u32 s17, s49, 701568
    buffer_load_dword v100, v9, s[20:23], s17 offen
    buffer_load_dword v101, v10, s[20:23], s17 offen
    buffer_load_dword v102, v12, s[20:23], s17 offen
    buffer_load_dword v103, v13, s[20:23], s17 offen
    s_waitcnt vmcnt(58)
    v_perm_b32 v5, v45, v44, s44
    v_perm_b32 v6, v45, v44, s45
    s_waitcnt vmcnt(56)
    v_perm_b32 v191, v47, v46, v11
    v_accvgpr_write_b32 a123, v5
    v_accvgpr_write_b32 a127, v6
    s_add_u32 s17, s49, 702720
    buffer_load_dword v104, v9, s[20:23], s17 offen
    buffer_load_dword v105, v10, s[20:23], s17 offen
    buffer_load_dword v106, v12, s[20:23], s17 offen
    buffer_load_dword v107, v13, s[20:23], s17 offen
    s_waitcnt vmcnt(58)
    v_perm_b32 v5, v49, v48, s44
    v_perm_b32 v6, v49, v48, s45
    s_waitcnt vmcnt(56)
    v_perm_b32 v192, v51, v50, v11
    v_accvgpr_write_b32 a128, v5
    v_accvgpr_write_b32 a132, v6
    s_add_u32 s17, s49, 703872
    buffer_load_dword v108, v9, s[20:23], s17 offen
    buffer_load_dword v109, v10, s[20:23], s17 offen
    buffer_load_dword v110, v12, s[20:23], s17 offen
    buffer_load_dword v111, v13, s[20:23], s17 offen
    s_waitcnt vmcnt(58)
    v_perm_b32 v5, v53, v52, s44
    v_perm_b32 v6, v53, v52, s45
    s_waitcnt vmcnt(56)
    v_perm_b32 v193, v55, v54, v11
    v_accvgpr_write_b32 a129, v5
    v_accvgpr_write_b32 a133, v6
    s_add_u32 s17, s49, 737280
    buffer_load_dword v112, v9, s[20:23], s17 offen
    buffer_load_dword v113, v10, s[20:23], s17 offen
    buffer_load_dword v114, v12, s[20:23], s17 offen
    buffer_load_dword v115, v13, s[20:23], s17 offen
    s_waitcnt vmcnt(58)
    v_perm_b32 v5, v57, v56, s44
    v_perm_b32 v6, v57, v56, s45
    s_waitcnt vmcnt(56)
    v_perm_b32 v194, v59, v58, v11
    v_accvgpr_write_b32 a130, v5
    v_accvgpr_write_b32 a134, v6
    s_add_u32 s17, s49, 738432
    buffer_load_dword v116, v9, s[20:23], s17 offen
    buffer_load_dword v117, v10, s[20:23], s17 offen
    buffer_load_dword v118, v12, s[20:23], s17 offen
    buffer_load_dword v119, v13, s[20:23], s17 offen
    s_waitcnt vmcnt(58)
    v_perm_b32 v5, v61, v60, s44
    v_perm_b32 v6, v61, v60, s45
    s_waitcnt vmcnt(56)
    v_perm_b32 v195, v63, v62, v11
    v_accvgpr_write_b32 a131, v5
    v_accvgpr_write_b32 a135, v6
    s_add_u32 s17, s49, 739584
    buffer_load_dword v120, v9, s[20:23], s17 offen
    buffer_load_dword v121, v10, s[20:23], s17 offen
    buffer_load_dword v122, v12, s[20:23], s17 offen
    buffer_load_dword v123, v13, s[20:23], s17 offen
    s_waitcnt vmcnt(58)
    v_perm_b32 v5, v65, v64, s44
    v_perm_b32 v6, v65, v64, s45
    s_waitcnt vmcnt(56)
    v_perm_b32 v196, v67, v66, v11
    v_accvgpr_write_b32 a136, v5
    v_accvgpr_write_b32 a140, v6
    s_add_u32 s17, s49, 740736
    buffer_load_dword v124, v9, s[20:23], s17 offen
    buffer_load_dword v125, v10, s[20:23], s17 offen
    buffer_load_dword v126, v12, s[20:23], s17 offen
    buffer_load_dword v127, v13, s[20:23], s17 offen
    s_waitcnt vmcnt(58)
    v_perm_b32 v5, v69, v68, s44
    v_perm_b32 v6, v69, v68, s45
    s_waitcnt vmcnt(56)
    v_perm_b32 v197, v71, v70, v11
    v_accvgpr_write_b32 a137, v5
    v_accvgpr_write_b32 a141, v6
    s_add_u32 s17, s49, 774144
    buffer_load_dword v16, v9, s[20:23], s17 offen
    buffer_load_dword v17, v10, s[20:23], s17 offen
    buffer_load_dword v18, v12, s[20:23], s17 offen
    buffer_load_dword v19, v13, s[20:23], s17 offen
    s_waitcnt vmcnt(58)
    v_perm_b32 v5, v73, v72, s44
    v_perm_b32 v6, v73, v72, s45
    s_waitcnt vmcnt(56)
    v_perm_b32 v198, v75, v74, v11
    v_accvgpr_write_b32 a138, v5
    v_accvgpr_write_b32 a142, v6
    s_add_u32 s17, s49, 775296
    buffer_load_dword v20, v9, s[20:23], s17 offen
    buffer_load_dword v21, v10, s[20:23], s17 offen
    buffer_load_dword v22, v12, s[20:23], s17 offen
    buffer_load_dword v23, v13, s[20:23], s17 offen
    s_waitcnt vmcnt(58)
    v_perm_b32 v5, v77, v76, s44
    v_perm_b32 v6, v77, v76, s45
    s_waitcnt vmcnt(56)
    v_perm_b32 v199, v79, v78, v11
    v_accvgpr_write_b32 a139, v5
    v_accvgpr_write_b32 a143, v6
    s_add_u32 s17, s49, 776448
    buffer_load_dword v24, v9, s[20:23], s17 offen
    buffer_load_dword v25, v10, s[20:23], s17 offen
    buffer_load_dword v26, v12, s[20:23], s17 offen
    buffer_load_dword v27, v13, s[20:23], s17 offen
    s_waitcnt vmcnt(58)
    v_perm_b32 v5, v81, v80, s44
    v_perm_b32 v6, v81, v80, s45
    s_waitcnt vmcnt(56)
    v_perm_b32 v200, v83, v82, v11
    v_accvgpr_write_b32 a144, v5
    v_accvgpr_write_b32 a148, v6
    s_add_u32 s17, s49, 777600
    buffer_load_dword v28, v9, s[20:23], s17 offen
    buffer_load_dword v29, v10, s[20:23], s17 offen
    buffer_load_dword v30, v12, s[20:23], s17 offen
    buffer_load_dword v31, v13, s[20:23], s17 offen
    s_waitcnt vmcnt(58)
    v_perm_b32 v5, v85, v84, s44
    v_perm_b32 v6, v85, v84, s45
    s_waitcnt vmcnt(56)
    v_perm_b32 v201, v87, v86, v11
    v_accvgpr_write_b32 a145, v5
    v_accvgpr_write_b32 a149, v6
    s_add_u32 s17, s49, 811008
    buffer_load_dword v32, v9, s[20:23], s17 offen
    buffer_load_dword v33, v10, s[20:23], s17 offen
    buffer_load_dword v34, v12, s[20:23], s17 offen
    buffer_load_dword v35, v13, s[20:23], s17 offen
    s_waitcnt vmcnt(58)
    v_perm_b32 v5, v89, v88, s44
    v_perm_b32 v6, v89, v88, s45
    s_waitcnt vmcnt(56)
    v_perm_b32 v202, v91, v90, v11
    v_accvgpr_write_b32 a146, v5
    v_accvgpr_write_b32 a150, v6
    s_add_u32 s17, s49, 812160
    buffer_load_dword v36, v9, s[20:23], s17 offen
    buffer_load_dword v37, v10, s[20:23], s17 offen
    buffer_load_dword v38, v12, s[20:23], s17 offen
    buffer_load_dword v39, v13, s[20:23], s17 offen
    s_waitcnt vmcnt(58)
    v_perm_b32 v5, v93, v92, s44
    v_perm_b32 v6, v93, v92, s45
    s_waitcnt vmcnt(56)
    v_perm_b32 v203, v95, v94, v11
    v_accvgpr_write_b32 a147, v5
    v_accvgpr_write_b32 a151, v6
    s_add_u32 s17, s49, 813312
    buffer_load_dword v40, v9, s[20:23], s17 offen
    buffer_load_dword v41, v10, s[20:23], s17 offen
    buffer_load_dword v42, v12, s[20:23], s17 offen
    buffer_load_dword v43, v13, s[20:23], s17 offen
    s_waitcnt vmcnt(58)
    v_perm_b32 v5, v97, v96, s44
    v_perm_b32 v6, v97, v96, s45
    s_waitcnt vmcnt(56)
    v_perm_b32 v204, v99, v98, v11
    v_accvgpr_write_b32 a152, v5
    v_accvgpr_write_b32 a156, v6
    s_add_u32 s17, s49, 814464
    buffer_load_dword v44, v9, s[20:23], s17 offen
    buffer_load_dword v45, v10, s[20:23], s17 offen
    buffer_load_dword v46, v12, s[20:23], s17 offen
    buffer_load_dword v47, v13, s[20:23], s17 offen
    s_waitcnt vmcnt(58)
    v_perm_b32 v5, v101, v100, s44
    v_perm_b32 v6, v101, v100, s45
    s_waitcnt vmcnt(56)
    v_perm_b32 v205, v103, v102, v11
    v_accvgpr_write_b32 a153, v5
    v_accvgpr_write_b32 a157, v6
    s_add_u32 s17, s49, 847872
    buffer_load_dword v48, v9, s[20:23], s17 offen
    buffer_load_dword v49, v10, s[20:23], s17 offen
    buffer_load_dword v50, v12, s[20:23], s17 offen
    buffer_load_dword v51, v13, s[20:23], s17 offen
    s_waitcnt vmcnt(58)
    v_perm_b32 v5, v105, v104, s44
    v_perm_b32 v6, v105, v104, s45
    s_waitcnt vmcnt(56)
    v_perm_b32 v206, v107, v106, v11
    v_accvgpr_write_b32 a154, v5
    v_accvgpr_write_b32 a158, v6
    s_add_u32 s17, s49, 849024
    buffer_load_dword v52, v9, s[20:23], s17 offen
    buffer_load_dword v53, v10, s[20:23], s17 offen
    buffer_load_dword v54, v12, s[20:23], s17 offen
    buffer_load_dword v55, v13, s[20:23], s17 offen
    s_waitcnt vmcnt(58)
    v_perm_b32 v5, v109, v108, s44
    v_perm_b32 v6, v109, v108, s45
    s_waitcnt vmcnt(56)
    v_perm_b32 v207, v111, v110, v11
    v_accvgpr_write_b32 a155, v5
    v_accvgpr_write_b32 a159, v6
    s_add_u32 s17, s49, 850176
    buffer_load_dword v56, v9, s[20:23], s17 offen
    buffer_load_dword v57, v10, s[20:23], s17 offen
    buffer_load_dword v58, v12, s[20:23], s17 offen
    buffer_load_dword v59, v13, s[20:23], s17 offen
    s_waitcnt vmcnt(58)
    v_perm_b32 v5, v113, v112, s44
    v_perm_b32 v6, v113, v112, s45
    s_waitcnt vmcnt(56)
    v_perm_b32 v208, v115, v114, v11
    v_accvgpr_write_b32 a160, v5
    v_accvgpr_write_b32 a164, v6
    s_add_u32 s17, s49, 851328
    buffer_load_dword v60, v9, s[20:23], s17 offen
    buffer_load_dword v61, v10, s[20:23], s17 offen
    buffer_load_dword v62, v12, s[20:23], s17 offen
    buffer_load_dword v63, v13, s[20:23], s17 offen
    s_waitcnt vmcnt(58)
    v_perm_b32 v5, v117, v116, s44
    v_perm_b32 v6, v117, v116, s45
    s_waitcnt vmcnt(56)
    v_perm_b32 v209, v119, v118, v11
    v_accvgpr_write_b32 a161, v5
    v_accvgpr_write_b32 a165, v6
    s_add_u32 s17, s49, 884736
    buffer_load_dword v64, v9, s[20:23], s17 offen
    buffer_load_dword v65, v10, s[20:23], s17 offen
    buffer_load_dword v66, v12, s[20:23], s17 offen
    buffer_load_dword v67, v13, s[20:23], s17 offen
    s_waitcnt vmcnt(58)
    v_perm_b32 v5, v121, v120, s44
    v_perm_b32 v6, v121, v120, s45
    s_waitcnt vmcnt(56)
    v_perm_b32 v210, v123, v122, v11
    v_accvgpr_write_b32 a162, v5
    v_accvgpr_write_b32 a166, v6
    s_add_u32 s17, s49, 885888
    buffer_load_dword v68, v9, s[20:23], s17 offen
    buffer_load_dword v69, v10, s[20:23], s17 offen
    buffer_load_dword v70, v12, s[20:23], s17 offen
    buffer_load_dword v71, v13, s[20:23], s17 offen
    s_waitcnt vmcnt(58)
    v_perm_b32 v5, v125, v124, s44
    v_perm_b32 v6, v125, v124, s45
    s_waitcnt vmcnt(56)
    v_perm_b32 v211, v127, v126, v11
    v_accvgpr_write_b32 a163, v5
    v_accvgpr_write_b32 a167, v6
    s_add_u32 s17, s49, 887040
    buffer_load_dword v72, v9, s[20:23], s17 offen
    buffer_load_dword v73, v10, s[20:23], s17 offen
    buffer_load_dword v74, v12, s[20:23], s17 offen
    buffer_load_dword v75, v13, s[20:23], s17 offen
    s_waitcnt vmcnt(58)
    v_perm_b32 v5, v17, v16, s44
    v_perm_b32 v6, v17, v16, s45
    s_waitcnt vmcnt(56)
    v_perm_b32 v212, v19, v18, v11
    v_accvgpr_write_b32 a168, v5
    v_accvgpr_write_b32 a172, v6
    s_add_u32 s17, s49, 888192
    buffer_load_dword v76, v9, s[20:23], s17 offen
    buffer_load_dword v77, v10, s[20:23], s17 offen
    buffer_load_dword v78, v12, s[20:23], s17 offen
    buffer_load_dword v79, v13, s[20:23], s17 offen
    s_waitcnt vmcnt(58)
    v_perm_b32 v5, v21, v20, s44
    v_perm_b32 v6, v21, v20, s45
    s_waitcnt vmcnt(56)
    v_perm_b32 v213, v23, v22, v11
    v_accvgpr_write_b32 a169, v5
    v_accvgpr_write_b32 a173, v6
    s_add_u32 s17, s49, 921600
    buffer_load_dword v80, v9, s[20:23], s17 offen
    buffer_load_dword v81, v10, s[20:23], s17 offen
    buffer_load_dword v82, v12, s[20:23], s17 offen
    buffer_load_dword v83, v13, s[20:23], s17 offen
    s_waitcnt vmcnt(58)
    v_perm_b32 v5, v25, v24, s44
    v_perm_b32 v6, v25, v24, s45
    s_waitcnt vmcnt(56)
    v_perm_b32 v214, v27, v26, v11
    v_accvgpr_write_b32 a170, v5
    v_accvgpr_write_b32 a174, v6
    s_add_u32 s17, s49, 922752
    buffer_load_dword v84, v9, s[20:23], s17 offen
    buffer_load_dword v85, v10, s[20:23], s17 offen
    buffer_load_dword v86, v12, s[20:23], s17 offen
    buffer_load_dword v87, v13, s[20:23], s17 offen
    s_waitcnt vmcnt(58)
    v_perm_b32 v5, v29, v28, s44
    v_perm_b32 v6, v29, v28, s45
    s_waitcnt vmcnt(56)
    v_perm_b32 v215, v31, v30, v11
    v_accvgpr_write_b32 a171, v5
    v_accvgpr_write_b32 a175, v6
    s_add_u32 s17, s49, 923904
    buffer_load_dword v88, v9, s[20:23], s17 offen
    buffer_load_dword v89, v10, s[20:23], s17 offen
    buffer_load_dword v90, v12, s[20:23], s17 offen
    buffer_load_dword v91, v13, s[20:23], s17 offen
    s_waitcnt vmcnt(58)
    v_perm_b32 v5, v33, v32, s44
    v_perm_b32 v6, v33, v32, s45
    s_waitcnt vmcnt(56)
    v_perm_b32 v216, v35, v34, v11
    v_accvgpr_write_b32 a176, v5
    v_accvgpr_write_b32 a180, v6
    s_add_u32 s17, s49, 925056
    buffer_load_dword v92, v9, s[20:23], s17 offen
    buffer_load_dword v93, v10, s[20:23], s17 offen
    buffer_load_dword v94, v12, s[20:23], s17 offen
    buffer_load_dword v95, v13, s[20:23], s17 offen
    s_waitcnt vmcnt(58)
    v_perm_b32 v5, v37, v36, s44
    v_perm_b32 v6, v37, v36, s45
    s_waitcnt vmcnt(56)
    v_perm_b32 v217, v39, v38, v11
    v_accvgpr_write_b32 a177, v5
    v_accvgpr_write_b32 a181, v6
    s_add_u32 s17, s49, 958464
    buffer_load_dword v96, v9, s[20:23], s17 offen
    buffer_load_dword v97, v10, s[20:23], s17 offen
    buffer_load_dword v98, v12, s[20:23], s17 offen
    buffer_load_dword v99, v13, s[20:23], s17 offen
    s_waitcnt vmcnt(58)
    v_perm_b32 v5, v41, v40, s44
    v_perm_b32 v6, v41, v40, s45
    s_waitcnt vmcnt(56)
    v_perm_b32 v218, v43, v42, v11
    v_accvgpr_write_b32 a178, v5
    v_accvgpr_write_b32 a182, v6
    s_add_u32 s17, s49, 959616
    buffer_load_dword v100, v9, s[20:23], s17 offen
    buffer_load_dword v101, v10, s[20:23], s17 offen
    buffer_load_dword v102, v12, s[20:23], s17 offen
    buffer_load_dword v103, v13, s[20:23], s17 offen
    s_waitcnt vmcnt(58)
    v_perm_b32 v5, v45, v44, s44
    v_perm_b32 v6, v45, v44, s45
    s_waitcnt vmcnt(56)
    v_perm_b32 v219, v47, v46, v11
    v_accvgpr_write_b32 a179, v5
    v_accvgpr_write_b32 a183, v6
    s_add_u32 s17, s49, 960768
    buffer_load_dword v104, v9, s[20:23], s17 offen
    buffer_load_dword v105, v10, s[20:23], s17 offen
    buffer_load_dword v106, v12, s[20:23], s17 offen
    buffer_load_dword v107, v13, s[20:23], s17 offen
    s_waitcnt vmcnt(58)
    v_perm_b32 v5, v49, v48, s44
    v_perm_b32 v6, v49, v48, s45
    s_waitcnt vmcnt(56)
    v_perm_b32 v220, v51, v50, v11
    v_accvgpr_write_b32 a184, v5
    v_accvgpr_write_b32 a188, v6
    s_add_u32 s17, s49, 961920
    buffer_load_dword v108, v9, s[20:23], s17 offen
    buffer_load_dword v109, v10, s[20:23], s17 offen
    buffer_load_dword v110, v12, s[20:23], s17 offen
    buffer_load_dword v111, v13, s[20:23], s17 offen
    s_waitcnt vmcnt(58)
    v_perm_b32 v5, v53, v52, s44
    v_perm_b32 v6, v53, v52, s45
    s_waitcnt vmcnt(56)
    v_perm_b32 v221, v55, v54, v11
    v_accvgpr_write_b32 a185, v5
    v_accvgpr_write_b32 a189, v6
    s_add_u32 s17, s49, 995328
    buffer_load_dword v112, v9, s[20:23], s17 offen
    buffer_load_dword v113, v10, s[20:23], s17 offen
    buffer_load_dword v114, v12, s[20:23], s17 offen
    buffer_load_dword v115, v13, s[20:23], s17 offen
    s_waitcnt vmcnt(58)
    v_perm_b32 v5, v57, v56, s44
    v_perm_b32 v6, v57, v56, s45
    s_waitcnt vmcnt(56)
    v_perm_b32 v222, v59, v58, v11
    v_accvgpr_write_b32 a186, v5
    v_accvgpr_write_b32 a190, v6
    s_add_u32 s17, s49, 996480
    buffer_load_dword v116, v9, s[20:23], s17 offen
    buffer_load_dword v117, v10, s[20:23], s17 offen
    buffer_load_dword v118, v12, s[20:23], s17 offen
    buffer_load_dword v119, v13, s[20:23], s17 offen
    s_waitcnt vmcnt(58)
    v_perm_b32 v5, v61, v60, s44
    v_perm_b32 v6, v61, v60, s45
    s_waitcnt vmcnt(56)
    v_perm_b32 v223, v63, v62, v11
    v_accvgpr_write_b32 a187, v5
    v_accvgpr_write_b32 a191, v6
    s_add_u32 s17, s49, 997632
    buffer_load_dword v120, v9, s[20:23], s17 offen
    buffer_load_dword v121, v10, s[20:23], s17 offen
    buffer_load_dword v122, v12, s[20:23], s17 offen
    buffer_load_dword v123, v13, s[20:23], s17 offen
    s_waitcnt vmcnt(58)
    v_perm_b32 v5, v65, v64, s44
    v_perm_b32 v6, v65, v64, s45
    s_waitcnt vmcnt(56)
    v_perm_b32 v224, v67, v66, v11
    v_accvgpr_write_b32 a192, v5
    v_accvgpr_write_b32 a196, v6
    s_add_u32 s17, s49, 998784
    buffer_load_dword v124, v9, s[20:23], s17 offen
    buffer_load_dword v125, v10, s[20:23], s17 offen
    buffer_load_dword v126, v12, s[20:23], s17 offen
    buffer_load_dword v127, v13, s[20:23], s17 offen
    s_waitcnt vmcnt(58)
    v_perm_b32 v5, v69, v68, s44
    v_perm_b32 v6, v69, v68, s45
    s_waitcnt vmcnt(56)
    v_perm_b32 v225, v71, v70, v11
    v_accvgpr_write_b32 a193, v5
    v_accvgpr_write_b32 a197, v6
    s_add_u32 s17, s49, 1032192
    buffer_load_dword v16, v9, s[20:23], s17 offen
    buffer_load_dword v17, v10, s[20:23], s17 offen
    buffer_load_dword v18, v12, s[20:23], s17 offen
    buffer_load_dword v19, v13, s[20:23], s17 offen
    s_waitcnt vmcnt(58)
    v_perm_b32 v5, v73, v72, s44
    v_perm_b32 v6, v73, v72, s45
    s_waitcnt vmcnt(56)
    v_perm_b32 v226, v75, v74, v11
    v_accvgpr_write_b32 a194, v5
    v_accvgpr_write_b32 a198, v6
    s_add_u32 s17, s49, 1033344
    buffer_load_dword v20, v9, s[20:23], s17 offen
    buffer_load_dword v21, v10, s[20:23], s17 offen
    buffer_load_dword v22, v12, s[20:23], s17 offen
    buffer_load_dword v23, v13, s[20:23], s17 offen
    s_waitcnt vmcnt(58)
    v_perm_b32 v5, v77, v76, s44
    v_perm_b32 v6, v77, v76, s45
    s_waitcnt vmcnt(56)
    v_perm_b32 v227, v79, v78, v11
    v_accvgpr_write_b32 a195, v5
    v_accvgpr_write_b32 a199, v6
    s_add_u32 s17, s49, 1034496
    buffer_load_dword v24, v9, s[20:23], s17 offen
    buffer_load_dword v25, v10, s[20:23], s17 offen
    buffer_load_dword v26, v12, s[20:23], s17 offen
    buffer_load_dword v27, v13, s[20:23], s17 offen
    s_waitcnt vmcnt(58)
    v_perm_b32 v5, v81, v80, s44
    v_perm_b32 v6, v81, v80, s45
    s_waitcnt vmcnt(56)
    v_perm_b32 v228, v83, v82, v11
    v_accvgpr_write_b32 a200, v5
    v_accvgpr_write_b32 a204, v6
    s_add_u32 s17, s49, 1035648
    buffer_load_dword v28, v9, s[20:23], s17 offen
    buffer_load_dword v29, v10, s[20:23], s17 offen
    buffer_load_dword v30, v12, s[20:23], s17 offen
    buffer_load_dword v31, v13, s[20:23], s17 offen
    s_waitcnt vmcnt(58)
    v_perm_b32 v5, v85, v84, s44
    v_perm_b32 v6, v85, v84, s45
    s_waitcnt vmcnt(56)
    v_perm_b32 v229, v87, v86, v11
    v_accvgpr_write_b32 a201, v5
    v_accvgpr_write_b32 a205, v6
    s_add_u32 s17, s49, 1069056
    buffer_load_dword v32, v9, s[20:23], s17 offen
    buffer_load_dword v33, v10, s[20:23], s17 offen
    buffer_load_dword v34, v12, s[20:23], s17 offen
    buffer_load_dword v35, v13, s[20:23], s17 offen
    s_waitcnt vmcnt(58)
    v_perm_b32 v5, v89, v88, s44
    v_perm_b32 v6, v89, v88, s45
    s_waitcnt vmcnt(56)
    v_perm_b32 v230, v91, v90, v11
    v_accvgpr_write_b32 a202, v5
    v_accvgpr_write_b32 a206, v6
    s_add_u32 s17, s49, 1070208
    buffer_load_dword v36, v9, s[20:23], s17 offen
    buffer_load_dword v37, v10, s[20:23], s17 offen
    buffer_load_dword v38, v12, s[20:23], s17 offen
    buffer_load_dword v39, v13, s[20:23], s17 offen
    s_waitcnt vmcnt(58)
    v_perm_b32 v5, v93, v92, s44
    v_perm_b32 v6, v93, v92, s45
    s_waitcnt vmcnt(56)
    v_perm_b32 v231, v95, v94, v11
    v_accvgpr_write_b32 a203, v5
    v_accvgpr_write_b32 a207, v6
    s_add_u32 s17, s49, 1071360
    buffer_load_dword v40, v9, s[20:23], s17 offen
    buffer_load_dword v41, v10, s[20:23], s17 offen
    buffer_load_dword v42, v12, s[20:23], s17 offen
    buffer_load_dword v43, v13, s[20:23], s17 offen
    s_waitcnt vmcnt(58)
    v_perm_b32 v5, v97, v96, s44
    v_perm_b32 v6, v97, v96, s45
    s_waitcnt vmcnt(56)
    v_perm_b32 v232, v99, v98, v11
    v_accvgpr_write_b32 a208, v5
    v_accvgpr_write_b32 a212, v6
    s_add_u32 s17, s49, 1072512
    buffer_load_dword v44, v9, s[20:23], s17 offen
    buffer_load_dword v45, v10, s[20:23], s17 offen
    buffer_load_dword v46, v12, s[20:23], s17 offen
    buffer_load_dword v47, v13, s[20:23], s17 offen
    s_waitcnt vmcnt(58)
    v_perm_b32 v5, v101, v100, s44
    v_perm_b32 v6, v101, v100, s45
    s_waitcnt vmcnt(56)
    v_perm_b32 v233, v103, v102, v11
    v_accvgpr_write_b32 a209, v5
    v_accvgpr_write_b32 a213, v6
    s_add_u32 s17, s49, 1105920
    buffer_load_dword v48, v9, s[20:23], s17 offen
    buffer_load_dword v49, v10, s[20:23], s17 offen
    buffer_load_dword v50, v12, s[20:23], s17 offen
    buffer_load_dword v51, v13, s[20:23], s17 offen
    s_waitcnt vmcnt(58)
    v_perm_b32 v5, v105, v104, s44
    v_perm_b32 v6, v105, v104, s45
    s_waitcnt vmcnt(56)
    v_perm_b32 v234, v107, v106, v11
    v_accvgpr_write_b32 a210, v5
    v_accvgpr_write_b32 a214, v6
    s_add_u32 s17, s49, 1107072
    buffer_load_dword v52, v9, s[20:23], s17 offen
    buffer_load_dword v53, v10, s[20:23], s17 offen
    buffer_load_dword v54, v12, s[20:23], s17 offen
    buffer_load_dword v55, v13, s[20:23], s17 offen
    s_waitcnt vmcnt(58)
    v_perm_b32 v5, v109, v108, s44
    v_perm_b32 v6, v109, v108, s45
    s_waitcnt vmcnt(56)
    v_perm_b32 v235, v111, v110, v11
    v_accvgpr_write_b32 a211, v5
    v_accvgpr_write_b32 a215, v6
    s_add_u32 s17, s49, 1108224
    buffer_load_dword v56, v9, s[20:23], s17 offen
    buffer_load_dword v57, v10, s[20:23], s17 offen
    buffer_load_dword v58, v12, s[20:23], s17 offen
    buffer_load_dword v59, v13, s[20:23], s17 offen
    s_waitcnt vmcnt(58)
    v_perm_b32 v5, v113, v112, s44
    v_perm_b32 v6, v113, v112, s45
    s_waitcnt vmcnt(56)
    v_perm_b32 v236, v115, v114, v11
    v_accvgpr_write_b32 a216, v5
    v_accvgpr_write_b32 a220, v6
    s_add_u32 s17, s49, 1109376
    buffer_load_dword v60, v9, s[20:23], s17 offen
    buffer_load_dword v61, v10, s[20:23], s17 offen
    buffer_load_dword v62, v12, s[20:23], s17 offen
    buffer_load_dword v63, v13, s[20:23], s17 offen
    s_waitcnt vmcnt(58)
    v_perm_b32 v5, v117, v116, s44
    v_perm_b32 v6, v117, v116, s45
    s_waitcnt vmcnt(56)
    v_perm_b32 v237, v119, v118, v11
    v_accvgpr_write_b32 a217, v5
    v_accvgpr_write_b32 a221, v6
    s_add_u32 s17, s49, 1142784
    buffer_load_dword v64, v9, s[20:23], s17 offen
    buffer_load_dword v65, v10, s[20:23], s17 offen
    buffer_load_dword v66, v12, s[20:23], s17 offen
    buffer_load_dword v67, v13, s[20:23], s17 offen
    s_waitcnt vmcnt(58)
    v_perm_b32 v5, v121, v120, s44
    v_perm_b32 v6, v121, v120, s45
    s_waitcnt vmcnt(56)
    v_perm_b32 v238, v123, v122, v11
    v_accvgpr_write_b32 a218, v5
    v_accvgpr_write_b32 a222, v6
    s_add_u32 s17, s49, 1143936
    buffer_load_dword v68, v9, s[20:23], s17 offen
    buffer_load_dword v69, v10, s[20:23], s17 offen
    buffer_load_dword v70, v12, s[20:23], s17 offen
    buffer_load_dword v71, v13, s[20:23], s17 offen
    s_waitcnt vmcnt(58)
    v_perm_b32 v5, v125, v124, s44
    v_perm_b32 v6, v125, v124, s45
    s_waitcnt vmcnt(56)
    v_perm_b32 v239, v127, v126, v11
    v_accvgpr_write_b32 a219, v5
    v_accvgpr_write_b32 a223, v6
    s_add_u32 s17, s49, 1145088
    buffer_load_dword v72, v9, s[20:23], s17 offen
    buffer_load_dword v73, v10, s[20:23], s17 offen
    buffer_load_dword v74, v12, s[20:23], s17 offen
    buffer_load_dword v75, v13, s[20:23], s17 offen
    s_waitcnt vmcnt(58)
    v_perm_b32 v5, v17, v16, s44
    v_perm_b32 v6, v17, v16, s45
    s_waitcnt vmcnt(56)
    v_perm_b32 v240, v19, v18, v11
    v_accvgpr_write_b32 a224, v5
    v_accvgpr_write_b32 a228, v6
    s_add_u32 s17, s49, 1146240
    buffer_load_dword v76, v9, s[20:23], s17 offen
    buffer_load_dword v77, v10, s[20:23], s17 offen
    buffer_load_dword v78, v12, s[20:23], s17 offen
    buffer_load_dword v79, v13, s[20:23], s17 offen
    s_waitcnt vmcnt(58)
    v_perm_b32 v5, v21, v20, s44
    v_perm_b32 v6, v21, v20, s45
    s_waitcnt vmcnt(56)
    v_perm_b32 v241, v23, v22, v11
    v_accvgpr_write_b32 a225, v5
    v_accvgpr_write_b32 a229, v6
    s_waitcnt vmcnt(54)
    v_perm_b32 v5, v25, v24, s44
    v_perm_b32 v6, v25, v24, s45
    s_waitcnt vmcnt(52)
    v_perm_b32 v242, v27, v26, v11
    v_accvgpr_write_b32 a226, v5
    v_accvgpr_write_b32 a230, v6
    s_waitcnt vmcnt(50)
    v_perm_b32 v5, v29, v28, s44
    v_perm_b32 v6, v29, v28, s45
    s_waitcnt vmcnt(48)
    v_perm_b32 v243, v31, v30, v11
    v_accvgpr_write_b32 a227, v5
    v_accvgpr_write_b32 a231, v6
    s_waitcnt vmcnt(46)
    v_perm_b32 v5, v33, v32, s44
    v_perm_b32 v6, v33, v32, s45
    s_waitcnt vmcnt(44)
    v_perm_b32 v244, v35, v34, v11
    v_accvgpr_write_b32 a232, v5
    v_accvgpr_write_b32 a236, v6
    s_waitcnt vmcnt(42)
    v_perm_b32 v5, v37, v36, s44
    v_perm_b32 v6, v37, v36, s45
    s_waitcnt vmcnt(40)
    v_perm_b32 v245, v39, v38, v11
    v_accvgpr_write_b32 a233, v5
    v_accvgpr_write_b32 a237, v6
    s_waitcnt vmcnt(38)
    v_perm_b32 v5, v41, v40, s44
    v_perm_b32 v6, v41, v40, s45
    s_waitcnt vmcnt(36)
    v_perm_b32 v246, v43, v42, v11
    v_accvgpr_write_b32 a234, v5
    v_accvgpr_write_b32 a238, v6
    s_waitcnt vmcnt(34)
    v_perm_b32 v5, v45, v44, s44
    v_perm_b32 v6, v45, v44, s45
    s_waitcnt vmcnt(32)
    v_perm_b32 v247, v47, v46, v11
    v_accvgpr_write_b32 a235, v5
    v_accvgpr_write_b32 a239, v6
    s_waitcnt vmcnt(30)
    v_perm_b32 v5, v49, v48, s44
    v_perm_b32 v6, v49, v48, s45
    s_waitcnt vmcnt(28)
    v_perm_b32 v248, v51, v50, v11
    v_accvgpr_write_b32 a240, v5
    v_accvgpr_write_b32 a244, v6
    s_waitcnt vmcnt(26)
    v_perm_b32 v5, v53, v52, s44
    v_perm_b32 v6, v53, v52, s45
    s_waitcnt vmcnt(24)
    v_perm_b32 v249, v55, v54, v11
    v_accvgpr_write_b32 a241, v5
    v_accvgpr_write_b32 a245, v6
    s_waitcnt vmcnt(22)
    v_perm_b32 v5, v57, v56, s44
    v_perm_b32 v6, v57, v56, s45
    s_waitcnt vmcnt(20)
    v_perm_b32 v250, v59, v58, v11
    v_accvgpr_write_b32 a242, v5
    v_accvgpr_write_b32 a246, v6
    s_waitcnt vmcnt(18)
    v_perm_b32 v5, v61, v60, s44
    v_perm_b32 v6, v61, v60, s45
    s_waitcnt vmcnt(16)
    v_perm_b32 v251, v63, v62, v11
    v_accvgpr_write_b32 a243, v5
    v_accvgpr_write_b32 a247, v6
    s_waitcnt vmcnt(14)
    v_perm_b32 v5, v65, v64, s44
    v_perm_b32 v6, v65, v64, s45
    s_waitcnt vmcnt(12)
    v_perm_b32 v252, v67, v66, v11
    v_accvgpr_write_b32 a248, v5
    v_accvgpr_write_b32 a252, v6
    s_waitcnt vmcnt(10)
    v_perm_b32 v5, v69, v68, s44
    v_perm_b32 v6, v69, v68, s45
    s_waitcnt vmcnt(8)
    v_perm_b32 v253, v71, v70, v11
    v_accvgpr_write_b32 a249, v5
    v_accvgpr_write_b32 a253, v6
    s_waitcnt vmcnt(6)
    v_perm_b32 v5, v73, v72, s44
    v_perm_b32 v6, v73, v72, s45
    s_waitcnt vmcnt(4)
    v_perm_b32 v254, v75, v74, v11
    v_accvgpr_write_b32 a250, v5
    v_accvgpr_write_b32 a254, v6
    s_waitcnt vmcnt(2)
    v_perm_b32 v5, v77, v76, s44
    v_perm_b32 v6, v77, v76, s45
    s_waitcnt vmcnt(0)
    v_perm_b32 v255, v79, v78, v11
    v_accvgpr_write_b32 a251, v5
    v_accvgpr_write_b32 a255, v6
    s_and_b32 s51, s14, 1
    s_lshl_b32 s17, s51, 4
    v_add_u32 v5, s17, v7
    v_lshlrev_b32 v14, 4, v5
    v_mul_u32_u24 v13, 1152, v5
    s_mul_i32 s17, s50, 96
    v_add_u32 v13, s17, v13
    s_mul_i32 s17, s50, 3072
    v_add_u32 v12, s17, v14
    s_lshl_b32 s17, s50, 9
    v_add_u32 v14, s17, v14
    s_lshl_b32 s49, s50, 7
    s_lshl_b32 s17, s14, 2
    s_add_u32 s49, s49, s17
    s_add_u32 s49, s49, 1441792
    s_mul_i32 s17, s14, 6144
    v_add_u32 v48, s17, v0
    v_mov_b32 v49, 0x10000
    s_cmp_gt_u32 s14, 1
    s_cbranch_scc1 Ltw_z
    v_lshl_add_u32 v12, v8, 9, v12
    v_lshl_add_u32 v13, v8, 4, v13
    s_lshl_b32 s58, s14, 16
    s_add_u32 s58, s58, 144703488
    s_mov_b32 s43, 0
    s_mov_b32 s28, s8
    s_mov_b32 s29, s9
    s_mov_b32 s30, 0
    s_mov_b32 s31, 0x00020000
    s_mul_i32 s17, s51, 3072
    v_add_u32 v50, s17, v0
    ds_write2_b32 v49, v4, v4 offset0:0 offset1:1
    s_waitcnt lgkmcnt(0)
    s_cmp_lg_u32 s14, 0
    s_cbranch_scc1 LtwX_ini_d
    v_mov_b32 v5, 160
    s_mov_b32 s16, 0
LtwX_ini:
    global_load_dword v6, v5, s[12:13] sc1
    s_add_u32 s16, s16, 1
    s_cmp_gt_u32 s16, 100000
    s_cbranch_scc1 L_role_tw_abort
    s_waitcnt vmcnt(0)
    v_cmp_gt_u32 vcc, 192, v6
    s_nop 0
    s_cbranch_vccz LtwX_ini_d
    s_sleep 8
    s_branch LtwX_ini
LtwX_ini_d:
    s_barrier
LtwX_idle:
    s_cmp_lg_u32 s14, 0
    s_cbranch_scc1 LtwX_nw0
    s_mul_i32 s60, s32, 22528
    s_add_u32 s60, s60, 4224
    s_cmp_lt_u32 s32, 64
    s_cselect_b32 s60, s60, 2883584
    s_mul_i32 s61, s33, 22528
    s_add_u32 s61, s61, 1446016
    s_cmp_lt_u32 s33, 64
    s_cselect_b32 s61, s61, 2883584
    s_mov_b32 s16, 0
LtwX_p_21:
    buffer_load_dword v2, v1, s[8:11], s60 offen sc1
    buffer_load_dword v15, v1, s[8:11], s61 offen sc1
    s_add_u32 s16, s16, 1
    s_cmp_gt_u32 s16, 100000
    s_cbranch_scc1 L_role_tw_abort
    s_waitcnt vmcnt(1)
    v_cmp_eq_u32 vcc, 0, v2
    s_waitcnt vmcnt(0)
    v_cmp_eq_u32 s[54:55], 0, v15
    s_nop 0
    s_cmp_eq_u64 s[54:55], 0
    s_cselect_b32 s62, 2, 0
    s_cmp_eq_u64 vcc, 0
    s_cselect_b32 s62, 1, s62
    s_cmp_lg_u32 s62, 0
    s_cbranch_scc1 LtwX_p_21d
    s_sleep 4
    s_branch LtwX_p_21
LtwX_p_21d:
    v_mov_b32 v5, s62
    ds_write_b32 v49, v5
    s_waitcnt lgkmcnt(0)
LtwX_nw0:
    s_barrier
    ds_read_b32 v6, v49
    v_xor_b32 v49, 4, v49
    s_waitcnt lgkmcnt(0)
    v_readfirstlane_b32 s62, v6
    s_nop 0
    s_cmp_eq_u32 s62, 0
    s_cbranch_scc1 L_role_tw_abort
    s_cmp_lt_u32 s33, 29
    s_cselect_b32 s38, 1, 3
    s_cmp_eq_u32 s62, 2
    s_cselect_b32 s36, 1, 0
    s_cselect_b32 s37, s33, s32
    s_cselect_b32 s17, s38, 0
    s_add_u32 s33, s33, s17
    s_cmp_eq_u32 s62, 1
    s_cselect_b32 s17, 2, 0
    s_add_u32 s32, s32, s17
    s_lshl_b32 s56, s36, 6
    s_add_u32 s56, s56, s37
    s_lshl_b32 s46, s56, 18
    s_add_u32 s46, s46, s58
    s_mul_i32 s41, s36, 4718592
    s_mul_i32 s17, s37, 36864
    s_add_u32 s41, s41, s17
    s_add_u32 s41, s41, 8650752
    s_cmp_ge_u32 s37, 64
    s_cbranch_scc1 L_role_tw_abort
    s_add_u32 s48, s46, 0
    buffer_load_dwordx4 v[64:67], v0, s[8:11], s48 offen offset:0
    buffer_load_dwordx4 v[68:71], v0, s[8:11], s48 offen offset:1024
    buffer_load_dwordx4 v[72:75], v0, s[8:11], s48 offen offset:2048
    buffer_load_dwordx4 v[76:79], v0, s[8:11], s48 offen offset:3072
    s_add_u32 s48, s46, 4096
    buffer_load_dwordx4 v[80:83], v0, s[8:11], s48 offen offset:0
    buffer_load_dwordx4 v[84:87], v0, s[8:11], s48 offen offset:1024
    buffer_load_dwordx4 v[88:91], v0, s[8:11], s48 offen offset:2048
    buffer_load_dwordx4 v[92:95], v0, s[8:11], s48 offen offset:3072
    s_add_u32 s48, s46, 8192
    buffer_load_dwordx4 v[96:99], v0, s[8:11], s48 offen offset:0
    buffer_load_dwordx4 v[100:103], v0, s[8:11], s48 offen offset:1024
    buffer_load_dwordx4 v[104:107], v0, s[8:11], s48 offen offset:2048
    buffer_load_dwordx4 v[108:111], v0, s[8:11], s48 offen offset:3072
    s_add_u32 s48, s46, 12288
    buffer_load_dwordx4 v[112:115], v0, s[8:11], s48 offen offset:0
    buffer_load_dwordx4 v[116:119], v0, s[8:11], s48 offen offset:1024
    buffer_load_dwordx4 v[120:123], v0, s[8:11], s48 offen offset:2048
    buffer_load_dwordx4 v[40:43], v12, s[8:11], s41 offen
LtwX_item:
    s_mov_b32 s34, s36
    s_mov_b32 s35, s37
    s_mov_b32 s47, s41
    buffer_load_dwordx4 v[124:127], v0, s[8:11], s48 offen offset:3072
    s_waitcnt vmcnt(16)
    v_mfma_f32_16x16x32_bf16 v[16:19], a[0:3], v[64:67], 0
    v_mfma_f32_16x16x32_bf16 v[20:23], a[4:7], v[64:67], 0
    v_mfma_f32_16x16x32_bf16 v[24:27], v[128:131], v[64:67], 0
    s_add_u32 s48, s46, 16384
    buffer_load_dwordx4 v[64:67], v0, s[8:11], s48 offen offset:0
    s_waitcnt vmcnt(16)
    v_mfma_f32_16x16x32_bf16 v[28:31], a[0:3], v[68:71], 0
    v_mfma_f32_16x16x32_bf16 v[32:35], a[4:7], v[68:71], 0
    v_mfma_f32_16x16x32_bf16 v[36:39], v[128:131], v[68:71], 0
    buffer_load_dwordx4 v[68:71], v0, s[8:11], s48 offen offset:1024
    s_waitcnt vmcnt(16)
    v_mfma_f32_16x16x32_bf16 v[16:19], a[8:11], v[72:75], v[16:19]
    v_mfma_f32_16x16x32_bf16 v[20:23], a[12:15], v[72:75], v[20:23]
    v_mfma_f32_16x16x32_bf16 v[24:27], v[132:135], v[72:75], v[24:27]
    buffer_load_dwordx4 v[72:75], v0, s[8:11], s48 offen offset:2048
    s_waitcnt vmcnt(16)
    v_mfma_f32_16x16x32_bf16 v[28:31], a[8:11], v[76:79], v[28:31]
    v_mfma_f32_16x16x32_bf16 v[32:35], a[12:15], v[76:79], v[32:35]
    v_mfma_f32_16x16x32_bf16 v[36:39], v[132:135], v[76:79], v[36:39]
    buffer_load_dwordx4 v[76:79], v0, s[8:11], s48 offen offset:3072
    s_waitcnt vmcnt(16)
    v_mfma_f32_16x16x32_bf16 v[16:19], a[16:19], v[80:83], v[16:19]
    v_mfma_f32_16x16x32_bf16 v[20:23], a[20:23], v[80:83], v[20:23]
    v_mfma_f32_16x16x32_bf16 v[24:27], v[136:139], v[80:83], v[24:27]
    s_add_u32 s48, s46, 20480
    buffer_load_dwordx4 v[80:83], v0, s[8:11], s48 offen offset:0
    s_waitcnt vmcnt(16)
    v_mfma_f32_16x16x32_bf16 v[28:31], a[16:19], v[84:87], v[28:31]
    v_mfma_f32_16x16x32_bf16 v[32:35], a[20:23], v[84:87], v[32:35]
    v_mfma_f32_16x16x32_bf16 v[36:39], v[136:139], v[84:87], v[36:39]
    buffer_load_dwordx4 v[84:87], v0, s[8:11], s48 offen offset:1024
    s_waitcnt vmcnt(16)
    v_mfma_f32_16x16x32_bf16 v[16:19], a[24:27], v[88:91], v[16:19]
    v_mfma_f32_16x16x32_bf16 v[20:23], a[28:31], v[88:91], v[20:23]
    v_mfma_f32_16x16x32_bf16 v[24:27], v[140:143], v[88:91], v[24:27]
    buffer_load_dwordx4 v[88:91], v0, s[8:11], s48 offen offset:2048
    s_waitcnt vmcnt(16)
    v_mfma_f32_16x16x32_bf16 v[28:31], a[24:27], v[92:95], v[28:31]
    v_mfma_f32_16x16x32_bf16 v[32:35], a[28:31], v[92:95], v[32:35]
    v_mfma_f32_16x16x32_bf16 v[36:39], v[140:143], v[92:95], v[36:39]
    buffer_load_dwordx4 v[92:95], v0, s[8:11], s48 offen offset:3072
    s_waitcnt vmcnt(16)
    v_mfma_f32_16x16x32_bf16 v[16:19], a[32:35], v[96:99], v[16:19]
    v_mfma_f32_16x16x32_bf16 v[20:23], a[36:39], v[96:99], v[20:23]
    v_mfma_f32_16x16x32_bf16 v[24:27], v[144:147], v[96:99], v[24:27]
    s_add_u32 s48, s46, 24576
    buffer_load_dwordx4 v[96:99], v0, s[8:11], s48 offen offset:0
    s_waitcnt vmcnt(16)
    v_mfma_f32_16x16x32_bf16 v[28:31], a[32:35], v[100:103], v[28:31]
    v_mfma_f32_16x16x32_bf16 v[32:35], a[36:39], v[100:103], v[32:35]
    v_mfma_f32_16x16x32_bf16 v[36:39], v[144:147], v[100:103], v[36:39]
    buffer_load_dwordx4 v[100:103], v0, s[8:11], s48 offen offset:1024
    s_waitcnt vmcnt(16)
    v_mfma_f32_16x16x32_bf16 v[16:19], a[40:43], v[104:107], v[16:19]
    v_mfma_f32_16x16x32_bf16 v[20:23], a[44:47], v[104:107], v[20:23]
    v_mfma_f32_16x16x32_bf16 v[24:27], v[148:151], v[104:107], v[24:27]
    buffer_load_dwordx4 v[104:107], v0, s[8:11], s48 offen offset:2048
    s_waitcnt vmcnt(16)
    v_mfma_f32_16x16x32_bf16 v[28:31], a[40:43], v[108:111], v[28:31]
    v_mfma_f32_16x16x32_bf16 v[32:35], a[44:47], v[108:111], v[32:35]
    v_mfma_f32_16x16x32_bf16 v[36:39], v[148:151], v[108:111], v[36:39]
    buffer_load_dwordx4 v[108:111], v0, s[8:11], s48 offen offset:3072
    s_waitcnt vmcnt(16)
    v_mfma_f32_16x16x32_bf16 v[16:19], a[48:51], v[112:115], v[16:19]
    v_mfma_f32_16x16x32_bf16 v[20:23], a[52:55], v[112:115], v[20:23]
    v_mfma_f32_16x16x32_bf16 v[24:27], v[152:155], v[112:115], v[24:27]
    s_add_u32 s48, s46, 28672
    buffer_load_dwordx4 v[112:115], v0, s[8:11], s48 offen offset:0
    s_waitcnt vmcnt(16)
    v_mfma_f32_16x16x32_bf16 v[28:31], a[48:51], v[116:119], v[28:31]
    v_mfma_f32_16x16x32_bf16 v[32:35], a[52:55], v[116:119], v[32:35]
    v_mfma_f32_16x16x32_bf16 v[36:39], v[152:155], v[116:119], v[36:39]
    buffer_load_dwordx4 v[116:119], v0, s[8:11], s48 offen offset:1024
    s_waitcnt vmcnt(16)
    v_mfma_f32_16x16x32_bf16 v[16:19], a[56:59], v[120:123], v[16:19]
    v_mfma_f32_16x16x32_bf16 v[20:23], a[60:63], v[120:123], v[20:23]
    v_mfma_f32_16x16x32_bf16 v[24:27], v[156:159], v[120:123], v[24:27]
    buffer_load_dwordx4 v[120:123], v0, s[8:11], s48 offen offset:2048
    s_waitcnt vmcnt(15)
    v_mfma_f32_16x16x32_bf16 v[28:31], a[56:59], v[124:127], v[28:31]
    v_mfma_f32_16x16x32_bf16 v[32:35], a[60:63], v[124:127], v[32:35]
    v_mfma_f32_16x16x32_bf16 v[36:39], v[156:159], v[124:127], v[36:39]
    buffer_load_dwordx4 v[124:127], v0, s[8:11], s48 offen offset:3072
    s_waitcnt vmcnt(15)
    v_mfma_f32_16x16x32_bf16 v[16:19], a[64:67], v[64:67], v[16:19]
    v_mfma_f32_16x16x32_bf16 v[20:23], a[68:71], v[64:67], v[20:23]
    v_mfma_f32_16x16x32_bf16 v[24:27], v[160:163], v[64:67], v[24:27]
    s_add_u32 s48, s46, 32768
    buffer_load_dwordx4 v[64:67], v0, s[8:11], s48 offen offset:0
    s_waitcnt vmcnt(15)
    v_mfma_f32_16x16x32_bf16 v[28:31], a[64:67], v[68:71], v[28:31]
    v_mfma_f32_16x16x32_bf16 v[32:35], a[68:71], v[68:71], v[32:35]
    v_mfma_f32_16x16x32_bf16 v[36:39], v[160:163], v[68:71], v[36:39]
    s_cmp_lg_u32 s43, 0
    s_cselect_b64 exec, 1, 0
    buffer_store_dword v3, v4, s[8:11], s43 offen sc1
    s_mov_b64 exec, -1
    s_mov_b32 s43, 0
    buffer_load_dwordx4 v[68:71], v0, s[8:11], s48 offen offset:1024
    s_waitcnt vmcnt(16)
    v_mfma_f32_16x16x32_bf16 v[16:19], a[72:75], v[72:75], v[16:19]
    v_mfma_f32_16x16x32_bf16 v[20:23], a[76:79], v[72:75], v[20:23]
    v_mfma_f32_16x16x32_bf16 v[24:27], v[164:167], v[72:75], v[24:27]
    buffer_load_dwordx4 v[72:75], v0, s[8:11], s48 offen offset:2048
    s_waitcnt vmcnt(16)
    v_mfma_f32_16x16x32_bf16 v[28:31], a[72:75], v[76:79], v[28:31]
    v_mfma_f32_16x16x32_bf16 v[32:35], a[76:79], v[76:79], v[32:35]
    v_mfma_f32_16x16x32_bf16 v[36:39], v[164:167], v[76:79], v[36:39]
    buffer_load_dwordx4 v[76:79], v0, s[8:11], s48 offen offset:3072
    s_waitcnt vmcnt(16)
    v_mfma_f32_16x16x32_bf16 v[16:19], a[80:83], v[80:83], v[16:19]
    v_mfma_f32_16x16x32_bf16 v[20:23], a[84:87], v[80:83], v[20:23]
    v_mfma_f32_16x16x32_bf16 v[24:27], v[168:171], v[80:83], v[24:27]
    s_add_u32 s48, s46, 36864
    buffer_load_dwordx4 v[80:83], v0, s[8:11], s48 offen offset:0
    s_waitcnt vmcnt(16)
    v_mfma_f32_16x16x32_bf16 v[28:31], a[80:83], v[84:87], v[28:31]
    v_mfma_f32_16x16x32_bf16 v[32:35], a[84:87], v[84:87], v[32:35]
    v_mfma_f32_16x16x32_bf16 v[36:39], v[168:171], v[84:87], v[36:39]
    buffer_load_dwordx4 v[84:87], v0, s[8:11], s48 offen offset:1024
    s_waitcnt vmcnt(16)
    v_mfma_f32_16x16x32_bf16 v[16:19], a[88:91], v[88:91], v[16:19]
    v_mfma_f32_16x16x32_bf16 v[20:23], a[92:95], v[88:91], v[20:23]
    v_mfma_f32_16x16x32_bf16 v[24:27], v[172:175], v[88:91], v[24:27]
    buffer_load_dwordx4 v[88:91], v0, s[8:11], s48 offen offset:2048
    s_waitcnt vmcnt(16)
    v_mfma_f32_16x16x32_bf16 v[28:31], a[88:91], v[92:95], v[28:31]
    v_mfma_f32_16x16x32_bf16 v[32:35], a[92:95], v[92:95], v[32:35]
    v_mfma_f32_16x16x32_bf16 v[36:39], v[172:175], v[92:95], v[36:39]
    buffer_load_dwordx4 v[92:95], v0, s[8:11], s48 offen offset:3072
    s_waitcnt vmcnt(16)
    v_mfma_f32_16x16x32_bf16 v[16:19], a[96:99], v[96:99], v[16:19]
    v_mfma_f32_16x16x32_bf16 v[20:23], a[100:103], v[96:99], v[20:23]
    v_mfma_f32_16x16x32_bf16 v[24:27], v[176:179], v[96:99], v[24:27]
    s_add_u32 s48, s46, 40960
    buffer_load_dwordx4 v[96:99], v0, s[8:11], s48 offen offset:0
    s_waitcnt vmcnt(16)
    v_mfma_f32_16x16x32_bf16 v[28:31], a[96:99], v[100:103], v[28:31]
    v_mfma_f32_16x16x32_bf16 v[32:35], a[100:103], v[100:103], v[32:35]
    v_mfma_f32_16x16x32_bf16 v[36:39], v[176:179], v[100:103], v[36:39]
    buffer_load_dwordx4 v[100:103], v0, s[8:11], s48 offen offset:1024
    s_waitcnt vmcnt(16)
    v_mfma_f32_16x16x32_bf16 v[16:19], a[104:107], v[104:107], v[16:19]
    v_mfma_f32_16x16x32_bf16 v[20:23], a[108:111], v[104:107], v[20:23]
    v_mfma_f32_16x16x32_bf16 v[24:27], v[180:183], v[104:107], v[24:27]
    s_cmp_lg_u32 s14, 0
    s_cbranch_scc1 LtwX_nw1
    s_mul_i32 s60, s32, 22528
    s_add_u32 s60, s60, 4224
    s_cmp_lt_u32 s32, 64
    s_cselect_b32 s60, s60, 2883584
    s_mul_i32 s61, s33, 22528
    s_add_u32 s61, s61, 1446016
    s_cmp_lt_u32 s33, 64
    s_cselect_b32 s61, s61, 2883584
    buffer_load_dword v2, v1, s[8:11], s60 offen sc1
    buffer_load_dword v15, v1, s[8:11], s61 offen sc1
LtwX_nw1:
    buffer_load_dwordx4 v[104:107], v0, s[8:11], s48 offen offset:2048
    s_waitcnt vmcnt(16)
    v_mfma_f32_16x16x32_bf16 v[28:31], a[104:107], v[108:111], v[28:31]
    v_mfma_f32_16x16x32_bf16 v[32:35], a[108:111], v[108:111], v[32:35]
    v_mfma_f32_16x16x32_bf16 v[36:39], v[180:183], v[108:111], v[36:39]
    buffer_load_dwordx4 v[108:111], v0, s[8:11], s48 offen offset:3072
    s_waitcnt vmcnt(16)
    v_mfma_f32_16x16x32_bf16 v[16:19], a[112:115], v[112:115], v[16:19]
    v_mfma_f32_16x16x32_bf16 v[20:23], a[116:119], v[112:115], v[20:23]
    v_mfma_f32_16x16x32_bf16 v[24:27], v[184:187], v[112:115], v[24:27]
    s_add_u32 s48, s46, 45056
    buffer_load_dwordx4 v[112:115], v0, s[8:11], s48 offen offset:0
    s_waitcnt vmcnt(16)
    v_mfma_f32_16x16x32_bf16 v[28:31], a[112:115], v[116:119], v[28:31]
    v_mfma_f32_16x16x32_bf16 v[32:35], a[116:119], v[116:119], v[32:35]
    v_mfma_f32_16x16x32_bf16 v[36:39], v[184:187], v[116:119], v[36:39]
    buffer_load_dwordx4 v[116:119], v0, s[8:11], s48 offen offset:1024
    s_waitcnt vmcnt(16)
    v_mfma_f32_16x16x32_bf16 v[16:19], a[120:123], v[120:123], v[16:19]
    v_mfma_f32_16x16x32_bf16 v[20:23], a[124:127], v[120:123], v[20:23]
    v_mfma_f32_16x16x32_bf16 v[24:27], v[188:191], v[120:123], v[24:27]
    buffer_load_dwordx4 v[120:123], v0, s[8:11], s48 offen offset:2048
    s_waitcnt vmcnt(16)
    v_mfma_f32_16x16x32_bf16 v[28:31], a[120:123], v[124:127], v[28:31]
    v_mfma_f32_16x16x32_bf16 v[32:35], a[124:127], v[124:127], v[32:35]
    v_mfma_f32_16x16x32_bf16 v[36:39], v[188:191], v[124:127], v[36:39]
    buffer_load_dwordx4 v[124:127], v0, s[8:11], s48 offen offset:3072
    s_waitcnt vmcnt(16)
    v_mfma_f32_16x16x32_bf16 v[16:19], a[128:131], v[64:67], v[16:19]
    v_mfma_f32_16x16x32_bf16 v[20:23], a[132:135], v[64:67], v[20:23]
    v_mfma_f32_16x16x32_bf16 v[24:27], v[192:195], v[64:67], v[24:27]
    s_add_u32 s48, s46, 49152
    buffer_load_dwordx4 v[64:67], v0, s[8:11], s48 offen offset:0
    s_waitcnt vmcnt(15)
    v_mfma_f32_16x16x32_bf16 v[28:31], a[128:131], v[68:71], v[28:31]
    v_mfma_f32_16x16x32_bf16 v[32:35], a[132:135], v[68:71], v[32:35]
    v_mfma_f32_16x16x32_bf16 v[36:39], v[192:195], v[68:71], v[36:39]
    buffer_load_dwordx4 v[68:71], v0, s[8:11], s48 offen offset:1024
    s_waitcnt vmcnt(15)
    v_mfma_f32_16x16x32_bf16 v[16:19], a[136:139], v[72:75], v[16:19]
    v_mfma_f32_16x16x32_bf16 v[20:23], a[140:143], v[72:75], v[20:23]
    v_mfma_f32_16x16x32_bf16 v[24:27], v[196:199], v[72:75], v[24:27]
    buffer_load_dwordx4 v[72:75], v0, s[8:11], s48 offen offset:2048
    s_waitcnt vmcnt(15)
    v_mfma_f32_16x16x32_bf16 v[28:31], a[136:139], v[76:79], v[28:31]
    v_mfma_f32_16x16x32_bf16 v[32:35], a[140:143], v[76:79], v[32:35]
    v_mfma_f32_16x16x32_bf16 v[36:39], v[196:199], v[76:79], v[36:39]
    buffer_load_dwordx4 v[76:79], v0, s[8:11], s48 offen offset:3072
    s_waitcnt vmcnt(15)
    v_mfma_f32_16x16x32_bf16 v[16:19], a[144:147], v[80:83], v[16:19]
    v_mfma_f32_16x16x32_bf16 v[20:23], a[148:151], v[80:83], v[20:23]
    v_mfma_f32_16x16x32_bf16 v[24:27], v[200:203], v[80:83], v[24:27]
    s_add_u32 s48, s46, 53248
    buffer_load_dwordx4 v[80:83], v0, s[8:11], s48 offen offset:0
    s_waitcnt vmcnt(15)
    v_mfma_f32_16x16x32_bf16 v[28:31], a[144:147], v[84:87], v[28:31]
    v_mfma_f32_16x16x32_bf16 v[32:35], a[148:151], v[84:87], v[32:35]
    v_mfma_f32_16x16x32_bf16 v[36:39], v[200:203], v[84:87], v[36:39]
    buffer_load_dwordx4 v[84:87], v0, s[8:11], s48 offen offset:1024
    s_waitcnt vmcnt(15)
    v_mfma_f32_16x16x32_bf16 v[16:19], a[152:155], v[88:91], v[16:19]
    v_mfma_f32_16x16x32_bf16 v[20:23], a[156:159], v[88:91], v[20:23]
    v_mfma_f32_16x16x32_bf16 v[24:27], v[204:207], v[88:91], v[24:27]
    buffer_load_dwordx4 v[88:91], v0, s[8:11], s48 offen offset:2048
    s_waitcnt vmcnt(15)
    v_mfma_f32_16x16x32_bf16 v[28:31], a[152:155], v[92:95], v[28:31]
    v_mfma_f32_16x16x32_bf16 v[32:35], a[156:159], v[92:95], v[32:35]
    v_mfma_f32_16x16x32_bf16 v[36:39], v[204:207], v[92:95], v[36:39]
    buffer_load_dwordx4 v[92:95], v0, s[8:11], s48 offen offset:3072
    s_waitcnt vmcnt(15)
    v_mfma_f32_16x16x32_bf16 v[16:19], a[160:163], v[96:99], v[16:19]
    v_mfma_f32_16x16x32_bf16 v[20:23], a[164:167], v[96:99], v[20:23]
    v_mfma_f32_16x16x32_bf16 v[24:27], v[208:211], v[96:99], v[24:27]
    s_add_u32 s48, s46, 57344
    buffer_load_dwordx4 v[96:99], v0, s[8:11], s48 offen offset:0
    s_waitcnt vmcnt(15)
    v_mfma_f32_16x16x32_bf16 v[28:31], a[160:163], v[100:103], v[28:31]
    v_mfma_f32_16x16x32_bf16 v[32:35], a[164:167], v[100:103], v[32:35]
    v_mfma_f32_16x16x32_bf16 v[36:39], v[208:211], v[100:103], v[36:39]
    buffer_load_dwordx4 v[100:103], v0, s[8:11], s48 offen offset:1024
    s_waitcnt vmcnt(15)
    v_mfma_f32_16x16x32_bf16 v[16:19], a[168:171], v[104:107], v[16:19]
    v_mfma_f32_16x16x32_bf16 v[20:23], a[172:175], v[104:107], v[20:23]
    v_mfma_f32_16x16x32_bf16 v[24:27], v[212:215], v[104:107], v[24:27]
    buffer_load_dwordx4 v[104:107], v0, s[8:11], s48 offen offset:2048
    s_waitcnt vmcnt(15)
    v_mfma_f32_16x16x32_bf16 v[28:31], a[168:171], v[108:111], v[28:31]
    v_mfma_f32_16x16x32_bf16 v[32:35], a[172:175], v[108:111], v[32:35]
    v_mfma_f32_16x16x32_bf16 v[36:39], v[212:215], v[108:111], v[36:39]
    buffer_load_dwordx4 v[108:111], v0, s[8:11], s48 offen offset:3072
    s_waitcnt vmcnt(15)
    v_mfma_f32_16x16x32_bf16 v[16:19], a[176:179], v[112:115], v[16:19]
    v_mfma_f32_16x16x32_bf16 v[20:23], a[180:183], v[112:115], v[20:23]
    v_mfma_f32_16x16x32_bf16 v[24:27], v[216:219], v[112:115], v[24:27]
    s_cmp_lg_u32 s14, 0
    s_cbranch_scc1 LtwX_nw2
    v_cmp_eq_u32 vcc, 0, v2
    v_cmp_eq_u32 s[54:55], 0, v15
    s_nop 0
    s_cmp_eq_u64 s[54:55], 0
    s_cselect_b32 s62, 2, 0
    s_cmp_eq_u64 vcc, 0
    s_cselect_b32 s62, 1, s62
    v_mov_b32 v5, s62
    ds_write_b32 v49, v5
    s_waitcnt lgkmcnt(0)
LtwX_nw2:
    s_barrier
    ds_read_b32 v6, v49
    v_xor_b32 v49, 4, v49
    s_add_u32 s48, s46, 61440
    buffer_load_dwordx4 v[112:115], v0, s[8:11], s48 offen offset:0
    s_waitcnt vmcnt(15)
    v_mfma_f32_16x16x32_bf16 v[28:31], a[176:179], v[116:119], v[28:31]
    v_mfma_f32_16x16x32_bf16 v[32:35], a[180:183], v[116:119], v[32:35]
    v_mfma_f32_16x16x32_bf16 v[36:39], v[216:219], v[116:119], v[36:39]
    buffer_load_dwordx4 v[116:119], v0, s[8:11], s48 offen offset:1024
    s_waitcnt vmcnt(15)
    v_mfma_f32_16x16x32_bf16 v[16:19], a[184:187], v[120:123], v[16:19]
    v_mfma_f32_16x16x32_bf16 v[20:23], a[188:191], v[120:123], v[20:23]
    v_mfma_f32_16x16x32_bf16 v[24:27], v[220:223], v[120:123], v[24:27]
    buffer_load_dwordx4 v[120:123], v0, s[8:11], s48 offen offset:2048
    s_waitcnt vmcnt(15)
    v_mfma_f32_16x16x32_bf16 v[28:31], a[184:187], v[124:127], v[28:31]
    v_mfma_f32_16x16x32_bf16 v[32:35], a[188:191], v[124:127], v[32:35]
    v_mfma_f32_16x16x32_bf16 v[36:39], v[220:223], v[124:127], v[36:39]
    s_waitcnt lgkmcnt(0)
    v_readfirstlane_b32 s62, v6
    s_cmp_lt_u32 s33, 29
    s_cselect_b32 s38, 1, 3
    s_cmp_eq_u32 s62, 2
    s_cselect_b32 s36, 1, 0
    s_cselect_b32 s37, s33, s32
    s_cselect_b32 s17, s38, 0
    s_add_u32 s33, s33, s17
    s_cmp_eq_u32 s62, 1
    s_cselect_b32 s17, 2, 0
    s_add_u32 s32, s32, s17
    s_lshl_b32 s56, s36, 6
    s_add_u32 s56, s56, s37
    buffer_load_dwordx4 v[124:127], v0, s[8:11], s48 offen offset:3072
    s_waitcnt vmcnt(15)
    v_mfma_f32_16x16x32_bf16 v[16:19], a[192:195], v[64:67], v[16:19]
    v_mfma_f32_16x16x32_bf16 v[20:23], a[196:199], v[64:67], v[20:23]
    v_mfma_f32_16x16x32_bf16 v[24:27], v[224:227], v[64:67], v[24:27]
    s_cmp_lt_u32 s37, 64
    s_cselect_b32 s62, s62, 0
    s_lshl_b32 s46, s56, 18
    s_add_u32 s46, s46, s58
    s_mul_i32 s41, s36, 4718592
    s_mul_i32 s17, s37, 36864
    s_add_u32 s41, s41, s17
    s_add_u32 s41, s41, 8650752
    s_cmp_lg_u32 s62, 0
    s_cselect_b32 s30, 268435456, 0
    s_add_u32 s48, s46, 0
    buffer_load_dwordx4 v[64:67], v0, s[28:31], s48 offen offset:0
    s_waitcnt vmcnt(15)
    v_mfma_f32_16x16x32_bf16 v[28:31], a[192:195], v[68:71], v[28:31]
    v_mfma_f32_16x16x32_bf16 v[32:35], a[196:199], v[68:71], v[32:35]
    v_mfma_f32_16x16x32_bf16 v[36:39], v[224:227], v[68:71], v[36:39]
    buffer_load_dwordx4 v[68:71], v0, s[28:31], s48 offen offset:1024
    s_waitcnt vmcnt(15)
    v_mfma_f32_16x16x32_bf16 v[16:19], a[200:203], v[72:75], v[16:19]
    v_mfma_f32_16x16x32_bf16 v[20:23], a[204:207], v[72:75], v[20:23]
    v_mfma_f32_16x16x32_bf16 v[24:27], v[228:231], v[72:75], v[24:27]
    buffer_load_dwordx4 v[72:75], v0, s[28:31], s48 offen offset:2048
    s_waitcnt vmcnt(15)
    v_mfma_f32_16x16x32_bf16 v[28:31], a[200:203], v[76:79], v[28:31]
    v_mfma_f32_16x16x32_bf16 v[32:35], a[204:207], v[76:79], v[32:35]
    v_mfma_f32_16x16x32_bf16 v[36:39], v[228:231], v[76:79], v[36:39]
    buffer_load_dwordx4 v[76:79], v0, s[28:31], s48 offen offset:3072
    s_waitcnt vmcnt(15)
    v_mfma_f32_16x16x32_bf16 v[16:19], a[208:211], v[80:83], v[16:19]
    v_mfma_f32_16x16x32_bf16 v[20:23], a[212:215], v[80:83], v[20:23]
    v_mfma_f32_16x16x32_bf16 v[24:27], v[232:235], v[80:83], v[24:27]
    s_add_u32 s48, s46, 4096
    buffer_load_dwordx4 v[80:83], v0, s[28:31], s48 offen offset:0
    s_waitcnt vmcnt(15)
    v_mfma_f32_16x16x32_bf16 v[28:31], a[208:211], v[84:87], v[28:31]
    v_mfma_f32_16x16x32_bf16 v[32:35], a[212:215], v[84:87], v[32:35]
    v_mfma_f32_16x16x32_bf16 v[36:39], v[232:235], v[84:87], v[36:39]
    buffer_load_dwordx4 v[84:87], v0, s[28:31], s48 offen offset:1024
    s_waitcnt vmcnt(15)
    v_mfma_f32_16x16x32_bf16 v[16:19], a[216:219], v[88:91], v[16:19]
    v_mfma_f32_16x16x32_bf16 v[20:23], a[220:223], v[88:91], v[20:23]
    v_mfma_f32_16x16x32_bf16 v[24:27], v[236:239], v[88:91], v[24:27]
    buffer_load_dwordx4 v[88:91], v0, s[28:31], s48 offen offset:2048
    s_waitcnt vmcnt(15)
    v_mfma_f32_16x16x32_bf16 v[28:31], a[216:219], v[92:95], v[28:31]
    v_mfma_f32_16x16x32_bf16 v[32:35], a[220:223], v[92:95], v[32:35]
    v_mfma_f32_16x16x32_bf16 v[36:39], v[236:239], v[92:95], v[36:39]
    buffer_load_dwordx4 v[92:95], v0, s[28:31], s48 offen offset:3072
    s_waitcnt vmcnt(15)
    v_mfma_f32_16x16x32_bf16 v[16:19], a[224:227], v[96:99], v[16:19]
    v_mfma_f32_16x16x32_bf16 v[20:23], a[228:231], v[96:99], v[20:23]
    v_mfma_f32_16x16x32_bf16 v[24:27], v[240:243], v[96:99], v[24:27]
    s_add_u32 s48, s46, 8192
    buffer_load_dwordx4 v[96:99], v0, s[28:31], s48 offen offset:0
    s_waitcnt vmcnt(15)
    v_mfma_f32_16x16x32_bf16 v[28:31], a[224:227], v[100:103], v[28:31]
    v_mfma_f32_16x16x32_bf16 v[32:35], a[228:231], v[100:103], v[32:35]
    v_mfma_f32_16x16x32_bf16 v[36:39], v[240:243], v[100:103], v[36:39]
    buffer_load_dwordx4 v[100:103], v0, s[28:31], s48 offen offset:1024
    s_waitcnt vmcnt(15)
    v_mfma_f32_16x16x32_bf16 v[16:19], a[232:235], v[104:107], v[16:19]
    v_mfma_f32_16x16x32_bf16 v[20:23], a[236:239], v[104:107], v[20:23]
    v_mfma_f32_16x16x32_bf16 v[24:27], v[244:247], v[104:107], v[24:27]
    buffer_load_dwordx4 v[104:107], v0, s[28:31], s48 offen offset:2048
    s_waitcnt vmcnt(15)
    v_mfma_f32_16x16x32_bf16 v[28:31], a[232:235], v[108:111], v[28:31]
    v_mfma_f32_16x16x32_bf16 v[32:35], a[236:239], v[108:111], v[32:35]
    v_mfma_f32_16x16x32_bf16 v[36:39], v[244:247], v[108:111], v[36:39]
    buffer_load_dwordx4 v[108:111], v0, s[28:31], s48 offen offset:3072
    s_waitcnt vmcnt(15)
    v_mfma_f32_16x16x32_bf16 v[16:19], a[240:243], v[112:115], v[16:19]
    v_mfma_f32_16x16x32_bf16 v[20:23], a[244:247], v[112:115], v[20:23]
    v_mfma_f32_16x16x32_bf16 v[24:27], v[248:251], v[112:115], v[24:27]
    s_add_u32 s48, s46, 12288
    buffer_load_dwordx4 v[112:115], v0, s[28:31], s48 offen offset:0
    s_waitcnt vmcnt(15)
    v_mfma_f32_16x16x32_bf16 v[28:31], a[240:243], v[116:119], v[28:31]
    v_mfma_f32_16x16x32_bf16 v[32:35], a[244:247], v[116:119], v[32:35]
    v_mfma_f32_16x16x32_bf16 v[36:39], v[248:251], v[116:119], v[36:39]
    buffer_load_dwordx4 v[116:119], v0, s[28:31], s48 offen offset:1024
    s_waitcnt vmcnt(15)
    v_mfma_f32_16x16x32_bf16 v[16:19], a[248:251], v[120:123], v[16:19]
    v_mfma_f32_16x16x32_bf16 v[20:23], a[252:255], v[120:123], v[20:23]
    v_mfma_f32_16x16x32_bf16 v[24:27], v[252:255], v[120:123], v[24:27]
    buffer_load_dwordx4 v[120:123], v0, s[28:31], s48 offen offset:2048
    s_waitcnt vmcnt(15)
    v_mfma_f32_16x16x32_bf16 v[28:31], a[248:251], v[124:127], v[28:31]
    v_mfma_f32_16x16x32_bf16 v[32:35], a[252:255], v[124:127], v[32:35]
    v_mfma_f32_16x16x32_bf16 v[36:39], v[252:255], v[124:127], v[36:39]
    s_nop 5
    ds_write_b128 v48, v[16:19] offset:0
    ds_write_b128 v48, v[20:23] offset:1024
    ds_write_b128 v48, v[24:27] offset:2048
    ds_write_b128 v48, v[28:31] offset:3072
    ds_write_b128 v48, v[32:35] offset:4096
    ds_write_b128 v48, v[36:39] offset:5120
    s_waitcnt lgkmcnt(0)
    s_barrier
    ds_read_b128 v[24:27], v50 offset:0
    ds_read_b128 v[28:31], v50 offset:1024
    ds_read_b128 v[32:35], v50 offset:6144
    ds_read_b128 v[36:39], v50 offset:7168
    ds_read_b128 v[56:59], v50 offset:12288
    ds_read_b128 v[60:63], v50 offset:13312
    ds_read_b128 v[124:127], v50 offset:18432
    ds_read_b128 v[52:55], v50 offset:19456
    v_xor_b32 v48, 0x8000, v48
    v_xor_b32 v50, 0x8000, v50
    v_lshlrev_b32 v16, 16, v40
    v_and_b32 v20, 0xffff0000, v40
    v_lshlrev_b32 v17, 16, v41
    v_and_b32 v21, 0xffff0000, v41
    v_lshlrev_b32 v18, 16, v42
    v_and_b32 v22, 0xffff0000, v42
    v_lshlrev_b32 v19, 16, v43
    v_and_b32 v23, 0xffff0000, v43
    buffer_load_dwordx4 v[40:43], v12, s[28:31], s41 offen
    s_waitcnt lgkmcnt(7)
    v_add_f32 v16, v16, v24
    v_add_f32 v17, v17, v25
    v_add_f32 v18, v18, v26
    v_add_f32 v19, v19, v27
    s_waitcnt lgkmcnt(6)
    v_add_f32 v20, v20, v28
    v_add_f32 v21, v21, v29
    v_add_f32 v22, v22, v30
    v_add_f32 v23, v23, v31
    s_waitcnt lgkmcnt(5)
    v_add_f32 v16, v16, v32
    v_add_f32 v17, v17, v33
    v_add_f32 v18, v18, v34
    v_add_f32 v19, v19, v35
    s_waitcnt lgkmcnt(4)
    v_add_f32 v20, v20, v36
    v_add_f32 v21, v21, v37
    v_add_f32 v22, v22, v38
    v_add_f32 v23, v23, v39
    s_waitcnt lgkmcnt(3)
    v_add_f32 v16, v16, v56
    v_add_f32 v17, v17, v57
    v_add_f32 v18, v18, v58
    v_add_f32 v19, v19, v59
    s_waitcnt lgkmcnt(2)
    v_add_f32 v20, v20, v60
    v_add_f32 v21, v21, v61
    v_add_f32 v22, v22, v62
    v_add_f32 v23, v23, v63
    s_waitcnt lgkmcnt(1)
    v_add_f32 v16, v16, v124
    v_add_f32 v17, v17, v125
    v_add_f32 v18, v18, v126
    v_add_f32 v19, v19, v127
    s_waitcnt lgkmcnt(0)
    v_add_f32 v20, v20, v52
    v_add_f32 v21, v21, v53
    v_add_f32 v22, v22, v54
    v_add_f32 v23, v23, v55
    v_cvt_pk_bf16_f32 v52, v16, v20
    v_cvt_pk_bf16_f32 v53, v17, v21
    v_cvt_pk_bf16_f32 v54, v18, v22
    v_cvt_pk_bf16_f32 v55, v19, v23
    s_cmp_eq_u32 s34, 0
    s_cbranch_scc1 LtwX_l0
    s_mul_i32 s17, s35, 36864
    buffer_store_dwordx4 v[52:55], v13, s[24:27], s17 offen sc1
    s_cmp_lg_u32 s62, 0
    s_cbranch_scc1 LtwX_item
LtwX_chk:
    s_min_u32 s17, s32, s33
    s_cmp_lt_u32 s17, 64
    s_cbranch_scc1 LtwX_idle
    s_branch L_role_tw_exit
LtwX_l0:
    s_add_u32 s47, s47, 2359296
    buffer_store_dwordx4 v[52:55], v12, s[8:11], s47 offen sc1
    v_add_f32 v44, v16, v17
    v_mul_f32 v45, v16, v16
    v_fmac_f32 v45, v17, v17
    v_add_f32 v44, v44, v18
    v_fmac_f32 v45, v18, v18
    v_add_f32 v44, v44, v19
    v_fmac_f32 v45, v19, v19
    v_add_f32 v44, v44, v20
    v_fmac_f32 v45, v20, v20
    v_add_f32 v44, v44, v21
    v_fmac_f32 v45, v21, v21
    v_add_f32 v44, v44, v22
    v_fmac_f32 v45, v22, v22
    v_add_f32 v44, v44, v23
    v_fmac_f32 v45, v23, v23
    v_mov_b32 v46, v44
    v_mov_b32 v47, v45
    s_nop 0
    v_permlane32_swap_b32 v44, v46
    v_permlane32_swap_b32 v45, v47
    v_add_f32 v44, v44, v46
    v_add_f32 v45, v45, v47
    v_mov_b32 v46, v44
    v_mov_b32 v47, v45
    s_nop 0
    v_permlane16_swap_b32 v44, v46
    v_permlane16_swap_b32 v45, v47
    v_add_f32 v44, v44, v46
    v_add_f32 v45, v45, v47
    s_mul_i32 s17, s35, 6144
    s_add_u32 s17, s17, 16515072
    s_mov_b64 exec, 0xffff
    buffer_store_dwordx2 v[44:45], v14, s[8:11], s17 offen sc1
    s_mov_b64 exec, -1
    s_mul_i32 s43, s35, 22528
    s_add_u32 s43, s43, s49
    s_cmp_lg_u32 s62, 0
    s_cbranch_scc1 LtwX_item
    s_waitcnt vmcnt(0)
    s_mov_b64 exec, 1
    buffer_store_dword v3, v4, s[8:11], s43 offen sc1
    s_mov_b64 exec, -1
    s_mov_b32 s43, 0
    s_branch LtwX_chk
Ltw_z:
    v_lshrrev_b32 v5, 1, v8
    v_lshl_add_u32 v12, v5, 9, v12
    v_and_b32 v5, 1, v8
    v_lshl_add_u32 v12, v5, 3, v12
    v_add_u32 v12, 2048, v12
    v_lshl_add_u32 v13, v8, 3, v13
    v_add_u32 v13, 64, v13
    v_add_u32 v14, 8, v14
    s_lshl_b32 s58, s14, 16
    s_add_u32 s58, s58, 144703488
    s_mov_b32 s43, 0
    s_mov_b32 s28, s8
    s_mov_b32 s29, s9
    s_mov_b32 s30, 0
    s_mov_b32 s31, 0x00020000
    s_mul_i32 s17, s51, 3072
    v_add_u32 v50, s17, v0
    ds_write2_b32 v49, v4, v4 offset0:0 offset1:1
    s_waitcnt lgkmcnt(0)
    s_cmp_lg_u32 s14, 0
    s_cbranch_scc1 LtwZ_ini_d
    v_mov_b32 v5, 160
    s_mov_b32 s16, 0
LtwZ_ini:
    global_load_dword v6, v5, s[12:13] sc1
    s_add_u32 s16, s16, 1
    s_cmp_gt_u32 s16, 100000
    s_cbranch_scc1 L_role_tw_abort
    s_waitcnt vmcnt(0)
    v_cmp_gt_u32 vcc, 192, v6
    s_nop 0
    s_cbranch_vccz LtwZ_ini_d
    s_sleep 8
    s_branch LtwZ_ini
LtwZ_ini_d:
    s_barrier
LtwZ_idle:
    s_barrier
    ds_read_b32 v6, v49
    v_xor_b32 v49, 4, v49
    s_waitcnt lgkmcnt(0)
    v_readfirstlane_b32 s62, v6
    s_nop 0
    s_cmp_eq_u32 s62, 0
    s_cbranch_scc1 L_role_tw_abort
    s_cmp_lt_u32 s33, 29
    s_cselect_b32 s38, 1, 3
    s_cmp_eq_u32 s62, 2
    s_cselect_b32 s36, 1, 0
    s_cselect_b32 s37, s33, s32
    s_cselect_b32 s17, s38, 0
    s_add_u32 s33, s33, s17
    s_cmp_eq_u32 s62, 1
    s_cselect_b32 s17, 2, 0
    s_add_u32 s32, s32, s17
    s_lshl_b32 s56, s36, 6
    s_add_u32 s56, s56, s37
    s_lshl_b32 s46, s56, 18
    s_add_u32 s46, s46, s58
    s_mul_i32 s41, s36, 4718592
    s_mul_i32 s17, s37, 36864
    s_add_u32 s41, s41, s17
    s_add_u32 s41, s41, 8650752
    s_cmp_ge_u32 s37, 64
    s_cbranch_scc1 L_role_tw_abort
    s_add_u32 s48, s46, 0
    buffer_load_dwordx4 v[64:67], v0, s[8:11], s48 offen offset:0
    buffer_load_dwordx4 v[68:71], v0, s[8:11], s48 offen offset:1024
    buffer_load_dwordx4 v[72:75], v0, s[8:11], s48 offen offset:2048
    buffer_load_dwordx4 v[76:79], v0, s[8:11], s48 offen offset:3072
    s_add_u32 s48, s46, 4096
    buffer_load_dwordx4 v[80:83], v0, s[8:11], s48 offen offset:0
    buffer_load_dwordx4 v[84:87], v0, s[8:11], s48 offen offset:1024
    buffer_load_dwordx4 v[88:91], v0, s[8:11], s48 offen offset:2048
    buffer_load_dwordx4 v[92:95], v0, s[8:11], s48 offen offset:3072
    s_add_u32 s48, s46, 8192
    buffer_load_dwordx4 v[96:99], v0, s[8:11], s48 offen offset:0
    buffer_load_dwordx4 v[100:103], v0, s[8:11], s48 offen offset:1024
    buffer_load_dwordx4 v[104:107], v0, s[8:11], s48 offen offset:2048
    buffer_load_dwordx4 v[108:111], v0, s[8:11], s48 offen offset:3072
    s_add_u32 s48, s46, 12288
    buffer_load_dwordx4 v[112:115], v0, s[8:11], s48 offen offset:0
    buffer_load_dwordx4 v[116:119], v0, s[8:11], s48 offen offset:1024
    buffer_load_dwordx4 v[120:123], v0, s[8:11], s48 offen offset:2048
    buffer_load_dwordx2 v[40:41], v12, s[8:11], s41 offen
LtwZ_item:
    s_mov_b32 s34, s36
    s_mov_b32 s35, s37
    s_mov_b32 s47, s41
    buffer_load_dwordx4 v[124:127], v0, s[8:11], s48 offen offset:3072
    s_waitcnt vmcnt(16)
    v_mfma_f32_16x16x32_bf16 v[16:19], a[0:3], v[64:67], 0
    v_mfma_f32_16x16x32_bf16 v[20:23], a[4:7], v[64:67], 0
    v_mfma_f32_16x16x32_bf16 v[24:27], v[128:131], v[64:67], 0
    s_add_u32 s48, s46, 16384
    buffer_load_dwordx4 v[64:67], v0, s[8:11], s48 offen offset:0
    s_waitcnt vmcnt(16)
    v_mfma_f32_16x16x32_bf16 v[28:31], a[0:3], v[68:71], 0
    v_mfma_f32_16x16x32_bf16 v[32:35], a[4:7], v[68:71], 0
    v_mfma_f32_16x16x32_bf16 v[36:39], v[128:131], v[68:71], 0
    buffer_load_dwordx4 v[68:71], v0, s[8:11], s48 offen offset:1024
    s_waitcnt vmcnt(16)
    v_mfma_f32_16x16x32_bf16 v[16:19], a[8:11], v[72:75], v[16:19]
    v_mfma_f32_16x16x32_bf16 v[20:23], a[12:15], v[72:75], v[20:23]
    v_mfma_f32_16x16x32_bf16 v[24:27], v[132:135], v[72:75], v[24:27]
    buffer_load_dwordx4 v[72:75], v0, s[8:11], s48 offen offset:2048
    s_waitcnt vmcnt(16)
    v_mfma_f32_16x16x32_bf16 v[28:31], a[8:11], v[76:79], v[28:31]
    v_mfma_f32_16x16x32_bf16 v[32:35], a[12:15], v[76:79], v[32:35]
    v_mfma_f32_16x16x32_bf16 v[36:39], v[132:135], v[76:79], v[36:39]
    buffer_load_dwordx4 v[76:79], v0, s[8:11], s48 offen offset:3072
    s_waitcnt vmcnt(16)
    v_mfma_f32_16x16x32_bf16 v[16:19], a[16:19], v[80:83], v[16:19]
    v_mfma_f32_16x16x32_bf16 v[20:23], a[20:23], v[80:83], v[20:23]
    v_mfma_f32_16x16x32_bf16 v[24:27], v[136:139], v[80:83], v[24:27]
    s_add_u32 s48, s46, 20480
    buffer_load_dwordx4 v[80:83], v0, s[8:11], s48 offen offset:0
    s_waitcnt vmcnt(16)
    v_mfma_f32_16x16x32_bf16 v[28:31], a[16:19], v[84:87], v[28:31]
    v_mfma_f32_16x16x32_bf16 v[32:35], a[20:23], v[84:87], v[32:35]
    v_mfma_f32_16x16x32_bf16 v[36:39], v[136:139], v[84:87], v[36:39]
    buffer_load_dwordx4 v[84:87], v0, s[8:11], s48 offen offset:1024
    s_waitcnt vmcnt(16)
    v_mfma_f32_16x16x32_bf16 v[16:19], a[24:27], v[88:91], v[16:19]
    v_mfma_f32_16x16x32_bf16 v[20:23], a[28:31], v[88:91], v[20:23]
    v_mfma_f32_16x16x32_bf16 v[24:27], v[140:143], v[88:91], v[24:27]
    buffer_load_dwordx4 v[88:91], v0, s[8:11], s48 offen offset:2048
    s_waitcnt vmcnt(16)
    v_mfma_f32_16x16x32_bf16 v[28:31], a[24:27], v[92:95], v[28:31]
    v_mfma_f32_16x16x32_bf16 v[32:35], a[28:31], v[92:95], v[32:35]
    v_mfma_f32_16x16x32_bf16 v[36:39], v[140:143], v[92:95], v[36:39]
    buffer_load_dwordx4 v[92:95], v0, s[8:11], s48 offen offset:3072
    s_waitcnt vmcnt(16)
    v_mfma_f32_16x16x32_bf16 v[16:19], a[32:35], v[96:99], v[16:19]
    v_mfma_f32_16x16x32_bf16 v[20:23], a[36:39], v[96:99], v[20:23]
    v_mfma_f32_16x16x32_bf16 v[24:27], v[144:147], v[96:99], v[24:27]
    s_add_u32 s48, s46, 24576
    buffer_load_dwordx4 v[96:99], v0, s[8:11], s48 offen offset:0
    s_waitcnt vmcnt(16)
    v_mfma_f32_16x16x32_bf16 v[28:31], a[32:35], v[100:103], v[28:31]
    v_mfma_f32_16x16x32_bf16 v[32:35], a[36:39], v[100:103], v[32:35]
    v_mfma_f32_16x16x32_bf16 v[36:39], v[144:147], v[100:103], v[36:39]
    buffer_load_dwordx4 v[100:103], v0, s[8:11], s48 offen offset:1024
    s_waitcnt vmcnt(16)
    v_mfma_f32_16x16x32_bf16 v[16:19], a[40:43], v[104:107], v[16:19]
    v_mfma_f32_16x16x32_bf16 v[20:23], a[44:47], v[104:107], v[20:23]
    v_mfma_f32_16x16x32_bf16 v[24:27], v[148:151], v[104:107], v[24:27]
    buffer_load_dwordx4 v[104:107], v0, s[8:11], s48 offen offset:2048
    s_waitcnt vmcnt(16)
    v_mfma_f32_16x16x32_bf16 v[28:31], a[40:43], v[108:111], v[28:31]
    v_mfma_f32_16x16x32_bf16 v[32:35], a[44:47], v[108:111], v[32:35]
    v_mfma_f32_16x16x32_bf16 v[36:39], v[148:151], v[108:111], v[36:39]
    buffer_load_dwordx4 v[108:111], v0, s[8:11], s48 offen offset:3072
    s_waitcnt vmcnt(16)
    v_mfma_f32_16x16x32_bf16 v[16:19], a[48:51], v[112:115], v[16:19]
    v_mfma_f32_16x16x32_bf16 v[20:23], a[52:55], v[112:115], v[20:23]
    v_mfma_f32_16x16x32_bf16 v[24:27], v[152:155], v[112:115], v[24:27]
    s_add_u32 s48, s46, 28672
    buffer_load_dwordx4 v[112:115], v0, s[8:11], s48 offen offset:0
    s_waitcnt vmcnt(16)
    v_mfma_f32_16x16x32_bf16 v[28:31], a[48:51], v[116:119], v[28:31]
    v_mfma_f32_16x16x32_bf16 v[32:35], a[52:55], v[116:119], v[32:35]
    v_mfma_f32_16x16x32_bf16 v[36:39], v[152:155], v[116:119], v[36:39]
    buffer_load_dwordx4 v[116:119], v0, s[8:11], s48 offen offset:1024
    s_waitcnt vmcnt(16)
    v_mfma_f32_16x16x32_bf16 v[16:19], a[56:59], v[120:123], v[16:19]
    v_mfma_f32_16x16x32_bf16 v[20:23], a[60:63], v[120:123], v[20:23]
    v_mfma_f32_16x16x32_bf16 v[24:27], v[156:159], v[120:123], v[24:27]
    buffer_load_dwordx4 v[120:123], v0, s[8:11], s48 offen offset:2048
    s_waitcnt vmcnt(15)
    v_mfma_f32_16x16x32_bf16 v[28:31], a[56:59], v[124:127], v[28:31]
    v_mfma_f32_16x16x32_bf16 v[32:35], a[60:63], v[124:127], v[32:35]
    v_mfma_f32_16x16x32_bf16 v[36:39], v[156:159], v[124:127], v[36:39]
    buffer_load_dwordx4 v[124:127], v0, s[8:11], s48 offen offset:3072
    s_waitcnt vmcnt(15)
    v_mfma_f32_16x16x32_bf16 v[16:19], a[64:67], v[64:67], v[16:19]
    v_mfma_f32_16x16x32_bf16 v[20:23], a[68:71], v[64:67], v[20:23]
    v_mfma_f32_16x16x32_bf16 v[24:27], v[160:163], v[64:67], v[24:27]
    s_add_u32 s48, s46, 32768
    buffer_load_dwordx4 v[64:67], v0, s[8:11], s48 offen offset:0
    s_waitcnt vmcnt(15)
    v_mfma_f32_16x16x32_bf16 v[28:31], a[64:67], v[68:71], v[28:31]
    v_mfma_f32_16x16x32_bf16 v[32:35], a[68:71], v[68:71], v[32:35]
    v_mfma_f32_16x16x32_bf16 v[36:39], v[160:163], v[68:71], v[36:39]
    s_cmp_lg_u32 s43, 0
    s_cselect_b64 exec, 1, 0
    buffer_store_dword v3, v4, s[8:11], s43 offen sc1
    s_mov_b64 exec, -1
    s_mov_b32 s43, 0
    buffer_load_dwordx4 v[68:71], v0, s[8:11], s48 offen offset:1024
    s_waitcnt vmcnt(16)
    v_mfma_f32_16x16x32_bf16 v[16:19], a[72:75], v[72:75], v[16:19]
    v_mfma_f32_16x16x32_bf16 v[20:23], a[76:79], v[72:75], v[20:23]
    v_mfma_f32_16x16x32_bf16 v[24:27], v[164:167], v[72:75], v[24:27]
    buffer_load_dwordx4 v[72:75], v0, s[8:11], s48 offen offset:2048
    s_waitcnt vmcnt(16)
    v_mfma_f32_16x16x32_bf16 v[28:31], a[72:75], v[76:79], v[28:31]
    v_mfma_f32_16x16x32_bf16 v[32:35], a[76:79], v[76:79], v[32:35]
    v_mfma_f32_16x16x32_bf16 v[36:39], v[164:167], v[76:79], v[36:39]
    buffer_load_dwordx4 v[76:79], v0, s[8:11], s48 offen offset:3072
    s_waitcnt vmcnt(16)
    v_mfma_f32_16x16x32_bf16 v[16:19], a[80:83], v[80:83], v[16:19]
    v_mfma_f32_16x16x32_bf16 v[20:23], a[84:87], v[80:83], v[20:23]
    v_mfma_f32_16x16x32_bf16 v[24:27], v[168:171], v[80:83], v[24:27]
    s_add_u32 s48, s46, 36864
    buffer_load_dwordx4 v[80:83], v0, s[8:11], s48 offen offset:0
    s_waitcnt vmcnt(16)
    v_mfma_f32_16x16x32_bf16 v[28:31], a[80:83], v[84:87], v[28:31]
    v_mfma_f32_16x16x32_bf16 v[32:35], a[84:87], v[84:87], v[32:35]
    v_mfma_f32_16x16x32_bf16 v[36:39], v[168:171], v[84:87], v[36:39]
    buffer_load_dwordx4 v[84:87], v0, s[8:11], s48 offen offset:1024
    s_waitcnt vmcnt(16)
    v_mfma_f32_16x16x32_bf16 v[16:19], a[88:91], v[88:91], v[16:19]
    v_mfma_f32_16x16x32_bf16 v[20:23], a[92:95], v[88:91], v[20:23]
    v_mfma_f32_16x16x32_bf16 v[24:27], v[172:175], v[88:91], v[24:27]
    buffer_load_dwordx4 v[88:91], v0, s[8:11], s48 offen offset:2048
    s_waitcnt vmcnt(16)
    v_mfma_f32_16x16x32_bf16 v[28:31], a[88:91], v[92:95], v[28:31]
    v_mfma_f32_16x16x32_bf16 v[32:35], a[92:95], v[92:95], v[32:35]
    v_mfma_f32_16x16x32_bf16 v[36:39], v[172:175], v[92:95], v[36:39]
    buffer_load_dwordx4 v[92:95], v0, s[8:11], s48 offen offset:3072
    s_waitcnt vmcnt(16)
    v_mfma_f32_16x16x32_bf16 v[16:19], a[96:99], v[96:99], v[16:19]
    v_mfma_f32_16x16x32_bf16 v[20:23], a[100:103], v[96:99], v[20:23]
    v_mfma_f32_16x16x32_bf16 v[24:27], v[176:179], v[96:99], v[24:27]
    s_add_u32 s48, s46, 40960
    buffer_load_dwordx4 v[96:99], v0, s[8:11], s48 offen offset:0
    s_waitcnt vmcnt(16)
    v_mfma_f32_16x16x32_bf16 v[28:31], a[96:99], v[100:103], v[28:31]
    v_mfma_f32_16x16x32_bf16 v[32:35], a[100:103], v[100:103], v[32:35]
    v_mfma_f32_16x16x32_bf16 v[36:39], v[176:179], v[100:103], v[36:39]
    buffer_load_dwordx4 v[100:103], v0, s[8:11], s48 offen offset:1024
    s_waitcnt vmcnt(16)
    v_mfma_f32_16x16x32_bf16 v[16:19], a[104:107], v[104:107], v[16:19]
    v_mfma_f32_16x16x32_bf16 v[20:23], a[108:111], v[104:107], v[20:23]
    v_mfma_f32_16x16x32_bf16 v[24:27], v[180:183], v[104:107], v[24:27]
    buffer_load_dwordx4 v[104:107], v0, s[8:11], s48 offen offset:2048
    s_waitcnt vmcnt(16)
    v_mfma_f32_16x16x32_bf16 v[28:31], a[104:107], v[108:111], v[28:31]
    v_mfma_f32_16x16x32_bf16 v[32:35], a[108:111], v[108:111], v[32:35]
    v_mfma_f32_16x16x32_bf16 v[36:39], v[180:183], v[108:111], v[36:39]
    buffer_load_dwordx4 v[108:111], v0, s[8:11], s48 offen offset:3072
    s_waitcnt vmcnt(16)
    v_mfma_f32_16x16x32_bf16 v[16:19], a[112:115], v[112:115], v[16:19]
    v_mfma_f32_16x16x32_bf16 v[20:23], a[116:119], v[112:115], v[20:23]
    v_mfma_f32_16x16x32_bf16 v[24:27], v[184:187], v[112:115], v[24:27]
    s_add_u32 s48, s46, 45056
    buffer_load_dwordx4 v[112:115], v0, s[8:11], s48 offen offset:0
    s_waitcnt vmcnt(16)
    v_mfma_f32_16x16x32_bf16 v[28:31], a[112:115], v[116:119], v[28:31]
    v_mfma_f32_16x16x32_bf16 v[32:35], a[116:119], v[116:119], v[32:35]
    v_mfma_f32_16x16x32_bf16 v[36:39], v[184:187], v[116:119], v[36:39]
    buffer_load_dwordx4 v[116:119], v0, s[8:11], s48 offen offset:1024
    s_waitcnt vmcnt(16)
    v_mfma_f32_16x16x32_bf16 v[16:19], a[120:123], v[120:123], v[16:19]
    v_mfma_f32_16x16x32_bf16 v[20:23], a[124:127], v[120:123], v[20:23]
    v_mfma_f32_16x16x32_bf16 v[24:27], v[188:191], v[120:123], v[24:27]
    buffer_load_dwordx4 v[120:123], v0, s[8:11], s48 offen offset:2048
    s_waitcnt vmcnt(16)
    v_mfma_f32_16x16x32_bf16 v[28:31], a[120:123], v[124:127], v[28:31]
    v_mfma_f32_16x16x32_bf16 v[32:35], a[124:127], v[124:127], v[32:35]
    v_mfma_f32_16x16x32_bf16 v[36:39], v[188:191], v[124:127], v[36:39]
    buffer_load_dwordx4 v[124:127], v0, s[8:11], s48 offen offset:3072
    s_waitcnt vmcnt(16)
    v_mfma_f32_16x16x32_bf16 v[16:19], a[128:131], v[64:67], v[16:19]
    v_mfma_f32_16x16x32_bf16 v[20:23], a[132:135], v[64:67], v[20:23]
    v_mfma_f32_16x16x32_bf16 v[24:27], v[192:195], v[64:67], v[24:27]
    s_add_u32 s48, s46, 49152
    buffer_load_dwordx4 v[64:67], v0, s[8:11], s48 offen offset:0
    s_waitcnt vmcnt(15)
    v_mfma_f32_16x16x32_bf16 v[28:31], a[128:131], v[68:71], v[28:31]
    v_mfma_f32_16x16x32_bf16 v[32:35], a[132:135], v[68:71], v[32:35]
    v_mfma_f32_16x16x32_bf16 v[36:39], v[192:195], v[68:71], v[36:39]
    buffer_load_dwordx4 v[68:71], v0, s[8:11], s48 offen offset:1024
    s_waitcnt vmcnt(15)
    v_mfma_f32_16x16x32_bf16 v[16:19], a[136:139], v[72:75], v[16:19]
    v_mfma_f32_16x16x32_bf16 v[20:23], a[140:143], v[72:75], v[20:23]
    v_mfma_f32_16x16x32_bf16 v[24:27], v[196:199], v[72:75], v[24:27]
    buffer_load_dwordx4 v[72:75], v0, s[8:11], s48 offen offset:2048
    s_waitcnt vmcnt(15)
    v_mfma_f32_16x16x32_bf16 v[28:31], a[136:139], v[76:79], v[28:31]
    v_mfma_f32_16x16x32_bf16 v[32:35], a[140:143], v[76:79], v[32:35]
    v_mfma_f32_16x16x32_bf16 v[36:39], v[196:199], v[76:79], v[36:39]
    buffer_load_dwordx4 v[76:79], v0, s[8:11], s48 offen offset:3072
    s_waitcnt vmcnt(15)
    v_mfma_f32_16x16x32_bf16 v[16:19], a[144:147], v[80:83], v[16:19]
    v_mfma_f32_16x16x32_bf16 v[20:23], a[148:151], v[80:83], v[20:23]
    v_mfma_f32_16x16x32_bf16 v[24:27], v[200:203], v[80:83], v[24:27]
    s_add_u32 s48, s46, 53248
    buffer_load_dwordx4 v[80:83], v0, s[8:11], s48 offen offset:0
    s_waitcnt vmcnt(15)
    v_mfma_f32_16x16x32_bf16 v[28:31], a[144:147], v[84:87], v[28:31]
    v_mfma_f32_16x16x32_bf16 v[32:35], a[148:151], v[84:87], v[32:35]
    v_mfma_f32_16x16x32_bf16 v[36:39], v[200:203], v[84:87], v[36:39]
    buffer_load_dwordx4 v[84:87], v0, s[8:11], s48 offen offset:1024
    s_waitcnt vmcnt(15)
    v_mfma_f32_16x16x32_bf16 v[16:19], a[152:155], v[88:91], v[16:19]
    v_mfma_f32_16x16x32_bf16 v[20:23], a[156:159], v[88:91], v[20:23]
    v_mfma_f32_16x16x32_bf16 v[24:27], v[204:207], v[88:91], v[24:27]
    buffer_load_dwordx4 v[88:91], v0, s[8:11], s48 offen offset:2048
    s_waitcnt vmcnt(15)
    v_mfma_f32_16x16x32_bf16 v[28:31], a[152:155], v[92:95], v[28:31]
    v_mfma_f32_16x16x32_bf16 v[32:35], a[156:159], v[92:95], v[32:35]
    v_mfma_f32_16x16x32_bf16 v[36:39], v[204:207], v[92:95], v[36:39]
    buffer_load_dwordx4 v[92:95], v0, s[8:11], s48 offen offset:3072
    s_waitcnt vmcnt(15)
    v_mfma_f32_16x16x32_bf16 v[16:19], a[160:163], v[96:99], v[16:19]
    v_mfma_f32_16x16x32_bf16 v[20:23], a[164:167], v[96:99], v[20:23]
    v_mfma_f32_16x16x32_bf16 v[24:27], v[208:211], v[96:99], v[24:27]
    s_add_u32 s48, s46, 57344
    buffer_load_dwordx4 v[96:99], v0, s[8:11], s48 offen offset:0
    s_waitcnt vmcnt(15)
    v_mfma_f32_16x16x32_bf16 v[28:31], a[160:163], v[100:103], v[28:31]
    v_mfma_f32_16x16x32_bf16 v[32:35], a[164:167], v[100:103], v[32:35]
    v_mfma_f32_16x16x32_bf16 v[36:39], v[208:211], v[100:103], v[36:39]
    buffer_load_dwordx4 v[100:103], v0, s[8:11], s48 offen offset:1024
    s_waitcnt vmcnt(15)
    v_mfma_f32_16x16x32_bf16 v[16:19], a[168:171], v[104:107], v[16:19]
    v_mfma_f32_16x16x32_bf16 v[20:23], a[172:175], v[104:107], v[20:23]
    v_mfma_f32_16x16x32_bf16 v[24:27], v[212:215], v[104:107], v[24:27]
    buffer_load_dwordx4 v[104:107], v0, s[8:11], s48 offen offset:2048
    s_waitcnt vmcnt(15)
    v_mfma_f32_16x16x32_bf16 v[28:31], a[168:171], v[108:111], v[28:31]
    v_mfma_f32_16x16x32_bf16 v[32:35], a[172:175], v[108:111], v[32:35]
    v_mfma_f32_16x16x32_bf16 v[36:39], v[212:215], v[108:111], v[36:39]
    buffer_load_dwordx4 v[108:111], v0, s[8:11], s48 offen offset:3072
    s_waitcnt vmcnt(15)
    v_mfma_f32_16x16x32_bf16 v[16:19], a[176:179], v[112:115], v[16:19]
    v_mfma_f32_16x16x32_bf16 v[20:23], a[180:183], v[112:115], v[20:23]
    v_mfma_f32_16x16x32_bf16 v[24:27], v[216:219], v[112:115], v[24:27]
    s_barrier
    ds_read_b32 v6, v49
    v_xor_b32 v49, 4, v49
    s_add_u32 s48, s46, 61440
    buffer_load_dwordx4 v[112:115], v0, s[8:11], s48 offen offset:0
    s_waitcnt vmcnt(15)
    v_mfma_f32_16x16x32_bf16 v[28:31], a[176:179], v[116:119], v[28:31]
    v_mfma_f32_16x16x32_bf16 v[32:35], a[180:183], v[116:119], v[32:35]
    v_mfma_f32_16x16x32_bf16 v[36:39], v[216:219], v[116:119], v[36:39]
    buffer_load_dwordx4 v[116:119], v0, s[8:11], s48 offen offset:1024
    s_waitcnt vmcnt(15)
    v_mfma_f32_16x16x32_bf16 v[16:19], a[184:187], v[120:123], v[16:19]
    v_mfma_f32_16x16x32_bf16 v[20:23], a[188:191], v[120:123], v[20:23]
    v_mfma_f32_16x16x32_bf16 v[24:27], v[220:223], v[120:123], v[24:27]
    buffer_load_dwordx4 v[120:123], v0, s[8:11], s48 offen offset:2048
    s_waitcnt vmcnt(15)
    v_mfma_f32_16x16x32_bf16 v[28:31], a[184:187], v[124:127], v[28:31]
    v_mfma_f32_16x16x32_bf16 v[32:35], a[188:191], v[124:127], v[32:35]
    v_mfma_f32_16x16x32_bf16 v[36:39], v[220:223], v[124:127], v[36:39]
    s_waitcnt lgkmcnt(0)
    v_readfirstlane_b32 s62, v6
    s_cmp_lt_u32 s33, 29
    s_cselect_b32 s38, 1, 3
    s_cmp_eq_u32 s62, 2
    s_cselect_b32 s36, 1, 0
    s_cselect_b32 s37, s33, s32
    s_cselect_b32 s17, s38, 0
    s_add_u32 s33, s33, s17
    s_cmp_eq_u32 s62, 1
    s_cselect_b32 s17, 2, 0
    s_add_u32 s32, s32, s17
    s_lshl_b32 s56, s36, 6
    s_add_u32 s56, s56, s37
    buffer_load_dwordx4 v[124:127], v0, s[8:11], s48 offen offset:3072
    s_waitcnt vmcnt(15)
    v_mfma_f32_16x16x32_bf16 v[16:19], a[192:195], v[64:67], v[16:19]
    v_mfma_f32_16x16x32_bf16 v[20:23], a[196:199], v[64:67], v[20:23]
    v_mfma_f32_16x16x32_bf16 v[24:27], v[224:227], v[64:67], v[24:27]
    s_cmp_lt_u32 s37, 64
    s_cselect_b32 s62, s62, 0
    s_lshl_b32 s46, s56, 18
    s_add_u32 s46, s46, s58
    s_mul_i32 s41, s36, 4718592
    s_mul_i32 s17, s37, 36864
    s_add_u32 s41, s41, s17
    s_add_u32 s41, s41, 8650752
    s_cmp_lg_u32 s62, 0
    s_cselect_b32 s30, 268435456, 0
    s_add_u32 s48, s46, 0
    buffer_load_dwordx4 v[64:67], v0, s[28:31], s48 offen offset:0
    s_waitcnt vmcnt(15)
    v_mfma_f32_16x16x32_bf16 v[28:31], a[192:195], v[68:71], v[28:31]
    v_mfma_f32_16x16x32_bf16 v[32:35], a[196:199], v[68:71], v[32:35]
    v_mfma_f32_16x16x32_bf16 v[36:39], v[224:227], v[68:71], v[36:39]
    buffer_load_dwordx4 v[68:71], v0, s[28:31], s48 offen offset:1024
    s_waitcnt vmcnt(15)
    v_mfma_f32_16x16x32_bf16 v[16:19], a[200:203], v[72:75], v[16:19]
    v_mfma_f32_16x16x32_bf16 v[20:23], a[204:207], v[72:75], v[20:23]
    v_mfma_f32_16x16x32_bf16 v[24:27], v[228:231], v[72:75], v[24:27]
    buffer_load_dwordx4 v[72:75], v0, s[28:31], s48 offen offset:2048
    s_waitcnt vmcnt(15)
    v_mfma_f32_16x16x32_bf16 v[28:31], a[200:203], v[76:79], v[28:31]
    v_mfma_f32_16x16x32_bf16 v[32:35], a[204:207], v[76:79], v[32:35]
    v_mfma_f32_16x16x32_bf16 v[36:39], v[228:231], v[76:79], v[36:39]
    buffer_load_dwordx4 v[76:79], v0, s[28:31], s48 offen offset:3072
    s_waitcnt vmcnt(15)
    v_mfma_f32_16x16x32_bf16 v[16:19], a[208:211], v[80:83], v[16:19]
    v_mfma_f32_16x16x32_bf16 v[20:23], a[212:215], v[80:83], v[20:23]
    v_mfma_f32_16x16x32_bf16 v[24:27], v[232:235], v[80:83], v[24:27]
    s_add_u32 s48, s46, 4096
    buffer_load_dwordx4 v[80:83], v0, s[28:31], s48 offen offset:0
    s_waitcnt vmcnt(15)
    v_mfma_f32_16x16x32_bf16 v[28:31], a[208:211], v[84:87], v[28:31]
    v_mfma_f32_16x16x32_bf16 v[32:35], a[212:215], v[84:87], v[32:35]
    v_mfma_f32_16x16x32_bf16 v[36:39], v[232:235], v[84:87], v[36:39]
    buffer_load_dwordx4 v[84:87], v0, s[28:31], s48 offen offset:1024
    s_waitcnt vmcnt(15)
    v_mfma_f32_16x16x32_bf16 v[16:19], a[216:219], v[88:91], v[16:19]
    v_mfma_f32_16x16x32_bf16 v[20:23], a[220:223], v[88:91], v[20:23]
    v_mfma_f32_16x16x32_bf16 v[24:27], v[236:239], v[88:91], v[24:27]
    buffer_load_dwordx4 v[88:91], v0, s[28:31], s48 offen offset:2048
    s_waitcnt vmcnt(15)
    v_mfma_f32_16x16x32_bf16 v[28:31], a[216:219], v[92:95], v[28:31]
    v_mfma_f32_16x16x32_bf16 v[32:35], a[220:223], v[92:95], v[32:35]
    v_mfma_f32_16x16x32_bf16 v[36:39], v[236:239], v[92:95], v[36:39]
    buffer_load_dwordx4 v[92:95], v0, s[28:31], s48 offen offset:3072
    s_waitcnt vmcnt(15)
    v_mfma_f32_16x16x32_bf16 v[16:19], a[224:227], v[96:99], v[16:19]
    v_mfma_f32_16x16x32_bf16 v[20:23], a[228:231], v[96:99], v[20:23]
    v_mfma_f32_16x16x32_bf16 v[24:27], v[240:243], v[96:99], v[24:27]
    s_add_u32 s48, s46, 8192
    buffer_load_dwordx4 v[96:99], v0, s[28:31], s48 offen offset:0
    s_waitcnt vmcnt(15)
    v_mfma_f32_16x16x32_bf16 v[28:31], a[224:227], v[100:103], v[28:31]
    v_mfma_f32_16x16x32_bf16 v[32:35], a[228:231], v[100:103], v[32:35]
    v_mfma_f32_16x16x32_bf16 v[36:39], v[240:243], v[100:103], v[36:39]
    buffer_load_dwordx4 v[100:103], v0, s[28:31], s48 offen offset:1024
    s_waitcnt vmcnt(15)
    v_mfma_f32_16x16x32_bf16 v[16:19], a[232:235], v[104:107], v[16:19]
    v_mfma_f32_16x16x32_bf16 v[20:23], a[236:239], v[104:107], v[20:23]
    v_mfma_f32_16x16x32_bf16 v[24:27], v[244:247], v[104:107], v[24:27]
    buffer_load_dwordx4 v[104:107], v0, s[28:31], s48 offen offset:2048
    s_waitcnt vmcnt(15)
    v_mfma_f32_16x16x32_bf16 v[28:31], a[232:235], v[108:111], v[28:31]
    v_mfma_f32_16x16x32_bf16 v[32:35], a[236:239], v[108:111], v[32:35]
    v_mfma_f32_16x16x32_bf16 v[36:39], v[244:247], v[108:111], v[36:39]
    buffer_load_dwordx4 v[108:111], v0, s[28:31], s48 offen offset:3072
    s_waitcnt vmcnt(15)
    v_mfma_f32_16x16x32_bf16 v[16:19], a[240:243], v[112:115], v[16:19]
    v_mfma_f32_16x16x32_bf16 v[20:23], a[244:247], v[112:115], v[20:23]
    v_mfma_f32_16x16x32_bf16 v[24:27], v[248:251], v[112:115], v[24:27]
    s_add_u32 s48, s46, 12288
    buffer_load_dwordx4 v[112:115], v0, s[28:31], s48 offen offset:0
    s_waitcnt vmcnt(15)
    v_mfma_f32_16x16x32_bf16 v[28:31], a[240:243], v[116:119], v[28:31]
    v_mfma_f32_16x16x32_bf16 v[32:35], a[244:247], v[116:119], v[32:35]
    v_mfma_f32_16x16x32_bf16 v[36:39], v[248:251], v[116:119], v[36:39]
    buffer_load_dwordx4 v[116:119], v0, s[28:31], s48 offen offset:1024
    s_waitcnt vmcnt(15)
    v_mfma_f32_16x16x32_bf16 v[16:19], a[248:251], v[120:123], v[16:19]
    v_mfma_f32_16x16x32_bf16 v[20:23], a[252:255], v[120:123], v[20:23]
    v_mfma_f32_16x16x32_bf16 v[24:27], v[252:255], v[120:123], v[24:27]
    buffer_load_dwordx4 v[120:123], v0, s[28:31], s48 offen offset:2048
    s_waitcnt vmcnt(15)
    v_mfma_f32_16x16x32_bf16 v[28:31], a[248:251], v[124:127], v[28:31]
    v_mfma_f32_16x16x32_bf16 v[32:35], a[252:255], v[124:127], v[32:35]
    v_mfma_f32_16x16x32_bf16 v[36:39], v[252:255], v[124:127], v[36:39]
    s_nop 5
    ds_write_b128 v48, v[16:19] offset:0
    ds_write_b128 v48, v[20:23] offset:1024
    ds_write_b128 v48, v[24:27] offset:2048
    ds_write_b128 v48, v[28:31] offset:3072
    ds_write_b128 v48, v[32:35] offset:4096
    ds_write_b128 v48, v[36:39] offset:5120
    s_waitcnt lgkmcnt(0)
    s_barrier
    ds_read_b128 v[24:27], v50 offset:2048
    ds_read_b128 v[28:31], v50 offset:8192
    ds_read_b128 v[32:35], v50 offset:14336
    ds_read_b128 v[36:39], v50 offset:20480
    v_xor_b32 v48, 0x8000, v48
    v_xor_b32 v50, 0x8000, v50
    v_lshlrev_b32 v16, 16, v40
    v_and_b32 v17, 0xffff0000, v40
    v_lshlrev_b32 v18, 16, v41
    v_and_b32 v19, 0xffff0000, v41
    buffer_load_dwordx2 v[40:41], v12, s[28:31], s41 offen
    s_waitcnt lgkmcnt(3)
    v_add_f32 v16, v16, v24
    v_add_f32 v17, v17, v25
    v_add_f32 v18, v18, v26
    v_add_f32 v19, v19, v27
    s_waitcnt lgkmcnt(2)
    v_add_f32 v16, v16, v28
    v_add_f32 v17, v17, v29
    v_add_f32 v18, v18, v30
    v_add_f32 v19, v19, v31
    s_waitcnt lgkmcnt(1)
    v_add_f32 v16, v16, v32
    v_add_f32 v17, v17, v33
    v_add_f32 v18, v18, v34
    v_add_f32 v19, v19, v35
    s_waitcnt lgkmcnt(0)
    v_add_f32 v16, v16, v36
    v_add_f32 v17, v17, v37
    v_add_f32 v18, v18, v38
    v_add_f32 v19, v19, v39
    v_cvt_pk_bf16_f32 v52, v16, v17
    v_cvt_pk_bf16_f32 v53, v18, v19
    s_cmp_eq_u32 s34, 0
    s_cbranch_scc1 LtwZ_l0
    s_mul_i32 s17, s35, 36864
    buffer_store_dwordx2 v[52:53], v13, s[24:27], s17 offen sc1
    s_cmp_lg_u32 s62, 0
    s_cbranch_scc1 LtwZ_item
LtwZ_chk:
    s_min_u32 s17, s32, s33
    s_cmp_lt_u32 s17, 64
    s_cbranch_scc1 LtwZ_idle
    s_branch L_role_tw_exit
LtwZ_l0:
    s_add_u32 s47, s47, 2359296
    buffer_store_dwordx2 v[52:53], v12, s[8:11], s47 offen sc1
    v_add_f32 v44, v16, v17
    v_mul_f32 v45, v16, v16
    v_fmac_f32 v45, v17, v17
    v_add_f32 v44, v44, v18
    v_fmac_f32 v45, v18, v18
    v_add_f32 v44, v44, v19
    v_fmac_f32 v45, v19, v19
    v_mov_b32 v46, v44
    v_mov_b32 v47, v45
    s_nop 0
    v_permlane32_swap_b32 v44, v46
    v_permlane32_swap_b32 v45, v47
    v_add_f32 v44, v44, v46
    v_add_f32 v45, v45, v47
    v_mov_b32 v46, v44
    v_mov_b32 v47, v45
    s_nop 0
    v_permlane16_swap_b32 v44, v46
    v_permlane16_swap_b32 v45, v47
    v_add_f32 v44, v44, v46
    v_add_f32 v45, v45, v47
    s_mul_i32 s17, s35, 6144
    s_add_u32 s17, s17, 16515072
    s_mov_b64 exec, 0xffff
    buffer_store_dwordx2 v[44:45], v14, s[8:11], s17 offen sc1
    s_mov_b64 exec, -1
    s_mul_i32 s43, s35, 22528
    s_add_u32 s43, s43, s49
    s_cmp_lg_u32 s62, 0
    s_cbranch_scc1 LtwZ_item
    s_waitcnt vmcnt(0)
    s_mov_b64 exec, 1
    buffer_store_dword v3, v4, s[8:11], s43 offen sc1
    s_mov_b64 exec, -1
    s_mov_b32 s43, 0
    s_branch LtwZ_chk
L_role_tw_abort:
    s_waitcnt lgkmcnt(0)
    s_mov_b64 exec, -1
    v_mov_b32 v0, 60
    s_lshl_b32 s5, s3, 8
    s_or_b32 s5, s5, s4
    s_or_b32 s5, s5, 0x10000
    v_mov_b32 v1, s5
    global_store_dword v0, v1, s[12:13]
    s_endpgm
L_role_tw_exit:
    s_endpgm
.p2align 6
L_role_r:
    s_mov_b32 s32, s3
    s_mov_b32 s15, s4
    v_and_b32 v60, 63, v0
    v_and_b32 v61, 15, v60
    v_lshrrev_b32 v62, 4, v60
    v_lshlrev_b32 v0, 4, v60
    s_mul_i32 s17, s14, 34816
    s_add_u32 s17, s17, 23296
    v_add_u32 v8, s17, v0
    s_mov_b32 s50, 0xfffffffe
    s_mov_b32 s44, 0x3e0293ee
    s_mov_b32 s45, 0x3e0293ee
    s_mov_b32 s52, 0x3f803f80
    s_mov_b32 s53, 0x3f803f80
    s_mov_b32 s40, 1
    s_mov_b32 s46, 0x00ff00ff
    s_cmp_eq_u32 s14, 2
    s_cselect_b32 s46, 0x00030003, s46
    s_mov_b32 s47, s46
    v_bfe_u32 v63, v61, 1, 1
    v_mov_b32 v1, 0x4444
    v_mov_b32 v64, 0xeeee
    v_cmp_eq_u32 vcc, 0, v63
    s_nop 1
    v_cndmask_b32 v1, v64, v1, vcc
    v_mul_u32_u24 v64, 1152, v62
    v_lshl_add_u32 v2, v61, 2, v64
    s_lshl_b32 s17, s14, 6
    s_add_u32 s18, s17, 0
    v_add_u32 v2, s18, v2
    v_mul_u32_u24 v64, 288, v61
    v_lshl_add_u32 v3, v62, 4, v64
    v_add_u32 v3, 0, v3
    v_lshrrev_b32 v64, 2, v61
    v_and_b32 v65, 1, v61
    v_lshl_add_u32 v64, v64, 1, v65
    v_mul_u32_u24 v65, 288, v64
    v_lshl_add_u32 v4, v62, 5, v65
    v_lshl_add_u32 v4, v63, 4, v4
    v_add_u32 v4, 4608, v4
    v_xor_b32 v63, 1, v63
    v_mul_u32_u24 v63, 2304, v63
    v_add_u32 v5, v65, v63
    v_lshl_add_u32 v5, v62, 4, v5
    s_add_u32 s18, s17, 4608
    v_add_u32 v5, s18, v5
    s_lshr_b32 s70, s15, 3
    s_bfe_u32 s71, s15, 0x20001
    s_and_b32 s72, s15, 1
    v_bfe_u32 v64, v61, 2, 1
    v_lshl_add_u32 v63, v64, 2, v62
    v_mul_u32_u24 v63, 9216, v63
    v_lshrrev_b32 v65, 3, v61
    v_lshlrev_b32 v65, 2, v65
    v_and_b32 v64, 3, v61
    v_add_u32 v65, v65, v64
    s_lshl_b32 s73, s71, 4
    s_lshl_b32 s17, s72, 3
    s_add_u32 s73, s73, s17
    v_add_u32 v65, s73, v65
    s_lshl_b32 s17, s70, 6
    v_add_u32 v65, s17, v65
    s_cmp_eq_u32 s14, 2
    s_cselect_b32 s17, 2, 4
    v_lshlrev_b32 v65, s17, v65
    v_add_u32 v6, v63, v65
    s_lshl_b32 s17, s14, 12
    v_add_u32 v6, s17, v6
    v_lshrrev_b32 v66, 1, v61
    s_lshl_b32 s17, s14, 2
    v_add_u32 v66, s17, v66
    v_and_b32 v64, 1, v61
    s_lshl_b32 s17, s70, 4
    s_lshl_b32 s18, s71, 2
    s_add_u32 s17, s17, s18
    s_lshl_b32 s18, s72, 1
    s_add_u32 s17, s17, s18
    v_add_u32 v65, s17, v64
    v_lshl_add_u32 v65, v66, 6, v65
    v_lshlrev_b32 v65, 4, v65
    v_lshl_add_u32 v7, v62, 2, v65
    s_lshl_b32 s17, s71, 1
    v_add_u32 v64, s17, v64
    v_mul_u32_u24 v64, 576, v64
    v_lshl_add_u32 v64, v66, 4, v64
    v_lshl_add_u32 v64, v62, 1, v64
    s_mul_i32 s17, s70, 144
    s_lshl_b32 s18, s72, 3
    s_add_u32 s17, s17, s18
    v_add_u32 v64, s17, v64
    v_lshlrev_b32 v67, 1, v64
    s_mul_i32 s48, s32, 1048576
    s_add_u32 s48, s48, 4194304
    s_mul_i32 s17, s15, 9216
    s_add_u32 s17, s17, s48
    s_lshl_b32 s18, s14, 10
    s_add_u32 s38, s17, s18
    s_lshl_b32 s19, s14, 8
    s_add_u32 s39, s17, s19
    s_add_u32 s39, s39, 8192
    s_add_u32 s37, s48, 983040
    s_xor_b32 s36, s37, 16384
    s_add_u32 s34, s37, s18
    s_add_u32 s35, s37, 8192
    s_mul_i32 s17, s32, 50331648
    s_lshl_b32 s19, s15, 13
    s_add_u32 s17, s17, s19
    s_add_u32 s68, s17, 77594624
    s_lshl_b32 s18, s14, 11
    s_add_u32 s17, s17, s18
    s_add_u32 s41, s17, 60817408
    s_add_u32 s42, s17, 77594624
    s_mul_i32 s17, s32, 8388608
    s_lshl_b32 s19, s15, 12
    s_add_u32 s17, s17, s19
    s_add_u32 s43, s17, 27262976
    s_mul_i32 s17, s32, 1441792
    s_lshl_b32 s19, s15, 9
    s_add_u32 s17, s17, s19
    s_add_u32 s66, s17, 5376
    s_mov_b32 s33, 0
    s_add_u32 s62, s48, 0
    s_add_u32 s63, s48, 73728
    s_add_u32 s64, s48, 147456
    s_add_u32 s65, s48, 221184
    s_load_dwordx2 s[20:21], s[0:1], 32
    s_mov_b32 s22, 9216
    s_mov_b32 s23, 0x00020000
    s_waitcnt lgkmcnt(0)
    s_and_b32 s21, s21, 0xffff
    s_cmp_gt_u32 s14, 2
    s_cbranch_scc1 Lr_mem0_done
    s_mov_b64 exec, s[46:47]
    buffer_load_dword v64, v67, s[20:23], 0 offen
    s_waitcnt vmcnt(0)
    v_min_u32 v64, s50, v64
    buffer_store_dword v64, v7, s[8:11], s37 offen sc1
    v_mov_b32 v64, -1
    buffer_store_dword v64, v7, s[8:11], s36 offen sc1
    s_mov_b64 exec, -1
Lr_mem0_done:
    v_mov_b32 v64, 0
    v_mov_b32 v65, 0
    v_mov_b32 v66, 0
    v_mov_b32 v67, 0
    v_lshrrev_b32 v63, 2, v0
    buffer_store_dwordx4 v[64:67], v0, s[8:11], s38 offen sc1
    s_add_u32 s17, s38, 4096
    buffer_store_dwordx4 v[64:67], v0, s[8:11], s17 offen sc1
    buffer_store_dword v64, v63, s[8:11], s39 offen sc1
    s_waitcnt vmcnt(0)
    s_barrier
    s_cmp_lg_u32 s14, 0
    s_cbranch_scc1 Lr_noadd
    s_lshl_b32 s17, s32, 2
    s_add_u32 s17, s17, 192
    v_mov_b32 v63, s17
    v_mov_b32 v64, 1
    s_mov_b64 exec, 1
    global_atomic_add v63, v64, s[12:13]
    s_mov_b64 exec, -1
Lr_noadd:
    s_cmp_lt_u32 s14, 3
    s_cbranch_scc1 Lr_not_w3
    v_lshlrev_b32 v6, 3, v0
    v_lshrrev_b32 v63, 2, v0
    v_and_b32 v7, 12, v63
    v_and_b32 v63, 16, v63
    v_lshl_add_u32 v7, v63, 3, v7
Lr_not_w3:
    s_load_dwordx2 s[20:21], s[0:1], 40
    s_mov_b32 s22, 4718592
    s_mov_b32 s23, 0x00020000
    s_waitcnt lgkmcnt(0)
    s_and_b32 s21, s21, 0xffff
    s_load_dwordx2 s[24:25], s[0:1], 48
    s_mov_b32 s26, 4718592
    s_mov_b32 s27, 0x00020000
    s_waitcnt lgkmcnt(0)
    s_and_b32 s25, s25, 0xffff
    s_load_dwordx2 s[28:29], s[0:1], 56
    s_mov_b32 s30, 4718592
    s_mov_b32 s31, 0x00020000
    s_waitcnt lgkmcnt(0)
    s_and_b32 s29, s29, 0xffff
    s_load_dwordx2 s[76:77], s[0:1], 64
    s_mov_b32 s78, 4718592
    s_mov_b32 s79, 0x00020000
    s_waitcnt lgkmcnt(0)
    s_and_b32 s77, s77, 0xffff
    v_lshrrev_b32 v60, 4, v0
    v_and_b32 v61, 15, v60
    v_lshrrev_b32 v62, 4, v60
    s_mul_i32 s72, s14, 34816
    s_add_u32 s72, s72, 23296
    s_mul_i32 s70, s14, 1179648
    s_lshl_b32 s17, s15, 8
    s_add_u32 s70, s70, s17
    s_mul_i32 s71, s15, 147456
    s_mul_i32 s17, s14, 288
    s_add_u32 s71, s71, s17
    v_and_b32 v63, 1, v62
    v_lshrrev_b32 v64, 1, v61
    v_xor_b32 v64, v64, v63
    v_lshlrev_b32 v64, 5, v64
    v_and_b32 v65, 1, v61
    v_lshl_add_u32 v64, v65, 4, v64
    v_lshl_add_u32 v12, v62, 13, v64
    v_xor_b32 v13, 128, v12
    v_xor_b32 v14, 64, v12
    v_xor_b32 v15, 192, v12
    v_lshrrev_b32 v63, 2, v60
    v_mul_u32_u24 v63, 1152, v63
    v_and_b32 v64, 3, v60
    v_lshl_add_u32 v16, v64, 4, v63
    v_lshrrev_b32 v63, 1, v60
    v_mul_u32_u24 v63, 1152, v63
    v_and_b32 v64, 1, v60
    v_lshl_add_u32 v17, v64, 4, v63
    v_lshrrev_b32 v40, 2, v61
    v_and_b32 v41, 3, v61
    v_and_b32 v63, 1, v62
    v_lshl_add_u32 v42, v63, 2, v40
    v_and_b32 v64, 1, v40
    v_lshl_add_u32 v64, v63, 2, v64
    v_lshrrev_b32 v65, 1, v40
    v_lshl_add_u32 v64, v65, 3, v64
    v_lshlrev_b32 v64, 8, v64
    v_lshl_add_u32 v64, v41, 3, v64
    v_lshrrev_b32 v65, 1, v62
    v_mul_u32_u24 v65, 34816, v65
    v_add_u32 v64, v64, v65
    v_add_u32 v64, 23296, v64
    s_lshl_b32 s17, s14, 1
    s_add_u32 s18, s17, 0
    v_xor_b32 v65, s18, v42
    v_lshl_add_u32 v18, v65, 5, v64
    v_add_u32 v19, 69632, v18
    s_add_u32 s18, s17, 1
    v_xor_b32 v65, s18, v42
    v_lshl_add_u32 v20, v65, 5, v64
    v_add_u32 v21, 69632, v20
    v_lshrrev_b32 v63, 1, v62
    v_lshlrev_b32 v63, 3, v63
    v_and_b32 v64, 1, v62
    v_lshl_add_u32 v63, v64, 1, v63
    v_and_b32 v64, 1, v40
    v_lshl_add_u32 v63, v64, 4, v63
    v_lshrrev_b32 v64, 1, v40
    v_lshl_add_u32 v63, v64, 2, v63
    v_lshlrev_b32 v64, 3, v41
    v_lshl_add_u32 v22, v63, 6, v64
    v_add_u32 v22, s72, v22
    v_lshl_add_u32 v23, v63, 5, v64
    v_add_u32 v23, s72, v23
    s_add_u32 m0, s72, 0
    s_add_u32 s17, s70, 0
    buffer_load_dwordx4 v12, s[20:23], s17 offen lds
    s_add_u32 m0, m0, 1024
    s_add_u32 s17, s70, 32768
    buffer_load_dwordx4 v13, s[20:23], s17 offen lds
    s_add_u32 m0, m0, 1024
    s_add_u32 s17, s70, 65536
    buffer_load_dwordx4 v14, s[20:23], s17 offen lds
    s_add_u32 m0, m0, 1024
    s_add_u32 s17, s70, 98304
    buffer_load_dwordx4 v15, s[20:23], s17 offen lds
    s_add_u32 m0, s72, 4096
    s_add_u32 s17, s70, 0
    buffer_load_dwordx4 v12, s[24:27], s17 offen lds
    s_add_u32 m0, m0, 1024
    s_add_u32 s17, s70, 32768
    buffer_load_dwordx4 v13, s[24:27], s17 offen lds
    s_add_u32 m0, m0, 1024
    s_add_u32 s17, s70, 65536
    buffer_load_dwordx4 v14, s[24:27], s17 offen lds
    s_add_u32 m0, m0, 1024
    s_add_u32 s17, s70, 98304
    buffer_load_dwordx4 v15, s[24:27], s17 offen lds
    s_add_u32 m0, s72, 8192
    s_add_u32 s17, s70, 131072
    buffer_load_dwordx4 v12, s[20:23], s17 offen lds
    s_add_u32 m0, m0, 1024
    s_add_u32 s17, s70, 163840
    buffer_load_dwordx4 v13, s[20:23], s17 offen lds
    s_add_u32 m0, m0, 1024
    s_add_u32 s17, s70, 196608
    buffer_load_dwordx4 v14, s[20:23], s17 offen lds
    s_add_u32 m0, m0, 1024
    s_add_u32 s17, s70, 229376
    buffer_load_dwordx4 v15, s[20:23], s17 offen lds
    s_add_u32 m0, s72, 12288
    s_add_u32 s17, s70, 131072
    buffer_load_dwordx4 v12, s[24:27], s17 offen lds
    s_add_u32 m0, m0, 1024
    s_add_u32 s17, s70, 163840
    buffer_load_dwordx4 v13, s[24:27], s17 offen lds
    s_add_u32 m0, m0, 1024
    s_add_u32 s17, s70, 196608
    buffer_load_dwordx4 v14, s[24:27], s17 offen lds
    s_add_u32 m0, m0, 1024
    s_add_u32 s17, s70, 229376
    buffer_load_dwordx4 v15, s[24:27], s17 offen lds
    s_add_u32 m0, s72, 16384
    s_add_u32 s17, s70, 131072
    buffer_load_dwordx4 v12, s[28:31], s17 offen lds
    s_add_u32 m0, m0, 1024
    s_add_u32 s17, s70, 163840
    buffer_load_dwordx4 v13, s[28:31], s17 offen lds
    s_add_u32 m0, m0, 1024
    s_add_u32 s17, s70, 196608
    buffer_load_dwordx4 v14, s[28:31], s17 offen lds
    s_add_u32 m0, m0, 1024
    s_add_u32 s17, s70, 229376
    buffer_load_dwordx4 v15, s[28:31], s17 offen lds
    s_add_u32 m0, s72, 20480
    s_add_u32 s17, s70, 262144
    buffer_load_dwordx4 v12, s[20:23], s17 offen lds
    s_add_u32 m0, m0, 1024
    s_add_u32 s17, s70, 294912
    buffer_load_dwordx4 v13, s[20:23], s17 offen lds
    s_add_u32 m0, m0, 1024
    s_add_u32 s17, s70, 327680
    buffer_load_dwordx4 v14, s[20:23], s17 offen lds
    s_add_u32 m0, m0, 1024
    s_add_u32 s17, s70, 360448
    buffer_load_dwordx4 v15, s[20:23], s17 offen lds
    s_add_u32 m0, s72, 24576
    s_add_u32 s17, s70, 262144
    buffer_load_dwordx4 v12, s[24:27], s17 offen lds
    s_add_u32 m0, m0, 1024
    s_add_u32 s17, s70, 294912
    buffer_load_dwordx4 v13, s[24:27], s17 offen lds
    s_add_u32 m0, m0, 1024
    s_add_u32 s17, s70, 327680
    buffer_load_dwordx4 v14, s[24:27], s17 offen lds
    s_add_u32 m0, m0, 1024
    s_add_u32 s17, s70, 360448
    buffer_load_dwordx4 v15, s[24:27], s17 offen lds
    s_add_u32 m0, s72, 28672
    s_add_u32 s17, s70, 393216
    buffer_load_dwordx4 v12, s[20:23], s17 offen lds
    s_add_u32 m0, m0, 1024
    s_add_u32 s17, s70, 425984
    buffer_load_dwordx4 v13, s[20:23], s17 offen lds
    s_add_u32 m0, m0, 1024
    s_add_u32 s17, s70, 458752
    buffer_load_dwordx4 v14, s[20:23], s17 offen lds
    s_add_u32 m0, m0, 1024
    s_add_u32 s17, s70, 491520
    buffer_load_dwordx4 v15, s[20:23], s17 offen lds
    s_add_u32 m0, s72, 32768
    s_add_u32 s17, s71, 256
    buffer_load_dwordx4 v17, s[76:79], s17 offen lds
    s_add_u32 m0, m0, 1024
    s_add_u32 s17, s71, 37120
    buffer_load_dwordx4 v17, s[76:79], s17 offen lds
    s_waitcnt vmcnt(30)
    s_barrier
    ds_read_b64_tr_b16 v[72:73], v18 offset:0
    ds_read_b64_tr_b16 v[74:75], v18 offset:512
    ds_read_b64_tr_b16 v[76:77], v19 offset:0
    ds_read_b64_tr_b16 v[78:79], v19 offset:512
    ds_read_b64_tr_b16 v[80:81], v20 offset:0
    ds_read_b64_tr_b16 v[82:83], v20 offset:512
    ds_read_b64_tr_b16 v[84:85], v21 offset:0
    ds_read_b64_tr_b16 v[86:87], v21 offset:512
    s_waitcnt lgkmcnt(0)
    s_waitcnt vmcnt(26)
    s_barrier
    s_add_u32 m0, s72, 0
    s_add_u32 s17, s70, 393216
    buffer_load_dwordx4 v12, s[24:27], s17 offen lds
    s_add_u32 m0, m0, 1024
    s_add_u32 s17, s70, 425984
    buffer_load_dwordx4 v13, s[24:27], s17 offen lds
    s_add_u32 m0, m0, 1024
    s_add_u32 s17, s70, 458752
    buffer_load_dwordx4 v14, s[24:27], s17 offen lds
    s_add_u32 m0, m0, 1024
    s_add_u32 s17, s70, 491520
    buffer_load_dwordx4 v15, s[24:27], s17 offen lds
    ds_read_b64_tr_b16 v[184:185], v18 offset:4096
    ds_read_b64_tr_b16 v[186:187], v18 offset:4608
    ds_read_b64_tr_b16 v[188:189], v19 offset:4096
    ds_read_b64_tr_b16 v[190:191], v19 offset:4608
    ds_read_b64_tr_b16 v[192:193], v20 offset:4096
    ds_read_b64_tr_b16 v[194:195], v20 offset:4608
    ds_read_b64_tr_b16 v[196:197], v21 offset:4096
    ds_read_b64_tr_b16 v[198:199], v21 offset:4608
    s_waitcnt lgkmcnt(0)
    s_waitcnt vmcnt(26)
    s_barrier
    s_add_u32 m0, s72, 4096
    s_add_u32 s17, s70, 393216
    buffer_load_dwordx4 v12, s[28:31], s17 offen lds
    s_add_u32 m0, m0, 1024
    s_add_u32 s17, s70, 425984
    buffer_load_dwordx4 v13, s[28:31], s17 offen lds
    s_add_u32 m0, m0, 1024
    s_add_u32 s17, s70, 458752
    buffer_load_dwordx4 v14, s[28:31], s17 offen lds
    s_add_u32 m0, m0, 1024
    s_add_u32 s17, s70, 491520
    buffer_load_dwordx4 v15, s[28:31], s17 offen lds
    ds_read_b64_tr_b16 v[88:89], v18 offset:8192
    ds_read_b64_tr_b16 v[90:91], v18 offset:8704
    ds_read_b64_tr_b16 v[92:93], v19 offset:8192
    ds_read_b64_tr_b16 v[94:95], v19 offset:8704
    ds_read_b64_tr_b16 v[96:97], v20 offset:8192
    ds_read_b64_tr_b16 v[98:99], v20 offset:8704
    ds_read_b64_tr_b16 v[100:101], v21 offset:8192
    ds_read_b64_tr_b16 v[102:103], v21 offset:8704
    s_waitcnt lgkmcnt(0)
    s_waitcnt vmcnt(26)
    s_barrier
    s_add_u32 m0, s72, 8192
    s_add_u32 s17, s70, 524288
    buffer_load_dwordx4 v12, s[24:27], s17 offen lds
    s_add_u32 m0, m0, 1024
    s_add_u32 s17, s70, 557056
    buffer_load_dwordx4 v13, s[24:27], s17 offen lds
    s_add_u32 m0, m0, 1024
    s_add_u32 s17, s70, 589824
    buffer_load_dwordx4 v14, s[24:27], s17 offen lds
    s_add_u32 m0, m0, 1024
    s_add_u32 s17, s70, 622592
    buffer_load_dwordx4 v15, s[24:27], s17 offen lds
    ds_read_b64_tr_b16 v[200:201], v18 offset:12288
    ds_read_b64_tr_b16 v[202:203], v18 offset:12800
    ds_read_b64_tr_b16 v[204:205], v19 offset:12288
    ds_read_b64_tr_b16 v[206:207], v19 offset:12800
    ds_read_b64_tr_b16 v[208:209], v20 offset:12288
    ds_read_b64_tr_b16 v[210:211], v20 offset:12800
    ds_read_b64_tr_b16 v[212:213], v21 offset:12288
    ds_read_b64_tr_b16 v[214:215], v21 offset:12800
    s_waitcnt lgkmcnt(0)
    s_waitcnt vmcnt(26)
    s_barrier
    s_add_u32 m0, s72, 12288
    s_add_u32 s17, s70, 524288
    buffer_load_dwordx4 v12, s[28:31], s17 offen lds
    s_add_u32 m0, m0, 1024
    s_add_u32 s17, s70, 557056
    buffer_load_dwordx4 v13, s[28:31], s17 offen lds
    s_add_u32 m0, m0, 1024
    s_add_u32 s17, s70, 589824
    buffer_load_dwordx4 v14, s[28:31], s17 offen lds
    s_add_u32 m0, m0, 1024
    s_add_u32 s17, s70, 622592
    buffer_load_dwordx4 v15, s[28:31], s17 offen lds
    ds_read_b64_tr_b16 a[72:73], v18 offset:16384
    ds_read_b64_tr_b16 a[74:75], v18 offset:16896
    ds_read_b64_tr_b16 a[76:77], v19 offset:16384
    ds_read_b64_tr_b16 a[78:79], v19 offset:16896
    ds_read_b64_tr_b16 a[80:81], v20 offset:16384
    ds_read_b64_tr_b16 a[82:83], v20 offset:16896
    ds_read_b64_tr_b16 a[84:85], v21 offset:16384
    ds_read_b64_tr_b16 a[86:87], v21 offset:16896
    s_waitcnt lgkmcnt(0)
    s_waitcnt vmcnt(26)
    s_barrier
    s_add_u32 m0, s72, 16384
    s_add_u32 s17, s70, 655360
    buffer_load_dwordx4 v12, s[20:23], s17 offen lds
    s_add_u32 m0, m0, 1024
    s_add_u32 s17, s70, 688128
    buffer_load_dwordx4 v13, s[20:23], s17 offen lds
    s_add_u32 m0, m0, 1024
    s_add_u32 s17, s70, 720896
    buffer_load_dwordx4 v14, s[20:23], s17 offen lds
    s_add_u32 m0, m0, 1024
    s_add_u32 s17, s70, 753664
    buffer_load_dwordx4 v15, s[20:23], s17 offen lds
    ds_read_b64_tr_b16 v[104:105], v18 offset:20480
    ds_read_b64_tr_b16 v[106:107], v18 offset:20992
    ds_read_b64_tr_b16 v[108:109], v19 offset:20480
    ds_read_b64_tr_b16 v[110:111], v19 offset:20992
    ds_read_b64_tr_b16 v[112:113], v20 offset:20480
    ds_read_b64_tr_b16 v[114:115], v20 offset:20992
    ds_read_b64_tr_b16 v[116:117], v21 offset:20480
    ds_read_b64_tr_b16 v[118:119], v21 offset:20992
    s_waitcnt lgkmcnt(0)
    s_waitcnt vmcnt(26)
    s_barrier
    s_add_u32 m0, s72, 20480
    s_add_u32 s17, s70, 655360
    buffer_load_dwordx4 v12, s[24:27], s17 offen lds
    s_add_u32 m0, m0, 1024
    s_add_u32 s17, s70, 688128
    buffer_load_dwordx4 v13, s[24:27], s17 offen lds
    s_add_u32 m0, m0, 1024
    s_add_u32 s17, s70, 720896
    buffer_load_dwordx4 v14, s[24:27], s17 offen lds
    s_add_u32 m0, m0, 1024
    s_add_u32 s17, s70, 753664
    buffer_load_dwordx4 v15, s[24:27], s17 offen lds
    ds_read_b64_tr_b16 v[216:217], v18 offset:24576
    ds_read_b64_tr_b16 v[218:219], v18 offset:25088
    ds_read_b64_tr_b16 v[220:221], v19 offset:24576
    ds_read_b64_tr_b16 v[222:223], v19 offset:25088
    ds_read_b64_tr_b16 v[224:225], v20 offset:24576
    ds_read_b64_tr_b16 v[226:227], v20 offset:25088
    ds_read_b64_tr_b16 v[228:229], v21 offset:24576
    ds_read_b64_tr_b16 v[230:231], v21 offset:25088
    s_waitcnt lgkmcnt(0)
    s_waitcnt vmcnt(26)
    s_barrier
    s_add_u32 m0, s72, 24576
    s_add_u32 s17, s70, 655360
    buffer_load_dwordx4 v12, s[28:31], s17 offen lds
    s_add_u32 m0, m0, 1024
    s_add_u32 s17, s70, 688128
    buffer_load_dwordx4 v13, s[28:31], s17 offen lds
    s_add_u32 m0, m0, 1024
    s_add_u32 s17, s70, 720896
    buffer_load_dwordx4 v14, s[28:31], s17 offen lds
    s_add_u32 m0, m0, 1024
    s_add_u32 s17, s70, 753664
    buffer_load_dwordx4 v15, s[28:31], s17 offen lds
    ds_read_b64_tr_b16 v[120:121], v18 offset:28672
    ds_read_b64_tr_b16 v[122:123], v18 offset:29184
    ds_read_b64_tr_b16 v[124:125], v19 offset:28672
    ds_read_b64_tr_b16 v[126:127], v19 offset:29184
    ds_read_b64_tr_b16 v[128:129], v20 offset:28672
    ds_read_b64_tr_b16 v[130:131], v20 offset:29184
    ds_read_b64_tr_b16 v[132:133], v21 offset:28672
    ds_read_b64_tr_b16 v[134:135], v21 offset:29184
    s_waitcnt lgkmcnt(0)
    s_waitcnt vmcnt(24)
    s_barrier
    s_add_u32 m0, s72, 28672
    s_add_u32 s17, s70, 786432
    buffer_load_dwordx4 v12, s[24:27], s17 offen lds
    s_add_u32 m0, m0, 1024
    s_add_u32 s17, s70, 819200
    buffer_load_dwordx4 v13, s[24:27], s17 offen lds
    s_add_u32 m0, m0, 1024
    s_add_u32 s17, s70, 851968
    buffer_load_dwordx4 v14, s[24:27], s17 offen lds
    s_add_u32 m0, m0, 1024
    s_add_u32 s17, s70, 884736
    buffer_load_dwordx4 v15, s[24:27], s17 offen lds
    ds_read_b64_tr_b16 v[232:233], v18 offset:0
    ds_read_b64_tr_b16 v[234:235], v18 offset:512
    ds_read_b64_tr_b16 v[236:237], v19 offset:0
    ds_read_b64_tr_b16 v[238:239], v19 offset:512
    ds_read_b64_tr_b16 v[240:241], v20 offset:0
    ds_read_b64_tr_b16 v[242:243], v20 offset:512
    ds_read_b64_tr_b16 v[244:245], v21 offset:0
    ds_read_b64_tr_b16 v[246:247], v21 offset:512
    s_waitcnt lgkmcnt(0)
    s_waitcnt vmcnt(24)
    s_barrier
    s_add_u32 m0, s72, 0
    s_add_u32 s17, s70, 786432
    buffer_load_dwordx4 v12, s[28:31], s17 offen lds
    s_add_u32 m0, m0, 1024
    s_add_u32 s17, s70, 819200
    buffer_load_dwordx4 v13, s[28:31], s17 offen lds
    s_add_u32 m0, m0, 1024
    s_add_u32 s17, s70, 851968
    buffer_load_dwordx4 v14, s[28:31], s17 offen lds
    s_add_u32 m0, m0, 1024
    s_add_u32 s17, s70, 884736
    buffer_load_dwordx4 v15, s[28:31], s17 offen lds
    ds_read_b64_tr_b16 a[88:89], v18 offset:4096
    ds_read_b64_tr_b16 a[90:91], v18 offset:4608
    ds_read_b64_tr_b16 a[92:93], v19 offset:4096
    ds_read_b64_tr_b16 a[94:95], v19 offset:4608
    ds_read_b64_tr_b16 a[96:97], v20 offset:4096
    ds_read_b64_tr_b16 a[98:99], v20 offset:4608
    ds_read_b64_tr_b16 a[100:101], v21 offset:4096
    ds_read_b64_tr_b16 a[102:103], v21 offset:4608
    s_waitcnt lgkmcnt(0)
    s_waitcnt vmcnt(24)
    s_barrier
    s_add_u32 m0, s72, 4096
    s_add_u32 s17, s70, 917504
    buffer_load_dwordx4 v12, s[20:23], s17 offen lds
    s_add_u32 m0, m0, 1024
    s_add_u32 s17, s70, 950272
    buffer_load_dwordx4 v13, s[20:23], s17 offen lds
    s_add_u32 m0, m0, 1024
    s_add_u32 s17, s70, 983040
    buffer_load_dwordx4 v14, s[20:23], s17 offen lds
    s_add_u32 m0, m0, 1024
    s_add_u32 s17, s70, 1015808
    buffer_load_dwordx4 v15, s[20:23], s17 offen lds
    ds_read_b64_tr_b16 v[248:249], v18 offset:8192
    ds_read_b64_tr_b16 v[250:251], v18 offset:8704
    ds_read_b64_tr_b16 v[252:253], v19 offset:8192
    ds_read_b64_tr_b16 v[254:255], v19 offset:8704
    ds_read_b64_tr_b16 a[0:1], v20 offset:8192
    ds_read_b64_tr_b16 a[2:3], v20 offset:8704
    ds_read_b64_tr_b16 a[4:5], v21 offset:8192
    ds_read_b64_tr_b16 a[6:7], v21 offset:8704
    s_waitcnt lgkmcnt(0)
    s_waitcnt vmcnt(24)
    s_barrier
    s_add_u32 m0, s72, 8192
    s_add_u32 s17, s70, 917504
    buffer_load_dwordx4 v12, s[24:27], s17 offen lds
    s_add_u32 m0, m0, 1024
    s_add_u32 s17, s70, 950272
    buffer_load_dwordx4 v13, s[24:27], s17 offen lds
    s_add_u32 m0, m0, 1024
    s_add_u32 s17, s70, 983040
    buffer_load_dwordx4 v14, s[24:27], s17 offen lds
    s_add_u32 m0, m0, 1024
    s_add_u32 s17, s70, 1015808
    buffer_load_dwordx4 v15, s[24:27], s17 offen lds
    ds_read_b64_tr_b16 a[104:105], v18 offset:12288
    ds_read_b64_tr_b16 a[106:107], v18 offset:12800
    ds_read_b64_tr_b16 a[108:109], v19 offset:12288
    ds_read_b64_tr_b16 a[110:111], v19 offset:12800
    ds_read_b64_tr_b16 a[112:113], v20 offset:12288
    ds_read_b64_tr_b16 a[114:115], v20 offset:12800
    ds_read_b64_tr_b16 a[116:117], v21 offset:12288
    ds_read_b64_tr_b16 a[118:119], v21 offset:12800
    s_waitcnt lgkmcnt(0)
    s_waitcnt vmcnt(24)
    s_barrier
    s_add_u32 m0, s72, 12288
    s_add_u32 s17, s70, 917504
    buffer_load_dwordx4 v12, s[28:31], s17 offen lds
    s_add_u32 m0, m0, 1024
    s_add_u32 s17, s70, 950272
    buffer_load_dwordx4 v13, s[28:31], s17 offen lds
    s_add_u32 m0, m0, 1024
    s_add_u32 s17, s70, 983040
    buffer_load_dwordx4 v14, s[28:31], s17 offen lds
    s_add_u32 m0, m0, 1024
    s_add_u32 s17, s70, 1015808
    buffer_load_dwordx4 v15, s[28:31], s17 offen lds
    ds_read_b64_tr_b16 v[136:137], v18 offset:16384
    ds_read_b64_tr_b16 v[138:139], v18 offset:16896
    ds_read_b64_tr_b16 v[140:141], v19 offset:16384
    ds_read_b64_tr_b16 v[142:143], v19 offset:16896
    ds_read_b64_tr_b16 v[144:145], v20 offset:16384
    ds_read_b64_tr_b16 v[146:147], v20 offset:16896
    ds_read_b64_tr_b16 v[148:149], v21 offset:16384
    ds_read_b64_tr_b16 v[150:151], v21 offset:16896
    s_waitcnt lgkmcnt(0)
    s_waitcnt vmcnt(24)
    s_barrier
    s_add_u32 m0, s72, 16384
    s_add_u32 s17, s70, 1048576
    buffer_load_dwordx4 v12, s[20:23], s17 offen lds
    s_add_u32 m0, m0, 1024
    s_add_u32 s17, s70, 1081344
    buffer_load_dwordx4 v13, s[20:23], s17 offen lds
    s_add_u32 m0, m0, 1024
    s_add_u32 s17, s70, 1114112
    buffer_load_dwordx4 v14, s[20:23], s17 offen lds
    s_add_u32 m0, m0, 1024
    s_add_u32 s17, s70, 1146880
    buffer_load_dwordx4 v15, s[20:23], s17 offen lds
    ds_read_b64_tr_b16 a[8:9], v18 offset:20480
    ds_read_b64_tr_b16 a[10:11], v18 offset:20992
    ds_read_b64_tr_b16 a[12:13], v19 offset:20480
    ds_read_b64_tr_b16 a[14:15], v19 offset:20992
    ds_read_b64_tr_b16 a[16:17], v20 offset:20480
    ds_read_b64_tr_b16 a[18:19], v20 offset:20992
    ds_read_b64_tr_b16 a[20:21], v21 offset:20480
    ds_read_b64_tr_b16 a[22:23], v21 offset:20992
    s_waitcnt lgkmcnt(0)
    s_waitcnt vmcnt(24)
    s_barrier
    s_add_u32 m0, s72, 20480
    s_add_u32 s17, s70, 1048576
    buffer_load_dwordx4 v12, s[24:27], s17 offen lds
    s_add_u32 m0, m0, 1024
    s_add_u32 s17, s70, 1081344
    buffer_load_dwordx4 v13, s[24:27], s17 offen lds
    s_add_u32 m0, m0, 1024
    s_add_u32 s17, s70, 1114112
    buffer_load_dwordx4 v14, s[24:27], s17 offen lds
    s_add_u32 m0, m0, 1024
    s_add_u32 s17, s70, 1146880
    buffer_load_dwordx4 v15, s[24:27], s17 offen lds
    ds_read_b64_tr_b16 a[120:121], v18 offset:24576
    ds_read_b64_tr_b16 a[122:123], v18 offset:25088
    ds_read_b64_tr_b16 a[124:125], v19 offset:24576
    ds_read_b64_tr_b16 a[126:127], v19 offset:25088
    ds_read_b64_tr_b16 a[128:129], v20 offset:24576
    ds_read_b64_tr_b16 a[130:131], v20 offset:25088
    ds_read_b64_tr_b16 a[132:133], v21 offset:24576
    ds_read_b64_tr_b16 a[134:135], v21 offset:25088
    s_waitcnt lgkmcnt(0)
    s_waitcnt vmcnt(24)
    s_barrier
    s_add_u32 m0, s72, 24576
    s_add_u32 s17, s70, 1048576
    buffer_load_dwordx4 v12, s[28:31], s17 offen lds
    s_add_u32 m0, m0, 1024
    s_add_u32 s17, s70, 1081344
    buffer_load_dwordx4 v13, s[28:31], s17 offen lds
    s_add_u32 m0, m0, 1024
    s_add_u32 s17, s70, 1114112
    buffer_load_dwordx4 v14, s[28:31], s17 offen lds
    s_add_u32 m0, m0, 1024
    s_add_u32 s17, s70, 1146880
    buffer_load_dwordx4 v15, s[28:31], s17 offen lds
    ds_read_b64_tr_b16 a[24:25], v18 offset:28672
    ds_read_b64_tr_b16 a[26:27], v18 offset:29184
    ds_read_b64_tr_b16 a[28:29], v19 offset:28672
    ds_read_b64_tr_b16 a[30:31], v19 offset:29184
    ds_read_b64_tr_b16 a[32:33], v20 offset:28672
    ds_read_b64_tr_b16 a[34:35], v20 offset:29184
    ds_read_b64_tr_b16 a[36:37], v21 offset:28672
    ds_read_b64_tr_b16 a[38:39], v21 offset:29184
    s_waitcnt lgkmcnt(0)
    s_waitcnt vmcnt(24)
    s_barrier
    ds_read_b64_tr_b16 a[136:137], v18 offset:0
    ds_read_b64_tr_b16 a[138:139], v18 offset:512
    ds_read_b64_tr_b16 a[140:141], v19 offset:0
    ds_read_b64_tr_b16 a[142:143], v19 offset:512
    ds_read_b64_tr_b16 a[144:145], v20 offset:0
    ds_read_b64_tr_b16 a[146:147], v20 offset:512
    ds_read_b64_tr_b16 a[148:149], v21 offset:0
    ds_read_b64_tr_b16 a[150:151], v21 offset:512
    s_waitcnt lgkmcnt(0)
    s_waitcnt vmcnt(20)
    s_barrier
    s_add_u32 m0, s72, 0
    s_add_u32 s17, s70, 0
    buffer_load_dwordx4 v12, s[28:31], s17 offen lds
    s_add_u32 m0, m0, 1024
    s_add_u32 s17, s70, 32768
    buffer_load_dwordx4 v13, s[28:31], s17 offen lds
    s_add_u32 m0, m0, 1024
    s_add_u32 s17, s70, 65536
    buffer_load_dwordx4 v14, s[28:31], s17 offen lds
    s_add_u32 m0, m0, 1024
    s_add_u32 s17, s70, 98304
    buffer_load_dwordx4 v15, s[28:31], s17 offen lds
    ds_read_b64_tr_b16 v[152:153], v18 offset:4096
    ds_read_b64_tr_b16 v[154:155], v18 offset:4608
    ds_read_b64_tr_b16 v[156:157], v19 offset:4096
    ds_read_b64_tr_b16 v[158:159], v19 offset:4608
    ds_read_b64_tr_b16 v[160:161], v20 offset:4096
    ds_read_b64_tr_b16 v[162:163], v20 offset:4608
    ds_read_b64_tr_b16 v[164:165], v21 offset:4096
    ds_read_b64_tr_b16 v[166:167], v21 offset:4608
    s_waitcnt lgkmcnt(0)
    s_waitcnt vmcnt(20)
    s_barrier
    s_add_u32 m0, s72, 4096
    s_add_u32 s17, s70, 262144
    buffer_load_dwordx4 v12, s[28:31], s17 offen lds
    s_add_u32 m0, m0, 1024
    s_add_u32 s17, s70, 294912
    buffer_load_dwordx4 v13, s[28:31], s17 offen lds
    s_add_u32 m0, m0, 1024
    s_add_u32 s17, s70, 327680
    buffer_load_dwordx4 v14, s[28:31], s17 offen lds
    s_add_u32 m0, m0, 1024
    s_add_u32 s17, s70, 360448
    buffer_load_dwordx4 v15, s[28:31], s17 offen lds
    ds_read_b64_tr_b16 a[40:41], v18 offset:8192
    ds_read_b64_tr_b16 a[42:43], v18 offset:8704
    ds_read_b64_tr_b16 a[44:45], v19 offset:8192
    ds_read_b64_tr_b16 a[46:47], v19 offset:8704
    ds_read_b64_tr_b16 a[48:49], v20 offset:8192
    ds_read_b64_tr_b16 a[50:51], v20 offset:8704
    ds_read_b64_tr_b16 a[52:53], v21 offset:8192
    ds_read_b64_tr_b16 a[54:55], v21 offset:8704
    s_waitcnt lgkmcnt(0)
    s_waitcnt vmcnt(20)
    s_barrier
    s_add_u32 m0, s72, 8192
    s_add_u32 s17, s70, 524288
    buffer_load_dwordx4 v12, s[20:23], s17 offen lds
    s_add_u32 m0, m0, 1024
    s_add_u32 s17, s70, 557056
    buffer_load_dwordx4 v13, s[20:23], s17 offen lds
    s_add_u32 m0, m0, 1024
    s_add_u32 s17, s70, 589824
    buffer_load_dwordx4 v14, s[20:23], s17 offen lds
    s_add_u32 m0, m0, 1024
    s_add_u32 s17, s70, 622592
    buffer_load_dwordx4 v15, s[20:23], s17 offen lds
    ds_read_b64_tr_b16 a[152:153], v18 offset:12288
    ds_read_b64_tr_b16 a[154:155], v18 offset:12800
    ds_read_b64_tr_b16 a[156:157], v19 offset:12288
    ds_read_b64_tr_b16 a[158:159], v19 offset:12800
    ds_read_b64_tr_b16 a[160:161], v20 offset:12288
    ds_read_b64_tr_b16 a[162:163], v20 offset:12800
    ds_read_b64_tr_b16 a[164:165], v21 offset:12288
    ds_read_b64_tr_b16 a[166:167], v21 offset:12800
    s_waitcnt lgkmcnt(0)
    s_waitcnt vmcnt(20)
    s_barrier
    s_add_u32 m0, s72, 12288
    s_add_u32 s17, s70, 786432
    buffer_load_dwordx4 v12, s[20:23], s17 offen lds
    s_add_u32 m0, m0, 1024
    s_add_u32 s17, s70, 819200
    buffer_load_dwordx4 v13, s[20:23], s17 offen lds
    s_add_u32 m0, m0, 1024
    s_add_u32 s17, s70, 851968
    buffer_load_dwordx4 v14, s[20:23], s17 offen lds
    s_add_u32 m0, m0, 1024
    s_add_u32 s17, s70, 884736
    buffer_load_dwordx4 v15, s[20:23], s17 offen lds
    ds_read_b64_tr_b16 v[168:169], v18 offset:16384
    ds_read_b64_tr_b16 v[170:171], v18 offset:16896
    ds_read_b64_tr_b16 v[172:173], v19 offset:16384
    ds_read_b64_tr_b16 v[174:175], v19 offset:16896
    ds_read_b64_tr_b16 v[176:177], v20 offset:16384
    ds_read_b64_tr_b16 v[178:179], v20 offset:16896
    ds_read_b64_tr_b16 v[180:181], v21 offset:16384
    ds_read_b64_tr_b16 v[182:183], v21 offset:16896
    s_waitcnt lgkmcnt(0)
    s_waitcnt vmcnt(20)
    s_barrier
    s_add_u32 m0, s72, 16384
    s_add_u32 s17, s71, 0
    buffer_load_dwordx4 v16, s[76:79], s17 offen lds
    s_add_u32 m0, m0, 1024
    s_add_u32 s17, s71, 18432
    buffer_load_dwordx4 v16, s[76:79], s17 offen lds
    s_add_u32 m0, m0, 1024
    s_add_u32 s17, s71, 36864
    buffer_load_dwordx4 v16, s[76:79], s17 offen lds
    s_add_u32 m0, m0, 1024
    s_add_u32 s17, s71, 55296
    buffer_load_dwordx4 v16, s[76:79], s17 offen lds
    ds_read_b64_tr_b16 a[56:57], v18 offset:20480
    ds_read_b64_tr_b16 a[58:59], v18 offset:20992
    ds_read_b64_tr_b16 a[60:61], v19 offset:20480
    ds_read_b64_tr_b16 a[62:63], v19 offset:20992
    ds_read_b64_tr_b16 a[64:65], v20 offset:20480
    ds_read_b64_tr_b16 a[66:67], v20 offset:20992
    ds_read_b64_tr_b16 a[68:69], v21 offset:20480
    ds_read_b64_tr_b16 a[70:71], v21 offset:20992
    s_waitcnt lgkmcnt(0)
    s_waitcnt vmcnt(20)
    s_barrier
    s_add_u32 m0, s72, 20480
    s_add_u32 s17, s71, 73728
    buffer_load_dwordx4 v16, s[76:79], s17 offen lds
    s_add_u32 m0, m0, 1024
    s_add_u32 s17, s71, 92160
    buffer_load_dwordx4 v16, s[76:79], s17 offen lds
    s_add_u32 m0, m0, 1024
    s_add_u32 s17, s71, 110592
    buffer_load_dwordx4 v16, s[76:79], s17 offen lds
    s_add_u32 m0, m0, 1024
    s_add_u32 s17, s71, 129024
    buffer_load_dwordx4 v16, s[76:79], s17 offen lds
    ds_read_b64_tr_b16 a[168:169], v18 offset:24576
    ds_read_b64_tr_b16 a[170:171], v18 offset:25088
    ds_read_b64_tr_b16 a[172:173], v19 offset:24576
    ds_read_b64_tr_b16 a[174:175], v19 offset:25088
    ds_read_b64_tr_b16 a[176:177], v20 offset:24576
    ds_read_b64_tr_b16 a[178:179], v20 offset:25088
    ds_read_b64_tr_b16 a[180:181], v21 offset:24576
    ds_read_b64_tr_b16 a[182:183], v21 offset:25088
    s_waitcnt lgkmcnt(0)
    s_waitcnt vmcnt(20)
    s_barrier
    s_add_u32 m0, s72, 24576
    s_add_u32 s17, s71, 64
    buffer_load_dwordx4 v16, s[76:79], s17 offen lds
    s_add_u32 m0, m0, 1024
    s_add_u32 s17, s71, 18496
    buffer_load_dwordx4 v16, s[76:79], s17 offen lds
    s_add_u32 m0, m0, 1024
    s_add_u32 s17, s71, 36928
    buffer_load_dwordx4 v16, s[76:79], s17 offen lds
    s_add_u32 m0, m0, 1024
    s_add_u32 s17, s71, 55360
    buffer_load_dwordx4 v16, s[76:79], s17 offen lds
    s_add_u32 m0, s72, 28672
    s_add_u32 s17, s71, 73792
    buffer_load_dwordx4 v16, s[76:79], s17 offen lds
    s_add_u32 m0, m0, 1024
    s_add_u32 s17, s71, 92224
    buffer_load_dwordx4 v16, s[76:79], s17 offen lds
    s_add_u32 m0, m0, 1024
    s_add_u32 s17, s71, 110656
    buffer_load_dwordx4 v16, s[76:79], s17 offen lds
    s_add_u32 m0, m0, 1024
    s_add_u32 s17, s71, 129088
    buffer_load_dwordx4 v16, s[76:79], s17 offen lds
    ds_read_b64_tr_b16 v[24:25], v18 offset:0
    ds_read_b64_tr_b16 v[26:27], v18 offset:512
    ds_read_b64_tr_b16 v[28:29], v19 offset:0
    ds_read_b64_tr_b16 v[30:31], v19 offset:512
    ds_read_b64_tr_b16 v[32:33], v20 offset:0
    ds_read_b64_tr_b16 v[34:35], v20 offset:512
    ds_read_b64_tr_b16 v[36:37], v21 offset:0
    ds_read_b64_tr_b16 v[38:39], v21 offset:512
    s_waitcnt lgkmcnt(0)
    s_barrier
    ds_write_b128 v8, v[24:27] offset:0
    ds_write_b128 v8, v[28:31] offset:1024
    ds_write_b128 v8, v[32:35] offset:2048
    ds_write_b128 v8, v[36:39] offset:3072
    s_waitcnt lgkmcnt(0)
    s_waitcnt vmcnt(24)
    s_barrier
    ds_read_b64_tr_b16 v[24:25], v18 offset:4096
    ds_read_b64_tr_b16 v[26:27], v18 offset:4608
    ds_read_b64_tr_b16 v[28:29], v19 offset:4096
    ds_read_b64_tr_b16 v[30:31], v19 offset:4608
    ds_read_b64_tr_b16 v[32:33], v20 offset:4096
    ds_read_b64_tr_b16 v[34:35], v20 offset:4608
    ds_read_b64_tr_b16 v[36:37], v21 offset:4096
    ds_read_b64_tr_b16 v[38:39], v21 offset:4608
    s_waitcnt lgkmcnt(0)
    s_barrier
    ds_write_b128 v8, v[24:27] offset:4096
    ds_write_b128 v8, v[28:31] offset:5120
    ds_write_b128 v8, v[32:35] offset:6144
    ds_write_b128 v8, v[36:39] offset:7168
    s_waitcnt lgkmcnt(0)
    s_waitcnt vmcnt(20)
    s_barrier
    ds_read_b64_tr_b16 v[24:25], v18 offset:8192
    ds_read_b64_tr_b16 v[26:27], v18 offset:8704
    ds_read_b64_tr_b16 v[28:29], v19 offset:8192
    ds_read_b64_tr_b16 v[30:31], v19 offset:8704
    ds_read_b64_tr_b16 v[32:33], v20 offset:8192
    ds_read_b64_tr_b16 v[34:35], v20 offset:8704
    ds_read_b64_tr_b16 v[36:37], v21 offset:8192
    ds_read_b64_tr_b16 v[38:39], v21 offset:8704
    s_waitcnt lgkmcnt(0)
    s_barrier
    ds_write_b128 v8, v[24:27] offset:8192
    ds_write_b128 v8, v[28:31] offset:9216
    ds_write_b128 v8, v[32:35] offset:10240
    ds_write_b128 v8, v[36:39] offset:11264
    s_waitcnt lgkmcnt(0)
    s_waitcnt vmcnt(16)
    s_barrier
    ds_read_b64_tr_b16 v[24:25], v18 offset:12288
    ds_read_b64_tr_b16 v[26:27], v18 offset:12800
    ds_read_b64_tr_b16 v[28:29], v19 offset:12288
    ds_read_b64_tr_b16 v[30:31], v19 offset:12800
    ds_read_b64_tr_b16 v[32:33], v20 offset:12288
    ds_read_b64_tr_b16 v[34:35], v20 offset:12800
    ds_read_b64_tr_b16 v[36:37], v21 offset:12288
    ds_read_b64_tr_b16 v[38:39], v21 offset:12800
    s_waitcnt lgkmcnt(0)
    s_barrier
    ds_write_b128 v8, v[24:27] offset:12288
    ds_write_b128 v8, v[28:31] offset:13312
    ds_write_b128 v8, v[32:35] offset:14336
    ds_write_b128 v8, v[36:39] offset:15360
    s_waitcnt lgkmcnt(0)
    s_barrier
    s_waitcnt vmcnt(12)
    ds_read_b64_tr_b16 a[184:185], v22 offset:16384
    ds_read_b64_tr_b16 a[186:187], v22 offset:16448
    ds_read_b64_tr_b16 a[188:189], v22 offset:18432
    ds_read_b64_tr_b16 a[190:191], v22 offset:18496
    ds_read_b64_tr_b16 a[200:201], v22 offset:16416
    ds_read_b64_tr_b16 a[202:203], v22 offset:16480
    ds_read_b64_tr_b16 a[204:205], v22 offset:18464
    ds_read_b64_tr_b16 a[206:207], v22 offset:18528
    s_waitcnt lgkmcnt(0)
    s_add_u32 m0, s72, 16384
    s_add_u32 s17, s71, 128
    buffer_load_dwordx4 v16, s[76:79], s17 offen lds
    s_add_u32 m0, m0, 1024
    s_add_u32 s17, s71, 18560
    buffer_load_dwordx4 v16, s[76:79], s17 offen lds
    s_add_u32 m0, m0, 1024
    s_add_u32 s17, s71, 36992
    buffer_load_dwordx4 v16, s[76:79], s17 offen lds
    s_add_u32 m0, m0, 1024
    s_add_u32 s17, s71, 55424
    buffer_load_dwordx4 v16, s[76:79], s17 offen lds
    s_waitcnt vmcnt(12)
    ds_read_b64_tr_b16 a[192:193], v22 offset:20480
    ds_read_b64_tr_b16 a[194:195], v22 offset:20544
    ds_read_b64_tr_b16 a[196:197], v22 offset:22528
    ds_read_b64_tr_b16 a[198:199], v22 offset:22592
    ds_read_b64_tr_b16 a[208:209], v22 offset:20512
    ds_read_b64_tr_b16 a[210:211], v22 offset:20576
    ds_read_b64_tr_b16 a[212:213], v22 offset:22560
    ds_read_b64_tr_b16 a[214:215], v22 offset:22624
    s_waitcnt lgkmcnt(0)
    s_add_u32 m0, s72, 20480
    s_add_u32 s17, s71, 73856
    buffer_load_dwordx4 v16, s[76:79], s17 offen lds
    s_add_u32 m0, m0, 1024
    s_add_u32 s17, s71, 92288
    buffer_load_dwordx4 v16, s[76:79], s17 offen lds
    s_add_u32 m0, m0, 1024
    s_add_u32 s17, s71, 110720
    buffer_load_dwordx4 v16, s[76:79], s17 offen lds
    s_add_u32 m0, m0, 1024
    s_add_u32 s17, s71, 129152
    buffer_load_dwordx4 v16, s[76:79], s17 offen lds
    s_waitcnt vmcnt(12)
    ds_read_b64_tr_b16 a[216:217], v22 offset:24576
    ds_read_b64_tr_b16 a[218:219], v22 offset:24640
    ds_read_b64_tr_b16 a[220:221], v22 offset:26624
    ds_read_b64_tr_b16 a[222:223], v22 offset:26688
    ds_read_b64_tr_b16 a[232:233], v22 offset:24608
    ds_read_b64_tr_b16 a[234:235], v22 offset:24672
    ds_read_b64_tr_b16 a[236:237], v22 offset:26656
    ds_read_b64_tr_b16 a[238:239], v22 offset:26720
    s_waitcnt lgkmcnt(0)
    s_add_u32 m0, s72, 24576
    s_add_u32 s17, s71, 192
    buffer_load_dwordx4 v16, s[76:79], s17 offen lds
    s_add_u32 m0, m0, 1024
    s_add_u32 s17, s71, 18624
    buffer_load_dwordx4 v16, s[76:79], s17 offen lds
    s_add_u32 m0, m0, 1024
    s_add_u32 s17, s71, 37056
    buffer_load_dwordx4 v16, s[76:79], s17 offen lds
    s_add_u32 m0, m0, 1024
    s_add_u32 s17, s71, 55488
    buffer_load_dwordx4 v16, s[76:79], s17 offen lds
    s_waitcnt vmcnt(12)
    ds_read_b64_tr_b16 a[224:225], v22 offset:28672
    ds_read_b64_tr_b16 a[226:227], v22 offset:28736
    ds_read_b64_tr_b16 a[228:229], v22 offset:30720
    ds_read_b64_tr_b16 a[230:231], v22 offset:30784
    ds_read_b64_tr_b16 a[240:241], v22 offset:28704
    ds_read_b64_tr_b16 a[242:243], v22 offset:28768
    ds_read_b64_tr_b16 a[244:245], v22 offset:30752
    ds_read_b64_tr_b16 a[246:247], v22 offset:30816
    s_waitcnt lgkmcnt(0)
    s_add_u32 m0, s72, 28672
    s_add_u32 s17, s71, 73920
    buffer_load_dwordx4 v16, s[76:79], s17 offen lds
    s_add_u32 m0, m0, 1024
    s_add_u32 s17, s71, 92352
    buffer_load_dwordx4 v16, s[76:79], s17 offen lds
    s_add_u32 m0, m0, 1024
    s_add_u32 s17, s71, 110784
    buffer_load_dwordx4 v16, s[76:79], s17 offen lds
    s_add_u32 m0, m0, 1024
    s_add_u32 s17, s71, 129216
    buffer_load_dwordx4 v16, s[76:79], s17 offen lds
    s_waitcnt vmcnt(63)
    ds_read_b64_tr_b16 a[248:249], v23 offset:32768
    ds_read_b64_tr_b16 a[250:251], v23 offset:32800
    ds_read_b64_tr_b16 a[252:253], v23 offset:33792
    ds_read_b64_tr_b16 a[254:255], v23 offset:33824
    s_waitcnt lgkmcnt(0)
    s_add_u32 m0, s72, 32768
    s_add_u32 s17, s71, 73984
    buffer_load_dwordx4 v17, s[76:79], s17 offen lds
    s_add_u32 m0, m0, 1024
    s_add_u32 s17, s71, 110848
    buffer_load_dwordx4 v17, s[76:79], s17 offen lds
    s_waitcnt vmcnt(14)
    ds_read_b64_tr_b16 v[24:25], v22 offset:16384
    ds_read_b64_tr_b16 v[26:27], v22 offset:16448
    ds_read_b64_tr_b16 v[28:29], v22 offset:18432
    ds_read_b64_tr_b16 v[30:31], v22 offset:18496
    ds_read_b64_tr_b16 v[32:33], v22 offset:16416
    ds_read_b64_tr_b16 v[34:35], v22 offset:16480
    ds_read_b64_tr_b16 v[36:37], v22 offset:18464
    ds_read_b64_tr_b16 v[38:39], v22 offset:18528
    s_waitcnt lgkmcnt(0)
    ds_write_b128 v8, v[24:27] offset:16384
    ds_write_b128 v8, v[28:31] offset:17408
    ds_write_b128 v8, v[32:35] offset:18432
    ds_write_b128 v8, v[36:39] offset:19456
    s_waitcnt lgkmcnt(0)
    s_waitcnt vmcnt(10)
    ds_read_b64_tr_b16 v[24:25], v22 offset:20480
    ds_read_b64_tr_b16 v[26:27], v22 offset:20544
    ds_read_b64_tr_b16 v[28:29], v22 offset:22528
    ds_read_b64_tr_b16 v[30:31], v22 offset:22592
    ds_read_b64_tr_b16 v[32:33], v22 offset:20512
    ds_read_b64_tr_b16 v[34:35], v22 offset:20576
    ds_read_b64_tr_b16 v[36:37], v22 offset:22560
    ds_read_b64_tr_b16 v[38:39], v22 offset:22624
    s_waitcnt lgkmcnt(0)
    ds_write_b128 v8, v[24:27] offset:20480
    ds_write_b128 v8, v[28:31] offset:21504
    ds_write_b128 v8, v[32:35] offset:22528
    ds_write_b128 v8, v[36:39] offset:23552
    s_waitcnt lgkmcnt(0)
    s_waitcnt vmcnt(6)
    ds_read_b64_tr_b16 v[24:25], v22 offset:24576
    ds_read_b64_tr_b16 v[26:27], v22 offset:24640
    ds_read_b64_tr_b16 v[28:29], v22 offset:26624
    ds_read_b64_tr_b16 v[30:31], v22 offset:26688
    ds_read_b64_tr_b16 v[32:33], v22 offset:24608
    ds_read_b64_tr_b16 v[34:35], v22 offset:24672
    ds_read_b64_tr_b16 v[36:37], v22 offset:26656
    ds_read_b64_tr_b16 v[38:39], v22 offset:26720
    s_waitcnt lgkmcnt(0)
    ds_write_b128 v8, v[24:27] offset:24576
    ds_write_b128 v8, v[28:31] offset:25600
    ds_write_b128 v8, v[32:35] offset:26624
    ds_write_b128 v8, v[36:39] offset:27648
    s_waitcnt lgkmcnt(0)
    s_waitcnt vmcnt(2)
    ds_read_b64_tr_b16 v[24:25], v22 offset:28672
    ds_read_b64_tr_b16 v[26:27], v22 offset:28736
    ds_read_b64_tr_b16 v[28:29], v22 offset:30720
    ds_read_b64_tr_b16 v[30:31], v22 offset:30784
    ds_read_b64_tr_b16 v[32:33], v22 offset:28704
    ds_read_b64_tr_b16 v[34:35], v22 offset:28768
    ds_read_b64_tr_b16 v[36:37], v22 offset:30752
    ds_read_b64_tr_b16 v[38:39], v22 offset:30816
    s_waitcnt lgkmcnt(0)
    ds_write_b128 v8, v[24:27] offset:28672
    ds_write_b128 v8, v[28:31] offset:29696
    ds_write_b128 v8, v[32:35] offset:30720
    ds_write_b128 v8, v[36:39] offset:31744
    s_waitcnt lgkmcnt(0)
    s_waitcnt vmcnt(0)
    ds_read_b64_tr_b16 v[24:25], v23 offset:32768
    ds_read_b64_tr_b16 v[26:27], v23 offset:32800
    ds_read_b64_tr_b16 v[28:29], v23 offset:33792
    ds_read_b64_tr_b16 v[30:31], v23 offset:33824
    s_waitcnt lgkmcnt(0)
    ds_write_b128 v8, v[24:27] offset:32768
    ds_write_b128 v8, v[28:31] offset:33792
    s_waitcnt lgkmcnt(0)
    v_bfe_u32 v9, v0, 4, 4
    v_mov_b32 v10, 0x3f80
    v_mov_b32 v16, 0x3f800000
    v_cmp_eq_u32 vcc, 0, v9
    v_cmp_eq_u32 s[48:49], 1, v9
    s_nop 0
    v_cndmask_b32 v12, 0, v10, vcc
    v_cndmask_b32 v12, v12, v16, s[48:49]
    v_cmp_eq_u32 vcc, 2, v9
    v_cmp_eq_u32 s[48:49], 3, v9
    s_nop 0
    v_cndmask_b32 v13, 0, v10, vcc
    v_cndmask_b32 v13, v13, v16, s[48:49]
    v_cmp_eq_u32 vcc, 4, v9
    v_cmp_eq_u32 s[48:49], 5, v9
    s_nop 0
    v_cndmask_b32 v14, 0, v10, vcc
    v_cndmask_b32 v14, v14, v16, s[48:49]
    v_cmp_eq_u32 vcc, 6, v9
    v_cmp_eq_u32 s[48:49], 7, v9
    s_nop 0
    v_cndmask_b32 v15, 0, v10, vcc
    v_cndmask_b32 v15, v15, v16, s[48:49]
    v_add_u32 v9, 162560, v0
    ds_write_b128 v9, v[12:15]
    s_waitcnt lgkmcnt(0)
    s_mov_b64 exec, 0xff
    v_lshrrev_b32 v14, 2, v0
    v_lshlrev_b32 v12, 5, v14
    v_and_b32 v12, 128, v12
    v_lshrrev_b32 v13, 1, v14
    v_and_or_b32 v12, v13, 12, v12
    s_mov_b32 s16, 0
L_pure:
    global_load_dword v13, v12, s[12:13] sc1
    s_add_u32 s16, s16, 1
    s_cmp_gt_u32 s16, 100000
    s_cbranch_scc1 Lr_abort
    s_mov_b32 s6, 0
    s_waitcnt vmcnt(0)
    v_readlane_b32 s7, v13, 0
    s_nop 0
    s_add_u32 s6, s6, s7
    v_readlane_b32 s7, v13, 1
    s_nop 0
    s_add_u32 s6, s6, s7
    v_readlane_b32 s7, v13, 2
    s_nop 0
    s_add_u32 s6, s6, s7
    v_readlane_b32 s7, v13, 3
    s_nop 0
    s_add_u32 s6, s6, s7
    v_readlane_b32 s7, v13, 4
    s_nop 0
    s_add_u32 s6, s6, s7
    v_readlane_b32 s7, v13, 5
    s_nop 0
    s_add_u32 s6, s6, s7
    v_readlane_b32 s7, v13, 6
    s_nop 0
    s_add_u32 s6, s6, s7
    v_readlane_b32 s7, v13, 7
    s_nop 0
    s_add_u32 s6, s6, s7
    v_readlane_b32 s7, v13, s32
    s_nop 0
    s_cmp_ge_u32 s7, 32
    s_cselect_b32 s51, 1, 0
    s_cselect_b32 s6, 256, s6
    s_cmp_lt_u32 s6, 256
    s_cbranch_scc1 L_pure
    s_mov_b64 exec, -1
    s_lshl_b32 s6, s32, 2
    s_add_u32 s6, s6, 192
    s_cmp_lg_u32 s14, 0
    s_cbranch_scc1 L_team_d
    v_mov_b32 v12, s6
    s_mov_b32 s16, 0
L_team:
    global_load_dword v13, v12, s[12:13] sc1
    s_add_u32 s16, s16, 1
    s_cmp_gt_u32 s16, 100000
    s_cbranch_scc1 Lr_abort
    s_waitcnt vmcnt(0)
    v_cmp_gt_u32 vcc, 32, v13
    s_nop 0
    s_cbranch_vccz L_team_d
    s_sleep 8
    s_branch L_team
L_team_d:
    s_barrier
    s_cmp_lg_u32 s14, 0
    s_cbranch_scc1 L_rpool_d
    v_mov_b32 v12, 160
    s_mov_b32 s16, 0
L_rpool:
    global_load_dword v13, v12, s[12:13] sc1
    s_add_u32 s16, s16, 1
    s_cmp_gt_u32 s16, 100000
    s_cbranch_scc1 Lr_abort
    s_waitcnt vmcnt(0)
    v_cmp_gt_u32 vcc, 192, v13
    s_nop 0
    s_cbranch_vccz L_rpool_d
    s_sleep 8
    s_branch L_rpool
L_rpool_d:
    s_barrier
    s_barrier
    s_cmp_eq_u32 s51, 0
    s_cbranch_scc1 L_slow
    s_cmp_lg_u32 s14, 0
    s_cbranch_scc1 L_w1_1
    s_mov_b32 s16, 0
    s_add_u32 s17, s66, 128
    v_lshrrev_b32 v10, 2, v0
    v_and_b32 v9, 16, v10
    v_lshlrev_b32 v9, 3, v9
    v_and_or_b32 v10, v10, 12, v9
Lr0f_fw_22:
    buffer_load_dword v9, v10, s[8:11], s17 offen sc1
    s_add_u32 s16, s16, 1
    s_cmp_gt_u32 s16, 100000
    s_cbranch_scc1 Lr_abort
    s_waitcnt vmcnt(0)
    v_cmp_eq_u32 vcc, 0, v9
    s_nop 0
    s_cbranch_vccnz Lr0f_fw_22
    s_mov_b32 m0, 15104
    s_nop 0
    buffer_load_dwordx4 v0, s[8:11], s41 offen offset:0 lds
    buffer_load_dwordx4 v0, s[8:11], s41 offen offset:1024 lds
    s_add_u32 s41, s41, 262144
    s_add_u32 s68, s68, 4278452224
    s_waitcnt vmcnt(0)
    ds_read_b128 v[56:59], v8 offset:0
    ds_read_b128 v[60:63], v8 offset:1024
    ds_read_b128 v[64:67], v8 offset:2048
    ds_read_b128 v[68:71], v8 offset:3072
    v_mov_b64 v[12:13], 0
    v_mov_b64 v[14:15], 0
    v_mov_b64 v[16:17], 0
    v_mov_b64 v[18:19], 0
    v_mov_b64 v[20:21], 0
    v_mov_b64 v[22:23], 0
    v_mov_b64 v[24:25], 0
    v_mov_b64 v[26:27], 0
    v_mov_b64 v[28:29], 0
    v_mov_b64 v[30:31], 0
    v_mov_b64 v[32:33], 0
    v_mov_b64 v[34:35], 0
    buffer_load_dwordx4 v[36:39], v0, s[8:11], s34 offen sc1
    s_waitcnt vmcnt(0) lgkmcnt(0)
Lr0f_step:
    s_waitcnt vmcnt(2)
    v_max3_u32 v10, v36, v37, v38
    v_max_u32 v10, v10, v39
    v_cmp_eq_u32 vcc, -1, v10
    s_nop 0
    s_cbranch_vccz Lr0f_aok
    s_waitcnt vmcnt(1)
    v_max3_u32 v10, v36, v37, v38
    v_max_u32 v10, v10, v39
    v_cmp_eq_u32 vcc, -1, v10
    s_nop 0
    s_cbranch_vccz Lr0f_aok
    s_mov_b32 s16, 0
Lr0f_alp:
    buffer_load_dwordx4 v[36:39], v0, s[8:11], s34 offen sc1
    s_add_u32 s16, s16, 1
    s_cmp_gt_u32 s16, 100000
    s_cbranch_scc1 Lr_abort
    s_waitcnt vmcnt(1)
    v_max3_u32 v10, v36, v37, v38
    v_max_u32 v10, v10, v39
    v_cmp_eq_u32 vcc, -1, v10
    s_nop 0
    s_cbranch_vccnz Lr0f_alp
Lr0f_aok:
    ds_write_b128 v0, v[36:39] offset:6912
    v_smfmac_f32_16x16x64_bf16 v[12:15], v[36:39], v[72:79], v1
    v_smfmac_f32_16x16x64_bf16 v[16:19], v[36:39], v[80:87], v1
    v_smfmac_f32_16x16x64_bf16 v[20:23], v[36:39], v[184:191], v1
    s_waitcnt lgkmcnt(0)
    s_barrier
    ds_read_b128 v[48:51], v0 offset:7936
    ds_read_b128 v[52:55], v0 offset:8960
    v_smfmac_f32_16x16x64_bf16 v[28:31], v[36:39], v[56:63], v1
    ds_read_b128 v[56:59], v8 offset:4096
    ds_read_b128 v[60:63], v8 offset:5120
    s_add_u32 s17, s34, 4096
    buffer_load_dwordx4 v[40:43], v0, s[8:11], s17 offen sc1
    v_smfmac_f32_16x16x64_bf16 v[24:27], v[36:39], v[192:199], v1
    v_smfmac_f32_16x16x64_bf16 v[32:35], v[36:39], v[64:71], v1
    ds_read_b128 v[64:67], v8 offset:6144
    ds_read_b128 v[68:71], v8 offset:7168
    s_waitcnt vmcnt(1)
    ds_read_b128 v[36:39], v0 offset:9984
    s_waitcnt lgkmcnt(6)
    v_smfmac_f32_16x16x64_bf16 v[28:31], v[48:51], a[72:79], v1
    v_smfmac_f32_16x16x64_bf16 v[12:15], v[48:51], v[88:95], v1
    buffer_load_dwordx4 v[44:47], v0, s[8:11], s35 offen sc1
    v_smfmac_f32_16x16x64_bf16 v[16:19], v[48:51], v[96:103], v1
    v_smfmac_f32_16x16x64_bf16 v[32:35], v[48:51], a[80:87], v1
    v_smfmac_f32_16x16x64_bf16 v[20:23], v[48:51], v[200:207], v1
    v_smfmac_f32_16x16x64_bf16 v[24:27], v[48:51], v[208:215], v1
    s_waitcnt lgkmcnt(3)
    v_smfmac_f32_16x16x64_bf16 v[28:31], v[52:55], v[56:63], v1
    ds_read_b128 v[56:59], v8 offset:8192
    ds_read_b128 v[60:63], v8 offset:9216
    v_smfmac_f32_16x16x64_bf16 v[12:15], v[52:55], v[104:111], v1
    v_smfmac_f32_16x16x64_bf16 v[16:19], v[52:55], v[112:119], v1
    s_waitcnt lgkmcnt(3)
    v_smfmac_f32_16x16x64_bf16 v[32:35], v[52:55], v[64:71], v1
    ds_read_b128 v[64:67], v8 offset:10240
    ds_read_b128 v[68:71], v8 offset:11264
    v_smfmac_f32_16x16x64_bf16 v[20:23], v[52:55], v[216:223], v1
    v_smfmac_f32_16x16x64_bf16 v[24:27], v[52:55], v[224:231], v1
    s_waitcnt lgkmcnt(4)
    v_smfmac_f32_16x16x64_bf16 v[28:31], v[36:39], a[88:95], v1
    v_smfmac_f32_16x16x64_bf16 v[12:15], v[36:39], v[120:127], v1
    v_smfmac_f32_16x16x64_bf16 v[16:19], v[36:39], v[128:135], v1
    v_smfmac_f32_16x16x64_bf16 v[32:35], v[36:39], a[96:103], v1
    v_smfmac_f32_16x16x64_bf16 v[20:23], v[36:39], v[232:239], v1
    v_smfmac_f32_16x16x64_bf16 v[24:27], v[36:39], v[240:247], v1
    s_waitcnt vmcnt(1)
    v_max3_u32 v10, v40, v41, v42
    v_max_u32 v10, v10, v43
    v_cmp_eq_u32 vcc, -1, v10
    s_nop 0
    s_cbranch_vccnz Lr0f_pb_re
Lr0f_pb_ok:
    ds_write_b128 v0, v[40:43] offset:11008
    s_waitcnt lgkmcnt(3)
    v_smfmac_f32_16x16x64_bf16 v[12:15], v[40:43], v[56:63], v1
    ds_read_b128 v[56:59], v8 offset:12288
    ds_read_b128 v[60:63], v8 offset:13312
    v_smfmac_f32_16x16x64_bf16 v[20:23], v[40:43], v[248:255], v1
    s_waitcnt lgkmcnt(3)
    v_smfmac_f32_16x16x64_bf16 v[16:19], v[40:43], v[64:71], v1
    ds_read_b128 v[64:67], v8 offset:14336
    ds_read_b128 v[68:71], v8 offset:15360
    v_smfmac_f32_16x16x64_bf16 v[24:27], v[40:43], a[0:7], v1
    s_waitcnt lgkmcnt(4)
    s_barrier
    ds_read_b128 v[48:51], v0 offset:13056
    ds_read_b128 v[52:55], v0 offset:12032
    ds_read_b128 v[36:39], v0 offset:14080
    v_smfmac_f32_16x16x64_bf16 v[28:31], v[40:43], a[104:111], v1
    v_smfmac_f32_16x16x64_bf16 v[32:35], v[40:43], a[112:119], v1
    s_waitcnt lgkmcnt(2)
    v_smfmac_f32_16x16x64_bf16 v[12:15], v[48:51], v[56:63], v1
    v_smfmac_f32_16x16x64_bf16 v[16:19], v[48:51], v[64:71], v1
    s_waitcnt lgkmcnt(1)
    v_smfmac_f32_16x16x64_bf16 v[12:15], v[52:55], v[136:143], v1
    v_smfmac_f32_16x16x64_bf16 v[16:19], v[52:55], v[144:151], v1
    s_waitcnt lgkmcnt(0)
    v_smfmac_f32_16x16x64_bf16 v[12:15], v[36:39], v[152:159], v1
    v_smfmac_f32_16x16x64_bf16 v[16:19], v[36:39], v[160:167], v1
    s_waitcnt vmcnt(0)
    v_max3_u32 v10, v44, v45, v46
    v_max_u32 v10, v10, v47
    v_cmp_eq_u32 vcc, -1, v10
    s_nop 0
    s_cbranch_vccnz Lr0f_pc_re
Lr0f_pc_ok:
    v_smfmac_f32_16x16x64_bf16 v[12:15], v[44:47], v[168:175], v1
    v_smfmac_f32_16x16x64_bf16 v[16:19], v[44:47], v[176:183], v1
    v_smfmac_f32_16x16x64_bf16 v[20:23], v[48:51], a[24:31], v1
    buffer_load_dwordx4 v[64:67], v0, s[8:11], s42 offen
    v_smfmac_f32_16x16x64_bf16 v[24:27], v[48:51], a[32:39], v1
    v_smfmac_f32_16x16x64_bf16 v[20:23], v[52:55], a[8:15], v1
    v_add_f32 v12, v12, v14
    v_smfmac_f32_16x16x64_bf16 v[24:27], v[52:55], a[16:23], v1
    v_add_f32 v16, v16, v18
    v_smfmac_f32_16x16x64_bf16 v[20:23], v[36:39], a[40:47], v1
    v_add_f32 v13, v13, v15
    buffer_load_dwordx4 v[68:71], v0, s[8:11], s42 offen offset:1024
    v_smfmac_f32_16x16x64_bf16 v[24:27], v[36:39], a[48:55], v1
    v_add_f32 v17, v17, v19
    v_smfmac_f32_16x16x64_bf16 v[20:23], v[44:47], a[56:63], v1
    v_cvt_pk_bf16_f32 v14, v12, v16
    ds_read_b128 v[56:59], v0 offset:15104
    v_smfmac_f32_16x16x64_bf16 v[24:27], v[44:47], a[64:71], v1
    v_cvt_pk_bf16_f32 v15, v13, v17
    ds_read_b128 v[60:63], v0 offset:16128
    ds_write_b32 v2, v14 offset:576
    ds_write_b32 v2, v15 offset:864
    v_smfmac_f32_16x16x64_bf16 v[28:31], v[48:51], a[136:143], v1
    v_smfmac_f32_16x16x64_bf16 v[32:35], v[48:51], a[144:151], v1
    v_add_f32 v20, v20, v22
    v_add_f32 v24, v24, v26
    v_add_f32 v21, v21, v23
    v_add_f32 v25, v25, v27
    v_cvt_pk_bf16_f32 v22, v20, v24
    v_cvt_pk_bf16_f32 v23, v21, v25
    ds_write_b32 v2, v22 offset:0
    ds_write_b32 v2, v23 offset:288
    v_smfmac_f32_16x16x64_bf16 v[28:31], v[52:55], a[120:127], v1
    v_smfmac_f32_16x16x64_bf16 v[32:35], v[52:55], a[128:135], v1
    s_waitcnt lgkmcnt(0)
    s_barrier
    ds_read_b128 v[40:43], v3 offset:0
    ds_read_b128 v[48:51], v3 offset:64
    ds_read_b128 v[20:23], v3 offset:128
    ds_read_b128 v[52:55], v3 offset:192
    v_smfmac_f32_16x16x64_bf16 v[28:31], v[36:39], a[152:159], v1
    v_smfmac_f32_16x16x64_bf16 v[32:35], v[36:39], a[160:167], v1
    ds_read_b128 v[36:39], v0 offset:17152
    v_lshlrev_b32 v9, 3, v0
    buffer_load_dword v11, v9, s[8:11], s68 offen
    v_smfmac_f32_16x16x64_bf16 v[28:31], v[44:47], a[168:175], v1
    v_smfmac_f32_16x16x64_bf16 v[32:35], v[44:47], a[176:183], v1
    ds_read_b128 v[44:47], v0 offset:18176
    s_waitcnt lgkmcnt(5)
    v_mfma_f32_16x16x32_bf16 v[12:15], v[56:59], v[40:43], 0
    v_mfma_f32_16x16x32_bf16 v[16:19], v[60:63], v[40:43], 0
    v_mfma_f32_16x16x32_bf16 v[24:27], v[40:43], v[40:43], 0
    ds_read_b128 v[56:59], v0 offset:19200
    ds_read_b128 v[60:63], v0 offset:20224
    s_waitcnt lgkmcnt(3)
    v_mfma_f32_16x16x32_bf16 v[12:15], v[36:39], v[48:51], v[12:15]
    v_lshrrev_b32 v10, 1, v0
    v_lshrrev_b32 v9, 9, v0
    s_waitcnt lgkmcnt(2)
    v_mfma_f32_16x16x32_bf16 v[16:19], v[44:47], v[48:51], v[16:19]
    v_lshl_add_u32 v9, v9, 5, v10
    v_add_f32 v28, v28, v30
    v_mfma_f32_16x16x32_bf16 v[24:27], v[48:51], v[48:51], v[24:27]
    v_add_f32 v32, v32, v34
    v_add_f32 v29, v29, v31
    ds_read_b128 v[36:39], v0 offset:21248
    ds_read_b128 v[44:47], v0 offset:22272
    s_waitcnt lgkmcnt(3)
    v_mfma_f32_16x16x32_bf16 v[12:15], v[56:59], v[20:23], v[12:15]
    v_add_f32 v33, v33, v35
    v_cvt_pk_bf16_f32 v30, v28, v29
    s_waitcnt lgkmcnt(2)
    v_mfma_f32_16x16x32_bf16 v[16:19], v[60:63], v[20:23], v[16:19]
    v_cvt_pk_bf16_f32 v31, v32, v33
    ds_read_b64 v[34:35], v9 offset:0
    v_mfma_f32_16x16x32_bf16 v[24:27], v[20:23], v[20:23], v[24:27]
    s_add_u32 s17, s43, 2048
    buffer_store_dwordx2 v[30:31], v10, s[8:11], s17 offen sc1
    s_waitcnt lgkmcnt(2)
    v_mfma_f32_16x16x32_bf16 v[12:15], v[36:39], v[52:55], v[12:15]
    s_waitcnt lgkmcnt(1)
    v_mfma_f32_16x16x32_bf16 v[16:19], v[44:47], v[52:55], v[16:19]
    v_mfma_f32_16x16x32_bf16 v[24:27], v[52:55], v[52:55], v[24:27]
    s_add_u32 s17, s43, 0
    s_waitcnt lgkmcnt(0)
    buffer_store_dwordx2 v[34:35], v10, s[8:11], s17 offen sc1
    ds_read_b128 v[56:59], v8 offset:16384
    ds_read_b128 v[60:63], v8 offset:17408
    v_mov_b64 v[20:21], s[52:53]
    v_mov_b64 v[22:23], s[52:53]
    v_mov_b32 v41, 0
    v_mov_b32 v42, 0
    v_max3_f32 v9, v12, v13, v14
    v_max3_f32 v9, v9, v15, v16
    v_max3_f32 v9, v9, v17, v18
    v_max3_f32 v9, v9, v19, v24
    v_max_f32 v9, v9, v25
    v_mov_b32 v10, v9
    v_mov_b64 v[32:33], 0
    v_mov_b64 v[34:35], 0
    v_permlane32_swap_b32 v9, v10
    v_max_f32 v9, v9, v10
    v_mov_b32 v10, v9
    s_nop 1
    v_permlane16_swap_b32 v9, v10
    v_max_f32 v9, v9, v10
    v_mul_f32 v28, s44, v9
    v_fma_f32 v12, v12, s44, -v28
    v_fma_f32 v13, v13, s44, -v28
    v_fma_f32 v14, v14, s44, -v28
    v_fma_f32 v15, v15, s44, -v28
    v_exp_f32 v12, v12
    v_exp_f32 v13, v13
    v_fma_f32 v16, v16, s44, -v28
    v_fma_f32 v17, v17, s44, -v28
    v_exp_f32 v14, v14
    v_exp_f32 v15, v15
    v_cvt_pk_bf16_f32 v36, v12, v13
    v_fma_f32 v18, v18, s44, -v28
    v_fma_f32 v19, v19, s44, -v28
    v_exp_f32 v16, v16
    v_exp_f32 v17, v17
    v_cvt_pk_bf16_f32 v37, v14, v15
    v_fma_f32 v24, v24, s44, -v28
    v_fma_f32 v25, v25, s44, -v28
    v_exp_f32 v18, v18
    v_exp_f32 v19, v19
    v_cvt_pk_bf16_f32 v38, v16, v17
    v_exp_f32 v24, v24
    v_exp_f32 v25, v25
    v_cvt_pk_bf16_f32 v39, v18, v19
    v_cvt_pk_bf16_f32 v40, v24, v25
    v_cvt_pk_bf16_f32 v43, v24, v25
    v_mfma_f32_16x16x32_bf16 v[52:55], v[20:23], v[36:39], 0
    v_mov_b64 v[12:13], 0
    v_mov_b64 v[14:15], 0
    s_waitcnt vmcnt(4)
    v_mfma_f32_16x16x32_bf16 v[44:47], v[64:67], v[36:39], 0
    v_mov_b64 v[24:25], 0
    v_mov_b64 v[26:27], 0
    s_waitcnt vmcnt(3)
    v_mfma_f32_16x16x32_bf16 v[48:51], v[68:71], v[36:39], 0
    ds_read_b128 v[64:67], v8 offset:20480
    ds_read_b128 v[68:71], v8 offset:21504
    v_mfma_f32_16x16x16_bf16 v[52:55], v[20:21], v[40:41], v[52:55]
    v_mfma_f32_16x16x16_bf16 v[44:47], v[30:31], v[40:41], v[44:47]
    v_mov_b64 v[20:21], 0
    v_mov_b64 v[22:23], 0
    v_mfma_f32_16x16x16_bf16 v[48:51], v[30:31], v[42:43], v[48:51]
    v_mov_b64 v[36:37], 0
    v_mov_b64 v[38:39], 0
    v_mov_b64 v[40:41], 0
    v_mov_b64 v[42:43], 0
    v_rcp_f32 v9, v52
    v_mov_b64 v[52:53], 0
    v_mov_b64 v[54:55], 0
    v_mul_f32 v44, v9, v44
    v_mul_f32 v48, v9, v48
    v_cvt_pk_bf16_f32 v16, v44, v48
    v_mul_f32 v45, v9, v45
    v_mul_f32 v49, v9, v49
    v_cvt_pk_bf16_f32 v17, v45, v49
    v_mul_f32 v46, v9, v46
    v_mul_f32 v50, v9, v50
    v_cvt_pk_bf16_f32 v18, v46, v50
    v_mul_f32 v47, v9, v47
    v_mul_f32 v51, v9, v51
    v_cvt_pk_bf16_f32 v19, v47, v51
    ds_write_b128 v5, v[16:19]
    v_mov_b64 v[28:29], 0
    v_mov_b64 v[30:31], 0
    s_waitcnt lgkmcnt(0)
    s_barrier
    ds_read_b128 v[44:47], v4 offset:0
    ds_read_b128 v[48:51], v4 offset:128
    s_cmp_eq_u32 s33, 63
    s_cbranch_scc1 Lr0f_last
    v_mov_b64 v[16:17], 0
    v_mov_b64 v[18:19], 0
    buffer_load_dwordx4 v0, s[8:11], s41 offen offset:0 lds
    buffer_load_dwordx4 v0, s[8:11], s41 offen offset:1024 lds
    s_waitcnt lgkmcnt(1)
    v_smfmac_f32_16x16x64_bf16 v[12:15], v[44:47], a[184:191], v1
    s_waitcnt lgkmcnt(0)
    v_smfmac_f32_16x16x64_bf16 v[12:15], v[48:51], a[192:199], v1
    v_smfmac_f32_16x16x64_bf16 v[24:27], v[44:47], a[200:207], v1
    v_smfmac_f32_16x16x64_bf16 v[24:27], v[48:51], a[208:215], v1
    v_add_f32 v12, v12, v14
    v_smfmac_f32_16x16x64_bf16 v[20:23], v[44:47], a[216:223], v1
    v_add_f32 v13, v13, v15
    v_smfmac_f32_16x16x64_bf16 v[20:23], v[48:51], a[224:231], v1
    v_cvt_pk_bf16_f32 v12, v12, v13
    v_smfmac_f32_16x16x64_bf16 v[16:19], v[44:47], a[232:239], v1
    v_add_f32 v24, v24, v26
    v_smfmac_f32_16x16x64_bf16 v[16:19], v[48:51], a[240:247], v1
    v_add_f32 v25, v25, v27
    v_smfmac_f32_16x16x64_bf16 v[36:39], v[44:47], v[56:63], v1
    v_cvt_pk_bf16_f32 v13, v24, v25
    v_smfmac_f32_16x16x64_bf16 v[36:39], v[48:51], v[64:71], v1
    v_add_f32 v20, v20, v22
    v_add_f32 v21, v21, v23
    v_cvt_pk_bf16_f32 v14, v20, v21
    v_add_f32 v16, v16, v18
    v_add_f32 v17, v17, v19
    v_cvt_pk_bf16_f32 v15, v16, v17
    v_and_or_b32 v15, v15, -2, s40
    buffer_store_dwordx4 v[12:15], v0, s[8:11], s38 offen
    s_nop 0
    ds_read_b128 v[12:15], v8 offset:18432
    ds_read_b128 v[16:19], v8 offset:19456
    ds_read_b128 v[20:23], v8 offset:22528
    ds_read_b128 v[24:27], v8 offset:23552
    ds_read_b128 v[56:59], v8 offset:24576
    ds_read_b128 v[60:63], v8 offset:25600
    ds_read_b128 v[64:67], v8 offset:28672
    ds_read_b128 v[68:71], v8 offset:29696
    s_waitcnt lgkmcnt(6)
    v_smfmac_f32_16x16x64_bf16 v[40:43], v[44:47], v[12:19], v1
    ds_read_b128 v[12:15], v8 offset:26624
    ds_read_b128 v[16:19], v8 offset:27648
    s_waitcnt lgkmcnt(6)
    v_smfmac_f32_16x16x64_bf16 v[40:43], v[48:51], v[20:27], v1
    ds_read_b128 v[20:23], v8 offset:30720
    ds_read_b128 v[24:27], v8 offset:31744
    s_waitcnt lgkmcnt(6)
    v_smfmac_f32_16x16x64_bf16 v[52:55], v[44:47], v[56:63], v1
    ds_read_b128 v[56:59], v8 offset:32768
    ds_read_b128 v[60:63], v8 offset:33792
    s_waitcnt lgkmcnt(6)
    v_smfmac_f32_16x16x64_bf16 v[52:55], v[48:51], v[64:71], v1
    s_waitcnt lgkmcnt(4)
    v_smfmac_f32_16x16x64_bf16 v[32:35], v[44:47], v[12:19], v1
    s_waitcnt lgkmcnt(2)
    v_smfmac_f32_16x16x64_bf16 v[32:35], v[48:51], v[20:27], v1
    v_smfmac_f32_16x16x64_bf16 v[28:31], v[44:47], a[248:255], v1
    s_waitcnt lgkmcnt(0)
    v_smfmac_f32_16x16x64_bf16 v[28:31], v[48:51], v[56:63], v1
    buffer_load_dwordx4 v[12:15], v6, s[8:11], s62 offen sc1
    buffer_load_dwordx4 v[16:19], v6, s[8:11], s63 offen sc1
    buffer_load_dwordx4 v[20:23], v6, s[8:11], s64 offen sc1
    buffer_load_dwordx4 v[24:27], v6, s[8:11], s65 offen sc1
    v_add_f32 v36, v36, v38
    v_add_f32 v37, v37, v39
    v_cvt_pk_bf16_f32 v36, v36, v37
    v_add_f32 v40, v40, v42
    v_add_f32 v41, v41, v43
    v_cvt_pk_bf16_f32 v37, v40, v41
    v_add_f32 v52, v52, v54
    v_add_f32 v53, v53, v55
    v_cvt_pk_bf16_f32 v38, v52, v53
    v_add_f32 v32, v32, v34
    v_add_f32 v33, v33, v35
    v_cvt_pk_bf16_f32 v39, v32, v33
    v_and_or_b32 v39, v39, -2, s40
    s_add_u32 s17, s38, 4096
    buffer_store_dwordx4 v[36:39], v0, s[8:11], s17 offen
    v_add_f32 v28, v28, v30
    v_add_f32 v29, v29, v31
    v_cvt_pk_bf16_f32 v28, v28, v29
    v_and_or_b32 v28, v28, -2, s40
    v_lshrrev_b32 v9, 2, v0
    buffer_store_dword v28, v9, s[8:11], s39 offen
    v_add_u32 v10, 162560, v0
    ds_read_b128 v[64:67], v10
    s_nop 9
    buffer_load_dwordx4 v[40:43], v6, s[8:11], s62 offen sc1
    buffer_load_dwordx4 v[44:47], v6, s[8:11], s63 offen sc1
    buffer_load_dwordx4 v[48:51], v6, s[8:11], s64 offen sc1
    buffer_load_dwordx4 v[52:55], v6, s[8:11], s65 offen sc1
    s_add_u32 s33, s33, 1
    s_add_u32 s42, s42, 262144
    s_add_u32 s41, s41, 262144
    s_add_u32 s43, s43, 131072
    s_add_u32 s68, s68, 262144
    s_add_u32 s66, s66, 22528
    ds_read_b128 v[56:59], v8 offset:0
    ds_read_b128 v[60:63], v8 offset:1024
    s_waitcnt lgkmcnt(2)
    s_waitcnt vmcnt(9)
    v_mfma_f32_16x16x32_bf16 v[68:71], v[12:15], v[64:67], 0
    v_and_b32 v10, 1, v15
    v_cmp_ne_u32 s[54:55], s40, v10
    s_waitcnt vmcnt(8)
    v_mfma_f32_16x16x32_bf16 v[68:71], v[16:19], v[64:67], v[68:71]
    v_and_b32 v10, 1, v19
    v_cmp_ne_u32 s[56:57], s40, v10
    s_waitcnt vmcnt(7)
    v_mfma_f32_16x16x32_bf16 v[68:71], v[20:23], v[64:67], v[68:71]
    v_and_b32 v10, 1, v23
    v_cmp_ne_u32 s[58:59], s40, v10
    s_waitcnt vmcnt(6)
    v_mfma_f32_16x16x32_bf16 v[68:71], v[24:27], v[64:67], v[68:71]
    v_and_b32 v10, 1, v27
    v_cmp_ne_u32 s[60:61], s40, v10
    s_or_b64 vcc, s[54:55], s[56:57]
    s_or_b64 vcc, vcc, s[58:59]
    s_or_b64 vcc, vcc, s[60:61]
    s_cbranch_scc0 Lr0f_red
    s_mov_b32 s16, 0
Lr0f_p1:
    buffer_load_dwordx4 v[12:15], v6, s[8:11], s62 offen sc1
    buffer_load_dwordx4 v[16:19], v6, s[8:11], s63 offen sc1
    buffer_load_dwordx4 v[20:23], v6, s[8:11], s64 offen sc1
    buffer_load_dwordx4 v[24:27], v6, s[8:11], s65 offen sc1
    s_waitcnt vmcnt(7)
    v_mfma_f32_16x16x32_bf16 v[68:71], v[40:43], v[64:67], 0
    v_and_b32 v10, 1, v43
    v_cmp_ne_u32 s[54:55], s40, v10
    s_waitcnt vmcnt(6)
    v_mfma_f32_16x16x32_bf16 v[68:71], v[44:47], v[64:67], v[68:71]
    v_and_b32 v10, 1, v47
    v_cmp_ne_u32 s[56:57], s40, v10
    s_waitcnt vmcnt(5)
    v_mfma_f32_16x16x32_bf16 v[68:71], v[48:51], v[64:67], v[68:71]
    v_and_b32 v10, 1, v51
    v_cmp_ne_u32 s[58:59], s40, v10
    s_waitcnt vmcnt(4)
    v_mfma_f32_16x16x32_bf16 v[68:71], v[52:55], v[64:67], v[68:71]
    v_and_b32 v10, 1, v55
    v_cmp_ne_u32 s[60:61], s40, v10
    s_or_b64 vcc, s[54:55], s[56:57]
    s_or_b64 vcc, vcc, s[58:59]
    s_or_b64 vcc, vcc, s[60:61]
    s_cbranch_scc0 Lr0f_red
    buffer_load_dwordx4 v[40:43], v6, s[8:11], s62 offen sc1
    buffer_load_dwordx4 v[44:47], v6, s[8:11], s63 offen sc1
    buffer_load_dwordx4 v[48:51], v6, s[8:11], s64 offen sc1
    buffer_load_dwordx4 v[52:55], v6, s[8:11], s65 offen sc1
    s_add_u32 s16, s16, 1
    s_cmp_gt_u32 s16, 100000
    s_cbranch_scc1 Lr_abort
    s_waitcnt vmcnt(7)
    v_mfma_f32_16x16x32_bf16 v[68:71], v[12:15], v[64:67], 0
    v_and_b32 v10, 1, v15
    v_cmp_ne_u32 s[54:55], s40, v10
    s_waitcnt vmcnt(6)
    v_mfma_f32_16x16x32_bf16 v[68:71], v[16:19], v[64:67], v[68:71]
    v_and_b32 v10, 1, v19
    v_cmp_ne_u32 s[56:57], s40, v10
    s_waitcnt vmcnt(5)
    v_mfma_f32_16x16x32_bf16 v[68:71], v[20:23], v[64:67], v[68:71]
    v_and_b32 v10, 1, v23
    v_cmp_ne_u32 s[58:59], s40, v10
    s_waitcnt vmcnt(4)
    v_mfma_f32_16x16x32_bf16 v[68:71], v[24:27], v[64:67], v[68:71]
    v_and_b32 v10, 1, v27
    v_cmp_ne_u32 s[60:61], s40, v10
    s_or_b64 vcc, s[54:55], s[56:57]
    s_or_b64 vcc, vcc, s[58:59]
    s_or_b64 vcc, vcc, s[60:61]
    s_cbranch_scc1 Lr0f_p1
Lr0f_red:
    s_nop 1
    v_permlane16_swap_b32 v68, v70
    v_permlane16_swap_b32 v69, v71
    s_mov_b64 exec, s[46:47]
    v_add_f32 v68, v68, v70
    v_add_f32 v69, v69, v71
    v_cvt_pk_bf16_f32 v68, v68, v69
    v_min_u32 v68, s50, v68
    buffer_store_dword v68, v7, s[8:11], s36 offen
    v_mov_b32 v69, -1
    buffer_store_dword v69, v7, s[8:11], s37 offen
    s_mov_b64 exec, -1
    s_xor_b32 s34, s34, 16384
    s_xor_b32 s35, s35, 16384
    s_xor_b32 s40, s40, 1
    s_xor_b32 s36, s36, 16384
    s_xor_b32 s37, s37, 16384
    s_nop 15
    s_nop 3
    buffer_load_dwordx4 v[36:39], v0, s[8:11], s34 offen sc1
    s_waitcnt vmcnt(3)
    ds_read_b128 v[64:67], v8 offset:2048
    ds_read_b128 v[68:71], v8 offset:3072
    v_mov_b64 v[12:13], 0
    v_mov_b64 v[14:15], 0
    v_mov_b64 v[16:17], 0
    v_mov_b64 v[18:19], 0
    v_mov_b64 v[20:21], 0
    v_mov_b64 v[22:23], 0
    v_mov_b64 v[24:25], 0
    v_mov_b64 v[26:27], 0
    v_mov_b64 v[28:29], 0
    v_mov_b64 v[30:31], 0
    v_mov_b64 v[32:33], 0
    v_mov_b64 v[34:35], 0
    s_nop 9
    buffer_load_dwordx4 v[36:39], v0, s[8:11], s34 offen sc1
    s_nop 15
    s_nop 8
    buffer_load_dwordx4 v[36:39], v0, s[8:11], s34 offen sc1
    s_waitcnt lgkmcnt(0)
    s_branch Lr0f_step
Lr0f_pb_re:
    s_mov_b32 s16, 0
Lr0f_pb_lp:
    s_add_u32 s17, s34, 4096
    buffer_load_dwordx4 v[40:43], v0, s[8:11], s17 offen sc1
    s_add_u32 s16, s16, 1
    s_cmp_gt_u32 s16, 100000
    s_cbranch_scc1 Lr_abort
    s_waitcnt vmcnt(0)
    v_max3_u32 v10, v40, v41, v42
    v_max_u32 v10, v10, v43
    v_cmp_eq_u32 vcc, -1, v10
    s_nop 0
    s_cbranch_vccnz Lr0f_pb_lp
    s_branch Lr0f_pb_ok
Lr0f_pc_re:
    s_mov_b32 s16, 0
Lr0f_pc_lp:
    buffer_load_dwordx4 v[44:47], v0, s[8:11], s35 offen sc1
    s_add_u32 s16, s16, 1
    s_cmp_gt_u32 s16, 100000
    s_cbranch_scc1 Lr_abort
    s_waitcnt vmcnt(0)
    v_max3_u32 v10, v44, v45, v46
    v_max_u32 v10, v10, v47
    v_cmp_eq_u32 vcc, -1, v10
    s_nop 0
    s_cbranch_vccnz Lr0f_pc_lp
    s_branch Lr0f_pc_ok
Lr0f_last:
    s_waitcnt vmcnt(0) lgkmcnt(0)
    s_barrier
    s_branch Lr_exit
L_w1_1:
    s_cmp_lg_u32 s14, 1
    s_cbranch_scc1 L_w2_1
    s_mov_b32 s16, 0
    s_add_u32 s17, s66, 128
    v_lshrrev_b32 v10, 2, v0
    v_and_b32 v9, 16, v10
    v_lshlrev_b32 v9, 3, v9
    v_and_or_b32 v10, v10, 12, v9
Lr1f_fw_23:
    buffer_load_dword v9, v10, s[8:11], s17 offen sc1
    s_add_u32 s16, s16, 1
    s_cmp_gt_u32 s16, 100000
    s_cbranch_scc1 Lr_abort
    s_waitcnt vmcnt(0)
    v_cmp_eq_u32 vcc, 0, v9
    s_nop 0
    s_cbranch_vccnz Lr1f_fw_23
    s_lshl_b32 s67, s32, 5
    s_add_u32 s67, s67, s15
    s_lshl_b32 s67, s67, 12
    s_add_u32 s67, s67, 3145728
    s_mov_b32 m0, 17152
    s_nop 0
    buffer_load_dwordx4 v0, s[8:11], s41 offen offset:0 lds
    buffer_load_dwordx4 v0, s[8:11], s41 offen offset:1024 lds
    s_add_u32 s41, s41, 262144
    s_add_u32 s68, s68, 262144
    s_waitcnt vmcnt(0)
    ds_read_b128 v[56:59], v8 offset:4096
    ds_read_b128 v[60:63], v8 offset:5120
    ds_read_b128 v[64:67], v8 offset:6144
    ds_read_b128 v[68:71], v8 offset:7168
    v_mov_b64 v[12:13], 0
    v_mov_b64 v[14:15], 0
    v_mov_b64 v[16:17], 0
    v_mov_b64 v[18:19], 0
    v_mov_b64 v[20:21], 0
    v_mov_b64 v[22:23], 0
    v_mov_b64 v[24:25], 0
    v_mov_b64 v[26:27], 0
    v_mov_b64 v[28:29], 0
    v_mov_b64 v[30:31], 0
    v_mov_b64 v[32:33], 0
    v_mov_b64 v[34:35], 0
    buffer_load_dwordx4 v[36:39], v0, s[8:11], s34 offen sc1
    s_waitcnt vmcnt(0) lgkmcnt(0)
Lr1f_step:
    s_waitcnt vmcnt(3)
    v_max3_u32 v10, v36, v37, v38
    v_max_u32 v10, v10, v39
    v_cmp_eq_u32 vcc, -1, v10
    s_nop 0
    s_cbranch_vccz Lr1f_aok
    buffer_load_dwordx4 v[36:39], v0, s[8:11], s34 offen sc1
    s_waitcnt vmcnt(1)
    v_max3_u32 v10, v36, v37, v38
    v_max_u32 v10, v10, v39
    v_cmp_eq_u32 vcc, -1, v10
    s_nop 0
    s_cbranch_vccz Lr1f_aok
    s_mov_b32 s16, 0
Lr1f_alp:
    buffer_load_dwordx4 v[36:39], v0, s[8:11], s34 offen sc1
    s_add_u32 s16, s16, 1
    s_cmp_gt_u32 s16, 100000
    s_cbranch_scc1 Lr_abort
    s_waitcnt vmcnt(1)
    v_max3_u32 v10, v36, v37, v38
    v_max_u32 v10, v10, v39
    v_cmp_eq_u32 vcc, -1, v10
    s_nop 0
    s_cbranch_vccnz Lr1f_alp
Lr1f_aok:
    ds_write_b128 v0, v[36:39] offset:7936
    v_smfmac_f32_16x16x64_bf16 v[12:15], v[36:39], v[88:95], v1
    v_smfmac_f32_16x16x64_bf16 v[16:19], v[36:39], v[96:103], v1
    v_smfmac_f32_16x16x64_bf16 v[20:23], v[36:39], v[200:207], v1
    s_waitcnt lgkmcnt(0)
    s_barrier
    ds_read_b128 v[48:51], v0 offset:8960
    ds_read_b128 v[52:55], v0 offset:9984
    v_smfmac_f32_16x16x64_bf16 v[28:31], v[36:39], a[72:79], v1
    v_smfmac_f32_16x16x64_bf16 v[24:27], v[36:39], v[208:215], v1
    s_add_u32 s17, s34, 4096
    buffer_load_dwordx4 v[40:43], v0, s[8:11], s17 offen sc1
    v_smfmac_f32_16x16x64_bf16 v[32:35], v[36:39], a[80:87], v1
    s_waitcnt vmcnt(1)
    ds_read_b128 v[36:39], v0 offset:6912
    s_waitcnt lgkmcnt(2)
    v_smfmac_f32_16x16x64_bf16 v[28:31], v[48:51], v[56:63], v1
    ds_read_b128 v[56:59], v8 offset:0
    ds_read_b128 v[60:63], v8 offset:1024
    v_smfmac_f32_16x16x64_bf16 v[12:15], v[48:51], v[104:111], v1
    v_smfmac_f32_16x16x64_bf16 v[16:19], v[48:51], v[112:119], v1
    buffer_load_dwordx4 v[44:47], v0, s[8:11], s35 offen sc1
    v_smfmac_f32_16x16x64_bf16 v[32:35], v[48:51], v[64:71], v1
    ds_read_b128 v[64:67], v8 offset:2048
    ds_read_b128 v[68:71], v8 offset:3072
    v_smfmac_f32_16x16x64_bf16 v[20:23], v[48:51], v[216:223], v1
    v_smfmac_f32_16x16x64_bf16 v[24:27], v[48:51], v[224:231], v1
    s_waitcnt lgkmcnt(5)
    v_smfmac_f32_16x16x64_bf16 v[28:31], v[52:55], a[88:95], v1
    v_smfmac_f32_16x16x64_bf16 v[12:15], v[52:55], v[120:127], v1
    v_smfmac_f32_16x16x64_bf16 v[16:19], v[52:55], v[128:135], v1
    v_smfmac_f32_16x16x64_bf16 v[32:35], v[52:55], a[96:103], v1
    v_smfmac_f32_16x16x64_bf16 v[20:23], v[52:55], v[232:239], v1
    v_smfmac_f32_16x16x64_bf16 v[24:27], v[52:55], v[240:247], v1
    s_waitcnt lgkmcnt(2)
    v_smfmac_f32_16x16x64_bf16 v[28:31], v[36:39], v[56:63], v1
    ds_read_b128 v[56:59], v8 offset:12288
    ds_read_b128 v[60:63], v8 offset:13312
    v_smfmac_f32_16x16x64_bf16 v[12:15], v[36:39], v[72:79], v1
    v_smfmac_f32_16x16x64_bf16 v[16:19], v[36:39], v[80:87], v1
    s_waitcnt lgkmcnt(2)
    v_smfmac_f32_16x16x64_bf16 v[32:35], v[36:39], v[64:71], v1
    ds_read_b128 v[64:67], v8 offset:14336
    ds_read_b128 v[68:71], v8 offset:15360
    v_smfmac_f32_16x16x64_bf16 v[20:23], v[36:39], v[184:191], v1
    v_smfmac_f32_16x16x64_bf16 v[24:27], v[36:39], v[192:199], v1
    s_waitcnt vmcnt(1)
    v_max3_u32 v10, v40, v41, v42
    v_max_u32 v10, v10, v43
    v_cmp_eq_u32 vcc, -1, v10
    s_nop 0
    s_cbranch_vccnz Lr1f_pb_re
Lr1f_pb_ok:
    ds_write_b128 v0, v[40:43] offset:12032
    v_mov_b32 v9, 1
    v_mov_b32 v10, 0
    s_mov_b64 exec, 1
    buffer_store_dword v9, v10, s[8:11], s67 offen offset:384 sc1
    s_mov_b64 exec, -1
    v_smfmac_f32_16x16x64_bf16 v[12:15], v[40:43], v[136:143], v1
    v_smfmac_f32_16x16x64_bf16 v[20:23], v[40:43], a[8:15], v1
    v_smfmac_f32_16x16x64_bf16 v[16:19], v[40:43], v[144:151], v1
    v_smfmac_f32_16x16x64_bf16 v[24:27], v[40:43], a[16:23], v1
    s_waitcnt lgkmcnt(0)
    s_barrier
    ds_read_b128 v[48:51], v0 offset:13056
    ds_read_b128 v[52:55], v0 offset:14080
    ds_read_b128 v[36:39], v0 offset:11008
    v_smfmac_f32_16x16x64_bf16 v[28:31], v[40:43], a[120:127], v1
    v_smfmac_f32_16x16x64_bf16 v[32:35], v[40:43], a[128:135], v1
    s_waitcnt lgkmcnt(2)
    v_smfmac_f32_16x16x64_bf16 v[12:15], v[48:51], v[56:63], v1
    ds_read_b128 v[56:59], v8 offset:8192
    ds_read_b128 v[60:63], v8 offset:9216
    v_smfmac_f32_16x16x64_bf16 v[16:19], v[48:51], v[64:71], v1
    ds_read_b128 v[64:67], v8 offset:10240
    ds_read_b128 v[68:71], v8 offset:11264
    s_waitcnt lgkmcnt(5)
    v_smfmac_f32_16x16x64_bf16 v[12:15], v[52:55], v[152:159], v1
    v_smfmac_f32_16x16x64_bf16 v[16:19], v[52:55], v[160:167], v1
    s_waitcnt vmcnt(1)
    v_max3_u32 v10, v44, v45, v46
    v_max_u32 v10, v10, v47
    v_cmp_eq_u32 vcc, -1, v10
    s_nop 0
    s_cbranch_vccnz Lr1f_pc_re
Lr1f_pc_ok:
    v_smfmac_f32_16x16x64_bf16 v[12:15], v[44:47], v[168:175], v1
    v_smfmac_f32_16x16x64_bf16 v[16:19], v[44:47], v[176:183], v1
    s_waitcnt lgkmcnt(2)
    v_smfmac_f32_16x16x64_bf16 v[12:15], v[36:39], v[56:63], v1
    s_waitcnt lgkmcnt(0)
    v_smfmac_f32_16x16x64_bf16 v[16:19], v[36:39], v[64:71], v1
    v_smfmac_f32_16x16x64_bf16 v[20:23], v[48:51], a[24:31], v1
    v_smfmac_f32_16x16x64_bf16 v[24:27], v[48:51], a[32:39], v1
    buffer_load_dwordx4 v[64:67], v0, s[8:11], s42 offen
    v_smfmac_f32_16x16x64_bf16 v[20:23], v[52:55], a[40:47], v1
    v_add_f32 v12, v12, v14
    v_smfmac_f32_16x16x64_bf16 v[24:27], v[52:55], a[48:55], v1
    v_add_f32 v16, v16, v18
    v_smfmac_f32_16x16x64_bf16 v[20:23], v[36:39], v[248:255], v1
    v_add_f32 v13, v13, v15
    v_smfmac_f32_16x16x64_bf16 v[24:27], v[36:39], a[0:7], v1
    v_add_f32 v17, v17, v19
    buffer_load_dwordx4 v[68:71], v0, s[8:11], s42 offen offset:1024
    v_smfmac_f32_16x16x64_bf16 v[20:23], v[44:47], a[56:63], v1
    v_cvt_pk_bf16_f32 v14, v12, v16
    ds_read_b128 v[56:59], v0 offset:15104
    v_smfmac_f32_16x16x64_bf16 v[24:27], v[44:47], a[64:71], v1
    v_cvt_pk_bf16_f32 v15, v13, v17
    ds_read_b128 v[60:63], v0 offset:16128
    ds_write_b32 v2, v14 offset:576
    ds_write_b32 v2, v15 offset:864
    v_smfmac_f32_16x16x64_bf16 v[28:31], v[48:51], a[136:143], v1
    v_smfmac_f32_16x16x64_bf16 v[32:35], v[48:51], a[144:151], v1
    v_add_f32 v20, v20, v22
    v_add_f32 v24, v24, v26
    v_add_f32 v21, v21, v23
    v_add_f32 v25, v25, v27
    v_cvt_pk_bf16_f32 v22, v20, v24
    v_cvt_pk_bf16_f32 v23, v21, v25
    ds_write_b32 v2, v22 offset:0
    ds_write_b32 v2, v23 offset:288
    v_smfmac_f32_16x16x64_bf16 v[28:31], v[52:55], a[152:159], v1
    v_smfmac_f32_16x16x64_bf16 v[32:35], v[52:55], a[160:167], v1
    s_waitcnt lgkmcnt(0)
    s_barrier
    ds_read_b128 v[40:43], v3 offset:0
    ds_read_b128 v[48:51], v3 offset:64
    ds_read_b128 v[20:23], v3 offset:128
    ds_read_b128 v[52:55], v3 offset:192
    v_smfmac_f32_16x16x64_bf16 v[28:31], v[36:39], a[104:111], v1
    v_smfmac_f32_16x16x64_bf16 v[32:35], v[36:39], a[112:119], v1
    ds_read_b128 v[36:39], v0 offset:17152
    v_smfmac_f32_16x16x64_bf16 v[28:31], v[44:47], a[168:175], v1
    v_smfmac_f32_16x16x64_bf16 v[32:35], v[44:47], a[176:183], v1
    ds_read_b128 v[44:47], v0 offset:18176
    s_waitcnt lgkmcnt(5)
    v_mfma_f32_16x16x32_bf16 v[12:15], v[56:59], v[40:43], 0
    v_mfma_f32_16x16x32_bf16 v[16:19], v[60:63], v[40:43], 0
    v_mfma_f32_16x16x32_bf16 v[24:27], v[40:43], v[40:43], 0
    ds_read_b128 v[56:59], v0 offset:19200
    ds_read_b128 v[60:63], v0 offset:20224
    s_waitcnt lgkmcnt(3)
    v_mfma_f32_16x16x32_bf16 v[12:15], v[36:39], v[48:51], v[12:15]
    v_lshrrev_b32 v10, 1, v0
    v_lshrrev_b32 v9, 9, v0
    s_waitcnt lgkmcnt(2)
    v_mfma_f32_16x16x32_bf16 v[16:19], v[44:47], v[48:51], v[16:19]
    v_lshl_add_u32 v9, v9, 5, v10
    v_add_f32 v28, v28, v30
    v_mfma_f32_16x16x32_bf16 v[24:27], v[48:51], v[48:51], v[24:27]
    v_add_f32 v32, v32, v34
    v_add_f32 v29, v29, v31
    ds_read_b128 v[36:39], v0 offset:21248
    ds_read_b128 v[44:47], v0 offset:22272
    s_waitcnt lgkmcnt(3)
    v_mfma_f32_16x16x32_bf16 v[12:15], v[56:59], v[20:23], v[12:15]
    v_add_f32 v33, v33, v35
    v_cvt_pk_bf16_f32 v30, v28, v29
    s_waitcnt lgkmcnt(2)
    v_mfma_f32_16x16x32_bf16 v[16:19], v[60:63], v[20:23], v[16:19]
    v_cvt_pk_bf16_f32 v31, v32, v33
    ds_read_b64 v[34:35], v9 offset:1152
    v_mfma_f32_16x16x32_bf16 v[24:27], v[20:23], v[20:23], v[24:27]
    s_add_u32 s17, s43, 2560
    buffer_store_dwordx2 v[30:31], v10, s[8:11], s17 offen sc1
    s_waitcnt lgkmcnt(2)
    v_mfma_f32_16x16x32_bf16 v[12:15], v[36:39], v[52:55], v[12:15]
    s_waitcnt lgkmcnt(1)
    v_mfma_f32_16x16x32_bf16 v[16:19], v[44:47], v[52:55], v[16:19]
    v_mfma_f32_16x16x32_bf16 v[24:27], v[52:55], v[52:55], v[24:27]
    s_add_u32 s17, s43, 512
    s_waitcnt lgkmcnt(0)
    buffer_store_dwordx2 v[34:35], v10, s[8:11], s17 offen sc1
    ds_read_b128 v[56:59], v8 offset:16384
    ds_read_b128 v[60:63], v8 offset:17408
    v_mov_b64 v[20:21], s[52:53]
    v_mov_b64 v[22:23], s[52:53]
    v_mov_b32 v41, 0
    v_mov_b32 v42, 0
    v_max3_f32 v9, v12, v13, v14
    v_max3_f32 v9, v9, v15, v16
    v_max3_f32 v9, v9, v17, v18
    v_max3_f32 v9, v9, v19, v24
    v_max_f32 v9, v9, v25
    v_mov_b32 v10, v9
    v_mov_b64 v[32:33], 0
    v_mov_b64 v[34:35], 0
    v_permlane32_swap_b32 v9, v10
    v_max_f32 v9, v9, v10
    v_mov_b32 v10, v9
    s_nop 1
    v_permlane16_swap_b32 v9, v10
    v_max_f32 v9, v9, v10
    v_mul_f32 v28, s44, v9
    v_fma_f32 v12, v12, s44, -v28
    v_fma_f32 v13, v13, s44, -v28
    v_fma_f32 v14, v14, s44, -v28
    v_fma_f32 v15, v15, s44, -v28
    v_exp_f32 v12, v12
    v_exp_f32 v13, v13
    v_fma_f32 v16, v16, s44, -v28
    v_fma_f32 v17, v17, s44, -v28
    v_exp_f32 v14, v14
    v_exp_f32 v15, v15
    v_cvt_pk_bf16_f32 v36, v12, v13
    v_fma_f32 v18, v18, s44, -v28
    v_fma_f32 v19, v19, s44, -v28
    v_exp_f32 v16, v16
    v_exp_f32 v17, v17
    v_cvt_pk_bf16_f32 v37, v14, v15
    v_fma_f32 v24, v24, s44, -v28
    v_fma_f32 v25, v25, s44, -v28
    v_exp_f32 v18, v18
    v_exp_f32 v19, v19
    v_cvt_pk_bf16_f32 v38, v16, v17
    v_exp_f32 v24, v24
    v_exp_f32 v25, v25
    v_cvt_pk_bf16_f32 v39, v18, v19
    v_cvt_pk_bf16_f32 v40, v24, v25
    v_cvt_pk_bf16_f32 v43, v24, v25
    v_mfma_f32_16x16x32_bf16 v[52:55], v[20:23], v[36:39], 0
    v_mov_b64 v[12:13], 0
    v_mov_b64 v[14:15], 0
    s_waitcnt vmcnt(3)
    v_mfma_f32_16x16x32_bf16 v[44:47], v[64:67], v[36:39], 0
    v_mov_b64 v[24:25], 0
    v_mov_b64 v[26:27], 0
    s_waitcnt vmcnt(2)
    v_mfma_f32_16x16x32_bf16 v[48:51], v[68:71], v[36:39], 0
    ds_read_b128 v[64:67], v8 offset:20480
    ds_read_b128 v[68:71], v8 offset:21504
    v_mfma_f32_16x16x16_bf16 v[52:55], v[20:21], v[40:41], v[52:55]
    v_mfma_f32_16x16x16_bf16 v[44:47], v[30:31], v[40:41], v[44:47]
    v_mov_b64 v[20:21], 0
    v_mov_b64 v[22:23], 0
    v_mfma_f32_16x16x16_bf16 v[48:51], v[30:31], v[42:43], v[48:51]
    v_mov_b64 v[36:37], 0
    v_mov_b64 v[38:39], 0
    v_mov_b64 v[40:41], 0
    v_mov_b64 v[42:43], 0
    v_rcp_f32 v9, v52
    v_mov_b64 v[52:53], 0
    v_mov_b64 v[54:55], 0
    v_mul_f32 v44, v9, v44
    v_mul_f32 v48, v9, v48
    v_cvt_pk_bf16_f32 v16, v44, v48
    v_mul_f32 v45, v9, v45
    v_mul_f32 v49, v9, v49
    v_cvt_pk_bf16_f32 v17, v45, v49
    v_mul_f32 v46, v9, v46
    v_mul_f32 v50, v9, v50
    v_cvt_pk_bf16_f32 v18, v46, v50
    v_mul_f32 v47, v9, v47
    v_mul_f32 v51, v9, v51
    v_cvt_pk_bf16_f32 v19, v47, v51
    ds_write_b128 v5, v[16:19]
    v_mov_b64 v[28:29], 0
    v_mov_b64 v[30:31], 0
    s_waitcnt lgkmcnt(0)
    s_barrier
    ds_read_b128 v[44:47], v4 offset:0
    ds_read_b128 v[48:51], v4 offset:128
    s_cmp_eq_u32 s33, 63
    s_cbranch_scc1 Lr1f_last
    v_mov_b64 v[16:17], 0
    v_mov_b64 v[18:19], 0
    buffer_load_dwordx4 v0, s[8:11], s41 offen offset:0 lds
    buffer_load_dwordx4 v0, s[8:11], s41 offen offset:1024 lds
    s_waitcnt lgkmcnt(1)
    v_smfmac_f32_16x16x64_bf16 v[12:15], v[44:47], a[184:191], v1
    s_waitcnt lgkmcnt(0)
    v_smfmac_f32_16x16x64_bf16 v[12:15], v[48:51], a[192:199], v1
    v_smfmac_f32_16x16x64_bf16 v[24:27], v[44:47], a[200:207], v1
    v_smfmac_f32_16x16x64_bf16 v[24:27], v[48:51], a[208:215], v1
    v_add_f32 v12, v12, v14
    v_smfmac_f32_16x16x64_bf16 v[20:23], v[44:47], a[216:223], v1
    v_add_f32 v13, v13, v15
    v_smfmac_f32_16x16x64_bf16 v[20:23], v[48:51], a[224:231], v1
    v_cvt_pk_bf16_f32 v12, v12, v13
    v_smfmac_f32_16x16x64_bf16 v[16:19], v[44:47], a[232:239], v1
    v_add_f32 v24, v24, v26
    v_smfmac_f32_16x16x64_bf16 v[16:19], v[48:51], a[240:247], v1
    v_add_f32 v25, v25, v27
    v_smfmac_f32_16x16x64_bf16 v[36:39], v[44:47], v[56:63], v1
    v_cvt_pk_bf16_f32 v13, v24, v25
    v_smfmac_f32_16x16x64_bf16 v[36:39], v[48:51], v[64:71], v1
    v_add_f32 v20, v20, v22
    v_add_f32 v21, v21, v23
    v_cvt_pk_bf16_f32 v14, v20, v21
    v_add_f32 v16, v16, v18
    v_add_f32 v17, v17, v19
    v_cvt_pk_bf16_f32 v15, v16, v17
    v_and_or_b32 v15, v15, -2, s40
    buffer_store_dwordx4 v[12:15], v0, s[8:11], s38 offen
    s_nop 0
    ds_read_b128 v[12:15], v8 offset:18432
    ds_read_b128 v[16:19], v8 offset:19456
    ds_read_b128 v[20:23], v8 offset:22528
    ds_read_b128 v[24:27], v8 offset:23552
    ds_read_b128 v[56:59], v8 offset:24576
    ds_read_b128 v[60:63], v8 offset:25600
    ds_read_b128 v[64:67], v8 offset:28672
    ds_read_b128 v[68:71], v8 offset:29696
    s_waitcnt lgkmcnt(6)
    v_smfmac_f32_16x16x64_bf16 v[40:43], v[44:47], v[12:19], v1
    ds_read_b128 v[12:15], v8 offset:26624
    ds_read_b128 v[16:19], v8 offset:27648
    s_waitcnt lgkmcnt(6)
    v_smfmac_f32_16x16x64_bf16 v[40:43], v[48:51], v[20:27], v1
    ds_read_b128 v[20:23], v8 offset:30720
    ds_read_b128 v[24:27], v8 offset:31744
    s_waitcnt lgkmcnt(6)
    v_smfmac_f32_16x16x64_bf16 v[52:55], v[44:47], v[56:63], v1
    ds_read_b128 v[56:59], v8 offset:32768
    ds_read_b128 v[60:63], v8 offset:33792
    s_waitcnt lgkmcnt(6)
    v_smfmac_f32_16x16x64_bf16 v[52:55], v[48:51], v[64:71], v1
    s_waitcnt lgkmcnt(4)
    v_smfmac_f32_16x16x64_bf16 v[32:35], v[44:47], v[12:19], v1
    s_waitcnt lgkmcnt(2)
    v_smfmac_f32_16x16x64_bf16 v[32:35], v[48:51], v[20:27], v1
    v_smfmac_f32_16x16x64_bf16 v[28:31], v[44:47], a[248:255], v1
    s_waitcnt lgkmcnt(0)
    v_smfmac_f32_16x16x64_bf16 v[28:31], v[48:51], v[56:63], v1
    v_add_f32 v36, v36, v38
    v_add_f32 v37, v37, v39
    v_cvt_pk_bf16_f32 v36, v36, v37
    v_add_f32 v40, v40, v42
    v_add_f32 v41, v41, v43
    v_cvt_pk_bf16_f32 v37, v40, v41
    v_add_f32 v52, v52, v54
    v_add_f32 v53, v53, v55
    v_cvt_pk_bf16_f32 v38, v52, v53
    v_add_f32 v32, v32, v34
    v_add_f32 v33, v33, v35
    v_cvt_pk_bf16_f32 v39, v32, v33
    v_and_or_b32 v39, v39, -2, s40
    s_add_u32 s17, s38, 4096
    buffer_store_dwordx4 v[36:39], v0, s[8:11], s17 offen
    v_add_f32 v28, v28, v30
    v_add_f32 v29, v29, v31
    v_cvt_pk_bf16_f32 v28, v28, v29
    v_and_or_b32 v28, v28, -2, s40
    v_lshrrev_b32 v9, 2, v0
    buffer_store_dword v28, v9, s[8:11], s39 offen
    v_add_u32 v10, 162560, v0
    ds_read_b128 v[64:67], v10
    s_add_u32 s33, s33, 1
    s_add_u32 s42, s42, 262144
    s_add_u32 s41, s41, 262144
    s_add_u32 s43, s43, 131072
    s_mov_b32 s67, s66
    s_add_u32 s68, s68, 262144
    s_add_u32 s66, s66, 22528
    ds_read_b128 v[56:59], v8 offset:4096
    ds_read_b128 v[60:63], v8 offset:5120
    v_mov_b64 v[12:13], 0
    v_mov_b64 v[14:15], 0
    v_mov_b64 v[16:17], 0
    v_mov_b64 v[18:19], 0
    v_mov_b64 v[20:21], 0
    v_mov_b64 v[22:23], 0
    v_mov_b64 v[24:25], 0
    v_mov_b64 v[26:27], 0
    v_mov_b64 v[28:29], 0
    v_mov_b64 v[30:31], 0
    v_mov_b64 v[32:33], 0
    v_mov_b64 v[34:35], 0
    s_nop 15
    s_nop 15
    s_nop 15
    s_nop 11
    buffer_load_dwordx4 v[40:43], v6, s[8:11], s62 offen sc1
    buffer_load_dwordx4 v[44:47], v6, s[8:11], s63 offen sc1
    buffer_load_dwordx4 v[48:51], v6, s[8:11], s64 offen sc1
    buffer_load_dwordx4 v[52:55], v6, s[8:11], s65 offen sc1
    s_waitcnt lgkmcnt(0)
    s_waitcnt vmcnt(3)
    v_mfma_f32_16x16x32_bf16 v[68:71], v[40:43], v[64:67], 0
    v_and_b32 v10, 1, v43
    v_cmp_ne_u32 s[54:55], s40, v10
    s_waitcnt vmcnt(2)
    v_mfma_f32_16x16x32_bf16 v[68:71], v[44:47], v[64:67], v[68:71]
    v_and_b32 v10, 1, v47
    v_cmp_ne_u32 s[56:57], s40, v10
    s_waitcnt vmcnt(1)
    v_mfma_f32_16x16x32_bf16 v[68:71], v[48:51], v[64:67], v[68:71]
    v_and_b32 v10, 1, v51
    v_cmp_ne_u32 s[58:59], s40, v10
    s_waitcnt vmcnt(0)
    v_mfma_f32_16x16x32_bf16 v[68:71], v[52:55], v[64:67], v[68:71]
    v_and_b32 v10, 1, v55
    v_cmp_ne_u32 s[60:61], s40, v10
    s_or_b64 vcc, s[54:55], s[56:57]
    s_or_b64 vcc, vcc, s[58:59]
    s_or_b64 vcc, vcc, s[60:61]
    s_cbranch_scc0 Lr1f_red
    s_mov_b32 s16, 0
Lr1f_p1:
    s_mov_b64 exec, s[54:55]
    buffer_load_dwordx4 v[40:43], v6, s[8:11], s62 offen sc1
    s_mov_b64 exec, s[56:57]
    buffer_load_dwordx4 v[44:47], v6, s[8:11], s63 offen sc1
    s_mov_b64 exec, s[58:59]
    buffer_load_dwordx4 v[48:51], v6, s[8:11], s64 offen sc1
    s_mov_b64 exec, s[60:61]
    buffer_load_dwordx4 v[52:55], v6, s[8:11], s65 offen sc1
    s_mov_b64 exec, -1
    s_add_u32 s16, s16, 1
    s_cmp_gt_u32 s16, 100000
    s_cbranch_scc1 Lr_abort
    s_waitcnt vmcnt(3)
    v_mfma_f32_16x16x32_bf16 v[68:71], v[40:43], v[64:67], 0
    v_and_b32 v10, 1, v43
    v_cmp_ne_u32 s[54:55], s40, v10
    s_waitcnt vmcnt(2)
    v_mfma_f32_16x16x32_bf16 v[68:71], v[44:47], v[64:67], v[68:71]
    v_and_b32 v10, 1, v47
    v_cmp_ne_u32 s[56:57], s40, v10
    s_waitcnt vmcnt(1)
    v_mfma_f32_16x16x32_bf16 v[68:71], v[48:51], v[64:67], v[68:71]
    v_and_b32 v10, 1, v51
    v_cmp_ne_u32 s[58:59], s40, v10
    s_waitcnt vmcnt(0)
    v_mfma_f32_16x16x32_bf16 v[68:71], v[52:55], v[64:67], v[68:71]
    v_and_b32 v10, 1, v55
    v_cmp_ne_u32 s[60:61], s40, v10
    s_or_b64 vcc, s[54:55], s[56:57]
    s_or_b64 vcc, vcc, s[58:59]
    s_or_b64 vcc, vcc, s[60:61]
    s_cbranch_scc1 Lr1f_p1
Lr1f_red:
    s_xor_b32 s34, s34, 16384
    s_xor_b32 s35, s35, 16384
    buffer_load_dwordx4 v[36:39], v0, s[8:11], s34 offen sc1
    v_permlane16_swap_b32 v68, v70
    v_permlane16_swap_b32 v69, v71
    s_mov_b64 exec, s[46:47]
    v_add_f32 v68, v68, v70
    v_add_f32 v69, v69, v71
    v_cvt_pk_bf16_f32 v68, v68, v69
    v_min_u32 v68, s50, v68
    buffer_store_dword v68, v7, s[8:11], s36 offen
    v_mov_b32 v69, -1
    buffer_store_dword v69, v7, s[8:11], s37 offen
    s_mov_b64 exec, -1
    buffer_load_dwordx4 v[36:39], v0, s[8:11], s34 offen sc1
    s_xor_b32 s40, s40, 1
    s_xor_b32 s36, s36, 16384
    s_xor_b32 s37, s37, 16384
    ds_read_b128 v[64:67], v8 offset:6144
    ds_read_b128 v[68:71], v8 offset:7168
    s_waitcnt lgkmcnt(0)
    s_branch Lr1f_step
Lr1f_pb_re:
    s_mov_b32 s16, 0
Lr1f_pb_lp:
    s_add_u32 s17, s34, 4096
    buffer_load_dwordx4 v[40:43], v0, s[8:11], s17 offen sc1
    s_add_u32 s16, s16, 1
    s_cmp_gt_u32 s16, 100000
    s_cbranch_scc1 Lr_abort
    s_waitcnt vmcnt(0)
    v_max3_u32 v10, v40, v41, v42
    v_max_u32 v10, v10, v43
    v_cmp_eq_u32 vcc, -1, v10
    s_nop 0
    s_cbranch_vccnz Lr1f_pb_lp
    s_branch Lr1f_pb_ok
Lr1f_pc_re:
    s_mov_b32 s16, 0
Lr1f_pc_lp:
    buffer_load_dwordx4 v[44:47], v0, s[8:11], s35 offen sc1
    s_add_u32 s16, s16, 1
    s_cmp_gt_u32 s16, 100000
    s_cbranch_scc1 Lr_abort
    s_waitcnt vmcnt(0)
    v_max3_u32 v10, v44, v45, v46
    v_max_u32 v10, v10, v47
    v_cmp_eq_u32 vcc, -1, v10
    s_nop 0
    s_cbranch_vccnz Lr1f_pc_lp
    s_branch Lr1f_pc_ok
Lr1f_last:
    s_waitcnt vmcnt(0) lgkmcnt(0)
    s_barrier
    s_mov_b32 s67, s66
    v_mov_b32 v9, 1
    v_mov_b32 v10, 0
    s_mov_b64 exec, 1
    buffer_store_dword v9, v10, s[8:11], s67 offen offset:384 sc1
    s_mov_b64 exec, -1
    s_branch Lr_exit
L_w2_1:
    s_cmp_lg_u32 s14, 2
    s_cbranch_scc1 L_w3_1
    s_mov_b32 s16, 0
    s_add_u32 s17, s66, 128
    v_lshrrev_b32 v10, 2, v0
    v_and_b32 v9, 16, v10
    v_lshlrev_b32 v9, 3, v9
    v_and_or_b32 v10, v10, 12, v9
Lr2f_fw_24:
    buffer_load_dword v9, v10, s[8:11], s17 offen sc1
    s_add_u32 s16, s16, 1
    s_cmp_gt_u32 s16, 100000
    s_cbranch_scc1 Lr_abort
    s_waitcnt vmcnt(0)
    v_cmp_eq_u32 vcc, 0, v9
    s_nop 0
    s_cbranch_vccnz Lr2f_fw_24
    s_mov_b32 m0, 19200
    s_nop 0
    buffer_load_dwordx4 v0, s[8:11], s41 offen offset:0 lds
    buffer_load_dwordx4 v0, s[8:11], s41 offen offset:1024 lds
    s_add_u32 s41, s41, 262144
    s_add_u32 s68, s68, 262144
    s_waitcnt vmcnt(0)
    ds_read_b128 v[56:59], v8 offset:4096
    ds_read_b128 v[60:63], v8 offset:5120
    ds_read_b128 v[64:67], v8 offset:6144
    ds_read_b128 v[68:71], v8 offset:7168
    v_mov_b64 v[12:13], 0
    v_mov_b64 v[14:15], 0
    v_mov_b64 v[16:17], 0
    v_mov_b64 v[18:19], 0
    v_mov_b64 v[20:21], 0
    v_mov_b64 v[22:23], 0
    v_mov_b64 v[24:25], 0
    v_mov_b64 v[26:27], 0
    v_mov_b64 v[28:29], 0
    v_mov_b64 v[30:31], 0
    v_mov_b64 v[32:33], 0
    v_mov_b64 v[34:35], 0
    buffer_load_dwordx4 v[36:39], v0, s[8:11], s34 offen sc1
    s_waitcnt vmcnt(0) lgkmcnt(0)
Lr2f_step:
    s_waitcnt vmcnt(3)
    v_max3_u32 v10, v36, v37, v38
    v_max_u32 v10, v10, v39
    v_cmp_eq_u32 vcc, -1, v10
    s_nop 0
    s_cbranch_vccz Lr2f_aok
    buffer_load_dwordx4 v[36:39], v0, s[8:11], s34 offen sc1
    s_waitcnt vmcnt(1)
    v_max3_u32 v10, v36, v37, v38
    v_max_u32 v10, v10, v39
    v_cmp_eq_u32 vcc, -1, v10
    s_nop 0
    s_cbranch_vccz Lr2f_aok
    s_mov_b32 s16, 0
Lr2f_alp:
    buffer_load_dwordx4 v[36:39], v0, s[8:11], s34 offen sc1
    s_add_u32 s16, s16, 1
    s_cmp_gt_u32 s16, 100000
    s_cbranch_scc1 Lr_abort
    s_waitcnt vmcnt(1)
    v_max3_u32 v10, v36, v37, v38
    v_max_u32 v10, v10, v39
    v_cmp_eq_u32 vcc, -1, v10
    s_nop 0
    s_cbranch_vccnz Lr2f_alp
Lr2f_aok:
    ds_write_b128 v0, v[36:39] offset:8960
    v_smfmac_f32_16x16x64_bf16 v[12:15], v[36:39], v[104:111], v1
    v_smfmac_f32_16x16x64_bf16 v[16:19], v[36:39], v[112:119], v1
    v_smfmac_f32_16x16x64_bf16 v[20:23], v[36:39], v[216:223], v1
    s_waitcnt lgkmcnt(0)
    s_barrier
    ds_read_b128 v[48:51], v0 offset:9984
    ds_read_b128 v[52:55], v0 offset:6912
    v_smfmac_f32_16x16x64_bf16 v[28:31], v[36:39], v[56:63], v1
    ds_read_b128 v[56:59], v8 offset:0
    ds_read_b128 v[60:63], v8 offset:1024
    v_smfmac_f32_16x16x64_bf16 v[24:27], v[36:39], v[224:231], v1
    v_smfmac_f32_16x16x64_bf16 v[32:35], v[36:39], v[64:71], v1
    ds_read_b128 v[64:67], v8 offset:2048
    ds_read_b128 v[68:71], v8 offset:3072
    s_add_u32 s17, s34, 4096
    buffer_load_dwordx4 v[40:43], v0, s[8:11], s17 offen sc1
    s_waitcnt vmcnt(1)
    ds_read_b128 v[36:39], v0 offset:7936
    s_waitcnt lgkmcnt(6)
    v_smfmac_f32_16x16x64_bf16 v[28:31], v[48:51], a[88:95], v1
    v_smfmac_f32_16x16x64_bf16 v[12:15], v[48:51], v[120:127], v1
    v_smfmac_f32_16x16x64_bf16 v[16:19], v[48:51], v[128:135], v1
    v_smfmac_f32_16x16x64_bf16 v[32:35], v[48:51], a[96:103], v1
    buffer_load_dwordx4 v[44:47], v0, s[8:11], s35 offen sc1
    v_smfmac_f32_16x16x64_bf16 v[20:23], v[48:51], v[232:239], v1
    v_lshrrev_b32 v10, 2, v0
    v_and_b32 v9, 16, v10
    v_lshlrev_b32 v9, 3, v9
    v_and_or_b32 v10, v10, 12, v9
    s_add_u32 s17, s66, 22656
    buffer_load_dword v11, v10, s[8:11], s17 offen sc1
    v_smfmac_f32_16x16x64_bf16 v[24:27], v[48:51], v[240:247], v1
    s_waitcnt lgkmcnt(3)
    v_smfmac_f32_16x16x64_bf16 v[28:31], v[52:55], v[56:63], v1
    ds_read_b128 v[56:59], v8 offset:12288
    ds_read_b128 v[60:63], v8 offset:13312
    v_smfmac_f32_16x16x64_bf16 v[12:15], v[52:55], v[72:79], v1
    v_smfmac_f32_16x16x64_bf16 v[16:19], v[52:55], v[80:87], v1
    s_waitcnt lgkmcnt(3)
    v_smfmac_f32_16x16x64_bf16 v[32:35], v[52:55], v[64:71], v1
    ds_read_b128 v[64:67], v8 offset:14336
    ds_read_b128 v[68:71], v8 offset:15360
    v_smfmac_f32_16x16x64_bf16 v[20:23], v[52:55], v[184:191], v1
    v_smfmac_f32_16x16x64_bf16 v[24:27], v[52:55], v[192:199], v1
    s_waitcnt lgkmcnt(4)
    v_smfmac_f32_16x16x64_bf16 v[28:31], v[36:39], a[72:79], v1
    v_smfmac_f32_16x16x64_bf16 v[12:15], v[36:39], v[88:95], v1
    v_smfmac_f32_16x16x64_bf16 v[16:19], v[36:39], v[96:103], v1
    v_smfmac_f32_16x16x64_bf16 v[32:35], v[36:39], a[80:87], v1
    v_smfmac_f32_16x16x64_bf16 v[20:23], v[36:39], v[200:207], v1
    v_smfmac_f32_16x16x64_bf16 v[24:27], v[36:39], v[208:215], v1
    s_waitcnt vmcnt(2)
    v_max3_u32 v10, v40, v41, v42
    v_max_u32 v10, v10, v43
    v_cmp_eq_u32 vcc, -1, v10
    s_nop 0
    s_cbranch_vccnz Lr2f_pb_re
Lr2f_pb_ok:
    ds_write_b128 v0, v[40:43] offset:13056
    s_waitcnt lgkmcnt(3)
    v_smfmac_f32_16x16x64_bf16 v[12:15], v[40:43], v[56:63], v1
    ds_read_b128 v[56:59], v8 offset:8192
    ds_read_b128 v[60:63], v8 offset:9216
    v_smfmac_f32_16x16x64_bf16 v[20:23], v[40:43], a[24:31], v1
    s_waitcnt lgkmcnt(3)
    v_smfmac_f32_16x16x64_bf16 v[16:19], v[40:43], v[64:71], v1
    ds_read_b128 v[64:67], v8 offset:10240
    ds_read_b128 v[68:71], v8 offset:11264
    v_smfmac_f32_16x16x64_bf16 v[24:27], v[40:43], a[32:39], v1
    s_waitcnt lgkmcnt(4)
    s_barrier
    ds_read_b128 v[48:51], v0 offset:11008
    ds_read_b128 v[52:55], v0 offset:14080
    ds_read_b128 v[36:39], v0 offset:12032
    v_smfmac_f32_16x16x64_bf16 v[28:31], v[40:43], a[136:143], v1
    v_smfmac_f32_16x16x64_bf16 v[32:35], v[40:43], a[144:151], v1
    s_waitcnt lgkmcnt(2)
    v_smfmac_f32_16x16x64_bf16 v[12:15], v[48:51], v[56:63], v1
    v_smfmac_f32_16x16x64_bf16 v[16:19], v[48:51], v[64:71], v1
    s_waitcnt lgkmcnt(1)
    v_smfmac_f32_16x16x64_bf16 v[12:15], v[52:55], v[152:159], v1
    v_smfmac_f32_16x16x64_bf16 v[16:19], v[52:55], v[160:167], v1
    s_waitcnt lgkmcnt(0)
    v_smfmac_f32_16x16x64_bf16 v[12:15], v[36:39], v[136:143], v1
    v_smfmac_f32_16x16x64_bf16 v[16:19], v[36:39], v[144:151], v1
    s_waitcnt vmcnt(1)
    v_max3_u32 v10, v44, v45, v46
    v_max_u32 v10, v10, v47
    v_cmp_eq_u32 vcc, -1, v10
    s_nop 0
    s_cbranch_vccnz Lr2f_pc_re
Lr2f_pc_ok:
    v_smfmac_f32_16x16x64_bf16 v[12:15], v[44:47], v[168:175], v1
    v_smfmac_f32_16x16x64_bf16 v[16:19], v[44:47], v[176:183], v1
    v_smfmac_f32_16x16x64_bf16 v[20:23], v[48:51], v[248:255], v1
    v_smfmac_f32_16x16x64_bf16 v[24:27], v[48:51], a[0:7], v1
    v_smfmac_f32_16x16x64_bf16 v[20:23], v[52:55], a[40:47], v1
    v_add_f32 v12, v12, v14
    buffer_load_dwordx4 v[64:67], v0, s[8:11], s42 offen
    v_smfmac_f32_16x16x64_bf16 v[24:27], v[52:55], a[48:55], v1
    v_add_f32 v16, v16, v18
    v_smfmac_f32_16x16x64_bf16 v[20:23], v[36:39], a[8:15], v1
    v_add_f32 v13, v13, v15
    v_smfmac_f32_16x16x64_bf16 v[24:27], v[36:39], a[16:23], v1
    v_add_f32 v17, v17, v19
    v_smfmac_f32_16x16x64_bf16 v[20:23], v[44:47], a[56:63], v1
    v_cvt_pk_bf16_f32 v14, v12, v16
    ds_read_b128 v[56:59], v0 offset:15104
    buffer_load_dwordx4 v[68:71], v0, s[8:11], s42 offen offset:1024
    v_smfmac_f32_16x16x64_bf16 v[24:27], v[44:47], a[64:71], v1
    v_cvt_pk_bf16_f32 v15, v13, v17
    ds_read_b128 v[60:63], v0 offset:16128
    ds_write_b32 v2, v14 offset:576
    ds_write_b32 v2, v15 offset:864
    v_smfmac_f32_16x16x64_bf16 v[28:31], v[48:51], a[104:111], v1
    v_smfmac_f32_16x16x64_bf16 v[32:35], v[48:51], a[112:119], v1
    v_add_f32 v20, v20, v22
    v_add_f32 v24, v24, v26
    v_add_f32 v21, v21, v23
    v_add_f32 v25, v25, v27
    v_cvt_pk_bf16_f32 v22, v20, v24
    v_cvt_pk_bf16_f32 v23, v21, v25
    ds_write_b32 v2, v22 offset:0
    ds_write_b32 v2, v23 offset:288
    v_smfmac_f32_16x16x64_bf16 v[28:31], v[52:55], a[152:159], v1
    v_smfmac_f32_16x16x64_bf16 v[32:35], v[52:55], a[160:167], v1
    s_waitcnt vmcnt(2)
    v_cmp_eq_u32 vcc, 0, v11
    s_nop 0
    s_cbranch_vccnz Lr2f_flbad
Lr2f_flok:
    s_waitcnt lgkmcnt(0)
    s_barrier
    ds_read_b128 v[40:43], v3 offset:0
    ds_read_b128 v[48:51], v3 offset:64
    ds_read_b128 v[20:23], v3 offset:128
    ds_read_b128 v[52:55], v3 offset:192
    v_smfmac_f32_16x16x64_bf16 v[28:31], v[36:39], a[120:127], v1
    v_smfmac_f32_16x16x64_bf16 v[32:35], v[36:39], a[128:135], v1
    ds_read_b128 v[36:39], v0 offset:17152
    v_smfmac_f32_16x16x64_bf16 v[28:31], v[44:47], a[168:175], v1
    v_smfmac_f32_16x16x64_bf16 v[32:35], v[44:47], a[176:183], v1
    ds_read_b128 v[44:47], v0 offset:18176
    s_waitcnt lgkmcnt(5)
    v_mfma_f32_16x16x32_bf16 v[12:15], v[56:59], v[40:43], 0
    v_mfma_f32_16x16x32_bf16 v[16:19], v[60:63], v[40:43], 0
    v_mfma_f32_16x16x32_bf16 v[24:27], v[40:43], v[40:43], 0
    ds_read_b128 v[56:59], v0 offset:19200
    ds_read_b128 v[60:63], v0 offset:20224
    s_waitcnt lgkmcnt(3)
    v_mfma_f32_16x16x32_bf16 v[12:15], v[36:39], v[48:51], v[12:15]
    v_lshrrev_b32 v10, 1, v0
    v_lshrrev_b32 v9, 9, v0
    s_waitcnt lgkmcnt(2)
    v_mfma_f32_16x16x32_bf16 v[16:19], v[44:47], v[48:51], v[16:19]
    v_lshl_add_u32 v9, v9, 5, v10
    v_add_f32 v28, v28, v30
    v_mfma_f32_16x16x32_bf16 v[24:27], v[48:51], v[48:51], v[24:27]
    v_add_f32 v32, v32, v34
    v_add_f32 v29, v29, v31
    ds_read_b128 v[36:39], v0 offset:21248
    ds_read_b128 v[44:47], v0 offset:22272
    s_waitcnt lgkmcnt(3)
    v_mfma_f32_16x16x32_bf16 v[12:15], v[56:59], v[20:23], v[12:15]
    v_add_f32 v33, v33, v35
    v_cvt_pk_bf16_f32 v30, v28, v29
    s_waitcnt lgkmcnt(2)
    v_mfma_f32_16x16x32_bf16 v[16:19], v[60:63], v[20:23], v[16:19]
    v_cvt_pk_bf16_f32 v31, v32, v33
    ds_read_b64 v[34:35], v9 offset:2304
    v_mfma_f32_16x16x32_bf16 v[24:27], v[20:23], v[20:23], v[24:27]
    s_add_u32 s17, s43, 3072
    buffer_store_dwordx2 v[30:31], v10, s[8:11], s17 offen sc1
    s_waitcnt lgkmcnt(2)
    v_mfma_f32_16x16x32_bf16 v[12:15], v[36:39], v[52:55], v[12:15]
    s_waitcnt lgkmcnt(1)
    v_mfma_f32_16x16x32_bf16 v[16:19], v[44:47], v[52:55], v[16:19]
    v_mfma_f32_16x16x32_bf16 v[24:27], v[52:55], v[52:55], v[24:27]
    s_add_u32 s17, s43, 1024
    s_waitcnt lgkmcnt(0)
    buffer_store_dwordx2 v[34:35], v10, s[8:11], s17 offen sc1
    ds_read_b128 v[56:59], v8 offset:16384
    ds_read_b128 v[60:63], v8 offset:17408
    v_mov_b64 v[20:21], s[52:53]
    v_mov_b64 v[22:23], s[52:53]
    v_mov_b32 v41, 0
    v_mov_b32 v42, 0
    v_max3_f32 v9, v12, v13, v14
    v_max3_f32 v9, v9, v15, v16
    v_max3_f32 v9, v9, v17, v18
    v_max3_f32 v9, v9, v19, v24
    v_max_f32 v9, v9, v25
    v_mov_b32 v10, v9
    v_mov_b64 v[32:33], 0
    v_mov_b64 v[34:35], 0
    v_permlane32_swap_b32 v9, v10
    v_max_f32 v9, v9, v10
    v_mov_b32 v10, v9
    s_nop 1
    v_permlane16_swap_b32 v9, v10
    v_max_f32 v9, v9, v10
    v_mul_f32 v28, s44, v9
    v_fma_f32 v12, v12, s44, -v28
    v_fma_f32 v13, v13, s44, -v28
    v_fma_f32 v14, v14, s44, -v28
    v_fma_f32 v15, v15, s44, -v28
    v_exp_f32 v12, v12
    v_exp_f32 v13, v13
    v_fma_f32 v16, v16, s44, -v28
    v_fma_f32 v17, v17, s44, -v28
    v_exp_f32 v14, v14
    v_exp_f32 v15, v15
    v_cvt_pk_bf16_f32 v36, v12, v13
    v_fma_f32 v18, v18, s44, -v28
    v_fma_f32 v19, v19, s44, -v28
    v_exp_f32 v16, v16
    v_exp_f32 v17, v17
    v_cvt_pk_bf16_f32 v37, v14, v15
    v_fma_f32 v24, v24, s44, -v28
    v_fma_f32 v25, v25, s44, -v28
    v_exp_f32 v18, v18
    v_exp_f32 v19, v19
    v_cvt_pk_bf16_f32 v38, v16, v17
    v_exp_f32 v24, v24
    v_exp_f32 v25, v25
    v_cvt_pk_bf16_f32 v39, v18, v19
    v_cvt_pk_bf16_f32 v40, v24, v25
    v_cvt_pk_bf16_f32 v43, v24, v25
    v_mfma_f32_16x16x32_bf16 v[52:55], v[20:23], v[36:39], 0
    v_mov_b64 v[12:13], 0
    v_mov_b64 v[14:15], 0
    s_waitcnt vmcnt(3)
    v_mfma_f32_16x16x32_bf16 v[44:47], v[64:67], v[36:39], 0
    v_mov_b64 v[24:25], 0
    v_mov_b64 v[26:27], 0
    s_waitcnt vmcnt(2)
    v_mfma_f32_16x16x32_bf16 v[48:51], v[68:71], v[36:39], 0
    ds_read_b128 v[64:67], v8 offset:20480
    ds_read_b128 v[68:71], v8 offset:21504
    v_mfma_f32_16x16x16_bf16 v[52:55], v[20:21], v[40:41], v[52:55]
    v_mfma_f32_16x16x16_bf16 v[44:47], v[30:31], v[40:41], v[44:47]
    v_mov_b64 v[20:21], 0
    v_mov_b64 v[22:23], 0
    v_mfma_f32_16x16x16_bf16 v[48:51], v[30:31], v[42:43], v[48:51]
    v_mov_b64 v[36:37], 0
    v_mov_b64 v[38:39], 0
    v_mov_b64 v[40:41], 0
    v_mov_b64 v[42:43], 0
    v_rcp_f32 v9, v52
    v_mov_b64 v[52:53], 0
    v_mov_b64 v[54:55], 0
    v_mul_f32 v44, v9, v44
    v_mul_f32 v48, v9, v48
    v_cvt_pk_bf16_f32 v16, v44, v48
    v_mul_f32 v45, v9, v45
    v_mul_f32 v49, v9, v49
    v_cvt_pk_bf16_f32 v17, v45, v49
    v_mul_f32 v46, v9, v46
    v_mul_f32 v50, v9, v50
    v_cvt_pk_bf16_f32 v18, v46, v50
    v_mul_f32 v47, v9, v47
    v_mul_f32 v51, v9, v51
    v_cvt_pk_bf16_f32 v19, v47, v51
    ds_write_b128 v5, v[16:19]
    v_mov_b64 v[28:29], 0
    v_mov_b64 v[30:31], 0
    s_waitcnt lgkmcnt(0)
    s_barrier
    ds_read_b128 v[44:47], v4 offset:0
    ds_read_b128 v[48:51], v4 offset:128
    s_cmp_eq_u32 s33, 63
    s_cbranch_scc1 Lr2f_last
    v_mov_b64 v[16:17], 0
    v_mov_b64 v[18:19], 0
    buffer_load_dwordx4 v0, s[8:11], s41 offen offset:0 lds
    buffer_load_dwordx4 v0, s[8:11], s41 offen offset:1024 lds
    s_waitcnt lgkmcnt(1)
    v_smfmac_f32_16x16x64_bf16 v[12:15], v[44:47], a[184:191], v1
    s_waitcnt lgkmcnt(0)
    v_smfmac_f32_16x16x64_bf16 v[12:15], v[48:51], a[192:199], v1
    v_smfmac_f32_16x16x64_bf16 v[24:27], v[44:47], a[200:207], v1
    v_smfmac_f32_16x16x64_bf16 v[24:27], v[48:51], a[208:215], v1
    v_add_f32 v12, v12, v14
    v_smfmac_f32_16x16x64_bf16 v[20:23], v[44:47], a[216:223], v1
    v_add_f32 v13, v13, v15
    v_smfmac_f32_16x16x64_bf16 v[20:23], v[48:51], a[224:231], v1
    v_cvt_pk_bf16_f32 v12, v12, v13
    v_smfmac_f32_16x16x64_bf16 v[16:19], v[44:47], a[232:239], v1
    v_add_f32 v24, v24, v26
    v_smfmac_f32_16x16x64_bf16 v[16:19], v[48:51], a[240:247], v1
    v_add_f32 v25, v25, v27
    v_smfmac_f32_16x16x64_bf16 v[36:39], v[44:47], v[56:63], v1
    v_cvt_pk_bf16_f32 v13, v24, v25
    v_smfmac_f32_16x16x64_bf16 v[36:39], v[48:51], v[64:71], v1
    v_add_f32 v20, v20, v22
    v_add_f32 v21, v21, v23
    v_cvt_pk_bf16_f32 v14, v20, v21
    v_add_f32 v16, v16, v18
    v_add_f32 v17, v17, v19
    v_cvt_pk_bf16_f32 v15, v16, v17
    v_and_or_b32 v15, v15, -2, s40
    buffer_store_dwordx4 v[12:15], v0, s[8:11], s38 offen
    s_nop 0
    ds_read_b128 v[12:15], v8 offset:18432
    ds_read_b128 v[16:19], v8 offset:19456
    ds_read_b128 v[20:23], v8 offset:22528
    ds_read_b128 v[24:27], v8 offset:23552
    ds_read_b128 v[56:59], v8 offset:24576
    ds_read_b128 v[60:63], v8 offset:25600
    ds_read_b128 v[64:67], v8 offset:28672
    ds_read_b128 v[68:71], v8 offset:29696
    s_waitcnt lgkmcnt(6)
    v_smfmac_f32_16x16x64_bf16 v[40:43], v[44:47], v[12:19], v1
    ds_read_b128 v[12:15], v8 offset:26624
    ds_read_b128 v[16:19], v8 offset:27648
    s_waitcnt lgkmcnt(6)
    v_smfmac_f32_16x16x64_bf16 v[40:43], v[48:51], v[20:27], v1
    ds_read_b128 v[20:23], v8 offset:30720
    ds_read_b128 v[24:27], v8 offset:31744
    s_waitcnt lgkmcnt(6)
    v_smfmac_f32_16x16x64_bf16 v[52:55], v[44:47], v[56:63], v1
    ds_read_b128 v[56:59], v8 offset:32768
    ds_read_b128 v[60:63], v8 offset:33792
    s_waitcnt lgkmcnt(6)
    v_smfmac_f32_16x16x64_bf16 v[52:55], v[48:51], v[64:71], v1
    s_waitcnt lgkmcnt(4)
    v_smfmac_f32_16x16x64_bf16 v[32:35], v[44:47], v[12:19], v1
    s_waitcnt lgkmcnt(2)
    v_smfmac_f32_16x16x64_bf16 v[32:35], v[48:51], v[20:27], v1
    v_smfmac_f32_16x16x64_bf16 v[28:31], v[44:47], a[248:255], v1
    s_waitcnt lgkmcnt(0)
    v_smfmac_f32_16x16x64_bf16 v[28:31], v[48:51], v[56:63], v1
    v_add_f32 v36, v36, v38
    v_add_f32 v37, v37, v39
    v_cvt_pk_bf16_f32 v36, v36, v37
    v_add_f32 v40, v40, v42
    v_add_f32 v41, v41, v43
    v_cvt_pk_bf16_f32 v37, v40, v41
    v_add_f32 v52, v52, v54
    v_add_f32 v53, v53, v55
    v_cvt_pk_bf16_f32 v38, v52, v53
    v_add_f32 v32, v32, v34
    v_add_f32 v33, v33, v35
    v_cvt_pk_bf16_f32 v39, v32, v33
    v_and_or_b32 v39, v39, -2, s40
    s_add_u32 s17, s38, 4096
    buffer_store_dwordx4 v[36:39], v0, s[8:11], s17 offen
    v_add_f32 v28, v28, v30
    v_add_f32 v29, v29, v31
    v_cvt_pk_bf16_f32 v28, v28, v29
    v_and_or_b32 v28, v28, -2, s40
    v_lshrrev_b32 v9, 2, v0
    buffer_store_dword v28, v9, s[8:11], s39 offen
    v_add_u32 v10, 162560, v0
    ds_read_b32 v64, v10
    v_mov_b32 v65, 0
    v_mov_b32 v41, 0
    v_mov_b32 v45, 0
    v_mov_b32 v49, 0
    v_mov_b32 v53, 0
    s_add_u32 s33, s33, 1
    s_add_u32 s42, s42, 262144
    s_add_u32 s41, s41, 262144
    s_add_u32 s43, s43, 131072
    s_add_u32 s68, s68, 262144
    s_add_u32 s66, s66, 22528
    ds_read_b128 v[56:59], v8 offset:4096
    ds_read_b128 v[60:63], v8 offset:5120
    v_mov_b64 v[12:13], 0
    v_mov_b64 v[14:15], 0
    v_mov_b64 v[16:17], 0
    v_mov_b64 v[18:19], 0
    v_mov_b64 v[20:21], 0
    v_mov_b64 v[22:23], 0
    v_mov_b64 v[24:25], 0
    v_mov_b64 v[26:27], 0
    v_mov_b64 v[28:29], 0
    v_mov_b64 v[30:31], 0
    v_mov_b64 v[32:33], 0
    v_mov_b64 v[34:35], 0
    s_nop 15
    s_nop 15
    s_nop 15
    s_nop 1
    buffer_load_dword v40, v6, s[8:11], s62 offen sc1
    buffer_load_dword v44, v6, s[8:11], s63 offen sc1
    buffer_load_dword v48, v6, s[8:11], s64 offen sc1
    buffer_load_dword v52, v6, s[8:11], s65 offen sc1
    s_waitcnt lgkmcnt(0)
    s_waitcnt vmcnt(3)
    v_mfma_f32_16x16x16_bf16 v[68:71], v[40:41], v[64:65], 0
    v_and_b32 v10, 1, v40
    v_cmp_ne_u32 s[54:55], s40, v10
    s_waitcnt vmcnt(2)
    v_mfma_f32_16x16x16_bf16 v[68:71], v[44:45], v[64:65], v[68:71]
    v_and_b32 v10, 1, v44
    v_cmp_ne_u32 s[56:57], s40, v10
    s_waitcnt vmcnt(1)
    v_mfma_f32_16x16x16_bf16 v[68:71], v[48:49], v[64:65], v[68:71]
    v_and_b32 v10, 1, v48
    v_cmp_ne_u32 s[58:59], s40, v10
    s_waitcnt vmcnt(0)
    v_mfma_f32_16x16x16_bf16 v[68:71], v[52:53], v[64:65], v[68:71]
    v_and_b32 v10, 1, v52
    v_cmp_ne_u32 s[60:61], s40, v10
    s_or_b64 vcc, s[54:55], s[56:57]
    s_or_b64 vcc, vcc, s[58:59]
    s_or_b64 vcc, vcc, s[60:61]
    s_cbranch_scc0 Lr2f_red
    s_mov_b32 s16, 0
Lr2f_p1:
    s_mov_b64 exec, s[54:55]
    buffer_load_dword v40, v6, s[8:11], s62 offen sc1
    s_mov_b64 exec, s[56:57]
    buffer_load_dword v44, v6, s[8:11], s63 offen sc1
    s_mov_b64 exec, s[58:59]
    buffer_load_dword v48, v6, s[8:11], s64 offen sc1
    s_mov_b64 exec, s[60:61]
    buffer_load_dword v52, v6, s[8:11], s65 offen sc1
    s_mov_b64 exec, -1
    s_add_u32 s16, s16, 1
    s_cmp_gt_u32 s16, 100000
    s_cbranch_scc1 Lr_abort
    s_waitcnt vmcnt(3)
    v_mfma_f32_16x16x16_bf16 v[68:71], v[40:41], v[64:65], 0
    v_and_b32 v10, 1, v40
    v_cmp_ne_u32 s[54:55], s40, v10
    s_waitcnt vmcnt(2)
    v_mfma_f32_16x16x16_bf16 v[68:71], v[44:45], v[64:65], v[68:71]
    v_and_b32 v10, 1, v44
    v_cmp_ne_u32 s[56:57], s40, v10
    s_waitcnt vmcnt(1)
    v_mfma_f32_16x16x16_bf16 v[68:71], v[48:49], v[64:65], v[68:71]
    v_and_b32 v10, 1, v48
    v_cmp_ne_u32 s[58:59], s40, v10
    s_waitcnt vmcnt(0)
    v_mfma_f32_16x16x16_bf16 v[68:71], v[52:53], v[64:65], v[68:71]
    v_and_b32 v10, 1, v52
    v_cmp_ne_u32 s[60:61], s40, v10
    s_or_b64 vcc, s[54:55], s[56:57]
    s_or_b64 vcc, vcc, s[58:59]
    s_or_b64 vcc, vcc, s[60:61]
    s_cbranch_scc1 Lr2f_p1
Lr2f_red:
    s_xor_b32 s34, s34, 16384
    s_xor_b32 s35, s35, 16384
    buffer_load_dwordx4 v[36:39], v0, s[8:11], s34 offen sc1
    v_permlane16_swap_b32 v68, v70
    v_permlane16_swap_b32 v69, v71
    s_mov_b64 exec, s[46:47]
    v_add_f32 v68, v68, v70
    v_add_f32 v69, v69, v71
    v_cvt_pk_bf16_f32 v68, v68, v69
    v_min_u32 v68, s50, v68
    buffer_store_dword v68, v7, s[8:11], s36 offen
    v_mov_b32 v69, -1
    buffer_store_dword v69, v7, s[8:11], s37 offen
    s_mov_b64 exec, -1
    buffer_load_dwordx4 v[36:39], v0, s[8:11], s34 offen sc1
    s_xor_b32 s40, s40, 1
    s_xor_b32 s36, s36, 16384
    s_xor_b32 s37, s37, 16384
    ds_read_b128 v[64:67], v8 offset:6144
    ds_read_b128 v[68:71], v8 offset:7168
    s_waitcnt lgkmcnt(0)
    s_branch Lr2f_step
Lr2f_pb_re:
    s_mov_b32 s16, 0
Lr2f_pb_lp:
    s_add_u32 s17, s34, 4096
    buffer_load_dwordx4 v[40:43], v0, s[8:11], s17 offen sc1
    s_add_u32 s16, s16, 1
    s_cmp_gt_u32 s16, 100000
    s_cbranch_scc1 Lr_abort
    s_waitcnt vmcnt(0)
    v_max3_u32 v10, v40, v41, v42
    v_max_u32 v10, v10, v43
    v_cmp_eq_u32 vcc, -1, v10
    s_nop 0
    s_cbranch_vccnz Lr2f_pb_lp
    s_branch Lr2f_pb_ok
Lr2f_pc_re:
    s_mov_b32 s16, 0
Lr2f_pc_lp:
    buffer_load_dwordx4 v[44:47], v0, s[8:11], s35 offen sc1
    s_add_u32 s16, s16, 1
    s_cmp_gt_u32 s16, 100000
    s_cbranch_scc1 Lr_abort
    s_waitcnt vmcnt(0)
    v_max3_u32 v10, v44, v45, v46
    v_max_u32 v10, v10, v47
    v_cmp_eq_u32 vcc, -1, v10
    s_nop 0
    s_cbranch_vccnz Lr2f_pc_lp
    s_branch Lr2f_pc_ok
Lr2f_flbad:
    s_cmp_eq_u32 s33, 63
    s_cbranch_scc1 Lr2f_flok
    s_mov_b32 s16, 0
    s_add_u32 s17, s66, 22656
    v_lshrrev_b32 v10, 2, v0
    v_and_b32 v9, 16, v10
    v_lshlrev_b32 v9, 3, v9
    v_and_or_b32 v10, v10, 12, v9
Lr2f_fw_25:
    buffer_load_dword v9, v10, s[8:11], s17 offen sc1
    s_add_u32 s16, s16, 1
    s_cmp_gt_u32 s16, 100000
    s_cbranch_scc1 Lr_abort
    s_waitcnt vmcnt(0)
    v_cmp_eq_u32 vcc, 0, v9
    s_nop 0
    s_cbranch_vccnz Lr2f_fw_25
    s_branch Lr2f_flok
Lr2f_last:
    s_waitcnt vmcnt(0) lgkmcnt(0)
    s_barrier
    s_branch Lr_exit
L_w3_1:
    s_mov_b32 s16, 0
    s_add_u32 s17, s66, 128
    v_lshrrev_b32 v10, 2, v0
    v_and_b32 v9, 16, v10
    v_lshlrev_b32 v9, 3, v9
    v_and_or_b32 v10, v10, 12, v9
Lr3f_fw_26:
    buffer_load_dword v9, v10, s[8:11], s17 offen sc1
    s_add_u32 s16, s16, 1
    s_cmp_gt_u32 s16, 100000
    s_cbranch_scc1 Lr_abort
    s_waitcnt vmcnt(0)
    v_cmp_eq_u32 vcc, 0, v9
    s_nop 0
    s_cbranch_vccnz Lr3f_fw_26
    s_mov_b32 m0, 21248
    s_nop 0
    buffer_load_dwordx4 v0, s[8:11], s41 offen offset:0 lds
    buffer_load_dwordx4 v0, s[8:11], s41 offen offset:1024 lds
    s_add_u32 s41, s41, 262144
    s_add_u32 s68, s68, 262144
    s_waitcnt vmcnt(0)
    ds_read_b128 v[56:59], v8 offset:0
    ds_read_b128 v[60:63], v8 offset:1024
    ds_read_b128 v[64:67], v8 offset:2048
    ds_read_b128 v[68:71], v8 offset:3072
    v_mov_b64 v[12:13], 0
    v_mov_b64 v[14:15], 0
    v_mov_b64 v[16:17], 0
    v_mov_b64 v[18:19], 0
    v_mov_b64 v[20:21], 0
    v_mov_b64 v[22:23], 0
    v_mov_b64 v[24:25], 0
    v_mov_b64 v[26:27], 0
    v_mov_b64 v[28:29], 0
    v_mov_b64 v[30:31], 0
    v_mov_b64 v[32:33], 0
    v_mov_b64 v[34:35], 0
    buffer_load_dwordx4 v[36:39], v0, s[8:11], s34 offen sc1
    s_waitcnt vmcnt(0) lgkmcnt(0)
Lr3f_step:
    s_waitcnt vmcnt(2)
    v_max3_u32 v10, v36, v37, v38
    v_max_u32 v10, v10, v39
    v_cmp_eq_u32 vcc, -1, v10
    s_nop 0
    s_cbranch_vccz Lr3f_aok
    s_waitcnt vmcnt(1)
    v_max3_u32 v10, v36, v37, v38
    v_max_u32 v10, v10, v39
    v_cmp_eq_u32 vcc, -1, v10
    s_nop 0
    s_cbranch_vccz Lr3f_aok
    s_mov_b32 s16, 0
Lr3f_alp:
    buffer_load_dwordx4 v[36:39], v0, s[8:11], s34 offen sc1
    s_add_u32 s16, s16, 1
    s_cmp_gt_u32 s16, 100000
    s_cbranch_scc1 Lr_abort
    s_waitcnt vmcnt(1)
    v_max3_u32 v10, v36, v37, v38
    v_max_u32 v10, v10, v39
    v_cmp_eq_u32 vcc, -1, v10
    s_nop 0
    s_cbranch_vccnz Lr3f_alp
Lr3f_aok:
    ds_write_b128 v0, v[36:39] offset:9984
    v_smfmac_f32_16x16x64_bf16 v[12:15], v[36:39], v[120:127], v1
    v_smfmac_f32_16x16x64_bf16 v[16:19], v[36:39], v[128:135], v1
    v_smfmac_f32_16x16x64_bf16 v[20:23], v[36:39], v[232:239], v1
    s_waitcnt lgkmcnt(0)
    s_barrier
    ds_read_b128 v[48:51], v0 offset:6912
    ds_read_b128 v[52:55], v0 offset:7936
    v_smfmac_f32_16x16x64_bf16 v[28:31], v[36:39], a[88:95], v1
    v_smfmac_f32_16x16x64_bf16 v[24:27], v[36:39], v[240:247], v1
    v_smfmac_f32_16x16x64_bf16 v[32:35], v[36:39], a[96:103], v1
    s_waitcnt vmcnt(0)
    ds_read_b128 v[36:39], v0 offset:8960
    s_waitcnt lgkmcnt(2)
    v_smfmac_f32_16x16x64_bf16 v[28:31], v[48:51], v[56:63], v1
    ds_read_b128 v[56:59], v8 offset:4096
    ds_read_b128 v[60:63], v8 offset:5120
    s_add_u32 s17, s34, 4096
    buffer_load_dwordx4 v[40:43], v0, s[8:11], s17 offen sc1
    v_smfmac_f32_16x16x64_bf16 v[12:15], v[48:51], v[72:79], v1
    v_smfmac_f32_16x16x64_bf16 v[16:19], v[48:51], v[80:87], v1
    v_smfmac_f32_16x16x64_bf16 v[32:35], v[48:51], v[64:71], v1
    ds_read_b128 v[64:67], v8 offset:6144
    ds_read_b128 v[68:71], v8 offset:7168
    v_smfmac_f32_16x16x64_bf16 v[20:23], v[48:51], v[184:191], v1
    buffer_load_dwordx4 v[44:47], v0, s[8:11], s35 offen sc1
    v_smfmac_f32_16x16x64_bf16 v[24:27], v[48:51], v[192:199], v1
    s_waitcnt lgkmcnt(5)
    v_smfmac_f32_16x16x64_bf16 v[28:31], v[52:55], a[72:79], v1
    v_smfmac_f32_16x16x64_bf16 v[12:15], v[52:55], v[88:95], v1
    v_smfmac_f32_16x16x64_bf16 v[16:19], v[52:55], v[96:103], v1
    v_smfmac_f32_16x16x64_bf16 v[32:35], v[52:55], a[80:87], v1
    v_smfmac_f32_16x16x64_bf16 v[20:23], v[52:55], v[200:207], v1
    v_smfmac_f32_16x16x64_bf16 v[24:27], v[52:55], v[208:215], v1
    s_waitcnt lgkmcnt(2)
    v_smfmac_f32_16x16x64_bf16 v[28:31], v[36:39], v[56:63], v1
    ds_read_b128 v[56:59], v8 offset:8192
    ds_read_b128 v[60:63], v8 offset:9216
    v_smfmac_f32_16x16x64_bf16 v[12:15], v[36:39], v[104:111], v1
    v_smfmac_f32_16x16x64_bf16 v[16:19], v[36:39], v[112:119], v1
    s_waitcnt lgkmcnt(2)
    v_smfmac_f32_16x16x64_bf16 v[32:35], v[36:39], v[64:71], v1
    ds_read_b128 v[64:67], v8 offset:10240
    ds_read_b128 v[68:71], v8 offset:11264
    v_smfmac_f32_16x16x64_bf16 v[20:23], v[36:39], v[216:223], v1
    v_smfmac_f32_16x16x64_bf16 v[24:27], v[36:39], v[224:231], v1
    s_waitcnt vmcnt(1)
    v_max3_u32 v10, v40, v41, v42
    v_max_u32 v10, v10, v43
    v_cmp_eq_u32 vcc, -1, v10
    s_nop 0
    s_cbranch_vccnz Lr3f_pb_re
Lr3f_pb_ok:
    ds_write_b128 v0, v[40:43] offset:14080
    v_smfmac_f32_16x16x64_bf16 v[12:15], v[40:43], v[152:159], v1
    v_smfmac_f32_16x16x64_bf16 v[20:23], v[40:43], a[40:47], v1
    v_smfmac_f32_16x16x64_bf16 v[16:19], v[40:43], v[160:167], v1
    v_smfmac_f32_16x16x64_bf16 v[24:27], v[40:43], a[48:55], v1
    s_waitcnt lgkmcnt(0)
    s_barrier
    ds_read_b128 v[48:51], v0 offset:11008
    ds_read_b128 v[52:55], v0 offset:12032
    ds_read_b128 v[36:39], v0 offset:13056
    v_smfmac_f32_16x16x64_bf16 v[28:31], v[40:43], a[152:159], v1
    v_smfmac_f32_16x16x64_bf16 v[32:35], v[40:43], a[160:167], v1
    s_waitcnt lgkmcnt(2)
    v_smfmac_f32_16x16x64_bf16 v[12:15], v[48:51], v[56:63], v1
    ds_read_b128 v[56:59], v8 offset:12288
    ds_read_b128 v[60:63], v8 offset:13312
    v_smfmac_f32_16x16x64_bf16 v[16:19], v[48:51], v[64:71], v1
    ds_read_b128 v[64:67], v8 offset:14336
    ds_read_b128 v[68:71], v8 offset:15360
    s_waitcnt lgkmcnt(5)
    v_smfmac_f32_16x16x64_bf16 v[12:15], v[52:55], v[136:143], v1
    v_smfmac_f32_16x16x64_bf16 v[16:19], v[52:55], v[144:151], v1
    s_waitcnt vmcnt(0)
    v_max3_u32 v10, v44, v45, v46
    v_max_u32 v10, v10, v47
    v_cmp_eq_u32 vcc, -1, v10
    s_nop 0
    s_cbranch_vccnz Lr3f_pc_re
Lr3f_pc_ok:
    v_smfmac_f32_16x16x64_bf16 v[12:15], v[44:47], v[168:175], v1
    v_smfmac_f32_16x16x64_bf16 v[16:19], v[44:47], v[176:183], v1
    s_waitcnt lgkmcnt(2)
    v_smfmac_f32_16x16x64_bf16 v[12:15], v[36:39], v[56:63], v1
    s_waitcnt lgkmcnt(0)
    v_smfmac_f32_16x16x64_bf16 v[16:19], v[36:39], v[64:71], v1
    v_smfmac_f32_16x16x64_bf16 v[20:23], v[48:51], v[248:255], v1
    v_smfmac_f32_16x16x64_bf16 v[24:27], v[48:51], a[0:7], v1
    v_smfmac_f32_16x16x64_bf16 v[20:23], v[52:55], a[8:15], v1
    v_add_f32 v12, v12, v14
    v_smfmac_f32_16x16x64_bf16 v[24:27], v[52:55], a[16:23], v1
    v_add_f32 v16, v16, v18
    buffer_load_dwordx4 v[64:67], v0, s[8:11], s42 offen
    v_smfmac_f32_16x16x64_bf16 v[20:23], v[36:39], a[24:31], v1
    v_add_f32 v13, v13, v15
    v_smfmac_f32_16x16x64_bf16 v[24:27], v[36:39], a[32:39], v1
    v_add_f32 v17, v17, v19
    v_smfmac_f32_16x16x64_bf16 v[20:23], v[44:47], a[56:63], v1
    v_cvt_pk_bf16_f32 v14, v12, v16
    ds_read_b128 v[56:59], v0 offset:15104
    v_smfmac_f32_16x16x64_bf16 v[24:27], v[44:47], a[64:71], v1
    v_cvt_pk_bf16_f32 v15, v13, v17
    ds_read_b128 v[60:63], v0 offset:16128
    buffer_load_dwordx4 v[68:71], v0, s[8:11], s42 offen offset:1024
    ds_write_b32 v2, v14 offset:576
    ds_write_b32 v2, v15 offset:864
    v_smfmac_f32_16x16x64_bf16 v[28:31], v[48:51], a[104:111], v1
    v_smfmac_f32_16x16x64_bf16 v[32:35], v[48:51], a[112:119], v1
    v_add_f32 v20, v20, v22
    v_add_f32 v24, v24, v26
    v_add_f32 v21, v21, v23
    v_add_f32 v25, v25, v27
    v_cvt_pk_bf16_f32 v22, v20, v24
    v_cvt_pk_bf16_f32 v23, v21, v25
    ds_write_b32 v2, v22 offset:0
    ds_write_b32 v2, v23 offset:288
    v_smfmac_f32_16x16x64_bf16 v[28:31], v[52:55], a[120:127], v1
    v_smfmac_f32_16x16x64_bf16 v[32:35], v[52:55], a[128:135], v1
    s_waitcnt lgkmcnt(0)
    s_barrier
    ds_read_b128 v[40:43], v3 offset:0
    ds_read_b128 v[48:51], v3 offset:64
    ds_read_b128 v[20:23], v3 offset:128
    ds_read_b128 v[52:55], v3 offset:192
    v_smfmac_f32_16x16x64_bf16 v[28:31], v[36:39], a[136:143], v1
    v_smfmac_f32_16x16x64_bf16 v[32:35], v[36:39], a[144:151], v1
    ds_read_b128 v[36:39], v0 offset:17152
    v_lshlrev_b32 v9, 3, v0
    buffer_load_dword v11, v9, s[8:11], s68 offen
    v_smfmac_f32_16x16x64_bf16 v[28:31], v[44:47], a[168:175], v1
    v_smfmac_f32_16x16x64_bf16 v[32:35], v[44:47], a[176:183], v1
    ds_read_b128 v[44:47], v0 offset:18176
    s_waitcnt lgkmcnt(5)
    v_mfma_f32_16x16x32_bf16 v[12:15], v[56:59], v[40:43], 0
    v_mfma_f32_16x16x32_bf16 v[16:19], v[60:63], v[40:43], 0
    v_mfma_f32_16x16x32_bf16 v[24:27], v[40:43], v[40:43], 0
    ds_read_b128 v[56:59], v0 offset:19200
    ds_read_b128 v[60:63], v0 offset:20224
    s_waitcnt lgkmcnt(3)
    v_mfma_f32_16x16x32_bf16 v[12:15], v[36:39], v[48:51], v[12:15]
    v_lshrrev_b32 v10, 1, v0
    v_lshrrev_b32 v9, 9, v0
    s_waitcnt lgkmcnt(2)
    v_mfma_f32_16x16x32_bf16 v[16:19], v[44:47], v[48:51], v[16:19]
    v_lshl_add_u32 v9, v9, 5, v10
    v_add_f32 v28, v28, v30
    v_mfma_f32_16x16x32_bf16 v[24:27], v[48:51], v[48:51], v[24:27]
    v_add_f32 v32, v32, v34
    v_add_f32 v29, v29, v31
    ds_read_b128 v[36:39], v0 offset:21248
    ds_read_b128 v[44:47], v0 offset:22272
    s_waitcnt lgkmcnt(3)
    v_mfma_f32_16x16x32_bf16 v[12:15], v[56:59], v[20:23], v[12:15]
    v_add_f32 v33, v33, v35
    v_cvt_pk_bf16_f32 v30, v28, v29
    s_waitcnt lgkmcnt(2)
    v_mfma_f32_16x16x32_bf16 v[16:19], v[60:63], v[20:23], v[16:19]
    v_cvt_pk_bf16_f32 v31, v32, v33
    ds_read_b64 v[34:35], v9 offset:3456
    v_mfma_f32_16x16x32_bf16 v[24:27], v[20:23], v[20:23], v[24:27]
    s_add_u32 s17, s43, 3584
    buffer_store_dwordx2 v[30:31], v10, s[8:11], s17 offen sc1
    s_waitcnt lgkmcnt(2)
    v_mfma_f32_16x16x32_bf16 v[12:15], v[36:39], v[52:55], v[12:15]
    s_waitcnt lgkmcnt(1)
    v_mfma_f32_16x16x32_bf16 v[16:19], v[44:47], v[52:55], v[16:19]
    v_mfma_f32_16x16x32_bf16 v[24:27], v[52:55], v[52:55], v[24:27]
    s_add_u32 s17, s43, 1536
    s_waitcnt lgkmcnt(0)
    buffer_store_dwordx2 v[34:35], v10, s[8:11], s17 offen sc1
    ds_read_b128 v[56:59], v8 offset:16384
    ds_read_b128 v[60:63], v8 offset:17408
    v_mov_b64 v[20:21], s[52:53]
    v_mov_b64 v[22:23], s[52:53]
    v_mov_b32 v41, 0
    v_mov_b32 v42, 0
    v_max3_f32 v9, v12, v13, v14
    v_max3_f32 v9, v9, v15, v16
    v_max3_f32 v9, v9, v17, v18
    v_max3_f32 v9, v9, v19, v24
    v_max_f32 v9, v9, v25
    v_mov_b32 v10, v9
    v_mov_b64 v[32:33], 0
    v_mov_b64 v[34:35], 0
    v_permlane32_swap_b32 v9, v10
    v_max_f32 v9, v9, v10
    v_mov_b32 v10, v9
    s_nop 1
    v_permlane16_swap_b32 v9, v10
    v_max_f32 v9, v9, v10
    v_mul_f32 v28, s44, v9
    v_fma_f32 v12, v12, s44, -v28
    v_fma_f32 v13, v13, s44, -v28
    v_fma_f32 v14, v14, s44, -v28
    v_fma_f32 v15, v15, s44, -v28
    v_exp_f32 v12, v12
    v_exp_f32 v13, v13
    v_fma_f32 v16, v16, s44, -v28
    v_fma_f32 v17, v17, s44, -v28
    v_exp_f32 v14, v14
    v_exp_f32 v15, v15
    v_cvt_pk_bf16_f32 v36, v12, v13
    v_fma_f32 v18, v18, s44, -v28
    v_fma_f32 v19, v19, s44, -v28
    v_exp_f32 v16, v16
    v_exp_f32 v17, v17
    v_cvt_pk_bf16_f32 v37, v14, v15
    v_fma_f32 v24, v24, s44, -v28
    v_fma_f32 v25, v25, s44, -v28
    v_exp_f32 v18, v18
    v_exp_f32 v19, v19
    v_cvt_pk_bf16_f32 v38, v16, v17
    v_exp_f32 v24, v24
    v_exp_f32 v25, v25
    v_cvt_pk_bf16_f32 v39, v18, v19
    v_cvt_pk_bf16_f32 v40, v24, v25
    v_cvt_pk_bf16_f32 v43, v24, v25
    v_mfma_f32_16x16x32_bf16 v[52:55], v[20:23], v[36:39], 0
    v_mov_b64 v[12:13], 0
    v_mov_b64 v[14:15], 0
    s_waitcnt vmcnt(4)
    v_mfma_f32_16x16x32_bf16 v[44:47], v[64:67], v[36:39], 0
    v_mov_b64 v[24:25], 0
    v_mov_b64 v[26:27], 0
    s_waitcnt vmcnt(3)
    v_mfma_f32_16x16x32_bf16 v[48:51], v[68:71], v[36:39], 0
    ds_read_b128 v[64:67], v8 offset:20480
    ds_read_b128 v[68:71], v8 offset:21504
    v_mfma_f32_16x16x16_bf16 v[52:55], v[20:21], v[40:41], v[52:55]
    v_mfma_f32_16x16x16_bf16 v[44:47], v[30:31], v[40:41], v[44:47]
    v_mov_b64 v[20:21], 0
    v_mov_b64 v[22:23], 0
    v_mfma_f32_16x16x16_bf16 v[48:51], v[30:31], v[42:43], v[48:51]
    v_mov_b64 v[36:37], 0
    v_mov_b64 v[38:39], 0
    v_mov_b64 v[40:41], 0
    v_mov_b64 v[42:43], 0
    v_rcp_f32 v9, v52
    v_mov_b64 v[52:53], 0
    v_mov_b64 v[54:55], 0
    v_mul_f32 v44, v9, v44
    v_mul_f32 v48, v9, v48
    v_cvt_pk_bf16_f32 v16, v44, v48
    v_mul_f32 v45, v9, v45
    v_mul_f32 v49, v9, v49
    v_cvt_pk_bf16_f32 v17, v45, v49
    v_mul_f32 v46, v9, v46
    v_mul_f32 v50, v9, v50
    v_cvt_pk_bf16_f32 v18, v46, v50
    v_mul_f32 v47, v9, v47
    v_mul_f32 v51, v9, v51
    v_cvt_pk_bf16_f32 v19, v47, v51
    ds_write_b128 v5, v[16:19]
    v_mov_b64 v[28:29], 0
    v_mov_b64 v[30:31], 0
    s_waitcnt lgkmcnt(0)
    s_barrier
    ds_read_b128 v[44:47], v4 offset:0
    ds_read_b128 v[48:51], v4 offset:128
    s_cmp_eq_u32 s33, 63
    s_cbranch_scc1 Lr3f_last
    v_mov_b64 v[16:17], 0
    v_mov_b64 v[18:19], 0
    buffer_load_dwordx4 v0, s[8:11], s41 offen offset:0 lds
    buffer_load_dwordx4 v0, s[8:11], s41 offen offset:1024 lds
    s_waitcnt lgkmcnt(1)
    v_smfmac_f32_16x16x64_bf16 v[12:15], v[44:47], a[184:191], v1
    s_waitcnt lgkmcnt(0)
    v_smfmac_f32_16x16x64_bf16 v[12:15], v[48:51], a[192:199], v1
    v_smfmac_f32_16x16x64_bf16 v[24:27], v[44:47], a[200:207], v1
    v_smfmac_f32_16x16x64_bf16 v[24:27], v[48:51], a[208:215], v1
    v_add_f32 v12, v12, v14
    v_smfmac_f32_16x16x64_bf16 v[20:23], v[44:47], a[216:223], v1
    v_add_f32 v13, v13, v15
    v_smfmac_f32_16x16x64_bf16 v[20:23], v[48:51], a[224:231], v1
    v_cvt_pk_bf16_f32 v12, v12, v13
    v_smfmac_f32_16x16x64_bf16 v[16:19], v[44:47], a[232:239], v1
    v_add_f32 v24, v24, v26
    v_smfmac_f32_16x16x64_bf16 v[16:19], v[48:51], a[240:247], v1
    v_add_f32 v25, v25, v27
    v_smfmac_f32_16x16x64_bf16 v[36:39], v[44:47], v[56:63], v1
    v_cvt_pk_bf16_f32 v13, v24, v25
    v_smfmac_f32_16x16x64_bf16 v[36:39], v[48:51], v[64:71], v1
    v_add_f32 v20, v20, v22
    v_add_f32 v21, v21, v23
    v_cvt_pk_bf16_f32 v14, v20, v21
    v_add_f32 v16, v16, v18
    v_add_f32 v17, v17, v19
    v_cvt_pk_bf16_f32 v15, v16, v17
    v_and_or_b32 v15, v15, -2, s40
    buffer_store_dwordx4 v[12:15], v0, s[8:11], s38 offen
    s_nop 0
    ds_read_b128 v[12:15], v8 offset:18432
    ds_read_b128 v[16:19], v8 offset:19456
    ds_read_b128 v[20:23], v8 offset:22528
    ds_read_b128 v[24:27], v8 offset:23552
    ds_read_b128 v[56:59], v8 offset:24576
    ds_read_b128 v[60:63], v8 offset:25600
    ds_read_b128 v[64:67], v8 offset:28672
    ds_read_b128 v[68:71], v8 offset:29696
    s_waitcnt lgkmcnt(6)
    v_smfmac_f32_16x16x64_bf16 v[40:43], v[44:47], v[12:19], v1
    ds_read_b128 v[12:15], v8 offset:26624
    ds_read_b128 v[16:19], v8 offset:27648
    s_waitcnt lgkmcnt(6)
    v_smfmac_f32_16x16x64_bf16 v[40:43], v[48:51], v[20:27], v1
    ds_read_b128 v[20:23], v8 offset:30720
    ds_read_b128 v[24:27], v8 offset:31744
    s_waitcnt lgkmcnt(6)
    v_smfmac_f32_16x16x64_bf16 v[52:55], v[44:47], v[56:63], v1
    ds_read_b128 v[56:59], v8 offset:32768
    ds_read_b128 v[60:63], v8 offset:33792
    s_waitcnt lgkmcnt(6)
    v_smfmac_f32_16x16x64_bf16 v[52:55], v[48:51], v[64:71], v1
    s_waitcnt lgkmcnt(4)
    v_smfmac_f32_16x16x64_bf16 v[32:35], v[44:47], v[12:19], v1
    s_waitcnt lgkmcnt(2)
    v_smfmac_f32_16x16x64_bf16 v[32:35], v[48:51], v[20:27], v1
    v_smfmac_f32_16x16x64_bf16 v[28:31], v[44:47], a[248:255], v1
    s_waitcnt lgkmcnt(0)
    v_smfmac_f32_16x16x64_bf16 v[28:31], v[48:51], v[56:63], v1
    v_add_f32 v36, v36, v38
    v_add_f32 v37, v37, v39
    v_cvt_pk_bf16_f32 v36, v36, v37
    v_add_f32 v40, v40, v42
    v_add_f32 v41, v41, v43
    v_cvt_pk_bf16_f32 v37, v40, v41
    v_add_f32 v52, v52, v54
    v_add_f32 v53, v53, v55
    v_cvt_pk_bf16_f32 v38, v52, v53
    v_add_f32 v32, v32, v34
    v_add_f32 v33, v33, v35
    v_cvt_pk_bf16_f32 v39, v32, v33
    v_and_or_b32 v39, v39, -2, s40
    s_add_u32 s17, s38, 4096
    buffer_store_dwordx4 v[36:39], v0, s[8:11], s17 offen
    v_add_f32 v28, v28, v30
    v_add_f32 v29, v29, v31
    v_cvt_pk_bf16_f32 v28, v28, v29
    v_and_or_b32 v28, v28, -2, s40
    v_lshrrev_b32 v9, 2, v0
    buffer_store_dword v28, v9, s[8:11], s39 offen
    s_xor_b32 s34, s34, 16384
    s_xor_b32 s35, s35, 16384
    s_add_u32 s33, s33, 1
    s_add_u32 s42, s42, 262144
    s_add_u32 s41, s41, 262144
    s_add_u32 s43, s43, 131072
    s_add_u32 s68, s68, 262144
    s_add_u32 s66, s66, 22528
    s_xor_b32 s40, s40, 1
    ds_read_b128 v[56:59], v8 offset:0
    ds_read_b128 v[60:63], v8 offset:1024
    ds_read_b128 v[64:67], v8 offset:2048
    ds_read_b128 v[68:71], v8 offset:3072
    v_mov_b64 v[12:13], 0
    v_mov_b64 v[14:15], 0
    v_mov_b64 v[16:17], 0
    v_mov_b64 v[18:19], 0
    v_mov_b64 v[20:21], 0
    v_mov_b64 v[22:23], 0
    v_mov_b64 v[24:25], 0
    v_mov_b64 v[26:27], 0
    v_mov_b64 v[28:29], 0
    v_mov_b64 v[30:31], 0
    v_mov_b64 v[32:33], 0
    v_mov_b64 v[34:35], 0
    s_sleep 5
    s_nop 9
    buffer_load_dwordx4 v[36:39], v0, s[8:11], s34 offen sc1
    s_nop 15
    s_nop 8
    buffer_load_dwordx4 v[36:39], v0, s[8:11], s34 offen sc1
    s_nop 15
    s_nop 8
    buffer_load_dwordx4 v[36:39], v0, s[8:11], s34 offen sc1
    s_waitcnt lgkmcnt(0)
    s_branch Lr3f_step
Lr3f_pb_re:
    s_mov_b32 s16, 0
Lr3f_pb_lp:
    s_add_u32 s17, s34, 4096
    buffer_load_dwordx4 v[40:43], v0, s[8:11], s17 offen sc1
    s_add_u32 s16, s16, 1
    s_cmp_gt_u32 s16, 100000
    s_cbranch_scc1 Lr_abort
    s_waitcnt vmcnt(0)
    v_max3_u32 v10, v40, v41, v42
    v_max_u32 v10, v10, v43
    v_cmp_eq_u32 vcc, -1, v10
    s_nop 0
    s_cbranch_vccnz Lr3f_pb_lp
    s_branch Lr3f_pb_ok
Lr3f_pc_re:
    s_mov_b32 s16, 0
Lr3f_pc_lp:
    buffer_load_dwordx4 v[44:47], v0, s[8:11], s35 offen sc1
    s_add_u32 s16, s16, 1
    s_cmp_gt_u32 s16, 100000
    s_cbranch_scc1 Lr_abort
    s_waitcnt vmcnt(0)
    v_max3_u32 v10, v44, v45, v46
    v_max_u32 v10, v10, v47
    v_cmp_eq_u32 vcc, -1, v10
    s_nop 0
    s_cbranch_vccnz Lr3f_pc_lp
    s_branch Lr3f_pc_ok
Lr3f_last:
    s_waitcnt vmcnt(0) lgkmcnt(0)
    s_barrier
    s_branch Lr_exit
L_slow:
    s_cmp_lg_u32 s14, 0
    s_cbranch_scc1 L_w1_0
    s_mov_b32 s16, 0
    s_add_u32 s17, s66, 128
    v_lshrrev_b32 v10, 2, v0
    v_and_b32 v9, 16, v10
    v_lshlrev_b32 v9, 3, v9
    v_and_or_b32 v10, v10, 12, v9
Lr0s_fw_27:
    buffer_load_dword v9, v10, s[8:11], s17 offen sc1
    s_add_u32 s16, s16, 1
    s_cmp_gt_u32 s16, 100000
    s_cbranch_scc1 Lr_abort
    s_waitcnt vmcnt(0)
    v_cmp_eq_u32 vcc, 0, v9
    s_nop 0
    s_cbranch_vccnz Lr0s_fw_27
    s_mov_b32 m0, 15104
    s_nop 0
    buffer_load_dwordx4 v0, s[8:11], s41 offen offset:0 lds
    buffer_load_dwordx4 v0, s[8:11], s41 offen offset:1024 lds
    s_add_u32 s41, s41, 262144
    s_add_u32 s68, s68, 4278452224
    s_waitcnt vmcnt(0)
    ds_read_b128 v[56:59], v8 offset:0
    ds_read_b128 v[60:63], v8 offset:1024
    ds_read_b128 v[64:67], v8 offset:2048
    ds_read_b128 v[68:71], v8 offset:3072
    v_mov_b64 v[12:13], 0
    v_mov_b64 v[14:15], 0
    v_mov_b64 v[16:17], 0
    v_mov_b64 v[18:19], 0
    v_mov_b64 v[20:21], 0
    v_mov_b64 v[22:23], 0
    v_mov_b64 v[24:25], 0
    v_mov_b64 v[26:27], 0
    v_mov_b64 v[28:29], 0
    v_mov_b64 v[30:31], 0
    v_mov_b64 v[32:33], 0
    v_mov_b64 v[34:35], 0
    buffer_load_dwordx4 v[36:39], v0, s[8:11], s34 offen sc1
    s_waitcnt vmcnt(0) lgkmcnt(0)
Lr0s_step:
    s_waitcnt vmcnt(2)
    v_max3_u32 v10, v36, v37, v38
    v_max_u32 v10, v10, v39
    v_cmp_eq_u32 vcc, -1, v10
    s_nop 0
    s_cbranch_vccz Lr0s_aok
    s_waitcnt vmcnt(1)
    v_max3_u32 v10, v36, v37, v38
    v_max_u32 v10, v10, v39
    v_cmp_eq_u32 vcc, -1, v10
    s_nop 0
    s_cbranch_vccz Lr0s_aok
    s_mov_b32 s16, 0
Lr0s_alp:
    buffer_load_dwordx4 v[36:39], v0, s[8:11], s34 offen sc1
    s_add_u32 s16, s16, 1
    s_cmp_gt_u32 s16, 100000
    s_cbranch_scc1 Lr_abort
    s_waitcnt vmcnt(1)
    v_max3_u32 v10, v36, v37, v38
    v_max_u32 v10, v10, v39
    v_cmp_eq_u32 vcc, -1, v10
    s_nop 0
    s_cbranch_vccnz Lr0s_alp
Lr0s_aok:
    ds_write_b128 v0, v[36:39] offset:6912
    v_smfmac_f32_16x16x64_bf16 v[12:15], v[36:39], v[72:79], v1
    v_smfmac_f32_16x16x64_bf16 v[16:19], v[36:39], v[80:87], v1
    v_smfmac_f32_16x16x64_bf16 v[20:23], v[36:39], v[184:191], v1
    s_waitcnt lgkmcnt(0)
    s_barrier
    ds_read_b128 v[48:51], v0 offset:7936
    ds_read_b128 v[52:55], v0 offset:8960
    v_smfmac_f32_16x16x64_bf16 v[28:31], v[36:39], v[56:63], v1
    ds_read_b128 v[56:59], v8 offset:4096
    ds_read_b128 v[60:63], v8 offset:5120
    s_add_u32 s17, s34, 4096
    buffer_load_dwordx4 v[40:43], v0, s[8:11], s17 offen sc1
    v_smfmac_f32_16x16x64_bf16 v[24:27], v[36:39], v[192:199], v1
    v_smfmac_f32_16x16x64_bf16 v[32:35], v[36:39], v[64:71], v1
    ds_read_b128 v[64:67], v8 offset:6144
    ds_read_b128 v[68:71], v8 offset:7168
    s_waitcnt vmcnt(1)
    ds_read_b128 v[36:39], v0 offset:9984
    s_waitcnt lgkmcnt(6)
    v_smfmac_f32_16x16x64_bf16 v[28:31], v[48:51], a[72:79], v1
    v_smfmac_f32_16x16x64_bf16 v[12:15], v[48:51], v[88:95], v1
    buffer_load_dwordx4 v[44:47], v0, s[8:11], s35 offen sc1
    v_smfmac_f32_16x16x64_bf16 v[16:19], v[48:51], v[96:103], v1
    v_smfmac_f32_16x16x64_bf16 v[32:35], v[48:51], a[80:87], v1
    v_smfmac_f32_16x16x64_bf16 v[20:23], v[48:51], v[200:207], v1
    v_smfmac_f32_16x16x64_bf16 v[24:27], v[48:51], v[208:215], v1
    s_waitcnt lgkmcnt(3)
    v_smfmac_f32_16x16x64_bf16 v[28:31], v[52:55], v[56:63], v1
    ds_read_b128 v[56:59], v8 offset:8192
    ds_read_b128 v[60:63], v8 offset:9216
    v_smfmac_f32_16x16x64_bf16 v[12:15], v[52:55], v[104:111], v1
    v_smfmac_f32_16x16x64_bf16 v[16:19], v[52:55], v[112:119], v1
    s_waitcnt lgkmcnt(3)
    v_smfmac_f32_16x16x64_bf16 v[32:35], v[52:55], v[64:71], v1
    ds_read_b128 v[64:67], v8 offset:10240
    ds_read_b128 v[68:71], v8 offset:11264
    v_smfmac_f32_16x16x64_bf16 v[20:23], v[52:55], v[216:223], v1
    v_smfmac_f32_16x16x64_bf16 v[24:27], v[52:55], v[224:231], v1
    s_waitcnt lgkmcnt(4)
    v_smfmac_f32_16x16x64_bf16 v[28:31], v[36:39], a[88:95], v1
    v_smfmac_f32_16x16x64_bf16 v[12:15], v[36:39], v[120:127], v1
    v_smfmac_f32_16x16x64_bf16 v[16:19], v[36:39], v[128:135], v1
    v_smfmac_f32_16x16x64_bf16 v[32:35], v[36:39], a[96:103], v1
    v_smfmac_f32_16x16x64_bf16 v[20:23], v[36:39], v[232:239], v1
    v_smfmac_f32_16x16x64_bf16 v[24:27], v[36:39], v[240:247], v1
    s_waitcnt vmcnt(1)
    v_max3_u32 v10, v40, v41, v42
    v_max_u32 v10, v10, v43
    v_cmp_eq_u32 vcc, -1, v10
    s_nop 0
    s_cbranch_vccnz Lr0s_pb_re
Lr0s_pb_ok:
    ds_write_b128 v0, v[40:43] offset:11008
    s_waitcnt lgkmcnt(3)
    v_smfmac_f32_16x16x64_bf16 v[12:15], v[40:43], v[56:63], v1
    ds_read_b128 v[56:59], v8 offset:12288
    ds_read_b128 v[60:63], v8 offset:13312
    v_smfmac_f32_16x16x64_bf16 v[20:23], v[40:43], v[248:255], v1
    s_waitcnt lgkmcnt(3)
    v_smfmac_f32_16x16x64_bf16 v[16:19], v[40:43], v[64:71], v1
    ds_read_b128 v[64:67], v8 offset:14336
    ds_read_b128 v[68:71], v8 offset:15360
    v_smfmac_f32_16x16x64_bf16 v[24:27], v[40:43], a[0:7], v1
    s_waitcnt lgkmcnt(4)
    s_barrier
    ds_read_b128 v[48:51], v0 offset:13056
    ds_read_b128 v[52:55], v0 offset:12032
    ds_read_b128 v[36:39], v0 offset:14080
    v_smfmac_f32_16x16x64_bf16 v[28:31], v[40:43], a[104:111], v1
    v_smfmac_f32_16x16x64_bf16 v[32:35], v[40:43], a[112:119], v1
    s_waitcnt lgkmcnt(2)
    v_smfmac_f32_16x16x64_bf16 v[12:15], v[48:51], v[56:63], v1
    v_smfmac_f32_16x16x64_bf16 v[16:19], v[48:51], v[64:71], v1
    s_waitcnt lgkmcnt(1)
    v_smfmac_f32_16x16x64_bf16 v[12:15], v[52:55], v[136:143], v1
    v_smfmac_f32_16x16x64_bf16 v[16:19], v[52:55], v[144:151], v1
    s_waitcnt lgkmcnt(0)
    v_smfmac_f32_16x16x64_bf16 v[12:15], v[36:39], v[152:159], v1
    v_smfmac_f32_16x16x64_bf16 v[16:19], v[36:39], v[160:167], v1
    s_waitcnt vmcnt(0)
    v_max3_u32 v10, v44, v45, v46
    v_max_u32 v10, v10, v47
    v_cmp_eq_u32 vcc, -1, v10
    s_nop 0
    s_cbranch_vccnz Lr0s_pc_re
Lr0s_pc_ok:
    v_smfmac_f32_16x16x64_bf16 v[12:15], v[44:47], v[168:175], v1
    v_smfmac_f32_16x16x64_bf16 v[16:19], v[44:47], v[176:183], v1
    v_smfmac_f32_16x16x64_bf16 v[20:23], v[48:51], a[24:31], v1
    buffer_load_dwordx4 v[64:67], v0, s[8:11], s42 offen
    v_smfmac_f32_16x16x64_bf16 v[24:27], v[48:51], a[32:39], v1
    v_smfmac_f32_16x16x64_bf16 v[20:23], v[52:55], a[8:15], v1
    v_add_f32 v12, v12, v14
    v_smfmac_f32_16x16x64_bf16 v[24:27], v[52:55], a[16:23], v1
    v_add_f32 v16, v16, v18
    v_smfmac_f32_16x16x64_bf16 v[20:23], v[36:39], a[40:47], v1
    v_add_f32 v13, v13, v15
    buffer_load_dwordx4 v[68:71], v0, s[8:11], s42 offen offset:1024
    v_smfmac_f32_16x16x64_bf16 v[24:27], v[36:39], a[48:55], v1
    v_add_f32 v17, v17, v19
    v_smfmac_f32_16x16x64_bf16 v[20:23], v[44:47], a[56:63], v1
    v_cvt_pk_bf16_f32 v14, v12, v16
    ds_read_b128 v[56:59], v0 offset:15104
    v_smfmac_f32_16x16x64_bf16 v[24:27], v[44:47], a[64:71], v1
    v_cvt_pk_bf16_f32 v15, v13, v17
    ds_read_b128 v[60:63], v0 offset:16128
    ds_write_b32 v2, v14 offset:576
    ds_write_b32 v2, v15 offset:864
    v_smfmac_f32_16x16x64_bf16 v[28:31], v[48:51], a[136:143], v1
    v_smfmac_f32_16x16x64_bf16 v[32:35], v[48:51], a[144:151], v1
    v_add_f32 v20, v20, v22
    v_add_f32 v24, v24, v26
    v_add_f32 v21, v21, v23
    v_add_f32 v25, v25, v27
    v_cvt_pk_bf16_f32 v22, v20, v24
    v_cvt_pk_bf16_f32 v23, v21, v25
    ds_write_b32 v2, v22 offset:0
    ds_write_b32 v2, v23 offset:288
    v_smfmac_f32_16x16x64_bf16 v[28:31], v[52:55], a[120:127], v1
    v_smfmac_f32_16x16x64_bf16 v[32:35], v[52:55], a[128:135], v1
    s_waitcnt lgkmcnt(0)
    s_barrier
    ds_read_b128 v[40:43], v3 offset:0
    ds_read_b128 v[48:51], v3 offset:64
    ds_read_b128 v[20:23], v3 offset:128
    ds_read_b128 v[52:55], v3 offset:192
    v_smfmac_f32_16x16x64_bf16 v[28:31], v[36:39], a[152:159], v1
    v_smfmac_f32_16x16x64_bf16 v[32:35], v[36:39], a[160:167], v1
    ds_read_b128 v[36:39], v0 offset:17152
    v_lshlrev_b32 v9, 3, v0
    buffer_load_dword v11, v9, s[8:11], s68 offen
    v_smfmac_f32_16x16x64_bf16 v[28:31], v[44:47], a[168:175], v1
    v_smfmac_f32_16x16x64_bf16 v[32:35], v[44:47], a[176:183], v1
    ds_read_b128 v[44:47], v0 offset:18176
    s_waitcnt lgkmcnt(5)
    v_mfma_f32_16x16x32_bf16 v[12:15], v[56:59], v[40:43], 0
    v_mfma_f32_16x16x32_bf16 v[16:19], v[60:63], v[40:43], 0
    v_mfma_f32_16x16x32_bf16 v[24:27], v[40:43], v[40:43], 0
    ds_read_b128 v[56:59], v0 offset:19200
    ds_read_b128 v[60:63], v0 offset:20224
    s_waitcnt lgkmcnt(3)
    v_mfma_f32_16x16x32_bf16 v[12:15], v[36:39], v[48:51], v[12:15]
    v_lshrrev_b32 v10, 1, v0
    v_lshrrev_b32 v9, 9, v0
    s_waitcnt lgkmcnt(2)
    v_mfma_f32_16x16x32_bf16 v[16:19], v[44:47], v[48:51], v[16:19]
    v_lshl_add_u32 v9, v9, 5, v10
    v_add_f32 v28, v28, v30
    v_mfma_f32_16x16x32_bf16 v[24:27], v[48:51], v[48:51], v[24:27]
    v_add_f32 v32, v32, v34
    v_add_f32 v29, v29, v31
    ds_read_b128 v[36:39], v0 offset:21248
    ds_read_b128 v[44:47], v0 offset:22272
    s_waitcnt lgkmcnt(3)
    v_mfma_f32_16x16x32_bf16 v[12:15], v[56:59], v[20:23], v[12:15]
    v_add_f32 v33, v33, v35
    v_cvt_pk_bf16_f32 v30, v28, v29
    s_waitcnt lgkmcnt(2)
    v_mfma_f32_16x16x32_bf16 v[16:19], v[60:63], v[20:23], v[16:19]
    v_cvt_pk_bf16_f32 v31, v32, v33
    ds_read_b64 v[34:35], v9 offset:0
    v_mfma_f32_16x16x32_bf16 v[24:27], v[20:23], v[20:23], v[24:27]
    s_add_u32 s17, s43, 2048
    buffer_store_dwordx2 v[30:31], v10, s[8:11], s17 offen sc1
    s_waitcnt lgkmcnt(2)
    v_mfma_f32_16x16x32_bf16 v[12:15], v[36:39], v[52:55], v[12:15]
    s_waitcnt lgkmcnt(1)
    v_mfma_f32_16x16x32_bf16 v[16:19], v[44:47], v[52:55], v[16:19]
    v_mfma_f32_16x16x32_bf16 v[24:27], v[52:55], v[52:55], v[24:27]
    s_add_u32 s17, s43, 0
    s_waitcnt lgkmcnt(0)
    buffer_store_dwordx2 v[34:35], v10, s[8:11], s17 offen sc1
    ds_read_b128 v[56:59], v8 offset:16384
    ds_read_b128 v[60:63], v8 offset:17408
    v_mov_b64 v[20:21], s[52:53]
    v_mov_b64 v[22:23], s[52:53]
    v_mov_b32 v41, 0
    v_mov_b32 v42, 0
    v_max3_f32 v9, v12, v13, v14
    v_max3_f32 v9, v9, v15, v16
    v_max3_f32 v9, v9, v17, v18
    v_max3_f32 v9, v9, v19, v24
    v_max_f32 v9, v9, v25
    v_mov_b32 v10, v9
    v_mov_b64 v[32:33], 0
    v_mov_b64 v[34:35], 0
    v_permlane32_swap_b32 v9, v10
    v_max_f32 v9, v9, v10
    v_mov_b32 v10, v9
    s_nop 1
    v_permlane16_swap_b32 v9, v10
    v_max_f32 v9, v9, v10
    v_mul_f32 v28, s44, v9
    v_fma_f32 v12, v12, s44, -v28
    v_fma_f32 v13, v13, s44, -v28
    v_fma_f32 v14, v14, s44, -v28
    v_fma_f32 v15, v15, s44, -v28
    v_exp_f32 v12, v12
    v_exp_f32 v13, v13
    v_fma_f32 v16, v16, s44, -v28
    v_fma_f32 v17, v17, s44, -v28
    v_exp_f32 v14, v14
    v_exp_f32 v15, v15
    v_cvt_pk_bf16_f32 v36, v12, v13
    v_fma_f32 v18, v18, s44, -v28
    v_fma_f32 v19, v19, s44, -v28
    v_exp_f32 v16, v16
    v_exp_f32 v17, v17
    v_cvt_pk_bf16_f32 v37, v14, v15
    v_fma_f32 v24, v24, s44, -v28
    v_fma_f32 v25, v25, s44, -v28
    v_exp_f32 v18, v18
    v_exp_f32 v19, v19
    v_cvt_pk_bf16_f32 v38, v16, v17
    v_exp_f32 v24, v24
    v_exp_f32 v25, v25
    v_cvt_pk_bf16_f32 v39, v18, v19
    v_cvt_pk_bf16_f32 v40, v24, v25
    v_cvt_pk_bf16_f32 v43, v24, v25
    v_mfma_f32_16x16x32_bf16 v[52:55], v[20:23], v[36:39], 0
    v_mov_b64 v[12:13], 0
    v_mov_b64 v[14:15], 0
    s_waitcnt vmcnt(4)
    v_mfma_f32_16x16x32_bf16 v[44:47], v[64:67], v[36:39], 0
    v_mov_b64 v[24:25], 0
    v_mov_b64 v[26:27], 0
    s_waitcnt vmcnt(3)
    v_mfma_f32_16x16x32_bf16 v[48:51], v[68:71], v[36:39], 0
    ds_read_b128 v[64:67], v8 offset:20480
    ds_read_b128 v[68:71], v8 offset:21504
    v_mfma_f32_16x16x16_bf16 v[52:55], v[20:21], v[40:41], v[52:55]
    v_mfma_f32_16x16x16_bf16 v[44:47], v[30:31], v[40:41], v[44:47]
    v_mov_b64 v[20:21], 0
    v_mov_b64 v[22:23], 0
    v_mfma_f32_16x16x16_bf16 v[48:51], v[30:31], v[42:43], v[48:51]
    v_mov_b64 v[36:37], 0
    v_mov_b64 v[38:39], 0
    v_mov_b64 v[40:41], 0
    v_mov_b64 v[42:43], 0
    v_rcp_f32 v9, v52
    v_mov_b64 v[52:53], 0
    v_mov_b64 v[54:55], 0
    v_mul_f32 v44, v9, v44
    v_mul_f32 v48, v9, v48
    v_cvt_pk_bf16_f32 v16, v44, v48
    v_mul_f32 v45, v9, v45
    v_mul_f32 v49, v9, v49
    v_cvt_pk_bf16_f32 v17, v45, v49
    v_mul_f32 v46, v9, v46
    v_mul_f32 v50, v9, v50
    v_cvt_pk_bf16_f32 v18, v46, v50
    v_mul_f32 v47, v9, v47
    v_mul_f32 v51, v9, v51
    v_cvt_pk_bf16_f32 v19, v47, v51
    ds_write_b128 v5, v[16:19]
    v_mov_b64 v[28:29], 0
    v_mov_b64 v[30:31], 0
    s_waitcnt lgkmcnt(0)
    s_barrier
    ds_read_b128 v[44:47], v4 offset:0
    ds_read_b128 v[48:51], v4 offset:128
    s_cmp_eq_u32 s33, 63
    s_cbranch_scc1 Lr0s_last
    v_mov_b64 v[16:17], 0
    v_mov_b64 v[18:19], 0
    buffer_load_dwordx4 v0, s[8:11], s41 offen offset:0 lds
    buffer_load_dwordx4 v0, s[8:11], s41 offen offset:1024 lds
    s_waitcnt lgkmcnt(1)
    v_smfmac_f32_16x16x64_bf16 v[12:15], v[44:47], a[184:191], v1
    s_waitcnt lgkmcnt(0)
    v_smfmac_f32_16x16x64_bf16 v[12:15], v[48:51], a[192:199], v1
    v_smfmac_f32_16x16x64_bf16 v[24:27], v[44:47], a[200:207], v1
    v_smfmac_f32_16x16x64_bf16 v[24:27], v[48:51], a[208:215], v1
    v_add_f32 v12, v12, v14
    v_smfmac_f32_16x16x64_bf16 v[20:23], v[44:47], a[216:223], v1
    v_add_f32 v13, v13, v15
    v_smfmac_f32_16x16x64_bf16 v[20:23], v[48:51], a[224:231], v1
    v_cvt_pk_bf16_f32 v12, v12, v13
    v_smfmac_f32_16x16x64_bf16 v[16:19], v[44:47], a[232:239], v1
    v_add_f32 v24, v24, v26
    v_smfmac_f32_16x16x64_bf16 v[16:19], v[48:51], a[240:247], v1
    v_add_f32 v25, v25, v27
    v_smfmac_f32_16x16x64_bf16 v[36:39], v[44:47], v[56:63], v1
    v_cvt_pk_bf16_f32 v13, v24, v25
    v_smfmac_f32_16x16x64_bf16 v[36:39], v[48:51], v[64:71], v1
    v_add_f32 v20, v20, v22
    v_add_f32 v21, v21, v23
    v_cvt_pk_bf16_f32 v14, v20, v21
    v_add_f32 v16, v16, v18
    v_add_f32 v17, v17, v19
    v_cvt_pk_bf16_f32 v15, v16, v17
    v_and_or_b32 v15, v15, -2, s40
    buffer_store_dwordx4 v[12:15], v0, s[8:11], s38 offen sc1
    s_nop 0
    ds_read_b128 v[12:15], v8 offset:18432
    ds_read_b128 v[16:19], v8 offset:19456
    ds_read_b128 v[20:23], v8 offset:22528
    ds_read_b128 v[24:27], v8 offset:23552
    ds_read_b128 v[56:59], v8 offset:24576
    ds_read_b128 v[60:63], v8 offset:25600
    ds_read_b128 v[64:67], v8 offset:28672
    ds_read_b128 v[68:71], v8 offset:29696
    s_waitcnt lgkmcnt(6)
    v_smfmac_f32_16x16x64_bf16 v[40:43], v[44:47], v[12:19], v1
    ds_read_b128 v[12:15], v8 offset:26624
    ds_read_b128 v[16:19], v8 offset:27648
    s_waitcnt lgkmcnt(6)
    v_smfmac_f32_16x16x64_bf16 v[40:43], v[48:51], v[20:27], v1
    ds_read_b128 v[20:23], v8 offset:30720
    ds_read_b128 v[24:27], v8 offset:31744
    s_waitcnt lgkmcnt(6)
    v_smfmac_f32_16x16x64_bf16 v[52:55], v[44:47], v[56:63], v1
    ds_read_b128 v[56:59], v8 offset:32768
    ds_read_b128 v[60:63], v8 offset:33792
    s_waitcnt lgkmcnt(6)
    v_smfmac_f32_16x16x64_bf16 v[52:55], v[48:51], v[64:71], v1
    s_waitcnt lgkmcnt(4)
    v_smfmac_f32_16x16x64_bf16 v[32:35], v[44:47], v[12:19], v1
    s_waitcnt lgkmcnt(2)
    v_smfmac_f32_16x16x64_bf16 v[32:35], v[48:51], v[20:27], v1
    v_smfmac_f32_16x16x64_bf16 v[28:31], v[44:47], a[248:255], v1
    s_waitcnt lgkmcnt(0)
    v_smfmac_f32_16x16x64_bf16 v[28:31], v[48:51], v[56:63], v1
    buffer_load_dwordx4 v[12:15], v6, s[8:11], s62 offen sc1
    buffer_load_dwordx4 v[16:19], v6, s[8:11], s63 offen sc1
    buffer_load_dwordx4 v[20:23], v6, s[8:11], s64 offen sc1
    buffer_load_dwordx4 v[24:27], v6, s[8:11], s65 offen sc1
    v_add_f32 v36, v36, v38
    v_add_f32 v37, v37, v39
    v_cvt_pk_bf16_f32 v36, v36, v37
    v_add_f32 v40, v40, v42
    v_add_f32 v41, v41, v43
    v_cvt_pk_bf16_f32 v37, v40, v41
    v_add_f32 v52, v52, v54
    v_add_f32 v53, v53, v55
    v_cvt_pk_bf16_f32 v38, v52, v53
    v_add_f32 v32, v32, v34
    v_add_f32 v33, v33, v35
    v_cvt_pk_bf16_f32 v39, v32, v33
    v_and_or_b32 v39, v39, -2, s40
    s_add_u32 s17, s38, 4096
    buffer_store_dwordx4 v[36:39], v0, s[8:11], s17 offen sc1
    v_add_f32 v28, v28, v30
    v_add_f32 v29, v29, v31
    v_cvt_pk_bf16_f32 v28, v28, v29
    v_and_or_b32 v28, v28, -2, s40
    v_lshrrev_b32 v9, 2, v0
    buffer_store_dword v28, v9, s[8:11], s39 offen sc1
    v_add_u32 v10, 162560, v0
    ds_read_b128 v[64:67], v10
    s_nop 9
    buffer_load_dwordx4 v[40:43], v6, s[8:11], s62 offen sc1
    buffer_load_dwordx4 v[44:47], v6, s[8:11], s63 offen sc1
    buffer_load_dwordx4 v[48:51], v6, s[8:11], s64 offen sc1
    buffer_load_dwordx4 v[52:55], v6, s[8:11], s65 offen sc1
    s_add_u32 s33, s33, 1
    s_add_u32 s42, s42, 262144
    s_add_u32 s41, s41, 262144
    s_add_u32 s43, s43, 131072
    s_add_u32 s68, s68, 262144
    s_add_u32 s66, s66, 22528
    ds_read_b128 v[56:59], v8 offset:0
    ds_read_b128 v[60:63], v8 offset:1024
    s_waitcnt lgkmcnt(2)
    s_waitcnt vmcnt(9)
    v_mfma_f32_16x16x32_bf16 v[68:71], v[12:15], v[64:67], 0
    v_and_b32 v10, 1, v15
    v_cmp_ne_u32 s[54:55], s40, v10
    s_waitcnt vmcnt(8)
    v_mfma_f32_16x16x32_bf16 v[68:71], v[16:19], v[64:67], v[68:71]
    v_and_b32 v10, 1, v19
    v_cmp_ne_u32 s[56:57], s40, v10
    s_waitcnt vmcnt(7)
    v_mfma_f32_16x16x32_bf16 v[68:71], v[20:23], v[64:67], v[68:71]
    v_and_b32 v10, 1, v23
    v_cmp_ne_u32 s[58:59], s40, v10
    s_waitcnt vmcnt(6)
    v_mfma_f32_16x16x32_bf16 v[68:71], v[24:27], v[64:67], v[68:71]
    v_and_b32 v10, 1, v27
    v_cmp_ne_u32 s[60:61], s40, v10
    s_or_b64 vcc, s[54:55], s[56:57]
    s_or_b64 vcc, vcc, s[58:59]
    s_or_b64 vcc, vcc, s[60:61]
    s_cbranch_scc0 Lr0s_red
    s_mov_b32 s16, 0
Lr0s_p1:
    buffer_load_dwordx4 v[12:15], v6, s[8:11], s62 offen sc1
    buffer_load_dwordx4 v[16:19], v6, s[8:11], s63 offen sc1
    buffer_load_dwordx4 v[20:23], v6, s[8:11], s64 offen sc1
    buffer_load_dwordx4 v[24:27], v6, s[8:11], s65 offen sc1
    s_waitcnt vmcnt(7)
    v_mfma_f32_16x16x32_bf16 v[68:71], v[40:43], v[64:67], 0
    v_and_b32 v10, 1, v43
    v_cmp_ne_u32 s[54:55], s40, v10
    s_waitcnt vmcnt(6)
    v_mfma_f32_16x16x32_bf16 v[68:71], v[44:47], v[64:67], v[68:71]
    v_and_b32 v10, 1, v47
    v_cmp_ne_u32 s[56:57], s40, v10
    s_waitcnt vmcnt(5)
    v_mfma_f32_16x16x32_bf16 v[68:71], v[48:51], v[64:67], v[68:71]
    v_and_b32 v10, 1, v51
    v_cmp_ne_u32 s[58:59], s40, v10
    s_waitcnt vmcnt(4)
    v_mfma_f32_16x16x32_bf16 v[68:71], v[52:55], v[64:67], v[68:71]
    v_and_b32 v10, 1, v55
    v_cmp_ne_u32 s[60:61], s40, v10
    s_or_b64 vcc, s[54:55], s[56:57]
    s_or_b64 vcc, vcc, s[58:59]
    s_or_b64 vcc, vcc, s[60:61]
    s_cbranch_scc0 Lr0s_red
    buffer_load_dwordx4 v[40:43], v6, s[8:11], s62 offen sc1
    buffer_load_dwordx4 v[44:47], v6, s[8:11], s63 offen sc1
    buffer_load_dwordx4 v[48:51], v6, s[8:11], s64 offen sc1
    buffer_load_dwordx4 v[52:55], v6, s[8:11], s65 offen sc1
    s_add_u32 s16, s16, 1
    s_cmp_gt_u32 s16, 100000
    s_cbranch_scc1 Lr_abort
    s_waitcnt vmcnt(7)
    v_mfma_f32_16x16x32_bf16 v[68:71], v[12:15], v[64:67], 0
    v_and_b32 v10, 1, v15
    v_cmp_ne_u32 s[54:55], s40, v10
    s_waitcnt vmcnt(6)
    v_mfma_f32_16x16x32_bf16 v[68:71], v[16:19], v[64:67], v[68:71]
    v_and_b32 v10, 1, v19
    v_cmp_ne_u32 s[56:57], s40, v10
    s_waitcnt vmcnt(5)
    v_mfma_f32_16x16x32_bf16 v[68:71], v[20:23], v[64:67], v[68:71]
    v_and_b32 v10, 1, v23
    v_cmp_ne_u32 s[58:59], s40, v10
    s_waitcnt vmcnt(4)
    v_mfma_f32_16x16x32_bf16 v[68:71], v[24:27], v[64:67], v[68:71]
    v_and_b32 v10, 1, v27
    v_cmp_ne_u32 s[60:61], s40, v10
    s_or_b64 vcc, s[54:55], s[56:57]
    s_or_b64 vcc, vcc, s[58:59]
    s_or_b64 vcc, vcc, s[60:61]
    s_cbranch_scc1 Lr0s_p1
Lr0s_red:
    s_nop 1
    v_permlane16_swap_b32 v68, v70
    v_permlane16_swap_b32 v69, v71
    s_mov_b64 exec, s[46:47]
    v_add_f32 v68, v68, v70
    v_add_f32 v69, v69, v71
    v_cvt_pk_bf16_f32 v68, v68, v69
    v_min_u32 v68, s50, v68
    buffer_store_dword v68, v7, s[8:11], s36 offen sc1
    v_mov_b32 v69, -1
    buffer_store_dword v69, v7, s[8:11], s37 offen sc1
    s_mov_b64 exec, -1
    s_xor_b32 s34, s34, 16384
    s_xor_b32 s35, s35, 16384
    s_xor_b32 s40, s40, 1
    s_xor_b32 s36, s36, 16384
    s_xor_b32 s37, s37, 16384
    s_nop 15
    s_nop 3
    buffer_load_dwordx4 v[36:39], v0, s[8:11], s34 offen sc1
    s_waitcnt vmcnt(3)
    ds_read_b128 v[64:67], v8 offset:2048
    ds_read_b128 v[68:71], v8 offset:3072
    v_mov_b64 v[12:13], 0
    v_mov_b64 v[14:15], 0
    v_mov_b64 v[16:17], 0
    v_mov_b64 v[18:19], 0
    v_mov_b64 v[20:21], 0
    v_mov_b64 v[22:23], 0
    v_mov_b64 v[24:25], 0
    v_mov_b64 v[26:27], 0
    v_mov_b64 v[28:29], 0
    v_mov_b64 v[30:31], 0
    v_mov_b64 v[32:33], 0
    v_mov_b64 v[34:35], 0
    s_nop 9
    buffer_load_dwordx4 v[36:39], v0, s[8:11], s34 offen sc1
    s_nop 15
    s_nop 8
    buffer_load_dwordx4 v[36:39], v0, s[8:11], s34 offen sc1
    s_waitcnt lgkmcnt(0)
    s_branch Lr0s_step
Lr0s_pb_re:
    s_mov_b32 s16, 0
Lr0s_pb_lp:
    s_add_u32 s17, s34, 4096
    buffer_load_dwordx4 v[40:43], v0, s[8:11], s17 offen sc1
    s_add_u32 s16, s16, 1
    s_cmp_gt_u32 s16, 100000
    s_cbranch_scc1 Lr_abort
    s_waitcnt vmcnt(0)
    v_max3_u32 v10, v40, v41, v42
    v_max_u32 v10, v10, v43
    v_cmp_eq_u32 vcc, -1, v10
    s_nop 0
    s_cbranch_vccnz Lr0s_pb_lp
    s_branch Lr0s_pb_ok
Lr0s_pc_re:
    s_mov_b32 s16, 0
Lr0s_pc_lp:
    buffer_load_dwordx4 v[44:47], v0, s[8:11], s35 offen sc1
    s_add_u32 s16, s16, 1
    s_cmp_gt_u32 s16, 100000
    s_cbranch_scc1 Lr_abort
    s_waitcnt vmcnt(0)
    v_max3_u32 v10, v44, v45, v46
    v_max_u32 v10, v10, v47
    v_cmp_eq_u32 vcc, -1, v10
    s_nop 0
    s_cbranch_vccnz Lr0s_pc_lp
    s_branch Lr0s_pc_ok
Lr0s_last:
    s_waitcnt vmcnt(0) lgkmcnt(0)
    s_barrier
    s_branch Lr_exit
L_w1_0:
    s_cmp_lg_u32 s14, 1
    s_cbranch_scc1 L_w2_0
    s_mov_b32 s16, 0
    s_add_u32 s17, s66, 128
    v_lshrrev_b32 v10, 2, v0
    v_and_b32 v9, 16, v10
    v_lshlrev_b32 v9, 3, v9
    v_and_or_b32 v10, v10, 12, v9
Lr1s_fw_28:
    buffer_load_dword v9, v10, s[8:11], s17 offen sc1
    s_add_u32 s16, s16, 1
    s_cmp_gt_u32 s16, 100000
    s_cbranch_scc1 Lr_abort
    s_waitcnt vmcnt(0)
    v_cmp_eq_u32 vcc, 0, v9
    s_nop 0
    s_cbranch_vccnz Lr1s_fw_28
    s_lshl_b32 s67, s32, 5
    s_add_u32 s67, s67, s15
    s_lshl_b32 s67, s67, 12
    s_add_u32 s67, s67, 3145728
    s_mov_b32 m0, 17152
    s_nop 0
    buffer_load_dwordx4 v0, s[8:11], s41 offen offset:0 lds
    buffer_load_dwordx4 v0, s[8:11], s41 offen offset:1024 lds
    s_add_u32 s41, s41, 262144
    s_add_u32 s68, s68, 262144
    s_waitcnt vmcnt(0)
    ds_read_b128 v[56:59], v8 offset:4096
    ds_read_b128 v[60:63], v8 offset:5120
    ds_read_b128 v[64:67], v8 offset:6144
    ds_read_b128 v[68:71], v8 offset:7168
    v_mov_b64 v[12:13], 0
    v_mov_b64 v[14:15], 0
    v_mov_b64 v[16:17], 0
    v_mov_b64 v[18:19], 0
    v_mov_b64 v[20:21], 0
    v_mov_b64 v[22:23], 0
    v_mov_b64 v[24:25], 0
    v_mov_b64 v[26:27], 0
    v_mov_b64 v[28:29], 0
    v_mov_b64 v[30:31], 0
    v_mov_b64 v[32:33], 0
    v_mov_b64 v[34:35], 0
    buffer_load_dwordx4 v[36:39], v0, s[8:11], s34 offen sc1
    s_waitcnt vmcnt(0) lgkmcnt(0)
Lr1s_step:
    s_waitcnt vmcnt(3)
    v_max3_u32 v10, v36, v37, v38
    v_max_u32 v10, v10, v39
    v_cmp_eq_u32 vcc, -1, v10
    s_nop 0
    s_cbranch_vccz Lr1s_aok
    buffer_load_dwordx4 v[36:39], v0, s[8:11], s34 offen sc1
    s_waitcnt vmcnt(1)
    v_max3_u32 v10, v36, v37, v38
    v_max_u32 v10, v10, v39
    v_cmp_eq_u32 vcc, -1, v10
    s_nop 0
    s_cbranch_vccz Lr1s_aok
    s_mov_b32 s16, 0
Lr1s_alp:
    buffer_load_dwordx4 v[36:39], v0, s[8:11], s34 offen sc1
    s_add_u32 s16, s16, 1
    s_cmp_gt_u32 s16, 100000
    s_cbranch_scc1 Lr_abort
    s_waitcnt vmcnt(1)
    v_max3_u32 v10, v36, v37, v38
    v_max_u32 v10, v10, v39
    v_cmp_eq_u32 vcc, -1, v10
    s_nop 0
    s_cbranch_vccnz Lr1s_alp
Lr1s_aok:
    ds_write_b128 v0, v[36:39] offset:7936
    v_smfmac_f32_16x16x64_bf16 v[12:15], v[36:39], v[88:95], v1
    v_smfmac_f32_16x16x64_bf16 v[16:19], v[36:39], v[96:103], v1
    v_smfmac_f32_16x16x64_bf16 v[20:23], v[36:39], v[200:207], v1
    s_waitcnt lgkmcnt(0)
    s_barrier
    ds_read_b128 v[48:51], v0 offset:8960
    ds_read_b128 v[52:55], v0 offset:9984
    v_smfmac_f32_16x16x64_bf16 v[28:31], v[36:39], a[72:79], v1
    v_smfmac_f32_16x16x64_bf16 v[24:27], v[36:39], v[208:215], v1
    s_add_u32 s17, s34, 4096
    buffer_load_dwordx4 v[40:43], v0, s[8:11], s17 offen sc1
    v_smfmac_f32_16x16x64_bf16 v[32:35], v[36:39], a[80:87], v1
    s_waitcnt vmcnt(1)
    ds_read_b128 v[36:39], v0 offset:6912
    s_waitcnt lgkmcnt(2)
    v_smfmac_f32_16x16x64_bf16 v[28:31], v[48:51], v[56:63], v1
    ds_read_b128 v[56:59], v8 offset:0
    ds_read_b128 v[60:63], v8 offset:1024
    v_smfmac_f32_16x16x64_bf16 v[12:15], v[48:51], v[104:111], v1
    v_smfmac_f32_16x16x64_bf16 v[16:19], v[48:51], v[112:119], v1
    buffer_load_dwordx4 v[44:47], v0, s[8:11], s35 offen sc1
    v_smfmac_f32_16x16x64_bf16 v[32:35], v[48:51], v[64:71], v1
    ds_read_b128 v[64:67], v8 offset:2048
    ds_read_b128 v[68:71], v8 offset:3072
    v_smfmac_f32_16x16x64_bf16 v[20:23], v[48:51], v[216:223], v1
    v_smfmac_f32_16x16x64_bf16 v[24:27], v[48:51], v[224:231], v1
    s_waitcnt lgkmcnt(5)
    v_smfmac_f32_16x16x64_bf16 v[28:31], v[52:55], a[88:95], v1
    v_smfmac_f32_16x16x64_bf16 v[12:15], v[52:55], v[120:127], v1
    v_smfmac_f32_16x16x64_bf16 v[16:19], v[52:55], v[128:135], v1
    v_smfmac_f32_16x16x64_bf16 v[32:35], v[52:55], a[96:103], v1
    v_smfmac_f32_16x16x64_bf16 v[20:23], v[52:55], v[232:239], v1
    v_smfmac_f32_16x16x64_bf16 v[24:27], v[52:55], v[240:247], v1
    s_waitcnt lgkmcnt(2)
    v_smfmac_f32_16x16x64_bf16 v[28:31], v[36:39], v[56:63], v1
    ds_read_b128 v[56:59], v8 offset:12288
    ds_read_b128 v[60:63], v8 offset:13312
    v_smfmac_f32_16x16x64_bf16 v[12:15], v[36:39], v[72:79], v1
    v_smfmac_f32_16x16x64_bf16 v[16:19], v[36:39], v[80:87], v1
    s_waitcnt lgkmcnt(2)
    v_smfmac_f32_16x16x64_bf16 v[32:35], v[36:39], v[64:71], v1
    ds_read_b128 v[64:67], v8 offset:14336
    ds_read_b128 v[68:71], v8 offset:15360
    v_smfmac_f32_16x16x64_bf16 v[20:23], v[36:39], v[184:191], v1
    v_smfmac_f32_16x16x64_bf16 v[24:27], v[36:39], v[192:199], v1
    s_waitcnt vmcnt(1)
    v_max3_u32 v10, v40, v41, v42
    v_max_u32 v10, v10, v43
    v_cmp_eq_u32 vcc, -1, v10
    s_nop 0
    s_cbranch_vccnz Lr1s_pb_re
Lr1s_pb_ok:
    ds_write_b128 v0, v[40:43] offset:12032
    v_mov_b32 v9, 1
    v_mov_b32 v10, 0
    s_mov_b64 exec, 1
    buffer_store_dword v9, v10, s[8:11], s67 offen offset:384 sc1
    s_mov_b64 exec, -1
    v_smfmac_f32_16x16x64_bf16 v[12:15], v[40:43], v[136:143], v1
    v_smfmac_f32_16x16x64_bf16 v[20:23], v[40:43], a[8:15], v1
    v_smfmac_f32_16x16x64_bf16 v[16:19], v[40:43], v[144:151], v1
    v_smfmac_f32_16x16x64_bf16 v[24:27], v[40:43], a[16:23], v1
    s_waitcnt lgkmcnt(0)
    s_barrier
    ds_read_b128 v[48:51], v0 offset:13056
    ds_read_b128 v[52:55], v0 offset:14080
    ds_read_b128 v[36:39], v0 offset:11008
    v_smfmac_f32_16x16x64_bf16 v[28:31], v[40:43], a[120:127], v1
    v_smfmac_f32_16x16x64_bf16 v[32:35], v[40:43], a[128:135], v1
    s_waitcnt lgkmcnt(2)
    v_smfmac_f32_16x16x64_bf16 v[12:15], v[48:51], v[56:63], v1
    ds_read_b128 v[56:59], v8 offset:8192
    ds_read_b128 v[60:63], v8 offset:9216
    v_smfmac_f32_16x16x64_bf16 v[16:19], v[48:51], v[64:71], v1
    ds_read_b128 v[64:67], v8 offset:10240
    ds_read_b128 v[68:71], v8 offset:11264
    s_waitcnt lgkmcnt(5)
    v_smfmac_f32_16x16x64_bf16 v[12:15], v[52:55], v[152:159], v1
    v_smfmac_f32_16x16x64_bf16 v[16:19], v[52:55], v[160:167], v1
    s_waitcnt vmcnt(1)
    v_max3_u32 v10, v44, v45, v46
    v_max_u32 v10, v10, v47
    v_cmp_eq_u32 vcc, -1, v10
    s_nop 0
    s_cbranch_vccnz Lr1s_pc_re
Lr1s_pc_ok:
    v_smfmac_f32_16x16x64_bf16 v[12:15], v[44:47], v[168:175], v1
    v_smfmac_f32_16x16x64_bf16 v[16:19], v[44:47], v[176:183], v1
    s_waitcnt lgkmcnt(2)
    v_smfmac_f32_16x16x64_bf16 v[12:15], v[36:39], v[56:63], v1
    s_waitcnt lgkmcnt(0)
    v_smfmac_f32_16x16x64_bf16 v[16:19], v[36:39], v[64:71], v1
    v_smfmac_f32_16x16x64_bf16 v[20:23], v[48:51], a[24:31], v1
    v_smfmac_f32_16x16x64_bf16 v[24:27], v[48:51], a[32:39], v1
    buffer_load_dwordx4 v[64:67], v0, s[8:11], s42 offen
    v_smfmac_f32_16x16x64_bf16 v[20:23], v[52:55], a[40:47], v1
    v_add_f32 v12, v12, v14
    v_smfmac_f32_16x16x64_bf16 v[24:27], v[52:55], a[48:55], v1
    v_add_f32 v16, v16, v18
    v_smfmac_f32_16x16x64_bf16 v[20:23], v[36:39], v[248:255], v1
    v_add_f32 v13, v13, v15
    v_smfmac_f32_16x16x64_bf16 v[24:27], v[36:39], a[0:7], v1
    v_add_f32 v17, v17, v19
    buffer_load_dwordx4 v[68:71], v0, s[8:11], s42 offen offset:1024
    v_smfmac_f32_16x16x64_bf16 v[20:23], v[44:47], a[56:63], v1
    v_cvt_pk_bf16_f32 v14, v12, v16
    ds_read_b128 v[56:59], v0 offset:15104
    v_smfmac_f32_16x16x64_bf16 v[24:27], v[44:47], a[64:71], v1
    v_cvt_pk_bf16_f32 v15, v13, v17
    ds_read_b128 v[60:63], v0 offset:16128
    ds_write_b32 v2, v14 offset:576
    ds_write_b32 v2, v15 offset:864
    v_smfmac_f32_16x16x64_bf16 v[28:31], v[48:51], a[136:143], v1
    v_smfmac_f32_16x16x64_bf16 v[32:35], v[48:51], a[144:151], v1
    v_add_f32 v20, v20, v22
    v_add_f32 v24, v24, v26
    v_add_f32 v21, v21, v23
    v_add_f32 v25, v25, v27
    v_cvt_pk_bf16_f32 v22, v20, v24
    v_cvt_pk_bf16_f32 v23, v21, v25
    ds_write_b32 v2, v22 offset:0
    ds_write_b32 v2, v23 offset:288
    v_smfmac_f32_16x16x64_bf16 v[28:31], v[52:55], a[152:159], v1
    v_smfmac_f32_16x16x64_bf16 v[32:35], v[52:55], a[160:167], v1
    s_waitcnt lgkmcnt(0)
    s_barrier
    ds_read_b128 v[40:43], v3 offset:0
    ds_read_b128 v[48:51], v3 offset:64
    ds_read_b128 v[20:23], v3 offset:128
    ds_read_b128 v[52:55], v3 offset:192
    v_smfmac_f32_16x16x64_bf16 v[28:31], v[36:39], a[104:111], v1
    v_smfmac_f32_16x16x64_bf16 v[32:35], v[36:39], a[112:119], v1
    ds_read_b128 v[36:39], v0 offset:17152
    v_smfmac_f32_16x16x64_bf16 v[28:31], v[44:47], a[168:175], v1
    v_smfmac_f32_16x16x64_bf16 v[32:35], v[44:47], a[176:183], v1
    ds_read_b128 v[44:47], v0 offset:18176
    s_waitcnt lgkmcnt(5)
    v_mfma_f32_16x16x32_bf16 v[12:15], v[56:59], v[40:43], 0
    v_mfma_f32_16x16x32_bf16 v[16:19], v[60:63], v[40:43], 0
    v_mfma_f32_16x16x32_bf16 v[24:27], v[40:43], v[40:43], 0
    ds_read_b128 v[56:59], v0 offset:19200
    ds_read_b128 v[60:63], v0 offset:20224
    s_waitcnt lgkmcnt(3)
    v_mfma_f32_16x16x32_bf16 v[12:15], v[36:39], v[48:51], v[12:15]
    v_lshrrev_b32 v10, 1, v0
    v_lshrrev_b32 v9, 9, v0
    s_waitcnt lgkmcnt(2)
    v_mfma_f32_16x16x32_bf16 v[16:19], v[44:47], v[48:51], v[16:19]
    v_lshl_add_u32 v9, v9, 5, v10
    v_add_f32 v28, v28, v30
    v_mfma_f32_16x16x32_bf16 v[24:27], v[48:51], v[48:51], v[24:27]
    v_add_f32 v32, v32, v34
    v_add_f32 v29, v29, v31
    ds_read_b128 v[36:39], v0 offset:21248
    ds_read_b128 v[44:47], v0 offset:22272
    s_waitcnt lgkmcnt(3)
    v_mfma_f32_16x16x32_bf16 v[12:15], v[56:59], v[20:23], v[12:15]
    v_add_f32 v33, v33, v35
    v_cvt_pk_bf16_f32 v30, v28, v29
    s_waitcnt lgkmcnt(2)
    v_mfma_f32_16x16x32_bf16 v[16:19], v[60:63], v[20:23], v[16:19]
    v_cvt_pk_bf16_f32 v31, v32, v33
    ds_read_b64 v[34:35], v9 offset:1152
    v_mfma_f32_16x16x32_bf16 v[24:27], v[20:23], v[20:23], v[24:27]
    s_add_u32 s17, s43, 2560
    buffer_store_dwordx2 v[30:31], v10, s[8:11], s17 offen sc1
    s_waitcnt lgkmcnt(2)
    v_mfma_f32_16x16x32_bf16 v[12:15], v[36:39], v[52:55], v[12:15]
    s_waitcnt lgkmcnt(1)
    v_mfma_f32_16x16x32_bf16 v[16:19], v[44:47], v[52:55], v[16:19]
    v_mfma_f32_16x16x32_bf16 v[24:27], v[52:55], v[52:55], v[24:27]
    s_add_u32 s17, s43, 512
    s_waitcnt lgkmcnt(0)
    buffer_store_dwordx2 v[34:35], v10, s[8:11], s17 offen sc1
    ds_read_b128 v[56:59], v8 offset:16384
    ds_read_b128 v[60:63], v8 offset:17408
    v_mov_b64 v[20:21], s[52:53]
    v_mov_b64 v[22:23], s[52:53]
    v_mov_b32 v41, 0
    v_mov_b32 v42, 0
    v_max3_f32 v9, v12, v13, v14
    v_max3_f32 v9, v9, v15, v16
    v_max3_f32 v9, v9, v17, v18
    v_max3_f32 v9, v9, v19, v24
    v_max_f32 v9, v9, v25
    v_mov_b32 v10, v9
    v_mov_b64 v[32:33], 0
    v_mov_b64 v[34:35], 0
    v_permlane32_swap_b32 v9, v10
    v_max_f32 v9, v9, v10
    v_mov_b32 v10, v9
    s_nop 1
    v_permlane16_swap_b32 v9, v10
    v_max_f32 v9, v9, v10
    v_mul_f32 v28, s44, v9
    v_fma_f32 v12, v12, s44, -v28
    v_fma_f32 v13, v13, s44, -v28
    v_fma_f32 v14, v14, s44, -v28
    v_fma_f32 v15, v15, s44, -v28
    v_exp_f32 v12, v12
    v_exp_f32 v13, v13
    v_fma_f32 v16, v16, s44, -v28
    v_fma_f32 v17, v17, s44, -v28
    v_exp_f32 v14, v14
    v_exp_f32 v15, v15
    v_cvt_pk_bf16_f32 v36, v12, v13
    v_fma_f32 v18, v18, s44, -v28
    v_fma_f32 v19, v19, s44, -v28
    v_exp_f32 v16, v16
    v_exp_f32 v17, v17
    v_cvt_pk_bf16_f32 v37, v14, v15
    v_fma_f32 v24, v24, s44, -v28
    v_fma_f32 v25, v25, s44, -v28
    v_exp_f32 v18, v18
    v_exp_f32 v19, v19
    v_cvt_pk_bf16_f32 v38, v16, v17
    v_exp_f32 v24, v24
    v_exp_f32 v25, v25
    v_cvt_pk_bf16_f32 v39, v18, v19
    v_cvt_pk_bf16_f32 v40, v24, v25
    v_cvt_pk_bf16_f32 v43, v24, v25
    v_mfma_f32_16x16x32_bf16 v[52:55], v[20:23], v[36:39], 0
    v_mov_b64 v[12:13], 0
    v_mov_b64 v[14:15], 0
    s_waitcnt vmcnt(3)
    v_mfma_f32_16x16x32_bf16 v[44:47], v[64:67], v[36:39], 0
    v_mov_b64 v[24:25], 0
    v_mov_b64 v[26:27], 0
    s_waitcnt vmcnt(2)
    v_mfma_f32_16x16x32_bf16 v[48:51], v[68:71], v[36:39], 0
    ds_read_b128 v[64:67], v8 offset:20480
    ds_read_b128 v[68:71], v8 offset:21504
    v_mfma_f32_16x16x16_bf16 v[52:55], v[20:21], v[40:41], v[52:55]
    v_mfma_f32_16x16x16_bf16 v[44:47], v[30:31], v[40:41], v[44:47]
    v_mov_b64 v[20:21], 0
    v_mov_b64 v[22:23], 0
    v_mfma_f32_16x16x16_bf16 v[48:51], v[30:31], v[42:43], v[48:51]
    v_mov_b64 v[36:37], 0
    v_mov_b64 v[38:39], 0
    v_mov_b64 v[40:41], 0
    v_mov_b64 v[42:43], 0
    v_rcp_f32 v9, v52
    v_mov_b64 v[52:53], 0
    v_mov_b64 v[54:55], 0
    v_mul_f32 v44, v9, v44
    v_mul_f32 v48, v9, v48
    v_cvt_pk_bf16_f32 v16, v44, v48
    v_mul_f32 v45, v9, v45
    v_mul_f32 v49, v9, v49
    v_cvt_pk_bf16_f32 v17, v45, v49
    v_mul_f32 v46, v9, v46
    v_mul_f32 v50, v9, v50
    v_cvt_pk_bf16_f32 v18, v46, v50
    v_mul_f32 v47, v9, v47
    v_mul_f32 v51, v9, v51
    v_cvt_pk_bf16_f32 v19, v47, v51
    ds_write_b128 v5, v[16:19]
    v_mov_b64 v[28:29], 0
    v_mov_b64 v[30:31], 0
    s_waitcnt lgkmcnt(0)
    s_barrier
    ds_read_b128 v[44:47], v4 offset:0
    ds_read_b128 v[48:51], v4 offset:128
    s_cmp_eq_u32 s33, 63
    s_cbranch_scc1 Lr1s_last
    v_mov_b64 v[16:17], 0
    v_mov_b64 v[18:19], 0
    buffer_load_dwordx4 v0, s[8:11], s41 offen offset:0 lds
    buffer_load_dwordx4 v0, s[8:11], s41 offen offset:1024 lds
    s_waitcnt lgkmcnt(1)
    v_smfmac_f32_16x16x64_bf16 v[12:15], v[44:47], a[184:191], v1
    s_waitcnt lgkmcnt(0)
    v_smfmac_f32_16x16x64_bf16 v[12:15], v[48:51], a[192:199], v1
    v_smfmac_f32_16x16x64_bf16 v[24:27], v[44:47], a[200:207], v1
    v_smfmac_f32_16x16x64_bf16 v[24:27], v[48:51], a[208:215], v1
    v_add_f32 v12, v12, v14
    v_smfmac_f32_16x16x64_bf16 v[20:23], v[44:47], a[216:223], v1
    v_add_f32 v13, v13, v15
    v_smfmac_f32_16x16x64_bf16 v[20:23], v[48:51], a[224:231], v1
    v_cvt_pk_bf16_f32 v12, v12, v13
    v_smfmac_f32_16x16x64_bf16 v[16:19], v[44:47], a[232:239], v1
    v_add_f32 v24, v24, v26
    v_smfmac_f32_16x16x64_bf16 v[16:19], v[48:51], a[240:247], v1
    v_add_f32 v25, v25, v27
    v_smfmac_f32_16x16x64_bf16 v[36:39], v[44:47], v[56:63], v1
    v_cvt_pk_bf16_f32 v13, v24, v25
    v_smfmac_f32_16x16x64_bf16 v[36:39], v[48:51], v[64:71], v1
    v_add_f32 v20, v20, v22
    v_add_f32 v21, v21, v23
    v_cvt_pk_bf16_f32 v14, v20, v21
    v_add_f32 v16, v16, v18
    v_add_f32 v17, v17, v19
    v_cvt_pk_bf16_f32 v15, v16, v17
    v_and_or_b32 v15, v15, -2, s40
    buffer_store_dwordx4 v[12:15], v0, s[8:11], s38 offen sc1
    s_nop 0
    ds_read_b128 v[12:15], v8 offset:18432
    ds_read_b128 v[16:19], v8 offset:19456
    ds_read_b128 v[20:23], v8 offset:22528
    ds_read_b128 v[24:27], v8 offset:23552
    ds_read_b128 v[56:59], v8 offset:24576
    ds_read_b128 v[60:63], v8 offset:25600
    ds_read_b128 v[64:67], v8 offset:28672
    ds_read_b128 v[68:71], v8 offset:29696
    s_waitcnt lgkmcnt(6)
    v_smfmac_f32_16x16x64_bf16 v[40:43], v[44:47], v[12:19], v1
    ds_read_b128 v[12:15], v8 offset:26624
    ds_read_b128 v[16:19], v8 offset:27648
    s_waitcnt lgkmcnt(6)
    v_smfmac_f32_16x16x64_bf16 v[40:43], v[48:51], v[20:27], v1
    ds_read_b128 v[20:23], v8 offset:30720
    ds_read_b128 v[24:27], v8 offset:31744
    s_waitcnt lgkmcnt(6)
    v_smfmac_f32_16x16x64_bf16 v[52:55], v[44:47], v[56:63], v1
    ds_read_b128 v[56:59], v8 offset:32768
    ds_read_b128 v[60:63], v8 offset:33792
    s_waitcnt lgkmcnt(6)
    v_smfmac_f32_16x16x64_bf16 v[52:55], v[48:51], v[64:71], v1
    s_waitcnt lgkmcnt(4)
    v_smfmac_f32_16x16x64_bf16 v[32:35], v[44:47], v[12:19], v1
    s_waitcnt lgkmcnt(2)
    v_smfmac_f32_16x16x64_bf16 v[32:35], v[48:51], v[20:27], v1
    v_smfmac_f32_16x16x64_bf16 v[28:31], v[44:47], a[248:255], v1
    s_waitcnt lgkmcnt(0)
    v_smfmac_f32_16x16x64_bf16 v[28:31], v[48:51], v[56:63], v1
    v_add_f32 v36, v36, v38
    v_add_f32 v37, v37, v39
    v_cvt_pk_bf16_f32 v36, v36, v37
    v_add_f32 v40, v40, v42
    v_add_f32 v41, v41, v43
    v_cvt_pk_bf16_f32 v37, v40, v41
    v_add_f32 v52, v52, v54
    v_add_f32 v53, v53, v55
    v_cvt_pk_bf16_f32 v38, v52, v53
    v_add_f32 v32, v32, v34
    v_add_f32 v33, v33, v35
    v_cvt_pk_bf16_f32 v39, v32, v33
    v_and_or_b32 v39, v39, -2, s40
    s_add_u32 s17, s38, 4096
    buffer_store_dwordx4 v[36:39], v0, s[8:11], s17 offen sc1
    v_add_f32 v28, v28, v30
    v_add_f32 v29, v29, v31
    v_cvt_pk_bf16_f32 v28, v28, v29
    v_and_or_b32 v28, v28, -2, s40
    v_lshrrev_b32 v9, 2, v0
    buffer_store_dword v28, v9, s[8:11], s39 offen sc1
    v_add_u32 v10, 162560, v0
    ds_read_b128 v[64:67], v10
    s_add_u32 s33, s33, 1
    s_add_u32 s42, s42, 262144
    s_add_u32 s41, s41, 262144
    s_add_u32 s43, s43, 131072
    s_mov_b32 s67, s66
    s_add_u32 s68, s68, 262144
    s_add_u32 s66, s66, 22528
    ds_read_b128 v[56:59], v8 offset:4096
    ds_read_b128 v[60:63], v8 offset:5120
    v_mov_b64 v[12:13], 0
    v_mov_b64 v[14:15], 0
    v_mov_b64 v[16:17], 0
    v_mov_b64 v[18:19], 0
    v_mov_b64 v[20:21], 0
    v_mov_b64 v[22:23], 0
    v_mov_b64 v[24:25], 0
    v_mov_b64 v[26:27], 0
    v_mov_b64 v[28:29], 0
    v_mov_b64 v[30:31], 0
    v_mov_b64 v[32:33], 0
    v_mov_b64 v[34:35], 0
    s_nop 15
    s_nop 15
    s_nop 15
    s_nop 11
    buffer_load_dwordx4 v[40:43], v6, s[8:11], s62 offen sc1
    buffer_load_dwordx4 v[44:47], v6, s[8:11], s63 offen sc1
    buffer_load_dwordx4 v[48:51], v6, s[8:11], s64 offen sc1
    buffer_load_dwordx4 v[52:55], v6, s[8:11], s65 offen sc1
    s_waitcnt lgkmcnt(0)
    s_waitcnt vmcnt(3)
    v_mfma_f32_16x16x32_bf16 v[68:71], v[40:43], v[64:67], 0
    v_and_b32 v10, 1, v43
    v_cmp_ne_u32 s[54:55], s40, v10
    s_waitcnt vmcnt(2)
    v_mfma_f32_16x16x32_bf16 v[68:71], v[44:47], v[64:67], v[68:71]
    v_and_b32 v10, 1, v47
    v_cmp_ne_u32 s[56:57], s40, v10
    s_waitcnt vmcnt(1)
    v_mfma_f32_16x16x32_bf16 v[68:71], v[48:51], v[64:67], v[68:71]
    v_and_b32 v10, 1, v51
    v_cmp_ne_u32 s[58:59], s40, v10
    s_waitcnt vmcnt(0)
    v_mfma_f32_16x16x32_bf16 v[68:71], v[52:55], v[64:67], v[68:71]
    v_and_b32 v10, 1, v55
    v_cmp_ne_u32 s[60:61], s40, v10
    s_or_b64 vcc, s[54:55], s[56:57]
    s_or_b64 vcc, vcc, s[58:59]
    s_or_b64 vcc, vcc, s[60:61]
    s_cbranch_scc0 Lr1s_red
    s_mov_b32 s16, 0
Lr1s_p1:
    s_mov_b64 exec, s[54:55]
    buffer_load_dwordx4 v[40:43], v6, s[8:11], s62 offen sc1
    s_mov_b64 exec, s[56:57]
    buffer_load_dwordx4 v[44:47], v6, s[8:11], s63 offen sc1
    s_mov_b64 exec, s[58:59]
    buffer_load_dwordx4 v[48:51], v6, s[8:11], s64 offen sc1
    s_mov_b64 exec, s[60:61]
    buffer_load_dwordx4 v[52:55], v6, s[8:11], s65 offen sc1
    s_mov_b64 exec, -1
    s_add_u32 s16, s16, 1
    s_cmp_gt_u32 s16, 100000
    s_cbranch_scc1 Lr_abort
    s_waitcnt vmcnt(3)
    v_mfma_f32_16x16x32_bf16 v[68:71], v[40:43], v[64:67], 0
    v_and_b32 v10, 1, v43
    v_cmp_ne_u32 s[54:55], s40, v10
    s_waitcnt vmcnt(2)
    v_mfma_f32_16x16x32_bf16 v[68:71], v[44:47], v[64:67], v[68:71]
    v_and_b32 v10, 1, v47
    v_cmp_ne_u32 s[56:57], s40, v10
    s_waitcnt vmcnt(1)
    v_mfma_f32_16x16x32_bf16 v[68:71], v[48:51], v[64:67], v[68:71]
    v_and_b32 v10, 1, v51
    v_cmp_ne_u32 s[58:59], s40, v10
    s_waitcnt vmcnt(0)
    v_mfma_f32_16x16x32_bf16 v[68:71], v[52:55], v[64:67], v[68:71]
    v_and_b32 v10, 1, v55
    v_cmp_ne_u32 s[60:61], s40, v10
    s_or_b64 vcc, s[54:55], s[56:57]
    s_or_b64 vcc, vcc, s[58:59]
    s_or_b64 vcc, vcc, s[60:61]
    s_cbranch_scc1 Lr1s_p1
Lr1s_red:
    s_xor_b32 s34, s34, 16384
    s_xor_b32 s35, s35, 16384
    buffer_load_dwordx4 v[36:39], v0, s[8:11], s34 offen sc1
    v_permlane16_swap_b32 v68, v70
    v_permlane16_swap_b32 v69, v71
    s_mov_b64 exec, s[46:47]
    v_add_f32 v68, v68, v70
    v_add_f32 v69, v69, v71
    v_cvt_pk_bf16_f32 v68, v68, v69
    v_min_u32 v68, s50, v68
    buffer_store_dword v68, v7, s[8:11], s36 offen sc1
    v_mov_b32 v69, -1
    buffer_store_dword v69, v7, s[8:11], s37 offen sc1
    s_mov_b64 exec, -1
    buffer_load_dwordx4 v[36:39], v0, s[8:11], s34 offen sc1
    s_xor_b32 s40, s40, 1
    s_xor_b32 s36, s36, 16384
    s_xor_b32 s37, s37, 16384
    ds_read_b128 v[64:67], v8 offset:6144
    ds_read_b128 v[68:71], v8 offset:7168
    s_waitcnt lgkmcnt(0)
    s_branch Lr1s_step
Lr1s_pb_re:
    s_mov_b32 s16, 0
Lr1s_pb_lp:
    s_add_u32 s17, s34, 4096
    buffer_load_dwordx4 v[40:43], v0, s[8:11], s17 offen sc1
    s_add_u32 s16, s16, 1
    s_cmp_gt_u32 s16, 100000
    s_cbranch_scc1 Lr_abort
    s_waitcnt vmcnt(0)
    v_max3_u32 v10, v40, v41, v42
    v_max_u32 v10, v10, v43
    v_cmp_eq_u32 vcc, -1, v10
    s_nop 0
    s_cbranch_vccnz Lr1s_pb_lp
    s_branch Lr1s_pb_ok
Lr1s_pc_re:
    s_mov_b32 s16, 0
Lr1s_pc_lp:
    buffer_load_dwordx4 v[44:47], v0, s[8:11], s35 offen sc1
    s_add_u32 s16, s16, 1
    s_cmp_gt_u32 s16, 100000
    s_cbranch_scc1 Lr_abort
    s_waitcnt vmcnt(0)
    v_max3_u32 v10, v44, v45, v46
    v_max_u32 v10, v10, v47
    v_cmp_eq_u32 vcc, -1, v10
    s_nop 0
    s_cbranch_vccnz Lr1s_pc_lp
    s_branch Lr1s_pc_ok
Lr1s_last:
    s_waitcnt vmcnt(0) lgkmcnt(0)
    s_barrier
    s_mov_b32 s67, s66
    v_mov_b32 v9, 1
    v_mov_b32 v10, 0
    s_mov_b64 exec, 1
    buffer_store_dword v9, v10, s[8:11], s67 offen offset:384 sc1
    s_mov_b64 exec, -1
    s_branch Lr_exit
L_w2_0:
    s_cmp_lg_u32 s14, 2
    s_cbranch_scc1 L_w3_0
    s_mov_b32 s16, 0
    s_add_u32 s17, s66, 128
    v_lshrrev_b32 v10, 2, v0
    v_and_b32 v9, 16, v10
    v_lshlrev_b32 v9, 3, v9
    v_and_or_b32 v10, v10, 12, v9
Lr2s_fw_29:
    buffer_load_dword v9, v10, s[8:11], s17 offen sc1
    s_add_u32 s16, s16, 1
    s_cmp_gt_u32 s16, 100000
    s_cbranch_scc1 Lr_abort
    s_waitcnt vmcnt(0)
    v_cmp_eq_u32 vcc, 0, v9
    s_nop 0
    s_cbranch_vccnz Lr2s_fw_29
    s_mov_b32 m0, 19200
    s_nop 0
    buffer_load_dwordx4 v0, s[8:11], s41 offen offset:0 lds
    buffer_load_dwordx4 v0, s[8:11], s41 offen offset:1024 lds
    s_add_u32 s41, s41, 262144
    s_add_u32 s68, s68, 262144
    s_waitcnt vmcnt(0)
    ds_read_b128 v[56:59], v8 offset:4096
    ds_read_b128 v[60:63], v8 offset:5120
    ds_read_b128 v[64:67], v8 offset:6144
    ds_read_b128 v[68:71], v8 offset:7168
    v_mov_b64 v[12:13], 0
    v_mov_b64 v[14:15], 0
    v_mov_b64 v[16:17], 0
    v_mov_b64 v[18:19], 0
    v_mov_b64 v[20:21], 0
    v_mov_b64 v[22:23], 0
    v_mov_b64 v[24:25], 0
    v_mov_b64 v[26:27], 0
    v_mov_b64 v[28:29], 0
    v_mov_b64 v[30:31], 0
    v_mov_b64 v[32:33], 0
    v_mov_b64 v[34:35], 0
    buffer_load_dwordx4 v[36:39], v0, s[8:11], s34 offen sc1
    s_waitcnt vmcnt(0) lgkmcnt(0)
Lr2s_step:
    s_waitcnt vmcnt(3)
    v_max3_u32 v10, v36, v37, v38
    v_max_u32 v10, v10, v39
    v_cmp_eq_u32 vcc, -1, v10
    s_nop 0
    s_cbranch_vccz Lr2s_aok
    buffer_load_dwordx4 v[36:39], v0, s[8:11], s34 offen sc1
    s_waitcnt vmcnt(1)
    v_max3_u32 v10, v36, v37, v38
    v_max_u32 v10, v10, v39
    v_cmp_eq_u32 vcc, -1, v10
    s_nop 0
    s_cbranch_vccz Lr2s_aok
    s_mov_b32 s16, 0
Lr2s_alp:
    buffer_load_dwordx4 v[36:39], v0, s[8:11], s34 offen sc1
    s_add_u32 s16, s16, 1
    s_cmp_gt_u32 s16, 100000
    s_cbranch_scc1 Lr_abort
    s_waitcnt vmcnt(1)
    v_max3_u32 v10, v36, v37, v38
    v_max_u32 v10, v10, v39
    v_cmp_eq_u32 vcc, -1, v10
    s_nop 0
    s_cbranch_vccnz Lr2s_alp
Lr2s_aok:
    ds_write_b128 v0, v[36:39] offset:8960
    v_smfmac_f32_16x16x64_bf16 v[12:15], v[36:39], v[104:111], v1
    v_smfmac_f32_16x16x64_bf16 v[16:19], v[36:39], v[112:119], v1
    v_smfmac_f32_16x16x64_bf16 v[20:23], v[36:39], v[216:223], v1
    s_waitcnt lgkmcnt(0)
    s_barrier
    ds_read_b128 v[48:51], v0 offset:9984
    ds_read_b128 v[52:55], v0 offset:6912
    v_smfmac_f32_16x16x64_bf16 v[28:31], v[36:39], v[56:63], v1
    ds_read_b128 v[56:59], v8 offset:0
    ds_read_b128 v[60:63], v8 offset:1024
    v_smfmac_f32_16x16x64_bf16 v[24:27], v[36:39], v[224:231], v1
    v_smfmac_f32_16x16x64_bf16 v[32:35], v[36:39], v[64:71], v1
    ds_read_b128 v[64:67], v8 offset:2048
    ds_read_b128 v[68:71], v8 offset:3072
    s_add_u32 s17, s34, 4096
    buffer_load_dwordx4 v[40:43], v0, s[8:11], s17 offen sc1
    s_waitcnt vmcnt(1)
    ds_read_b128 v[36:39], v0 offset:7936
    s_waitcnt lgkmcnt(6)
    v_smfmac_f32_16x16x64_bf16 v[28:31], v[48:51], a[88:95], v1
    v_smfmac_f32_16x16x64_bf16 v[12:15], v[48:51], v[120:127], v1
    v_smfmac_f32_16x16x64_bf16 v[16:19], v[48:51], v[128:135], v1
    v_smfmac_f32_16x16x64_bf16 v[32:35], v[48:51], a[96:103], v1
    buffer_load_dwordx4 v[44:47], v0, s[8:11], s35 offen sc1
    v_smfmac_f32_16x16x64_bf16 v[20:23], v[48:51], v[232:239], v1
    v_lshrrev_b32 v10, 2, v0
    v_and_b32 v9, 16, v10
    v_lshlrev_b32 v9, 3, v9
    v_and_or_b32 v10, v10, 12, v9
    s_add_u32 s17, s66, 22656
    buffer_load_dword v11, v10, s[8:11], s17 offen sc1
    v_smfmac_f32_16x16x64_bf16 v[24:27], v[48:51], v[240:247], v1
    s_waitcnt lgkmcnt(3)
    v_smfmac_f32_16x16x64_bf16 v[28:31], v[52:55], v[56:63], v1
    ds_read_b128 v[56:59], v8 offset:12288
    ds_read_b128 v[60:63], v8 offset:13312
    v_smfmac_f32_16x16x64_bf16 v[12:15], v[52:55], v[72:79], v1
    v_smfmac_f32_16x16x64_bf16 v[16:19], v[52:55], v[80:87], v1
    s_waitcnt lgkmcnt(3)
    v_smfmac_f32_16x16x64_bf16 v[32:35], v[52:55], v[64:71], v1
    ds_read_b128 v[64:67], v8 offset:14336
    ds_read_b128 v[68:71], v8 offset:15360
    v_smfmac_f32_16x16x64_bf16 v[20:23], v[52:55], v[184:191], v1
    v_smfmac_f32_16x16x64_bf16 v[24:27], v[52:55], v[192:199], v1
    s_waitcnt lgkmcnt(4)
    v_smfmac_f32_16x16x64_bf16 v[28:31], v[36:39], a[72:79], v1
    v_smfmac_f32_16x16x64_bf16 v[12:15], v[36:39], v[88:95], v1
    v_smfmac_f32_16x16x64_bf16 v[16:19], v[36:39], v[96:103], v1
    v_smfmac_f32_16x16x64_bf16 v[32:35], v[36:39], a[80:87], v1
    v_smfmac_f32_16x16x64_bf16 v[20:23], v[36:39], v[200:207], v1
    v_smfmac_f32_16x16x64_bf16 v[24:27], v[36:39], v[208:215], v1
    s_waitcnt vmcnt(2)
    v_max3_u32 v10, v40, v41, v42
    v_max_u32 v10, v10, v43
    v_cmp_eq_u32 vcc, -1, v10
    s_nop 0
    s_cbranch_vccnz Lr2s_pb_re
Lr2s_pb_ok:
    ds_write_b128 v0, v[40:43] offset:13056
    s_waitcnt lgkmcnt(3)
    v_smfmac_f32_16x16x64_bf16 v[12:15], v[40:43], v[56:63], v1
    ds_read_b128 v[56:59], v8 offset:8192
    ds_read_b128 v[60:63], v8 offset:9216
    v_smfmac_f32_16x16x64_bf16 v[20:23], v[40:43], a[24:31], v1
    s_waitcnt lgkmcnt(3)
    v_smfmac_f32_16x16x64_bf16 v[16:19], v[40:43], v[64:71], v1
    ds_read_b128 v[64:67], v8 offset:10240
    ds_read_b128 v[68:71], v8 offset:11264
    v_smfmac_f32_16x16x64_bf16 v[24:27], v[40:43], a[32:39], v1
    s_waitcnt lgkmcnt(4)
    s_barrier
    ds_read_b128 v[48:51], v0 offset:11008
    ds_read_b128 v[52:55], v0 offset:14080
    ds_read_b128 v[36:39], v0 offset:12032
    v_smfmac_f32_16x16x64_bf16 v[28:31], v[40:43], a[136:143], v1
    v_smfmac_f32_16x16x64_bf16 v[32:35], v[40:43], a[144:151], v1
    s_waitcnt lgkmcnt(2)
    v_smfmac_f32_16x16x64_bf16 v[12:15], v[48:51], v[56:63], v1
    v_smfmac_f32_16x16x64_bf16 v[16:19], v[48:51], v[64:71], v1
    s_waitcnt lgkmcnt(1)
    v_smfmac_f32_16x16x64_bf16 v[12:15], v[52:55], v[152:159], v1
    v_smfmac_f32_16x16x64_bf16 v[16:19], v[52:55], v[160:167], v1
    s_waitcnt lgkmcnt(0)
    v_smfmac_f32_16x16x64_bf16 v[12:15], v[36:39], v[136:143], v1
    v_smfmac_f32_16x16x64_bf16 v[16:19], v[36:39], v[144:151], v1
    s_waitcnt vmcnt(1)
    v_max3_u32 v10, v44, v45, v46
    v_max_u32 v10, v10, v47
    v_cmp_eq_u32 vcc, -1, v10
    s_nop 0
    s_cbranch_vccnz Lr2s_pc_re
Lr2s_pc_ok:
    v_smfmac_f32_16x16x64_bf16 v[12:15], v[44:47], v[168:175], v1
    v_smfmac_f32_16x16x64_bf16 v[16:19], v[44:47], v[176:183], v1
    v_smfmac_f32_16x16x64_bf16 v[20:23], v[48:51], v[248:255], v1
    v_smfmac_f32_16x16x64_bf16 v[24:27], v[48:51], a[0:7], v1
    v_smfmac_f32_16x16x64_bf16 v[20:23], v[52:55], a[40:47], v1
    v_add_f32 v12, v12, v14
    buffer_load_dwordx4 v[64:67], v0, s[8:11], s42 offen
    v_smfmac_f32_16x16x64_bf16 v[24:27], v[52:55], a[48:55], v1
    v_add_f32 v16, v16, v18
    v_smfmac_f32_16x16x64_bf16 v[20:23], v[36:39], a[8:15], v1
    v_add_f32 v13, v13, v15
    v_smfmac_f32_16x16x64_bf16 v[24:27], v[36:39], a[16:23], v1
    v_add_f32 v17, v17, v19
    v_smfmac_f32_16x16x64_bf16 v[20:23], v[44:47], a[56:63], v1
    v_cvt_pk_bf16_f32 v14, v12, v16
    ds_read_b128 v[56:59], v0 offset:15104
    buffer_load_dwordx4 v[68:71], v0, s[8:11], s42 offen offset:1024
    v_smfmac_f32_16x16x64_bf16 v[24:27], v[44:47], a[64:71], v1
    v_cvt_pk_bf16_f32 v15, v13, v17
    ds_read_b128 v[60:63], v0 offset:16128
    ds_write_b32 v2, v14 offset:576
    ds_write_b32 v2, v15 offset:864
    v_smfmac_f32_16x16x64_bf16 v[28:31], v[48:51], a[104:111], v1
    v_smfmac_f32_16x16x64_bf16 v[32:35], v[48:51], a[112:119], v1
    v_add_f32 v20, v20, v22
    v_add_f32 v24, v24, v26
    v_add_f32 v21, v21, v23
    v_add_f32 v25, v25, v27
    v_cvt_pk_bf16_f32 v22, v20, v24
    v_cvt_pk_bf16_f32 v23, v21, v25
    ds_write_b32 v2, v22 offset:0
    ds_write_b32 v2, v23 offset:288
    v_smfmac_f32_16x16x64_bf16 v[28:31], v[52:55], a[152:159], v1
    v_smfmac_f32_16x16x64_bf16 v[32:35], v[52:55], a[160:167], v1
    s_waitcnt vmcnt(2)
    v_cmp_eq_u32 vcc, 0, v11
    s_nop 0
    s_cbranch_vccnz Lr2s_flbad
Lr2s_flok:
    s_waitcnt lgkmcnt(0)
    s_barrier
    ds_read_b128 v[40:43], v3 offset:0
    ds_read_b128 v[48:51], v3 offset:64
    ds_read_b128 v[20:23], v3 offset:128
    ds_read_b128 v[52:55], v3 offset:192
    v_smfmac_f32_16x16x64_bf16 v[28:31], v[36:39], a[120:127], v1
    v_smfmac_f32_16x16x64_bf16 v[32:35], v[36:39], a[128:135], v1
    ds_read_b128 v[36:39], v0 offset:17152
    v_smfmac_f32_16x16x64_bf16 v[28:31], v[44:47], a[168:175], v1
    v_smfmac_f32_16x16x64_bf16 v[32:35], v[44:47], a[176:183], v1
    ds_read_b128 v[44:47], v0 offset:18176
    s_waitcnt lgkmcnt(5)
    v_mfma_f32_16x16x32_bf16 v[12:15], v[56:59], v[40:43], 0
    v_mfma_f32_16x16x32_bf16 v[16:19], v[60:63], v[40:43], 0
    v_mfma_f32_16x16x32_bf16 v[24:27], v[40:43], v[40:43], 0
    ds_read_b128 v[56:59], v0 offset:19200
    ds_read_b128 v[60:63], v0 offset:20224
    s_waitcnt lgkmcnt(3)
    v_mfma_f32_16x16x32_bf16 v[12:15], v[36:39], v[48:51], v[12:15]
    v_lshrrev_b32 v10, 1, v0
    v_lshrrev_b32 v9, 9, v0
    s_waitcnt lgkmcnt(2)
    v_mfma_f32_16x16x32_bf16 v[16:19], v[44:47], v[48:51], v[16:19]
    v_lshl_add_u32 v9, v9, 5, v10
    v_add_f32 v28, v28, v30
    v_mfma_f32_16x16x32_bf16 v[24:27], v[48:51], v[48:51], v[24:27]
    v_add_f32 v32, v32, v34
    v_add_f32 v29, v29, v31
    ds_read_b128 v[36:39], v0 offset:21248
    ds_read_b128 v[44:47], v0 offset:22272
    s_waitcnt lgkmcnt(3)
    v_mfma_f32_16x16x32_bf16 v[12:15], v[56:59], v[20:23], v[12:15]
    v_add_f32 v33, v33, v35
    v_cvt_pk_bf16_f32 v30, v28, v29
    s_waitcnt lgkmcnt(2)
    v_mfma_f32_16x16x32_bf16 v[16:19], v[60:63], v[20:23], v[16:19]
    v_cvt_pk_bf16_f32 v31, v32, v33
    ds_read_b64 v[34:35], v9 offset:2304
    v_mfma_f32_16x16x32_bf16 v[24:27], v[20:23], v[20:23], v[24:27]
    s_add_u32 s17, s43, 3072
    buffer_store_dwordx2 v[30:31], v10, s[8:11], s17 offen sc1
    s_waitcnt lgkmcnt(2)
    v_mfma_f32_16x16x32_bf16 v[12:15], v[36:39], v[52:55], v[12:15]
    s_waitcnt lgkmcnt(1)
    v_mfma_f32_16x16x32_bf16 v[16:19], v[44:47], v[52:55], v[16:19]
    v_mfma_f32_16x16x32_bf16 v[24:27], v[52:55], v[52:55], v[24:27]
    s_add_u32 s17, s43, 1024
    s_waitcnt lgkmcnt(0)
    buffer_store_dwordx2 v[34:35], v10, s[8:11], s17 offen sc1
    ds_read_b128 v[56:59], v8 offset:16384
    ds_read_b128 v[60:63], v8 offset:17408
    v_mov_b64 v[20:21], s[52:53]
    v_mov_b64 v[22:23], s[52:53]
    v_mov_b32 v41, 0
    v_mov_b32 v42, 0
    v_max3_f32 v9, v12, v13, v14
    v_max3_f32 v9, v9, v15, v16
    v_max3_f32 v9, v9, v17, v18
    v_max3_f32 v9, v9, v19, v24
    v_max_f32 v9, v9, v25
    v_mov_b32 v10, v9
    v_mov_b64 v[32:33], 0
    v_mov_b64 v[34:35], 0
    v_permlane32_swap_b32 v9, v10
    v_max_f32 v9, v9, v10
    v_mov_b32 v10, v9
    s_nop 1
    v_permlane16_swap_b32 v9, v10
    v_max_f32 v9, v9, v10
    v_mul_f32 v28, s44, v9
    v_fma_f32 v12, v12, s44, -v28
    v_fma_f32 v13, v13, s44, -v28
    v_fma_f32 v14, v14, s44, -v28
    v_fma_f32 v15, v15, s44, -v28
    v_exp_f32 v12, v12
    v_exp_f32 v13, v13
    v_fma_f32 v16, v16, s44, -v28
    v_fma_f32 v17, v17, s44, -v28
    v_exp_f32 v14, v14
    v_exp_f32 v15, v15
    v_cvt_pk_bf16_f32 v36, v12, v13
    v_fma_f32 v18, v18, s44, -v28
    v_fma_f32 v19, v19, s44, -v28
    v_exp_f32 v16, v16
    v_exp_f32 v17, v17
    v_cvt_pk_bf16_f32 v37, v14, v15
    v_fma_f32 v24, v24, s44, -v28
    v_fma_f32 v25, v25, s44, -v28
    v_exp_f32 v18, v18
    v_exp_f32 v19, v19
    v_cvt_pk_bf16_f32 v38, v16, v17
    v_exp_f32 v24, v24
    v_exp_f32 v25, v25
    v_cvt_pk_bf16_f32 v39, v18, v19
    v_cvt_pk_bf16_f32 v40, v24, v25
    v_cvt_pk_bf16_f32 v43, v24, v25
    v_mfma_f32_16x16x32_bf16 v[52:55], v[20:23], v[36:39], 0
    v_mov_b64 v[12:13], 0
    v_mov_b64 v[14:15], 0
    s_waitcnt vmcnt(3)
    v_mfma_f32_16x16x32_bf16 v[44:47], v[64:67], v[36:39], 0
    v_mov_b64 v[24:25], 0
    v_mov_b64 v[26:27], 0
    s_waitcnt vmcnt(2)
    v_mfma_f32_16x16x32_bf16 v[48:51], v[68:71], v[36:39], 0
    ds_read_b128 v[64:67], v8 offset:20480
    ds_read_b128 v[68:71], v8 offset:21504
    v_mfma_f32_16x16x16_bf16 v[52:55], v[20:21], v[40:41], v[52:55]
    v_mfma_f32_16x16x16_bf16 v[44:47], v[30:31], v[40:41], v[44:47]
    v_mov_b64 v[20:21], 0
    v_mov_b64 v[22:23], 0
    v_mfma_f32_16x16x16_bf16 v[48:51], v[30:31], v[42:43], v[48:51]
    v_mov_b64 v[36:37], 0
    v_mov_b64 v[38:39], 0
    v_mov_b64 v[40:41], 0
    v_mov_b64 v[42:43], 0
    v_rcp_f32 v9, v52
    v_mov_b64 v[52:53], 0
    v_mov_b64 v[54:55], 0
    v_mul_f32 v44, v9, v44
    v_mul_f32 v48, v9, v48
    v_cvt_pk_bf16_f32 v16, v44, v48
    v_mul_f32 v45, v9, v45
    v_mul_f32 v49, v9, v49
    v_cvt_pk_bf16_f32 v17, v45, v49
    v_mul_f32 v46, v9, v46
    v_mul_f32 v50, v9, v50
    v_cvt_pk_bf16_f32 v18, v46, v50
    v_mul_f32 v47, v9, v47
    v_mul_f32 v51, v9, v51
    v_cvt_pk_bf16_f32 v19, v47, v51
    ds_write_b128 v5, v[16:19]
    v_mov_b64 v[28:29], 0
    v_mov_b64 v[30:31], 0
    s_waitcnt lgkmcnt(0)
    s_barrier
    ds_read_b128 v[44:47], v4 offset:0
    ds_read_b128 v[48:51], v4 offset:128
    s_cmp_eq_u32 s33, 63
    s_cbranch_scc1 Lr2s_last
    v_mov_b64 v[16:17], 0
    v_mov_b64 v[18:19], 0
    buffer_load_dwordx4 v0, s[8:11], s41 offen offset:0 lds
    buffer_load_dwordx4 v0, s[8:11], s41 offen offset:1024 lds
    s_waitcnt lgkmcnt(1)
    v_smfmac_f32_16x16x64_bf16 v[12:15], v[44:47], a[184:191], v1
    s_waitcnt lgkmcnt(0)
    v_smfmac_f32_16x16x64_bf16 v[12:15], v[48:51], a[192:199], v1
    v_smfmac_f32_16x16x64_bf16 v[24:27], v[44:47], a[200:207], v1
    v_smfmac_f32_16x16x64_bf16 v[24:27], v[48:51], a[208:215], v1
    v_add_f32 v12, v12, v14
    v_smfmac_f32_16x16x64_bf16 v[20:23], v[44:47], a[216:223], v1
    v_add_f32 v13, v13, v15
    v_smfmac_f32_16x16x64_bf16 v[20:23], v[48:51], a[224:231], v1
    v_cvt_pk_bf16_f32 v12, v12, v13
    v_smfmac_f32_16x16x64_bf16 v[16:19], v[44:47], a[232:239], v1
    v_add_f32 v24, v24, v26
    v_smfmac_f32_16x16x64_bf16 v[16:19], v[48:51], a[240:247], v1
    v_add_f32 v25, v25, v27
    v_smfmac_f32_16x16x64_bf16 v[36:39], v[44:47], v[56:63], v1
    v_cvt_pk_bf16_f32 v13, v24, v25
    v_smfmac_f32_16x16x64_bf16 v[36:39], v[48:51], v[64:71], v1
    v_add_f32 v20, v20, v22
    v_add_f32 v21, v21, v23
    v_cvt_pk_bf16_f32 v14, v20, v21
    v_add_f32 v16, v16, v18
    v_add_f32 v17, v17, v19
    v_cvt_pk_bf16_f32 v15, v16, v17
    v_and_or_b32 v15, v15, -2, s40
    buffer_store_dwordx4 v[12:15], v0, s[8:11], s38 offen sc1
    s_nop 0
    ds_read_b128 v[12:15], v8 offset:18432
    ds_read_b128 v[16:19], v8 offset:19456
    ds_read_b128 v[20:23], v8 offset:22528
    ds_read_b128 v[24:27], v8 offset:23552
    ds_read_b128 v[56:59], v8 offset:24576
    ds_read_b128 v[60:63], v8 offset:25600
    ds_read_b128 v[64:67], v8 offset:28672
    ds_read_b128 v[68:71], v8 offset:29696
    s_waitcnt lgkmcnt(6)
    v_smfmac_f32_16x16x64_bf16 v[40:43], v[44:47], v[12:19], v1
    ds_read_b128 v[12:15], v8 offset:26624
    ds_read_b128 v[16:19], v8 offset:27648
    s_waitcnt lgkmcnt(6)
    v_smfmac_f32_16x16x64_bf16 v[40:43], v[48:51], v[20:27], v1
    ds_read_b128 v[20:23], v8 offset:30720
    ds_read_b128 v[24:27], v8 offset:31744
    s_waitcnt lgkmcnt(6)
    v_smfmac_f32_16x16x64_bf16 v[52:55], v[44:47], v[56:63], v1
    ds_read_b128 v[56:59], v8 offset:32768
    ds_read_b128 v[60:63], v8 offset:33792
    s_waitcnt lgkmcnt(6)
    v_smfmac_f32_16x16x64_bf16 v[52:55], v[48:51], v[64:71], v1
    s_waitcnt lgkmcnt(4)
    v_smfmac_f32_16x16x64_bf16 v[32:35], v[44:47], v[12:19], v1
    s_waitcnt lgkmcnt(2)
    v_smfmac_f32_16x16x64_bf16 v[32:35], v[48:51], v[20:27], v1
    v_smfmac_f32_16x16x64_bf16 v[28:31], v[44:47], a[248:255], v1
    s_waitcnt lgkmcnt(0)
    v_smfmac_f32_16x16x64_bf16 v[28:31], v[48:51], v[56:63], v1
    v_add_f32 v36, v36, v38
    v_add_f32 v37, v37, v39
    v_cvt_pk_bf16_f32 v36, v36, v37
    v_add_f32 v40, v40, v42
    v_add_f32 v41, v41, v43
    v_cvt_pk_bf16_f32 v37, v40, v41
    v_add_f32 v52, v52, v54
    v_add_f32 v53, v53, v55
    v_cvt_pk_bf16_f32 v38, v52, v53
    v_add_f32 v32, v32, v34
    v_add_f32 v33, v33, v35
    v_cvt_pk_bf16_f32 v39, v32, v33
    v_and_or_b32 v39, v39, -2, s40
    s_add_u32 s17, s38, 4096
    buffer_store_dwordx4 v[36:39], v0, s[8:11], s17 offen sc1
    v_add_f32 v28, v28, v30
    v_add_f32 v29, v29, v31
    v_cvt_pk_bf16_f32 v28, v28, v29
    v_and_or_b32 v28, v28, -2, s40
    v_lshrrev_b32 v9, 2, v0
    buffer_store_dword v28, v9, s[8:11], s39 offen sc1
    v_add_u32 v10, 162560, v0
    ds_read_b32 v64, v10
    v_mov_b32 v65, 0
    v_mov_b32 v41, 0
    v_mov_b32 v45, 0
    v_mov_b32 v49, 0
    v_mov_b32 v53, 0
    s_add_u32 s33, s33, 1
    s_add_u32 s42, s42, 262144
    s_add_u32 s41, s41, 262144
    s_add_u32 s43, s43, 131072
    s_add_u32 s68, s68, 262144
    s_add_u32 s66, s66, 22528
    ds_read_b128 v[56:59], v8 offset:4096
    ds_read_b128 v[60:63], v8 offset:5120
    v_mov_b64 v[12:13], 0
    v_mov_b64 v[14:15], 0
    v_mov_b64 v[16:17], 0
    v_mov_b64 v[18:19], 0
    v_mov_b64 v[20:21], 0
    v_mov_b64 v[22:23], 0
    v_mov_b64 v[24:25], 0
    v_mov_b64 v[26:27], 0
    v_mov_b64 v[28:29], 0
    v_mov_b64 v[30:31], 0
    v_mov_b64 v[32:33], 0
    v_mov_b64 v[34:35], 0
    s_nop 15
    s_nop 15
    s_nop 15
    s_nop 1
    buffer_load_dword v40, v6, s[8:11], s62 offen sc1
    buffer_load_dword v44, v6, s[8:11], s63 offen sc1
    buffer_load_dword v48, v6, s[8:11], s64 offen sc1
    buffer_load_dword v52, v6, s[8:11], s65 offen sc1
    s_waitcnt lgkmcnt(0)
    s_waitcnt vmcnt(3)
    v_mfma_f32_16x16x16_bf16 v[68:71], v[40:41], v[64:65], 0
    v_and_b32 v10, 1, v40
    v_cmp_ne_u32 s[54:55], s40, v10
    s_waitcnt vmcnt(2)
    v_mfma_f32_16x16x16_bf16 v[68:71], v[44:45], v[64:65], v[68:71]
    v_and_b32 v10, 1, v44
    v_cmp_ne_u32 s[56:57], s40, v10
    s_waitcnt vmcnt(1)
    v_mfma_f32_16x16x16_bf16 v[68:71], v[48:49], v[64:65], v[68:71]
    v_and_b32 v10, 1, v48
    v_cmp_ne_u32 s[58:59], s40, v10
    s_waitcnt vmcnt(0)
    v_mfma_f32_16x16x16_bf16 v[68:71], v[52:53], v[64:65], v[68:71]
    v_and_b32 v10, 1, v52
    v_cmp_ne_u32 s[60:61], s40, v10
    s_or_b64 vcc, s[54:55], s[56:57]
    s_or_b64 vcc, vcc, s[58:59]
    s_or_b64 vcc, vcc, s[60:61]
    s_cbranch_scc0 Lr2s_red
    s_mov_b32 s16, 0
Lr2s_p1:
    s_mov_b64 exec, s[54:55]
    buffer_load_dword v40, v6, s[8:11], s62 offen sc1
    s_mov_b64 exec, s[56:57]
    buffer_load_dword v44, v6, s[8:11], s63 offen sc1
    s_mov_b64 exec, s[58:59]
    buffer_load_dword v48, v6, s[8:11], s64 offen sc1
    s_mov_b64 exec, s[60:61]
    buffer_load_dword v52, v6, s[8:11], s65 offen sc1
    s_mov_b64 exec, -1
    s_add_u32 s16, s16, 1
    s_cmp_gt_u32 s16, 100000
    s_cbranch_scc1 Lr_abort
    s_waitcnt vmcnt(3)
    v_mfma_f32_16x16x16_bf16 v[68:71], v[40:41], v[64:65], 0
    v_and_b32 v10, 1, v40
    v_cmp_ne_u32 s[54:55], s40, v10
    s_waitcnt vmcnt(2)
    v_mfma_f32_16x16x16_bf16 v[68:71], v[44:45], v[64:65], v[68:71]
    v_and_b32 v10, 1, v44
    v_cmp_ne_u32 s[56:57], s40, v10
    s_waitcnt vmcnt(1)
    v_mfma_f32_16x16x16_bf16 v[68:71], v[48:49], v[64:65], v[68:71]
    v_and_b32 v10, 1, v48
    v_cmp_ne_u32 s[58:59], s40, v10
    s_waitcnt vmcnt(0)
    v_mfma_f32_16x16x16_bf16 v[68:71], v[52:53], v[64:65], v[68:71]
    v_and_b32 v10, 1, v52
    v_cmp_ne_u32 s[60:61], s40, v10
    s_or_b64 vcc, s[54:55], s[56:57]
    s_or_b64 vcc, vcc, s[58:59]
    s_or_b64 vcc, vcc, s[60:61]
    s_cbranch_scc1 Lr2s_p1
Lr2s_red:
    s_xor_b32 s34, s34, 16384
    s_xor_b32 s35, s35, 16384
    buffer_load_dwordx4 v[36:39], v0, s[8:11], s34 offen sc1
    v_permlane16_swap_b32 v68, v70
    v_permlane16_swap_b32 v69, v71
    s_mov_b64 exec, s[46:47]
    v_add_f32 v68, v68, v70
    v_add_f32 v69, v69, v71
    v_cvt_pk_bf16_f32 v68, v68, v69
    v_min_u32 v68, s50, v68
    buffer_store_dword v68, v7, s[8:11], s36 offen sc1
    v_mov_b32 v69, -1
    buffer_store_dword v69, v7, s[8:11], s37 offen sc1
    s_mov_b64 exec, -1
    buffer_load_dwordx4 v[36:39], v0, s[8:11], s34 offen sc1
    s_xor_b32 s40, s40, 1
    s_xor_b32 s36, s36, 16384
    s_xor_b32 s37, s37, 16384
    ds_read_b128 v[64:67], v8 offset:6144
    ds_read_b128 v[68:71], v8 offset:7168
    s_waitcnt lgkmcnt(0)
    s_branch Lr2s_step
Lr2s_pb_re:
    s_mov_b32 s16, 0
Lr2s_pb_lp:
    s_add_u32 s17, s34, 4096
    buffer_load_dwordx4 v[40:43], v0, s[8:11], s17 offen sc1
    s_add_u32 s16, s16, 1
    s_cmp_gt_u32 s16, 100000
    s_cbranch_scc1 Lr_abort
    s_waitcnt vmcnt(0)
    v_max3_u32 v10, v40, v41, v42
    v_max_u32 v10, v10, v43
    v_cmp_eq_u32 vcc, -1, v10
    s_nop 0
    s_cbranch_vccnz Lr2s_pb_lp
    s_branch Lr2s_pb_ok
Lr2s_pc_re:
    s_mov_b32 s16, 0
Lr2s_pc_lp:
    buffer_load_dwordx4 v[44:47], v0, s[8:11], s35 offen sc1
    s_add_u32 s16, s16, 1
    s_cmp_gt_u32 s16, 100000
    s_cbranch_scc1 Lr_abort
    s_waitcnt vmcnt(0)
    v_max3_u32 v10, v44, v45, v46
    v_max_u32 v10, v10, v47
    v_cmp_eq_u32 vcc, -1, v10
    s_nop 0
    s_cbranch_vccnz Lr2s_pc_lp
    s_branch Lr2s_pc_ok
Lr2s_flbad:
    s_cmp_eq_u32 s33, 63
    s_cbranch_scc1 Lr2s_flok
    s_mov_b32 s16, 0
    s_add_u32 s17, s66, 22656
    v_lshrrev_b32 v10, 2, v0
    v_and_b32 v9, 16, v10
    v_lshlrev_b32 v9, 3, v9
    v_and_or_b32 v10, v10, 12, v9
Lr2s_fw_30:
    buffer_load_dword v9, v10, s[8:11], s17 offen sc1
    s_add_u32 s16, s16, 1
    s_cmp_gt_u32 s16, 100000
    s_cbranch_scc1 Lr_abort
    s_waitcnt vmcnt(0)
    v_cmp_eq_u32 vcc, 0, v9
    s_nop 0
    s_cbranch_vccnz Lr2s_fw_30
    s_branch Lr2s_flok
Lr2s_last:
    s_waitcnt vmcnt(0) lgkmcnt(0)
    s_barrier
    s_branch Lr_exit
L_w3_0:
    s_mov_b32 s16, 0
    s_add_u32 s17, s66, 128
    v_lshrrev_b32 v10, 2, v0
    v_and_b32 v9, 16, v10
    v_lshlrev_b32 v9, 3, v9
    v_and_or_b32 v10, v10, 12, v9
Lr3s_fw_31:
    buffer_load_dword v9, v10, s[8:11], s17 offen sc1
    s_add_u32 s16, s16, 1
    s_cmp_gt_u32 s16, 100000
    s_cbranch_scc1 Lr_abort
    s_waitcnt vmcnt(0)
    v_cmp_eq_u32 vcc, 0, v9
    s_nop 0
    s_cbranch_vccnz Lr3s_fw_31
    s_mov_b32 m0, 21248
    s_nop 0
    buffer_load_dwordx4 v0, s[8:11], s41 offen offset:0 lds
    buffer_load_dwordx4 v0, s[8:11], s41 offen offset:1024 lds
    s_add_u32 s41, s41, 262144
    s_add_u32 s68, s68, 262144
    s_waitcnt vmcnt(0)
    ds_read_b128 v[56:59], v8 offset:0
    ds_read_b128 v[60:63], v8 offset:1024
    ds_read_b128 v[64:67], v8 offset:2048
    ds_read_b128 v[68:71], v8 offset:3072
    v_mov_b64 v[12:13], 0
    v_mov_b64 v[14:15], 0
    v_mov_b64 v[16:17], 0
    v_mov_b64 v[18:19], 0
    v_mov_b64 v[20:21], 0
    v_mov_b64 v[22:23], 0
    v_mov_b64 v[24:25], 0
    v_mov_b64 v[26:27], 0
    v_mov_b64 v[28:29], 0
    v_mov_b64 v[30:31], 0
    v_mov_b64 v[32:33], 0
    v_mov_b64 v[34:35], 0
    buffer_load_dwordx4 v[36:39], v0, s[8:11], s34 offen sc1
    s_waitcnt vmcnt(0) lgkmcnt(0)
Lr3s_step:
    s_waitcnt vmcnt(2)
    v_max3_u32 v10, v36, v37, v38
    v_max_u32 v10, v10, v39
    v_cmp_eq_u32 vcc, -1, v10
    s_nop 0
    s_cbranch_vccz Lr3s_aok
    s_waitcnt vmcnt(1)
    v_max3_u32 v10, v36, v37, v38
    v_max_u32 v10, v10, v39
    v_cmp_eq_u32 vcc, -1, v10
    s_nop 0
    s_cbranch_vccz Lr3s_aok
    s_mov_b32 s16, 0
Lr3s_alp:
    buffer_load_dwordx4 v[36:39], v0, s[8:11], s34 offen sc1
    s_add_u32 s16, s16, 1
    s_cmp_gt_u32 s16, 100000
    s_cbranch_scc1 Lr_abort
    s_waitcnt vmcnt(1)
    v_max3_u32 v10, v36, v37, v38
    v_max_u32 v10, v10, v39
    v_cmp_eq_u32 vcc, -1, v10
    s_nop 0
    s_cbranch_vccnz Lr3s_alp
Lr3s_aok:
    ds_write_b128 v0, v[36:39] offset:9984
    v_smfmac_f32_16x16x64_bf16 v[12:15], v[36:39], v[120:127], v1
    v_smfmac_f32_16x16x64_bf16 v[16:19], v[36:39], v[128:135], v1
    v_smfmac_f32_16x16x64_bf16 v[20:23], v[36:39], v[232:239], v1
    s_waitcnt lgkmcnt(0)
    s_barrier
    ds_read_b128 v[48:51], v0 offset:6912
    ds_read_b128 v[52:55], v0 offset:7936
    v_smfmac_f32_16x16x64_bf16 v[28:31], v[36:39], a[88:95], v1
    v_smfmac_f32_16x16x64_bf16 v[24:27], v[36:39], v[240:247], v1
    v_smfmac_f32_16x16x64_bf16 v[32:35], v[36:39], a[96:103], v1
    s_waitcnt vmcnt(0)
    ds_read_b128 v[36:39], v0 offset:8960
    s_waitcnt lgkmcnt(2)
    v_smfmac_f32_16x16x64_bf16 v[28:31], v[48:51], v[56:63], v1
    ds_read_b128 v[56:59], v8 offset:4096
    ds_read_b128 v[60:63], v8 offset:5120
    s_add_u32 s17, s34, 4096
    buffer_load_dwordx4 v[40:43], v0, s[8:11], s17 offen sc1
    v_smfmac_f32_16x16x64_bf16 v[12:15], v[48:51], v[72:79], v1
    v_smfmac_f32_16x16x64_bf16 v[16:19], v[48:51], v[80:87], v1
    v_smfmac_f32_16x16x64_bf16 v[32:35], v[48:51], v[64:71], v1
    ds_read_b128 v[64:67], v8 offset:6144
    ds_read_b128 v[68:71], v8 offset:7168
    v_smfmac_f32_16x16x64_bf16 v[20:23], v[48:51], v[184:191], v1
    buffer_load_dwordx4 v[44:47], v0, s[8:11], s35 offen sc1
    v_smfmac_f32_16x16x64_bf16 v[24:27], v[48:51], v[192:199], v1
    s_waitcnt lgkmcnt(5)
    v_smfmac_f32_16x16x64_bf16 v[28:31], v[52:55], a[72:79], v1
    v_smfmac_f32_16x16x64_bf16 v[12:15], v[52:55], v[88:95], v1
    v_smfmac_f32_16x16x64_bf16 v[16:19], v[52:55], v[96:103], v1
    v_smfmac_f32_16x16x64_bf16 v[32:35], v[52:55], a[80:87], v1
    v_smfmac_f32_16x16x64_bf16 v[20:23], v[52:55], v[200:207], v1
    v_smfmac_f32_16x16x64_bf16 v[24:27], v[52:55], v[208:215], v1
    s_waitcnt lgkmcnt(2)
    v_smfmac_f32_16x16x64_bf16 v[28:31], v[36:39], v[56:63], v1
    ds_read_b128 v[56:59], v8 offset:8192
    ds_read_b128 v[60:63], v8 offset:9216
    v_smfmac_f32_16x16x64_bf16 v[12:15], v[36:39], v[104:111], v1
    v_smfmac_f32_16x16x64_bf16 v[16:19], v[36:39], v[112:119], v1
    s_waitcnt lgkmcnt(2)
    v_smfmac_f32_16x16x64_bf16 v[32:35], v[36:39], v[64:71], v1
    ds_read_b128 v[64:67], v8 offset:10240
    ds_read_b128 v[68:71], v8 offset:11264
    v_smfmac_f32_16x16x64_bf16 v[20:23], v[36:39], v[216:223], v1
    v_smfmac_f32_16x16x64_bf16 v[24:27], v[36:39], v[224:231], v1
    s_waitcnt vmcnt(1)
    v_max3_u32 v10, v40, v41, v42
    v_max_u32 v10, v10, v43
    v_cmp_eq_u32 vcc, -1, v10
    s_nop 0
    s_cbranch_vccnz Lr3s_pb_re
Lr3s_pb_ok:
    ds_write_b128 v0, v[40:43] offset:14080
    v_smfmac_f32_16x16x64_bf16 v[12:15], v[40:43], v[152:159], v1
    v_smfmac_f32_16x16x64_bf16 v[20:23], v[40:43], a[40:47], v1
    v_smfmac_f32_16x16x64_bf16 v[16:19], v[40:43], v[160:167], v1
    v_smfmac_f32_16x16x64_bf16 v[24:27], v[40:43], a[48:55], v1
    s_waitcnt lgkmcnt(0)
    s_barrier
    ds_read_b128 v[48:51], v0 offset:11008
    ds_read_b128 v[52:55], v0 offset:12032
    ds_read_b128 v[36:39], v0 offset:13056
    v_smfmac_f32_16x16x64_bf16 v[28:31], v[40:43], a[152:159], v1
    v_smfmac_f32_16x16x64_bf16 v[32:35], v[40:43], a[160:167], v1
    s_waitcnt lgkmcnt(2)
    v_smfmac_f32_16x16x64_bf16 v[12:15], v[48:51], v[56:63], v1
    ds_read_b128 v[56:59], v8 offset:12288
    ds_read_b128 v[60:63], v8 offset:13312
    v_smfmac_f32_16x16x64_bf16 v[16:19], v[48:51], v[64:71], v1
    ds_read_b128 v[64:67], v8 offset:14336
    ds_read_b128 v[68:71], v8 offset:15360
    s_waitcnt lgkmcnt(5)
    v_smfmac_f32_16x16x64_bf16 v[12:15], v[52:55], v[136:143], v1
    v_smfmac_f32_16x16x64_bf16 v[16:19], v[52:55], v[144:151], v1
    s_waitcnt vmcnt(0)
    v_max3_u32 v10, v44, v45, v46
    v_max_u32 v10, v10, v47
    v_cmp_eq_u32 vcc, -1, v10
    s_nop 0
    s_cbranch_vccnz Lr3s_pc_re
Lr3s_pc_ok:
    v_smfmac_f32_16x16x64_bf16 v[12:15], v[44:47], v[168:175], v1
    v_smfmac_f32_16x16x64_bf16 v[16:19], v[44:47], v[176:183], v1
    s_waitcnt lgkmcnt(2)
    v_smfmac_f32_16x16x64_bf16 v[12:15], v[36:39], v[56:63], v1
    s_waitcnt lgkmcnt(0)
    v_smfmac_f32_16x16x64_bf16 v[16:19], v[36:39], v[64:71], v1
    v_smfmac_f32_16x16x64_bf16 v[20:23], v[48:51], v[248:255], v1
    v_smfmac_f32_16x16x64_bf16 v[24:27], v[48:51], a[0:7], v1
    v_smfmac_f32_16x16x64_bf16 v[20:23], v[52:55], a[8:15], v1
    v_add_f32 v12, v12, v14
    v_smfmac_f32_16x16x64_bf16 v[24:27], v[52:55], a[16:23], v1
    v_add_f32 v16, v16, v18
    buffer_load_dwordx4 v[64:67], v0, s[8:11], s42 offen
    v_smfmac_f32_16x16x64_bf16 v[20:23], v[36:39], a[24:31], v1
    v_add_f32 v13, v13, v15
    v_smfmac_f32_16x16x64_bf16 v[24:27], v[36:39], a[32:39], v1
    v_add_f32 v17, v17, v19
    v_smfmac_f32_16x16x64_bf16 v[20:23], v[44:47], a[56:63], v1
    v_cvt_pk_bf16_f32 v14, v12, v16
    ds_read_b128 v[56:59], v0 offset:15104
    v_smfmac_f32_16x16x64_bf16 v[24:27], v[44:47], a[64:71], v1
    v_cvt_pk_bf16_f32 v15, v13, v17
    ds_read_b128 v[60:63], v0 offset:16128
    buffer_load_dwordx4 v[68:71], v0, s[8:11], s42 offen offset:1024
    ds_write_b32 v2, v14 offset:576
    ds_write_b32 v2, v15 offset:864
    v_smfmac_f32_16x16x64_bf16 v[28:31], v[48:51], a[104:111], v1
    v_smfmac_f32_16x16x64_bf16 v[32:35], v[48:51], a[112:119], v1
    v_add_f32 v20, v20, v22
    v_add_f32 v24, v24, v26
    v_add_f32 v21, v21, v23
    v_add_f32 v25, v25, v27
    v_cvt_pk_bf16_f32 v22, v20, v24
    v_cvt_pk_bf16_f32 v23, v21, v25
    ds_write_b32 v2, v22 offset:0
    ds_write_b32 v2, v23 offset:288
    v_smfmac_f32_16x16x64_bf16 v[28:31], v[52:55], a[120:127], v1
    v_smfmac_f32_16x16x64_bf16 v[32:35], v[52:55], a[128:135], v1
    s_waitcnt lgkmcnt(0)
    s_barrier
    ds_read_b128 v[40:43], v3 offset:0
    ds_read_b128 v[48:51], v3 offset:64
    ds_read_b128 v[20:23], v3 offset:128
    ds_read_b128 v[52:55], v3 offset:192
    v_smfmac_f32_16x16x64_bf16 v[28:31], v[36:39], a[136:143], v1
    v_smfmac_f32_16x16x64_bf16 v[32:35], v[36:39], a[144:151], v1
    ds_read_b128 v[36:39], v0 offset:17152
    v_lshlrev_b32 v9, 3, v0
    buffer_load_dword v11, v9, s[8:11], s68 offen
    v_smfmac_f32_16x16x64_bf16 v[28:31], v[44:47], a[168:175], v1
    v_smfmac_f32_16x16x64_bf16 v[32:35], v[44:47], a[176:183], v1
    ds_read_b128 v[44:47], v0 offset:18176
    s_waitcnt lgkmcnt(5)
    v_mfma_f32_16x16x32_bf16 v[12:15], v[56:59], v[40:43], 0
    v_mfma_f32_16x16x32_bf16 v[16:19], v[60:63], v[40:43], 0
    v_mfma_f32_16x16x32_bf16 v[24:27], v[40:43], v[40:43], 0
    ds_read_b128 v[56:59], v0 offset:19200
    ds_read_b128 v[60:63], v0 offset:20224
    s_waitcnt lgkmcnt(3)
    v_mfma_f32_16x16x32_bf16 v[12:15], v[36:39], v[48:51], v[12:15]
    v_lshrrev_b32 v10, 1, v0
    v_lshrrev_b32 v9, 9, v0
    s_waitcnt lgkmcnt(2)
    v_mfma_f32_16x16x32_bf16 v[16:19], v[44:47], v[48:51], v[16:19]
    v_lshl_add_u32 v9, v9, 5, v10
    v_add_f32 v28, v28, v30
    v_mfma_f32_16x16x32_bf16 v[24:27], v[48:51], v[48:51], v[24:27]
    v_add_f32 v32, v32, v34
    v_add_f32 v29, v29, v31
    ds_read_b128 v[36:39], v0 offset:21248
    ds_read_b128 v[44:47], v0 offset:22272
    s_waitcnt lgkmcnt(3)
    v_mfma_f32_16x16x32_bf16 v[12:15], v[56:59], v[20:23], v[12:15]
    v_add_f32 v33, v33, v35
    v_cvt_pk_bf16_f32 v30, v28, v29
    s_waitcnt lgkmcnt(2)
    v_mfma_f32_16x16x32_bf16 v[16:19], v[60:63], v[20:23], v[16:19]
    v_cvt_pk_bf16_f32 v31, v32, v33
    ds_read_b64 v[34:35], v9 offset:3456
    v_mfma_f32_16x16x32_bf16 v[24:27], v[20:23], v[20:23], v[24:27]
    s_add_u32 s17, s43, 3584
    buffer_store_dwordx2 v[30:31], v10, s[8:11], s17 offen sc1
    s_waitcnt lgkmcnt(2)
    v_mfma_f32_16x16x32_bf16 v[12:15], v[36:39], v[52:55], v[12:15]
    s_waitcnt lgkmcnt(1)
    v_mfma_f32_16x16x32_bf16 v[16:19], v[44:47], v[52:55], v[16:19]
    v_mfma_f32_16x16x32_bf16 v[24:27], v[52:55], v[52:55], v[24:27]
    s_add_u32 s17, s43, 1536
    s_waitcnt lgkmcnt(0)
    buffer_store_dwordx2 v[34:35], v10, s[8:11], s17 offen sc1
    ds_read_b128 v[56:59], v8 offset:16384
    ds_read_b128 v[60:63], v8 offset:17408
    v_mov_b64 v[20:21], s[52:53]
    v_mov_b64 v[22:23], s[52:53]
    v_mov_b32 v41, 0
    v_mov_b32 v42, 0
    v_max3_f32 v9, v12, v13, v14
    v_max3_f32 v9, v9, v15, v16
    v_max3_f32 v9, v9, v17, v18
    v_max3_f32 v9, v9, v19, v24
    v_max_f32 v9, v9, v25
    v_mov_b32 v10, v9
    v_mov_b64 v[32:33], 0
    v_mov_b64 v[34:35], 0
    v_permlane32_swap_b32 v9, v10
    v_max_f32 v9, v9, v10
    v_mov_b32 v10, v9
    s_nop 1
    v_permlane16_swap_b32 v9, v10
    v_max_f32 v9, v9, v10
    v_mul_f32 v28, s44, v9
    v_fma_f32 v12, v12, s44, -v28
    v_fma_f32 v13, v13, s44, -v28
    v_fma_f32 v14, v14, s44, -v28
    v_fma_f32 v15, v15, s44, -v28
    v_exp_f32 v12, v12
    v_exp_f32 v13, v13
    v_fma_f32 v16, v16, s44, -v28
    v_fma_f32 v17, v17, s44, -v28
    v_exp_f32 v14, v14
    v_exp_f32 v15, v15
    v_cvt_pk_bf16_f32 v36, v12, v13
    v_fma_f32 v18, v18, s44, -v28
    v_fma_f32 v19, v19, s44, -v28
    v_exp_f32 v16, v16
    v_exp_f32 v17, v17
    v_cvt_pk_bf16_f32 v37, v14, v15
    v_fma_f32 v24, v24, s44, -v28
    v_fma_f32 v25, v25, s44, -v28
    v_exp_f32 v18, v18
    v_exp_f32 v19, v19
    v_cvt_pk_bf16_f32 v38, v16, v17
    v_exp_f32 v24, v24
    v_exp_f32 v25, v25
    v_cvt_pk_bf16_f32 v39, v18, v19
    v_cvt_pk_bf16_f32 v40, v24, v25
    v_cvt_pk_bf16_f32 v43, v24, v25
    v_mfma_f32_16x16x32_bf16 v[52:55], v[20:23], v[36:39], 0
    v_mov_b64 v[12:13], 0
    v_mov_b64 v[14:15], 0
    s_waitcnt vmcnt(4)
    v_mfma_f32_16x16x32_bf16 v[44:47], v[64:67], v[36:39], 0
    v_mov_b64 v[24:25], 0
    v_mov_b64 v[26:27], 0
    s_waitcnt vmcnt(3)
    v_mfma_f32_16x16x32_bf16 v[48:51], v[68:71], v[36:39], 0
    ds_read_b128 v[64:67], v8 offset:20480
    ds_read_b128 v[68:71], v8 offset:21504
    v_mfma_f32_16x16x16_bf16 v[52:55], v[20:21], v[40:41], v[52:55]
    v_mfma_f32_16x16x16_bf16 v[44:47], v[30:31], v[40:41], v[44:47]
    v_mov_b64 v[20:21], 0
    v_mov_b64 v[22:23], 0
    v_mfma_f32_16x16x16_bf16 v[48:51], v[30:31], v[42:43], v[48:51]
    v_mov_b64 v[36:37], 0
    v_mov_b64 v[38:39], 0
    v_mov_b64 v[40:41], 0
    v_mov_b64 v[42:43], 0
    v_rcp_f32 v9, v52
    v_mov_b64 v[52:53], 0
    v_mov_b64 v[54:55], 0
    v_mul_f32 v44, v9, v44
    v_mul_f32 v48, v9, v48
    v_cvt_pk_bf16_f32 v16, v44, v48
    v_mul_f32 v45, v9, v45
    v_mul_f32 v49, v9, v49
    v_cvt_pk_bf16_f32 v17, v45, v49
    v_mul_f32 v46, v9, v46
    v_mul_f32 v50, v9, v50
    v_cvt_pk_bf16_f32 v18, v46, v50
    v_mul_f32 v47, v9, v47
    v_mul_f32 v51, v9, v51
    v_cvt_pk_bf16_f32 v19, v47, v51
    ds_write_b128 v5, v[16:19]
    v_mov_b64 v[28:29], 0
    v_mov_b64 v[30:31], 0
    s_waitcnt lgkmcnt(0)
    s_barrier
    ds_read_b128 v[44:47], v4 offset:0
    ds_read_b128 v[48:51], v4 offset:128
    s_cmp_eq_u32 s33, 63
    s_cbranch_scc1 Lr3s_last
    v_mov_b64 v[16:17], 0
    v_mov_b64 v[18:19], 0
    buffer_load_dwordx4 v0, s[8:11], s41 offen offset:0 lds
    buffer_load_dwordx4 v0, s[8:11], s41 offen offset:1024 lds
    s_waitcnt lgkmcnt(1)
    v_smfmac_f32_16x16x64_bf16 v[12:15], v[44:47], a[184:191], v1
    s_waitcnt lgkmcnt(0)
    v_smfmac_f32_16x16x64_bf16 v[12:15], v[48:51], a[192:199], v1
    v_smfmac_f32_16x16x64_bf16 v[24:27], v[44:47], a[200:207], v1
    v_smfmac_f32_16x16x64_bf16 v[24:27], v[48:51], a[208:215], v1
    v_add_f32 v12, v12, v14
    v_smfmac_f32_16x16x64_bf16 v[20:23], v[44:47], a[216:223], v1
    v_add_f32 v13, v13, v15
    v_smfmac_f32_16x16x64_bf16 v[20:23], v[48:51], a[224:231], v1
    v_cvt_pk_bf16_f32 v12, v12, v13
    v_smfmac_f32_16x16x64_bf16 v[16:19], v[44:47], a[232:239], v1
    v_add_f32 v24, v24, v26
    v_smfmac_f32_16x16x64_bf16 v[16:19], v[48:51], a[240:247], v1
    v_add_f32 v25, v25, v27
    v_smfmac_f32_16x16x64_bf16 v[36:39], v[44:47], v[56:63], v1
    v_cvt_pk_bf16_f32 v13, v24, v25
    v_smfmac_f32_16x16x64_bf16 v[36:39], v[48:51], v[64:71], v1
    v_add_f32 v20, v20, v22
    v_add_f32 v21, v21, v23
    v_cvt_pk_bf16_f32 v14, v20, v21
    v_add_f32 v16, v16, v18
    v_add_f32 v17, v17, v19
    v_cvt_pk_bf16_f32 v15, v16, v17
    v_and_or_b32 v15, v15, -2, s40
    buffer_store_dwordx4 v[12:15], v0, s[8:11], s38 offen sc1
    s_nop 0
    ds_read_b128 v[12:15], v8 offset:18432
    ds_read_b128 v[16:19], v8 offset:19456
    ds_read_b128 v[20:23], v8 offset:22528
    ds_read_b128 v[24:27], v8 offset:23552
    ds_read_b128 v[56:59], v8 offset:24576
    ds_read_b128 v[60:63], v8 offset:25600
    ds_read_b128 v[64:67], v8 offset:28672
    ds_read_b128 v[68:71], v8 offset:29696
    s_waitcnt lgkmcnt(6)
    v_smfmac_f32_16x16x64_bf16 v[40:43], v[44:47], v[12:19], v1
    ds_read_b128 v[12:15], v8 offset:26624
    ds_read_b128 v[16:19], v8 offset:27648
    s_waitcnt lgkmcnt(6)
    v_smfmac_f32_16x16x64_bf16 v[40:43], v[48:51], v[20:27], v1
    ds_read_b128 v[20:23], v8 offset:30720
    ds_read_b128 v[24:27], v8 offset:31744
    s_waitcnt lgkmcnt(6)
    v_smfmac_f32_16x16x64_bf16 v[52:55], v[44:47], v[56:63], v1
    ds_read_b128 v[56:59], v8 offset:32768
    ds_read_b128 v[60:63], v8 offset:33792
    s_waitcnt lgkmcnt(6)
    v_smfmac_f32_16x16x64_bf16 v[52:55], v[48:51], v[64:71], v1
    s_waitcnt lgkmcnt(4)
    v_smfmac_f32_16x16x64_bf16 v[32:35], v[44:47], v[12:19], v1
    s_waitcnt lgkmcnt(2)
    v_smfmac_f32_16x16x64_bf16 v[32:35], v[48:51], v[20:27], v1
    v_smfmac_f32_16x16x64_bf16 v[28:31], v[44:47], a[248:255], v1
    s_waitcnt lgkmcnt(0)
    v_smfmac_f32_16x16x64_bf16 v[28:31], v[48:51], v[56:63], v1
    v_add_f32 v36, v36, v38
    v_add_f32 v37, v37, v39
    v_cvt_pk_bf16_f32 v36, v36, v37
    v_add_f32 v40, v40, v42
    v_add_f32 v41, v41, v43
    v_cvt_pk_bf16_f32 v37, v40, v41
    v_add_f32 v52, v52, v54
    v_add_f32 v53, v53, v55
    v_cvt_pk_bf16_f32 v38, v52, v53
    v_add_f32 v32, v32, v34
    v_add_f32 v33, v33, v35
    v_cvt_pk_bf16_f32 v39, v32, v33
    v_and_or_b32 v39, v39, -2, s40
    s_add_u32 s17, s38, 4096
    buffer_store_dwordx4 v[36:39], v0, s[8:11], s17 offen sc1
    v_add_f32 v28, v28, v30
    v_add_f32 v29, v29, v31
    v_cvt_pk_bf16_f32 v28, v28, v29
    v_and_or_b32 v28, v28, -2, s40
    v_lshrrev_b32 v9, 2, v0
    buffer_store_dword v28, v9, s[8:11], s39 offen sc1
    s_xor_b32 s34, s34, 16384
    s_xor_b32 s35, s35, 16384
    s_add_u32 s33, s33, 1
    s_add_u32 s42, s42, 262144
    s_add_u32 s41, s41, 262144
    s_add_u32 s43, s43, 131072
    s_add_u32 s68, s68, 262144
    s_add_u32 s66, s66, 22528
    s_xor_b32 s40, s40, 1
    ds_read_b128 v[56:59], v8 offset:0
    ds_read_b128 v[60:63], v8 offset:1024
    ds_read_b128 v[64:67], v8 offset:2048
    ds_read_b128 v[68:71], v8 offset:3072
    v_mov_b64 v[12:13], 0
    v_mov_b64 v[14:15], 0
    v_mov_b64 v[16:17], 0
    v_mov_b64 v[18:19], 0
    v_mov_b64 v[20:21], 0
    v_mov_b64 v[22:23], 0
    v_mov_b64 v[24:25], 0
    v_mov_b64 v[26:27], 0
    v_mov_b64 v[28:29], 0
    v_mov_b64 v[30:31], 0
    v_mov_b64 v[32:33], 0
    v_mov_b64 v[34:35], 0
    s_sleep 5
    s_nop 9
    buffer_load_dwordx4 v[36:39], v0, s[8:11], s34 offen sc1
    s_nop 15
    s_nop 8
    buffer_load_dwordx4 v[36:39], v0, s[8:11], s34 offen sc1
    s_nop 15
    s_nop 8
    buffer_load_dwordx4 v[36:39], v0, s[8:11], s34 offen sc1
    s_waitcnt lgkmcnt(0)
    s_branch Lr3s_step
Lr3s_pb_re:
    s_mov_b32 s16, 0
Lr3s_pb_lp:
    s_add_u32 s17, s34, 4096
    buffer_load_dwordx4 v[40:43], v0, s[8:11], s17 offen sc1
    s_add_u32 s16, s16, 1
    s_cmp_gt_u32 s16, 100000
    s_cbranch_scc1 Lr_abort
    s_waitcnt vmcnt(0)
    v_max3_u32 v10, v40, v41, v42
    v_max_u32 v10, v10, v43
    v_cmp_eq_u32 vcc, -1, v10
    s_nop 0
    s_cbranch_vccnz Lr3s_pb_lp
    s_branch Lr3s_pb_ok
Lr3s_pc_re:
    s_mov_b32 s16, 0
Lr3s_pc_lp:
    buffer_load_dwordx4 v[44:47], v0, s[8:11], s35 offen sc1
    s_add_u32 s16, s16, 1
    s_cmp_gt_u32 s16, 100000
    s_cbranch_scc1 Lr_abort
    s_waitcnt vmcnt(0)
    v_max3_u32 v10, v44, v45, v46
    v_max_u32 v10, v10, v47
    v_cmp_eq_u32 vcc, -1, v10
    s_nop 0
    s_cbranch_vccnz Lr3s_pc_lp
    s_branch Lr3s_pc_ok
Lr3s_last:
    s_waitcnt vmcnt(0) lgkmcnt(0)
    s_barrier
    s_branch Lr_exit
Lr_abort:
    s_waitcnt lgkmcnt(0)
    s_mov_b64 exec, -1
    v_mov_b32 v0, 60
    s_lshl_b32 s5, s3, 8
    s_or_b32 s5, s5, s4
    s_or_b32 s5, s5, 0x10000
    v_mov_b32 v1, s5
    global_store_dword v0, v1, s[12:13]
    s_endpgm
Lr_exit:
    s_endpgm
.section .rodata,"a"
.p2align 6
.amdhsa_kernel interleave_layers__sliding_local_dilated__memory_aug_recurrent_mem_tr__prompt_kernel
  .amdhsa_next_free_vgpr 512
  .amdhsa_next_free_sgpr 102
  .amdhsa_accum_offset 256
  .amdhsa_group_segment_fixed_size 0
  .amdhsa_kernarg_size 104
  .amdhsa_user_sgpr_count 2
  .amdhsa_user_sgpr_kernarg_segment_ptr 1
  .amdhsa_system_sgpr_workgroup_id_x 1
.end_amdhsa_kernel
```

```asm
; @launch grid=(256,1,1) block=(256,1,1) lds=163840
.amdgcn_target "amdgcn-amd-amdhsa--gfx950"
.text
.globl interleave_layers__sliding_local_dilated__memory_aug_recurrent_mem_tr__prompt_kernel
.p2align 8
.type interleave_layers__sliding_local_dilated__memory_aug_recurrent_mem_tr__prompt_kernel,@function
interleave_layers__sliding_local_dilated__memory_aug_recurrent_mem_tr__prompt_kernel:
    s_cmp_ge_u32 s2, 256
    s_cbranch_scc1 L_exit
    s_load_dwordx2 s[8:9], s[0:1], 96
    s_mov_b32 s10, 268435456
    s_mov_b32 s11, 0x00020000
    s_waitcnt lgkmcnt(0)
    s_and_b32 s9, s9, 0xffff
    s_load_dwordx2 s[12:13], s[0:1], 88
    v_lshrrev_b32 v1, 6, v0
    s_getreg_b32 s3, hwreg(HW_REG_XCC_ID)
    v_readfirstlane_b32 s14, v1
    s_and_b32 s3, s3, 7
    s_and_b32 s17, s3, 1
    s_lshl_b32 s17, s17, 7
    s_lshl_b32 s18, s3, 1
    s_and_b32 s18, s18, 12
    s_add_u32 s17, s17, s18
    v_mov_b32 v2, 0
    v_mov_b32 v3, 1
    v_mov_b32 v4, s17
    s_mov_b32 s33, 0
    s_waitcnt lgkmcnt(0)
    s_cmp_lg_u32 s14, 0
    s_cbranch_scc1 L_tk_wait
    s_mov_b64 exec, 1
    global_atomic_add v3, v4, v3, s[12:13] sc0
    s_waitcnt vmcnt(0)
    v_readfirstlane_b32 s4, v3
    s_nop 0
    s_cmp_lt_u32 s4, 32
    s_cbranch_scc1 L_tk_have
    v_mov_b32 v3, 1
    v_mov_b32 v4, 32
    global_atomic_add v3, v4, v3, s[12:13] sc0
    s_waitcnt vmcnt(0)
    v_readfirstlane_b32 s5, v3
    s_mov_b64 exec, 0xff
    v_and_b32 v4, 1, v0
    v_lshlrev_b32 v4, 7, v4
    v_lshlrev_b32 v5, 1, v0
    v_and_or_b32 v4, v5, 12, v4
    s_mov_b32 s16, 0
L_hl_poll:
    global_load_dword v5, v4, s[12:13] sc1
    s_add_u32 s16, s16, 1
    s_cmp_gt_u32 s16, 100000
    s_cbranch_scc1 L_abort
    s_mov_b32 s6, 0
    s_waitcnt vmcnt(0)
    v_readlane_b32 s40, v5, 0
    s_nop 0
    s_add_u32 s6, s6, s40
    v_readlane_b32 s41, v5, 1
    s_nop 0
    s_add_u32 s6, s6, s41
    v_readlane_b32 s42, v5, 2
    s_nop 0
    s_add_u32 s6, s6, s42
    v_readlane_b32 s43, v5, 3
    s_nop 0
    s_add_u32 s6, s6, s43
    v_readlane_b32 s44, v5, 4
    s_nop 0
    s_add_u32 s6, s6, s44
    v_readlane_b32 s45, v5, 5
    s_nop 0
    s_add_u32 s6, s6, s45
    v_readlane_b32 s46, v5, 6
    s_nop 0
    s_add_u32 s6, s6, s46
    v_readlane_b32 s47, v5, 7
    s_nop 0
    s_add_u32 s6, s6, s47
    s_cmp_lt_u32 s6, 256
    s_cbranch_scc1 L_hl_poll
    s_mov_b32 s3, 0
    s_mov_b32 s4, 0
    s_min_u32 s6, s47, 32
    s_sub_u32 s7, 32, s6
    s_cmp_lt_u32 s5, s7
    s_cselect_b32 s3, 7, s3
    s_add_u32 s6, s6, s5
    s_cmp_lt_u32 s5, s7
    s_cselect_b32 s4, s6, s4
    s_sub_u32 s5, s5, s7
    s_min_u32 s6, s46, 32
    s_sub_u32 s7, 32, s6
    s_cmp_lt_u32 s5, s7
    s_cselect_b32 s3, 6, s3
    s_add_u32 s6, s6, s5
    s_cmp_lt_u32 s5, s7
    s_cselect_b32 s4, s6, s4
    s_sub_u32 s5, s5, s7
    s_min_u32 s6, s45, 32
    s_sub_u32 s7, 32, s6
    s_cmp_lt_u32 s5, s7
    s_cselect_b32 s3, 5, s3
    s_add_u32 s6, s6, s5
    s_cmp_lt_u32 s5, s7
    s_cselect_b32 s4, s6, s4
    s_sub_u32 s5, s5, s7
    s_min_u32 s6, s44, 32
    s_sub_u32 s7, 32, s6
    s_cmp_lt_u32 s5, s7
    s_cselect_b32 s3, 4, s3
    s_add_u32 s6, s6, s5
    s_cmp_lt_u32 s5, s7
    s_cselect_b32 s4, s6, s4
    s_sub_u32 s5, s5, s7
    s_min_u32 s6, s43, 32
    s_sub_u32 s7, 32, s6
    s_cmp_lt_u32 s5, s7
    s_cselect_b32 s3, 3, s3
    s_add_u32 s6, s6, s5
    s_cmp_lt_u32 s5, s7
    s_cselect_b32 s4, s6, s4
    s_sub_u32 s5, s5, s7
    s_min_u32 s6, s42, 32
    s_sub_u32 s7, 32, s6
    s_cmp_lt_u32 s5, s7
    s_cselect_b32 s3, 2, s3
    s_add_u32 s6, s6, s5
    s_cmp_lt_u32 s5, s7
    s_cselect_b32 s4, s6, s4
    s_sub_u32 s5, s5, s7
    s_min_u32 s6, s41, 32
    s_sub_u32 s7, 32, s6
    s_cmp_lt_u32 s5, s7
    s_cselect_b32 s3, 1, s3
    s_add_u32 s6, s6, s5
    s_cmp_lt_u32 s5, s7
    s_cselect_b32 s4, s6, s4
    s_sub_u32 s5, s5, s7
    s_min_u32 s6, s40, 32
    s_sub_u32 s7, 32, s6
    s_cmp_lt_u32 s5, s7
    s_cselect_b32 s3, 0, s3
    s_add_u32 s6, s6, s5
    s_cmp_lt_u32 s5, s7
    s_cselect_b32 s4, s6, s4
    s_sub_u32 s5, s5, s7
L_tk_have:
    s_lshl_b32 s5, s3, 8
    s_or_b32 s5, s5, s4
    v_mov_b32 v3, s5
    s_mov_b64 exec, 1
    ds_write_b32 v2, v3
    s_mov_b64 exec, -1
L_tk_wait:
    s_waitcnt vmcnt(0) lgkmcnt(0)
    s_barrier
    ds_read_b32 v3, v2
    s_waitcnt lgkmcnt(0)
    v_readfirstlane_b32 s5, v3
    s_nop 0
    s_lshr_b32 s3, s5, 8
    s_and_b32 s4, s5, 255
    s_barrier
    s_cmp_lt_u32 s3, 2
    s_cbranch_scc1 L_role_r
    s_sub_u32 s6, s3, 2
    s_lshl_b32 s6, s6, 5
    s_add_u32 s6, s6, s4
    s_load_dwordx2 s[20:21], s[0:1], 8
    s_mov_b32 s22, 1990656
    s_mov_b32 s23, 0x00020000
    s_waitcnt lgkmcnt(0)
    s_and_b32 s21, s21, 0xffff
    s_load_dwordx2 s[24:25], s[0:1], 16
    s_mov_b32 s26, 663552
    s_mov_b32 s27, 0x00020000
    s_waitcnt lgkmcnt(0)
    s_and_b32 s25, s25, 0xffff
    s_sub_u32 s41, 191, s6
    s_lshl_b32 s41, s41, 15
    v_lshlrev_b32 v254, 7, v0
    buffer_load_dword v255, v254, s[20:23], s41 offen
    s_sub_u32 s41, s41, 1998848
    s_cmp_lt_u32 s41, 688128
    s_cselect_b32 s41, s41, 0x7f000000
    s_waitcnt vmcnt(0)
    buffer_load_dword v255, v254, s[24:27], s41 offen
    s_cmp_ge_u32 s6, 136
    s_cbranch_scc1 Li_end
    v_lshlrev_b32 v7, 4, v0
    v_mov_b32 v12, 0
    v_mov_b32 v13, 0
    v_mov_b32 v14, 0
    v_mov_b32 v15, 0
    s_cmp_ge_u32 s6, 64
    s_cbranch_scc1 Li_rest
    s_load_dwordx2 s[20:21], s[0:1], 0
    s_mov_b32 s22, 2359296
    s_mov_b32 s23, 0x00020000
    s_waitcnt lgkmcnt(0)
    s_and_b32 s21, s21, 0xffff
    v_and_b32 v1, 31, v0
    v_lshrrev_b32 v2, 5, v0
    v_mul_u32_u24 v3, 1152, v1
    v_mul_u32_u24 v5, 144, v2
    v_add_u32 v3, v3, v5
    s_mul_i32 s41, s6, 36864
    buffer_load_dwordx4 v[64:67], v3, s[20:23], s41 offen offset:0
    buffer_load_dwordx4 v[68:71], v3, s[20:23], s41 offen offset:16
    buffer_load_dwordx4 v[72:75], v3, s[20:23], s41 offen offset:32
    buffer_load_dwordx4 v[76:79], v3, s[20:23], s41 offen offset:48
    buffer_load_dwordx4 v[80:83], v3, s[20:23], s41 offen offset:64
    buffer_load_dwordx4 v[84:87], v3, s[20:23], s41 offen offset:80
    buffer_load_dwordx4 v[88:91], v3, s[20:23], s41 offen offset:96
    buffer_load_dwordx4 v[92:95], v3, s[20:23], s41 offen offset:112
    buffer_load_dwordx4 v[96:99], v3, s[20:23], s41 offen offset:128
    v_mul_u32_u24 v4, 4608, v2
    v_lshl_add_u32 v4, v1, 4, v4
    s_mul_i32 s41, s6, 36864
    s_add_u32 s41, s41, 6291456
    s_mul_i32 s42, s6, 6144
    s_add_u32 s42, s42, 15728640
    s_add_u32 s43, s42, 2048
    s_add_u32 s44, s42, 397824
    v_mov_b32 v60, 0
    v_mov_b32 v61, 0
    s_waitcnt vmcnt(8)
    buffer_store_dwordx4 v[64:67], v4, s[8:11], s41 offen offset:0 sc1
    s_waitcnt vmcnt(8)
    buffer_store_dwordx4 v[68:71], v4, s[8:11], s41 offen offset:512 sc1
    s_waitcnt vmcnt(8)
    buffer_store_dwordx4 v[72:75], v4, s[8:11], s41 offen offset:1024 sc1
    s_waitcnt vmcnt(8)
    buffer_store_dwordx4 v[76:79], v4, s[8:11], s41 offen offset:1536 sc1
    s_waitcnt vmcnt(8)
    buffer_store_dwordx4 v[80:83], v4, s[8:11], s41 offen offset:2048 sc1
    s_waitcnt vmcnt(8)
    buffer_store_dwordx4 v[84:87], v4, s[8:11], s41 offen offset:2560 sc1
    s_waitcnt vmcnt(8)
    buffer_store_dwordx4 v[88:91], v4, s[8:11], s41 offen offset:3072 sc1
    s_waitcnt vmcnt(8)
    buffer_store_dwordx4 v[92:95], v4, s[8:11], s41 offen offset:3584 sc1
    v_add_u32 v4, 4096, v4
    s_waitcnt vmcnt(8)
    buffer_store_dwordx4 v[96:99], v4, s[8:11], s41 offen offset:0 sc1
    buffer_store_dwordx4 v[12:15], v7, s[8:11], s43 offen sc1
    v_cmp_gt_u32 vcc, 96, v0
    s_nop 0
    s_and_saveexec_b64 s[46:47], vcc
    s_cbranch_execz Li_z1
    buffer_store_dwordx4 v[12:15], v7, s[8:11], s44 offen sc1
Li_z1:
    s_mov_b64 exec, s[46:47]
    v_mov_b32 v62, 0x3f803f80
    v_dot2c_f32_bf16 v60, v64, v62
    v_dot2c_f32_bf16 v61, v64, v64
    v_dot2c_f32_bf16 v60, v65, v62
    v_dot2c_f32_bf16 v61, v65, v65
    v_dot2c_f32_bf16 v60, v66, v62
    v_dot2c_f32_bf16 v61, v66, v66
    v_dot2c_f32_bf16 v60, v67, v62
    v_dot2c_f32_bf16 v61, v67, v67
    v_dot2c_f32_bf16 v60, v68, v62
    v_dot2c_f32_bf16 v61, v68, v68
    v_dot2c_f32_bf16 v60, v69, v62
    v_dot2c_f32_bf16 v61, v69, v69
    v_dot2c_f32_bf16 v60, v70, v62
    v_dot2c_f32_bf16 v61, v70, v70
    v_dot2c_f32_bf16 v60, v71, v62
    v_dot2c_f32_bf16 v61, v71, v71
    v_dot2c_f32_bf16 v60, v72, v62
    v_dot2c_f32_bf16 v61, v72, v72
    v_dot2c_f32_bf16 v60, v73, v62
    v_dot2c_f32_bf16 v61, v73, v73
    v_dot2c_f32_bf16 v60, v74, v62
    v_dot2c_f32_bf16 v61, v74, v74
    v_dot2c_f32_bf16 v60, v75, v62
    v_dot2c_f32_bf16 v61, v75, v75
    v_dot2c_f32_bf16 v60, v76, v62
    v_dot2c_f32_bf16 v61, v76, v76
    v_dot2c_f32_bf16 v60, v77, v62
    v_dot2c_f32_bf16 v61, v77, v77
    v_dot2c_f32_bf16 v60, v78, v62
    v_dot2c_f32_bf16 v61, v78, v78
    v_dot2c_f32_bf16 v60, v79, v62
    v_dot2c_f32_bf16 v61, v79, v79
    v_dot2c_f32_bf16 v60, v80, v62
    v_dot2c_f32_bf16 v61, v80, v80
    v_dot2c_f32_bf16 v60, v81, v62
    v_dot2c_f32_bf16 v61, v81, v81
    v_dot2c_f32_bf16 v60, v82, v62
    v_dot2c_f32_bf16 v61, v82, v82
    v_dot2c_f32_bf16 v60, v83, v62
    v_dot2c_f32_bf16 v61, v83, v83
    v_dot2c_f32_bf16 v60, v84, v62
    v_dot2c_f32_bf16 v61, v84, v84
    v_dot2c_f32_bf16 v60, v85, v62
    v_dot2c_f32_bf16 v61, v85, v85
    v_dot2c_f32_bf16 v60, v86, v62
    v_dot2c_f32_bf16 v61, v86, v86
    v_dot2c_f32_bf16 v60, v87, v62
    v_dot2c_f32_bf16 v61, v87, v87
    v_dot2c_f32_bf16 v60, v88, v62
    v_dot2c_f32_bf16 v61, v88, v88
    v_dot2c_f32_bf16 v60, v89, v62
    v_dot2c_f32_bf16 v61, v89, v89
    v_dot2c_f32_bf16 v60, v90, v62
    v_dot2c_f32_bf16 v61, v90, v90
    v_dot2c_f32_bf16 v60, v91, v62
    v_dot2c_f32_bf16 v61, v91, v91
    v_dot2c_f32_bf16 v60, v92, v62
    v_dot2c_f32_bf16 v61, v92, v92
    v_dot2c_f32_bf16 v60, v93, v62
    v_dot2c_f32_bf16 v61, v93, v93
    v_dot2c_f32_bf16 v60, v94, v62
    v_dot2c_f32_bf16 v61, v94, v94
    v_dot2c_f32_bf16 v60, v95, v62
    v_dot2c_f32_bf16 v61, v95, v95
    v_dot2c_f32_bf16 v60, v96, v62
    v_dot2c_f32_bf16 v61, v96, v96
    v_dot2c_f32_bf16 v60, v97, v62
    v_dot2c_f32_bf16 v61, v97, v97
    v_dot2c_f32_bf16 v60, v98, v62
    v_dot2c_f32_bf16 v61, v98, v98
    v_dot2c_f32_bf16 v60, v99, v62
    v_dot2c_f32_bf16 v61, v99, v99
    s_nop 3
    v_lshrrev_b32 v5, 1, v2
    v_lshlrev_b32 v5, 9, v5
    v_lshl_add_u32 v5, v1, 4, v5
    v_and_b32 v6, 1, v2
    v_lshl_add_u32 v5, v6, 3, v5
    buffer_store_dwordx2 v[60:61], v5, s[8:11], s42 offen sc1
    s_branch Li_flags
Li_rest:
    s_cmp_ge_u32 s6, 128
    s_cbranch_scc1 Li_flags
    s_sub_u32 s41, s6, 64
    s_mul_i32 s41, s41, 6144
    s_add_u32 s41, s41, 16912896
    v_cmp_gt_u32 vcc, 96, v0
    s_nop 0
    s_and_saveexec_b64 s[42:43], vcc
    s_cbranch_execz Li_rest2
    buffer_store_dwordx4 v[12:15], v7, s[8:11], s41 offen sc1
Li_rest2:
    s_mov_b64 exec, s[42:43]
Li_flags:
    v_cmp_gt_u32 vcc, 96, v0
    s_cmp_lt_u32 s6, 64
    s_cselect_b64 s[42:43], -1, 0
    s_and_b64 vcc, vcc, s[42:43]
    s_cmp_lt_u32 s6, 128
    s_cselect_b32 s44, 0, 0
    v_mov_b32 v12, s44
    v_mov_b32 v13, s44
    v_mov_b32 v14, s44
    v_mov_b32 v15, s44
    v_mov_b32 v9, 1
    v_cndmask_b32 v8, v12, v9, vcc
    v_mov_b32 v9, v8
    v_mov_b32 v10, v8
    v_mov_b32 v11, v8
    s_mul_i32 s41, s6, 22528
    s_sub_u32 s42, s6, 128
    s_lshl_b32 s42, s42, 12
    s_add_u32 s42, s42, 2883584
    s_cmp_ge_u32 s6, 128
    s_cselect_b32 s41, s42, s41
    buffer_store_dwordx4 v[8:11], v7, s[8:11], s41 offen sc1
    s_cbranch_scc1 Li_nofl
    s_add_u32 s41, s41, 4096
    buffer_store_dwordx4 v[12:15], v7, s[8:11], s41 offen sc1
    s_add_u32 s41, s41, 4096
    buffer_store_dwordx4 v[12:15], v7, s[8:11], s41 offen sc1
    s_add_u32 s41, s41, 4096
    buffer_store_dwordx4 v[12:15], v7, s[8:11], s41 offen sc1
    s_add_u32 s41, s41, 4096
    buffer_store_dwordx4 v[12:15], v7, s[8:11], s41 offen sc1
    s_add_u32 s41, s41, 4096
    v_cmp_gt_u32 vcc, 128, v0
    s_nop 0
    s_and_saveexec_b64 s[42:43], vcc
    s_cbranch_execz Li_fl5
    buffer_store_dwordx4 v[12:15], v7, s[8:11], s41 offen sc1
Li_fl5:
    s_mov_b64 exec, s[42:43]
Li_nofl:
    s_waitcnt vmcnt(0)
    s_barrier
    s_cmp_lg_u32 s14, 0
    s_cbranch_scc1 Li_end
    s_sub_u32 s41, s6, 64
    s_cmp_lt_u32 s41, 64
    s_cbranch_scc1 Li_l1
    v_mov_b32 v2, 40
    v_mov_b32 v3, 1
    s_mov_b64 exec, 1
    global_atomic_add v2, v3, s[12:13]
    s_mov_b64 exec, -1
    s_branch Li_end
Li_l1:
    v_mov_b32 v2, 160
    v_mov_b32 v3, 1
    s_mov_b64 exec, 1
    global_atomic_add v2, v3, s[12:13]
    s_mov_b64 exec, -1
Li_end:
    s_cmp_lg_u32 s3, 2
    s_cbranch_scc1 L_cls2_no
    s_add_u32 s15, s4, 0
    s_cmp_lt_u32 s4, 24
    s_cbranch_scc1 L_role_tw
    s_add_u32 s15, s4, 4294967272
    s_cmp_lt_u32 s4, 32
    s_cbranch_scc1 L_role_p
    s_endpgm
L_cls2_no:
    s_cmp_lg_u32 s3, 3
    s_cbranch_scc1 L_cls3_no
    s_add_u32 s15, s4, 24
    s_cmp_lt_u32 s4, 12
    s_cbranch_scc1 L_role_tw
    s_add_u32 s15, s4, 4294967292
    s_cmp_lt_u32 s4, 32
    s_cbranch_scc1 L_role_p
    s_endpgm
L_cls3_no:
    s_cmp_lg_u32 s3, 4
    s_cbranch_scc1 L_cls4_no
    s_add_u32 s15, s4, 0
    s_cmp_lt_u32 s4, 16
    s_cbranch_scc1 L_role_aq
    s_add_u32 s15, s4, 4294967280
    s_cmp_lt_u32 s4, 19
    s_cbranch_scc1 L_role_awo
    s_add_u32 s15, s4, 9
    s_cmp_lt_u32 s4, 32
    s_cbranch_scc1 L_role_p
    s_endpgm
L_cls4_no:
    s_cmp_lg_u32 s3, 5
    s_cbranch_scc1 L_cls5_no
    s_add_u32 s15, s4, 16
    s_cmp_lt_u32 s4, 16
    s_cbranch_scc1 L_role_aq
    s_add_u32 s15, s4, 4294967283
    s_cmp_lt_u32 s4, 19
    s_cbranch_scc1 L_role_awo
    s_add_u32 s15, s4, 22
    s_cmp_lt_u32 s4, 32
    s_cbranch_scc1 L_role_p
    s_endpgm
L_cls5_no:
    s_cmp_lg_u32 s3, 6
    s_cbranch_scc1 L_cls6_no
    s_add_u32 s15, s4, 0
    s_cmp_lt_u32 s4, 11
    s_cbranch_scc1 L_role_ta
    s_add_u32 s15, s4, 43
    s_cmp_lt_u32 s4, 32
    s_cbranch_scc1 L_role_p
    s_endpgm
L_cls6_no:
    s_cmp_lg_u32 s3, 7
    s_cbranch_scc1 L_cls7_no
    s_add_u32 s15, s4, 11
    s_cmp_lt_u32 s4, 11
    s_cbranch_scc1 L_role_ta
    s_add_u32 s15, s4, 64
    s_cmp_lt_u32 s4, 32
    s_cbranch_scc1 L_role_p
    s_endpgm
L_cls7_no:
L_exit:
    s_endpgm
L_abort:
    s_waitcnt lgkmcnt(0)
    s_mov_b64 exec, -1
    v_mov_b32 v0, 60
    s_lshl_b32 s5, s3, 8
    s_or_b32 s5, s5, s4
    s_or_b32 s5, s5, 0x10000
    v_mov_b32 v1, s5
    global_store_dword v0, v1, s[12:13]
    s_endpgm
.p2align 6
L_role_p:
    v_and_b32 v5, 63, v0
    v_lshlrev_b32 v0, 4, v5
    v_and_b32 v7, 15, v5
    v_lshrrev_b32 v8, 4, v5
    v_min_u32 v1, 17, v5
    v_lshrrev_b32 v6, 2, v1
    v_and_b32 v1, 3, v1
    v_lshlrev_b32 v1, 2, v1
    v_lshl_add_u32 v1, v6, 7, v1
    v_mov_b32 v3, 1
    v_mov_b32 v4, 0
    s_mov_b32 s44, 0x05040100
    s_mov_b32 s45, 0x07060302
    s_cmp_ge_u32 s15, 48
    s_cselect_b32 s63, 1, 0
    s_cselect_b32 s17, 48, 0
    s_sub_u32 s15, s15, s17
    s_cmp_lt_u32 s15, 32
    s_cselect_b32 s50, 1, 0
    s_sub_u32 s17, s15, 32
    s_lshl_b32 s17, s17, 1
    s_cmp_eq_u32 s50, 1
    s_cselect_b32 s51, s15, s17
    s_cselect_b32 s17, 48, 40
    s_cselect_b32 s18, 56, 40
    s_load_dwordx2 s[20:21], s[0:1], s17
    s_load_dwordx2 s[24:25], s[0:1], s18
    s_mov_b32 s22, 4718592
    s_mov_b32 s23, 0x00020000
    s_mov_b32 s26, 4718592
    s_mov_b32 s27, 0x00020000
    s_lshl_b32 s49, s51, 8
    s_mul_i32 s17, s14, 131072
    s_add_u32 s49, s49, s17
    s_cmp_eq_u32 s50, 1
    s_cselect_b32 s17, 0, 256
    s_add_u32 s52, s49, s17
    s_waitcnt lgkmcnt(0)
    s_and_b32 s21, s21, 0xffff
    s_and_b32 s25, s25, 0xffff
    s_cmp_eq_u32 s63, 0
    s_cbranch_scc1 Lp2_gate_ng
    s_cmp_lg_u32 s14, 0
    s_cbranch_scc1 Lp2_gate_d
    v_mov_b32 v5, 48
    s_mov_b32 s16, 0
Lp2_gate:
    global_load_dword v6, v5, s[12:13] sc1
    s_add_u32 s16, s16, 1
    s_cmp_gt_u32 s16, 100000
    s_cbranch_scc1 L_role_p_abort
    s_waitcnt vmcnt(0)
    v_cmp_gt_u32 vcc, 32, v6
    s_nop 0
    s_cbranch_vccz Lp2_gate_d
    s_sleep 100
    s_branch Lp2_gate
Lp2_gate_d:
    s_barrier
Lp2_gate_ng:
    v_lshrrev_b32 v5, 8, v0
    v_bfe_u32 v6, v0, 6, 2
    v_xor_b32 v6, v6, v5
    v_lshlrev_b32 v6, 6, v6
    v_and_b32 v16, 0x30, v0
    v_add_u32 v16, v16, v6
    v_lshl_add_u32 v16, v5, 13, v16
    v_lshrrev_b32 v5, 2, v7
    v_xor_b32 v6, s14, v5
    v_lshlrev_b32 v17, 6, v6
    v_lshrrev_b32 v6, 1, v8
    v_lshl_add_u32 v5, v6, 3, v5
    v_lshl_add_u32 v17, v5, 8, v17
    v_and_b32 v5, 1, v8
    v_lshl_add_u32 v17, v5, 5, v17
    v_and_b32 v5, 3, v7
    v_lshl_add_u32 v17, v5, 3, v17
    v_add_u32 v18, 65536, v17
    s_lshl_b32 s46, s14, 12
    s_add_u32 m0, s46, 0
    s_add_u32 s17, s49, 0
    buffer_load_dwordx4 v16, s[20:23], s17 offen lds
    s_add_u32 m0, m0, 1024
    s_add_u32 s17, s49, 32768
    buffer_load_dwordx4 v16, s[20:23], s17 offen lds
    s_add_u32 m0, m0, 1024
    s_add_u32 s17, s49, 65536
    buffer_load_dwordx4 v16, s[20:23], s17 offen lds
    s_add_u32 m0, m0, 1024
    s_add_u32 s17, s49, 98304
    buffer_load_dwordx4 v16, s[20:23], s17 offen lds
    s_add_u32 m0, s46, 16384
    s_add_u32 s17, s49, 524288
    buffer_load_dwordx4 v16, s[20:23], s17 offen lds
    s_add_u32 m0, m0, 1024
    s_add_u32 s17, s49, 557056
    buffer_load_dwordx4 v16, s[20:23], s17 offen lds
    s_add_u32 m0, m0, 1024
    s_add_u32 s17, s49, 589824
    buffer_load_dwordx4 v16, s[20:23], s17 offen lds
    s_add_u32 m0, m0, 1024
    s_add_u32 s17, s49, 622592
    buffer_load_dwordx4 v16, s[20:23], s17 offen lds
    s_add_u32 m0, s46, 32768
    s_add_u32 s17, s49, 1048576
    buffer_load_dwordx4 v16, s[20:23], s17 offen lds
    s_add_u32 m0, m0, 1024
    s_add_u32 s17, s49, 1081344
    buffer_load_dwordx4 v16, s[20:23], s17 offen lds
    s_add_u32 m0, m0, 1024
    s_add_u32 s17, s49, 1114112
    buffer_load_dwordx4 v16, s[20:23], s17 offen lds
    s_add_u32 m0, m0, 1024
    s_add_u32 s17, s49, 1146880
    buffer_load_dwordx4 v16, s[20:23], s17 offen lds
    s_add_u32 m0, s46, 49152
    s_add_u32 s17, s49, 1572864
    buffer_load_dwordx4 v16, s[20:23], s17 offen lds
    s_add_u32 m0, m0, 1024
    s_add_u32 s17, s49, 1605632
    buffer_load_dwordx4 v16, s[20:23], s17 offen lds
    s_add_u32 m0, m0, 1024
    s_add_u32 s17, s49, 1638400
    buffer_load_dwordx4 v16, s[20:23], s17 offen lds
    s_add_u32 m0, m0, 1024
    s_add_u32 s17, s49, 1671168
    buffer_load_dwordx4 v16, s[20:23], s17 offen lds
    s_add_u32 m0, s46, 65536
    s_add_u32 s17, s49, 2097152
    buffer_load_dwordx4 v16, s[20:23], s17 offen lds
    s_add_u32 m0, m0, 1024
    s_add_u32 s17, s49, 2129920
    buffer_load_dwordx4 v16, s[20:23], s17 offen lds
    s_add_u32 m0, m0, 1024
    s_add_u32 s17, s49, 2162688
    buffer_load_dwordx4 v16, s[20:23], s17 offen lds
    s_add_u32 m0, m0, 1024
    s_add_u32 s17, s49, 2195456
    buffer_load_dwordx4 v16, s[20:23], s17 offen lds
    s_add_u32 m0, s46, 81920
    s_add_u32 s17, s49, 2621440
    buffer_load_dwordx4 v16, s[20:23], s17 offen lds
    s_add_u32 m0, m0, 1024
    s_add_u32 s17, s49, 2654208
    buffer_load_dwordx4 v16, s[20:23], s17 offen lds
    s_add_u32 m0, m0, 1024
    s_add_u32 s17, s49, 2686976
    buffer_load_dwordx4 v16, s[20:23], s17 offen lds
    s_add_u32 m0, m0, 1024
    s_add_u32 s17, s49, 2719744
    buffer_load_dwordx4 v16, s[20:23], s17 offen lds
    s_add_u32 m0, s46, 98304
    s_add_u32 s17, s49, 3145728
    buffer_load_dwordx4 v16, s[20:23], s17 offen lds
    s_add_u32 m0, m0, 1024
    s_add_u32 s17, s49, 3178496
    buffer_load_dwordx4 v16, s[20:23], s17 offen lds
    s_add_u32 m0, m0, 1024
    s_add_u32 s17, s49, 3211264
    buffer_load_dwordx4 v16, s[20:23], s17 offen lds
    s_add_u32 m0, m0, 1024
    s_add_u32 s17, s49, 3244032
    buffer_load_dwordx4 v16, s[20:23], s17 offen lds
    s_waitcnt vmcnt(24)
    s_barrier
    s_add_u32 m0, s46, 114688
    s_add_u32 s17, s49, 3670016
    buffer_load_dwordx4 v16, s[20:23], s17 offen lds
    s_add_u32 m0, m0, 1024
    s_add_u32 s17, s49, 3702784
    buffer_load_dwordx4 v16, s[20:23], s17 offen lds
    s_add_u32 m0, m0, 1024
    s_add_u32 s17, s49, 3735552
    buffer_load_dwordx4 v16, s[20:23], s17 offen lds
    s_add_u32 m0, m0, 1024
    s_add_u32 s17, s49, 3768320
    buffer_load_dwordx4 v16, s[20:23], s17 offen lds
    ds_read_b64_tr_b16 a[0:1], v17 offset:0
    ds_read_b64_tr_b16 a[2:3], v17 offset:1024
    ds_read_b64_tr_b16 a[4:5], v17 offset:4096
    ds_read_b64_tr_b16 a[6:7], v17 offset:5120
    ds_read_b64_tr_b16 a[8:9], v17 offset:8192
    ds_read_b64_tr_b16 a[10:11], v17 offset:9216
    ds_read_b64_tr_b16 a[12:13], v17 offset:12288
    ds_read_b64_tr_b16 a[14:15], v17 offset:13312
    s_waitcnt lgkmcnt(0)
    s_waitcnt vmcnt(24)
    s_barrier
    s_add_u32 m0, s46, 0
    s_add_u32 s17, s49, 4194304
    buffer_load_dwordx4 v16, s[20:23], s17 offen lds
    s_add_u32 m0, m0, 1024
    s_add_u32 s17, s49, 4227072
    buffer_load_dwordx4 v16, s[20:23], s17 offen lds
    s_add_u32 m0, m0, 1024
    s_add_u32 s17, s49, 4259840
    buffer_load_dwordx4 v16, s[20:23], s17 offen lds
    s_add_u32 m0, m0, 1024
    s_add_u32 s17, s49, 4292608
    buffer_load_dwordx4 v16, s[20:23], s17 offen lds
    ds_read_b64_tr_b16 a[16:17], v17 offset:16384
    ds_read_b64_tr_b16 a[18:19], v17 offset:17408
    ds_read_b64_tr_b16 a[20:21], v17 offset:20480
    ds_read_b64_tr_b16 a[22:23], v17 offset:21504
    ds_read_b64_tr_b16 a[24:25], v17 offset:24576
    ds_read_b64_tr_b16 a[26:27], v17 offset:25600
    ds_read_b64_tr_b16 a[28:29], v17 offset:28672
    ds_read_b64_tr_b16 a[30:31], v17 offset:29696
    s_waitcnt lgkmcnt(0)
    s_waitcnt vmcnt(24)
    s_barrier
    s_add_u32 m0, s46, 16384
    s_add_u32 s17, s52, 0
    buffer_load_dwordx4 v16, s[24:27], s17 offen lds
    s_add_u32 m0, m0, 1024
    s_add_u32 s17, s52, 32768
    buffer_load_dwordx4 v16, s[24:27], s17 offen lds
    s_add_u32 m0, m0, 1024
    s_add_u32 s17, s52, 65536
    buffer_load_dwordx4 v16, s[24:27], s17 offen lds
    s_add_u32 m0, m0, 1024
    s_add_u32 s17, s52, 98304
    buffer_load_dwordx4 v16, s[24:27], s17 offen lds
    ds_read_b64_tr_b16 a[32:33], v17 offset:32768
    ds_read_b64_tr_b16 a[34:35], v17 offset:33792
    ds_read_b64_tr_b16 a[36:37], v17 offset:36864
    ds_read_b64_tr_b16 a[38:39], v17 offset:37888
    ds_read_b64_tr_b16 a[40:41], v17 offset:40960
    ds_read_b64_tr_b16 a[42:43], v17 offset:41984
    ds_read_b64_tr_b16 a[44:45], v17 offset:45056
    ds_read_b64_tr_b16 a[46:47], v17 offset:46080
    s_waitcnt lgkmcnt(0)
    s_waitcnt vmcnt(24)
    s_barrier
    s_add_u32 m0, s46, 32768
    s_add_u32 s17, s52, 524288
    buffer_load_dwordx4 v16, s[24:27], s17 offen lds
    s_add_u32 m0, m0, 1024
    s_add_u32 s17, s52, 557056
    buffer_load_dwordx4 v16, s[24:27], s17 offen lds
    s_add_u32 m0, m0, 1024
    s_add_u32 s17, s52, 589824
    buffer_load_dwordx4 v16, s[24:27], s17 offen lds
    s_add_u32 m0, m0, 1024
    s_add_u32 s17, s52, 622592
    buffer_load_dwordx4 v16, s[24:27], s17 offen lds
    ds_read_b64_tr_b16 a[48:49], v17 offset:49152
    ds_read_b64_tr_b16 a[50:51], v17 offset:50176
    ds_read_b64_tr_b16 a[52:53], v17 offset:53248
    ds_read_b64_tr_b16 a[54:55], v17 offset:54272
    ds_read_b64_tr_b16 a[56:57], v17 offset:57344
    ds_read_b64_tr_b16 a[58:59], v17 offset:58368
    ds_read_b64_tr_b16 a[60:61], v17 offset:61440
    ds_read_b64_tr_b16 a[62:63], v17 offset:62464
    s_waitcnt lgkmcnt(0)
    s_waitcnt vmcnt(24)
    s_barrier
    s_add_u32 m0, s46, 49152
    s_add_u32 s17, s52, 1048576
    buffer_load_dwordx4 v16, s[24:27], s17 offen lds
    s_add_u32 m0, m0, 1024
    s_add_u32 s17, s52, 1081344
    buffer_load_dwordx4 v16, s[24:27], s17 offen lds
    s_add_u32 m0, m0, 1024
    s_add_u32 s17, s52, 1114112
    buffer_load_dwordx4 v16, s[24:27], s17 offen lds
    s_add_u32 m0, m0, 1024
    s_add_u32 s17, s52, 1146880
    buffer_load_dwordx4 v16, s[24:27], s17 offen lds
    ds_read_b64_tr_b16 a[64:65], v18 offset:0
    ds_read_b64_tr_b16 a[66:67], v18 offset:1024
    ds_read_b64_tr_b16 a[68:69], v18 offset:4096
    ds_read_b64_tr_b16 a[70:71], v18 offset:5120
    ds_read_b64_tr_b16 a[72:73], v18 offset:8192
    ds_read_b64_tr_b16 a[74:75], v18 offset:9216
    ds_read_b64_tr_b16 a[76:77], v18 offset:12288
    ds_read_b64_tr_b16 a[78:79], v18 offset:13312
    s_waitcnt lgkmcnt(0)
    s_waitcnt vmcnt(24)
    s_barrier
    s_add_u32 m0, s46, 65536
    s_add_u32 s17, s52, 1572864
    buffer_load_dwordx4 v16, s[24:27], s17 offen lds
    s_add_u32 m0, m0, 1024
    s_add_u32 s17, s52, 1605632
    buffer_load_dwordx4 v16, s[24:27], s17 offen lds
    s_add_u32 m0, m0, 1024
    s_add_u32 s17, s52, 1638400
    buffer_load_dwordx4 v16, s[24:27], s17 offen lds
    s_add_u32 m0, m0, 1024
    s_add_u32 s17, s52, 1671168
    buffer_load_dwordx4 v16, s[24:27], s17 offen lds
    ds_read_b64_tr_b16 a[80:81], v18 offset:16384
    ds_read_b64_tr_b16 a[82:83], v18 offset:17408
    ds_read_b64_tr_b16 a[84:85], v18 offset:20480
    ds_read_b64_tr_b16 a[86:87], v18 offset:21504
    ds_read_b64_tr_b16 a[88:89], v18 offset:24576
    ds_read_b64_tr_b16 a[90:91], v18 offset:25600
    ds_read_b64_tr_b16 a[92:93], v18 offset:28672
    ds_read_b64_tr_b16 a[94:95], v18 offset:29696
    s_waitcnt lgkmcnt(0)
    s_waitcnt vmcnt(24)
    s_barrier
    s_add_u32 m0, s46, 81920
    s_add_u32 s17, s52, 2097152
    buffer_load_dwordx4 v16, s[24:27], s17 offen lds
    s_add_u32 m0, m0, 1024
    s_add_u32 s17, s52, 2129920
    buffer_load_dwordx4 v16, s[24:27], s17 offen lds
    s_add_u32 m0, m0, 1024
    s_add_u32 s17, s52, 2162688
    buffer_load_dwordx4 v16, s[24:27], s17 offen lds
    s_add_u32 m0, m0, 1024
    s_add_u32 s17, s52, 2195456
    buffer_load_dwordx4 v16, s[24:27], s17 offen lds
    ds_read_b64_tr_b16 a[96:97], v18 offset:32768
    ds_read_b64_tr_b16 a[98:99], v18 offset:33792
    ds_read_b64_tr_b16 a[100:101], v18 offset:36864
    ds_read_b64_tr_b16 a[102:103], v18 offset:37888
    ds_read_b64_tr_b16 a[104:105], v18 offset:40960
    ds_read_b64_tr_b16 a[106:107], v18 offset:41984
    ds_read_b64_tr_b16 a[108:109], v18 offset:45056
    ds_read_b64_tr_b16 a[110:111], v18 offset:46080
    s_waitcnt lgkmcnt(0)
    s_waitcnt vmcnt(24)
    s_barrier
    s_add_u32 m0, s46, 98304
    s_add_u32 s17, s52, 2621440
    buffer_load_dwordx4 v16, s[24:27], s17 offen lds
    s_add_u32 m0, m0, 1024
    s_add_u32 s17, s52, 2654208
    buffer_load_dwordx4 v16, s[24:27], s17 offen lds
    s_add_u32 m0, m0, 1024
    s_add_u32 s17, s52, 2686976
    buffer_load_dwordx4 v16, s[24:27], s17 offen lds
    s_add_u32 m0, m0, 1024
    s_add_u32 s17, s52, 2719744
    buffer_load_dwordx4 v16, s[24:27], s17 offen lds
    ds_read_b64_tr_b16 a[112:113], v18 offset:49152
    ds_read_b64_tr_b16 a[114:115], v18 offset:50176
    ds_read_b64_tr_b16 a[116:117], v18 offset:53248
    ds_read_b64_tr_b16 a[118:119], v18 offset:54272
    ds_read_b64_tr_b16 a[120:121], v18 offset:57344
    ds_read_b64_tr_b16 a[122:123], v18 offset:58368
    ds_read_b64_tr_b16 a[124:125], v18 offset:61440
    ds_read_b64_tr_b16 a[126:127], v18 offset:62464
    s_waitcnt lgkmcnt(0)
    s_waitcnt vmcnt(24)
    s_barrier
    s_add_u32 m0, s46, 114688
    s_add_u32 s17, s52, 3145728
    buffer_load_dwordx4 v16, s[24:27], s17 offen lds
    s_add_u32 m0, m0, 1024
    s_add_u32 s17, s52, 3178496
    buffer_load_dwordx4 v16, s[24:27], s17 offen lds
    s_add_u32 m0, m0, 1024
    s_add_u32 s17, s52, 3211264
    buffer_load_dwordx4 v16, s[24:27], s17 offen lds
    s_add_u32 m0, m0, 1024
    s_add_u32 s17, s52, 3244032
    buffer_load_dwordx4 v16, s[24:27], s17 offen lds
    ds_read_b64_tr_b16 a[128:129], v17 offset:0
    ds_read_b64_tr_b16 a[130:131], v17 offset:1024
    ds_read_b64_tr_b16 a[132:133], v17 offset:4096
    ds_read_b64_tr_b16 a[134:135], v17 offset:5120
    ds_read_b64_tr_b16 a[136:137], v17 offset:8192
    ds_read_b64_tr_b16 a[138:139], v17 offset:9216
    ds_read_b64_tr_b16 a[140:141], v17 offset:12288
    ds_read_b64_tr_b16 a[142:143], v17 offset:13312
    s_waitcnt lgkmcnt(0)
    s_waitcnt vmcnt(24)
    s_barrier
    s_add_u32 m0, s46, 0
    s_add_u32 s17, s52, 3670016
    buffer_load_dwordx4 v16, s[24:27], s17 offen lds
    s_add_u32 m0, m0, 1024
    s_add_u32 s17, s52, 3702784
    buffer_load_dwordx4 v16, s[24:27], s17 offen lds
    s_add_u32 m0, m0, 1024
    s_add_u32 s17, s52, 3735552
    buffer_load_dwordx4 v16, s[24:27], s17 offen lds
    s_add_u32 m0, m0, 1024
    s_add_u32 s17, s52, 3768320
    buffer_load_dwordx4 v16, s[24:27], s17 offen lds
    ds_read_b64_tr_b16 a[144:145], v17 offset:16384
    ds_read_b64_tr_b16 a[146:147], v17 offset:17408
    ds_read_b64_tr_b16 a[148:149], v17 offset:20480
    ds_read_b64_tr_b16 a[150:151], v17 offset:21504
    ds_read_b64_tr_b16 a[152:153], v17 offset:24576
    ds_read_b64_tr_b16 a[154:155], v17 offset:25600
    ds_read_b64_tr_b16 a[156:157], v17 offset:28672
    ds_read_b64_tr_b16 a[158:159], v17 offset:29696
    s_waitcnt lgkmcnt(0)
    s_waitcnt vmcnt(24)
    s_barrier
    s_add_u32 m0, s46, 16384
    s_add_u32 s17, s52, 4194304
    buffer_load_dwordx4 v16, s[24:27], s17 offen lds
    s_add_u32 m0, m0, 1024
    s_add_u32 s17, s52, 4227072
    buffer_load_dwordx4 v16, s[24:27], s17 offen lds
    s_add_u32 m0, m0, 1024
    s_add_u32 s17, s52, 4259840
    buffer_load_dwordx4 v16, s[24:27], s17 offen lds
    s_add_u32 m0, m0, 1024
    s_add_u32 s17, s52, 4292608
    buffer_load_dwordx4 v16, s[24:27], s17 offen lds
    ds_read_b64_tr_b16 a[160:161], v17 offset:32768
    ds_read_b64_tr_b16 a[162:163], v17 offset:33792
    ds_read_b64_tr_b16 a[164:165], v17 offset:36864
    ds_read_b64_tr_b16 a[166:167], v17 offset:37888
    ds_read_b64_tr_b16 a[168:169], v17 offset:40960
    ds_read_b64_tr_b16 a[170:171], v17 offset:41984
    ds_read_b64_tr_b16 a[172:173], v17 offset:45056
    ds_read_b64_tr_b16 a[174:175], v17 offset:46080
    s_waitcnt lgkmcnt(0)
    s_waitcnt vmcnt(24)
    s_barrier
    ds_read_b64_tr_b16 a[176:177], v17 offset:49152
    ds_read_b64_tr_b16 a[178:179], v17 offset:50176
    ds_read_b64_tr_b16 a[180:181], v17 offset:53248
    ds_read_b64_tr_b16 a[182:183], v17 offset:54272
    ds_read_b64_tr_b16 a[184:185], v17 offset:57344
    ds_read_b64_tr_b16 a[186:187], v17 offset:58368
    ds_read_b64_tr_b16 a[188:189], v17 offset:61440
    ds_read_b64_tr_b16 a[190:191], v17 offset:62464
    s_waitcnt lgkmcnt(0)
    s_waitcnt vmcnt(20)
    s_barrier
    ds_read_b64_tr_b16 a[192:193], v18 offset:0
    ds_read_b64_tr_b16 a[194:195], v18 offset:1024
    ds_read_b64_tr_b16 a[196:197], v18 offset:4096
    ds_read_b64_tr_b16 a[198:199], v18 offset:5120
    ds_read_b64_tr_b16 a[200:201], v18 offset:8192
    ds_read_b64_tr_b16 a[202:203], v18 offset:9216
    ds_read_b64_tr_b16 a[204:205], v18 offset:12288
    ds_read_b64_tr_b16 a[206:207], v18 offset:13312
    s_waitcnt lgkmcnt(0)
    s_waitcnt vmcnt(16)
    s_barrier
    ds_read_b64_tr_b16 a[208:209], v18 offset:16384
    ds_read_b64_tr_b16 a[210:211], v18 offset:17408
    ds_read_b64_tr_b16 a[212:213], v18 offset:20480
    ds_read_b64_tr_b16 a[214:215], v18 offset:21504
    ds_read_b64_tr_b16 a[216:217], v18 offset:24576
    ds_read_b64_tr_b16 a[218:219], v18 offset:25600
    ds_read_b64_tr_b16 a[220:221], v18 offset:28672
    ds_read_b64_tr_b16 a[222:223], v18 offset:29696
    s_waitcnt lgkmcnt(0)
    s_waitcnt vmcnt(12)
    s_barrier
    ds_read_b64_tr_b16 a[224:225], v18 offset:32768
    ds_read_b64_tr_b16 a[226:227], v18 offset:33792
    ds_read_b64_tr_b16 a[228:229], v18 offset:36864
    ds_read_b64_tr_b16 a[230:231], v18 offset:37888
    ds_read_b64_tr_b16 a[232:233], v18 offset:40960
    ds_read_b64_tr_b16 a[234:235], v18 offset:41984
    ds_read_b64_tr_b16 a[236:237], v18 offset:45056
    ds_read_b64_tr_b16 a[238:239], v18 offset:46080
    s_waitcnt lgkmcnt(0)
    s_waitcnt vmcnt(8)
    s_barrier
    ds_read_b64_tr_b16 a[240:241], v18 offset:49152
    ds_read_b64_tr_b16 a[242:243], v18 offset:50176
    ds_read_b64_tr_b16 a[244:245], v18 offset:53248
    ds_read_b64_tr_b16 a[246:247], v18 offset:54272
    ds_read_b64_tr_b16 a[248:249], v18 offset:57344
    ds_read_b64_tr_b16 a[250:251], v18 offset:58368
    ds_read_b64_tr_b16 a[252:253], v18 offset:61440
    ds_read_b64_tr_b16 a[254:255], v18 offset:62464
    s_waitcnt lgkmcnt(0)
    s_waitcnt vmcnt(4)
    s_barrier
    ds_read_b64_tr_b16 v[152:153], v17 offset:0
    ds_read_b64_tr_b16 v[154:155], v17 offset:1024
    ds_read_b64_tr_b16 v[156:157], v17 offset:4096
    ds_read_b64_tr_b16 v[158:159], v17 offset:5120
    ds_read_b64_tr_b16 v[160:161], v17 offset:8192
    ds_read_b64_tr_b16 v[162:163], v17 offset:9216
    ds_read_b64_tr_b16 v[164:165], v17 offset:12288
    ds_read_b64_tr_b16 v[166:167], v17 offset:13312
    s_waitcnt lgkmcnt(0)
    s_waitcnt vmcnt(0)
    s_barrier
    ds_read_b64_tr_b16 v[168:169], v17 offset:16384
    ds_read_b64_tr_b16 v[170:171], v17 offset:17408
    ds_read_b64_tr_b16 v[172:173], v17 offset:20480
    ds_read_b64_tr_b16 v[174:175], v17 offset:21504
    ds_read_b64_tr_b16 v[176:177], v17 offset:24576
    ds_read_b64_tr_b16 v[178:179], v17 offset:25600
    ds_read_b64_tr_b16 v[180:181], v17 offset:28672
    ds_read_b64_tr_b16 v[182:183], v17 offset:29696
    s_waitcnt lgkmcnt(0)
    s_barrier
    v_bfe_u32 v10, v0, 4, 5
    v_lshrrev_b32 v5, 9, v0
    v_lshlrev_b32 v10, 4, v10
    v_mul_u32_u24 v6, 2560, v5
    v_add_u32 v10, v10, v6
    v_add_u32 v10, 114688, v10
    s_lshl_b32 s67, s14, 10
    v_bfe_u32 v6, v0, 8, 1
    v_lshlrev_b32 v14, 10, v6
    v_lshl_add_u32 v14, v7, 4, v14
    v_lshl_add_u32 v14, v5, 8, v14
    s_lshl_b32 s17, s51, 13
    s_lshl_b32 s18, s14, 11
    s_add_u32 s52, s17, s18
    s_add_u32 s52, s52, 44040192
    s_lshl_b32 s49, s51, 9
    s_lshl_b32 s17, s14, 2
    s_add_u32 s49, s49, s17
    s_add_u32 s49, s49, 5376
    s_cmp_eq_u32 s50, 1
    s_cselect_b32 s17, 16777216, 0
    s_cselect_b32 s18, 128, 0
    s_add_u32 s52, s52, s17
    s_add_u32 s49, s49, s18
    s_cmp_eq_u32 s50, 1
    s_cselect_b32 s17, 0, 384
    s_add_u32 s17, s17, 128
    v_lshrrev_b32 v185, 4, v0
    v_mul_lo_u32 v185, v185, s17
    v_mov_b32 v48, 0x3f803f80
    v_mov_b32 v49, 0x3f803f80
    v_mov_b32 v50, 0x3f803f80
    v_mov_b32 v51, 0x3f803f80
    s_lshl_b32 s17, s14, 8
    s_add_u32 s17, s17, 110592
    v_bfe_u32 v5, v0, 4, 5
    v_lshl_add_u32 v12, v5, 2, s17
    v_lshrrev_b32 v5, 9, v0
    v_lshl_add_u32 v13, v5, 4, s17
    s_cmp_eq_u32 s50, 1
    s_cbranch_scc1 Lp2_kv
    v_mfma_f32_32x32x16_bf16 v[84:99], a[0:3], v[48:51], 0
    v_mfma_f32_32x32x16_bf16 v[116:131], a[144:147], v[48:51], 0
    v_mfma_f32_32x32x16_bf16 v[84:99], a[4:7], v[48:51], v[84:99]
    v_mfma_f32_32x32x16_bf16 v[116:131], a[148:151], v[48:51], v[116:131]
    v_mfma_f32_32x32x16_bf16 v[84:99], a[8:11], v[48:51], v[84:99]
    v_mfma_f32_32x32x16_bf16 v[116:131], a[152:155], v[48:51], v[116:131]
    v_mfma_f32_32x32x16_bf16 v[84:99], a[12:15], v[48:51], v[84:99]
    v_mfma_f32_32x32x16_bf16 v[116:131], a[156:159], v[48:51], v[116:131]
    v_mfma_f32_32x32x16_bf16 v[84:99], a[16:19], v[48:51], v[84:99]
    v_mfma_f32_32x32x16_bf16 v[116:131], a[160:163], v[48:51], v[116:131]
    v_mfma_f32_32x32x16_bf16 v[84:99], a[20:23], v[48:51], v[84:99]
    v_mfma_f32_32x32x16_bf16 v[116:131], a[164:167], v[48:51], v[116:131]
    v_mfma_f32_32x32x16_bf16 v[84:99], a[24:27], v[48:51], v[84:99]
    v_mfma_f32_32x32x16_bf16 v[116:131], a[168:171], v[48:51], v[116:131]
    v_mfma_f32_32x32x16_bf16 v[84:99], a[28:31], v[48:51], v[84:99]
    v_mfma_f32_32x32x16_bf16 v[116:131], a[172:175], v[48:51], v[116:131]
    v_mfma_f32_32x32x16_bf16 v[84:99], a[32:35], v[48:51], v[84:99]
    v_mfma_f32_32x32x16_bf16 v[116:131], a[176:179], v[48:51], v[116:131]
    v_mfma_f32_32x32x16_bf16 v[84:99], a[36:39], v[48:51], v[84:99]
    v_mfma_f32_32x32x16_bf16 v[116:131], a[180:183], v[48:51], v[116:131]
    v_mfma_f32_32x32x16_bf16 v[84:99], a[40:43], v[48:51], v[84:99]
    v_mfma_f32_32x32x16_bf16 v[116:131], a[184:187], v[48:51], v[116:131]
    v_mfma_f32_32x32x16_bf16 v[84:99], a[44:47], v[48:51], v[84:99]
    v_mfma_f32_32x32x16_bf16 v[116:131], a[188:191], v[48:51], v[116:131]
    v_mfma_f32_32x32x16_bf16 v[84:99], a[48:51], v[48:51], v[84:99]
    v_mfma_f32_32x32x16_bf16 v[116:131], a[192:195], v[48:51], v[116:131]
    v_mfma_f32_32x32x16_bf16 v[84:99], a[52:55], v[48:51], v[84:99]
    v_mfma_f32_32x32x16_bf16 v[116:131], a[196:199], v[48:51], v[116:131]
    v_mfma_f32_32x32x16_bf16 v[84:99], a[56:59], v[48:51], v[84:99]
    v_mfma_f32_32x32x16_bf16 v[116:131], a[200:203], v[48:51], v[116:131]
    v_mfma_f32_32x32x16_bf16 v[84:99], a[60:63], v[48:51], v[84:99]
    v_mfma_f32_32x32x16_bf16 v[116:131], a[204:207], v[48:51], v[116:131]
    v_mfma_f32_32x32x16_bf16 v[84:99], a[64:67], v[48:51], v[84:99]
    v_mfma_f32_32x32x16_bf16 v[116:131], a[208:211], v[48:51], v[116:131]
    v_mfma_f32_32x32x16_bf16 v[84:99], a[68:71], v[48:51], v[84:99]
    v_mfma_f32_32x32x16_bf16 v[116:131], a[212:215], v[48:51], v[116:131]
    v_mfma_f32_32x32x16_bf16 v[84:99], a[72:75], v[48:51], v[84:99]
    v_mfma_f32_32x32x16_bf16 v[116:131], a[216:219], v[48:51], v[116:131]
    v_mfma_f32_32x32x16_bf16 v[84:99], a[76:79], v[48:51], v[84:99]
    v_mfma_f32_32x32x16_bf16 v[116:131], a[220:223], v[48:51], v[116:131]
    v_mfma_f32_32x32x16_bf16 v[84:99], a[80:83], v[48:51], v[84:99]
    v_mfma_f32_32x32x16_bf16 v[116:131], a[224:227], v[48:51], v[116:131]
    v_mfma_f32_32x32x16_bf16 v[84:99], a[84:87], v[48:51], v[84:99]
    v_mfma_f32_32x32x16_bf16 v[116:131], a[228:231], v[48:51], v[116:131]
    v_mfma_f32_32x32x16_bf16 v[84:99], a[88:91], v[48:51], v[84:99]
    v_mfma_f32_32x32x16_bf16 v[116:131], a[232:235], v[48:51], v[116:131]
    v_mfma_f32_32x32x16_bf16 v[84:99], a[92:95], v[48:51], v[84:99]
    v_mfma_f32_32x32x16_bf16 v[116:131], a[236:239], v[48:51], v[116:131]
    v_mfma_f32_32x32x16_bf16 v[84:99], a[96:99], v[48:51], v[84:99]
    v_mfma_f32_32x32x16_bf16 v[116:131], a[240:243], v[48:51], v[116:131]
    v_mfma_f32_32x32x16_bf16 v[84:99], a[100:103], v[48:51], v[84:99]
    v_mfma_f32_32x32x16_bf16 v[116:131], a[244:247], v[48:51], v[116:131]
    v_mfma_f32_32x32x16_bf16 v[84:99], a[104:107], v[48:51], v[84:99]
    v_mfma_f32_32x32x16_bf16 v[116:131], a[248:251], v[48:51], v[116:131]
    v_mfma_f32_32x32x16_bf16 v[84:99], a[108:111], v[48:51], v[84:99]
    v_mfma_f32_32x32x16_bf16 v[116:131], a[252:255], v[48:51], v[116:131]
    v_mfma_f32_32x32x16_bf16 v[84:99], a[112:115], v[48:51], v[84:99]
    v_mfma_f32_32x32x16_bf16 v[116:131], v[152:155], v[48:51], v[116:131]
    v_mfma_f32_32x32x16_bf16 v[84:99], a[116:119], v[48:51], v[84:99]
    v_mfma_f32_32x32x16_bf16 v[116:131], v[156:159], v[48:51], v[116:131]
    v_mfma_f32_32x32x16_bf16 v[84:99], a[120:123], v[48:51], v[84:99]
    v_mfma_f32_32x32x16_bf16 v[116:131], v[160:163], v[48:51], v[116:131]
    v_mfma_f32_32x32x16_bf16 v[84:99], a[124:127], v[48:51], v[84:99]
    v_mfma_f32_32x32x16_bf16 v[116:131], v[164:167], v[48:51], v[116:131]
    v_mfma_f32_32x32x16_bf16 v[84:99], a[128:131], v[48:51], v[84:99]
    v_mfma_f32_32x32x16_bf16 v[116:131], v[168:171], v[48:51], v[116:131]
    v_mfma_f32_32x32x16_bf16 v[84:99], a[132:135], v[48:51], v[84:99]
    v_mfma_f32_32x32x16_bf16 v[116:131], v[172:175], v[48:51], v[116:131]
    v_mfma_f32_32x32x16_bf16 v[84:99], a[136:139], v[48:51], v[84:99]
    v_mfma_f32_32x32x16_bf16 v[116:131], v[176:179], v[48:51], v[116:131]
    v_mfma_f32_32x32x16_bf16 v[84:99], a[140:143], v[48:51], v[84:99]
    v_mfma_f32_32x32x16_bf16 v[116:131], v[180:183], v[48:51], v[116:131]
    s_mov_b32 s66, 114688
    s_mov_b32 s71, 0x2000
    s_mov_b32 s36, s63
    s_mov_b32 s34, s63
    s_mul_i32 s58, s14, 9216
    s_mul_i32 s64, s63, 4718592
    s_add_u32 s64, s64, s58
    s_add_u32 s64, s64, 8650752
    s_mul_i32 s61, s63, 1441792
    s_add_u32 s61, s61, 3584
    s_mov_b32 s37, 0
    s_mov_b32 s40, 36864
    s_mov_b32 s59, s58
    s_mov_b32 s43, 0
    s_mov_b32 s62, 1
    s_mov_b32 s28, s8
    s_mov_b32 s29, s9
    s_mov_b32 s30, 0
    s_mov_b32 s31, 0x00020000
    v_mov_b32 v184, 74752
    v_mov_b32 v5, -1
    ds_write_b32 v184, v5
    s_waitcnt lgkmcnt(0)
    s_cmp_lg_u32 s14, 0
    s_cbranch_scc1 LpQQ_inia_d
    v_mov_b32 v5, 40
    s_mov_b32 s16, 0
LpQQ_inia:
    global_load_dword v6, v5, s[12:13] sc1
    s_add_u32 s16, s16, 1
    s_cmp_gt_u32 s16, 100000
    s_cbranch_scc1 L_role_p_abort
    s_waitcnt vmcnt(0)
    v_cmp_gt_u32 vcc, 72, v6
    s_nop 0
    s_cbranch_vccz LpQQ_inia_d
    s_sleep 8
    s_branch LpQQ_inia
LpQQ_inia_d:
    s_barrier
    s_cmp_eq_u32 s63, 0
    s_cbranch_scc1 LpQQ_ini_sk
    s_cmp_lg_u32 s14, 0
    s_cbranch_scc1 LpQQ_inib_d
    v_mov_b32 v5, 160
    s_mov_b32 s16, 0
LpQQ_inib:
    global_load_dword v6, v5, s[12:13] sc1
    s_add_u32 s16, s16, 1
    s_cmp_gt_u32 s16, 100000
    s_cbranch_scc1 L_role_p_abort
    s_waitcnt vmcnt(0)
    v_cmp_gt_u32 vcc, 64, v6
    s_nop 0
    s_cbranch_vccz LpQQ_inib_d
    s_sleep 8
    s_branch LpQQ_inib
LpQQ_inib_d:
    s_barrier
LpQQ_ini_sk:
    s_mul_i32 s41, s37, 36864
    s_add_u32 s41, s41, s64
    s_mul_i32 s60, s37, 22528
    s_add_u32 s60, s60, s61
    s_cmp_lt_u32 s37, 64
    s_cselect_b32 s60, s60, 2883584
    s_branch LpQQ_wait
LpQQ_head:
    s_waitcnt vmcnt(4)
LpQQ_head2:
    s_barrier
    ds_read_b32 v15, v184
    s_xor_b32 s40, s40, 36864
    s_xor_b32 s59, s59, 36864
    s_mov_b32 s35, s37
    s_lshl_b32 s57, s34, 6
    s_add_u32 s57, s57, s35
    s_add_u32 s37, s37, 1
    s_mov_b32 s39, 0
    s_mov_b32 s54, 0
    s_xor_b32 s66, s66, 8192
    s_xor_b32 s71, s71, 8192
    s_mul_i32 s41, s37, 36864
    s_add_u32 s41, s41, s64
    s_mul_i32 s60, s37, 22528
    s_add_u32 s60, s60, s61
    s_cmp_lt_u32 s37, 64
    s_cselect_b32 s60, s60, 2883584
    v_add_u32 v9, s40, v0
    v_add_u32 v5, s71, v10
    ds_read_b128 v[48:51], v9 offset:0
    ds_read_b128 v[52:55], v9 offset:1024
    ds_read_b128 v[56:59], v9 offset:2048
    ds_read_b128 v[64:67], v5 offset:0
    ds_read_b128 v[68:71], v5 offset:512
    ds_read_b128 v[72:75], v5 offset:1024
    ds_read_b128 v[76:79], v5 offset:1536
    ds_read_b128 v[80:83], v5 offset:2048
    s_waitcnt lgkmcnt(7)
    v_mfma_f32_32x32x16_bf16 v[16:31], a[0:3], v[48:51], 0
    ds_read_b128 v[60:63], v9 offset:3072
    v_mfma_f32_32x32x16_bf16 v[32:47], a[144:147], v[48:51], 0
    s_waitcnt lgkmcnt(4)
    v_add_f32 v64, v64, v68
    v_add_f32 v65, v65, v69
    v_add_f32 v66, v66, v70
    v_add_f32 v67, v67, v71
    v_mfma_f32_32x32x16_bf16 v[16:31], a[4:7], v[52:55], v[16:31]
    ds_read_b128 v[48:51], v9 offset:4096
    s_waitcnt lgkmcnt(4)
    v_add_f32 v64, v64, v72
    v_add_f32 v65, v65, v73
    v_add_f32 v66, v66, v74
    v_mfma_f32_32x32x16_bf16 v[32:47], a[148:151], v[52:55], v[32:47]
    v_add_f32 v67, v67, v75
    s_waitcnt lgkmcnt(3)
    v_add_f32 v64, v64, v76
    v_add_f32 v65, v65, v77
    v_add_f32 v66, v66, v78
    v_readfirstlane_b32 s17, v15
    s_nop 0
    s_add_u32 s18, s17, 1
    s_max_i32 s32, s18, s37
    s_add_u32 s39, s37, 1
    s_min_u32 s39, s39, 63
    s_mul_i32 s33, s32, 22528
    s_add_u32 s33, s33, s61
    s_cmp_eq_u32 s14, 0
    s_cselect_b32 s18, s32, 0x7fff
    v_mov_b32 v2, 2
    s_cmp_le_u32 s18, s39
    s_cselect_b64 exec, -1, 0
    buffer_load_dword v2, v1, s[8:11], s33 offen sc1
    s_mov_b64 exec, -1
    s_cmp_ge_i32 s17, s37
    s_cbranch_scc1 LpQQ_f_1
    v_mfma_f32_32x32x16_bf16 v[16:31], a[8:11], v[56:59], v[16:31]
    ds_read_b128 v[52:55], v9 offset:5120
    v_add_f32 v67, v67, v79
    s_waitcnt lgkmcnt(3)
    v_add_f32 v64, v64, v80
    v_add_f32 v65, v65, v81
    v_mfma_f32_32x32x16_bf16 v[32:47], a[152:155], v[56:59], v[32:47]
    v_add_f32 v66, v66, v82
    v_add_f32 v67, v67, v83
    v_add_f32 v64, v64, v66
    v_add_f32 v65, v65, v67
    s_waitcnt lgkmcnt(2)
    v_mfma_f32_32x32x16_bf16 v[16:31], a[12:15], v[60:63], v[16:31]
    ds_read_b128 v[56:59], v9 offset:6144
    v_mov_b32 v66, v64
    v_mov_b32 v67, v65
    s_nop 0
    v_permlane32_swap_b32 v64, v66
    v_mfma_f32_32x32x16_bf16 v[32:47], a[156:159], v[60:63], v[32:47]
    v_permlane32_swap_b32 v65, v67
    v_add_f32 v64, v64, v66
    v_add_f32 v65, v65, v67
    v_mul_f32 v64, 0x3ae38e39, v64
    s_waitcnt lgkmcnt(2)
    v_mfma_f32_32x32x16_bf16 v[16:31], a[16:19], v[48:51], v[16:31]
    ds_read_b128 v[60:63], v9 offset:7168
    v_mul_f32 v65, 0x3ae38e39, v65
    v_fma_f32 v65, -v64, v64, v65
    v_max_f32 v65, 0, v65
    v_mfma_f32_32x32x16_bf16 v[32:47], a[160:163], v[48:51], v[32:47]
    v_add_f32 v65, 0x3727c5ac, v65
    v_rsq_f32 v148, v65
    s_nop 0
    v_mul_f32 v149, v64, v148
    v_mul_f32 v100, v149, v84
    s_waitcnt lgkmcnt(2)
    v_mfma_f32_32x32x16_bf16 v[16:31], a[20:23], v[52:55], v[16:31]
    ds_read_b128 v[48:51], v9 offset:8192
    v_mul_f32 v101, v149, v85
    v_mul_f32 v102, v149, v86
    v_mul_f32 v103, v149, v87
    v_mfma_f32_32x32x16_bf16 v[32:47], a[164:167], v[52:55], v[32:47]
    v_mul_f32 v104, v149, v88
    v_mul_f32 v105, v149, v89
    v_mul_f32 v106, v149, v90
    v_mul_f32 v107, v149, v91
    s_waitcnt lgkmcnt(2)
    v_mfma_f32_32x32x16_bf16 v[16:31], a[24:27], v[56:59], v[16:31]
    ds_read_b128 v[52:55], v9 offset:9216
    v_mul_f32 v108, v149, v92
    v_mul_f32 v109, v149, v93
    v_mul_f32 v110, v149, v94
    v_mfma_f32_32x32x16_bf16 v[32:47], a[168:171], v[56:59], v[32:47]
    v_mul_f32 v111, v149, v95
    v_mul_f32 v112, v149, v96
    v_mul_f32 v113, v149, v97
    v_mul_f32 v114, v149, v98
    s_waitcnt lgkmcnt(2)
    v_mfma_f32_32x32x16_bf16 v[16:31], a[28:31], v[60:63], v[16:31]
    ds_read_b128 v[56:59], v9 offset:10240
    v_mul_f32 v115, v149, v99
    v_mul_f32 v132, v149, v116
    v_mul_f32 v133, v149, v117
    v_mfma_f32_32x32x16_bf16 v[32:47], a[172:175], v[60:63], v[32:47]
    v_mul_f32 v134, v149, v118
    v_mul_f32 v135, v149, v119
    v_mul_f32 v136, v149, v120
    v_mul_f32 v137, v149, v121
    s_waitcnt lgkmcnt(2)
    v_mfma_f32_32x32x16_bf16 v[16:31], a[32:35], v[48:51], v[16:31]
    ds_read_b128 v[60:63], v9 offset:11264
    v_mul_f32 v138, v149, v122
    v_mul_f32 v139, v149, v123
    v_mul_f32 v140, v149, v124
    v_mfma_f32_32x32x16_bf16 v[32:47], a[176:179], v[48:51], v[32:47]
    v_mul_f32 v141, v149, v125
    v_mul_f32 v142, v149, v126
    v_mul_f32 v143, v149, v127
    v_mul_f32 v144, v149, v128
    s_waitcnt lgkmcnt(2)
    v_mfma_f32_32x32x16_bf16 v[16:31], a[36:39], v[52:55], v[16:31]
    ds_read_b128 v[48:51], v9 offset:12288
    v_mul_f32 v145, v149, v129
    v_mul_f32 v146, v149, v130
    v_mul_f32 v147, v149, v131
    v_mfma_f32_32x32x16_bf16 v[32:47], a[180:183], v[52:55], v[32:47]
    s_mul_i32 s46, s34, 50331648
    s_lshl_b32 s51, s35, 18
    s_add_u32 s46, s46, s51
    s_add_u32 s46, s46, s52
    s_waitcnt lgkmcnt(2)
    v_mfma_f32_32x32x16_bf16 v[16:31], a[40:43], v[56:59], v[16:31]
    ds_read_b128 v[52:55], v9 offset:13312
    v_mfma_f32_32x32x16_bf16 v[32:47], a[184:187], v[56:59], v[32:47]
    s_waitcnt lgkmcnt(2)
    v_mfma_f32_32x32x16_bf16 v[16:31], a[44:47], v[60:63], v[16:31]
    ds_read_b128 v[56:59], v9 offset:14336
    v_mfma_f32_32x32x16_bf16 v[32:47], a[188:191], v[60:63], v[32:47]
    s_waitcnt lgkmcnt(2)
    v_mfma_f32_32x32x16_bf16 v[16:31], a[48:51], v[48:51], v[16:31]
    ds_read_b128 v[60:63], v9 offset:15360
    v_mfma_f32_32x32x16_bf16 v[32:47], a[192:195], v[48:51], v[32:47]
    s_waitcnt vmcnt(1)
    s_cmp_lg_u32 s43, 0
    s_cselect_b64 exec, 3, 0
    buffer_store_dword v3, v185, s[8:11], s43 offen sc1
    s_mov_b64 exec, -1
    s_mov_b32 s43, 0
    s_waitcnt lgkmcnt(2)
    v_mfma_f32_32x32x16_bf16 v[16:31], a[52:55], v[52:55], v[16:31]
    ds_read_b128 v[48:51], v9 offset:16384
    v_mfma_f32_32x32x16_bf16 v[32:47], a[196:199], v[52:55], v[32:47]
    s_waitcnt lgkmcnt(2)
    v_mfma_f32_32x32x16_bf16 v[16:31], a[56:59], v[56:59], v[16:31]
    v_cmp_eq_u32 s[76:77], 1, v2
    v_cmp_eq_u32 vcc, 2, v2
    s_cmp_eq_u64 s[76:77], -1
    s_cselect_b32 s38, 1, 0
    ds_read_b128 v[52:55], v9 offset:17408
    v_mfma_f32_32x32x16_bf16 v[32:47], a[200:203], v[56:59], v[32:47]
    s_cmp_lg_u32 s38, 0
    s_cselect_b64 exec, 1, 0
    v_mov_b32 v15, s32
    ds_write_b32 v184, v15
    v_mov_b32 v2, 2
    s_mov_b64 exec, -1
    s_waitcnt lgkmcnt(3)
    v_mfma_f32_32x32x16_bf16 v[16:31], a[60:63], v[60:63], v[16:31]
    s_add_u32 s32, s32, s38
    s_mul_i32 s38, s38, 22528
    s_add_u32 s33, s33, s38
    ds_read_b128 v[56:59], v9 offset:18432
    v_mfma_f32_32x32x16_bf16 v[32:47], a[204:207], v[60:63], v[32:47]
    s_cmp_eq_u64 vcc, 0
    s_cselect_b32 s38, s32, 0x7fff
    s_waitcnt lgkmcnt(3)
    v_mfma_f32_32x32x16_bf16 v[16:31], a[64:67], v[48:51], v[16:31]
    ds_read_b128 v[60:63], v9 offset:19456
    v_mfma_f32_32x32x16_bf16 v[32:47], a[208:211], v[48:51], v[32:47]
    s_cmp_le_u32 s38, s39
    s_cselect_b64 exec, -1, 0
    v_mov_b32 v2, 2
    buffer_load_dword v2, v1, s[8:11], s33 offen sc1
    s_mov_b64 exec, -1
    ds_read_b32 v15, v184
    s_waitcnt lgkmcnt(4)
    v_mfma_f32_32x32x16_bf16 v[16:31], a[68:71], v[52:55], v[16:31]
    ds_read_b128 v[48:51], v9 offset:20480
    v_mfma_f32_32x32x16_bf16 v[32:47], a[212:215], v[52:55], v[32:47]
    s_waitcnt lgkmcnt(3)
    v_mfma_f32_32x32x16_bf16 v[16:31], a[72:75], v[56:59], v[16:31]
    ds_read_b128 v[52:55], v9 offset:21504
    v_mfma_f32_32x32x16_bf16 v[32:47], a[216:219], v[56:59], v[32:47]
    s_waitcnt lgkmcnt(2)
    v_readfirstlane_b32 s17, v15
    s_nop 0
    s_cmp_ge_i32 s17, s37
    s_cbranch_scc1 LpQQ_f_2
    v_mfma_f32_32x32x16_bf16 v[16:31], a[76:79], v[60:63], v[16:31]
    ds_read_b128 v[56:59], v9 offset:22528
    v_mfma_f32_32x32x16_bf16 v[32:47], a[220:223], v[60:63], v[32:47]
    s_waitcnt lgkmcnt(2)
    v_mfma_f32_32x32x16_bf16 v[16:31], a[80:83], v[48:51], v[16:31]
    ds_read_b128 v[60:63], v9 offset:23552
    v_mfma_f32_32x32x16_bf16 v[32:47], a[224:227], v[48:51], v[32:47]
    s_waitcnt lgkmcnt(2)
    v_mfma_f32_32x32x16_bf16 v[16:31], a[84:87], v[52:55], v[16:31]
    ds_read_b128 v[48:51], v9 offset:24576
    v_mfma_f32_32x32x16_bf16 v[32:47], a[228:231], v[52:55], v[32:47]
    s_waitcnt lgkmcnt(2)
    v_mfma_f32_32x32x16_bf16 v[16:31], a[88:91], v[56:59], v[16:31]
    ds_read_b128 v[52:55], v9 offset:25600
    v_mfma_f32_32x32x16_bf16 v[32:47], a[232:235], v[56:59], v[32:47]
    s_waitcnt lgkmcnt(2)
    v_mfma_f32_32x32x16_bf16 v[16:31], a[92:95], v[60:63], v[16:31]
    ds_read_b128 v[56:59], v9 offset:26624
    v_mfma_f32_32x32x16_bf16 v[32:47], a[236:239], v[60:63], v[32:47]
    s_waitcnt lgkmcnt(2)
    v_mfma_f32_32x32x16_bf16 v[16:31], a[96:99], v[48:51], v[16:31]
    ds_read_b128 v[60:63], v9 offset:27648
    v_mfma_f32_32x32x16_bf16 v[32:47], a[240:243], v[48:51], v[32:47]
    s_waitcnt lgkmcnt(2)
    v_mfma_f32_32x32x16_bf16 v[16:31], a[100:103], v[52:55], v[16:31]
    ds_read_b128 v[48:51], v9 offset:28672
    v_mfma_f32_32x32x16_bf16 v[32:47], a[244:247], v[52:55], v[32:47]
    s_waitcnt lgkmcnt(2)
    v_mfma_f32_32x32x16_bf16 v[16:31], a[104:107], v[56:59], v[16:31]
    ds_read_b128 v[52:55], v9 offset:29696
    v_mfma_f32_32x32x16_bf16 v[32:47], a[248:251], v[56:59], v[32:47]
    s_waitcnt lgkmcnt(2)
    v_mfma_f32_32x32x16_bf16 v[16:31], a[108:111], v[60:63], v[16:31]
    ds_read_b128 v[56:59], v9 offset:30720
    v_mfma_f32_32x32x16_bf16 v[32:47], a[252:255], v[60:63], v[32:47]
    s_waitcnt lgkmcnt(2)
    v_mfma_f32_32x32x16_bf16 v[16:31], a[112:115], v[48:51], v[16:31]
    ds_read_b128 v[60:63], v9 offset:31744
    v_mfma_f32_32x32x16_bf16 v[32:47], v[152:155], v[48:51], v[32:47]
    s_waitcnt lgkmcnt(2)
    v_mfma_f32_32x32x16_bf16 v[16:31], a[116:119], v[52:55], v[16:31]
    ds_read_b128 v[48:51], v9 offset:32768
    v_mfma_f32_32x32x16_bf16 v[32:47], v[156:159], v[52:55], v[32:47]
    s_waitcnt lgkmcnt(2)
    v_mfma_f32_32x32x16_bf16 v[16:31], a[120:123], v[56:59], v[16:31]
    ds_read_b128 v[52:55], v9 offset:33792
    v_mfma_f32_32x32x16_bf16 v[32:47], v[160:163], v[56:59], v[32:47]
    s_waitcnt lgkmcnt(2)
    v_mfma_f32_32x32x16_bf16 v[16:31], a[124:127], v[60:63], v[16:31]
    v_cmp_eq_u32 s[76:77], 1, v2
    v_cmp_eq_u32 vcc, 2, v2
    s_cmp_eq_u64 s[76:77], -1
    s_cselect_b32 s38, 1, 0
    ds_read_b128 v[56:59], v9 offset:34816
    v_mfma_f32_32x32x16_bf16 v[32:47], v[164:167], v[60:63], v[32:47]
    s_cmp_lg_u32 s38, 0
    s_cselect_b64 exec, 1, 0
    v_mov_b32 v15, s32
    ds_write_b32 v184, v15
    v_mov_b32 v2, 2
    s_mov_b64 exec, -1
    s_waitcnt lgkmcnt(3)
    v_mfma_f32_32x32x16_bf16 v[16:31], a[128:131], v[48:51], v[16:31]
    s_add_u32 s32, s32, s38
    s_mul_i32 s38, s38, 22528
    s_add_u32 s33, s33, s38
    ds_read_b128 v[60:63], v9 offset:35840
    v_mfma_f32_32x32x16_bf16 v[32:47], v[168:171], v[48:51], v[32:47]
    s_cmp_eq_u64 vcc, 0
    s_cselect_b32 s38, s32, 0x7fff
    s_waitcnt lgkmcnt(3)
    v_mfma_f32_32x32x16_bf16 v[16:31], a[132:135], v[52:55], v[16:31]
    s_cmp_le_u32 s38, s39
    s_cselect_b64 exec, -1, 0
    v_mov_b32 v2, 2
    buffer_load_dword v2, v1, s[8:11], s33 offen sc1
    s_mov_b64 exec, -1
    v_mfma_f32_32x32x16_bf16 v[32:47], v[172:175], v[52:55], v[32:47]
    s_waitcnt lgkmcnt(2)
    v_mfma_f32_32x32x16_bf16 v[16:31], a[136:139], v[56:59], v[16:31]
    v_mfma_f32_32x32x16_bf16 v[32:47], v[176:179], v[56:59], v[32:47]
    s_waitcnt lgkmcnt(0)
    v_mfma_f32_32x32x16_bf16 v[16:31], a[140:143], v[60:63], v[16:31]
    v_mfma_f32_32x32x16_bf16 v[32:47], v[180:183], v[60:63], v[32:47]
    s_add_u32 s51, s46, 8192
    s_nop 2
    v_pk_fma_f32 v[16:17], v[16:17], v[148:149], v[100:101] op_sel_hi:[1,0,1] neg_lo:[0,0,1] neg_hi:[0,0,1]
    v_pk_fma_f32 v[18:19], v[18:19], v[148:149], v[102:103] op_sel_hi:[1,0,1] neg_lo:[0,0,1] neg_hi:[0,0,1]
    v_pk_fma_f32 v[20:21], v[20:21], v[148:149], v[104:105] op_sel_hi:[1,0,1] neg_lo:[0,0,1] neg_hi:[0,0,1]
    v_pk_fma_f32 v[22:23], v[22:23], v[148:149], v[106:107] op_sel_hi:[1,0,1] neg_lo:[0,0,1] neg_hi:[0,0,1]
    v_pk_fma_f32 v[24:25], v[24:25], v[148:149], v[108:109] op_sel_hi:[1,0,1] neg_lo:[0,0,1] neg_hi:[0,0,1]
    v_pk_fma_f32 v[26:27], v[26:27], v[148:149], v[110:111] op_sel_hi:[1,0,1] neg_lo:[0,0,1] neg_hi:[0,0,1]
    v_pk_fma_f32 v[28:29], v[28:29], v[148:149], v[112:113] op_sel_hi:[1,0,1] neg_lo:[0,0,1] neg_hi:[0,0,1]
    v_pk_fma_f32 v[30:31], v[30:31], v[148:149], v[114:115] op_sel_hi:[1,0,1] neg_lo:[0,0,1] neg_hi:[0,0,1]
    v_cvt_pk_bf16_f32 v188, v16, v24
    v_cvt_pk_bf16_f32 v189, v17, v25
    v_cvt_pk_bf16_f32 v190, v18, v26
    v_cvt_pk_bf16_f32 v191, v19, v27
    buffer_store_dwordx4 v[188:191], v14, s[8:11], s46 offen offset:0 sc1
    v_cvt_pk_bf16_f32 v192, v20, v28
    v_cvt_pk_bf16_f32 v193, v21, v29
    v_cvt_pk_bf16_f32 v194, v22, v30
    v_cvt_pk_bf16_f32 v195, v23, v31
    buffer_store_dwordx4 v[192:195], v14, s[8:11], s46 offen offset:512 sc1
    v_pk_fma_f32 v[32:33], v[32:33], v[148:149], v[132:133] op_sel_hi:[1,0,1] neg_lo:[0,0,1] neg_hi:[0,0,1]
    v_pk_fma_f32 v[34:35], v[34:35], v[148:149], v[134:135] op_sel_hi:[1,0,1] neg_lo:[0,0,1] neg_hi:[0,0,1]
    v_pk_fma_f32 v[36:37], v[36:37], v[148:149], v[136:137] op_sel_hi:[1,0,1] neg_lo:[0,0,1] neg_hi:[0,0,1]
    v_pk_fma_f32 v[38:39], v[38:39], v[148:149], v[138:139] op_sel_hi:[1,0,1] neg_lo:[0,0,1] neg_hi:[0,0,1]
    v_pk_fma_f32 v[40:41], v[40:41], v[148:149], v[140:141] op_sel_hi:[1,0,1] neg_lo:[0,0,1] neg_hi:[0,0,1]
    v_pk_fma_f32 v[42:43], v[42:43], v[148:149], v[142:143] op_sel_hi:[1,0,1] neg_lo:[0,0,1] neg_hi:[0,0,1]
    v_pk_fma_f32 v[44:45], v[44:45], v[148:149], v[144:145] op_sel_hi:[1,0,1] neg_lo:[0,0,1] neg_hi:[0,0,1]
    v_pk_fma_f32 v[46:47], v[46:47], v[148:149], v[146:147] op_sel_hi:[1,0,1] neg_lo:[0,0,1] neg_hi:[0,0,1]
    v_cvt_pk_bf16_f32 v196, v32, v40
    v_cvt_pk_bf16_f32 v197, v33, v41
    v_cvt_pk_bf16_f32 v198, v34, v42
    v_cvt_pk_bf16_f32 v199, v35, v43
    buffer_store_dwordx4 v[196:199], v14, s[8:11], s51 offen offset:0 sc1
    v_cvt_pk_bf16_f32 v200, v36, v44
    v_cvt_pk_bf16_f32 v201, v37, v45
    v_cvt_pk_bf16_f32 v202, v38, v46
    v_cvt_pk_bf16_f32 v203, v39, v47
    buffer_store_dwordx4 v[200:203], v14, s[8:11], s51 offen offset:512 sc1
    s_mul_i32 s43, s57, 22528
    s_add_u32 s43, s43, s49
    s_branch LpQQ_none
LpQQ_f_1:
    v_mfma_f32_32x32x16_bf16 v[16:31], a[8:11], v[56:59], v[16:31]
    ds_read_b128 v[52:55], v9 offset:5120
    v_add_f32 v67, v67, v79
    s_waitcnt lgkmcnt(3)
    v_add_f32 v64, v64, v80
    v_add_f32 v65, v65, v81
    v_mfma_f32_32x32x16_bf16 v[32:47], a[152:155], v[56:59], v[32:47]
    v_add_f32 v66, v66, v82
    v_add_f32 v67, v67, v83
    v_add_f32 v64, v64, v66
    v_add_f32 v65, v65, v67
    s_waitcnt lgkmcnt(2)
    v_mfma_f32_32x32x16_bf16 v[16:31], a[12:15], v[60:63], v[16:31]
    ds_read_b128 v[56:59], v9 offset:6144
    v_mov_b32 v66, v64
    v_mov_b32 v67, v65
    s_nop 0
    v_permlane32_swap_b32 v64, v66
    v_mfma_f32_32x32x16_bf16 v[32:47], a[156:159], v[60:63], v[32:47]
    v_permlane32_swap_b32 v65, v67
    v_add_f32 v64, v64, v66
    v_add_f32 v65, v65, v67
    v_mul_f32 v64, 0x3ae38e39, v64
    s_waitcnt lgkmcnt(2)
    v_mfma_f32_32x32x16_bf16 v[16:31], a[16:19], v[48:51], v[16:31]
    ds_read_b128 v[60:63], v9 offset:7168
    v_mul_f32 v65, 0x3ae38e39, v65
    v_fma_f32 v65, -v64, v64, v65
    v_max_f32 v65, 0, v65
    v_mfma_f32_32x32x16_bf16 v[32:47], a[160:163], v[48:51], v[32:47]
    v_add_f32 v65, 0x3727c5ac, v65
    v_rsq_f32 v148, v65
    s_nop 0
    v_mul_f32 v149, v64, v148
    v_mul_f32 v100, v149, v84
    s_waitcnt lgkmcnt(2)
    v_mfma_f32_32x32x16_bf16 v[16:31], a[20:23], v[52:55], v[16:31]
    ds_read_b128 v[48:51], v9 offset:8192
    v_mul_f32 v101, v149, v85
    v_mul_f32 v102, v149, v86
    v_mul_f32 v103, v149, v87
    v_mfma_f32_32x32x16_bf16 v[32:47], a[164:167], v[52:55], v[32:47]
    v_mul_f32 v104, v149, v88
    v_mul_f32 v105, v149, v89
    v_mul_f32 v106, v149, v90
    v_mul_f32 v107, v149, v91
    s_waitcnt lgkmcnt(2)
    v_mfma_f32_32x32x16_bf16 v[16:31], a[24:27], v[56:59], v[16:31]
    ds_read_b128 v[52:55], v9 offset:9216
    v_mul_f32 v108, v149, v92
    v_mul_f32 v109, v149, v93
    v_mul_f32 v110, v149, v94
    v_mfma_f32_32x32x16_bf16 v[32:47], a[168:171], v[56:59], v[32:47]
    v_mul_f32 v111, v149, v95
    v_mul_f32 v112, v149, v96
    v_mul_f32 v113, v149, v97
    v_mul_f32 v114, v149, v98
    s_waitcnt lgkmcnt(2)
    v_mfma_f32_32x32x16_bf16 v[16:31], a[28:31], v[60:63], v[16:31]
    ds_read_b128 v[56:59], v9 offset:10240
    v_mul_f32 v115, v149, v99
    v_mul_f32 v132, v149, v116
    v_mul_f32 v133, v149, v117
    v_mfma_f32_32x32x16_bf16 v[32:47], a[172:175], v[60:63], v[32:47]
    v_mul_f32 v134, v149, v118
    v_mul_f32 v135, v149, v119
    v_mul_f32 v136, v149, v120
    v_mul_f32 v137, v149, v121
    s_waitcnt lgkmcnt(2)
    v_mfma_f32_32x32x16_bf16 v[16:31], a[32:35], v[48:51], v[16:31]
    ds_read_b128 v[60:63], v9 offset:11264
    v_mul_f32 v138, v149, v122
    v_mul_f32 v139, v149, v123
    v_mul_f32 v140, v149, v124
    v_mfma_f32_32x32x16_bf16 v[32:47], a[176:179], v[48:51], v[32:47]
    v_mul_f32 v141, v149, v125
    v_mul_f32 v142, v149, v126
    v_mul_f32 v143, v149, v127
    v_mul_f32 v144, v149, v128
    s_waitcnt lgkmcnt(2)
    v_mfma_f32_32x32x16_bf16 v[16:31], a[36:39], v[52:55], v[16:31]
    ds_read_b128 v[48:51], v9 offset:12288
    v_mul_f32 v145, v149, v129
    v_mul_f32 v146, v149, v130
    v_mul_f32 v147, v149, v131
    v_mfma_f32_32x32x16_bf16 v[32:47], a[180:183], v[52:55], v[32:47]
    s_mul_i32 s46, s34, 50331648
    s_lshl_b32 s51, s35, 18
    s_add_u32 s46, s46, s51
    s_add_u32 s46, s46, s52
    s_waitcnt lgkmcnt(2)
    v_mfma_f32_32x32x16_bf16 v[16:31], a[40:43], v[56:59], v[16:31]
    s_add_u32 m0, s59, 0
    s_add_u32 s47, s41, 0
    buffer_load_dwordx4 v0, s[8:11], s47 offen offset:0 lds
    buffer_load_dwordx4 v0, s[8:11], s47 offen offset:1024 lds
    ds_read_b128 v[52:55], v9 offset:13312
    v_mfma_f32_32x32x16_bf16 v[32:47], a[184:187], v[56:59], v[32:47]
    buffer_load_dwordx4 v0, s[8:11], s47 offen offset:2048 lds
    buffer_load_dwordx4 v0, s[8:11], s47 offen offset:3072 lds
    s_add_u32 m0, s59, 4096
    s_add_u32 s47, s41, 4096
    buffer_load_dwordx4 v0, s[8:11], s47 offen offset:0 lds
    s_waitcnt lgkmcnt(2)
    v_mfma_f32_32x32x16_bf16 v[16:31], a[44:47], v[60:63], v[16:31]
    buffer_load_dwordx4 v0, s[8:11], s47 offen offset:1024 lds
    buffer_load_dwordx4 v0, s[8:11], s47 offen offset:2048 lds
    buffer_load_dwordx4 v0, s[8:11], s47 offen offset:3072 lds
    ds_read_b128 v[56:59], v9 offset:14336
    v_mfma_f32_32x32x16_bf16 v[32:47], a[188:191], v[60:63], v[32:47]
    s_add_u32 m0, s59, 8192
    s_add_u32 s47, s41, 8192
    buffer_load_dwordx4 v0, s[8:11], s47 offen offset:0 lds
    s_waitcnt lgkmcnt(2)
    v_mfma_f32_32x32x16_bf16 v[16:31], a[48:51], v[48:51], v[16:31]
    s_mul_i32 s48, s36, 786432
    s_mul_i32 s18, s37, 6144
    s_add_u32 s48, s48, s18
    s_add_u32 s48, s48, 16125952
    s_add_u32 m0, s66, 4096
    s_nop 0
    buffer_load_dwordx4 v0, s[8:11], s48 offen lds
    ds_read_b128 v[60:63], v9 offset:15360
    v_mfma_f32_32x32x16_bf16 v[32:47], a[192:195], v[48:51], v[32:47]
    s_add_u32 m0, s66, s67
    s_sub_u32 s48, s48, 4096
    s_add_u32 s48, s48, s67
    buffer_load_dwordx4 v0, s[8:11], s48 offen lds
    s_waitcnt vmcnt(12)
    s_cmp_lg_u32 s43, 0
    s_cselect_b64 exec, 3, 0
    buffer_store_dword v3, v185, s[8:11], s43 offen sc1
    s_mov_b64 exec, -1
    s_mov_b32 s43, 0
    s_waitcnt lgkmcnt(2)
    v_mfma_f32_32x32x16_bf16 v[16:31], a[52:55], v[52:55], v[16:31]
    ds_read_b128 v[48:51], v9 offset:16384
    v_mfma_f32_32x32x16_bf16 v[32:47], a[196:199], v[52:55], v[32:47]
    s_waitcnt lgkmcnt(2)
    v_mfma_f32_32x32x16_bf16 v[16:31], a[56:59], v[56:59], v[16:31]
    v_cmp_eq_u32 s[76:77], 1, v2
    v_cmp_eq_u32 vcc, 2, v2
    s_cmp_eq_u64 s[76:77], -1
    s_cselect_b32 s38, 1, 0
    ds_read_b128 v[52:55], v9 offset:17408
    v_mfma_f32_32x32x16_bf16 v[32:47], a[200:203], v[56:59], v[32:47]
    s_cmp_lg_u32 s38, 0
    s_cselect_b64 exec, 1, 0
    v_mov_b32 v15, s32
    ds_write_b32 v184, v15
    v_mov_b32 v2, 2
    s_mov_b64 exec, -1
    s_waitcnt lgkmcnt(3)
    v_mfma_f32_32x32x16_bf16 v[16:31], a[60:63], v[60:63], v[16:31]
    s_add_u32 s32, s32, s38
    s_mul_i32 s38, s38, 22528
    s_add_u32 s33, s33, s38
    ds_read_b128 v[56:59], v9 offset:18432
    v_mfma_f32_32x32x16_bf16 v[32:47], a[204:207], v[60:63], v[32:47]
    s_cmp_eq_u64 vcc, 0
    s_cselect_b32 s38, s32, 0x7fff
    s_waitcnt lgkmcnt(3)
    v_mfma_f32_32x32x16_bf16 v[16:31], a[64:67], v[48:51], v[16:31]
    ds_read_b128 v[60:63], v9 offset:19456
    v_mfma_f32_32x32x16_bf16 v[32:47], a[208:211], v[48:51], v[32:47]
    s_cmp_le_u32 s38, s39
    s_cselect_b64 exec, -1, 0
    v_mov_b32 v2, 2
    buffer_load_dword v2, v1, s[8:11], s33 offen sc1
    s_mov_b64 exec, -1
    s_waitcnt lgkmcnt(3)
    v_mfma_f32_32x32x16_bf16 v[16:31], a[68:71], v[52:55], v[16:31]
    ds_read_b128 v[48:51], v9 offset:20480
    v_mfma_f32_32x32x16_bf16 v[32:47], a[212:215], v[52:55], v[32:47]
    s_waitcnt lgkmcnt(2)
    v_mfma_f32_32x32x16_bf16 v[16:31], a[72:75], v[56:59], v[16:31]
    ds_read_b128 v[52:55], v9 offset:21504
    v_mfma_f32_32x32x16_bf16 v[32:47], a[216:219], v[56:59], v[32:47]
    s_waitcnt lgkmcnt(2)
    v_mfma_f32_32x32x16_bf16 v[16:31], a[76:79], v[60:63], v[16:31]
    ds_read_b128 v[56:59], v9 offset:22528
    v_mfma_f32_32x32x16_bf16 v[32:47], a[220:223], v[60:63], v[32:47]
    s_waitcnt lgkmcnt(2)
    v_mfma_f32_32x32x16_bf16 v[16:31], a[80:83], v[48:51], v[16:31]
    ds_read_b128 v[60:63], v9 offset:23552
    v_mfma_f32_32x32x16_bf16 v[32:47], a[224:227], v[48:51], v[32:47]
    s_waitcnt lgkmcnt(2)
    v_mfma_f32_32x32x16_bf16 v[16:31], a[84:87], v[52:55], v[16:31]
    ds_read_b128 v[48:51], v9 offset:24576
    v_mfma_f32_32x32x16_bf16 v[32:47], a[228:231], v[52:55], v[32:47]
    s_waitcnt lgkmcnt(2)
    v_mfma_f32_32x32x16_bf16 v[16:31], a[88:91], v[56:59], v[16:31]
    ds_read_b128 v[52:55], v9 offset:25600
    v_mfma_f32_32x32x16_bf16 v[32:47], a[232:235], v[56:59], v[32:47]
    s_waitcnt lgkmcnt(2)
    v_mfma_f32_32x32x16_bf16 v[16:31], a[92:95], v[60:63], v[16:31]
    ds_read_b128 v[56:59], v9 offset:26624
    v_mfma_f32_32x32x16_bf16 v[32:47], a[236:239], v[60:63], v[32:47]
    s_waitcnt lgkmcnt(2)
    v_mfma_f32_32x32x16_bf16 v[16:31], a[96:99], v[48:51], v[16:31]
    ds_read_b128 v[60:63], v9 offset:27648
    v_mfma_f32_32x32x16_bf16 v[32:47], a[240:243], v[48:51], v[32:47]
    s_waitcnt lgkmcnt(2)
    v_mfma_f32_32x32x16_bf16 v[16:31], a[100:103], v[52:55], v[16:31]
    ds_read_b128 v[48:51], v9 offset:28672
    v_mfma_f32_32x32x16_bf16 v[32:47], a[244:247], v[52:55], v[32:47]
    s_waitcnt lgkmcnt(2)
    v_mfma_f32_32x32x16_bf16 v[16:31], a[104:107], v[56:59], v[16:31]
    ds_read_b128 v[52:55], v9 offset:29696
    v_mfma_f32_32x32x16_bf16 v[32:47], a[248:251], v[56:59], v[32:47]
    s_waitcnt lgkmcnt(2)
    v_mfma_f32_32x32x16_bf16 v[16:31], a[108:111], v[60:63], v[16:31]
    ds_read_b128 v[56:59], v9 offset:30720
    v_mfma_f32_32x32x16_bf16 v[32:47], a[252:255], v[60:63], v[32:47]
    s_waitcnt lgkmcnt(2)
    v_mfma_f32_32x32x16_bf16 v[16:31], a[112:115], v[48:51], v[16:31]
    ds_read_b128 v[60:63], v9 offset:31744
    v_mfma_f32_32x32x16_bf16 v[32:47], v[152:155], v[48:51], v[32:47]
    s_waitcnt lgkmcnt(2)
    v_mfma_f32_32x32x16_bf16 v[16:31], a[116:119], v[52:55], v[16:31]
    ds_read_b128 v[48:51], v9 offset:32768
    v_mfma_f32_32x32x16_bf16 v[32:47], v[156:159], v[52:55], v[32:47]
    s_waitcnt lgkmcnt(2)
    v_mfma_f32_32x32x16_bf16 v[16:31], a[120:123], v[56:59], v[16:31]
    ds_read_b128 v[52:55], v9 offset:33792
    v_mfma_f32_32x32x16_bf16 v[32:47], v[160:163], v[56:59], v[32:47]
    s_waitcnt lgkmcnt(2)
    v_mfma_f32_32x32x16_bf16 v[16:31], a[124:127], v[60:63], v[16:31]
    v_cmp_eq_u32 s[76:77], 1, v2
    v_cmp_eq_u32 vcc, 2, v2
    s_cmp_eq_u64 s[76:77], -1
    s_cselect_b32 s38, 1, 0
    ds_read_b128 v[56:59], v9 offset:34816
    v_mfma_f32_32x32x16_bf16 v[32:47], v[164:167], v[60:63], v[32:47]
    s_cmp_lg_u32 s38, 0
    s_cselect_b64 exec, 1, 0
    v_mov_b32 v15, s32
    ds_write_b32 v184, v15
    v_mov_b32 v2, 2
    s_mov_b64 exec, -1
    s_waitcnt lgkmcnt(3)
    v_mfma_f32_32x32x16_bf16 v[16:31], a[128:131], v[48:51], v[16:31]
    s_add_u32 s32, s32, s38
    s_mul_i32 s38, s38, 22528
    s_add_u32 s33, s33, s38
    ds_read_b128 v[60:63], v9 offset:35840
    v_mfma_f32_32x32x16_bf16 v[32:47], v[168:171], v[48:51], v[32:47]
    s_cmp_eq_u64 vcc, 0
    s_cselect_b32 s38, s32, 0x7fff
    s_waitcnt lgkmcnt(3)
    v_mfma_f32_32x32x16_bf16 v[16:31], a[132:135], v[52:55], v[16:31]
    s_cmp_le_u32 s38, s39
    s_cselect_b64 exec, -1, 0
    v_mov_b32 v2, 2
    buffer_load_dword v2, v1, s[8:11], s33 offen sc1
    s_mov_b64 exec, -1
    v_mfma_f32_32x32x16_bf16 v[32:47], v[172:175], v[52:55], v[32:47]
    s_waitcnt lgkmcnt(2)
    v_mfma_f32_32x32x16_bf16 v[16:31], a[136:139], v[56:59], v[16:31]
    v_mfma_f32_32x32x16_bf16 v[32:47], v[176:179], v[56:59], v[32:47]
    s_waitcnt lgkmcnt(0)
    v_mfma_f32_32x32x16_bf16 v[16:31], a[140:143], v[60:63], v[16:31]
    v_mfma_f32_32x32x16_bf16 v[32:47], v[180:183], v[60:63], v[32:47]
    s_add_u32 s51, s46, 8192
    s_nop 2
    v_pk_fma_f32 v[16:17], v[16:17], v[148:149], v[100:101] op_sel_hi:[1,0,1] neg_lo:[0,0,1] neg_hi:[0,0,1]
    v_pk_fma_f32 v[18:19], v[18:19], v[148:149], v[102:103] op_sel_hi:[1,0,1] neg_lo:[0,0,1] neg_hi:[0,0,1]
    v_pk_fma_f32 v[20:21], v[20:21], v[148:149], v[104:105] op_sel_hi:[1,0,1] neg_lo:[0,0,1] neg_hi:[0,0,1]
    v_pk_fma_f32 v[22:23], v[22:23], v[148:149], v[106:107] op_sel_hi:[1,0,1] neg_lo:[0,0,1] neg_hi:[0,0,1]
    v_pk_fma_f32 v[24:25], v[24:25], v[148:149], v[108:109] op_sel_hi:[1,0,1] neg_lo:[0,0,1] neg_hi:[0,0,1]
    v_pk_fma_f32 v[26:27], v[26:27], v[148:149], v[110:111] op_sel_hi:[1,0,1] neg_lo:[0,0,1] neg_hi:[0,0,1]
    v_pk_fma_f32 v[28:29], v[28:29], v[148:149], v[112:113] op_sel_hi:[1,0,1] neg_lo:[0,0,1] neg_hi:[0,0,1]
    v_pk_fma_f32 v[30:31], v[30:31], v[148:149], v[114:115] op_sel_hi:[1,0,1] neg_lo:[0,0,1] neg_hi:[0,0,1]
    v_cvt_pk_bf16_f32 v188, v16, v24
    v_cvt_pk_bf16_f32 v189, v17, v25
    v_cvt_pk_bf16_f32 v190, v18, v26
    v_cvt_pk_bf16_f32 v191, v19, v27
    buffer_store_dwordx4 v[188:191], v14, s[8:11], s46 offen offset:0 sc1
    v_cvt_pk_bf16_f32 v192, v20, v28
    v_cvt_pk_bf16_f32 v193, v21, v29
    v_cvt_pk_bf16_f32 v194, v22, v30
    v_cvt_pk_bf16_f32 v195, v23, v31
    buffer_store_dwordx4 v[192:195], v14, s[8:11], s46 offen offset:512 sc1
    v_pk_fma_f32 v[32:33], v[32:33], v[148:149], v[132:133] op_sel_hi:[1,0,1] neg_lo:[0,0,1] neg_hi:[0,0,1]
    v_pk_fma_f32 v[34:35], v[34:35], v[148:149], v[134:135] op_sel_hi:[1,0,1] neg_lo:[0,0,1] neg_hi:[0,0,1]
    v_pk_fma_f32 v[36:37], v[36:37], v[148:149], v[136:137] op_sel_hi:[1,0,1] neg_lo:[0,0,1] neg_hi:[0,0,1]
    v_pk_fma_f32 v[38:39], v[38:39], v[148:149], v[138:139] op_sel_hi:[1,0,1] neg_lo:[0,0,1] neg_hi:[0,0,1]
    v_pk_fma_f32 v[40:41], v[40:41], v[148:149], v[140:141] op_sel_hi:[1,0,1] neg_lo:[0,0,1] neg_hi:[0,0,1]
    v_pk_fma_f32 v[42:43], v[42:43], v[148:149], v[142:143] op_sel_hi:[1,0,1] neg_lo:[0,0,1] neg_hi:[0,0,1]
    v_pk_fma_f32 v[44:45], v[44:45], v[148:149], v[144:145] op_sel_hi:[1,0,1] neg_lo:[0,0,1] neg_hi:[0,0,1]
    v_pk_fma_f32 v[46:47], v[46:47], v[148:149], v[146:147] op_sel_hi:[1,0,1] neg_lo:[0,0,1] neg_hi:[0,0,1]
    v_cvt_pk_bf16_f32 v196, v32, v40
    v_cvt_pk_bf16_f32 v197, v33, v41
    v_cvt_pk_bf16_f32 v198, v34, v42
    v_cvt_pk_bf16_f32 v199, v35, v43
    buffer_store_dwordx4 v[196:199], v14, s[8:11], s51 offen offset:0 sc1
    v_cvt_pk_bf16_f32 v200, v36, v44
    v_cvt_pk_bf16_f32 v201, v37, v45
    v_cvt_pk_bf16_f32 v202, v38, v46
    v_cvt_pk_bf16_f32 v203, v39, v47
    buffer_store_dwordx4 v[200:203], v14, s[8:11], s51 offen offset:512 sc1
    s_mul_i32 s43, s57, 22528
    s_add_u32 s43, s43, s49
    s_branch LpQQ_head
LpQQ_f_2:
    v_mfma_f32_32x32x16_bf16 v[16:31], a[76:79], v[60:63], v[16:31]
    s_add_u32 m0, s59, 0
    s_add_u32 s47, s41, 0
    buffer_load_dwordx4 v0, s[8:11], s47 offen offset:0 lds
    ds_read_b128 v[56:59], v9 offset:22528
    v_mfma_f32_32x32x16_bf16 v[32:47], a[220:223], v[60:63], v[32:47]
    s_waitcnt lgkmcnt(2)
    v_mfma_f32_32x32x16_bf16 v[16:31], a[80:83], v[48:51], v[16:31]
    buffer_load_dwordx4 v0, s[8:11], s47 offen offset:1024 lds
    ds_read_b128 v[60:63], v9 offset:23552
    v_mfma_f32_32x32x16_bf16 v[32:47], a[224:227], v[48:51], v[32:47]
    s_waitcnt lgkmcnt(2)
    v_mfma_f32_32x32x16_bf16 v[16:31], a[84:87], v[52:55], v[16:31]
    buffer_load_dwordx4 v0, s[8:11], s47 offen offset:2048 lds
    ds_read_b128 v[48:51], v9 offset:24576
    v_mfma_f32_32x32x16_bf16 v[32:47], a[228:231], v[52:55], v[32:47]
    s_waitcnt lgkmcnt(2)
    v_mfma_f32_32x32x16_bf16 v[16:31], a[88:91], v[56:59], v[16:31]
    buffer_load_dwordx4 v0, s[8:11], s47 offen offset:3072 lds
    ds_read_b128 v[52:55], v9 offset:25600
    v_mfma_f32_32x32x16_bf16 v[32:47], a[232:235], v[56:59], v[32:47]
    s_waitcnt lgkmcnt(2)
    v_mfma_f32_32x32x16_bf16 v[16:31], a[92:95], v[60:63], v[16:31]
    s_add_u32 m0, s59, 4096
    s_add_u32 s47, s41, 4096
    buffer_load_dwordx4 v0, s[8:11], s47 offen offset:0 lds
    ds_read_b128 v[56:59], v9 offset:26624
    v_mfma_f32_32x32x16_bf16 v[32:47], a[236:239], v[60:63], v[32:47]
    s_waitcnt lgkmcnt(2)
    v_mfma_f32_32x32x16_bf16 v[16:31], a[96:99], v[48:51], v[16:31]
    buffer_load_dwordx4 v0, s[8:11], s47 offen offset:1024 lds
    ds_read_b128 v[60:63], v9 offset:27648
    v_mfma_f32_32x32x16_bf16 v[32:47], a[240:243], v[48:51], v[32:47]
    s_waitcnt lgkmcnt(2)
    v_mfma_f32_32x32x16_bf16 v[16:31], a[100:103], v[52:55], v[16:31]
    buffer_load_dwordx4 v0, s[8:11], s47 offen offset:2048 lds
    ds_read_b128 v[48:51], v9 offset:28672
    v_mfma_f32_32x32x16_bf16 v[32:47], a[244:247], v[52:55], v[32:47]
    s_waitcnt lgkmcnt(2)
    v_mfma_f32_32x32x16_bf16 v[16:31], a[104:107], v[56:59], v[16:31]
    buffer_load_dwordx4 v0, s[8:11], s47 offen offset:3072 lds
    ds_read_b128 v[52:55], v9 offset:29696
    v_mfma_f32_32x32x16_bf16 v[32:47], a[248:251], v[56:59], v[32:47]
    s_waitcnt lgkmcnt(2)
    v_mfma_f32_32x32x16_bf16 v[16:31], a[108:111], v[60:63], v[16:31]
    s_add_u32 m0, s59, 8192
    s_add_u32 s47, s41, 8192
    buffer_load_dwordx4 v0, s[8:11], s47 offen offset:0 lds
    ds_read_b128 v[56:59], v9 offset:30720
    v_mfma_f32_32x32x16_bf16 v[32:47], a[252:255], v[60:63], v[32:47]
    s_waitcnt lgkmcnt(2)
    v_mfma_f32_32x32x16_bf16 v[16:31], a[112:115], v[48:51], v[16:31]
    s_mul_i32 s48, s36, 786432
    s_mul_i32 s18, s37, 6144
    s_add_u32 s48, s48, s18
    s_add_u32 s48, s48, 16125952
    s_add_u32 m0, s66, 4096
    s_nop 0
    buffer_load_dwordx4 v0, s[8:11], s48 offen lds
    ds_read_b128 v[60:63], v9 offset:31744
    v_mfma_f32_32x32x16_bf16 v[32:47], v[152:155], v[48:51], v[32:47]
    s_waitcnt lgkmcnt(2)
    v_mfma_f32_32x32x16_bf16 v[16:31], a[116:119], v[52:55], v[16:31]
    s_add_u32 m0, s66, s67
    s_sub_u32 s48, s48, 4096
    s_add_u32 s48, s48, s67
    buffer_load_dwordx4 v0, s[8:11], s48 offen lds
    ds_read_b128 v[48:51], v9 offset:32768
    v_mfma_f32_32x32x16_bf16 v[32:47], v[156:159], v[52:55], v[32:47]
    s_waitcnt lgkmcnt(2)
    v_mfma_f32_32x32x16_bf16 v[16:31], a[120:123], v[56:59], v[16:31]
    ds_read_b128 v[52:55], v9 offset:33792
    v_mfma_f32_32x32x16_bf16 v[32:47], v[160:163], v[56:59], v[32:47]
    s_waitcnt lgkmcnt(2)
    v_mfma_f32_32x32x16_bf16 v[16:31], a[124:127], v[60:63], v[16:31]
    v_cmp_eq_u32 s[76:77], 1, v2
    v_cmp_eq_u32 vcc, 2, v2
    s_cmp_eq_u64 s[76:77], -1
    s_cselect_b32 s38, 1, 0
    ds_read_b128 v[56:59], v9 offset:34816
    v_mfma_f32_32x32x16_bf16 v[32:47], v[164:167], v[60:63], v[32:47]
    s_cmp_lg_u32 s38, 0
    s_cselect_b64 exec, 1, 0
    v_mov_b32 v15, s32
    ds_write_b32 v184, v15
    v_mov_b32 v2, 2
    s_mov_b64 exec, -1
    s_waitcnt lgkmcnt(3)
    v_mfma_f32_32x32x16_bf16 v[16:31], a[128:131], v[48:51], v[16:31]
    s_add_u32 s32, s32, s38
    s_mul_i32 s38, s38, 22528
    s_add_u32 s33, s33, s38
    ds_read_b128 v[60:63], v9 offset:35840
    v_mfma_f32_32x32x16_bf16 v[32:47], v[168:171], v[48:51], v[32:47]
    s_cmp_eq_u64 vcc, 0
    s_cselect_b32 s38, s32, 0x7fff
    s_waitcnt lgkmcnt(3)
    v_mfma_f32_32x32x16_bf16 v[16:31], a[132:135], v[52:55], v[16:31]
    s_cmp_le_u32 s38, s39
    s_cselect_b64 exec, -1, 0
    v_mov_b32 v2, 2
    buffer_load_dword v2, v1, s[8:11], s33 offen sc1
    s_mov_b64 exec, -1
    v_mfma_f32_32x32x16_bf16 v[32:47], v[172:175], v[52:55], v[32:47]
    s_waitcnt lgkmcnt(2)
    v_mfma_f32_32x32x16_bf16 v[16:31], a[136:139], v[56:59], v[16:31]
    v_mfma_f32_32x32x16_bf16 v[32:47], v[176:179], v[56:59], v[32:47]
    s_waitcnt lgkmcnt(0)
    v_mfma_f32_32x32x16_bf16 v[16:31], a[140:143], v[60:63], v[16:31]
    v_mfma_f32_32x32x16_bf16 v[32:47], v[180:183], v[60:63], v[32:47]
    s_add_u32 s51, s46, 8192
    s_nop 2
    v_pk_fma_f32 v[16:17], v[16:17], v[148:149], v[100:101] op_sel_hi:[1,0,1] neg_lo:[0,0,1] neg_hi:[0,0,1]
    v_pk_fma_f32 v[18:19], v[18:19], v[148:149], v[102:103] op_sel_hi:[1,0,1] neg_lo:[0,0,1] neg_hi:[0,0,1]
    v_pk_fma_f32 v[20:21], v[20:21], v[148:149], v[104:105] op_sel_hi:[1,0,1] neg_lo:[0,0,1] neg_hi:[0,0,1]
    v_pk_fma_f32 v[22:23], v[22:23], v[148:149], v[106:107] op_sel_hi:[1,0,1] neg_lo:[0,0,1] neg_hi:[0,0,1]
    v_pk_fma_f32 v[24:25], v[24:25], v[148:149], v[108:109] op_sel_hi:[1,0,1] neg_lo:[0,0,1] neg_hi:[0,0,1]
    v_pk_fma_f32 v[26:27], v[26:27], v[148:149], v[110:111] op_sel_hi:[1,0,1] neg_lo:[0,0,1] neg_hi:[0,0,1]
    v_pk_fma_f32 v[28:29], v[28:29], v[148:149], v[112:113] op_sel_hi:[1,0,1] neg_lo:[0,0,1] neg_hi:[0,0,1]
    v_pk_fma_f32 v[30:31], v[30:31], v[148:149], v[114:115] op_sel_hi:[1,0,1] neg_lo:[0,0,1] neg_hi:[0,0,1]
    v_cvt_pk_bf16_f32 v188, v16, v24
    v_cvt_pk_bf16_f32 v189, v17, v25
    v_cvt_pk_bf16_f32 v190, v18, v26
    v_cvt_pk_bf16_f32 v191, v19, v27
    buffer_store_dwordx4 v[188:191], v14, s[8:11], s46 offen offset:0 sc1
    v_cvt_pk_bf16_f32 v192, v20, v28
    v_cvt_pk_bf16_f32 v193, v21, v29
    v_cvt_pk_bf16_f32 v194, v22, v30
    v_cvt_pk_bf16_f32 v195, v23, v31
    buffer_store_dwordx4 v[192:195], v14, s[8:11], s46 offen offset:512 sc1
    v_pk_fma_f32 v[32:33], v[32:33], v[148:149], v[132:133] op_sel_hi:[1,0,1] neg_lo:[0,0,1] neg_hi:[0,0,1]
    v_pk_fma_f32 v[34:35], v[34:35], v[148:149], v[134:135] op_sel_hi:[1,0,1] neg_lo:[0,0,1] neg_hi:[0,0,1]
    v_pk_fma_f32 v[36:37], v[36:37], v[148:149], v[136:137] op_sel_hi:[1,0,1] neg_lo:[0,0,1] neg_hi:[0,0,1]
    v_pk_fma_f32 v[38:39], v[38:39], v[148:149], v[138:139] op_sel_hi:[1,0,1] neg_lo:[0,0,1] neg_hi:[0,0,1]
    v_pk_fma_f32 v[40:41], v[40:41], v[148:149], v[140:141] op_sel_hi:[1,0,1] neg_lo:[0,0,1] neg_hi:[0,0,1]
    v_pk_fma_f32 v[42:43], v[42:43], v[148:149], v[142:143] op_sel_hi:[1,0,1] neg_lo:[0,0,1] neg_hi:[0,0,1]
    v_pk_fma_f32 v[44:45], v[44:45], v[148:149], v[144:145] op_sel_hi:[1,0,1] neg_lo:[0,0,1] neg_hi:[0,0,1]
    v_pk_fma_f32 v[46:47], v[46:47], v[148:149], v[146:147] op_sel_hi:[1,0,1] neg_lo:[0,0,1] neg_hi:[0,0,1]
    v_cvt_pk_bf16_f32 v196, v32, v40
    v_cvt_pk_bf16_f32 v197, v33, v41
    v_cvt_pk_bf16_f32 v198, v34, v42
    v_cvt_pk_bf16_f32 v199, v35, v43
    buffer_store_dwordx4 v[196:199], v14, s[8:11], s51 offen offset:0 sc1
    v_cvt_pk_bf16_f32 v200, v36, v44
    v_cvt_pk_bf16_f32 v201, v37, v45
    v_cvt_pk_bf16_f32 v202, v38, v46
    v_cvt_pk_bf16_f32 v203, v39, v47
    buffer_store_dwordx4 v[200:203], v14, s[8:11], s51 offen offset:512 sc1
    s_mul_i32 s43, s57, 22528
    s_add_u32 s43, s43, s49
    s_branch LpQQ_head
LpQQ_none:
    s_waitcnt vmcnt(0)
    s_cmp_lg_u32 s43, 0
    s_cselect_b64 exec, 3, 0
    buffer_store_dword v3, v185, s[8:11], s43 offen sc1
    s_mov_b64 exec, -1
    s_mov_b32 s43, 0
    s_cmp_ge_u32 s37, 64
    s_cbranch_scc1 LpQQ_end
LpQQ_wait:
    s_mov_b32 s16, 0
    s_cmp_lg_u32 s14, 0
    s_cbranch_scc1 LpQQ_wl
LpQQ_wp:
    buffer_load_dword v2, v1, s[8:11], s60 offen sc1
    s_add_u32 s16, s16, 1
    s_cmp_gt_u32 s16, 100000
    s_cbranch_scc1 LpQQ_giveup
    s_waitcnt vmcnt(0)
    v_cmp_eq_u32 vcc, 0, v2
    s_nop 0
    s_cbranch_vccz LpQQ_wok
    s_sleep 4
    s_branch LpQQ_wp
LpQQ_giveup:
    v_mov_b32 v5, -2
    ds_write_b32 v184, v5
    s_waitcnt lgkmcnt(0)
    s_branch L_role_p_abort
LpQQ_wok:
    v_mov_b32 v5, s37
    ds_write_b32 v184, v5
    s_branch LpQQ_go
LpQQ_wl:
    ds_read_b32 v15, v184
    s_add_u32 s16, s16, 1
    s_cmp_gt_u32 s16, 1600000
    s_cbranch_scc1 L_role_p_abort
    s_waitcnt lgkmcnt(0)
    v_readfirstlane_b32 s17, v15
    s_nop 0
    s_cmp_eq_u32 s17, -2
    s_cbranch_scc1 L_role_p_abort
    s_cmp_ge_i32 s17, s37
    s_cbranch_scc1 LpQQ_go
    s_sleep 1
    s_branch LpQQ_wl
LpQQ_go:
    s_add_u32 m0, s59, 0
    s_add_u32 s47, s41, 0
    buffer_load_dwordx4 v0, s[8:11], s47 offen offset:0 lds
    buffer_load_dwordx4 v0, s[8:11], s47 offen offset:1024 lds
    buffer_load_dwordx4 v0, s[8:11], s47 offen offset:2048 lds
    buffer_load_dwordx4 v0, s[8:11], s47 offen offset:3072 lds
    s_add_u32 m0, s59, 4096
    s_add_u32 s47, s41, 4096
    buffer_load_dwordx4 v0, s[8:11], s47 offen offset:0 lds
    buffer_load_dwordx4 v0, s[8:11], s47 offen offset:1024 lds
    buffer_load_dwordx4 v0, s[8:11], s47 offen offset:2048 lds
    buffer_load_dwordx4 v0, s[8:11], s47 offen offset:3072 lds
    s_add_u32 m0, s59, 8192
    s_add_u32 s47, s41, 8192
    buffer_load_dwordx4 v0, s[8:11], s47 offen offset:0 lds
    s_mul_i32 s48, s36, 786432
    s_mul_i32 s18, s37, 6144
    s_add_u32 s48, s48, s18
    s_add_u32 s48, s48, 16125952
    s_add_u32 m0, s66, 4096
    s_nop 0
    buffer_load_dwordx4 v0, s[8:11], s48 offen lds
    s_add_u32 m0, s66, s67
    s_sub_u32 s48, s48, 4096
    s_add_u32 s48, s48, s67
    buffer_load_dwordx4 v0, s[8:11], s48 offen lds
    s_waitcnt vmcnt(0) lgkmcnt(0)
    s_branch LpQQ_head2
LpQQ_end:
    s_branch L_role_p_exit
Lp2_kv:
    v_mfma_f32_32x32x16_bf16 v[84:99], a[0:3], v[48:51], 0
    v_mfma_f32_32x32x16_bf16 v[32:47], v[48:51], a[144:147], 0
    v_mfma_f32_32x32x16_bf16 v[84:99], a[4:7], v[48:51], v[84:99]
    v_mfma_f32_32x32x16_bf16 v[32:47], v[48:51], a[148:151], v[32:47]
    v_mfma_f32_32x32x16_bf16 v[84:99], a[8:11], v[48:51], v[84:99]
    v_mfma_f32_32x32x16_bf16 v[32:47], v[48:51], a[152:155], v[32:47]
    v_mfma_f32_32x32x16_bf16 v[84:99], a[12:15], v[48:51], v[84:99]
    v_mfma_f32_32x32x16_bf16 v[32:47], v[48:51], a[156:159], v[32:47]
    v_mfma_f32_32x32x16_bf16 v[84:99], a[16:19], v[48:51], v[84:99]
    v_mfma_f32_32x32x16_bf16 v[32:47], v[48:51], a[160:163], v[32:47]
    v_mfma_f32_32x32x16_bf16 v[84:99], a[20:23], v[48:51], v[84:99]
    v_mfma_f32_32x32x16_bf16 v[32:47], v[48:51], a[164:167], v[32:47]
    v_mfma_f32_32x32x16_bf16 v[84:99], a[24:27], v[48:51], v[84:99]
    v_mfma_f32_32x32x16_bf16 v[32:47], v[48:51], a[168:171], v[32:47]
    v_mfma_f32_32x32x16_bf16 v[84:99], a[28:31], v[48:51], v[84:99]
    v_mfma_f32_32x32x16_bf16 v[32:47], v[48:51], a[172:175], v[32:47]
    v_mfma_f32_32x32x16_bf16 v[84:99], a[32:35], v[48:51], v[84:99]
    v_mfma_f32_32x32x16_bf16 v[32:47], v[48:51], a[176:179], v[32:47]
    v_mfma_f32_32x32x16_bf16 v[84:99], a[36:39], v[48:51], v[84:99]
    v_mfma_f32_32x32x16_bf16 v[32:47], v[48:51], a[180:183], v[32:47]
    v_mfma_f32_32x32x16_bf16 v[84:99], a[40:43], v[48:51], v[84:99]
    v_mfma_f32_32x32x16_bf16 v[32:47], v[48:51], a[184:187], v[32:47]
    v_mfma_f32_32x32x16_bf16 v[84:99], a[44:47], v[48:51], v[84:99]
    v_mfma_f32_32x32x16_bf16 v[32:47], v[48:51], a[188:191], v[32:47]
    v_mfma_f32_32x32x16_bf16 v[84:99], a[48:51], v[48:51], v[84:99]
    v_mfma_f32_32x32x16_bf16 v[32:47], v[48:51], a[192:195], v[32:47]
    v_mfma_f32_32x32x16_bf16 v[84:99], a[52:55], v[48:51], v[84:99]
    v_mfma_f32_32x32x16_bf16 v[32:47], v[48:51], a[196:199], v[32:47]
    v_mfma_f32_32x32x16_bf16 v[84:99], a[56:59], v[48:51], v[84:99]
    v_mfma_f32_32x32x16_bf16 v[32:47], v[48:51], a[200:203], v[32:47]
    v_mfma_f32_32x32x16_bf16 v[84:99], a[60:63], v[48:51], v[84:99]
    v_mfma_f32_32x32x16_bf16 v[32:47], v[48:51], a[204:207], v[32:47]
    v_mfma_f32_32x32x16_bf16 v[84:99], a[64:67], v[48:51], v[84:99]
    v_mfma_f32_32x32x16_bf16 v[32:47], v[48:51], a[208:211], v[32:47]
    v_mfma_f32_32x32x16_bf16 v[84:99], a[68:71], v[48:51], v[84:99]
    v_mfma_f32_32x32x16_bf16 v[32:47], v[48:51], a[212:215], v[32:47]
    v_mfma_f32_32x32x16_bf16 v[84:99], a[72:75], v[48:51], v[84:99]
    v_mfma_f32_32x32x16_bf16 v[32:47], v[48:51], a[216:219], v[32:47]
    v_mfma_f32_32x32x16_bf16 v[84:99], a[76:79], v[48:51], v[84:99]
    v_mfma_f32_32x32x16_bf16 v[32:47], v[48:51], a[220:223], v[32:47]
    v_mfma_f32_32x32x16_bf16 v[84:99], a[80:83], v[48:51], v[84:99]
    v_mfma_f32_32x32x16_bf16 v[32:47], v[48:51], a[224:227], v[32:47]
    v_mfma_f32_32x32x16_bf16 v[84:99], a[84:87], v[48:51], v[84:99]
    v_mfma_f32_32x32x16_bf16 v[32:47], v[48:51], a[228:231], v[32:47]
    v_mfma_f32_32x32x16_bf16 v[84:99], a[88:91], v[48:51], v[84:99]
    v_mfma_f32_32x32x16_bf16 v[32:47], v[48:51], a[232:235], v[32:47]
    v_mfma_f32_32x32x16_bf16 v[84:99], a[92:95], v[48:51], v[84:99]
    v_mfma_f32_32x32x16_bf16 v[32:47], v[48:51], a[236:239], v[32:47]
    v_mfma_f32_32x32x16_bf16 v[84:99], a[96:99], v[48:51], v[84:99]
    v_mfma_f32_32x32x16_bf16 v[32:47], v[48:51], a[240:243], v[32:47]
    v_mfma_f32_32x32x16_bf16 v[84:99], a[100:103], v[48:51], v[84:99]
    v_mfma_f32_32x32x16_bf16 v[32:47], v[48:51], a[244:247], v[32:47]
    v_mfma_f32_32x32x16_bf16 v[84:99], a[104:107], v[48:51], v[84:99]
    v_mfma_f32_32x32x16_bf16 v[32:47], v[48:51], a[248:251], v[32:47]
    v_mfma_f32_32x32x16_bf16 v[84:99], a[108:111], v[48:51], v[84:99]
    v_mfma_f32_32x32x16_bf16 v[32:47], v[48:51], a[252:255], v[32:47]
    v_mfma_f32_32x32x16_bf16 v[84:99], a[112:115], v[48:51], v[84:99]
    v_mfma_f32_32x32x16_bf16 v[32:47], v[48:51], v[152:155], v[32:47]
    v_mfma_f32_32x32x16_bf16 v[84:99], a[116:119], v[48:51], v[84:99]
    v_mfma_f32_32x32x16_bf16 v[32:47], v[48:51], v[156:159], v[32:47]
    v_mfma_f32_32x32x16_bf16 v[84:99], a[120:123], v[48:51], v[84:99]
    v_mfma_f32_32x32x16_bf16 v[32:47], v[48:51], v[160:163], v[32:47]
    v_mfma_f32_32x32x16_bf16 v[84:99], a[124:127], v[48:51], v[84:99]
    v_mfma_f32_32x32x16_bf16 v[32:47], v[48:51], v[164:167], v[32:47]
    v_mfma_f32_32x32x16_bf16 v[84:99], a[128:131], v[48:51], v[84:99]
    v_mfma_f32_32x32x16_bf16 v[32:47], v[48:51], v[168:171], v[32:47]
    v_mfma_f32_32x32x16_bf16 v[84:99], a[132:135], v[48:51], v[84:99]
    v_mfma_f32_32x32x16_bf16 v[32:47], v[48:51], v[172:175], v[32:47]
    v_mfma_f32_32x32x16_bf16 v[84:99], a[136:139], v[48:51], v[84:99]
    v_mfma_f32_32x32x16_bf16 v[32:47], v[48:51], v[176:179], v[32:47]
    v_mfma_f32_32x32x16_bf16 v[84:99], a[140:143], v[48:51], v[84:99]
    v_mfma_f32_32x32x16_bf16 v[32:47], v[48:51], v[180:183], v[32:47]
    s_nop 11
    v_mov_b32 v11, v32
    s_mov_b32 s66, 114688
    s_mov_b32 s71, 0x2000
    s_mov_b32 s36, s63
    s_mov_b32 s34, s63
    s_mul_i32 s58, s14, 9216
    s_mul_i32 s64, s63, 4718592
    s_add_u32 s64, s64, s58
    s_add_u32 s64, s64, 8650752
    s_mul_i32 s61, s63, 1441792
    s_add_u32 s61, s61, 3584
    s_mov_b32 s37, 0
    s_mov_b32 s40, 36864
    s_mov_b32 s59, s58
    s_mov_b32 s43, 0
    s_mov_b32 s62, 1
    s_mov_b32 s28, s8
    s_mov_b32 s29, s9
    s_mov_b32 s30, 0
    s_mov_b32 s31, 0x00020000
    v_mov_b32 v184, 74752
    v_mov_b32 v5, -1
    ds_write_b32 v184, v5
    s_waitcnt lgkmcnt(0)
    s_cmp_lg_u32 s14, 0
    s_cbranch_scc1 LpKV_inia_d
    v_mov_b32 v5, 40
    s_mov_b32 s16, 0
LpKV_inia:
    global_load_dword v6, v5, s[12:13] sc1
    s_add_u32 s16, s16, 1
    s_cmp_gt_u32 s16, 100000
    s_cbranch_scc1 L_role_p_abort
    s_waitcnt vmcnt(0)
    v_cmp_gt_u32 vcc, 72, v6
    s_nop 0
    s_cbranch_vccz LpKV_inia_d
    s_sleep 8
    s_branch LpKV_inia
LpKV_inia_d:
    s_barrier
    s_cmp_eq_u32 s63, 0
    s_cbranch_scc1 LpKV_ini_sk
    s_cmp_lg_u32 s14, 0
    s_cbranch_scc1 LpKV_inib_d
    v_mov_b32 v5, 160
    s_mov_b32 s16, 0
LpKV_inib:
    global_load_dword v6, v5, s[12:13] sc1
    s_add_u32 s16, s16, 1
    s_cmp_gt_u32 s16, 100000
    s_cbranch_scc1 L_role_p_abort
    s_waitcnt vmcnt(0)
    v_cmp_gt_u32 vcc, 64, v6
    s_nop 0
    s_cbranch_vccz LpKV_inib_d
    s_sleep 8
    s_branch LpKV_inib
LpKV_inib_d:
    s_barrier
LpKV_ini_sk:
    s_mul_i32 s41, s37, 36864
    s_add_u32 s41, s41, s64
    s_mul_i32 s60, s37, 22528
    s_add_u32 s60, s60, s61
    s_cmp_lt_u32 s37, 64
    s_cselect_b32 s60, s60, 2883584
    s_branch LpKV_wait
LpKV_head:
    s_waitcnt vmcnt(4)
LpKV_head2:
    s_barrier
    ds_read_b32 v15, v184
    s_xor_b32 s40, s40, 36864
    s_xor_b32 s59, s59, 36864
    s_mov_b32 s35, s37
    s_lshl_b32 s57, s34, 6
    s_add_u32 s57, s57, s35
    s_add_u32 s37, s37, 1
    s_mov_b32 s39, 0
    s_mov_b32 s54, 0
    s_xor_b32 s66, s66, 8192
    s_xor_b32 s71, s71, 8192
    s_mul_i32 s41, s37, 36864
    s_add_u32 s41, s41, s64
    s_mul_i32 s60, s37, 22528
    s_add_u32 s60, s60, s61
    s_cmp_lt_u32 s37, 64
    s_cselect_b32 s60, s60, 2883584
    v_add_u32 v9, s40, v0
    v_add_u32 v5, s71, v10
    ds_read_b128 v[48:51], v9 offset:0
    ds_read_b128 v[52:55], v9 offset:1024
    ds_read_b128 v[56:59], v9 offset:2048
    ds_read_b128 v[64:67], v5 offset:0
    ds_read_b128 v[68:71], v5 offset:512
    ds_read_b128 v[72:75], v5 offset:1024
    ds_read_b128 v[76:79], v5 offset:1536
    ds_read_b128 v[80:83], v5 offset:2048
    s_waitcnt lgkmcnt(7)
    v_mfma_f32_32x32x16_bf16 v[16:31], a[0:3], v[48:51], 0
    ds_read_b128 v[60:63], v9 offset:3072
    v_mfma_f32_32x32x16_bf16 v[32:47], v[48:51], a[144:147], 0
    s_waitcnt lgkmcnt(4)
    v_add_f32 v64, v64, v68
    v_add_f32 v65, v65, v69
    v_add_f32 v66, v66, v70
    v_add_f32 v67, v67, v71
    v_mfma_f32_32x32x16_bf16 v[16:31], a[4:7], v[52:55], v[16:31]
    ds_read_b128 v[48:51], v9 offset:4096
    s_waitcnt lgkmcnt(4)
    v_add_f32 v64, v64, v72
    v_add_f32 v65, v65, v73
    v_add_f32 v66, v66, v74
    v_mfma_f32_32x32x16_bf16 v[32:47], v[52:55], a[148:151], v[32:47]
    v_add_f32 v67, v67, v75
    s_waitcnt lgkmcnt(3)
    v_add_f32 v64, v64, v76
    v_add_f32 v65, v65, v77
    v_add_f32 v66, v66, v78
    v_readfirstlane_b32 s17, v15
    s_nop 0
    s_add_u32 s18, s17, 1
    s_max_i32 s32, s18, s37
    s_add_u32 s39, s37, 1
    s_min_u32 s39, s39, 63
    s_mul_i32 s33, s32, 22528
    s_add_u32 s33, s33, s61
    s_cmp_eq_u32 s14, 0
    s_cselect_b32 s18, s32, 0x7fff
    v_mov_b32 v2, 2
    s_cmp_le_u32 s18, s39
    s_cselect_b64 exec, -1, 0
    buffer_load_dword v2, v1, s[8:11], s33 offen sc1
    s_mov_b64 exec, -1
    s_cmp_ge_i32 s17, s37
    s_cbranch_scc1 LpKV_f_3
    v_mfma_f32_32x32x16_bf16 v[16:31], a[8:11], v[56:59], v[16:31]
    ds_read_b128 v[52:55], v9 offset:5120
    v_add_f32 v67, v67, v79
    s_waitcnt lgkmcnt(3)
    v_add_f32 v64, v64, v80
    v_add_f32 v65, v65, v81
    v_mfma_f32_32x32x16_bf16 v[32:47], v[56:59], a[152:155], v[32:47]
    v_add_f32 v66, v66, v82
    v_add_f32 v67, v67, v83
    v_add_f32 v64, v64, v66
    v_add_f32 v65, v65, v67
    s_waitcnt lgkmcnt(2)
    v_mfma_f32_32x32x16_bf16 v[16:31], a[12:15], v[60:63], v[16:31]
    ds_read_b128 v[56:59], v9 offset:6144
    v_mov_b32 v66, v64
    v_mov_b32 v67, v65
    s_nop 0
    v_permlane32_swap_b32 v64, v66
    v_mfma_f32_32x32x16_bf16 v[32:47], v[60:63], a[156:159], v[32:47]
    v_permlane32_swap_b32 v65, v67
    v_add_f32 v64, v64, v66
    v_add_f32 v65, v65, v67
    v_mul_f32 v64, 0x3ae38e39, v64
    s_waitcnt lgkmcnt(2)
    v_mfma_f32_32x32x16_bf16 v[16:31], a[16:19], v[48:51], v[16:31]
    ds_read_b128 v[60:63], v9 offset:7168
    v_mul_f32 v65, 0x3ae38e39, v65
    v_fma_f32 v65, -v64, v64, v65
    v_max_f32 v65, 0, v65
    v_mfma_f32_32x32x16_bf16 v[32:47], v[48:51], a[160:163], v[32:47]
    v_add_f32 v65, 0x3727c5ac, v65
    v_rsq_f32 v148, v65
    s_nop 0
    v_mul_f32 v149, v64, v148
    v_mul_f32 v100, v149, v84
    s_waitcnt lgkmcnt(2)
    v_mfma_f32_32x32x16_bf16 v[16:31], a[20:23], v[52:55], v[16:31]
    ds_read_b128 v[48:51], v9 offset:8192
    v_mul_f32 v101, v149, v85
    v_mul_f32 v102, v149, v86
    v_mul_f32 v103, v149, v87
    v_mfma_f32_32x32x16_bf16 v[32:47], v[52:55], a[164:167], v[32:47]
    v_mul_f32 v104, v149, v88
    v_mul_f32 v105, v149, v89
    v_mul_f32 v106, v149, v90
    v_mul_f32 v107, v149, v91
    s_waitcnt lgkmcnt(2)
    v_mfma_f32_32x32x16_bf16 v[16:31], a[24:27], v[56:59], v[16:31]
    ds_read_b128 v[52:55], v9 offset:9216
    v_mul_f32 v108, v149, v92
    v_mul_f32 v109, v149, v93
    v_mul_f32 v110, v149, v94
    v_mfma_f32_32x32x16_bf16 v[32:47], v[56:59], a[168:171], v[32:47]
    v_mul_f32 v111, v149, v95
    v_mul_f32 v112, v149, v96
    v_mul_f32 v113, v149, v97
    v_mul_f32 v114, v149, v98
    s_waitcnt lgkmcnt(2)
    v_mfma_f32_32x32x16_bf16 v[16:31], a[28:31], v[60:63], v[16:31]
    ds_read_b128 v[56:59], v9 offset:10240
    v_mul_f32 v115, v149, v99
    ds_write2_b32 v12, v148, v149 offset0:0 offset1:32
    ds_read_b128 v[116:119], v13 offset:0
    v_mfma_f32_32x32x16_bf16 v[32:47], v[60:63], a[172:175], v[32:47]
    ds_read_b128 v[120:123], v13 offset:32
    ds_read_b128 v[124:127], v13 offset:64
    ds_read_b128 v[128:131], v13 offset:96
    ds_read_b128 v[132:135], v13 offset:128
    s_waitcnt lgkmcnt(8)
    v_mfma_f32_32x32x16_bf16 v[16:31], a[32:35], v[48:51], v[16:31]
    ds_read_b128 v[60:63], v9 offset:11264
    ds_read_b128 v[136:139], v13 offset:160
    ds_read_b128 v[140:143], v13 offset:192
    ds_read_b128 v[144:147], v13 offset:224
    v_mfma_f32_32x32x16_bf16 v[32:47], v[48:51], a[176:179], v[32:47]
    s_waitcnt lgkmcnt(11)
    v_mfma_f32_32x32x16_bf16 v[16:31], a[36:39], v[52:55], v[16:31]
    ds_read_b128 v[48:51], v9 offset:12288
    v_mfma_f32_32x32x16_bf16 v[32:47], v[52:55], a[180:183], v[32:47]
    s_waitcnt lgkmcnt(5)
    v_mul_f32 v132, v11, v132
    v_mul_f32 v133, v11, v133
    v_mfma_f32_32x32x16_bf16 v[16:31], a[40:43], v[56:59], v[16:31]
    ds_read_b128 v[52:55], v9 offset:13312
    v_mul_f32 v134, v11, v134
    v_mul_f32 v135, v11, v135
    s_waitcnt lgkmcnt(4)
    v_mul_f32 v136, v11, v136
    v_mfma_f32_32x32x16_bf16 v[32:47], v[56:59], a[184:187], v[32:47]
    v_mul_f32 v137, v11, v137
    v_mul_f32 v138, v11, v138
    v_mul_f32 v139, v11, v139
    s_waitcnt lgkmcnt(3)
    v_mul_f32 v140, v11, v140
    v_mfma_f32_32x32x16_bf16 v[16:31], a[44:47], v[60:63], v[16:31]
    ds_read_b128 v[56:59], v9 offset:14336
    v_mul_f32 v141, v11, v141
    v_mul_f32 v142, v11, v142
    v_mul_f32 v143, v11, v143
    v_mfma_f32_32x32x16_bf16 v[32:47], v[60:63], a[188:191], v[32:47]
    s_waitcnt lgkmcnt(3)
    v_mul_f32 v144, v11, v144
    v_mul_f32 v145, v11, v145
    v_mul_f32 v146, v11, v146
    v_mul_f32 v147, v11, v147
    s_waitcnt lgkmcnt(2)
    v_mfma_f32_32x32x16_bf16 v[16:31], a[48:51], v[48:51], v[16:31]
    ds_read_b128 v[60:63], v9 offset:15360
    s_mul_i32 s46, s34, 50331648
    s_lshl_b32 s51, s35, 18
    s_add_u32 s46, s46, s51
    v_mfma_f32_32x32x16_bf16 v[32:47], v[48:51], a[192:195], v[32:47]
    s_add_u32 s46, s46, s52
    s_waitcnt vmcnt(1)
    s_cmp_lg_u32 s43, 0
    s_cselect_b64 exec, 3, 0
    buffer_store_dword v3, v185, s[8:11], s43 offen sc1
    s_mov_b64 exec, -1
    s_mov_b32 s43, 0
    s_waitcnt lgkmcnt(2)
    v_mfma_f32_32x32x16_bf16 v[16:31], a[52:55], v[52:55], v[16:31]
    ds_read_b128 v[48:51], v9 offset:16384
    v_mfma_f32_32x32x16_bf16 v[32:47], v[52:55], a[196:199], v[32:47]
    s_waitcnt lgkmcnt(2)
    v_mfma_f32_32x32x16_bf16 v[16:31], a[56:59], v[56:59], v[16:31]
    v_cmp_eq_u32 s[76:77], 1, v2
    v_cmp_eq_u32 vcc, 2, v2
    s_cmp_eq_u64 s[76:77], -1
    s_cselect_b32 s38, 1, 0
    ds_read_b128 v[52:55], v9 offset:17408
    v_mfma_f32_32x32x16_bf16 v[32:47], v[56:59], a[200:203], v[32:47]
    s_cmp_lg_u32 s38, 0
    s_cselect_b64 exec, 1, 0
    v_mov_b32 v15, s32
    ds_write_b32 v184, v15
    v_mov_b32 v2, 2
    s_mov_b64 exec, -1
    s_waitcnt lgkmcnt(3)
    v_mfma_f32_32x32x16_bf16 v[16:31], a[60:63], v[60:63], v[16:31]
    s_add_u32 s32, s32, s38
    s_mul_i32 s38, s38, 22528
    s_add_u32 s33, s33, s38
    ds_read_b128 v[56:59], v9 offset:18432
    v_mfma_f32_32x32x16_bf16 v[32:47], v[60:63], a[204:207], v[32:47]
    s_cmp_eq_u64 vcc, 0
    s_cselect_b32 s38, s32, 0x7fff
    s_waitcnt lgkmcnt(3)
    v_mfma_f32_32x32x16_bf16 v[16:31], a[64:67], v[48:51], v[16:31]
    ds_read_b128 v[60:63], v9 offset:19456
    v_mfma_f32_32x32x16_bf16 v[32:47], v[48:51], a[208:211], v[32:47]
    s_cmp_le_u32 s38, s39
    s_cselect_b64 exec, -1, 0
    v_mov_b32 v2, 2
    buffer_load_dword v2, v1, s[8:11], s33 offen sc1
    s_mov_b64 exec, -1
    ds_read_b32 v15, v184
    s_waitcnt lgkmcnt(4)
    v_mfma_f32_32x32x16_bf16 v[16:31], a[68:71], v[52:55], v[16:31]
    ds_read_b128 v[48:51], v9 offset:20480
    v_mfma_f32_32x32x16_bf16 v[32:47], v[52:55], a[212:215], v[32:47]
    s_waitcnt lgkmcnt(3)
    v_mfma_f32_32x32x16_bf16 v[16:31], a[72:75], v[56:59], v[16:31]
    ds_read_b128 v[52:55], v9 offset:21504
    v_mfma_f32_32x32x16_bf16 v[32:47], v[56:59], a[216:219], v[32:47]
    s_waitcnt lgkmcnt(2)
    v_readfirstlane_b32 s17, v15
    s_nop 0
    s_cmp_ge_i32 s17, s37
    s_cbranch_scc1 LpKV_f_4
    v_mfma_f32_32x32x16_bf16 v[16:31], a[76:79], v[60:63], v[16:31]
    ds_read_b128 v[56:59], v9 offset:22528
    v_mfma_f32_32x32x16_bf16 v[32:47], v[60:63], a[220:223], v[32:47]
    s_waitcnt lgkmcnt(2)
    v_mfma_f32_32x32x16_bf16 v[16:31], a[80:83], v[48:51], v[16:31]
    ds_read_b128 v[60:63], v9 offset:23552
    v_mfma_f32_32x32x16_bf16 v[32:47], v[48:51], a[224:227], v[32:47]
    s_waitcnt lgkmcnt(2)
    v_mfma_f32_32x32x16_bf16 v[16:31], a[84:87], v[52:55], v[16:31]
    ds_read_b128 v[48:51], v9 offset:24576
    v_mfma_f32_32x32x16_bf16 v[32:47], v[52:55], a[228:231], v[32:47]
    s_waitcnt lgkmcnt(2)
    v_mfma_f32_32x32x16_bf16 v[16:31], a[88:91], v[56:59], v[16:31]
    ds_read_b128 v[52:55], v9 offset:25600
    v_mfma_f32_32x32x16_bf16 v[32:47], v[56:59], a[232:235], v[32:47]
    s_waitcnt lgkmcnt(2)
    v_mfma_f32_32x32x16_bf16 v[16:31], a[92:95], v[60:63], v[16:31]
    ds_read_b128 v[56:59], v9 offset:26624
    v_mfma_f32_32x32x16_bf16 v[32:47], v[60:63], a[236:239], v[32:47]
    s_waitcnt lgkmcnt(2)
    v_mfma_f32_32x32x16_bf16 v[16:31], a[96:99], v[48:51], v[16:31]
    ds_read_b128 v[60:63], v9 offset:27648
    v_mfma_f32_32x32x16_bf16 v[32:47], v[48:51], a[240:243], v[32:47]
    s_waitcnt lgkmcnt(2)
    v_mfma_f32_32x32x16_bf16 v[16:31], a[100:103], v[52:55], v[16:31]
    ds_read_b128 v[48:51], v9 offset:28672
    v_mfma_f32_32x32x16_bf16 v[32:47], v[52:55], a[244:247], v[32:47]
    s_waitcnt lgkmcnt(2)
    v_mfma_f32_32x32x16_bf16 v[16:31], a[104:107], v[56:59], v[16:31]
    ds_read_b128 v[52:55], v9 offset:29696
    v_mfma_f32_32x32x16_bf16 v[32:47], v[56:59], a[248:251], v[32:47]
    s_waitcnt lgkmcnt(2)
    v_mfma_f32_32x32x16_bf16 v[16:31], a[108:111], v[60:63], v[16:31]
    ds_read_b128 v[56:59], v9 offset:30720
    v_mfma_f32_32x32x16_bf16 v[32:47], v[60:63], a[252:255], v[32:47]
    s_waitcnt lgkmcnt(2)
    v_mfma_f32_32x32x16_bf16 v[16:31], a[112:115], v[48:51], v[16:31]
    ds_read_b128 v[60:63], v9 offset:31744
    v_mfma_f32_32x32x16_bf16 v[32:47], v[48:51], v[152:155], v[32:47]
    s_waitcnt lgkmcnt(2)
    v_mfma_f32_32x32x16_bf16 v[16:31], a[116:119], v[52:55], v[16:31]
    ds_read_b128 v[48:51], v9 offset:32768
    v_mfma_f32_32x32x16_bf16 v[32:47], v[52:55], v[156:159], v[32:47]
    s_waitcnt lgkmcnt(2)
    v_mfma_f32_32x32x16_bf16 v[16:31], a[120:123], v[56:59], v[16:31]
    ds_read_b128 v[52:55], v9 offset:33792
    v_mfma_f32_32x32x16_bf16 v[32:47], v[56:59], v[160:163], v[32:47]
    s_waitcnt lgkmcnt(2)
    v_mfma_f32_32x32x16_bf16 v[16:31], a[124:127], v[60:63], v[16:31]
    v_cmp_eq_u32 s[76:77], 1, v2
    v_cmp_eq_u32 vcc, 2, v2
    s_cmp_eq_u64 s[76:77], -1
    s_cselect_b32 s38, 1, 0
    ds_read_b128 v[56:59], v9 offset:34816
    v_mfma_f32_32x32x16_bf16 v[32:47], v[60:63], v[164:167], v[32:47]
    s_cmp_lg_u32 s38, 0
    s_cselect_b64 exec, 1, 0
    v_mov_b32 v15, s32
    ds_write_b32 v184, v15
    v_mov_b32 v2, 2
    s_mov_b64 exec, -1
    s_waitcnt lgkmcnt(3)
    v_mfma_f32_32x32x16_bf16 v[16:31], a[128:131], v[48:51], v[16:31]
    s_add_u32 s32, s32, s38
    s_mul_i32 s38, s38, 22528
    s_add_u32 s33, s33, s38
    ds_read_b128 v[60:63], v9 offset:35840
    v_mfma_f32_32x32x16_bf16 v[32:47], v[48:51], v[168:171], v[32:47]
    s_cmp_eq_u64 vcc, 0
    s_cselect_b32 s38, s32, 0x7fff
    s_waitcnt lgkmcnt(3)
    v_mfma_f32_32x32x16_bf16 v[16:31], a[132:135], v[52:55], v[16:31]
    s_cmp_le_u32 s38, s39
    s_cselect_b64 exec, -1, 0
    v_mov_b32 v2, 2
    buffer_load_dword v2, v1, s[8:11], s33 offen sc1
    s_mov_b64 exec, -1
    v_mfma_f32_32x32x16_bf16 v[32:47], v[52:55], v[172:175], v[32:47]
    s_waitcnt lgkmcnt(2)
    v_mfma_f32_32x32x16_bf16 v[16:31], a[136:139], v[56:59], v[16:31]
    v_mfma_f32_32x32x16_bf16 v[32:47], v[56:59], v[176:179], v[32:47]
    s_waitcnt lgkmcnt(0)
    v_mfma_f32_32x32x16_bf16 v[16:31], a[140:143], v[60:63], v[16:31]
    v_mfma_f32_32x32x16_bf16 v[32:47], v[60:63], v[180:183], v[32:47]
    s_add_u32 s51, s46, 16777216
    s_nop 2
    v_pk_fma_f32 v[16:17], v[16:17], v[148:149], v[100:101] op_sel_hi:[1,0,1] neg_lo:[0,0,1] neg_hi:[0,0,1]
    v_pk_fma_f32 v[18:19], v[18:19], v[148:149], v[102:103] op_sel_hi:[1,0,1] neg_lo:[0,0,1] neg_hi:[0,0,1]
    v_pk_fma_f32 v[20:21], v[20:21], v[148:149], v[104:105] op_sel_hi:[1,0,1] neg_lo:[0,0,1] neg_hi:[0,0,1]
    v_pk_fma_f32 v[22:23], v[22:23], v[148:149], v[106:107] op_sel_hi:[1,0,1] neg_lo:[0,0,1] neg_hi:[0,0,1]
    v_pk_fma_f32 v[24:25], v[24:25], v[148:149], v[108:109] op_sel_hi:[1,0,1] neg_lo:[0,0,1] neg_hi:[0,0,1]
    v_pk_fma_f32 v[26:27], v[26:27], v[148:149], v[110:111] op_sel_hi:[1,0,1] neg_lo:[0,0,1] neg_hi:[0,0,1]
    v_pk_fma_f32 v[28:29], v[28:29], v[148:149], v[112:113] op_sel_hi:[1,0,1] neg_lo:[0,0,1] neg_hi:[0,0,1]
    v_pk_fma_f32 v[30:31], v[30:31], v[148:149], v[114:115] op_sel_hi:[1,0,1] neg_lo:[0,0,1] neg_hi:[0,0,1]
    v_cvt_pk_bf16_f32 v188, v16, v24
    v_cvt_pk_bf16_f32 v189, v17, v25
    v_cvt_pk_bf16_f32 v190, v18, v26
    v_cvt_pk_bf16_f32 v191, v19, v27
    buffer_store_dwordx4 v[188:191], v14, s[8:11], s46 offen offset:0 sc1
    v_cvt_pk_bf16_f32 v192, v20, v28
    v_cvt_pk_bf16_f32 v193, v21, v29
    v_cvt_pk_bf16_f32 v194, v22, v30
    v_cvt_pk_bf16_f32 v195, v23, v31
    buffer_store_dwordx4 v[192:195], v14, s[8:11], s46 offen offset:512 sc1
    v_pk_fma_f32 v[32:33], v[32:33], v[116:117], v[132:133] neg_lo:[0,0,1] neg_hi:[0,0,1]
    v_pk_fma_f32 v[34:35], v[34:35], v[118:119], v[134:135] neg_lo:[0,0,1] neg_hi:[0,0,1]
    v_pk_fma_f32 v[36:37], v[36:37], v[120:121], v[136:137] neg_lo:[0,0,1] neg_hi:[0,0,1]
    v_pk_fma_f32 v[38:39], v[38:39], v[122:123], v[138:139] neg_lo:[0,0,1] neg_hi:[0,0,1]
    v_pk_fma_f32 v[40:41], v[40:41], v[124:125], v[140:141] neg_lo:[0,0,1] neg_hi:[0,0,1]
    v_pk_fma_f32 v[42:43], v[42:43], v[126:127], v[142:143] neg_lo:[0,0,1] neg_hi:[0,0,1]
    v_pk_fma_f32 v[44:45], v[44:45], v[128:129], v[144:145] neg_lo:[0,0,1] neg_hi:[0,0,1]
    v_pk_fma_f32 v[46:47], v[46:47], v[130:131], v[146:147] neg_lo:[0,0,1] neg_hi:[0,0,1]
    v_cvt_pk_bf16_f32 v196, v32, v33
    v_cvt_pk_bf16_f32 v197, v34, v35
    v_cvt_pk_bf16_f32 v198, v40, v41
    v_cvt_pk_bf16_f32 v199, v42, v43
    buffer_store_dwordx4 v[196:199], v14, s[8:11], s51 offen offset:0 sc1
    v_cvt_pk_bf16_f32 v200, v36, v37
    v_cvt_pk_bf16_f32 v201, v38, v39
    v_cvt_pk_bf16_f32 v202, v44, v45
    v_cvt_pk_bf16_f32 v203, v46, v47
    buffer_store_dwordx4 v[200:203], v14, s[8:11], s51 offen offset:512 sc1
    s_mul_i32 s43, s57, 22528
    s_add_u32 s43, s43, s49
    s_branch LpKV_none
LpKV_f_3:
    v_mfma_f32_32x32x16_bf16 v[16:31], a[8:11], v[56:59], v[16:31]
    ds_read_b128 v[52:55], v9 offset:5120
    v_add_f32 v67, v67, v79
    s_waitcnt lgkmcnt(3)
    v_add_f32 v64, v64, v80
    v_add_f32 v65, v65, v81
    v_mfma_f32_32x32x16_bf16 v[32:47], v[56:59], a[152:155], v[32:47]
    v_add_f32 v66, v66, v82
    v_add_f32 v67, v67, v83
    v_add_f32 v64, v64, v66
    v_add_f32 v65, v65, v67
    s_waitcnt lgkmcnt(2)
    v_mfma_f32_32x32x16_bf16 v[16:31], a[12:15], v[60:63], v[16:31]
    ds_read_b128 v[56:59], v9 offset:6144
    v_mov_b32 v66, v64
    v_mov_b32 v67, v65
    s_nop 0
    v_permlane32_swap_b32 v64, v66
    v_mfma_f32_32x32x16_bf16 v[32:47], v[60:63], a[156:159], v[32:47]
    v_permlane32_swap_b32 v65, v67
    v_add_f32 v64, v64, v66
    v_add_f32 v65, v65, v67
    v_mul_f32 v64, 0x3ae38e39, v64
    s_waitcnt lgkmcnt(2)
    v_mfma_f32_32x32x16_bf16 v[16:31], a[16:19], v[48:51], v[16:31]
    ds_read_b128 v[60:63], v9 offset:7168
    v_mul_f32 v65, 0x3ae38e39, v65
    v_fma_f32 v65, -v64, v64, v65
    v_max_f32 v65, 0, v65
    v_mfma_f32_32x32x16_bf16 v[32:47], v[48:51], a[160:163], v[32:47]
    v_add_f32 v65, 0x3727c5ac, v65
    v_rsq_f32 v148, v65
    s_nop 0
    v_mul_f32 v149, v64, v148
    v_mul_f32 v100, v149, v84
    s_waitcnt lgkmcnt(2)
    v_mfma_f32_32x32x16_bf16 v[16:31], a[20:23], v[52:55], v[16:31]
    ds_read_b128 v[48:51], v9 offset:8192
    v_mul_f32 v101, v149, v85
    v_mul_f32 v102, v149, v86
    v_mul_f32 v103, v149, v87
    v_mfma_f32_32x32x16_bf16 v[32:47], v[52:55], a[164:167], v[32:47]
    v_mul_f32 v104, v149, v88
    v_mul_f32 v105, v149, v89
    v_mul_f32 v106, v149, v90
    v_mul_f32 v107, v149, v91
    s_waitcnt lgkmcnt(2)
    v_mfma_f32_32x32x16_bf16 v[16:31], a[24:27], v[56:59], v[16:31]
    ds_read_b128 v[52:55], v9 offset:9216
    v_mul_f32 v108, v149, v92
    v_mul_f32 v109, v149, v93
    v_mul_f32 v110, v149, v94
    v_mfma_f32_32x32x16_bf16 v[32:47], v[56:59], a[168:171], v[32:47]
    v_mul_f32 v111, v149, v95
    v_mul_f32 v112, v149, v96
    v_mul_f32 v113, v149, v97
    v_mul_f32 v114, v149, v98
    s_waitcnt lgkmcnt(2)
    v_mfma_f32_32x32x16_bf16 v[16:31], a[28:31], v[60:63], v[16:31]
    ds_read_b128 v[56:59], v9 offset:10240
    v_mul_f32 v115, v149, v99
    ds_write2_b32 v12, v148, v149 offset0:0 offset1:32
    ds_read_b128 v[116:119], v13 offset:0
    v_mfma_f32_32x32x16_bf16 v[32:47], v[60:63], a[172:175], v[32:47]
    ds_read_b128 v[120:123], v13 offset:32
    ds_read_b128 v[124:127], v13 offset:64
    ds_read_b128 v[128:131], v13 offset:96
    ds_read_b128 v[132:135], v13 offset:128
    s_waitcnt lgkmcnt(8)
    v_mfma_f32_32x32x16_bf16 v[16:31], a[32:35], v[48:51], v[16:31]
    ds_read_b128 v[60:63], v9 offset:11264
    ds_read_b128 v[136:139], v13 offset:160
    ds_read_b128 v[140:143], v13 offset:192
    ds_read_b128 v[144:147], v13 offset:224
    v_mfma_f32_32x32x16_bf16 v[32:47], v[48:51], a[176:179], v[32:47]
    s_add_u32 m0, s59, 0
    s_add_u32 s47, s41, 0
    buffer_load_dwordx4 v0, s[8:11], s47 offen offset:0 lds
    buffer_load_dwordx4 v0, s[8:11], s47 offen offset:1024 lds
    buffer_load_dwordx4 v0, s[8:11], s47 offen offset:2048 lds
    s_waitcnt lgkmcnt(11)
    v_mfma_f32_32x32x16_bf16 v[16:31], a[36:39], v[52:55], v[16:31]
    buffer_load_dwordx4 v0, s[8:11], s47 offen offset:3072 lds
    s_add_u32 m0, s59, 4096
    s_add_u32 s47, s41, 4096
    buffer_load_dwordx4 v0, s[8:11], s47 offen offset:0 lds
    ds_read_b128 v[48:51], v9 offset:12288
    v_mfma_f32_32x32x16_bf16 v[32:47], v[52:55], a[180:183], v[32:47]
    buffer_load_dwordx4 v0, s[8:11], s47 offen offset:1024 lds
    buffer_load_dwordx4 v0, s[8:11], s47 offen offset:2048 lds
    buffer_load_dwordx4 v0, s[8:11], s47 offen offset:3072 lds
    s_waitcnt lgkmcnt(5)
    v_mul_f32 v132, v11, v132
    v_mul_f32 v133, v11, v133
    v_mfma_f32_32x32x16_bf16 v[16:31], a[40:43], v[56:59], v[16:31]
    ds_read_b128 v[52:55], v9 offset:13312
    v_mul_f32 v134, v11, v134
    v_mul_f32 v135, v11, v135
    s_waitcnt lgkmcnt(4)
    v_mul_f32 v136, v11, v136
    v_mfma_f32_32x32x16_bf16 v[32:47], v[56:59], a[184:187], v[32:47]
    v_mul_f32 v137, v11, v137
    v_mul_f32 v138, v11, v138
    v_mul_f32 v139, v11, v139
    s_waitcnt lgkmcnt(3)
    v_mul_f32 v140, v11, v140
    v_mfma_f32_32x32x16_bf16 v[16:31], a[44:47], v[60:63], v[16:31]
    ds_read_b128 v[56:59], v9 offset:14336
    v_mul_f32 v141, v11, v141
    v_mul_f32 v142, v11, v142
    v_mul_f32 v143, v11, v143
    v_mfma_f32_32x32x16_bf16 v[32:47], v[60:63], a[188:191], v[32:47]
    s_waitcnt lgkmcnt(3)
    v_mul_f32 v144, v11, v144
    v_mul_f32 v145, v11, v145
    v_mul_f32 v146, v11, v146
    v_mul_f32 v147, v11, v147
    s_waitcnt lgkmcnt(2)
    v_mfma_f32_32x32x16_bf16 v[16:31], a[48:51], v[48:51], v[16:31]
    ds_read_b128 v[60:63], v9 offset:15360
    s_mul_i32 s46, s34, 50331648
    s_lshl_b32 s51, s35, 18
    s_add_u32 s46, s46, s51
    v_mfma_f32_32x32x16_bf16 v[32:47], v[48:51], a[192:195], v[32:47]
    s_add_u32 m0, s59, 8192
    s_add_u32 s47, s41, 8192
    buffer_load_dwordx4 v0, s[8:11], s47 offen offset:0 lds
    s_add_u32 s46, s46, s52
    s_waitcnt vmcnt(10)
    s_cmp_lg_u32 s43, 0
    s_cselect_b64 exec, 3, 0
    buffer_store_dword v3, v185, s[8:11], s43 offen sc1
    s_mov_b64 exec, -1
    s_mov_b32 s43, 0
    s_waitcnt lgkmcnt(2)
    v_mfma_f32_32x32x16_bf16 v[16:31], a[52:55], v[52:55], v[16:31]
    s_mul_i32 s48, s36, 786432
    s_mul_i32 s18, s37, 6144
    s_add_u32 s48, s48, s18
    s_add_u32 s48, s48, 16125952
    s_add_u32 m0, s66, 4096
    s_nop 0
    buffer_load_dwordx4 v0, s[8:11], s48 offen lds
    ds_read_b128 v[48:51], v9 offset:16384
    v_mfma_f32_32x32x16_bf16 v[32:47], v[52:55], a[196:199], v[32:47]
    s_add_u32 m0, s66, s67
    s_sub_u32 s48, s48, 4096
    s_add_u32 s48, s48, s67
    buffer_load_dwordx4 v0, s[8:11], s48 offen lds
    s_waitcnt lgkmcnt(2)
    v_mfma_f32_32x32x16_bf16 v[16:31], a[56:59], v[56:59], v[16:31]
    v_cmp_eq_u32 s[76:77], 1, v2
    v_cmp_eq_u32 vcc, 2, v2
    s_cmp_eq_u64 s[76:77], -1
    s_cselect_b32 s38, 1, 0
    ds_read_b128 v[52:55], v9 offset:17408
    v_mfma_f32_32x32x16_bf16 v[32:47], v[56:59], a[200:203], v[32:47]
    s_cmp_lg_u32 s38, 0
    s_cselect_b64 exec, 1, 0
    v_mov_b32 v15, s32
    ds_write_b32 v184, v15
    v_mov_b32 v2, 2
    s_mov_b64 exec, -1
    s_waitcnt lgkmcnt(3)
    v_mfma_f32_32x32x16_bf16 v[16:31], a[60:63], v[60:63], v[16:31]
    s_add_u32 s32, s32, s38
    s_mul_i32 s38, s38, 22528
    s_add_u32 s33, s33, s38
    ds_read_b128 v[56:59], v9 offset:18432
    v_mfma_f32_32x32x16_bf16 v[32:47], v[60:63], a[204:207], v[32:47]
    s_cmp_eq_u64 vcc, 0
    s_cselect_b32 s38, s32, 0x7fff
    s_waitcnt lgkmcnt(3)
    v_mfma_f32_32x32x16_bf16 v[16:31], a[64:67], v[48:51], v[16:31]
    ds_read_b128 v[60:63], v9 offset:19456
    v_mfma_f32_32x32x16_bf16 v[32:47], v[48:51], a[208:211], v[32:47]
    s_cmp_le_u32 s38, s39
    s_cselect_b64 exec, -1, 0
    v_mov_b32 v2, 2
    buffer_load_dword v2, v1, s[8:11], s33 offen sc1
    s_mov_b64 exec, -1
    s_waitcnt lgkmcnt(3)
    v_mfma_f32_32x32x16_bf16 v[16:31], a[68:71], v[52:55], v[16:31]
    ds_read_b128 v[48:51], v9 offset:20480
    v_mfma_f32_32x32x16_bf16 v[32:47], v[52:55], a[212:215], v[32:47]
    s_waitcnt lgkmcnt(2)
    v_mfma_f32_32x32x16_bf16 v[16:31], a[72:75], v[56:59], v[16:31]
    ds_read_b128 v[52:55], v9 offset:21504
    v_mfma_f32_32x32x16_bf16 v[32:47], v[56:59], a[216:219], v[32:47]
    s_waitcnt lgkmcnt(2)
    v_mfma_f32_32x32x16_bf16 v[16:31], a[76:79], v[60:63], v[16:31]
    ds_read_b128 v[56:59], v9 offset:22528
    v_mfma_f32_32x32x16_bf16 v[32:47], v[60:63], a[220:223], v[32:47]
    s_waitcnt lgkmcnt(2)
    v_mfma_f32_32x32x16_bf16 v[16:31], a[80:83], v[48:51], v[16:31]
    ds_read_b128 v[60:63], v9 offset:23552
    v_mfma_f32_32x32x16_bf16 v[32:47], v[48:51], a[224:227], v[32:47]
    s_waitcnt lgkmcnt(2)
    v_mfma_f32_32x32x16_bf16 v[16:31], a[84:87], v[52:55], v[16:31]
    ds_read_b128 v[48:51], v9 offset:24576
    v_mfma_f32_32x32x16_bf16 v[32:47], v[52:55], a[228:231], v[32:47]
    s_waitcnt lgkmcnt(2)
    v_mfma_f32_32x32x16_bf16 v[16:31], a[88:91], v[56:59], v[16:31]
    ds_read_b128 v[52:55], v9 offset:25600
    v_mfma_f32_32x32x16_bf16 v[32:47], v[56:59], a[232:235], v[32:47]
    s_waitcnt lgkmcnt(2)
    v_mfma_f32_32x32x16_bf16 v[16:31], a[92:95], v[60:63], v[16:31]
    ds_read_b128 v[56:59], v9 offset:26624
    v_mfma_f32_32x32x16_bf16 v[32:47], v[60:63], a[236:239], v[32:47]
    s_waitcnt lgkmcnt(2)
    v_mfma_f32_32x32x16_bf16 v[16:31], a[96:99], v[48:51], v[16:31]
    ds_read_b128 v[60:63], v9 offset:27648
    v_mfma_f32_32x32x16_bf16 v[32:47], v[48:51], a[240:243], v[32:47]
    s_waitcnt lgkmcnt(2)
    v_mfma_f32_32x32x16_bf16 v[16:31], a[100:103], v[52:55], v[16:31]
    ds_read_b128 v[48:51], v9 offset:28672
    v_mfma_f32_32x32x16_bf16 v[32:47], v[52:55], a[244:247], v[32:47]
    s_waitcnt lgkmcnt(2)
    v_mfma_f32_32x32x16_bf16 v[16:31], a[104:107], v[56:59], v[16:31]
    ds_read_b128 v[52:55], v9 offset:29696
    v_mfma_f32_32x32x16_bf16 v[32:47], v[56:59], a[248:251], v[32:47]
    s_waitcnt lgkmcnt(2)
    v_mfma_f32_32x32x16_bf16 v[16:31], a[108:111], v[60:63], v[16:31]
    ds_read_b128 v[56:59], v9 offset:30720
    v_mfma_f32_32x32x16_bf16 v[32:47], v[60:63], a[252:255], v[32:47]
    s_waitcnt lgkmcnt(2)
    v_mfma_f32_32x32x16_bf16 v[16:31], a[112:115], v[48:51], v[16:31]
    ds_read_b128 v[60:63], v9 offset:31744
    v_mfma_f32_32x32x16_bf16 v[32:47], v[48:51], v[152:155], v[32:47]
    s_waitcnt lgkmcnt(2)
    v_mfma_f32_32x32x16_bf16 v[16:31], a[116:119], v[52:55], v[16:31]
    ds_read_b128 v[48:51], v9 offset:32768
    v_mfma_f32_32x32x16_bf16 v[32:47], v[52:55], v[156:159], v[32:47]
    s_waitcnt lgkmcnt(2)
    v_mfma_f32_32x32x16_bf16 v[16:31], a[120:123], v[56:59], v[16:31]
    ds_read_b128 v[52:55], v9 offset:33792
    v_mfma_f32_32x32x16_bf16 v[32:47], v[56:59], v[160:163], v[32:47]
    s_waitcnt lgkmcnt(2)
    v_mfma_f32_32x32x16_bf16 v[16:31], a[124:127], v[60:63], v[16:31]
    v_cmp_eq_u32 s[76:77], 1, v2
    v_cmp_eq_u32 vcc, 2, v2
    s_cmp_eq_u64 s[76:77], -1
    s_cselect_b32 s38, 1, 0
    ds_read_b128 v[56:59], v9 offset:34816
    v_mfma_f32_32x32x16_bf16 v[32:47], v[60:63], v[164:167], v[32:47]
    s_cmp_lg_u32 s38, 0
    s_cselect_b64 exec, 1, 0
    v_mov_b32 v15, s32
    ds_write_b32 v184, v15
    v_mov_b32 v2, 2
    s_mov_b64 exec, -1
    s_waitcnt lgkmcnt(3)
    v_mfma_f32_32x32x16_bf16 v[16:31], a[128:131], v[48:51], v[16:31]
    s_add_u32 s32, s32, s38
    s_mul_i32 s38, s38, 22528
    s_add_u32 s33, s33, s38
    ds_read_b128 v[60:63], v9 offset:35840
    v_mfma_f32_32x32x16_bf16 v[32:47], v[48:51], v[168:171], v[32:47]
    s_cmp_eq_u64 vcc, 0
    s_cselect_b32 s38, s32, 0x7fff
    s_waitcnt lgkmcnt(3)
    v_mfma_f32_32x32x16_bf16 v[16:31], a[132:135], v[52:55], v[16:31]
    s_cmp_le_u32 s38, s39
    s_cselect_b64 exec, -1, 0
    v_mov_b32 v2, 2
    buffer_load_dword v2, v1, s[8:11], s33 offen sc1
    s_mov_b64 exec, -1
    v_mfma_f32_32x32x16_bf16 v[32:47], v[52:55], v[172:175], v[32:47]
    s_waitcnt lgkmcnt(2)
    v_mfma_f32_32x32x16_bf16 v[16:31], a[136:139], v[56:59], v[16:31]
    v_mfma_f32_32x32x16_bf16 v[32:47], v[56:59], v[176:179], v[32:47]
    s_waitcnt lgkmcnt(0)
    v_mfma_f32_32x32x16_bf16 v[16:31], a[140:143], v[60:63], v[16:31]
    v_mfma_f32_32x32x16_bf16 v[32:47], v[60:63], v[180:183], v[32:47]
    s_add_u32 s51, s46, 16777216
    s_nop 2
    v_pk_fma_f32 v[16:17], v[16:17], v[148:149], v[100:101] op_sel_hi:[1,0,1] neg_lo:[0,0,1] neg_hi:[0,0,1]
    v_pk_fma_f32 v[18:19], v[18:19], v[148:149], v[102:103] op_sel_hi:[1,0,1] neg_lo:[0,0,1] neg_hi:[0,0,1]
    v_pk_fma_f32 v[20:21], v[20:21], v[148:149], v[104:105] op_sel_hi:[1,0,1] neg_lo:[0,0,1] neg_hi:[0,0,1]
    v_pk_fma_f32 v[22:23], v[22:23], v[148:149], v[106:107] op_sel_hi:[1,0,1] neg_lo:[0,0,1] neg_hi:[0,0,1]
    v_pk_fma_f32 v[24:25], v[24:25], v[148:149], v[108:109] op_sel_hi:[1,0,1] neg_lo:[0,0,1] neg_hi:[0,0,1]
    v_pk_fma_f32 v[26:27], v[26:27], v[148:149], v[110:111] op_sel_hi:[1,0,1] neg_lo:[0,0,1] neg_hi:[0,0,1]
    v_pk_fma_f32 v[28:29], v[28:29], v[148:149], v[112:113] op_sel_hi:[1,0,1] neg_lo:[0,0,1] neg_hi:[0,0,1]
    v_pk_fma_f32 v[30:31], v[30:31], v[148:149], v[114:115] op_sel_hi:[1,0,1] neg_lo:[0,0,1] neg_hi:[0,0,1]
    v_cvt_pk_bf16_f32 v188, v16, v24
    v_cvt_pk_bf16_f32 v189, v17, v25
    v_cvt_pk_bf16_f32 v190, v18, v26
    v_cvt_pk_bf16_f32 v191, v19, v27
    buffer_store_dwordx4 v[188:191], v14, s[8:11], s46 offen offset:0 sc1
    v_cvt_pk_bf16_f32 v192, v20, v28
    v_cvt_pk_bf16_f32 v193, v21, v29
    v_cvt_pk_bf16_f32 v194, v22, v30
    v_cvt_pk_bf16_f32 v195, v23, v31
    buffer_store_dwordx4 v[192:195], v14, s[8:11], s46 offen offset:512 sc1
    v_pk_fma_f32 v[32:33], v[32:33], v[116:117], v[132:133] neg_lo:[0,0,1] neg_hi:[0,0,1]
    v_pk_fma_f32 v[34:35], v[34:35], v[118:119], v[134:135] neg_lo:[0,0,1] neg_hi:[0,0,1]
    v_pk_fma_f32 v[36:37], v[36:37], v[120:121], v[136:137] neg_lo:[0,0,1] neg_hi:[0,0,1]
    v_pk_fma_f32 v[38:39], v[38:39], v[122:123], v[138:139] neg_lo:[0,0,1] neg_hi:[0,0,1]
    v_pk_fma_f32 v[40:41], v[40:41], v[124:125], v[140:141] neg_lo:[0,0,1] neg_hi:[0,0,1]
    v_pk_fma_f32 v[42:43], v[42:43], v[126:127], v[142:143] neg_lo:[0,0,1] neg_hi:[0,0,1]
    v_pk_fma_f32 v[44:45], v[44:45], v[128:129], v[144:145] neg_lo:[0,0,1] neg_hi:[0,0,1]
    v_pk_fma_f32 v[46:47], v[46:47], v[130:131], v[146:147] neg_lo:[0,0,1] neg_hi:[0,0,1]
    v_cvt_pk_bf16_f32 v196, v32, v33
    v_cvt_pk_bf16_f32 v197, v34, v35
    v_cvt_pk_bf16_f32 v198, v40, v41
    v_cvt_pk_bf16_f32 v199, v42, v43
    buffer_store_dwordx4 v[196:199], v14, s[8:11], s51 offen offset:0 sc1
    v_cvt_pk_bf16_f32 v200, v36, v37
    v_cvt_pk_bf16_f32 v201, v38, v39
    v_cvt_pk_bf16_f32 v202, v44, v45
    v_cvt_pk_bf16_f32 v203, v46, v47
    buffer_store_dwordx4 v[200:203], v14, s[8:11], s51 offen offset:512 sc1
    s_mul_i32 s43, s57, 22528
    s_add_u32 s43, s43, s49
    s_branch LpKV_head
LpKV_f_4:
    v_mfma_f32_32x32x16_bf16 v[16:31], a[76:79], v[60:63], v[16:31]
    s_add_u32 m0, s59, 0
    s_add_u32 s47, s41, 0
    buffer_load_dwordx4 v0, s[8:11], s47 offen offset:0 lds
    ds_read_b128 v[56:59], v9 offset:22528
    v_mfma_f32_32x32x16_bf16 v[32:47], v[60:63], a[220:223], v[32:47]
    s_waitcnt lgkmcnt(2)
    v_mfma_f32_32x32x16_bf16 v[16:31], a[80:83], v[48:51], v[16:31]
    buffer_load_dwordx4 v0, s[8:11], s47 offen offset:1024 lds
    ds_read_b128 v[60:63], v9 offset:23552
    v_mfma_f32_32x32x16_bf16 v[32:47], v[48:51], a[224:227], v[32:47]
    s_waitcnt lgkmcnt(2)
    v_mfma_f32_32x32x16_bf16 v[16:31], a[84:87], v[52:55], v[16:31]
    buffer_load_dwordx4 v0, s[8:11], s47 offen offset:2048 lds
    ds_read_b128 v[48:51], v9 offset:24576
    v_mfma_f32_32x32x16_bf16 v[32:47], v[52:55], a[228:231], v[32:47]
    s_waitcnt lgkmcnt(2)
    v_mfma_f32_32x32x16_bf16 v[16:31], a[88:91], v[56:59], v[16:31]
    buffer_load_dwordx4 v0, s[8:11], s47 offen offset:3072 lds
    ds_read_b128 v[52:55], v9 offset:25600
    v_mfma_f32_32x32x16_bf16 v[32:47], v[56:59], a[232:235], v[32:47]
    s_waitcnt lgkmcnt(2)
    v_mfma_f32_32x32x16_bf16 v[16:31], a[92:95], v[60:63], v[16:31]
    s_add_u32 m0, s59, 4096
    s_add_u32 s47, s41, 4096
    buffer_load_dwordx4 v0, s[8:11], s47 offen offset:0 lds
    ds_read_b128 v[56:59], v9 offset:26624
    v_mfma_f32_32x32x16_bf16 v[32:47], v[60:63], a[236:239], v[32:47]
    s_waitcnt lgkmcnt(2)
    v_mfma_f32_32x32x16_bf16 v[16:31], a[96:99], v[48:51], v[16:31]
    buffer_load_dwordx4 v0, s[8:11], s47 offen offset:1024 lds
    ds_read_b128 v[60:63], v9 offset:27648
    v_mfma_f32_32x32x16_bf16 v[32:47], v[48:51], a[240:243], v[32:47]
    s_waitcnt lgkmcnt(2)
    v_mfma_f32_32x32x16_bf16 v[16:31], a[100:103], v[52:55], v[16:31]
    buffer_load_dwordx4 v0, s[8:11], s47 offen offset:2048 lds
    ds_read_b128 v[48:51], v9 offset:28672
    v_mfma_f32_32x32x16_bf16 v[32:47], v[52:55], a[244:247], v[32:47]
    s_waitcnt lgkmcnt(2)
    v_mfma_f32_32x32x16_bf16 v[16:31], a[104:107], v[56:59], v[16:31]
    buffer_load_dwordx4 v0, s[8:11], s47 offen offset:3072 lds
    ds_read_b128 v[52:55], v9 offset:29696
    v_mfma_f32_32x32x16_bf16 v[32:47], v[56:59], a[248:251], v[32:47]
    s_waitcnt lgkmcnt(2)
    v_mfma_f32_32x32x16_bf16 v[16:31], a[108:111], v[60:63], v[16:31]
    s_add_u32 m0, s59, 8192
    s_add_u32 s47, s41, 8192
    buffer_load_dwordx4 v0, s[8:11], s47 offen offset:0 lds
    ds_read_b128 v[56:59], v9 offset:30720
    v_mfma_f32_32x32x16_bf16 v[32:47], v[60:63], a[252:255], v[32:47]
    s_waitcnt lgkmcnt(2)
    v_mfma_f32_32x32x16_bf16 v[16:31], a[112:115], v[48:51], v[16:31]
    s_mul_i32 s48, s36, 786432
    s_mul_i32 s18, s37, 6144
    s_add_u32 s48, s48, s18
    s_add_u32 s48, s48, 16125952
    s_add_u32 m0, s66, 4096
    s_nop 0
    buffer_load_dwordx4 v0, s[8:11], s48 offen lds
    ds_read_b128 v[60:63], v9 offset:31744
    v_mfma_f32_32x32x16_bf16 v[32:47], v[48:51], v[152:155], v[32:47]
    s_waitcnt lgkmcnt(2)
    v_mfma_f32_32x32x16_bf16 v[16:31], a[116:119], v[52:55], v[16:31]
    s_add_u32 m0, s66, s67
    s_sub_u32 s48, s48, 4096
    s_add_u32 s48, s48, s67
    buffer_load_dwordx4 v0, s[8:11], s48 offen lds
    ds_read_b128 v[48:51], v9 offset:32768
    v_mfma_f32_32x32x16_bf16 v[32:47], v[52:55], v[156:159], v[32:47]
    s_waitcnt lgkmcnt(2)
    v_mfma_f32_32x32x16_bf16 v[16:31], a[120:123], v[56:59], v[16:31]
    ds_read_b128 v[52:55], v9 offset:33792
    v_mfma_f32_32x32x16_bf16 v[32:47], v[56:59], v[160:163], v[32:47]
    s_waitcnt lgkmcnt(2)
    v_mfma_f32_32x32x16_bf16 v[16:31], a[124:127], v[60:63], v[16:31]
    v_cmp_eq_u32 s[76:77], 1, v2
    v_cmp_eq_u32 vcc, 2, v2
    s_cmp_eq_u64 s[76:77], -1
    s_cselect_b32 s38, 1, 0
    ds_read_b128 v[56:59], v9 offset:34816
    v_mfma_f32_32x32x16_bf16 v[32:47], v[60:63], v[164:167], v[32:47]
    s_cmp_lg_u32 s38, 0
    s_cselect_b64 exec, 1, 0
    v_mov_b32 v15, s32
    ds_write_b32 v184, v15
    v_mov_b32 v2, 2
    s_mov_b64 exec, -1
    s_waitcnt lgkmcnt(3)
    v_mfma_f32_32x32x16_bf16 v[16:31], a[128:131], v[48:51], v[16:31]
    s_add_u32 s32, s32, s38
    s_mul_i32 s38, s38, 22528
    s_add_u32 s33, s33, s38
    ds_read_b128 v[60:63], v9 offset:35840
    v_mfma_f32_32x32x16_bf16 v[32:47], v[48:51], v[168:171], v[32:47]
    s_cmp_eq_u64 vcc, 0
    s_cselect_b32 s38, s32, 0x7fff
    s_waitcnt lgkmcnt(3)
    v_mfma_f32_32x32x16_bf16 v[16:31], a[132:135], v[52:55], v[16:31]
    s_cmp_le_u32 s38, s39
    s_cselect_b64 exec, -1, 0
    v_mov_b32 v2, 2
    buffer_load_dword v2, v1, s[8:11], s33 offen sc1
    s_mov_b64 exec, -1
    v_mfma_f32_32x32x16_bf16 v[32:47], v[52:55], v[172:175], v[32:47]
    s_waitcnt lgkmcnt(2)
    v_mfma_f32_32x32x16_bf16 v[16:31], a[136:139], v[56:59], v[16:31]
    v_mfma_f32_32x32x16_bf16 v[32:47], v[56:59], v[176:179], v[32:47]
    s_waitcnt lgkmcnt(0)
    v_mfma_f32_32x32x16_bf16 v[16:31], a[140:143], v[60:63], v[16:31]
    v_mfma_f32_32x32x16_bf16 v[32:47], v[60:63], v[180:183], v[32:47]
    s_add_u32 s51, s46, 16777216
    s_nop 2
    v_pk_fma_f32 v[16:17], v[16:17], v[148:149], v[100:101] op_sel_hi:[1,0,1] neg_lo:[0,0,1] neg_hi:[0,0,1]
    v_pk_fma_f32 v[18:19], v[18:19], v[148:149], v[102:103] op_sel_hi:[1,0,1] neg_lo:[0,0,1] neg_hi:[0,0,1]
    v_pk_fma_f32 v[20:21], v[20:21], v[148:149], v[104:105] op_sel_hi:[1,0,1] neg_lo:[0,0,1] neg_hi:[0,0,1]
    v_pk_fma_f32 v[22:23], v[22:23], v[148:149], v[106:107] op_sel_hi:[1,0,1] neg_lo:[0,0,1] neg_hi:[0,0,1]
    v_pk_fma_f32 v[24:25], v[24:25], v[148:149], v[108:109] op_sel_hi:[1,0,1] neg_lo:[0,0,1] neg_hi:[0,0,1]
    v_pk_fma_f32 v[26:27], v[26:27], v[148:149], v[110:111] op_sel_hi:[1,0,1] neg_lo:[0,0,1] neg_hi:[0,0,1]
    v_pk_fma_f32 v[28:29], v[28:29], v[148:149], v[112:113] op_sel_hi:[1,0,1] neg_lo:[0,0,1] neg_hi:[0,0,1]
    v_pk_fma_f32 v[30:31], v[30:31], v[148:149], v[114:115] op_sel_hi:[1,0,1] neg_lo:[0,0,1] neg_hi:[0,0,1]
    v_cvt_pk_bf16_f32 v188, v16, v24
    v_cvt_pk_bf16_f32 v189, v17, v25
    v_cvt_pk_bf16_f32 v190, v18, v26
    v_cvt_pk_bf16_f32 v191, v19, v27
    buffer_store_dwordx4 v[188:191], v14, s[8:11], s46 offen offset:0 sc1
    v_cvt_pk_bf16_f32 v192, v20, v28
    v_cvt_pk_bf16_f32 v193, v21, v29
    v_cvt_pk_bf16_f32 v194, v22, v30
    v_cvt_pk_bf16_f32 v195, v23, v31
    buffer_store_dwordx4 v[192:195], v14, s[8:11], s46 offen offset:512 sc1
    v_pk_fma_f32 v[32:33], v[32:33], v[116:117], v[132:133] neg_lo:[0,0,1] neg_hi:[0,0,1]
    v_pk_fma_f32 v[34:35], v[34:35], v[118:119], v[134:135] neg_lo:[0,0,1] neg_hi:[0,0,1]
    v_pk_fma_f32 v[36:37], v[36:37], v[120:121], v[136:137] neg_lo:[0,0,1] neg_hi:[0,0,1]
    v_pk_fma_f32 v[38:39], v[38:39], v[122:123], v[138:139] neg_lo:[0,0,1] neg_hi:[0,0,1]
    v_pk_fma_f32 v[40:41], v[40:41], v[124:125], v[140:141] neg_lo:[0,0,1] neg_hi:[0,0,1]
    v_pk_fma_f32 v[42:43], v[42:43], v[126:127], v[142:143] neg_lo:[0,0,1] neg_hi:[0,0,1]
    v_pk_fma_f32 v[44:45], v[44:45], v[128:129], v[144:145] neg_lo:[0,0,1] neg_hi:[0,0,1]
    v_pk_fma_f32 v[46:47], v[46:47], v[130:131], v[146:147] neg_lo:[0,0,1] neg_hi:[0,0,1]
    v_cvt_pk_bf16_f32 v196, v32, v33
    v_cvt_pk_bf16_f32 v197, v34, v35
    v_cvt_pk_bf16_f32 v198, v40, v41
    v_cvt_pk_bf16_f32 v199, v42, v43
    buffer_store_dwordx4 v[196:199], v14, s[8:11], s51 offen offset:0 sc1
    v_cvt_pk_bf16_f32 v200, v36, v37
    v_cvt_pk_bf16_f32 v201, v38, v39
    v_cvt_pk_bf16_f32 v202, v44, v45
    v_cvt_pk_bf16_f32 v203, v46, v47
    buffer_store_dwordx4 v[200:203], v14, s[8:11], s51 offen offset:512 sc1
    s_mul_i32 s43, s57, 22528
    s_add_u32 s43, s43, s49
    s_branch LpKV_head
LpKV_none:
    s_waitcnt vmcnt(0)
    s_cmp_lg_u32 s43, 0
    s_cselect_b64 exec, 3, 0
    buffer_store_dword v3, v185, s[8:11], s43 offen sc1
    s_mov_b64 exec, -1
    s_mov_b32 s43, 0
    s_cmp_ge_u32 s37, 64
    s_cbranch_scc1 LpKV_end
LpKV_wait:
    s_mov_b32 s16, 0
    s_cmp_lg_u32 s14, 0
    s_cbranch_scc1 LpKV_wl
LpKV_wp:
    buffer_load_dword v2, v1, s[8:11], s60 offen sc1
    s_add_u32 s16, s16, 1
    s_cmp_gt_u32 s16, 100000
    s_cbranch_scc1 LpKV_giveup
    s_waitcnt vmcnt(0)
    v_cmp_eq_u32 vcc, 0, v2
    s_nop 0
    s_cbranch_vccz LpKV_wok
    s_sleep 4
    s_branch LpKV_wp
LpKV_giveup:
    v_mov_b32 v5, -2
    ds_write_b32 v184, v5
    s_waitcnt lgkmcnt(0)
    s_branch L_role_p_abort
LpKV_wok:
    v_mov_b32 v5, s37
    ds_write_b32 v184, v5
    s_branch LpKV_go
LpKV_wl:
    ds_read_b32 v15, v184
    s_add_u32 s16, s16, 1
    s_cmp_gt_u32 s16, 1600000
    s_cbranch_scc1 L_role_p_abort
    s_waitcnt lgkmcnt(0)
    v_readfirstlane_b32 s17, v15
    s_nop 0
    s_cmp_eq_u32 s17, -2
    s_cbranch_scc1 L_role_p_abort
    s_cmp_ge_i32 s17, s37
    s_cbranch_scc1 LpKV_go
    s_sleep 1
    s_branch LpKV_wl
LpKV_go:
    s_add_u32 m0, s59, 0
    s_add_u32 s47, s41, 0
    buffer_load_dwordx4 v0, s[8:11], s47 offen offset:0 lds
    buffer_load_dwordx4 v0, s[8:11], s47 offen offset:1024 lds
    buffer_load_dwordx4 v0, s[8:11], s47 offen offset:2048 lds
    buffer_load_dwordx4 v0, s[8:11], s47 offen offset:3072 lds
    s_add_u32 m0, s59, 4096
    s_add_u32 s47, s41, 4096
    buffer_load_dwordx4 v0, s[8:11], s47 offen offset:0 lds
    buffer_load_dwordx4 v0, s[8:11], s47 offen offset:1024 lds
    buffer_load_dwordx4 v0, s[8:11], s47 offen offset:2048 lds
    buffer_load_dwordx4 v0, s[8:11], s47 offen offset:3072 lds
    s_add_u32 m0, s59, 8192
    s_add_u32 s47, s41, 8192
    buffer_load_dwordx4 v0, s[8:11], s47 offen offset:0 lds
    s_mul_i32 s48, s36, 786432
    s_mul_i32 s18, s37, 6144
    s_add_u32 s48, s48, s18
    s_add_u32 s48, s48, 16125952
    s_add_u32 m0, s66, 4096
    s_nop 0
    buffer_load_dwordx4 v0, s[8:11], s48 offen lds
    s_add_u32 m0, s66, s67
    s_sub_u32 s48, s48, 4096
    s_add_u32 s48, s48, s67
    buffer_load_dwordx4 v0, s[8:11], s48 offen lds
    s_waitcnt vmcnt(0) lgkmcnt(0)
    s_branch LpKV_head2
LpKV_end:
    s_branch L_role_p_exit
L_role_p_abort:
    s_waitcnt lgkmcnt(0)
    s_mov_b64 exec, -1
    v_mov_b32 v0, 60
    s_lshl_b32 s5, s3, 8
    s_or_b32 s5, s5, s4
    s_or_b32 s5, s5, 0x10000
    v_mov_b32 v1, s5
    global_store_dword v0, v1, s[12:13]
    s_endpgm
L_role_p_exit:
    s_endpgm
.p2align 6
L_role_awo:
    v_and_b32 v5, 63, v0
    v_lshlrev_b32 v0, 4, v5
    v_and_b32 v7, 15, v5
    v_lshrrev_b32 v8, 4, v5
    v_min_u32 v1, 63, v5
    v_lshrrev_b32 v6, 2, v1
    v_and_b32 v1, 3, v1
    v_lshlrev_b32 v1, 2, v1
    v_lshl_add_u32 v1, v6, 7, v1
    v_mov_b32 v3, 1
    v_mov_b32 v4, 0
    s_mov_b32 s44, 0x05040100
    s_mov_b32 s45, 0x07060302
    s_load_dwordx2 s[20:21], s[0:1], 16
    s_mov_b32 s22, 663552
    s_mov_b32 s23, 0x00020000
    s_waitcnt lgkmcnt(0)
    s_and_b32 s21, s21, 0xffff
    s_cmp_ge_u32 s15, 3
    s_cselect_b32 s63, 1, 0
    s_cselect_b32 s17, 3, 0
    s_sub_u32 s15, s15, s17
    s_mul_i32 s50, s15, 6
    s_lshl_b32 s17, s14, 1
    s_add_u32 s18, s14, 2
    s_cmp_lt_u32 s14, 2
    s_cselect_b32 s17, s17, s18
    s_cselect_b32 s18, 1, 0
    s_add_u32 s50, s50, s17
    s_add_u32 s51, s50, s18
    s_cmp_eq_u32 s63, 0
    s_cbranch_scc1 Lao_gate_ng
    s_cmp_lg_u32 s14, 0
    s_cbranch_scc1 Lao_gate_d
    v_mov_b32 v5, 48
    s_mov_b32 s16, 0
Lao_gate:
    global_load_dword v6, v5, s[12:13] sc1
    s_add_u32 s16, s16, 1
    s_cmp_gt_u32 s16, 100000
    s_cbranch_scc1 L_role_awo_abort
    s_waitcnt vmcnt(0)
    v_cmp_gt_u32 vcc, 32, v6
    s_nop 0
    s_cbranch_vccz Lao_gate_d
    s_sleep 100
    s_branch Lao_gate
Lao_gate_d:
    s_barrier
Lao_gate_ng:
    v_lshrrev_b32 v5, 6, v0
    v_and_b32 v6, 0x30, v0
    v_mul_u32_u24 v16, 1152, v5
    v_add_u32 v16, v16, v6
    v_lshrrev_b32 v17, 1, v5
    v_mul_u32_u24 v17, 18, v17
    v_and_b32 v5, 1, v5
    v_add_u32 v17, v17, v5
    v_add_u32 v17, 16, v17
    v_mul_u32_u24 v17, 1152, v17
    v_add_u32 v17, v17, v6
    v_lshrrev_b32 v5, 2, v7
    v_lshrrev_b32 v6, 1, v8
    v_lshl_add_u32 v5, v6, 3, v5
    v_lshlrev_b32 v18, 6, v5
    v_and_b32 v5, 1, v7
    v_lshl_add_u32 v18, v5, 4, v18
    v_and_b32 v5, 1, v8
    v_lshl_add_u32 v18, v5, 5, v18
    v_bfe_u32 v5, v7, 1, 1
    v_lshl_add_u32 v18, v5, 3, v18
    s_lshl_b32 s46, s14, 15
    v_add_u32 v18, s46, v18
    s_lshl_b32 s49, s50, 6
    s_lshl_b32 s52, s51, 6
    s_add_u32 m0, s46, 0
    s_add_u32 s17, s49, 0
    buffer_load_dwordx4 v16, s[20:23], s17 offen lds
    s_add_u32 m0, s46, 1024
    s_add_u32 s17, s49, 20736
    buffer_load_dwordx4 v16, s[20:23], s17 offen lds
    s_add_u32 m0, s46, 2048
    s_add_u32 s17, s49, 41472
    buffer_load_dwordx4 v16, s[20:23], s17 offen lds
    s_add_u32 m0, s46, 3072
    s_add_u32 s17, s49, 62208
    buffer_load_dwordx4 v16, s[20:23], s17 offen lds
    s_add_u32 m0, s46, 4096
    s_add_u32 s17, s49, 82944
    buffer_load_dwordx4 v16, s[20:23], s17 offen lds
    s_add_u32 m0, s46, 5120
    s_add_u32 s17, s49, 103680
    buffer_load_dwordx4 v16, s[20:23], s17 offen lds
    s_add_u32 m0, s46, 6144
    s_add_u32 s17, s49, 124416
    buffer_load_dwordx4 v16, s[20:23], s17 offen lds
    s_add_u32 m0, s46, 7168
    s_add_u32 s17, s49, 145152
    buffer_load_dwordx4 v16, s[20:23], s17 offen lds
    s_add_u32 m0, s46, 8192
    s_add_u32 s17, s49, 165888
    buffer_load_dwordx4 v16, s[20:23], s17 offen lds
    s_add_u32 m0, s46, 9216
    s_add_u32 s17, s49, 186624
    buffer_load_dwordx4 v16, s[20:23], s17 offen lds
    s_add_u32 m0, s46, 10240
    s_add_u32 s17, s49, 207360
    buffer_load_dwordx4 v16, s[20:23], s17 offen lds
    s_add_u32 m0, s46, 11264
    s_add_u32 s17, s49, 228096
    buffer_load_dwordx4 v16, s[20:23], s17 offen lds
    s_add_u32 m0, s46, 12288
    s_add_u32 s17, s49, 248832
    buffer_load_dwordx4 v16, s[20:23], s17 offen lds
    s_add_u32 m0, s46, 13312
    s_add_u32 s17, s49, 269568
    buffer_load_dwordx4 v16, s[20:23], s17 offen lds
    s_add_u32 m0, s46, 14336
    s_add_u32 s17, s49, 290304
    buffer_load_dwordx4 v16, s[20:23], s17 offen lds
    s_add_u32 m0, s46, 15360
    s_add_u32 s17, s49, 311040
    buffer_load_dwordx4 v16, s[20:23], s17 offen lds
    s_add_u32 m0, s46, 16384
    s_add_u32 s17, s49, 331776
    buffer_load_dwordx4 v16, s[20:23], s17 offen lds
    s_add_u32 m0, s46, 17408
    s_add_u32 s17, s49, 352512
    buffer_load_dwordx4 v16, s[20:23], s17 offen lds
    s_add_u32 m0, s46, 18432
    s_add_u32 s17, s49, 373248
    buffer_load_dwordx4 v16, s[20:23], s17 offen lds
    s_add_u32 m0, s46, 19456
    s_add_u32 s17, s49, 393984
    buffer_load_dwordx4 v16, s[20:23], s17 offen lds
    s_add_u32 m0, s46, 20480
    s_add_u32 s17, s49, 414720
    buffer_load_dwordx4 v16, s[20:23], s17 offen lds
    s_add_u32 m0, s46, 21504
    s_add_u32 s17, s49, 435456
    buffer_load_dwordx4 v16, s[20:23], s17 offen lds
    s_add_u32 m0, s46, 22528
    s_add_u32 s17, s49, 456192
    buffer_load_dwordx4 v16, s[20:23], s17 offen lds
    s_add_u32 m0, s46, 23552
    s_add_u32 s17, s49, 476928
    buffer_load_dwordx4 v16, s[20:23], s17 offen lds
    s_add_u32 m0, s46, 24576
    s_add_u32 s17, s49, 497664
    buffer_load_dwordx4 v16, s[20:23], s17 offen lds
    s_add_u32 m0, s46, 25600
    s_add_u32 s17, s49, 518400
    buffer_load_dwordx4 v16, s[20:23], s17 offen lds
    s_add_u32 m0, s46, 26624
    s_add_u32 s17, s49, 539136
    buffer_load_dwordx4 v16, s[20:23], s17 offen lds
    s_add_u32 m0, s46, 27648
    s_add_u32 s17, s49, 559872
    buffer_load_dwordx4 v16, s[20:23], s17 offen lds
    s_add_u32 m0, s46, 28672
    s_add_u32 s17, s49, 580608
    buffer_load_dwordx4 v16, s[20:23], s17 offen lds
    s_add_u32 m0, s46, 29696
    s_add_u32 s17, s49, 601344
    buffer_load_dwordx4 v16, s[20:23], s17 offen lds
    s_add_u32 m0, s46, 30720
    s_add_u32 s17, s49, 622080
    buffer_load_dwordx4 v16, s[20:23], s17 offen lds
    s_add_u32 m0, s46, 31744
    s_add_u32 s17, s49, 642816
    buffer_load_dwordx4 v16, s[20:23], s17 offen lds
    s_waitcnt vmcnt(28)
    ds_read_b64_tr_b16 a[0:1], v18 offset:0
    ds_read_b64_tr_b16 a[2:3], v18 offset:256
    ds_read_b64_tr_b16 a[4:5], v18 offset:1024
    ds_read_b64_tr_b16 a[6:7], v18 offset:1280
    ds_read_b64_tr_b16 a[8:9], v18 offset:2048
    ds_read_b64_tr_b16 a[10:11], v18 offset:2304
    ds_read_b64_tr_b16 a[12:13], v18 offset:3072
    ds_read_b64_tr_b16 a[14:15], v18 offset:3328
    s_waitcnt lgkmcnt(0)
    s_add_u32 m0, s46, 0
    s_add_u32 s17, s49, 0
    buffer_load_dwordx4 v17, s[20:23], s17 offen lds
    s_add_u32 m0, s46, 1024
    s_add_u32 s17, s49, 165888
    buffer_load_dwordx4 v17, s[20:23], s17 offen lds
    s_add_u32 m0, s46, 2048
    s_add_u32 s17, s49, 331776
    buffer_load_dwordx4 v17, s[20:23], s17 offen lds
    s_add_u32 m0, s46, 3072
    s_add_u32 s17, s49, 497664
    buffer_load_dwordx4 v17, s[20:23], s17 offen lds
    s_waitcnt vmcnt(28)
    ds_read_b64_tr_b16 a[16:17], v18 offset:4096
    ds_read_b64_tr_b16 a[18:19], v18 offset:4352
    ds_read_b64_tr_b16 a[20:21], v18 offset:5120
    ds_read_b64_tr_b16 a[22:23], v18 offset:5376
    ds_read_b64_tr_b16 a[24:25], v18 offset:6144
    ds_read_b64_tr_b16 a[26:27], v18 offset:6400
    ds_read_b64_tr_b16 a[28:29], v18 offset:7168
    ds_read_b64_tr_b16 a[30:31], v18 offset:7424
    s_waitcnt lgkmcnt(0)
    s_add_u32 m0, s46, 4096
    s_add_u32 s17, s52, 0
    buffer_load_dwordx4 v16, s[20:23], s17 offen lds
    s_add_u32 m0, s46, 5120
    s_add_u32 s17, s52, 20736
    buffer_load_dwordx4 v16, s[20:23], s17 offen lds
    s_add_u32 m0, s46, 6144
    s_add_u32 s17, s52, 41472
    buffer_load_dwordx4 v16, s[20:23], s17 offen lds
    s_add_u32 m0, s46, 7168
    s_add_u32 s17, s52, 62208
    buffer_load_dwordx4 v16, s[20:23], s17 offen lds
    s_waitcnt vmcnt(28)
    ds_read_b64_tr_b16 a[32:33], v18 offset:8192
    ds_read_b64_tr_b16 a[34:35], v18 offset:8448
    ds_read_b64_tr_b16 a[36:37], v18 offset:9216
    ds_read_b64_tr_b16 a[38:39], v18 offset:9472
    ds_read_b64_tr_b16 a[40:41], v18 offset:10240
    ds_read_b64_tr_b16 a[42:43], v18 offset:10496
    ds_read_b64_tr_b16 a[44:45], v18 offset:11264
    ds_read_b64_tr_b16 a[46:47], v18 offset:11520
    s_waitcnt lgkmcnt(0)
    s_add_u32 m0, s46, 8192
    s_add_u32 s17, s52, 82944
    buffer_load_dwordx4 v16, s[20:23], s17 offen lds
    s_add_u32 m0, s46, 9216
    s_add_u32 s17, s52, 103680
    buffer_load_dwordx4 v16, s[20:23], s17 offen lds
    s_add_u32 m0, s46, 10240
    s_add_u32 s17, s52, 124416
    buffer_load_dwordx4 v16, s[20:23], s17 offen lds
    s_add_u32 m0, s46, 11264
    s_add_u32 s17, s52, 145152
    buffer_load_dwordx4 v16, s[20:23], s17 offen lds
    s_waitcnt vmcnt(28)
    ds_read_b64_tr_b16 a[48:49], v18 offset:12288
    ds_read_b64_tr_b16 a[50:51], v18 offset:12544
    ds_read_b64_tr_b16 a[52:53], v18 offset:13312
    ds_read_b64_tr_b16 a[54:55], v18 offset:13568
    ds_read_b64_tr_b16 a[56:57], v18 offset:14336
    ds_read_b64_tr_b16 a[58:59], v18 offset:14592
    ds_read_b64_tr_b16 a[60:61], v18 offset:15360
    ds_read_b64_tr_b16 a[62:63], v18 offset:15616
    s_waitcnt lgkmcnt(0)
    s_add_u32 m0, s46, 12288
    s_add_u32 s17, s52, 165888
    buffer_load_dwordx4 v16, s[20:23], s17 offen lds
    s_add_u32 m0, s46, 13312
    s_add_u32 s17, s52, 186624
    buffer_load_dwordx4 v16, s[20:23], s17 offen lds
    s_add_u32 m0, s46, 14336
    s_add_u32 s17, s52, 207360
    buffer_load_dwordx4 v16, s[20:23], s17 offen lds
    s_add_u32 m0, s46, 15360
    s_add_u32 s17, s52, 228096
    buffer_load_dwordx4 v16, s[20:23], s17 offen lds
    s_waitcnt vmcnt(28)
    ds_read_b64_tr_b16 a[64:65], v18 offset:16384
    ds_read_b64_tr_b16 a[66:67], v18 offset:16640
    ds_read_b64_tr_b16 a[68:69], v18 offset:17408
    ds_read_b64_tr_b16 a[70:71], v18 offset:17664
    ds_read_b64_tr_b16 a[72:73], v18 offset:18432
    ds_read_b64_tr_b16 a[74:75], v18 offset:18688
    ds_read_b64_tr_b16 a[76:77], v18 offset:19456
    ds_read_b64_tr_b16 a[78:79], v18 offset:19712
    s_waitcnt lgkmcnt(0)
    s_add_u32 m0, s46, 16384
    s_add_u32 s17, s52, 248832
    buffer_load_dwordx4 v16, s[20:23], s17 offen lds
    s_add_u32 m0, s46, 17408
    s_add_u32 s17, s52, 269568
    buffer_load_dwordx4 v16, s[20:23], s17 offen lds
    s_add_u32 m0, s46, 18432
    s_add_u32 s17, s52, 290304
    buffer_load_dwordx4 v16, s[20:23], s17 offen lds
    s_add_u32 m0, s46, 19456
    s_add_u32 s17, s52, 311040
    buffer_load_dwordx4 v16, s[20:23], s17 offen lds
    s_waitcnt vmcnt(28)
    ds_read_b64_tr_b16 a[80:81], v18 offset:20480
    ds_read_b64_tr_b16 a[82:83], v18 offset:20736
    ds_read_b64_tr_b16 a[84:85], v18 offset:21504
    ds_read_b64_tr_b16 a[86:87], v18 offset:21760
    ds_read_b64_tr_b16 a[88:89], v18 offset:22528
    ds_read_b64_tr_b16 a[90:91], v18 offset:22784
    ds_read_b64_tr_b16 a[92:93], v18 offset:23552
    ds_read_b64_tr_b16 a[94:95], v18 offset:23808
    s_waitcnt lgkmcnt(0)
    s_add_u32 m0, s46, 20480
    s_add_u32 s17, s52, 331776
    buffer_load_dwordx4 v16, s[20:23], s17 offen lds
    s_add_u32 m0, s46, 21504
    s_add_u32 s17, s52, 352512
    buffer_load_dwordx4 v16, s[20:23], s17 offen lds
    s_add_u32 m0, s46, 22528
    s_add_u32 s17, s52, 373248
    buffer_load_dwordx4 v16, s[20:23], s17 offen lds
    s_add_u32 m0, s46, 23552
    s_add_u32 s17, s52, 393984
    buffer_load_dwordx4 v16, s[20:23], s17 offen lds
    s_waitcnt vmcnt(28)
    ds_read_b64_tr_b16 a[96:97], v18 offset:24576
    ds_read_b64_tr_b16 a[98:99], v18 offset:24832
    ds_read_b64_tr_b16 a[100:101], v18 offset:25600
    ds_read_b64_tr_b16 a[102:103], v18 offset:25856
    ds_read_b64_tr_b16 a[104:105], v18 offset:26624
    ds_read_b64_tr_b16 a[106:107], v18 offset:26880
    ds_read_b64_tr_b16 a[108:109], v18 offset:27648
    ds_read_b64_tr_b16 a[110:111], v18 offset:27904
    s_waitcnt lgkmcnt(0)
    s_add_u32 m0, s46, 24576
    s_add_u32 s17, s52, 414720
    buffer_load_dwordx4 v16, s[20:23], s17 offen lds
    s_add_u32 m0, s46, 25600
    s_add_u32 s17, s52, 435456
    buffer_load_dwordx4 v16, s[20:23], s17 offen lds
    s_add_u32 m0, s46, 26624
    s_add_u32 s17, s52, 456192
    buffer_load_dwordx4 v16, s[20:23], s17 offen lds
    s_add_u32 m0, s46, 27648
    s_add_u32 s17, s52, 476928
    buffer_load_dwordx4 v16, s[20:23], s17 offen lds
    s_waitcnt vmcnt(28)
    ds_read_b64_tr_b16 a[112:113], v18 offset:28672
    ds_read_b64_tr_b16 a[114:115], v18 offset:28928
    ds_read_b64_tr_b16 a[116:117], v18 offset:29696
    ds_read_b64_tr_b16 a[118:119], v18 offset:29952
    ds_read_b64_tr_b16 a[120:121], v18 offset:30720
    ds_read_b64_tr_b16 a[122:123], v18 offset:30976
    ds_read_b64_tr_b16 a[124:125], v18 offset:31744
    ds_read_b64_tr_b16 a[126:127], v18 offset:32000
    s_waitcnt lgkmcnt(0)
    s_add_u32 m0, s46, 28672
    s_add_u32 s17, s52, 497664
    buffer_load_dwordx4 v16, s[20:23], s17 offen lds
    s_add_u32 m0, s46, 29696
    s_add_u32 s17, s52, 518400
    buffer_load_dwordx4 v16, s[20:23], s17 offen lds
    s_add_u32 m0, s46, 30720
    s_add_u32 s17, s52, 539136
    buffer_load_dwordx4 v16, s[20:23], s17 offen lds
    s_add_u32 m0, s46, 31744
    s_add_u32 s17, s52, 559872
    buffer_load_dwordx4 v16, s[20:23], s17 offen lds
    s_waitcnt vmcnt(28)
    ds_read_b64_tr_b16 a[128:129], v18 offset:0
    ds_read_b64_tr_b16 a[130:131], v18 offset:256
    ds_read_b64_tr_b16 a[132:133], v18 offset:1024
    ds_read_b64_tr_b16 a[134:135], v18 offset:1280
    ds_read_b64_tr_b16 a[136:137], v18 offset:2048
    ds_read_b64_tr_b16 a[138:139], v18 offset:2304
    ds_read_b64_tr_b16 a[140:141], v18 offset:3072
    ds_read_b64_tr_b16 a[142:143], v18 offset:3328
    s_waitcnt lgkmcnt(0)
    s_add_u32 m0, s46, 0
    s_add_u32 s17, s52, 580608
    buffer_load_dwordx4 v16, s[20:23], s17 offen lds
    s_add_u32 m0, s46, 1024
    s_add_u32 s17, s52, 601344
    buffer_load_dwordx4 v16, s[20:23], s17 offen lds
    s_add_u32 m0, s46, 2048
    s_add_u32 s17, s52, 622080
    buffer_load_dwordx4 v16, s[20:23], s17 offen lds
    s_add_u32 m0, s46, 3072
    s_add_u32 s17, s52, 642816
    buffer_load_dwordx4 v16, s[20:23], s17 offen lds
    s_waitcnt vmcnt(28)
    ds_read_b64_tr_b16 a[144:145], v18 offset:4096
    ds_read_b64_tr_b16 a[146:147], v18 offset:4352
    ds_read_b64_tr_b16 a[148:149], v18 offset:5120
    ds_read_b64_tr_b16 a[150:151], v18 offset:5376
    ds_read_b64_tr_b16 a[152:153], v18 offset:6144
    ds_read_b64_tr_b16 a[154:155], v18 offset:6400
    ds_read_b64_tr_b16 a[156:157], v18 offset:7168
    ds_read_b64_tr_b16 a[158:159], v18 offset:7424
    s_waitcnt lgkmcnt(0)
    s_add_u32 m0, s46, 4096
    s_add_u32 s17, s52, 0
    buffer_load_dwordx4 v17, s[20:23], s17 offen lds
    s_add_u32 m0, s46, 5120
    s_add_u32 s17, s52, 165888
    buffer_load_dwordx4 v17, s[20:23], s17 offen lds
    s_add_u32 m0, s46, 6144
    s_add_u32 s17, s52, 331776
    buffer_load_dwordx4 v17, s[20:23], s17 offen lds
    s_add_u32 m0, s46, 7168
    s_add_u32 s17, s52, 497664
    buffer_load_dwordx4 v17, s[20:23], s17 offen lds
    s_waitcnt vmcnt(28)
    ds_read_b64_tr_b16 a[160:161], v18 offset:8192
    ds_read_b64_tr_b16 a[162:163], v18 offset:8448
    ds_read_b64_tr_b16 a[164:165], v18 offset:9216
    ds_read_b64_tr_b16 a[166:167], v18 offset:9472
    ds_read_b64_tr_b16 a[168:169], v18 offset:10240
    ds_read_b64_tr_b16 a[170:171], v18 offset:10496
    ds_read_b64_tr_b16 a[172:173], v18 offset:11264
    ds_read_b64_tr_b16 a[174:175], v18 offset:11520
    s_waitcnt lgkmcnt(0)
    s_waitcnt vmcnt(24)
    ds_read_b64_tr_b16 a[176:177], v18 offset:12288
    ds_read_b64_tr_b16 a[178:179], v18 offset:12544
    ds_read_b64_tr_b16 a[180:181], v18 offset:13312
    ds_read_b64_tr_b16 a[182:183], v18 offset:13568
    ds_read_b64_tr_b16 a[184:185], v18 offset:14336
    ds_read_b64_tr_b16 a[186:187], v18 offset:14592
    ds_read_b64_tr_b16 a[188:189], v18 offset:15360
    ds_read_b64_tr_b16 a[190:191], v18 offset:15616
    s_waitcnt lgkmcnt(0)
    s_waitcnt vmcnt(20)
    ds_read_b64_tr_b16 a[192:193], v18 offset:16384
    ds_read_b64_tr_b16 a[194:195], v18 offset:16640
    ds_read_b64_tr_b16 a[196:197], v18 offset:17408
    ds_read_b64_tr_b16 a[198:199], v18 offset:17664
    ds_read_b64_tr_b16 a[200:201], v18 offset:18432
    ds_read_b64_tr_b16 a[202:203], v18 offset:18688
    ds_read_b64_tr_b16 a[204:205], v18 offset:19456
    ds_read_b64_tr_b16 a[206:207], v18 offset:19712
    s_waitcnt lgkmcnt(0)
    s_waitcnt vmcnt(16)
    ds_read_b64_tr_b16 a[208:209], v18 offset:20480
    ds_read_b64_tr_b16 a[210:211], v18 offset:20736
    ds_read_b64_tr_b16 a[212:213], v18 offset:21504
    ds_read_b64_tr_b16 a[214:215], v18 offset:21760
    ds_read_b64_tr_b16 a[216:217], v18 offset:22528
    ds_read_b64_tr_b16 a[218:219], v18 offset:22784
    ds_read_b64_tr_b16 a[220:221], v18 offset:23552
    ds_read_b64_tr_b16 a[222:223], v18 offset:23808
    s_waitcnt lgkmcnt(0)
    s_waitcnt vmcnt(12)
    ds_read_b64_tr_b16 a[224:225], v18 offset:24576
    ds_read_b64_tr_b16 a[226:227], v18 offset:24832
    ds_read_b64_tr_b16 a[228:229], v18 offset:25600
    ds_read_b64_tr_b16 a[230:231], v18 offset:25856
    ds_read_b64_tr_b16 a[232:233], v18 offset:26624
    ds_read_b64_tr_b16 a[234:235], v18 offset:26880
    ds_read_b64_tr_b16 a[236:237], v18 offset:27648
    ds_read_b64_tr_b16 a[238:239], v18 offset:27904
    s_waitcnt lgkmcnt(0)
    s_waitcnt vmcnt(8)
    ds_read_b64_tr_b16 a[240:241], v18 offset:28672
    ds_read_b64_tr_b16 a[242:243], v18 offset:28928
    ds_read_b64_tr_b16 a[244:245], v18 offset:29696
    ds_read_b64_tr_b16 a[246:247], v18 offset:29952
    ds_read_b64_tr_b16 a[248:249], v18 offset:30720
    ds_read_b64_tr_b16 a[250:251], v18 offset:30976
    ds_read_b64_tr_b16 a[252:253], v18 offset:31744
    ds_read_b64_tr_b16 a[254:255], v18 offset:32000
    s_waitcnt lgkmcnt(0)
    s_waitcnt vmcnt(4)
    ds_read_b64_tr_b16 v[152:153], v18 offset:0
    ds_read_b64_tr_b16 v[154:155], v18 offset:256
    ds_read_b64_tr_b16 v[156:157], v18 offset:1024
    ds_read_b64_tr_b16 v[158:159], v18 offset:1280
    ds_read_b64_tr_b16 v[160:161], v18 offset:2048
    ds_read_b64_tr_b16 v[162:163], v18 offset:2304
    ds_read_b64_tr_b16 v[164:165], v18 offset:3072
    ds_read_b64_tr_b16 v[166:167], v18 offset:3328
    s_waitcnt lgkmcnt(0)
    s_waitcnt vmcnt(0)
    ds_read_b64_tr_b16 v[168:169], v18 offset:4096
    ds_read_b64_tr_b16 v[170:171], v18 offset:4352
    ds_read_b64_tr_b16 v[172:173], v18 offset:5120
    ds_read_b64_tr_b16 v[174:175], v18 offset:5376
    ds_read_b64_tr_b16 v[176:177], v18 offset:6144
    ds_read_b64_tr_b16 v[178:179], v18 offset:6400
    ds_read_b64_tr_b16 v[180:181], v18 offset:7168
    ds_read_b64_tr_b16 v[182:183], v18 offset:7424
    s_waitcnt lgkmcnt(0)
    s_barrier
    v_bfe_u32 v5, v0, 4, 5
    v_lshlrev_b32 v5, 4, v5
    v_lshrrev_b32 v6, 9, v0
    v_lshl_add_u32 v6, v6, 9, v5
    s_lshl_b32 s17, s50, 11
    v_add_u32 v12, s17, v6
    s_lshr_b32 s17, s50, 1
    s_lshl_b32 s17, s17, 9
    s_and_b32 s18, s50, 1
    s_lshl_b32 s18, s18, 3
    s_add_u32 s17, s17, s18
    v_add_u32 v10, s17, v5
    s_lshl_b32 s17, s51, 11
    v_add_u32 v13, s17, v6
    s_lshr_b32 s17, s51, 1
    s_lshl_b32 s17, s17, 9
    s_and_b32 s18, s51, 1
    s_lshl_b32 s18, s18, 3
    s_add_u32 s17, s17, s18
    v_add_u32 v11, s17, v5
    s_lshr_b32 s49, s50, 2
    s_lshl_b32 s49, s49, 7
    s_and_b32 s17, s50, 3
    s_lshl_b32 s17, s17, 2
    s_add_u32 s49, s49, s17
    s_lshr_b32 s52, s51, 2
    s_lshl_b32 s52, s52, 7
    s_and_b32 s17, s51, 3
    s_lshl_b32 s17, s17, 2
    s_add_u32 s52, s52, s17
    s_sub_u32 s17, s52, s49
    v_lshrrev_b32 v185, 4, v0
    v_mul_lo_u32 v185, v185, s17
    s_add_u32 s49, s49, 3584
    s_mov_b32 s36, s63
    s_mov_b32 s34, s63
    s_mul_i32 s58, s14, 9216
    s_mul_i32 s64, s63, 2359296
    s_add_u32 s64, s64, s58
    s_add_u32 s64, s64, 17301504
    s_mul_i32 s61, s63, 1441792
    s_add_u32 s61, s61, 1536
    s_mov_b32 s37, 0
    s_mov_b32 s40, 36864
    s_mov_b32 s59, s58
    s_mov_b32 s43, 0
    s_mov_b32 s62, 1
    s_mov_b32 s28, s8
    s_mov_b32 s29, s9
    s_mov_b32 s30, 0
    s_mov_b32 s31, 0x00020000
    v_mov_b32 v184, 74752
    v_mov_b32 v5, -1
    ds_write_b32 v184, v5
    s_waitcnt lgkmcnt(0)
    s_cmp_lg_u32 s14, 0
    s_cbranch_scc1 Lawo_inia_d
    v_mov_b32 v5, 40
    s_mov_b32 s16, 0
Lawo_inia:
    global_load_dword v6, v5, s[12:13] sc1
    s_add_u32 s16, s16, 1
    s_cmp_gt_u32 s16, 100000
    s_cbranch_scc1 L_role_awo_abort
    s_waitcnt vmcnt(0)
    v_cmp_gt_u32 vcc, 72, v6
    s_nop 0
    s_cbranch_vccz Lawo_inia_d
    s_sleep 8
    s_branch Lawo_inia
Lawo_inia_d:
    s_barrier
    s_cmp_eq_u32 s63, 0
    s_cbranch_scc1 Lawo_ini_sk
    s_cmp_lg_u32 s14, 0
    s_cbranch_scc1 Lawo_inib_d
    v_mov_b32 v5, 160
    s_mov_b32 s16, 0
Lawo_inib:
    global_load_dword v6, v5, s[12:13] sc1
    s_add_u32 s16, s16, 1
    s_cmp_gt_u32 s16, 100000
    s_cbranch_scc1 L_role_awo_abort
    s_waitcnt vmcnt(0)
    v_cmp_gt_u32 vcc, 64, v6
    s_nop 0
    s_cbranch_vccz Lawo_inib_d
    s_sleep 8
    s_branch Lawo_inib
Lawo_inib_d:
    s_barrier
Lawo_ini_sk:
    s_mul_i32 s41, s37, 36864
    s_add_u32 s41, s41, s64
    s_mul_i32 s60, s37, 22528
    s_add_u32 s60, s60, s61
    s_cmp_lt_u32 s37, 64
    s_cselect_b32 s60, s60, 2883584
    s_branch Lawo_wait
Lawo_head:
    s_waitcnt vmcnt(6)
Lawo_head2:
    s_barrier
    ds_read_b32 v15, v184
    s_xor_b32 s40, s40, 36864
    s_xor_b32 s59, s59, 36864
    s_mov_b32 s35, s37
    s_lshl_b32 s57, s34, 6
    s_add_u32 s57, s57, s35
    s_add_u32 s37, s37, 1
    s_mov_b32 s39, 0
    s_mov_b32 s54, 0
    s_mul_i32 s41, s37, 36864
    s_add_u32 s41, s41, s64
    s_mul_i32 s60, s37, 22528
    s_add_u32 s60, s60, s61
    s_cmp_lt_u32 s37, 64
    s_cselect_b32 s60, s60, 2883584
    v_add_u32 v9, s40, v0
    ds_read_b128 v[48:51], v9 offset:0
    ds_read_b128 v[52:55], v9 offset:1024
    ds_read_b128 v[56:59], v9 offset:2048
    ds_read_b128 v[60:63], v9 offset:3072
    ds_read_b128 v[64:67], v9 offset:4096
    ds_read_b128 v[68:71], v9 offset:5120
    ds_read_b128 v[72:75], v9 offset:6144
    v_lshlrev_b32 v16, 16, v80
    v_and_b32 v17, 0xffff0000, v80
    v_lshlrev_b32 v18, 16, v81
    v_and_b32 v19, 0xffff0000, v81
    v_lshlrev_b32 v20, 16, v82
    v_and_b32 v21, 0xffff0000, v82
    v_lshlrev_b32 v22, 16, v83
    v_and_b32 v23, 0xffff0000, v83
    v_lshlrev_b32 v24, 16, v84
    v_and_b32 v25, 0xffff0000, v84
    v_lshlrev_b32 v26, 16, v85
    v_and_b32 v27, 0xffff0000, v85
    v_lshlrev_b32 v28, 16, v86
    v_and_b32 v29, 0xffff0000, v86
    v_lshlrev_b32 v30, 16, v87
    v_and_b32 v31, 0xffff0000, v87
    v_lshlrev_b32 v32, 16, v88
    v_and_b32 v33, 0xffff0000, v88
    v_lshlrev_b32 v34, 16, v89
    v_and_b32 v35, 0xffff0000, v89
    v_lshlrev_b32 v36, 16, v90
    v_and_b32 v37, 0xffff0000, v90
    v_lshlrev_b32 v38, 16, v91
    v_and_b32 v39, 0xffff0000, v91
    v_lshlrev_b32 v40, 16, v92
    v_and_b32 v41, 0xffff0000, v92
    v_lshlrev_b32 v42, 16, v93
    v_and_b32 v43, 0xffff0000, v93
    v_lshlrev_b32 v44, 16, v94
    v_and_b32 v45, 0xffff0000, v94
    v_lshlrev_b32 v46, 16, v95
    v_and_b32 v47, 0xffff0000, v95
    s_waitcnt lgkmcnt(6)
    v_mfma_f32_32x32x16_bf16 v[16:31], a[0:3], v[48:51], v[16:31]
    ds_read_b128 v[76:79], v9 offset:7168
    v_mfma_f32_32x32x16_bf16 v[32:47], a[144:147], v[48:51], v[32:47]
    s_mul_i32 s46, s34, 4718592
    s_mul_i32 s51, s35, 36864
    s_add_u32 s46, s46, s51
    s_waitcnt lgkmcnt(6)
    v_mfma_f32_32x32x16_bf16 v[16:31], a[4:7], v[52:55], v[16:31]
    ds_read_b128 v[48:51], v9 offset:8192
    v_mfma_f32_32x32x16_bf16 v[32:47], a[148:151], v[52:55], v[32:47]
    s_add_u32 s46, s46, 8650752
    s_mul_i32 s52, s34, 786432
    s_mul_i32 s51, s35, 6144
    v_readfirstlane_b32 s17, v15
    s_nop 0
    s_add_u32 s18, s17, 1
    s_max_i32 s32, s18, s37
    s_add_u32 s39, s37, 1
    s_min_u32 s39, s39, 63
    s_mul_i32 s33, s32, 22528
    s_add_u32 s33, s33, s61
    s_cmp_eq_u32 s14, 0
    s_cselect_b32 s18, s32, 0x7fff
    v_mov_b32 v2, 2
    s_cmp_le_u32 s18, s39
    s_cselect_b64 exec, -1, 0
    buffer_load_dword v2, v1, s[8:11], s33 offen sc1
    s_mov_b64 exec, -1
    s_cmp_ge_i32 s17, s37
    s_cbranch_scc1 Lawo_f_5
    s_waitcnt lgkmcnt(6)
    v_mfma_f32_32x32x16_bf16 v[16:31], a[8:11], v[56:59], v[16:31]
    ds_read_b128 v[52:55], v9 offset:9216
    v_mfma_f32_32x32x16_bf16 v[32:47], a[152:155], v[56:59], v[32:47]
    s_add_u32 s52, s52, s51
    s_add_u32 s52, s52, 16121856
    s_waitcnt lgkmcnt(6)
    v_mfma_f32_32x32x16_bf16 v[16:31], a[12:15], v[60:63], v[16:31]
    ds_read_b128 v[56:59], v9 offset:10240
    v_mfma_f32_32x32x16_bf16 v[32:47], a[156:159], v[60:63], v[32:47]
    s_waitcnt lgkmcnt(6)
    v_mfma_f32_32x32x16_bf16 v[16:31], a[16:19], v[64:67], v[16:31]
    ds_read_b128 v[60:63], v9 offset:11264
    v_mfma_f32_32x32x16_bf16 v[32:47], a[160:163], v[64:67], v[32:47]
    s_waitcnt lgkmcnt(6)
    v_mfma_f32_32x32x16_bf16 v[16:31], a[20:23], v[68:71], v[16:31]
    ds_read_b128 v[64:67], v9 offset:12288
    v_mfma_f32_32x32x16_bf16 v[32:47], a[164:167], v[68:71], v[32:47]
    s_waitcnt lgkmcnt(6)
    v_mfma_f32_32x32x16_bf16 v[16:31], a[24:27], v[72:75], v[16:31]
    ds_read_b128 v[68:71], v9 offset:13312
    v_mfma_f32_32x32x16_bf16 v[32:47], a[168:171], v[72:75], v[32:47]
    s_waitcnt lgkmcnt(6)
    v_mfma_f32_32x32x16_bf16 v[16:31], a[28:31], v[76:79], v[16:31]
    ds_read_b128 v[72:75], v9 offset:14336
    v_mfma_f32_32x32x16_bf16 v[32:47], a[172:175], v[76:79], v[32:47]
    s_waitcnt lgkmcnt(6)
    v_mfma_f32_32x32x16_bf16 v[16:31], a[32:35], v[48:51], v[16:31]
    ds_read_b128 v[76:79], v9 offset:15360
    v_mfma_f32_32x32x16_bf16 v[32:47], a[176:179], v[48:51], v[32:47]
    s_waitcnt lgkmcnt(6)
    v_mfma_f32_32x32x16_bf16 v[16:31], a[36:39], v[52:55], v[16:31]
    ds_read_b128 v[48:51], v9 offset:16384
    v_mfma_f32_32x32x16_bf16 v[32:47], a[180:183], v[52:55], v[32:47]
    s_waitcnt lgkmcnt(6)
    v_mfma_f32_32x32x16_bf16 v[16:31], a[40:43], v[56:59], v[16:31]
    ds_read_b128 v[52:55], v9 offset:17408
    v_mfma_f32_32x32x16_bf16 v[32:47], a[184:187], v[56:59], v[32:47]
    s_waitcnt lgkmcnt(6)
    v_mfma_f32_32x32x16_bf16 v[16:31], a[44:47], v[60:63], v[16:31]
    ds_read_b128 v[56:59], v9 offset:18432
    v_mfma_f32_32x32x16_bf16 v[32:47], a[188:191], v[60:63], v[32:47]
    s_waitcnt lgkmcnt(6)
    v_mfma_f32_32x32x16_bf16 v[16:31], a[48:51], v[64:67], v[16:31]
    ds_read_b128 v[60:63], v9 offset:19456
    v_mfma_f32_32x32x16_bf16 v[32:47], a[192:195], v[64:67], v[32:47]
    s_waitcnt vmcnt(1)
    s_cmp_lg_u32 s43, 0
    s_cselect_b64 exec, 3, 0
    buffer_store_dword v3, v185, s[8:11], s43 offen sc1
    s_mov_b64 exec, -1
    s_mov_b32 s43, 0
    s_waitcnt lgkmcnt(6)
    v_mfma_f32_32x32x16_bf16 v[16:31], a[52:55], v[68:71], v[16:31]
    ds_read_b128 v[64:67], v9 offset:20480
    v_mfma_f32_32x32x16_bf16 v[32:47], a[196:199], v[68:71], v[32:47]
    s_waitcnt lgkmcnt(6)
    v_mfma_f32_32x32x16_bf16 v[16:31], a[56:59], v[72:75], v[16:31]
    v_cmp_eq_u32 s[76:77], 1, v2
    v_cmp_eq_u32 vcc, 2, v2
    s_cmp_eq_u64 s[76:77], -1
    s_cselect_b32 s38, 1, 0
    ds_read_b128 v[68:71], v9 offset:21504
    v_mfma_f32_32x32x16_bf16 v[32:47], a[200:203], v[72:75], v[32:47]
    s_cmp_lg_u32 s38, 0
    s_cselect_b64 exec, 1, 0
    v_mov_b32 v15, s32
    ds_write_b32 v184, v15
    v_mov_b32 v2, 2
    s_mov_b64 exec, -1
    s_waitcnt lgkmcnt(7)
    v_mfma_f32_32x32x16_bf16 v[16:31], a[60:63], v[76:79], v[16:31]
    s_add_u32 s32, s32, s38
    s_mul_i32 s38, s38, 22528
    s_add_u32 s33, s33, s38
    ds_read_b128 v[72:75], v9 offset:22528
    v_mfma_f32_32x32x16_bf16 v[32:47], a[204:207], v[76:79], v[32:47]
    s_cmp_eq_u64 vcc, 0
    s_cselect_b32 s38, s32, 0x7fff
    s_waitcnt lgkmcnt(7)
    v_mfma_f32_32x32x16_bf16 v[16:31], a[64:67], v[48:51], v[16:31]
    ds_read_b128 v[76:79], v9 offset:23552
    v_mfma_f32_32x32x16_bf16 v[32:47], a[208:211], v[48:51], v[32:47]
    s_cmp_le_u32 s38, s39
    s_cselect_b64 exec, -1, 0
    v_mov_b32 v2, 2
    buffer_load_dword v2, v1, s[8:11], s33 offen sc1
    s_mov_b64 exec, -1
    ds_read_b32 v15, v184
    s_waitcnt lgkmcnt(8)
    v_mfma_f32_32x32x16_bf16 v[16:31], a[68:71], v[52:55], v[16:31]
    ds_read_b128 v[48:51], v9 offset:24576
    v_mfma_f32_32x32x16_bf16 v[32:47], a[212:215], v[52:55], v[32:47]
    s_waitcnt lgkmcnt(8)
    v_mfma_f32_32x32x16_bf16 v[16:31], a[72:75], v[56:59], v[16:31]
    ds_read_b128 v[52:55], v9 offset:25600
    v_mfma_f32_32x32x16_bf16 v[32:47], a[216:219], v[56:59], v[32:47]
    s_waitcnt lgkmcnt(2)
    v_readfirstlane_b32 s17, v15
    s_nop 0
    s_cmp_ge_i32 s17, s37
    s_cbranch_scc1 Lawo_f_6
    v_mfma_f32_32x32x16_bf16 v[16:31], a[76:79], v[60:63], v[16:31]
    ds_read_b128 v[56:59], v9 offset:26624
    v_mfma_f32_32x32x16_bf16 v[32:47], a[220:223], v[60:63], v[32:47]
    v_mfma_f32_32x32x16_bf16 v[16:31], a[80:83], v[64:67], v[16:31]
    ds_read_b128 v[60:63], v9 offset:27648
    v_mfma_f32_32x32x16_bf16 v[32:47], a[224:227], v[64:67], v[32:47]
    v_mfma_f32_32x32x16_bf16 v[16:31], a[84:87], v[68:71], v[16:31]
    ds_read_b128 v[64:67], v9 offset:28672
    v_mfma_f32_32x32x16_bf16 v[32:47], a[228:231], v[68:71], v[32:47]
    v_mfma_f32_32x32x16_bf16 v[16:31], a[88:91], v[72:75], v[16:31]
    ds_read_b128 v[68:71], v9 offset:29696
    v_mfma_f32_32x32x16_bf16 v[32:47], a[232:235], v[72:75], v[32:47]
    v_mfma_f32_32x32x16_bf16 v[16:31], a[92:95], v[76:79], v[16:31]
    ds_read_b128 v[72:75], v9 offset:30720
    v_mfma_f32_32x32x16_bf16 v[32:47], a[236:239], v[76:79], v[32:47]
    s_waitcnt lgkmcnt(6)
    v_mfma_f32_32x32x16_bf16 v[16:31], a[96:99], v[48:51], v[16:31]
    ds_read_b128 v[76:79], v9 offset:31744
    v_mfma_f32_32x32x16_bf16 v[32:47], a[240:243], v[48:51], v[32:47]
    s_waitcnt lgkmcnt(6)
    v_mfma_f32_32x32x16_bf16 v[16:31], a[100:103], v[52:55], v[16:31]
    ds_read_b128 v[48:51], v9 offset:32768
    v_mfma_f32_32x32x16_bf16 v[32:47], a[244:247], v[52:55], v[32:47]
    s_waitcnt lgkmcnt(6)
    v_mfma_f32_32x32x16_bf16 v[16:31], a[104:107], v[56:59], v[16:31]
    ds_read_b128 v[52:55], v9 offset:33792
    v_mfma_f32_32x32x16_bf16 v[32:47], a[248:251], v[56:59], v[32:47]
    s_waitcnt lgkmcnt(6)
    v_mfma_f32_32x32x16_bf16 v[16:31], a[108:111], v[60:63], v[16:31]
    ds_read_b128 v[56:59], v9 offset:34816
    v_mfma_f32_32x32x16_bf16 v[32:47], a[252:255], v[60:63], v[32:47]
    s_waitcnt lgkmcnt(6)
    v_mfma_f32_32x32x16_bf16 v[16:31], a[112:115], v[64:67], v[16:31]
    ds_read_b128 v[60:63], v9 offset:35840
    v_mfma_f32_32x32x16_bf16 v[32:47], v[152:155], v[64:67], v[32:47]
    s_waitcnt lgkmcnt(6)
    v_mfma_f32_32x32x16_bf16 v[16:31], a[116:119], v[68:71], v[16:31]
    v_mfma_f32_32x32x16_bf16 v[32:47], v[156:159], v[68:71], v[32:47]
    s_waitcnt lgkmcnt(5)
    v_mfma_f32_32x32x16_bf16 v[16:31], a[120:123], v[72:75], v[16:31]
    v_mfma_f32_32x32x16_bf16 v[32:47], v[160:163], v[72:75], v[32:47]
    s_waitcnt lgkmcnt(4)
    v_mfma_f32_32x32x16_bf16 v[16:31], a[124:127], v[76:79], v[16:31]
    v_cmp_eq_u32 s[76:77], 1, v2
    v_cmp_eq_u32 vcc, 2, v2
    s_cmp_eq_u64 s[76:77], -1
    s_cselect_b32 s38, 1, 0
    v_mfma_f32_32x32x16_bf16 v[32:47], v[164:167], v[76:79], v[32:47]
    s_cmp_lg_u32 s38, 0
    s_cselect_b64 exec, 1, 0
    v_mov_b32 v15, s32
    ds_write_b32 v184, v15
    v_mov_b32 v2, 2
    s_mov_b64 exec, -1
    s_waitcnt lgkmcnt(4)
    v_mfma_f32_32x32x16_bf16 v[16:31], a[128:131], v[48:51], v[16:31]
    s_add_u32 s32, s32, s38
    s_mul_i32 s38, s38, 22528
    s_add_u32 s33, s33, s38
    s_cmp_eq_u64 vcc, 0
    s_cselect_b32 s38, s32, 0x7fff
    v_mfma_f32_32x32x16_bf16 v[32:47], v[168:171], v[48:51], v[32:47]
    s_cmp_le_u32 s38, s39
    s_cselect_b64 exec, -1, 0
    v_mov_b32 v2, 2
    buffer_load_dword v2, v1, s[8:11], s33 offen sc1
    s_mov_b64 exec, -1
    s_waitcnt lgkmcnt(3)
    v_mfma_f32_32x32x16_bf16 v[16:31], a[132:135], v[52:55], v[16:31]
    v_mfma_f32_32x32x16_bf16 v[32:47], v[172:175], v[52:55], v[32:47]
    s_waitcnt lgkmcnt(2)
    v_mfma_f32_32x32x16_bf16 v[16:31], a[136:139], v[56:59], v[16:31]
    v_mfma_f32_32x32x16_bf16 v[32:47], v[176:179], v[56:59], v[32:47]
    s_waitcnt lgkmcnt(1)
    v_mfma_f32_32x32x16_bf16 v[16:31], a[140:143], v[60:63], v[16:31]
    v_mfma_f32_32x32x16_bf16 v[32:47], v[180:183], v[60:63], v[32:47]
    s_nop 3
    v_cvt_pk_bf16_f32 v108, v16, v17
    v_cvt_pk_bf16_f32 v109, v18, v19
    v_cvt_pk_bf16_f32 v110, v20, v21
    v_cvt_pk_bf16_f32 v111, v22, v23
    buffer_store_dwordx4 v[108:111], v12, s[8:11], s46 offen offset:0 sc1
    v_cvt_pk_bf16_f32 v112, v24, v25
    v_cvt_pk_bf16_f32 v113, v26, v27
    v_cvt_pk_bf16_f32 v114, v28, v29
    v_cvt_pk_bf16_f32 v115, v30, v31
    buffer_store_dwordx4 v[112:115], v12, s[8:11], s46 offen offset:1024 sc1
    v_cvt_pk_bf16_f32 v116, v32, v33
    v_cvt_pk_bf16_f32 v117, v34, v35
    v_cvt_pk_bf16_f32 v118, v36, v37
    v_cvt_pk_bf16_f32 v119, v38, v39
    buffer_store_dwordx4 v[116:119], v13, s[8:11], s46 offen offset:0 sc1
    v_cvt_pk_bf16_f32 v120, v40, v41
    v_cvt_pk_bf16_f32 v121, v42, v43
    v_cvt_pk_bf16_f32 v122, v44, v45
    v_cvt_pk_bf16_f32 v123, v46, v47
    buffer_store_dwordx4 v[120:123], v13, s[8:11], s46 offen offset:1024 sc1
    v_mov_b32 v104, 0x3f803f80
    v_mov_b32 v96, 0
    v_mov_b32 v97, 0
    v_mov_b32 v100, 0
    v_mov_b32 v101, 0
    v_dot2c_f32_bf16 v96, v108, v104
    v_dot2c_f32_bf16 v97, v108, v108
    v_dot2c_f32_bf16 v100, v116, v104
    v_dot2c_f32_bf16 v101, v116, v116
    v_dot2c_f32_bf16 v96, v109, v104
    v_dot2c_f32_bf16 v97, v109, v109
    v_dot2c_f32_bf16 v100, v117, v104
    v_dot2c_f32_bf16 v101, v117, v117
    v_dot2c_f32_bf16 v96, v110, v104
    v_dot2c_f32_bf16 v97, v110, v110
    v_dot2c_f32_bf16 v100, v118, v104
    v_dot2c_f32_bf16 v101, v118, v118
    v_dot2c_f32_bf16 v96, v111, v104
    v_dot2c_f32_bf16 v97, v111, v111
    v_dot2c_f32_bf16 v100, v119, v104
    v_dot2c_f32_bf16 v101, v119, v119
    v_dot2c_f32_bf16 v96, v112, v104
    v_dot2c_f32_bf16 v97, v112, v112
    v_dot2c_f32_bf16 v100, v120, v104
    v_dot2c_f32_bf16 v101, v120, v120
    v_dot2c_f32_bf16 v96, v113, v104
    v_dot2c_f32_bf16 v97, v113, v113
    v_dot2c_f32_bf16 v100, v121, v104
    v_dot2c_f32_bf16 v101, v121, v121
    v_dot2c_f32_bf16 v96, v114, v104
    v_dot2c_f32_bf16 v97, v114, v114
    v_dot2c_f32_bf16 v100, v122, v104
    v_dot2c_f32_bf16 v101, v122, v122
    v_dot2c_f32_bf16 v96, v115, v104
    v_dot2c_f32_bf16 v97, v115, v115
    v_dot2c_f32_bf16 v100, v123, v104
    v_dot2c_f32_bf16 v101, v123, v123
    s_nop 2
    v_mov_b32 v98, v96
    v_mov_b32 v99, v97
    v_mov_b32 v102, v100
    v_mov_b32 v103, v101
    v_permlane32_swap_b32 v96, v98
    v_permlane32_swap_b32 v97, v99
    v_permlane32_swap_b32 v100, v102
    v_permlane32_swap_b32 v101, v103
    v_add_f32 v96, v96, v98
    v_add_f32 v97, v97, v99
    buffer_store_dwordx2 v[96:97], v10, s[8:11], s52 offen sc1
    v_add_f32 v100, v100, v102
    v_add_f32 v101, v101, v103
    buffer_store_dwordx2 v[100:101], v11, s[8:11], s52 offen sc1
    s_mul_i32 s43, s57, 22528
    s_add_u32 s43, s43, s49
    s_branch Lawo_none
Lawo_f_5:
    s_waitcnt lgkmcnt(6)
    v_mfma_f32_32x32x16_bf16 v[16:31], a[8:11], v[56:59], v[16:31]
    s_add_u32 m0, s59, 0
    s_add_u32 s47, s41, 0
    buffer_load_dwordx4 v0, s[8:11], s47 offen offset:0 lds
    ds_read_b128 v[52:55], v9 offset:9216
    v_mfma_f32_32x32x16_bf16 v[32:47], a[152:155], v[56:59], v[32:47]
    s_add_u32 s52, s52, s51
    s_add_u32 s52, s52, 16121856
    s_waitcnt lgkmcnt(6)
    v_mfma_f32_32x32x16_bf16 v[16:31], a[12:15], v[60:63], v[16:31]
    buffer_load_dwordx4 v0, s[8:11], s47 offen offset:1024 lds
    ds_read_b128 v[56:59], v9 offset:10240
    v_mfma_f32_32x32x16_bf16 v[32:47], a[156:159], v[60:63], v[32:47]
    s_waitcnt lgkmcnt(6)
    v_mfma_f32_32x32x16_bf16 v[16:31], a[16:19], v[64:67], v[16:31]
    buffer_load_dwordx4 v0, s[8:11], s47 offen offset:2048 lds
    ds_read_b128 v[60:63], v9 offset:11264
    v_mfma_f32_32x32x16_bf16 v[32:47], a[160:163], v[64:67], v[32:47]
    s_waitcnt lgkmcnt(6)
    v_mfma_f32_32x32x16_bf16 v[16:31], a[20:23], v[68:71], v[16:31]
    buffer_load_dwordx4 v0, s[8:11], s47 offen offset:3072 lds
    ds_read_b128 v[64:67], v9 offset:12288
    v_mfma_f32_32x32x16_bf16 v[32:47], a[164:167], v[68:71], v[32:47]
    s_waitcnt lgkmcnt(6)
    v_mfma_f32_32x32x16_bf16 v[16:31], a[24:27], v[72:75], v[16:31]
    s_add_u32 m0, s59, 4096
    s_add_u32 s47, s41, 4096
    buffer_load_dwordx4 v0, s[8:11], s47 offen offset:0 lds
    ds_read_b128 v[68:71], v9 offset:13312
    v_mfma_f32_32x32x16_bf16 v[32:47], a[168:171], v[72:75], v[32:47]
    s_waitcnt lgkmcnt(6)
    v_mfma_f32_32x32x16_bf16 v[16:31], a[28:31], v[76:79], v[16:31]
    buffer_load_dwordx4 v0, s[8:11], s47 offen offset:1024 lds
    ds_read_b128 v[72:75], v9 offset:14336
    v_mfma_f32_32x32x16_bf16 v[32:47], a[172:175], v[76:79], v[32:47]
    s_waitcnt lgkmcnt(6)
    v_mfma_f32_32x32x16_bf16 v[16:31], a[32:35], v[48:51], v[16:31]
    buffer_load_dwordx4 v0, s[8:11], s47 offen offset:2048 lds
    ds_read_b128 v[76:79], v9 offset:15360
    v_mfma_f32_32x32x16_bf16 v[32:47], a[176:179], v[48:51], v[32:47]
    s_waitcnt lgkmcnt(6)
    v_mfma_f32_32x32x16_bf16 v[16:31], a[36:39], v[52:55], v[16:31]
    buffer_load_dwordx4 v0, s[8:11], s47 offen offset:3072 lds
    ds_read_b128 v[48:51], v9 offset:16384
    v_mfma_f32_32x32x16_bf16 v[32:47], a[180:183], v[52:55], v[32:47]
    s_waitcnt lgkmcnt(6)
    v_mfma_f32_32x32x16_bf16 v[16:31], a[40:43], v[56:59], v[16:31]
    s_add_u32 m0, s59, 8192
    s_add_u32 s47, s41, 8192
    buffer_load_dwordx4 v0, s[8:11], s47 offen offset:0 lds
    ds_read_b128 v[52:55], v9 offset:17408
    v_mfma_f32_32x32x16_bf16 v[32:47], a[184:187], v[56:59], v[32:47]
    s_waitcnt lgkmcnt(6)
    v_mfma_f32_32x32x16_bf16 v[16:31], a[44:47], v[60:63], v[16:31]
    ds_read_b128 v[56:59], v9 offset:18432
    v_mfma_f32_32x32x16_bf16 v[32:47], a[188:191], v[60:63], v[32:47]
    s_mul_i32 s48, s36, 4718592
    s_mul_i32 s18, s37, 36864
    s_add_u32 s48, s48, s18
    s_add_u32 s48, s48, 6291456
    buffer_load_dwordx4 v[80:83], v12, s[8:11], s48 offen offset:0
    s_waitcnt lgkmcnt(6)
    v_mfma_f32_32x32x16_bf16 v[16:31], a[48:51], v[64:67], v[16:31]
    buffer_load_dwordx4 v[84:87], v12, s[8:11], s48 offen offset:1024
    ds_read_b128 v[60:63], v9 offset:19456
    v_mfma_f32_32x32x16_bf16 v[32:47], a[192:195], v[64:67], v[32:47]
    s_waitcnt vmcnt(12)
    s_cmp_lg_u32 s43, 0
    s_cselect_b64 exec, 3, 0
    buffer_store_dword v3, v185, s[8:11], s43 offen sc1
    s_mov_b64 exec, -1
    s_mov_b32 s43, 0
    s_waitcnt lgkmcnt(6)
    v_mfma_f32_32x32x16_bf16 v[16:31], a[52:55], v[68:71], v[16:31]
    buffer_load_dwordx4 v[88:91], v13, s[8:11], s48 offen offset:0
    ds_read_b128 v[64:67], v9 offset:20480
    v_mfma_f32_32x32x16_bf16 v[32:47], a[196:199], v[68:71], v[32:47]
    s_waitcnt lgkmcnt(6)
    v_mfma_f32_32x32x16_bf16 v[16:31], a[56:59], v[72:75], v[16:31]
    buffer_load_dwordx4 v[92:95], v13, s[8:11], s48 offen offset:1024
    v_cmp_eq_u32 s[76:77], 1, v2
    v_cmp_eq_u32 vcc, 2, v2
    ds_read_b128 v[68:71], v9 offset:21504
    v_mfma_f32_32x32x16_bf16 v[32:47], a[200:203], v[72:75], v[32:47]
    s_cmp_eq_u64 s[76:77], -1
    s_cselect_b32 s38, 1, 0
    s_waitcnt lgkmcnt(6)
    v_mfma_f32_32x32x16_bf16 v[16:31], a[60:63], v[76:79], v[16:31]
    s_cmp_lg_u32 s38, 0
    s_cselect_b64 exec, 1, 0
    v_mov_b32 v15, s32
    ds_write_b32 v184, v15
    v_mov_b32 v2, 2
    s_mov_b64 exec, -1
    ds_read_b128 v[72:75], v9 offset:22528
    v_mfma_f32_32x32x16_bf16 v[32:47], a[204:207], v[76:79], v[32:47]
    s_add_u32 s32, s32, s38
    s_mul_i32 s38, s38, 22528
    s_add_u32 s33, s33, s38
    s_cmp_eq_u64 vcc, 0
    s_cselect_b32 s38, s32, 0x7fff
    s_waitcnt lgkmcnt(7)
    v_mfma_f32_32x32x16_bf16 v[16:31], a[64:67], v[48:51], v[16:31]
    ds_read_b128 v[76:79], v9 offset:23552
    v_mfma_f32_32x32x16_bf16 v[32:47], a[208:211], v[48:51], v[32:47]
    s_cmp_le_u32 s38, s39
    s_cselect_b64 exec, -1, 0
    v_mov_b32 v2, 2
    buffer_load_dword v2, v1, s[8:11], s33 offen sc1
    s_mov_b64 exec, -1
    s_waitcnt lgkmcnt(7)
    v_mfma_f32_32x32x16_bf16 v[16:31], a[68:71], v[52:55], v[16:31]
    ds_read_b128 v[48:51], v9 offset:24576
    v_mfma_f32_32x32x16_bf16 v[32:47], a[212:215], v[52:55], v[32:47]
    s_waitcnt lgkmcnt(7)
    v_mfma_f32_32x32x16_bf16 v[16:31], a[72:75], v[56:59], v[16:31]
    ds_read_b128 v[52:55], v9 offset:25600
    v_mfma_f32_32x32x16_bf16 v[32:47], a[216:219], v[56:59], v[32:47]
    s_waitcnt lgkmcnt(7)
    v_mfma_f32_32x32x16_bf16 v[16:31], a[76:79], v[60:63], v[16:31]
    ds_read_b128 v[56:59], v9 offset:26624
    v_mfma_f32_32x32x16_bf16 v[32:47], a[220:223], v[60:63], v[32:47]
    s_waitcnt lgkmcnt(7)
    v_mfma_f32_32x32x16_bf16 v[16:31], a[80:83], v[64:67], v[16:31]
    ds_read_b128 v[60:63], v9 offset:27648
    v_mfma_f32_32x32x16_bf16 v[32:47], a[224:227], v[64:67], v[32:47]
    s_waitcnt lgkmcnt(7)
    v_mfma_f32_32x32x16_bf16 v[16:31], a[84:87], v[68:71], v[16:31]
    ds_read_b128 v[64:67], v9 offset:28672
    v_mfma_f32_32x32x16_bf16 v[32:47], a[228:231], v[68:71], v[32:47]
    s_waitcnt lgkmcnt(6)
    v_mfma_f32_32x32x16_bf16 v[16:31], a[88:91], v[72:75], v[16:31]
    ds_read_b128 v[68:71], v9 offset:29696
    v_mfma_f32_32x32x16_bf16 v[32:47], a[232:235], v[72:75], v[32:47]
    s_waitcnt lgkmcnt(6)
    v_mfma_f32_32x32x16_bf16 v[16:31], a[92:95], v[76:79], v[16:31]
    ds_read_b128 v[72:75], v9 offset:30720
    v_mfma_f32_32x32x16_bf16 v[32:47], a[236:239], v[76:79], v[32:47]
    s_waitcnt lgkmcnt(6)
    v_mfma_f32_32x32x16_bf16 v[16:31], a[96:99], v[48:51], v[16:31]
    ds_read_b128 v[76:79], v9 offset:31744
    v_mfma_f32_32x32x16_bf16 v[32:47], a[240:243], v[48:51], v[32:47]
    s_waitcnt lgkmcnt(6)
    v_mfma_f32_32x32x16_bf16 v[16:31], a[100:103], v[52:55], v[16:31]
    ds_read_b128 v[48:51], v9 offset:32768
    v_mfma_f32_32x32x16_bf16 v[32:47], a[244:247], v[52:55], v[32:47]
    s_waitcnt lgkmcnt(6)
    v_mfma_f32_32x32x16_bf16 v[16:31], a[104:107], v[56:59], v[16:31]
    ds_read_b128 v[52:55], v9 offset:33792
    v_mfma_f32_32x32x16_bf16 v[32:47], a[248:251], v[56:59], v[32:47]
    s_waitcnt lgkmcnt(6)
    v_mfma_f32_32x32x16_bf16 v[16:31], a[108:111], v[60:63], v[16:31]
    ds_read_b128 v[56:59], v9 offset:34816
    v_mfma_f32_32x32x16_bf16 v[32:47], a[252:255], v[60:63], v[32:47]
    s_waitcnt lgkmcnt(6)
    v_mfma_f32_32x32x16_bf16 v[16:31], a[112:115], v[64:67], v[16:31]
    ds_read_b128 v[60:63], v9 offset:35840
    v_mfma_f32_32x32x16_bf16 v[32:47], v[152:155], v[64:67], v[32:47]
    s_waitcnt lgkmcnt(6)
    v_mfma_f32_32x32x16_bf16 v[16:31], a[116:119], v[68:71], v[16:31]
    v_mfma_f32_32x32x16_bf16 v[32:47], v[156:159], v[68:71], v[32:47]
    s_waitcnt lgkmcnt(5)
    v_mfma_f32_32x32x16_bf16 v[16:31], a[120:123], v[72:75], v[16:31]
    v_mfma_f32_32x32x16_bf16 v[32:47], v[160:163], v[72:75], v[32:47]
    s_waitcnt lgkmcnt(4)
    v_mfma_f32_32x32x16_bf16 v[16:31], a[124:127], v[76:79], v[16:31]
    v_cmp_eq_u32 s[76:77], 1, v2
    v_cmp_eq_u32 vcc, 2, v2
    s_cmp_eq_u64 s[76:77], -1
    s_cselect_b32 s38, 1, 0
    v_mfma_f32_32x32x16_bf16 v[32:47], v[164:167], v[76:79], v[32:47]
    s_cmp_lg_u32 s38, 0
    s_cselect_b64 exec, 1, 0
    v_mov_b32 v15, s32
    ds_write_b32 v184, v15
    v_mov_b32 v2, 2
    s_mov_b64 exec, -1
    s_waitcnt lgkmcnt(4)
    v_mfma_f32_32x32x16_bf16 v[16:31], a[128:131], v[48:51], v[16:31]
    s_add_u32 s32, s32, s38
    s_mul_i32 s38, s38, 22528
    s_add_u32 s33, s33, s38
    s_cmp_eq_u64 vcc, 0
    s_cselect_b32 s38, s32, 0x7fff
    v_mfma_f32_32x32x16_bf16 v[32:47], v[168:171], v[48:51], v[32:47]
    s_cmp_le_u32 s38, s39
    s_cselect_b64 exec, -1, 0
    v_mov_b32 v2, 2
    buffer_load_dword v2, v1, s[8:11], s33 offen sc1
    s_mov_b64 exec, -1
    s_waitcnt lgkmcnt(3)
    v_mfma_f32_32x32x16_bf16 v[16:31], a[132:135], v[52:55], v[16:31]
    v_mfma_f32_32x32x16_bf16 v[32:47], v[172:175], v[52:55], v[32:47]
    s_waitcnt lgkmcnt(2)
    v_mfma_f32_32x32x16_bf16 v[16:31], a[136:139], v[56:59], v[16:31]
    v_mfma_f32_32x32x16_bf16 v[32:47], v[176:179], v[56:59], v[32:47]
    s_waitcnt lgkmcnt(1)
    v_mfma_f32_32x32x16_bf16 v[16:31], a[140:143], v[60:63], v[16:31]
    v_mfma_f32_32x32x16_bf16 v[32:47], v[180:183], v[60:63], v[32:47]
    s_nop 3
    v_cvt_pk_bf16_f32 v108, v16, v17
    v_cvt_pk_bf16_f32 v109, v18, v19
    v_cvt_pk_bf16_f32 v110, v20, v21
    v_cvt_pk_bf16_f32 v111, v22, v23
    buffer_store_dwordx4 v[108:111], v12, s[8:11], s46 offen offset:0 sc1
    v_cvt_pk_bf16_f32 v112, v24, v25
    v_cvt_pk_bf16_f32 v113, v26, v27
    v_cvt_pk_bf16_f32 v114, v28, v29
    v_cvt_pk_bf16_f32 v115, v30, v31
    buffer_store_dwordx4 v[112:115], v12, s[8:11], s46 offen offset:1024 sc1
    v_cvt_pk_bf16_f32 v116, v32, v33
    v_cvt_pk_bf16_f32 v117, v34, v35
    v_cvt_pk_bf16_f32 v118, v36, v37
    v_cvt_pk_bf16_f32 v119, v38, v39
    buffer_store_dwordx4 v[116:119], v13, s[8:11], s46 offen offset:0 sc1
    v_cvt_pk_bf16_f32 v120, v40, v41
    v_cvt_pk_bf16_f32 v121, v42, v43
    v_cvt_pk_bf16_f32 v122, v44, v45
    v_cvt_pk_bf16_f32 v123, v46, v47
    buffer_store_dwordx4 v[120:123], v13, s[8:11], s46 offen offset:1024 sc1
    v_mov_b32 v104, 0x3f803f80
    v_mov_b32 v96, 0
    v_mov_b32 v97, 0
    v_mov_b32 v100, 0
    v_mov_b32 v101, 0
    v_dot2c_f32_bf16 v96, v108, v104
    v_dot2c_f32_bf16 v97, v108, v108
    v_dot2c_f32_bf16 v100, v116, v104
    v_dot2c_f32_bf16 v101, v116, v116
    v_dot2c_f32_bf16 v96, v109, v104
    v_dot2c_f32_bf16 v97, v109, v109
    v_dot2c_f32_bf16 v100, v117, v104
    v_dot2c_f32_bf16 v101, v117, v117
    v_dot2c_f32_bf16 v96, v110, v104
    v_dot2c_f32_bf16 v97, v110, v110
    v_dot2c_f32_bf16 v100, v118, v104
    v_dot2c_f32_bf16 v101, v118, v118
    v_dot2c_f32_bf16 v96, v111, v104
    v_dot2c_f32_bf16 v97, v111, v111
    v_dot2c_f32_bf16 v100, v119, v104
    v_dot2c_f32_bf16 v101, v119, v119
    v_dot2c_f32_bf16 v96, v112, v104
    v_dot2c_f32_bf16 v97, v112, v112
    v_dot2c_f32_bf16 v100, v120, v104
    v_dot2c_f32_bf16 v101, v120, v120
    v_dot2c_f32_bf16 v96, v113, v104
    v_dot2c_f32_bf16 v97, v113, v113
    v_dot2c_f32_bf16 v100, v121, v104
    v_dot2c_f32_bf16 v101, v121, v121
    v_dot2c_f32_bf16 v96, v114, v104
    v_dot2c_f32_bf16 v97, v114, v114
    v_dot2c_f32_bf16 v100, v122, v104
    v_dot2c_f32_bf16 v101, v122, v122
    v_dot2c_f32_bf16 v96, v115, v104
    v_dot2c_f32_bf16 v97, v115, v115
    v_dot2c_f32_bf16 v100, v123, v104
    v_dot2c_f32_bf16 v101, v123, v123
    s_nop 2
    v_mov_b32 v98, v96
    v_mov_b32 v99, v97
    v_mov_b32 v102, v100
    v_mov_b32 v103, v101
    v_permlane32_swap_b32 v96, v98
    v_permlane32_swap_b32 v97, v99
    v_permlane32_swap_b32 v100, v102
    v_permlane32_swap_b32 v101, v103
    v_add_f32 v96, v96, v98
    v_add_f32 v97, v97, v99
    buffer_store_dwordx2 v[96:97], v10, s[8:11], s52 offen sc1
    v_add_f32 v100, v100, v102
    v_add_f32 v101, v101, v103
    buffer_store_dwordx2 v[100:101], v11, s[8:11], s52 offen sc1
    s_mul_i32 s43, s57, 22528
    s_add_u32 s43, s43, s49
    s_branch Lawo_head
Lawo_f_6:
    v_mfma_f32_32x32x16_bf16 v[16:31], a[76:79], v[60:63], v[16:31]
    s_add_u32 m0, s59, 0
    s_add_u32 s47, s41, 0
    buffer_load_dwordx4 v0, s[8:11], s47 offen offset:0 lds
    ds_read_b128 v[56:59], v9 offset:26624
    v_mfma_f32_32x32x16_bf16 v[32:47], a[220:223], v[60:63], v[32:47]
    v_mfma_f32_32x32x16_bf16 v[16:31], a[80:83], v[64:67], v[16:31]
    buffer_load_dwordx4 v0, s[8:11], s47 offen offset:1024 lds
    ds_read_b128 v[60:63], v9 offset:27648
    v_mfma_f32_32x32x16_bf16 v[32:47], a[224:227], v[64:67], v[32:47]
    v_mfma_f32_32x32x16_bf16 v[16:31], a[84:87], v[68:71], v[16:31]
    buffer_load_dwordx4 v0, s[8:11], s47 offen offset:2048 lds
    ds_read_b128 v[64:67], v9 offset:28672
    v_mfma_f32_32x32x16_bf16 v[32:47], a[228:231], v[68:71], v[32:47]
    v_mfma_f32_32x32x16_bf16 v[16:31], a[88:91], v[72:75], v[16:31]
    buffer_load_dwordx4 v0, s[8:11], s47 offen offset:3072 lds
    ds_read_b128 v[68:71], v9 offset:29696
    v_mfma_f32_32x32x16_bf16 v[32:47], a[232:235], v[72:75], v[32:47]
    v_mfma_f32_32x32x16_bf16 v[16:31], a[92:95], v[76:79], v[16:31]
    s_add_u32 m0, s59, 4096
    s_add_u32 s47, s41, 4096
    buffer_load_dwordx4 v0, s[8:11], s47 offen offset:0 lds
    ds_read_b128 v[72:75], v9 offset:30720
    v_mfma_f32_32x32x16_bf16 v[32:47], a[236:239], v[76:79], v[32:47]
    s_waitcnt lgkmcnt(6)
    v_mfma_f32_32x32x16_bf16 v[16:31], a[96:99], v[48:51], v[16:31]
    buffer_load_dwordx4 v0, s[8:11], s47 offen offset:1024 lds
    ds_read_b128 v[76:79], v9 offset:31744
    v_mfma_f32_32x32x16_bf16 v[32:47], a[240:243], v[48:51], v[32:47]
    s_waitcnt lgkmcnt(6)
    v_mfma_f32_32x32x16_bf16 v[16:31], a[100:103], v[52:55], v[16:31]
    buffer_load_dwordx4 v0, s[8:11], s47 offen offset:2048 lds
    ds_read_b128 v[48:51], v9 offset:32768
    v_mfma_f32_32x32x16_bf16 v[32:47], a[244:247], v[52:55], v[32:47]
    s_waitcnt lgkmcnt(6)
    v_mfma_f32_32x32x16_bf16 v[16:31], a[104:107], v[56:59], v[16:31]
    buffer_load_dwordx4 v0, s[8:11], s47 offen offset:3072 lds
    ds_read_b128 v[52:55], v9 offset:33792
    v_mfma_f32_32x32x16_bf16 v[32:47], a[248:251], v[56:59], v[32:47]
    s_waitcnt lgkmcnt(6)
    v_mfma_f32_32x32x16_bf16 v[16:31], a[108:111], v[60:63], v[16:31]
    s_add_u32 m0, s59, 8192
    s_add_u32 s47, s41, 8192
    buffer_load_dwordx4 v0, s[8:11], s47 offen offset:0 lds
    ds_read_b128 v[56:59], v9 offset:34816
    v_mfma_f32_32x32x16_bf16 v[32:47], a[252:255], v[60:63], v[32:47]
    s_waitcnt lgkmcnt(6)
    v_mfma_f32_32x32x16_bf16 v[16:31], a[112:115], v[64:67], v[16:31]
    ds_read_b128 v[60:63], v9 offset:35840
    v_mfma_f32_32x32x16_bf16 v[32:47], v[152:155], v[64:67], v[32:47]
    s_mul_i32 s48, s36, 4718592
    s_mul_i32 s18, s37, 36864
    s_add_u32 s48, s48, s18
    s_add_u32 s48, s48, 6291456
    buffer_load_dwordx4 v[80:83], v12, s[8:11], s48 offen offset:0
    s_waitcnt lgkmcnt(6)
    v_mfma_f32_32x32x16_bf16 v[16:31], a[116:119], v[68:71], v[16:31]
    buffer_load_dwordx4 v[84:87], v12, s[8:11], s48 offen offset:1024
    v_mfma_f32_32x32x16_bf16 v[32:47], v[156:159], v[68:71], v[32:47]
    s_waitcnt lgkmcnt(5)
    v_mfma_f32_32x32x16_bf16 v[16:31], a[120:123], v[72:75], v[16:31]
    buffer_load_dwordx4 v[88:91], v13, s[8:11], s48 offen offset:0
    v_mfma_f32_32x32x16_bf16 v[32:47], v[160:163], v[72:75], v[32:47]
    s_waitcnt lgkmcnt(4)
    v_mfma_f32_32x32x16_bf16 v[16:31], a[124:127], v[76:79], v[16:31]
    buffer_load_dwordx4 v[92:95], v13, s[8:11], s48 offen offset:1024
    v_cmp_eq_u32 s[76:77], 1, v2
    v_cmp_eq_u32 vcc, 2, v2
    s_cmp_eq_u64 s[76:77], -1
    s_cselect_b32 s38, 1, 0
    v_mfma_f32_32x32x16_bf16 v[32:47], v[164:167], v[76:79], v[32:47]
    s_cmp_lg_u32 s38, 0
    s_cselect_b64 exec, 1, 0
    v_mov_b32 v15, s32
    ds_write_b32 v184, v15
    v_mov_b32 v2, 2
    s_mov_b64 exec, -1
    s_waitcnt lgkmcnt(4)
    v_mfma_f32_32x32x16_bf16 v[16:31], a[128:131], v[48:51], v[16:31]
    s_add_u32 s32, s32, s38
    s_mul_i32 s38, s38, 22528
    s_add_u32 s33, s33, s38
    s_cmp_eq_u64 vcc, 0
    s_cselect_b32 s38, s32, 0x7fff
    v_mfma_f32_32x32x16_bf16 v[32:47], v[168:171], v[48:51], v[32:47]
    s_cmp_le_u32 s38, s39
    s_cselect_b64 exec, -1, 0
    v_mov_b32 v2, 2
    buffer_load_dword v2, v1, s[8:11], s33 offen sc1
    s_mov_b64 exec, -1
    s_waitcnt lgkmcnt(3)
    v_mfma_f32_32x32x16_bf16 v[16:31], a[132:135], v[52:55], v[16:31]
    v_mfma_f32_32x32x16_bf16 v[32:47], v[172:175], v[52:55], v[32:47]
    s_waitcnt lgkmcnt(2)
    v_mfma_f32_32x32x16_bf16 v[16:31], a[136:139], v[56:59], v[16:31]
    v_mfma_f32_32x32x16_bf16 v[32:47], v[176:179], v[56:59], v[32:47]
    s_waitcnt lgkmcnt(1)
    v_mfma_f32_32x32x16_bf16 v[16:31], a[140:143], v[60:63], v[16:31]
    v_mfma_f32_32x32x16_bf16 v[32:47], v[180:183], v[60:63], v[32:47]
    s_nop 3
    v_cvt_pk_bf16_f32 v108, v16, v17
    v_cvt_pk_bf16_f32 v109, v18, v19
    v_cvt_pk_bf16_f32 v110, v20, v21
    v_cvt_pk_bf16_f32 v111, v22, v23
    buffer_store_dwordx4 v[108:111], v12, s[8:11], s46 offen offset:0 sc1
    v_cvt_pk_bf16_f32 v112, v24, v25
    v_cvt_pk_bf16_f32 v113, v26, v27
    v_cvt_pk_bf16_f32 v114, v28, v29
    v_cvt_pk_bf16_f32 v115, v30, v31
    buffer_store_dwordx4 v[112:115], v12, s[8:11], s46 offen offset:1024 sc1
    v_cvt_pk_bf16_f32 v116, v32, v33
    v_cvt_pk_bf16_f32 v117, v34, v35
    v_cvt_pk_bf16_f32 v118, v36, v37
    v_cvt_pk_bf16_f32 v119, v38, v39
    buffer_store_dwordx4 v[116:119], v13, s[8:11], s46 offen offset:0 sc1
    v_cvt_pk_bf16_f32 v120, v40, v41
    v_cvt_pk_bf16_f32 v121, v42, v43
    v_cvt_pk_bf16_f32 v122, v44, v45
    v_cvt_pk_bf16_f32 v123, v46, v47
    buffer_store_dwordx4 v[120:123], v13, s[8:11], s46 offen offset:1024 sc1
    v_mov_b32 v104, 0x3f803f80
    v_mov_b32 v96, 0
    v_mov_b32 v97, 0
    v_mov_b32 v100, 0
    v_mov_b32 v101, 0
    v_dot2c_f32_bf16 v96, v108, v104
    v_dot2c_f32_bf16 v97, v108, v108
    v_dot2c_f32_bf16 v100, v116, v104
    v_dot2c_f32_bf16 v101, v116, v116
    v_dot2c_f32_bf16 v96, v109, v104
    v_dot2c_f32_bf16 v97, v109, v109
    v_dot2c_f32_bf16 v100, v117, v104
    v_dot2c_f32_bf16 v101, v117, v117
    v_dot2c_f32_bf16 v96, v110, v104
    v_dot2c_f32_bf16 v97, v110, v110
    v_dot2c_f32_bf16 v100, v118, v104
    v_dot2c_f32_bf16 v101, v118, v118
    v_dot2c_f32_bf16 v96, v111, v104
    v_dot2c_f32_bf16 v97, v111, v111
    v_dot2c_f32_bf16 v100, v119, v104
    v_dot2c_f32_bf16 v101, v119, v119
    v_dot2c_f32_bf16 v96, v112, v104
    v_dot2c_f32_bf16 v97, v112, v112
    v_dot2c_f32_bf16 v100, v120, v104
    v_dot2c_f32_bf16 v101, v120, v120
    v_dot2c_f32_bf16 v96, v113, v104
    v_dot2c_f32_bf16 v97, v113, v113
    v_dot2c_f32_bf16 v100, v121, v104
    v_dot2c_f32_bf16 v101, v121, v121
    v_dot2c_f32_bf16 v96, v114, v104
    v_dot2c_f32_bf16 v97, v114, v114
    v_dot2c_f32_bf16 v100, v122, v104
    v_dot2c_f32_bf16 v101, v122, v122
    v_dot2c_f32_bf16 v96, v115, v104
    v_dot2c_f32_bf16 v97, v115, v115
    v_dot2c_f32_bf16 v100, v123, v104
    v_dot2c_f32_bf16 v101, v123, v123
    s_nop 2
    v_mov_b32 v98, v96
    v_mov_b32 v99, v97
    v_mov_b32 v102, v100
    v_mov_b32 v103, v101
    v_permlane32_swap_b32 v96, v98
    v_permlane32_swap_b32 v97, v99
    v_permlane32_swap_b32 v100, v102
    v_permlane32_swap_b32 v101, v103
    v_add_f32 v96, v96, v98
    v_add_f32 v97, v97, v99
    buffer_store_dwordx2 v[96:97], v10, s[8:11], s52 offen sc1
    v_add_f32 v100, v100, v102
    v_add_f32 v101, v101, v103
    buffer_store_dwordx2 v[100:101], v11, s[8:11], s52 offen sc1
    s_mul_i32 s43, s57, 22528
    s_add_u32 s43, s43, s49
    s_branch Lawo_head
Lawo_none:
    s_waitcnt vmcnt(0)
    s_cmp_lg_u32 s43, 0
    s_cselect_b64 exec, 3, 0
    buffer_store_dword v3, v185, s[8:11], s43 offen sc1
    s_mov_b64 exec, -1
    s_mov_b32 s43, 0
    s_cmp_ge_u32 s37, 64
    s_cbranch_scc1 Lawo_end
Lawo_wait:
    s_mov_b32 s16, 0
    s_cmp_lg_u32 s14, 0
    s_cbranch_scc1 Lawo_wl
Lawo_wp:
    buffer_load_dword v2, v1, s[8:11], s60 offen sc1
    s_add_u32 s16, s16, 1
    s_cmp_gt_u32 s16, 100000
    s_cbranch_scc1 Lawo_giveup
    s_waitcnt vmcnt(0)
    v_cmp_eq_u32 vcc, 0, v2
    s_nop 0
    s_cbranch_vccz Lawo_wok
    s_sleep 4
    s_branch Lawo_wp
Lawo_giveup:
    v_mov_b32 v5, -2
    ds_write_b32 v184, v5
    s_waitcnt lgkmcnt(0)
    s_branch L_role_awo_abort
Lawo_wok:
    v_mov_b32 v5, s37
    ds_write_b32 v184, v5
    s_branch Lawo_go
Lawo_wl:
    ds_read_b32 v15, v184
    s_add_u32 s16, s16, 1
    s_cmp_gt_u32 s16, 1600000
    s_cbranch_scc1 L_role_awo_abort
    s_waitcnt lgkmcnt(0)
    v_readfirstlane_b32 s17, v15
    s_nop 0
    s_cmp_eq_u32 s17, -2
    s_cbranch_scc1 L_role_awo_abort
    s_cmp_ge_i32 s17, s37
    s_cbranch_scc1 Lawo_go
    s_sleep 1
    s_branch Lawo_wl
Lawo_go:
    s_add_u32 m0, s59, 0
    s_add_u32 s47, s41, 0
    buffer_load_dwordx4 v0, s[8:11], s47 offen offset:0 lds
    buffer_load_dwordx4 v0, s[8:11], s47 offen offset:1024 lds
    buffer_load_dwordx4 v0, s[8:11], s47 offen offset:2048 lds
    buffer_load_dwordx4 v0, s[8:11], s47 offen offset:3072 lds
    s_add_u32 m0, s59, 4096
    s_add_u32 s47, s41, 4096
    buffer_load_dwordx4 v0, s[8:11], s47 offen offset:0 lds
    buffer_load_dwordx4 v0, s[8:11], s47 offen offset:1024 lds
    buffer_load_dwordx4 v0, s[8:11], s47 offen offset:2048 lds
    buffer_load_dwordx4 v0, s[8:11], s47 offen offset:3072 lds
    s_add_u32 m0, s59, 8192
    s_add_u32 s47, s41, 8192
    buffer_load_dwordx4 v0, s[8:11], s47 offen offset:0 lds
    s_mul_i32 s48, s36, 4718592
    s_mul_i32 s18, s37, 36864
    s_add_u32 s48, s48, s18
    s_add_u32 s48, s48, 6291456
    buffer_load_dwordx4 v[80:83], v12, s[8:11], s48 offen offset:0
    buffer_load_dwordx4 v[84:87], v12, s[8:11], s48 offen offset:1024
    buffer_load_dwordx4 v[88:91], v13, s[8:11], s48 offen offset:0
    buffer_load_dwordx4 v[92:95], v13, s[8:11], s48 offen offset:1024
    s_waitcnt vmcnt(0) lgkmcnt(0)
    s_branch Lawo_head2
Lawo_end:
    s_branch L_role_awo_exit
L_role_awo_abort:
    s_waitcnt lgkmcnt(0)
    s_mov_b64 exec, -1
    v_mov_b32 v0, 60
    s_lshl_b32 s5, s3, 8
    s_or_b32 s5, s5, s4
    s_or_b32 s5, s5, 0x10000
    v_mov_b32 v1, s5
    global_store_dword v0, v1, s[12:13]
    s_endpgm
L_role_awo_exit:
    s_endpgm
.p2align 6
L_role_aq:
    v_and_b32 v5, 63, v0
    v_lshlrev_b32 v0, 4, v5
    v_and_b32 v7, 15, v5
    v_lshrrev_b32 v8, 4, v5
    v_min_u32 v1, 47, v5
    v_lshrrev_b32 v6, 2, v1
    v_and_b32 v1, 3, v1
    v_lshlrev_b32 v1, 2, v1
    v_lshl_add_u32 v1, v6, 7, v1
    v_mov_b32 v3, 1
    v_mov_b32 v4, 0
    s_mov_b32 s44, 0x05040100
    s_mov_b32 s45, 0x07060302
    s_lshr_b32 s63, s15, 4
    s_and_b32 s15, s15, 15
    s_lshr_b32 s50, s15, 1
    s_lshl_b32 s50, s50, 2
    s_and_b32 s17, s15, 1
    s_add_u32 s50, s50, s17
    s_and_b32 s17, s14, 2
    s_add_u32 s50, s50, s17
    s_and_b32 s51, s14, 1
    s_cmp_eq_u32 s63, 0
    s_cbranch_scc1 Laq_gate_ng
    s_cmp_lg_u32 s14, 0
    s_cbranch_scc1 Laq_gate_d
    v_mov_b32 v5, 48
    s_mov_b32 s16, 0
Laq_gate:
    global_load_dword v6, v5, s[12:13] sc1
    s_add_u32 s16, s16, 1
    s_cmp_gt_u32 s16, 100000
    s_cbranch_scc1 L_role_aq_abort
    s_waitcnt vmcnt(0)
    v_cmp_gt_u32 vcc, 32, v6
    s_nop 0
    s_cbranch_vccz Laq_gate_d
    s_sleep 100
    s_branch Laq_gate
Laq_gate_d:
    s_barrier
Laq_gate_ng:
    s_load_dwordx2 s[20:21], s[0:1], 8
    s_mov_b32 s22, 1990656
    s_mov_b32 s23, 0x00020000
    s_waitcnt lgkmcnt(0)
    s_and_b32 s21, s21, 0xffff
    v_lshrrev_b32 v5, 7, v0
    v_mul_u32_u24 v16, 3456, v5
    v_and_b32 v5, 0x70, v0
    v_add_u32 v16, v16, v5
    s_lshr_b32 s17, s14, 1
    s_mul_i32 s46, s17, 72
    v_lshrrev_b32 v5, 2, v7
    v_lshl_add_u32 v5, v8, 3, v5
    v_and_b32 v6, 3, v7
    v_lshlrev_b32 v17, 7, v5
    v_lshl_add_u32 v17, v6, 3, v17
    v_add_u32 v17, s46, v17
    v_lshlrev_b32 v18, 5, v5
    v_min_u32 v6, 1, v6
    v_lshl_add_u32 v18, v6, 4, v18
    s_mul_i32 s17, s17, 3072
    s_add_u32 s17, s17, 36864
    v_add_u32 v18, s17, v18
    s_sub_u32 s17, s50, s14
    s_lshr_b32 s17, s14, 1
    s_lshl_b32 s17, s17, 1
    s_sub_u32 s17, s50, s17
    s_mul_i32 s49, s17, 36
    s_mul_i32 s17, s14, 82944
    s_add_u32 s49, s49, s17
    s_mul_i32 s47, s14, 3072
    v_lshrrev_b32 v21, 4, v0
    s_lshl_b32 s17, s14, 6
    v_add_u32 v21, s17, v21
    v_cmp_le_u32 vcc, 96, v21
    s_nop 1
    v_cndmask_b32 v5, 0, 1, vcc
    v_mul_u32_u24 v6, 96, v5
    v_sub_u32 v6, v21, v6
    v_lshlrev_b32 v19, 7, v6
    v_mul_u32_u24 v20, 72, v5
    v_add_u32 v19, v19, v20
    v_add_u32 v19, 32, v19
    v_lshlrev_b32 v20, 5, v21
    v_add_u32 v20, 36864, v20
    v_mov_b32 v24, 0
    v_mov_b32 v25, 0
    v_mov_b32 v26, 0
    v_mov_b32 v27, 0
    v_mov_b32 v31, 0
    s_cmp_eq_u32 s14, 3
    s_cselect_b64 s[76:77], 0, -1
    s_mov_b64 exec, s[76:77]
    v_add_u32 v22, 0, v20
    ds_write_b128 v22, v[24:27] offset:16
    v_add_u32 v22, 43008, v20
    ds_write_b128 v22, v[24:27] offset:16
    v_add_u32 v22, 86016, v20
    ds_write_b128 v22, v[24:27] offset:16
    s_mov_b64 exec, -1
    s_add_u32 m0, s47, 0
    s_add_u32 s17, s49, 0
    buffer_load_dwordx4 v16, s[20:23], s17 offen lds
    s_add_u32 m0, s47, 1024
    s_add_u32 s17, s49, 27648
    buffer_load_dwordx4 v16, s[20:23], s17 offen lds
    s_add_u32 m0, s47, 2048
    s_add_u32 s17, s49, 55296
    buffer_load_dwordx4 v16, s[20:23], s17 offen lds
    s_add_u32 m0, s47, 12288
    s_add_u32 s17, s49, 1152
    buffer_load_dwordx4 v16, s[20:23], s17 offen lds
    s_add_u32 m0, s47, 13312
    s_add_u32 s17, s49, 28800
    buffer_load_dwordx4 v16, s[20:23], s17 offen lds
    s_add_u32 m0, s47, 14336
    s_add_u32 s17, s49, 56448
    buffer_load_dwordx4 v16, s[20:23], s17 offen lds
    s_add_u32 m0, s47, 24576
    s_add_u32 s17, s49, 2304
    buffer_load_dwordx4 v16, s[20:23], s17 offen lds
    s_add_u32 m0, s47, 25600
    s_add_u32 s17, s49, 29952
    buffer_load_dwordx4 v16, s[20:23], s17 offen lds
    s_add_u32 m0, s47, 26624
    s_add_u32 s17, s49, 57600
    buffer_load_dwordx4 v16, s[20:23], s17 offen lds
    s_add_u32 m0, s47, 43008
    s_add_u32 s17, s49, 331776
    buffer_load_dwordx4 v16, s[20:23], s17 offen lds
    s_add_u32 m0, s47, 44032
    s_add_u32 s17, s49, 359424
    buffer_load_dwordx4 v16, s[20:23], s17 offen lds
    s_add_u32 m0, s47, 45056
    s_add_u32 s17, s49, 387072
    buffer_load_dwordx4 v16, s[20:23], s17 offen lds
    s_add_u32 m0, s47, 55296
    s_add_u32 s17, s49, 332928
    buffer_load_dwordx4 v16, s[20:23], s17 offen lds
    s_add_u32 m0, s47, 56320
    s_add_u32 s17, s49, 360576
    buffer_load_dwordx4 v16, s[20:23], s17 offen lds
    s_add_u32 m0, s47, 57344
    s_add_u32 s17, s49, 388224
    buffer_load_dwordx4 v16, s[20:23], s17 offen lds
    s_add_u32 m0, s47, 67584
    s_add_u32 s17, s49, 334080
    buffer_load_dwordx4 v16, s[20:23], s17 offen lds
    s_add_u32 m0, s47, 68608
    s_add_u32 s17, s49, 361728
    buffer_load_dwordx4 v16, s[20:23], s17 offen lds
    s_add_u32 m0, s47, 69632
    s_add_u32 s17, s49, 389376
    buffer_load_dwordx4 v16, s[20:23], s17 offen lds
    s_add_u32 m0, s47, 86016
    s_add_u32 s17, s49, 663552
    buffer_load_dwordx4 v16, s[20:23], s17 offen lds
    s_add_u32 m0, s47, 87040
    s_add_u32 s17, s49, 691200
    buffer_load_dwordx4 v16, s[20:23], s17 offen lds
    s_add_u32 m0, s47, 88064
    s_add_u32 s17, s49, 718848
    buffer_load_dwordx4 v16, s[20:23], s17 offen lds
    s_add_u32 m0, s47, 98304
    s_add_u32 s17, s49, 664704
    buffer_load_dwordx4 v16, s[20:23], s17 offen lds
    s_add_u32 m0, s47, 99328
    s_add_u32 s17, s49, 692352
    buffer_load_dwordx4 v16, s[20:23], s17 offen lds
    s_add_u32 m0, s47, 100352
    s_add_u32 s17, s49, 720000
    buffer_load_dwordx4 v16, s[20:23], s17 offen lds
    s_add_u32 m0, s47, 110592
    s_add_u32 s17, s49, 665856
    buffer_load_dwordx4 v16, s[20:23], s17 offen lds
    s_add_u32 m0, s47, 111616
    s_add_u32 s17, s49, 693504
    buffer_load_dwordx4 v16, s[20:23], s17 offen lds
    s_add_u32 m0, s47, 112640
    s_add_u32 s17, s49, 721152
    buffer_load_dwordx4 v16, s[20:23], s17 offen lds
    s_waitcnt vmcnt(18) lgkmcnt(0)
    s_barrier
    s_mov_b64 exec, s[76:77]
    v_add_u32 v22, 0, v19
    ds_read_b32 v28, v22 offset:0
    ds_read_b32 v29, v22 offset:12288
    ds_read_b32 v30, v22 offset:24576
    s_waitcnt lgkmcnt(0)
    v_add_u32 v22, 0, v20
    ds_write_b128 v22, v[28:31]
    s_mov_b64 exec, -1
    v_add_u32 v22, 0, v17
    v_add_u32 v23, 0, v18
    ds_read_b64_tr_b16 v[152:153], v22 offset:0
    ds_read_b64_tr_b16 v[154:155], v22 offset:512
    ds_read_b64_tr_b16 v[224:225], v22 offset:12288
    ds_read_b64_tr_b16 v[226:227], v22 offset:12800
    ds_read_b64_tr_b16 a[112:113], v22 offset:24576
    ds_read_b64_tr_b16 a[114:115], v22 offset:25088
    ds_read_b64_tr_b16 v[156:157], v22 offset:4096
    ds_read_b64_tr_b16 v[158:159], v22 offset:4608
    ds_read_b64_tr_b16 v[228:229], v22 offset:16384
    ds_read_b64_tr_b16 v[230:231], v22 offset:16896
    ds_read_b64_tr_b16 a[116:117], v22 offset:28672
    ds_read_b64_tr_b16 a[118:119], v22 offset:29184
    ds_read_b64_tr_b16 v[160:161], v22 offset:8192
    ds_read_b64_tr_b16 v[162:163], v22 offset:8704
    ds_read_b64_tr_b16 v[232:233], v22 offset:20480
    ds_read_b64_tr_b16 v[234:235], v22 offset:20992
    ds_read_b64_tr_b16 a[120:121], v22 offset:32768
    ds_read_b64_tr_b16 a[122:123], v22 offset:33280
    s_waitcnt lgkmcnt(0)
    s_barrier
    ds_read_b64_tr_b16 a[40:41], v23 offset:0
    ds_read_b64_tr_b16 a[42:43], v23 offset:128
    ds_read_b64_tr_b16 a[184:185], v23 offset:8
    ds_read_b64_tr_b16 a[186:187], v23 offset:136
    ds_read_b64_tr_b16 a[44:45], v23 offset:1024
    ds_read_b64_tr_b16 a[46:47], v23 offset:1152
    ds_read_b64_tr_b16 a[188:189], v23 offset:1032
    ds_read_b64_tr_b16 a[190:191], v23 offset:1160
    ds_read_b64_tr_b16 a[48:49], v23 offset:2048
    ds_read_b64_tr_b16 a[50:51], v23 offset:2176
    ds_read_b64_tr_b16 a[192:193], v23 offset:2056
    ds_read_b64_tr_b16 a[194:195], v23 offset:2184
    s_waitcnt vmcnt(9) lgkmcnt(0)
    s_barrier
    s_add_u32 m0, s47, 0
    s_add_u32 s17, s49, 995328
    buffer_load_dwordx4 v16, s[20:23], s17 offen lds
    s_add_u32 m0, s47, 1024
    s_add_u32 s17, s49, 1022976
    buffer_load_dwordx4 v16, s[20:23], s17 offen lds
    s_add_u32 m0, s47, 2048
    s_add_u32 s17, s49, 1050624
    buffer_load_dwordx4 v16, s[20:23], s17 offen lds
    s_add_u32 m0, s47, 12288
    s_add_u32 s17, s49, 996480
    buffer_load_dwordx4 v16, s[20:23], s17 offen lds
    s_add_u32 m0, s47, 13312
    s_add_u32 s17, s49, 1024128
    buffer_load_dwordx4 v16, s[20:23], s17 offen lds
    s_add_u32 m0, s47, 14336
    s_add_u32 s17, s49, 1051776
    buffer_load_dwordx4 v16, s[20:23], s17 offen lds
    s_add_u32 m0, s47, 24576
    s_add_u32 s17, s49, 997632
    buffer_load_dwordx4 v16, s[20:23], s17 offen lds
    s_add_u32 m0, s47, 25600
    s_add_u32 s17, s49, 1025280
    buffer_load_dwordx4 v16, s[20:23], s17 offen lds
    s_add_u32 m0, s47, 26624
    s_add_u32 s17, s49, 1052928
    buffer_load_dwordx4 v16, s[20:23], s17 offen lds
    s_mov_b64 exec, s[76:77]
    v_add_u32 v22, 43008, v19
    ds_read_b32 v28, v22 offset:0
    ds_read_b32 v29, v22 offset:12288
    ds_read_b32 v30, v22 offset:24576
    s_waitcnt lgkmcnt(0)
    v_add_u32 v22, 43008, v20
    ds_write_b128 v22, v[28:31]
    s_mov_b64 exec, -1
    v_add_u32 v22, 43008, v17
    v_add_u32 v23, 43008, v18
    ds_read_b64_tr_b16 v[164:165], v22 offset:0
    ds_read_b64_tr_b16 v[166:167], v22 offset:512
    ds_read_b64_tr_b16 v[236:237], v22 offset:12288
    ds_read_b64_tr_b16 v[238:239], v22 offset:12800
    ds_read_b64_tr_b16 a[124:125], v22 offset:24576
    ds_read_b64_tr_b16 a[126:127], v22 offset:25088
    ds_read_b64_tr_b16 v[168:169], v22 offset:4096
    ds_read_b64_tr_b16 v[170:171], v22 offset:4608
    ds_read_b64_tr_b16 v[240:241], v22 offset:16384
    ds_read_b64_tr_b16 v[242:243], v22 offset:16896
    ds_read_b64_tr_b16 a[128:129], v22 offset:28672
    ds_read_b64_tr_b16 a[130:131], v22 offset:29184
    ds_read_b64_tr_b16 v[172:173], v22 offset:8192
    ds_read_b64_tr_b16 v[174:175], v22 offset:8704
    ds_read_b64_tr_b16 v[244:245], v22 offset:20480
    ds_read_b64_tr_b16 v[246:247], v22 offset:20992
    ds_read_b64_tr_b16 a[132:133], v22 offset:32768
    ds_read_b64_tr_b16 a[134:135], v22 offset:33280
    s_waitcnt lgkmcnt(0)
    s_barrier
    ds_read_b64_tr_b16 a[52:53], v23 offset:0
    ds_read_b64_tr_b16 a[54:55], v23 offset:128
    ds_read_b64_tr_b16 a[196:197], v23 offset:8
    ds_read_b64_tr_b16 a[198:199], v23 offset:136
    ds_read_b64_tr_b16 a[56:57], v23 offset:1024
    ds_read_b64_tr_b16 a[58:59], v23 offset:1152
    ds_read_b64_tr_b16 a[200:201], v23 offset:1032
    ds_read_b64_tr_b16 a[202:203], v23 offset:1160
    ds_read_b64_tr_b16 a[60:61], v23 offset:2048
    ds_read_b64_tr_b16 a[62:63], v23 offset:2176
    ds_read_b64_tr_b16 a[204:205], v23 offset:2056
    ds_read_b64_tr_b16 a[206:207], v23 offset:2184
    s_waitcnt vmcnt(9) lgkmcnt(0)
    s_barrier
    s_add_u32 m0, s47, 43008
    s_add_u32 s17, s49, 1327104
    buffer_load_dwordx4 v16, s[20:23], s17 offen lds
    s_add_u32 m0, s47, 44032
    s_add_u32 s17, s49, 1354752
    buffer_load_dwordx4 v16, s[20:23], s17 offen lds
    s_add_u32 m0, s47, 45056
    s_add_u32 s17, s49, 1382400
    buffer_load_dwordx4 v16, s[20:23], s17 offen lds
    s_add_u32 m0, s47, 55296
    s_add_u32 s17, s49, 1328256
    buffer_load_dwordx4 v16, s[20:23], s17 offen lds
    s_add_u32 m0, s47, 56320
    s_add_u32 s17, s49, 1355904
    buffer_load_dwordx4 v16, s[20:23], s17 offen lds
    s_add_u32 m0, s47, 57344
    s_add_u32 s17, s49, 1383552
    buffer_load_dwordx4 v16, s[20:23], s17 offen lds
    s_add_u32 m0, s47, 67584
    s_add_u32 s17, s49, 1329408
    buffer_load_dwordx4 v16, s[20:23], s17 offen lds
    s_add_u32 m0, s47, 68608
    s_add_u32 s17, s49, 1357056
    buffer_load_dwordx4 v16, s[20:23], s17 offen lds
    s_add_u32 m0, s47, 69632
    s_add_u32 s17, s49, 1384704
    buffer_load_dwordx4 v16, s[20:23], s17 offen lds
    s_mov_b64 exec, s[76:77]
    v_add_u32 v22, 86016, v19
    ds_read_b32 v28, v22 offset:0
    ds_read_b32 v29, v22 offset:12288
    ds_read_b32 v30, v22 offset:24576
    s_waitcnt lgkmcnt(0)
    v_add_u32 v22, 86016, v20
    ds_write_b128 v22, v[28:31]
    s_mov_b64 exec, -1
    v_add_u32 v22, 86016, v17
    v_add_u32 v23, 86016, v18
    ds_read_b64_tr_b16 v[176:177], v22 offset:0
    ds_read_b64_tr_b16 v[178:179], v22 offset:512
    ds_read_b64_tr_b16 v[248:249], v22 offset:12288
    ds_read_b64_tr_b16 v[250:251], v22 offset:12800
    ds_read_b64_tr_b16 a[136:137], v22 offset:24576
    ds_read_b64_tr_b16 a[138:139], v22 offset:25088
    ds_read_b64_tr_b16 v[180:181], v22 offset:4096
    ds_read_b64_tr_b16 v[182:183], v22 offset:4608
    ds_read_b64_tr_b16 v[252:253], v22 offset:16384
    ds_read_b64_tr_b16 v[254:255], v22 offset:16896
    ds_read_b64_tr_b16 a[140:141], v22 offset:28672
    ds_read_b64_tr_b16 a[142:143], v22 offset:29184
    ds_read_b64_tr_b16 v[184:185], v22 offset:8192
    ds_read_b64_tr_b16 v[186:187], v22 offset:8704
    ds_read_b64_tr_b16 a[0:1], v22 offset:20480
    ds_read_b64_tr_b16 a[2:3], v22 offset:20992
    ds_read_b64_tr_b16 a[144:145], v22 offset:32768
    ds_read_b64_tr_b16 a[146:147], v22 offset:33280
    s_waitcnt lgkmcnt(0)
    s_barrier
    ds_read_b64_tr_b16 a[64:65], v23 offset:0
    ds_read_b64_tr_b16 a[66:67], v23 offset:128
    ds_read_b64_tr_b16 a[208:209], v23 offset:8
    ds_read_b64_tr_b16 a[210:211], v23 offset:136
    ds_read_b64_tr_b16 a[68:69], v23 offset:1024
    ds_read_b64_tr_b16 a[70:71], v23 offset:1152
    ds_read_b64_tr_b16 a[212:213], v23 offset:1032
    ds_read_b64_tr_b16 a[214:215], v23 offset:1160
    ds_read_b64_tr_b16 a[72:73], v23 offset:2048
    ds_read_b64_tr_b16 a[74:75], v23 offset:2176
    ds_read_b64_tr_b16 a[216:217], v23 offset:2056
    ds_read_b64_tr_b16 a[218:219], v23 offset:2184
    s_waitcnt vmcnt(9) lgkmcnt(0)
    s_barrier
    s_add_u32 m0, s47, 86016
    s_add_u32 s17, s49, 1658880
    buffer_load_dwordx4 v16, s[20:23], s17 offen lds
    s_add_u32 m0, s47, 87040
    s_add_u32 s17, s49, 1686528
    buffer_load_dwordx4 v16, s[20:23], s17 offen lds
    s_add_u32 m0, s47, 88064
    s_add_u32 s17, s49, 1714176
    buffer_load_dwordx4 v16, s[20:23], s17 offen lds
    s_add_u32 m0, s47, 98304
    s_add_u32 s17, s49, 1660032
    buffer_load_dwordx4 v16, s[20:23], s17 offen lds
    s_add_u32 m0, s47, 99328
    s_add_u32 s17, s49, 1687680
    buffer_load_dwordx4 v16, s[20:23], s17 offen lds
    s_add_u32 m0, s47, 100352
    s_add_u32 s17, s49, 1715328
    buffer_load_dwordx4 v16, s[20:23], s17 offen lds
    s_add_u32 m0, s47, 110592
    s_add_u32 s17, s49, 1661184
    buffer_load_dwordx4 v16, s[20:23], s17 offen lds
    s_add_u32 m0, s47, 111616
    s_add_u32 s17, s49, 1688832
    buffer_load_dwordx4 v16, s[20:23], s17 offen lds
    s_add_u32 m0, s47, 112640
    s_add_u32 s17, s49, 1716480
    buffer_load_dwordx4 v16, s[20:23], s17 offen lds
    s_mov_b64 exec, s[76:77]
    v_add_u32 v22, 0, v19
    ds_read_b32 v28, v22 offset:0
    ds_read_b32 v29, v22 offset:12288
    ds_read_b32 v30, v22 offset:24576
    s_waitcnt lgkmcnt(0)
    v_add_u32 v22, 0, v20
    ds_write_b128 v22, v[28:31]
    s_mov_b64 exec, -1
    v_add_u32 v22, 0, v17
    v_add_u32 v23, 0, v18
    ds_read_b64_tr_b16 v[188:189], v22 offset:0
    ds_read_b64_tr_b16 v[190:191], v22 offset:512
    ds_read_b64_tr_b16 a[4:5], v22 offset:12288
    ds_read_b64_tr_b16 a[6:7], v22 offset:12800
    ds_read_b64_tr_b16 a[148:149], v22 offset:24576
    ds_read_b64_tr_b16 a[150:151], v22 offset:25088
    ds_read_b64_tr_b16 v[192:193], v22 offset:4096
    ds_read_b64_tr_b16 v[194:195], v22 offset:4608
    ds_read_b64_tr_b16 a[8:9], v22 offset:16384
    ds_read_b64_tr_b16 a[10:11], v22 offset:16896
    ds_read_b64_tr_b16 a[152:153], v22 offset:28672
    ds_read_b64_tr_b16 a[154:155], v22 offset:29184
    ds_read_b64_tr_b16 v[196:197], v22 offset:8192
    ds_read_b64_tr_b16 v[198:199], v22 offset:8704
    ds_read_b64_tr_b16 a[12:13], v22 offset:20480
    ds_read_b64_tr_b16 a[14:15], v22 offset:20992
    ds_read_b64_tr_b16 a[156:157], v22 offset:32768
    ds_read_b64_tr_b16 a[158:159], v22 offset:33280
    s_waitcnt lgkmcnt(0)
    s_barrier
    ds_read_b64_tr_b16 a[76:77], v23 offset:0
    ds_read_b64_tr_b16 a[78:79], v23 offset:128
    ds_read_b64_tr_b16 a[220:221], v23 offset:8
    ds_read_b64_tr_b16 a[222:223], v23 offset:136
    ds_read_b64_tr_b16 a[80:81], v23 offset:1024
    ds_read_b64_tr_b16 a[82:83], v23 offset:1152
    ds_read_b64_tr_b16 a[224:225], v23 offset:1032
    ds_read_b64_tr_b16 a[226:227], v23 offset:1160
    ds_read_b64_tr_b16 a[84:85], v23 offset:2048
    ds_read_b64_tr_b16 a[86:87], v23 offset:2176
    ds_read_b64_tr_b16 a[228:229], v23 offset:2056
    ds_read_b64_tr_b16 a[230:231], v23 offset:2184
    s_waitcnt vmcnt(9) lgkmcnt(0)
    s_barrier
    s_mov_b64 exec, s[76:77]
    v_add_u32 v22, 43008, v19
    ds_read_b32 v28, v22 offset:0
    ds_read_b32 v29, v22 offset:12288
    ds_read_b32 v30, v22 offset:24576
    s_waitcnt lgkmcnt(0)
    v_add_u32 v22, 43008, v20
    ds_write_b128 v22, v[28:31]
    s_mov_b64 exec, -1
    v_add_u32 v22, 43008, v17
    v_add_u32 v23, 43008, v18
    ds_read_b64_tr_b16 v[200:201], v22 offset:0
    ds_read_b64_tr_b16 v[202:203], v22 offset:512
    ds_read_b64_tr_b16 a[16:17], v22 offset:12288
    ds_read_b64_tr_b16 a[18:19], v22 offset:12800
    ds_read_b64_tr_b16 a[160:161], v22 offset:24576
    ds_read_b64_tr_b16 a[162:163], v22 offset:25088
    ds_read_b64_tr_b16 v[204:205], v22 offset:4096
    ds_read_b64_tr_b16 v[206:207], v22 offset:4608
    ds_read_b64_tr_b16 a[20:21], v22 offset:16384
    ds_read_b64_tr_b16 a[22:23], v22 offset:16896
    ds_read_b64_tr_b16 a[164:165], v22 offset:28672
    ds_read_b64_tr_b16 a[166:167], v22 offset:29184
    ds_read_b64_tr_b16 v[208:209], v22 offset:8192
    ds_read_b64_tr_b16 v[210:211], v22 offset:8704
    ds_read_b64_tr_b16 a[24:25], v22 offset:20480
    ds_read_b64_tr_b16 a[26:27], v22 offset:20992
    ds_read_b64_tr_b16 a[168:169], v22 offset:32768
    ds_read_b64_tr_b16 a[170:171], v22 offset:33280
    s_waitcnt lgkmcnt(0)
    s_barrier
    ds_read_b64_tr_b16 a[88:89], v23 offset:0
    ds_read_b64_tr_b16 a[90:91], v23 offset:128
    ds_read_b64_tr_b16 a[232:233], v23 offset:8
    ds_read_b64_tr_b16 a[234:235], v23 offset:136
    ds_read_b64_tr_b16 a[92:93], v23 offset:1024
    ds_read_b64_tr_b16 a[94:95], v23 offset:1152
    ds_read_b64_tr_b16 a[236:237], v23 offset:1032
    ds_read_b64_tr_b16 a[238:239], v23 offset:1160
    ds_read_b64_tr_b16 a[96:97], v23 offset:2048
    ds_read_b64_tr_b16 a[98:99], v23 offset:2176
    ds_read_b64_tr_b16 a[240:241], v23 offset:2056
    ds_read_b64_tr_b16 a[242:243], v23 offset:2184
    s_waitcnt vmcnt(0) lgkmcnt(0)
    s_barrier
    s_mov_b64 exec, s[76:77]
    v_add_u32 v22, 86016, v19
    ds_read_b32 v28, v22 offset:0
    ds_read_b32 v29, v22 offset:12288
    ds_read_b32 v30, v22 offset:24576
    s_waitcnt lgkmcnt(0)
    v_add_u32 v22, 86016, v20
    ds_write_b128 v22, v[28:31]
    s_mov_b64 exec, -1
    v_add_u32 v22, 86016, v17
    v_add_u32 v23, 86016, v18
    ds_read_b64_tr_b16 v[212:213], v22 offset:0
    ds_read_b64_tr_b16 v[214:215], v22 offset:512
    ds_read_b64_tr_b16 a[28:29], v22 offset:12288
    ds_read_b64_tr_b16 a[30:31], v22 offset:12800
    ds_read_b64_tr_b16 a[172:173], v22 offset:24576
    ds_read_b64_tr_b16 a[174:175], v22 offset:25088
    ds_read_b64_tr_b16 v[216:217], v22 offset:4096
    ds_read_b64_tr_b16 v[218:219], v22 offset:4608
    ds_read_b64_tr_b16 a[32:33], v22 offset:16384
    ds_read_b64_tr_b16 a[34:35], v22 offset:16896
    ds_read_b64_tr_b16 a[176:177], v22 offset:28672
    ds_read_b64_tr_b16 a[178:179], v22 offset:29184
    ds_read_b64_tr_b16 v[220:221], v22 offset:8192
    ds_read_b64_tr_b16 v[222:223], v22 offset:8704
    ds_read_b64_tr_b16 a[36:37], v22 offset:20480
    ds_read_b64_tr_b16 a[38:39], v22 offset:20992
    ds_read_b64_tr_b16 a[180:181], v22 offset:32768
    ds_read_b64_tr_b16 a[182:183], v22 offset:33280
    s_waitcnt lgkmcnt(0)
    s_barrier
    ds_read_b64_tr_b16 a[100:101], v23 offset:0
    ds_read_b64_tr_b16 a[102:103], v23 offset:128
    ds_read_b64_tr_b16 a[244:245], v23 offset:8
    ds_read_b64_tr_b16 a[246:247], v23 offset:136
    ds_read_b64_tr_b16 a[104:105], v23 offset:1024
    ds_read_b64_tr_b16 a[106:107], v23 offset:1152
    ds_read_b64_tr_b16 a[248:249], v23 offset:1032
    ds_read_b64_tr_b16 a[250:251], v23 offset:1160
    ds_read_b64_tr_b16 a[108:109], v23 offset:2048
    ds_read_b64_tr_b16 a[110:111], v23 offset:2176
    ds_read_b64_tr_b16 a[252:253], v23 offset:2056
    ds_read_b64_tr_b16 a[254:255], v23 offset:2184
    s_waitcnt lgkmcnt(0)
    s_barrier
    v_mov_b32 v56, 0x3f803f80
    v_mov_b32 v57, 0x3f803f80
    v_mov_b32 v58, 0x3f803f80
    v_mov_b32 v59, 0x3f803f80
    s_nop 1
    v_mfma_f32_16x16x32_bf16 v[36:39], v[152:155], v[56:59], 0
    v_mfma_f32_16x16x32_bf16 v[40:43], v[224:227], v[56:59], 0
    v_mfma_f32_16x16x32_bf16 v[44:47], a[40:43], v[56:59], 0
    v_mfma_f32_16x16x32_bf16 v[48:51], v[56:59], a[112:115], 0
    v_mfma_f32_16x16x32_bf16 v[52:55], v[56:59], a[184:187], 0
    v_mfma_f32_16x16x32_bf16 v[36:39], v[156:159], v[56:59], v[36:39]
    v_mfma_f32_16x16x32_bf16 v[40:43], v[228:231], v[56:59], v[40:43]
    v_mfma_f32_16x16x32_bf16 v[44:47], a[44:47], v[56:59], v[44:47]
    v_mfma_f32_16x16x32_bf16 v[48:51], v[56:59], a[116:119], v[48:51]
    v_mfma_f32_16x16x32_bf16 v[52:55], v[56:59], a[188:191], v[52:55]
    v_mfma_f32_16x16x32_bf16 v[36:39], v[160:163], v[56:59], v[36:39]
    v_mfma_f32_16x16x32_bf16 v[40:43], v[232:235], v[56:59], v[40:43]
    v_mfma_f32_16x16x32_bf16 v[44:47], a[48:51], v[56:59], v[44:47]
    v_mfma_f32_16x16x32_bf16 v[48:51], v[56:59], a[120:123], v[48:51]
    v_mfma_f32_16x16x32_bf16 v[52:55], v[56:59], a[192:195], v[52:55]
    v_mfma_f32_16x16x32_bf16 v[36:39], v[164:167], v[56:59], v[36:39]
    v_mfma_f32_16x16x32_bf16 v[40:43], v[236:239], v[56:59], v[40:43]
    v_mfma_f32_16x16x32_bf16 v[44:47], a[52:55], v[56:59], v[44:47]
    v_mfma_f32_16x16x32_bf16 v[48:51], v[56:59], a[124:127], v[48:51]
    v_mfma_f32_16x16x32_bf16 v[52:55], v[56:59], a[196:199], v[52:55]
    v_mfma_f32_16x16x32_bf16 v[36:39], v[168:171], v[56:59], v[36:39]
    v_mfma_f32_16x16x32_bf16 v[40:43], v[240:243], v[56:59], v[40:43]
    v_mfma_f32_16x16x32_bf16 v[44:47], a[56:59], v[56:59], v[44:47]
    v_mfma_f32_16x16x32_bf16 v[48:51], v[56:59], a[128:131], v[48:51]
    v_mfma_f32_16x16x32_bf16 v[52:55], v[56:59], a[200:203], v[52:55]
    v_mfma_f32_16x16x32_bf16 v[36:39], v[172:175], v[56:59], v[36:39]
    v_mfma_f32_16x16x32_bf16 v[40:43], v[244:247], v[56:59], v[40:43]
    v_mfma_f32_16x16x32_bf16 v[44:47], a[60:63], v[56:59], v[44:47]
    v_mfma_f32_16x16x32_bf16 v[48:51], v[56:59], a[132:135], v[48:51]
    v_mfma_f32_16x16x32_bf16 v[52:55], v[56:59], a[204:207], v[52:55]
    v_mfma_f32_16x16x32_bf16 v[36:39], v[176:179], v[56:59], v[36:39]
    v_mfma_f32_16x16x32_bf16 v[40:43], v[248:251], v[56:59], v[40:43]
    v_mfma_f32_16x16x32_bf16 v[44:47], a[64:67], v[56:59], v[44:47]
    v_mfma_f32_16x16x32_bf16 v[48:51], v[56:59], a[136:139], v[48:51]
    v_mfma_f32_16x16x32_bf16 v[52:55], v[56:59], a[208:211], v[52:55]
    v_mfma_f32_16x16x32_bf16 v[36:39], v[180:183], v[56:59], v[36:39]
    v_mfma_f32_16x16x32_bf16 v[40:43], v[252:255], v[56:59], v[40:43]
    v_mfma_f32_16x16x32_bf16 v[44:47], a[68:71], v[56:59], v[44:47]
    v_mfma_f32_16x16x32_bf16 v[48:51], v[56:59], a[140:143], v[48:51]
    v_mfma_f32_16x16x32_bf16 v[52:55], v[56:59], a[212:215], v[52:55]
    v_mfma_f32_16x16x32_bf16 v[36:39], v[184:187], v[56:59], v[36:39]
    v_mfma_f32_16x16x32_bf16 v[40:43], a[0:3], v[56:59], v[40:43]
    v_mfma_f32_16x16x32_bf16 v[44:47], a[72:75], v[56:59], v[44:47]
    v_mfma_f32_16x16x32_bf16 v[48:51], v[56:59], a[144:147], v[48:51]
    v_mfma_f32_16x16x32_bf16 v[52:55], v[56:59], a[216:219], v[52:55]
    v_mfma_f32_16x16x32_bf16 v[36:39], v[188:191], v[56:59], v[36:39]
    v_mfma_f32_16x16x32_bf16 v[40:43], a[4:7], v[56:59], v[40:43]
    v_mfma_f32_16x16x32_bf16 v[44:47], a[76:79], v[56:59], v[44:47]
    v_mfma_f32_16x16x32_bf16 v[48:51], v[56:59], a[148:151], v[48:51]
    v_mfma_f32_16x16x32_bf16 v[52:55], v[56:59], a[220:223], v[52:55]
    v_mfma_f32_16x16x32_bf16 v[36:39], v[192:195], v[56:59], v[36:39]
    v_mfma_f32_16x16x32_bf16 v[40:43], a[8:11], v[56:59], v[40:43]
    v_mfma_f32_16x16x32_bf16 v[44:47], a[80:83], v[56:59], v[44:47]
    v_mfma_f32_16x16x32_bf16 v[48:51], v[56:59], a[152:155], v[48:51]
    v_mfma_f32_16x16x32_bf16 v[52:55], v[56:59], a[224:227], v[52:55]
    v_mfma_f32_16x16x32_bf16 v[36:39], v[196:199], v[56:59], v[36:39]
    v_mfma_f32_16x16x32_bf16 v[40:43], a[12:15], v[56:59], v[40:43]
    v_mfma_f32_16x16x32_bf16 v[44:47], a[84:87], v[56:59], v[44:47]
    v_mfma_f32_16x16x32_bf16 v[48:51], v[56:59], a[156:159], v[48:51]
    v_mfma_f32_16x16x32_bf16 v[52:55], v[56:59], a[228:231], v[52:55]
    v_mfma_f32_16x16x32_bf16 v[36:39], v[200:203], v[56:59], v[36:39]
    v_mfma_f32_16x16x32_bf16 v[40:43], a[16:19], v[56:59], v[40:43]
    v_mfma_f32_16x16x32_bf16 v[44:47], a[88:91], v[56:59], v[44:47]
    v_mfma_f32_16x16x32_bf16 v[48:51], v[56:59], a[160:163], v[48:51]
    v_mfma_f32_16x16x32_bf16 v[52:55], v[56:59], a[232:235], v[52:55]
    v_mfma_f32_16x16x32_bf16 v[36:39], v[204:207], v[56:59], v[36:39]
    v_mfma_f32_16x16x32_bf16 v[40:43], a[20:23], v[56:59], v[40:43]
    v_mfma_f32_16x16x32_bf16 v[44:47], a[92:95], v[56:59], v[44:47]
    v_mfma_f32_16x16x32_bf16 v[48:51], v[56:59], a[164:167], v[48:51]
    v_mfma_f32_16x16x32_bf16 v[52:55], v[56:59], a[236:239], v[52:55]
    v_mfma_f32_16x16x32_bf16 v[36:39], v[208:211], v[56:59], v[36:39]
    v_mfma_f32_16x16x32_bf16 v[40:43], a[24:27], v[56:59], v[40:43]
    v_mfma_f32_16x16x32_bf16 v[44:47], a[96:99], v[56:59], v[44:47]
    v_mfma_f32_16x16x32_bf16 v[48:51], v[56:59], a[168:171], v[48:51]
    v_mfma_f32_16x16x32_bf16 v[52:55], v[56:59], a[240:243], v[52:55]
    v_mfma_f32_16x16x32_bf16 v[36:39], v[212:215], v[56:59], v[36:39]
    v_mfma_f32_16x16x32_bf16 v[40:43], a[28:31], v[56:59], v[40:43]
    v_mfma_f32_16x16x32_bf16 v[44:47], a[100:103], v[56:59], v[44:47]
    v_mfma_f32_16x16x32_bf16 v[48:51], v[56:59], a[172:175], v[48:51]
    v_mfma_f32_16x16x32_bf16 v[52:55], v[56:59], a[244:247], v[52:55]
    v_mfma_f32_16x16x32_bf16 v[36:39], v[216:219], v[56:59], v[36:39]
    v_mfma_f32_16x16x32_bf16 v[40:43], a[32:35], v[56:59], v[40:43]
    v_mfma_f32_16x16x32_bf16 v[44:47], a[104:107], v[56:59], v[44:47]
    v_mfma_f32_16x16x32_bf16 v[48:51], v[56:59], a[176:179], v[48:51]
    v_mfma_f32_16x16x32_bf16 v[52:55], v[56:59], a[248:251], v[52:55]
    v_mfma_f32_16x16x32_bf16 v[36:39], v[220:223], v[56:59], v[36:39]
    v_mfma_f32_16x16x32_bf16 v[40:43], a[36:39], v[56:59], v[40:43]
    v_mfma_f32_16x16x32_bf16 v[44:47], a[108:111], v[56:59], v[44:47]
    v_mfma_f32_16x16x32_bf16 v[48:51], v[56:59], a[180:183], v[48:51]
    v_mfma_f32_16x16x32_bf16 v[52:55], v[56:59], a[252:255], v[52:55]
    v_lshlrev_b32 v10, 5, v7
    s_lshl_b32 s17, s51, 4
    v_add_u32 v10, s17, v10
    v_mul_u32_u24 v6, 1536, v8
    v_add_u32 v10, v10, v6
    s_lshl_b32 s17, s14, 7
    s_add_u32 s17, s17, 73728
    v_lshl_add_u32 v11, v7, 3, s17
    v_lshl_add_u32 v12, v8, 5, s17
    v_lshlrev_b32 v13, 5, v7
    s_lshl_b32 s17, s51, 4
    v_add_u32 v13, s17, v13
    s_lshr_b32 s17, s50, 2
    s_add_u32 s17, s17, 64
    s_lshl_b32 s17, s17, 9
    s_and_b32 s18, s50, 3
    s_lshl_b32 s18, s18, 2
    s_add_u32 s17, s17, s18
    v_add_u32 v14, s17, v13
    v_lshrrev_b32 v5, 1, v8
    v_lshl_add_u32 v13, v5, 9, v13
    v_and_b32 v5, 1, v8
    v_lshl_add_u32 v13, v5, 3, v13
    s_lshl_b32 s17, s50, 10
    v_add_u32 v13, s17, v13
    s_lshl_b32 s49, s15, 7
    s_lshl_b32 s17, s14, 2
    s_add_u32 s49, s49, s17
    s_add_u32 s49, s49, 1536
    s_mov_b32 s52, 0x3eae1a93
    v_mov_b32 v6, 0xf149f2ca
    v_lshl_add_u32 v5, v8, 2, 0
    v_sub_u32 v5, v5, v7
    v_cmp_le_i32 vcc, 9, v5
    s_nop 1
    v_cndmask_b32 v72, v6, v4, vcc
    v_add_u32 v5, 7, v5
    v_cmp_ge_u32 vcc, 7, v5
    s_nop 1
    v_cndmask_b32 v76, v6, v4, vcc
    v_lshl_add_u32 v5, v8, 2, 1
    v_sub_u32 v5, v5, v7
    v_cmp_le_i32 vcc, 9, v5
    s_nop 1
    v_cndmask_b32 v73, v6, v4, vcc
    v_add_u32 v5, 7, v5
    v_cmp_ge_u32 vcc, 7, v5
    s_nop 1
    v_cndmask_b32 v77, v6, v4, vcc
    v_lshl_add_u32 v5, v8, 2, 2
    v_sub_u32 v5, v5, v7
    v_cmp_le_i32 vcc, 9, v5
    s_nop 1
    v_cndmask_b32 v74, v6, v4, vcc
    v_add_u32 v5, 7, v5
    v_cmp_ge_u32 vcc, 7, v5
    s_nop 1
    v_cndmask_b32 v78, v6, v4, vcc
    v_lshl_add_u32 v5, v8, 2, 3
    v_sub_u32 v5, v5, v7
    v_cmp_le_i32 vcc, 9, v5
    s_nop 1
    v_cndmask_b32 v75, v6, v4, vcc
    v_add_u32 v5, 7, v5
    v_cmp_ge_u32 vcc, 7, v5
    s_nop 1
    v_cndmask_b32 v79, v6, v4, vcc
    v_mov_b32 v112, 0
    v_mov_b32 v113, 0
    v_mov_b32 v114, 0
    v_mov_b32 v115, 0
    v_mov_b32 v136, 0
    v_mov_b32 v137, 0
    v_mov_b32 v138, 0
    v_mov_b32 v139, 0
    v_mov_b32 v140, 0
    v_mov_b32 v141, 0
    v_mov_b32 v142, 0
    v_mov_b32 v143, 0
    v_mov_b32 v116, 0x3f803f80
    v_mov_b32 v117, 0x3f803f80
    v_mov_b32 v118, 0x3f803f80
    v_mov_b32 v119, 0x3f803f80
    v_mov_b32 v131, 0
    v_mov_b32 v135, 0
    s_mov_b32 s36, s63
    s_mov_b32 s34, s63
    s_mul_i32 s58, s14, 9216
    s_mul_i32 s64, s63, 4718592
    s_add_u32 s64, s64, s58
    s_add_u32 s64, s64, 6291456
    s_mul_i32 s61, s63, 1441792
    s_add_u32 s61, s61, 0
    s_mov_b32 s37, 0
    s_mov_b32 s40, 36864
    s_mov_b32 s59, s58
    s_mov_b32 s43, 0
    s_mov_b32 s62, 1
    s_mov_b32 s28, s8
    s_mov_b32 s29, s9
    s_mov_b32 s30, 0
    s_mov_b32 s31, 0x00020000
    v_mov_b32 v110, 74752
    v_mov_b32 v5, -1
    ds_write_b32 v110, v5
    s_waitcnt lgkmcnt(0)
    s_cmp_lg_u32 s14, 0
    s_cbranch_scc1 Laq_inia_d
    v_mov_b32 v5, 40
    s_mov_b32 s16, 0
Laq_inia:
    global_load_dword v6, v5, s[12:13] sc1
    s_add_u32 s16, s16, 1
    s_cmp_gt_u32 s16, 100000
    s_cbranch_scc1 L_role_aq_abort
    s_waitcnt vmcnt(0)
    v_cmp_gt_u32 vcc, 72, v6
    s_nop 0
    s_cbranch_vccz Laq_inia_d
    s_sleep 8
    s_branch Laq_inia
Laq_inia_d:
    s_barrier
    s_cmp_eq_u32 s63, 0
    s_cbranch_scc1 Laq_ini_sk
    s_cmp_lg_u32 s14, 0
    s_cbranch_scc1 Laq_inib_d
    v_mov_b32 v5, 160
    s_mov_b32 s16, 0
Laq_inib:
    global_load_dword v6, v5, s[12:13] sc1
    s_add_u32 s16, s16, 1
    s_cmp_gt_u32 s16, 100000
    s_cbranch_scc1 L_role_aq_abort
    s_waitcnt vmcnt(0)
    v_cmp_gt_u32 vcc, 64, v6
    s_nop 0
    s_cbranch_vccz Laq_inib_d
    s_sleep 8
    s_branch Laq_inib
Laq_inib_d:
    s_barrier
Laq_ini_sk:
    s_mul_i32 s41, s37, 36864
    s_add_u32 s41, s41, s64
    s_mul_i32 s60, s37, 22528
    s_add_u32 s60, s60, s61
    s_cmp_lt_u32 s37, 64
    s_cselect_b32 s60, s60, 2883584
    s_branch Laq_wait
Laq_head:
    s_waitcnt vmcnt(2)
Laq_head2:
    s_barrier
    ds_read_b32 v15, v110
    s_xor_b32 s40, s40, 36864
    s_xor_b32 s59, s59, 36864
    s_mov_b32 s35, s37
    s_lshl_b32 s57, s34, 6
    s_add_u32 s57, s57, s35
    s_add_u32 s37, s37, 1
    s_mov_b32 s39, 0
    s_mov_b32 s54, 0
    s_mul_i32 s41, s37, 36864
    s_add_u32 s41, s41, s64
    s_mul_i32 s60, s37, 22528
    s_add_u32 s60, s60, s61
    s_cmp_lt_u32 s37, 64
    s_cselect_b32 s60, s60, 2883584
    v_lshlrev_b32 v9, 9, v8
    v_lshl_add_u32 v9, v7, 5, v9
    s_lshl_b32 s17, s51, 4
    s_add_u32 s17, s17, s40
    v_add_u32 v9, s17, v9
    ds_read_b128 v[56:59], v9 offset:0
    ds_read_b128 v[60:63], v9 offset:2048
    ds_read_b128 v[64:67], v9 offset:4096
    s_waitcnt lgkmcnt(2)
    v_mfma_f32_16x16x32_bf16 v[16:19], v[152:155], v[56:59], 0
    v_add_f32 v80, v80, v84
    v_mfma_f32_16x16x32_bf16 v[20:23], v[224:227], v[56:59], 0
    v_add_f32 v81, v81, v85
    v_mfma_f32_16x16x32_bf16 v[24:27], a[40:43], v[56:59], 0
    v_add_f32 v82, v82, v86
    ds_read_b128 v[56:59], v9 offset:6144
    s_waitcnt lgkmcnt(2)
    v_mfma_f32_16x16x32_bf16 v[16:19], v[156:159], v[60:63], v[16:19]
    v_add_f32 v83, v83, v87
    v_mfma_f32_16x16x32_bf16 v[20:23], v[228:231], v[60:63], v[20:23]
    v_add_f32 v80, v80, v88
    v_mfma_f32_16x16x32_bf16 v[24:27], a[44:47], v[60:63], v[24:27]
    v_add_f32 v81, v81, v89
    v_readfirstlane_b32 s17, v15
    s_nop 0
    s_add_u32 s18, s17, 1
    s_max_i32 s32, s18, s37
    s_add_u32 s39, s37, 1
    s_min_u32 s39, s39, 63
    s_mul_i32 s33, s32, 22528
    s_add_u32 s33, s33, s61
    s_cmp_eq_u32 s14, 0
    s_cselect_b32 s18, s32, 0x7fff
    v_mov_b32 v2, 2
    s_cmp_le_u32 s18, s39
    s_cselect_b64 exec, -1, 0
    buffer_load_dword v2, v1, s[8:11], s33 offen sc1
    s_mov_b64 exec, -1
    s_cmp_ge_i32 s17, s37
    s_cbranch_scc1 Laq_f_7
    ds_read_b128 v[60:63], v9 offset:8192
    s_waitcnt lgkmcnt(2)
    v_mfma_f32_16x16x32_bf16 v[16:19], v[160:163], v[64:67], v[16:19]
    v_add_f32 v82, v82, v90
    v_mfma_f32_16x16x32_bf16 v[20:23], v[232:235], v[64:67], v[20:23]
    v_add_f32 v83, v83, v91
    v_mfma_f32_16x16x32_bf16 v[24:27], a[48:51], v[64:67], v[24:27]
    v_add_f32 v80, v80, v82
    ds_read_b128 v[64:67], v9 offset:10240
    s_waitcnt lgkmcnt(2)
    v_mfma_f32_16x16x32_bf16 v[16:19], v[164:167], v[56:59], v[16:19]
    v_add_f32 v81, v81, v83
    v_mfma_f32_16x16x32_bf16 v[20:23], v[236:239], v[56:59], v[20:23]
    v_mov_b32 v82, v80
    v_mfma_f32_16x16x32_bf16 v[24:27], a[52:55], v[56:59], v[24:27]
    v_mov_b32 v83, v81
    ds_read_b128 v[56:59], v9 offset:12288
    s_waitcnt lgkmcnt(2)
    v_mfma_f32_16x16x32_bf16 v[16:19], v[168:171], v[60:63], v[16:19]
    v_permlane32_swap_b32 v80, v82
    v_mfma_f32_16x16x32_bf16 v[20:23], v[240:243], v[60:63], v[20:23]
    v_permlane32_swap_b32 v81, v83
    v_mfma_f32_16x16x32_bf16 v[24:27], a[56:59], v[60:63], v[24:27]
    v_add_f32 v80, v80, v82
    ds_read_b128 v[60:63], v9 offset:14336
    s_waitcnt lgkmcnt(2)
    v_mfma_f32_16x16x32_bf16 v[16:19], v[172:175], v[64:67], v[16:19]
    v_add_f32 v81, v81, v83
    v_mfma_f32_16x16x32_bf16 v[20:23], v[244:247], v[64:67], v[20:23]
    v_mov_b32 v82, v80
    v_mfma_f32_16x16x32_bf16 v[24:27], a[60:63], v[64:67], v[24:27]
    v_mov_b32 v83, v81
    ds_read_b128 v[64:67], v9 offset:16384
    s_waitcnt lgkmcnt(2)
    v_mfma_f32_16x16x32_bf16 v[16:19], v[176:179], v[56:59], v[16:19]
    v_permlane16_swap_b32 v80, v82
    v_mfma_f32_16x16x32_bf16 v[20:23], v[248:251], v[56:59], v[20:23]
    v_permlane16_swap_b32 v81, v83
    v_mfma_f32_16x16x32_bf16 v[24:27], a[64:67], v[56:59], v[24:27]
    v_add_f32 v80, v80, v82
    ds_read_b128 v[56:59], v9 offset:18432
    s_waitcnt lgkmcnt(2)
    v_mfma_f32_16x16x32_bf16 v[16:19], v[180:183], v[60:63], v[16:19]
    v_add_f32 v81, v81, v83
    v_mfma_f32_16x16x32_bf16 v[20:23], v[252:255], v[60:63], v[20:23]
    v_mul_f32 v80, 0x3ae38e39, v80
    v_mfma_f32_16x16x32_bf16 v[24:27], a[68:71], v[60:63], v[24:27]
    v_mul_f32 v81, 0x3ae38e39, v81
    ds_read_b128 v[60:63], v9 offset:20480
    s_waitcnt lgkmcnt(2)
    v_mfma_f32_16x16x32_bf16 v[16:19], v[184:187], v[64:67], v[16:19]
    v_fma_f32 v81, -v80, v80, v81
    v_mfma_f32_16x16x32_bf16 v[20:23], a[0:3], v[64:67], v[20:23]
    v_max_f32 v81, 0, v81
    v_mfma_f32_16x16x32_bf16 v[24:27], a[72:75], v[64:67], v[24:27]
    v_add_f32 v81, 0x3727c5ac, v81
    ds_read_b128 v[64:67], v9 offset:22528
    s_waitcnt lgkmcnt(2)
    v_mfma_f32_16x16x32_bf16 v[16:19], v[188:191], v[56:59], v[16:19]
    v_rsq_f32 v92, v81
    v_mfma_f32_16x16x32_bf16 v[20:23], a[4:7], v[56:59], v[20:23]
    v_mul_f32 v93, v80, v92
    v_mfma_f32_16x16x32_bf16 v[24:27], a[76:79], v[56:59], v[24:27]
    ds_write_b64 v11, v[92:93]
    ds_read_b128 v[56:59], v9 offset:24576
    s_waitcnt lgkmcnt(3)
    v_mfma_f32_16x16x32_bf16 v[16:19], v[192:195], v[60:63], v[16:19]
    ds_read_b128 v[96:99], v12
    v_mfma_f32_16x16x32_bf16 v[20:23], a[8:11], v[60:63], v[20:23]
    ds_read_b128 v[100:103], v12 offset:16
    v_mfma_f32_16x16x32_bf16 v[24:27], a[80:83], v[60:63], v[24:27]
    ds_read_b128 v[60:63], v9 offset:26624
    s_waitcnt lgkmcnt(5)
    v_mfma_f32_16x16x32_bf16 v[16:19], v[196:199], v[64:67], v[16:19]
    v_mfma_f32_16x16x32_bf16 v[20:23], a[12:15], v[64:67], v[20:23]
    v_mfma_f32_16x16x32_bf16 v[24:27], a[84:87], v[64:67], v[24:27]
    ds_read_b128 v[64:67], v9 offset:28672
    s_waitcnt lgkmcnt(4)
    v_mfma_f32_16x16x32_bf16 v[16:19], v[200:203], v[56:59], v[16:19]
    v_mfma_f32_16x16x32_bf16 v[20:23], a[16:19], v[56:59], v[20:23]
    v_mfma_f32_16x16x32_bf16 v[24:27], a[88:91], v[56:59], v[24:27]
    ds_read_b128 v[56:59], v9 offset:30720
    s_waitcnt lgkmcnt(2)
    v_mfma_f32_16x16x32_bf16 v[16:19], v[204:207], v[60:63], v[16:19]
    v_mfma_f32_16x16x32_bf16 v[20:23], a[20:23], v[60:63], v[20:23]
    v_mfma_f32_16x16x32_bf16 v[24:27], a[92:95], v[60:63], v[24:27]
    ds_read_b128 v[60:63], v9 offset:32768
    s_waitcnt lgkmcnt(2)
    v_mfma_f32_16x16x32_bf16 v[16:19], v[208:211], v[64:67], v[16:19]
    v_mfma_f32_16x16x32_bf16 v[20:23], a[24:27], v[64:67], v[20:23]
    v_mfma_f32_16x16x32_bf16 v[24:27], a[96:99], v[64:67], v[24:27]
    s_waitcnt vmcnt(1)
    s_cmp_lg_u32 s43, 0
    s_cselect_b64 exec, 1, 0
    buffer_store_dword v3, v4, s[8:11], s43 offen sc1
    s_mov_b64 exec, -1
    s_mov_b32 s43, 0
    ds_read_b128 v[64:67], v9 offset:34816
    s_waitcnt lgkmcnt(2)
    v_mfma_f32_16x16x32_bf16 v[16:19], v[212:215], v[56:59], v[16:19]
    v_cmp_eq_u32 s[76:77], 1, v2
    v_cmp_eq_u32 vcc, 2, v2
    v_mfma_f32_16x16x32_bf16 v[20:23], a[28:31], v[56:59], v[20:23]
    s_cmp_eq_u64 s[76:77], -1
    s_cselect_b32 s38, 1, 0
    v_mfma_f32_16x16x32_bf16 v[24:27], a[100:103], v[56:59], v[24:27]
    s_cmp_lg_u32 s38, 0
    s_cselect_b64 exec, 1, 0
    v_mov_b32 v15, s32
    ds_write_b32 v110, v15
    v_mov_b32 v2, 2
    s_mov_b64 exec, -1
    ds_read_b128 v[56:59], v9 offset:0
    s_waitcnt lgkmcnt(3)
    v_mfma_f32_16x16x32_bf16 v[16:19], v[216:219], v[60:63], v[16:19]
    s_add_u32 s32, s32, s38
    s_mul_i32 s38, s38, 22528
    s_add_u32 s33, s33, s38
    v_mfma_f32_16x16x32_bf16 v[20:23], a[32:35], v[60:63], v[20:23]
    s_cmp_eq_u64 vcc, 0
    s_cselect_b32 s38, s32, 0x7fff
    v_mfma_f32_16x16x32_bf16 v[24:27], a[104:107], v[60:63], v[24:27]
    s_cmp_le_u32 s38, s39
    s_cselect_b64 exec, -1, 0
    v_mov_b32 v2, 2
    buffer_load_dword v2, v1, s[8:11], s33 offen sc1
    s_mov_b64 exec, -1
    ds_read_b128 v[60:63], v9 offset:2048
    s_waitcnt lgkmcnt(3)
    v_mfma_f32_16x16x32_bf16 v[16:19], v[220:223], v[64:67], v[16:19]
    v_mfma_f32_16x16x32_bf16 v[20:23], a[36:39], v[64:67], v[20:23]
    v_mfma_f32_16x16x32_bf16 v[24:27], a[108:111], v[64:67], v[24:27]
    ds_read_b32 v15, v110
    ds_read_b128 v[64:67], v9 offset:4096
    s_waitcnt lgkmcnt(3)
    v_mfma_f32_16x16x32_bf16 v[28:31], v[56:59], a[112:115], 0
    v_mfma_f32_16x16x32_bf16 v[32:35], v[56:59], a[184:187], 0
    ds_read_b128 v[56:59], v9 offset:6144
    s_waitcnt lgkmcnt(3)
    v_mfma_f32_16x16x32_bf16 v[28:31], v[60:63], a[116:119], v[28:31]
    v_mul_f32 v94, v93, v36
    v_fma_f32 v16, v16, v92, -v94
    v_mfma_f32_16x16x32_bf16 v[32:35], v[60:63], a[188:191], v[32:35]
    v_mul_f32 v94, v93, v37
    v_fma_f32 v17, v17, v92, -v94
    s_waitcnt lgkmcnt(2)
    v_readfirstlane_b32 s17, v15
    s_nop 0
    s_cmp_ge_i32 s17, s37
    s_cbranch_scc1 Laq_f_8
    ds_read_b128 v[60:63], v9 offset:8192
    s_waitcnt lgkmcnt(2)
    v_mfma_f32_16x16x32_bf16 v[28:31], v[64:67], a[120:123], v[28:31]
    v_mul_f32 v94, v93, v38
    v_fma_f32 v18, v18, v92, -v94
    v_mfma_f32_16x16x32_bf16 v[32:35], v[64:67], a[192:195], v[32:35]
    v_mul_f32 v94, v93, v39
    v_fma_f32 v19, v19, v92, -v94
    ds_read_b128 v[64:67], v9 offset:10240
    s_waitcnt lgkmcnt(2)
    v_mfma_f32_16x16x32_bf16 v[28:31], v[56:59], a[124:127], v[28:31]
    v_mul_f32 v94, v93, v44
    v_fma_f32 v24, v24, v92, -v94
    v_mfma_f32_16x16x32_bf16 v[32:35], v[56:59], a[196:199], v[32:35]
    v_mul_f32 v94, v93, v45
    v_fma_f32 v25, v25, v92, -v94
    ds_read_b128 v[56:59], v9 offset:12288
    s_waitcnt lgkmcnt(2)
    v_mfma_f32_16x16x32_bf16 v[28:31], v[60:63], a[128:131], v[28:31]
    v_mul_f32 v94, v93, v46
    v_fma_f32 v26, v26, v92, -v94
    v_mfma_f32_16x16x32_bf16 v[32:35], v[60:63], a[200:203], v[32:35]
    v_mul_f32 v94, v93, v47
    v_fma_f32 v27, v27, v92, -v94
    ds_read_b128 v[60:63], v9 offset:14336
    s_waitcnt lgkmcnt(2)
    v_mfma_f32_16x16x32_bf16 v[28:31], v[64:67], a[132:135], v[28:31]
    v_mul_f32 v94, v93, v40
    v_fma_f32 v20, v20, v92, -v94
    v_mfma_f32_16x16x32_bf16 v[32:35], v[64:67], a[204:207], v[32:35]
    v_mul_f32 v94, v93, v41
    v_fma_f32 v21, v21, v92, -v94
    ds_read_b128 v[64:67], v9 offset:16384
    s_waitcnt lgkmcnt(2)
    v_mfma_f32_16x16x32_bf16 v[28:31], v[56:59], a[136:139], v[28:31]
    v_mul_f32 v94, v93, v42
    v_fma_f32 v22, v22, v92, -v94
    v_mfma_f32_16x16x32_bf16 v[32:35], v[56:59], a[208:211], v[32:35]
    v_mul_f32 v94, v93, v43
    v_fma_f32 v23, v23, v92, -v94
    ds_read_b128 v[56:59], v9 offset:18432
    s_waitcnt lgkmcnt(2)
    v_mfma_f32_16x16x32_bf16 v[28:31], v[60:63], a[140:143], v[28:31]
    v_cvt_pk_bf16_f32 v128, v16, v17
    v_cvt_pk_bf16_f32 v129, v18, v19
    v_mfma_f32_16x16x32_bf16 v[32:35], v[60:63], a[212:215], v[32:35]
    v_cvt_pk_bf16_f32 v130, v24, v25
    v_cvt_pk_bf16_f32 v132, v20, v21
    ds_read_b128 v[60:63], v9 offset:20480
    s_waitcnt lgkmcnt(2)
    v_mfma_f32_16x16x32_bf16 v[28:31], v[64:67], a[144:147], v[28:31]
    v_cvt_pk_bf16_f32 v133, v22, v23
    v_cvt_pk_bf16_f32 v134, v26, v27
    v_mfma_f32_16x16x32_bf16 v[32:35], v[64:67], a[216:219], v[32:35]
    s_cmp_eq_u32 s35, 0
    s_cselect_b32 s46, 0xf149f2ca, 0
    ds_read_b128 v[64:67], v9 offset:22528
    s_waitcnt lgkmcnt(2)
    v_mfma_f32_16x16x32_bf16 v[28:31], v[56:59], a[148:151], v[28:31]
    v_mfma_f32_16x16x32_bf16 v[144:147], v[112:115], v[128:131], 0
    v_mfma_f32_16x16x32_bf16 v[32:35], v[56:59], a[220:223], v[32:35]
    v_mfma_f32_16x16x32_bf16 v[148:151], v[132:135], v[128:131], 0
    ds_read_b128 v[56:59], v9 offset:24576
    s_waitcnt lgkmcnt(2)
    v_mfma_f32_16x16x32_bf16 v[28:31], v[60:63], a[152:155], v[28:31]
    v_mov_b32 v112, v132
    v_mfma_f32_16x16x32_bf16 v[32:35], v[60:63], a[224:227], v[32:35]
    v_mov_b32 v113, v133
    v_mov_b32 v114, v134
    ds_read_b128 v[60:63], v9 offset:26624
    s_waitcnt lgkmcnt(2)
    v_mfma_f32_16x16x32_bf16 v[28:31], v[64:67], a[156:159], v[28:31]
    v_mfma_f32_16x16x32_bf16 v[32:35], v[64:67], a[228:231], v[32:35]
    v_fma_f32 v144, v144, s52, v72
    ds_read_b128 v[64:67], v9 offset:28672
    s_waitcnt lgkmcnt(2)
    v_mfma_f32_16x16x32_bf16 v[28:31], v[56:59], a[160:163], v[28:31]
    v_fma_f32 v145, v145, s52, v73
    v_fma_f32 v146, v146, s52, v74
    v_fma_f32 v147, v147, s52, v75
    v_mfma_f32_16x16x32_bf16 v[32:35], v[56:59], a[232:235], v[32:35]
    v_fma_f32 v148, v148, s52, v76
    v_fma_f32 v149, v149, s52, v77
    v_fma_f32 v150, v150, s52, v78
    ds_read_b128 v[56:59], v9 offset:30720
    s_waitcnt lgkmcnt(2)
    v_mfma_f32_16x16x32_bf16 v[28:31], v[60:63], a[164:167], v[28:31]
    v_fma_f32 v151, v151, s52, v79
    v_add_f32 v144, s46, v144
    v_add_f32 v145, s46, v145
    v_mfma_f32_16x16x32_bf16 v[32:35], v[60:63], a[236:239], v[32:35]
    v_add_f32 v146, s46, v146
    v_add_f32 v147, s46, v147
    v_max3_f32 v5, v144, v145, v146
    ds_read_b128 v[60:63], v9 offset:32768
    s_waitcnt lgkmcnt(2)
    v_mfma_f32_16x16x32_bf16 v[28:31], v[64:67], a[168:171], v[28:31]
    v_max3_f32 v5, v5, v147, v148
    v_max3_f32 v5, v5, v149, v150
    v_max_f32 v5, v5, v151
    v_mfma_f32_16x16x32_bf16 v[32:35], v[64:67], a[240:243], v[32:35]
    v_mov_b32 v6, v5
    s_nop 1
    v_permlane32_swap_b32 v5, v6
    ds_read_b128 v[64:67], v9 offset:34816
    s_waitcnt lgkmcnt(2)
    v_mfma_f32_16x16x32_bf16 v[28:31], v[56:59], a[172:175], v[28:31]
    v_max_f32 v5, v5, v6
    v_mov_b32 v6, v5
    v_mfma_f32_16x16x32_bf16 v[32:35], v[56:59], a[244:247], v[32:35]
    s_nop 0
    v_permlane16_swap_b32 v5, v6
    v_max_f32 v5, v5, v6
    v_sub_f32 v144, v144, v5
    s_waitcnt lgkmcnt(1)
    v_mfma_f32_16x16x32_bf16 v[28:31], v[60:63], a[176:179], v[28:31]
    v_sub_f32 v145, v145, v5
    v_sub_f32 v146, v146, v5
    v_sub_f32 v147, v147, v5
    v_mfma_f32_16x16x32_bf16 v[32:35], v[60:63], a[248:251], v[32:35]
    v_sub_f32 v148, v148, v5
    v_sub_f32 v149, v149, v5
    v_sub_f32 v150, v150, v5
    s_waitcnt lgkmcnt(0)
    v_mfma_f32_16x16x32_bf16 v[28:31], v[64:67], a[180:183], v[28:31]
    v_sub_f32 v151, v151, v5
    v_exp_f32 v144, v144
    v_exp_f32 v145, v145
    v_mfma_f32_16x16x32_bf16 v[32:35], v[64:67], a[252:255], v[32:35]
    v_exp_f32 v146, v146
    v_exp_f32 v147, v147
    v_exp_f32 v148, v148
    v_cmp_eq_u32 s[76:77], 1, v2
    v_cmp_eq_u32 vcc, 2, v2
    s_cmp_eq_u64 s[76:77], -1
    s_cselect_b32 s38, 1, 0
    s_cmp_lg_u32 s38, 0
    s_cselect_b64 exec, 1, 0
    v_mov_b32 v15, s32
    ds_write_b32 v110, v15
    v_mov_b32 v2, 2
    s_mov_b64 exec, -1
    s_add_u32 s32, s32, s38
    s_mul_i32 s38, s38, 22528
    s_add_u32 s33, s33, s38
    s_cmp_eq_u64 vcc, 0
    s_cselect_b32 s38, s32, 0x7fff
    s_cmp_le_u32 s38, s39
    s_cselect_b64 exec, -1, 0
    v_mov_b32 v2, 2
    buffer_load_dword v2, v1, s[8:11], s33 offen sc1
    s_mov_b64 exec, -1
    v_exp_f32 v149, v149
    v_exp_f32 v150, v150
    v_exp_f32 v151, v151
    v_cvt_pk_bf16_f32 v68, v144, v145
    v_cvt_pk_bf16_f32 v69, v146, v147
    v_cvt_pk_bf16_f32 v70, v148, v149
    v_cvt_pk_bf16_f32 v71, v150, v151
    s_nop 1
    v_mfma_f32_16x16x32_bf16 v[16:19], v[116:119], v[68:71], 0
    s_mul_i32 s46, s57, 36864
    s_add_u32 s46, s46, 17301504
    s_nop 5
    v_rcp_f32 v6, v16
    v_mul_f32 v94, v97, v48
    v_fma_f32 v28, v28, v96, -v94
    v_mul_f32 v94, v99, v49
    v_fma_f32 v29, v29, v98, -v94
    v_mul_f32 v94, v101, v50
    v_fma_f32 v30, v30, v100, -v94
    v_mul_f32 v94, v103, v51
    v_fma_f32 v31, v31, v102, -v94
    v_cvt_pk_bf16_f32 v138, v28, v29
    v_cvt_pk_bf16_f32 v139, v30, v31
    v_mul_f32 v94, v97, v52
    v_fma_f32 v32, v32, v96, -v94
    v_mfma_f32_16x16x32_bf16 v[20:23], v[136:139], v[68:71], 0
    v_mul_f32 v94, v99, v53
    v_fma_f32 v33, v33, v98, -v94
    v_mul_f32 v94, v101, v54
    v_fma_f32 v34, v34, v100, -v94
    v_mul_f32 v94, v103, v55
    v_fma_f32 v35, v35, v102, -v94
    v_cvt_pk_bf16_f32 v142, v32, v33
    v_cvt_pk_bf16_f32 v143, v34, v35
    v_mov_b32 v136, v138
    v_mov_b32 v137, v139
    v_mfma_f32_16x16x32_bf16 v[24:27], v[140:143], v[68:71], 0
    v_mul_f32 v20, v6, v20
    v_mul_f32 v21, v6, v21
    v_mul_f32 v22, v6, v22
    v_mul_f32 v23, v6, v23
    v_cvt_pk_bf16_f32 v20, v20, v21
    v_cvt_pk_bf16_f32 v21, v22, v23
    buffer_store_dwordx2 v[20:21], v13, s[8:11], s46 offen sc1
    v_mov_b32 v140, v142
    v_mov_b32 v141, v143
    v_mul_f32 v24, v6, v24
    v_mul_f32 v25, v6, v25
    v_cvt_pk_bf16_f32 v24, v24, v25
    s_mov_b64 exec, 0xffff
    buffer_store_dword v24, v14, s[8:11], s46 offen sc1
    s_mov_b64 exec, -1
    s_mul_i32 s43, s57, 22528
    s_add_u32 s43, s43, s49
    s_branch Laq_none
Laq_f_7:
    ds_read_b128 v[60:63], v9 offset:8192
    s_waitcnt lgkmcnt(2)
    v_mfma_f32_16x16x32_bf16 v[16:19], v[160:163], v[64:67], v[16:19]
    v_add_f32 v82, v82, v90
    v_mfma_f32_16x16x32_bf16 v[20:23], v[232:235], v[64:67], v[20:23]
    v_add_f32 v83, v83, v91
    v_mfma_f32_16x16x32_bf16 v[24:27], a[48:51], v[64:67], v[24:27]
    v_add_f32 v80, v80, v82
    ds_read_b128 v[64:67], v9 offset:10240
    s_waitcnt lgkmcnt(2)
    v_mfma_f32_16x16x32_bf16 v[16:19], v[164:167], v[56:59], v[16:19]
    v_add_f32 v81, v81, v83
    v_mfma_f32_16x16x32_bf16 v[20:23], v[236:239], v[56:59], v[20:23]
    v_mov_b32 v82, v80
    v_mfma_f32_16x16x32_bf16 v[24:27], a[52:55], v[56:59], v[24:27]
    v_mov_b32 v83, v81
    ds_read_b128 v[56:59], v9 offset:12288
    s_waitcnt lgkmcnt(2)
    v_mfma_f32_16x16x32_bf16 v[16:19], v[168:171], v[60:63], v[16:19]
    v_permlane32_swap_b32 v80, v82
    v_mfma_f32_16x16x32_bf16 v[20:23], v[240:243], v[60:63], v[20:23]
    v_permlane32_swap_b32 v81, v83
    v_mfma_f32_16x16x32_bf16 v[24:27], a[56:59], v[60:63], v[24:27]
    v_add_f32 v80, v80, v82
    ds_read_b128 v[60:63], v9 offset:14336
    s_waitcnt lgkmcnt(2)
    v_mfma_f32_16x16x32_bf16 v[16:19], v[172:175], v[64:67], v[16:19]
    v_add_f32 v81, v81, v83
    v_mfma_f32_16x16x32_bf16 v[20:23], v[244:247], v[64:67], v[20:23]
    v_mov_b32 v82, v80
    v_mfma_f32_16x16x32_bf16 v[24:27], a[60:63], v[64:67], v[24:27]
    v_mov_b32 v83, v81
    ds_read_b128 v[64:67], v9 offset:16384
    s_waitcnt lgkmcnt(2)
    v_mfma_f32_16x16x32_bf16 v[16:19], v[176:179], v[56:59], v[16:19]
    v_permlane16_swap_b32 v80, v82
    v_mfma_f32_16x16x32_bf16 v[20:23], v[248:251], v[56:59], v[20:23]
    v_permlane16_swap_b32 v81, v83
    v_mfma_f32_16x16x32_bf16 v[24:27], a[64:67], v[56:59], v[24:27]
    v_add_f32 v80, v80, v82
    ds_read_b128 v[56:59], v9 offset:18432
    s_waitcnt lgkmcnt(2)
    v_mfma_f32_16x16x32_bf16 v[16:19], v[180:183], v[60:63], v[16:19]
    v_add_f32 v81, v81, v83
    v_mfma_f32_16x16x32_bf16 v[20:23], v[252:255], v[60:63], v[20:23]
    v_mul_f32 v80, 0x3ae38e39, v80
    v_mfma_f32_16x16x32_bf16 v[24:27], a[68:71], v[60:63], v[24:27]
    v_mul_f32 v81, 0x3ae38e39, v81
    ds_read_b128 v[60:63], v9 offset:20480
    s_waitcnt lgkmcnt(2)
    v_mfma_f32_16x16x32_bf16 v[16:19], v[184:187], v[64:67], v[16:19]
    v_fma_f32 v81, -v80, v80, v81
    v_mfma_f32_16x16x32_bf16 v[20:23], a[0:3], v[64:67], v[20:23]
    v_max_f32 v81, 0, v81
    v_mfma_f32_16x16x32_bf16 v[24:27], a[72:75], v[64:67], v[24:27]
    v_add_f32 v81, 0x3727c5ac, v81
    ds_read_b128 v[64:67], v9 offset:22528
    s_waitcnt lgkmcnt(2)
    v_mfma_f32_16x16x32_bf16 v[16:19], v[188:191], v[56:59], v[16:19]
    v_rsq_f32 v92, v81
    v_mfma_f32_16x16x32_bf16 v[20:23], a[4:7], v[56:59], v[20:23]
    v_mul_f32 v93, v80, v92
    v_mfma_f32_16x16x32_bf16 v[24:27], a[76:79], v[56:59], v[24:27]
    ds_write_b64 v11, v[92:93]
    ds_read_b128 v[56:59], v9 offset:24576
    s_waitcnt lgkmcnt(3)
    v_mfma_f32_16x16x32_bf16 v[16:19], v[192:195], v[60:63], v[16:19]
    ds_read_b128 v[96:99], v12
    v_mfma_f32_16x16x32_bf16 v[20:23], a[8:11], v[60:63], v[20:23]
    ds_read_b128 v[100:103], v12 offset:16
    v_mfma_f32_16x16x32_bf16 v[24:27], a[80:83], v[60:63], v[24:27]
    s_add_u32 m0, s59, 0
    s_add_u32 s47, s41, 0
    buffer_load_dwordx4 v0, s[8:11], s47 offen offset:0 lds
    ds_read_b128 v[60:63], v9 offset:26624
    s_waitcnt lgkmcnt(5)
    v_mfma_f32_16x16x32_bf16 v[16:19], v[196:199], v[64:67], v[16:19]
    buffer_load_dwordx4 v0, s[8:11], s47 offen offset:1024 lds
    buffer_load_dwordx4 v0, s[8:11], s47 offen offset:2048 lds
    buffer_load_dwordx4 v0, s[8:11], s47 offen offset:3072 lds
    v_mfma_f32_16x16x32_bf16 v[20:23], a[12:15], v[64:67], v[20:23]
    s_add_u32 m0, s59, 4096
    s_add_u32 s47, s41, 4096
    buffer_load_dwordx4 v0, s[8:11], s47 offen offset:0 lds
    v_mfma_f32_16x16x32_bf16 v[24:27], a[84:87], v[64:67], v[24:27]
    buffer_load_dwordx4 v0, s[8:11], s47 offen offset:1024 lds
    buffer_load_dwordx4 v0, s[8:11], s47 offen offset:2048 lds
    buffer_load_dwordx4 v0, s[8:11], s47 offen offset:3072 lds
    ds_read_b128 v[64:67], v9 offset:28672
    s_waitcnt lgkmcnt(4)
    v_mfma_f32_16x16x32_bf16 v[16:19], v[200:203], v[56:59], v[16:19]
    s_add_u32 m0, s59, 8192
    s_add_u32 s47, s41, 8192
    buffer_load_dwordx4 v0, s[8:11], s47 offen offset:0 lds
    v_mfma_f32_16x16x32_bf16 v[20:23], a[16:19], v[56:59], v[20:23]
    v_mfma_f32_16x16x32_bf16 v[24:27], a[88:91], v[56:59], v[24:27]
    ds_read_b128 v[56:59], v9 offset:30720
    s_waitcnt lgkmcnt(2)
    v_mfma_f32_16x16x32_bf16 v[16:19], v[204:207], v[60:63], v[16:19]
    v_mfma_f32_16x16x32_bf16 v[20:23], a[20:23], v[60:63], v[20:23]
    v_mfma_f32_16x16x32_bf16 v[24:27], a[92:95], v[60:63], v[24:27]
    ds_read_b128 v[60:63], v9 offset:32768
    s_waitcnt lgkmcnt(2)
    v_mfma_f32_16x16x32_bf16 v[16:19], v[208:211], v[64:67], v[16:19]
    v_mfma_f32_16x16x32_bf16 v[20:23], a[24:27], v[64:67], v[20:23]
    v_mfma_f32_16x16x32_bf16 v[24:27], a[96:99], v[64:67], v[24:27]
    s_waitcnt vmcnt(10)
    s_cmp_lg_u32 s43, 0
    s_cselect_b64 exec, 1, 0
    buffer_store_dword v3, v4, s[8:11], s43 offen sc1
    s_mov_b64 exec, -1
    s_mov_b32 s43, 0
    ds_read_b128 v[64:67], v9 offset:34816
    s_waitcnt lgkmcnt(2)
    v_mfma_f32_16x16x32_bf16 v[16:19], v[212:215], v[56:59], v[16:19]
    v_cmp_eq_u32 s[76:77], 1, v2
    v_cmp_eq_u32 vcc, 2, v2
    v_mfma_f32_16x16x32_bf16 v[20:23], a[28:31], v[56:59], v[20:23]
    s_cmp_eq_u64 s[76:77], -1
    s_cselect_b32 s38, 1, 0
    v_mfma_f32_16x16x32_bf16 v[24:27], a[100:103], v[56:59], v[24:27]
    s_cmp_lg_u32 s38, 0
    s_cselect_b64 exec, 1, 0
    v_mov_b32 v15, s32
    ds_write_b32 v110, v15
    v_mov_b32 v2, 2
    s_mov_b64 exec, -1
    ds_read_b128 v[56:59], v9 offset:0
    s_waitcnt lgkmcnt(3)
    v_mfma_f32_16x16x32_bf16 v[16:19], v[216:219], v[60:63], v[16:19]
    s_add_u32 s32, s32, s38
    s_mul_i32 s38, s38, 22528
    s_add_u32 s33, s33, s38
    v_mfma_f32_16x16x32_bf16 v[20:23], a[32:35], v[60:63], v[20:23]
    s_cmp_eq_u64 vcc, 0
    s_cselect_b32 s38, s32, 0x7fff
    v_mfma_f32_16x16x32_bf16 v[24:27], a[104:107], v[60:63], v[24:27]
    s_cmp_le_u32 s38, s39
    s_cselect_b64 exec, -1, 0
    v_mov_b32 v2, 2
    buffer_load_dword v2, v1, s[8:11], s33 offen sc1
    s_mov_b64 exec, -1
    ds_read_b128 v[60:63], v9 offset:2048
    s_waitcnt lgkmcnt(3)
    v_mfma_f32_16x16x32_bf16 v[16:19], v[220:223], v[64:67], v[16:19]
    s_mul_i32 s48, s36, 786432
    s_mul_i32 s18, s37, 6144
    s_add_u32 s48, s48, s18
    s_add_u32 s48, s48, 15728640
    buffer_load_dwordx4 v[80:83], v10, s[8:11], s48 offen offset:0
    v_mfma_f32_16x16x32_bf16 v[20:23], a[36:39], v[64:67], v[20:23]
    v_mfma_f32_16x16x32_bf16 v[24:27], a[108:111], v[64:67], v[24:27]
    ds_read_b128 v[64:67], v9 offset:4096
    s_waitcnt lgkmcnt(2)
    v_mfma_f32_16x16x32_bf16 v[28:31], v[56:59], a[112:115], 0
    buffer_load_dwordx4 v[84:87], v10, s[8:11], s48 offen offset:512
    v_mfma_f32_16x16x32_bf16 v[32:35], v[56:59], a[184:187], 0
    ds_read_b128 v[56:59], v9 offset:6144
    s_waitcnt lgkmcnt(2)
    v_mfma_f32_16x16x32_bf16 v[28:31], v[60:63], a[116:119], v[28:31]
    buffer_load_dwordx4 v[88:91], v10, s[8:11], s48 offen offset:1024
    v_mul_f32 v94, v93, v36
    v_fma_f32 v16, v16, v92, -v94
    v_mfma_f32_16x16x32_bf16 v[32:35], v[60:63], a[188:191], v[32:35]
    v_mul_f32 v94, v93, v37
    v_fma_f32 v17, v17, v92, -v94
    ds_read_b128 v[60:63], v9 offset:8192
    s_waitcnt lgkmcnt(2)
    v_mfma_f32_16x16x32_bf16 v[28:31], v[64:67], a[120:123], v[28:31]
    v_mul_f32 v94, v93, v38
    v_fma_f32 v18, v18, v92, -v94
    v_mfma_f32_16x16x32_bf16 v[32:35], v[64:67], a[192:195], v[32:35]
    v_mul_f32 v94, v93, v39
    v_fma_f32 v19, v19, v92, -v94
    ds_read_b128 v[64:67], v9 offset:10240
    s_waitcnt lgkmcnt(2)
    v_mfma_f32_16x16x32_bf16 v[28:31], v[56:59], a[124:127], v[28:31]
    v_mul_f32 v94, v93, v44
    v_fma_f32 v24, v24, v92, -v94
    v_mfma_f32_16x16x32_bf16 v[32:35], v[56:59], a[196:199], v[32:35]
    v_mul_f32 v94, v93, v45
    v_fma_f32 v25, v25, v92, -v94
    ds_read_b128 v[56:59], v9 offset:12288
    s_waitcnt lgkmcnt(2)
    v_mfma_f32_16x16x32_bf16 v[28:31], v[60:63], a[128:131], v[28:31]
    v_mul_f32 v94, v93, v46
    v_fma_f32 v26, v26, v92, -v94
    v_mfma_f32_16x16x32_bf16 v[32:35], v[60:63], a[200:203], v[32:35]
    v_mul_f32 v94, v93, v47
    v_fma_f32 v27, v27, v92, -v94
    ds_read_b128 v[60:63], v9 offset:14336
    s_waitcnt lgkmcnt(2)
    v_mfma_f32_16x16x32_bf16 v[28:31], v[64:67], a[132:135], v[28:31]
    v_mul_f32 v94, v93, v40
    v_fma_f32 v20, v20, v92, -v94
    v_mfma_f32_16x16x32_bf16 v[32:35], v[64:67], a[204:207], v[32:35]
    v_mul_f32 v94, v93, v41
    v_fma_f32 v21, v21, v92, -v94
    ds_read_b128 v[64:67], v9 offset:16384
    s_waitcnt lgkmcnt(2)
    v_mfma_f32_16x16x32_bf16 v[28:31], v[56:59], a[136:139], v[28:31]
    v_mul_f32 v94, v93, v42
    v_fma_f32 v22, v22, v92, -v94
    v_mfma_f32_16x16x32_bf16 v[32:35], v[56:59], a[208:211], v[32:35]
    v_mul_f32 v94, v93, v43
    v_fma_f32 v23, v23, v92, -v94
    ds_read_b128 v[56:59], v9 offset:18432
    s_waitcnt lgkmcnt(2)
    v_mfma_f32_16x16x32_bf16 v[28:31], v[60:63], a[140:143], v[28:31]
    v_cvt_pk_bf16_f32 v128, v16, v17
    v_cvt_pk_bf16_f32 v129, v18, v19
    v_mfma_f32_16x16x32_bf16 v[32:35], v[60:63], a[212:215], v[32:35]
    v_cvt_pk_bf16_f32 v130, v24, v25
    v_cvt_pk_bf16_f32 v132, v20, v21
    ds_read_b128 v[60:63], v9 offset:20480
    s_waitcnt lgkmcnt(2)
    v_mfma_f32_16x16x32_bf16 v[28:31], v[64:67], a[144:147], v[28:31]
    v_cvt_pk_bf16_f32 v133, v22, v23
    v_cvt_pk_bf16_f32 v134, v26, v27
    v_mfma_f32_16x16x32_bf16 v[32:35], v[64:67], a[216:219], v[32:35]
    s_cmp_eq_u32 s35, 0
    s_cselect_b32 s46, 0xf149f2ca, 0
    ds_read_b128 v[64:67], v9 offset:22528
    s_waitcnt lgkmcnt(2)
    v_mfma_f32_16x16x32_bf16 v[28:31], v[56:59], a[148:151], v[28:31]
    v_mfma_f32_16x16x32_bf16 v[144:147], v[112:115], v[128:131], 0
    v_mfma_f32_16x16x32_bf16 v[32:35], v[56:59], a[220:223], v[32:35]
    v_mfma_f32_16x16x32_bf16 v[148:151], v[132:135], v[128:131], 0
    ds_read_b128 v[56:59], v9 offset:24576
    s_waitcnt lgkmcnt(2)
    v_mfma_f32_16x16x32_bf16 v[28:31], v[60:63], a[152:155], v[28:31]
    v_mov_b32 v112, v132
    v_mfma_f32_16x16x32_bf16 v[32:35], v[60:63], a[224:227], v[32:35]
    v_mov_b32 v113, v133
    v_mov_b32 v114, v134
    ds_read_b128 v[60:63], v9 offset:26624
    s_waitcnt lgkmcnt(2)
    v_mfma_f32_16x16x32_bf16 v[28:31], v[64:67], a[156:159], v[28:31]
    v_mfma_f32_16x16x32_bf16 v[32:35], v[64:67], a[228:231], v[32:35]
    v_fma_f32 v144, v144, s52, v72
    ds_read_b128 v[64:67], v9 offset:28672
    s_waitcnt lgkmcnt(2)
    v_mfma_f32_16x16x32_bf16 v[28:31], v[56:59], a[160:163], v[28:31]
    v_fma_f32 v145, v145, s52, v73
    v_fma_f32 v146, v146, s52, v74
    v_fma_f32 v147, v147, s52, v75
    v_mfma_f32_16x16x32_bf16 v[32:35], v[56:59], a[232:235], v[32:35]
    v_fma_f32 v148, v148, s52, v76
    v_fma_f32 v149, v149, s52, v77
    v_fma_f32 v150, v150, s52, v78
    ds_read_b128 v[56:59], v9 offset:30720
    s_waitcnt lgkmcnt(2)
    v_mfma_f32_16x16x32_bf16 v[28:31], v[60:63], a[164:167], v[28:31]
    v_fma_f32 v151, v151, s52, v79
    v_add_f32 v144, s46, v144
    v_add_f32 v145, s46, v145
    v_mfma_f32_16x16x32_bf16 v[32:35], v[60:63], a[236:239], v[32:35]
    v_add_f32 v146, s46, v146
    v_add_f32 v147, s46, v147
    v_max3_f32 v5, v144, v145, v146
    ds_read_b128 v[60:63], v9 offset:32768
    s_waitcnt lgkmcnt(2)
    v_mfma_f32_16x16x32_bf16 v[28:31], v[64:67], a[168:171], v[28:31]
    v_max3_f32 v5, v5, v147, v148
    v_max3_f32 v5, v5, v149, v150
    v_max_f32 v5, v5, v151
    v_mfma_f32_16x16x32_bf16 v[32:35], v[64:67], a[240:243], v[32:35]
    v_mov_b32 v6, v5
    s_nop 1
    v_permlane32_swap_b32 v5, v6
    ds_read_b128 v[64:67], v9 offset:34816
    s_waitcnt lgkmcnt(2)
    v_mfma_f32_16x16x32_bf16 v[28:31], v[56:59], a[172:175], v[28:31]
    v_max_f32 v5, v5, v6
    v_mov_b32 v6, v5
    v_mfma_f32_16x16x32_bf16 v[32:35], v[56:59], a[244:247], v[32:35]
    s_nop 0
    v_permlane16_swap_b32 v5, v6
    v_max_f32 v5, v5, v6
    v_sub_f32 v144, v144, v5
    s_waitcnt lgkmcnt(1)
    v_mfma_f32_16x16x32_bf16 v[28:31], v[60:63], a[176:179], v[28:31]
    v_sub_f32 v145, v145, v5
    v_sub_f32 v146, v146, v5
    v_sub_f32 v147, v147, v5
    v_mfma_f32_16x16x32_bf16 v[32:35], v[60:63], a[248:251], v[32:35]
    v_sub_f32 v148, v148, v5
    v_sub_f32 v149, v149, v5
    v_sub_f32 v150, v150, v5
    s_waitcnt lgkmcnt(0)
    v_mfma_f32_16x16x32_bf16 v[28:31], v[64:67], a[180:183], v[28:31]
    v_sub_f32 v151, v151, v5
    v_exp_f32 v144, v144
    v_exp_f32 v145, v145
    v_mfma_f32_16x16x32_bf16 v[32:35], v[64:67], a[252:255], v[32:35]
    v_exp_f32 v146, v146
    v_exp_f32 v147, v147
    v_exp_f32 v148, v148
    v_cmp_eq_u32 s[76:77], 1, v2
    v_cmp_eq_u32 vcc, 2, v2
    s_cmp_eq_u64 s[76:77], -1
    s_cselect_b32 s38, 1, 0
    s_cmp_lg_u32 s38, 0
    s_cselect_b64 exec, 1, 0
    v_mov_b32 v15, s32
    ds_write_b32 v110, v15
    v_mov_b32 v2, 2
    s_mov_b64 exec, -1
    s_add_u32 s32, s32, s38
    s_mul_i32 s38, s38, 22528
    s_add_u32 s33, s33, s38
    s_cmp_eq_u64 vcc, 0
    s_cselect_b32 s38, s32, 0x7fff
    s_cmp_le_u32 s38, s39
    s_cselect_b64 exec, -1, 0
    v_mov_b32 v2, 2
    buffer_load_dword v2, v1, s[8:11], s33 offen sc1
    s_mov_b64 exec, -1
    v_exp_f32 v149, v149
    v_exp_f32 v150, v150
    v_exp_f32 v151, v151
    v_cvt_pk_bf16_f32 v68, v144, v145
    v_cvt_pk_bf16_f32 v69, v146, v147
    v_cvt_pk_bf16_f32 v70, v148, v149
    v_cvt_pk_bf16_f32 v71, v150, v151
    s_nop 1
    v_mfma_f32_16x16x32_bf16 v[16:19], v[116:119], v[68:71], 0
    s_mul_i32 s46, s57, 36864
    s_add_u32 s46, s46, 17301504
    s_nop 5
    v_rcp_f32 v6, v16
    v_mul_f32 v94, v97, v48
    v_fma_f32 v28, v28, v96, -v94
    v_mul_f32 v94, v99, v49
    v_fma_f32 v29, v29, v98, -v94
    v_mul_f32 v94, v101, v50
    v_fma_f32 v30, v30, v100, -v94
    v_mul_f32 v94, v103, v51
    v_fma_f32 v31, v31, v102, -v94
    v_cvt_pk_bf16_f32 v138, v28, v29
    v_cvt_pk_bf16_f32 v139, v30, v31
    v_mul_f32 v94, v97, v52
    v_fma_f32 v32, v32, v96, -v94
    v_mfma_f32_16x16x32_bf16 v[20:23], v[136:139], v[68:71], 0
    v_mul_f32 v94, v99, v53
    v_fma_f32 v33, v33, v98, -v94
    v_mul_f32 v94, v101, v54
    v_fma_f32 v34, v34, v100, -v94
    v_mul_f32 v94, v103, v55
    v_fma_f32 v35, v35, v102, -v94
    v_cvt_pk_bf16_f32 v142, v32, v33
    v_cvt_pk_bf16_f32 v143, v34, v35
    v_mov_b32 v136, v138
    v_mov_b32 v137, v139
    v_mfma_f32_16x16x32_bf16 v[24:27], v[140:143], v[68:71], 0
    v_mul_f32 v20, v6, v20
    v_mul_f32 v21, v6, v21
    v_mul_f32 v22, v6, v22
    v_mul_f32 v23, v6, v23
    v_cvt_pk_bf16_f32 v20, v20, v21
    v_cvt_pk_bf16_f32 v21, v22, v23
    buffer_store_dwordx2 v[20:21], v13, s[8:11], s46 offen sc1
    v_mov_b32 v140, v142
    v_mov_b32 v141, v143
    v_mul_f32 v24, v6, v24
    v_mul_f32 v25, v6, v25
    v_cvt_pk_bf16_f32 v24, v24, v25
    s_mov_b64 exec, 0xffff
    buffer_store_dword v24, v14, s[8:11], s46 offen sc1
    s_mov_b64 exec, -1
    s_mul_i32 s43, s57, 22528
    s_add_u32 s43, s43, s49
    s_branch Laq_head
Laq_f_8:
    ds_read_b128 v[60:63], v9 offset:8192
    s_waitcnt lgkmcnt(2)
    v_mfma_f32_16x16x32_bf16 v[28:31], v[64:67], a[120:123], v[28:31]
    v_mul_f32 v94, v93, v38
    v_fma_f32 v18, v18, v92, -v94
    v_mfma_f32_16x16x32_bf16 v[32:35], v[64:67], a[192:195], v[32:35]
    v_mul_f32 v94, v93, v39
    v_fma_f32 v19, v19, v92, -v94
    ds_read_b128 v[64:67], v9 offset:10240
    s_waitcnt lgkmcnt(2)
    v_mfma_f32_16x16x32_bf16 v[28:31], v[56:59], a[124:127], v[28:31]
    v_mul_f32 v94, v93, v44
    v_fma_f32 v24, v24, v92, -v94
    v_mfma_f32_16x16x32_bf16 v[32:35], v[56:59], a[196:199], v[32:35]
    v_mul_f32 v94, v93, v45
    v_fma_f32 v25, v25, v92, -v94
    ds_read_b128 v[56:59], v9 offset:12288
    s_waitcnt lgkmcnt(2)
    v_mfma_f32_16x16x32_bf16 v[28:31], v[60:63], a[128:131], v[28:31]
    v_mul_f32 v94, v93, v46
    v_fma_f32 v26, v26, v92, -v94
    v_mfma_f32_16x16x32_bf16 v[32:35], v[60:63], a[200:203], v[32:35]
    v_mul_f32 v94, v93, v47
    v_fma_f32 v27, v27, v92, -v94
    ds_read_b128 v[60:63], v9 offset:14336
    s_waitcnt lgkmcnt(2)
    v_mfma_f32_16x16x32_bf16 v[28:31], v[64:67], a[132:135], v[28:31]
    v_mul_f32 v94, v93, v40
    v_fma_f32 v20, v20, v92, -v94
    v_mfma_f32_16x16x32_bf16 v[32:35], v[64:67], a[204:207], v[32:35]
    v_mul_f32 v94, v93, v41
    v_fma_f32 v21, v21, v92, -v94
    ds_read_b128 v[64:67], v9 offset:16384
    s_waitcnt lgkmcnt(2)
    v_mfma_f32_16x16x32_bf16 v[28:31], v[56:59], a[136:139], v[28:31]
    v_mul_f32 v94, v93, v42
    v_fma_f32 v22, v22, v92, -v94
    v_mfma_f32_16x16x32_bf16 v[32:35], v[56:59], a[208:211], v[32:35]
    v_mul_f32 v94, v93, v43
    v_fma_f32 v23, v23, v92, -v94
    ds_read_b128 v[56:59], v9 offset:18432
    s_waitcnt lgkmcnt(2)
    v_mfma_f32_16x16x32_bf16 v[28:31], v[60:63], a[140:143], v[28:31]
    v_cvt_pk_bf16_f32 v128, v16, v17
    v_cvt_pk_bf16_f32 v129, v18, v19
    v_mfma_f32_16x16x32_bf16 v[32:35], v[60:63], a[212:215], v[32:35]
    v_cvt_pk_bf16_f32 v130, v24, v25
    v_cvt_pk_bf16_f32 v132, v20, v21
    ds_read_b128 v[60:63], v9 offset:20480
    s_waitcnt lgkmcnt(2)
    v_mfma_f32_16x16x32_bf16 v[28:31], v[64:67], a[144:147], v[28:31]
    v_cvt_pk_bf16_f32 v133, v22, v23
    v_cvt_pk_bf16_f32 v134, v26, v27
    v_mfma_f32_16x16x32_bf16 v[32:35], v[64:67], a[216:219], v[32:35]
    s_cmp_eq_u32 s35, 0
    s_cselect_b32 s46, 0xf149f2ca, 0
    ds_read_b128 v[64:67], v9 offset:22528
    s_waitcnt lgkmcnt(2)
    v_mfma_f32_16x16x32_bf16 v[28:31], v[56:59], a[148:151], v[28:31]
    s_add_u32 m0, s59, 0
    s_add_u32 s47, s41, 0
    buffer_load_dwordx4 v0, s[8:11], s47 offen offset:0 lds
    v_mfma_f32_16x16x32_bf16 v[144:147], v[112:115], v[128:131], 0
    buffer_load_dwordx4 v0, s[8:11], s47 offen offset:1024 lds
    buffer_load_dwordx4 v0, s[8:11], s47 offen offset:2048 lds
    buffer_load_dwordx4 v0, s[8:11], s47 offen offset:3072 lds
    v_mfma_f32_16x16x32_bf16 v[32:35], v[56:59], a[220:223], v[32:35]
    s_add_u32 m0, s59, 4096
    s_add_u32 s47, s41, 4096
    buffer_load_dwordx4 v0, s[8:11], s47 offen offset:0 lds
    v_mfma_f32_16x16x32_bf16 v[148:151], v[132:135], v[128:131], 0
    buffer_load_dwordx4 v0, s[8:11], s47 offen offset:1024 lds
    buffer_load_dwordx4 v0, s[8:11], s47 offen offset:2048 lds
    buffer_load_dwordx4 v0, s[8:11], s47 offen offset:3072 lds
    ds_read_b128 v[56:59], v9 offset:24576
    s_waitcnt lgkmcnt(2)
    v_mfma_f32_16x16x32_bf16 v[28:31], v[60:63], a[152:155], v[28:31]
    v_mov_b32 v112, v132
    v_mfma_f32_16x16x32_bf16 v[32:35], v[60:63], a[224:227], v[32:35]
    v_mov_b32 v113, v133
    v_mov_b32 v114, v134
    ds_read_b128 v[60:63], v9 offset:26624
    s_waitcnt lgkmcnt(2)
    v_mfma_f32_16x16x32_bf16 v[28:31], v[64:67], a[156:159], v[28:31]
    s_add_u32 m0, s59, 8192
    s_add_u32 s47, s41, 8192
    buffer_load_dwordx4 v0, s[8:11], s47 offen offset:0 lds
    v_mfma_f32_16x16x32_bf16 v[32:35], v[64:67], a[228:231], v[32:35]
    s_mul_i32 s48, s36, 786432
    s_mul_i32 s18, s37, 6144
    s_add_u32 s48, s48, s18
    s_add_u32 s48, s48, 15728640
    buffer_load_dwordx4 v[80:83], v10, s[8:11], s48 offen offset:0
    v_fma_f32 v144, v144, s52, v72
    ds_read_b128 v[64:67], v9 offset:28672
    s_waitcnt lgkmcnt(2)
    v_mfma_f32_16x16x32_bf16 v[28:31], v[56:59], a[160:163], v[28:31]
    v_fma_f32 v145, v145, s52, v73
    v_fma_f32 v146, v146, s52, v74
    v_fma_f32 v147, v147, s52, v75
    v_mfma_f32_16x16x32_bf16 v[32:35], v[56:59], a[232:235], v[32:35]
    v_fma_f32 v148, v148, s52, v76
    v_fma_f32 v149, v149, s52, v77
    v_fma_f32 v150, v150, s52, v78
    ds_read_b128 v[56:59], v9 offset:30720
    s_waitcnt lgkmcnt(2)
    v_mfma_f32_16x16x32_bf16 v[28:31], v[60:63], a[164:167], v[28:31]
    v_fma_f32 v151, v151, s52, v79
    v_add_f32 v144, s46, v144
    v_add_f32 v145, s46, v145
    v_mfma_f32_16x16x32_bf16 v[32:35], v[60:63], a[236:239], v[32:35]
    v_add_f32 v146, s46, v146
    v_add_f32 v147, s46, v147
    v_max3_f32 v5, v144, v145, v146
    ds_read_b128 v[60:63], v9 offset:32768
    s_waitcnt lgkmcnt(2)
    v_mfma_f32_16x16x32_bf16 v[28:31], v[64:67], a[168:171], v[28:31]
    v_max3_f32 v5, v5, v147, v148
    v_max3_f32 v5, v5, v149, v150
    v_max_f32 v5, v5, v151
    v_mfma_f32_16x16x32_bf16 v[32:35], v[64:67], a[240:243], v[32:35]
    buffer_load_dwordx4 v[84:87], v10, s[8:11], s48 offen offset:512
    v_mov_b32 v6, v5
    s_nop 1
    v_permlane32_swap_b32 v5, v6
    ds_read_b128 v[64:67], v9 offset:34816
    s_waitcnt lgkmcnt(2)
    v_mfma_f32_16x16x32_bf16 v[28:31], v[56:59], a[172:175], v[28:31]
    buffer_load_dwordx4 v[88:91], v10, s[8:11], s48 offen offset:1024
    v_max_f32 v5, v5, v6
    v_mov_b32 v6, v5
    v_mfma_f32_16x16x32_bf16 v[32:35], v[56:59], a[244:247], v[32:35]
    s_nop 0
    v_permlane16_swap_b32 v5, v6
    v_max_f32 v5, v5, v6
    v_sub_f32 v144, v144, v5
    s_waitcnt lgkmcnt(1)
    v_mfma_f32_16x16x32_bf16 v[28:31], v[60:63], a[176:179], v[28:31]
    v_sub_f32 v145, v145, v5
    v_sub_f32 v146, v146, v5
    v_sub_f32 v147, v147, v5
    v_mfma_f32_16x16x32_bf16 v[32:35], v[60:63], a[248:251], v[32:35]
    v_sub_f32 v148, v148, v5
    v_sub_f32 v149, v149, v5
    v_sub_f32 v150, v150, v5
    s_waitcnt lgkmcnt(0)
    v_mfma_f32_16x16x32_bf16 v[28:31], v[64:67], a[180:183], v[28:31]
    v_sub_f32 v151, v151, v5
    v_exp_f32 v144, v144
    v_exp_f32 v145, v145
    v_mfma_f32_16x16x32_bf16 v[32:35], v[64:67], a[252:255], v[32:35]
    v_exp_f32 v146, v146
    v_exp_f32 v147, v147
    v_exp_f32 v148, v148
    v_cmp_eq_u32 s[76:77], 1, v2
    v_cmp_eq_u32 vcc, 2, v2
    s_cmp_eq_u64 s[76:77], -1
    s_cselect_b32 s38, 1, 0
    s_cmp_lg_u32 s38, 0
    s_cselect_b64 exec, 1, 0
    v_mov_b32 v15, s32
    ds_write_b32 v110, v15
    v_mov_b32 v2, 2
    s_mov_b64 exec, -1
    s_add_u32 s32, s32, s38
    s_mul_i32 s38, s38, 22528
    s_add_u32 s33, s33, s38
    s_cmp_eq_u64 vcc, 0
    s_cselect_b32 s38, s32, 0x7fff
    s_cmp_le_u32 s38, s39
    s_cselect_b64 exec, -1, 0
    v_mov_b32 v2, 2
    buffer_load_dword v2, v1, s[8:11], s33 offen sc1
    s_mov_b64 exec, -1
    v_exp_f32 v149, v149
    v_exp_f32 v150, v150
    v_exp_f32 v151, v151
    v_cvt_pk_bf16_f32 v68, v144, v145
    v_cvt_pk_bf16_f32 v69, v146, v147
    v_cvt_pk_bf16_f32 v70, v148, v149
    v_cvt_pk_bf16_f32 v71, v150, v151
    s_nop 1
    v_mfma_f32_16x16x32_bf16 v[16:19], v[116:119], v[68:71], 0
    s_mul_i32 s46, s57, 36864
    s_add_u32 s46, s46, 17301504
    s_nop 5
    v_rcp_f32 v6, v16
    v_mul_f32 v94, v97, v48
    v_fma_f32 v28, v28, v96, -v94
    v_mul_f32 v94, v99, v49
    v_fma_f32 v29, v29, v98, -v94
    v_mul_f32 v94, v101, v50
    v_fma_f32 v30, v30, v100, -v94
    v_mul_f32 v94, v103, v51
    v_fma_f32 v31, v31, v102, -v94
    v_cvt_pk_bf16_f32 v138, v28, v29
    v_cvt_pk_bf16_f32 v139, v30, v31
    v_mul_f32 v94, v97, v52
    v_fma_f32 v32, v32, v96, -v94
    v_mfma_f32_16x16x32_bf16 v[20:23], v[136:139], v[68:71], 0
    v_mul_f32 v94, v99, v53
    v_fma_f32 v33, v33, v98, -v94
    v_mul_f32 v94, v101, v54
    v_fma_f32 v34, v34, v100, -v94
    v_mul_f32 v94, v103, v55
    v_fma_f32 v35, v35, v102, -v94
    v_cvt_pk_bf16_f32 v142, v32, v33
    v_cvt_pk_bf16_f32 v143, v34, v35
    v_mov_b32 v136, v138
    v_mov_b32 v137, v139
    v_mfma_f32_16x16x32_bf16 v[24:27], v[140:143], v[68:71], 0
    v_mul_f32 v20, v6, v20
    v_mul_f32 v21, v6, v21
    v_mul_f32 v22, v6, v22
    v_mul_f32 v23, v6, v23
    v_cvt_pk_bf16_f32 v20, v20, v21
    v_cvt_pk_bf16_f32 v21, v22, v23
    buffer_store_dwordx2 v[20:21], v13, s[8:11], s46 offen sc1
    v_mov_b32 v140, v142
    v_mov_b32 v141, v143
    v_mul_f32 v24, v6, v24
    v_mul_f32 v25, v6, v25
    v_cvt_pk_bf16_f32 v24, v24, v25
    s_mov_b64 exec, 0xffff
    buffer_store_dword v24, v14, s[8:11], s46 offen sc1
    s_mov_b64 exec, -1
    s_mul_i32 s43, s57, 22528
    s_add_u32 s43, s43, s49
    s_branch Laq_head
Laq_none:
    s_waitcnt vmcnt(0)
    s_cmp_lg_u32 s43, 0
    s_cselect_b64 exec, 1, 0
    buffer_store_dword v3, v4, s[8:11], s43 offen sc1
    s_mov_b64 exec, -1
    s_mov_b32 s43, 0
    s_cmp_ge_u32 s37, 64
    s_cbranch_scc1 Laq_end
Laq_wait:
    s_mov_b32 s16, 0
    s_cmp_lg_u32 s14, 0
    s_cbranch_scc1 Laq_wl
Laq_wp:
    buffer_load_dword v2, v1, s[8:11], s60 offen sc1
    s_add_u32 s16, s16, 1
    s_cmp_gt_u32 s16, 100000
    s_cbranch_scc1 Laq_giveup
    s_waitcnt vmcnt(0)
    v_cmp_eq_u32 vcc, 0, v2
    s_nop 0
    s_cbranch_vccz Laq_wok
    s_sleep 4
    s_branch Laq_wp
Laq_giveup:
    v_mov_b32 v5, -2
    ds_write_b32 v110, v5
    s_waitcnt lgkmcnt(0)
    s_branch L_role_aq_abort
Laq_wok:
    v_mov_b32 v5, s37
    ds_write_b32 v110, v5
    s_branch Laq_go
Laq_wl:
    ds_read_b32 v15, v110
    s_add_u32 s16, s16, 1
    s_cmp_gt_u32 s16, 1600000
    s_cbranch_scc1 L_role_aq_abort
    s_waitcnt lgkmcnt(0)
    v_readfirstlane_b32 s17, v15
    s_nop 0
    s_cmp_eq_u32 s17, -2
    s_cbranch_scc1 L_role_aq_abort
    s_cmp_ge_i32 s17, s37
    s_cbranch_scc1 Laq_go
    s_sleep 1
    s_branch Laq_wl
Laq_go:
    s_add_u32 m0, s59, 0
    s_add_u32 s47, s41, 0
    buffer_load_dwordx4 v0, s[8:11], s47 offen offset:0 lds
    buffer_load_dwordx4 v0, s[8:11], s47 offen offset:1024 lds
    buffer_load_dwordx4 v0, s[8:11], s47 offen offset:2048 lds
    buffer_load_dwordx4 v0, s[8:11], s47 offen offset:3072 lds
    s_add_u32 m0, s59, 4096
    s_add_u32 s47, s41, 4096
    buffer_load_dwordx4 v0, s[8:11], s47 offen offset:0 lds
    buffer_load_dwordx4 v0, s[8:11], s47 offen offset:1024 lds
    buffer_load_dwordx4 v0, s[8:11], s47 offen offset:2048 lds
    buffer_load_dwordx4 v0, s[8:11], s47 offen offset:3072 lds
    s_add_u32 m0, s59, 8192
    s_add_u32 s47, s41, 8192
    buffer_load_dwordx4 v0, s[8:11], s47 offen offset:0 lds
    s_mul_i32 s48, s36, 786432
    s_mul_i32 s18, s37, 6144
    s_add_u32 s48, s48, s18
    s_add_u32 s48, s48, 15728640
    buffer_load_dwordx4 v[80:83], v10, s[8:11], s48 offen offset:0
    buffer_load_dwordx4 v[84:87], v10, s[8:11], s48 offen offset:512
    buffer_load_dwordx4 v[88:91], v10, s[8:11], s48 offen offset:1024
    s_waitcnt vmcnt(0) lgkmcnt(0)
    s_branch Laq_head2
Laq_end:
    s_branch L_role_aq_exit
L_role_aq_abort:
    s_waitcnt lgkmcnt(0)
    s_mov_b64 exec, -1
    v_mov_b32 v0, 60
    s_lshl_b32 s5, s3, 8
    s_or_b32 s5, s5, s4
    s_or_b32 s5, s5, 0x10000
    v_mov_b32 v1, s5
    global_store_dword v0, v1, s[12:13]
    s_endpgm
L_role_aq_exit:
    s_endpgm
.p2align 6
L_role_ta:
    v_and_b32 v5, 63, v0
    v_lshlrev_b32 v0, 4, v5
    v_and_b32 v7, 15, v5
    v_lshrrev_b32 v8, 4, v5
    v_min_u32 v1, 12, v5
    v_lshrrev_b32 v6, 2, v1
    v_and_b32 v1, 3, v1
    v_lshlrev_b32 v1, 2, v1
    v_lshl_add_u32 v1, v6, 7, v1
    v_mov_b32 v3, 1
    v_mov_b32 v4, 0
    s_mov_b32 s44, 0x05040100
    s_mov_b32 s45, 0x07060302
    s_cmp_ge_u32 s15, 11
    s_cselect_b32 s36, 1, 0
    s_cselect_b32 s17, 11, 0
    s_sub_u32 s17, s15, s17
    s_mul_i32 s50, s17, 3
    s_add_u32 s50, s50, s14
    s_cmp_eq_u32 s14, 3
    s_cselect_b32 s50, 32, s50
    s_mov_b32 s40, s50
    s_mov_b32 s37, 0
    s_mov_b32 s52, 0x3e0293ee
    v_lshrrev_b32 v5, 2, v7
    v_and_b32 v6, 1, v7
    v_lshl_add_u32 v5, v5, 1, v6
    v_lshlrev_b32 v9, 8, v5
    v_lshl_add_u32 v9, v8, 4, v9
    v_lshrrev_b32 v10, 1, v0
    v_mov_b32 v11, 384
    v_mov_b32 v6, 0xf149f2ca
    v_mov_b32 v21, 0
    v_mov_b32 v22, 0
    s_mul_i32 s42, s36, 1441792
    s_lshl_b32 s17, s50, 9
    s_add_u32 s42, s42, s17
    s_add_u32 s42, s42, 5376
    s_mul_i32 s51, s36, 50331648
    s_lshl_b32 s17, s50, 13
    s_add_u32 s51, s51, s17
    s_add_u32 s51, s51, 44040192
    s_lshl_b32 s47, s36, 11
    s_add_u32 s47, s47, s50
    s_lshl_b32 s48, s47, 13
    s_add_u32 s48, s48, 144703488
    s_lshl_b32 s47, s47, 12
    s_add_u32 s47, s47, 27262976
    s_mul_i32 s43, s36, 1441792
    s_lshr_b32 s17, s50, 2
    s_lshl_b32 s17, s17, 7
    s_add_u32 s43, s43, s17
    s_and_b32 s17, s50, 3
    s_lshl_b32 s17, s17, 2
    s_add_u32 s43, s43, s17
    s_add_u32 s43, s43, 4224
    s_mov_b32 s28, s8
    s_mov_b32 s29, s9
    s_mov_b32 s30, 0
    s_mov_b32 s31, 0x00020000
    s_mov_b32 s39, 0
    s_mov_b32 s38, 0
    s_mov_b32 s49, 0
    s_mov_b32 s20, s8
    s_mov_b32 s21, s9
    s_mov_b32 s22, 0
    s_mov_b32 s23, 0x00020000
    v_mov_b32 v16, 0x3f803f80
    v_lshl_add_u32 v5, v8, 2, 0
    v_cmp_le_u32 vcc, v5, v7
    s_nop 1
    v_cndmask_b32 v236, v6, v4, vcc
    v_mov_b32 v17, 0x3f803f80
    v_lshl_add_u32 v5, v8, 2, 1
    v_cmp_le_u32 vcc, v5, v7
    s_nop 1
    v_cndmask_b32 v237, v6, v4, vcc
    v_mov_b32 v18, 0x3f803f80
    v_lshl_add_u32 v5, v8, 2, 2
    v_cmp_le_u32 vcc, v5, v7
    s_nop 1
    v_cndmask_b32 v238, v6, v4, vcc
    v_mov_b32 v19, 0x3f803f80
    v_lshl_add_u32 v5, v8, 2, 3
    v_cmp_le_u32 vcc, v5, v7
    s_nop 1
    v_cndmask_b32 v239, v6, v4, vcc
    v_mov_b32 v15, 0
    s_cmp_lg_u32 s14, 0
    s_cbranch_scc1 Lta_inia_d
    v_mov_b32 v5, 40
    s_mov_b32 s16, 0
Lta_inia:
    global_load_dword v6, v5, s[12:13] sc1
    s_add_u32 s16, s16, 1
    s_cmp_gt_u32 s16, 100000
    s_cbranch_scc1 L_role_ta_abort
    s_waitcnt vmcnt(0)
    v_cmp_gt_u32 vcc, 72, v6
    s_nop 0
    s_cbranch_vccz Lta_inia_d
    s_sleep 8
    s_branch Lta_inia
Lta_inia_d:
    s_barrier
    s_cmp_eq_u32 s36, 0
    s_cbranch_scc1 Lta_ini_sk
    s_cmp_lg_u32 s14, 0
    s_cbranch_scc1 Lta_inib_d
    v_mov_b32 v5, 160
    s_mov_b32 s16, 0
Lta_inib:
    global_load_dword v6, v5, s[12:13] sc1
    s_add_u32 s16, s16, 1
    s_cmp_gt_u32 s16, 100000
    s_cbranch_scc1 L_role_ta_abort
    s_waitcnt vmcnt(0)
    v_cmp_gt_u32 vcc, 64, v6
    s_nop 0
    s_cbranch_vccz Lta_inib_d
    s_sleep 8
    s_branch Lta_inib
Lta_inib_d:
    s_barrier
Lta_ini_sk:
    s_cmp_ge_u32 s40, 32
    s_cbranch_scc1 L_role_ta_exit
Lta0:
    s_cmp_eq_u32 s39, 1
    s_cbranch_scc1 Lta0_have
    s_waitcnt vmcnt(0)
    s_cmp_lg_u32 s49, 0
    s_cselect_b64 exec, 1, 0
    buffer_store_dword v3, v4, s[8:11], s43 offen sc1
    s_mov_b64 exec, -1
    s_add_u32 s43, s43, s49
    s_mov_b32 s49, 0
    s_mov_b32 s16, 0
Lta0_f:
    buffer_load_dword v2, v1, s[8:11], s42 offen sc1
    s_add_u32 s16, s16, 1
    s_cmp_gt_u32 s16, 100000
    s_cbranch_scc1 L_role_ta_abort
    s_waitcnt vmcnt(0)
    v_cmp_eq_u32 vcc, 0, v2
    s_nop 0
    s_and_b32 s17, vcc_lo, 0xfff
    s_cbranch_scc0 Lta0_fd
    s_sleep 4
    s_branch Lta0_f
Lta0_fd:
    s_add_u32 s46, s51, 0
    buffer_load_dwordx4 v[140:143], v0, s[8:11], s46 offen offset:0
    buffer_load_dwordx4 v[144:147], v0, s[8:11], s46 offen offset:1024
    buffer_load_dwordx4 v[148:151], v0, s[8:11], s46 offen offset:2048
    buffer_load_dwordx4 v[152:155], v0, s[8:11], s46 offen offset:3072
    s_add_u32 s46, s51, 4096
    buffer_load_dwordx4 v[156:159], v0, s[8:11], s46 offen offset:0
    buffer_load_dwordx4 v[160:163], v0, s[8:11], s46 offen offset:1024
    buffer_load_dwordx4 v[164:167], v0, s[8:11], s46 offen offset:2048
    buffer_load_dwordx4 v[168:171], v0, s[8:11], s46 offen offset:3072
    s_add_u32 s46, s51, 16777216
    buffer_load_dwordx4 v[172:175], v0, s[8:11], s46 offen offset:0
    buffer_load_dwordx4 v[176:179], v0, s[8:11], s46 offen offset:1024
    buffer_load_dwordx4 v[180:183], v0, s[8:11], s46 offen offset:2048
    buffer_load_dwordx4 v[184:187], v0, s[8:11], s46 offen offset:3072
    s_add_u32 s46, s51, 16781312
    buffer_load_dwordx4 v[188:191], v0, s[8:11], s46 offen offset:0
    buffer_load_dwordx4 v[192:195], v0, s[8:11], s46 offen offset:1024
    buffer_load_dwordx4 v[196:199], v0, s[8:11], s46 offen offset:2048
    buffer_load_dwordx4 v[200:203], v0, s[8:11], s46 offen offset:3072
    s_add_u32 s46, s51, 33554432
    buffer_load_dwordx4 v[204:207], v0, s[8:11], s46 offen offset:0
    buffer_load_dwordx4 v[208:211], v0, s[8:11], s46 offen offset:1024
    buffer_load_dwordx4 v[212:215], v0, s[8:11], s46 offen offset:2048
    buffer_load_dwordx4 v[216:219], v0, s[8:11], s46 offen offset:3072
    s_add_u32 s46, s51, 33558528
    buffer_load_dwordx4 v[220:223], v0, s[8:11], s46 offen offset:0
    buffer_load_dwordx4 v[224:227], v0, s[8:11], s46 offen offset:1024
    buffer_load_dwordx4 v[228:231], v0, s[8:11], s46 offen offset:2048
    buffer_load_dwordx4 v[232:235], v0, s[8:11], s46 offen offset:3072
    s_waitcnt vmcnt(0)
Lta0_have:
    buffer_load_dword v2, v11, s[8:11], s42 offen sc1
    s_waitcnt vmcnt(5)
    v_cmp_eq_u32 vcc, 0, v15
    s_add_u32 s51, s51, 262144
    s_add_u32 s37, s37, 1
    s_mov_b32 s62, s38
    s_and_b32 s17, vcc_lo, 0xfff
    s_cselect_b32 s39, 0, 1
    s_cmp_eq_u64 vcc, 0
    s_cselect_b32 s38, 1, 0
    s_cmp_lt_u32 s37, 64
    s_cselect_b32 s39, s39, 0
    s_cselect_b32 s38, s38, 0
    s_cmp_eq_u32 s39, 1
    s_cselect_b32 s30, 268435456, 0
    s_cmp_eq_u32 s38, 1
    s_cselect_b32 s22, 268435456, 0
    v_mfma_f32_16x16x32_bf16 v[32:35], v[172:175], v[140:143], 0
    s_add_u32 s46, s51, 0
    buffer_load_dwordx4 a[0:3], v0, s[28:31], s46 offen offset:0
    v_mfma_f32_16x16x32_bf16 v[36:39], v[172:175], v[144:147], 0
    buffer_load_dwordx4 a[4:7], v0, s[28:31], s46 offen offset:1024
    v_mfma_f32_16x16x32_bf16 v[40:43], v[176:179], v[144:147], 0
    buffer_load_dwordx4 a[8:11], v0, s[28:31], s46 offen offset:2048
    v_mfma_f32_16x16x32_bf16 v[32:35], v[180:183], v[148:151], v[32:35]
    buffer_load_dwordx4 a[12:15], v0, s[28:31], s46 offen offset:3072
    v_mfma_f32_16x16x32_bf16 v[36:39], v[180:183], v[152:155], v[36:39]
    s_add_u32 s46, s51, 4096
    buffer_load_dwordx4 a[16:19], v0, s[28:31], s46 offen offset:0
    v_mfma_f32_16x16x32_bf16 v[40:43], v[184:187], v[152:155], v[40:43]
    buffer_load_dwordx4 a[20:23], v0, s[28:31], s46 offen offset:1024
    v_mfma_f32_16x16x32_bf16 v[32:35], v[188:191], v[156:159], v[32:35]
    v_mfma_f32_16x16x32_bf16 v[36:39], v[188:191], v[160:163], v[36:39]
    v_mfma_f32_16x16x32_bf16 v[40:43], v[192:195], v[160:163], v[40:43]
    v_mfma_f32_16x16x32_bf16 v[32:35], v[196:199], v[164:167], v[32:35]
    v_mfma_f32_16x16x32_bf16 v[36:39], v[196:199], v[168:171], v[36:39]
    v_mfma_f32_16x16x32_bf16 v[40:43], v[200:203], v[168:171], v[40:43]
    s_waitcnt vmcnt(7)
    s_cmp_lg_u32 s49, 0
    s_cselect_b64 exec, 1, 0
    buffer_store_dword v3, v4, s[8:11], s43 offen sc1
    s_mov_b64 exec, -1
    s_add_u32 s43, s43, s49
    s_mov_b32 s49, 0
    s_cmp_eq_u32 s62, 1
    s_cbranch_scc1 Lta0_km
    s_waitcnt vmcnt(6)
    v_cmp_eq_u32 vcc, 0, v2
    s_nop 0
    s_cbranch_vccz Lta0_r
    s_mov_b32 s16, 0
Lta0_rp:
    buffer_load_dword v2, v11, s[8:11], s42 offen sc1
    s_add_u32 s16, s16, 1
    s_cmp_gt_u32 s16, 100000
    s_cbranch_scc1 L_role_ta_abort
    s_waitcnt vmcnt(0)
    v_cmp_eq_u32 vcc, 0, v2
    s_nop 0
    s_cbranch_vccnz Lta0_rp
Lta0_r:
    buffer_load_dwordx4 a[96:99], v9, s[8:11], s47 offen offset:0
    buffer_load_dwordx4 a[100:103], v9, s[8:11], s47 offen offset:64
    buffer_load_dwordx4 a[104:107], v9, s[8:11], s47 offen offset:128
    buffer_load_dwordx4 a[108:111], v9, s[8:11], s47 offen offset:192
    buffer_load_dwordx2 a[112:113], v10, s[8:11], s47 offen offset:2048
    buffer_load_dwordx2 a[114:115], v10, s[8:11], s47 offen offset:2560
    buffer_load_dwordx2 a[116:117], v10, s[8:11], s47 offen offset:3072
    buffer_load_dwordx2 a[118:119], v10, s[8:11], s47 offen offset:3584
Lta0_km:
    s_add_u32 s42, s42, 22528
    s_add_u32 s47, s47, 131072
    v_fma_f32 v32, v32, s52, v236
    v_fma_f32 v33, v33, s52, v237
    v_fma_f32 v34, v34, s52, v238
    v_fma_f32 v35, v35, s52, v239
    buffer_load_dwordx4 a[24:27], v0, s[28:31], s46 offen offset:2048
    buffer_load_dwordx4 a[28:31], v0, s[28:31], s46 offen offset:3072
    v_mul_f32 v36, s52, v36
    v_mul_f32 v37, s52, v37
    v_mul_f32 v38, s52, v38
    v_mul_f32 v39, s52, v39
    s_add_u32 s46, s51, 16777216
    buffer_load_dwordx4 a[32:35], v0, s[28:31], s46 offen offset:0
    buffer_load_dwordx4 a[36:39], v0, s[28:31], s46 offen offset:1024
    v_fma_f32 v40, v40, s52, v236
    v_fma_f32 v41, v41, s52, v237
    v_fma_f32 v42, v42, s52, v238
    v_fma_f32 v43, v43, s52, v239
    buffer_load_dwordx4 a[40:43], v0, s[28:31], s46 offen offset:2048
    buffer_load_dwordx4 a[44:47], v0, s[28:31], s46 offen offset:3072
    s_waitcnt vmcnt(13)
    v_mfma_f32_16x16x32_bf16 v[44:47], a[96:99], v[140:143], 0
    v_mfma_f32_16x16x32_bf16 v[48:51], a[96:99], v[144:147], 0
    s_add_u32 s46, s51, 16781312
    buffer_load_dwordx4 a[48:51], v0, s[28:31], s46 offen offset:0
    s_waitcnt vmcnt(13)
    v_mfma_f32_16x16x32_bf16 v[44:47], a[100:103], v[148:151], v[44:47]
    v_mfma_f32_16x16x32_bf16 v[48:51], a[100:103], v[152:155], v[48:51]
    buffer_load_dwordx4 a[52:55], v0, s[28:31], s46 offen offset:1024
    s_waitcnt vmcnt(13)
    v_mfma_f32_16x16x32_bf16 v[44:47], a[104:107], v[156:159], v[44:47]
    v_mfma_f32_16x16x32_bf16 v[48:51], a[104:107], v[160:163], v[48:51]
    buffer_load_dwordx4 a[56:59], v0, s[28:31], s46 offen offset:2048
    s_waitcnt vmcnt(13)
    v_mfma_f32_16x16x32_bf16 v[44:47], a[108:111], v[164:167], v[44:47]
    v_mfma_f32_16x16x32_bf16 v[48:51], a[108:111], v[168:171], v[48:51]
    buffer_load_dwordx4 a[60:63], v0, s[28:31], s46 offen offset:3072
    v_max3_f32 v5, v32, v33, v34
    v_max_f32 v5, v5, v35
    s_nop 0
    v_mul_f32 v44, s52, v44
    v_mul_f32 v45, s52, v45
    v_max3_f32 v5, v5, v44, v45
    v_mov_b32 v6, v5
    s_add_u32 s46, s51, 33554432
    buffer_load_dwordx4 a[64:67], v0, s[28:31], s46 offen offset:0
    v_permlane32_swap_b32 v5, v6
    v_max_f32 v5, v5, v6
    v_mov_b32 v6, v5
    buffer_load_dwordx4 a[68:71], v0, s[28:31], s46 offen offset:1024
    s_nop 0
    v_permlane16_swap_b32 v5, v6
    v_max_f32 v5, v5, v6
    v_sub_f32 v32, v32, v5
    v_sub_f32 v33, v33, v5
    v_sub_f32 v34, v34, v5
    v_sub_f32 v35, v35, v5
    v_sub_f32 v44, v44, v5
    v_sub_f32 v45, v45, v5
    v_exp_f32 v32, v32
    v_exp_f32 v33, v33
    v_exp_f32 v34, v34
    v_exp_f32 v35, v35
    v_exp_f32 v44, v44
    v_exp_f32 v45, v45
    v_cvt_pk_bf16_f32 v24, v32, v33
    v_cvt_pk_bf16_f32 v25, v34, v35
    v_mov_b32 v26, 0
    v_mov_b32 v27, 0
    v_cvt_pk_bf16_f32 v20, v44, v45
    v_cvt_pk_bf16_f32 v23, v44, v45
    v_mfma_f32_16x16x32_bf16 v[28:31], v[16:19], v[24:27], 0
    v_mfma_f32_16x16x32_bf16 v[76:79], v[204:207], v[24:27], 0
    v_mfma_f32_16x16x32_bf16 v[80:83], v[208:211], v[24:27], 0
    s_add_u32 s17, s42, 22528
    buffer_load_dword v15, v1, s[8:11], s17 offen sc1
    v_mfma_f32_16x16x32_bf16 v[84:87], v[212:215], v[24:27], 0
    v_mfma_f32_16x16x32_bf16 v[88:91], v[216:219], v[24:27], 0
    buffer_load_dwordx4 a[72:75], v0, s[28:31], s46 offen offset:2048
    v_mfma_f32_16x16x32_bf16 v[92:95], v[220:223], v[24:27], 0
    v_mfma_f32_16x16x32_bf16 v[96:99], v[224:227], v[24:27], 0
    buffer_load_dwordx4 a[76:79], v0, s[28:31], s46 offen offset:3072
    v_mfma_f32_16x16x16_bf16 v[28:31], v[16:17], v[20:21], v[28:31]
    v_mfma_f32_16x16x32_bf16 v[100:103], v[228:231], v[24:27], 0
    v_mfma_f32_16x16x32_bf16 v[104:107], v[232:235], v[24:27], 0
    s_add_u32 s46, s51, 33558528
    buffer_load_dwordx4 a[80:83], v0, s[28:31], s46 offen offset:0
    s_waitcnt vmcnt(19)
    v_mfma_f32_16x16x16_bf16 v[76:79], a[112:113], v[20:21], v[76:79]
    v_mfma_f32_16x16x16_bf16 v[80:83], a[112:113], v[22:23], v[80:83]
    v_rcp_f32 v6, v28
    s_waitcnt vmcnt(18)
    v_mfma_f32_16x16x16_bf16 v[84:87], a[114:115], v[20:21], v[84:87]
    v_mfma_f32_16x16x16_bf16 v[88:91], a[114:115], v[22:23], v[88:91]
    v_mul_f32 v76, v6, v76
    v_mul_f32 v80, v6, v80
    v_cvt_pk_bf16_f32 v108, v76, v80
    v_mul_f32 v77, v6, v77
    v_mul_f32 v81, v6, v81
    v_cvt_pk_bf16_f32 v109, v77, v81
    v_mul_f32 v78, v6, v78
    v_mul_f32 v82, v6, v82
    v_cvt_pk_bf16_f32 v110, v78, v82
    v_mul_f32 v79, v6, v79
    v_mul_f32 v83, v6, v83
    v_cvt_pk_bf16_f32 v111, v79, v83
    s_add_u32 s17, s48, 0
    buffer_store_dwordx4 v[108:111], v0, s[8:11], s17 offen offset:0 sc1
    buffer_load_dwordx4 a[84:87], v0, s[28:31], s46 offen offset:1024
    s_waitcnt vmcnt(19)
    v_mfma_f32_16x16x16_bf16 v[92:95], a[116:117], v[20:21], v[92:95]
    v_mfma_f32_16x16x16_bf16 v[96:99], a[116:117], v[22:23], v[96:99]
    v_mul_f32 v84, v6, v84
    v_mul_f32 v88, v6, v88
    v_cvt_pk_bf16_f32 v112, v84, v88
    v_mul_f32 v85, v6, v85
    v_mul_f32 v89, v6, v89
    v_cvt_pk_bf16_f32 v113, v85, v89
    v_mul_f32 v86, v6, v86
    v_mul_f32 v90, v6, v90
    v_cvt_pk_bf16_f32 v114, v86, v90
    v_mul_f32 v87, v6, v87
    v_mul_f32 v91, v6, v91
    v_cvt_pk_bf16_f32 v115, v87, v91
    buffer_store_dwordx4 v[112:115], v0, s[8:11], s17 offen offset:2048 sc1
    buffer_load_dwordx4 a[88:91], v0, s[28:31], s46 offen offset:2048
    s_waitcnt vmcnt(20)
    v_mfma_f32_16x16x16_bf16 v[100:103], a[118:119], v[20:21], v[100:103]
    v_mfma_f32_16x16x16_bf16 v[104:107], a[118:119], v[22:23], v[104:107]
    v_mul_f32 v92, v6, v92
    v_mul_f32 v96, v6, v96
    v_cvt_pk_bf16_f32 v116, v92, v96
    v_mul_f32 v93, v6, v93
    v_mul_f32 v97, v6, v97
    v_cvt_pk_bf16_f32 v117, v93, v97
    v_mul_f32 v94, v6, v94
    v_mul_f32 v98, v6, v98
    v_cvt_pk_bf16_f32 v118, v94, v98
    v_mul_f32 v95, v6, v95
    v_mul_f32 v99, v6, v99
    v_cvt_pk_bf16_f32 v119, v95, v99
    s_add_u32 s17, s48, 4096
    buffer_store_dwordx4 v[116:119], v0, s[8:11], s17 offen offset:0 sc1
    buffer_load_dwordx4 a[92:95], v0, s[28:31], s46 offen offset:3072
    v_mul_f32 v100, v6, v100
    v_mul_f32 v104, v6, v104
    v_cvt_pk_bf16_f32 v120, v100, v104
    v_mul_f32 v101, v6, v101
    v_mul_f32 v105, v6, v105
    v_cvt_pk_bf16_f32 v121, v101, v105
    v_mul_f32 v102, v6, v102
    v_mul_f32 v106, v6, v106
    v_cvt_pk_bf16_f32 v122, v102, v106
    v_mul_f32 v103, v6, v103
    v_mul_f32 v107, v6, v107
    v_cvt_pk_bf16_f32 v123, v103, v107
    buffer_store_dwordx4 v[120:123], v0, s[8:11], s17 offen offset:2048 sc1
    buffer_load_dwordx4 a[120:123], v9, s[20:23], s47 offen offset:0
    v_max3_f32 v5, v36, v37, v38
    v_max_f32 v5, v5, v39
    v_max3_f32 v5, v5, v40, v41
    v_max3_f32 v5, v5, v42, v43
    v_mul_f32 v48, s52, v48
    v_mul_f32 v49, s52, v49
    v_max3_f32 v5, v5, v48, v49
    v_mov_b32 v6, v5
    buffer_load_dwordx4 a[124:127], v9, s[20:23], s47 offen offset:64
    s_nop 0
    v_permlane32_swap_b32 v5, v6
    v_max_f32 v5, v5, v6
    v_mov_b32 v6, v5
    buffer_load_dwordx4 a[128:131], v9, s[20:23], s47 offen offset:128
    s_nop 0
    v_permlane16_swap_b32 v5, v6
    v_max_f32 v5, v5, v6
    v_sub_f32 v36, v36, v5
    v_sub_f32 v37, v37, v5
    v_sub_f32 v38, v38, v5
    v_sub_f32 v39, v39, v5
    v_sub_f32 v40, v40, v5
    v_sub_f32 v41, v41, v5
    v_sub_f32 v42, v42, v5
    v_sub_f32 v43, v43, v5
    v_sub_f32 v48, v48, v5
    v_sub_f32 v49, v49, v5
    v_exp_f32 v36, v36
    v_exp_f32 v37, v37
    v_exp_f32 v38, v38
    v_exp_f32 v39, v39
    v_exp_f32 v40, v40
    v_exp_f32 v41, v41
    v_exp_f32 v42, v42
    v_exp_f32 v43, v43
    v_exp_f32 v48, v48
    v_exp_f32 v49, v49
    v_cvt_pk_bf16_f32 v24, v36, v37
    v_cvt_pk_bf16_f32 v25, v38, v39
    v_cvt_pk_bf16_f32 v26, v40, v41
    v_cvt_pk_bf16_f32 v27, v42, v43
    v_cvt_pk_bf16_f32 v20, v48, v49
    v_cvt_pk_bf16_f32 v23, v48, v49
    v_mfma_f32_16x16x32_bf16 v[28:31], v[16:19], v[24:27], 0
    v_mfma_f32_16x16x32_bf16 v[76:79], v[204:207], v[24:27], 0
    v_mfma_f32_16x16x32_bf16 v[80:83], v[208:211], v[24:27], 0
    buffer_load_dwordx4 a[132:135], v9, s[20:23], s47 offen offset:192
    v_mfma_f32_16x16x32_bf16 v[84:87], v[212:215], v[24:27], 0
    v_mfma_f32_16x16x32_bf16 v[88:91], v[216:219], v[24:27], 0
    buffer_load_dwordx2 a[136:137], v10, s[20:23], s47 offen offset:2048
    v_mfma_f32_16x16x32_bf16 v[92:95], v[220:223], v[24:27], 0
    v_mfma_f32_16x16x32_bf16 v[96:99], v[224:227], v[24:27], 0
    buffer_load_dwordx2 a[138:139], v10, s[20:23], s47 offen offset:2560
    v_mfma_f32_16x16x16_bf16 v[28:31], v[16:17], v[20:21], v[28:31]
    v_mfma_f32_16x16x32_bf16 v[100:103], v[228:231], v[24:27], 0
    v_mfma_f32_16x16x32_bf16 v[104:107], v[232:235], v[24:27], 0
    buffer_load_dwordx2 a[140:141], v10, s[20:23], s47 offen offset:3072
    buffer_load_dwordx2 a[142:143], v10, s[20:23], s47 offen offset:3584
    v_mfma_f32_16x16x16_bf16 v[76:79], a[112:113], v[20:21], v[76:79]
    v_mfma_f32_16x16x16_bf16 v[80:83], a[112:113], v[22:23], v[80:83]
    v_rcp_f32 v6, v28
    v_mfma_f32_16x16x16_bf16 v[84:87], a[114:115], v[20:21], v[84:87]
    v_mfma_f32_16x16x16_bf16 v[88:91], a[114:115], v[22:23], v[88:91]
    v_mul_f32 v76, v6, v76
    v_mul_f32 v80, v6, v80
    v_cvt_pk_bf16_f32 v124, v76, v80
    v_mul_f32 v77, v6, v77
    v_mul_f32 v81, v6, v81
    v_cvt_pk_bf16_f32 v125, v77, v81
    v_mul_f32 v78, v6, v78
    v_mul_f32 v82, v6, v82
    v_cvt_pk_bf16_f32 v126, v78, v82
    v_mul_f32 v79, v6, v79
    v_mul_f32 v83, v6, v83
    v_cvt_pk_bf16_f32 v127, v79, v83
    s_add_u32 s17, s48, 0
    buffer_store_dwordx4 v[124:127], v0, s[8:11], s17 offen offset:1024 sc1
    v_mfma_f32_16x16x16_bf16 v[92:95], a[116:117], v[20:21], v[92:95]
    v_mfma_f32_16x16x16_bf16 v[96:99], a[116:117], v[22:23], v[96:99]
    v_mul_f32 v84, v6, v84
    v_mul_f32 v88, v6, v88
    v_cvt_pk_bf16_f32 v128, v84, v88
    v_mul_f32 v85, v6, v85
    v_mul_f32 v89, v6, v89
    v_cvt_pk_bf16_f32 v129, v85, v89
    v_mul_f32 v86, v6, v86
    v_mul_f32 v90, v6, v90
    v_cvt_pk_bf16_f32 v130, v86, v90
    v_mul_f32 v87, v6, v87
    v_mul_f32 v91, v6, v91
    v_cvt_pk_bf16_f32 v131, v87, v91
    buffer_store_dwordx4 v[128:131], v0, s[8:11], s17 offen offset:3072 sc1
    v_mfma_f32_16x16x16_bf16 v[100:103], a[118:119], v[20:21], v[100:103]
    v_mfma_f32_16x16x16_bf16 v[104:107], a[118:119], v[22:23], v[104:107]
    v_mul_f32 v92, v6, v92
    v_mul_f32 v96, v6, v96
    v_cvt_pk_bf16_f32 v132, v92, v96
    v_mul_f32 v93, v6, v93
    v_mul_f32 v97, v6, v97
    v_cvt_pk_bf16_f32 v133, v93, v97
    v_mul_f32 v94, v6, v94
    v_mul_f32 v98, v6, v98
    v_cvt_pk_bf16_f32 v134, v94, v98
    v_mul_f32 v95, v6, v95
    v_mul_f32 v99, v6, v99
    v_cvt_pk_bf16_f32 v135, v95, v99
    s_add_u32 s17, s48, 4096
    buffer_store_dwordx4 v[132:135], v0, s[8:11], s17 offen offset:1024 sc1
    v_mul_f32 v100, v6, v100
    v_mul_f32 v104, v6, v104
    v_cvt_pk_bf16_f32 v136, v100, v104
    v_mul_f32 v101, v6, v101
    v_mul_f32 v105, v6, v105
    v_cvt_pk_bf16_f32 v137, v101, v105
    v_mul_f32 v102, v6, v102
    v_mul_f32 v106, v6, v106
    v_cvt_pk_bf16_f32 v138, v102, v106
    v_mul_f32 v103, v6, v103
    v_mul_f32 v107, v6, v107
    v_cvt_pk_bf16_f32 v139, v103, v107
    buffer_store_dwordx4 v[136:139], v0, s[8:11], s17 offen offset:3072 sc1
    s_add_u32 s48, s48, 262144
    s_mov_b32 s49, 22528
    s_cmp_ge_u32 s37, 64
    s_cbranch_scc1 Lta_end
Lta1:
    s_cmp_eq_u32 s39, 1
    s_cbranch_scc1 Lta1_have
    s_waitcnt vmcnt(0)
    s_cmp_lg_u32 s49, 0
    s_cselect_b64 exec, 1, 0
    buffer_store_dword v3, v4, s[8:11], s43 offen sc1
    s_mov_b64 exec, -1
    s_add_u32 s43, s43, s49
    s_mov_b32 s49, 0
    s_mov_b32 s16, 0
Lta1_f:
    buffer_load_dword v2, v1, s[8:11], s42 offen sc1
    s_add_u32 s16, s16, 1
    s_cmp_gt_u32 s16, 100000
    s_cbranch_scc1 L_role_ta_abort
    s_waitcnt vmcnt(0)
    v_cmp_eq_u32 vcc, 0, v2
    s_nop 0
    s_and_b32 s17, vcc_lo, 0xfff
    s_cbranch_scc0 Lta1_fd
    s_sleep 4
    s_branch Lta1_f
Lta1_fd:
    s_add_u32 s46, s51, 0
    buffer_load_dwordx4 a[0:3], v0, s[8:11], s46 offen offset:0
    buffer_load_dwordx4 a[4:7], v0, s[8:11], s46 offen offset:1024
    buffer_load_dwordx4 a[8:11], v0, s[8:11], s46 offen offset:2048
    buffer_load_dwordx4 a[12:15], v0, s[8:11], s46 offen offset:3072
    s_add_u32 s46, s51, 4096
    buffer_load_dwordx4 a[16:19], v0, s[8:11], s46 offen offset:0
    buffer_load_dwordx4 a[20:23], v0, s[8:11], s46 offen offset:1024
    buffer_load_dwordx4 a[24:27], v0, s[8:11], s46 offen offset:2048
    buffer_load_dwordx4 a[28:31], v0, s[8:11], s46 offen offset:3072
    s_add_u32 s46, s51, 16777216
    buffer_load_dwordx4 a[32:35], v0, s[8:11], s46 offen offset:0
    buffer_load_dwordx4 a[36:39], v0, s[8:11], s46 offen offset:1024
    buffer_load_dwordx4 a[40:43], v0, s[8:11], s46 offen offset:2048
    buffer_load_dwordx4 a[44:47], v0, s[8:11], s46 offen offset:3072
    s_add_u32 s46, s51, 16781312
    buffer_load_dwordx4 a[48:51], v0, s[8:11], s46 offen offset:0
    buffer_load_dwordx4 a[52:55], v0, s[8:11], s46 offen offset:1024
    buffer_load_dwordx4 a[56:59], v0, s[8:11], s46 offen offset:2048
    buffer_load_dwordx4 a[60:63], v0, s[8:11], s46 offen offset:3072
    s_add_u32 s46, s51, 33554432
    buffer_load_dwordx4 a[64:67], v0, s[8:11], s46 offen offset:0
    buffer_load_dwordx4 a[68:71], v0, s[8:11], s46 offen offset:1024
    buffer_load_dwordx4 a[72:75], v0, s[8:11], s46 offen offset:2048
    buffer_load_dwordx4 a[76:79], v0, s[8:11], s46 offen offset:3072
    s_add_u32 s46, s51, 33558528
    buffer_load_dwordx4 a[80:83], v0, s[8:11], s46 offen offset:0
    buffer_load_dwordx4 a[84:87], v0, s[8:11], s46 offen offset:1024
    buffer_load_dwordx4 a[88:91], v0, s[8:11], s46 offen offset:2048
    buffer_load_dwordx4 a[92:95], v0, s[8:11], s46 offen offset:3072
    s_waitcnt vmcnt(0)
Lta1_have:
    buffer_load_dword v2, v11, s[8:11], s42 offen sc1
    s_waitcnt vmcnt(5)
    v_cmp_eq_u32 vcc, 0, v15
    s_add_u32 s51, s51, 262144
    s_add_u32 s37, s37, 1
    s_mov_b32 s62, s38
    s_and_b32 s17, vcc_lo, 0xfff
    s_cselect_b32 s39, 0, 1
    s_cmp_eq_u64 vcc, 0
    s_cselect_b32 s38, 1, 0
    s_cmp_lt_u32 s37, 64
    s_cselect_b32 s39, s39, 0
    s_cselect_b32 s38, s38, 0
    s_cmp_eq_u32 s39, 1
    s_cselect_b32 s30, 268435456, 0
    s_cmp_eq_u32 s38, 1
    s_cselect_b32 s22, 268435456, 0
    v_mfma_f32_16x16x32_bf16 v[32:35], a[32:35], a[0:3], 0
    s_add_u32 s46, s51, 0
    buffer_load_dwordx4 v[140:143], v0, s[28:31], s46 offen offset:0
    v_mfma_f32_16x16x32_bf16 v[36:39], a[32:35], a[4:7], 0
    buffer_load_dwordx4 v[144:147], v0, s[28:31], s46 offen offset:1024
    v_mfma_f32_16x16x32_bf16 v[40:43], a[36:39], a[4:7], 0
    buffer_load_dwordx4 v[148:151], v0, s[28:31], s46 offen offset:2048
    v_mfma_f32_16x16x32_bf16 v[32:35], a[40:43], a[8:11], v[32:35]
    buffer_load_dwordx4 v[152:155], v0, s[28:31], s46 offen offset:3072
    v_mfma_f32_16x16x32_bf16 v[36:39], a[40:43], a[12:15], v[36:39]
    s_add_u32 s46, s51, 4096
    buffer_load_dwordx4 v[156:159], v0, s[28:31], s46 offen offset:0
    v_mfma_f32_16x16x32_bf16 v[40:43], a[44:47], a[12:15], v[40:43]
    buffer_load_dwordx4 v[160:163], v0, s[28:31], s46 offen offset:1024
    v_mfma_f32_16x16x32_bf16 v[32:35], a[48:51], a[16:19], v[32:35]
    v_mfma_f32_16x16x32_bf16 v[36:39], a[48:51], a[20:23], v[36:39]
    v_mfma_f32_16x16x32_bf16 v[40:43], a[52:55], a[20:23], v[40:43]
    v_mfma_f32_16x16x32_bf16 v[32:35], a[56:59], a[24:27], v[32:35]
    v_mfma_f32_16x16x32_bf16 v[36:39], a[56:59], a[28:31], v[36:39]
    v_mfma_f32_16x16x32_bf16 v[40:43], a[60:63], a[28:31], v[40:43]
    s_waitcnt vmcnt(7)
    s_cmp_lg_u32 s49, 0
    s_cselect_b64 exec, 1, 0
    buffer_store_dword v3, v4, s[8:11], s43 offen sc1
    s_mov_b64 exec, -1
    s_add_u32 s43, s43, s49
    s_mov_b32 s49, 0
    s_cmp_eq_u32 s62, 1
    s_cbranch_scc1 Lta1_km
    s_waitcnt vmcnt(6)
    v_cmp_eq_u32 vcc, 0, v2
    s_nop 0
    s_cbranch_vccz Lta1_r
    s_mov_b32 s16, 0
Lta1_rp:
    buffer_load_dword v2, v11, s[8:11], s42 offen sc1
    s_add_u32 s16, s16, 1
    s_cmp_gt_u32 s16, 100000
    s_cbranch_scc1 L_role_ta_abort
    s_waitcnt vmcnt(0)
    v_cmp_eq_u32 vcc, 0, v2
    s_nop 0
    s_cbranch_vccnz Lta1_rp
Lta1_r:
    buffer_load_dwordx4 a[120:123], v9, s[8:11], s47 offen offset:0
    buffer_load_dwordx4 a[124:127], v9, s[8:11], s47 offen offset:64
    buffer_load_dwordx4 a[128:131], v9, s[8:11], s47 offen offset:128
    buffer_load_dwordx4 a[132:135], v9, s[8:11], s47 offen offset:192
    buffer_load_dwordx2 a[136:137], v10, s[8:11], s47 offen offset:2048
    buffer_load_dwordx2 a[138:139], v10, s[8:11], s47 offen offset:2560
    buffer_load_dwordx2 a[140:141], v10, s[8:11], s47 offen offset:3072
    buffer_load_dwordx2 a[142:143], v10, s[8:11], s47 offen offset:3584
Lta1_km:
    s_add_u32 s42, s42, 22528
    s_add_u32 s47, s47, 131072
    v_fma_f32 v32, v32, s52, v236
    v_fma_f32 v33, v33, s52, v237
    v_fma_f32 v34, v34, s52, v238
    v_fma_f32 v35, v35, s52, v239
    buffer_load_dwordx4 v[164:167], v0, s[28:31], s46 offen offset:2048
    buffer_load_dwordx4 v[168:171], v0, s[28:31], s46 offen offset:3072
    v_mul_f32 v36, s52, v36
    v_mul_f32 v37, s52, v37
    v_mul_f32 v38, s52, v38
    v_mul_f32 v39, s52, v39
    s_add_u32 s46, s51, 16777216
    buffer_load_dwordx4 v[172:175], v0, s[28:31], s46 offen offset:0
    buffer_load_dwordx4 v[176:179], v0, s[28:31], s46 offen offset:1024
    v_fma_f32 v40, v40, s52, v236
    v_fma_f32 v41, v41, s52, v237
    v_fma_f32 v42, v42, s52, v238
    v_fma_f32 v43, v43, s52, v239
    buffer_load_dwordx4 v[180:183], v0, s[28:31], s46 offen offset:2048
    buffer_load_dwordx4 v[184:187], v0, s[28:31], s46 offen offset:3072
    s_waitcnt vmcnt(13)
    v_mfma_f32_16x16x32_bf16 v[44:47], a[120:123], a[0:3], 0
    v_mfma_f32_16x16x32_bf16 v[48:51], a[120:123], a[4:7], 0
    s_add_u32 s46, s51, 16781312
    buffer_load_dwordx4 v[188:191], v0, s[28:31], s46 offen offset:0
    s_waitcnt vmcnt(13)
    v_mfma_f32_16x16x32_bf16 v[44:47], a[124:127], a[8:11], v[44:47]
    v_mfma_f32_16x16x32_bf16 v[48:51], a[124:127], a[12:15], v[48:51]
    buffer_load_dwordx4 v[192:195], v0, s[28:31], s46 offen offset:1024
    s_waitcnt vmcnt(13)
    v_mfma_f32_16x16x32_bf16 v[44:47], a[128:131], a[16:19], v[44:47]
    v_mfma_f32_16x16x32_bf16 v[48:51], a[128:131], a[20:23], v[48:51]
    buffer_load_dwordx4 v[196:199], v0, s[28:31], s46 offen offset:2048
    s_waitcnt vmcnt(13)
    v_mfma_f32_16x16x32_bf16 v[44:47], a[132:135], a[24:27], v[44:47]
    v_mfma_f32_16x16x32_bf16 v[48:51], a[132:135], a[28:31], v[48:51]
    buffer_load_dwordx4 v[200:203], v0, s[28:31], s46 offen offset:3072
    v_max3_f32 v5, v32, v33, v34
    v_max_f32 v5, v5, v35
    s_nop 0
    v_mul_f32 v44, s52, v44
    v_mul_f32 v45, s52, v45
    v_max3_f32 v5, v5, v44, v45
    v_mov_b32 v6, v5
    s_add_u32 s46, s51, 33554432
    buffer_load_dwordx4 v[204:207], v0, s[28:31], s46 offen offset:0
    v_permlane32_swap_b32 v5, v6
    v_max_f32 v5, v5, v6
    v_mov_b32 v6, v5
    buffer_load_dwordx4 v[208:211], v0, s[28:31], s46 offen offset:1024
    s_nop 0
    v_permlane16_swap_b32 v5, v6
    v_max_f32 v5, v5, v6
    v_sub_f32 v32, v32, v5
    v_sub_f32 v33, v33, v5
    v_sub_f32 v34, v34, v5
    v_sub_f32 v35, v35, v5
    v_sub_f32 v44, v44, v5
    v_sub_f32 v45, v45, v5
    v_exp_f32 v32, v32
    v_exp_f32 v33, v33
    v_exp_f32 v34, v34
    v_exp_f32 v35, v35
    v_exp_f32 v44, v44
    v_exp_f32 v45, v45
    v_cvt_pk_bf16_f32 v24, v32, v33
    v_cvt_pk_bf16_f32 v25, v34, v35
    v_mov_b32 v26, 0
    v_mov_b32 v27, 0
    v_cvt_pk_bf16_f32 v20, v44, v45
    v_cvt_pk_bf16_f32 v23, v44, v45
    v_mfma_f32_16x16x32_bf16 v[28:31], v[16:19], v[24:27], 0
    v_mfma_f32_16x16x32_bf16 v[76:79], a[64:67], v[24:27], 0
    v_mfma_f32_16x16x32_bf16 v[80:83], a[68:71], v[24:27], 0
    s_add_u32 s17, s42, 22528
    buffer_load_dword v15, v1, s[8:11], s17 offen sc1
    v_mfma_f32_16x16x32_bf16 v[84:87], a[72:75], v[24:27], 0
    v_mfma_f32_16x16x32_bf16 v[88:91], a[76:79], v[24:27], 0
    buffer_load_dwordx4 v[212:215], v0, s[28:31], s46 offen offset:2048
    v_mfma_f32_16x16x32_bf16 v[92:95], a[80:83], v[24:27], 0
    v_mfma_f32_16x16x32_bf16 v[96:99], a[84:87], v[24:27], 0
    buffer_load_dwordx4 v[216:219], v0, s[28:31], s46 offen offset:3072
    v_mfma_f32_16x16x16_bf16 v[28:31], v[16:17], v[20:21], v[28:31]
    v_mfma_f32_16x16x32_bf16 v[100:103], a[88:91], v[24:27], 0
    v_mfma_f32_16x16x32_bf16 v[104:107], a[92:95], v[24:27], 0
    s_add_u32 s46, s51, 33558528
    buffer_load_dwordx4 v[220:223], v0, s[28:31], s46 offen offset:0
    s_waitcnt vmcnt(19)
    v_mfma_f32_16x16x16_bf16 v[76:79], a[136:137], v[20:21], v[76:79]
    v_mfma_f32_16x16x16_bf16 v[80:83], a[136:137], v[22:23], v[80:83]
    v_rcp_f32 v6, v28
    s_waitcnt vmcnt(18)
    v_mfma_f32_16x16x16_bf16 v[84:87], a[138:139], v[20:21], v[84:87]
    v_mfma_f32_16x16x16_bf16 v[88:91], a[138:139], v[22:23], v[88:91]
    v_mul_f32 v76, v6, v76
    v_mul_f32 v80, v6, v80
    v_cvt_pk_bf16_f32 v108, v76, v80
    v_mul_f32 v77, v6, v77
    v_mul_f32 v81, v6, v81
    v_cvt_pk_bf16_f32 v109, v77, v81
    v_mul_f32 v78, v6, v78
    v_mul_f32 v82, v6, v82
    v_cvt_pk_bf16_f32 v110, v78, v82
    v_mul_f32 v79, v6, v79
    v_mul_f32 v83, v6, v83
    v_cvt_pk_bf16_f32 v111, v79, v83
    s_add_u32 s17, s48, 0
    buffer_store_dwordx4 v[108:111], v0, s[8:11], s17 offen offset:0 sc1
    buffer_load_dwordx4 v[224:227], v0, s[28:31], s46 offen offset:1024
    s_waitcnt vmcnt(19)
    v_mfma_f32_16x16x16_bf16 v[92:95], a[140:141], v[20:21], v[92:95]
    v_mfma_f32_16x16x16_bf16 v[96:99], a[140:141], v[22:23], v[96:99]
    v_mul_f32 v84, v6, v84
    v_mul_f32 v88, v6, v88
    v_cvt_pk_bf16_f32 v112, v84, v88
    v_mul_f32 v85, v6, v85
    v_mul_f32 v89, v6, v89
    v_cvt_pk_bf16_f32 v113, v85, v89
    v_mul_f32 v86, v6, v86
    v_mul_f32 v90, v6, v90
    v_cvt_pk_bf16_f32 v114, v86, v90
    v_mul_f32 v87, v6, v87
    v_mul_f32 v91, v6, v91
    v_cvt_pk_bf16_f32 v115, v87, v91
    buffer_store_dwordx4 v[112:115], v0, s[8:11], s17 offen offset:2048 sc1
    buffer_load_dwordx4 v[228:231], v0, s[28:31], s46 offen offset:2048
    s_waitcnt vmcnt(20)
    v_mfma_f32_16x16x16_bf16 v[100:103], a[142:143], v[20:21], v[100:103]
    v_mfma_f32_16x16x16_bf16 v[104:107], a[142:143], v[22:23], v[104:107]
    v_mul_f32 v92, v6, v92
    v_mul_f32 v96, v6, v96
    v_cvt_pk_bf16_f32 v116, v92, v96
    v_mul_f32 v93, v6, v93
    v_mul_f32 v97, v6, v97
    v_cvt_pk_bf16_f32 v117, v93, v97
    v_mul_f32 v94, v6, v94
    v_mul_f32 v98, v6, v98
    v_cvt_pk_bf16_f32 v118, v94, v98
    v_mul_f32 v95, v6, v95
    v_mul_f32 v99, v6, v99
    v_cvt_pk_bf16_f32 v119, v95, v99
    s_add_u32 s17, s48, 4096
    buffer_store_dwordx4 v[116:119], v0, s[8:11], s17 offen offset:0 sc1
    buffer_load_dwordx4 v[232:235], v0, s[28:31], s46 offen offset:3072
    v_mul_f32 v100, v6, v100
    v_mul_f32 v104, v6, v104
    v_cvt_pk_bf16_f32 v120, v100, v104
    v_mul_f32 v101, v6, v101
    v_mul_f32 v105, v6, v105
    v_cvt_pk_bf16_f32 v121, v101, v105
    v_mul_f32 v102, v6, v102
    v_mul_f32 v106, v6, v106
    v_cvt_pk_bf16_f32 v122, v102, v106
    v_mul_f32 v103, v6, v103
    v_mul_f32 v107, v6, v107
    v_cvt_pk_bf16_f32 v123, v103, v107
    buffer_store_dwordx4 v[120:123], v0, s[8:11], s17 offen offset:2048 sc1
    buffer_load_dwordx4 a[96:99], v9, s[20:23], s47 offen offset:0
    v_max3_f32 v5, v36, v37, v38
    v_max_f32 v5, v5, v39
    v_max3_f32 v5, v5, v40, v41
    v_max3_f32 v5, v5, v42, v43
    v_mul_f32 v48, s52, v48
    v_mul_f32 v49, s52, v49
    v_max3_f32 v5, v5, v48, v49
    v_mov_b32 v6, v5
    buffer_load_dwordx4 a[100:103], v9, s[20:23], s47 offen offset:64
    s_nop 0
    v_permlane32_swap_b32 v5, v6
    v_max_f32 v5, v5, v6
    v_mov_b32 v6, v5
    buffer_load_dwordx4 a[104:107], v9, s[20:23], s47 offen offset:128
    s_nop 0
    v_permlane16_swap_b32 v5, v6
    v_max_f32 v5, v5, v6
    v_sub_f32 v36, v36, v5
    v_sub_f32 v37, v37, v5
    v_sub_f32 v38, v38, v5
    v_sub_f32 v39, v39, v5
    v_sub_f32 v40, v40, v5
    v_sub_f32 v41, v41, v5
    v_sub_f32 v42, v42, v5
    v_sub_f32 v43, v43, v5
    v_sub_f32 v48, v48, v5
    v_sub_f32 v49, v49, v5
    v_exp_f32 v36, v36
    v_exp_f32 v37, v37
    v_exp_f32 v38, v38
    v_exp_f32 v39, v39
    v_exp_f32 v40, v40
    v_exp_f32 v41, v41
    v_exp_f32 v42, v42
    v_exp_f32 v43, v43
    v_exp_f32 v48, v48
    v_exp_f32 v49, v49
    v_cvt_pk_bf16_f32 v24, v36, v37
    v_cvt_pk_bf16_f32 v25, v38, v39
    v_cvt_pk_bf16_f32 v26, v40, v41
    v_cvt_pk_bf16_f32 v27, v42, v43
    v_cvt_pk_bf16_f32 v20, v48, v49
    v_cvt_pk_bf16_f32 v23, v48, v49
    v_mfma_f32_16x16x32_bf16 v[28:31], v[16:19], v[24:27], 0
    v_mfma_f32_16x16x32_bf16 v[76:79], a[64:67], v[24:27], 0
    v_mfma_f32_16x16x32_bf16 v[80:83], a[68:71], v[24:27], 0
    buffer_load_dwordx4 a[108:111], v9, s[20:23], s47 offen offset:192
    v_mfma_f32_16x16x32_bf16 v[84:87], a[72:75], v[24:27], 0
    v_mfma_f32_16x16x32_bf16 v[88:91], a[76:79], v[24:27], 0
    buffer_load_dwordx2 a[112:113], v10, s[20:23], s47 offen offset:2048
    v_mfma_f32_16x16x32_bf16 v[92:95], a[80:83], v[24:27], 0
    v_mfma_f32_16x16x32_bf16 v[96:99], a[84:87], v[24:27], 0
    buffer_load_dwordx2 a[114:115], v10, s[20:23], s47 offen offset:2560
    v_mfma_f32_16x16x16_bf16 v[28:31], v[16:17], v[20:21], v[28:31]
    v_mfma_f32_16x16x32_bf16 v[100:103], a[88:91], v[24:27], 0
    v_mfma_f32_16x16x32_bf16 v[104:107], a[92:95], v[24:27], 0
    buffer_load_dwordx2 a[116:117], v10, s[20:23], s47 offen offset:3072
    buffer_load_dwordx2 a[118:119], v10, s[20:23], s47 offen offset:3584
    v_mfma_f32_16x16x16_bf16 v[76:79], a[136:137], v[20:21], v[76:79]
    v_mfma_f32_16x16x16_bf16 v[80:83], a[136:137], v[22:23], v[80:83]
    v_rcp_f32 v6, v28
    v_mfma_f32_16x16x16_bf16 v[84:87], a[138:139], v[20:21], v[84:87]
    v_mfma_f32_16x16x16_bf16 v[88:91], a[138:139], v[22:23], v[88:91]
    v_mul_f32 v76, v6, v76
    v_mul_f32 v80, v6, v80
    v_cvt_pk_bf16_f32 v124, v76, v80
    v_mul_f32 v77, v6, v77
    v_mul_f32 v81, v6, v81
    v_cvt_pk_bf16_f32 v125, v77, v81
    v_mul_f32 v78, v6, v78
    v_mul_f32 v82, v6, v82
    v_cvt_pk_bf16_f32 v126, v78, v82
    v_mul_f32 v79, v6, v79
    v_mul_f32 v83, v6, v83
    v_cvt_pk_bf16_f32 v127, v79, v83
    s_add_u32 s17, s48, 0
    buffer_store_dwordx4 v[124:127], v0, s[8:11], s17 offen offset:1024 sc1
    v_mfma_f32_16x16x16_bf16 v[92:95], a[140:141], v[20:21], v[92:95]
    v_mfma_f32_16x16x16_bf16 v[96:99], a[140:141], v[22:23], v[96:99]
    v_mul_f32 v84, v6, v84
    v_mul_f32 v88, v6, v88
    v_cvt_pk_bf16_f32 v128, v84, v88
    v_mul_f32 v85, v6, v85
    v_mul_f32 v89, v6, v89
    v_cvt_pk_bf16_f32 v129, v85, v89
    v_mul_f32 v86, v6, v86
    v_mul_f32 v90, v6, v90
    v_cvt_pk_bf16_f32 v130, v86, v90
    v_mul_f32 v87, v6, v87
    v_mul_f32 v91, v6, v91
    v_cvt_pk_bf16_f32 v131, v87, v91
    buffer_store_dwordx4 v[128:131], v0, s[8:11], s17 offen offset:3072 sc1
    v_mfma_f32_16x16x16_bf16 v[100:103], a[142:143], v[20:21], v[100:103]
    v_mfma_f32_16x16x16_bf16 v[104:107], a[142:143], v[22:23], v[104:107]
    v_mul_f32 v92, v6, v92
    v_mul_f32 v96, v6, v96
    v_cvt_pk_bf16_f32 v132, v92, v96
    v_mul_f32 v93, v6, v93
    v_mul_f32 v97, v6, v97
    v_cvt_pk_bf16_f32 v133, v93, v97
    v_mul_f32 v94, v6, v94
    v_mul_f32 v98, v6, v98
    v_cvt_pk_bf16_f32 v134, v94, v98
    v_mul_f32 v95, v6, v95
    v_mul_f32 v99, v6, v99
    v_cvt_pk_bf16_f32 v135, v95, v99
    s_add_u32 s17, s48, 4096
    buffer_store_dwordx4 v[132:135], v0, s[8:11], s17 offen offset:1024 sc1
    v_mul_f32 v100, v6, v100
    v_mul_f32 v104, v6, v104
    v_cvt_pk_bf16_f32 v136, v100, v104
    v_mul_f32 v101, v6, v101
    v_mul_f32 v105, v6, v105
    v_cvt_pk_bf16_f32 v137, v101, v105
    v_mul_f32 v102, v6, v102
    v_mul_f32 v106, v6, v106
    v_cvt_pk_bf16_f32 v138, v102, v106
    v_mul_f32 v103, v6, v103
    v_mul_f32 v107, v6, v107
    v_cvt_pk_bf16_f32 v139, v103, v107
    buffer_store_dwordx4 v[136:139], v0, s[8:11], s17 offen offset:3072 sc1
    s_add_u32 s48, s48, 262144
    s_mov_b32 s49, 22528
    s_cmp_ge_u32 s37, 64
    s_cbranch_scc1 Lta_end
    s_branch Lta0
Lta_end:
    s_waitcnt vmcnt(0)
    s_mov_b64 exec, 1
    buffer_store_dword v3, v4, s[8:11], s43 offen sc1
    s_mov_b64 exec, -1
    s_branch L_role_ta_exit
L_role_ta_abort:
    s_waitcnt lgkmcnt(0)
    s_mov_b64 exec, -1
    v_mov_b32 v0, 60
    s_lshl_b32 s5, s3, 8
    s_or_b32 s5, s5, s4
    s_or_b32 s5, s5, 0x10000
    v_mov_b32 v1, s5
    global_store_dword v0, v1, s[12:13]
    s_endpgm
L_role_ta_exit:
    s_endpgm
.p2align 6
L_role_tw:
    v_and_b32 v5, 63, v0
    v_lshlrev_b32 v0, 4, v5
    v_and_b32 v7, 15, v5
    v_lshrrev_b32 v8, 4, v5
    v_min_u32 v1, 31, v5
    v_lshrrev_b32 v6, 2, v1
    v_and_b32 v1, 3, v1
    v_lshlrev_b32 v1, 2, v1
    v_lshl_add_u32 v1, v6, 7, v1
    v_mov_b32 v3, 1
    v_mov_b32 v4, 0
    s_mov_b32 s44, 0x05040100
    s_mov_b32 s45, 0x07060302
    s_cmp_lg_u32 s14, 0
    s_cbranch_scc1 Ltw_gate_d
    v_mov_b32 v5, 48
    s_mov_b32 s16, 0
Ltw_gate:
    global_load_dword v6, v5, s[12:13] sc1
    s_add_u32 s16, s16, 1
    s_cmp_gt_u32 s16, 100000
    s_cbranch_scc1 L_role_tw_abort
    s_waitcnt vmcnt(0)
    v_cmp_gt_u32 vcc, 32, v6
    s_nop 0
    s_cbranch_vccz Ltw_gate_d
    s_sleep 100
    s_branch Ltw_gate
Ltw_gate_d:
    s_barrier
    s_load_dwordx2 s[20:21], s[0:1], 64
    s_mov_b32 s22, 4718592
    s_mov_b32 s23, 0x00020000
    s_waitcnt lgkmcnt(0)
    s_and_b32 s21, s21, 0xffff
    s_load_dwordx2 s[24:25], s[0:1], 80
    s_mov_b32 s26, 2359296
    s_mov_b32 s27, 0x00020000
    s_waitcnt lgkmcnt(0)
    s_and_b32 s25, s25, 0xffff
    s_mul_i32 s17, s15, 43
    s_lshr_b32 s32, s17, 9
    s_mul_i32 s17, s32, 12
    s_sub_u32 s50, s15, s17
    s_add_u32 s33, s32, 30
    s_cmp_eq_u32 s32, 2
    s_cselect_b32 s33, 0, s33
    s_cselect_b32 s32, 64, s32
    s_mul_i32 s49, s50, 96
    s_mul_i32 s17, s14, 1179648
    s_add_u32 s49, s49, s17
    v_mul_u32_u24 v5, 4608, v8
    v_lshl_add_u32 v9, v7, 2, v5
    v_add_u32 v10, 18432, v9
    v_and_b32 v6, 14, v7
    v_lshl_add_u32 v12, v6, 1, v5
    v_add_u32 v12, 64, v12
    v_add_u32 v13, 18432, v12
    v_and_b32 v5, 1, v7
    v_mov_b32 v11, s44
    v_mov_b32 v6, s45
    v_cmp_eq_u32 vcc, 1, v5
    s_nop 1
    v_cndmask_b32 v11, v11, v6, vcc
    s_add_u32 s17, s49, 0
    buffer_load_dword v16, v9, s[20:23], s17 offen
    buffer_load_dword v17, v10, s[20:23], s17 offen
    buffer_load_dword v18, v12, s[20:23], s17 offen
    buffer_load_dword v19, v13, s[20:23], s17 offen
    s_add_u32 s17, s49, 1152
    buffer_load_dword v20, v9, s[20:23], s17 offen
    buffer_load_dword v21, v10, s[20:23], s17 offen
    buffer_load_dword v22, v12, s[20:23], s17 offen
    buffer_load_dword v23, v13, s[20:23], s17 offen
    s_add_u32 s17, s49, 2304
    buffer_load_dword v24, v9, s[20:23], s17 offen
    buffer_load_dword v25, v10, s[20:23], s17 offen
    buffer_load_dword v26, v12, s[20:23], s17 offen
    buffer_load_dword v27, v13, s[20:23], s17 offen
    s_add_u32 s17, s49, 3456
    buffer_load_dword v28, v9, s[20:23], s17 offen
    buffer_load_dword v29, v10, s[20:23], s17 offen
    buffer_load_dword v30, v12, s[20:23], s17 offen
    buffer_load_dword v31, v13, s[20:23], s17 offen
    s_add_u32 s17, s49, 36864
    buffer_load_dword v32, v9, s[20:23], s17 offen
    buffer_load_dword v33, v10, s[20:23], s17 offen
    buffer_load_dword v34, v12, s[20:23], s17 offen
    buffer_load_dword v35, v13, s[20:23], s17 offen
    s_add_u32 s17, s49, 38016
    buffer_load_dword v36, v9, s[20:23], s17 offen
    buffer_load_dword v37, v10, s[20:23], s17 offen
    buffer_load_dword v38, v12, s[20:23], s17 offen
    buffer_load_dword v39, v13, s[20:23], s17 offen
    s_add_u32 s17, s49, 39168
    buffer_load_dword v40, v9, s[20:23], s17 offen
    buffer_load_dword v41, v10, s[20:23], s17 offen
    buffer_load_dword v42, v12, s[20:23], s17 offen
    buffer_load_dword v43, v13, s[20:23], s17 offen
    s_add_u32 s17, s49, 40320
    buffer_load_dword v44, v9, s[20:23], s17 offen
    buffer_load_dword v45, v10, s[20:23], s17 offen
    buffer_load_dword v46, v12, s[20:23], s17 offen
    buffer_load_dword v47, v13, s[20:23], s17 offen
    s_add_u32 s17, s49, 73728
    buffer_load_dword v48, v9, s[20:23], s17 offen
    buffer_load_dword v49, v10, s[20:23], s17 offen
    buffer_load_dword v50, v12, s[20:23], s17 offen
    buffer_load_dword v51, v13, s[20:23], s17 offen
    s_add_u32 s17, s49, 74880
    buffer_load_dword v52, v9, s[20:23], s17 offen
    buffer_load_dword v53, v10, s[20:23], s17 offen
    buffer_load_dword v54, v12, s[20:23], s17 offen
    buffer_load_dword v55, v13, s[20:23], s17 offen
    s_add_u32 s17, s49, 76032
    buffer_load_dword v56, v9, s[20:23], s17 offen
    buffer_load_dword v57, v10, s[20:23], s17 offen
    buffer_load_dword v58, v12, s[20:23], s17 offen
    buffer_load_dword v59, v13, s[20:23], s17 offen
    s_add_u32 s17, s49, 77184
    buffer_load_dword v60, v9, s[20:23], s17 offen
    buffer_load_dword v61, v10, s[20:23], s17 offen
    buffer_load_dword v62, v12, s[20:23], s17 offen
    buffer_load_dword v63, v13, s[20:23], s17 offen
    s_add_u32 s17, s49, 110592
    buffer_load_dword v64, v9, s[20:23], s17 offen
    buffer_load_dword v65, v10, s[20:23], s17 offen
    buffer_load_dword v66, v12, s[20:23], s17 offen
    buffer_load_dword v67, v13, s[20:23], s17 offen
    s_add_u32 s17, s49, 111744
    buffer_load_dword v68, v9, s[20:23], s17 offen
    buffer_load_dword v69, v10, s[20:23], s17 offen
    buffer_load_dword v70, v12, s[20:23], s17 offen
    buffer_load_dword v71, v13, s[20:23], s17 offen
    s_add_u32 s17, s49, 112896
    buffer_load_dword v72, v9, s[20:23], s17 offen
    buffer_load_dword v73, v10, s[20:23], s17 offen
    buffer_load_dword v74, v12, s[20:23], s17 offen
    buffer_load_dword v75, v13, s[20:23], s17 offen
    s_waitcnt vmcnt(58)
    v_perm_b32 v5, v17, v16, s44
    v_perm_b32 v6, v17, v16, s45
    s_waitcnt vmcnt(56)
    v_perm_b32 v128, v19, v18, v11
    v_accvgpr_write_b32 a0, v5
    v_accvgpr_write_b32 a4, v6
    s_add_u32 s17, s49, 114048
    buffer_load_dword v76, v9, s[20:23], s17 offen
    buffer_load_dword v77, v10, s[20:23], s17 offen
    buffer_load_dword v78, v12, s[20:23], s17 offen
    buffer_load_dword v79, v13, s[20:23], s17 offen
    s_waitcnt vmcnt(58)
    v_perm_b32 v5, v21, v20, s44
    v_perm_b32 v6, v21, v20, s45
    s_waitcnt vmcnt(56)
    v_perm_b32 v129, v23, v22, v11
    v_accvgpr_write_b32 a1, v5
    v_accvgpr_write_b32 a5, v6
    s_add_u32 s17, s49, 147456
    buffer_load_dword v80, v9, s[20:23], s17 offen
    buffer_load_dword v81, v10, s[20:23], s17 offen
    buffer_load_dword v82, v12, s[20:23], s17 offen
    buffer_load_dword v83, v13, s[20:23], s17 offen
    s_waitcnt vmcnt(58)
    v_perm_b32 v5, v25, v24, s44
    v_perm_b32 v6, v25, v24, s45
    s_waitcnt vmcnt(56)
    v_perm_b32 v130, v27, v26, v11
    v_accvgpr_write_b32 a2, v5
    v_accvgpr_write_b32 a6, v6
    s_add_u32 s17, s49, 148608
    buffer_load_dword v84, v9, s[20:23], s17 offen
    buffer_load_dword v85, v10, s[20:23], s17 offen
    buffer_load_dword v86, v12, s[20:23], s17 offen
    buffer_load_dword v87, v13, s[20:23], s17 offen
    s_waitcnt vmcnt(58)
    v_perm_b32 v5, v29, v28, s44
    v_perm_b32 v6, v29, v28, s45
    s_waitcnt vmcnt(56)
    v_perm_b32 v131, v31, v30, v11
    v_accvgpr_write_b32 a3, v5
    v_accvgpr_write_b32 a7, v6
    s_add_u32 s17, s49, 149760
    buffer_load_dword v88, v9, s[20:23], s17 offen
    buffer_load_dword v89, v10, s[20:23], s17 offen
    buffer_load_dword v90, v12, s[20:23], s17 offen
    buffer_load_dword v91, v13, s[20:23], s17 offen
    s_waitcnt vmcnt(58)
    v_perm_b32 v5, v33, v32, s44
    v_perm_b32 v6, v33, v32, s45
    s_waitcnt vmcnt(56)
    v_perm_b32 v132, v35, v34, v11
    v_accvgpr_write_b32 a8, v5
    v_accvgpr_write_b32 a12, v6
    s_add_u32 s17, s49, 150912
    buffer_load_dword v92, v9, s[20:23], s17 offen
    buffer_load_dword v93, v10, s[20:23], s17 offen
    buffer_load_dword v94, v12, s[20:23], s17 offen
    buffer_load_dword v95, v13, s[20:23], s17 offen
    s_waitcnt vmcnt(58)
    v_perm_b32 v5, v37, v36, s44
    v_perm_b32 v6, v37, v36, s45
    s_waitcnt vmcnt(56)
    v_perm_b32 v133, v39, v38, v11
    v_accvgpr_write_b32 a9, v5
    v_accvgpr_write_b32 a13, v6
    s_add_u32 s17, s49, 184320
    buffer_load_dword v96, v9, s[20:23], s17 offen
    buffer_load_dword v97, v10, s[20:23], s17 offen
    buffer_load_dword v98, v12, s[20:23], s17 offen
    buffer_load_dword v99, v13, s[20:23], s17 offen
    s_waitcnt vmcnt(58)
    v_perm_b32 v5, v41, v40, s44
    v_perm_b32 v6, v41, v40, s45
    s_waitcnt vmcnt(56)
    v_perm_b32 v134, v43, v42, v11
    v_accvgpr_write_b32 a10, v5
    v_accvgpr_write_b32 a14, v6
    s_add_u32 s17, s49, 185472
    buffer_load_dword v100, v9, s[20:23], s17 offen
    buffer_load_dword v101, v10, s[20:23], s17 offen
    buffer_load_dword v102, v12, s[20:23], s17 offen
    buffer_load_dword v103, v13, s[20:23], s17 offen
    s_waitcnt vmcnt(58)
    v_perm_b32 v5, v45, v44, s44
    v_perm_b32 v6, v45, v44, s45
    s_waitcnt vmcnt(56)
    v_perm_b32 v135, v47, v46, v11
    v_accvgpr_write_b32 a11, v5
    v_accvgpr_write_b32 a15, v6
    s_add_u32 s17, s49, 186624
    buffer_load_dword v104, v9, s[20:23], s17 offen
    buffer_load_dword v105, v10, s[20:23], s17 offen
    buffer_load_dword v106, v12, s[20:23], s17 offen
    buffer_load_dword v107, v13, s[20:23], s17 offen
    s_waitcnt vmcnt(58)
    v_perm_b32 v5, v49, v48, s44
    v_perm_b32 v6, v49, v48, s45
    s_waitcnt vmcnt(56)
    v_perm_b32 v136, v51, v50, v11
    v_accvgpr_write_b32 a16, v5
    v_accvgpr_write_b32 a20, v6
    s_add_u32 s17, s49, 187776
    buffer_load_dword v108, v9, s[20:23], s17 offen
    buffer_load_dword v109, v10, s[20:23], s17 offen
    buffer_load_dword v110, v12, s[20:23], s17 offen
    buffer_load_dword v111, v13, s[20:23], s17 offen
    s_waitcnt vmcnt(58)
    v_perm_b32 v5, v53, v52, s44
    v_perm_b32 v6, v53, v52, s45
    s_waitcnt vmcnt(56)
    v_perm_b32 v137, v55, v54, v11
    v_accvgpr_write_b32 a17, v5
    v_accvgpr_write_b32 a21, v6
    s_add_u32 s17, s49, 221184
    buffer_load_dword v112, v9, s[20:23], s17 offen
    buffer_load_dword v113, v10, s[20:23], s17 offen
    buffer_load_dword v114, v12, s[20:23], s17 offen
    buffer_load_dword v115, v13, s[20:23], s17 offen
    s_waitcnt vmcnt(58)
    v_perm_b32 v5, v57, v56, s44
    v_perm_b32 v6, v57, v56, s45
    s_waitcnt vmcnt(56)
    v_perm_b32 v138, v59, v58, v11
    v_accvgpr_write_b32 a18, v5
    v_accvgpr_write_b32 a22, v6
    s_add_u32 s17, s49, 222336
    buffer_load_dword v116, v9, s[20:23], s17 offen
    buffer_load_dword v117, v10, s[20:23], s17 offen
    buffer_load_dword v118, v12, s[20:23], s17 offen
    buffer_load_dword v119, v13, s[20:23], s17 offen
    s_waitcnt vmcnt(58)
    v_perm_b32 v5, v61, v60, s44
    v_perm_b32 v6, v61, v60, s45
    s_waitcnt vmcnt(56)
    v_perm_b32 v139, v63, v62, v11
    v_accvgpr_write_b32 a19, v5
    v_accvgpr_write_b32 a23, v6
    s_add_u32 s17, s49, 223488
    buffer_load_dword v120, v9, s[20:23], s17 offen
    buffer_load_dword v121, v10, s[20:23], s17 offen
    buffer_load_dword v122, v12, s[20:23], s17 offen
    buffer_load_dword v123, v13, s[20:23], s17 offen
    s_waitcnt vmcnt(58)
    v_perm_b32 v5, v65, v64, s44
    v_perm_b32 v6, v65, v64, s45
    s_waitcnt vmcnt(56)
    v_perm_b32 v140, v67, v66, v11
    v_accvgpr_write_b32 a24, v5
    v_accvgpr_write_b32 a28, v6
    s_add_u32 s17, s49, 224640
    buffer_load_dword v124, v9, s[20:23], s17 offen
    buffer_load_dword v125, v10, s[20:23], s17 offen
    buffer_load_dword v126, v12, s[20:23], s17 offen
    buffer_load_dword v127, v13, s[20:23], s17 offen
    s_waitcnt vmcnt(58)
    v_perm_b32 v5, v69, v68, s44
    v_perm_b32 v6, v69, v68, s45
    s_waitcnt vmcnt(56)
    v_perm_b32 v141, v71, v70, v11
    v_accvgpr_write_b32 a25, v5
    v_accvgpr_write_b32 a29, v6
    s_add_u32 s17, s49, 258048
    buffer_load_dword v16, v9, s[20:23], s17 offen
    buffer_load_dword v17, v10, s[20:23], s17 offen
    buffer_load_dword v18, v12, s[20:23], s17 offen
    buffer_load_dword v19, v13, s[20:23], s17 offen
    s_waitcnt vmcnt(58)
    v_perm_b32 v5, v73, v72, s44
    v_perm_b32 v6, v73, v72, s45
    s_waitcnt vmcnt(56)
    v_perm_b32 v142, v75, v74, v11
    v_accvgpr_write_b32 a26, v5
    v_accvgpr_write_b32 a30, v6
    s_add_u32 s17, s49, 259200
    buffer_load_dword v20, v9, s[20:23], s17 offen
    buffer_load_dword v21, v10, s[20:23], s17 offen
    buffer_load_dword v22, v12, s[20:23], s17 offen
    buffer_load_dword v23, v13, s[20:23], s17 offen
    s_waitcnt vmcnt(58)
    v_perm_b32 v5, v77, v76, s44
    v_perm_b32 v6, v77, v76, s45
    s_waitcnt vmcnt(56)
    v_perm_b32 v143, v79, v78, v11
    v_accvgpr_write_b32 a27, v5
    v_accvgpr_write_b32 a31, v6
    s_add_u32 s17, s49, 260352
    buffer_load_dword v24, v9, s[20:23], s17 offen
    buffer_load_dword v25, v10, s[20:23], s17 offen
    buffer_load_dword v26, v12, s[20:23], s17 offen
    buffer_load_dword v27, v13, s[20:23], s17 offen
    s_waitcnt vmcnt(58)
    v_perm_b32 v5, v81, v80, s44
    v_perm_b32 v6, v81, v80, s45
    s_waitcnt vmcnt(56)
    v_perm_b32 v144, v83, v82, v11
    v_accvgpr_write_b32 a32, v5
    v_accvgpr_write_b32 a36, v6
    s_add_u32 s17, s49, 261504
    buffer_load_dword v28, v9, s[20:23], s17 offen
    buffer_load_dword v29, v10, s[20:23], s17 offen
    buffer_load_dword v30, v12, s[20:23], s17 offen
    buffer_load_dword v31, v13, s[20:23], s17 offen
    s_waitcnt vmcnt(58)
    v_perm_b32 v5, v85, v84, s44
    v_perm_b32 v6, v85, v84, s45
    s_waitcnt vmcnt(56)
    v_perm_b32 v145, v87, v86, v11
    v_accvgpr_write_b32 a33, v5
    v_accvgpr_write_b32 a37, v6
    s_add_u32 s17, s49, 294912
    buffer_load_dword v32, v9, s[20:23], s17 offen
    buffer_load_dword v33, v10, s[20:23], s17 offen
    buffer_load_dword v34, v12, s[20:23], s17 offen
    buffer_load_dword v35, v13, s[20:23], s17 offen
    s_waitcnt vmcnt(58)
    v_perm_b32 v5, v89, v88, s44
    v_perm_b32 v6, v89, v88, s45
    s_waitcnt vmcnt(56)
    v_perm_b32 v146, v91, v90, v11
    v_accvgpr_write_b32 a34, v5
    v_accvgpr_write_b32 a38, v6
    s_add_u32 s17, s49, 296064
    buffer_load_dword v36, v9, s[20:23], s17 offen
    buffer_load_dword v37, v10, s[20:23], s17 offen
    buffer_load_dword v38, v12, s[20:23], s17 offen
    buffer_load_dword v39, v13, s[20:23], s17 offen
    s_waitcnt vmcnt(58)
    v_perm_b32 v5, v93, v92, s44
    v_perm_b32 v6, v93, v92, s45
    s_waitcnt vmcnt(56)
    v_perm_b32 v147, v95, v94, v11
    v_accvgpr_write_b32 a35, v5
    v_accvgpr_write_b32 a39, v6
    s_add_u32 s17, s49, 297216
    buffer_load_dword v40, v9, s[20:23], s17 offen
    buffer_load_dword v41, v10, s[20:23], s17 offen
    buffer_load_dword v42, v12, s[20:23], s17 offen
    buffer_load_dword v43, v13, s[20:23], s17 offen
    s_waitcnt vmcnt(58)
    v_perm_b32 v5, v97, v96, s44
    v_perm_b32 v6, v97, v96, s45
    s_waitcnt vmcnt(56)
    v_perm_b32 v148, v99, v98, v11
    v_accvgpr_write_b32 a40, v5
    v_accvgpr_write_b32 a44, v6
    s_add_u32 s17, s49, 298368
    buffer_load_dword v44, v9, s[20:23], s17 offen
    buffer_load_dword v45, v10, s[20:23], s17 offen
    buffer_load_dword v46, v12, s[20:23], s17 offen
    buffer_load_dword v47, v13, s[20:23], s17 offen
    s_waitcnt vmcnt(58)
    v_perm_b32 v5, v101, v100, s44
    v_perm_b32 v6, v101, v100, s45
    s_waitcnt vmcnt(56)
    v_perm_b32 v149, v103, v102, v11
    v_accvgpr_write_b32 a41, v5
    v_accvgpr_write_b32 a45, v6
    s_add_u32 s17, s49, 331776
    buffer_load_dword v48, v9, s[20:23], s17 offen
    buffer_load_dword v49, v10, s[20:23], s17 offen
    buffer_load_dword v50, v12, s[20:23], s17 offen
    buffer_load_dword v51, v13, s[20:23], s17 offen
    s_waitcnt vmcnt(58)
    v_perm_b32 v5, v105, v104, s44
    v_perm_b32 v6, v105, v104, s45
    s_waitcnt vmcnt(56)
    v_perm_b32 v150, v107, v106, v11
    v_accvgpr_write_b32 a42, v5
    v_accvgpr_write_b32 a46, v6
    s_add_u32 s17, s49, 332928
    buffer_load_dword v52, v9, s[20:23], s17 offen
    buffer_load_dword v53, v10, s[20:23], s17 offen
    buffer_load_dword v54, v12, s[20:23], s17 offen
    buffer_load_dword v55, v13, s[20:23], s17 offen
    s_waitcnt vmcnt(58)
    v_perm_b32 v5, v109, v108, s44
    v_perm_b32 v6, v109, v108, s45
    s_waitcnt vmcnt(56)
    v_perm_b32 v151, v111, v110, v11
    v_accvgpr_write_b32 a43, v5
    v_accvgpr_write_b32 a47, v6
    s_add_u32 s17, s49, 334080
    buffer_load_dword v56, v9, s[20:23], s17 offen
    buffer_load_dword v57, v10, s[20:23], s17 offen
    buffer_load_dword v58, v12, s[20:23], s17 offen
    buffer_load_dword v59, v13, s[20:23], s17 offen
    s_waitcnt vmcnt(58)
    v_perm_b32 v5, v113, v112, s44
    v_perm_b32 v6, v113, v112, s45
    s_waitcnt vmcnt(56)
    v_perm_b32 v152, v115, v114, v11
    v_accvgpr_write_b32 a48, v5
    v_accvgpr_write_b32 a52, v6
    s_add_u32 s17, s49, 335232
    buffer_load_dword v60, v9, s[20:23], s17 offen
    buffer_load_dword v61, v10, s[20:23], s17 offen
    buffer_load_dword v62, v12, s[20:23], s17 offen
    buffer_load_dword v63, v13, s[20:23], s17 offen
    s_waitcnt vmcnt(58)
    v_perm_b32 v5, v117, v116, s44
    v_perm_b32 v6, v117, v116, s45
    s_waitcnt vmcnt(56)
    v_perm_b32 v153, v119, v118, v11
    v_accvgpr_write_b32 a49, v5
    v_accvgpr_write_b32 a53, v6
    s_add_u32 s17, s49, 368640
    buffer_load_dword v64, v9, s[20:23], s17 offen
    buffer_load_dword v65, v10, s[20:23], s17 offen
    buffer_load_dword v66, v12, s[20:23], s17 offen
    buffer_load_dword v67, v13, s[20:23], s17 offen
    s_waitcnt vmcnt(58)
    v_perm_b32 v5, v121, v120, s44
    v_perm_b32 v6, v121, v120, s45
    s_waitcnt vmcnt(56)
    v_perm_b32 v154, v123, v122, v11
    v_accvgpr_write_b32 a50, v5
    v_accvgpr_write_b32 a54, v6
    s_add_u32 s17, s49, 369792
    buffer_load_dword v68, v9, s[20:23], s17 offen
    buffer_load_dword v69, v10, s[20:23], s17 offen
    buffer_load_dword v70, v12, s[20:23], s17 offen
    buffer_load_dword v71, v13, s[20:23], s17 offen
    s_waitcnt vmcnt(58)
    v_perm_b32 v5, v125, v124, s44
    v_perm_b32 v6, v125, v124, s45
    s_waitcnt vmcnt(56)
    v_perm_b32 v155, v127, v126, v11
    v_accvgpr_write_b32 a51, v5
    v_accvgpr_write_b32 a55, v6
    s_add_u32 s17, s49, 370944
    buffer_load_dword v72, v9, s[20:23], s17 offen
    buffer_load_dword v73, v10, s[20:23], s17 offen
    buffer_load_dword v74, v12, s[20:23], s17 offen
    buffer_load_dword v75, v13, s[20:23], s17 offen
    s_waitcnt vmcnt(58)
    v_perm_b32 v5, v17, v16, s44
    v_perm_b32 v6, v17, v16, s45
    s_waitcnt vmcnt(56)
    v_perm_b32 v156, v19, v18, v11
    v_accvgpr_write_b32 a56, v5
    v_accvgpr_write_b32 a60, v6
    s_add_u32 s17, s49, 372096
    buffer_load_dword v76, v9, s[20:23], s17 offen
    buffer_load_dword v77, v10, s[20:23], s17 offen
    buffer_load_dword v78, v12, s[20:23], s17 offen
    buffer_load_dword v79, v13, s[20:23], s17 offen
    s_waitcnt vmcnt(58)
    v_perm_b32 v5, v21, v20, s44
    v_perm_b32 v6, v21, v20, s45
    s_waitcnt vmcnt(56)
    v_perm_b32 v157, v23, v22, v11
    v_accvgpr_write_b32 a57, v5
    v_accvgpr_write_b32 a61, v6
    s_add_u32 s17, s49, 405504
    buffer_load_dword v80, v9, s[20:23], s17 offen
    buffer_load_dword v81, v10, s[20:23], s17 offen
    buffer_load_dword v82, v12, s[20:23], s17 offen
    buffer_load_dword v83, v13, s[20:23], s17 offen
    s_waitcnt vmcnt(58)
    v_perm_b32 v5, v25, v24, s44
    v_perm_b32 v6, v25, v24, s45
    s_waitcnt vmcnt(56)
    v_perm_b32 v158, v27, v26, v11
    v_accvgpr_write_b32 a58, v5
    v_accvgpr_write_b32 a62, v6
    s_add_u32 s17, s49, 406656
    buffer_load_dword v84, v9, s[20:23], s17 offen
    buffer_load_dword v85, v10, s[20:23], s17 offen
    buffer_load_dword v86, v12, s[20:23], s17 offen
    buffer_load_dword v87, v13, s[20:23], s17 offen
    s_waitcnt vmcnt(58)
    v_perm_b32 v5, v29, v28, s44
    v_perm_b32 v6, v29, v28, s45
    s_waitcnt vmcnt(56)
    v_perm_b32 v159, v31, v30, v11
    v_accvgpr_write_b32 a59, v5
    v_accvgpr_write_b32 a63, v6
    s_add_u32 s17, s49, 407808
    buffer_load_dword v88, v9, s[20:23], s17 offen
    buffer_load_dword v89, v10, s[20:23], s17 offen
    buffer_load_dword v90, v12, s[20:23], s17 offen
    buffer_load_dword v91, v13, s[20:23], s17 offen
    s_waitcnt vmcnt(58)
    v_perm_b32 v5, v33, v32, s44
    v_perm_b32 v6, v33, v32, s45
    s_waitcnt vmcnt(56)
    v_perm_b32 v160, v35, v34, v11
    v_accvgpr_write_b32 a64, v5
    v_accvgpr_write_b32 a68, v6
    s_add_u32 s17, s49, 408960
    buffer_load_dword v92, v9, s[20:23], s17 offen
    buffer_load_dword v93, v10, s[20:23], s17 offen
    buffer_load_dword v94, v12, s[20:23], s17 offen
    buffer_load_dword v95, v13, s[20:23], s17 offen
    s_waitcnt vmcnt(58)
    v_perm_b32 v5, v37, v36, s44
    v_perm_b32 v6, v37, v36, s45
    s_waitcnt vmcnt(56)
    v_perm_b32 v161, v39, v38, v11
    v_accvgpr_write_b32 a65, v5
    v_accvgpr_write_b32 a69, v6
    s_add_u32 s17, s49, 442368
    buffer_load_dword v96, v9, s[20:23], s17 offen
    buffer_load_dword v97, v10, s[20:23], s17 offen
    buffer_load_dword v98, v12, s[20:23], s17 offen
    buffer_load_dword v99, v13, s[20:23], s17 offen
    s_waitcnt vmcnt(58)
    v_perm_b32 v5, v41, v40, s44
    v_perm_b32 v6, v41, v40, s45
    s_waitcnt vmcnt(56)
    v_perm_b32 v162, v43, v42, v11
    v_accvgpr_write_b32 a66, v5
    v_accvgpr_write_b32 a70, v6
    s_add_u32 s17, s49, 443520
    buffer_load_dword v100, v9, s[20:23], s17 offen
    buffer_load_dword v101, v10, s[20:23], s17 offen
    buffer_load_dword v102, v12, s[20:23], s17 offen
    buffer_load_dword v103, v13, s[20:23], s17 offen
    s_waitcnt vmcnt(58)
    v_perm_b32 v5, v45, v44, s44
    v_perm_b32 v6, v45, v44, s45
    s_waitcnt vmcnt(56)
    v_perm_b32 v163, v47, v46, v11
    v_accvgpr_write_b32 a67, v5
    v_accvgpr_write_b32 a71, v6
    s_add_u32 s17, s49, 444672
    buffer_load_dword v104, v9, s[20:23], s17 offen
    buffer_load_dword v105, v10, s[20:23], s17 offen
    buffer_load_dword v106, v12, s[20:23], s17 offen
    buffer_load_dword v107, v13, s[20:23], s17 offen
    s_waitcnt vmcnt(58)
    v_perm_b32 v5, v49, v48, s44
    v_perm_b32 v6, v49, v48, s45
    s_waitcnt vmcnt(56)
    v_perm_b32 v164, v51, v50, v11
    v_accvgpr_write_b32 a72, v5
    v_accvgpr_write_b32 a76, v6
    s_add_u32 s17, s49, 445824
    buffer_load_dword v108, v9, s[20:23], s17 offen
    buffer_load_dword v109, v10, s[20:23], s17 offen
    buffer_load_dword v110, v12, s[20:23], s17 offen
    buffer_load_dword v111, v13, s[20:23], s17 offen
    s_waitcnt vmcnt(58)
    v_perm_b32 v5, v53, v52, s44
    v_perm_b32 v6, v53, v52, s45
    s_waitcnt vmcnt(56)
    v_perm_b32 v165, v55, v54, v11
    v_accvgpr_write_b32 a73, v5
    v_accvgpr_write_b32 a77, v6
    s_add_u32 s17, s49, 479232
    buffer_load_dword v112, v9, s[20:23], s17 offen
    buffer_load_dword v113, v10, s[20:23], s17 offen
    buffer_load_dword v114, v12, s[20:23], s17 offen
    buffer_load_dword v115, v13, s[20:23], s17 offen
    s_waitcnt vmcnt(58)
    v_perm_b32 v5, v57, v56, s44
    v_perm_b32 v6, v57, v56, s45
    s_waitcnt vmcnt(56)
    v_perm_b32 v166, v59, v58, v11
    v_accvgpr_write_b32 a74, v5
    v_accvgpr_write_b32 a78, v6
    s_add_u32 s17, s49, 480384
    buffer_load_dword v116, v9, s[20:23], s17 offen
    buffer_load_dword v117, v10, s[20:23], s17 offen
    buffer_load_dword v118, v12, s[20:23], s17 offen
    buffer_load_dword v119, v13, s[20:23], s17 offen
    s_waitcnt vmcnt(58)
    v_perm_b32 v5, v61, v60, s44
    v_perm_b32 v6, v61, v60, s45
    s_waitcnt vmcnt(56)
    v_perm_b32 v167, v63, v62, v11
    v_accvgpr_write_b32 a75, v5
    v_accvgpr_write_b32 a79, v6
    s_add_u32 s17, s49, 481536
    buffer_load_dword v120, v9, s[20:23], s17 offen
    buffer_load_dword v121, v10, s[20:23], s17 offen
    buffer_load_dword v122, v12, s[20:23], s17 offen
    buffer_load_dword v123, v13, s[20:23], s17 offen
    s_waitcnt vmcnt(58)
    v_perm_b32 v5, v65, v64, s44
    v_perm_b32 v6, v65, v64, s45
    s_waitcnt vmcnt(56)
    v_perm_b32 v168, v67, v66, v11
    v_accvgpr_write_b32 a80, v5
    v_accvgpr_write_b32 a84, v6
    s_add_u32 s17, s49, 482688
    buffer_load_dword v124, v9, s[20:23], s17 offen
    buffer_load_dword v125, v10, s[20:23], s17 offen
    buffer_load_dword v126, v12, s[20:23], s17 offen
    buffer_load_dword v127, v13, s[20:23], s17 offen
    s_waitcnt vmcnt(58)
    v_perm_b32 v5, v69, v68, s44
    v_perm_b32 v6, v69, v68, s45
    s_waitcnt vmcnt(56)
    v_perm_b32 v169, v71, v70, v11
    v_accvgpr_write_b32 a81, v5
    v_accvgpr_write_b32 a85, v6
    s_add_u32 s17, s49, 516096
    buffer_load_dword v16, v9, s[20:23], s17 offen
    buffer_load_dword v17, v10, s[20:23], s17 offen
    buffer_load_dword v18, v12, s[20:23], s17 offen
    buffer_load_dword v19, v13, s[20:23], s17 offen
    s_waitcnt vmcnt(58)
    v_perm_b32 v5, v73, v72, s44
    v_perm_b32 v6, v73, v72, s45
    s_waitcnt vmcnt(56)
    v_perm_b32 v170, v75, v74, v11
    v_accvgpr_write_b32 a82, v5
    v_accvgpr_write_b32 a86, v6
    s_add_u32 s17, s49, 517248
    buffer_load_dword v20, v9, s[20:23], s17 offen
    buffer_load_dword v21, v10, s[20:23], s17 offen
    buffer_load_dword v22, v12, s[20:23], s17 offen
    buffer_load_dword v23, v13, s[20:23], s17 offen
    s_waitcnt vmcnt(58)
    v_perm_b32 v5, v77, v76, s44
    v_perm_b32 v6, v77, v76, s45
    s_waitcnt vmcnt(56)
    v_perm_b32 v171, v79, v78, v11
    v_accvgpr_write_b32 a83, v5
    v_accvgpr_write_b32 a87, v6
    s_add_u32 s17, s49, 518400
    buffer_load_dword v24, v9, s[20:23], s17 offen
    buffer_load_dword v25, v10, s[20:23], s17 offen
    buffer_load_dword v26, v12, s[20:23], s17 offen
    buffer_load_dword v27, v13, s[20:23], s17 offen
    s_waitcnt vmcnt(58)
    v_perm_b32 v5, v81, v80, s44
    v_perm_b32 v6, v81, v80, s45
    s_waitcnt vmcnt(56)
    v_perm_b32 v172, v83, v82, v11
    v_accvgpr_write_b32 a88, v5
    v_accvgpr_write_b32 a92, v6
    s_add_u32 s17, s49, 519552
    buffer_load_dword v28, v9, s[20:23], s17 offen
    buffer_load_dword v29, v10, s[20:23], s17 offen
    buffer_load_dword v30, v12, s[20:23], s17 offen
    buffer_load_dword v31, v13, s[20:23], s17 offen
    s_waitcnt vmcnt(58)
    v_perm_b32 v5, v85, v84, s44
    v_perm_b32 v6, v85, v84, s45
    s_waitcnt vmcnt(56)
    v_perm_b32 v173, v87, v86, v11
    v_accvgpr_write_b32 a89, v5
    v_accvgpr_write_b32 a93, v6
    s_add_u32 s17, s49, 552960
    buffer_load_dword v32, v9, s[20:23], s17 offen
    buffer_load_dword v33, v10, s[20:23], s17 offen
    buffer_load_dword v34, v12, s[20:23], s17 offen
    buffer_load_dword v35, v13, s[20:23], s17 offen
    s_waitcnt vmcnt(58)
    v_perm_b32 v5, v89, v88, s44
    v_perm_b32 v6, v89, v88, s45
    s_waitcnt vmcnt(56)
    v_perm_b32 v174, v91, v90, v11
    v_accvgpr_write_b32 a90, v5
    v_accvgpr_write_b32 a94, v6
    s_add_u32 s17, s49, 554112
    buffer_load_dword v36, v9, s[20:23], s17 offen
    buffer_load_dword v37, v10, s[20:23], s17 offen
    buffer_load_dword v38, v12, s[20:23], s17 offen
    buffer_load_dword v39, v13, s[20:23], s17 offen
    s_waitcnt vmcnt(58)
    v_perm_b32 v5, v93, v92, s44
    v_perm_b32 v6, v93, v92, s45
    s_waitcnt vmcnt(56)
    v_perm_b32 v175, v95, v94, v11
    v_accvgpr_write_b32 a91, v5
    v_accvgpr_write_b32 a95, v6
    s_add_u32 s17, s49, 555264
    buffer_load_dword v40, v9, s[20:23], s17 offen
    buffer_load_dword v41, v10, s[20:23], s17 offen
    buffer_load_dword v42, v12, s[20:23], s17 offen
    buffer_load_dword v43, v13, s[20:23], s17 offen
    s_waitcnt vmcnt(58)
    v_perm_b32 v5, v97, v96, s44
    v_perm_b32 v6, v97, v96, s45
    s_waitcnt vmcnt(56)
    v_perm_b32 v176, v99, v98, v11
    v_accvgpr_write_b32 a96, v5
    v_accvgpr_write_b32 a100, v6
    s_add_u32 s17, s49, 556416
    buffer_load_dword v44, v9, s[20:23], s17 offen
    buffer_load_dword v45, v10, s[20:23], s17 offen
    buffer_load_dword v46, v12, s[20:23], s17 offen
    buffer_load_dword v47, v13, s[20:23], s17 offen
    s_waitcnt vmcnt(58)
    v_perm_b32 v5, v101, v100, s44
    v_perm_b32 v6, v101, v100, s45
    s_waitcnt vmcnt(56)
    v_perm_b32 v177, v103, v102, v11
    v_accvgpr_write_b32 a97, v5
    v_accvgpr_write_b32 a101, v6
    s_add_u32 s17, s49, 589824
    buffer_load_dword v48, v9, s[20:23], s17 offen
    buffer_load_dword v49, v10, s[20:23], s17 offen
    buffer_load_dword v50, v12, s[20:23], s17 offen
    buffer_load_dword v51, v13, s[20:23], s17 offen
    s_waitcnt vmcnt(58)
    v_perm_b32 v5, v105, v104, s44
    v_perm_b32 v6, v105, v104, s45
    s_waitcnt vmcnt(56)
    v_perm_b32 v178, v107, v106, v11
    v_accvgpr_write_b32 a98, v5
    v_accvgpr_write_b32 a102, v6
    s_add_u32 s17, s49, 590976
    buffer_load_dword v52, v9, s[20:23], s17 offen
    buffer_load_dword v53, v10, s[20:23], s17 offen
    buffer_load_dword v54, v12, s[20:23], s17 offen
    buffer_load_dword v55, v13, s[20:23], s17 offen
    s_waitcnt vmcnt(58)
    v_perm_b32 v5, v109, v108, s44
    v_perm_b32 v6, v109, v108, s45
    s_waitcnt vmcnt(56)
    v_perm_b32 v179, v111, v110, v11
    v_accvgpr_write_b32 a99, v5
    v_accvgpr_write_b32 a103, v6
    s_add_u32 s17, s49, 592128
    buffer_load_dword v56, v9, s[20:23], s17 offen
    buffer_load_dword v57, v10, s[20:23], s17 offen
    buffer_load_dword v58, v12, s[20:23], s17 offen
    buffer_load_dword v59, v13, s[20:23], s17 offen
    s_waitcnt vmcnt(58)
    v_perm_b32 v5, v113, v112, s44
    v_perm_b32 v6, v113, v112, s45
    s_waitcnt vmcnt(56)
    v_perm_b32 v180, v115, v114, v11
    v_accvgpr_write_b32 a104, v5
    v_accvgpr_write_b32 a108, v6
    s_add_u32 s17, s49, 593280
    buffer_load_dword v60, v9, s[20:23], s17 offen
    buffer_load_dword v61, v10, s[20:23], s17 offen
    buffer_load_dword v62, v12, s[20:23], s17 offen
    buffer_load_dword v63, v13, s[20:23], s17 offen
    s_waitcnt vmcnt(58)
    v_perm_b32 v5, v117, v116, s44
    v_perm_b32 v6, v117, v116, s45
    s_waitcnt vmcnt(56)
    v_perm_b32 v181, v119, v118, v11
    v_accvgpr_write_b32 a105, v5
    v_accvgpr_write_b32 a109, v6
    s_add_u32 s17, s49, 626688
    buffer_load_dword v64, v9, s[20:23], s17 offen
    buffer_load_dword v65, v10, s[20:23], s17 offen
    buffer_load_dword v66, v12, s[20:23], s17 offen
    buffer_load_dword v67, v13, s[20:23], s17 offen
    s_waitcnt vmcnt(58)
    v_perm_b32 v5, v121, v120, s44
    v_perm_b32 v6, v121, v120, s45
    s_waitcnt vmcnt(56)
    v_perm_b32 v182, v123, v122, v11
    v_accvgpr_write_b32 a106, v5
    v_accvgpr_write_b32 a110, v6
    s_add_u32 s17, s49, 627840
    buffer_load_dword v68, v9, s[20:23], s17 offen
    buffer_load_dword v69, v10, s[20:23], s17 offen
    buffer_load_dword v70, v12, s[20:23], s17 offen
    buffer_load_dword v71, v13, s[20:23], s17 offen
    s_waitcnt vmcnt(58)
    v_perm_b32 v5, v125, v124, s44
    v_perm_b32 v6, v125, v124, s45
    s_waitcnt vmcnt(56)
    v_perm_b32 v183, v127, v126, v11
    v_accvgpr_write_b32 a107, v5
    v_accvgpr_write_b32 a111, v6
    s_add_u32 s17, s49, 628992
    buffer_load_dword v72, v9, s[20:23], s17 offen
    buffer_load_dword v73, v10, s[20:23], s17 offen
    buffer_load_dword v74, v12, s[20:23], s17 offen
    buffer_load_dword v75, v13, s[20:23], s17 offen
    s_waitcnt vmcnt(58)
    v_perm_b32 v5, v17, v16, s44
    v_perm_b32 v6, v17, v16, s45
    s_waitcnt vmcnt(56)
    v_perm_b32 v184, v19, v18, v11
    v_accvgpr_write_b32 a112, v5
    v_accvgpr_write_b32 a116, v6
    s_add_u32 s17, s49, 630144
    buffer_load_dword v76, v9, s[20:23], s17 offen
    buffer_load_dword v77, v10, s[20:23], s17 offen
    buffer_load_dword v78, v12, s[20:23], s17 offen
    buffer_load_dword v79, v13, s[20:23], s17 offen
    s_waitcnt vmcnt(58)
    v_perm_b32 v5, v21, v20, s44
    v_perm_b32 v6, v21, v20, s45
    s_waitcnt vmcnt(56)
    v_perm_b32 v185, v23, v22, v11
    v_accvgpr_write_b32 a113, v5
    v_accvgpr_write_b32 a117, v6
    s_add_u32 s17, s49, 663552
    buffer_load_dword v80, v9, s[20:23], s17 offen
    buffer_load_dword v81, v10, s[20:23], s17 offen
    buffer_load_dword v82, v12, s[20:23], s17 offen
    buffer_load_dword v83, v13, s[20:23], s17 offen
    s_waitcnt vmcnt(58)
    v_perm_b32 v5, v25, v24, s44
    v_perm_b32 v6, v25, v24, s45
    s_waitcnt vmcnt(56)
    v_perm_b32 v186, v27, v26, v11
    v_accvgpr_write_b32 a114, v5
    v_accvgpr_write_b32 a118, v6
    s_add_u32 s17, s49, 664704
    buffer_load_dword v84, v9, s[20:23], s17 offen
    buffer_load_dword v85, v10, s[20:23], s17 offen
    buffer_load_dword v86, v12, s[20:23], s17 offen
    buffer_load_dword v87, v13, s[20:23], s17 offen
    s_waitcnt vmcnt(58)
    v_perm_b32 v5, v29, v28, s44
    v_perm_b32 v6, v29, v28, s45
    s_waitcnt vmcnt(56)
    v_perm_b32 v187, v31, v30, v11
    v_accvgpr_write_b32 a115, v5
    v_accvgpr_write_b32 a119, v6
    s_add_u32 s17, s49, 665856
    buffer_load_dword v88, v9, s[20:23], s17 offen
    buffer_load_dword v89, v10, s[20:23], s17 offen
    buffer_load_dword v90, v12, s[20:23], s17 offen
    buffer_load_dword v91, v13, s[20:23], s17 offen
    s_waitcnt vmcnt(58)
    v_perm_b32 v5, v33, v32, s44
    v_perm_b32 v6, v33, v32, s45
    s_waitcnt vmcnt(56)
    v_perm_b32 v188, v35, v34, v11
    v_accvgpr_write_b32 a120, v5
    v_accvgpr_write_b32 a124, v6
    s_add_u32 s17, s49, 667008
    buffer_load_dword v92, v9, s[20:23], s17 offen
    buffer_load_dword v93, v10, s[20:23], s17 offen
    buffer_load_dword v94, v12, s[20:23], s17 offen
    buffer_load_dword v95, v13, s[20:23], s17 offen
    s_waitcnt vmcnt(58)
    v_perm_b32 v5, v37, v36, s44
    v_perm_b32 v6, v37, v36, s45
    s_waitcnt vmcnt(56)
    v_perm_b32 v189, v39, v38, v11
    v_accvgpr_write_b32 a121, v5
    v_accvgpr_write_b32 a125, v6
    s_add_u32 s17, s49, 700416
    buffer_load_dword v96, v9, s[20:23], s17 offen
    buffer_load_dword v97, v10, s[20:23], s17 offen
    buffer_load_dword v98, v12, s[20:23], s17 offen
    buffer_load_dword v99, v13, s[20:23], s17 offen
    s_waitcnt vmcnt(58)
    v_perm_b32 v5, v41, v40, s44
    v_perm_b32 v6, v41, v40, s45
    s_waitcnt vmcnt(56)
    v_perm_b32 v190, v43, v42, v11
    v_accvgpr_write_b32 a122, v5
    v_accvgpr_write_b32 a126, v6
    s_add_u32 s17, s49, 701568
    buffer_load_dword v100, v9, s[20:23], s17 offen
    buffer_load_dword v101, v10, s[20:23], s17 offen
    buffer_load_dword v102, v12, s[20:23], s17 offen
    buffer_load_dword v103, v13, s[20:23], s17 offen
    s_waitcnt vmcnt(58)
    v_perm_b32 v5, v45, v44, s44
    v_perm_b32 v6, v45, v44, s45
    s_waitcnt vmcnt(56)
    v_perm_b32 v191, v47, v46, v11
    v_accvgpr_write_b32 a123, v5
    v_accvgpr_write_b32 a127, v6
    s_add_u32 s17, s49, 702720
    buffer_load_dword v104, v9, s[20:23], s17 offen
    buffer_load_dword v105, v10, s[20:23], s17 offen
    buffer_load_dword v106, v12, s[20:23], s17 offen
    buffer_load_dword v107, v13, s[20:23], s17 offen
    s_waitcnt vmcnt(58)
    v_perm_b32 v5, v49, v48, s44
    v_perm_b32 v6, v49, v48, s45
    s_waitcnt vmcnt(56)
    v_perm_b32 v192, v51, v50, v11
    v_accvgpr_write_b32 a128, v5
    v_accvgpr_write_b32 a132, v6
    s_add_u32 s17, s49, 703872
    buffer_load_dword v108, v9, s[20:23], s17 offen
    buffer_load_dword v109, v10, s[20:23], s17 offen
    buffer_load_dword v110, v12, s[20:23], s17 offen
    buffer_load_dword v111, v13, s[20:23], s17 offen
    s_waitcnt vmcnt(58)
    v_perm_b32 v5, v53, v52, s44
    v_perm_b32 v6, v53, v52, s45
    s_waitcnt vmcnt(56)
    v_perm_b32 v193, v55, v54, v11
    v_accvgpr_write_b32 a129, v5
    v_accvgpr_write_b32 a133, v6
    s_add_u32 s17, s49, 737280
    buffer_load_dword v112, v9, s[20:23], s17 offen
    buffer_load_dword v113, v10, s[20:23], s17 offen
    buffer_load_dword v114, v12, s[20:23], s17 offen
    buffer_load_dword v115, v13, s[20:23], s17 offen
    s_waitcnt vmcnt(58)
    v_perm_b32 v5, v57, v56, s44
    v_perm_b32 v6, v57, v56, s45
    s_waitcnt vmcnt(56)
    v_perm_b32 v194, v59, v58, v11
    v_accvgpr_write_b32 a130, v5
    v_accvgpr_write_b32 a134, v6
    s_add_u32 s17, s49, 738432
    buffer_load_dword v116, v9, s[20:23], s17 offen
    buffer_load_dword v117, v10, s[20:23], s17 offen
    buffer_load_dword v118, v12, s[20:23], s17 offen
    buffer_load_dword v119, v13, s[20:23], s17 offen
    s_waitcnt vmcnt(58)
    v_perm_b32 v5, v61, v60, s44
    v_perm_b32 v6, v61, v60, s45
    s_waitcnt vmcnt(56)
    v_perm_b32 v195, v63, v62, v11
    v_accvgpr_write_b32 a131, v5
    v_accvgpr_write_b32 a135, v6
    s_add_u32 s17, s49, 739584
    buffer_load_dword v120, v9, s[20:23], s17 offen
    buffer_load_dword v121, v10, s[20:23], s17 offen
    buffer_load_dword v122, v12, s[20:23], s17 offen
    buffer_load_dword v123, v13, s[20:23], s17 offen
    s_waitcnt vmcnt(58)
    v_perm_b32 v5, v65, v64, s44
    v_perm_b32 v6, v65, v64, s45
    s_waitcnt vmcnt(56)
    v_perm_b32 v196, v67, v66, v11
    v_accvgpr_write_b32 a136, v5
    v_accvgpr_write_b32 a140, v6
    s_add_u32 s17, s49, 740736
    buffer_load_dword v124, v9, s[20:23], s17 offen
    buffer_load_dword v125, v10, s[20:23], s17 offen
    buffer_load_dword v126, v12, s[20:23], s17 offen
    buffer_load_dword v127, v13, s[20:23], s17 offen
    s_waitcnt vmcnt(58)
    v_perm_b32 v5, v69, v68, s44
    v_perm_b32 v6, v69, v68, s45
    s_waitcnt vmcnt(56)
    v_perm_b32 v197, v71, v70, v11
    v_accvgpr_write_b32 a137, v5
    v_accvgpr_write_b32 a141, v6
    s_add_u32 s17, s49, 774144
    buffer_load_dword v16, v9, s[20:23], s17 offen
    buffer_load_dword v17, v10, s[20:23], s17 offen
    buffer_load_dword v18, v12, s[20:23], s17 offen
    buffer_load_dword v19, v13, s[20:23], s17 offen
    s_waitcnt vmcnt(58)
    v_perm_b32 v5, v73, v72, s44
    v_perm_b32 v6, v73, v72, s45
    s_waitcnt vmcnt(56)
    v_perm_b32 v198, v75, v74, v11
    v_accvgpr_write_b32 a138, v5
    v_accvgpr_write_b32 a142, v6
    s_add_u32 s17, s49, 775296
    buffer_load_dword v20, v9, s[20:23], s17 offen
    buffer_load_dword v21, v10, s[20:23], s17 offen
    buffer_load_dword v22, v12, s[20:23], s17 offen
    buffer_load_dword v23, v13, s[20:23], s17 offen
    s_waitcnt vmcnt(58)
    v_perm_b32 v5, v77, v76, s44
    v_perm_b32 v6, v77, v76, s45
    s_waitcnt vmcnt(56)
    v_perm_b32 v199, v79, v78, v11
    v_accvgpr_write_b32 a139, v5
    v_accvgpr_write_b32 a143, v6
    s_add_u32 s17, s49, 776448
    buffer_load_dword v24, v9, s[20:23], s17 offen
    buffer_load_dword v25, v10, s[20:23], s17 offen
    buffer_load_dword v26, v12, s[20:23], s17 offen
    buffer_load_dword v27, v13, s[20:23], s17 offen
    s_waitcnt vmcnt(58)
    v_perm_b32 v5, v81, v80, s44
    v_perm_b32 v6, v81, v80, s45
    s_waitcnt vmcnt(56)
    v_perm_b32 v200, v83, v82, v11
    v_accvgpr_write_b32 a144, v5
    v_accvgpr_write_b32 a148, v6
    s_add_u32 s17, s49, 777600
    buffer_load_dword v28, v9, s[20:23], s17 offen
    buffer_load_dword v29, v10, s[20:23], s17 offen
    buffer_load_dword v30, v12, s[20:23], s17 offen
    buffer_load_dword v31, v13, s[20:23], s17 offen
    s_waitcnt vmcnt(58)
    v_perm_b32 v5, v85, v84, s44
    v_perm_b32 v6, v85, v84, s45
    s_waitcnt vmcnt(56)
    v_perm_b32 v201, v87, v86, v11
    v_accvgpr_write_b32 a145, v5
    v_accvgpr_write_b32 a149, v6
    s_add_u32 s17, s49, 811008
    buffer_load_dword v32, v9, s[20:23], s17 offen
    buffer_load_dword v33, v10, s[20:23], s17 offen
    buffer_load_dword v34, v12, s[20:23], s17 offen
    buffer_load_dword v35, v13, s[20:23], s17 offen
    s_waitcnt vmcnt(58)
    v_perm_b32 v5, v89, v88, s44
    v_perm_b32 v6, v89, v88, s45
    s_waitcnt vmcnt(56)
    v_perm_b32 v202, v91, v90, v11
    v_accvgpr_write_b32 a146, v5
    v_accvgpr_write_b32 a150, v6
    s_add_u32 s17, s49, 812160
    buffer_load_dword v36, v9, s[20:23], s17 offen
    buffer_load_dword v37, v10, s[20:23], s17 offen
    buffer_load_dword v38, v12, s[20:23], s17 offen
    buffer_load_dword v39, v13, s[20:23], s17 offen
    s_waitcnt vmcnt(58)
    v_perm_b32 v5, v93, v92, s44
    v_perm_b32 v6, v93, v92, s45
    s_waitcnt vmcnt(56)
    v_perm_b32 v203, v95, v94, v11
    v_accvgpr_write_b32 a147, v5
    v_accvgpr_write_b32 a151, v6
    s_add_u32 s17, s49, 813312
    buffer_load_dword v40, v9, s[20:23], s17 offen
    buffer_load_dword v41, v10, s[20:23], s17 offen
    buffer_load_dword v42, v12, s[20:23], s17 offen
    buffer_load_dword v43, v13, s[20:23], s17 offen
    s_waitcnt vmcnt(58)
    v_perm_b32 v5, v97, v96, s44
    v_perm_b32 v6, v97, v96, s45
    s_waitcnt vmcnt(56)
    v_perm_b32 v204, v99, v98, v11
    v_accvgpr_write_b32 a152, v5
    v_accvgpr_write_b32 a156, v6
    s_add_u32 s17, s49, 814464
    buffer_load_dword v44, v9, s[20:23], s17 offen
    buffer_load_dword v45, v10, s[20:23], s17 offen
    buffer_load_dword v46, v12, s[20:23], s17 offen
    buffer_load_dword v47, v13, s[20:23], s17 offen
    s_waitcnt vmcnt(58)
    v_perm_b32 v5, v101, v100, s44
    v_perm_b32 v6, v101, v100, s45
    s_waitcnt vmcnt(56)
    v_perm_b32 v205, v103, v102, v11
    v_accvgpr_write_b32 a153, v5
    v_accvgpr_write_b32 a157, v6
    s_add_u32 s17, s49, 847872
    buffer_load_dword v48, v9, s[20:23], s17 offen
    buffer_load_dword v49, v10, s[20:23], s17 offen
    buffer_load_dword v50, v12, s[20:23], s17 offen
    buffer_load_dword v51, v13, s[20:23], s17 offen
    s_waitcnt vmcnt(58)
    v_perm_b32 v5, v105, v104, s44
    v_perm_b32 v6, v105, v104, s45
    s_waitcnt vmcnt(56)
    v_perm_b32 v206, v107, v106, v11
    v_accvgpr_write_b32 a154, v5
    v_accvgpr_write_b32 a158, v6
    s_add_u32 s17, s49, 849024
    buffer_load_dword v52, v9, s[20:23], s17 offen
    buffer_load_dword v53, v10, s[20:23], s17 offen
    buffer_load_dword v54, v12, s[20:23], s17 offen
    buffer_load_dword v55, v13, s[20:23], s17 offen
    s_waitcnt vmcnt(58)
    v_perm_b32 v5, v109, v108, s44
    v_perm_b32 v6, v109, v108, s45
    s_waitcnt vmcnt(56)
    v_perm_b32 v207, v111, v110, v11
    v_accvgpr_write_b32 a155, v5
    v_accvgpr_write_b32 a159, v6
    s_add_u32 s17, s49, 850176
    buffer_load_dword v56, v9, s[20:23], s17 offen
    buffer_load_dword v57, v10, s[20:23], s17 offen
    buffer_load_dword v58, v12, s[20:23], s17 offen
    buffer_load_dword v59, v13, s[20:23], s17 offen
    s_waitcnt vmcnt(58)
    v_perm_b32 v5, v113, v112, s44
    v_perm_b32 v6, v113, v112, s45
    s_waitcnt vmcnt(56)
    v_perm_b32 v208, v115, v114, v11
    v_accvgpr_write_b32 a160, v5
    v_accvgpr_write_b32 a164, v6
    s_add_u32 s17, s49, 851328
    buffer_load_dword v60, v9, s[20:23], s17 offen
    buffer_load_dword v61, v10, s[20:23], s17 offen
    buffer_load_dword v62, v12, s[20:23], s17 offen
    buffer_load_dword v63, v13, s[20:23], s17 offen
    s_waitcnt vmcnt(58)
    v_perm_b32 v5, v117, v116, s44
    v_perm_b32 v6, v117, v116, s45
    s_waitcnt vmcnt(56)
    v_perm_b32 v209, v119, v118, v11
    v_accvgpr_write_b32 a161, v5
    v_accvgpr_write_b32 a165, v6
    s_add_u32 s17, s49, 884736
    buffer_load_dword v64, v9, s[20:23], s17 offen
    buffer_load_dword v65, v10, s[20:23], s17 offen
    buffer_load_dword v66, v12, s[20:23], s17 offen
    buffer_load_dword v67, v13, s[20:23], s17 offen
    s_waitcnt vmcnt(58)
    v_perm_b32 v5, v121, v120, s44
    v_perm_b32 v6, v121, v120, s45
    s_waitcnt vmcnt(56)
    v_perm_b32 v210, v123, v122, v11
    v_accvgpr_write_b32 a162, v5
    v_accvgpr_write_b32 a166, v6
    s_add_u32 s17, s49, 885888
    buffer_load_dword v68, v9, s[20:23], s17 offen
    buffer_load_dword v69, v10, s[20:23], s17 offen
    buffer_load_dword v70, v12, s[20:23], s17 offen
    buffer_load_dword v71, v13, s[20:23], s17 offen
    s_waitcnt vmcnt(58)
    v_perm_b32 v5, v125, v124, s44
    v_perm_b32 v6, v125, v124, s45
    s_waitcnt vmcnt(56)
    v_perm_b32 v211, v127, v126, v11
    v_accvgpr_write_b32 a163, v5
    v_accvgpr_write_b32 a167, v6
    s_add_u32 s17, s49, 887040
    buffer_load_dword v72, v9, s[20:23], s17 offen
    buffer_load_dword v73, v10, s[20:23], s17 offen
    buffer_load_dword v74, v12, s[20:23], s17 offen
    buffer_load_dword v75, v13, s[20:23], s17 offen
    s_waitcnt vmcnt(58)
    v_perm_b32 v5, v17, v16, s44
    v_perm_b32 v6, v17, v16, s45
    s_waitcnt vmcnt(56)
    v_perm_b32 v212, v19, v18, v11
    v_accvgpr_write_b32 a168, v5
    v_accvgpr_write_b32 a172, v6
    s_add_u32 s17, s49, 888192
    buffer_load_dword v76, v9, s[20:23], s17 offen
    buffer_load_dword v77, v10, s[20:23], s17 offen
    buffer_load_dword v78, v12, s[20:23], s17 offen
    buffer_load_dword v79, v13, s[20:23], s17 offen
    s_waitcnt vmcnt(58)
    v_perm_b32 v5, v21, v20, s44
    v_perm_b32 v6, v21, v20, s45
    s_waitcnt vmcnt(56)
    v_perm_b32 v213, v23, v22, v11
    v_accvgpr_write_b32 a169, v5
    v_accvgpr_write_b32 a173, v6
    s_add_u32 s17, s49, 921600
    buffer_load_dword v80, v9, s[20:23], s17 offen
    buffer_load_dword v81, v10, s[20:23], s17 offen
    buffer_load_dword v82, v12, s[20:23], s17 offen
    buffer_load_dword v83, v13, s[20:23], s17 offen
    s_waitcnt vmcnt(58)
    v_perm_b32 v5, v25, v24, s44
    v_perm_b32 v6, v25, v24, s45
    s_waitcnt vmcnt(56)
    v_perm_b32 v214, v27, v26, v11
    v_accvgpr_write_b32 a170, v5
    v_accvgpr_write_b32 a174, v6
    s_add_u32 s17, s49, 922752
    buffer_load_dword v84, v9, s[20:23], s17 offen
    buffer_load_dword v85, v10, s[20:23], s17 offen
    buffer_load_dword v86, v12, s[20:23], s17 offen
    buffer_load_dword v87, v13, s[20:23], s17 offen
    s_waitcnt vmcnt(58)
    v_perm_b32 v5, v29, v28, s44
    v_perm_b32 v6, v29, v28, s45
    s_waitcnt vmcnt(56)
    v_perm_b32 v215, v31, v30, v11
    v_accvgpr_write_b32 a171, v5
    v_accvgpr_write_b32 a175, v6
    s_add_u32 s17, s49, 923904
    buffer_load_dword v88, v9, s[20:23], s17 offen
    buffer_load_dword v89, v10, s[20:23], s17 offen
    buffer_load_dword v90, v12, s[20:23], s17 offen
    buffer_load_dword v91, v13, s[20:23], s17 offen
    s_waitcnt vmcnt(58)
    v_perm_b32 v5, v33, v32, s44
    v_perm_b32 v6, v33, v32, s45
    s_waitcnt vmcnt(56)
    v_perm_b32 v216, v35, v34, v11
    v_accvgpr_write_b32 a176, v5
    v_accvgpr_write_b32 a180, v6
    s_add_u32 s17, s49, 925056
    buffer_load_dword v92, v9, s[20:23], s17 offen
    buffer_load_dword v93, v10, s[20:23], s17 offen
    buffer_load_dword v94, v12, s[20:23], s17 offen
    buffer_load_dword v95, v13, s[20:23], s17 offen
    s_waitcnt vmcnt(58)
    v_perm_b32 v5, v37, v36, s44
    v_perm_b32 v6, v37, v36, s45
    s_waitcnt vmcnt(56)
    v_perm_b32 v217, v39, v38, v11
    v_accvgpr_write_b32 a177, v5
    v_accvgpr_write_b32 a181, v6
    s_add_u32 s17, s49, 958464
    buffer_load_dword v96, v9, s[20:23], s17 offen
    buffer_load_dword v97, v10, s[20:23], s17 offen
    buffer_load_dword v98, v12, s[20:23], s17 offen
    buffer_load_dword v99, v13, s[20:23], s17 offen
    s_waitcnt vmcnt(58)
    v_perm_b32 v5, v41, v40, s44
    v_perm_b32 v6, v41, v40, s45
    s_waitcnt vmcnt(56)
    v_perm_b32 v218, v43, v42, v11
    v_accvgpr_write_b32 a178, v5
    v_accvgpr_write_b32 a182, v6
    s_add_u32 s17, s49, 959616
    buffer_load_dword v100, v9, s[20:23], s17 offen
    buffer_load_dword v101, v10, s[20:23], s17 offen
    buffer_load_dword v102, v12, s[20:23], s17 offen
    buffer_load_dword v103, v13, s[20:23], s17 offen
    s_waitcnt vmcnt(58)
    v_perm_b32 v5, v45, v44, s44
    v_perm_b32 v6, v45, v44, s45
    s_waitcnt vmcnt(56)
    v_perm_b32 v219, v47, v46, v11
    v_accvgpr_write_b32 a179, v5
    v_accvgpr_write_b32 a183, v6
    s_add_u32 s17, s49, 960768
    buffer_load_dword v104, v9, s[20:23], s17 offen
    buffer_load_dword v105, v10, s[20:23], s17 offen
    buffer_load_dword v106, v12, s[20:23], s17 offen
    buffer_load_dword v107, v13, s[20:23], s17 offen
    s_waitcnt vmcnt(58)
    v_perm_b32 v5, v49, v48, s44
    v_perm_b32 v6, v49, v48, s45
    s_waitcnt vmcnt(56)
    v_perm_b32 v220, v51, v50, v11
    v_accvgpr_write_b32 a184, v5
    v_accvgpr_write_b32 a188, v6
    s_add_u32 s17, s49, 961920
    buffer_load_dword v108, v9, s[20:23], s17 offen
    buffer_load_dword v109, v10, s[20:23], s17 offen
    buffer_load_dword v110, v12, s[20:23], s17 offen
    buffer_load_dword v111, v13, s[20:23], s17 offen
    s_waitcnt vmcnt(58)
    v_perm_b32 v5, v53, v52, s44
    v_perm_b32 v6, v53, v52, s45
    s_waitcnt vmcnt(56)
    v_perm_b32 v221, v55, v54, v11
    v_accvgpr_write_b32 a185, v5
    v_accvgpr_write_b32 a189, v6
    s_add_u32 s17, s49, 995328
    buffer_load_dword v112, v9, s[20:23], s17 offen
    buffer_load_dword v113, v10, s[20:23], s17 offen
    buffer_load_dword v114, v12, s[20:23], s17 offen
    buffer_load_dword v115, v13, s[20:23], s17 offen
    s_waitcnt vmcnt(58)
    v_perm_b32 v5, v57, v56, s44
    v_perm_b32 v6, v57, v56, s45
    s_waitcnt vmcnt(56)
    v_perm_b32 v222, v59, v58, v11
    v_accvgpr_write_b32 a186, v5
    v_accvgpr_write_b32 a190, v6
    s_add_u32 s17, s49, 996480
    buffer_load_dword v116, v9, s[20:23], s17 offen
    buffer_load_dword v117, v10, s[20:23], s17 offen
    buffer_load_dword v118, v12, s[20:23], s17 offen
    buffer_load_dword v119, v13, s[20:23], s17 offen
    s_waitcnt vmcnt(58)
    v_perm_b32 v5, v61, v60, s44
    v_perm_b32 v6, v61, v60, s45
    s_waitcnt vmcnt(56)
    v_perm_b32 v223, v63, v62, v11
    v_accvgpr_write_b32 a187, v5
    v_accvgpr_write_b32 a191, v6
    s_add_u32 s17, s49, 997632
    buffer_load_dword v120, v9, s[20:23], s17 offen
    buffer_load_dword v121, v10, s[20:23], s17 offen
    buffer_load_dword v122, v12, s[20:23], s17 offen
    buffer_load_dword v123, v13, s[20:23], s17 offen
    s_waitcnt vmcnt(58)
    v_perm_b32 v5, v65, v64, s44
    v_perm_b32 v6, v65, v64, s45
    s_waitcnt vmcnt(56)
    v_perm_b32 v224, v67, v66, v11
    v_accvgpr_write_b32 a192, v5
    v_accvgpr_write_b32 a196, v6
    s_add_u32 s17, s49, 998784
    buffer_load_dword v124, v9, s[20:23], s17 offen
    buffer_load_dword v125, v10, s[20:23], s17 offen
    buffer_load_dword v126, v12, s[20:23], s17 offen
    buffer_load_dword v127, v13, s[20:23], s17 offen
    s_waitcnt vmcnt(58)
    v_perm_b32 v5, v69, v68, s44
    v_perm_b32 v6, v69, v68, s45
    s_waitcnt vmcnt(56)
    v_perm_b32 v225, v71, v70, v11
    v_accvgpr_write_b32 a193, v5
    v_accvgpr_write_b32 a197, v6
    s_add_u32 s17, s49, 1032192
    buffer_load_dword v16, v9, s[20:23], s17 offen
    buffer_load_dword v17, v10, s[20:23], s17 offen
    buffer_load_dword v18, v12, s[20:23], s17 offen
    buffer_load_dword v19, v13, s[20:23], s17 offen
    s_waitcnt vmcnt(58)
    v_perm_b32 v5, v73, v72, s44
    v_perm_b32 v6, v73, v72, s45
    s_waitcnt vmcnt(56)
    v_perm_b32 v226, v75, v74, v11
    v_accvgpr_write_b32 a194, v5
    v_accvgpr_write_b32 a198, v6
    s_add_u32 s17, s49, 1033344
    buffer_load_dword v20, v9, s[20:23], s17 offen
    buffer_load_dword v21, v10, s[20:23], s17 offen
    buffer_load_dword v22, v12, s[20:23], s17 offen
    buffer_load_dword v23, v13, s[20:23], s17 offen
    s_waitcnt vmcnt(58)
    v_perm_b32 v5, v77, v76, s44
    v_perm_b32 v6, v77, v76, s45
    s_waitcnt vmcnt(56)
    v_perm_b32 v227, v79, v78, v11
    v_accvgpr_write_b32 a195, v5
    v_accvgpr_write_b32 a199, v6
    s_add_u32 s17, s49, 1034496
    buffer_load_dword v24, v9, s[20:23], s17 offen
    buffer_load_dword v25, v10, s[20:23], s17 offen
    buffer_load_dword v26, v12, s[20:23], s17 offen
    buffer_load_dword v27, v13, s[20:23], s17 offen
    s_waitcnt vmcnt(58)
    v_perm_b32 v5, v81, v80, s44
    v_perm_b32 v6, v81, v80, s45
    s_waitcnt vmcnt(56)
    v_perm_b32 v228, v83, v82, v11
    v_accvgpr_write_b32 a200, v5
    v_accvgpr_write_b32 a204, v6
    s_add_u32 s17, s49, 1035648
    buffer_load_dword v28, v9, s[20:23], s17 offen
    buffer_load_dword v29, v10, s[20:23], s17 offen
    buffer_load_dword v30, v12, s[20:23], s17 offen
    buffer_load_dword v31, v13, s[20:23], s17 offen
    s_waitcnt vmcnt(58)
    v_perm_b32 v5, v85, v84, s44
    v_perm_b32 v6, v85, v84, s45
    s_waitcnt vmcnt(56)
    v_perm_b32 v229, v87, v86, v11
    v_accvgpr_write_b32 a201, v5
    v_accvgpr_write_b32 a205, v6
    s_add_u32 s17, s49, 1069056
    buffer_load_dword v32, v9, s[20:23], s17 offen
    buffer_load_dword v33, v10, s[20:23], s17 offen
    buffer_load_dword v34, v12, s[20:23], s17 offen
    buffer_load_dword v35, v13, s[20:23], s17 offen
    s_waitcnt vmcnt(58)
    v_perm_b32 v5, v89, v88, s44
    v_perm_b32 v6, v89, v88, s45
    s_waitcnt vmcnt(56)
    v_perm_b32 v230, v91, v90, v11
    v_accvgpr_write_b32 a202, v5
    v_accvgpr_write_b32 a206, v6
    s_add_u32 s17, s49, 1070208
    buffer_load_dword v36, v9, s[20:23], s17 offen
    buffer_load_dword v37, v10, s[20:23], s17 offen
    buffer_load_dword v38, v12, s[20:23], s17 offen
    buffer_load_dword v39, v13, s[20:23], s17 offen
    s_waitcnt vmcnt(58)
    v_perm_b32 v5, v93, v92, s44
    v_perm_b32 v6, v93, v92, s45
    s_waitcnt vmcnt(56)
    v_perm_b32 v231, v95, v94, v11
    v_accvgpr_write_b32 a203, v5
    v_accvgpr_write_b32 a207, v6
    s_add_u32 s17, s49, 1071360
    buffer_load_dword v40, v9, s[20:23], s17 offen
    buffer_load_dword v41, v10, s[20:23], s17 offen
    buffer_load_dword v42, v12, s[20:23], s17 offen
    buffer_load_dword v43, v13, s[20:23], s17 offen
    s_waitcnt vmcnt(58)
    v_perm_b32 v5, v97, v96, s44
    v_perm_b32 v6, v97, v96, s45
    s_waitcnt vmcnt(56)
    v_perm_b32 v232, v99, v98, v11
    v_accvgpr_write_b32 a208, v5
    v_accvgpr_write_b32 a212, v6
    s_add_u32 s17, s49, 1072512
    buffer_load_dword v44, v9, s[20:23], s17 offen
    buffer_load_dword v45, v10, s[20:23], s17 offen
    buffer_load_dword v46, v12, s[20:23], s17 offen
    buffer_load_dword v47, v13, s[20:23], s17 offen
    s_waitcnt vmcnt(58)
    v_perm_b32 v5, v101, v100, s44
    v_perm_b32 v6, v101, v100, s45
    s_waitcnt vmcnt(56)
    v_perm_b32 v233, v103, v102, v11
    v_accvgpr_write_b32 a209, v5
    v_accvgpr_write_b32 a213, v6
    s_add_u32 s17, s49, 1105920
    buffer_load_dword v48, v9, s[20:23], s17 offen
    buffer_load_dword v49, v10, s[20:23], s17 offen
    buffer_load_dword v50, v12, s[20:23], s17 offen
    buffer_load_dword v51, v13, s[20:23], s17 offen
    s_waitcnt vmcnt(58)
    v_perm_b32 v5, v105, v104, s44
    v_perm_b32 v6, v105, v104, s45
    s_waitcnt vmcnt(56)
    v_perm_b32 v234, v107, v106, v11
    v_accvgpr_write_b32 a210, v5
    v_accvgpr_write_b32 a214, v6
    s_add_u32 s17, s49, 1107072
    buffer_load_dword v52, v9, s[20:23], s17 offen
    buffer_load_dword v53, v10, s[20:23], s17 offen
    buffer_load_dword v54, v12, s[20:23], s17 offen
    buffer_load_dword v55, v13, s[20:23], s17 offen
    s_waitcnt vmcnt(58)
    v_perm_b32 v5, v109, v108, s44
    v_perm_b32 v6, v109, v108, s45
    s_waitcnt vmcnt(56)
    v_perm_b32 v235, v111, v110, v11
    v_accvgpr_write_b32 a211, v5
    v_accvgpr_write_b32 a215, v6
    s_add_u32 s17, s49, 1108224
    buffer_load_dword v56, v9, s[20:23], s17 offen
    buffer_load_dword v57, v10, s[20:23], s17 offen
    buffer_load_dword v58, v12, s[20:23], s17 offen
    buffer_load_dword v59, v13, s[20:23], s17 offen
    s_waitcnt vmcnt(58)
    v_perm_b32 v5, v113, v112, s44
    v_perm_b32 v6, v113, v112, s45
    s_waitcnt vmcnt(56)
    v_perm_b32 v236, v115, v114, v11
    v_accvgpr_write_b32 a216, v5
    v_accvgpr_write_b32 a220, v6
    s_add_u32 s17, s49, 1109376
    buffer_load_dword v60, v9, s[20:23], s17 offen
    buffer_load_dword v61, v10, s[20:23], s17 offen
    buffer_load_dword v62, v12, s[20:23], s17 offen
    buffer_load_dword v63, v13, s[20:23], s17 offen
    s_waitcnt vmcnt(58)
    v_perm_b32 v5, v117, v116, s44
    v_perm_b32 v6, v117, v116, s45
    s_waitcnt vmcnt(56)
    v_perm_b32 v237, v119, v118, v11
    v_accvgpr_write_b32 a217, v5
    v_accvgpr_write_b32 a221, v6
    s_add_u32 s17, s49, 1142784
    buffer_load_dword v64, v9, s[20:23], s17 offen
    buffer_load_dword v65, v10, s[20:23], s17 offen
    buffer_load_dword v66, v12, s[20:23], s17 offen
    buffer_load_dword v67, v13, s[20:23], s17 offen
    s_waitcnt vmcnt(58)
    v_perm_b32 v5, v121, v120, s44
    v_perm_b32 v6, v121, v120, s45
    s_waitcnt vmcnt(56)
    v_perm_b32 v238, v123, v122, v11
    v_accvgpr_write_b32 a218, v5
    v_accvgpr_write_b32 a222, v6
    s_add_u32 s17, s49, 1143936
    buffer_load_dword v68, v9, s[20:23], s17 offen
    buffer_load_dword v69, v10, s[20:23], s17 offen
    buffer_load_dword v70, v12, s[20:23], s17 offen
    buffer_load_dword v71, v13, s[20:23], s17 offen
    s_waitcnt vmcnt(58)
    v_perm_b32 v5, v125, v124, s44
    v_perm_b32 v6, v125, v124, s45
    s_waitcnt vmcnt(56)
    v_perm_b32 v239, v127, v126, v11
    v_accvgpr_write_b32 a219, v5
    v_accvgpr_write_b32 a223, v6
    s_add_u32 s17, s49, 1145088
    buffer_load_dword v72, v9, s[20:23], s17 offen
    buffer_load_dword v73, v10, s[20:23], s17 offen
    buffer_load_dword v74, v12, s[20:23], s17 offen
    buffer_load_dword v75, v13, s[20:23], s17 offen
    s_waitcnt vmcnt(58)
    v_perm_b32 v5, v17, v16, s44
    v_perm_b32 v6, v17, v16, s45
    s_waitcnt vmcnt(56)
    v_perm_b32 v240, v19, v18, v11
    v_accvgpr_write_b32 a224, v5
    v_accvgpr_write_b32 a228, v6
    s_add_u32 s17, s49, 1146240
    buffer_load_dword v76, v9, s[20:23], s17 offen
    buffer_load_dword v77, v10, s[20:23], s17 offen
    buffer_load_dword v78, v12, s[20:23], s17 offen
    buffer_load_dword v79, v13, s[20:23], s17 offen
    s_waitcnt vmcnt(58)
    v_perm_b32 v5, v21, v20, s44
    v_perm_b32 v6, v21, v20, s45
    s_waitcnt vmcnt(56)
    v_perm_b32 v241, v23, v22, v11
    v_accvgpr_write_b32 a225, v5
    v_accvgpr_write_b32 a229, v6
    s_waitcnt vmcnt(54)
    v_perm_b32 v5, v25, v24, s44
    v_perm_b32 v6, v25, v24, s45
    s_waitcnt vmcnt(52)
    v_perm_b32 v242, v27, v26, v11
    v_accvgpr_write_b32 a226, v5
    v_accvgpr_write_b32 a230, v6
    s_waitcnt vmcnt(50)
    v_perm_b32 v5, v29, v28, s44
    v_perm_b32 v6, v29, v28, s45
    s_waitcnt vmcnt(48)
    v_perm_b32 v243, v31, v30, v11
    v_accvgpr_write_b32 a227, v5
    v_accvgpr_write_b32 a231, v6
    s_waitcnt vmcnt(46)
    v_perm_b32 v5, v33, v32, s44
    v_perm_b32 v6, v33, v32, s45
    s_waitcnt vmcnt(44)
    v_perm_b32 v244, v35, v34, v11
    v_accvgpr_write_b32 a232, v5
    v_accvgpr_write_b32 a236, v6
    s_waitcnt vmcnt(42)
    v_perm_b32 v5, v37, v36, s44
    v_perm_b32 v6, v37, v36, s45
    s_waitcnt vmcnt(40)
    v_perm_b32 v245, v39, v38, v11
    v_accvgpr_write_b32 a233, v5
    v_accvgpr_write_b32 a237, v6
    s_waitcnt vmcnt(38)
    v_perm_b32 v5, v41, v40, s44
    v_perm_b32 v6, v41, v40, s45
    s_waitcnt vmcnt(36)
    v_perm_b32 v246, v43, v42, v11
    v_accvgpr_write_b32 a234, v5
    v_accvgpr_write_b32 a238, v6
    s_waitcnt vmcnt(34)
    v_perm_b32 v5, v45, v44, s44
    v_perm_b32 v6, v45, v44, s45
    s_waitcnt vmcnt(32)
    v_perm_b32 v247, v47, v46, v11
    v_accvgpr_write_b32 a235, v5
    v_accvgpr_write_b32 a239, v6
    s_waitcnt vmcnt(30)
    v_perm_b32 v5, v49, v48, s44
    v_perm_b32 v6, v49, v48, s45
    s_waitcnt vmcnt(28)
    v_perm_b32 v248, v51, v50, v11
    v_accvgpr_write_b32 a240, v5
    v_accvgpr_write_b32 a244, v6
    s_waitcnt vmcnt(26)
    v_perm_b32 v5, v53, v52, s44
    v_perm_b32 v6, v53, v52, s45
    s_waitcnt vmcnt(24)
    v_perm_b32 v249, v55, v54, v11
    v_accvgpr_write_b32 a241, v5
    v_accvgpr_write_b32 a245, v6
    s_waitcnt vmcnt(22)
    v_perm_b32 v5, v57, v56, s44
    v_perm_b32 v6, v57, v56, s45
    s_waitcnt vmcnt(20)
    v_perm_b32 v250, v59, v58, v11
    v_accvgpr_write_b32 a242, v5
    v_accvgpr_write_b32 a246, v6
    s_waitcnt vmcnt(18)
    v_perm_b32 v5, v61, v60, s44
    v_perm_b32 v6, v61, v60, s45
    s_waitcnt vmcnt(16)
    v_perm_b32 v251, v63, v62, v11
    v_accvgpr_write_b32 a243, v5
    v_accvgpr_write_b32 a247, v6
    s_waitcnt vmcnt(14)
    v_perm_b32 v5, v65, v64, s44
    v_perm_b32 v6, v65, v64, s45
    s_waitcnt vmcnt(12)
    v_perm_b32 v252, v67, v66, v11
    v_accvgpr_write_b32 a248, v5
    v_accvgpr_write_b32 a252, v6
    s_waitcnt vmcnt(10)
    v_perm_b32 v5, v69, v68, s44
    v_perm_b32 v6, v69, v68, s45
    s_waitcnt vmcnt(8)
    v_perm_b32 v253, v71, v70, v11
    v_accvgpr_write_b32 a249, v5
    v_accvgpr_write_b32 a253, v6
    s_waitcnt vmcnt(6)
    v_perm_b32 v5, v73, v72, s44
    v_perm_b32 v6, v73, v72, s45
    s_waitcnt vmcnt(4)
    v_perm_b32 v254, v75, v74, v11
    v_accvgpr_write_b32 a250, v5
    v_accvgpr_write_b32 a254, v6
    s_waitcnt vmcnt(2)
    v_perm_b32 v5, v77, v76, s44
    v_perm_b32 v6, v77, v76, s45
    s_waitcnt vmcnt(0)
    v_perm_b32 v255, v79, v78, v11
    v_accvgpr_write_b32 a251, v5
    v_accvgpr_write_b32 a255, v6
    s_and_b32 s51, s14, 1
    s_lshl_b32 s17, s51, 4
    v_add_u32 v5, s17, v7
    v_lshlrev_b32 v14, 4, v5
    v_mul_u32_u24 v13, 1152, v5
    s_mul_i32 s17, s50, 96
    v_add_u32 v13, s17, v13
    s_mul_i32 s17, s50, 3072
    v_add_u32 v12, s17, v14
    s_lshl_b32 s17, s50, 9
    v_add_u32 v14, s17, v14
    s_lshl_b32 s49, s50, 7
    s_lshl_b32 s17, s14, 2
    s_add_u32 s49, s49, s17
    s_add_u32 s49, s49, 1441792
    s_mul_i32 s17, s14, 6144
    v_add_u32 v48, s17, v0
    v_mov_b32 v49, 0x10000
    s_mul_i32 s17, s50, 43
    v_lshrrev_b32 v10, 4, v0
    v_add_u32 v10, s17, v10
    v_min_u32 v10, 511, v10
    v_lshlrev_b32 v10, 7, v10
    s_cmp_gt_u32 s14, 1
    s_cbranch_scc1 Ltw_z
    v_lshl_add_u32 v12, v8, 9, v12
    v_lshl_add_u32 v13, v8, 4, v13
    s_lshl_b32 s58, s14, 16
    s_add_u32 s58, s58, 144703488
    s_mov_b32 s43, 0
    s_mov_b32 s28, s8
    s_mov_b32 s29, s9
    s_mov_b32 s30, 0
    s_mov_b32 s31, 0x00020000
    s_mul_i32 s17, s51, 3072
    v_add_u32 v50, s17, v0
    ds_write2_b32 v49, v4, v4 offset0:0 offset1:1
    s_waitcnt lgkmcnt(0)
    s_cmp_lg_u32 s14, 0
    s_cbranch_scc1 LtwX_inia_d
    v_mov_b32 v5, 40
    s_mov_b32 s16, 0
LtwX_inia:
    global_load_dword v6, v5, s[12:13] sc1
    s_add_u32 s16, s16, 1
    s_cmp_gt_u32 s16, 100000
    s_cbranch_scc1 L_role_tw_abort
    s_waitcnt vmcnt(0)
    v_cmp_gt_u32 vcc, 72, v6
    s_nop 0
    s_cbranch_vccz LtwX_inia_d
    s_sleep 8
    s_branch LtwX_inia
LtwX_inia_d:
    s_barrier
    s_cmp_lg_u32 s14, 0
    s_cbranch_scc1 LtwX_inib_d
    v_mov_b32 v5, 160
    s_mov_b32 s16, 0
LtwX_inib:
    global_load_dword v6, v5, s[12:13] sc1
    s_add_u32 s16, s16, 1
    s_cmp_gt_u32 s16, 100000
    s_cbranch_scc1 L_role_tw_abort
    s_waitcnt vmcnt(0)
    v_cmp_gt_u32 vcc, 64, v6
    s_nop 0
    s_cbranch_vccz LtwX_inib_d
    s_sleep 8
    s_branch LtwX_inib
LtwX_inib_d:
    s_barrier
LtwX_idle:
    s_cmp_lg_u32 s14, 0
    s_cbranch_scc1 LtwX_nw0
    s_mul_i32 s60, s32, 22528
    s_add_u32 s60, s60, 4224
    s_cmp_lt_u32 s32, 64
    s_cselect_b32 s60, s60, 2883584
    s_mul_i32 s61, s33, 22528
    s_add_u32 s61, s61, 1446016
    s_cmp_lt_u32 s33, 64
    s_cselect_b32 s61, s61, 2883584
    s_mov_b32 s16, 0
LtwX_p_9:
    buffer_load_dword v2, v1, s[8:11], s60 offen sc1
    buffer_load_dword v15, v1, s[8:11], s61 offen sc1
    s_add_u32 s16, s16, 1
    s_cmp_gt_u32 s16, 100000
    s_cbranch_scc1 L_role_tw_abort
    s_waitcnt vmcnt(1)
    v_cmp_eq_u32 vcc, 0, v2
    s_waitcnt vmcnt(0)
    v_cmp_eq_u32 s[54:55], 0, v15
    s_nop 0
    s_cmp_eq_u64 s[54:55], 0
    s_cselect_b32 s62, 2, 0
    s_cmp_eq_u64 vcc, 0
    s_cselect_b32 s62, 1, s62
    s_cmp_lg_u32 s62, 0
    s_cbranch_scc1 LtwX_p_9d
    s_sleep 4
    s_branch LtwX_p_9
LtwX_p_9d:
    v_mov_b32 v5, s62
    ds_write_b32 v49, v5
    s_waitcnt lgkmcnt(0)
LtwX_nw0:
    s_barrier
    ds_read_b32 v6, v49
    v_xor_b32 v49, 4, v49
    s_waitcnt lgkmcnt(0)
    v_readfirstlane_b32 s62, v6
    s_nop 0
    s_cmp_eq_u32 s62, 0
    s_cbranch_scc1 L_role_tw_abort
    s_cmp_lt_u32 s33, 29
    s_cselect_b32 s38, 1, 3
    s_cmp_eq_u32 s62, 2
    s_cselect_b32 s36, 1, 0
    s_cselect_b32 s37, s33, s32
    s_cselect_b32 s17, s38, 0
    s_add_u32 s33, s33, s17
    s_cmp_eq_u32 s62, 1
    s_cselect_b32 s17, 2, 0
    s_add_u32 s32, s32, s17
    s_lshl_b32 s56, s36, 6
    s_add_u32 s56, s56, s37
    s_lshl_b32 s46, s56, 18
    s_add_u32 s46, s46, s58
    s_mul_i32 s41, s36, 4718592
    s_mul_i32 s17, s37, 36864
    s_add_u32 s41, s41, s17
    s_add_u32 s41, s41, 8650752
    s_cmp_ge_u32 s37, 64
    s_cbranch_scc1 L_role_tw_abort
    buffer_load_dword v9, v10, s[8:11], s46 offen
    s_add_u32 s48, s46, 0
    buffer_load_dwordx4 v[64:67], v0, s[8:11], s48 offen offset:0
    buffer_load_dwordx4 v[68:71], v0, s[8:11], s48 offen offset:1024
    buffer_load_dwordx4 v[72:75], v0, s[8:11], s48 offen offset:2048
    buffer_load_dwordx4 v[76:79], v0, s[8:11], s48 offen offset:3072
    s_add_u32 s48, s46, 4096
    buffer_load_dwordx4 v[80:83], v0, s[8:11], s48 offen offset:0
    buffer_load_dwordx4 v[84:87], v0, s[8:11], s48 offen offset:1024
    buffer_load_dwordx4 v[88:91], v0, s[8:11], s48 offen offset:2048
    buffer_load_dwordx4 v[92:95], v0, s[8:11], s48 offen offset:3072
    s_add_u32 s48, s46, 8192
    buffer_load_dwordx4 v[96:99], v0, s[8:11], s48 offen offset:0
    buffer_load_dwordx4 v[100:103], v0, s[8:11], s48 offen offset:1024
    buffer_load_dwordx4 v[104:107], v0, s[8:11], s48 offen offset:2048
    buffer_load_dwordx4 v[108:111], v0, s[8:11], s48 offen offset:3072
    s_add_u32 s48, s46, 12288
    buffer_load_dwordx4 v[112:115], v0, s[8:11], s48 offen offset:0
    buffer_load_dwordx4 v[116:119], v0, s[8:11], s48 offen offset:1024
    buffer_load_dwordx4 v[120:123], v0, s[8:11], s48 offen offset:2048
    buffer_load_dwordx4 v[40:43], v12, s[8:11], s41 offen
LtwX_item:
    s_mov_b32 s34, s36
    s_mov_b32 s35, s37
    s_mov_b32 s47, s41
    buffer_load_dwordx4 v[124:127], v0, s[8:11], s48 offen offset:3072
    s_waitcnt vmcnt(15)
    v_mfma_f32_16x16x32_bf16 v[16:19], a[0:3], v[64:67], 0
    v_mfma_f32_16x16x32_bf16 v[20:23], a[4:7], v[64:67], 0
    v_mfma_f32_16x16x32_bf16 v[24:27], v[128:131], v[64:67], 0
    s_add_u32 s48, s46, 16384
    buffer_load_dwordx4 v[64:67], v0, s[8:11], s48 offen offset:0
    s_waitcnt vmcnt(15)
    v_mfma_f32_16x16x32_bf16 v[28:31], a[0:3], v[68:71], 0
    v_mfma_f32_16x16x32_bf16 v[32:35], a[4:7], v[68:71], 0
    v_mfma_f32_16x16x32_bf16 v[36:39], v[128:131], v[68:71], 0
    buffer_load_dwordx4 v[68:71], v0, s[8:11], s48 offen offset:1024
    s_waitcnt vmcnt(15)
    v_mfma_f32_16x16x32_bf16 v[16:19], a[8:11], v[72:75], v[16:19]
    v_mfma_f32_16x16x32_bf16 v[20:23], a[12:15], v[72:75], v[20:23]
    v_mfma_f32_16x16x32_bf16 v[24:27], v[132:135], v[72:75], v[24:27]
    buffer_load_dwordx4 v[72:75], v0, s[8:11], s48 offen offset:2048
    s_waitcnt vmcnt(15)
    v_mfma_f32_16x16x32_bf16 v[28:31], a[8:11], v[76:79], v[28:31]
    v_mfma_f32_16x16x32_bf16 v[32:35], a[12:15], v[76:79], v[32:35]
    v_mfma_f32_16x16x32_bf16 v[36:39], v[132:135], v[76:79], v[36:39]
    buffer_load_dwordx4 v[76:79], v0, s[8:11], s48 offen offset:3072
    s_waitcnt vmcnt(15)
    v_mfma_f32_16x16x32_bf16 v[16:19], a[16:19], v[80:83], v[16:19]
    v_mfma_f32_16x16x32_bf16 v[20:23], a[20:23], v[80:83], v[20:23]
    v_mfma_f32_16x16x32_bf16 v[24:27], v[136:139], v[80:83], v[24:27]
    s_add_u32 s48, s46, 20480
    buffer_load_dwordx4 v[80:83], v0, s[8:11], s48 offen offset:0
    s_waitcnt vmcnt(15)
    v_mfma_f32_16x16x32_bf16 v[28:31], a[16:19], v[84:87], v[28:31]
    v_mfma_f32_16x16x32_bf16 v[32:35], a[20:23], v[84:87], v[32:35]
    v_mfma_f32_16x16x32_bf16 v[36:39], v[136:139], v[84:87], v[36:39]
    buffer_load_dwordx4 v[84:87], v0, s[8:11], s48 offen offset:1024
    s_waitcnt vmcnt(15)
    v_mfma_f32_16x16x32_bf16 v[16:19], a[24:27], v[88:91], v[16:19]
    v_mfma_f32_16x16x32_bf16 v[20:23], a[28:31], v[88:91], v[20:23]
    v_mfma_f32_16x16x32_bf16 v[24:27], v[140:143], v[88:91], v[24:27]
    buffer_load_dwordx4 v[88:91], v0, s[8:11], s48 offen offset:2048
    s_waitcnt vmcnt(15)
    v_mfma_f32_16x16x32_bf16 v[28:31], a[24:27], v[92:95], v[28:31]
    v_mfma_f32_16x16x32_bf16 v[32:35], a[28:31], v[92:95], v[32:35]
    v_mfma_f32_16x16x32_bf16 v[36:39], v[140:143], v[92:95], v[36:39]
    buffer_load_dwordx4 v[92:95], v0, s[8:11], s48 offen offset:3072
    s_waitcnt vmcnt(15)
    v_mfma_f32_16x16x32_bf16 v[16:19], a[32:35], v[96:99], v[16:19]
    v_mfma_f32_16x16x32_bf16 v[20:23], a[36:39], v[96:99], v[20:23]
    v_mfma_f32_16x16x32_bf16 v[24:27], v[144:147], v[96:99], v[24:27]
    s_add_u32 s48, s46, 24576
    buffer_load_dwordx4 v[96:99], v0, s[8:11], s48 offen offset:0
    s_waitcnt vmcnt(15)
    v_mfma_f32_16x16x32_bf16 v[28:31], a[32:35], v[100:103], v[28:31]
    v_mfma_f32_16x16x32_bf16 v[32:35], a[36:39], v[100:103], v[32:35]
    v_mfma_f32_16x16x32_bf16 v[36:39], v[144:147], v[100:103], v[36:39]
    buffer_load_dwordx4 v[100:103], v0, s[8:11], s48 offen offset:1024
    s_waitcnt vmcnt(15)
    v_mfma_f32_16x16x32_bf16 v[16:19], a[40:43], v[104:107], v[16:19]
    v_mfma_f32_16x16x32_bf16 v[20:23], a[44:47], v[104:107], v[20:23]
    v_mfma_f32_16x16x32_bf16 v[24:27], v[148:151], v[104:107], v[24:27]
    buffer_load_dwordx4 v[104:107], v0, s[8:11], s48 offen offset:2048
    s_waitcnt vmcnt(15)
    v_mfma_f32_16x16x32_bf16 v[28:31], a[40:43], v[108:111], v[28:31]
    v_mfma_f32_16x16x32_bf16 v[32:35], a[44:47], v[108:111], v[32:35]
    v_mfma_f32_16x16x32_bf16 v[36:39], v[148:151], v[108:111], v[36:39]
    buffer_load_dwordx4 v[108:111], v0, s[8:11], s48 offen offset:3072
    s_waitcnt vmcnt(15)
    v_mfma_f32_16x16x32_bf16 v[16:19], a[48:51], v[112:115], v[16:19]
    v_mfma_f32_16x16x32_bf16 v[20:23], a[52:55], v[112:115], v[20:23]
    v_mfma_f32_16x16x32_bf16 v[24:27], v[152:155], v[112:115], v[24:27]
    s_add_u32 s48, s46, 28672
    buffer_load_dwordx4 v[112:115], v0, s[8:11], s48 offen offset:0
    s_waitcnt vmcnt(15)
    v_mfma_f32_16x16x32_bf16 v[28:31], a[48:51], v[116:119], v[28:31]
    v_mfma_f32_16x16x32_bf16 v[32:35], a[52:55], v[116:119], v[32:35]
    v_mfma_f32_16x16x32_bf16 v[36:39], v[152:155], v[116:119], v[36:39]
    buffer_load_dwordx4 v[116:119], v0, s[8:11], s48 offen offset:1024
    s_waitcnt vmcnt(15)
    v_mfma_f32_16x16x32_bf16 v[16:19], a[56:59], v[120:123], v[16:19]
    v_mfma_f32_16x16x32_bf16 v[20:23], a[60:63], v[120:123], v[20:23]
    v_mfma_f32_16x16x32_bf16 v[24:27], v[156:159], v[120:123], v[24:27]
    buffer_load_dwordx4 v[120:123], v0, s[8:11], s48 offen offset:2048
    s_waitcnt vmcnt(15)
    v_mfma_f32_16x16x32_bf16 v[28:31], a[56:59], v[124:127], v[28:31]
    v_mfma_f32_16x16x32_bf16 v[32:35], a[60:63], v[124:127], v[32:35]
    v_mfma_f32_16x16x32_bf16 v[36:39], v[156:159], v[124:127], v[36:39]
    buffer_load_dwordx4 v[124:127], v0, s[8:11], s48 offen offset:3072
    s_waitcnt vmcnt(15)
    v_mfma_f32_16x16x32_bf16 v[16:19], a[64:67], v[64:67], v[16:19]
    v_mfma_f32_16x16x32_bf16 v[20:23], a[68:71], v[64:67], v[20:23]
    v_mfma_f32_16x16x32_bf16 v[24:27], v[160:163], v[64:67], v[24:27]
    s_add_u32 s48, s46, 32768
    buffer_load_dwordx4 v[64:67], v0, s[8:11], s48 offen offset:0
    s_waitcnt vmcnt(15)
    v_mfma_f32_16x16x32_bf16 v[28:31], a[64:67], v[68:71], v[28:31]
    v_mfma_f32_16x16x32_bf16 v[32:35], a[68:71], v[68:71], v[32:35]
    v_mfma_f32_16x16x32_bf16 v[36:39], v[160:163], v[68:71], v[36:39]
    s_cmp_lg_u32 s43, 0
    s_cselect_b64 exec, 1, 0
    buffer_store_dword v3, v4, s[8:11], s43 offen sc1
    s_mov_b64 exec, -1
    s_mov_b32 s43, 0
    buffer_load_dwordx4 v[68:71], v0, s[8:11], s48 offen offset:1024
    s_waitcnt vmcnt(16)
    v_mfma_f32_16x16x32_bf16 v[16:19], a[72:75], v[72:75], v[16:19]
    v_mfma_f32_16x16x32_bf16 v[20:23], a[76:79], v[72:75], v[20:23]
    v_mfma_f32_16x16x32_bf16 v[24:27], v[164:167], v[72:75], v[24:27]
    buffer_load_dwordx4 v[72:75], v0, s[8:11], s48 offen offset:2048
    s_waitcnt vmcnt(16)
    v_mfma_f32_16x16x32_bf16 v[28:31], a[72:75], v[76:79], v[28:31]
    v_mfma_f32_16x16x32_bf16 v[32:35], a[76:79], v[76:79], v[32:35]
    v_mfma_f32_16x16x32_bf16 v[36:39], v[164:167], v[76:79], v[36:39]
    buffer_load_dwordx4 v[76:79], v0, s[8:11], s48 offen offset:3072
    s_waitcnt vmcnt(16)
    v_mfma_f32_16x16x32_bf16 v[16:19], a[80:83], v[80:83], v[16:19]
    v_mfma_f32_16x16x32_bf16 v[20:23], a[84:87], v[80:83], v[20:23]
    v_mfma_f32_16x16x32_bf16 v[24:27], v[168:171], v[80:83], v[24:27]
    s_add_u32 s48, s46, 36864
    buffer_load_dwordx4 v[80:83], v0, s[8:11], s48 offen offset:0
    s_waitcnt vmcnt(16)
    v_mfma_f32_16x16x32_bf16 v[28:31], a[80:83], v[84:87], v[28:31]
    v_mfma_f32_16x16x32_bf16 v[32:35], a[84:87], v[84:87], v[32:35]
    v_mfma_f32_16x16x32_bf16 v[36:39], v[168:171], v[84:87], v[36:39]
    buffer_load_dwordx4 v[84:87], v0, s[8:11], s48 offen offset:1024
    s_waitcnt vmcnt(16)
    v_mfma_f32_16x16x32_bf16 v[16:19], a[88:91], v[88:91], v[16:19]
    v_mfma_f32_16x16x32_bf16 v[20:23], a[92:95], v[88:91], v[20:23]
    v_mfma_f32_16x16x32_bf16 v[24:27], v[172:175], v[88:91], v[24:27]
    buffer_load_dwordx4 v[88:91], v0, s[8:11], s48 offen offset:2048
    s_waitcnt vmcnt(16)
    v_mfma_f32_16x16x32_bf16 v[28:31], a[88:91], v[92:95], v[28:31]
    v_mfma_f32_16x16x32_bf16 v[32:35], a[92:95], v[92:95], v[32:35]
    v_mfma_f32_16x16x32_bf16 v[36:39], v[172:175], v[92:95], v[36:39]
    buffer_load_dwordx4 v[92:95], v0, s[8:11], s48 offen offset:3072
    s_waitcnt vmcnt(16)
    v_mfma_f32_16x16x32_bf16 v[16:19], a[96:99], v[96:99], v[16:19]
    v_mfma_f32_16x16x32_bf16 v[20:23], a[100:103], v[96:99], v[20:23]
    v_mfma_f32_16x16x32_bf16 v[24:27], v[176:179], v[96:99], v[24:27]
    s_add_u32 s48, s46, 40960
    buffer_load_dwordx4 v[96:99], v0, s[8:11], s48 offen offset:0
    s_waitcnt vmcnt(16)
    v_mfma_f32_16x16x32_bf16 v[28:31], a[96:99], v[100:103], v[28:31]
    v_mfma_f32_16x16x32_bf16 v[32:35], a[100:103], v[100:103], v[32:35]
    v_mfma_f32_16x16x32_bf16 v[36:39], v[176:179], v[100:103], v[36:39]
    buffer_load_dwordx4 v[100:103], v0, s[8:11], s48 offen offset:1024
    s_waitcnt vmcnt(16)
    v_mfma_f32_16x16x32_bf16 v[16:19], a[104:107], v[104:107], v[16:19]
    v_mfma_f32_16x16x32_bf16 v[20:23], a[108:111], v[104:107], v[20:23]
    v_mfma_f32_16x16x32_bf16 v[24:27], v[180:183], v[104:107], v[24:27]
    s_cmp_lg_u32 s14, 0
    s_cbranch_scc1 LtwX_nw1
    s_mul_i32 s60, s32, 22528
    s_add_u32 s60, s60, 4224
    s_cmp_lt_u32 s32, 64
    s_cselect_b32 s60, s60, 2883584
    s_mul_i32 s61, s33, 22528
    s_add_u32 s61, s61, 1446016
    s_cmp_lt_u32 s33, 64
    s_cselect_b32 s61, s61, 2883584
    buffer_load_dword v2, v1, s[8:11], s60 offen sc1
    buffer_load_dword v15, v1, s[8:11], s61 offen sc1
LtwX_nw1:
    buffer_load_dwordx4 v[104:107], v0, s[8:11], s48 offen offset:2048
    s_waitcnt vmcnt(16)
    v_mfma_f32_16x16x32_bf16 v[28:31], a[104:107], v[108:111], v[28:31]
    v_mfma_f32_16x16x32_bf16 v[32:35], a[108:111], v[108:111], v[32:35]
    v_mfma_f32_16x16x32_bf16 v[36:39], v[180:183], v[108:111], v[36:39]
    buffer_load_dwordx4 v[108:111], v0, s[8:11], s48 offen offset:3072
    s_waitcnt vmcnt(16)
    v_mfma_f32_16x16x32_bf16 v[16:19], a[112:115], v[112:115], v[16:19]
    v_mfma_f32_16x16x32_bf16 v[20:23], a[116:119], v[112:115], v[20:23]
    v_mfma_f32_16x16x32_bf16 v[24:27], v[184:187], v[112:115], v[24:27]
    s_add_u32 s48, s46, 45056
    buffer_load_dwordx4 v[112:115], v0, s[8:11], s48 offen offset:0
    s_waitcnt vmcnt(16)
    v_mfma_f32_16x16x32_bf16 v[28:31], a[112:115], v[116:119], v[28:31]
    v_mfma_f32_16x16x32_bf16 v[32:35], a[116:119], v[116:119], v[32:35]
    v_mfma_f32_16x16x32_bf16 v[36:39], v[184:187], v[116:119], v[36:39]
    buffer_load_dwordx4 v[116:119], v0, s[8:11], s48 offen offset:1024
    s_waitcnt vmcnt(16)
    v_mfma_f32_16x16x32_bf16 v[16:19], a[120:123], v[120:123], v[16:19]
    v_mfma_f32_16x16x32_bf16 v[20:23], a[124:127], v[120:123], v[20:23]
    v_mfma_f32_16x16x32_bf16 v[24:27], v[188:191], v[120:123], v[24:27]
    buffer_load_dwordx4 v[120:123], v0, s[8:11], s48 offen offset:2048
    s_waitcnt vmcnt(16)
    v_mfma_f32_16x16x32_bf16 v[28:31], a[120:123], v[124:127], v[28:31]
    v_mfma_f32_16x16x32_bf16 v[32:35], a[124:127], v[124:127], v[32:35]
    v_mfma_f32_16x16x32_bf16 v[36:39], v[188:191], v[124:127], v[36:39]
    buffer_load_dwordx4 v[124:127], v0, s[8:11], s48 offen offset:3072
    s_waitcnt vmcnt(16)
    v_mfma_f32_16x16x32_bf16 v[16:19], a[128:131], v[64:67], v[16:19]
    v_mfma_f32_16x16x32_bf16 v[20:23], a[132:135], v[64:67], v[20:23]
    v_mfma_f32_16x16x32_bf16 v[24:27], v[192:195], v[64:67], v[24:27]
    s_add_u32 s48, s46, 49152
    buffer_load_dwordx4 v[64:67], v0, s[8:11], s48 offen offset:0
    s_waitcnt vmcnt(15)
    v_mfma_f32_16x16x32_bf16 v[28:31], a[128:131], v[68:71], v[28:31]
    v_mfma_f32_16x16x32_bf16 v[32:35], a[132:135], v[68:71], v[32:35]
    v_mfma_f32_16x16x32_bf16 v[36:39], v[192:195], v[68:71], v[36:39]
    buffer_load_dwordx4 v[68:71], v0, s[8:11], s48 offen offset:1024
    s_waitcnt vmcnt(15)
    v_mfma_f32_16x16x32_bf16 v[16:19], a[136:139], v[72:75], v[16:19]
    v_mfma_f32_16x16x32_bf16 v[20:23], a[140:143], v[72:75], v[20:23]
    v_mfma_f32_16x16x32_bf16 v[24:27], v[196:199], v[72:75], v[24:27]
    buffer_load_dwordx4 v[72:75], v0, s[8:11], s48 offen offset:2048
    s_waitcnt vmcnt(15)
    v_mfma_f32_16x16x32_bf16 v[28:31], a[136:139], v[76:79], v[28:31]
    v_mfma_f32_16x16x32_bf16 v[32:35], a[140:143], v[76:79], v[32:35]
    v_mfma_f32_16x16x32_bf16 v[36:39], v[196:199], v[76:79], v[36:39]
    buffer_load_dwordx4 v[76:79], v0, s[8:11], s48 offen offset:3072
    s_waitcnt vmcnt(15)
    v_mfma_f32_16x16x32_bf16 v[16:19], a[144:147], v[80:83], v[16:19]
    v_mfma_f32_16x16x32_bf16 v[20:23], a[148:151], v[80:83], v[20:23]
    v_mfma_f32_16x16x32_bf16 v[24:27], v[200:203], v[80:83], v[24:27]
    s_add_u32 s48, s46, 53248
    buffer_load_dwordx4 v[80:83], v0, s[8:11], s48 offen offset:0
    s_waitcnt vmcnt(15)
    v_mfma_f32_16x16x32_bf16 v[28:31], a[144:147], v[84:87], v[28:31]
    v_mfma_f32_16x16x32_bf16 v[32:35], a[148:151], v[84:87], v[32:35]
    v_mfma_f32_16x16x32_bf16 v[36:39], v[200:203], v[84:87], v[36:39]
    buffer_load_dwordx4 v[84:87], v0, s[8:11], s48 offen offset:1024
    s_waitcnt vmcnt(15)
    v_mfma_f32_16x16x32_bf16 v[16:19], a[152:155], v[88:91], v[16:19]
    v_mfma_f32_16x16x32_bf16 v[20:23], a[156:159], v[88:91], v[20:23]
    v_mfma_f32_16x16x32_bf16 v[24:27], v[204:207], v[88:91], v[24:27]
    buffer_load_dwordx4 v[88:91], v0, s[8:11], s48 offen offset:2048
    s_waitcnt vmcnt(15)
    v_mfma_f32_16x16x32_bf16 v[28:31], a[152:155], v[92:95], v[28:31]
    v_mfma_f32_16x16x32_bf16 v[32:35], a[156:159], v[92:95], v[32:35]
    v_mfma_f32_16x16x32_bf16 v[36:39], v[204:207], v[92:95], v[36:39]
    buffer_load_dwordx4 v[92:95], v0, s[8:11], s48 offen offset:3072
    s_waitcnt vmcnt(15)
    v_mfma_f32_16x16x32_bf16 v[16:19], a[160:163], v[96:99], v[16:19]
    v_mfma_f32_16x16x32_bf16 v[20:23], a[164:167], v[96:99], v[20:23]
    v_mfma_f32_16x16x32_bf16 v[24:27], v[208:211], v[96:99], v[24:27]
    s_add_u32 s48, s46, 57344
    buffer_load_dwordx4 v[96:99], v0, s[8:11], s48 offen offset:0
    s_waitcnt vmcnt(15)
    v_mfma_f32_16x16x32_bf16 v[28:31], a[160:163], v[100:103], v[28:31]
    v_mfma_f32_16x16x32_bf16 v[32:35], a[164:167], v[100:103], v[32:35]
    v_mfma_f32_16x16x32_bf16 v[36:39], v[208:211], v[100:103], v[36:39]
    buffer_load_dwordx4 v[100:103], v0, s[8:11], s48 offen offset:1024
    s_waitcnt vmcnt(15)
    v_mfma_f32_16x16x32_bf16 v[16:19], a[168:171], v[104:107], v[16:19]
    v_mfma_f32_16x16x32_bf16 v[20:23], a[172:175], v[104:107], v[20:23]
    v_mfma_f32_16x16x32_bf16 v[24:27], v[212:215], v[104:107], v[24:27]
    buffer_load_dwordx4 v[104:107], v0, s[8:11], s48 offen offset:2048
    s_waitcnt vmcnt(15)
    v_mfma_f32_16x16x32_bf16 v[28:31], a[168:171], v[108:111], v[28:31]
    v_mfma_f32_16x16x32_bf16 v[32:35], a[172:175], v[108:111], v[32:35]
    v_mfma_f32_16x16x32_bf16 v[36:39], v[212:215], v[108:111], v[36:39]
    buffer_load_dwordx4 v[108:111], v0, s[8:11], s48 offen offset:3072
    s_waitcnt vmcnt(15)
    v_mfma_f32_16x16x32_bf16 v[16:19], a[176:179], v[112:115], v[16:19]
    v_mfma_f32_16x16x32_bf16 v[20:23], a[180:183], v[112:115], v[20:23]
    v_mfma_f32_16x16x32_bf16 v[24:27], v[216:219], v[112:115], v[24:27]
    s_cmp_lg_u32 s14, 0
    s_cbranch_scc1 LtwX_nw2
    v_cmp_eq_u32 vcc, 0, v2
    v_cmp_eq_u32 s[54:55], 0, v15
    s_nop 0
    s_cmp_eq_u64 s[54:55], 0
    s_cselect_b32 s62, 2, 0
    s_cmp_eq_u64 vcc, 0
    s_cselect_b32 s62, 1, s62
    v_mov_b32 v5, s62
    ds_write_b32 v49, v5
    s_waitcnt lgkmcnt(0)
LtwX_nw2:
    s_barrier
    ds_read_b32 v6, v49
    v_xor_b32 v49, 4, v49
    s_add_u32 s48, s46, 61440
    buffer_load_dwordx4 v[112:115], v0, s[8:11], s48 offen offset:0
    s_waitcnt vmcnt(15)
    v_mfma_f32_16x16x32_bf16 v[28:31], a[176:179], v[116:119], v[28:31]
    v_mfma_f32_16x16x32_bf16 v[32:35], a[180:183], v[116:119], v[32:35]
    v_mfma_f32_16x16x32_bf16 v[36:39], v[216:219], v[116:119], v[36:39]
    buffer_load_dwordx4 v[116:119], v0, s[8:11], s48 offen offset:1024
    s_waitcnt vmcnt(15)
    v_mfma_f32_16x16x32_bf16 v[16:19], a[184:187], v[120:123], v[16:19]
    v_mfma_f32_16x16x32_bf16 v[20:23], a[188:191], v[120:123], v[20:23]
    v_mfma_f32_16x16x32_bf16 v[24:27], v[220:223], v[120:123], v[24:27]
    buffer_load_dwordx4 v[120:123], v0, s[8:11], s48 offen offset:2048
    s_waitcnt vmcnt(15)
    v_mfma_f32_16x16x32_bf16 v[28:31], a[184:187], v[124:127], v[28:31]
    v_mfma_f32_16x16x32_bf16 v[32:35], a[188:191], v[124:127], v[32:35]
    v_mfma_f32_16x16x32_bf16 v[36:39], v[220:223], v[124:127], v[36:39]
    s_waitcnt lgkmcnt(0)
    v_readfirstlane_b32 s62, v6
    s_cmp_lt_u32 s33, 29
    s_cselect_b32 s38, 1, 3
    s_cmp_eq_u32 s62, 2
    s_cselect_b32 s36, 1, 0
    s_cselect_b32 s37, s33, s32
    s_cselect_b32 s17, s38, 0
    s_add_u32 s33, s33, s17
    s_cmp_eq_u32 s62, 1
    s_cselect_b32 s17, 2, 0
    s_add_u32 s32, s32, s17
    s_lshl_b32 s56, s36, 6
    s_add_u32 s56, s56, s37
    buffer_load_dwordx4 v[124:127], v0, s[8:11], s48 offen offset:3072
    s_waitcnt vmcnt(15)
    v_mfma_f32_16x16x32_bf16 v[16:19], a[192:195], v[64:67], v[16:19]
    v_mfma_f32_16x16x32_bf16 v[20:23], a[196:199], v[64:67], v[20:23]
    v_mfma_f32_16x16x32_bf16 v[24:27], v[224:227], v[64:67], v[24:27]
    s_cmp_lt_u32 s37, 64
    s_cselect_b32 s62, s62, 0
    s_lshl_b32 s46, s56, 18
    s_add_u32 s46, s46, s58
    s_mul_i32 s41, s36, 4718592
    s_mul_i32 s17, s37, 36864
    s_add_u32 s41, s41, s17
    s_add_u32 s41, s41, 8650752
    s_cmp_lg_u32 s62, 0
    s_cselect_b32 s30, 268435456, 0
    buffer_load_dword v9, v10, s[28:31], s46 offen
    s_add_u32 s48, s46, 0
    buffer_load_dwordx4 v[64:67], v0, s[28:31], s48 offen offset:0
    s_waitcnt vmcnt(16)
    v_mfma_f32_16x16x32_bf16 v[28:31], a[192:195], v[68:71], v[28:31]
    v_mfma_f32_16x16x32_bf16 v[32:35], a[196:199], v[68:71], v[32:35]
    v_mfma_f32_16x16x32_bf16 v[36:39], v[224:227], v[68:71], v[36:39]
    buffer_load_dwordx4 v[68:71], v0, s[28:31], s48 offen offset:1024
    s_waitcnt vmcnt(16)
    v_mfma_f32_16x16x32_bf16 v[16:19], a[200:203], v[72:75], v[16:19]
    v_mfma_f32_16x16x32_bf16 v[20:23], a[204:207], v[72:75], v[20:23]
    v_mfma_f32_16x16x32_bf16 v[24:27], v[228:231], v[72:75], v[24:27]
    buffer_load_dwordx4 v[72:75], v0, s[28:31], s48 offen offset:2048
    s_waitcnt vmcnt(16)
    v_mfma_f32_16x16x32_bf16 v[28:31], a[200:203], v[76:79], v[28:31]
    v_mfma_f32_16x16x32_bf16 v[32:35], a[204:207], v[76:79], v[32:35]
    v_mfma_f32_16x16x32_bf16 v[36:39], v[228:231], v[76:79], v[36:39]
    buffer_load_dwordx4 v[76:79], v0, s[28:31], s48 offen offset:3072
    s_waitcnt vmcnt(16)
    v_mfma_f32_16x16x32_bf16 v[16:19], a[208:211], v[80:83], v[16:19]
    v_mfma_f32_16x16x32_bf16 v[20:23], a[212:215], v[80:83], v[20:23]
    v_mfma_f32_16x16x32_bf16 v[24:27], v[232:235], v[80:83], v[24:27]
    s_add_u32 s48, s46, 4096
    buffer_load_dwordx4 v[80:83], v0, s[28:31], s48 offen offset:0
    s_waitcnt vmcnt(16)
    v_mfma_f32_16x16x32_bf16 v[28:31], a[208:211], v[84:87], v[28:31]
    v_mfma_f32_16x16x32_bf16 v[32:35], a[212:215], v[84:87], v[32:35]
    v_mfma_f32_16x16x32_bf16 v[36:39], v[232:235], v[84:87], v[36:39]
    buffer_load_dwordx4 v[84:87], v0, s[28:31], s48 offen offset:1024
    s_waitcnt vmcnt(16)
    v_mfma_f32_16x16x32_bf16 v[16:19], a[216:219], v[88:91], v[16:19]
    v_mfma_f32_16x16x32_bf16 v[20:23], a[220:223], v[88:91], v[20:23]
    v_mfma_f32_16x16x32_bf16 v[24:27], v[236:239], v[88:91], v[24:27]
    buffer_load_dwordx4 v[88:91], v0, s[28:31], s48 offen offset:2048
    s_waitcnt vmcnt(16)
    v_mfma_f32_16x16x32_bf16 v[28:31], a[216:219], v[92:95], v[28:31]
    v_mfma_f32_16x16x32_bf16 v[32:35], a[220:223], v[92:95], v[32:35]
    v_mfma_f32_16x16x32_bf16 v[36:39], v[236:239], v[92:95], v[36:39]
    buffer_load_dwordx4 v[92:95], v0, s[28:31], s48 offen offset:3072
    s_waitcnt vmcnt(16)
    v_mfma_f32_16x16x32_bf16 v[16:19], a[224:227], v[96:99], v[16:19]
    v_mfma_f32_16x16x32_bf16 v[20:23], a[228:231], v[96:99], v[20:23]
    v_mfma_f32_16x16x32_bf16 v[24:27], v[240:243], v[96:99], v[24:27]
    s_add_u32 s48, s46, 8192
    buffer_load_dwordx4 v[96:99], v0, s[28:31], s48 offen offset:0
    s_waitcnt vmcnt(16)
    v_mfma_f32_16x16x32_bf16 v[28:31], a[224:227], v[100:103], v[28:31]
    v_mfma_f32_16x16x32_bf16 v[32:35], a[228:231], v[100:103], v[32:35]
    v_mfma_f32_16x16x32_bf16 v[36:39], v[240:243], v[100:103], v[36:39]
    buffer_load_dwordx4 v[100:103], v0, s[28:31], s48 offen offset:1024
    s_waitcnt vmcnt(16)
    v_mfma_f32_16x16x32_bf16 v[16:19], a[232:235], v[104:107], v[16:19]
    v_mfma_f32_16x16x32_bf16 v[20:23], a[236:239], v[104:107], v[20:23]
    v_mfma_f32_16x16x32_bf16 v[24:27], v[244:247], v[104:107], v[24:27]
    buffer_load_dwordx4 v[104:107], v0, s[28:31], s48 offen offset:2048
    s_waitcnt vmcnt(16)
    v_mfma_f32_16x16x32_bf16 v[28:31], a[232:235], v[108:111], v[28:31]
    v_mfma_f32_16x16x32_bf16 v[32:35], a[236:239], v[108:111], v[32:35]
    v_mfma_f32_16x16x32_bf16 v[36:39], v[244:247], v[108:111], v[36:39]
    buffer_load_dwordx4 v[108:111], v0, s[28:31], s48 offen offset:3072
    s_waitcnt vmcnt(16)
    v_mfma_f32_16x16x32_bf16 v[16:19], a[240:243], v[112:115], v[16:19]
    v_mfma_f32_16x16x32_bf16 v[20:23], a[244:247], v[112:115], v[20:23]
    v_mfma_f32_16x16x32_bf16 v[24:27], v[248:251], v[112:115], v[24:27]
    s_add_u32 s48, s46, 12288
    buffer_load_dwordx4 v[112:115], v0, s[28:31], s48 offen offset:0
    s_waitcnt vmcnt(16)
    v_mfma_f32_16x16x32_bf16 v[28:31], a[240:243], v[116:119], v[28:31]
    v_mfma_f32_16x16x32_bf16 v[32:35], a[244:247], v[116:119], v[32:35]
    v_mfma_f32_16x16x32_bf16 v[36:39], v[248:251], v[116:119], v[36:39]
    buffer_load_dwordx4 v[116:119], v0, s[28:31], s48 offen offset:1024
    s_waitcnt vmcnt(16)
    v_mfma_f32_16x16x32_bf16 v[16:19], a[248:251], v[120:123], v[16:19]
    v_mfma_f32_16x16x32_bf16 v[20:23], a[252:255], v[120:123], v[20:23]
    v_mfma_f32_16x16x32_bf16 v[24:27], v[252:255], v[120:123], v[24:27]
    buffer_load_dwordx4 v[120:123], v0, s[28:31], s48 offen offset:2048
    s_waitcnt vmcnt(16)
    v_mfma_f32_16x16x32_bf16 v[28:31], a[248:251], v[124:127], v[28:31]
    v_mfma_f32_16x16x32_bf16 v[32:35], a[252:255], v[124:127], v[32:35]
    v_mfma_f32_16x16x32_bf16 v[36:39], v[252:255], v[124:127], v[36:39]
    s_nop 5
    ds_write_b128 v48, v[16:19] offset:0
    ds_write_b128 v48, v[20:23] offset:1024
    ds_write_b128 v48, v[24:27] offset:2048
    ds_write_b128 v48, v[28:31] offset:3072
    ds_write_b128 v48, v[32:35] offset:4096
    ds_write_b128 v48, v[36:39] offset:5120
    s_waitcnt lgkmcnt(0)
    s_barrier
    ds_read_b128 v[24:27], v50 offset:0
    ds_read_b128 v[28:31], v50 offset:1024
    ds_read_b128 v[32:35], v50 offset:6144
    ds_read_b128 v[36:39], v50 offset:7168
    ds_read_b128 v[56:59], v50 offset:12288
    ds_read_b128 v[60:63], v50 offset:13312
    ds_read_b128 v[124:127], v50 offset:18432
    ds_read_b128 v[52:55], v50 offset:19456
    v_xor_b32 v48, 0x8000, v48
    v_xor_b32 v50, 0x8000, v50
    v_lshlrev_b32 v16, 16, v40
    v_and_b32 v20, 0xffff0000, v40
    v_lshlrev_b32 v17, 16, v41
    v_and_b32 v21, 0xffff0000, v41
    v_lshlrev_b32 v18, 16, v42
    v_and_b32 v22, 0xffff0000, v42
    v_lshlrev_b32 v19, 16, v43
    v_and_b32 v23, 0xffff0000, v43
    buffer_load_dwordx4 v[40:43], v12, s[28:31], s41 offen
    s_waitcnt lgkmcnt(7)
    v_add_f32 v16, v16, v24
    v_add_f32 v17, v17, v25
    v_add_f32 v18, v18, v26
    v_add_f32 v19, v19, v27
    s_waitcnt lgkmcnt(6)
    v_add_f32 v20, v20, v28
    v_add_f32 v21, v21, v29
    v_add_f32 v22, v22, v30
    v_add_f32 v23, v23, v31
    s_waitcnt lgkmcnt(5)
    v_add_f32 v16, v16, v32
    v_add_f32 v17, v17, v33
    v_add_f32 v18, v18, v34
    v_add_f32 v19, v19, v35
    s_waitcnt lgkmcnt(4)
    v_add_f32 v20, v20, v36
    v_add_f32 v21, v21, v37
    v_add_f32 v22, v22, v38
    v_add_f32 v23, v23, v39
    s_waitcnt lgkmcnt(3)
    v_add_f32 v16, v16, v56
    v_add_f32 v17, v17, v57
    v_add_f32 v18, v18, v58
    v_add_f32 v19, v19, v59
    s_waitcnt lgkmcnt(2)
    v_add_f32 v20, v20, v60
    v_add_f32 v21, v21, v61
    v_add_f32 v22, v22, v62
    v_add_f32 v23, v23, v63
    s_waitcnt lgkmcnt(1)
    v_add_f32 v16, v16, v124
    v_add_f32 v17, v17, v125
    v_add_f32 v18, v18, v126
    v_add_f32 v19, v19, v127
    s_waitcnt lgkmcnt(0)
    v_add_f32 v20, v20, v52
    v_add_f32 v21, v21, v53
    v_add_f32 v22, v22, v54
    v_add_f32 v23, v23, v55
    v_cvt_pk_bf16_f32 v52, v16, v20
    v_cvt_pk_bf16_f32 v53, v17, v21
    v_cvt_pk_bf16_f32 v54, v18, v22
    v_cvt_pk_bf16_f32 v55, v19, v23
    s_cmp_eq_u32 s34, 0
    s_cbranch_scc1 LtwX_l0
    s_mul_i32 s17, s35, 36864
    buffer_store_dwordx4 v[52:55], v13, s[24:27], s17 offen sc1
    s_cmp_lg_u32 s62, 0
    s_cbranch_scc1 LtwX_item
LtwX_chk:
    s_min_u32 s17, s32, s33
    s_cmp_lt_u32 s17, 64
    s_cbranch_scc1 LtwX_idle
    s_branch L_role_tw_exit
LtwX_l0:
    s_add_u32 s47, s47, 2359296
    buffer_store_dwordx4 v[52:55], v12, s[8:11], s47 offen sc1
    v_add_f32 v44, v16, v17
    v_mul_f32 v45, v16, v16
    v_fmac_f32 v45, v17, v17
    v_add_f32 v44, v44, v18
    v_fmac_f32 v45, v18, v18
    v_add_f32 v44, v44, v19
    v_fmac_f32 v45, v19, v19
    v_add_f32 v44, v44, v20
    v_fmac_f32 v45, v20, v20
    v_add_f32 v44, v44, v21
    v_fmac_f32 v45, v21, v21
    v_add_f32 v44, v44, v22
    v_fmac_f32 v45, v22, v22
    v_add_f32 v44, v44, v23
    v_fmac_f32 v45, v23, v23
    v_mov_b32 v46, v44
    v_mov_b32 v47, v45
    s_nop 0
    v_permlane32_swap_b32 v44, v46
    v_permlane32_swap_b32 v45, v47
    v_add_f32 v44, v44, v46
    v_add_f32 v45, v45, v47
    v_mov_b32 v46, v44
    v_mov_b32 v47, v45
    s_nop 0
    v_permlane16_swap_b32 v44, v46
    v_permlane16_swap_b32 v45, v47
    v_add_f32 v44, v44, v46
    v_add_f32 v45, v45, v47
    s_mul_i32 s17, s35, 6144
    s_add_u32 s17, s17, 16515072
    s_mov_b64 exec, 0xffff
    buffer_store_dwordx2 v[44:45], v14, s[8:11], s17 offen sc1
    s_mov_b64 exec, -1
    s_mul_i32 s43, s35, 22528
    s_add_u32 s43, s43, s49
    s_cmp_lg_u32 s62, 0
    s_cbranch_scc1 LtwX_item
    s_waitcnt vmcnt(0)
    s_mov_b64 exec, 1
    buffer_store_dword v3, v4, s[8:11], s43 offen sc1
    s_mov_b64 exec, -1
    s_mov_b32 s43, 0
    s_branch LtwX_chk
Ltw_z:
    v_lshrrev_b32 v5, 1, v8
    v_lshl_add_u32 v12, v5, 9, v12
    v_and_b32 v5, 1, v8
    v_lshl_add_u32 v12, v5, 3, v12
    v_add_u32 v12, 2048, v12
    v_lshl_add_u32 v13, v8, 3, v13
    v_add_u32 v13, 64, v13
    v_add_u32 v14, 8, v14
    s_lshl_b32 s58, s14, 16
    s_add_u32 s58, s58, 144703488
    s_mov_b32 s43, 0
    s_mov_b32 s28, s8
    s_mov_b32 s29, s9
    s_mov_b32 s30, 0
    s_mov_b32 s31, 0x00020000
    s_mul_i32 s17, s51, 3072
    v_add_u32 v50, s17, v0
    ds_write2_b32 v49, v4, v4 offset0:0 offset1:1
    s_waitcnt lgkmcnt(0)
    s_cmp_lg_u32 s14, 0
    s_cbranch_scc1 LtwZ_inia_d
    v_mov_b32 v5, 40
    s_mov_b32 s16, 0
LtwZ_inia:
    global_load_dword v6, v5, s[12:13] sc1
    s_add_u32 s16, s16, 1
    s_cmp_gt_u32 s16, 100000
    s_cbranch_scc1 L_role_tw_abort
    s_waitcnt vmcnt(0)
    v_cmp_gt_u32 vcc, 72, v6
    s_nop 0
    s_cbranch_vccz LtwZ_inia_d
    s_sleep 8
    s_branch LtwZ_inia
LtwZ_inia_d:
    s_barrier
    s_cmp_lg_u32 s14, 0
    s_cbranch_scc1 LtwZ_inib_d
    v_mov_b32 v5, 160
    s_mov_b32 s16, 0
LtwZ_inib:
    global_load_dword v6, v5, s[12:13] sc1
    s_add_u32 s16, s16, 1
    s_cmp_gt_u32 s16, 100000
    s_cbranch_scc1 L_role_tw_abort
    s_waitcnt vmcnt(0)
    v_cmp_gt_u32 vcc, 64, v6
    s_nop 0
    s_cbranch_vccz LtwZ_inib_d
    s_sleep 8
    s_branch LtwZ_inib
LtwZ_inib_d:
    s_barrier
LtwZ_idle:
    s_barrier
    ds_read_b32 v6, v49
    v_xor_b32 v49, 4, v49
    s_waitcnt lgkmcnt(0)
    v_readfirstlane_b32 s62, v6
    s_nop 0
    s_cmp_eq_u32 s62, 0
    s_cbranch_scc1 L_role_tw_abort
    s_cmp_lt_u32 s33, 29
    s_cselect_b32 s38, 1, 3
    s_cmp_eq_u32 s62, 2
    s_cselect_b32 s36, 1, 0
    s_cselect_b32 s37, s33, s32
    s_cselect_b32 s17, s38, 0
    s_add_u32 s33, s33, s17
    s_cmp_eq_u32 s62, 1
    s_cselect_b32 s17, 2, 0
    s_add_u32 s32, s32, s17
    s_lshl_b32 s56, s36, 6
    s_add_u32 s56, s56, s37
    s_lshl_b32 s46, s56, 18
    s_add_u32 s46, s46, s58
    s_mul_i32 s41, s36, 4718592
    s_mul_i32 s17, s37, 36864
    s_add_u32 s41, s41, s17
    s_add_u32 s41, s41, 8650752
    s_cmp_ge_u32 s37, 64
    s_cbranch_scc1 L_role_tw_abort
    buffer_load_dword v9, v10, s[8:11], s46 offen
    s_add_u32 s48, s46, 0
    buffer_load_dwordx4 v[64:67], v0, s[8:11], s48 offen offset:0
    buffer_load_dwordx4 v[68:71], v0, s[8:11], s48 offen offset:1024
    buffer_load_dwordx4 v[72:75], v0, s[8:11], s48 offen offset:2048
    buffer_load_dwordx4 v[76:79], v0, s[8:11], s48 offen offset:3072
    s_add_u32 s48, s46, 4096
    buffer_load_dwordx4 v[80:83], v0, s[8:11], s48 offen offset:0
    buffer_load_dwordx4 v[84:87], v0, s[8:11], s48 offen offset:1024
    buffer_load_dwordx4 v[88:91], v0, s[8:11], s48 offen offset:2048
    buffer_load_dwordx4 v[92:95], v0, s[8:11], s48 offen offset:3072
    s_add_u32 s48, s46, 8192
    buffer_load_dwordx4 v[96:99], v0, s[8:11], s48 offen offset:0
    buffer_load_dwordx4 v[100:103], v0, s[8:11], s48 offen offset:1024
    buffer_load_dwordx4 v[104:107], v0, s[8:11], s48 offen offset:2048
    buffer_load_dwordx4 v[108:111], v0, s[8:11], s48 offen offset:3072
    s_add_u32 s48, s46, 12288
    buffer_load_dwordx4 v[112:115], v0, s[8:11], s48 offen offset:0
    buffer_load_dwordx4 v[116:119], v0, s[8:11], s48 offen offset:1024
    buffer_load_dwordx4 v[120:123], v0, s[8:11], s48 offen offset:2048
    buffer_load_dwordx2 v[40:41], v12, s[8:11], s41 offen
LtwZ_item:
    s_mov_b32 s34, s36
    s_mov_b32 s35, s37
    s_mov_b32 s47, s41
    buffer_load_dwordx4 v[124:127], v0, s[8:11], s48 offen offset:3072
    s_waitcnt vmcnt(15)
    v_mfma_f32_16x16x32_bf16 v[16:19], a[0:3], v[64:67], 0
    v_mfma_f32_16x16x32_bf16 v[20:23], a[4:7], v[64:67], 0
    v_mfma_f32_16x16x32_bf16 v[24:27], v[128:131], v[64:67], 0
    s_add_u32 s48, s46, 16384
    buffer_load_dwordx4 v[64:67], v0, s[8:11], s48 offen offset:0
    s_waitcnt vmcnt(15)
    v_mfma_f32_16x16x32_bf16 v[28:31], a[0:3], v[68:71], 0
    v_mfma_f32_16x16x32_bf16 v[32:35], a[4:7], v[68:71], 0
    v_mfma_f32_16x16x32_bf16 v[36:39], v[128:131], v[68:71], 0
    buffer_load_dwordx4 v[68:71], v0, s[8:11], s48 offen offset:1024
    s_waitcnt vmcnt(15)
    v_mfma_f32_16x16x32_bf16 v[16:19], a[8:11], v[72:75], v[16:19]
    v_mfma_f32_16x16x32_bf16 v[20:23], a[12:15], v[72:75], v[20:23]
    v_mfma_f32_16x16x32_bf16 v[24:27], v[132:135], v[72:75], v[24:27]
    buffer_load_dwordx4 v[72:75], v0, s[8:11], s48 offen offset:2048
    s_waitcnt vmcnt(15)
    v_mfma_f32_16x16x32_bf16 v[28:31], a[8:11], v[76:79], v[28:31]
    v_mfma_f32_16x16x32_bf16 v[32:35], a[12:15], v[76:79], v[32:35]
    v_mfma_f32_16x16x32_bf16 v[36:39], v[132:135], v[76:79], v[36:39]
    buffer_load_dwordx4 v[76:79], v0, s[8:11], s48 offen offset:3072
    s_waitcnt vmcnt(15)
    v_mfma_f32_16x16x32_bf16 v[16:19], a[16:19], v[80:83], v[16:19]
    v_mfma_f32_16x16x32_bf16 v[20:23], a[20:23], v[80:83], v[20:23]
    v_mfma_f32_16x16x32_bf16 v[24:27], v[136:139], v[80:83], v[24:27]
    s_add_u32 s48, s46, 20480
    buffer_load_dwordx4 v[80:83], v0, s[8:11], s48 offen offset:0
    s_waitcnt vmcnt(15)
    v_mfma_f32_16x16x32_bf16 v[28:31], a[16:19], v[84:87], v[28:31]
    v_mfma_f32_16x16x32_bf16 v[32:35], a[20:23], v[84:87], v[32:35]
    v_mfma_f32_16x16x32_bf16 v[36:39], v[136:139], v[84:87], v[36:39]
    buffer_load_dwordx4 v[84:87], v0, s[8:11], s48 offen offset:1024
    s_waitcnt vmcnt(15)
    v_mfma_f32_16x16x32_bf16 v[16:19], a[24:27], v[88:91], v[16:19]
    v_mfma_f32_16x16x32_bf16 v[20:23], a[28:31], v[88:91], v[20:23]
    v_mfma_f32_16x16x32_bf16 v[24:27], v[140:143], v[88:91], v[24:27]
    buffer_load_dwordx4 v[88:91], v0, s[8:11], s48 offen offset:2048
    s_waitcnt vmcnt(15)
    v_mfma_f32_16x16x32_bf16 v[28:31], a[24:27], v[92:95], v[28:31]
    v_mfma_f32_16x16x32_bf16 v[32:35], a[28:31], v[92:95], v[32:35]
    v_mfma_f32_16x16x32_bf16 v[36:39], v[140:143], v[92:95], v[36:39]
    buffer_load_dwordx4 v[92:95], v0, s[8:11], s48 offen offset:3072
    s_waitcnt vmcnt(15)
    v_mfma_f32_16x16x32_bf16 v[16:19], a[32:35], v[96:99], v[16:19]
    v_mfma_f32_16x16x32_bf16 v[20:23], a[36:39], v[96:99], v[20:23]
    v_mfma_f32_16x16x32_bf16 v[24:27], v[144:147], v[96:99], v[24:27]
    s_add_u32 s48, s46, 24576
    buffer_load_dwordx4 v[96:99], v0, s[8:11], s48 offen offset:0
    s_waitcnt vmcnt(15)
    v_mfma_f32_16x16x32_bf16 v[28:31], a[32:35], v[100:103], v[28:31]
    v_mfma_f32_16x16x32_bf16 v[32:35], a[36:39], v[100:103], v[32:35]
    v_mfma_f32_16x16x32_bf16 v[36:39], v[144:147], v[100:103], v[36:39]
    buffer_load_dwordx4 v[100:103], v0, s[8:11], s48 offen offset:1024
    s_waitcnt vmcnt(15)
    v_mfma_f32_16x16x32_bf16 v[16:19], a[40:43], v[104:107], v[16:19]
    v_mfma_f32_16x16x32_bf16 v[20:23], a[44:47], v[104:107], v[20:23]
    v_mfma_f32_16x16x32_bf16 v[24:27], v[148:151], v[104:107], v[24:27]
    buffer_load_dwordx4 v[104:107], v0, s[8:11], s48 offen offset:2048
    s_waitcnt vmcnt(15)
    v_mfma_f32_16x16x32_bf16 v[28:31], a[40:43], v[108:111], v[28:31]
    v_mfma_f32_16x16x32_bf16 v[32:35], a[44:47], v[108:111], v[32:35]
    v_mfma_f32_16x16x32_bf16 v[36:39], v[148:151], v[108:111], v[36:39]
    buffer_load_dwordx4 v[108:111], v0, s[8:11], s48 offen offset:3072
    s_waitcnt vmcnt(15)
    v_mfma_f32_16x16x32_bf16 v[16:19], a[48:51], v[112:115], v[16:19]
    v_mfma_f32_16x16x32_bf16 v[20:23], a[52:55], v[112:115], v[20:23]
    v_mfma_f32_16x16x32_bf16 v[24:27], v[152:155], v[112:115], v[24:27]
    s_add_u32 s48, s46, 28672
    buffer_load_dwordx4 v[112:115], v0, s[8:11], s48 offen offset:0
    s_waitcnt vmcnt(15)
    v_mfma_f32_16x16x32_bf16 v[28:31], a[48:51], v[116:119], v[28:31]
    v_mfma_f32_16x16x32_bf16 v[32:35], a[52:55], v[116:119], v[32:35]
    v_mfma_f32_16x16x32_bf16 v[36:39], v[152:155], v[116:119], v[36:39]
    buffer_load_dwordx4 v[116:119], v0, s[8:11], s48 offen offset:1024
    s_waitcnt vmcnt(15)
    v_mfma_f32_16x16x32_bf16 v[16:19], a[56:59], v[120:123], v[16:19]
    v_mfma_f32_16x16x32_bf16 v[20:23], a[60:63], v[120:123], v[20:23]
    v_mfma_f32_16x16x32_bf16 v[24:27], v[156:159], v[120:123], v[24:27]
    buffer_load_dwordx4 v[120:123], v0, s[8:11], s48 offen offset:2048
    s_waitcnt vmcnt(15)
    v_mfma_f32_16x16x32_bf16 v[28:31], a[56:59], v[124:127], v[28:31]
    v_mfma_f32_16x16x32_bf16 v[32:35], a[60:63], v[124:127], v[32:35]
    v_mfma_f32_16x16x32_bf16 v[36:39], v[156:159], v[124:127], v[36:39]
    buffer_load_dwordx4 v[124:127], v0, s[8:11], s48 offen offset:3072
    s_waitcnt vmcnt(15)
    v_mfma_f32_16x16x32_bf16 v[16:19], a[64:67], v[64:67], v[16:19]
    v_mfma_f32_16x16x32_bf16 v[20:23], a[68:71], v[64:67], v[20:23]
    v_mfma_f32_16x16x32_bf16 v[24:27], v[160:163], v[64:67], v[24:27]
    s_add_u32 s48, s46, 32768
    buffer_load_dwordx4 v[64:67], v0, s[8:11], s48 offen offset:0
    s_waitcnt vmcnt(15)
    v_mfma_f32_16x16x32_bf16 v[28:31], a[64:67], v[68:71], v[28:31]
    v_mfma_f32_16x16x32_bf16 v[32:35], a[68:71], v[68:71], v[32:35]
    v_mfma_f32_16x16x32_bf16 v[36:39], v[160:163], v[68:71], v[36:39]
    s_cmp_lg_u32 s43, 0
    s_cselect_b64 exec, 1, 0
    buffer_store_dword v3, v4, s[8:11], s43 offen sc1
    s_mov_b64 exec, -1
    s_mov_b32 s43, 0
    buffer_load_dwordx4 v[68:71], v0, s[8:11], s48 offen offset:1024
    s_waitcnt vmcnt(16)
    v_mfma_f32_16x16x32_bf16 v[16:19], a[72:75], v[72:75], v[16:19]
    v_mfma_f32_16x16x32_bf16 v[20:23], a[76:79], v[72:75], v[20:23]
    v_mfma_f32_16x16x32_bf16 v[24:27], v[164:167], v[72:75], v[24:27]
    buffer_load_dwordx4 v[72:75], v0, s[8:11], s48 offen offset:2048
    s_waitcnt vmcnt(16)
    v_mfma_f32_16x16x32_bf16 v[28:31], a[72:75], v[76:79], v[28:31]
    v_mfma_f32_16x16x32_bf16 v[32:35], a[76:79], v[76:79], v[32:35]
    v_mfma_f32_16x16x32_bf16 v[36:39], v[164:167], v[76:79], v[36:39]
    buffer_load_dwordx4 v[76:79], v0, s[8:11], s48 offen offset:3072
    s_waitcnt vmcnt(16)
    v_mfma_f32_16x16x32_bf16 v[16:19], a[80:83], v[80:83], v[16:19]
    v_mfma_f32_16x16x32_bf16 v[20:23], a[84:87], v[80:83], v[20:23]
    v_mfma_f32_16x16x32_bf16 v[24:27], v[168:171], v[80:83], v[24:27]
    s_add_u32 s48, s46, 36864
    buffer_load_dwordx4 v[80:83], v0, s[8:11], s48 offen offset:0
    s_waitcnt vmcnt(16)
    v_mfma_f32_16x16x32_bf16 v[28:31], a[80:83], v[84:87], v[28:31]
    v_mfma_f32_16x16x32_bf16 v[32:35], a[84:87], v[84:87], v[32:35]
    v_mfma_f32_16x16x32_bf16 v[36:39], v[168:171], v[84:87], v[36:39]
    buffer_load_dwordx4 v[84:87], v0, s[8:11], s48 offen offset:1024
    s_waitcnt vmcnt(16)
    v_mfma_f32_16x16x32_bf16 v[16:19], a[88:91], v[88:91], v[16:19]
    v_mfma_f32_16x16x32_bf16 v[20:23], a[92:95], v[88:91], v[20:23]
    v_mfma_f32_16x16x32_bf16 v[24:27], v[172:175], v[88:91], v[24:27]
    buffer_load_dwordx4 v[88:91], v0, s[8:11], s48 offen offset:2048
    s_waitcnt vmcnt(16)
    v_mfma_f32_16x16x32_bf16 v[28:31], a[88:91], v[92:95], v[28:31]
    v_mfma_f32_16x16x32_bf16 v[32:35], a[92:95], v[92:95], v[32:35]
    v_mfma_f32_16x16x32_bf16 v[36:39], v[172:175], v[92:95], v[36:39]
    buffer_load_dwordx4 v[92:95], v0, s[8:11], s48 offen offset:3072
    s_waitcnt vmcnt(16)
    v_mfma_f32_16x16x32_bf16 v[16:19], a[96:99], v[96:99], v[16:19]
    v_mfma_f32_16x16x32_bf16 v[20:23], a[100:103], v[96:99], v[20:23]
    v_mfma_f32_16x16x32_bf16 v[24:27], v[176:179], v[96:99], v[24:27]
    s_add_u32 s48, s46, 40960
    buffer_load_dwordx4 v[96:99], v0, s[8:11], s48 offen offset:0
    s_waitcnt vmcnt(16)
    v_mfma_f32_16x16x32_bf16 v[28:31], a[96:99], v[100:103], v[28:31]
    v_mfma_f32_16x16x32_bf16 v[32:35], a[100:103], v[100:103], v[32:35]
    v_mfma_f32_16x16x32_bf16 v[36:39], v[176:179], v[100:103], v[36:39]
    buffer_load_dwordx4 v[100:103], v0, s[8:11], s48 offen offset:1024
    s_waitcnt vmcnt(16)
    v_mfma_f32_16x16x32_bf16 v[16:19], a[104:107], v[104:107], v[16:19]
    v_mfma_f32_16x16x32_bf16 v[20:23], a[108:111], v[104:107], v[20:23]
    v_mfma_f32_16x16x32_bf16 v[24:27], v[180:183], v[104:107], v[24:27]
    buffer_load_dwordx4 v[104:107], v0, s[8:11], s48 offen offset:2048
    s_waitcnt vmcnt(16)
    v_mfma_f32_16x16x32_bf16 v[28:31], a[104:107], v[108:111], v[28:31]
    v_mfma_f32_16x16x32_bf16 v[32:35], a[108:111], v[108:111], v[32:35]
    v_mfma_f32_16x16x32_bf16 v[36:39], v[180:183], v[108:111], v[36:39]
    buffer_load_dwordx4 v[108:111], v0, s[8:11], s48 offen offset:3072
    s_waitcnt vmcnt(16)
    v_mfma_f32_16x16x32_bf16 v[16:19], a[112:115], v[112:115], v[16:19]
    v_mfma_f32_16x16x32_bf16 v[20:23], a[116:119], v[112:115], v[20:23]
    v_mfma_f32_16x16x32_bf16 v[24:27], v[184:187], v[112:115], v[24:27]
    s_add_u32 s48, s46, 45056
    buffer_load_dwordx4 v[112:115], v0, s[8:11], s48 offen offset:0
    s_waitcnt vmcnt(16)
    v_mfma_f32_16x16x32_bf16 v[28:31], a[112:115], v[116:119], v[28:31]
    v_mfma_f32_16x16x32_bf16 v[32:35], a[116:119], v[116:119], v[32:35]
    v_mfma_f32_16x16x32_bf16 v[36:39], v[184:187], v[116:119], v[36:39]
    buffer_load_dwordx4 v[116:119], v0, s[8:11], s48 offen offset:1024
    s_waitcnt vmcnt(16)
    v_mfma_f32_16x16x32_bf16 v[16:19], a[120:123], v[120:123], v[16:19]
    v_mfma_f32_16x16x32_bf16 v[20:23], a[124:127], v[120:123], v[20:23]
    v_mfma_f32_16x16x32_bf16 v[24:27], v[188:191], v[120:123], v[24:27]
    buffer_load_dwordx4 v[120:123], v0, s[8:11], s48 offen offset:2048
    s_waitcnt vmcnt(16)
    v_mfma_f32_16x16x32_bf16 v[28:31], a[120:123], v[124:127], v[28:31]
    v_mfma_f32_16x16x32_bf16 v[32:35], a[124:127], v[124:127], v[32:35]
    v_mfma_f32_16x16x32_bf16 v[36:39], v[188:191], v[124:127], v[36:39]
    buffer_load_dwordx4 v[124:127], v0, s[8:11], s48 offen offset:3072
    s_waitcnt vmcnt(16)
    v_mfma_f32_16x16x32_bf16 v[16:19], a[128:131], v[64:67], v[16:19]
    v_mfma_f32_16x16x32_bf16 v[20:23], a[132:135], v[64:67], v[20:23]
    v_mfma_f32_16x16x32_bf16 v[24:27], v[192:195], v[64:67], v[24:27]
    s_add_u32 s48, s46, 49152
    buffer_load_dwordx4 v[64:67], v0, s[8:11], s48 offen offset:0
    s_waitcnt vmcnt(15)
    v_mfma_f32_16x16x32_bf16 v[28:31], a[128:131], v[68:71], v[28:31]
    v_mfma_f32_16x16x32_bf16 v[32:35], a[132:135], v[68:71], v[32:35]
    v_mfma_f32_16x16x32_bf16 v[36:39], v[192:195], v[68:71], v[36:39]
    buffer_load_dwordx4 v[68:71], v0, s[8:11], s48 offen offset:1024
    s_waitcnt vmcnt(15)
    v_mfma_f32_16x16x32_bf16 v[16:19], a[136:139], v[72:75], v[16:19]
    v_mfma_f32_16x16x32_bf16 v[20:23], a[140:143], v[72:75], v[20:23]
    v_mfma_f32_16x16x32_bf16 v[24:27], v[196:199], v[72:75], v[24:27]
    buffer_load_dwordx4 v[72:75], v0, s[8:11], s48 offen offset:2048
    s_waitcnt vmcnt(15)
    v_mfma_f32_16x16x32_bf16 v[28:31], a[136:139], v[76:79], v[28:31]
    v_mfma_f32_16x16x32_bf16 v[32:35], a[140:143], v[76:79], v[32:35]
    v_mfma_f32_16x16x32_bf16 v[36:39], v[196:199], v[76:79], v[36:39]
    buffer_load_dwordx4 v[76:79], v0, s[8:11], s48 offen offset:3072
    s_waitcnt vmcnt(15)
    v_mfma_f32_16x16x32_bf16 v[16:19], a[144:147], v[80:83], v[16:19]
    v_mfma_f32_16x16x32_bf16 v[20:23], a[148:151], v[80:83], v[20:23]
    v_mfma_f32_16x16x32_bf16 v[24:27], v[200:203], v[80:83], v[24:27]
    s_add_u32 s48, s46, 53248
    buffer_load_dwordx4 v[80:83], v0, s[8:11], s48 offen offset:0
    s_waitcnt vmcnt(15)
    v_mfma_f32_16x16x32_bf16 v[28:31], a[144:147], v[84:87], v[28:31]
    v_mfma_f32_16x16x32_bf16 v[32:35], a[148:151], v[84:87], v[32:35]
    v_mfma_f32_16x16x32_bf16 v[36:39], v[200:203], v[84:87], v[36:39]
    buffer_load_dwordx4 v[84:87], v0, s[8:11], s48 offen offset:1024
    s_waitcnt vmcnt(15)
    v_mfma_f32_16x16x32_bf16 v[16:19], a[152:155], v[88:91], v[16:19]
    v_mfma_f32_16x16x32_bf16 v[20:23], a[156:159], v[88:91], v[20:23]
    v_mfma_f32_16x16x32_bf16 v[24:27], v[204:207], v[88:91], v[24:27]
    buffer_load_dwordx4 v[88:91], v0, s[8:11], s48 offen offset:2048
    s_waitcnt vmcnt(15)
    v_mfma_f32_16x16x32_bf16 v[28:31], a[152:155], v[92:95], v[28:31]
    v_mfma_f32_16x16x32_bf16 v[32:35], a[156:159], v[92:95], v[32:35]
    v_mfma_f32_16x16x32_bf16 v[36:39], v[204:207], v[92:95], v[36:39]
    buffer_load_dwordx4 v[92:95], v0, s[8:11], s48 offen offset:3072
    s_waitcnt vmcnt(15)
    v_mfma_f32_16x16x32_bf16 v[16:19], a[160:163], v[96:99], v[16:19]
    v_mfma_f32_16x16x32_bf16 v[20:23], a[164:167], v[96:99], v[20:23]
    v_mfma_f32_16x16x32_bf16 v[24:27], v[208:211], v[96:99], v[24:27]
    s_add_u32 s48, s46, 57344
    buffer_load_dwordx4 v[96:99], v0, s[8:11], s48 offen offset:0
    s_waitcnt vmcnt(15)
    v_mfma_f32_16x16x32_bf16 v[28:31], a[160:163], v[100:103], v[28:31]
    v_mfma_f32_16x16x32_bf16 v[32:35], a[164:167], v[100:103], v[32:35]
    v_mfma_f32_16x16x32_bf16 v[36:39], v[208:211], v[100:103], v[36:39]
    buffer_load_dwordx4 v[100:103], v0, s[8:11], s48 offen offset:1024
    s_waitcnt vmcnt(15)
    v_mfma_f32_16x16x32_bf16 v[16:19], a[168:171], v[104:107], v[16:19]
    v_mfma_f32_16x16x32_bf16 v[20:23], a[172:175], v[104:107], v[20:23]
    v_mfma_f32_16x16x32_bf16 v[24:27], v[212:215], v[104:107], v[24:27]
    buffer_load_dwordx4 v[104:107], v0, s[8:11], s48 offen offset:2048
    s_waitcnt vmcnt(15)
    v_mfma_f32_16x16x32_bf16 v[28:31], a[168:171], v[108:111], v[28:31]
    v_mfma_f32_16x16x32_bf16 v[32:35], a[172:175], v[108:111], v[32:35]
    v_mfma_f32_16x16x32_bf16 v[36:39], v[212:215], v[108:111], v[36:39]
    buffer_load_dwordx4 v[108:111], v0, s[8:11], s48 offen offset:3072
    s_waitcnt vmcnt(15)
    v_mfma_f32_16x16x32_bf16 v[16:19], a[176:179], v[112:115], v[16:19]
    v_mfma_f32_16x16x32_bf16 v[20:23], a[180:183], v[112:115], v[20:23]
    v_mfma_f32_16x16x32_bf16 v[24:27], v[216:219], v[112:115], v[24:27]
    s_barrier
    ds_read_b32 v6, v49
    v_xor_b32 v49, 4, v49
    s_add_u32 s48, s46, 61440
    buffer_load_dwordx4 v[112:115], v0, s[8:11], s48 offen offset:0
    s_waitcnt vmcnt(15)
    v_mfma_f32_16x16x32_bf16 v[28:31], a[176:179], v[116:119], v[28:31]
    v_mfma_f32_16x16x32_bf16 v[32:35], a[180:183], v[116:119], v[32:35]
    v_mfma_f32_16x16x32_bf16 v[36:39], v[216:219], v[116:119], v[36:39]
    buffer_load_dwordx4 v[116:119], v0, s[8:11], s48 offen offset:1024
    s_waitcnt vmcnt(15)
    v_mfma_f32_16x16x32_bf16 v[16:19], a[184:187], v[120:123], v[16:19]
    v_mfma_f32_16x16x32_bf16 v[20:23], a[188:191], v[120:123], v[20:23]
    v_mfma_f32_16x16x32_bf16 v[24:27], v[220:223], v[120:123], v[24:27]
    buffer_load_dwordx4 v[120:123], v0, s[8:11], s48 offen offset:2048
    s_waitcnt vmcnt(15)
    v_mfma_f32_16x16x32_bf16 v[28:31], a[184:187], v[124:127], v[28:31]
    v_mfma_f32_16x16x32_bf16 v[32:35], a[188:191], v[124:127], v[32:35]
    v_mfma_f32_16x16x32_bf16 v[36:39], v[220:223], v[124:127], v[36:39]
    s_waitcnt lgkmcnt(0)
    v_readfirstlane_b32 s62, v6
    s_cmp_lt_u32 s33, 29
    s_cselect_b32 s38, 1, 3
    s_cmp_eq_u32 s62, 2
    s_cselect_b32 s36, 1, 0
    s_cselect_b32 s37, s33, s32
    s_cselect_b32 s17, s38, 0
    s_add_u32 s33, s33, s17
    s_cmp_eq_u32 s62, 1
    s_cselect_b32 s17, 2, 0
    s_add_u32 s32, s32, s17
    s_lshl_b32 s56, s36, 6
    s_add_u32 s56, s56, s37
    buffer_load_dwordx4 v[124:127], v0, s[8:11], s48 offen offset:3072
    s_waitcnt vmcnt(15)
    v_mfma_f32_16x16x32_bf16 v[16:19], a[192:195], v[64:67], v[16:19]
    v_mfma_f32_16x16x32_bf16 v[20:23], a[196:199], v[64:67], v[20:23]
    v_mfma_f32_16x16x32_bf16 v[24:27], v[224:227], v[64:67], v[24:27]
    s_cmp_lt_u32 s37, 64
    s_cselect_b32 s62, s62, 0
    s_lshl_b32 s46, s56, 18
    s_add_u32 s46, s46, s58
    s_mul_i32 s41, s36, 4718592
    s_mul_i32 s17, s37, 36864
    s_add_u32 s41, s41, s17
    s_add_u32 s41, s41, 8650752
    s_cmp_lg_u32 s62, 0
    s_cselect_b32 s30, 268435456, 0
    buffer_load_dword v9, v10, s[28:31], s46 offen
    s_add_u32 s48, s46, 0
    buffer_load_dwordx4 v[64:67], v0, s[28:31], s48 offen offset:0
    s_waitcnt vmcnt(16)
    v_mfma_f32_16x16x32_bf16 v[28:31], a[192:195], v[68:71], v[28:31]
    v_mfma_f32_16x16x32_bf16 v[32:35], a[196:199], v[68:71], v[32:35]
    v_mfma_f32_16x16x32_bf16 v[36:39], v[224:227], v[68:71], v[36:39]
    buffer_load_dwordx4 v[68:71], v0, s[28:31], s48 offen offset:1024
    s_waitcnt vmcnt(16)
    v_mfma_f32_16x16x32_bf16 v[16:19], a[200:203], v[72:75], v[16:19]
    v_mfma_f32_16x16x32_bf16 v[20:23], a[204:207], v[72:75], v[20:23]
    v_mfma_f32_16x16x32_bf16 v[24:27], v[228:231], v[72:75], v[24:27]
    buffer_load_dwordx4 v[72:75], v0, s[28:31], s48 offen offset:2048
    s_waitcnt vmcnt(16)
    v_mfma_f32_16x16x32_bf16 v[28:31], a[200:203], v[76:79], v[28:31]
    v_mfma_f32_16x16x32_bf16 v[32:35], a[204:207], v[76:79], v[32:35]
    v_mfma_f32_16x16x32_bf16 v[36:39], v[228:231], v[76:79], v[36:39]
    buffer_load_dwordx4 v[76:79], v0, s[28:31], s48 offen offset:3072
    s_waitcnt vmcnt(16)
    v_mfma_f32_16x16x32_bf16 v[16:19], a[208:211], v[80:83], v[16:19]
    v_mfma_f32_16x16x32_bf16 v[20:23], a[212:215], v[80:83], v[20:23]
    v_mfma_f32_16x16x32_bf16 v[24:27], v[232:235], v[80:83], v[24:27]
    s_add_u32 s48, s46, 4096
    buffer_load_dwordx4 v[80:83], v0, s[28:31], s48 offen offset:0
    s_waitcnt vmcnt(16)
    v_mfma_f32_16x16x32_bf16 v[28:31], a[208:211], v[84:87], v[28:31]
    v_mfma_f32_16x16x32_bf16 v[32:35], a[212:215], v[84:87], v[32:35]
    v_mfma_f32_16x16x32_bf16 v[36:39], v[232:235], v[84:87], v[36:39]
    buffer_load_dwordx4 v[84:87], v0, s[28:31], s48 offen offset:1024
    s_waitcnt vmcnt(16)
    v_mfma_f32_16x16x32_bf16 v[16:19], a[216:219], v[88:91], v[16:19]
    v_mfma_f32_16x16x32_bf16 v[20:23], a[220:223], v[88:91], v[20:23]
    v_mfma_f32_16x16x32_bf16 v[24:27], v[236:239], v[88:91], v[24:27]
    buffer_load_dwordx4 v[88:91], v0, s[28:31], s48 offen offset:2048
    s_waitcnt vmcnt(16)
    v_mfma_f32_16x16x32_bf16 v[28:31], a[216:219], v[92:95], v[28:31]
    v_mfma_f32_16x16x32_bf16 v[32:35], a[220:223], v[92:95], v[32:35]
    v_mfma_f32_16x16x32_bf16 v[36:39], v[236:239], v[92:95], v[36:39]
    buffer_load_dwordx4 v[92:95], v0, s[28:31], s48 offen offset:3072
    s_waitcnt vmcnt(16)
    v_mfma_f32_16x16x32_bf16 v[16:19], a[224:227], v[96:99], v[16:19]
    v_mfma_f32_16x16x32_bf16 v[20:23], a[228:231], v[96:99], v[20:23]
    v_mfma_f32_16x16x32_bf16 v[24:27], v[240:243], v[96:99], v[24:27]
    s_add_u32 s48, s46, 8192
    buffer_load_dwordx4 v[96:99], v0, s[28:31], s48 offen offset:0
    s_waitcnt vmcnt(16)
    v_mfma_f32_16x16x32_bf16 v[28:31], a[224:227], v[100:103], v[28:31]
    v_mfma_f32_16x16x32_bf16 v[32:35], a[228:231], v[100:103], v[32:35]
    v_mfma_f32_16x16x32_bf16 v[36:39], v[240:243], v[100:103], v[36:39]
    buffer_load_dwordx4 v[100:103], v0, s[28:31], s48 offen offset:1024
    s_waitcnt vmcnt(16)
    v_mfma_f32_16x16x32_bf16 v[16:19], a[232:235], v[104:107], v[16:19]
    v_mfma_f32_16x16x32_bf16 v[20:23], a[236:239], v[104:107], v[20:23]
    v_mfma_f32_16x16x32_bf16 v[24:27], v[244:247], v[104:107], v[24:27]
    buffer_load_dwordx4 v[104:107], v0, s[28:31], s48 offen offset:2048
    s_waitcnt vmcnt(16)
    v_mfma_f32_16x16x32_bf16 v[28:31], a[232:235], v[108:111], v[28:31]
    v_mfma_f32_16x16x32_bf16 v[32:35], a[236:239], v[108:111], v[32:35]
    v_mfma_f32_16x16x32_bf16 v[36:39], v[244:247], v[108:111], v[36:39]
    buffer_load_dwordx4 v[108:111], v0, s[28:31], s48 offen offset:3072
    s_waitcnt vmcnt(16)
    v_mfma_f32_16x16x32_bf16 v[16:19], a[240:243], v[112:115], v[16:19]
    v_mfma_f32_16x16x32_bf16 v[20:23], a[244:247], v[112:115], v[20:23]
    v_mfma_f32_16x16x32_bf16 v[24:27], v[248:251], v[112:115], v[24:27]
    s_add_u32 s48, s46, 12288
    buffer_load_dwordx4 v[112:115], v0, s[28:31], s48 offen offset:0
    s_waitcnt vmcnt(16)
    v_mfma_f32_16x16x32_bf16 v[28:31], a[240:243], v[116:119], v[28:31]
    v_mfma_f32_16x16x32_bf16 v[32:35], a[244:247], v[116:119], v[32:35]
    v_mfma_f32_16x16x32_bf16 v[36:39], v[248:251], v[116:119], v[36:39]
    buffer_load_dwordx4 v[116:119], v0, s[28:31], s48 offen offset:1024
    s_waitcnt vmcnt(16)
    v_mfma_f32_16x16x32_bf16 v[16:19], a[248:251], v[120:123], v[16:19]
    v_mfma_f32_16x16x32_bf16 v[20:23], a[252:255], v[120:123], v[20:23]
    v_mfma_f32_16x16x32_bf16 v[24:27], v[252:255], v[120:123], v[24:27]
    buffer_load_dwordx4 v[120:123], v0, s[28:31], s48 offen offset:2048
    s_waitcnt vmcnt(16)
    v_mfma_f32_16x16x32_bf16 v[28:31], a[248:251], v[124:127], v[28:31]
    v_mfma_f32_16x16x32_bf16 v[32:35], a[252:255], v[124:127], v[32:35]
    v_mfma_f32_16x16x32_bf16 v[36:39], v[252:255], v[124:127], v[36:39]
    s_nop 5
    ds_write_b128 v48, v[16:19] offset:0
    ds_write_b128 v48, v[20:23] offset:1024
    ds_write_b128 v48, v[24:27] offset:2048
    ds_write_b128 v48, v[28:31] offset:3072
    ds_write_b128 v48, v[32:35] offset:4096
    ds_write_b128 v48, v[36:39] offset:5120
    s_waitcnt lgkmcnt(0)
    s_barrier
    ds_read_b128 v[24:27], v50 offset:2048
    ds_read_b128 v[28:31], v50 offset:8192
    ds_read_b128 v[32:35], v50 offset:14336
    ds_read_b128 v[36:39], v50 offset:20480
    v_xor_b32 v48, 0x8000, v48
    v_xor_b32 v50, 0x8000, v50
    v_lshlrev_b32 v16, 16, v40
    v_and_b32 v17, 0xffff0000, v40
    v_lshlrev_b32 v18, 16, v41
    v_and_b32 v19, 0xffff0000, v41
    buffer_load_dwordx2 v[40:41], v12, s[28:31], s41 offen
    s_waitcnt lgkmcnt(3)
    v_add_f32 v16, v16, v24
    v_add_f32 v17, v17, v25
    v_add_f32 v18, v18, v26
    v_add_f32 v19, v19, v27
    s_waitcnt lgkmcnt(2)
    v_add_f32 v16, v16, v28
    v_add_f32 v17, v17, v29
    v_add_f32 v18, v18, v30
    v_add_f32 v19, v19, v31
    s_waitcnt lgkmcnt(1)
    v_add_f32 v16, v16, v32
    v_add_f32 v17, v17, v33
    v_add_f32 v18, v18, v34
    v_add_f32 v19, v19, v35
    s_waitcnt lgkmcnt(0)
    v_add_f32 v16, v16, v36
    v_add_f32 v17, v17, v37
    v_add_f32 v18, v18, v38
    v_add_f32 v19, v19, v39
    v_cvt_pk_bf16_f32 v52, v16, v17
    v_cvt_pk_bf16_f32 v53, v18, v19
    s_cmp_eq_u32 s34, 0
    s_cbranch_scc1 LtwZ_l0
    s_mul_i32 s17, s35, 36864
    buffer_store_dwordx2 v[52:53], v13, s[24:27], s17 offen sc1
    s_cmp_lg_u32 s62, 0
    s_cbranch_scc1 LtwZ_item
LtwZ_chk:
    s_min_u32 s17, s32, s33
    s_cmp_lt_u32 s17, 64
    s_cbranch_scc1 LtwZ_idle
    s_branch L_role_tw_exit
LtwZ_l0:
    s_add_u32 s47, s47, 2359296
    buffer_store_dwordx2 v[52:53], v12, s[8:11], s47 offen sc1
    v_add_f32 v44, v16, v17
    v_mul_f32 v45, v16, v16
    v_fmac_f32 v45, v17, v17
    v_add_f32 v44, v44, v18
    v_fmac_f32 v45, v18, v18
    v_add_f32 v44, v44, v19
    v_fmac_f32 v45, v19, v19
    v_mov_b32 v46, v44
    v_mov_b32 v47, v45
    s_nop 0
    v_permlane32_swap_b32 v44, v46
    v_permlane32_swap_b32 v45, v47
    v_add_f32 v44, v44, v46
    v_add_f32 v45, v45, v47
    v_mov_b32 v46, v44
    v_mov_b32 v47, v45
    s_nop 0
    v_permlane16_swap_b32 v44, v46
    v_permlane16_swap_b32 v45, v47
    v_add_f32 v44, v44, v46
    v_add_f32 v45, v45, v47
    s_mul_i32 s17, s35, 6144
    s_add_u32 s17, s17, 16515072
    s_mov_b64 exec, 0xffff
    buffer_store_dwordx2 v[44:45], v14, s[8:11], s17 offen sc1
    s_mov_b64 exec, -1
    s_mul_i32 s43, s35, 22528
    s_add_u32 s43, s43, s49
    s_cmp_lg_u32 s62, 0
    s_cbranch_scc1 LtwZ_item
    s_waitcnt vmcnt(0)
    s_mov_b64 exec, 1
    buffer_store_dword v3, v4, s[8:11], s43 offen sc1
    s_mov_b64 exec, -1
    s_mov_b32 s43, 0
    s_branch LtwZ_chk
L_role_tw_abort:
    s_waitcnt lgkmcnt(0)
    s_mov_b64 exec, -1
    v_mov_b32 v0, 60
    s_lshl_b32 s5, s3, 8
    s_or_b32 s5, s5, s4
    s_or_b32 s5, s5, 0x10000
    v_mov_b32 v1, s5
    global_store_dword v0, v1, s[12:13]
    s_endpgm
L_role_tw_exit:
    s_endpgm
.p2align 6
L_role_r:
    s_mov_b32 s32, s3
    s_mov_b32 s15, s4
    v_and_b32 v60, 63, v0
    v_and_b32 v61, 15, v60
    v_lshrrev_b32 v62, 4, v60
    v_lshlrev_b32 v0, 4, v60
    s_mul_i32 s17, s14, 34816
    s_add_u32 s17, s17, 23296
    v_add_u32 v8, s17, v0
    s_mov_b32 s50, 0xfffffffe
    s_mov_b32 s44, 0x3e0293ee
    s_mov_b32 s45, 0x3e0293ee
    s_mov_b32 s52, 0x3f803f80
    s_mov_b32 s53, 0x3f803f80
    s_mov_b32 s40, 1
    s_mov_b32 s46, 0x00ff00ff
    s_cmp_eq_u32 s14, 2
    s_cselect_b32 s46, 0x00030003, s46
    s_mov_b32 s47, s46
    v_bfe_u32 v63, v61, 1, 1
    v_mov_b32 v1, 0x4444
    v_mov_b32 v64, 0xeeee
    v_cmp_eq_u32 vcc, 0, v63
    s_nop 1
    v_cndmask_b32 v1, v64, v1, vcc
    v_mul_u32_u24 v64, 1152, v62
    v_lshl_add_u32 v2, v61, 2, v64
    s_lshl_b32 s17, s14, 6
    s_add_u32 s18, s17, 0
    v_add_u32 v2, s18, v2
    v_mul_u32_u24 v64, 288, v61
    v_lshl_add_u32 v3, v62, 4, v64
    v_add_u32 v3, 0, v3
    v_lshrrev_b32 v64, 2, v61
    v_and_b32 v65, 1, v61
    v_lshl_add_u32 v64, v64, 1, v65
    v_mul_u32_u24 v65, 288, v64
    v_lshl_add_u32 v4, v62, 5, v65
    v_lshl_add_u32 v4, v63, 4, v4
    v_add_u32 v4, 4608, v4
    v_xor_b32 v63, 1, v63
    v_mul_u32_u24 v63, 2304, v63
    v_add_u32 v5, v65, v63
    v_lshl_add_u32 v5, v62, 4, v5
    s_add_u32 s18, s17, 4608
    v_add_u32 v5, s18, v5
    s_lshr_b32 s70, s15, 3
    s_bfe_u32 s71, s15, 0x20001
    s_and_b32 s72, s15, 1
    v_bfe_u32 v64, v61, 2, 1
    v_lshl_add_u32 v63, v64, 2, v62
    v_mul_u32_u24 v63, 9216, v63
    v_lshrrev_b32 v65, 3, v61
    v_lshlrev_b32 v65, 2, v65
    v_and_b32 v64, 3, v61
    v_add_u32 v65, v65, v64
    s_lshl_b32 s73, s71, 4
    s_lshl_b32 s17, s72, 3
    s_add_u32 s73, s73, s17
    v_add_u32 v65, s73, v65
    s_lshl_b32 s17, s70, 6
    v_add_u32 v65, s17, v65
    s_cmp_eq_u32 s14, 2
    s_cselect_b32 s17, 2, 4
    v_lshlrev_b32 v65, s17, v65
    v_add_u32 v6, v63, v65
    s_lshl_b32 s17, s14, 12
    v_add_u32 v6, s17, v6
    v_lshrrev_b32 v66, 1, v61
    s_lshl_b32 s17, s14, 2
    v_add_u32 v66, s17, v66
    v_and_b32 v64, 1, v61
    s_lshl_b32 s17, s70, 4
    s_lshl_b32 s18, s71, 2
    s_add_u32 s17, s17, s18
    s_lshl_b32 s18, s72, 1
    s_add_u32 s17, s17, s18
    v_add_u32 v65, s17, v64
    v_lshl_add_u32 v65, v66, 6, v65
    v_lshlrev_b32 v65, 4, v65
    v_lshl_add_u32 v7, v62, 2, v65
    s_lshl_b32 s17, s71, 1
    v_add_u32 v64, s17, v64
    v_mul_u32_u24 v64, 576, v64
    v_lshl_add_u32 v64, v66, 4, v64
    v_lshl_add_u32 v64, v62, 1, v64
    s_mul_i32 s17, s70, 144
    s_lshl_b32 s18, s72, 3
    s_add_u32 s17, s17, s18
    v_add_u32 v64, s17, v64
    v_lshlrev_b32 v67, 1, v64
    s_mul_i32 s48, s32, 1048576
    s_add_u32 s48, s48, 4194304
    s_mul_i32 s17, s15, 9216
    s_add_u32 s17, s17, s48
    s_lshl_b32 s18, s14, 10
    s_add_u32 s38, s17, s18
    s_lshl_b32 s19, s14, 8
    s_add_u32 s39, s17, s19
    s_add_u32 s39, s39, 8192
    s_add_u32 s37, s48, 983040
    s_xor_b32 s36, s37, 16384
    s_add_u32 s34, s37, s18
    s_add_u32 s35, s37, 8192
    s_mul_i32 s17, s32, 50331648
    s_lshl_b32 s19, s15, 13
    s_add_u32 s17, s17, s19
    s_add_u32 s68, s17, 77594624
    s_lshl_b32 s18, s14, 11
    s_add_u32 s17, s17, s18
    s_add_u32 s41, s17, 60817408
    s_add_u32 s42, s17, 77594624
    s_mul_i32 s17, s32, 8388608
    s_lshl_b32 s19, s15, 12
    s_add_u32 s17, s17, s19
    s_add_u32 s43, s17, 27262976
    s_mul_i32 s17, s32, 1441792
    s_lshl_b32 s19, s15, 9
    s_add_u32 s17, s17, s19
    s_add_u32 s66, s17, 5376
    s_mov_b32 s33, 0
    s_add_u32 s62, s48, 0
    s_add_u32 s63, s48, 73728
    s_add_u32 s64, s48, 147456
    s_add_u32 s65, s48, 221184
    s_load_dwordx2 s[20:21], s[0:1], 32
    s_mov_b32 s22, 9216
    s_mov_b32 s23, 0x00020000
    s_waitcnt lgkmcnt(0)
    s_and_b32 s21, s21, 0xffff
    s_cmp_gt_u32 s14, 2
    s_cbranch_scc1 Lr_mem0_done
    s_mov_b64 exec, s[46:47]
    buffer_load_dword v64, v67, s[20:23], 0 offen
    s_waitcnt vmcnt(0)
    v_min_u32 v64, s50, v64
    buffer_store_dword v64, v7, s[8:11], s37 offen sc1
    v_mov_b32 v64, -1
    buffer_store_dword v64, v7, s[8:11], s36 offen sc1
    s_mov_b64 exec, -1
Lr_mem0_done:
    v_mov_b32 v64, 0
    v_mov_b32 v65, 0
    v_mov_b32 v66, 0
    v_mov_b32 v67, 0
    v_lshrrev_b32 v63, 2, v0
    buffer_store_dwordx4 v[64:67], v0, s[8:11], s38 offen sc1
    s_add_u32 s17, s38, 4096
    buffer_store_dwordx4 v[64:67], v0, s[8:11], s17 offen sc1
    buffer_store_dword v64, v63, s[8:11], s39 offen sc1
    s_waitcnt vmcnt(0)
    s_barrier
    s_cmp_lg_u32 s14, 0
    s_cbranch_scc1 Lr_noadd
    s_lshl_b32 s17, s32, 2
    s_add_u32 s17, s17, 192
    v_mov_b32 v63, s17
    v_mov_b32 v64, 1
    s_mov_b64 exec, 1
    global_atomic_add v63, v64, s[12:13]
    s_mov_b64 exec, -1
Lr_noadd:
    s_cmp_lt_u32 s14, 3
    s_cbranch_scc1 Lr_not_w3
    v_lshlrev_b32 v6, 3, v0
    v_lshrrev_b32 v63, 2, v0
    v_and_b32 v7, 12, v63
    v_and_b32 v63, 16, v63
    v_lshl_add_u32 v7, v63, 3, v7
Lr_not_w3:
    s_cmp_eq_u32 s32, 0
    s_cbranch_scc1 Lr_gate_ng
    s_cmp_lg_u32 s14, 0
    s_cbranch_scc1 Lr_gate_d
    v_mov_b32 v63, 48
    s_mov_b32 s16, 0
Lr_gate:
    global_load_dword v64, v63, s[12:13] sc1
    s_add_u32 s16, s16, 1
    s_cmp_gt_u32 s16, 100000
    s_cbranch_scc1 Lr_abort
    s_waitcnt vmcnt(0)
    v_cmp_gt_u32 vcc, 32, v64
    s_nop 0
    s_cbranch_vccz Lr_gate_d
    s_sleep 100
    s_branch Lr_gate
Lr_gate_d:
    s_barrier
Lr_gate_ng:
    s_load_dwordx2 s[20:21], s[0:1], 40
    s_mov_b32 s22, 4718592
    s_mov_b32 s23, 0x00020000
    s_waitcnt lgkmcnt(0)
    s_and_b32 s21, s21, 0xffff
    s_load_dwordx2 s[24:25], s[0:1], 48
    s_mov_b32 s26, 4718592
    s_mov_b32 s27, 0x00020000
    s_waitcnt lgkmcnt(0)
    s_and_b32 s25, s25, 0xffff
    s_load_dwordx2 s[28:29], s[0:1], 56
    s_mov_b32 s30, 4718592
    s_mov_b32 s31, 0x00020000
    s_waitcnt lgkmcnt(0)
    s_and_b32 s29, s29, 0xffff
    s_load_dwordx2 s[76:77], s[0:1], 64
    s_mov_b32 s78, 4718592
    s_mov_b32 s79, 0x00020000
    s_waitcnt lgkmcnt(0)
    s_and_b32 s77, s77, 0xffff
    v_lshrrev_b32 v60, 4, v0
    v_and_b32 v61, 15, v60
    v_lshrrev_b32 v62, 4, v60
    s_mul_i32 s72, s14, 34816
    s_add_u32 s72, s72, 23296
    s_mul_i32 s70, s14, 1179648
    s_lshl_b32 s17, s15, 8
    s_add_u32 s70, s70, s17
    s_mul_i32 s71, s15, 147456
    s_mul_i32 s17, s14, 288
    s_add_u32 s71, s71, s17
    v_and_b32 v63, 1, v62
    v_lshrrev_b32 v64, 1, v61
    v_xor_b32 v64, v64, v63
    v_lshlrev_b32 v64, 5, v64
    v_and_b32 v65, 1, v61
    v_lshl_add_u32 v64, v65, 4, v64
    v_lshl_add_u32 v12, v62, 13, v64
    v_xor_b32 v13, 128, v12
    v_xor_b32 v14, 64, v12
    v_xor_b32 v15, 192, v12
    v_lshrrev_b32 v63, 2, v60
    v_mul_u32_u24 v63, 1152, v63
    v_and_b32 v64, 3, v60
    v_lshl_add_u32 v16, v64, 4, v63
    v_lshrrev_b32 v63, 1, v60
    v_mul_u32_u24 v63, 1152, v63
    v_and_b32 v64, 1, v60
    v_lshl_add_u32 v17, v64, 4, v63
    v_lshrrev_b32 v40, 2, v61
    v_and_b32 v41, 3, v61
    v_and_b32 v63, 1, v62
    v_lshl_add_u32 v42, v63, 2, v40
    v_and_b32 v64, 1, v40
    v_lshl_add_u32 v64, v63, 2, v64
    v_lshrrev_b32 v65, 1, v40
    v_lshl_add_u32 v64, v65, 3, v64
    v_lshlrev_b32 v64, 8, v64
    v_lshl_add_u32 v64, v41, 3, v64
    v_lshrrev_b32 v65, 1, v62
    v_mul_u32_u24 v65, 34816, v65
    v_add_u32 v64, v64, v65
    v_add_u32 v64, 23296, v64
    s_lshl_b32 s17, s14, 1
    s_add_u32 s18, s17, 0
    v_xor_b32 v65, s18, v42
    v_lshl_add_u32 v18, v65, 5, v64
    v_add_u32 v19, 69632, v18
    s_add_u32 s18, s17, 1
    v_xor_b32 v65, s18, v42
    v_lshl_add_u32 v20, v65, 5, v64
    v_add_u32 v21, 69632, v20
    v_lshrrev_b32 v63, 1, v62
    v_lshlrev_b32 v63, 3, v63
    v_and_b32 v64, 1, v62
    v_lshl_add_u32 v63, v64, 1, v63
    v_and_b32 v64, 1, v40
    v_lshl_add_u32 v63, v64, 4, v63
    v_lshrrev_b32 v64, 1, v40
    v_lshl_add_u32 v63, v64, 2, v63
    v_lshlrev_b32 v64, 3, v41
    v_lshl_add_u32 v22, v63, 6, v64
    v_add_u32 v22, s72, v22
    v_lshl_add_u32 v23, v63, 5, v64
    v_add_u32 v23, s72, v23
    s_add_u32 m0, s72, 0
    s_add_u32 s17, s70, 0
    buffer_load_dwordx4 v12, s[20:23], s17 offen lds
    s_add_u32 m0, m0, 1024
    s_add_u32 s17, s70, 32768
    buffer_load_dwordx4 v13, s[20:23], s17 offen lds
    s_add_u32 m0, m0, 1024
    s_add_u32 s17, s70, 65536
    buffer_load_dwordx4 v14, s[20:23], s17 offen lds
    s_add_u32 m0, m0, 1024
    s_add_u32 s17, s70, 98304
    buffer_load_dwordx4 v15, s[20:23], s17 offen lds
    s_add_u32 m0, s72, 4096
    s_add_u32 s17, s70, 0
    buffer_load_dwordx4 v12, s[24:27], s17 offen lds
    s_add_u32 m0, m0, 1024
    s_add_u32 s17, s70, 32768
    buffer_load_dwordx4 v13, s[24:27], s17 offen lds
    s_add_u32 m0, m0, 1024
    s_add_u32 s17, s70, 65536
    buffer_load_dwordx4 v14, s[24:27], s17 offen lds
    s_add_u32 m0, m0, 1024
    s_add_u32 s17, s70, 98304
    buffer_load_dwordx4 v15, s[24:27], s17 offen lds
    s_add_u32 m0, s72, 8192
    s_add_u32 s17, s70, 131072
    buffer_load_dwordx4 v12, s[20:23], s17 offen lds
    s_add_u32 m0, m0, 1024
    s_add_u32 s17, s70, 163840
    buffer_load_dwordx4 v13, s[20:23], s17 offen lds
    s_add_u32 m0, m0, 1024
    s_add_u32 s17, s70, 196608
    buffer_load_dwordx4 v14, s[20:23], s17 offen lds
    s_add_u32 m0, m0, 1024
    s_add_u32 s17, s70, 229376
    buffer_load_dwordx4 v15, s[20:23], s17 offen lds
    s_add_u32 m0, s72, 12288
    s_add_u32 s17, s70, 131072
    buffer_load_dwordx4 v12, s[24:27], s17 offen lds
    s_add_u32 m0, m0, 1024
    s_add_u32 s17, s70, 163840
    buffer_load_dwordx4 v13, s[24:27], s17 offen lds
    s_add_u32 m0, m0, 1024
    s_add_u32 s17, s70, 196608
    buffer_load_dwordx4 v14, s[24:27], s17 offen lds
    s_add_u32 m0, m0, 1024
    s_add_u32 s17, s70, 229376
    buffer_load_dwordx4 v15, s[24:27], s17 offen lds
    s_add_u32 m0, s72, 16384
    s_add_u32 s17, s70, 131072
    buffer_load_dwordx4 v12, s[28:31], s17 offen lds
    s_add_u32 m0, m0, 1024
    s_add_u32 s17, s70, 163840
    buffer_load_dwordx4 v13, s[28:31], s17 offen lds
    s_add_u32 m0, m0, 1024
    s_add_u32 s17, s70, 196608
    buffer_load_dwordx4 v14, s[28:31], s17 offen lds
    s_add_u32 m0, m0, 1024
    s_add_u32 s17, s70, 229376
    buffer_load_dwordx4 v15, s[28:31], s17 offen lds
    s_add_u32 m0, s72, 20480
    s_add_u32 s17, s70, 262144
    buffer_load_dwordx4 v12, s[20:23], s17 offen lds
    s_add_u32 m0, m0, 1024
    s_add_u32 s17, s70, 294912
    buffer_load_dwordx4 v13, s[20:23], s17 offen lds
    s_add_u32 m0, m0, 1024
    s_add_u32 s17, s70, 327680
    buffer_load_dwordx4 v14, s[20:23], s17 offen lds
    s_add_u32 m0, m0, 1024
    s_add_u32 s17, s70, 360448
    buffer_load_dwordx4 v15, s[20:23], s17 offen lds
    s_add_u32 m0, s72, 24576
    s_add_u32 s17, s70, 262144
    buffer_load_dwordx4 v12, s[24:27], s17 offen lds
    s_add_u32 m0, m0, 1024
    s_add_u32 s17, s70, 294912
    buffer_load_dwordx4 v13, s[24:27], s17 offen lds
    s_add_u32 m0, m0, 1024
    s_add_u32 s17, s70, 327680
    buffer_load_dwordx4 v14, s[24:27], s17 offen lds
    s_add_u32 m0, m0, 1024
    s_add_u32 s17, s70, 360448
    buffer_load_dwordx4 v15, s[24:27], s17 offen lds
    s_add_u32 m0, s72, 28672
    s_add_u32 s17, s70, 393216
    buffer_load_dwordx4 v12, s[20:23], s17 offen lds
    s_add_u32 m0, m0, 1024
    s_add_u32 s17, s70, 425984
    buffer_load_dwordx4 v13, s[20:23], s17 offen lds
    s_add_u32 m0, m0, 1024
    s_add_u32 s17, s70, 458752
    buffer_load_dwordx4 v14, s[20:23], s17 offen lds
    s_add_u32 m0, m0, 1024
    s_add_u32 s17, s70, 491520
    buffer_load_dwordx4 v15, s[20:23], s17 offen lds
    s_add_u32 m0, s72, 32768
    s_add_u32 s17, s71, 256
    buffer_load_dwordx4 v17, s[76:79], s17 offen lds
    s_add_u32 m0, m0, 1024
    s_add_u32 s17, s71, 37120
    buffer_load_dwordx4 v17, s[76:79], s17 offen lds
    s_waitcnt vmcnt(30)
    s_barrier
    ds_read_b64_tr_b16 v[72:73], v18 offset:0
    ds_read_b64_tr_b16 v[74:75], v18 offset:512
    ds_read_b64_tr_b16 v[76:77], v19 offset:0
    ds_read_b64_tr_b16 v[78:79], v19 offset:512
    ds_read_b64_tr_b16 v[80:81], v20 offset:0
    ds_read_b64_tr_b16 v[82:83], v20 offset:512
    ds_read_b64_tr_b16 v[84:85], v21 offset:0
    ds_read_b64_tr_b16 v[86:87], v21 offset:512
    s_waitcnt lgkmcnt(0)
    s_waitcnt vmcnt(26)
    s_barrier
    s_add_u32 m0, s72, 0
    s_add_u32 s17, s70, 393216
    buffer_load_dwordx4 v12, s[24:27], s17 offen lds
    s_add_u32 m0, m0, 1024
    s_add_u32 s17, s70, 425984
    buffer_load_dwordx4 v13, s[24:27], s17 offen lds
    s_add_u32 m0, m0, 1024
    s_add_u32 s17, s70, 458752
    buffer_load_dwordx4 v14, s[24:27], s17 offen lds
    s_add_u32 m0, m0, 1024
    s_add_u32 s17, s70, 491520
    buffer_load_dwordx4 v15, s[24:27], s17 offen lds
    ds_read_b64_tr_b16 v[184:185], v18 offset:4096
    ds_read_b64_tr_b16 v[186:187], v18 offset:4608
    ds_read_b64_tr_b16 v[188:189], v19 offset:4096
    ds_read_b64_tr_b16 v[190:191], v19 offset:4608
    ds_read_b64_tr_b16 v[192:193], v20 offset:4096
    ds_read_b64_tr_b16 v[194:195], v20 offset:4608
    ds_read_b64_tr_b16 v[196:197], v21 offset:4096
    ds_read_b64_tr_b16 v[198:199], v21 offset:4608
    s_waitcnt lgkmcnt(0)
    s_waitcnt vmcnt(26)
    s_barrier
    s_add_u32 m0, s72, 4096
    s_add_u32 s17, s70, 393216
    buffer_load_dwordx4 v12, s[28:31], s17 offen lds
    s_add_u32 m0, m0, 1024
    s_add_u32 s17, s70, 425984
    buffer_load_dwordx4 v13, s[28:31], s17 offen lds
    s_add_u32 m0, m0, 1024
    s_add_u32 s17, s70, 458752
    buffer_load_dwordx4 v14, s[28:31], s17 offen lds
    s_add_u32 m0, m0, 1024
    s_add_u32 s17, s70, 491520
    buffer_load_dwordx4 v15, s[28:31], s17 offen lds
    ds_read_b64_tr_b16 v[88:89], v18 offset:8192
    ds_read_b64_tr_b16 v[90:91], v18 offset:8704
    ds_read_b64_tr_b16 v[92:93], v19 offset:8192
    ds_read_b64_tr_b16 v[94:95], v19 offset:8704
    ds_read_b64_tr_b16 v[96:97], v20 offset:8192
    ds_read_b64_tr_b16 v[98:99], v20 offset:8704
    ds_read_b64_tr_b16 v[100:101], v21 offset:8192
    ds_read_b64_tr_b16 v[102:103], v21 offset:8704
    s_waitcnt lgkmcnt(0)
    s_waitcnt vmcnt(26)
    s_barrier
    s_add_u32 m0, s72, 8192
    s_add_u32 s17, s70, 524288
    buffer_load_dwordx4 v12, s[24:27], s17 offen lds
    s_add_u32 m0, m0, 1024
    s_add_u32 s17, s70, 557056
    buffer_load_dwordx4 v13, s[24:27], s17 offen lds
    s_add_u32 m0, m0, 1024
    s_add_u32 s17, s70, 589824
    buffer_load_dwordx4 v14, s[24:27], s17 offen lds
    s_add_u32 m0, m0, 1024
    s_add_u32 s17, s70, 622592
    buffer_load_dwordx4 v15, s[24:27], s17 offen lds
    ds_read_b64_tr_b16 v[200:201], v18 offset:12288
    ds_read_b64_tr_b16 v[202:203], v18 offset:12800
    ds_read_b64_tr_b16 v[204:205], v19 offset:12288
    ds_read_b64_tr_b16 v[206:207], v19 offset:12800
    ds_read_b64_tr_b16 v[208:209], v20 offset:12288
    ds_read_b64_tr_b16 v[210:211], v20 offset:12800
    ds_read_b64_tr_b16 v[212:213], v21 offset:12288
    ds_read_b64_tr_b16 v[214:215], v21 offset:12800
    s_waitcnt lgkmcnt(0)
    s_waitcnt vmcnt(26)
    s_barrier
    s_add_u32 m0, s72, 12288
    s_add_u32 s17, s70, 524288
    buffer_load_dwordx4 v12, s[28:31], s17 offen lds
    s_add_u32 m0, m0, 1024
    s_add_u32 s17, s70, 557056
    buffer_load_dwordx4 v13, s[28:31], s17 offen lds
    s_add_u32 m0, m0, 1024
    s_add_u32 s17, s70, 589824
    buffer_load_dwordx4 v14, s[28:31], s17 offen lds
    s_add_u32 m0, m0, 1024
    s_add_u32 s17, s70, 622592
    buffer_load_dwordx4 v15, s[28:31], s17 offen lds
    ds_read_b64_tr_b16 a[72:73], v18 offset:16384
    ds_read_b64_tr_b16 a[74:75], v18 offset:16896
    ds_read_b64_tr_b16 a[76:77], v19 offset:16384
    ds_read_b64_tr_b16 a[78:79], v19 offset:16896
    ds_read_b64_tr_b16 a[80:81], v20 offset:16384
    ds_read_b64_tr_b16 a[82:83], v20 offset:16896
    ds_read_b64_tr_b16 a[84:85], v21 offset:16384
    ds_read_b64_tr_b16 a[86:87], v21 offset:16896
    s_waitcnt lgkmcnt(0)
    s_waitcnt vmcnt(26)
    s_barrier
    s_add_u32 m0, s72, 16384
    s_add_u32 s17, s70, 655360
    buffer_load_dwordx4 v12, s[20:23], s17 offen lds
    s_add_u32 m0, m0, 1024
    s_add_u32 s17, s70, 688128
    buffer_load_dwordx4 v13, s[20:23], s17 offen lds
    s_add_u32 m0, m0, 1024
    s_add_u32 s17, s70, 720896
    buffer_load_dwordx4 v14, s[20:23], s17 offen lds
    s_add_u32 m0, m0, 1024
    s_add_u32 s17, s70, 753664
    buffer_load_dwordx4 v15, s[20:23], s17 offen lds
    ds_read_b64_tr_b16 v[104:105], v18 offset:20480
    ds_read_b64_tr_b16 v[106:107], v18 offset:20992
    ds_read_b64_tr_b16 v[108:109], v19 offset:20480
    ds_read_b64_tr_b16 v[110:111], v19 offset:20992
    ds_read_b64_tr_b16 v[112:113], v20 offset:20480
    ds_read_b64_tr_b16 v[114:115], v20 offset:20992
    ds_read_b64_tr_b16 v[116:117], v21 offset:20480
    ds_read_b64_tr_b16 v[118:119], v21 offset:20992
    s_waitcnt lgkmcnt(0)
    s_waitcnt vmcnt(26)
    s_barrier
    s_add_u32 m0, s72, 20480
    s_add_u32 s17, s70, 655360
    buffer_load_dwordx4 v12, s[24:27], s17 offen lds
    s_add_u32 m0, m0, 1024
    s_add_u32 s17, s70, 688128
    buffer_load_dwordx4 v13, s[24:27], s17 offen lds
    s_add_u32 m0, m0, 1024
    s_add_u32 s17, s70, 720896
    buffer_load_dwordx4 v14, s[24:27], s17 offen lds
    s_add_u32 m0, m0, 1024
    s_add_u32 s17, s70, 753664
    buffer_load_dwordx4 v15, s[24:27], s17 offen lds
    ds_read_b64_tr_b16 v[216:217], v18 offset:24576
    ds_read_b64_tr_b16 v[218:219], v18 offset:25088
    ds_read_b64_tr_b16 v[220:221], v19 offset:24576
    ds_read_b64_tr_b16 v[222:223], v19 offset:25088
    ds_read_b64_tr_b16 v[224:225], v20 offset:24576
    ds_read_b64_tr_b16 v[226:227], v20 offset:25088
    ds_read_b64_tr_b16 v[228:229], v21 offset:24576
    ds_read_b64_tr_b16 v[230:231], v21 offset:25088
    s_waitcnt lgkmcnt(0)
    s_waitcnt vmcnt(26)
    s_barrier
    s_add_u32 m0, s72, 24576
    s_add_u32 s17, s70, 655360
    buffer_load_dwordx4 v12, s[28:31], s17 offen lds
    s_add_u32 m0, m0, 1024
    s_add_u32 s17, s70, 688128
    buffer_load_dwordx4 v13, s[28:31], s17 offen lds
    s_add_u32 m0, m0, 1024
    s_add_u32 s17, s70, 720896
    buffer_load_dwordx4 v14, s[28:31], s17 offen lds
    s_add_u32 m0, m0, 1024
    s_add_u32 s17, s70, 753664
    buffer_load_dwordx4 v15, s[28:31], s17 offen lds
    ds_read_b64_tr_b16 v[120:121], v18 offset:28672
    ds_read_b64_tr_b16 v[122:123], v18 offset:29184
    ds_read_b64_tr_b16 v[124:125], v19 offset:28672
    ds_read_b64_tr_b16 v[126:127], v19 offset:29184
    ds_read_b64_tr_b16 v[128:129], v20 offset:28672
    ds_read_b64_tr_b16 v[130:131], v20 offset:29184
    ds_read_b64_tr_b16 v[132:133], v21 offset:28672
    ds_read_b64_tr_b16 v[134:135], v21 offset:29184
    s_waitcnt lgkmcnt(0)
    s_waitcnt vmcnt(24)
    s_barrier
    s_add_u32 m0, s72, 28672
    s_add_u32 s17, s70, 786432
    buffer_load_dwordx4 v12, s[24:27], s17 offen lds
    s_add_u32 m0, m0, 1024
    s_add_u32 s17, s70, 819200
    buffer_load_dwordx4 v13, s[24:27], s17 offen lds
    s_add_u32 m0, m0, 1024
    s_add_u32 s17, s70, 851968
    buffer_load_dwordx4 v14, s[24:27], s17 offen lds
    s_add_u32 m0, m0, 1024
    s_add_u32 s17, s70, 884736
    buffer_load_dwordx4 v15, s[24:27], s17 offen lds
    ds_read_b64_tr_b16 v[232:233], v18 offset:0
    ds_read_b64_tr_b16 v[234:235], v18 offset:512
    ds_read_b64_tr_b16 v[236:237], v19 offset:0
    ds_read_b64_tr_b16 v[238:239], v19 offset:512
    ds_read_b64_tr_b16 v[240:241], v20 offset:0
    ds_read_b64_tr_b16 v[242:243], v20 offset:512
    ds_read_b64_tr_b16 v[244:245], v21 offset:0
    ds_read_b64_tr_b16 v[246:247], v21 offset:512
    s_waitcnt lgkmcnt(0)
    s_waitcnt vmcnt(24)
    s_barrier
    s_add_u32 m0, s72, 0
    s_add_u32 s17, s70, 786432
    buffer_load_dwordx4 v12, s[28:31], s17 offen lds
    s_add_u32 m0, m0, 1024
    s_add_u32 s17, s70, 819200
    buffer_load_dwordx4 v13, s[28:31], s17 offen lds
    s_add_u32 m0, m0, 1024
    s_add_u32 s17, s70, 851968
    buffer_load_dwordx4 v14, s[28:31], s17 offen lds
    s_add_u32 m0, m0, 1024
    s_add_u32 s17, s70, 884736
    buffer_load_dwordx4 v15, s[28:31], s17 offen lds
    ds_read_b64_tr_b16 a[88:89], v18 offset:4096
    ds_read_b64_tr_b16 a[90:91], v18 offset:4608
    ds_read_b64_tr_b16 a[92:93], v19 offset:4096
    ds_read_b64_tr_b16 a[94:95], v19 offset:4608
    ds_read_b64_tr_b16 a[96:97], v20 offset:4096
    ds_read_b64_tr_b16 a[98:99], v20 offset:4608
    ds_read_b64_tr_b16 a[100:101], v21 offset:4096
    ds_read_b64_tr_b16 a[102:103], v21 offset:4608
    s_waitcnt lgkmcnt(0)
    s_waitcnt vmcnt(24)
    s_barrier
    s_add_u32 m0, s72, 4096
    s_add_u32 s17, s70, 917504
    buffer_load_dwordx4 v12, s[20:23], s17 offen lds
    s_add_u32 m0, m0, 1024
    s_add_u32 s17, s70, 950272
    buffer_load_dwordx4 v13, s[20:23], s17 offen lds
    s_add_u32 m0, m0, 1024
    s_add_u32 s17, s70, 983040
    buffer_load_dwordx4 v14, s[20:23], s17 offen lds
    s_add_u32 m0, m0, 1024
    s_add_u32 s17, s70, 1015808
    buffer_load_dwordx4 v15, s[20:23], s17 offen lds
    ds_read_b64_tr_b16 v[248:249], v18 offset:8192
    ds_read_b64_tr_b16 v[250:251], v18 offset:8704
    ds_read_b64_tr_b16 v[252:253], v19 offset:8192
    ds_read_b64_tr_b16 v[254:255], v19 offset:8704
    ds_read_b64_tr_b16 a[0:1], v20 offset:8192
    ds_read_b64_tr_b16 a[2:3], v20 offset:8704
    ds_read_b64_tr_b16 a[4:5], v21 offset:8192
    ds_read_b64_tr_b16 a[6:7], v21 offset:8704
    s_waitcnt lgkmcnt(0)
    s_waitcnt vmcnt(24)
    s_barrier
    s_add_u32 m0, s72, 8192
    s_add_u32 s17, s70, 917504
    buffer_load_dwordx4 v12, s[24:27], s17 offen lds
    s_add_u32 m0, m0, 1024
    s_add_u32 s17, s70, 950272
    buffer_load_dwordx4 v13, s[24:27], s17 offen lds
    s_add_u32 m0, m0, 1024
    s_add_u32 s17, s70, 983040
    buffer_load_dwordx4 v14, s[24:27], s17 offen lds
    s_add_u32 m0, m0, 1024
    s_add_u32 s17, s70, 1015808
    buffer_load_dwordx4 v15, s[24:27], s17 offen lds
    ds_read_b64_tr_b16 a[104:105], v18 offset:12288
    ds_read_b64_tr_b16 a[106:107], v18 offset:12800
    ds_read_b64_tr_b16 a[108:109], v19 offset:12288
    ds_read_b64_tr_b16 a[110:111], v19 offset:12800
    ds_read_b64_tr_b16 a[112:113], v20 offset:12288
    ds_read_b64_tr_b16 a[114:115], v20 offset:12800
    ds_read_b64_tr_b16 a[116:117], v21 offset:12288
    ds_read_b64_tr_b16 a[118:119], v21 offset:12800
    s_waitcnt lgkmcnt(0)
    s_waitcnt vmcnt(24)
    s_barrier
    s_add_u32 m0, s72, 12288
    s_add_u32 s17, s70, 917504
    buffer_load_dwordx4 v12, s[28:31], s17 offen lds
    s_add_u32 m0, m0, 1024
    s_add_u32 s17, s70, 950272
    buffer_load_dwordx4 v13, s[28:31], s17 offen lds
    s_add_u32 m0, m0, 1024
    s_add_u32 s17, s70, 983040
    buffer_load_dwordx4 v14, s[28:31], s17 offen lds
    s_add_u32 m0, m0, 1024
    s_add_u32 s17, s70, 1015808
    buffer_load_dwordx4 v15, s[28:31], s17 offen lds
    ds_read_b64_tr_b16 v[136:137], v18 offset:16384
    ds_read_b64_tr_b16 v[138:139], v18 offset:16896
    ds_read_b64_tr_b16 v[140:141], v19 offset:16384
    ds_read_b64_tr_b16 v[142:143], v19 offset:16896
    ds_read_b64_tr_b16 v[144:145], v20 offset:16384
    ds_read_b64_tr_b16 v[146:147], v20 offset:16896
    ds_read_b64_tr_b16 v[148:149], v21 offset:16384
    ds_read_b64_tr_b16 v[150:151], v21 offset:16896
    s_waitcnt lgkmcnt(0)
    s_add_u32 s17, s32, s14
    s_cmp_lg_u32 s17, 0
    s_cbranch_scc1 Lr_nold
    v_mov_b32 v63, 48
    v_mov_b32 v64, 1
    s_mov_b64 exec, 1
    global_atomic_add v63, v64, s[12:13]
    s_mov_b64 exec, -1
Lr_nold:
    s_waitcnt vmcnt(24)
    s_barrier
    s_add_u32 m0, s72, 16384
    s_add_u32 s17, s70, 1048576
    buffer_load_dwordx4 v12, s[20:23], s17 offen lds
    s_add_u32 m0, m0, 1024
    s_add_u32 s17, s70, 1081344
    buffer_load_dwordx4 v13, s[20:23], s17 offen lds
    s_add_u32 m0, m0, 1024
    s_add_u32 s17, s70, 1114112
    buffer_load_dwordx4 v14, s[20:23], s17 offen lds
    s_add_u32 m0, m0, 1024
    s_add_u32 s17, s70, 1146880
    buffer_load_dwordx4 v15, s[20:23], s17 offen lds
    ds_read_b64_tr_b16 a[8:9], v18 offset:20480
    ds_read_b64_tr_b16 a[10:11], v18 offset:20992
    ds_read_b64_tr_b16 a[12:13], v19 offset:20480
    ds_read_b64_tr_b16 a[14:15], v19 offset:20992
    ds_read_b64_tr_b16 a[16:17], v20 offset:20480
    ds_read_b64_tr_b16 a[18:19], v20 offset:20992
    ds_read_b64_tr_b16 a[20:21], v21 offset:20480
    ds_read_b64_tr_b16 a[22:23], v21 offset:20992
    s_waitcnt lgkmcnt(0)
    s_waitcnt vmcnt(24)
    s_barrier
    s_add_u32 m0, s72, 20480
    s_add_u32 s17, s70, 1048576
    buffer_load_dwordx4 v12, s[24:27], s17 offen lds
    s_add_u32 m0, m0, 1024
    s_add_u32 s17, s70, 1081344
    buffer_load_dwordx4 v13, s[24:27], s17 offen lds
    s_add_u32 m0, m0, 1024
    s_add_u32 s17, s70, 1114112
    buffer_load_dwordx4 v14, s[24:27], s17 offen lds
    s_add_u32 m0, m0, 1024
    s_add_u32 s17, s70, 1146880
    buffer_load_dwordx4 v15, s[24:27], s17 offen lds
    ds_read_b64_tr_b16 a[120:121], v18 offset:24576
    ds_read_b64_tr_b16 a[122:123], v18 offset:25088
    ds_read_b64_tr_b16 a[124:125], v19 offset:24576
    ds_read_b64_tr_b16 a[126:127], v19 offset:25088
    ds_read_b64_tr_b16 a[128:129], v20 offset:24576
    ds_read_b64_tr_b16 a[130:131], v20 offset:25088
    ds_read_b64_tr_b16 a[132:133], v21 offset:24576
    ds_read_b64_tr_b16 a[134:135], v21 offset:25088
    s_waitcnt lgkmcnt(0)
    s_waitcnt vmcnt(24)
    s_barrier
    s_add_u32 m0, s72, 24576
    s_add_u32 s17, s70, 1048576
    buffer_load_dwordx4 v12, s[28:31], s17 offen lds
    s_add_u32 m0, m0, 1024
    s_add_u32 s17, s70, 1081344
    buffer_load_dwordx4 v13, s[28:31], s17 offen lds
    s_add_u32 m0, m0, 1024
    s_add_u32 s17, s70, 1114112
    buffer_load_dwordx4 v14, s[28:31], s17 offen lds
    s_add_u32 m0, m0, 1024
    s_add_u32 s17, s70, 1146880
    buffer_load_dwordx4 v15, s[28:31], s17 offen lds
    ds_read_b64_tr_b16 a[24:25], v18 offset:28672
    ds_read_b64_tr_b16 a[26:27], v18 offset:29184
    ds_read_b64_tr_b16 a[28:29], v19 offset:28672
    ds_read_b64_tr_b16 a[30:31], v19 offset:29184
    ds_read_b64_tr_b16 a[32:33], v20 offset:28672
    ds_read_b64_tr_b16 a[34:35], v20 offset:29184
    ds_read_b64_tr_b16 a[36:37], v21 offset:28672
    ds_read_b64_tr_b16 a[38:39], v21 offset:29184
    s_waitcnt lgkmcnt(0)
    s_waitcnt vmcnt(24)
    s_barrier
    ds_read_b64_tr_b16 a[136:137], v18 offset:0
    ds_read_b64_tr_b16 a[138:139], v18 offset:512
    ds_read_b64_tr_b16 a[140:141], v19 offset:0
    ds_read_b64_tr_b16 a[142:143], v19 offset:512
    ds_read_b64_tr_b16 a[144:145], v20 offset:0
    ds_read_b64_tr_b16 a[146:147], v20 offset:512
    ds_read_b64_tr_b16 a[148:149], v21 offset:0
    ds_read_b64_tr_b16 a[150:151], v21 offset:512
    s_waitcnt lgkmcnt(0)
    s_waitcnt vmcnt(20)
    s_barrier
    s_add_u32 m0, s72, 0
    s_add_u32 s17, s70, 0
    buffer_load_dwordx4 v12, s[28:31], s17 offen lds
    s_add_u32 m0, m0, 1024
    s_add_u32 s17, s70, 32768
    buffer_load_dwordx4 v13, s[28:31], s17 offen lds
    s_add_u32 m0, m0, 1024
    s_add_u32 s17, s70, 65536
    buffer_load_dwordx4 v14, s[28:31], s17 offen lds
    s_add_u32 m0, m0, 1024
    s_add_u32 s17, s70, 98304
    buffer_load_dwordx4 v15, s[28:31], s17 offen lds
    ds_read_b64_tr_b16 v[152:153], v18 offset:4096
    ds_read_b64_tr_b16 v[154:155], v18 offset:4608
    ds_read_b64_tr_b16 v[156:157], v19 offset:4096
    ds_read_b64_tr_b16 v[158:159], v19 offset:4608
    ds_read_b64_tr_b16 v[160:161], v20 offset:4096
    ds_read_b64_tr_b16 v[162:163], v20 offset:4608
    ds_read_b64_tr_b16 v[164:165], v21 offset:4096
    ds_read_b64_tr_b16 v[166:167], v21 offset:4608
    s_waitcnt lgkmcnt(0)
    s_waitcnt vmcnt(20)
    s_barrier
    s_add_u32 m0, s72, 4096
    s_add_u32 s17, s70, 262144
    buffer_load_dwordx4 v12, s[28:31], s17 offen lds
    s_add_u32 m0, m0, 1024
    s_add_u32 s17, s70, 294912
    buffer_load_dwordx4 v13, s[28:31], s17 offen lds
    s_add_u32 m0, m0, 1024
    s_add_u32 s17, s70, 327680
    buffer_load_dwordx4 v14, s[28:31], s17 offen lds
    s_add_u32 m0, m0, 1024
    s_add_u32 s17, s70, 360448
    buffer_load_dwordx4 v15, s[28:31], s17 offen lds
    ds_read_b64_tr_b16 a[40:41], v18 offset:8192
    ds_read_b64_tr_b16 a[42:43], v18 offset:8704
    ds_read_b64_tr_b16 a[44:45], v19 offset:8192
    ds_read_b64_tr_b16 a[46:47], v19 offset:8704
    ds_read_b64_tr_b16 a[48:49], v20 offset:8192
    ds_read_b64_tr_b16 a[50:51], v20 offset:8704
    ds_read_b64_tr_b16 a[52:53], v21 offset:8192
    ds_read_b64_tr_b16 a[54:55], v21 offset:8704
    s_waitcnt lgkmcnt(0)
    s_waitcnt vmcnt(20)
    s_barrier
    s_add_u32 m0, s72, 8192
    s_add_u32 s17, s70, 524288
    buffer_load_dwordx4 v12, s[20:23], s17 offen lds
    s_add_u32 m0, m0, 1024
    s_add_u32 s17, s70, 557056
    buffer_load_dwordx4 v13, s[20:23], s17 offen lds
    s_add_u32 m0, m0, 1024
    s_add_u32 s17, s70, 589824
    buffer_load_dwordx4 v14, s[20:23], s17 offen lds
    s_add_u32 m0, m0, 1024
    s_add_u32 s17, s70, 622592
    buffer_load_dwordx4 v15, s[20:23], s17 offen lds
    ds_read_b64_tr_b16 a[152:153], v18 offset:12288
    ds_read_b64_tr_b16 a[154:155], v18 offset:12800
    ds_read_b64_tr_b16 a[156:157], v19 offset:12288
    ds_read_b64_tr_b16 a[158:159], v19 offset:12800
    ds_read_b64_tr_b16 a[160:161], v20 offset:12288
    ds_read_b64_tr_b16 a[162:163], v20 offset:12800
    ds_read_b64_tr_b16 a[164:165], v21 offset:12288
    ds_read_b64_tr_b16 a[166:167], v21 offset:12800
    s_waitcnt lgkmcnt(0)
    s_waitcnt vmcnt(20)
    s_barrier
    s_add_u32 m0, s72, 12288
    s_add_u32 s17, s70, 786432
    buffer_load_dwordx4 v12, s[20:23], s17 offen lds
    s_add_u32 m0, m0, 1024
    s_add_u32 s17, s70, 819200
    buffer_load_dwordx4 v13, s[20:23], s17 offen lds
    s_add_u32 m0, m0, 1024
    s_add_u32 s17, s70, 851968
    buffer_load_dwordx4 v14, s[20:23], s17 offen lds
    s_add_u32 m0, m0, 1024
    s_add_u32 s17, s70, 884736
    buffer_load_dwordx4 v15, s[20:23], s17 offen lds
    ds_read_b64_tr_b16 v[168:169], v18 offset:16384
    ds_read_b64_tr_b16 v[170:171], v18 offset:16896
    ds_read_b64_tr_b16 v[172:173], v19 offset:16384
    ds_read_b64_tr_b16 v[174:175], v19 offset:16896
    ds_read_b64_tr_b16 v[176:177], v20 offset:16384
    ds_read_b64_tr_b16 v[178:179], v20 offset:16896
    ds_read_b64_tr_b16 v[180:181], v21 offset:16384
    ds_read_b64_tr_b16 v[182:183], v21 offset:16896
    s_waitcnt lgkmcnt(0)
    s_waitcnt vmcnt(20)
    s_barrier
    s_add_u32 m0, s72, 16384
    s_add_u32 s17, s71, 0
    buffer_load_dwordx4 v16, s[76:79], s17 offen lds
    s_add_u32 m0, m0, 1024
    s_add_u32 s17, s71, 18432
    buffer_load_dwordx4 v16, s[76:79], s17 offen lds
    s_add_u32 m0, m0, 1024
    s_add_u32 s17, s71, 36864
    buffer_load_dwordx4 v16, s[76:79], s17 offen lds
    s_add_u32 m0, m0, 1024
    s_add_u32 s17, s71, 55296
    buffer_load_dwordx4 v16, s[76:79], s17 offen lds
    ds_read_b64_tr_b16 a[56:57], v18 offset:20480
    ds_read_b64_tr_b16 a[58:59], v18 offset:20992
    ds_read_b64_tr_b16 a[60:61], v19 offset:20480
    ds_read_b64_tr_b16 a[62:63], v19 offset:20992
    ds_read_b64_tr_b16 a[64:65], v20 offset:20480
    ds_read_b64_tr_b16 a[66:67], v20 offset:20992
    ds_read_b64_tr_b16 a[68:69], v21 offset:20480
    ds_read_b64_tr_b16 a[70:71], v21 offset:20992
    s_waitcnt lgkmcnt(0)
    s_waitcnt vmcnt(20)
    s_barrier
    s_add_u32 m0, s72, 20480
    s_add_u32 s17, s71, 73728
    buffer_load_dwordx4 v16, s[76:79], s17 offen lds
    s_add_u32 m0, m0, 1024
    s_add_u32 s17, s71, 92160
    buffer_load_dwordx4 v16, s[76:79], s17 offen lds
    s_add_u32 m0, m0, 1024
    s_add_u32 s17, s71, 110592
    buffer_load_dwordx4 v16, s[76:79], s17 offen lds
    s_add_u32 m0, m0, 1024
    s_add_u32 s17, s71, 129024
    buffer_load_dwordx4 v16, s[76:79], s17 offen lds
    ds_read_b64_tr_b16 a[168:169], v18 offset:24576
    ds_read_b64_tr_b16 a[170:171], v18 offset:25088
    ds_read_b64_tr_b16 a[172:173], v19 offset:24576
    ds_read_b64_tr_b16 a[174:175], v19 offset:25088
    ds_read_b64_tr_b16 a[176:177], v20 offset:24576
    ds_read_b64_tr_b16 a[178:179], v20 offset:25088
    ds_read_b64_tr_b16 a[180:181], v21 offset:24576
    ds_read_b64_tr_b16 a[182:183], v21 offset:25088
    s_waitcnt lgkmcnt(0)
    s_waitcnt vmcnt(20)
    s_barrier
    s_add_u32 m0, s72, 24576
    s_add_u32 s17, s71, 64
    buffer_load_dwordx4 v16, s[76:79], s17 offen lds
    s_add_u32 m0, m0, 1024
    s_add_u32 s17, s71, 18496
    buffer_load_dwordx4 v16, s[76:79], s17 offen lds
    s_add_u32 m0, m0, 1024
    s_add_u32 s17, s71, 36928
    buffer_load_dwordx4 v16, s[76:79], s17 offen lds
    s_add_u32 m0, m0, 1024
    s_add_u32 s17, s71, 55360
    buffer_load_dwordx4 v16, s[76:79], s17 offen lds
    s_add_u32 m0, s72, 28672
    s_add_u32 s17, s71, 73792
    buffer_load_dwordx4 v16, s[76:79], s17 offen lds
    s_add_u32 m0, m0, 1024
    s_add_u32 s17, s71, 92224
    buffer_load_dwordx4 v16, s[76:79], s17 offen lds
    s_add_u32 m0, m0, 1024
    s_add_u32 s17, s71, 110656
    buffer_load_dwordx4 v16, s[76:79], s17 offen lds
    s_add_u32 m0, m0, 1024
    s_add_u32 s17, s71, 129088
    buffer_load_dwordx4 v16, s[76:79], s17 offen lds
    ds_read_b64_tr_b16 v[24:25], v18 offset:0
    ds_read_b64_tr_b16 v[26:27], v18 offset:512
    ds_read_b64_tr_b16 v[28:29], v19 offset:0
    ds_read_b64_tr_b16 v[30:31], v19 offset:512
    ds_read_b64_tr_b16 v[32:33], v20 offset:0
    ds_read_b64_tr_b16 v[34:35], v20 offset:512
    ds_read_b64_tr_b16 v[36:37], v21 offset:0
    ds_read_b64_tr_b16 v[38:39], v21 offset:512
    s_waitcnt lgkmcnt(0)
    s_barrier
    ds_write_b128 v8, v[24:27] offset:0
    ds_write_b128 v8, v[28:31] offset:1024
    ds_write_b128 v8, v[32:35] offset:2048
    ds_write_b128 v8, v[36:39] offset:3072
    s_waitcnt lgkmcnt(0)
    s_waitcnt vmcnt(24)
    s_barrier
    ds_read_b64_tr_b16 v[24:25], v18 offset:4096
    ds_read_b64_tr_b16 v[26:27], v18 offset:4608
    ds_read_b64_tr_b16 v[28:29], v19 offset:4096
    ds_read_b64_tr_b16 v[30:31], v19 offset:4608
    ds_read_b64_tr_b16 v[32:33], v20 offset:4096
    ds_read_b64_tr_b16 v[34:35], v20 offset:4608
    ds_read_b64_tr_b16 v[36:37], v21 offset:4096
    ds_read_b64_tr_b16 v[38:39], v21 offset:4608
    s_waitcnt lgkmcnt(0)
    s_barrier
    ds_write_b128 v8, v[24:27] offset:4096
    ds_write_b128 v8, v[28:31] offset:5120
    ds_write_b128 v8, v[32:35] offset:6144
    ds_write_b128 v8, v[36:39] offset:7168
    s_waitcnt lgkmcnt(0)
    s_waitcnt vmcnt(20)
    s_barrier
    ds_read_b64_tr_b16 v[24:25], v18 offset:8192
    ds_read_b64_tr_b16 v[26:27], v18 offset:8704
    ds_read_b64_tr_b16 v[28:29], v19 offset:8192
    ds_read_b64_tr_b16 v[30:31], v19 offset:8704
    ds_read_b64_tr_b16 v[32:33], v20 offset:8192
    ds_read_b64_tr_b16 v[34:35], v20 offset:8704
    ds_read_b64_tr_b16 v[36:37], v21 offset:8192
    ds_read_b64_tr_b16 v[38:39], v21 offset:8704
    s_waitcnt lgkmcnt(0)
    s_barrier
    ds_write_b128 v8, v[24:27] offset:8192
    ds_write_b128 v8, v[28:31] offset:9216
    ds_write_b128 v8, v[32:35] offset:10240
    ds_write_b128 v8, v[36:39] offset:11264
    s_waitcnt lgkmcnt(0)
    s_waitcnt vmcnt(16)
    s_barrier
    ds_read_b64_tr_b16 v[24:25], v18 offset:12288
    ds_read_b64_tr_b16 v[26:27], v18 offset:12800
    ds_read_b64_tr_b16 v[28:29], v19 offset:12288
    ds_read_b64_tr_b16 v[30:31], v19 offset:12800
    ds_read_b64_tr_b16 v[32:33], v20 offset:12288
    ds_read_b64_tr_b16 v[34:35], v20 offset:12800
    ds_read_b64_tr_b16 v[36:37], v21 offset:12288
    ds_read_b64_tr_b16 v[38:39], v21 offset:12800
    s_waitcnt lgkmcnt(0)
    s_barrier
    ds_write_b128 v8, v[24:27] offset:12288
    ds_write_b128 v8, v[28:31] offset:13312
    ds_write_b128 v8, v[32:35] offset:14336
    ds_write_b128 v8, v[36:39] offset:15360
    s_waitcnt lgkmcnt(0)
    s_barrier
    s_waitcnt vmcnt(12)
    ds_read_b64_tr_b16 a[184:185], v22 offset:16384
    ds_read_b64_tr_b16 a[186:187], v22 offset:16448
    ds_read_b64_tr_b16 a[188:189], v22 offset:18432
    ds_read_b64_tr_b16 a[190:191], v22 offset:18496
    ds_read_b64_tr_b16 a[200:201], v22 offset:16416
    ds_read_b64_tr_b16 a[202:203], v22 offset:16480
    ds_read_b64_tr_b16 a[204:205], v22 offset:18464
    ds_read_b64_tr_b16 a[206:207], v22 offset:18528
    s_waitcnt lgkmcnt(0)
    s_add_u32 m0, s72, 16384
    s_add_u32 s17, s71, 128
    buffer_load_dwordx4 v16, s[76:79], s17 offen lds
    s_add_u32 m0, m0, 1024
    s_add_u32 s17, s71, 18560
    buffer_load_dwordx4 v16, s[76:79], s17 offen lds
    s_add_u32 m0, m0, 1024
    s_add_u32 s17, s71, 36992
    buffer_load_dwordx4 v16, s[76:79], s17 offen lds
    s_add_u32 m0, m0, 1024
    s_add_u32 s17, s71, 55424
    buffer_load_dwordx4 v16, s[76:79], s17 offen lds
    s_waitcnt vmcnt(12)
    ds_read_b64_tr_b16 a[192:193], v22 offset:20480
    ds_read_b64_tr_b16 a[194:195], v22 offset:20544
    ds_read_b64_tr_b16 a[196:197], v22 offset:22528
    ds_read_b64_tr_b16 a[198:199], v22 offset:22592
    ds_read_b64_tr_b16 a[208:209], v22 offset:20512
    ds_read_b64_tr_b16 a[210:211], v22 offset:20576
    ds_read_b64_tr_b16 a[212:213], v22 offset:22560
    ds_read_b64_tr_b16 a[214:215], v22 offset:22624
    s_waitcnt lgkmcnt(0)
    s_add_u32 m0, s72, 20480
    s_add_u32 s17, s71, 73856
    buffer_load_dwordx4 v16, s[76:79], s17 offen lds
    s_add_u32 m0, m0, 1024
    s_add_u32 s17, s71, 92288
    buffer_load_dwordx4 v16, s[76:79], s17 offen lds
    s_add_u32 m0, m0, 1024
    s_add_u32 s17, s71, 110720
    buffer_load_dwordx4 v16, s[76:79], s17 offen lds
    s_add_u32 m0, m0, 1024
    s_add_u32 s17, s71, 129152
    buffer_load_dwordx4 v16, s[76:79], s17 offen lds
    s_waitcnt vmcnt(12)
    ds_read_b64_tr_b16 a[216:217], v22 offset:24576
    ds_read_b64_tr_b16 a[218:219], v22 offset:24640
    ds_read_b64_tr_b16 a[220:221], v22 offset:26624
    ds_read_b64_tr_b16 a[222:223], v22 offset:26688
    ds_read_b64_tr_b16 a[232:233], v22 offset:24608
    ds_read_b64_tr_b16 a[234:235], v22 offset:24672
    ds_read_b64_tr_b16 a[236:237], v22 offset:26656
    ds_read_b64_tr_b16 a[238:239], v22 offset:26720
    s_waitcnt lgkmcnt(0)
    s_add_u32 m0, s72, 24576
    s_add_u32 s17, s71, 192
    buffer_load_dwordx4 v16, s[76:79], s17 offen lds
    s_add_u32 m0, m0, 1024
    s_add_u32 s17, s71, 18624
    buffer_load_dwordx4 v16, s[76:79], s17 offen lds
    s_add_u32 m0, m0, 1024
    s_add_u32 s17, s71, 37056
    buffer_load_dwordx4 v16, s[76:79], s17 offen lds
    s_add_u32 m0, m0, 1024
    s_add_u32 s17, s71, 55488
    buffer_load_dwordx4 v16, s[76:79], s17 offen lds
    s_waitcnt vmcnt(12)
    ds_read_b64_tr_b16 a[224:225], v22 offset:28672
    ds_read_b64_tr_b16 a[226:227], v22 offset:28736
    ds_read_b64_tr_b16 a[228:229], v22 offset:30720
    ds_read_b64_tr_b16 a[230:231], v22 offset:30784
    ds_read_b64_tr_b16 a[240:241], v22 offset:28704
    ds_read_b64_tr_b16 a[242:243], v22 offset:28768
    ds_read_b64_tr_b16 a[244:245], v22 offset:30752
    ds_read_b64_tr_b16 a[246:247], v22 offset:30816
    s_waitcnt lgkmcnt(0)
    s_add_u32 m0, s72, 28672
    s_add_u32 s17, s71, 73920
    buffer_load_dwordx4 v16, s[76:79], s17 offen lds
    s_add_u32 m0, m0, 1024
    s_add_u32 s17, s71, 92352
    buffer_load_dwordx4 v16, s[76:79], s17 offen lds
    s_add_u32 m0, m0, 1024
    s_add_u32 s17, s71, 110784
    buffer_load_dwordx4 v16, s[76:79], s17 offen lds
    s_add_u32 m0, m0, 1024
    s_add_u32 s17, s71, 129216
    buffer_load_dwordx4 v16, s[76:79], s17 offen lds
    s_waitcnt vmcnt(63)
    ds_read_b64_tr_b16 a[248:249], v23 offset:32768
    ds_read_b64_tr_b16 a[250:251], v23 offset:32800
    ds_read_b64_tr_b16 a[252:253], v23 offset:33792
    ds_read_b64_tr_b16 a[254:255], v23 offset:33824
    s_waitcnt lgkmcnt(0)
    s_add_u32 m0, s72, 32768
    s_add_u32 s17, s71, 73984
    buffer_load_dwordx4 v17, s[76:79], s17 offen lds
    s_add_u32 m0, m0, 1024
    s_add_u32 s17, s71, 110848
    buffer_load_dwordx4 v17, s[76:79], s17 offen lds
    s_waitcnt vmcnt(14)
    ds_read_b64_tr_b16 v[24:25], v22 offset:16384
    ds_read_b64_tr_b16 v[26:27], v22 offset:16448
    ds_read_b64_tr_b16 v[28:29], v22 offset:18432
    ds_read_b64_tr_b16 v[30:31], v22 offset:18496
    ds_read_b64_tr_b16 v[32:33], v22 offset:16416
    ds_read_b64_tr_b16 v[34:35], v22 offset:16480
    ds_read_b64_tr_b16 v[36:37], v22 offset:18464
    ds_read_b64_tr_b16 v[38:39], v22 offset:18528
    s_waitcnt lgkmcnt(0)
    ds_write_b128 v8, v[24:27] offset:16384
    ds_write_b128 v8, v[28:31] offset:17408
    ds_write_b128 v8, v[32:35] offset:18432
    ds_write_b128 v8, v[36:39] offset:19456
    s_waitcnt lgkmcnt(0)
    s_waitcnt vmcnt(10)
    ds_read_b64_tr_b16 v[24:25], v22 offset:20480
    ds_read_b64_tr_b16 v[26:27], v22 offset:20544
    ds_read_b64_tr_b16 v[28:29], v22 offset:22528
    ds_read_b64_tr_b16 v[30:31], v22 offset:22592
    ds_read_b64_tr_b16 v[32:33], v22 offset:20512
    ds_read_b64_tr_b16 v[34:35], v22 offset:20576
    ds_read_b64_tr_b16 v[36:37], v22 offset:22560
    ds_read_b64_tr_b16 v[38:39], v22 offset:22624
    s_waitcnt lgkmcnt(0)
    ds_write_b128 v8, v[24:27] offset:20480
    ds_write_b128 v8, v[28:31] offset:21504
    ds_write_b128 v8, v[32:35] offset:22528
    ds_write_b128 v8, v[36:39] offset:23552
    s_waitcnt lgkmcnt(0)
    s_waitcnt vmcnt(6)
    ds_read_b64_tr_b16 v[24:25], v22 offset:24576
    ds_read_b64_tr_b16 v[26:27], v22 offset:24640
    ds_read_b64_tr_b16 v[28:29], v22 offset:26624
    ds_read_b64_tr_b16 v[30:31], v22 offset:26688
    ds_read_b64_tr_b16 v[32:33], v22 offset:24608
    ds_read_b64_tr_b16 v[34:35], v22 offset:24672
    ds_read_b64_tr_b16 v[36:37], v22 offset:26656
    ds_read_b64_tr_b16 v[38:39], v22 offset:26720
    s_waitcnt lgkmcnt(0)
    ds_write_b128 v8, v[24:27] offset:24576
    ds_write_b128 v8, v[28:31] offset:25600
    ds_write_b128 v8, v[32:35] offset:26624
    ds_write_b128 v8, v[36:39] offset:27648
    s_waitcnt lgkmcnt(0)
    s_waitcnt vmcnt(2)
    ds_read_b64_tr_b16 v[24:25], v22 offset:28672
    ds_read_b64_tr_b16 v[26:27], v22 offset:28736
    ds_read_b64_tr_b16 v[28:29], v22 offset:30720
    ds_read_b64_tr_b16 v[30:31], v22 offset:30784
    ds_read_b64_tr_b16 v[32:33], v22 offset:28704
    ds_read_b64_tr_b16 v[34:35], v22 offset:28768
    ds_read_b64_tr_b16 v[36:37], v22 offset:30752
    ds_read_b64_tr_b16 v[38:39], v22 offset:30816
    s_waitcnt lgkmcnt(0)
    ds_write_b128 v8, v[24:27] offset:28672
    ds_write_b128 v8, v[28:31] offset:29696
    ds_write_b128 v8, v[32:35] offset:30720
    ds_write_b128 v8, v[36:39] offset:31744
    s_waitcnt lgkmcnt(0)
    s_waitcnt vmcnt(0)
    ds_read_b64_tr_b16 v[24:25], v23 offset:32768
    ds_read_b64_tr_b16 v[26:27], v23 offset:32800
    ds_read_b64_tr_b16 v[28:29], v23 offset:33792
    ds_read_b64_tr_b16 v[30:31], v23 offset:33824
    s_waitcnt lgkmcnt(0)
    ds_write_b128 v8, v[24:27] offset:32768
    ds_write_b128 v8, v[28:31] offset:33792
    s_waitcnt lgkmcnt(0)
    v_bfe_u32 v9, v0, 4, 4
    v_mov_b32 v10, 0x3f80
    v_mov_b32 v16, 0x3f800000
    v_cmp_eq_u32 vcc, 0, v9
    v_cmp_eq_u32 s[48:49], 1, v9
    s_nop 0
    v_cndmask_b32 v12, 0, v10, vcc
    v_cndmask_b32 v12, v12, v16, s[48:49]
    v_cmp_eq_u32 vcc, 2, v9
    v_cmp_eq_u32 s[48:49], 3, v9
    s_nop 0
    v_cndmask_b32 v13, 0, v10, vcc
    v_cndmask_b32 v13, v13, v16, s[48:49]
    v_cmp_eq_u32 vcc, 4, v9
    v_cmp_eq_u32 s[48:49], 5, v9
    s_nop 0
    v_cndmask_b32 v14, 0, v10, vcc
    v_cndmask_b32 v14, v14, v16, s[48:49]
    v_cmp_eq_u32 vcc, 6, v9
    v_cmp_eq_u32 s[48:49], 7, v9
    s_nop 0
    v_cndmask_b32 v15, 0, v10, vcc
    v_cndmask_b32 v15, v15, v16, s[48:49]
    v_add_u32 v9, 162560, v0
    ds_write_b128 v9, v[12:15]
    s_waitcnt lgkmcnt(0)
    s_mov_b64 exec, 0xff
    v_lshrrev_b32 v14, 2, v0
    v_lshlrev_b32 v12, 5, v14
    v_and_b32 v12, 128, v12
    v_lshrrev_b32 v13, 1, v14
    v_and_or_b32 v12, v13, 12, v12
    s_mov_b32 s16, 0
L_pure:
    global_load_dword v13, v12, s[12:13] sc1
    s_add_u32 s16, s16, 1
    s_cmp_gt_u32 s16, 100000
    s_cbranch_scc1 Lr_abort
    s_mov_b32 s6, 0
    s_waitcnt vmcnt(0)
    v_readlane_b32 s7, v13, 0
    s_nop 0
    s_add_u32 s6, s6, s7
    v_readlane_b32 s7, v13, 1
    s_nop 0
    s_add_u32 s6, s6, s7
    v_readlane_b32 s7, v13, 2
    s_nop 0
    s_add_u32 s6, s6, s7
    v_readlane_b32 s7, v13, 3
    s_nop 0
    s_add_u32 s6, s6, s7
    v_readlane_b32 s7, v13, 4
    s_nop 0
    s_add_u32 s6, s6, s7
    v_readlane_b32 s7, v13, 5
    s_nop 0
    s_add_u32 s6, s6, s7
    v_readlane_b32 s7, v13, 6
    s_nop 0
    s_add_u32 s6, s6, s7
    v_readlane_b32 s7, v13, 7
    s_nop 0
    s_add_u32 s6, s6, s7
    v_readlane_b32 s7, v13, s32
    s_nop 0
    s_cmp_ge_u32 s7, 32
    s_cselect_b32 s51, 1, 0
    s_cselect_b32 s6, 256, s6
    s_cmp_lt_u32 s6, 256
    s_cbranch_scc1 L_pure
    s_mov_b64 exec, -1
    s_lshl_b32 s6, s32, 2
    s_add_u32 s6, s6, 192
    s_cmp_lg_u32 s14, 0
    s_cbranch_scc1 L_team_d
    v_mov_b32 v12, s6
    s_mov_b32 s16, 0
L_team:
    global_load_dword v13, v12, s[12:13] sc1
    s_add_u32 s16, s16, 1
    s_cmp_gt_u32 s16, 100000
    s_cbranch_scc1 Lr_abort
    s_waitcnt vmcnt(0)
    v_cmp_gt_u32 vcc, 32, v13
    s_nop 0
    s_cbranch_vccz L_team_d
    s_sleep 8
    s_branch L_team
L_team_d:
    s_barrier
    s_cmp_lg_u32 s14, 0
    s_cbranch_scc1 L_rpoola_d
    v_mov_b32 v12, 40
    s_mov_b32 s16, 0
L_rpoola:
    global_load_dword v13, v12, s[12:13] sc1
    s_add_u32 s16, s16, 1
    s_cmp_gt_u32 s16, 100000
    s_cbranch_scc1 Lr_abort
    s_waitcnt vmcnt(0)
    v_cmp_gt_u32 vcc, 72, v13
    s_nop 0
    s_cbranch_vccz L_rpoola_d
    s_sleep 8
    s_branch L_rpoola
L_rpoola_d:
    s_barrier
    s_cmp_eq_u32 s32, 0
    s_cbranch_scc1 L_rpool_skip
    s_cmp_lg_u32 s14, 0
    s_cbranch_scc1 L_rpool_d
    v_mov_b32 v12, 160
    s_mov_b32 s16, 0
L_rpool:
    global_load_dword v13, v12, s[12:13] sc1
    s_add_u32 s16, s16, 1
    s_cmp_gt_u32 s16, 100000
    s_cbranch_scc1 Lr_abort
    s_waitcnt vmcnt(0)
    v_cmp_gt_u32 vcc, 64, v13
    s_nop 0
    s_cbranch_vccz L_rpool_d
    s_sleep 8
    s_branch L_rpool
L_rpool_d:
    s_barrier
L_rpool_skip:
    s_barrier
    s_cmp_eq_u32 s51, 0
    s_cbranch_scc1 L_slow
    s_cmp_lg_u32 s14, 0
    s_cbranch_scc1 L_w1_1
    s_mov_b32 s16, 0
    s_add_u32 s17, s66, 128
    v_lshrrev_b32 v10, 2, v0
    v_and_b32 v9, 16, v10
    v_lshlrev_b32 v9, 3, v9
    v_and_or_b32 v10, v10, 12, v9
Lr0f_fw_10:
    buffer_load_dword v9, v10, s[8:11], s17 offen sc1
    s_add_u32 s16, s16, 1
    s_cmp_gt_u32 s16, 100000
    s_cbranch_scc1 Lr_abort
    s_waitcnt vmcnt(0)
    v_cmp_eq_u32 vcc, 0, v9
    s_nop 0
    s_cbranch_vccnz Lr0f_fw_10
    s_mov_b32 m0, 15104
    s_nop 0
    buffer_load_dwordx4 v0, s[8:11], s41 offen offset:0 lds
    buffer_load_dwordx4 v0, s[8:11], s41 offen offset:1024 lds
    s_add_u32 s41, s41, 262144
    s_add_u32 s68, s68, 4278452224
    s_waitcnt vmcnt(0)
    ds_read_b128 v[56:59], v8 offset:0
    ds_read_b128 v[60:63], v8 offset:1024
    ds_read_b128 v[64:67], v8 offset:2048
    ds_read_b128 v[68:71], v8 offset:3072
    v_mov_b64 v[12:13], 0
    v_mov_b64 v[14:15], 0
    v_mov_b64 v[16:17], 0
    v_mov_b64 v[18:19], 0
    v_mov_b64 v[20:21], 0
    v_mov_b64 v[22:23], 0
    v_mov_b64 v[24:25], 0
    v_mov_b64 v[26:27], 0
    v_mov_b64 v[28:29], 0
    v_mov_b64 v[30:31], 0
    v_mov_b64 v[32:33], 0
    v_mov_b64 v[34:35], 0
    buffer_load_dwordx4 v[36:39], v0, s[8:11], s34 offen sc1
    s_waitcnt vmcnt(0) lgkmcnt(0)
Lr0f_step:
    s_mov_b32 s16, 0
Lr0f_alp:
    s_waitcnt vmcnt(2)
    v_max3_u32 v10, v36, v37, v38
    v_max_u32 v10, v10, v39
    v_cmp_eq_u32 vcc, -1, v10
    s_nop 0
    s_cbranch_vccz Lr0f_aok
    buffer_load_dwordx4 v[36:39], v0, s[8:11], s34 offen sc1
    s_add_u32 s16, s16, 1
    s_cmp_gt_u32 s16, 100000
    s_cbranch_scc1 Lr_abort
    s_branch Lr0f_alp
Lr0f_aok:
    ds_write_b128 v0, v[36:39] offset:6912
    v_smfmac_f32_16x16x64_bf16 v[12:15], v[36:39], v[72:79], v1
    v_smfmac_f32_16x16x64_bf16 v[16:19], v[36:39], v[80:87], v1
    v_smfmac_f32_16x16x64_bf16 v[20:23], v[36:39], v[184:191], v1
    s_waitcnt lgkmcnt(0)
    s_barrier
    ds_read_b128 v[48:51], v0 offset:7936
    ds_read_b128 v[52:55], v0 offset:8960
    v_smfmac_f32_16x16x64_bf16 v[28:31], v[36:39], v[56:63], v1
    ds_read_b128 v[56:59], v8 offset:4096
    ds_read_b128 v[60:63], v8 offset:5120
    s_add_u32 s17, s34, 4096
    buffer_load_dwordx4 v[40:43], v0, s[8:11], s17 offen sc1
    v_smfmac_f32_16x16x64_bf16 v[24:27], v[36:39], v[192:199], v1
    v_smfmac_f32_16x16x64_bf16 v[32:35], v[36:39], v[64:71], v1
    ds_read_b128 v[64:67], v8 offset:6144
    ds_read_b128 v[68:71], v8 offset:7168
    s_waitcnt vmcnt(1)
    ds_read_b128 v[36:39], v0 offset:9984
    s_waitcnt lgkmcnt(6)
    v_smfmac_f32_16x16x64_bf16 v[28:31], v[48:51], a[72:79], v1
    v_smfmac_f32_16x16x64_bf16 v[12:15], v[48:51], v[88:95], v1
    buffer_load_dwordx4 v[44:47], v0, s[8:11], s35 offen sc1
    v_smfmac_f32_16x16x64_bf16 v[16:19], v[48:51], v[96:103], v1
    v_smfmac_f32_16x16x64_bf16 v[32:35], v[48:51], a[80:87], v1
    v_smfmac_f32_16x16x64_bf16 v[20:23], v[48:51], v[200:207], v1
    v_smfmac_f32_16x16x64_bf16 v[24:27], v[48:51], v[208:215], v1
    s_waitcnt lgkmcnt(3)
    v_smfmac_f32_16x16x64_bf16 v[28:31], v[52:55], v[56:63], v1
    ds_read_b128 v[56:59], v8 offset:8192
    ds_read_b128 v[60:63], v8 offset:9216
    v_smfmac_f32_16x16x64_bf16 v[12:15], v[52:55], v[104:111], v1
    v_smfmac_f32_16x16x64_bf16 v[16:19], v[52:55], v[112:119], v1
    s_waitcnt lgkmcnt(3)
    v_smfmac_f32_16x16x64_bf16 v[32:35], v[52:55], v[64:71], v1
    ds_read_b128 v[64:67], v8 offset:10240
    ds_read_b128 v[68:71], v8 offset:11264
    v_smfmac_f32_16x16x64_bf16 v[20:23], v[52:55], v[216:223], v1
    v_smfmac_f32_16x16x64_bf16 v[24:27], v[52:55], v[224:231], v1
    s_waitcnt lgkmcnt(4)
    v_smfmac_f32_16x16x64_bf16 v[28:31], v[36:39], a[88:95], v1
    v_smfmac_f32_16x16x64_bf16 v[12:15], v[36:39], v[120:127], v1
    v_smfmac_f32_16x16x64_bf16 v[16:19], v[36:39], v[128:135], v1
    v_smfmac_f32_16x16x64_bf16 v[32:35], v[36:39], a[96:103], v1
    v_smfmac_f32_16x16x64_bf16 v[20:23], v[36:39], v[232:239], v1
    v_smfmac_f32_16x16x64_bf16 v[24:27], v[36:39], v[240:247], v1
    s_waitcnt vmcnt(1)
    v_max3_u32 v10, v40, v41, v42
    v_max_u32 v10, v10, v43
    v_cmp_eq_u32 vcc, -1, v10
    s_nop 0
    s_cbranch_vccnz Lr0f_pb_re
Lr0f_pb_ok:
    ds_write_b128 v0, v[40:43] offset:11008
    s_waitcnt lgkmcnt(3)
    v_smfmac_f32_16x16x64_bf16 v[12:15], v[40:43], v[56:63], v1
    ds_read_b128 v[56:59], v8 offset:12288
    ds_read_b128 v[60:63], v8 offset:13312
    v_smfmac_f32_16x16x64_bf16 v[20:23], v[40:43], v[248:255], v1
    s_waitcnt lgkmcnt(3)
    v_smfmac_f32_16x16x64_bf16 v[16:19], v[40:43], v[64:71], v1
    ds_read_b128 v[64:67], v8 offset:14336
    ds_read_b128 v[68:71], v8 offset:15360
    v_smfmac_f32_16x16x64_bf16 v[24:27], v[40:43], a[0:7], v1
    s_waitcnt lgkmcnt(4)
    s_barrier
    ds_read_b128 v[48:51], v0 offset:13056
    ds_read_b128 v[52:55], v0 offset:12032
    ds_read_b128 v[36:39], v0 offset:14080
    v_smfmac_f32_16x16x64_bf16 v[28:31], v[40:43], a[104:111], v1
    v_smfmac_f32_16x16x64_bf16 v[32:35], v[40:43], a[112:119], v1
    s_waitcnt lgkmcnt(2)
    v_smfmac_f32_16x16x64_bf16 v[12:15], v[48:51], v[56:63], v1
    v_smfmac_f32_16x16x64_bf16 v[16:19], v[48:51], v[64:71], v1
    s_waitcnt lgkmcnt(1)
    v_smfmac_f32_16x16x64_bf16 v[12:15], v[52:55], v[136:143], v1
    v_smfmac_f32_16x16x64_bf16 v[16:19], v[52:55], v[144:151], v1
    s_waitcnt lgkmcnt(0)
    v_smfmac_f32_16x16x64_bf16 v[12:15], v[36:39], v[152:159], v1
    v_smfmac_f32_16x16x64_bf16 v[16:19], v[36:39], v[160:167], v1
    s_waitcnt vmcnt(0)
    v_max3_u32 v10, v44, v45, v46
    v_max_u32 v10, v10, v47
    v_cmp_eq_u32 vcc, -1, v10
    s_nop 0
    s_cbranch_vccnz Lr0f_pc_re
Lr0f_pc_ok:
    v_smfmac_f32_16x16x64_bf16 v[12:15], v[44:47], v[168:175], v1
    v_smfmac_f32_16x16x64_bf16 v[16:19], v[44:47], v[176:183], v1
    v_smfmac_f32_16x16x64_bf16 v[20:23], v[48:51], a[24:31], v1
    buffer_load_dwordx4 v[64:67], v0, s[8:11], s42 offen
    v_smfmac_f32_16x16x64_bf16 v[24:27], v[48:51], a[32:39], v1
    v_smfmac_f32_16x16x64_bf16 v[20:23], v[52:55], a[8:15], v1
    v_add_f32 v12, v12, v14
    v_smfmac_f32_16x16x64_bf16 v[24:27], v[52:55], a[16:23], v1
    v_add_f32 v16, v16, v18
    v_smfmac_f32_16x16x64_bf16 v[20:23], v[36:39], a[40:47], v1
    v_add_f32 v13, v13, v15
    buffer_load_dwordx4 v[68:71], v0, s[8:11], s42 offen offset:1024
    v_smfmac_f32_16x16x64_bf16 v[24:27], v[36:39], a[48:55], v1
    v_add_f32 v17, v17, v19
    v_smfmac_f32_16x16x64_bf16 v[20:23], v[44:47], a[56:63], v1
    v_cvt_pk_bf16_f32 v14, v12, v16
    ds_read_b128 v[56:59], v0 offset:15104
    v_smfmac_f32_16x16x64_bf16 v[24:27], v[44:47], a[64:71], v1
    v_cvt_pk_bf16_f32 v15, v13, v17
    ds_read_b128 v[60:63], v0 offset:16128
    ds_write_b32 v2, v14 offset:576
    ds_write_b32 v2, v15 offset:864
    v_smfmac_f32_16x16x64_bf16 v[28:31], v[48:51], a[136:143], v1
    v_smfmac_f32_16x16x64_bf16 v[32:35], v[48:51], a[144:151], v1
    v_add_f32 v20, v20, v22
    v_add_f32 v24, v24, v26
    v_add_f32 v21, v21, v23
    v_add_f32 v25, v25, v27
    v_cvt_pk_bf16_f32 v22, v20, v24
    v_cvt_pk_bf16_f32 v23, v21, v25
    ds_write_b32 v2, v22 offset:0
    ds_write_b32 v2, v23 offset:288
    v_smfmac_f32_16x16x64_bf16 v[28:31], v[52:55], a[120:127], v1
    v_smfmac_f32_16x16x64_bf16 v[32:35], v[52:55], a[128:135], v1
    s_waitcnt lgkmcnt(0)
    s_barrier
    ds_read_b128 v[40:43], v3 offset:0
    ds_read_b128 v[48:51], v3 offset:64
    ds_read_b128 v[20:23], v3 offset:128
    ds_read_b128 v[52:55], v3 offset:192
    v_smfmac_f32_16x16x64_bf16 v[28:31], v[36:39], a[152:159], v1
    v_smfmac_f32_16x16x64_bf16 v[32:35], v[36:39], a[160:167], v1
    ds_read_b128 v[36:39], v0 offset:17152
    v_lshlrev_b32 v9, 3, v0
    buffer_load_dword v11, v9, s[8:11], s68 offen
    v_smfmac_f32_16x16x64_bf16 v[28:31], v[44:47], a[168:175], v1
    v_smfmac_f32_16x16x64_bf16 v[32:35], v[44:47], a[176:183], v1
    ds_read_b128 v[44:47], v0 offset:18176
    s_waitcnt lgkmcnt(5)
    v_mfma_f32_16x16x32_bf16 v[12:15], v[56:59], v[40:43], 0
    v_mfma_f32_16x16x32_bf16 v[16:19], v[60:63], v[40:43], 0
    v_mfma_f32_16x16x32_bf16 v[24:27], v[40:43], v[40:43], 0
    ds_read_b128 v[56:59], v0 offset:19200
    ds_read_b128 v[60:63], v0 offset:20224
    s_waitcnt lgkmcnt(3)
    v_mfma_f32_16x16x32_bf16 v[12:15], v[36:39], v[48:51], v[12:15]
    v_lshrrev_b32 v10, 1, v0
    v_lshrrev_b32 v9, 9, v0
    s_waitcnt lgkmcnt(2)
    v_mfma_f32_16x16x32_bf16 v[16:19], v[44:47], v[48:51], v[16:19]
    v_lshl_add_u32 v9, v9, 5, v10
    v_add_f32 v28, v28, v30
    v_mfma_f32_16x16x32_bf16 v[24:27], v[48:51], v[48:51], v[24:27]
    v_add_f32 v32, v32, v34
    v_add_f32 v29, v29, v31
    ds_read_b128 v[36:39], v0 offset:21248
    ds_read_b128 v[44:47], v0 offset:22272
    s_waitcnt lgkmcnt(3)
    v_mfma_f32_16x16x32_bf16 v[12:15], v[56:59], v[20:23], v[12:15]
    v_add_f32 v33, v33, v35
    v_cvt_pk_bf16_f32 v30, v28, v29
    s_waitcnt lgkmcnt(2)
    v_mfma_f32_16x16x32_bf16 v[16:19], v[60:63], v[20:23], v[16:19]
    v_cvt_pk_bf16_f32 v31, v32, v33
    ds_read_b64 v[34:35], v9 offset:0
    v_mfma_f32_16x16x32_bf16 v[24:27], v[20:23], v[20:23], v[24:27]
    s_add_u32 s17, s43, 2048
    buffer_store_dwordx2 v[30:31], v10, s[8:11], s17 offen sc1
    s_waitcnt lgkmcnt(2)
    v_mfma_f32_16x16x32_bf16 v[12:15], v[36:39], v[52:55], v[12:15]
    s_waitcnt lgkmcnt(1)
    v_mfma_f32_16x16x32_bf16 v[16:19], v[44:47], v[52:55], v[16:19]
    v_mfma_f32_16x16x32_bf16 v[24:27], v[52:55], v[52:55], v[24:27]
    s_add_u32 s17, s43, 0
    s_waitcnt lgkmcnt(0)
    buffer_store_dwordx2 v[34:35], v10, s[8:11], s17 offen sc1
    ds_read_b128 v[56:59], v8 offset:16384
    ds_read_b128 v[60:63], v8 offset:17408
    v_mov_b64 v[20:21], s[52:53]
    v_mov_b64 v[22:23], s[52:53]
    v_mov_b32 v41, 0
    v_mov_b32 v42, 0
    v_max3_f32 v9, v12, v13, v14
    v_max3_f32 v9, v9, v15, v16
    v_max3_f32 v9, v9, v17, v18
    v_max3_f32 v9, v9, v19, v24
    v_max_f32 v9, v9, v25
    v_mov_b32 v10, v9
    v_mov_b64 v[32:33], 0
    v_mov_b64 v[34:35], 0
    v_permlane32_swap_b32 v9, v10
    v_max_f32 v9, v9, v10
    v_mov_b32 v10, v9
    s_nop 1
    v_permlane16_swap_b32 v9, v10
    v_max_f32 v9, v9, v10
    v_mul_f32 v28, s44, v9
    v_fma_f32 v12, v12, s44, -v28
    v_fma_f32 v13, v13, s44, -v28
    v_fma_f32 v14, v14, s44, -v28
    v_fma_f32 v15, v15, s44, -v28
    v_exp_f32 v12, v12
    v_exp_f32 v13, v13
    v_fma_f32 v16, v16, s44, -v28
    v_fma_f32 v17, v17, s44, -v28
    v_exp_f32 v14, v14
    v_exp_f32 v15, v15
    v_cvt_pk_bf16_f32 v36, v12, v13
    v_fma_f32 v18, v18, s44, -v28
    v_fma_f32 v19, v19, s44, -v28
    v_exp_f32 v16, v16
    v_exp_f32 v17, v17
    v_cvt_pk_bf16_f32 v37, v14, v15
    v_fma_f32 v24, v24, s44, -v28
    v_fma_f32 v25, v25, s44, -v28
    v_exp_f32 v18, v18
    v_exp_f32 v19, v19
    v_cvt_pk_bf16_f32 v38, v16, v17
    v_exp_f32 v24, v24
    v_exp_f32 v25, v25
    v_cvt_pk_bf16_f32 v39, v18, v19
    v_cvt_pk_bf16_f32 v40, v24, v25
    v_cvt_pk_bf16_f32 v43, v24, v25
    v_mfma_f32_16x16x32_bf16 v[52:55], v[20:23], v[36:39], 0
    v_mov_b64 v[12:13], 0
    v_mov_b64 v[14:15], 0
    s_waitcnt vmcnt(4)
    v_mfma_f32_16x16x32_bf16 v[44:47], v[64:67], v[36:39], 0
    v_mov_b64 v[24:25], 0
    v_mov_b64 v[26:27], 0
    s_waitcnt vmcnt(3)
    v_mfma_f32_16x16x32_bf16 v[48:51], v[68:71], v[36:39], 0
    ds_read_b128 v[64:67], v8 offset:20480
    ds_read_b128 v[68:71], v8 offset:21504
    v_mfma_f32_16x16x16_bf16 v[52:55], v[20:21], v[40:41], v[52:55]
    v_mfma_f32_16x16x16_bf16 v[44:47], v[30:31], v[40:41], v[44:47]
    v_mov_b64 v[20:21], 0
    v_mov_b64 v[22:23], 0
    v_mfma_f32_16x16x16_bf16 v[48:51], v[30:31], v[42:43], v[48:51]
    v_mov_b64 v[36:37], 0
    v_mov_b64 v[38:39], 0
    v_mov_b64 v[40:41], 0
    v_mov_b64 v[42:43], 0
    v_rcp_f32 v9, v52
    v_mov_b64 v[52:53], 0
    v_mov_b64 v[54:55], 0
    v_mul_f32 v44, v9, v44
    v_mul_f32 v48, v9, v48
    v_cvt_pk_bf16_f32 v16, v44, v48
    v_mul_f32 v45, v9, v45
    v_mul_f32 v49, v9, v49
    v_cvt_pk_bf16_f32 v17, v45, v49
    v_mul_f32 v46, v9, v46
    v_mul_f32 v50, v9, v50
    v_cvt_pk_bf16_f32 v18, v46, v50
    v_mul_f32 v47, v9, v47
    v_mul_f32 v51, v9, v51
    v_cvt_pk_bf16_f32 v19, v47, v51
    ds_write_b128 v5, v[16:19]
    v_mov_b64 v[28:29], 0
    v_mov_b64 v[30:31], 0
    s_waitcnt lgkmcnt(0)
    s_barrier
    ds_read_b128 v[44:47], v4 offset:0
    ds_read_b128 v[48:51], v4 offset:128
    s_cmp_eq_u32 s33, 63
    s_cbranch_scc1 Lr0f_last
    v_mov_b64 v[16:17], 0
    v_mov_b64 v[18:19], 0
    buffer_load_dwordx4 v0, s[8:11], s41 offen offset:0 lds
    buffer_load_dwordx4 v0, s[8:11], s41 offen offset:1024 lds
    s_waitcnt lgkmcnt(1)
    v_smfmac_f32_16x16x64_bf16 v[12:15], v[44:47], a[184:191], v1
    s_waitcnt lgkmcnt(0)
    v_smfmac_f32_16x16x64_bf16 v[12:15], v[48:51], a[192:199], v1
    v_smfmac_f32_16x16x64_bf16 v[24:27], v[44:47], a[200:207], v1
    v_smfmac_f32_16x16x64_bf16 v[24:27], v[48:51], a[208:215], v1
    v_add_f32 v12, v12, v14
    v_smfmac_f32_16x16x64_bf16 v[20:23], v[44:47], a[216:223], v1
    v_add_f32 v13, v13, v15
    v_smfmac_f32_16x16x64_bf16 v[20:23], v[48:51], a[224:231], v1
    v_cvt_pk_bf16_f32 v12, v12, v13
    v_smfmac_f32_16x16x64_bf16 v[16:19], v[44:47], a[232:239], v1
    v_add_f32 v24, v24, v26
    v_smfmac_f32_16x16x64_bf16 v[16:19], v[48:51], a[240:247], v1
    v_add_f32 v25, v25, v27
    v_smfmac_f32_16x16x64_bf16 v[36:39], v[44:47], v[56:63], v1
    v_cvt_pk_bf16_f32 v13, v24, v25
    v_smfmac_f32_16x16x64_bf16 v[36:39], v[48:51], v[64:71], v1
    v_add_f32 v20, v20, v22
    v_add_f32 v21, v21, v23
    v_cvt_pk_bf16_f32 v14, v20, v21
    v_add_f32 v16, v16, v18
    v_add_f32 v17, v17, v19
    v_cvt_pk_bf16_f32 v15, v16, v17
    v_and_or_b32 v15, v15, -2, s40
    buffer_store_dwordx4 v[12:15], v0, s[8:11], s38 offen
    s_nop 0
    ds_read_b128 v[12:15], v8 offset:18432
    ds_read_b128 v[16:19], v8 offset:19456
    ds_read_b128 v[20:23], v8 offset:22528
    ds_read_b128 v[24:27], v8 offset:23552
    ds_read_b128 v[56:59], v8 offset:24576
    ds_read_b128 v[60:63], v8 offset:25600
    ds_read_b128 v[64:67], v8 offset:28672
    ds_read_b128 v[68:71], v8 offset:29696
    s_waitcnt lgkmcnt(6)
    v_smfmac_f32_16x16x64_bf16 v[40:43], v[44:47], v[12:19], v1
    ds_read_b128 v[12:15], v8 offset:26624
    ds_read_b128 v[16:19], v8 offset:27648
    s_waitcnt lgkmcnt(6)
    v_smfmac_f32_16x16x64_bf16 v[40:43], v[48:51], v[20:27], v1
    ds_read_b128 v[20:23], v8 offset:30720
    ds_read_b128 v[24:27], v8 offset:31744
    s_waitcnt lgkmcnt(6)
    v_smfmac_f32_16x16x64_bf16 v[52:55], v[44:47], v[56:63], v1
    ds_read_b128 v[56:59], v8 offset:32768
    ds_read_b128 v[60:63], v8 offset:33792
    s_waitcnt lgkmcnt(6)
    v_smfmac_f32_16x16x64_bf16 v[52:55], v[48:51], v[64:71], v1
    s_waitcnt lgkmcnt(4)
    v_smfmac_f32_16x16x64_bf16 v[32:35], v[44:47], v[12:19], v1
    s_waitcnt lgkmcnt(2)
    v_smfmac_f32_16x16x64_bf16 v[32:35], v[48:51], v[20:27], v1
    v_smfmac_f32_16x16x64_bf16 v[28:31], v[44:47], a[248:255], v1
    s_waitcnt lgkmcnt(0)
    v_smfmac_f32_16x16x64_bf16 v[28:31], v[48:51], v[56:63], v1
    buffer_load_dwordx4 v[12:15], v6, s[8:11], s62 offen sc1
    buffer_load_dwordx4 v[16:19], v6, s[8:11], s63 offen sc1
    buffer_load_dwordx4 v[20:23], v6, s[8:11], s64 offen sc1
    buffer_load_dwordx4 v[24:27], v6, s[8:11], s65 offen sc1
    v_add_f32 v36, v36, v38
    v_add_f32 v37, v37, v39
    v_cvt_pk_bf16_f32 v36, v36, v37
    v_add_f32 v40, v40, v42
    v_add_f32 v41, v41, v43
    v_cvt_pk_bf16_f32 v37, v40, v41
    v_add_f32 v52, v52, v54
    v_add_f32 v53, v53, v55
    v_cvt_pk_bf16_f32 v38, v52, v53
    v_add_f32 v32, v32, v34
    v_add_f32 v33, v33, v35
    v_cvt_pk_bf16_f32 v39, v32, v33
    v_and_or_b32 v39, v39, -2, s40
    s_add_u32 s17, s38, 4096
    buffer_store_dwordx4 v[36:39], v0, s[8:11], s17 offen
    v_add_f32 v28, v28, v30
    v_add_f32 v29, v29, v31
    v_cvt_pk_bf16_f32 v28, v28, v29
    v_and_or_b32 v28, v28, -2, s40
    v_lshrrev_b32 v9, 2, v0
    buffer_store_dword v28, v9, s[8:11], s39 offen
    v_add_u32 v10, 162560, v0
    ds_read_b128 v[64:67], v10
    s_nop 9
    buffer_load_dwordx4 v[40:43], v6, s[8:11], s62 offen sc1
    buffer_load_dwordx4 v[44:47], v6, s[8:11], s63 offen sc1
    buffer_load_dwordx4 v[48:51], v6, s[8:11], s64 offen sc1
    buffer_load_dwordx4 v[52:55], v6, s[8:11], s65 offen sc1
    s_add_u32 s33, s33, 1
    s_add_u32 s42, s42, 262144
    s_add_u32 s41, s41, 262144
    s_add_u32 s43, s43, 131072
    s_add_u32 s68, s68, 262144
    s_add_u32 s66, s66, 22528
    ds_read_b128 v[56:59], v8 offset:0
    ds_read_b128 v[60:63], v8 offset:1024
    s_waitcnt lgkmcnt(2)
    s_waitcnt vmcnt(9)
    v_mfma_f32_16x16x32_bf16 v[68:71], v[12:15], v[64:67], 0
    v_and_b32 v10, 1, v15
    v_cmp_ne_u32 s[54:55], s40, v10
    s_waitcnt vmcnt(8)
    v_mfma_f32_16x16x32_bf16 v[68:71], v[16:19], v[64:67], v[68:71]
    v_and_b32 v10, 1, v19
    v_cmp_ne_u32 s[56:57], s40, v10
    s_waitcnt vmcnt(7)
    v_mfma_f32_16x16x32_bf16 v[68:71], v[20:23], v[64:67], v[68:71]
    v_and_b32 v10, 1, v23
    v_cmp_ne_u32 s[58:59], s40, v10
    s_waitcnt vmcnt(6)
    v_mfma_f32_16x16x32_bf16 v[68:71], v[24:27], v[64:67], v[68:71]
    v_and_b32 v10, 1, v27
    v_cmp_ne_u32 s[60:61], s40, v10
    s_or_b64 vcc, s[54:55], s[56:57]
    s_or_b64 vcc, vcc, s[58:59]
    s_or_b64 vcc, vcc, s[60:61]
    s_cbranch_scc0 Lr0f_red
    s_mov_b32 s16, 0
Lr0f_p1:
    buffer_load_dwordx4 v[12:15], v6, s[8:11], s62 offen sc1
    buffer_load_dwordx4 v[16:19], v6, s[8:11], s63 offen sc1
    buffer_load_dwordx4 v[20:23], v6, s[8:11], s64 offen sc1
    buffer_load_dwordx4 v[24:27], v6, s[8:11], s65 offen sc1
    s_waitcnt vmcnt(7)
    v_mfma_f32_16x16x32_bf16 v[68:71], v[40:43], v[64:67], 0
    v_and_b32 v10, 1, v43
    v_cmp_ne_u32 s[54:55], s40, v10
    s_waitcnt vmcnt(6)
    v_mfma_f32_16x16x32_bf16 v[68:71], v[44:47], v[64:67], v[68:71]
    v_and_b32 v10, 1, v47
    v_cmp_ne_u32 s[56:57], s40, v10
    s_waitcnt vmcnt(5)
    v_mfma_f32_16x16x32_bf16 v[68:71], v[48:51], v[64:67], v[68:71]
    v_and_b32 v10, 1, v51
    v_cmp_ne_u32 s[58:59], s40, v10
    s_waitcnt vmcnt(4)
    v_mfma_f32_16x16x32_bf16 v[68:71], v[52:55], v[64:67], v[68:71]
    v_and_b32 v10, 1, v55
    v_cmp_ne_u32 s[60:61], s40, v10
    s_or_b64 vcc, s[54:55], s[56:57]
    s_or_b64 vcc, vcc, s[58:59]
    s_or_b64 vcc, vcc, s[60:61]
    s_cbranch_scc0 Lr0f_red
    buffer_load_dwordx4 v[40:43], v6, s[8:11], s62 offen sc1
    buffer_load_dwordx4 v[44:47], v6, s[8:11], s63 offen sc1
    buffer_load_dwordx4 v[48:51], v6, s[8:11], s64 offen sc1
    buffer_load_dwordx4 v[52:55], v6, s[8:11], s65 offen sc1
    s_add_u32 s16, s16, 1
    s_cmp_gt_u32 s16, 100000
    s_cbranch_scc1 Lr_abort
    s_waitcnt vmcnt(7)
    v_mfma_f32_16x16x32_bf16 v[68:71], v[12:15], v[64:67], 0
    v_and_b32 v10, 1, v15
    v_cmp_ne_u32 s[54:55], s40, v10
    s_waitcnt vmcnt(6)
    v_mfma_f32_16x16x32_bf16 v[68:71], v[16:19], v[64:67], v[68:71]
    v_and_b32 v10, 1, v19
    v_cmp_ne_u32 s[56:57], s40, v10
    s_waitcnt vmcnt(5)
    v_mfma_f32_16x16x32_bf16 v[68:71], v[20:23], v[64:67], v[68:71]
    v_and_b32 v10, 1, v23
    v_cmp_ne_u32 s[58:59], s40, v10
    s_waitcnt vmcnt(4)
    v_mfma_f32_16x16x32_bf16 v[68:71], v[24:27], v[64:67], v[68:71]
    v_and_b32 v10, 1, v27
    v_cmp_ne_u32 s[60:61], s40, v10
    s_or_b64 vcc, s[54:55], s[56:57]
    s_or_b64 vcc, vcc, s[58:59]
    s_or_b64 vcc, vcc, s[60:61]
    s_cbranch_scc1 Lr0f_p1
Lr0f_red:
    s_nop 1
    v_permlane16_swap_b32 v68, v70
    v_permlane16_swap_b32 v69, v71
    s_mov_b64 exec, s[46:47]
    v_add_f32 v68, v68, v70
    v_add_f32 v69, v69, v71
    v_cvt_pk_bf16_f32 v68, v68, v69
    v_min_u32 v68, s50, v68
    buffer_store_dword v68, v7, s[8:11], s36 offen
    v_mov_b32 v69, -1
    buffer_store_dword v69, v7, s[8:11], s37 offen
    s_mov_b64 exec, -1
    s_xor_b32 s34, s34, 16384
    s_xor_b32 s35, s35, 16384
    s_xor_b32 s40, s40, 1
    s_xor_b32 s36, s36, 16384
    s_xor_b32 s37, s37, 16384
    s_nop 15
    s_nop 3
    buffer_load_dwordx4 v[36:39], v0, s[8:11], s34 offen sc1
    s_waitcnt vmcnt(3)
    ds_read_b128 v[64:67], v8 offset:2048
    ds_read_b128 v[68:71], v8 offset:3072
    v_mov_b64 v[12:13], 0
    v_mov_b64 v[14:15], 0
    v_mov_b64 v[16:17], 0
    v_mov_b64 v[18:19], 0
    v_mov_b64 v[20:21], 0
    v_mov_b64 v[22:23], 0
    v_mov_b64 v[24:25], 0
    v_mov_b64 v[26:27], 0
    v_mov_b64 v[28:29], 0
    v_mov_b64 v[30:31], 0
    v_mov_b64 v[32:33], 0
    v_mov_b64 v[34:35], 0
    s_nop 9
    buffer_load_dwordx4 v[36:39], v0, s[8:11], s34 offen sc1
    s_nop 15
    s_nop 8
    buffer_load_dwordx4 v[36:39], v0, s[8:11], s34 offen sc1
    s_waitcnt lgkmcnt(0)
    s_branch Lr0f_step
Lr0f_pb_re:
    s_mov_b32 s16, 0
Lr0f_pb_lp:
    s_add_u32 s17, s34, 4096
    buffer_load_dwordx4 v[40:43], v0, s[8:11], s17 offen sc1
    s_add_u32 s16, s16, 1
    s_cmp_gt_u32 s16, 100000
    s_cbranch_scc1 Lr_abort
    s_waitcnt vmcnt(0)
    v_max3_u32 v10, v40, v41, v42
    v_max_u32 v10, v10, v43
    v_cmp_eq_u32 vcc, -1, v10
    s_nop 0
    s_cbranch_vccnz Lr0f_pb_lp
    s_branch Lr0f_pb_ok
Lr0f_pc_re:
    s_mov_b32 s16, 0
Lr0f_pc_lp:
    buffer_load_dwordx4 v[44:47], v0, s[8:11], s35 offen sc1
    s_add_u32 s16, s16, 1
    s_cmp_gt_u32 s16, 100000
    s_cbranch_scc1 Lr_abort
    s_waitcnt vmcnt(0)
    v_max3_u32 v10, v44, v45, v46
    v_max_u32 v10, v10, v47
    v_cmp_eq_u32 vcc, -1, v10
    s_nop 0
    s_cbranch_vccnz Lr0f_pc_lp
    s_branch Lr0f_pc_ok
Lr0f_last:
    s_waitcnt vmcnt(0) lgkmcnt(0)
    s_barrier
    s_branch Lr_exit
L_w1_1:
    s_cmp_lg_u32 s14, 1
    s_cbranch_scc1 L_w2_1
    s_mov_b32 s16, 0
    s_add_u32 s17, s66, 128
    v_lshrrev_b32 v10, 2, v0
    v_and_b32 v9, 16, v10
    v_lshlrev_b32 v9, 3, v9
    v_and_or_b32 v10, v10, 12, v9
Lr1f_fw_11:
    buffer_load_dword v9, v10, s[8:11], s17 offen sc1
    s_add_u32 s16, s16, 1
    s_cmp_gt_u32 s16, 100000
    s_cbranch_scc1 Lr_abort
    s_waitcnt vmcnt(0)
    v_cmp_eq_u32 vcc, 0, v9
    s_nop 0
    s_cbranch_vccnz Lr1f_fw_11
    s_lshl_b32 s67, s32, 5
    s_add_u32 s67, s67, s15
    s_lshl_b32 s67, s67, 12
    s_add_u32 s67, s67, 3145728
    s_mov_b32 m0, 17152
    s_nop 0
    buffer_load_dwordx4 v0, s[8:11], s41 offen offset:0 lds
    buffer_load_dwordx4 v0, s[8:11], s41 offen offset:1024 lds
    s_add_u32 s41, s41, 262144
    s_add_u32 s68, s68, 262144
    s_waitcnt vmcnt(0)
    ds_read_b128 v[56:59], v8 offset:4096
    ds_read_b128 v[60:63], v8 offset:5120
    ds_read_b128 v[64:67], v8 offset:6144
    ds_read_b128 v[68:71], v8 offset:7168
    v_mov_b64 v[12:13], 0
    v_mov_b64 v[14:15], 0
    v_mov_b64 v[16:17], 0
    v_mov_b64 v[18:19], 0
    v_mov_b64 v[20:21], 0
    v_mov_b64 v[22:23], 0
    v_mov_b64 v[24:25], 0
    v_mov_b64 v[26:27], 0
    v_mov_b64 v[28:29], 0
    v_mov_b64 v[30:31], 0
    v_mov_b64 v[32:33], 0
    v_mov_b64 v[34:35], 0
    buffer_load_dwordx4 v[36:39], v0, s[8:11], s34 offen sc1
    s_waitcnt vmcnt(0) lgkmcnt(0)
Lr1f_step:
    s_waitcnt vmcnt(3)
    v_max3_u32 v10, v36, v37, v38
    v_max_u32 v10, v10, v39
    v_cmp_eq_u32 vcc, -1, v10
    s_nop 0
    s_cbranch_vccz Lr1f_aok
    buffer_load_dwordx4 v[36:39], v0, s[8:11], s34 offen sc1
    s_nop 15
    s_nop 8
    buffer_load_dwordx4 v[36:39], v0, s[8:11], s34 offen sc1
    s_mov_b32 s16, 0
Lr1f_alp:
    s_waitcnt vmcnt(2)
    v_max3_u32 v10, v36, v37, v38
    v_max_u32 v10, v10, v39
    v_cmp_eq_u32 vcc, -1, v10
    s_nop 0
    s_cbranch_vccz Lr1f_aok
    buffer_load_dwordx4 v[36:39], v0, s[8:11], s34 offen sc1
    s_add_u32 s16, s16, 1
    s_cmp_gt_u32 s16, 100000
    s_cbranch_scc1 Lr_abort
    s_branch Lr1f_alp
Lr1f_aok:
    ds_write_b128 v0, v[36:39] offset:7936
    v_smfmac_f32_16x16x64_bf16 v[12:15], v[36:39], v[88:95], v1
    v_smfmac_f32_16x16x64_bf16 v[16:19], v[36:39], v[96:103], v1
    v_smfmac_f32_16x16x64_bf16 v[20:23], v[36:39], v[200:207], v1
    s_waitcnt lgkmcnt(0)
    s_barrier
    ds_read_b128 v[48:51], v0 offset:8960
    ds_read_b128 v[52:55], v0 offset:9984
    v_smfmac_f32_16x16x64_bf16 v[28:31], v[36:39], a[72:79], v1
    v_smfmac_f32_16x16x64_bf16 v[24:27], v[36:39], v[208:215], v1
    s_add_u32 s17, s34, 4096
    buffer_load_dwordx4 v[40:43], v0, s[8:11], s17 offen sc1
    v_smfmac_f32_16x16x64_bf16 v[32:35], v[36:39], a[80:87], v1
    s_waitcnt vmcnt(1)
    ds_read_b128 v[36:39], v0 offset:6912
    s_waitcnt lgkmcnt(2)
    v_smfmac_f32_16x16x64_bf16 v[28:31], v[48:51], v[56:63], v1
    ds_read_b128 v[56:59], v8 offset:0
    ds_read_b128 v[60:63], v8 offset:1024
    v_smfmac_f32_16x16x64_bf16 v[12:15], v[48:51], v[104:111], v1
    v_smfmac_f32_16x16x64_bf16 v[16:19], v[48:51], v[112:119], v1
    buffer_load_dwordx4 v[44:47], v0, s[8:11], s35 offen sc1
    v_smfmac_f32_16x16x64_bf16 v[32:35], v[48:51], v[64:71], v1
    ds_read_b128 v[64:67], v8 offset:2048
    ds_read_b128 v[68:71], v8 offset:3072
    v_smfmac_f32_16x16x64_bf16 v[20:23], v[48:51], v[216:223], v1
    v_smfmac_f32_16x16x64_bf16 v[24:27], v[48:51], v[224:231], v1
    s_waitcnt lgkmcnt(5)
    v_smfmac_f32_16x16x64_bf16 v[28:31], v[52:55], a[88:95], v1
    v_smfmac_f32_16x16x64_bf16 v[12:15], v[52:55], v[120:127], v1
    v_smfmac_f32_16x16x64_bf16 v[16:19], v[52:55], v[128:135], v1
    v_smfmac_f32_16x16x64_bf16 v[32:35], v[52:55], a[96:103], v1
    v_smfmac_f32_16x16x64_bf16 v[20:23], v[52:55], v[232:239], v1
    v_smfmac_f32_16x16x64_bf16 v[24:27], v[52:55], v[240:247], v1
    s_waitcnt lgkmcnt(2)
    v_smfmac_f32_16x16x64_bf16 v[28:31], v[36:39], v[56:63], v1
    ds_read_b128 v[56:59], v8 offset:12288
    ds_read_b128 v[60:63], v8 offset:13312
    v_smfmac_f32_16x16x64_bf16 v[12:15], v[36:39], v[72:79], v1
    v_smfmac_f32_16x16x64_bf16 v[16:19], v[36:39], v[80:87], v1
    s_waitcnt lgkmcnt(2)
    v_smfmac_f32_16x16x64_bf16 v[32:35], v[36:39], v[64:71], v1
    ds_read_b128 v[64:67], v8 offset:14336
    ds_read_b128 v[68:71], v8 offset:15360
    v_smfmac_f32_16x16x64_bf16 v[20:23], v[36:39], v[184:191], v1
    v_smfmac_f32_16x16x64_bf16 v[24:27], v[36:39], v[192:199], v1
    s_waitcnt vmcnt(1)
    v_max3_u32 v10, v40, v41, v42
    v_max_u32 v10, v10, v43
    v_cmp_eq_u32 vcc, -1, v10
    s_nop 0
    s_cbranch_vccnz Lr1f_pb_re
Lr1f_pb_ok:
    ds_write_b128 v0, v[40:43] offset:12032
    v_mov_b32 v9, 1
    v_mov_b32 v10, 0
    s_mov_b64 exec, 1
    buffer_store_dword v9, v10, s[8:11], s67 offen offset:384 sc1
    s_mov_b64 exec, -1
    v_smfmac_f32_16x16x64_bf16 v[12:15], v[40:43], v[136:143], v1
    v_smfmac_f32_16x16x64_bf16 v[20:23], v[40:43], a[8:15], v1
    v_smfmac_f32_16x16x64_bf16 v[16:19], v[40:43], v[144:151], v1
    v_smfmac_f32_16x16x64_bf16 v[24:27], v[40:43], a[16:23], v1
    s_waitcnt lgkmcnt(0)
    s_barrier
    ds_read_b128 v[48:51], v0 offset:13056
    ds_read_b128 v[52:55], v0 offset:14080
    ds_read_b128 v[36:39], v0 offset:11008
    v_smfmac_f32_16x16x64_bf16 v[28:31], v[40:43], a[120:127], v1
    v_smfmac_f32_16x16x64_bf16 v[32:35], v[40:43], a[128:135], v1
    s_waitcnt lgkmcnt(2)
    v_smfmac_f32_16x16x64_bf16 v[12:15], v[48:51], v[56:63], v1
    ds_read_b128 v[56:59], v8 offset:8192
    ds_read_b128 v[60:63], v8 offset:9216
    v_smfmac_f32_16x16x64_bf16 v[16:19], v[48:51], v[64:71], v1
    ds_read_b128 v[64:67], v8 offset:10240
    ds_read_b128 v[68:71], v8 offset:11264
    s_waitcnt lgkmcnt(5)
    v_smfmac_f32_16x16x64_bf16 v[12:15], v[52:55], v[152:159], v1
    v_smfmac_f32_16x16x64_bf16 v[16:19], v[52:55], v[160:167], v1
    s_waitcnt vmcnt(1)
    v_max3_u32 v10, v44, v45, v46
    v_max_u32 v10, v10, v47
    v_cmp_eq_u32 vcc, -1, v10
    s_nop 0
    s_cbranch_vccnz Lr1f_pc_re
Lr1f_pc_ok:
    v_smfmac_f32_16x16x64_bf16 v[12:15], v[44:47], v[168:175], v1
    v_smfmac_f32_16x16x64_bf16 v[16:19], v[44:47], v[176:183], v1
    s_waitcnt lgkmcnt(2)
    v_smfmac_f32_16x16x64_bf16 v[12:15], v[36:39], v[56:63], v1
    s_waitcnt lgkmcnt(0)
    v_smfmac_f32_16x16x64_bf16 v[16:19], v[36:39], v[64:71], v1
    v_smfmac_f32_16x16x64_bf16 v[20:23], v[48:51], a[24:31], v1
    v_smfmac_f32_16x16x64_bf16 v[24:27], v[48:51], a[32:39], v1
    buffer_load_dwordx4 v[64:67], v0, s[8:11], s42 offen
    v_smfmac_f32_16x16x64_bf16 v[20:23], v[52:55], a[40:47], v1
    v_add_f32 v12, v12, v14
    v_smfmac_f32_16x16x64_bf16 v[24:27], v[52:55], a[48:55], v1
    v_add_f32 v16, v16, v18
    v_smfmac_f32_16x16x64_bf16 v[20:23], v[36:39], v[248:255], v1
    v_add_f32 v13, v13, v15
    v_smfmac_f32_16x16x64_bf16 v[24:27], v[36:39], a[0:7], v1
    v_add_f32 v17, v17, v19
    buffer_load_dwordx4 v[68:71], v0, s[8:11], s42 offen offset:1024
    v_smfmac_f32_16x16x64_bf16 v[20:23], v[44:47], a[56:63], v1
    v_cvt_pk_bf16_f32 v14, v12, v16
    ds_read_b128 v[56:59], v0 offset:15104
    v_smfmac_f32_16x16x64_bf16 v[24:27], v[44:47], a[64:71], v1
    v_cvt_pk_bf16_f32 v15, v13, v17
    ds_read_b128 v[60:63], v0 offset:16128
    ds_write_b32 v2, v14 offset:576
    ds_write_b32 v2, v15 offset:864
    v_smfmac_f32_16x16x64_bf16 v[28:31], v[48:51], a[136:143], v1
    v_smfmac_f32_16x16x64_bf16 v[32:35], v[48:51], a[144:151], v1
    v_add_f32 v20, v20, v22
    v_add_f32 v24, v24, v26
    v_add_f32 v21, v21, v23
    v_add_f32 v25, v25, v27
    v_cvt_pk_bf16_f32 v22, v20, v24
    v_cvt_pk_bf16_f32 v23, v21, v25
    ds_write_b32 v2, v22 offset:0
    ds_write_b32 v2, v23 offset:288
    v_smfmac_f32_16x16x64_bf16 v[28:31], v[52:55], a[152:159], v1
    v_smfmac_f32_16x16x64_bf16 v[32:35], v[52:55], a[160:167], v1
    s_waitcnt lgkmcnt(0)
    s_barrier
    ds_read_b128 v[40:43], v3 offset:0
    ds_read_b128 v[48:51], v3 offset:64
    ds_read_b128 v[20:23], v3 offset:128
    ds_read_b128 v[52:55], v3 offset:192
    v_smfmac_f32_16x16x64_bf16 v[28:31], v[36:39], a[104:111], v1
    v_smfmac_f32_16x16x64_bf16 v[32:35], v[36:39], a[112:119], v1
    ds_read_b128 v[36:39], v0 offset:17152
    v_smfmac_f32_16x16x64_bf16 v[28:31], v[44:47], a[168:175], v1
    v_smfmac_f32_16x16x64_bf16 v[32:35], v[44:47], a[176:183], v1
    ds_read_b128 v[44:47], v0 offset:18176
    s_waitcnt lgkmcnt(5)
    v_mfma_f32_16x16x32_bf16 v[12:15], v[56:59], v[40:43], 0
    v_mfma_f32_16x16x32_bf16 v[16:19], v[60:63], v[40:43], 0
    v_mfma_f32_16x16x32_bf16 v[24:27], v[40:43], v[40:43], 0
    ds_read_b128 v[56:59], v0 offset:19200
    ds_read_b128 v[60:63], v0 offset:20224
    s_waitcnt lgkmcnt(3)
    v_mfma_f32_16x16x32_bf16 v[12:15], v[36:39], v[48:51], v[12:15]
    v_lshrrev_b32 v10, 1, v0
    v_lshrrev_b32 v9, 9, v0
    s_waitcnt lgkmcnt(2)
    v_mfma_f32_16x16x32_bf16 v[16:19], v[44:47], v[48:51], v[16:19]
    v_lshl_add_u32 v9, v9, 5, v10
    v_add_f32 v28, v28, v30
    v_mfma_f32_16x16x32_bf16 v[24:27], v[48:51], v[48:51], v[24:27]
    v_add_f32 v32, v32, v34
    v_add_f32 v29, v29, v31
    ds_read_b128 v[36:39], v0 offset:21248
    ds_read_b128 v[44:47], v0 offset:22272
    s_waitcnt lgkmcnt(3)
    v_mfma_f32_16x16x32_bf16 v[12:15], v[56:59], v[20:23], v[12:15]
    v_add_f32 v33, v33, v35
    v_cvt_pk_bf16_f32 v30, v28, v29
    s_waitcnt lgkmcnt(2)
    v_mfma_f32_16x16x32_bf16 v[16:19], v[60:63], v[20:23], v[16:19]
    v_cvt_pk_bf16_f32 v31, v32, v33
    ds_read_b64 v[34:35], v9 offset:1152
    v_mfma_f32_16x16x32_bf16 v[24:27], v[20:23], v[20:23], v[24:27]
    s_add_u32 s17, s43, 2560
    buffer_store_dwordx2 v[30:31], v10, s[8:11], s17 offen sc1
    s_waitcnt lgkmcnt(2)
    v_mfma_f32_16x16x32_bf16 v[12:15], v[36:39], v[52:55], v[12:15]
    s_waitcnt lgkmcnt(1)
    v_mfma_f32_16x16x32_bf16 v[16:19], v[44:47], v[52:55], v[16:19]
    v_mfma_f32_16x16x32_bf16 v[24:27], v[52:55], v[52:55], v[24:27]
    s_add_u32 s17, s43, 512
    s_waitcnt lgkmcnt(0)
    buffer_store_dwordx2 v[34:35], v10, s[8:11], s17 offen sc1
    ds_read_b128 v[56:59], v8 offset:16384
    ds_read_b128 v[60:63], v8 offset:17408
    v_mov_b64 v[20:21], s[52:53]
    v_mov_b64 v[22:23], s[52:53]
    v_mov_b32 v41, 0
    v_mov_b32 v42, 0
    v_max3_f32 v9, v12, v13, v14
    v_max3_f32 v9, v9, v15, v16
    v_max3_f32 v9, v9, v17, v18
    v_max3_f32 v9, v9, v19, v24
    v_max_f32 v9, v9, v25
    v_mov_b32 v10, v9
    v_mov_b64 v[32:33], 0
    v_mov_b64 v[34:35], 0
    v_permlane32_swap_b32 v9, v10
    v_max_f32 v9, v9, v10
    v_mov_b32 v10, v9
    s_nop 1
    v_permlane16_swap_b32 v9, v10
    v_max_f32 v9, v9, v10
    v_mul_f32 v28, s44, v9
    v_fma_f32 v12, v12, s44, -v28
    v_fma_f32 v13, v13, s44, -v28
    v_fma_f32 v14, v14, s44, -v28
    v_fma_f32 v15, v15, s44, -v28
    v_exp_f32 v12, v12
    v_exp_f32 v13, v13
    v_fma_f32 v16, v16, s44, -v28
    v_fma_f32 v17, v17, s44, -v28
    v_exp_f32 v14, v14
    v_exp_f32 v15, v15
    v_cvt_pk_bf16_f32 v36, v12, v13
    v_fma_f32 v18, v18, s44, -v28
    v_fma_f32 v19, v19, s44, -v28
    v_exp_f32 v16, v16
    v_exp_f32 v17, v17
    v_cvt_pk_bf16_f32 v37, v14, v15
    v_fma_f32 v24, v24, s44, -v28
    v_fma_f32 v25, v25, s44, -v28
    v_exp_f32 v18, v18
    v_exp_f32 v19, v19
    v_cvt_pk_bf16_f32 v38, v16, v17
    v_exp_f32 v24, v24
    v_exp_f32 v25, v25
    v_cvt_pk_bf16_f32 v39, v18, v19
    v_cvt_pk_bf16_f32 v40, v24, v25
    v_cvt_pk_bf16_f32 v43, v24, v25
    v_mfma_f32_16x16x32_bf16 v[52:55], v[20:23], v[36:39], 0
    v_mov_b64 v[12:13], 0
    v_mov_b64 v[14:15], 0
    s_waitcnt vmcnt(3)
    v_mfma_f32_16x16x32_bf16 v[44:47], v[64:67], v[36:39], 0
    v_mov_b64 v[24:25], 0
    v_mov_b64 v[26:27], 0
    s_waitcnt vmcnt(2)
    v_mfma_f32_16x16x32_bf16 v[48:51], v[68:71], v[36:39], 0
    ds_read_b128 v[64:67], v8 offset:20480
    ds_read_b128 v[68:71], v8 offset:21504
    v_mfma_f32_16x16x16_bf16 v[52:55], v[20:21], v[40:41], v[52:55]
    v_mfma_f32_16x16x16_bf16 v[44:47], v[30:31], v[40:41], v[44:47]
    v_mov_b64 v[20:21], 0
    v_mov_b64 v[22:23], 0
    v_mfma_f32_16x16x16_bf16 v[48:51], v[30:31], v[42:43], v[48:51]
    v_mov_b64 v[36:37], 0
    v_mov_b64 v[38:39], 0
    v_mov_b64 v[40:41], 0
    v_mov_b64 v[42:43], 0
    v_rcp_f32 v9, v52
    v_mov_b64 v[52:53], 0
    v_mov_b64 v[54:55], 0
    v_mul_f32 v44, v9, v44
    v_mul_f32 v48, v9, v48
    v_cvt_pk_bf16_f32 v16, v44, v48
    v_mul_f32 v45, v9, v45
    v_mul_f32 v49, v9, v49
    v_cvt_pk_bf16_f32 v17, v45, v49
    v_mul_f32 v46, v9, v46
    v_mul_f32 v50, v9, v50
    v_cvt_pk_bf16_f32 v18, v46, v50
    v_mul_f32 v47, v9, v47
    v_mul_f32 v51, v9, v51
    v_cvt_pk_bf16_f32 v19, v47, v51
    ds_write_b128 v5, v[16:19]
    v_mov_b64 v[28:29], 0
    v_mov_b64 v[30:31], 0
    s_waitcnt lgkmcnt(0)
    s_barrier
    ds_read_b128 v[44:47], v4 offset:0
    ds_read_b128 v[48:51], v4 offset:128
    s_cmp_eq_u32 s33, 63
    s_cbranch_scc1 Lr1f_last
    v_mov_b64 v[16:17], 0
    v_mov_b64 v[18:19], 0
    buffer_load_dwordx4 v0, s[8:11], s41 offen offset:0 lds
    buffer_load_dwordx4 v0, s[8:11], s41 offen offset:1024 lds
    s_waitcnt lgkmcnt(1)
    v_smfmac_f32_16x16x64_bf16 v[12:15], v[44:47], a[184:191], v1
    s_waitcnt lgkmcnt(0)
    v_smfmac_f32_16x16x64_bf16 v[12:15], v[48:51], a[192:199], v1
    v_smfmac_f32_16x16x64_bf16 v[24:27], v[44:47], a[200:207], v1
    v_smfmac_f32_16x16x64_bf16 v[24:27], v[48:51], a[208:215], v1
    v_add_f32 v12, v12, v14
    v_smfmac_f32_16x16x64_bf16 v[20:23], v[44:47], a[216:223], v1
    v_add_f32 v13, v13, v15
    v_smfmac_f32_16x16x64_bf16 v[20:23], v[48:51], a[224:231], v1
    v_cvt_pk_bf16_f32 v12, v12, v13
    v_smfmac_f32_16x16x64_bf16 v[16:19], v[44:47], a[232:239], v1
    v_add_f32 v24, v24, v26
    v_smfmac_f32_16x16x64_bf16 v[16:19], v[48:51], a[240:247], v1
    v_add_f32 v25, v25, v27
    v_smfmac_f32_16x16x64_bf16 v[36:39], v[44:47], v[56:63], v1
    v_cvt_pk_bf16_f32 v13, v24, v25
    v_smfmac_f32_16x16x64_bf16 v[36:39], v[48:51], v[64:71], v1
    v_add_f32 v20, v20, v22
    v_add_f32 v21, v21, v23
    v_cvt_pk_bf16_f32 v14, v20, v21
    v_add_f32 v16, v16, v18
    v_add_f32 v17, v17, v19
    v_cvt_pk_bf16_f32 v15, v16, v17
    v_and_or_b32 v15, v15, -2, s40
    buffer_store_dwordx4 v[12:15], v0, s[8:11], s38 offen
    s_nop 0
    ds_read_b128 v[12:15], v8 offset:18432
    ds_read_b128 v[16:19], v8 offset:19456
    ds_read_b128 v[20:23], v8 offset:22528
    ds_read_b128 v[24:27], v8 offset:23552
    ds_read_b128 v[56:59], v8 offset:24576
    ds_read_b128 v[60:63], v8 offset:25600
    ds_read_b128 v[64:67], v8 offset:28672
    ds_read_b128 v[68:71], v8 offset:29696
    s_waitcnt lgkmcnt(6)
    v_smfmac_f32_16x16x64_bf16 v[40:43], v[44:47], v[12:19], v1
    ds_read_b128 v[12:15], v8 offset:26624
    ds_read_b128 v[16:19], v8 offset:27648
    s_waitcnt lgkmcnt(6)
    v_smfmac_f32_16x16x64_bf16 v[40:43], v[48:51], v[20:27], v1
    ds_read_b128 v[20:23], v8 offset:30720
    ds_read_b128 v[24:27], v8 offset:31744
    s_waitcnt lgkmcnt(6)
    v_smfmac_f32_16x16x64_bf16 v[52:55], v[44:47], v[56:63], v1
    ds_read_b128 v[56:59], v8 offset:32768
    ds_read_b128 v[60:63], v8 offset:33792
    s_waitcnt lgkmcnt(6)
    v_smfmac_f32_16x16x64_bf16 v[52:55], v[48:51], v[64:71], v1
    s_waitcnt lgkmcnt(4)
    v_smfmac_f32_16x16x64_bf16 v[32:35], v[44:47], v[12:19], v1
    s_waitcnt lgkmcnt(2)
    v_smfmac_f32_16x16x64_bf16 v[32:35], v[48:51], v[20:27], v1
    v_smfmac_f32_16x16x64_bf16 v[28:31], v[44:47], a[248:255], v1
    s_waitcnt lgkmcnt(0)
    v_smfmac_f32_16x16x64_bf16 v[28:31], v[48:51], v[56:63], v1
    v_add_f32 v36, v36, v38
    v_add_f32 v37, v37, v39
    v_cvt_pk_bf16_f32 v36, v36, v37
    v_add_f32 v40, v40, v42
    v_add_f32 v41, v41, v43
    v_cvt_pk_bf16_f32 v37, v40, v41
    v_add_f32 v52, v52, v54
    v_add_f32 v53, v53, v55
    v_cvt_pk_bf16_f32 v38, v52, v53
    v_add_f32 v32, v32, v34
    v_add_f32 v33, v33, v35
    v_cvt_pk_bf16_f32 v39, v32, v33
    v_and_or_b32 v39, v39, -2, s40
    s_add_u32 s17, s38, 4096
    buffer_store_dwordx4 v[36:39], v0, s[8:11], s17 offen
    v_add_f32 v28, v28, v30
    v_add_f32 v29, v29, v31
    v_cvt_pk_bf16_f32 v28, v28, v29
    v_and_or_b32 v28, v28, -2, s40
    v_lshrrev_b32 v9, 2, v0
    buffer_store_dword v28, v9, s[8:11], s39 offen
    v_add_u32 v10, 162560, v0
    ds_read_b128 v[64:67], v10
    s_add_u32 s33, s33, 1
    s_add_u32 s42, s42, 262144
    s_add_u32 s41, s41, 262144
    s_add_u32 s43, s43, 131072
    s_mov_b32 s67, s66
    s_add_u32 s68, s68, 262144
    s_add_u32 s66, s66, 22528
    ds_read_b128 v[56:59], v8 offset:4096
    ds_read_b128 v[60:63], v8 offset:5120
    v_mov_b64 v[12:13], 0
    v_mov_b64 v[14:15], 0
    v_mov_b64 v[16:17], 0
    v_mov_b64 v[18:19], 0
    v_mov_b64 v[20:21], 0
    v_mov_b64 v[22:23], 0
    v_mov_b64 v[24:25], 0
    v_mov_b64 v[26:27], 0
    v_mov_b64 v[28:29], 0
    v_mov_b64 v[30:31], 0
    v_mov_b64 v[32:33], 0
    v_mov_b64 v[34:35], 0
    s_nop 15
    s_nop 15
    s_nop 15
    s_nop 11
    buffer_load_dwordx4 v[40:43], v6, s[8:11], s62 offen sc1
    buffer_load_dwordx4 v[44:47], v6, s[8:11], s63 offen sc1
    buffer_load_dwordx4 v[48:51], v6, s[8:11], s64 offen sc1
    buffer_load_dwordx4 v[52:55], v6, s[8:11], s65 offen sc1
    s_waitcnt lgkmcnt(0)
    s_waitcnt vmcnt(3)
    v_mfma_f32_16x16x32_bf16 v[68:71], v[40:43], v[64:67], 0
    v_and_b32 v10, 1, v43
    v_cmp_ne_u32 s[54:55], s40, v10
    s_waitcnt vmcnt(2)
    v_mfma_f32_16x16x32_bf16 v[68:71], v[44:47], v[64:67], v[68:71]
    v_and_b32 v10, 1, v47
    v_cmp_ne_u32 s[56:57], s40, v10
    s_waitcnt vmcnt(1)
    v_mfma_f32_16x16x32_bf16 v[68:71], v[48:51], v[64:67], v[68:71]
    v_and_b32 v10, 1, v51
    v_cmp_ne_u32 s[58:59], s40, v10
    s_waitcnt vmcnt(0)
    v_mfma_f32_16x16x32_bf16 v[68:71], v[52:55], v[64:67], v[68:71]
    v_and_b32 v10, 1, v55
    v_cmp_ne_u32 s[60:61], s40, v10
    s_or_b64 vcc, s[54:55], s[56:57]
    s_or_b64 vcc, vcc, s[58:59]
    s_or_b64 vcc, vcc, s[60:61]
    s_cbranch_scc0 Lr1f_red
    s_mov_b32 s16, 0
Lr1f_p1:
    s_mov_b64 exec, s[54:55]
    buffer_load_dwordx4 v[40:43], v6, s[8:11], s62 offen sc1
    s_mov_b64 exec, s[56:57]
    buffer_load_dwordx4 v[44:47], v6, s[8:11], s63 offen sc1
    s_mov_b64 exec, s[58:59]
    buffer_load_dwordx4 v[48:51], v6, s[8:11], s64 offen sc1
    s_mov_b64 exec, s[60:61]
    buffer_load_dwordx4 v[52:55], v6, s[8:11], s65 offen sc1
    s_mov_b64 exec, -1
    s_add_u32 s16, s16, 1
    s_cmp_gt_u32 s16, 100000
    s_cbranch_scc1 Lr_abort
    s_waitcnt vmcnt(3)
    v_mfma_f32_16x16x32_bf16 v[68:71], v[40:43], v[64:67], 0
    v_and_b32 v10, 1, v43
    v_cmp_ne_u32 s[54:55], s40, v10
    s_waitcnt vmcnt(2)
    v_mfma_f32_16x16x32_bf16 v[68:71], v[44:47], v[64:67], v[68:71]
    v_and_b32 v10, 1, v47
    v_cmp_ne_u32 s[56:57], s40, v10
    s_waitcnt vmcnt(1)
    v_mfma_f32_16x16x32_bf16 v[68:71], v[48:51], v[64:67], v[68:71]
    v_and_b32 v10, 1, v51
    v_cmp_ne_u32 s[58:59], s40, v10
    s_waitcnt vmcnt(0)
    v_mfma_f32_16x16x32_bf16 v[68:71], v[52:55], v[64:67], v[68:71]
    v_and_b32 v10, 1, v55
    v_cmp_ne_u32 s[60:61], s40, v10
    s_or_b64 vcc, s[54:55], s[56:57]
    s_or_b64 vcc, vcc, s[58:59]
    s_or_b64 vcc, vcc, s[60:61]
    s_cbranch_scc1 Lr1f_p1
Lr1f_red:
    s_xor_b32 s34, s34, 16384
    s_xor_b32 s35, s35, 16384
    buffer_load_dwordx4 v[36:39], v0, s[8:11], s34 offen sc1
    v_permlane16_swap_b32 v68, v70
    v_permlane16_swap_b32 v69, v71
    s_mov_b64 exec, s[46:47]
    v_add_f32 v68, v68, v70
    v_add_f32 v69, v69, v71
    v_cvt_pk_bf16_f32 v68, v68, v69
    v_min_u32 v68, s50, v68
    buffer_store_dword v68, v7, s[8:11], s36 offen
    v_mov_b32 v69, -1
    buffer_store_dword v69, v7, s[8:11], s37 offen
    s_mov_b64 exec, -1
    buffer_load_dwordx4 v[36:39], v0, s[8:11], s34 offen sc1
    s_xor_b32 s40, s40, 1
    s_xor_b32 s36, s36, 16384
    s_xor_b32 s37, s37, 16384
    ds_read_b128 v[64:67], v8 offset:6144
    ds_read_b128 v[68:71], v8 offset:7168
    s_waitcnt lgkmcnt(0)
    s_branch Lr1f_step
Lr1f_pb_re:
    s_mov_b32 s16, 0
Lr1f_pb_lp:
    s_add_u32 s17, s34, 4096
    buffer_load_dwordx4 v[40:43], v0, s[8:11], s17 offen sc1
    s_add_u32 s16, s16, 1
    s_cmp_gt_u32 s16, 100000
    s_cbranch_scc1 Lr_abort
    s_waitcnt vmcnt(0)
    v_max3_u32 v10, v40, v41, v42
    v_max_u32 v10, v10, v43
    v_cmp_eq_u32 vcc, -1, v10
    s_nop 0
    s_cbranch_vccnz Lr1f_pb_lp
    s_branch Lr1f_pb_ok
Lr1f_pc_re:
    s_mov_b32 s16, 0
Lr1f_pc_lp:
    buffer_load_dwordx4 v[44:47], v0, s[8:11], s35 offen sc1
    s_add_u32 s16, s16, 1
    s_cmp_gt_u32 s16, 100000
    s_cbranch_scc1 Lr_abort
    s_waitcnt vmcnt(0)
    v_max3_u32 v10, v44, v45, v46
    v_max_u32 v10, v10, v47
    v_cmp_eq_u32 vcc, -1, v10
    s_nop 0
    s_cbranch_vccnz Lr1f_pc_lp
    s_branch Lr1f_pc_ok
Lr1f_last:
    s_waitcnt vmcnt(0) lgkmcnt(0)
    s_barrier
    s_mov_b32 s67, s66
    v_mov_b32 v9, 1
    v_mov_b32 v10, 0
    s_mov_b64 exec, 1
    buffer_store_dword v9, v10, s[8:11], s67 offen offset:384 sc1
    s_mov_b64 exec, -1
    s_branch Lr_exit
L_w2_1:
    s_cmp_lg_u32 s14, 2
    s_cbranch_scc1 L_w3_1
    s_mov_b32 s16, 0
    s_add_u32 s17, s66, 128
    v_lshrrev_b32 v10, 2, v0
    v_and_b32 v9, 16, v10
    v_lshlrev_b32 v9, 3, v9
    v_and_or_b32 v10, v10, 12, v9
Lr2f_fw_12:
    buffer_load_dword v9, v10, s[8:11], s17 offen sc1
    s_add_u32 s16, s16, 1
    s_cmp_gt_u32 s16, 100000
    s_cbranch_scc1 Lr_abort
    s_waitcnt vmcnt(0)
    v_cmp_eq_u32 vcc, 0, v9
    s_nop 0
    s_cbranch_vccnz Lr2f_fw_12
    s_mov_b32 m0, 19200
    s_nop 0
    buffer_load_dwordx4 v0, s[8:11], s41 offen offset:0 lds
    buffer_load_dwordx4 v0, s[8:11], s41 offen offset:1024 lds
    s_add_u32 s41, s41, 262144
    s_add_u32 s68, s68, 262144
    s_waitcnt vmcnt(0)
    ds_read_b128 v[56:59], v8 offset:4096
    ds_read_b128 v[60:63], v8 offset:5120
    ds_read_b128 v[64:67], v8 offset:6144
    ds_read_b128 v[68:71], v8 offset:7168
    v_mov_b64 v[12:13], 0
    v_mov_b64 v[14:15], 0
    v_mov_b64 v[16:17], 0
    v_mov_b64 v[18:19], 0
    v_mov_b64 v[20:21], 0
    v_mov_b64 v[22:23], 0
    v_mov_b64 v[24:25], 0
    v_mov_b64 v[26:27], 0
    v_mov_b64 v[28:29], 0
    v_mov_b64 v[30:31], 0
    v_mov_b64 v[32:33], 0
    v_mov_b64 v[34:35], 0
    buffer_load_dwordx4 v[36:39], v0, s[8:11], s34 offen sc1
    s_waitcnt vmcnt(0) lgkmcnt(0)
Lr2f_step:
    s_waitcnt vmcnt(3)
    v_max3_u32 v10, v36, v37, v38
    v_max_u32 v10, v10, v39
    v_cmp_eq_u32 vcc, -1, v10
    s_nop 0
    s_cbranch_vccz Lr2f_aok
    buffer_load_dwordx4 v[36:39], v0, s[8:11], s34 offen sc1
    s_nop 15
    s_nop 8
    buffer_load_dwordx4 v[36:39], v0, s[8:11], s34 offen sc1
    s_mov_b32 s16, 0
Lr2f_alp:
    s_waitcnt vmcnt(2)
    v_max3_u32 v10, v36, v37, v38
    v_max_u32 v10, v10, v39
    v_cmp_eq_u32 vcc, -1, v10
    s_nop 0
    s_cbranch_vccz Lr2f_aok
    buffer_load_dwordx4 v[36:39], v0, s[8:11], s34 offen sc1
    s_add_u32 s16, s16, 1
    s_cmp_gt_u32 s16, 100000
    s_cbranch_scc1 Lr_abort
    s_branch Lr2f_alp
Lr2f_aok:
    ds_write_b128 v0, v[36:39] offset:8960
    v_smfmac_f32_16x16x64_bf16 v[12:15], v[36:39], v[104:111], v1
    v_smfmac_f32_16x16x64_bf16 v[16:19], v[36:39], v[112:119], v1
    v_smfmac_f32_16x16x64_bf16 v[20:23], v[36:39], v[216:223], v1
    s_waitcnt lgkmcnt(0)
    s_barrier
    ds_read_b128 v[48:51], v0 offset:9984
    ds_read_b128 v[52:55], v0 offset:6912
    v_smfmac_f32_16x16x64_bf16 v[28:31], v[36:39], v[56:63], v1
    ds_read_b128 v[56:59], v8 offset:0
    ds_read_b128 v[60:63], v8 offset:1024
    v_smfmac_f32_16x16x64_bf16 v[24:27], v[36:39], v[224:231], v1
    v_smfmac_f32_16x16x64_bf16 v[32:35], v[36:39], v[64:71], v1
    ds_read_b128 v[64:67], v8 offset:2048
    ds_read_b128 v[68:71], v8 offset:3072
    s_add_u32 s17, s34, 4096
    buffer_load_dwordx4 v[40:43], v0, s[8:11], s17 offen sc1
    s_waitcnt vmcnt(1)
    ds_read_b128 v[36:39], v0 offset:7936
    s_waitcnt lgkmcnt(6)
    v_smfmac_f32_16x16x64_bf16 v[28:31], v[48:51], a[88:95], v1
    v_smfmac_f32_16x16x64_bf16 v[12:15], v[48:51], v[120:127], v1
    v_smfmac_f32_16x16x64_bf16 v[16:19], v[48:51], v[128:135], v1
    v_smfmac_f32_16x16x64_bf16 v[32:35], v[48:51], a[96:103], v1
    buffer_load_dwordx4 v[44:47], v0, s[8:11], s35 offen sc1
    v_smfmac_f32_16x16x64_bf16 v[20:23], v[48:51], v[232:239], v1
    v_lshrrev_b32 v10, 2, v0
    v_and_b32 v9, 16, v10
    v_lshlrev_b32 v9, 3, v9
    v_and_or_b32 v10, v10, 12, v9
    s_add_u32 s17, s66, 22656
    v_mov_b32 v11, 2
    buffer_load_dword v11, v10, s[8:11], s17 offen sc1
    v_smfmac_f32_16x16x64_bf16 v[24:27], v[48:51], v[240:247], v1
    s_waitcnt lgkmcnt(3)
    v_smfmac_f32_16x16x64_bf16 v[28:31], v[52:55], v[56:63], v1
    ds_read_b128 v[56:59], v8 offset:12288
    ds_read_b128 v[60:63], v8 offset:13312
    v_smfmac_f32_16x16x64_bf16 v[12:15], v[52:55], v[72:79], v1
    v_smfmac_f32_16x16x64_bf16 v[16:19], v[52:55], v[80:87], v1
    s_waitcnt lgkmcnt(3)
    v_smfmac_f32_16x16x64_bf16 v[32:35], v[52:55], v[64:71], v1
    ds_read_b128 v[64:67], v8 offset:14336
    ds_read_b128 v[68:71], v8 offset:15360
    v_smfmac_f32_16x16x64_bf16 v[20:23], v[52:55], v[184:191], v1
    v_smfmac_f32_16x16x64_bf16 v[24:27], v[52:55], v[192:199], v1
    s_waitcnt lgkmcnt(4)
    v_smfmac_f32_16x16x64_bf16 v[28:31], v[36:39], a[72:79], v1
    v_smfmac_f32_16x16x64_bf16 v[12:15], v[36:39], v[88:95], v1
    v_smfmac_f32_16x16x64_bf16 v[16:19], v[36:39], v[96:103], v1
    v_smfmac_f32_16x16x64_bf16 v[32:35], v[36:39], a[80:87], v1
    v_smfmac_f32_16x16x64_bf16 v[20:23], v[36:39], v[200:207], v1
    v_smfmac_f32_16x16x64_bf16 v[24:27], v[36:39], v[208:215], v1
    s_waitcnt vmcnt(2)
    v_max3_u32 v10, v40, v41, v42
    v_max_u32 v10, v10, v43
    v_cmp_eq_u32 vcc, -1, v10
    s_nop 0
    s_cbranch_vccnz Lr2f_pb_re
Lr2f_pb_ok:
    ds_write_b128 v0, v[40:43] offset:13056
    s_waitcnt lgkmcnt(3)
    v_smfmac_f32_16x16x64_bf16 v[12:15], v[40:43], v[56:63], v1
    ds_read_b128 v[56:59], v8 offset:8192
    ds_read_b128 v[60:63], v8 offset:9216
    v_smfmac_f32_16x16x64_bf16 v[20:23], v[40:43], a[24:31], v1
    s_waitcnt lgkmcnt(3)
    v_smfmac_f32_16x16x64_bf16 v[16:19], v[40:43], v[64:71], v1
    ds_read_b128 v[64:67], v8 offset:10240
    ds_read_b128 v[68:71], v8 offset:11264
    v_smfmac_f32_16x16x64_bf16 v[24:27], v[40:43], a[32:39], v1
    s_waitcnt lgkmcnt(4)
    s_barrier
    ds_read_b128 v[48:51], v0 offset:11008
    ds_read_b128 v[52:55], v0 offset:14080
    ds_read_b128 v[36:39], v0 offset:12032
    v_smfmac_f32_16x16x64_bf16 v[28:31], v[40:43], a[136:143], v1
    v_smfmac_f32_16x16x64_bf16 v[32:35], v[40:43], a[144:151], v1
    s_waitcnt lgkmcnt(2)
    v_smfmac_f32_16x16x64_bf16 v[12:15], v[48:51], v[56:63], v1
    v_smfmac_f32_16x16x64_bf16 v[16:19], v[48:51], v[64:71], v1
    s_waitcnt lgkmcnt(1)
    v_smfmac_f32_16x16x64_bf16 v[12:15], v[52:55], v[152:159], v1
    v_smfmac_f32_16x16x64_bf16 v[16:19], v[52:55], v[160:167], v1
    s_waitcnt lgkmcnt(0)
    v_smfmac_f32_16x16x64_bf16 v[12:15], v[36:39], v[136:143], v1
    v_smfmac_f32_16x16x64_bf16 v[16:19], v[36:39], v[144:151], v1
    s_waitcnt vmcnt(1)
    v_max3_u32 v10, v44, v45, v46
    v_max_u32 v10, v10, v47
    v_cmp_eq_u32 vcc, -1, v10
    s_nop 0
    s_cbranch_vccnz Lr2f_pc_re
Lr2f_pc_ok:
    v_smfmac_f32_16x16x64_bf16 v[12:15], v[44:47], v[168:175], v1
    v_smfmac_f32_16x16x64_bf16 v[16:19], v[44:47], v[176:183], v1
    v_smfmac_f32_16x16x64_bf16 v[20:23], v[48:51], v[248:255], v1
    v_smfmac_f32_16x16x64_bf16 v[24:27], v[48:51], a[0:7], v1
    v_smfmac_f32_16x16x64_bf16 v[20:23], v[52:55], a[40:47], v1
    v_add_f32 v12, v12, v14
    buffer_load_dwordx4 v[64:67], v0, s[8:11], s42 offen
    v_smfmac_f32_16x16x64_bf16 v[24:27], v[52:55], a[48:55], v1
    v_add_f32 v16, v16, v18
    v_smfmac_f32_16x16x64_bf16 v[20:23], v[36:39], a[8:15], v1
    v_add_f32 v13, v13, v15
    v_smfmac_f32_16x16x64_bf16 v[24:27], v[36:39], a[16:23], v1
    v_add_f32 v17, v17, v19
    v_smfmac_f32_16x16x64_bf16 v[20:23], v[44:47], a[56:63], v1
    v_cvt_pk_bf16_f32 v14, v12, v16
    ds_read_b128 v[56:59], v0 offset:15104
    buffer_load_dwordx4 v[68:71], v0, s[8:11], s42 offen offset:1024
    v_smfmac_f32_16x16x64_bf16 v[24:27], v[44:47], a[64:71], v1
    v_cvt_pk_bf16_f32 v15, v13, v17
    ds_read_b128 v[60:63], v0 offset:16128
    ds_write_b32 v2, v14 offset:576
    ds_write_b32 v2, v15 offset:864
    v_smfmac_f32_16x16x64_bf16 v[28:31], v[48:51], a[104:111], v1
    v_smfmac_f32_16x16x64_bf16 v[32:35], v[48:51], a[112:119], v1
    v_add_f32 v20, v20, v22
    v_add_f32 v24, v24, v26
    v_add_f32 v21, v21, v23
    v_add_f32 v25, v25, v27
    v_cvt_pk_bf16_f32 v22, v20, v24
    v_cvt_pk_bf16_f32 v23, v21, v25
    ds_write_b32 v2, v22 offset:0
    ds_write_b32 v2, v23 offset:288
    v_smfmac_f32_16x16x64_bf16 v[28:31], v[52:55], a[152:159], v1
    v_smfmac_f32_16x16x64_bf16 v[32:35], v[52:55], a[160:167], v1
    s_waitcnt vmcnt(2)
    v_cmp_eq_u32 vcc, 0, v11
    s_nop 0
    s_cbranch_vccnz Lr2f_flbad
Lr2f_flok:
    s_waitcnt lgkmcnt(0)
    s_barrier
    ds_read_b128 v[40:43], v3 offset:0
    ds_read_b128 v[48:51], v3 offset:64
    ds_read_b128 v[20:23], v3 offset:128
    ds_read_b128 v[52:55], v3 offset:192
    v_smfmac_f32_16x16x64_bf16 v[28:31], v[36:39], a[120:127], v1
    v_smfmac_f32_16x16x64_bf16 v[32:35], v[36:39], a[128:135], v1
    ds_read_b128 v[36:39], v0 offset:17152
    v_smfmac_f32_16x16x64_bf16 v[28:31], v[44:47], a[168:175], v1
    v_smfmac_f32_16x16x64_bf16 v[32:35], v[44:47], a[176:183], v1
    ds_read_b128 v[44:47], v0 offset:18176
    s_waitcnt lgkmcnt(5)
    v_mfma_f32_16x16x32_bf16 v[12:15], v[56:59], v[40:43], 0
    v_mfma_f32_16x16x32_bf16 v[16:19], v[60:63], v[40:43], 0
    v_mfma_f32_16x16x32_bf16 v[24:27], v[40:43], v[40:43], 0
    ds_read_b128 v[56:59], v0 offset:19200
    ds_read_b128 v[60:63], v0 offset:20224
    s_waitcnt lgkmcnt(3)
    v_mfma_f32_16x16x32_bf16 v[12:15], v[36:39], v[48:51], v[12:15]
    v_lshrrev_b32 v10, 1, v0
    v_lshrrev_b32 v9, 9, v0
    s_waitcnt lgkmcnt(2)
    v_mfma_f32_16x16x32_bf16 v[16:19], v[44:47], v[48:51], v[16:19]
    v_lshl_add_u32 v9, v9, 5, v10
    v_add_f32 v28, v28, v30
    v_mfma_f32_16x16x32_bf16 v[24:27], v[48:51], v[48:51], v[24:27]
    v_add_f32 v32, v32, v34
    v_add_f32 v29, v29, v31
    ds_read_b128 v[36:39], v0 offset:21248
    ds_read_b128 v[44:47], v0 offset:22272
    s_waitcnt lgkmcnt(3)
    v_mfma_f32_16x16x32_bf16 v[12:15], v[56:59], v[20:23], v[12:15]
    v_add_f32 v33, v33, v35
    v_cvt_pk_bf16_f32 v30, v28, v29
    s_waitcnt lgkmcnt(2)
    v_mfma_f32_16x16x32_bf16 v[16:19], v[60:63], v[20:23], v[16:19]
    v_cvt_pk_bf16_f32 v31, v32, v33
    ds_read_b64 v[34:35], v9 offset:2304
    v_mfma_f32_16x16x32_bf16 v[24:27], v[20:23], v[20:23], v[24:27]
    s_add_u32 s17, s43, 3072
    buffer_store_dwordx2 v[30:31], v10, s[8:11], s17 offen sc1
    s_waitcnt lgkmcnt(2)
    v_mfma_f32_16x16x32_bf16 v[12:15], v[36:39], v[52:55], v[12:15]
    s_waitcnt lgkmcnt(1)
    v_mfma_f32_16x16x32_bf16 v[16:19], v[44:47], v[52:55], v[16:19]
    v_mfma_f32_16x16x32_bf16 v[24:27], v[52:55], v[52:55], v[24:27]
    s_add_u32 s17, s43, 1024
    s_waitcnt lgkmcnt(0)
    buffer_store_dwordx2 v[34:35], v10, s[8:11], s17 offen sc1
    ds_read_b128 v[56:59], v8 offset:16384
    ds_read_b128 v[60:63], v8 offset:17408
    v_mov_b64 v[20:21], s[52:53]
    v_mov_b64 v[22:23], s[52:53]
    v_mov_b32 v41, 0
    v_mov_b32 v42, 0
    v_max3_f32 v9, v12, v13, v14
    v_max3_f32 v9, v9, v15, v16
    v_max3_f32 v9, v9, v17, v18
    v_max3_f32 v9, v9, v19, v24
    v_max_f32 v9, v9, v25
    v_mov_b32 v10, v9
    v_mov_b64 v[32:33], 0
    v_mov_b64 v[34:35], 0
    v_permlane32_swap_b32 v9, v10
    v_max_f32 v9, v9, v10
    v_mov_b32 v10, v9
    s_nop 1
    v_permlane16_swap_b32 v9, v10
    v_max_f32 v9, v9, v10
    v_mul_f32 v28, s44, v9
    v_fma_f32 v12, v12, s44, -v28
    v_fma_f32 v13, v13, s44, -v28
    v_fma_f32 v14, v14, s44, -v28
    v_fma_f32 v15, v15, s44, -v28
    v_exp_f32 v12, v12
    v_exp_f32 v13, v13
    v_fma_f32 v16, v16, s44, -v28
    v_fma_f32 v17, v17, s44, -v28
    v_exp_f32 v14, v14
    v_exp_f32 v15, v15
    v_cvt_pk_bf16_f32 v36, v12, v13
    v_fma_f32 v18, v18, s44, -v28
    v_fma_f32 v19, v19, s44, -v28
    v_exp_f32 v16, v16
    v_exp_f32 v17, v17
    v_cvt_pk_bf16_f32 v37, v14, v15
    v_fma_f32 v24, v24, s44, -v28
    v_fma_f32 v25, v25, s44, -v28
    v_exp_f32 v18, v18
    v_exp_f32 v19, v19
    v_cvt_pk_bf16_f32 v38, v16, v17
    v_exp_f32 v24, v24
    v_exp_f32 v25, v25
    v_cvt_pk_bf16_f32 v39, v18, v19
    v_cvt_pk_bf16_f32 v40, v24, v25
    v_cvt_pk_bf16_f32 v43, v24, v25
    v_mfma_f32_16x16x32_bf16 v[52:55], v[20:23], v[36:39], 0
    v_mov_b64 v[12:13], 0
    v_mov_b64 v[14:15], 0
    s_waitcnt vmcnt(3)
    v_mfma_f32_16x16x32_bf16 v[44:47], v[64:67], v[36:39], 0
    v_mov_b64 v[24:25], 0
    v_mov_b64 v[26:27], 0
    s_waitcnt vmcnt(2)
    v_mfma_f32_16x16x32_bf16 v[48:51], v[68:71], v[36:39], 0
    ds_read_b128 v[64:67], v8 offset:20480
    ds_read_b128 v[68:71], v8 offset:21504
    v_mfma_f32_16x16x16_bf16 v[52:55], v[20:21], v[40:41], v[52:55]
    v_mfma_f32_16x16x16_bf16 v[44:47], v[30:31], v[40:41], v[44:47]
    v_mov_b64 v[20:21], 0
    v_mov_b64 v[22:23], 0
    v_mfma_f32_16x16x16_bf16 v[48:51], v[30:31], v[42:43], v[48:51]
    v_mov_b64 v[36:37], 0
    v_mov_b64 v[38:39], 0
    v_mov_b64 v[40:41], 0
    v_mov_b64 v[42:43], 0
    v_rcp_f32 v9, v52
    v_mov_b64 v[52:53], 0
    v_mov_b64 v[54:55], 0
    v_mul_f32 v44, v9, v44
    v_mul_f32 v48, v9, v48
    v_cvt_pk_bf16_f32 v16, v44, v48
    v_mul_f32 v45, v9, v45
    v_mul_f32 v49, v9, v49
    v_cvt_pk_bf16_f32 v17, v45, v49
    v_mul_f32 v46, v9, v46
    v_mul_f32 v50, v9, v50
    v_cvt_pk_bf16_f32 v18, v46, v50
    v_mul_f32 v47, v9, v47
    v_mul_f32 v51, v9, v51
    v_cvt_pk_bf16_f32 v19, v47, v51
    ds_write_b128 v5, v[16:19]
    v_mov_b64 v[28:29], 0
    v_mov_b64 v[30:31], 0
    s_waitcnt lgkmcnt(0)
    s_barrier
    ds_read_b128 v[44:47], v4 offset:0
    ds_read_b128 v[48:51], v4 offset:128
    s_cmp_eq_u32 s33, 63
    s_cbranch_scc1 Lr2f_last
    v_mov_b64 v[16:17], 0
    v_mov_b64 v[18:19], 0
    buffer_load_dwordx4 v0, s[8:11], s41 offen offset:0 lds
    buffer_load_dwordx4 v0, s[8:11], s41 offen offset:1024 lds
    s_waitcnt lgkmcnt(1)
    v_smfmac_f32_16x16x64_bf16 v[12:15], v[44:47], a[184:191], v1
    s_waitcnt lgkmcnt(0)
    v_smfmac_f32_16x16x64_bf16 v[12:15], v[48:51], a[192:199], v1
    v_smfmac_f32_16x16x64_bf16 v[24:27], v[44:47], a[200:207], v1
    v_smfmac_f32_16x16x64_bf16 v[24:27], v[48:51], a[208:215], v1
    v_add_f32 v12, v12, v14
    v_smfmac_f32_16x16x64_bf16 v[20:23], v[44:47], a[216:223], v1
    v_add_f32 v13, v13, v15
    v_smfmac_f32_16x16x64_bf16 v[20:23], v[48:51], a[224:231], v1
    v_cvt_pk_bf16_f32 v12, v12, v13
    v_smfmac_f32_16x16x64_bf16 v[16:19], v[44:47], a[232:239], v1
    v_add_f32 v24, v24, v26
    v_smfmac_f32_16x16x64_bf16 v[16:19], v[48:51], a[240:247], v1
    v_add_f32 v25, v25, v27
    v_smfmac_f32_16x16x64_bf16 v[36:39], v[44:47], v[56:63], v1
    v_cvt_pk_bf16_f32 v13, v24, v25
    v_smfmac_f32_16x16x64_bf16 v[36:39], v[48:51], v[64:71], v1
    v_add_f32 v20, v20, v22
    v_add_f32 v21, v21, v23
    v_cvt_pk_bf16_f32 v14, v20, v21
    v_add_f32 v16, v16, v18
    v_add_f32 v17, v17, v19
    v_cvt_pk_bf16_f32 v15, v16, v17
    v_and_or_b32 v15, v15, -2, s40
    buffer_store_dwordx4 v[12:15], v0, s[8:11], s38 offen
    s_nop 0
    ds_read_b128 v[12:15], v8 offset:18432
    ds_read_b128 v[16:19], v8 offset:19456
    ds_read_b128 v[20:23], v8 offset:22528
    ds_read_b128 v[24:27], v8 offset:23552
    ds_read_b128 v[56:59], v8 offset:24576
    ds_read_b128 v[60:63], v8 offset:25600
    ds_read_b128 v[64:67], v8 offset:28672
    ds_read_b128 v[68:71], v8 offset:29696
    s_waitcnt lgkmcnt(6)
    v_smfmac_f32_16x16x64_bf16 v[40:43], v[44:47], v[12:19], v1
    ds_read_b128 v[12:15], v8 offset:26624
    ds_read_b128 v[16:19], v8 offset:27648
    s_waitcnt lgkmcnt(6)
    v_smfmac_f32_16x16x64_bf16 v[40:43], v[48:51], v[20:27], v1
    ds_read_b128 v[20:23], v8 offset:30720
    ds_read_b128 v[24:27], v8 offset:31744
    s_waitcnt lgkmcnt(6)
    v_smfmac_f32_16x16x64_bf16 v[52:55], v[44:47], v[56:63], v1
    ds_read_b128 v[56:59], v8 offset:32768
    ds_read_b128 v[60:63], v8 offset:33792
    s_waitcnt lgkmcnt(6)
    v_smfmac_f32_16x16x64_bf16 v[52:55], v[48:51], v[64:71], v1
    s_waitcnt lgkmcnt(4)
    v_smfmac_f32_16x16x64_bf16 v[32:35], v[44:47], v[12:19], v1
    s_waitcnt lgkmcnt(2)
    v_smfmac_f32_16x16x64_bf16 v[32:35], v[48:51], v[20:27], v1
    v_smfmac_f32_16x16x64_bf16 v[28:31], v[44:47], a[248:255], v1
    s_waitcnt lgkmcnt(0)
    v_smfmac_f32_16x16x64_bf16 v[28:31], v[48:51], v[56:63], v1
    v_add_f32 v36, v36, v38
    v_add_f32 v37, v37, v39
    v_cvt_pk_bf16_f32 v36, v36, v37
    v_add_f32 v40, v40, v42
    v_add_f32 v41, v41, v43
    v_cvt_pk_bf16_f32 v37, v40, v41
    v_add_f32 v52, v52, v54
    v_add_f32 v53, v53, v55
    v_cvt_pk_bf16_f32 v38, v52, v53
    v_add_f32 v32, v32, v34
    v_add_f32 v33, v33, v35
    v_cvt_pk_bf16_f32 v39, v32, v33
    v_and_or_b32 v39, v39, -2, s40
    s_add_u32 s17, s38, 4096
    buffer_store_dwordx4 v[36:39], v0, s[8:11], s17 offen
    v_add_f32 v28, v28, v30
    v_add_f32 v29, v29, v31
    v_cvt_pk_bf16_f32 v28, v28, v29
    v_and_or_b32 v28, v28, -2, s40
    v_lshrrev_b32 v9, 2, v0
    buffer_store_dword v28, v9, s[8:11], s39 offen
    v_add_u32 v10, 162560, v0
    ds_read_b32 v64, v10
    v_mov_b32 v65, 0
    v_mov_b32 v41, 0
    v_mov_b32 v45, 0
    v_mov_b32 v49, 0
    v_mov_b32 v53, 0
    s_add_u32 s33, s33, 1
    s_add_u32 s42, s42, 262144
    s_add_u32 s41, s41, 262144
    s_add_u32 s43, s43, 131072
    s_add_u32 s68, s68, 262144
    s_add_u32 s66, s66, 22528
    ds_read_b128 v[56:59], v8 offset:4096
    ds_read_b128 v[60:63], v8 offset:5120
    v_mov_b64 v[12:13], 0
    v_mov_b64 v[14:15], 0
    v_mov_b64 v[16:17], 0
    v_mov_b64 v[18:19], 0
    v_mov_b64 v[20:21], 0
    v_mov_b64 v[22:23], 0
    v_mov_b64 v[24:25], 0
    v_mov_b64 v[26:27], 0
    v_mov_b64 v[28:29], 0
    v_mov_b64 v[30:31], 0
    v_mov_b64 v[32:33], 0
    v_mov_b64 v[34:35], 0
    s_nop 15
    s_nop 15
    s_nop 15
    s_nop 1
    buffer_load_dword v40, v6, s[8:11], s62 offen sc1
    buffer_load_dword v44, v6, s[8:11], s63 offen sc1
    buffer_load_dword v48, v6, s[8:11], s64 offen sc1
    buffer_load_dword v52, v6, s[8:11], s65 offen sc1
    s_waitcnt lgkmcnt(0)
    s_waitcnt vmcnt(3)
    v_mfma_f32_16x16x16_bf16 v[68:71], v[40:41], v[64:65], 0
    v_and_b32 v10, 1, v40
    v_cmp_ne_u32 s[54:55], s40, v10
    s_waitcnt vmcnt(2)
    v_mfma_f32_16x16x16_bf16 v[68:71], v[44:45], v[64:65], v[68:71]
    v_and_b32 v10, 1, v44
    v_cmp_ne_u32 s[56:57], s40, v10
    s_waitcnt vmcnt(1)
    v_mfma_f32_16x16x16_bf16 v[68:71], v[48:49], v[64:65], v[68:71]
    v_and_b32 v10, 1, v48
    v_cmp_ne_u32 s[58:59], s40, v10
    s_waitcnt vmcnt(0)
    v_mfma_f32_16x16x16_bf16 v[68:71], v[52:53], v[64:65], v[68:71]
    v_and_b32 v10, 1, v52
    v_cmp_ne_u32 s[60:61], s40, v10
    s_or_b64 vcc, s[54:55], s[56:57]
    s_or_b64 vcc, vcc, s[58:59]
    s_or_b64 vcc, vcc, s[60:61]
    s_cbranch_scc0 Lr2f_red
    s_mov_b32 s16, 0
Lr2f_p1:
    s_mov_b64 exec, s[54:55]
    buffer_load_dword v40, v6, s[8:11], s62 offen sc1
    s_mov_b64 exec, s[56:57]
    buffer_load_dword v44, v6, s[8:11], s63 offen sc1
    s_mov_b64 exec, s[58:59]
    buffer_load_dword v48, v6, s[8:11], s64 offen sc1
    s_mov_b64 exec, s[60:61]
    buffer_load_dword v52, v6, s[8:11], s65 offen sc1
    s_mov_b64 exec, -1
    s_add_u32 s16, s16, 1
    s_cmp_gt_u32 s16, 100000
    s_cbranch_scc1 Lr_abort
    s_waitcnt vmcnt(3)
    v_mfma_f32_16x16x16_bf16 v[68:71], v[40:41], v[64:65], 0
    v_and_b32 v10, 1, v40
    v_cmp_ne_u32 s[54:55], s40, v10
    s_waitcnt vmcnt(2)
    v_mfma_f32_16x16x16_bf16 v[68:71], v[44:45], v[64:65], v[68:71]
    v_and_b32 v10, 1, v44
    v_cmp_ne_u32 s[56:57], s40, v10
    s_waitcnt vmcnt(1)
    v_mfma_f32_16x16x16_bf16 v[68:71], v[48:49], v[64:65], v[68:71]
    v_and_b32 v10, 1, v48
    v_cmp_ne_u32 s[58:59], s40, v10
    s_waitcnt vmcnt(0)
    v_mfma_f32_16x16x16_bf16 v[68:71], v[52:53], v[64:65], v[68:71]
    v_and_b32 v10, 1, v52
    v_cmp_ne_u32 s[60:61], s40, v10
    s_or_b64 vcc, s[54:55], s[56:57]
    s_or_b64 vcc, vcc, s[58:59]
    s_or_b64 vcc, vcc, s[60:61]
    s_cbranch_scc1 Lr2f_p1
Lr2f_red:
    s_xor_b32 s34, s34, 16384
    s_xor_b32 s35, s35, 16384
    buffer_load_dwordx4 v[36:39], v0, s[8:11], s34 offen sc1
    v_permlane16_swap_b32 v68, v70
    v_permlane16_swap_b32 v69, v71
    s_mov_b64 exec, s[46:47]
    v_add_f32 v68, v68, v70
    v_add_f32 v69, v69, v71
    v_cvt_pk_bf16_f32 v68, v68, v69
    v_min_u32 v68, s50, v68
    buffer_store_dword v68, v7, s[8:11], s36 offen
    v_mov_b32 v69, -1
    buffer_store_dword v69, v7, s[8:11], s37 offen
    s_mov_b64 exec, -1
    buffer_load_dwordx4 v[36:39], v0, s[8:11], s34 offen sc1
    s_xor_b32 s40, s40, 1
    s_xor_b32 s36, s36, 16384
    s_xor_b32 s37, s37, 16384
    ds_read_b128 v[64:67], v8 offset:6144
    ds_read_b128 v[68:71], v8 offset:7168
    s_waitcnt lgkmcnt(0)
    s_branch Lr2f_step
Lr2f_pb_re:
    s_mov_b32 s16, 0
Lr2f_pb_lp:
    s_add_u32 s17, s34, 4096
    buffer_load_dwordx4 v[40:43], v0, s[8:11], s17 offen sc1
    s_add_u32 s16, s16, 1
    s_cmp_gt_u32 s16, 100000
    s_cbranch_scc1 Lr_abort
    s_waitcnt vmcnt(0)
    v_max3_u32 v10, v40, v41, v42
    v_max_u32 v10, v10, v43
    v_cmp_eq_u32 vcc, -1, v10
    s_nop 0
    s_cbranch_vccnz Lr2f_pb_lp
    s_branch Lr2f_pb_ok
Lr2f_pc_re:
    s_mov_b32 s16, 0
Lr2f_pc_lp:
    buffer_load_dwordx4 v[44:47], v0, s[8:11], s35 offen sc1
    s_add_u32 s16, s16, 1
    s_cmp_gt_u32 s16, 100000
    s_cbranch_scc1 Lr_abort
    s_waitcnt vmcnt(0)
    v_max3_u32 v10, v44, v45, v46
    v_max_u32 v10, v10, v47
    v_cmp_eq_u32 vcc, -1, v10
    s_nop 0
    s_cbranch_vccnz Lr2f_pc_lp
    s_branch Lr2f_pc_ok
Lr2f_flbad:
    s_cmp_eq_u32 s33, 63
    s_cbranch_scc1 Lr2f_flok
    s_mov_b32 s16, 0
    s_add_u32 s17, s66, 22656
    v_lshrrev_b32 v10, 2, v0
    v_and_b32 v9, 16, v10
    v_lshlrev_b32 v9, 3, v9
    v_and_or_b32 v10, v10, 12, v9
Lr2f_fw_13:
    buffer_load_dword v9, v10, s[8:11], s17 offen sc1
    s_add_u32 s16, s16, 1
    s_cmp_gt_u32 s16, 100000
    s_cbranch_scc1 Lr_abort
    s_waitcnt vmcnt(0)
    v_cmp_eq_u32 vcc, 0, v9
    s_nop 0
    s_cbranch_vccnz Lr2f_fw_13
    s_branch Lr2f_flok
Lr2f_last:
    s_waitcnt vmcnt(0) lgkmcnt(0)
    s_barrier
    s_branch Lr_exit
L_w3_1:
    s_mov_b32 s16, 0
    s_add_u32 s17, s66, 128
    v_lshrrev_b32 v10, 2, v0
    v_and_b32 v9, 16, v10
    v_lshlrev_b32 v9, 3, v9
    v_and_or_b32 v10, v10, 12, v9
Lr3f_fw_14:
    buffer_load_dword v9, v10, s[8:11], s17 offen sc1
    s_add_u32 s16, s16, 1
    s_cmp_gt_u32 s16, 100000
    s_cbranch_scc1 Lr_abort
    s_waitcnt vmcnt(0)
    v_cmp_eq_u32 vcc, 0, v9
    s_nop 0
    s_cbranch_vccnz Lr3f_fw_14
    s_mov_b32 m0, 21248
    s_nop 0
    buffer_load_dwordx4 v0, s[8:11], s41 offen offset:0 lds
    buffer_load_dwordx4 v0, s[8:11], s41 offen offset:1024 lds
    s_add_u32 s41, s41, 262144
    s_add_u32 s68, s68, 262144
    s_waitcnt vmcnt(0)
    ds_read_b128 v[56:59], v8 offset:0
    ds_read_b128 v[60:63], v8 offset:1024
    ds_read_b128 v[64:67], v8 offset:2048
    ds_read_b128 v[68:71], v8 offset:3072
    v_mov_b64 v[12:13], 0
    v_mov_b64 v[14:15], 0
    v_mov_b64 v[16:17], 0
    v_mov_b64 v[18:19], 0
    v_mov_b64 v[20:21], 0
    v_mov_b64 v[22:23], 0
    v_mov_b64 v[24:25], 0
    v_mov_b64 v[26:27], 0
    v_mov_b64 v[28:29], 0
    v_mov_b64 v[30:31], 0
    v_mov_b64 v[32:33], 0
    v_mov_b64 v[34:35], 0
    buffer_load_dwordx4 v[36:39], v0, s[8:11], s34 offen sc1
    s_waitcnt vmcnt(0) lgkmcnt(0)
Lr3f_step:
    s_mov_b32 s16, 0
Lr3f_alp:
    s_waitcnt vmcnt(2)
    v_max3_u32 v10, v36, v37, v38
    v_max_u32 v10, v10, v39
    v_cmp_eq_u32 vcc, -1, v10
    s_nop 0
    s_cbranch_vccz Lr3f_aok
    buffer_load_dwordx4 v[36:39], v0, s[8:11], s34 offen sc1
    s_add_u32 s16, s16, 1
    s_cmp_gt_u32 s16, 100000
    s_cbranch_scc1 Lr_abort
    s_branch Lr3f_alp
Lr3f_aok:
    ds_write_b128 v0, v[36:39] offset:9984
    v_smfmac_f32_16x16x64_bf16 v[12:15], v[36:39], v[120:127], v1
    v_smfmac_f32_16x16x64_bf16 v[16:19], v[36:39], v[128:135], v1
    v_smfmac_f32_16x16x64_bf16 v[20:23], v[36:39], v[232:239], v1
    s_waitcnt lgkmcnt(0)
    s_barrier
    ds_read_b128 v[48:51], v0 offset:6912
    ds_read_b128 v[52:55], v0 offset:7936
    v_smfmac_f32_16x16x64_bf16 v[28:31], v[36:39], a[88:95], v1
    v_smfmac_f32_16x16x64_bf16 v[24:27], v[36:39], v[240:247], v1
    v_smfmac_f32_16x16x64_bf16 v[32:35], v[36:39], a[96:103], v1
    s_waitcnt vmcnt(0)
    ds_read_b128 v[36:39], v0 offset:8960
    s_waitcnt lgkmcnt(2)
    v_smfmac_f32_16x16x64_bf16 v[28:31], v[48:51], v[56:63], v1
    ds_read_b128 v[56:59], v8 offset:4096
    ds_read_b128 v[60:63], v8 offset:5120
    s_add_u32 s17, s34, 4096
    buffer_load_dwordx4 v[40:43], v0, s[8:11], s17 offen sc1
    v_smfmac_f32_16x16x64_bf16 v[12:15], v[48:51], v[72:79], v1
    v_smfmac_f32_16x16x64_bf16 v[16:19], v[48:51], v[80:87], v1
    v_smfmac_f32_16x16x64_bf16 v[32:35], v[48:51], v[64:71], v1
    ds_read_b128 v[64:67], v8 offset:6144
    ds_read_b128 v[68:71], v8 offset:7168
    v_smfmac_f32_16x16x64_bf16 v[20:23], v[48:51], v[184:191], v1
    buffer_load_dwordx4 v[44:47], v0, s[8:11], s35 offen sc1
    v_smfmac_f32_16x16x64_bf16 v[24:27], v[48:51], v[192:199], v1
    s_waitcnt lgkmcnt(5)
    v_smfmac_f32_16x16x64_bf16 v[28:31], v[52:55], a[72:79], v1
    v_smfmac_f32_16x16x64_bf16 v[12:15], v[52:55], v[88:95], v1
    v_smfmac_f32_16x16x64_bf16 v[16:19], v[52:55], v[96:103], v1
    v_smfmac_f32_16x16x64_bf16 v[32:35], v[52:55], a[80:87], v1
    v_smfmac_f32_16x16x64_bf16 v[20:23], v[52:55], v[200:207], v1
    v_smfmac_f32_16x16x64_bf16 v[24:27], v[52:55], v[208:215], v1
    s_waitcnt lgkmcnt(2)
    v_smfmac_f32_16x16x64_bf16 v[28:31], v[36:39], v[56:63], v1
    ds_read_b128 v[56:59], v8 offset:8192
    ds_read_b128 v[60:63], v8 offset:9216
    v_smfmac_f32_16x16x64_bf16 v[12:15], v[36:39], v[104:111], v1
    v_smfmac_f32_16x16x64_bf16 v[16:19], v[36:39], v[112:119], v1
    s_waitcnt lgkmcnt(2)
    v_smfmac_f32_16x16x64_bf16 v[32:35], v[36:39], v[64:71], v1
    ds_read_b128 v[64:67], v8 offset:10240
    ds_read_b128 v[68:71], v8 offset:11264
    v_smfmac_f32_16x16x64_bf16 v[20:23], v[36:39], v[216:223], v1
    v_smfmac_f32_16x16x64_bf16 v[24:27], v[36:39], v[224:231], v1
    s_waitcnt vmcnt(1)
    v_max3_u32 v10, v40, v41, v42
    v_max_u32 v10, v10, v43
    v_cmp_eq_u32 vcc, -1, v10
    s_nop 0
    s_cbranch_vccnz Lr3f_pb_re
Lr3f_pb_ok:
    ds_write_b128 v0, v[40:43] offset:14080
    v_smfmac_f32_16x16x64_bf16 v[12:15], v[40:43], v[152:159], v1
    v_smfmac_f32_16x16x64_bf16 v[20:23], v[40:43], a[40:47], v1
    v_smfmac_f32_16x16x64_bf16 v[16:19], v[40:43], v[160:167], v1
    v_smfmac_f32_16x16x64_bf16 v[24:27], v[40:43], a[48:55], v1
    s_waitcnt lgkmcnt(0)
    s_barrier
    ds_read_b128 v[48:51], v0 offset:11008
    ds_read_b128 v[52:55], v0 offset:12032
    ds_read_b128 v[36:39], v0 offset:13056
    v_smfmac_f32_16x16x64_bf16 v[28:31], v[40:43], a[152:159], v1
    v_smfmac_f32_16x16x64_bf16 v[32:35], v[40:43], a[160:167], v1
    s_waitcnt lgkmcnt(2)
    v_smfmac_f32_16x16x64_bf16 v[12:15], v[48:51], v[56:63], v1
    ds_read_b128 v[56:59], v8 offset:12288
    ds_read_b128 v[60:63], v8 offset:13312
    v_smfmac_f32_16x16x64_bf16 v[16:19], v[48:51], v[64:71], v1
    ds_read_b128 v[64:67], v8 offset:14336
    ds_read_b128 v[68:71], v8 offset:15360
    s_waitcnt lgkmcnt(5)
    v_smfmac_f32_16x16x64_bf16 v[12:15], v[52:55], v[136:143], v1
    v_smfmac_f32_16x16x64_bf16 v[16:19], v[52:55], v[144:151], v1
    s_waitcnt vmcnt(0)
    v_max3_u32 v10, v44, v45, v46
    v_max_u32 v10, v10, v47
    v_cmp_eq_u32 vcc, -1, v10
    s_nop 0
    s_cbranch_vccnz Lr3f_pc_re
Lr3f_pc_ok:
    v_smfmac_f32_16x16x64_bf16 v[12:15], v[44:47], v[168:175], v1
    v_smfmac_f32_16x16x64_bf16 v[16:19], v[44:47], v[176:183], v1
    s_waitcnt lgkmcnt(2)
    v_smfmac_f32_16x16x64_bf16 v[12:15], v[36:39], v[56:63], v1
    s_waitcnt lgkmcnt(0)
    v_smfmac_f32_16x16x64_bf16 v[16:19], v[36:39], v[64:71], v1
    v_smfmac_f32_16x16x64_bf16 v[20:23], v[48:51], v[248:255], v1
    v_smfmac_f32_16x16x64_bf16 v[24:27], v[48:51], a[0:7], v1
    v_smfmac_f32_16x16x64_bf16 v[20:23], v[52:55], a[8:15], v1
    v_add_f32 v12, v12, v14
    v_smfmac_f32_16x16x64_bf16 v[24:27], v[52:55], a[16:23], v1
    v_add_f32 v16, v16, v18
    buffer_load_dwordx4 v[64:67], v0, s[8:11], s42 offen
    v_smfmac_f32_16x16x64_bf16 v[20:23], v[36:39], a[24:31], v1
    v_add_f32 v13, v13, v15
    v_smfmac_f32_16x16x64_bf16 v[24:27], v[36:39], a[32:39], v1
    v_add_f32 v17, v17, v19
    v_smfmac_f32_16x16x64_bf16 v[20:23], v[44:47], a[56:63], v1
    v_cvt_pk_bf16_f32 v14, v12, v16
    ds_read_b128 v[56:59], v0 offset:15104
    v_smfmac_f32_16x16x64_bf16 v[24:27], v[44:47], a[64:71], v1
    v_cvt_pk_bf16_f32 v15, v13, v17
    ds_read_b128 v[60:63], v0 offset:16128
    buffer_load_dwordx4 v[68:71], v0, s[8:11], s42 offen offset:1024
    ds_write_b32 v2, v14 offset:576
    ds_write_b32 v2, v15 offset:864
    v_smfmac_f32_16x16x64_bf16 v[28:31], v[48:51], a[104:111], v1
    v_smfmac_f32_16x16x64_bf16 v[32:35], v[48:51], a[112:119], v1
    v_add_f32 v20, v20, v22
    v_add_f32 v24, v24, v26
    v_add_f32 v21, v21, v23
    v_add_f32 v25, v25, v27
    v_cvt_pk_bf16_f32 v22, v20, v24
    v_cvt_pk_bf16_f32 v23, v21, v25
    ds_write_b32 v2, v22 offset:0
    ds_write_b32 v2, v23 offset:288
    v_smfmac_f32_16x16x64_bf16 v[28:31], v[52:55], a[120:127], v1
    v_smfmac_f32_16x16x64_bf16 v[32:35], v[52:55], a[128:135], v1
    s_waitcnt lgkmcnt(0)
    s_barrier
    ds_read_b128 v[40:43], v3 offset:0
    ds_read_b128 v[48:51], v3 offset:64
    ds_read_b128 v[20:23], v3 offset:128
    ds_read_b128 v[52:55], v3 offset:192
    v_smfmac_f32_16x16x64_bf16 v[28:31], v[36:39], a[136:143], v1
    v_smfmac_f32_16x16x64_bf16 v[32:35], v[36:39], a[144:151], v1
    ds_read_b128 v[36:39], v0 offset:17152
    v_lshlrev_b32 v9, 3, v0
    buffer_load_dword v11, v9, s[8:11], s68 offen
    v_smfmac_f32_16x16x64_bf16 v[28:31], v[44:47], a[168:175], v1
    v_smfmac_f32_16x16x64_bf16 v[32:35], v[44:47], a[176:183], v1
    ds_read_b128 v[44:47], v0 offset:18176
    s_waitcnt lgkmcnt(5)
    v_mfma_f32_16x16x32_bf16 v[12:15], v[56:59], v[40:43], 0
    v_mfma_f32_16x16x32_bf16 v[16:19], v[60:63], v[40:43], 0
    v_mfma_f32_16x16x32_bf16 v[24:27], v[40:43], v[40:43], 0
    ds_read_b128 v[56:59], v0 offset:19200
    ds_read_b128 v[60:63], v0 offset:20224
    s_waitcnt lgkmcnt(3)
    v_mfma_f32_16x16x32_bf16 v[12:15], v[36:39], v[48:51], v[12:15]
    v_lshrrev_b32 v10, 1, v0
    v_lshrrev_b32 v9, 9, v0
    s_waitcnt lgkmcnt(2)
    v_mfma_f32_16x16x32_bf16 v[16:19], v[44:47], v[48:51], v[16:19]
    v_lshl_add_u32 v9, v9, 5, v10
    v_add_f32 v28, v28, v30
    v_mfma_f32_16x16x32_bf16 v[24:27], v[48:51], v[48:51], v[24:27]
    v_add_f32 v32, v32, v34
    v_add_f32 v29, v29, v31
    ds_read_b128 v[36:39], v0 offset:21248
    ds_read_b128 v[44:47], v0 offset:22272
    s_waitcnt lgkmcnt(3)
    v_mfma_f32_16x16x32_bf16 v[12:15], v[56:59], v[20:23], v[12:15]
    v_add_f32 v33, v33, v35
    v_cvt_pk_bf16_f32 v30, v28, v29
    s_waitcnt lgkmcnt(2)
    v_mfma_f32_16x16x32_bf16 v[16:19], v[60:63], v[20:23], v[16:19]
    v_cvt_pk_bf16_f32 v31, v32, v33
    ds_read_b64 v[34:35], v9 offset:3456
    v_mfma_f32_16x16x32_bf16 v[24:27], v[20:23], v[20:23], v[24:27]
    s_add_u32 s17, s43, 3584
    buffer_store_dwordx2 v[30:31], v10, s[8:11], s17 offen sc1
    s_waitcnt lgkmcnt(2)
    v_mfma_f32_16x16x32_bf16 v[12:15], v[36:39], v[52:55], v[12:15]
    s_waitcnt lgkmcnt(1)
    v_mfma_f32_16x16x32_bf16 v[16:19], v[44:47], v[52:55], v[16:19]
    v_mfma_f32_16x16x32_bf16 v[24:27], v[52:55], v[52:55], v[24:27]
    s_add_u32 s17, s43, 1536
    s_waitcnt lgkmcnt(0)
    buffer_store_dwordx2 v[34:35], v10, s[8:11], s17 offen sc1
    ds_read_b128 v[56:59], v8 offset:16384
    ds_read_b128 v[60:63], v8 offset:17408
    v_mov_b64 v[20:21], s[52:53]
    v_mov_b64 v[22:23], s[52:53]
    v_mov_b32 v41, 0
    v_mov_b32 v42, 0
    v_max3_f32 v9, v12, v13, v14
    v_max3_f32 v9, v9, v15, v16
    v_max3_f32 v9, v9, v17, v18
    v_max3_f32 v9, v9, v19, v24
    v_max_f32 v9, v9, v25
    v_mov_b32 v10, v9
    v_mov_b64 v[32:33], 0
    v_mov_b64 v[34:35], 0
    v_permlane32_swap_b32 v9, v10
    v_max_f32 v9, v9, v10
    v_mov_b32 v10, v9
    s_nop 1
    v_permlane16_swap_b32 v9, v10
    v_max_f32 v9, v9, v10
    v_mul_f32 v28, s44, v9
    v_fma_f32 v12, v12, s44, -v28
    v_fma_f32 v13, v13, s44, -v28
    v_fma_f32 v14, v14, s44, -v28
    v_fma_f32 v15, v15, s44, -v28
    v_exp_f32 v12, v12
    v_exp_f32 v13, v13
    v_fma_f32 v16, v16, s44, -v28
    v_fma_f32 v17, v17, s44, -v28
    v_exp_f32 v14, v14
    v_exp_f32 v15, v15
    v_cvt_pk_bf16_f32 v36, v12, v13
    v_fma_f32 v18, v18, s44, -v28
    v_fma_f32 v19, v19, s44, -v28
    v_exp_f32 v16, v16
    v_exp_f32 v17, v17
    v_cvt_pk_bf16_f32 v37, v14, v15
    v_fma_f32 v24, v24, s44, -v28
    v_fma_f32 v25, v25, s44, -v28
    v_exp_f32 v18, v18
    v_exp_f32 v19, v19
    v_cvt_pk_bf16_f32 v38, v16, v17
    v_exp_f32 v24, v24
    v_exp_f32 v25, v25
    v_cvt_pk_bf16_f32 v39, v18, v19
    v_cvt_pk_bf16_f32 v40, v24, v25
    v_cvt_pk_bf16_f32 v43, v24, v25
    v_mfma_f32_16x16x32_bf16 v[52:55], v[20:23], v[36:39], 0
    v_mov_b64 v[12:13], 0
    v_mov_b64 v[14:15], 0
    s_waitcnt vmcnt(4)
    v_mfma_f32_16x16x32_bf16 v[44:47], v[64:67], v[36:39], 0
    v_mov_b64 v[24:25], 0
    v_mov_b64 v[26:27], 0
    s_waitcnt vmcnt(3)
    v_mfma_f32_16x16x32_bf16 v[48:51], v[68:71], v[36:39], 0
    ds_read_b128 v[64:67], v8 offset:20480
    ds_read_b128 v[68:71], v8 offset:21504
    v_mfma_f32_16x16x16_bf16 v[52:55], v[20:21], v[40:41], v[52:55]
    v_mfma_f32_16x16x16_bf16 v[44:47], v[30:31], v[40:41], v[44:47]
    v_mov_b64 v[20:21], 0
    v_mov_b64 v[22:23], 0
    v_mfma_f32_16x16x16_bf16 v[48:51], v[30:31], v[42:43], v[48:51]
    v_mov_b64 v[36:37], 0
    v_mov_b64 v[38:39], 0
    v_mov_b64 v[40:41], 0
    v_mov_b64 v[42:43], 0
    v_rcp_f32 v9, v52
    v_mov_b64 v[52:53], 0
    v_mov_b64 v[54:55], 0
    v_mul_f32 v44, v9, v44
    v_mul_f32 v48, v9, v48
    v_cvt_pk_bf16_f32 v16, v44, v48
    v_mul_f32 v45, v9, v45
    v_mul_f32 v49, v9, v49
    v_cvt_pk_bf16_f32 v17, v45, v49
    v_mul_f32 v46, v9, v46
    v_mul_f32 v50, v9, v50
    v_cvt_pk_bf16_f32 v18, v46, v50
    v_mul_f32 v47, v9, v47
    v_mul_f32 v51, v9, v51
    v_cvt_pk_bf16_f32 v19, v47, v51
    ds_write_b128 v5, v[16:19]
    v_mov_b64 v[28:29], 0
    v_mov_b64 v[30:31], 0
    s_waitcnt lgkmcnt(0)
    s_barrier
    ds_read_b128 v[44:47], v4 offset:0
    ds_read_b128 v[48:51], v4 offset:128
    s_cmp_eq_u32 s33, 63
    s_cbranch_scc1 Lr3f_last
    v_mov_b64 v[16:17], 0
    v_mov_b64 v[18:19], 0
    buffer_load_dwordx4 v0, s[8:11], s41 offen offset:0 lds
    buffer_load_dwordx4 v0, s[8:11], s41 offen offset:1024 lds
    s_waitcnt lgkmcnt(1)
    v_smfmac_f32_16x16x64_bf16 v[12:15], v[44:47], a[184:191], v1
    s_waitcnt lgkmcnt(0)
    v_smfmac_f32_16x16x64_bf16 v[12:15], v[48:51], a[192:199], v1
    v_smfmac_f32_16x16x64_bf16 v[24:27], v[44:47], a[200:207], v1
    v_smfmac_f32_16x16x64_bf16 v[24:27], v[48:51], a[208:215], v1
    v_add_f32 v12, v12, v14
    v_smfmac_f32_16x16x64_bf16 v[20:23], v[44:47], a[216:223], v1
    v_add_f32 v13, v13, v15
    v_smfmac_f32_16x16x64_bf16 v[20:23], v[48:51], a[224:231], v1
    v_cvt_pk_bf16_f32 v12, v12, v13
    v_smfmac_f32_16x16x64_bf16 v[16:19], v[44:47], a[232:239], v1
    v_add_f32 v24, v24, v26
    v_smfmac_f32_16x16x64_bf16 v[16:19], v[48:51], a[240:247], v1
    v_add_f32 v25, v25, v27
    v_smfmac_f32_16x16x64_bf16 v[36:39], v[44:47], v[56:63], v1
    v_cvt_pk_bf16_f32 v13, v24, v25
    v_smfmac_f32_16x16x64_bf16 v[36:39], v[48:51], v[64:71], v1
    v_add_f32 v20, v20, v22
    v_add_f32 v21, v21, v23
    v_cvt_pk_bf16_f32 v14, v20, v21
    v_add_f32 v16, v16, v18
    v_add_f32 v17, v17, v19
    v_cvt_pk_bf16_f32 v15, v16, v17
    v_and_or_b32 v15, v15, -2, s40
    buffer_store_dwordx4 v[12:15], v0, s[8:11], s38 offen
    s_nop 0
    ds_read_b128 v[12:15], v8 offset:18432
    ds_read_b128 v[16:19], v8 offset:19456
    ds_read_b128 v[20:23], v8 offset:22528
    ds_read_b128 v[24:27], v8 offset:23552
    ds_read_b128 v[56:59], v8 offset:24576
    ds_read_b128 v[60:63], v8 offset:25600
    ds_read_b128 v[64:67], v8 offset:28672
    ds_read_b128 v[68:71], v8 offset:29696
    s_waitcnt lgkmcnt(6)
    v_smfmac_f32_16x16x64_bf16 v[40:43], v[44:47], v[12:19], v1
    ds_read_b128 v[12:15], v8 offset:26624
    ds_read_b128 v[16:19], v8 offset:27648
    s_waitcnt lgkmcnt(6)
    v_smfmac_f32_16x16x64_bf16 v[40:43], v[48:51], v[20:27], v1
    ds_read_b128 v[20:23], v8 offset:30720
    ds_read_b128 v[24:27], v8 offset:31744
    s_waitcnt lgkmcnt(6)
    v_smfmac_f32_16x16x64_bf16 v[52:55], v[44:47], v[56:63], v1
    ds_read_b128 v[56:59], v8 offset:32768
    ds_read_b128 v[60:63], v8 offset:33792
    s_waitcnt lgkmcnt(6)
    v_smfmac_f32_16x16x64_bf16 v[52:55], v[48:51], v[64:71], v1
    s_waitcnt lgkmcnt(4)
    v_smfmac_f32_16x16x64_bf16 v[32:35], v[44:47], v[12:19], v1
    s_waitcnt lgkmcnt(2)
    v_smfmac_f32_16x16x64_bf16 v[32:35], v[48:51], v[20:27], v1
    v_smfmac_f32_16x16x64_bf16 v[28:31], v[44:47], a[248:255], v1
    s_waitcnt lgkmcnt(0)
    v_smfmac_f32_16x16x64_bf16 v[28:31], v[48:51], v[56:63], v1
    v_add_f32 v36, v36, v38
    v_add_f32 v37, v37, v39
    v_cvt_pk_bf16_f32 v36, v36, v37
    v_add_f32 v40, v40, v42
    v_add_f32 v41, v41, v43
    v_cvt_pk_bf16_f32 v37, v40, v41
    v_add_f32 v52, v52, v54
    v_add_f32 v53, v53, v55
    v_cvt_pk_bf16_f32 v38, v52, v53
    v_add_f32 v32, v32, v34
    v_add_f32 v33, v33, v35
    v_cvt_pk_bf16_f32 v39, v32, v33
    v_and_or_b32 v39, v39, -2, s40
    s_add_u32 s17, s38, 4096
    buffer_store_dwordx4 v[36:39], v0, s[8:11], s17 offen
    v_add_f32 v28, v28, v30
    v_add_f32 v29, v29, v31
    v_cvt_pk_bf16_f32 v28, v28, v29
    v_and_or_b32 v28, v28, -2, s40
    v_lshrrev_b32 v9, 2, v0
    buffer_store_dword v28, v9, s[8:11], s39 offen
    s_xor_b32 s34, s34, 16384
    s_xor_b32 s35, s35, 16384
    s_add_u32 s33, s33, 1
    s_add_u32 s42, s42, 262144
    s_add_u32 s41, s41, 262144
    s_add_u32 s43, s43, 131072
    s_add_u32 s68, s68, 262144
    s_add_u32 s66, s66, 22528
    s_xor_b32 s40, s40, 1
    ds_read_b128 v[56:59], v8 offset:0
    ds_read_b128 v[60:63], v8 offset:1024
    ds_read_b128 v[64:67], v8 offset:2048
    ds_read_b128 v[68:71], v8 offset:3072
    v_mov_b64 v[12:13], 0
    v_mov_b64 v[14:15], 0
    v_mov_b64 v[16:17], 0
    v_mov_b64 v[18:19], 0
    v_mov_b64 v[20:21], 0
    v_mov_b64 v[22:23], 0
    v_mov_b64 v[24:25], 0
    v_mov_b64 v[26:27], 0
    v_mov_b64 v[28:29], 0
    v_mov_b64 v[30:31], 0
    v_mov_b64 v[32:33], 0
    v_mov_b64 v[34:35], 0
    s_sleep 5
    s_nop 9
    buffer_load_dwordx4 v[36:39], v0, s[8:11], s34 offen sc1
    s_nop 15
    s_nop 8
    buffer_load_dwordx4 v[36:39], v0, s[8:11], s34 offen sc1
    s_nop 15
    s_nop 8
    buffer_load_dwordx4 v[36:39], v0, s[8:11], s34 offen sc1
    s_waitcnt lgkmcnt(0)
    s_branch Lr3f_step
Lr3f_pb_re:
    s_mov_b32 s16, 0
Lr3f_pb_lp:
    s_add_u32 s17, s34, 4096
    buffer_load_dwordx4 v[40:43], v0, s[8:11], s17 offen sc1
    s_add_u32 s16, s16, 1
    s_cmp_gt_u32 s16, 100000
    s_cbranch_scc1 Lr_abort
    s_waitcnt vmcnt(0)
    v_max3_u32 v10, v40, v41, v42
    v_max_u32 v10, v10, v43
    v_cmp_eq_u32 vcc, -1, v10
    s_nop 0
    s_cbranch_vccnz Lr3f_pb_lp
    s_branch Lr3f_pb_ok
Lr3f_pc_re:
    s_mov_b32 s16, 0
Lr3f_pc_lp:
    buffer_load_dwordx4 v[44:47], v0, s[8:11], s35 offen sc1
    s_add_u32 s16, s16, 1
    s_cmp_gt_u32 s16, 100000
    s_cbranch_scc1 Lr_abort
    s_waitcnt vmcnt(0)
    v_max3_u32 v10, v44, v45, v46
    v_max_u32 v10, v10, v47
    v_cmp_eq_u32 vcc, -1, v10
    s_nop 0
    s_cbranch_vccnz Lr3f_pc_lp
    s_branch Lr3f_pc_ok
Lr3f_last:
    s_waitcnt vmcnt(0) lgkmcnt(0)
    s_barrier
    s_branch Lr_exit
L_slow:
    s_cmp_lg_u32 s14, 0
    s_cbranch_scc1 L_w1_0
    s_mov_b32 s16, 0
    s_add_u32 s17, s66, 128
    v_lshrrev_b32 v10, 2, v0
    v_and_b32 v9, 16, v10
    v_lshlrev_b32 v9, 3, v9
    v_and_or_b32 v10, v10, 12, v9
Lr0s_fw_15:
    buffer_load_dword v9, v10, s[8:11], s17 offen sc1
    s_add_u32 s16, s16, 1
    s_cmp_gt_u32 s16, 100000
    s_cbranch_scc1 Lr_abort
    s_waitcnt vmcnt(0)
    v_cmp_eq_u32 vcc, 0, v9
    s_nop 0
    s_cbranch_vccnz Lr0s_fw_15
    s_mov_b32 m0, 15104
    s_nop 0
    buffer_load_dwordx4 v0, s[8:11], s41 offen offset:0 lds
    buffer_load_dwordx4 v0, s[8:11], s41 offen offset:1024 lds
    s_add_u32 s41, s41, 262144
    s_add_u32 s68, s68, 4278452224
    s_waitcnt vmcnt(0)
    ds_read_b128 v[56:59], v8 offset:0
    ds_read_b128 v[60:63], v8 offset:1024
    ds_read_b128 v[64:67], v8 offset:2048
    ds_read_b128 v[68:71], v8 offset:3072
    v_mov_b64 v[12:13], 0
    v_mov_b64 v[14:15], 0
    v_mov_b64 v[16:17], 0
    v_mov_b64 v[18:19], 0
    v_mov_b64 v[20:21], 0
    v_mov_b64 v[22:23], 0
    v_mov_b64 v[24:25], 0
    v_mov_b64 v[26:27], 0
    v_mov_b64 v[28:29], 0
    v_mov_b64 v[30:31], 0
    v_mov_b64 v[32:33], 0
    v_mov_b64 v[34:35], 0
    buffer_load_dwordx4 v[36:39], v0, s[8:11], s34 offen sc1
    s_waitcnt vmcnt(0) lgkmcnt(0)
Lr0s_step:
    s_mov_b32 s16, 0
Lr0s_alp:
    s_waitcnt vmcnt(2)
    v_max3_u32 v10, v36, v37, v38
    v_max_u32 v10, v10, v39
    v_cmp_eq_u32 vcc, -1, v10
    s_nop 0
    s_cbranch_vccz Lr0s_aok
    buffer_load_dwordx4 v[36:39], v0, s[8:11], s34 offen sc1
    s_add_u32 s16, s16, 1
    s_cmp_gt_u32 s16, 100000
    s_cbranch_scc1 Lr_abort
    s_branch Lr0s_alp
Lr0s_aok:
    ds_write_b128 v0, v[36:39] offset:6912
    v_smfmac_f32_16x16x64_bf16 v[12:15], v[36:39], v[72:79], v1
    v_smfmac_f32_16x16x64_bf16 v[16:19], v[36:39], v[80:87], v1
    v_smfmac_f32_16x16x64_bf16 v[20:23], v[36:39], v[184:191], v1
    s_waitcnt lgkmcnt(0)
    s_barrier
    ds_read_b128 v[48:51], v0 offset:7936
    ds_read_b128 v[52:55], v0 offset:8960
    v_smfmac_f32_16x16x64_bf16 v[28:31], v[36:39], v[56:63], v1
    ds_read_b128 v[56:59], v8 offset:4096
    ds_read_b128 v[60:63], v8 offset:5120
    s_add_u32 s17, s34, 4096
    buffer_load_dwordx4 v[40:43], v0, s[8:11], s17 offen sc1
    v_smfmac_f32_16x16x64_bf16 v[24:27], v[36:39], v[192:199], v1
    v_smfmac_f32_16x16x64_bf16 v[32:35], v[36:39], v[64:71], v1
    ds_read_b128 v[64:67], v8 offset:6144
    ds_read_b128 v[68:71], v8 offset:7168
    s_waitcnt vmcnt(1)
    ds_read_b128 v[36:39], v0 offset:9984
    s_waitcnt lgkmcnt(6)
    v_smfmac_f32_16x16x64_bf16 v[28:31], v[48:51], a[72:79], v1
    v_smfmac_f32_16x16x64_bf16 v[12:15], v[48:51], v[88:95], v1
    buffer_load_dwordx4 v[44:47], v0, s[8:11], s35 offen sc1
    v_smfmac_f32_16x16x64_bf16 v[16:19], v[48:51], v[96:103], v1
    v_smfmac_f32_16x16x64_bf16 v[32:35], v[48:51], a[80:87], v1
    v_smfmac_f32_16x16x64_bf16 v[20:23], v[48:51], v[200:207], v1
    v_smfmac_f32_16x16x64_bf16 v[24:27], v[48:51], v[208:215], v1
    s_waitcnt lgkmcnt(3)
    v_smfmac_f32_16x16x64_bf16 v[28:31], v[52:55], v[56:63], v1
    ds_read_b128 v[56:59], v8 offset:8192
    ds_read_b128 v[60:63], v8 offset:9216
    v_smfmac_f32_16x16x64_bf16 v[12:15], v[52:55], v[104:111], v1
    v_smfmac_f32_16x16x64_bf16 v[16:19], v[52:55], v[112:119], v1
    s_waitcnt lgkmcnt(3)
    v_smfmac_f32_16x16x64_bf16 v[32:35], v[52:55], v[64:71], v1
    ds_read_b128 v[64:67], v8 offset:10240
    ds_read_b128 v[68:71], v8 offset:11264
    v_smfmac_f32_16x16x64_bf16 v[20:23], v[52:55], v[216:223], v1
    v_smfmac_f32_16x16x64_bf16 v[24:27], v[52:55], v[224:231], v1
    s_waitcnt lgkmcnt(4)
    v_smfmac_f32_16x16x64_bf16 v[28:31], v[36:39], a[88:95], v1
    v_smfmac_f32_16x16x64_bf16 v[12:15], v[36:39], v[120:127], v1
    v_smfmac_f32_16x16x64_bf16 v[16:19], v[36:39], v[128:135], v1
    v_smfmac_f32_16x16x64_bf16 v[32:35], v[36:39], a[96:103], v1
    v_smfmac_f32_16x16x64_bf16 v[20:23], v[36:39], v[232:239], v1
    v_smfmac_f32_16x16x64_bf16 v[24:27], v[36:39], v[240:247], v1
    s_waitcnt vmcnt(1)
    v_max3_u32 v10, v40, v41, v42
    v_max_u32 v10, v10, v43
    v_cmp_eq_u32 vcc, -1, v10
    s_nop 0
    s_cbranch_vccnz Lr0s_pb_re
Lr0s_pb_ok:
    ds_write_b128 v0, v[40:43] offset:11008
    s_waitcnt lgkmcnt(3)
    v_smfmac_f32_16x16x64_bf16 v[12:15], v[40:43], v[56:63], v1
    ds_read_b128 v[56:59], v8 offset:12288
    ds_read_b128 v[60:63], v8 offset:13312
    v_smfmac_f32_16x16x64_bf16 v[20:23], v[40:43], v[248:255], v1
    s_waitcnt lgkmcnt(3)
    v_smfmac_f32_16x16x64_bf16 v[16:19], v[40:43], v[64:71], v1
    ds_read_b128 v[64:67], v8 offset:14336
    ds_read_b128 v[68:71], v8 offset:15360
    v_smfmac_f32_16x16x64_bf16 v[24:27], v[40:43], a[0:7], v1
    s_waitcnt lgkmcnt(4)
    s_barrier
    ds_read_b128 v[48:51], v0 offset:13056
    ds_read_b128 v[52:55], v0 offset:12032
    ds_read_b128 v[36:39], v0 offset:14080
    v_smfmac_f32_16x16x64_bf16 v[28:31], v[40:43], a[104:111], v1
    v_smfmac_f32_16x16x64_bf16 v[32:35], v[40:43], a[112:119], v1
    s_waitcnt lgkmcnt(2)
    v_smfmac_f32_16x16x64_bf16 v[12:15], v[48:51], v[56:63], v1
    v_smfmac_f32_16x16x64_bf16 v[16:19], v[48:51], v[64:71], v1
    s_waitcnt lgkmcnt(1)
    v_smfmac_f32_16x16x64_bf16 v[12:15], v[52:55], v[136:143], v1
    v_smfmac_f32_16x16x64_bf16 v[16:19], v[52:55], v[144:151], v1
    s_waitcnt lgkmcnt(0)
    v_smfmac_f32_16x16x64_bf16 v[12:15], v[36:39], v[152:159], v1
    v_smfmac_f32_16x16x64_bf16 v[16:19], v[36:39], v[160:167], v1
    s_waitcnt vmcnt(0)
    v_max3_u32 v10, v44, v45, v46
    v_max_u32 v10, v10, v47
    v_cmp_eq_u32 vcc, -1, v10
    s_nop 0
    s_cbranch_vccnz Lr0s_pc_re
Lr0s_pc_ok:
    v_smfmac_f32_16x16x64_bf16 v[12:15], v[44:47], v[168:175], v1
    v_smfmac_f32_16x16x64_bf16 v[16:19], v[44:47], v[176:183], v1
    v_smfmac_f32_16x16x64_bf16 v[20:23], v[48:51], a[24:31], v1
    buffer_load_dwordx4 v[64:67], v0, s[8:11], s42 offen
    v_smfmac_f32_16x16x64_bf16 v[24:27], v[48:51], a[32:39], v1
    v_smfmac_f32_16x16x64_bf16 v[20:23], v[52:55], a[8:15], v1
    v_add_f32 v12, v12, v14
    v_smfmac_f32_16x16x64_bf16 v[24:27], v[52:55], a[16:23], v1
    v_add_f32 v16, v16, v18
    v_smfmac_f32_16x16x64_bf16 v[20:23], v[36:39], a[40:47], v1
    v_add_f32 v13, v13, v15
    buffer_load_dwordx4 v[68:71], v0, s[8:11], s42 offen offset:1024
    v_smfmac_f32_16x16x64_bf16 v[24:27], v[36:39], a[48:55], v1
    v_add_f32 v17, v17, v19
    v_smfmac_f32_16x16x64_bf16 v[20:23], v[44:47], a[56:63], v1
    v_cvt_pk_bf16_f32 v14, v12, v16
    ds_read_b128 v[56:59], v0 offset:15104
    v_smfmac_f32_16x16x64_bf16 v[24:27], v[44:47], a[64:71], v1
    v_cvt_pk_bf16_f32 v15, v13, v17
    ds_read_b128 v[60:63], v0 offset:16128
    ds_write_b32 v2, v14 offset:576
    ds_write_b32 v2, v15 offset:864
    v_smfmac_f32_16x16x64_bf16 v[28:31], v[48:51], a[136:143], v1
    v_smfmac_f32_16x16x64_bf16 v[32:35], v[48:51], a[144:151], v1
    v_add_f32 v20, v20, v22
    v_add_f32 v24, v24, v26
    v_add_f32 v21, v21, v23
    v_add_f32 v25, v25, v27
    v_cvt_pk_bf16_f32 v22, v20, v24
    v_cvt_pk_bf16_f32 v23, v21, v25
    ds_write_b32 v2, v22 offset:0
    ds_write_b32 v2, v23 offset:288
    v_smfmac_f32_16x16x64_bf16 v[28:31], v[52:55], a[120:127], v1
    v_smfmac_f32_16x16x64_bf16 v[32:35], v[52:55], a[128:135], v1
    s_waitcnt lgkmcnt(0)
    s_barrier
    ds_read_b128 v[40:43], v3 offset:0
    ds_read_b128 v[48:51], v3 offset:64
    ds_read_b128 v[20:23], v3 offset:128
    ds_read_b128 v[52:55], v3 offset:192
    v_smfmac_f32_16x16x64_bf16 v[28:31], v[36:39], a[152:159], v1
    v_smfmac_f32_16x16x64_bf16 v[32:35], v[36:39], a[160:167], v1
    ds_read_b128 v[36:39], v0 offset:17152
    v_lshlrev_b32 v9, 3, v0
    buffer_load_dword v11, v9, s[8:11], s68 offen
    v_smfmac_f32_16x16x64_bf16 v[28:31], v[44:47], a[168:175], v1
    v_smfmac_f32_16x16x64_bf16 v[32:35], v[44:47], a[176:183], v1
    ds_read_b128 v[44:47], v0 offset:18176
    s_waitcnt lgkmcnt(5)
    v_mfma_f32_16x16x32_bf16 v[12:15], v[56:59], v[40:43], 0
    v_mfma_f32_16x16x32_bf16 v[16:19], v[60:63], v[40:43], 0
    v_mfma_f32_16x16x32_bf16 v[24:27], v[40:43], v[40:43], 0
    ds_read_b128 v[56:59], v0 offset:19200
    ds_read_b128 v[60:63], v0 offset:20224
    s_waitcnt lgkmcnt(3)
    v_mfma_f32_16x16x32_bf16 v[12:15], v[36:39], v[48:51], v[12:15]
    v_lshrrev_b32 v10, 1, v0
    v_lshrrev_b32 v9, 9, v0
    s_waitcnt lgkmcnt(2)
    v_mfma_f32_16x16x32_bf16 v[16:19], v[44:47], v[48:51], v[16:19]
    v_lshl_add_u32 v9, v9, 5, v10
    v_add_f32 v28, v28, v30
    v_mfma_f32_16x16x32_bf16 v[24:27], v[48:51], v[48:51], v[24:27]
    v_add_f32 v32, v32, v34
    v_add_f32 v29, v29, v31
    ds_read_b128 v[36:39], v0 offset:21248
    ds_read_b128 v[44:47], v0 offset:22272
    s_waitcnt lgkmcnt(3)
    v_mfma_f32_16x16x32_bf16 v[12:15], v[56:59], v[20:23], v[12:15]
    v_add_f32 v33, v33, v35
    v_cvt_pk_bf16_f32 v30, v28, v29
    s_waitcnt lgkmcnt(2)
    v_mfma_f32_16x16x32_bf16 v[16:19], v[60:63], v[20:23], v[16:19]
    v_cvt_pk_bf16_f32 v31, v32, v33
    ds_read_b64 v[34:35], v9 offset:0
    v_mfma_f32_16x16x32_bf16 v[24:27], v[20:23], v[20:23], v[24:27]
    s_add_u32 s17, s43, 2048
    buffer_store_dwordx2 v[30:31], v10, s[8:11], s17 offen sc1
    s_waitcnt lgkmcnt(2)
    v_mfma_f32_16x16x32_bf16 v[12:15], v[36:39], v[52:55], v[12:15]
    s_waitcnt lgkmcnt(1)
    v_mfma_f32_16x16x32_bf16 v[16:19], v[44:47], v[52:55], v[16:19]
    v_mfma_f32_16x16x32_bf16 v[24:27], v[52:55], v[52:55], v[24:27]
    s_add_u32 s17, s43, 0
    s_waitcnt lgkmcnt(0)
    buffer_store_dwordx2 v[34:35], v10, s[8:11], s17 offen sc1
    ds_read_b128 v[56:59], v8 offset:16384
    ds_read_b128 v[60:63], v8 offset:17408
    v_mov_b64 v[20:21], s[52:53]
    v_mov_b64 v[22:23], s[52:53]
    v_mov_b32 v41, 0
    v_mov_b32 v42, 0
    v_max3_f32 v9, v12, v13, v14
    v_max3_f32 v9, v9, v15, v16
    v_max3_f32 v9, v9, v17, v18
    v_max3_f32 v9, v9, v19, v24
    v_max_f32 v9, v9, v25
    v_mov_b32 v10, v9
    v_mov_b64 v[32:33], 0
    v_mov_b64 v[34:35], 0
    v_permlane32_swap_b32 v9, v10
    v_max_f32 v9, v9, v10
    v_mov_b32 v10, v9
    s_nop 1
    v_permlane16_swap_b32 v9, v10
    v_max_f32 v9, v9, v10
    v_mul_f32 v28, s44, v9
    v_fma_f32 v12, v12, s44, -v28
    v_fma_f32 v13, v13, s44, -v28
    v_fma_f32 v14, v14, s44, -v28
    v_fma_f32 v15, v15, s44, -v28
    v_exp_f32 v12, v12
    v_exp_f32 v13, v13
    v_fma_f32 v16, v16, s44, -v28
    v_fma_f32 v17, v17, s44, -v28
    v_exp_f32 v14, v14
    v_exp_f32 v15, v15
    v_cvt_pk_bf16_f32 v36, v12, v13
    v_fma_f32 v18, v18, s44, -v28
    v_fma_f32 v19, v19, s44, -v28
    v_exp_f32 v16, v16
    v_exp_f32 v17, v17
    v_cvt_pk_bf16_f32 v37, v14, v15
    v_fma_f32 v24, v24, s44, -v28
    v_fma_f32 v25, v25, s44, -v28
    v_exp_f32 v18, v18
    v_exp_f32 v19, v19
    v_cvt_pk_bf16_f32 v38, v16, v17
    v_exp_f32 v24, v24
    v_exp_f32 v25, v25
    v_cvt_pk_bf16_f32 v39, v18, v19
    v_cvt_pk_bf16_f32 v40, v24, v25
    v_cvt_pk_bf16_f32 v43, v24, v25
    v_mfma_f32_16x16x32_bf16 v[52:55], v[20:23], v[36:39], 0
    v_mov_b64 v[12:13], 0
    v_mov_b64 v[14:15], 0
    s_waitcnt vmcnt(4)
    v_mfma_f32_16x16x32_bf16 v[44:47], v[64:67], v[36:39], 0
    v_mov_b64 v[24:25], 0
    v_mov_b64 v[26:27], 0
    s_waitcnt vmcnt(3)
    v_mfma_f32_16x16x32_bf16 v[48:51], v[68:71], v[36:39], 0
    ds_read_b128 v[64:67], v8 offset:20480
    ds_read_b128 v[68:71], v8 offset:21504
    v_mfma_f32_16x16x16_bf16 v[52:55], v[20:21], v[40:41], v[52:55]
    v_mfma_f32_16x16x16_bf16 v[44:47], v[30:31], v[40:41], v[44:47]
    v_mov_b64 v[20:21], 0
    v_mov_b64 v[22:23], 0
    v_mfma_f32_16x16x16_bf16 v[48:51], v[30:31], v[42:43], v[48:51]
    v_mov_b64 v[36:37], 0
    v_mov_b64 v[38:39], 0
    v_mov_b64 v[40:41], 0
    v_mov_b64 v[42:43], 0
    v_rcp_f32 v9, v52
    v_mov_b64 v[52:53], 0
    v_mov_b64 v[54:55], 0
    v_mul_f32 v44, v9, v44
    v_mul_f32 v48, v9, v48
    v_cvt_pk_bf16_f32 v16, v44, v48
    v_mul_f32 v45, v9, v45
    v_mul_f32 v49, v9, v49
    v_cvt_pk_bf16_f32 v17, v45, v49
    v_mul_f32 v46, v9, v46
    v_mul_f32 v50, v9, v50
    v_cvt_pk_bf16_f32 v18, v46, v50
    v_mul_f32 v47, v9, v47
    v_mul_f32 v51, v9, v51
    v_cvt_pk_bf16_f32 v19, v47, v51
    ds_write_b128 v5, v[16:19]
    v_mov_b64 v[28:29], 0
    v_mov_b64 v[30:31], 0
    s_waitcnt lgkmcnt(0)
    s_barrier
    ds_read_b128 v[44:47], v4 offset:0
    ds_read_b128 v[48:51], v4 offset:128
    s_cmp_eq_u32 s33, 63
    s_cbranch_scc1 Lr0s_last
    v_mov_b64 v[16:17], 0
    v_mov_b64 v[18:19], 0
    buffer_load_dwordx4 v0, s[8:11], s41 offen offset:0 lds
    buffer_load_dwordx4 v0, s[8:11], s41 offen offset:1024 lds
    s_waitcnt lgkmcnt(1)
    v_smfmac_f32_16x16x64_bf16 v[12:15], v[44:47], a[184:191], v1
    s_waitcnt lgkmcnt(0)
    v_smfmac_f32_16x16x64_bf16 v[12:15], v[48:51], a[192:199], v1
    v_smfmac_f32_16x16x64_bf16 v[24:27], v[44:47], a[200:207], v1
    v_smfmac_f32_16x16x64_bf16 v[24:27], v[48:51], a[208:215], v1
    v_add_f32 v12, v12, v14
    v_smfmac_f32_16x16x64_bf16 v[20:23], v[44:47], a[216:223], v1
    v_add_f32 v13, v13, v15
    v_smfmac_f32_16x16x64_bf16 v[20:23], v[48:51], a[224:231], v1
    v_cvt_pk_bf16_f32 v12, v12, v13
    v_smfmac_f32_16x16x64_bf16 v[16:19], v[44:47], a[232:239], v1
    v_add_f32 v24, v24, v26
    v_smfmac_f32_16x16x64_bf16 v[16:19], v[48:51], a[240:247], v1
    v_add_f32 v25, v25, v27
    v_smfmac_f32_16x16x64_bf16 v[36:39], v[44:47], v[56:63], v1
    v_cvt_pk_bf16_f32 v13, v24, v25
    v_smfmac_f32_16x16x64_bf16 v[36:39], v[48:51], v[64:71], v1
    v_add_f32 v20, v20, v22
    v_add_f32 v21, v21, v23
    v_cvt_pk_bf16_f32 v14, v20, v21
    v_add_f32 v16, v16, v18
    v_add_f32 v17, v17, v19
    v_cvt_pk_bf16_f32 v15, v16, v17
    v_and_or_b32 v15, v15, -2, s40
    buffer_store_dwordx4 v[12:15], v0, s[8:11], s38 offen sc1
    s_nop 0
    ds_read_b128 v[12:15], v8 offset:18432
    ds_read_b128 v[16:19], v8 offset:19456
    ds_read_b128 v[20:23], v8 offset:22528
    ds_read_b128 v[24:27], v8 offset:23552
    ds_read_b128 v[56:59], v8 offset:24576
    ds_read_b128 v[60:63], v8 offset:25600
    ds_read_b128 v[64:67], v8 offset:28672
    ds_read_b128 v[68:71], v8 offset:29696
    s_waitcnt lgkmcnt(6)
    v_smfmac_f32_16x16x64_bf16 v[40:43], v[44:47], v[12:19], v1
    ds_read_b128 v[12:15], v8 offset:26624
    ds_read_b128 v[16:19], v8 offset:27648
    s_waitcnt lgkmcnt(6)
    v_smfmac_f32_16x16x64_bf16 v[40:43], v[48:51], v[20:27], v1
    ds_read_b128 v[20:23], v8 offset:30720
    ds_read_b128 v[24:27], v8 offset:31744
    s_waitcnt lgkmcnt(6)
    v_smfmac_f32_16x16x64_bf16 v[52:55], v[44:47], v[56:63], v1
    ds_read_b128 v[56:59], v8 offset:32768
    ds_read_b128 v[60:63], v8 offset:33792
    s_waitcnt lgkmcnt(6)
    v_smfmac_f32_16x16x64_bf16 v[52:55], v[48:51], v[64:71], v1
    s_waitcnt lgkmcnt(4)
    v_smfmac_f32_16x16x64_bf16 v[32:35], v[44:47], v[12:19], v1
    s_waitcnt lgkmcnt(2)
    v_smfmac_f32_16x16x64_bf16 v[32:35], v[48:51], v[20:27], v1
    v_smfmac_f32_16x16x64_bf16 v[28:31], v[44:47], a[248:255], v1
    s_waitcnt lgkmcnt(0)
    v_smfmac_f32_16x16x64_bf16 v[28:31], v[48:51], v[56:63], v1
    buffer_load_dwordx4 v[12:15], v6, s[8:11], s62 offen sc1
    buffer_load_dwordx4 v[16:19], v6, s[8:11], s63 offen sc1
    buffer_load_dwordx4 v[20:23], v6, s[8:11], s64 offen sc1
    buffer_load_dwordx4 v[24:27], v6, s[8:11], s65 offen sc1
    v_add_f32 v36, v36, v38
    v_add_f32 v37, v37, v39
    v_cvt_pk_bf16_f32 v36, v36, v37
    v_add_f32 v40, v40, v42
    v_add_f32 v41, v41, v43
    v_cvt_pk_bf16_f32 v37, v40, v41
    v_add_f32 v52, v52, v54
    v_add_f32 v53, v53, v55
    v_cvt_pk_bf16_f32 v38, v52, v53
    v_add_f32 v32, v32, v34
    v_add_f32 v33, v33, v35
    v_cvt_pk_bf16_f32 v39, v32, v33
    v_and_or_b32 v39, v39, -2, s40
    s_add_u32 s17, s38, 4096
    buffer_store_dwordx4 v[36:39], v0, s[8:11], s17 offen sc1
    v_add_f32 v28, v28, v30
    v_add_f32 v29, v29, v31
    v_cvt_pk_bf16_f32 v28, v28, v29
    v_and_or_b32 v28, v28, -2, s40
    v_lshrrev_b32 v9, 2, v0
    buffer_store_dword v28, v9, s[8:11], s39 offen sc1
    v_add_u32 v10, 162560, v0
    ds_read_b128 v[64:67], v10
    s_nop 9
    buffer_load_dwordx4 v[40:43], v6, s[8:11], s62 offen sc1
    buffer_load_dwordx4 v[44:47], v6, s[8:11], s63 offen sc1
    buffer_load_dwordx4 v[48:51], v6, s[8:11], s64 offen sc1
    buffer_load_dwordx4 v[52:55], v6, s[8:11], s65 offen sc1
    s_add_u32 s33, s33, 1
    s_add_u32 s42, s42, 262144
    s_add_u32 s41, s41, 262144
    s_add_u32 s43, s43, 131072
    s_add_u32 s68, s68, 262144
    s_add_u32 s66, s66, 22528
    ds_read_b128 v[56:59], v8 offset:0
    ds_read_b128 v[60:63], v8 offset:1024
    s_waitcnt lgkmcnt(2)
    s_waitcnt vmcnt(9)
    v_mfma_f32_16x16x32_bf16 v[68:71], v[12:15], v[64:67], 0
    v_and_b32 v10, 1, v15
    v_cmp_ne_u32 s[54:55], s40, v10
    s_waitcnt vmcnt(8)
    v_mfma_f32_16x16x32_bf16 v[68:71], v[16:19], v[64:67], v[68:71]
    v_and_b32 v10, 1, v19
    v_cmp_ne_u32 s[56:57], s40, v10
    s_waitcnt vmcnt(7)
    v_mfma_f32_16x16x32_bf16 v[68:71], v[20:23], v[64:67], v[68:71]
    v_and_b32 v10, 1, v23
    v_cmp_ne_u32 s[58:59], s40, v10
    s_waitcnt vmcnt(6)
    v_mfma_f32_16x16x32_bf16 v[68:71], v[24:27], v[64:67], v[68:71]
    v_and_b32 v10, 1, v27
    v_cmp_ne_u32 s[60:61], s40, v10
    s_or_b64 vcc, s[54:55], s[56:57]
    s_or_b64 vcc, vcc, s[58:59]
    s_or_b64 vcc, vcc, s[60:61]
    s_cbranch_scc0 Lr0s_red
    s_mov_b32 s16, 0
Lr0s_p1:
    buffer_load_dwordx4 v[12:15], v6, s[8:11], s62 offen sc1
    buffer_load_dwordx4 v[16:19], v6, s[8:11], s63 offen sc1
    buffer_load_dwordx4 v[20:23], v6, s[8:11], s64 offen sc1
    buffer_load_dwordx4 v[24:27], v6, s[8:11], s65 offen sc1
    s_waitcnt vmcnt(7)
    v_mfma_f32_16x16x32_bf16 v[68:71], v[40:43], v[64:67], 0
    v_and_b32 v10, 1, v43
    v_cmp_ne_u32 s[54:55], s40, v10
    s_waitcnt vmcnt(6)
    v_mfma_f32_16x16x32_bf16 v[68:71], v[44:47], v[64:67], v[68:71]
    v_and_b32 v10, 1, v47
    v_cmp_ne_u32 s[56:57], s40, v10
    s_waitcnt vmcnt(5)
    v_mfma_f32_16x16x32_bf16 v[68:71], v[48:51], v[64:67], v[68:71]
    v_and_b32 v10, 1, v51
    v_cmp_ne_u32 s[58:59], s40, v10
    s_waitcnt vmcnt(4)
    v_mfma_f32_16x16x32_bf16 v[68:71], v[52:55], v[64:67], v[68:71]
    v_and_b32 v10, 1, v55
    v_cmp_ne_u32 s[60:61], s40, v10
    s_or_b64 vcc, s[54:55], s[56:57]
    s_or_b64 vcc, vcc, s[58:59]
    s_or_b64 vcc, vcc, s[60:61]
    s_cbranch_scc0 Lr0s_red
    buffer_load_dwordx4 v[40:43], v6, s[8:11], s62 offen sc1
    buffer_load_dwordx4 v[44:47], v6, s[8:11], s63 offen sc1
    buffer_load_dwordx4 v[48:51], v6, s[8:11], s64 offen sc1
    buffer_load_dwordx4 v[52:55], v6, s[8:11], s65 offen sc1
    s_add_u32 s16, s16, 1
    s_cmp_gt_u32 s16, 100000
    s_cbranch_scc1 Lr_abort
    s_waitcnt vmcnt(7)
    v_mfma_f32_16x16x32_bf16 v[68:71], v[12:15], v[64:67], 0
    v_and_b32 v10, 1, v15
    v_cmp_ne_u32 s[54:55], s40, v10
    s_waitcnt vmcnt(6)
    v_mfma_f32_16x16x32_bf16 v[68:71], v[16:19], v[64:67], v[68:71]
    v_and_b32 v10, 1, v19
    v_cmp_ne_u32 s[56:57], s40, v10
    s_waitcnt vmcnt(5)
    v_mfma_f32_16x16x32_bf16 v[68:71], v[20:23], v[64:67], v[68:71]
    v_and_b32 v10, 1, v23
    v_cmp_ne_u32 s[58:59], s40, v10
    s_waitcnt vmcnt(4)
    v_mfma_f32_16x16x32_bf16 v[68:71], v[24:27], v[64:67], v[68:71]
    v_and_b32 v10, 1, v27
    v_cmp_ne_u32 s[60:61], s40, v10
    s_or_b64 vcc, s[54:55], s[56:57]
    s_or_b64 vcc, vcc, s[58:59]
    s_or_b64 vcc, vcc, s[60:61]
    s_cbranch_scc1 Lr0s_p1
Lr0s_red:
    s_nop 1
    v_permlane16_swap_b32 v68, v70
    v_permlane16_swap_b32 v69, v71
    s_mov_b64 exec, s[46:47]
    v_add_f32 v68, v68, v70
    v_add_f32 v69, v69, v71
    v_cvt_pk_bf16_f32 v68, v68, v69
    v_min_u32 v68, s50, v68
    buffer_store_dword v68, v7, s[8:11], s36 offen sc1
    v_mov_b32 v69, -1
    buffer_store_dword v69, v7, s[8:11], s37 offen sc1
    s_mov_b64 exec, -1
    s_xor_b32 s34, s34, 16384
    s_xor_b32 s35, s35, 16384
    s_xor_b32 s40, s40, 1
    s_xor_b32 s36, s36, 16384
    s_xor_b32 s37, s37, 16384
    s_nop 15
    s_nop 3
    buffer_load_dwordx4 v[36:39], v0, s[8:11], s34 offen sc1
    s_waitcnt vmcnt(3)
    ds_read_b128 v[64:67], v8 offset:2048
    ds_read_b128 v[68:71], v8 offset:3072
    v_mov_b64 v[12:13], 0
    v_mov_b64 v[14:15], 0
    v_mov_b64 v[16:17], 0
    v_mov_b64 v[18:19], 0
    v_mov_b64 v[20:21], 0
    v_mov_b64 v[22:23], 0
    v_mov_b64 v[24:25], 0
    v_mov_b64 v[26:27], 0
    v_mov_b64 v[28:29], 0
    v_mov_b64 v[30:31], 0
    v_mov_b64 v[32:33], 0
    v_mov_b64 v[34:35], 0
    s_nop 9
    buffer_load_dwordx4 v[36:39], v0, s[8:11], s34 offen sc1
    s_nop 15
    s_nop 8
    buffer_load_dwordx4 v[36:39], v0, s[8:11], s34 offen sc1
    s_waitcnt lgkmcnt(0)
    s_branch Lr0s_step
Lr0s_pb_re:
    s_mov_b32 s16, 0
Lr0s_pb_lp:
    s_add_u32 s17, s34, 4096
    buffer_load_dwordx4 v[40:43], v0, s[8:11], s17 offen sc1
    s_add_u32 s16, s16, 1
    s_cmp_gt_u32 s16, 100000
    s_cbranch_scc1 Lr_abort
    s_waitcnt vmcnt(0)
    v_max3_u32 v10, v40, v41, v42
    v_max_u32 v10, v10, v43
    v_cmp_eq_u32 vcc, -1, v10
    s_nop 0
    s_cbranch_vccnz Lr0s_pb_lp
    s_branch Lr0s_pb_ok
Lr0s_pc_re:
    s_mov_b32 s16, 0
Lr0s_pc_lp:
    buffer_load_dwordx4 v[44:47], v0, s[8:11], s35 offen sc1
    s_add_u32 s16, s16, 1
    s_cmp_gt_u32 s16, 100000
    s_cbranch_scc1 Lr_abort
    s_waitcnt vmcnt(0)
    v_max3_u32 v10, v44, v45, v46
    v_max_u32 v10, v10, v47
    v_cmp_eq_u32 vcc, -1, v10
    s_nop 0
    s_cbranch_vccnz Lr0s_pc_lp
    s_branch Lr0s_pc_ok
Lr0s_last:
    s_waitcnt vmcnt(0) lgkmcnt(0)
    s_barrier
    s_branch Lr_exit
L_w1_0:
    s_cmp_lg_u32 s14, 1
    s_cbranch_scc1 L_w2_0
    s_mov_b32 s16, 0
    s_add_u32 s17, s66, 128
    v_lshrrev_b32 v10, 2, v0
    v_and_b32 v9, 16, v10
    v_lshlrev_b32 v9, 3, v9
    v_and_or_b32 v10, v10, 12, v9
Lr1s_fw_16:
    buffer_load_dword v9, v10, s[8:11], s17 offen sc1
    s_add_u32 s16, s16, 1
    s_cmp_gt_u32 s16, 100000
    s_cbranch_scc1 Lr_abort
    s_waitcnt vmcnt(0)
    v_cmp_eq_u32 vcc, 0, v9
    s_nop 0
    s_cbranch_vccnz Lr1s_fw_16
    s_lshl_b32 s67, s32, 5
    s_add_u32 s67, s67, s15
    s_lshl_b32 s67, s67, 12
    s_add_u32 s67, s67, 3145728
    s_mov_b32 m0, 17152
    s_nop 0
    buffer_load_dwordx4 v0, s[8:11], s41 offen offset:0 lds
    buffer_load_dwordx4 v0, s[8:11], s41 offen offset:1024 lds
    s_add_u32 s41, s41, 262144
    s_add_u32 s68, s68, 262144
    s_waitcnt vmcnt(0)
    ds_read_b128 v[56:59], v8 offset:4096
    ds_read_b128 v[60:63], v8 offset:5120
    ds_read_b128 v[64:67], v8 offset:6144
    ds_read_b128 v[68:71], v8 offset:7168
    v_mov_b64 v[12:13], 0
    v_mov_b64 v[14:15], 0
    v_mov_b64 v[16:17], 0
    v_mov_b64 v[18:19], 0
    v_mov_b64 v[20:21], 0
    v_mov_b64 v[22:23], 0
    v_mov_b64 v[24:25], 0
    v_mov_b64 v[26:27], 0
    v_mov_b64 v[28:29], 0
    v_mov_b64 v[30:31], 0
    v_mov_b64 v[32:33], 0
    v_mov_b64 v[34:35], 0
    buffer_load_dwordx4 v[36:39], v0, s[8:11], s34 offen sc1
    s_waitcnt vmcnt(0) lgkmcnt(0)
Lr1s_step:
    s_waitcnt vmcnt(3)
    v_max3_u32 v10, v36, v37, v38
    v_max_u32 v10, v10, v39
    v_cmp_eq_u32 vcc, -1, v10
    s_nop 0
    s_cbranch_vccz Lr1s_aok
    buffer_load_dwordx4 v[36:39], v0, s[8:11], s34 offen sc1
    s_nop 15
    s_nop 8
    buffer_load_dwordx4 v[36:39], v0, s[8:11], s34 offen sc1
    s_mov_b32 s16, 0
Lr1s_alp:
    s_waitcnt vmcnt(2)
    v_max3_u32 v10, v36, v37, v38
    v_max_u32 v10, v10, v39
    v_cmp_eq_u32 vcc, -1, v10
    s_nop 0
    s_cbranch_vccz Lr1s_aok
    buffer_load_dwordx4 v[36:39], v0, s[8:11], s34 offen sc1
    s_add_u32 s16, s16, 1
    s_cmp_gt_u32 s16, 100000
    s_cbranch_scc1 Lr_abort
    s_branch Lr1s_alp
Lr1s_aok:
    ds_write_b128 v0, v[36:39] offset:7936
    v_smfmac_f32_16x16x64_bf16 v[12:15], v[36:39], v[88:95], v1
    v_smfmac_f32_16x16x64_bf16 v[16:19], v[36:39], v[96:103], v1
    v_smfmac_f32_16x16x64_bf16 v[20:23], v[36:39], v[200:207], v1
    s_waitcnt lgkmcnt(0)
    s_barrier
    ds_read_b128 v[48:51], v0 offset:8960
    ds_read_b128 v[52:55], v0 offset:9984
    v_smfmac_f32_16x16x64_bf16 v[28:31], v[36:39], a[72:79], v1
    v_smfmac_f32_16x16x64_bf16 v[24:27], v[36:39], v[208:215], v1
    s_add_u32 s17, s34, 4096
    buffer_load_dwordx4 v[40:43], v0, s[8:11], s17 offen sc1
    v_smfmac_f32_16x16x64_bf16 v[32:35], v[36:39], a[80:87], v1
    s_waitcnt vmcnt(1)
    ds_read_b128 v[36:39], v0 offset:6912
    s_waitcnt lgkmcnt(2)
    v_smfmac_f32_16x16x64_bf16 v[28:31], v[48:51], v[56:63], v1
    ds_read_b128 v[56:59], v8 offset:0
    ds_read_b128 v[60:63], v8 offset:1024
    v_smfmac_f32_16x16x64_bf16 v[12:15], v[48:51], v[104:111], v1
    v_smfmac_f32_16x16x64_bf16 v[16:19], v[48:51], v[112:119], v1
    buffer_load_dwordx4 v[44:47], v0, s[8:11], s35 offen sc1
    v_smfmac_f32_16x16x64_bf16 v[32:35], v[48:51], v[64:71], v1
    ds_read_b128 v[64:67], v8 offset:2048
    ds_read_b128 v[68:71], v8 offset:3072
    v_smfmac_f32_16x16x64_bf16 v[20:23], v[48:51], v[216:223], v1
    v_smfmac_f32_16x16x64_bf16 v[24:27], v[48:51], v[224:231], v1
    s_waitcnt lgkmcnt(5)
    v_smfmac_f32_16x16x64_bf16 v[28:31], v[52:55], a[88:95], v1
    v_smfmac_f32_16x16x64_bf16 v[12:15], v[52:55], v[120:127], v1
    v_smfmac_f32_16x16x64_bf16 v[16:19], v[52:55], v[128:135], v1
    v_smfmac_f32_16x16x64_bf16 v[32:35], v[52:55], a[96:103], v1
    v_smfmac_f32_16x16x64_bf16 v[20:23], v[52:55], v[232:239], v1
    v_smfmac_f32_16x16x64_bf16 v[24:27], v[52:55], v[240:247], v1
    s_waitcnt lgkmcnt(2)
    v_smfmac_f32_16x16x64_bf16 v[28:31], v[36:39], v[56:63], v1
    ds_read_b128 v[56:59], v8 offset:12288
    ds_read_b128 v[60:63], v8 offset:13312
    v_smfmac_f32_16x16x64_bf16 v[12:15], v[36:39], v[72:79], v1
    v_smfmac_f32_16x16x64_bf16 v[16:19], v[36:39], v[80:87], v1
    s_waitcnt lgkmcnt(2)
    v_smfmac_f32_16x16x64_bf16 v[32:35], v[36:39], v[64:71], v1
    ds_read_b128 v[64:67], v8 offset:14336
    ds_read_b128 v[68:71], v8 offset:15360
    v_smfmac_f32_16x16x64_bf16 v[20:23], v[36:39], v[184:191], v1
    v_smfmac_f32_16x16x64_bf16 v[24:27], v[36:39], v[192:199], v1
    s_waitcnt vmcnt(1)
    v_max3_u32 v10, v40, v41, v42
    v_max_u32 v10, v10, v43
    v_cmp_eq_u32 vcc, -1, v10
    s_nop 0
    s_cbranch_vccnz Lr1s_pb_re
Lr1s_pb_ok:
    ds_write_b128 v0, v[40:43] offset:12032
    v_mov_b32 v9, 1
    v_mov_b32 v10, 0
    s_mov_b64 exec, 1
    buffer_store_dword v9, v10, s[8:11], s67 offen offset:384 sc1
    s_mov_b64 exec, -1
    v_smfmac_f32_16x16x64_bf16 v[12:15], v[40:43], v[136:143], v1
    v_smfmac_f32_16x16x64_bf16 v[20:23], v[40:43], a[8:15], v1
    v_smfmac_f32_16x16x64_bf16 v[16:19], v[40:43], v[144:151], v1
    v_smfmac_f32_16x16x64_bf16 v[24:27], v[40:43], a[16:23], v1
    s_waitcnt lgkmcnt(0)
    s_barrier
    ds_read_b128 v[48:51], v0 offset:13056
    ds_read_b128 v[52:55], v0 offset:14080
    ds_read_b128 v[36:39], v0 offset:11008
    v_smfmac_f32_16x16x64_bf16 v[28:31], v[40:43], a[120:127], v1
    v_smfmac_f32_16x16x64_bf16 v[32:35], v[40:43], a[128:135], v1
    s_waitcnt lgkmcnt(2)
    v_smfmac_f32_16x16x64_bf16 v[12:15], v[48:51], v[56:63], v1
    ds_read_b128 v[56:59], v8 offset:8192
    ds_read_b128 v[60:63], v8 offset:9216
    v_smfmac_f32_16x16x64_bf16 v[16:19], v[48:51], v[64:71], v1
    ds_read_b128 v[64:67], v8 offset:10240
    ds_read_b128 v[68:71], v8 offset:11264
    s_waitcnt lgkmcnt(5)
    v_smfmac_f32_16x16x64_bf16 v[12:15], v[52:55], v[152:159], v1
    v_smfmac_f32_16x16x64_bf16 v[16:19], v[52:55], v[160:167], v1
    s_waitcnt vmcnt(1)
    v_max3_u32 v10, v44, v45, v46
    v_max_u32 v10, v10, v47
    v_cmp_eq_u32 vcc, -1, v10
    s_nop 0
    s_cbranch_vccnz Lr1s_pc_re
Lr1s_pc_ok:
    v_smfmac_f32_16x16x64_bf16 v[12:15], v[44:47], v[168:175], v1
    v_smfmac_f32_16x16x64_bf16 v[16:19], v[44:47], v[176:183], v1
    s_waitcnt lgkmcnt(2)
    v_smfmac_f32_16x16x64_bf16 v[12:15], v[36:39], v[56:63], v1
    s_waitcnt lgkmcnt(0)
    v_smfmac_f32_16x16x64_bf16 v[16:19], v[36:39], v[64:71], v1
    v_smfmac_f32_16x16x64_bf16 v[20:23], v[48:51], a[24:31], v1
    v_smfmac_f32_16x16x64_bf16 v[24:27], v[48:51], a[32:39], v1
    buffer_load_dwordx4 v[64:67], v0, s[8:11], s42 offen
    v_smfmac_f32_16x16x64_bf16 v[20:23], v[52:55], a[40:47], v1
    v_add_f32 v12, v12, v14
    v_smfmac_f32_16x16x64_bf16 v[24:27], v[52:55], a[48:55], v1
    v_add_f32 v16, v16, v18
    v_smfmac_f32_16x16x64_bf16 v[20:23], v[36:39], v[248:255], v1
    v_add_f32 v13, v13, v15
    v_smfmac_f32_16x16x64_bf16 v[24:27], v[36:39], a[0:7], v1
    v_add_f32 v17, v17, v19
    buffer_load_dwordx4 v[68:71], v0, s[8:11], s42 offen offset:1024
    v_smfmac_f32_16x16x64_bf16 v[20:23], v[44:47], a[56:63], v1
    v_cvt_pk_bf16_f32 v14, v12, v16
    ds_read_b128 v[56:59], v0 offset:15104
    v_smfmac_f32_16x16x64_bf16 v[24:27], v[44:47], a[64:71], v1
    v_cvt_pk_bf16_f32 v15, v13, v17
    ds_read_b128 v[60:63], v0 offset:16128
    ds_write_b32 v2, v14 offset:576
    ds_write_b32 v2, v15 offset:864
    v_smfmac_f32_16x16x64_bf16 v[28:31], v[48:51], a[136:143], v1
    v_smfmac_f32_16x16x64_bf16 v[32:35], v[48:51], a[144:151], v1
    v_add_f32 v20, v20, v22
    v_add_f32 v24, v24, v26
    v_add_f32 v21, v21, v23
    v_add_f32 v25, v25, v27
    v_cvt_pk_bf16_f32 v22, v20, v24
    v_cvt_pk_bf16_f32 v23, v21, v25
    ds_write_b32 v2, v22 offset:0
    ds_write_b32 v2, v23 offset:288
    v_smfmac_f32_16x16x64_bf16 v[28:31], v[52:55], a[152:159], v1
    v_smfmac_f32_16x16x64_bf16 v[32:35], v[52:55], a[160:167], v1
    s_waitcnt lgkmcnt(0)
    s_barrier
    ds_read_b128 v[40:43], v3 offset:0
    ds_read_b128 v[48:51], v3 offset:64
    ds_read_b128 v[20:23], v3 offset:128
    ds_read_b128 v[52:55], v3 offset:192
    v_smfmac_f32_16x16x64_bf16 v[28:31], v[36:39], a[104:111], v1
    v_smfmac_f32_16x16x64_bf16 v[32:35], v[36:39], a[112:119], v1
    ds_read_b128 v[36:39], v0 offset:17152
    v_smfmac_f32_16x16x64_bf16 v[28:31], v[44:47], a[168:175], v1
    v_smfmac_f32_16x16x64_bf16 v[32:35], v[44:47], a[176:183], v1
    ds_read_b128 v[44:47], v0 offset:18176
    s_waitcnt lgkmcnt(5)
    v_mfma_f32_16x16x32_bf16 v[12:15], v[56:59], v[40:43], 0
    v_mfma_f32_16x16x32_bf16 v[16:19], v[60:63], v[40:43], 0
    v_mfma_f32_16x16x32_bf16 v[24:27], v[40:43], v[40:43], 0
    ds_read_b128 v[56:59], v0 offset:19200
    ds_read_b128 v[60:63], v0 offset:20224
    s_waitcnt lgkmcnt(3)
    v_mfma_f32_16x16x32_bf16 v[12:15], v[36:39], v[48:51], v[12:15]
    v_lshrrev_b32 v10, 1, v0
    v_lshrrev_b32 v9, 9, v0
    s_waitcnt lgkmcnt(2)
    v_mfma_f32_16x16x32_bf16 v[16:19], v[44:47], v[48:51], v[16:19]
    v_lshl_add_u32 v9, v9, 5, v10
    v_add_f32 v28, v28, v30
    v_mfma_f32_16x16x32_bf16 v[24:27], v[48:51], v[48:51], v[24:27]
    v_add_f32 v32, v32, v34
    v_add_f32 v29, v29, v31
    ds_read_b128 v[36:39], v0 offset:21248
    ds_read_b128 v[44:47], v0 offset:22272
    s_waitcnt lgkmcnt(3)
    v_mfma_f32_16x16x32_bf16 v[12:15], v[56:59], v[20:23], v[12:15]
    v_add_f32 v33, v33, v35
    v_cvt_pk_bf16_f32 v30, v28, v29
    s_waitcnt lgkmcnt(2)
    v_mfma_f32_16x16x32_bf16 v[16:19], v[60:63], v[20:23], v[16:19]
    v_cvt_pk_bf16_f32 v31, v32, v33
    ds_read_b64 v[34:35], v9 offset:1152
    v_mfma_f32_16x16x32_bf16 v[24:27], v[20:23], v[20:23], v[24:27]
    s_add_u32 s17, s43, 2560
    buffer_store_dwordx2 v[30:31], v10, s[8:11], s17 offen sc1
    s_waitcnt lgkmcnt(2)
    v_mfma_f32_16x16x32_bf16 v[12:15], v[36:39], v[52:55], v[12:15]
    s_waitcnt lgkmcnt(1)
    v_mfma_f32_16x16x32_bf16 v[16:19], v[44:47], v[52:55], v[16:19]
    v_mfma_f32_16x16x32_bf16 v[24:27], v[52:55], v[52:55], v[24:27]
    s_add_u32 s17, s43, 512
    s_waitcnt lgkmcnt(0)
    buffer_store_dwordx2 v[34:35], v10, s[8:11], s17 offen sc1
    ds_read_b128 v[56:59], v8 offset:16384
    ds_read_b128 v[60:63], v8 offset:17408
    v_mov_b64 v[20:21], s[52:53]
    v_mov_b64 v[22:23], s[52:53]
    v_mov_b32 v41, 0
    v_mov_b32 v42, 0
    v_max3_f32 v9, v12, v13, v14
    v_max3_f32 v9, v9, v15, v16
    v_max3_f32 v9, v9, v17, v18
    v_max3_f32 v9, v9, v19, v24
    v_max_f32 v9, v9, v25
    v_mov_b32 v10, v9
    v_mov_b64 v[32:33], 0
    v_mov_b64 v[34:35], 0
    v_permlane32_swap_b32 v9, v10
    v_max_f32 v9, v9, v10
    v_mov_b32 v10, v9
    s_nop 1
    v_permlane16_swap_b32 v9, v10
    v_max_f32 v9, v9, v10
    v_mul_f32 v28, s44, v9
    v_fma_f32 v12, v12, s44, -v28
    v_fma_f32 v13, v13, s44, -v28
    v_fma_f32 v14, v14, s44, -v28
    v_fma_f32 v15, v15, s44, -v28
    v_exp_f32 v12, v12
    v_exp_f32 v13, v13
    v_fma_f32 v16, v16, s44, -v28
    v_fma_f32 v17, v17, s44, -v28
    v_exp_f32 v14, v14
    v_exp_f32 v15, v15
    v_cvt_pk_bf16_f32 v36, v12, v13
    v_fma_f32 v18, v18, s44, -v28
    v_fma_f32 v19, v19, s44, -v28
    v_exp_f32 v16, v16
    v_exp_f32 v17, v17
    v_cvt_pk_bf16_f32 v37, v14, v15
    v_fma_f32 v24, v24, s44, -v28
    v_fma_f32 v25, v25, s44, -v28
    v_exp_f32 v18, v18
    v_exp_f32 v19, v19
    v_cvt_pk_bf16_f32 v38, v16, v17
    v_exp_f32 v24, v24
    v_exp_f32 v25, v25
    v_cvt_pk_bf16_f32 v39, v18, v19
    v_cvt_pk_bf16_f32 v40, v24, v25
    v_cvt_pk_bf16_f32 v43, v24, v25
    v_mfma_f32_16x16x32_bf16 v[52:55], v[20:23], v[36:39], 0
    v_mov_b64 v[12:13], 0
    v_mov_b64 v[14:15], 0
    s_waitcnt vmcnt(3)
    v_mfma_f32_16x16x32_bf16 v[44:47], v[64:67], v[36:39], 0
    v_mov_b64 v[24:25], 0
    v_mov_b64 v[26:27], 0
    s_waitcnt vmcnt(2)
    v_mfma_f32_16x16x32_bf16 v[48:51], v[68:71], v[36:39], 0
    ds_read_b128 v[64:67], v8 offset:20480
    ds_read_b128 v[68:71], v8 offset:21504
    v_mfma_f32_16x16x16_bf16 v[52:55], v[20:21], v[40:41], v[52:55]
    v_mfma_f32_16x16x16_bf16 v[44:47], v[30:31], v[40:41], v[44:47]
    v_mov_b64 v[20:21], 0
    v_mov_b64 v[22:23], 0
    v_mfma_f32_16x16x16_bf16 v[48:51], v[30:31], v[42:43], v[48:51]
    v_mov_b64 v[36:37], 0
    v_mov_b64 v[38:39], 0
    v_mov_b64 v[40:41], 0
    v_mov_b64 v[42:43], 0
    v_rcp_f32 v9, v52
    v_mov_b64 v[52:53], 0
    v_mov_b64 v[54:55], 0
    v_mul_f32 v44, v9, v44
    v_mul_f32 v48, v9, v48
    v_cvt_pk_bf16_f32 v16, v44, v48
    v_mul_f32 v45, v9, v45
    v_mul_f32 v49, v9, v49
    v_cvt_pk_bf16_f32 v17, v45, v49
    v_mul_f32 v46, v9, v46
    v_mul_f32 v50, v9, v50
    v_cvt_pk_bf16_f32 v18, v46, v50
    v_mul_f32 v47, v9, v47
    v_mul_f32 v51, v9, v51
    v_cvt_pk_bf16_f32 v19, v47, v51
    ds_write_b128 v5, v[16:19]
    v_mov_b64 v[28:29], 0
    v_mov_b64 v[30:31], 0
    s_waitcnt lgkmcnt(0)
    s_barrier
    ds_read_b128 v[44:47], v4 offset:0
    ds_read_b128 v[48:51], v4 offset:128
    s_cmp_eq_u32 s33, 63
    s_cbranch_scc1 Lr1s_last
    v_mov_b64 v[16:17], 0
    v_mov_b64 v[18:19], 0
    buffer_load_dwordx4 v0, s[8:11], s41 offen offset:0 lds
    buffer_load_dwordx4 v0, s[8:11], s41 offen offset:1024 lds
    s_waitcnt lgkmcnt(1)
    v_smfmac_f32_16x16x64_bf16 v[12:15], v[44:47], a[184:191], v1
    s_waitcnt lgkmcnt(0)
    v_smfmac_f32_16x16x64_bf16 v[12:15], v[48:51], a[192:199], v1
    v_smfmac_f32_16x16x64_bf16 v[24:27], v[44:47], a[200:207], v1
    v_smfmac_f32_16x16x64_bf16 v[24:27], v[48:51], a[208:215], v1
    v_add_f32 v12, v12, v14
    v_smfmac_f32_16x16x64_bf16 v[20:23], v[44:47], a[216:223], v1
    v_add_f32 v13, v13, v15
    v_smfmac_f32_16x16x64_bf16 v[20:23], v[48:51], a[224:231], v1
    v_cvt_pk_bf16_f32 v12, v12, v13
    v_smfmac_f32_16x16x64_bf16 v[16:19], v[44:47], a[232:239], v1
    v_add_f32 v24, v24, v26
    v_smfmac_f32_16x16x64_bf16 v[16:19], v[48:51], a[240:247], v1
    v_add_f32 v25, v25, v27
    v_smfmac_f32_16x16x64_bf16 v[36:39], v[44:47], v[56:63], v1
    v_cvt_pk_bf16_f32 v13, v24, v25
    v_smfmac_f32_16x16x64_bf16 v[36:39], v[48:51], v[64:71], v1
    v_add_f32 v20, v20, v22
    v_add_f32 v21, v21, v23
    v_cvt_pk_bf16_f32 v14, v20, v21
    v_add_f32 v16, v16, v18
    v_add_f32 v17, v17, v19
    v_cvt_pk_bf16_f32 v15, v16, v17
    v_and_or_b32 v15, v15, -2, s40
    buffer_store_dwordx4 v[12:15], v0, s[8:11], s38 offen sc1
    s_nop 0
    ds_read_b128 v[12:15], v8 offset:18432
    ds_read_b128 v[16:19], v8 offset:19456
    ds_read_b128 v[20:23], v8 offset:22528
    ds_read_b128 v[24:27], v8 offset:23552
    ds_read_b128 v[56:59], v8 offset:24576
    ds_read_b128 v[60:63], v8 offset:25600
    ds_read_b128 v[64:67], v8 offset:28672
    ds_read_b128 v[68:71], v8 offset:29696
    s_waitcnt lgkmcnt(6)
    v_smfmac_f32_16x16x64_bf16 v[40:43], v[44:47], v[12:19], v1
    ds_read_b128 v[12:15], v8 offset:26624
    ds_read_b128 v[16:19], v8 offset:27648
    s_waitcnt lgkmcnt(6)
    v_smfmac_f32_16x16x64_bf16 v[40:43], v[48:51], v[20:27], v1
    ds_read_b128 v[20:23], v8 offset:30720
    ds_read_b128 v[24:27], v8 offset:31744
    s_waitcnt lgkmcnt(6)
    v_smfmac_f32_16x16x64_bf16 v[52:55], v[44:47], v[56:63], v1
    ds_read_b128 v[56:59], v8 offset:32768
    ds_read_b128 v[60:63], v8 offset:33792
    s_waitcnt lgkmcnt(6)
    v_smfmac_f32_16x16x64_bf16 v[52:55], v[48:51], v[64:71], v1
    s_waitcnt lgkmcnt(4)
    v_smfmac_f32_16x16x64_bf16 v[32:35], v[44:47], v[12:19], v1
    s_waitcnt lgkmcnt(2)
    v_smfmac_f32_16x16x64_bf16 v[32:35], v[48:51], v[20:27], v1
    v_smfmac_f32_16x16x64_bf16 v[28:31], v[44:47], a[248:255], v1
    s_waitcnt lgkmcnt(0)
    v_smfmac_f32_16x16x64_bf16 v[28:31], v[48:51], v[56:63], v1
    v_add_f32 v36, v36, v38
    v_add_f32 v37, v37, v39
    v_cvt_pk_bf16_f32 v36, v36, v37
    v_add_f32 v40, v40, v42
    v_add_f32 v41, v41, v43
    v_cvt_pk_bf16_f32 v37, v40, v41
    v_add_f32 v52, v52, v54
    v_add_f32 v53, v53, v55
    v_cvt_pk_bf16_f32 v38, v52, v53
    v_add_f32 v32, v32, v34
    v_add_f32 v33, v33, v35
    v_cvt_pk_bf16_f32 v39, v32, v33
    v_and_or_b32 v39, v39, -2, s40
    s_add_u32 s17, s38, 4096
    buffer_store_dwordx4 v[36:39], v0, s[8:11], s17 offen sc1
    v_add_f32 v28, v28, v30
    v_add_f32 v29, v29, v31
    v_cvt_pk_bf16_f32 v28, v28, v29
    v_and_or_b32 v28, v28, -2, s40
    v_lshrrev_b32 v9, 2, v0
    buffer_store_dword v28, v9, s[8:11], s39 offen sc1
    v_add_u32 v10, 162560, v0
    ds_read_b128 v[64:67], v10
    s_add_u32 s33, s33, 1
    s_add_u32 s42, s42, 262144
    s_add_u32 s41, s41, 262144
    s_add_u32 s43, s43, 131072
    s_mov_b32 s67, s66
    s_add_u32 s68, s68, 262144
    s_add_u32 s66, s66, 22528
    ds_read_b128 v[56:59], v8 offset:4096
    ds_read_b128 v[60:63], v8 offset:5120
    v_mov_b64 v[12:13], 0
    v_mov_b64 v[14:15], 0
    v_mov_b64 v[16:17], 0
    v_mov_b64 v[18:19], 0
    v_mov_b64 v[20:21], 0
    v_mov_b64 v[22:23], 0
    v_mov_b64 v[24:25], 0
    v_mov_b64 v[26:27], 0
    v_mov_b64 v[28:29], 0
    v_mov_b64 v[30:31], 0
    v_mov_b64 v[32:33], 0
    v_mov_b64 v[34:35], 0
    s_nop 15
    s_nop 15
    s_nop 15
    s_nop 11
    buffer_load_dwordx4 v[40:43], v6, s[8:11], s62 offen sc1
    buffer_load_dwordx4 v[44:47], v6, s[8:11], s63 offen sc1
    buffer_load_dwordx4 v[48:51], v6, s[8:11], s64 offen sc1
    buffer_load_dwordx4 v[52:55], v6, s[8:11], s65 offen sc1
    s_waitcnt lgkmcnt(0)
    s_waitcnt vmcnt(3)
    v_mfma_f32_16x16x32_bf16 v[68:71], v[40:43], v[64:67], 0
    v_and_b32 v10, 1, v43
    v_cmp_ne_u32 s[54:55], s40, v10
    s_waitcnt vmcnt(2)
    v_mfma_f32_16x16x32_bf16 v[68:71], v[44:47], v[64:67], v[68:71]
    v_and_b32 v10, 1, v47
    v_cmp_ne_u32 s[56:57], s40, v10
    s_waitcnt vmcnt(1)
    v_mfma_f32_16x16x32_bf16 v[68:71], v[48:51], v[64:67], v[68:71]
    v_and_b32 v10, 1, v51
    v_cmp_ne_u32 s[58:59], s40, v10
    s_waitcnt vmcnt(0)
    v_mfma_f32_16x16x32_bf16 v[68:71], v[52:55], v[64:67], v[68:71]
    v_and_b32 v10, 1, v55
    v_cmp_ne_u32 s[60:61], s40, v10
    s_or_b64 vcc, s[54:55], s[56:57]
    s_or_b64 vcc, vcc, s[58:59]
    s_or_b64 vcc, vcc, s[60:61]
    s_cbranch_scc0 Lr1s_red
    s_mov_b32 s16, 0
Lr1s_p1:
    s_mov_b64 exec, s[54:55]
    buffer_load_dwordx4 v[40:43], v6, s[8:11], s62 offen sc1
    s_mov_b64 exec, s[56:57]
    buffer_load_dwordx4 v[44:47], v6, s[8:11], s63 offen sc1
    s_mov_b64 exec, s[58:59]
    buffer_load_dwordx4 v[48:51], v6, s[8:11], s64 offen sc1
    s_mov_b64 exec, s[60:61]
    buffer_load_dwordx4 v[52:55], v6, s[8:11], s65 offen sc1
    s_mov_b64 exec, -1
    s_add_u32 s16, s16, 1
    s_cmp_gt_u32 s16, 100000
    s_cbranch_scc1 Lr_abort
    s_waitcnt vmcnt(3)
    v_mfma_f32_16x16x32_bf16 v[68:71], v[40:43], v[64:67], 0
    v_and_b32 v10, 1, v43
    v_cmp_ne_u32 s[54:55], s40, v10
    s_waitcnt vmcnt(2)
    v_mfma_f32_16x16x32_bf16 v[68:71], v[44:47], v[64:67], v[68:71]
    v_and_b32 v10, 1, v47
    v_cmp_ne_u32 s[56:57], s40, v10
    s_waitcnt vmcnt(1)
    v_mfma_f32_16x16x32_bf16 v[68:71], v[48:51], v[64:67], v[68:71]
    v_and_b32 v10, 1, v51
    v_cmp_ne_u32 s[58:59], s40, v10
    s_waitcnt vmcnt(0)
    v_mfma_f32_16x16x32_bf16 v[68:71], v[52:55], v[64:67], v[68:71]
    v_and_b32 v10, 1, v55
    v_cmp_ne_u32 s[60:61], s40, v10
    s_or_b64 vcc, s[54:55], s[56:57]
    s_or_b64 vcc, vcc, s[58:59]
    s_or_b64 vcc, vcc, s[60:61]
    s_cbranch_scc1 Lr1s_p1
Lr1s_red:
    s_xor_b32 s34, s34, 16384
    s_xor_b32 s35, s35, 16384
    buffer_load_dwordx4 v[36:39], v0, s[8:11], s34 offen sc1
    v_permlane16_swap_b32 v68, v70
    v_permlane16_swap_b32 v69, v71
    s_mov_b64 exec, s[46:47]
    v_add_f32 v68, v68, v70
    v_add_f32 v69, v69, v71
    v_cvt_pk_bf16_f32 v68, v68, v69
    v_min_u32 v68, s50, v68
    buffer_store_dword v68, v7, s[8:11], s36 offen sc1
    v_mov_b32 v69, -1
    buffer_store_dword v69, v7, s[8:11], s37 offen sc1
    s_mov_b64 exec, -1
    buffer_load_dwordx4 v[36:39], v0, s[8:11], s34 offen sc1
    s_xor_b32 s40, s40, 1
    s_xor_b32 s36, s36, 16384
    s_xor_b32 s37, s37, 16384
    ds_read_b128 v[64:67], v8 offset:6144
    ds_read_b128 v[68:71], v8 offset:7168
    s_waitcnt lgkmcnt(0)
    s_branch Lr1s_step
Lr1s_pb_re:
    s_mov_b32 s16, 0
Lr1s_pb_lp:
    s_add_u32 s17, s34, 4096
    buffer_load_dwordx4 v[40:43], v0, s[8:11], s17 offen sc1
    s_add_u32 s16, s16, 1
    s_cmp_gt_u32 s16, 100000
    s_cbranch_scc1 Lr_abort
    s_waitcnt vmcnt(0)
    v_max3_u32 v10, v40, v41, v42
    v_max_u32 v10, v10, v43
    v_cmp_eq_u32 vcc, -1, v10
    s_nop 0
    s_cbranch_vccnz Lr1s_pb_lp
    s_branch Lr1s_pb_ok
Lr1s_pc_re:
    s_mov_b32 s16, 0
Lr1s_pc_lp:
    buffer_load_dwordx4 v[44:47], v0, s[8:11], s35 offen sc1
    s_add_u32 s16, s16, 1
    s_cmp_gt_u32 s16, 100000
    s_cbranch_scc1 Lr_abort
    s_waitcnt vmcnt(0)
    v_max3_u32 v10, v44, v45, v46
    v_max_u32 v10, v10, v47
    v_cmp_eq_u32 vcc, -1, v10
    s_nop 0
    s_cbranch_vccnz Lr1s_pc_lp
    s_branch Lr1s_pc_ok
Lr1s_last:
    s_waitcnt vmcnt(0) lgkmcnt(0)
    s_barrier
    s_mov_b32 s67, s66
    v_mov_b32 v9, 1
    v_mov_b32 v10, 0
    s_mov_b64 exec, 1
    buffer_store_dword v9, v10, s[8:11], s67 offen offset:384 sc1
    s_mov_b64 exec, -1
    s_branch Lr_exit
L_w2_0:
    s_cmp_lg_u32 s14, 2
    s_cbranch_scc1 L_w3_0
    s_mov_b32 s16, 0
    s_add_u32 s17, s66, 128
    v_lshrrev_b32 v10, 2, v0
    v_and_b32 v9, 16, v10
    v_lshlrev_b32 v9, 3, v9
    v_and_or_b32 v10, v10, 12, v9
Lr2s_fw_17:
    buffer_load_dword v9, v10, s[8:11], s17 offen sc1
    s_add_u32 s16, s16, 1
    s_cmp_gt_u32 s16, 100000
    s_cbranch_scc1 Lr_abort
    s_waitcnt vmcnt(0)
    v_cmp_eq_u32 vcc, 0, v9
    s_nop 0
    s_cbranch_vccnz Lr2s_fw_17
    s_mov_b32 m0, 19200
    s_nop 0
    buffer_load_dwordx4 v0, s[8:11], s41 offen offset:0 lds
    buffer_load_dwordx4 v0, s[8:11], s41 offen offset:1024 lds
    s_add_u32 s41, s41, 262144
    s_add_u32 s68, s68, 262144
    s_waitcnt vmcnt(0)
    ds_read_b128 v[56:59], v8 offset:4096
    ds_read_b128 v[60:63], v8 offset:5120
    ds_read_b128 v[64:67], v8 offset:6144
    ds_read_b128 v[68:71], v8 offset:7168
    v_mov_b64 v[12:13], 0
    v_mov_b64 v[14:15], 0
    v_mov_b64 v[16:17], 0
    v_mov_b64 v[18:19], 0
    v_mov_b64 v[20:21], 0
    v_mov_b64 v[22:23], 0
    v_mov_b64 v[24:25], 0
    v_mov_b64 v[26:27], 0
    v_mov_b64 v[28:29], 0
    v_mov_b64 v[30:31], 0
    v_mov_b64 v[32:33], 0
    v_mov_b64 v[34:35], 0
    buffer_load_dwordx4 v[36:39], v0, s[8:11], s34 offen sc1
    s_waitcnt vmcnt(0) lgkmcnt(0)
Lr2s_step:
    s_waitcnt vmcnt(3)
    v_max3_u32 v10, v36, v37, v38
    v_max_u32 v10, v10, v39
    v_cmp_eq_u32 vcc, -1, v10
    s_nop 0
    s_cbranch_vccz Lr2s_aok
    buffer_load_dwordx4 v[36:39], v0, s[8:11], s34 offen sc1
    s_nop 15
    s_nop 8
    buffer_load_dwordx4 v[36:39], v0, s[8:11], s34 offen sc1
    s_mov_b32 s16, 0
Lr2s_alp:
    s_waitcnt vmcnt(2)
    v_max3_u32 v10, v36, v37, v38
    v_max_u32 v10, v10, v39
    v_cmp_eq_u32 vcc, -1, v10
    s_nop 0
    s_cbranch_vccz Lr2s_aok
    buffer_load_dwordx4 v[36:39], v0, s[8:11], s34 offen sc1
    s_add_u32 s16, s16, 1
    s_cmp_gt_u32 s16, 100000
    s_cbranch_scc1 Lr_abort
    s_branch Lr2s_alp
Lr2s_aok:
    ds_write_b128 v0, v[36:39] offset:8960
    v_smfmac_f32_16x16x64_bf16 v[12:15], v[36:39], v[104:111], v1
    v_smfmac_f32_16x16x64_bf16 v[16:19], v[36:39], v[112:119], v1
    v_smfmac_f32_16x16x64_bf16 v[20:23], v[36:39], v[216:223], v1
    s_waitcnt lgkmcnt(0)
    s_barrier
    ds_read_b128 v[48:51], v0 offset:9984
    ds_read_b128 v[52:55], v0 offset:6912
    v_smfmac_f32_16x16x64_bf16 v[28:31], v[36:39], v[56:63], v1
    ds_read_b128 v[56:59], v8 offset:0
    ds_read_b128 v[60:63], v8 offset:1024
    v_smfmac_f32_16x16x64_bf16 v[24:27], v[36:39], v[224:231], v1
    v_smfmac_f32_16x16x64_bf16 v[32:35], v[36:39], v[64:71], v1
    ds_read_b128 v[64:67], v8 offset:2048
    ds_read_b128 v[68:71], v8 offset:3072
    s_add_u32 s17, s34, 4096
    buffer_load_dwordx4 v[40:43], v0, s[8:11], s17 offen sc1
    s_waitcnt vmcnt(1)
    ds_read_b128 v[36:39], v0 offset:7936
    s_waitcnt lgkmcnt(6)
    v_smfmac_f32_16x16x64_bf16 v[28:31], v[48:51], a[88:95], v1
    v_smfmac_f32_16x16x64_bf16 v[12:15], v[48:51], v[120:127], v1
    v_smfmac_f32_16x16x64_bf16 v[16:19], v[48:51], v[128:135], v1
    v_smfmac_f32_16x16x64_bf16 v[32:35], v[48:51], a[96:103], v1
    buffer_load_dwordx4 v[44:47], v0, s[8:11], s35 offen sc1
    v_smfmac_f32_16x16x64_bf16 v[20:23], v[48:51], v[232:239], v1
    v_lshrrev_b32 v10, 2, v0
    v_and_b32 v9, 16, v10
    v_lshlrev_b32 v9, 3, v9
    v_and_or_b32 v10, v10, 12, v9
    s_add_u32 s17, s66, 22656
    v_mov_b32 v11, 2
    buffer_load_dword v11, v10, s[8:11], s17 offen sc1
    v_smfmac_f32_16x16x64_bf16 v[24:27], v[48:51], v[240:247], v1
    s_waitcnt lgkmcnt(3)
    v_smfmac_f32_16x16x64_bf16 v[28:31], v[52:55], v[56:63], v1
    ds_read_b128 v[56:59], v8 offset:12288
    ds_read_b128 v[60:63], v8 offset:13312
    v_smfmac_f32_16x16x64_bf16 v[12:15], v[52:55], v[72:79], v1
    v_smfmac_f32_16x16x64_bf16 v[16:19], v[52:55], v[80:87], v1
    s_waitcnt lgkmcnt(3)
    v_smfmac_f32_16x16x64_bf16 v[32:35], v[52:55], v[64:71], v1
    ds_read_b128 v[64:67], v8 offset:14336
    ds_read_b128 v[68:71], v8 offset:15360
    v_smfmac_f32_16x16x64_bf16 v[20:23], v[52:55], v[184:191], v1
    v_smfmac_f32_16x16x64_bf16 v[24:27], v[52:55], v[192:199], v1
    s_waitcnt lgkmcnt(4)
    v_smfmac_f32_16x16x64_bf16 v[28:31], v[36:39], a[72:79], v1
    v_smfmac_f32_16x16x64_bf16 v[12:15], v[36:39], v[88:95], v1
    v_smfmac_f32_16x16x64_bf16 v[16:19], v[36:39], v[96:103], v1
    v_smfmac_f32_16x16x64_bf16 v[32:35], v[36:39], a[80:87], v1
    v_smfmac_f32_16x16x64_bf16 v[20:23], v[36:39], v[200:207], v1
    v_smfmac_f32_16x16x64_bf16 v[24:27], v[36:39], v[208:215], v1
    s_waitcnt vmcnt(2)
    v_max3_u32 v10, v40, v41, v42
    v_max_u32 v10, v10, v43
    v_cmp_eq_u32 vcc, -1, v10
    s_nop 0
    s_cbranch_vccnz Lr2s_pb_re
Lr2s_pb_ok:
    ds_write_b128 v0, v[40:43] offset:13056
    s_waitcnt lgkmcnt(3)
    v_smfmac_f32_16x16x64_bf16 v[12:15], v[40:43], v[56:63], v1
    ds_read_b128 v[56:59], v8 offset:8192
    ds_read_b128 v[60:63], v8 offset:9216
    v_smfmac_f32_16x16x64_bf16 v[20:23], v[40:43], a[24:31], v1
    s_waitcnt lgkmcnt(3)
    v_smfmac_f32_16x16x64_bf16 v[16:19], v[40:43], v[64:71], v1
    ds_read_b128 v[64:67], v8 offset:10240
    ds_read_b128 v[68:71], v8 offset:11264
    v_smfmac_f32_16x16x64_bf16 v[24:27], v[40:43], a[32:39], v1
    s_waitcnt lgkmcnt(4)
    s_barrier
    ds_read_b128 v[48:51], v0 offset:11008
    ds_read_b128 v[52:55], v0 offset:14080
    ds_read_b128 v[36:39], v0 offset:12032
    v_smfmac_f32_16x16x64_bf16 v[28:31], v[40:43], a[136:143], v1
    v_smfmac_f32_16x16x64_bf16 v[32:35], v[40:43], a[144:151], v1
    s_waitcnt lgkmcnt(2)
    v_smfmac_f32_16x16x64_bf16 v[12:15], v[48:51], v[56:63], v1
    v_smfmac_f32_16x16x64_bf16 v[16:19], v[48:51], v[64:71], v1
    s_waitcnt lgkmcnt(1)
    v_smfmac_f32_16x16x64_bf16 v[12:15], v[52:55], v[152:159], v1
    v_smfmac_f32_16x16x64_bf16 v[16:19], v[52:55], v[160:167], v1
    s_waitcnt lgkmcnt(0)
    v_smfmac_f32_16x16x64_bf16 v[12:15], v[36:39], v[136:143], v1
    v_smfmac_f32_16x16x64_bf16 v[16:19], v[36:39], v[144:151], v1
    s_waitcnt vmcnt(1)
    v_max3_u32 v10, v44, v45, v46
    v_max_u32 v10, v10, v47
    v_cmp_eq_u32 vcc, -1, v10
    s_nop 0
    s_cbranch_vccnz Lr2s_pc_re
Lr2s_pc_ok:
    v_smfmac_f32_16x16x64_bf16 v[12:15], v[44:47], v[168:175], v1
    v_smfmac_f32_16x16x64_bf16 v[16:19], v[44:47], v[176:183], v1
    v_smfmac_f32_16x16x64_bf16 v[20:23], v[48:51], v[248:255], v1
    v_smfmac_f32_16x16x64_bf16 v[24:27], v[48:51], a[0:7], v1
    v_smfmac_f32_16x16x64_bf16 v[20:23], v[52:55], a[40:47], v1
    v_add_f32 v12, v12, v14
    buffer_load_dwordx4 v[64:67], v0, s[8:11], s42 offen
    v_smfmac_f32_16x16x64_bf16 v[24:27], v[52:55], a[48:55], v1
    v_add_f32 v16, v16, v18
    v_smfmac_f32_16x16x64_bf16 v[20:23], v[36:39], a[8:15], v1
    v_add_f32 v13, v13, v15
    v_smfmac_f32_16x16x64_bf16 v[24:27], v[36:39], a[16:23], v1
    v_add_f32 v17, v17, v19
    v_smfmac_f32_16x16x64_bf16 v[20:23], v[44:47], a[56:63], v1
    v_cvt_pk_bf16_f32 v14, v12, v16
    ds_read_b128 v[56:59], v0 offset:15104
    buffer_load_dwordx4 v[68:71], v0, s[8:11], s42 offen offset:1024
    v_smfmac_f32_16x16x64_bf16 v[24:27], v[44:47], a[64:71], v1
    v_cvt_pk_bf16_f32 v15, v13, v17
    ds_read_b128 v[60:63], v0 offset:16128
    ds_write_b32 v2, v14 offset:576
    ds_write_b32 v2, v15 offset:864
    v_smfmac_f32_16x16x64_bf16 v[28:31], v[48:51], a[104:111], v1
    v_smfmac_f32_16x16x64_bf16 v[32:35], v[48:51], a[112:119], v1
    v_add_f32 v20, v20, v22
    v_add_f32 v24, v24, v26
    v_add_f32 v21, v21, v23
    v_add_f32 v25, v25, v27
    v_cvt_pk_bf16_f32 v22, v20, v24
    v_cvt_pk_bf16_f32 v23, v21, v25
    ds_write_b32 v2, v22 offset:0
    ds_write_b32 v2, v23 offset:288
    v_smfmac_f32_16x16x64_bf16 v[28:31], v[52:55], a[152:159], v1
    v_smfmac_f32_16x16x64_bf16 v[32:35], v[52:55], a[160:167], v1
    s_waitcnt vmcnt(2)
    v_cmp_eq_u32 vcc, 0, v11
    s_nop 0
    s_cbranch_vccnz Lr2s_flbad
Lr2s_flok:
    s_waitcnt lgkmcnt(0)
    s_barrier
    ds_read_b128 v[40:43], v3 offset:0
    ds_read_b128 v[48:51], v3 offset:64
    ds_read_b128 v[20:23], v3 offset:128
    ds_read_b128 v[52:55], v3 offset:192
    v_smfmac_f32_16x16x64_bf16 v[28:31], v[36:39], a[120:127], v1
    v_smfmac_f32_16x16x64_bf16 v[32:35], v[36:39], a[128:135], v1
    ds_read_b128 v[36:39], v0 offset:17152
    v_smfmac_f32_16x16x64_bf16 v[28:31], v[44:47], a[168:175], v1
    v_smfmac_f32_16x16x64_bf16 v[32:35], v[44:47], a[176:183], v1
    ds_read_b128 v[44:47], v0 offset:18176
    s_waitcnt lgkmcnt(5)
    v_mfma_f32_16x16x32_bf16 v[12:15], v[56:59], v[40:43], 0
    v_mfma_f32_16x16x32_bf16 v[16:19], v[60:63], v[40:43], 0
    v_mfma_f32_16x16x32_bf16 v[24:27], v[40:43], v[40:43], 0
    ds_read_b128 v[56:59], v0 offset:19200
    ds_read_b128 v[60:63], v0 offset:20224
    s_waitcnt lgkmcnt(3)
    v_mfma_f32_16x16x32_bf16 v[12:15], v[36:39], v[48:51], v[12:15]
    v_lshrrev_b32 v10, 1, v0
    v_lshrrev_b32 v9, 9, v0
    s_waitcnt lgkmcnt(2)
    v_mfma_f32_16x16x32_bf16 v[16:19], v[44:47], v[48:51], v[16:19]
    v_lshl_add_u32 v9, v9, 5, v10
    v_add_f32 v28, v28, v30
    v_mfma_f32_16x16x32_bf16 v[24:27], v[48:51], v[48:51], v[24:27]
    v_add_f32 v32, v32, v34
    v_add_f32 v29, v29, v31
    ds_read_b128 v[36:39], v0 offset:21248
    ds_read_b128 v[44:47], v0 offset:22272
    s_waitcnt lgkmcnt(3)
    v_mfma_f32_16x16x32_bf16 v[12:15], v[56:59], v[20:23], v[12:15]
    v_add_f32 v33, v33, v35
    v_cvt_pk_bf16_f32 v30, v28, v29
    s_waitcnt lgkmcnt(2)
    v_mfma_f32_16x16x32_bf16 v[16:19], v[60:63], v[20:23], v[16:19]
    v_cvt_pk_bf16_f32 v31, v32, v33
    ds_read_b64 v[34:35], v9 offset:2304
    v_mfma_f32_16x16x32_bf16 v[24:27], v[20:23], v[20:23], v[24:27]
    s_add_u32 s17, s43, 3072
    buffer_store_dwordx2 v[30:31], v10, s[8:11], s17 offen sc1
    s_waitcnt lgkmcnt(2)
    v_mfma_f32_16x16x32_bf16 v[12:15], v[36:39], v[52:55], v[12:15]
    s_waitcnt lgkmcnt(1)
    v_mfma_f32_16x16x32_bf16 v[16:19], v[44:47], v[52:55], v[16:19]
    v_mfma_f32_16x16x32_bf16 v[24:27], v[52:55], v[52:55], v[24:27]
    s_add_u32 s17, s43, 1024
    s_waitcnt lgkmcnt(0)
    buffer_store_dwordx2 v[34:35], v10, s[8:11], s17 offen sc1
    ds_read_b128 v[56:59], v8 offset:16384
    ds_read_b128 v[60:63], v8 offset:17408
    v_mov_b64 v[20:21], s[52:53]
    v_mov_b64 v[22:23], s[52:53]
    v_mov_b32 v41, 0
    v_mov_b32 v42, 0
    v_max3_f32 v9, v12, v13, v14
    v_max3_f32 v9, v9, v15, v16
    v_max3_f32 v9, v9, v17, v18
    v_max3_f32 v9, v9, v19, v24
    v_max_f32 v9, v9, v25
    v_mov_b32 v10, v9
    v_mov_b64 v[32:33], 0
    v_mov_b64 v[34:35], 0
    v_permlane32_swap_b32 v9, v10
    v_max_f32 v9, v9, v10
    v_mov_b32 v10, v9
    s_nop 1
    v_permlane16_swap_b32 v9, v10
    v_max_f32 v9, v9, v10
    v_mul_f32 v28, s44, v9
    v_fma_f32 v12, v12, s44, -v28
    v_fma_f32 v13, v13, s44, -v28
    v_fma_f32 v14, v14, s44, -v28
    v_fma_f32 v15, v15, s44, -v28
    v_exp_f32 v12, v12
    v_exp_f32 v13, v13
    v_fma_f32 v16, v16, s44, -v28
    v_fma_f32 v17, v17, s44, -v28
    v_exp_f32 v14, v14
    v_exp_f32 v15, v15
    v_cvt_pk_bf16_f32 v36, v12, v13
    v_fma_f32 v18, v18, s44, -v28
    v_fma_f32 v19, v19, s44, -v28
    v_exp_f32 v16, v16
    v_exp_f32 v17, v17
    v_cvt_pk_bf16_f32 v37, v14, v15
    v_fma_f32 v24, v24, s44, -v28
    v_fma_f32 v25, v25, s44, -v28
    v_exp_f32 v18, v18
    v_exp_f32 v19, v19
    v_cvt_pk_bf16_f32 v38, v16, v17
    v_exp_f32 v24, v24
    v_exp_f32 v25, v25
    v_cvt_pk_bf16_f32 v39, v18, v19
    v_cvt_pk_bf16_f32 v40, v24, v25
    v_cvt_pk_bf16_f32 v43, v24, v25
    v_mfma_f32_16x16x32_bf16 v[52:55], v[20:23], v[36:39], 0
    v_mov_b64 v[12:13], 0
    v_mov_b64 v[14:15], 0
    s_waitcnt vmcnt(3)
    v_mfma_f32_16x16x32_bf16 v[44:47], v[64:67], v[36:39], 0
    v_mov_b64 v[24:25], 0
    v_mov_b64 v[26:27], 0
    s_waitcnt vmcnt(2)
    v_mfma_f32_16x16x32_bf16 v[48:51], v[68:71], v[36:39], 0
    ds_read_b128 v[64:67], v8 offset:20480
    ds_read_b128 v[68:71], v8 offset:21504
    v_mfma_f32_16x16x16_bf16 v[52:55], v[20:21], v[40:41], v[52:55]
    v_mfma_f32_16x16x16_bf16 v[44:47], v[30:31], v[40:41], v[44:47]
    v_mov_b64 v[20:21], 0
    v_mov_b64 v[22:23], 0
    v_mfma_f32_16x16x16_bf16 v[48:51], v[30:31], v[42:43], v[48:51]
    v_mov_b64 v[36:37], 0
    v_mov_b64 v[38:39], 0
    v_mov_b64 v[40:41], 0
    v_mov_b64 v[42:43], 0
    v_rcp_f32 v9, v52
    v_mov_b64 v[52:53], 0
    v_mov_b64 v[54:55], 0
    v_mul_f32 v44, v9, v44
    v_mul_f32 v48, v9, v48
    v_cvt_pk_bf16_f32 v16, v44, v48
    v_mul_f32 v45, v9, v45
    v_mul_f32 v49, v9, v49
    v_cvt_pk_bf16_f32 v17, v45, v49
    v_mul_f32 v46, v9, v46
    v_mul_f32 v50, v9, v50
    v_cvt_pk_bf16_f32 v18, v46, v50
    v_mul_f32 v47, v9, v47
    v_mul_f32 v51, v9, v51
    v_cvt_pk_bf16_f32 v19, v47, v51
    ds_write_b128 v5, v[16:19]
    v_mov_b64 v[28:29], 0
    v_mov_b64 v[30:31], 0
    s_waitcnt lgkmcnt(0)
    s_barrier
    ds_read_b128 v[44:47], v4 offset:0
    ds_read_b128 v[48:51], v4 offset:128
    s_cmp_eq_u32 s33, 63
    s_cbranch_scc1 Lr2s_last
    v_mov_b64 v[16:17], 0
    v_mov_b64 v[18:19], 0
    buffer_load_dwordx4 v0, s[8:11], s41 offen offset:0 lds
    buffer_load_dwordx4 v0, s[8:11], s41 offen offset:1024 lds
    s_waitcnt lgkmcnt(1)
    v_smfmac_f32_16x16x64_bf16 v[12:15], v[44:47], a[184:191], v1
    s_waitcnt lgkmcnt(0)
    v_smfmac_f32_16x16x64_bf16 v[12:15], v[48:51], a[192:199], v1
    v_smfmac_f32_16x16x64_bf16 v[24:27], v[44:47], a[200:207], v1
    v_smfmac_f32_16x16x64_bf16 v[24:27], v[48:51], a[208:215], v1
    v_add_f32 v12, v12, v14
    v_smfmac_f32_16x16x64_bf16 v[20:23], v[44:47], a[216:223], v1
    v_add_f32 v13, v13, v15
    v_smfmac_f32_16x16x64_bf16 v[20:23], v[48:51], a[224:231], v1
    v_cvt_pk_bf16_f32 v12, v12, v13
    v_smfmac_f32_16x16x64_bf16 v[16:19], v[44:47], a[232:239], v1
    v_add_f32 v24, v24, v26
    v_smfmac_f32_16x16x64_bf16 v[16:19], v[48:51], a[240:247], v1
    v_add_f32 v25, v25, v27
    v_smfmac_f32_16x16x64_bf16 v[36:39], v[44:47], v[56:63], v1
    v_cvt_pk_bf16_f32 v13, v24, v25
    v_smfmac_f32_16x16x64_bf16 v[36:39], v[48:51], v[64:71], v1
    v_add_f32 v20, v20, v22
    v_add_f32 v21, v21, v23
    v_cvt_pk_bf16_f32 v14, v20, v21
    v_add_f32 v16, v16, v18
    v_add_f32 v17, v17, v19
    v_cvt_pk_bf16_f32 v15, v16, v17
    v_and_or_b32 v15, v15, -2, s40
    buffer_store_dwordx4 v[12:15], v0, s[8:11], s38 offen sc1
    s_nop 0
    ds_read_b128 v[12:15], v8 offset:18432
    ds_read_b128 v[16:19], v8 offset:19456
    ds_read_b128 v[20:23], v8 offset:22528
    ds_read_b128 v[24:27], v8 offset:23552
    ds_read_b128 v[56:59], v8 offset:24576
    ds_read_b128 v[60:63], v8 offset:25600
    ds_read_b128 v[64:67], v8 offset:28672
    ds_read_b128 v[68:71], v8 offset:29696
    s_waitcnt lgkmcnt(6)
    v_smfmac_f32_16x16x64_bf16 v[40:43], v[44:47], v[12:19], v1
    ds_read_b128 v[12:15], v8 offset:26624
    ds_read_b128 v[16:19], v8 offset:27648
    s_waitcnt lgkmcnt(6)
    v_smfmac_f32_16x16x64_bf16 v[40:43], v[48:51], v[20:27], v1
    ds_read_b128 v[20:23], v8 offset:30720
    ds_read_b128 v[24:27], v8 offset:31744
    s_waitcnt lgkmcnt(6)
    v_smfmac_f32_16x16x64_bf16 v[52:55], v[44:47], v[56:63], v1
    ds_read_b128 v[56:59], v8 offset:32768
    ds_read_b128 v[60:63], v8 offset:33792
    s_waitcnt lgkmcnt(6)
    v_smfmac_f32_16x16x64_bf16 v[52:55], v[48:51], v[64:71], v1
    s_waitcnt lgkmcnt(4)
    v_smfmac_f32_16x16x64_bf16 v[32:35], v[44:47], v[12:19], v1
    s_waitcnt lgkmcnt(2)
    v_smfmac_f32_16x16x64_bf16 v[32:35], v[48:51], v[20:27], v1
    v_smfmac_f32_16x16x64_bf16 v[28:31], v[44:47], a[248:255], v1
    s_waitcnt lgkmcnt(0)
    v_smfmac_f32_16x16x64_bf16 v[28:31], v[48:51], v[56:63], v1
    v_add_f32 v36, v36, v38
    v_add_f32 v37, v37, v39
    v_cvt_pk_bf16_f32 v36, v36, v37
    v_add_f32 v40, v40, v42
    v_add_f32 v41, v41, v43
    v_cvt_pk_bf16_f32 v37, v40, v41
    v_add_f32 v52, v52, v54
    v_add_f32 v53, v53, v55
    v_cvt_pk_bf16_f32 v38, v52, v53
    v_add_f32 v32, v32, v34
    v_add_f32 v33, v33, v35
    v_cvt_pk_bf16_f32 v39, v32, v33
    v_and_or_b32 v39, v39, -2, s40
    s_add_u32 s17, s38, 4096
    buffer_store_dwordx4 v[36:39], v0, s[8:11], s17 offen sc1
    v_add_f32 v28, v28, v30
    v_add_f32 v29, v29, v31
    v_cvt_pk_bf16_f32 v28, v28, v29
    v_and_or_b32 v28, v28, -2, s40
    v_lshrrev_b32 v9, 2, v0
    buffer_store_dword v28, v9, s[8:11], s39 offen sc1
    v_add_u32 v10, 162560, v0
    ds_read_b32 v64, v10
    v_mov_b32 v65, 0
    v_mov_b32 v41, 0
    v_mov_b32 v45, 0
    v_mov_b32 v49, 0
    v_mov_b32 v53, 0
    s_add_u32 s33, s33, 1
    s_add_u32 s42, s42, 262144
    s_add_u32 s41, s41, 262144
    s_add_u32 s43, s43, 131072
    s_add_u32 s68, s68, 262144
    s_add_u32 s66, s66, 22528
    ds_read_b128 v[56:59], v8 offset:4096
    ds_read_b128 v[60:63], v8 offset:5120
    v_mov_b64 v[12:13], 0
    v_mov_b64 v[14:15], 0
    v_mov_b64 v[16:17], 0
    v_mov_b64 v[18:19], 0
    v_mov_b64 v[20:21], 0
    v_mov_b64 v[22:23], 0
    v_mov_b64 v[24:25], 0
    v_mov_b64 v[26:27], 0
    v_mov_b64 v[28:29], 0
    v_mov_b64 v[30:31], 0
    v_mov_b64 v[32:33], 0
    v_mov_b64 v[34:35], 0
    s_nop 15
    s_nop 15
    s_nop 15
    s_nop 1
    buffer_load_dword v40, v6, s[8:11], s62 offen sc1
    buffer_load_dword v44, v6, s[8:11], s63 offen sc1
    buffer_load_dword v48, v6, s[8:11], s64 offen sc1
    buffer_load_dword v52, v6, s[8:11], s65 offen sc1
    s_waitcnt lgkmcnt(0)
    s_waitcnt vmcnt(3)
    v_mfma_f32_16x16x16_bf16 v[68:71], v[40:41], v[64:65], 0
    v_and_b32 v10, 1, v40
    v_cmp_ne_u32 s[54:55], s40, v10
    s_waitcnt vmcnt(2)
    v_mfma_f32_16x16x16_bf16 v[68:71], v[44:45], v[64:65], v[68:71]
    v_and_b32 v10, 1, v44
    v_cmp_ne_u32 s[56:57], s40, v10
    s_waitcnt vmcnt(1)
    v_mfma_f32_16x16x16_bf16 v[68:71], v[48:49], v[64:65], v[68:71]
    v_and_b32 v10, 1, v48
    v_cmp_ne_u32 s[58:59], s40, v10
    s_waitcnt vmcnt(0)
    v_mfma_f32_16x16x16_bf16 v[68:71], v[52:53], v[64:65], v[68:71]
    v_and_b32 v10, 1, v52
    v_cmp_ne_u32 s[60:61], s40, v10
    s_or_b64 vcc, s[54:55], s[56:57]
    s_or_b64 vcc, vcc, s[58:59]
    s_or_b64 vcc, vcc, s[60:61]
    s_cbranch_scc0 Lr2s_red
    s_mov_b32 s16, 0
Lr2s_p1:
    s_mov_b64 exec, s[54:55]
    buffer_load_dword v40, v6, s[8:11], s62 offen sc1
    s_mov_b64 exec, s[56:57]
    buffer_load_dword v44, v6, s[8:11], s63 offen sc1
    s_mov_b64 exec, s[58:59]
    buffer_load_dword v48, v6, s[8:11], s64 offen sc1
    s_mov_b64 exec, s[60:61]
    buffer_load_dword v52, v6, s[8:11], s65 offen sc1
    s_mov_b64 exec, -1
    s_add_u32 s16, s16, 1
    s_cmp_gt_u32 s16, 100000
    s_cbranch_scc1 Lr_abort
    s_waitcnt vmcnt(3)
    v_mfma_f32_16x16x16_bf16 v[68:71], v[40:41], v[64:65], 0
    v_and_b32 v10, 1, v40
    v_cmp_ne_u32 s[54:55], s40, v10
    s_waitcnt vmcnt(2)
    v_mfma_f32_16x16x16_bf16 v[68:71], v[44:45], v[64:65], v[68:71]
    v_and_b32 v10, 1, v44
    v_cmp_ne_u32 s[56:57], s40, v10
    s_waitcnt vmcnt(1)
    v_mfma_f32_16x16x16_bf16 v[68:71], v[48:49], v[64:65], v[68:71]
    v_and_b32 v10, 1, v48
    v_cmp_ne_u32 s[58:59], s40, v10
    s_waitcnt vmcnt(0)
    v_mfma_f32_16x16x16_bf16 v[68:71], v[52:53], v[64:65], v[68:71]
    v_and_b32 v10, 1, v52
    v_cmp_ne_u32 s[60:61], s40, v10
    s_or_b64 vcc, s[54:55], s[56:57]
    s_or_b64 vcc, vcc, s[58:59]
    s_or_b64 vcc, vcc, s[60:61]
    s_cbranch_scc1 Lr2s_p1
Lr2s_red:
    s_xor_b32 s34, s34, 16384
    s_xor_b32 s35, s35, 16384
    buffer_load_dwordx4 v[36:39], v0, s[8:11], s34 offen sc1
    v_permlane16_swap_b32 v68, v70
    v_permlane16_swap_b32 v69, v71
    s_mov_b64 exec, s[46:47]
    v_add_f32 v68, v68, v70
    v_add_f32 v69, v69, v71
    v_cvt_pk_bf16_f32 v68, v68, v69
    v_min_u32 v68, s50, v68
    buffer_store_dword v68, v7, s[8:11], s36 offen sc1
    v_mov_b32 v69, -1
    buffer_store_dword v69, v7, s[8:11], s37 offen sc1
    s_mov_b64 exec, -1
    buffer_load_dwordx4 v[36:39], v0, s[8:11], s34 offen sc1
    s_xor_b32 s40, s40, 1
    s_xor_b32 s36, s36, 16384
    s_xor_b32 s37, s37, 16384
    ds_read_b128 v[64:67], v8 offset:6144
    ds_read_b128 v[68:71], v8 offset:7168
    s_waitcnt lgkmcnt(0)
    s_branch Lr2s_step
Lr2s_pb_re:
    s_mov_b32 s16, 0
Lr2s_pb_lp:
    s_add_u32 s17, s34, 4096
    buffer_load_dwordx4 v[40:43], v0, s[8:11], s17 offen sc1
    s_add_u32 s16, s16, 1
    s_cmp_gt_u32 s16, 100000
    s_cbranch_scc1 Lr_abort
    s_waitcnt vmcnt(0)
    v_max3_u32 v10, v40, v41, v42
    v_max_u32 v10, v10, v43
    v_cmp_eq_u32 vcc, -1, v10
    s_nop 0
    s_cbranch_vccnz Lr2s_pb_lp
    s_branch Lr2s_pb_ok
Lr2s_pc_re:
    s_mov_b32 s16, 0
Lr2s_pc_lp:
    buffer_load_dwordx4 v[44:47], v0, s[8:11], s35 offen sc1
    s_add_u32 s16, s16, 1
    s_cmp_gt_u32 s16, 100000
    s_cbranch_scc1 Lr_abort
    s_waitcnt vmcnt(0)
    v_max3_u32 v10, v44, v45, v46
    v_max_u32 v10, v10, v47
    v_cmp_eq_u32 vcc, -1, v10
    s_nop 0
    s_cbranch_vccnz Lr2s_pc_lp
    s_branch Lr2s_pc_ok
Lr2s_flbad:
    s_cmp_eq_u32 s33, 63
    s_cbranch_scc1 Lr2s_flok
    s_mov_b32 s16, 0
    s_add_u32 s17, s66, 22656
    v_lshrrev_b32 v10, 2, v0
    v_and_b32 v9, 16, v10
    v_lshlrev_b32 v9, 3, v9
    v_and_or_b32 v10, v10, 12, v9
Lr2s_fw_18:
    buffer_load_dword v9, v10, s[8:11], s17 offen sc1
    s_add_u32 s16, s16, 1
    s_cmp_gt_u32 s16, 100000
    s_cbranch_scc1 Lr_abort
    s_waitcnt vmcnt(0)
    v_cmp_eq_u32 vcc, 0, v9
    s_nop 0
    s_cbranch_vccnz Lr2s_fw_18
    s_branch Lr2s_flok
Lr2s_last:
    s_waitcnt vmcnt(0) lgkmcnt(0)
    s_barrier
    s_branch Lr_exit
L_w3_0:
    s_mov_b32 s16, 0
    s_add_u32 s17, s66, 128
    v_lshrrev_b32 v10, 2, v0
    v_and_b32 v9, 16, v10
    v_lshlrev_b32 v9, 3, v9
    v_and_or_b32 v10, v10, 12, v9
Lr3s_fw_19:
    buffer_load_dword v9, v10, s[8:11], s17 offen sc1
    s_add_u32 s16, s16, 1
    s_cmp_gt_u32 s16, 100000
    s_cbranch_scc1 Lr_abort
    s_waitcnt vmcnt(0)
    v_cmp_eq_u32 vcc, 0, v9
    s_nop 0
    s_cbranch_vccnz Lr3s_fw_19
    s_mov_b32 m0, 21248
    s_nop 0
    buffer_load_dwordx4 v0, s[8:11], s41 offen offset:0 lds
    buffer_load_dwordx4 v0, s[8:11], s41 offen offset:1024 lds
    s_add_u32 s41, s41, 262144
    s_add_u32 s68, s68, 262144
    s_waitcnt vmcnt(0)
    ds_read_b128 v[56:59], v8 offset:0
    ds_read_b128 v[60:63], v8 offset:1024
    ds_read_b128 v[64:67], v8 offset:2048
    ds_read_b128 v[68:71], v8 offset:3072
    v_mov_b64 v[12:13], 0
    v_mov_b64 v[14:15], 0
    v_mov_b64 v[16:17], 0
    v_mov_b64 v[18:19], 0
    v_mov_b64 v[20:21], 0
    v_mov_b64 v[22:23], 0
    v_mov_b64 v[24:25], 0
    v_mov_b64 v[26:27], 0
    v_mov_b64 v[28:29], 0
    v_mov_b64 v[30:31], 0
    v_mov_b64 v[32:33], 0
    v_mov_b64 v[34:35], 0
    buffer_load_dwordx4 v[36:39], v0, s[8:11], s34 offen sc1
    s_waitcnt vmcnt(0) lgkmcnt(0)
Lr3s_step:
    s_mov_b32 s16, 0
Lr3s_alp:
    s_waitcnt vmcnt(2)
    v_max3_u32 v10, v36, v37, v38
    v_max_u32 v10, v10, v39
    v_cmp_eq_u32 vcc, -1, v10
    s_nop 0
    s_cbranch_vccz Lr3s_aok
    buffer_load_dwordx4 v[36:39], v0, s[8:11], s34 offen sc1
    s_add_u32 s16, s16, 1
    s_cmp_gt_u32 s16, 100000
    s_cbranch_scc1 Lr_abort
    s_branch Lr3s_alp
Lr3s_aok:
    ds_write_b128 v0, v[36:39] offset:9984
    v_smfmac_f32_16x16x64_bf16 v[12:15], v[36:39], v[120:127], v1
    v_smfmac_f32_16x16x64_bf16 v[16:19], v[36:39], v[128:135], v1
    v_smfmac_f32_16x16x64_bf16 v[20:23], v[36:39], v[232:239], v1
    s_waitcnt lgkmcnt(0)
    s_barrier
    ds_read_b128 v[48:51], v0 offset:6912
    ds_read_b128 v[52:55], v0 offset:7936
    v_smfmac_f32_16x16x64_bf16 v[28:31], v[36:39], a[88:95], v1
    v_smfmac_f32_16x16x64_bf16 v[24:27], v[36:39], v[240:247], v1
    v_smfmac_f32_16x16x64_bf16 v[32:35], v[36:39], a[96:103], v1
    s_waitcnt vmcnt(0)
    ds_read_b128 v[36:39], v0 offset:8960
    s_waitcnt lgkmcnt(2)
    v_smfmac_f32_16x16x64_bf16 v[28:31], v[48:51], v[56:63], v1
    ds_read_b128 v[56:59], v8 offset:4096
    ds_read_b128 v[60:63], v8 offset:5120
    s_add_u32 s17, s34, 4096
    buffer_load_dwordx4 v[40:43], v0, s[8:11], s17 offen sc1
    v_smfmac_f32_16x16x64_bf16 v[12:15], v[48:51], v[72:79], v1
    v_smfmac_f32_16x16x64_bf16 v[16:19], v[48:51], v[80:87], v1
    v_smfmac_f32_16x16x64_bf16 v[32:35], v[48:51], v[64:71], v1
    ds_read_b128 v[64:67], v8 offset:6144
    ds_read_b128 v[68:71], v8 offset:7168
    v_smfmac_f32_16x16x64_bf16 v[20:23], v[48:51], v[184:191], v1
    buffer_load_dwordx4 v[44:47], v0, s[8:11], s35 offen sc1
    v_smfmac_f32_16x16x64_bf16 v[24:27], v[48:51], v[192:199], v1
    s_waitcnt lgkmcnt(5)
    v_smfmac_f32_16x16x64_bf16 v[28:31], v[52:55], a[72:79], v1
    v_smfmac_f32_16x16x64_bf16 v[12:15], v[52:55], v[88:95], v1
    v_smfmac_f32_16x16x64_bf16 v[16:19], v[52:55], v[96:103], v1
    v_smfmac_f32_16x16x64_bf16 v[32:35], v[52:55], a[80:87], v1
    v_smfmac_f32_16x16x64_bf16 v[20:23], v[52:55], v[200:207], v1
    v_smfmac_f32_16x16x64_bf16 v[24:27], v[52:55], v[208:215], v1
    s_waitcnt lgkmcnt(2)
    v_smfmac_f32_16x16x64_bf16 v[28:31], v[36:39], v[56:63], v1
    ds_read_b128 v[56:59], v8 offset:8192
    ds_read_b128 v[60:63], v8 offset:9216
    v_smfmac_f32_16x16x64_bf16 v[12:15], v[36:39], v[104:111], v1
    v_smfmac_f32_16x16x64_bf16 v[16:19], v[36:39], v[112:119], v1
    s_waitcnt lgkmcnt(2)
    v_smfmac_f32_16x16x64_bf16 v[32:35], v[36:39], v[64:71], v1
    ds_read_b128 v[64:67], v8 offset:10240
    ds_read_b128 v[68:71], v8 offset:11264
    v_smfmac_f32_16x16x64_bf16 v[20:23], v[36:39], v[216:223], v1
    v_smfmac_f32_16x16x64_bf16 v[24:27], v[36:39], v[224:231], v1
    s_waitcnt vmcnt(1)
    v_max3_u32 v10, v40, v41, v42
    v_max_u32 v10, v10, v43
    v_cmp_eq_u32 vcc, -1, v10
    s_nop 0
    s_cbranch_vccnz Lr3s_pb_re
Lr3s_pb_ok:
    ds_write_b128 v0, v[40:43] offset:14080
    v_smfmac_f32_16x16x64_bf16 v[12:15], v[40:43], v[152:159], v1
    v_smfmac_f32_16x16x64_bf16 v[20:23], v[40:43], a[40:47], v1
    v_smfmac_f32_16x16x64_bf16 v[16:19], v[40:43], v[160:167], v1
    v_smfmac_f32_16x16x64_bf16 v[24:27], v[40:43], a[48:55], v1
    s_waitcnt lgkmcnt(0)
    s_barrier
    ds_read_b128 v[48:51], v0 offset:11008
    ds_read_b128 v[52:55], v0 offset:12032
    ds_read_b128 v[36:39], v0 offset:13056
    v_smfmac_f32_16x16x64_bf16 v[28:31], v[40:43], a[152:159], v1
    v_smfmac_f32_16x16x64_bf16 v[32:35], v[40:43], a[160:167], v1
    s_waitcnt lgkmcnt(2)
    v_smfmac_f32_16x16x64_bf16 v[12:15], v[48:51], v[56:63], v1
    ds_read_b128 v[56:59], v8 offset:12288
    ds_read_b128 v[60:63], v8 offset:13312
    v_smfmac_f32_16x16x64_bf16 v[16:19], v[48:51], v[64:71], v1
    ds_read_b128 v[64:67], v8 offset:14336
    ds_read_b128 v[68:71], v8 offset:15360
    s_waitcnt lgkmcnt(5)
    v_smfmac_f32_16x16x64_bf16 v[12:15], v[52:55], v[136:143], v1
    v_smfmac_f32_16x16x64_bf16 v[16:19], v[52:55], v[144:151], v1
    s_waitcnt vmcnt(0)
    v_max3_u32 v10, v44, v45, v46
    v_max_u32 v10, v10, v47
    v_cmp_eq_u32 vcc, -1, v10
    s_nop 0
    s_cbranch_vccnz Lr3s_pc_re
Lr3s_pc_ok:
    v_smfmac_f32_16x16x64_bf16 v[12:15], v[44:47], v[168:175], v1
    v_smfmac_f32_16x16x64_bf16 v[16:19], v[44:47], v[176:183], v1
    s_waitcnt lgkmcnt(2)
    v_smfmac_f32_16x16x64_bf16 v[12:15], v[36:39], v[56:63], v1
    s_waitcnt lgkmcnt(0)
    v_smfmac_f32_16x16x64_bf16 v[16:19], v[36:39], v[64:71], v1
    v_smfmac_f32_16x16x64_bf16 v[20:23], v[48:51], v[248:255], v1
    v_smfmac_f32_16x16x64_bf16 v[24:27], v[48:51], a[0:7], v1
    v_smfmac_f32_16x16x64_bf16 v[20:23], v[52:55], a[8:15], v1
    v_add_f32 v12, v12, v14
    v_smfmac_f32_16x16x64_bf16 v[24:27], v[52:55], a[16:23], v1
    v_add_f32 v16, v16, v18
    buffer_load_dwordx4 v[64:67], v0, s[8:11], s42 offen
    v_smfmac_f32_16x16x64_bf16 v[20:23], v[36:39], a[24:31], v1
    v_add_f32 v13, v13, v15
    v_smfmac_f32_16x16x64_bf16 v[24:27], v[36:39], a[32:39], v1
    v_add_f32 v17, v17, v19
    v_smfmac_f32_16x16x64_bf16 v[20:23], v[44:47], a[56:63], v1
    v_cvt_pk_bf16_f32 v14, v12, v16
    ds_read_b128 v[56:59], v0 offset:15104
    v_smfmac_f32_16x16x64_bf16 v[24:27], v[44:47], a[64:71], v1
    v_cvt_pk_bf16_f32 v15, v13, v17
    ds_read_b128 v[60:63], v0 offset:16128
    buffer_load_dwordx4 v[68:71], v0, s[8:11], s42 offen offset:1024
    ds_write_b32 v2, v14 offset:576
    ds_write_b32 v2, v15 offset:864
    v_smfmac_f32_16x16x64_bf16 v[28:31], v[48:51], a[104:111], v1
    v_smfmac_f32_16x16x64_bf16 v[32:35], v[48:51], a[112:119], v1
    v_add_f32 v20, v20, v22
    v_add_f32 v24, v24, v26
    v_add_f32 v21, v21, v23
    v_add_f32 v25, v25, v27
    v_cvt_pk_bf16_f32 v22, v20, v24
    v_cvt_pk_bf16_f32 v23, v21, v25
    ds_write_b32 v2, v22 offset:0
    ds_write_b32 v2, v23 offset:288
    v_smfmac_f32_16x16x64_bf16 v[28:31], v[52:55], a[120:127], v1
    v_smfmac_f32_16x16x64_bf16 v[32:35], v[52:55], a[128:135], v1
    s_waitcnt lgkmcnt(0)
    s_barrier
    ds_read_b128 v[40:43], v3 offset:0
    ds_read_b128 v[48:51], v3 offset:64
    ds_read_b128 v[20:23], v3 offset:128
    ds_read_b128 v[52:55], v3 offset:192
    v_smfmac_f32_16x16x64_bf16 v[28:31], v[36:39], a[136:143], v1
    v_smfmac_f32_16x16x64_bf16 v[32:35], v[36:39], a[144:151], v1
    ds_read_b128 v[36:39], v0 offset:17152
    v_lshlrev_b32 v9, 3, v0
    buffer_load_dword v11, v9, s[8:11], s68 offen
    v_smfmac_f32_16x16x64_bf16 v[28:31], v[44:47], a[168:175], v1
    v_smfmac_f32_16x16x64_bf16 v[32:35], v[44:47], a[176:183], v1
    ds_read_b128 v[44:47], v0 offset:18176
    s_waitcnt lgkmcnt(5)
    v_mfma_f32_16x16x32_bf16 v[12:15], v[56:59], v[40:43], 0
    v_mfma_f32_16x16x32_bf16 v[16:19], v[60:63], v[40:43], 0
    v_mfma_f32_16x16x32_bf16 v[24:27], v[40:43], v[40:43], 0
    ds_read_b128 v[56:59], v0 offset:19200
    ds_read_b128 v[60:63], v0 offset:20224
    s_waitcnt lgkmcnt(3)
    v_mfma_f32_16x16x32_bf16 v[12:15], v[36:39], v[48:51], v[12:15]
    v_lshrrev_b32 v10, 1, v0
    v_lshrrev_b32 v9, 9, v0
    s_waitcnt lgkmcnt(2)
    v_mfma_f32_16x16x32_bf16 v[16:19], v[44:47], v[48:51], v[16:19]
    v_lshl_add_u32 v9, v9, 5, v10
    v_add_f32 v28, v28, v30
    v_mfma_f32_16x16x32_bf16 v[24:27], v[48:51], v[48:51], v[24:27]
    v_add_f32 v32, v32, v34
    v_add_f32 v29, v29, v31
    ds_read_b128 v[36:39], v0 offset:21248
    ds_read_b128 v[44:47], v0 offset:22272
    s_waitcnt lgkmcnt(3)
    v_mfma_f32_16x16x32_bf16 v[12:15], v[56:59], v[20:23], v[12:15]
    v_add_f32 v33, v33, v35
    v_cvt_pk_bf16_f32 v30, v28, v29
    s_waitcnt lgkmcnt(2)
    v_mfma_f32_16x16x32_bf16 v[16:19], v[60:63], v[20:23], v[16:19]
    v_cvt_pk_bf16_f32 v31, v32, v33
    ds_read_b64 v[34:35], v9 offset:3456
    v_mfma_f32_16x16x32_bf16 v[24:27], v[20:23], v[20:23], v[24:27]
    s_add_u32 s17, s43, 3584
    buffer_store_dwordx2 v[30:31], v10, s[8:11], s17 offen sc1
    s_waitcnt lgkmcnt(2)
    v_mfma_f32_16x16x32_bf16 v[12:15], v[36:39], v[52:55], v[12:15]
    s_waitcnt lgkmcnt(1)
    v_mfma_f32_16x16x32_bf16 v[16:19], v[44:47], v[52:55], v[16:19]
    v_mfma_f32_16x16x32_bf16 v[24:27], v[52:55], v[52:55], v[24:27]
    s_add_u32 s17, s43, 1536
    s_waitcnt lgkmcnt(0)
    buffer_store_dwordx2 v[34:35], v10, s[8:11], s17 offen sc1
    ds_read_b128 v[56:59], v8 offset:16384
    ds_read_b128 v[60:63], v8 offset:17408
    v_mov_b64 v[20:21], s[52:53]
    v_mov_b64 v[22:23], s[52:53]
    v_mov_b32 v41, 0
    v_mov_b32 v42, 0
    v_max3_f32 v9, v12, v13, v14
    v_max3_f32 v9, v9, v15, v16
    v_max3_f32 v9, v9, v17, v18
    v_max3_f32 v9, v9, v19, v24
    v_max_f32 v9, v9, v25
    v_mov_b32 v10, v9
    v_mov_b64 v[32:33], 0
    v_mov_b64 v[34:35], 0
    v_permlane32_swap_b32 v9, v10
    v_max_f32 v9, v9, v10
    v_mov_b32 v10, v9
    s_nop 1
    v_permlane16_swap_b32 v9, v10
    v_max_f32 v9, v9, v10
    v_mul_f32 v28, s44, v9
    v_fma_f32 v12, v12, s44, -v28
    v_fma_f32 v13, v13, s44, -v28
    v_fma_f32 v14, v14, s44, -v28
    v_fma_f32 v15, v15, s44, -v28
    v_exp_f32 v12, v12
    v_exp_f32 v13, v13
    v_fma_f32 v16, v16, s44, -v28
    v_fma_f32 v17, v17, s44, -v28
    v_exp_f32 v14, v14
    v_exp_f32 v15, v15
    v_cvt_pk_bf16_f32 v36, v12, v13
    v_fma_f32 v18, v18, s44, -v28
    v_fma_f32 v19, v19, s44, -v28
    v_exp_f32 v16, v16
    v_exp_f32 v17, v17
    v_cvt_pk_bf16_f32 v37, v14, v15
    v_fma_f32 v24, v24, s44, -v28
    v_fma_f32 v25, v25, s44, -v28
    v_exp_f32 v18, v18
    v_exp_f32 v19, v19
    v_cvt_pk_bf16_f32 v38, v16, v17
    v_exp_f32 v24, v24
    v_exp_f32 v25, v25
    v_cvt_pk_bf16_f32 v39, v18, v19
    v_cvt_pk_bf16_f32 v40, v24, v25
    v_cvt_pk_bf16_f32 v43, v24, v25
    v_mfma_f32_16x16x32_bf16 v[52:55], v[20:23], v[36:39], 0
    v_mov_b64 v[12:13], 0
    v_mov_b64 v[14:15], 0
    s_waitcnt vmcnt(4)
    v_mfma_f32_16x16x32_bf16 v[44:47], v[64:67], v[36:39], 0
    v_mov_b64 v[24:25], 0
    v_mov_b64 v[26:27], 0
    s_waitcnt vmcnt(3)
    v_mfma_f32_16x16x32_bf16 v[48:51], v[68:71], v[36:39], 0
    ds_read_b128 v[64:67], v8 offset:20480
    ds_read_b128 v[68:71], v8 offset:21504
    v_mfma_f32_16x16x16_bf16 v[52:55], v[20:21], v[40:41], v[52:55]
    v_mfma_f32_16x16x16_bf16 v[44:47], v[30:31], v[40:41], v[44:47]
    v_mov_b64 v[20:21], 0
    v_mov_b64 v[22:23], 0
    v_mfma_f32_16x16x16_bf16 v[48:51], v[30:31], v[42:43], v[48:51]
    v_mov_b64 v[36:37], 0
    v_mov_b64 v[38:39], 0
    v_mov_b64 v[40:41], 0
    v_mov_b64 v[42:43], 0
    v_rcp_f32 v9, v52
    v_mov_b64 v[52:53], 0
    v_mov_b64 v[54:55], 0
    v_mul_f32 v44, v9, v44
    v_mul_f32 v48, v9, v48
    v_cvt_pk_bf16_f32 v16, v44, v48
    v_mul_f32 v45, v9, v45
    v_mul_f32 v49, v9, v49
    v_cvt_pk_bf16_f32 v17, v45, v49
    v_mul_f32 v46, v9, v46
    v_mul_f32 v50, v9, v50
    v_cvt_pk_bf16_f32 v18, v46, v50
    v_mul_f32 v47, v9, v47
    v_mul_f32 v51, v9, v51
    v_cvt_pk_bf16_f32 v19, v47, v51
    ds_write_b128 v5, v[16:19]
    v_mov_b64 v[28:29], 0
    v_mov_b64 v[30:31], 0
    s_waitcnt lgkmcnt(0)
    s_barrier
    ds_read_b128 v[44:47], v4 offset:0
    ds_read_b128 v[48:51], v4 offset:128
    s_cmp_eq_u32 s33, 63
    s_cbranch_scc1 Lr3s_last
    v_mov_b64 v[16:17], 0
    v_mov_b64 v[18:19], 0
    buffer_load_dwordx4 v0, s[8:11], s41 offen offset:0 lds
    buffer_load_dwordx4 v0, s[8:11], s41 offen offset:1024 lds
    s_waitcnt lgkmcnt(1)
    v_smfmac_f32_16x16x64_bf16 v[12:15], v[44:47], a[184:191], v1
    s_waitcnt lgkmcnt(0)
    v_smfmac_f32_16x16x64_bf16 v[12:15], v[48:51], a[192:199], v1
    v_smfmac_f32_16x16x64_bf16 v[24:27], v[44:47], a[200:207], v1
    v_smfmac_f32_16x16x64_bf16 v[24:27], v[48:51], a[208:215], v1
    v_add_f32 v12, v12, v14
    v_smfmac_f32_16x16x64_bf16 v[20:23], v[44:47], a[216:223], v1
    v_add_f32 v13, v13, v15
    v_smfmac_f32_16x16x64_bf16 v[20:23], v[48:51], a[224:231], v1
    v_cvt_pk_bf16_f32 v12, v12, v13
    v_smfmac_f32_16x16x64_bf16 v[16:19], v[44:47], a[232:239], v1
    v_add_f32 v24, v24, v26
    v_smfmac_f32_16x16x64_bf16 v[16:19], v[48:51], a[240:247], v1
    v_add_f32 v25, v25, v27
    v_smfmac_f32_16x16x64_bf16 v[36:39], v[44:47], v[56:63], v1
    v_cvt_pk_bf16_f32 v13, v24, v25
    v_smfmac_f32_16x16x64_bf16 v[36:39], v[48:51], v[64:71], v1
    v_add_f32 v20, v20, v22
    v_add_f32 v21, v21, v23
    v_cvt_pk_bf16_f32 v14, v20, v21
    v_add_f32 v16, v16, v18
    v_add_f32 v17, v17, v19
    v_cvt_pk_bf16_f32 v15, v16, v17
    v_and_or_b32 v15, v15, -2, s40
    buffer_store_dwordx4 v[12:15], v0, s[8:11], s38 offen sc1
    s_nop 0
    ds_read_b128 v[12:15], v8 offset:18432
    ds_read_b128 v[16:19], v8 offset:19456
    ds_read_b128 v[20:23], v8 offset:22528
    ds_read_b128 v[24:27], v8 offset:23552
    ds_read_b128 v[56:59], v8 offset:24576
    ds_read_b128 v[60:63], v8 offset:25600
    ds_read_b128 v[64:67], v8 offset:28672
    ds_read_b128 v[68:71], v8 offset:29696
    s_waitcnt lgkmcnt(6)
    v_smfmac_f32_16x16x64_bf16 v[40:43], v[44:47], v[12:19], v1
    ds_read_b128 v[12:15], v8 offset:26624
    ds_read_b128 v[16:19], v8 offset:27648
    s_waitcnt lgkmcnt(6)
    v_smfmac_f32_16x16x64_bf16 v[40:43], v[48:51], v[20:27], v1
    ds_read_b128 v[20:23], v8 offset:30720
    ds_read_b128 v[24:27], v8 offset:31744
    s_waitcnt lgkmcnt(6)
    v_smfmac_f32_16x16x64_bf16 v[52:55], v[44:47], v[56:63], v1
    ds_read_b128 v[56:59], v8 offset:32768
    ds_read_b128 v[60:63], v8 offset:33792
    s_waitcnt lgkmcnt(6)
    v_smfmac_f32_16x16x64_bf16 v[52:55], v[48:51], v[64:71], v1
    s_waitcnt lgkmcnt(4)
    v_smfmac_f32_16x16x64_bf16 v[32:35], v[44:47], v[12:19], v1
    s_waitcnt lgkmcnt(2)
    v_smfmac_f32_16x16x64_bf16 v[32:35], v[48:51], v[20:27], v1
    v_smfmac_f32_16x16x64_bf16 v[28:31], v[44:47], a[248:255], v1
    s_waitcnt lgkmcnt(0)
    v_smfmac_f32_16x16x64_bf16 v[28:31], v[48:51], v[56:63], v1
    v_add_f32 v36, v36, v38
    v_add_f32 v37, v37, v39
    v_cvt_pk_bf16_f32 v36, v36, v37
    v_add_f32 v40, v40, v42
    v_add_f32 v41, v41, v43
    v_cvt_pk_bf16_f32 v37, v40, v41
    v_add_f32 v52, v52, v54
    v_add_f32 v53, v53, v55
    v_cvt_pk_bf16_f32 v38, v52, v53
    v_add_f32 v32, v32, v34
    v_add_f32 v33, v33, v35
    v_cvt_pk_bf16_f32 v39, v32, v33
    v_and_or_b32 v39, v39, -2, s40
    s_add_u32 s17, s38, 4096
    buffer_store_dwordx4 v[36:39], v0, s[8:11], s17 offen sc1
    v_add_f32 v28, v28, v30
    v_add_f32 v29, v29, v31
    v_cvt_pk_bf16_f32 v28, v28, v29
    v_and_or_b32 v28, v28, -2, s40
    v_lshrrev_b32 v9, 2, v0
    buffer_store_dword v28, v9, s[8:11], s39 offen sc1
    s_xor_b32 s34, s34, 16384
    s_xor_b32 s35, s35, 16384
    s_add_u32 s33, s33, 1
    s_add_u32 s42, s42, 262144
    s_add_u32 s41, s41, 262144
    s_add_u32 s43, s43, 131072
    s_add_u32 s68, s68, 262144
    s_add_u32 s66, s66, 22528
    s_xor_b32 s40, s40, 1
    ds_read_b128 v[56:59], v8 offset:0
    ds_read_b128 v[60:63], v8 offset:1024
    ds_read_b128 v[64:67], v8 offset:2048
    ds_read_b128 v[68:71], v8 offset:3072
    v_mov_b64 v[12:13], 0
    v_mov_b64 v[14:15], 0
    v_mov_b64 v[16:17], 0
    v_mov_b64 v[18:19], 0
    v_mov_b64 v[20:21], 0
    v_mov_b64 v[22:23], 0
    v_mov_b64 v[24:25], 0
    v_mov_b64 v[26:27], 0
    v_mov_b64 v[28:29], 0
    v_mov_b64 v[30:31], 0
    v_mov_b64 v[32:33], 0
    v_mov_b64 v[34:35], 0
    s_sleep 5
    s_nop 9
    buffer_load_dwordx4 v[36:39], v0, s[8:11], s34 offen sc1
    s_nop 15
    s_nop 8
    buffer_load_dwordx4 v[36:39], v0, s[8:11], s34 offen sc1
    s_nop 15
    s_nop 8
    buffer_load_dwordx4 v[36:39], v0, s[8:11], s34 offen sc1
    s_waitcnt lgkmcnt(0)
    s_branch Lr3s_step
Lr3s_pb_re:
    s_mov_b32 s16, 0
Lr3s_pb_lp:
    s_add_u32 s17, s34, 4096
    buffer_load_dwordx4 v[40:43], v0, s[8:11], s17 offen sc1
    s_add_u32 s16, s16, 1
    s_cmp_gt_u32 s16, 100000
    s_cbranch_scc1 Lr_abort
    s_waitcnt vmcnt(0)
    v_max3_u32 v10, v40, v41, v42
    v_max_u32 v10, v10, v43
    v_cmp_eq_u32 vcc, -1, v10
    s_nop 0
    s_cbranch_vccnz Lr3s_pb_lp
    s_branch Lr3s_pb_ok
Lr3s_pc_re:
    s_mov_b32 s16, 0
Lr3s_pc_lp:
    buffer_load_dwordx4 v[44:47], v0, s[8:11], s35 offen sc1
    s_add_u32 s16, s16, 1
    s_cmp_gt_u32 s16, 100000
    s_cbranch_scc1 Lr_abort
    s_waitcnt vmcnt(0)
    v_max3_u32 v10, v44, v45, v46
    v_max_u32 v10, v10, v47
    v_cmp_eq_u32 vcc, -1, v10
    s_nop 0
    s_cbranch_vccnz Lr3s_pc_lp
    s_branch Lr3s_pc_ok
Lr3s_last:
    s_waitcnt vmcnt(0) lgkmcnt(0)
    s_barrier
    s_branch Lr_exit
Lr_abort:
    s_waitcnt lgkmcnt(0)
    s_mov_b64 exec, -1
    v_mov_b32 v0, 60
    s_lshl_b32 s5, s3, 8
    s_or_b32 s5, s5, s4
    s_or_b32 s5, s5, 0x10000
    v_mov_b32 v1, s5
    global_store_dword v0, v1, s[12:13]
    s_endpgm
Lr_exit:
    s_endpgm
.section .rodata,"a"
.p2align 6
.amdhsa_kernel interleave_layers__sliding_local_dilated__memory_aug_recurrent_mem_tr__prompt_kernel
  .amdhsa_next_free_vgpr 512
  .amdhsa_next_free_sgpr 102
  .amdhsa_accum_offset 256
  .amdhsa_group_segment_fixed_size 0
  .amdhsa_kernarg_size 104
  .amdhsa_user_sgpr_count 2
  .amdhsa_user_sgpr_kernarg_segment_ptr 1
  .amdhsa_system_sgpr_workgroup_id_x 1
.end_amdhsa_kernel
```

```asm
; @launch grid=(256,1,1) block=(256,1,1) lds=163840
.amdgcn_target "amdgcn-amd-amdhsa--gfx950"
.text
.globl interleave_layers__sliding_local_dilated__memory_aug_recurrent_mem_tr__prompt_kernel
.p2align 8
.type interleave_layers__sliding_local_dilated__memory_aug_recurrent_mem_tr__prompt_kernel,@function
interleave_layers__sliding_local_dilated__memory_aug_recurrent_mem_tr__prompt_kernel:
    s_cmp_ge_u32 s2, 256
    s_cbranch_scc1 L_exit
    s_load_dwordx2 s[8:9], s[0:1], 96
    s_mov_b32 s10, 268435456
    s_mov_b32 s11, 0x00020000
    s_waitcnt lgkmcnt(0)
    s_and_b32 s9, s9, 0xffff
    s_load_dwordx2 s[12:13], s[0:1], 88
    v_lshrrev_b32 v1, 6, v0
    s_getreg_b32 s3, hwreg(HW_REG_XCC_ID)
    v_readfirstlane_b32 s14, v1
    s_and_b32 s3, s3, 7
    s_and_b32 s17, s3, 1
    s_lshl_b32 s17, s17, 7
    s_lshl_b32 s18, s3, 1
    s_and_b32 s18, s18, 12
    s_add_u32 s17, s17, s18
    v_mov_b32 v2, 0
    v_mov_b32 v3, 1
    v_mov_b32 v4, s17
    s_mov_b32 s33, 0
    s_waitcnt lgkmcnt(0)
    s_cmp_lg_u32 s14, 0
    s_cbranch_scc1 L_tk_wait
    s_mov_b64 exec, 1
    global_atomic_add v3, v4, v3, s[12:13] sc0
    s_waitcnt vmcnt(0)
    v_readfirstlane_b32 s4, v3
    s_nop 0
    s_cmp_lt_u32 s4, 32
    s_cbranch_scc1 L_tk_have
    v_mov_b32 v3, 1
    v_mov_b32 v4, 32
    global_atomic_add v3, v4, v3, s[12:13] sc0
    s_waitcnt vmcnt(0)
    v_readfirstlane_b32 s5, v3
    s_mov_b64 exec, 0xff
    v_and_b32 v4, 1, v0
    v_lshlrev_b32 v4, 7, v4
    v_lshlrev_b32 v5, 1, v0
    v_and_or_b32 v4, v5, 12, v4
    s_mov_b32 s16, 0
L_hl_poll:
    global_load_dword v5, v4, s[12:13] sc1
    s_add_u32 s16, s16, 1
    s_cmp_gt_u32 s16, 100000
    s_cbranch_scc1 L_abort
    s_mov_b32 s6, 0
    s_waitcnt vmcnt(0)
    v_readlane_b32 s40, v5, 0
    s_nop 0
    s_add_u32 s6, s6, s40
    v_readlane_b32 s41, v5, 1
    s_nop 0
    s_add_u32 s6, s6, s41
    v_readlane_b32 s42, v5, 2
    s_nop 0
    s_add_u32 s6, s6, s42
    v_readlane_b32 s43, v5, 3
    s_nop 0
    s_add_u32 s6, s6, s43
    v_readlane_b32 s44, v5, 4
    s_nop 0
    s_add_u32 s6, s6, s44
    v_readlane_b32 s45, v5, 5
    s_nop 0
    s_add_u32 s6, s6, s45
    v_readlane_b32 s46, v5, 6
    s_nop 0
    s_add_u32 s6, s6, s46
    v_readlane_b32 s47, v5, 7
    s_nop 0
    s_add_u32 s6, s6, s47
    s_cmp_lt_u32 s6, 256
    s_cbranch_scc1 L_hl_poll
    s_mov_b32 s3, 0
    s_mov_b32 s4, 0
    s_min_u32 s6, s47, 32
    s_sub_u32 s7, 32, s6
    s_cmp_lt_u32 s5, s7
    s_cselect_b32 s3, 7, s3
    s_add_u32 s6, s6, s5
    s_cmp_lt_u32 s5, s7
    s_cselect_b32 s4, s6, s4
    s_sub_u32 s5, s5, s7
    s_min_u32 s6, s46, 32
    s_sub_u32 s7, 32, s6
    s_cmp_lt_u32 s5, s7
    s_cselect_b32 s3, 6, s3
    s_add_u32 s6, s6, s5
    s_cmp_lt_u32 s5, s7
    s_cselect_b32 s4, s6, s4
    s_sub_u32 s5, s5, s7
    s_min_u32 s6, s45, 32
    s_sub_u32 s7, 32, s6
    s_cmp_lt_u32 s5, s7
    s_cselect_b32 s3, 5, s3
    s_add_u32 s6, s6, s5
    s_cmp_lt_u32 s5, s7
    s_cselect_b32 s4, s6, s4
    s_sub_u32 s5, s5, s7
    s_min_u32 s6, s44, 32
    s_sub_u32 s7, 32, s6
    s_cmp_lt_u32 s5, s7
    s_cselect_b32 s3, 4, s3
    s_add_u32 s6, s6, s5
    s_cmp_lt_u32 s5, s7
    s_cselect_b32 s4, s6, s4
    s_sub_u32 s5, s5, s7
    s_min_u32 s6, s43, 32
    s_sub_u32 s7, 32, s6
    s_cmp_lt_u32 s5, s7
    s_cselect_b32 s3, 3, s3
    s_add_u32 s6, s6, s5
    s_cmp_lt_u32 s5, s7
    s_cselect_b32 s4, s6, s4
    s_sub_u32 s5, s5, s7
    s_min_u32 s6, s42, 32
    s_sub_u32 s7, 32, s6
    s_cmp_lt_u32 s5, s7
    s_cselect_b32 s3, 2, s3
    s_add_u32 s6, s6, s5
    s_cmp_lt_u32 s5, s7
    s_cselect_b32 s4, s6, s4
    s_sub_u32 s5, s5, s7
    s_min_u32 s6, s41, 32
    s_sub_u32 s7, 32, s6
    s_cmp_lt_u32 s5, s7
    s_cselect_b32 s3, 1, s3
    s_add_u32 s6, s6, s5
    s_cmp_lt_u32 s5, s7
    s_cselect_b32 s4, s6, s4
    s_sub_u32 s5, s5, s7
    s_min_u32 s6, s40, 32
    s_sub_u32 s7, 32, s6
    s_cmp_lt_u32 s5, s7
    s_cselect_b32 s3, 0, s3
    s_add_u32 s6, s6, s5
    s_cmp_lt_u32 s5, s7
    s_cselect_b32 s4, s6, s4
    s_sub_u32 s5, s5, s7
L_tk_have:
    s_lshl_b32 s5, s3, 8
    s_or_b32 s5, s5, s4
    v_mov_b32 v3, s5
    s_mov_b64 exec, 1
    ds_write_b32 v2, v3
    s_mov_b64 exec, -1
L_tk_wait:
    s_waitcnt vmcnt(0) lgkmcnt(0)
    s_barrier
    ds_read_b32 v3, v2
    s_waitcnt lgkmcnt(0)
    v_readfirstlane_b32 s5, v3
    s_nop 0
    s_lshr_b32 s3, s5, 8
    s_and_b32 s4, s5, 255
    s_barrier
    s_cmp_lt_u32 s3, 2
    s_cbranch_scc1 L_role_r
    s_sub_u32 s6, s3, 2
    s_lshl_b32 s6, s6, 5
    s_add_u32 s6, s6, s4
    s_load_dwordx2 s[20:21], s[0:1], 8
    s_mov_b32 s22, 1990656
    s_mov_b32 s23, 0x00020000
    s_waitcnt lgkmcnt(0)
    s_and_b32 s21, s21, 0xffff
    s_load_dwordx2 s[24:25], s[0:1], 16
    s_mov_b32 s26, 663552
    s_mov_b32 s27, 0x00020000
    s_waitcnt lgkmcnt(0)
    s_and_b32 s25, s25, 0xffff
    s_sub_u32 s41, 191, s6
    s_lshl_b32 s41, s41, 15
    v_lshlrev_b32 v254, 7, v0
    buffer_load_dword v255, v254, s[20:23], s41 offen
    s_sub_u32 s41, s41, 1998848
    s_cmp_lt_u32 s41, 688128
    s_cselect_b32 s41, s41, 0x7f000000
    s_waitcnt vmcnt(0)
    buffer_load_dword v255, v254, s[24:27], s41 offen
    s_cmp_ge_u32 s6, 136
    s_cbranch_scc1 Li_end
    v_lshlrev_b32 v7, 4, v0
    v_mov_b32 v12, 0
    v_mov_b32 v13, 0
    v_mov_b32 v14, 0
    v_mov_b32 v15, 0
    s_cmp_ge_u32 s6, 64
    s_cbranch_scc1 Li_rest
    s_load_dwordx2 s[20:21], s[0:1], 0
    s_mov_b32 s22, 2359296
    s_mov_b32 s23, 0x00020000
    s_waitcnt lgkmcnt(0)
    s_and_b32 s21, s21, 0xffff
    v_and_b32 v1, 31, v0
    v_lshrrev_b32 v2, 5, v0
    v_mul_u32_u24 v3, 1152, v1
    v_mul_u32_u24 v5, 144, v2
    v_add_u32 v3, v3, v5
    s_mul_i32 s41, s6, 36864
    buffer_load_dwordx4 v[64:67], v3, s[20:23], s41 offen offset:0
    buffer_load_dwordx4 v[68:71], v3, s[20:23], s41 offen offset:16
    buffer_load_dwordx4 v[72:75], v3, s[20:23], s41 offen offset:32
    buffer_load_dwordx4 v[76:79], v3, s[20:23], s41 offen offset:48
    buffer_load_dwordx4 v[80:83], v3, s[20:23], s41 offen offset:64
    buffer_load_dwordx4 v[84:87], v3, s[20:23], s41 offen offset:80
    buffer_load_dwordx4 v[88:91], v3, s[20:23], s41 offen offset:96
    buffer_load_dwordx4 v[92:95], v3, s[20:23], s41 offen offset:112
    buffer_load_dwordx4 v[96:99], v3, s[20:23], s41 offen offset:128
    v_mul_u32_u24 v4, 4608, v2
    v_lshl_add_u32 v4, v1, 4, v4
    s_mul_i32 s41, s6, 36864
    s_add_u32 s41, s41, 6291456
    s_mul_i32 s42, s6, 6144
    s_add_u32 s42, s42, 15728640
    s_add_u32 s43, s42, 2048
    s_add_u32 s44, s42, 397824
    v_mov_b32 v60, 0
    v_mov_b32 v61, 0
    s_waitcnt vmcnt(8)
    buffer_store_dwordx4 v[64:67], v4, s[8:11], s41 offen offset:0 sc1
    s_waitcnt vmcnt(8)
    buffer_store_dwordx4 v[68:71], v4, s[8:11], s41 offen offset:512 sc1
    s_waitcnt vmcnt(8)
    buffer_store_dwordx4 v[72:75], v4, s[8:11], s41 offen offset:1024 sc1
    s_waitcnt vmcnt(8)
    buffer_store_dwordx4 v[76:79], v4, s[8:11], s41 offen offset:1536 sc1
    s_waitcnt vmcnt(8)
    buffer_store_dwordx4 v[80:83], v4, s[8:11], s41 offen offset:2048 sc1
    s_waitcnt vmcnt(8)
    buffer_store_dwordx4 v[84:87], v4, s[8:11], s41 offen offset:2560 sc1
    s_waitcnt vmcnt(8)
    buffer_store_dwordx4 v[88:91], v4, s[8:11], s41 offen offset:3072 sc1
    s_waitcnt vmcnt(8)
    buffer_store_dwordx4 v[92:95], v4, s[8:11], s41 offen offset:3584 sc1
    v_add_u32 v4, 4096, v4
    s_waitcnt vmcnt(8)
    buffer_store_dwordx4 v[96:99], v4, s[8:11], s41 offen offset:0 sc1
    buffer_store_dwordx4 v[12:15], v7, s[8:11], s43 offen sc1
    v_cmp_gt_u32 vcc, 96, v0
    s_nop 0
    s_and_saveexec_b64 s[46:47], vcc
    s_cbranch_execz Li_z1
    buffer_store_dwordx4 v[12:15], v7, s[8:11], s44 offen sc1
Li_z1:
    s_mov_b64 exec, s[46:47]
    v_mov_b32 v62, 0x3f803f80
    v_dot2c_f32_bf16 v60, v64, v62
    v_dot2c_f32_bf16 v61, v64, v64
    v_dot2c_f32_bf16 v60, v65, v62
    v_dot2c_f32_bf16 v61, v65, v65
    v_dot2c_f32_bf16 v60, v66, v62
    v_dot2c_f32_bf16 v61, v66, v66
    v_dot2c_f32_bf16 v60, v67, v62
    v_dot2c_f32_bf16 v61, v67, v67
    v_dot2c_f32_bf16 v60, v68, v62
    v_dot2c_f32_bf16 v61, v68, v68
    v_dot2c_f32_bf16 v60, v69, v62
    v_dot2c_f32_bf16 v61, v69, v69
    v_dot2c_f32_bf16 v60, v70, v62
    v_dot2c_f32_bf16 v61, v70, v70
    v_dot2c_f32_bf16 v60, v71, v62
    v_dot2c_f32_bf16 v61, v71, v71
    v_dot2c_f32_bf16 v60, v72, v62
    v_dot2c_f32_bf16 v61, v72, v72
    v_dot2c_f32_bf16 v60, v73, v62
    v_dot2c_f32_bf16 v61, v73, v73
    v_dot2c_f32_bf16 v60, v74, v62
    v_dot2c_f32_bf16 v61, v74, v74
    v_dot2c_f32_bf16 v60, v75, v62
    v_dot2c_f32_bf16 v61, v75, v75
    v_dot2c_f32_bf16 v60, v76, v62
    v_dot2c_f32_bf16 v61, v76, v76
    v_dot2c_f32_bf16 v60, v77, v62
    v_dot2c_f32_bf16 v61, v77, v77
    v_dot2c_f32_bf16 v60, v78, v62
    v_dot2c_f32_bf16 v61, v78, v78
    v_dot2c_f32_bf16 v60, v79, v62
    v_dot2c_f32_bf16 v61, v79, v79
    v_dot2c_f32_bf16 v60, v80, v62
    v_dot2c_f32_bf16 v61, v80, v80
    v_dot2c_f32_bf16 v60, v81, v62
    v_dot2c_f32_bf16 v61, v81, v81
    v_dot2c_f32_bf16 v60, v82, v62
    v_dot2c_f32_bf16 v61, v82, v82
    v_dot2c_f32_bf16 v60, v83, v62
    v_dot2c_f32_bf16 v61, v83, v83
    v_dot2c_f32_bf16 v60, v84, v62
    v_dot2c_f32_bf16 v61, v84, v84
    v_dot2c_f32_bf16 v60, v85, v62
    v_dot2c_f32_bf16 v61, v85, v85
    v_dot2c_f32_bf16 v60, v86, v62
    v_dot2c_f32_bf16 v61, v86, v86
    v_dot2c_f32_bf16 v60, v87, v62
    v_dot2c_f32_bf16 v61, v87, v87
    v_dot2c_f32_bf16 v60, v88, v62
    v_dot2c_f32_bf16 v61, v88, v88
    v_dot2c_f32_bf16 v60, v89, v62
    v_dot2c_f32_bf16 v61, v89, v89
    v_dot2c_f32_bf16 v60, v90, v62
    v_dot2c_f32_bf16 v61, v90, v90
    v_dot2c_f32_bf16 v60, v91, v62
    v_dot2c_f32_bf16 v61, v91, v91
    v_dot2c_f32_bf16 v60, v92, v62
    v_dot2c_f32_bf16 v61, v92, v92
    v_dot2c_f32_bf16 v60, v93, v62
    v_dot2c_f32_bf16 v61, v93, v93
    v_dot2c_f32_bf16 v60, v94, v62
    v_dot2c_f32_bf16 v61, v94, v94
    v_dot2c_f32_bf16 v60, v95, v62
    v_dot2c_f32_bf16 v61, v95, v95
    v_dot2c_f32_bf16 v60, v96, v62
    v_dot2c_f32_bf16 v61, v96, v96
    v_dot2c_f32_bf16 v60, v97, v62
    v_dot2c_f32_bf16 v61, v97, v97
    v_dot2c_f32_bf16 v60, v98, v62
    v_dot2c_f32_bf16 v61, v98, v98
    v_dot2c_f32_bf16 v60, v99, v62
    v_dot2c_f32_bf16 v61, v99, v99
    s_nop 3
    v_lshrrev_b32 v5, 1, v2
    v_lshlrev_b32 v5, 9, v5
    v_lshl_add_u32 v5, v1, 4, v5
    v_and_b32 v6, 1, v2
    v_lshl_add_u32 v5, v6, 3, v5
    buffer_store_dwordx2 v[60:61], v5, s[8:11], s42 offen sc1
    s_branch Li_flags
Li_rest:
    s_cmp_ge_u32 s6, 128
    s_cbranch_scc1 Li_flags
    s_sub_u32 s41, s6, 64
    s_mul_i32 s41, s41, 6144
    s_add_u32 s41, s41, 16912896
    v_cmp_gt_u32 vcc, 96, v0
    s_nop 0
    s_and_saveexec_b64 s[42:43], vcc
    s_cbranch_execz Li_rest2
    buffer_store_dwordx4 v[12:15], v7, s[8:11], s41 offen sc1
Li_rest2:
    s_mov_b64 exec, s[42:43]
Li_flags:
    v_cmp_gt_u32 vcc, 96, v0
    s_cmp_lt_u32 s6, 64
    s_cselect_b64 s[42:43], -1, 0
    s_and_b64 vcc, vcc, s[42:43]
    s_cmp_lt_u32 s6, 128
    s_cselect_b32 s44, 0, 0
    v_mov_b32 v12, s44
    v_mov_b32 v13, s44
    v_mov_b32 v14, s44
    v_mov_b32 v15, s44
    v_mov_b32 v9, 1
    v_cndmask_b32 v8, v12, v9, vcc
    v_mov_b32 v9, v8
    v_mov_b32 v10, v8
    v_mov_b32 v11, v8
    s_mul_i32 s41, s6, 22528
    s_sub_u32 s42, s6, 128
    s_lshl_b32 s42, s42, 12
    s_add_u32 s42, s42, 2883584
    s_cmp_ge_u32 s6, 128
    s_cselect_b32 s41, s42, s41
    buffer_store_dwordx4 v[8:11], v7, s[8:11], s41 offen sc1
    s_cbranch_scc1 Li_nofl
    s_add_u32 s41, s41, 4096
    buffer_store_dwordx4 v[12:15], v7, s[8:11], s41 offen sc1
    s_add_u32 s41, s41, 4096
    buffer_store_dwordx4 v[12:15], v7, s[8:11], s41 offen sc1
    s_add_u32 s41, s41, 4096
    buffer_store_dwordx4 v[12:15], v7, s[8:11], s41 offen sc1
    s_add_u32 s41, s41, 4096
    buffer_store_dwordx4 v[12:15], v7, s[8:11], s41 offen sc1
    s_add_u32 s41, s41, 4096
    v_cmp_gt_u32 vcc, 128, v0
    s_nop 0
    s_and_saveexec_b64 s[42:43], vcc
    s_cbranch_execz Li_fl5
    buffer_store_dwordx4 v[12:15], v7, s[8:11], s41 offen sc1
Li_fl5:
    s_mov_b64 exec, s[42:43]
Li_nofl:
    s_waitcnt vmcnt(0)
    s_barrier
    s_cmp_lg_u32 s14, 0
    s_cbranch_scc1 Li_end
    s_sub_u32 s41, s6, 64
    s_cmp_lt_u32 s41, 64
    s_cbranch_scc1 Li_l1
    v_mov_b32 v2, 40
    v_mov_b32 v3, 1
    s_mov_b64 exec, 1
    global_atomic_add v2, v3, s[12:13]
    s_mov_b64 exec, -1
    s_branch Li_end
Li_l1:
    v_mov_b32 v2, 160
    v_mov_b32 v3, 1
    s_mov_b64 exec, 1
    global_atomic_add v2, v3, s[12:13]
    s_mov_b64 exec, -1
Li_end:
    s_cmp_lg_u32 s3, 2
    s_cbranch_scc1 L_cls2_no
    s_add_u32 s15, s4, 0
    s_cmp_lt_u32 s4, 24
    s_cbranch_scc1 L_role_tw
    s_add_u32 s15, s4, 4294967272
    s_cmp_lt_u32 s4, 32
    s_cbranch_scc1 L_role_p
    s_endpgm
L_cls2_no:
    s_cmp_lg_u32 s3, 3
    s_cbranch_scc1 L_cls3_no
    s_add_u32 s15, s4, 24
    s_cmp_lt_u32 s4, 12
    s_cbranch_scc1 L_role_tw
    s_add_u32 s15, s4, 4294967292
    s_cmp_lt_u32 s4, 32
    s_cbranch_scc1 L_role_p
    s_endpgm
L_cls3_no:
    s_cmp_lg_u32 s3, 4
    s_cbranch_scc1 L_cls4_no
    s_add_u32 s15, s4, 0
    s_cmp_lt_u32 s4, 16
    s_cbranch_scc1 L_role_aq
    s_add_u32 s15, s4, 4294967280
    s_cmp_lt_u32 s4, 19
    s_cbranch_scc1 L_role_awo
    s_add_u32 s15, s4, 9
    s_cmp_lt_u32 s4, 32
    s_cbranch_scc1 L_role_p
    s_endpgm
L_cls4_no:
    s_cmp_lg_u32 s3, 5
    s_cbranch_scc1 L_cls5_no
    s_add_u32 s15, s4, 16
    s_cmp_lt_u32 s4, 16
    s_cbranch_scc1 L_role_aq
    s_add_u32 s15, s4, 4294967283
    s_cmp_lt_u32 s4, 19
    s_cbranch_scc1 L_role_awo
    s_add_u32 s15, s4, 22
    s_cmp_lt_u32 s4, 32
    s_cbranch_scc1 L_role_p
    s_endpgm
L_cls5_no:
    s_cmp_lg_u32 s3, 6
    s_cbranch_scc1 L_cls6_no
    s_add_u32 s15, s4, 0
    s_cmp_lt_u32 s4, 11
    s_cbranch_scc1 L_role_ta
    s_add_u32 s15, s4, 43
    s_cmp_lt_u32 s4, 32
    s_cbranch_scc1 L_role_p
    s_endpgm
L_cls6_no:
    s_cmp_lg_u32 s3, 7
    s_cbranch_scc1 L_cls7_no
    s_add_u32 s15, s4, 11
    s_cmp_lt_u32 s4, 11
    s_cbranch_scc1 L_role_ta
    s_add_u32 s15, s4, 64
    s_cmp_lt_u32 s4, 32
    s_cbranch_scc1 L_role_p
    s_endpgm
L_cls7_no:
L_exit:
    s_endpgm
L_abort:
    s_waitcnt lgkmcnt(0)
    s_mov_b64 exec, -1
    v_mov_b32 v0, 60
    s_lshl_b32 s5, s3, 8
    s_or_b32 s5, s5, s4
    s_or_b32 s5, s5, 0x10000
    v_mov_b32 v1, s5
    global_store_dword v0, v1, s[12:13]
    s_endpgm
.p2align 6
L_role_p:
    v_and_b32 v5, 63, v0
    v_lshlrev_b32 v0, 4, v5
    v_and_b32 v7, 15, v5
    v_lshrrev_b32 v8, 4, v5
    v_min_u32 v1, 17, v5
    v_lshrrev_b32 v6, 2, v1
    v_and_b32 v1, 3, v1
    v_lshlrev_b32 v1, 2, v1
    v_lshl_add_u32 v1, v6, 7, v1
    v_mov_b32 v3, 1
    v_mov_b32 v4, 0
    s_mov_b32 s44, 0x05040100
    s_mov_b32 s45, 0x07060302
    s_cmp_ge_u32 s15, 48
    s_cselect_b32 s63, 1, 0
    s_cselect_b32 s17, 48, 0
    s_sub_u32 s15, s15, s17
    s_cmp_lt_u32 s15, 32
    s_cselect_b32 s50, 1, 0
    s_sub_u32 s17, s15, 32
    s_lshl_b32 s17, s17, 1
    s_cmp_eq_u32 s50, 1
    s_cselect_b32 s51, s15, s17
    s_cselect_b32 s17, 48, 40
    s_cselect_b32 s18, 56, 40
    s_load_dwordx2 s[20:21], s[0:1], s17
    s_load_dwordx2 s[24:25], s[0:1], s18
    s_mov_b32 s22, 4718592
    s_mov_b32 s23, 0x00020000
    s_mov_b32 s26, 4718592
    s_mov_b32 s27, 0x00020000
    s_lshl_b32 s49, s51, 8
    s_mul_i32 s17, s14, 131072
    s_add_u32 s49, s49, s17
    s_cmp_eq_u32 s50, 1
    s_cselect_b32 s17, 0, 256
    s_add_u32 s52, s49, s17
    s_waitcnt lgkmcnt(0)
    s_and_b32 s21, s21, 0xffff
    s_and_b32 s25, s25, 0xffff
    s_cmp_eq_u32 s63, 0
    s_cbranch_scc1 Lp2_gate_ng
    s_cmp_lg_u32 s14, 0
    s_cbranch_scc1 Lp2_gate_d
    v_mov_b32 v5, 48
    s_mov_b32 s16, 0
Lp2_gate:
    global_load_dword v6, v5, s[12:13] sc1
    s_add_u32 s16, s16, 1
    s_cmp_gt_u32 s16, 100000
    s_cbranch_scc1 L_role_p_abort
    s_waitcnt vmcnt(0)
    v_cmp_gt_u32 vcc, 32, v6
    s_nop 0
    s_cbranch_vccz Lp2_gate_d
    s_sleep 100
    s_branch Lp2_gate
Lp2_gate_d:
    s_barrier
Lp2_gate_ng:
    v_lshrrev_b32 v5, 8, v0
    v_bfe_u32 v6, v0, 6, 2
    v_xor_b32 v6, v6, v5
    v_lshlrev_b32 v6, 6, v6
    v_and_b32 v16, 0x30, v0
    v_add_u32 v16, v16, v6
    v_lshl_add_u32 v16, v5, 13, v16
    v_lshrrev_b32 v5, 2, v7
    v_xor_b32 v6, s14, v5
    v_lshlrev_b32 v17, 6, v6
    v_lshrrev_b32 v6, 1, v8
    v_lshl_add_u32 v5, v6, 3, v5
    v_lshl_add_u32 v17, v5, 8, v17
    v_and_b32 v5, 1, v8
    v_lshl_add_u32 v17, v5, 5, v17
    v_and_b32 v5, 3, v7
    v_lshl_add_u32 v17, v5, 3, v17
    v_add_u32 v18, 65536, v17
    s_lshl_b32 s46, s14, 12
    s_add_u32 m0, s46, 0
    s_add_u32 s17, s49, 0
    buffer_load_dwordx4 v16, s[20:23], s17 offen lds
    s_add_u32 m0, m0, 1024
    s_add_u32 s17, s49, 32768
    buffer_load_dwordx4 v16, s[20:23], s17 offen lds
    s_add_u32 m0, m0, 1024
    s_add_u32 s17, s49, 65536
    buffer_load_dwordx4 v16, s[20:23], s17 offen lds
    s_add_u32 m0, m0, 1024
    s_add_u32 s17, s49, 98304
    buffer_load_dwordx4 v16, s[20:23], s17 offen lds
    s_add_u32 m0, s46, 16384
    s_add_u32 s17, s49, 524288
    buffer_load_dwordx4 v16, s[20:23], s17 offen lds
    s_add_u32 m0, m0, 1024
    s_add_u32 s17, s49, 557056
    buffer_load_dwordx4 v16, s[20:23], s17 offen lds
    s_add_u32 m0, m0, 1024
    s_add_u32 s17, s49, 589824
    buffer_load_dwordx4 v16, s[20:23], s17 offen lds
    s_add_u32 m0, m0, 1024
    s_add_u32 s17, s49, 622592
    buffer_load_dwordx4 v16, s[20:23], s17 offen lds
    s_add_u32 m0, s46, 32768
    s_add_u32 s17, s49, 1048576
    buffer_load_dwordx4 v16, s[20:23], s17 offen lds
    s_add_u32 m0, m0, 1024
    s_add_u32 s17, s49, 1081344
    buffer_load_dwordx4 v16, s[20:23], s17 offen lds
    s_add_u32 m0, m0, 1024
    s_add_u32 s17, s49, 1114112
    buffer_load_dwordx4 v16, s[20:23], s17 offen lds
    s_add_u32 m0, m0, 1024
    s_add_u32 s17, s49, 1146880
    buffer_load_dwordx4 v16, s[20:23], s17 offen lds
    s_add_u32 m0, s46, 49152
    s_add_u32 s17, s49, 1572864
    buffer_load_dwordx4 v16, s[20:23], s17 offen lds
    s_add_u32 m0, m0, 1024
    s_add_u32 s17, s49, 1605632
    buffer_load_dwordx4 v16, s[20:23], s17 offen lds
    s_add_u32 m0, m0, 1024
    s_add_u32 s17, s49, 1638400
    buffer_load_dwordx4 v16, s[20:23], s17 offen lds
    s_add_u32 m0, m0, 1024
    s_add_u32 s17, s49, 1671168
    buffer_load_dwordx4 v16, s[20:23], s17 offen lds
    s_add_u32 m0, s46, 65536
    s_add_u32 s17, s49, 2097152
    buffer_load_dwordx4 v16, s[20:23], s17 offen lds
    s_add_u32 m0, m0, 1024
    s_add_u32 s17, s49, 2129920
    buffer_load_dwordx4 v16, s[20:23], s17 offen lds
    s_add_u32 m0, m0, 1024
    s_add_u32 s17, s49, 2162688
    buffer_load_dwordx4 v16, s[20:23], s17 offen lds
    s_add_u32 m0, m0, 1024
    s_add_u32 s17, s49, 2195456
    buffer_load_dwordx4 v16, s[20:23], s17 offen lds
    s_add_u32 m0, s46, 81920
    s_add_u32 s17, s49, 2621440
    buffer_load_dwordx4 v16, s[20:23], s17 offen lds
    s_add_u32 m0, m0, 1024
    s_add_u32 s17, s49, 2654208
    buffer_load_dwordx4 v16, s[20:23], s17 offen lds
    s_add_u32 m0, m0, 1024
    s_add_u32 s17, s49, 2686976
    buffer_load_dwordx4 v16, s[20:23], s17 offen lds
    s_add_u32 m0, m0, 1024
    s_add_u32 s17, s49, 2719744
    buffer_load_dwordx4 v16, s[20:23], s17 offen lds
    s_add_u32 m0, s46, 98304
    s_add_u32 s17, s49, 3145728
    buffer_load_dwordx4 v16, s[20:23], s17 offen lds
    s_add_u32 m0, m0, 1024
    s_add_u32 s17, s49, 3178496
    buffer_load_dwordx4 v16, s[20:23], s17 offen lds
    s_add_u32 m0, m0, 1024
    s_add_u32 s17, s49, 3211264
    buffer_load_dwordx4 v16, s[20:23], s17 offen lds
    s_add_u32 m0, m0, 1024
    s_add_u32 s17, s49, 3244032
    buffer_load_dwordx4 v16, s[20:23], s17 offen lds
    s_waitcnt vmcnt(24)
    s_barrier
    s_add_u32 m0, s46, 114688
    s_add_u32 s17, s49, 3670016
    buffer_load_dwordx4 v16, s[20:23], s17 offen lds
    s_add_u32 m0, m0, 1024
    s_add_u32 s17, s49, 3702784
    buffer_load_dwordx4 v16, s[20:23], s17 offen lds
    s_add_u32 m0, m0, 1024
    s_add_u32 s17, s49, 3735552
    buffer_load_dwordx4 v16, s[20:23], s17 offen lds
    s_add_u32 m0, m0, 1024
    s_add_u32 s17, s49, 3768320
    buffer_load_dwordx4 v16, s[20:23], s17 offen lds
    ds_read_b64_tr_b16 a[0:1], v17 offset:0
    ds_read_b64_tr_b16 a[2:3], v17 offset:1024
    ds_read_b64_tr_b16 a[4:5], v17 offset:4096
    ds_read_b64_tr_b16 a[6:7], v17 offset:5120
    ds_read_b64_tr_b16 a[8:9], v17 offset:8192
    ds_read_b64_tr_b16 a[10:11], v17 offset:9216
    ds_read_b64_tr_b16 a[12:13], v17 offset:12288
    ds_read_b64_tr_b16 a[14:15], v17 offset:13312
    s_waitcnt lgkmcnt(0)
    s_waitcnt vmcnt(24)
    s_barrier
    s_add_u32 m0, s46, 0
    s_add_u32 s17, s49, 4194304
    buffer_load_dwordx4 v16, s[20:23], s17 offen lds
    s_add_u32 m0, m0, 1024
    s_add_u32 s17, s49, 4227072
    buffer_load_dwordx4 v16, s[20:23], s17 offen lds
    s_add_u32 m0, m0, 1024
    s_add_u32 s17, s49, 4259840
    buffer_load_dwordx4 v16, s[20:23], s17 offen lds
    s_add_u32 m0, m0, 1024
    s_add_u32 s17, s49, 4292608
    buffer_load_dwordx4 v16, s[20:23], s17 offen lds
    ds_read_b64_tr_b16 a[16:17], v17 offset:16384
    ds_read_b64_tr_b16 a[18:19], v17 offset:17408
    ds_read_b64_tr_b16 a[20:21], v17 offset:20480
    ds_read_b64_tr_b16 a[22:23], v17 offset:21504
    ds_read_b64_tr_b16 a[24:25], v17 offset:24576
    ds_read_b64_tr_b16 a[26:27], v17 offset:25600
    ds_read_b64_tr_b16 a[28:29], v17 offset:28672
    ds_read_b64_tr_b16 a[30:31], v17 offset:29696
    s_waitcnt lgkmcnt(0)
    s_waitcnt vmcnt(24)
    s_barrier
    s_add_u32 m0, s46, 16384
    s_add_u32 s17, s52, 0
    buffer_load_dwordx4 v16, s[24:27], s17 offen lds
    s_add_u32 m0, m0, 1024
    s_add_u32 s17, s52, 32768
    buffer_load_dwordx4 v16, s[24:27], s17 offen lds
    s_add_u32 m0, m0, 1024
    s_add_u32 s17, s52, 65536
    buffer_load_dwordx4 v16, s[24:27], s17 offen lds
    s_add_u32 m0, m0, 1024
    s_add_u32 s17, s52, 98304
    buffer_load_dwordx4 v16, s[24:27], s17 offen lds
    ds_read_b64_tr_b16 a[32:33], v17 offset:32768
    ds_read_b64_tr_b16 a[34:35], v17 offset:33792
    ds_read_b64_tr_b16 a[36:37], v17 offset:36864
    ds_read_b64_tr_b16 a[38:39], v17 offset:37888
    ds_read_b64_tr_b16 a[40:41], v17 offset:40960
    ds_read_b64_tr_b16 a[42:43], v17 offset:41984
    ds_read_b64_tr_b16 a[44:45], v17 offset:45056
    ds_read_b64_tr_b16 a[46:47], v17 offset:46080
    s_waitcnt lgkmcnt(0)
    s_waitcnt vmcnt(24)
    s_barrier
    s_add_u32 m0, s46, 32768
    s_add_u32 s17, s52, 524288
    buffer_load_dwordx4 v16, s[24:27], s17 offen lds
    s_add_u32 m0, m0, 1024
    s_add_u32 s17, s52, 557056
    buffer_load_dwordx4 v16, s[24:27], s17 offen lds
    s_add_u32 m0, m0, 1024
    s_add_u32 s17, s52, 589824
    buffer_load_dwordx4 v16, s[24:27], s17 offen lds
    s_add_u32 m0, m0, 1024
    s_add_u32 s17, s52, 622592
    buffer_load_dwordx4 v16, s[24:27], s17 offen lds
    ds_read_b64_tr_b16 a[48:49], v17 offset:49152
    ds_read_b64_tr_b16 a[50:51], v17 offset:50176
    ds_read_b64_tr_b16 a[52:53], v17 offset:53248
    ds_read_b64_tr_b16 a[54:55], v17 offset:54272
    ds_read_b64_tr_b16 a[56:57], v17 offset:57344
    ds_read_b64_tr_b16 a[58:59], v17 offset:58368
    ds_read_b64_tr_b16 a[60:61], v17 offset:61440
    ds_read_b64_tr_b16 a[62:63], v17 offset:62464
    s_waitcnt lgkmcnt(0)
    s_waitcnt vmcnt(24)
    s_barrier
    s_add_u32 m0, s46, 49152
    s_add_u32 s17, s52, 1048576
    buffer_load_dwordx4 v16, s[24:27], s17 offen lds
    s_add_u32 m0, m0, 1024
    s_add_u32 s17, s52, 1081344
    buffer_load_dwordx4 v16, s[24:27], s17 offen lds
    s_add_u32 m0, m0, 1024
    s_add_u32 s17, s52, 1114112
    buffer_load_dwordx4 v16, s[24:27], s17 offen lds
    s_add_u32 m0, m0, 1024
    s_add_u32 s17, s52, 1146880
    buffer_load_dwordx4 v16, s[24:27], s17 offen lds
    ds_read_b64_tr_b16 a[64:65], v18 offset:0
    ds_read_b64_tr_b16 a[66:67], v18 offset:1024
    ds_read_b64_tr_b16 a[68:69], v18 offset:4096
    ds_read_b64_tr_b16 a[70:71], v18 offset:5120
    ds_read_b64_tr_b16 a[72:73], v18 offset:8192
    ds_read_b64_tr_b16 a[74:75], v18 offset:9216
    ds_read_b64_tr_b16 a[76:77], v18 offset:12288
    ds_read_b64_tr_b16 a[78:79], v18 offset:13312
    s_waitcnt lgkmcnt(0)
    s_waitcnt vmcnt(24)
    s_barrier
    s_add_u32 m0, s46, 65536
    s_add_u32 s17, s52, 1572864
    buffer_load_dwordx4 v16, s[24:27], s17 offen lds
    s_add_u32 m0, m0, 1024
    s_add_u32 s17, s52, 1605632
    buffer_load_dwordx4 v16, s[24:27], s17 offen lds
    s_add_u32 m0, m0, 1024
    s_add_u32 s17, s52, 1638400
    buffer_load_dwordx4 v16, s[24:27], s17 offen lds
    s_add_u32 m0, m0, 1024
    s_add_u32 s17, s52, 1671168
    buffer_load_dwordx4 v16, s[24:27], s17 offen lds
    ds_read_b64_tr_b16 a[80:81], v18 offset:16384
    ds_read_b64_tr_b16 a[82:83], v18 offset:17408
    ds_read_b64_tr_b16 a[84:85], v18 offset:20480
    ds_read_b64_tr_b16 a[86:87], v18 offset:21504
    ds_read_b64_tr_b16 a[88:89], v18 offset:24576
    ds_read_b64_tr_b16 a[90:91], v18 offset:25600
    ds_read_b64_tr_b16 a[92:93], v18 offset:28672
    ds_read_b64_tr_b16 a[94:95], v18 offset:29696
    s_waitcnt lgkmcnt(0)
    s_waitcnt vmcnt(24)
    s_barrier
    s_add_u32 m0, s46, 81920
    s_add_u32 s17, s52, 2097152
    buffer_load_dwordx4 v16, s[24:27], s17 offen lds
    s_add_u32 m0, m0, 1024
    s_add_u32 s17, s52, 2129920
    buffer_load_dwordx4 v16, s[24:27], s17 offen lds
    s_add_u32 m0, m0, 1024
    s_add_u32 s17, s52, 2162688
    buffer_load_dwordx4 v16, s[24:27], s17 offen lds
    s_add_u32 m0, m0, 1024
    s_add_u32 s17, s52, 2195456
    buffer_load_dwordx4 v16, s[24:27], s17 offen lds
    ds_read_b64_tr_b16 a[96:97], v18 offset:32768
    ds_read_b64_tr_b16 a[98:99], v18 offset:33792
    ds_read_b64_tr_b16 a[100:101], v18 offset:36864
    ds_read_b64_tr_b16 a[102:103], v18 offset:37888
    ds_read_b64_tr_b16 a[104:105], v18 offset:40960
    ds_read_b64_tr_b16 a[106:107], v18 offset:41984
    ds_read_b64_tr_b16 a[108:109], v18 offset:45056
    ds_read_b64_tr_b16 a[110:111], v18 offset:46080
    s_waitcnt lgkmcnt(0)
    s_waitcnt vmcnt(24)
    s_barrier
    s_add_u32 m0, s46, 98304
    s_add_u32 s17, s52, 2621440
    buffer_load_dwordx4 v16, s[24:27], s17 offen lds
    s_add_u32 m0, m0, 1024
    s_add_u32 s17, s52, 2654208
    buffer_load_dwordx4 v16, s[24:27], s17 offen lds
    s_add_u32 m0, m0, 1024
    s_add_u32 s17, s52, 2686976
    buffer_load_dwordx4 v16, s[24:27], s17 offen lds
    s_add_u32 m0, m0, 1024
    s_add_u32 s17, s52, 2719744
    buffer_load_dwordx4 v16, s[24:27], s17 offen lds
    ds_read_b64_tr_b16 a[112:113], v18 offset:49152
    ds_read_b64_tr_b16 a[114:115], v18 offset:50176
    ds_read_b64_tr_b16 a[116:117], v18 offset:53248
    ds_read_b64_tr_b16 a[118:119], v18 offset:54272
    ds_read_b64_tr_b16 a[120:121], v18 offset:57344
    ds_read_b64_tr_b16 a[122:123], v18 offset:58368
    ds_read_b64_tr_b16 a[124:125], v18 offset:61440
    ds_read_b64_tr_b16 a[126:127], v18 offset:62464
    s_waitcnt lgkmcnt(0)
    s_waitcnt vmcnt(24)
    s_barrier
    s_add_u32 m0, s46, 114688
    s_add_u32 s17, s52, 3145728
    buffer_load_dwordx4 v16, s[24:27], s17 offen lds
    s_add_u32 m0, m0, 1024
    s_add_u32 s17, s52, 3178496
    buffer_load_dwordx4 v16, s[24:27], s17 offen lds
    s_add_u32 m0, m0, 1024
    s_add_u32 s17, s52, 3211264
    buffer_load_dwordx4 v16, s[24:27], s17 offen lds
    s_add_u32 m0, m0, 1024
    s_add_u32 s17, s52, 3244032
    buffer_load_dwordx4 v16, s[24:27], s17 offen lds
    ds_read_b64_tr_b16 a[128:129], v17 offset:0
    ds_read_b64_tr_b16 a[130:131], v17 offset:1024
    ds_read_b64_tr_b16 a[132:133], v17 offset:4096
    ds_read_b64_tr_b16 a[134:135], v17 offset:5120
    ds_read_b64_tr_b16 a[136:137], v17 offset:8192
    ds_read_b64_tr_b16 a[138:139], v17 offset:9216
    ds_read_b64_tr_b16 a[140:141], v17 offset:12288
    ds_read_b64_tr_b16 a[142:143], v17 offset:13312
    s_waitcnt lgkmcnt(0)
    s_waitcnt vmcnt(24)
    s_barrier
    s_add_u32 m0, s46, 0
    s_add_u32 s17, s52, 3670016
    buffer_load_dwordx4 v16, s[24:27], s17 offen lds
    s_add_u32 m0, m0, 1024
    s_add_u32 s17, s52, 3702784
    buffer_load_dwordx4 v16, s[24:27], s17 offen lds
    s_add_u32 m0, m0, 1024
    s_add_u32 s17, s52, 3735552
    buffer_load_dwordx4 v16, s[24:27], s17 offen lds
    s_add_u32 m0, m0, 1024
    s_add_u32 s17, s52, 3768320
    buffer_load_dwordx4 v16, s[24:27], s17 offen lds
    ds_read_b64_tr_b16 a[144:145], v17 offset:16384
    ds_read_b64_tr_b16 a[146:147], v17 offset:17408
    ds_read_b64_tr_b16 a[148:149], v17 offset:20480
    ds_read_b64_tr_b16 a[150:151], v17 offset:21504
    ds_read_b64_tr_b16 a[152:153], v17 offset:24576
    ds_read_b64_tr_b16 a[154:155], v17 offset:25600
    ds_read_b64_tr_b16 a[156:157], v17 offset:28672
    ds_read_b64_tr_b16 a[158:159], v17 offset:29696
    s_waitcnt lgkmcnt(0)
    s_waitcnt vmcnt(24)
    s_barrier
    s_add_u32 m0, s46, 16384
    s_add_u32 s17, s52, 4194304
    buffer_load_dwordx4 v16, s[24:27], s17 offen lds
    s_add_u32 m0, m0, 1024
    s_add_u32 s17, s52, 4227072
    buffer_load_dwordx4 v16, s[24:27], s17 offen lds
    s_add_u32 m0, m0, 1024
    s_add_u32 s17, s52, 4259840
    buffer_load_dwordx4 v16, s[24:27], s17 offen lds
    s_add_u32 m0, m0, 1024
    s_add_u32 s17, s52, 4292608
    buffer_load_dwordx4 v16, s[24:27], s17 offen lds
    ds_read_b64_tr_b16 a[160:161], v17 offset:32768
    ds_read_b64_tr_b16 a[162:163], v17 offset:33792
    ds_read_b64_tr_b16 a[164:165], v17 offset:36864
    ds_read_b64_tr_b16 a[166:167], v17 offset:37888
    ds_read_b64_tr_b16 a[168:169], v17 offset:40960
    ds_read_b64_tr_b16 a[170:171], v17 offset:41984
    ds_read_b64_tr_b16 a[172:173], v17 offset:45056
    ds_read_b64_tr_b16 a[174:175], v17 offset:46080
    s_waitcnt lgkmcnt(0)
    s_waitcnt vmcnt(24)
    s_barrier
    ds_read_b64_tr_b16 a[176:177], v17 offset:49152
    ds_read_b64_tr_b16 a[178:179], v17 offset:50176
    ds_read_b64_tr_b16 a[180:181], v17 offset:53248
    ds_read_b64_tr_b16 a[182:183], v17 offset:54272
    ds_read_b64_tr_b16 a[184:185], v17 offset:57344
    ds_read_b64_tr_b16 a[186:187], v17 offset:58368
    ds_read_b64_tr_b16 a[188:189], v17 offset:61440
    ds_read_b64_tr_b16 a[190:191], v17 offset:62464
    s_waitcnt lgkmcnt(0)
    s_waitcnt vmcnt(20)
    s_barrier
    ds_read_b64_tr_b16 a[192:193], v18 offset:0
    ds_read_b64_tr_b16 a[194:195], v18 offset:1024
    ds_read_b64_tr_b16 a[196:197], v18 offset:4096
    ds_read_b64_tr_b16 a[198:199], v18 offset:5120
    ds_read_b64_tr_b16 a[200:201], v18 offset:8192
    ds_read_b64_tr_b16 a[202:203], v18 offset:9216
    ds_read_b64_tr_b16 a[204:205], v18 offset:12288
    ds_read_b64_tr_b16 a[206:207], v18 offset:13312
    s_waitcnt lgkmcnt(0)
    s_waitcnt vmcnt(16)
    s_barrier
    ds_read_b64_tr_b16 a[208:209], v18 offset:16384
    ds_read_b64_tr_b16 a[210:211], v18 offset:17408
    ds_read_b64_tr_b16 a[212:213], v18 offset:20480
    ds_read_b64_tr_b16 a[214:215], v18 offset:21504
    ds_read_b64_tr_b16 a[216:217], v18 offset:24576
    ds_read_b64_tr_b16 a[218:219], v18 offset:25600
    ds_read_b64_tr_b16 a[220:221], v18 offset:28672
    ds_read_b64_tr_b16 a[222:223], v18 offset:29696
    s_waitcnt lgkmcnt(0)
    s_waitcnt vmcnt(12)
    s_barrier
    ds_read_b64_tr_b16 a[224:225], v18 offset:32768
    ds_read_b64_tr_b16 a[226:227], v18 offset:33792
    ds_read_b64_tr_b16 a[228:229], v18 offset:36864
    ds_read_b64_tr_b16 a[230:231], v18 offset:37888
    ds_read_b64_tr_b16 a[232:233], v18 offset:40960
    ds_read_b64_tr_b16 a[234:235], v18 offset:41984
    ds_read_b64_tr_b16 a[236:237], v18 offset:45056
    ds_read_b64_tr_b16 a[238:239], v18 offset:46080
    s_waitcnt lgkmcnt(0)
    s_waitcnt vmcnt(8)
    s_barrier
    ds_read_b64_tr_b16 a[240:241], v18 offset:49152
    ds_read_b64_tr_b16 a[242:243], v18 offset:50176
    ds_read_b64_tr_b16 a[244:245], v18 offset:53248
    ds_read_b64_tr_b16 a[246:247], v18 offset:54272
    ds_read_b64_tr_b16 a[248:249], v18 offset:57344
    ds_read_b64_tr_b16 a[250:251], v18 offset:58368
    ds_read_b64_tr_b16 a[252:253], v18 offset:61440
    ds_read_b64_tr_b16 a[254:255], v18 offset:62464
    s_waitcnt lgkmcnt(0)
    s_waitcnt vmcnt(4)
    s_barrier
    ds_read_b64_tr_b16 v[152:153], v17 offset:0
    ds_read_b64_tr_b16 v[154:155], v17 offset:1024
    ds_read_b64_tr_b16 v[156:157], v17 offset:4096
    ds_read_b64_tr_b16 v[158:159], v17 offset:5120
    ds_read_b64_tr_b16 v[160:161], v17 offset:8192
    ds_read_b64_tr_b16 v[162:163], v17 offset:9216
    ds_read_b64_tr_b16 v[164:165], v17 offset:12288
    ds_read_b64_tr_b16 v[166:167], v17 offset:13312
    s_waitcnt lgkmcnt(0)
    s_waitcnt vmcnt(0)
    s_barrier
    ds_read_b64_tr_b16 v[168:169], v17 offset:16384
    ds_read_b64_tr_b16 v[170:171], v17 offset:17408
    ds_read_b64_tr_b16 v[172:173], v17 offset:20480
    ds_read_b64_tr_b16 v[174:175], v17 offset:21504
    ds_read_b64_tr_b16 v[176:177], v17 offset:24576
    ds_read_b64_tr_b16 v[178:179], v17 offset:25600
    ds_read_b64_tr_b16 v[180:181], v17 offset:28672
    ds_read_b64_tr_b16 v[182:183], v17 offset:29696
    s_waitcnt lgkmcnt(0)
    s_barrier
    v_bfe_u32 v10, v0, 4, 5
    v_lshrrev_b32 v5, 9, v0
    v_lshlrev_b32 v10, 4, v10
    v_mul_u32_u24 v6, 2560, v5
    v_add_u32 v10, v10, v6
    v_add_u32 v10, 114688, v10
    s_lshl_b32 s67, s14, 10
    v_bfe_u32 v6, v0, 8, 1
    v_lshlrev_b32 v14, 10, v6
    v_lshl_add_u32 v14, v7, 4, v14
    v_lshl_add_u32 v14, v5, 8, v14
    s_lshl_b32 s17, s51, 13
    s_lshl_b32 s18, s14, 11
    s_add_u32 s52, s17, s18
    s_add_u32 s52, s52, 44040192
    s_lshl_b32 s49, s51, 9
    s_lshl_b32 s17, s14, 2
    s_add_u32 s49, s49, s17
    s_add_u32 s49, s49, 5376
    s_cmp_eq_u32 s50, 1
    s_cselect_b32 s17, 16777216, 0
    s_cselect_b32 s18, 128, 0
    s_add_u32 s52, s52, s17
    s_add_u32 s49, s49, s18
    s_cmp_eq_u32 s50, 1
    s_cselect_b32 s17, 0, 384
    s_add_u32 s17, s17, 128
    v_lshrrev_b32 v185, 4, v0
    v_mul_lo_u32 v185, v185, s17
    v_mov_b32 v48, 0x3f803f80
    v_mov_b32 v49, 0x3f803f80
    v_mov_b32 v50, 0x3f803f80
    v_mov_b32 v51, 0x3f803f80
    s_lshl_b32 s17, s14, 8
    s_add_u32 s17, s17, 110592
    v_bfe_u32 v5, v0, 4, 5
    v_lshl_add_u32 v12, v5, 2, s17
    v_lshrrev_b32 v5, 9, v0
    v_lshl_add_u32 v13, v5, 4, s17
    s_cmp_eq_u32 s50, 1
    s_cbranch_scc1 Lp2_kv
    v_mfma_f32_32x32x16_bf16 v[84:99], a[0:3], v[48:51], 0
    v_mfma_f32_32x32x16_bf16 v[116:131], a[144:147], v[48:51], 0
    v_mfma_f32_32x32x16_bf16 v[84:99], a[4:7], v[48:51], v[84:99]
    v_mfma_f32_32x32x16_bf16 v[116:131], a[148:151], v[48:51], v[116:131]
    v_mfma_f32_32x32x16_bf16 v[84:99], a[8:11], v[48:51], v[84:99]
    v_mfma_f32_32x32x16_bf16 v[116:131], a[152:155], v[48:51], v[116:131]
    v_mfma_f32_32x32x16_bf16 v[84:99], a[12:15], v[48:51], v[84:99]
    v_mfma_f32_32x32x16_bf16 v[116:131], a[156:159], v[48:51], v[116:131]
    v_mfma_f32_32x32x16_bf16 v[84:99], a[16:19], v[48:51], v[84:99]
    v_mfma_f32_32x32x16_bf16 v[116:131], a[160:163], v[48:51], v[116:131]
    v_mfma_f32_32x32x16_bf16 v[84:99], a[20:23], v[48:51], v[84:99]
    v_mfma_f32_32x32x16_bf16 v[116:131], a[164:167], v[48:51], v[116:131]
    v_mfma_f32_32x32x16_bf16 v[84:99], a[24:27], v[48:51], v[84:99]
    v_mfma_f32_32x32x16_bf16 v[116:131], a[168:171], v[48:51], v[116:131]
    v_mfma_f32_32x32x16_bf16 v[84:99], a[28:31], v[48:51], v[84:99]
    v_mfma_f32_32x32x16_bf16 v[116:131], a[172:175], v[48:51], v[116:131]
    v_mfma_f32_32x32x16_bf16 v[84:99], a[32:35], v[48:51], v[84:99]
    v_mfma_f32_32x32x16_bf16 v[116:131], a[176:179], v[48:51], v[116:131]
    v_mfma_f32_32x32x16_bf16 v[84:99], a[36:39], v[48:51], v[84:99]
    v_mfma_f32_32x32x16_bf16 v[116:131], a[180:183], v[48:51], v[116:131]
    v_mfma_f32_32x32x16_bf16 v[84:99], a[40:43], v[48:51], v[84:99]
    v_mfma_f32_32x32x16_bf16 v[116:131], a[184:187], v[48:51], v[116:131]
    v_mfma_f32_32x32x16_bf16 v[84:99], a[44:47], v[48:51], v[84:99]
    v_mfma_f32_32x32x16_bf16 v[116:131], a[188:191], v[48:51], v[116:131]
    v_mfma_f32_32x32x16_bf16 v[84:99], a[48:51], v[48:51], v[84:99]
    v_mfma_f32_32x32x16_bf16 v[116:131], a[192:195], v[48:51], v[116:131]
    v_mfma_f32_32x32x16_bf16 v[84:99], a[52:55], v[48:51], v[84:99]
    v_mfma_f32_32x32x16_bf16 v[116:131], a[196:199], v[48:51], v[116:131]
    v_mfma_f32_32x32x16_bf16 v[84:99], a[56:59], v[48:51], v[84:99]
    v_mfma_f32_32x32x16_bf16 v[116:131], a[200:203], v[48:51], v[116:131]
    v_mfma_f32_32x32x16_bf16 v[84:99], a[60:63], v[48:51], v[84:99]
    v_mfma_f32_32x32x16_bf16 v[116:131], a[204:207], v[48:51], v[116:131]
    v_mfma_f32_32x32x16_bf16 v[84:99], a[64:67], v[48:51], v[84:99]
    v_mfma_f32_32x32x16_bf16 v[116:131], a[208:211], v[48:51], v[116:131]
    v_mfma_f32_32x32x16_bf16 v[84:99], a[68:71], v[48:51], v[84:99]
    v_mfma_f32_32x32x16_bf16 v[116:131], a[212:215], v[48:51], v[116:131]
    v_mfma_f32_32x32x16_bf16 v[84:99], a[72:75], v[48:51], v[84:99]
    v_mfma_f32_32x32x16_bf16 v[116:131], a[216:219], v[48:51], v[116:131]
    v_mfma_f32_32x32x16_bf16 v[84:99], a[76:79], v[48:51], v[84:99]
    v_mfma_f32_32x32x16_bf16 v[116:131], a[220:223], v[48:51], v[116:131]
    v_mfma_f32_32x32x16_bf16 v[84:99], a[80:83], v[48:51], v[84:99]
    v_mfma_f32_32x32x16_bf16 v[116:131], a[224:227], v[48:51], v[116:131]
    v_mfma_f32_32x32x16_bf16 v[84:99], a[84:87], v[48:51], v[84:99]
    v_mfma_f32_32x32x16_bf16 v[116:131], a[228:231], v[48:51], v[116:131]
    v_mfma_f32_32x32x16_bf16 v[84:99], a[88:91], v[48:51], v[84:99]
    v_mfma_f32_32x32x16_bf16 v[116:131], a[232:235], v[48:51], v[116:131]
    v_mfma_f32_32x32x16_bf16 v[84:99], a[92:95], v[48:51], v[84:99]
    v_mfma_f32_32x32x16_bf16 v[116:131], a[236:239], v[48:51], v[116:131]
    v_mfma_f32_32x32x16_bf16 v[84:99], a[96:99], v[48:51], v[84:99]
    v_mfma_f32_32x32x16_bf16 v[116:131], a[240:243], v[48:51], v[116:131]
    v_mfma_f32_32x32x16_bf16 v[84:99], a[100:103], v[48:51], v[84:99]
    v_mfma_f32_32x32x16_bf16 v[116:131], a[244:247], v[48:51], v[116:131]
    v_mfma_f32_32x32x16_bf16 v[84:99], a[104:107], v[48:51], v[84:99]
    v_mfma_f32_32x32x16_bf16 v[116:131], a[248:251], v[48:51], v[116:131]
    v_mfma_f32_32x32x16_bf16 v[84:99], a[108:111], v[48:51], v[84:99]
    v_mfma_f32_32x32x16_bf16 v[116:131], a[252:255], v[48:51], v[116:131]
    v_mfma_f32_32x32x16_bf16 v[84:99], a[112:115], v[48:51], v[84:99]
    v_mfma_f32_32x32x16_bf16 v[116:131], v[152:155], v[48:51], v[116:131]
    v_mfma_f32_32x32x16_bf16 v[84:99], a[116:119], v[48:51], v[84:99]
    v_mfma_f32_32x32x16_bf16 v[116:131], v[156:159], v[48:51], v[116:131]
    v_mfma_f32_32x32x16_bf16 v[84:99], a[120:123], v[48:51], v[84:99]
    v_mfma_f32_32x32x16_bf16 v[116:131], v[160:163], v[48:51], v[116:131]
    v_mfma_f32_32x32x16_bf16 v[84:99], a[124:127], v[48:51], v[84:99]
    v_mfma_f32_32x32x16_bf16 v[116:131], v[164:167], v[48:51], v[116:131]
    v_mfma_f32_32x32x16_bf16 v[84:99], a[128:131], v[48:51], v[84:99]
    v_mfma_f32_32x32x16_bf16 v[116:131], v[168:171], v[48:51], v[116:131]
    v_mfma_f32_32x32x16_bf16 v[84:99], a[132:135], v[48:51], v[84:99]
    v_mfma_f32_32x32x16_bf16 v[116:131], v[172:175], v[48:51], v[116:131]
    v_mfma_f32_32x32x16_bf16 v[84:99], a[136:139], v[48:51], v[84:99]
    v_mfma_f32_32x32x16_bf16 v[116:131], v[176:179], v[48:51], v[116:131]
    v_mfma_f32_32x32x16_bf16 v[84:99], a[140:143], v[48:51], v[84:99]
    v_mfma_f32_32x32x16_bf16 v[116:131], v[180:183], v[48:51], v[116:131]
    s_mov_b32 s66, 114688
    s_mov_b32 s71, 0x2000
    s_mov_b32 s36, s63
    s_mov_b32 s34, s63
    s_mul_i32 s58, s14, 9216
    s_mul_i32 s64, s63, 4718592
    s_add_u32 s64, s64, s58
    s_add_u32 s64, s64, 8650752
    s_mul_i32 s61, s63, 1441792
    s_add_u32 s61, s61, 3584
    s_mov_b32 s37, 0
    s_mov_b32 s40, 36864
    s_mov_b32 s59, s58
    s_mov_b32 s43, 0
    s_mov_b32 s62, 1
    s_mov_b32 s28, s8
    s_mov_b32 s29, s9
    s_mov_b32 s30, 0
    s_mov_b32 s31, 0x00020000
    v_mov_b32 v184, 74752
    v_mov_b32 v5, -1
    ds_write_b32 v184, v5
    s_waitcnt lgkmcnt(0)
    s_cmp_lg_u32 s14, 0
    s_cbranch_scc1 LpQQ_inia_d
    v_mov_b32 v5, 40
    s_mov_b32 s16, 0
LpQQ_inia:
    global_load_dword v6, v5, s[12:13] sc1
    s_add_u32 s16, s16, 1
    s_cmp_gt_u32 s16, 100000
    s_cbranch_scc1 L_role_p_abort
    s_waitcnt vmcnt(0)
    v_cmp_gt_u32 vcc, 72, v6
    s_nop 0
    s_cbranch_vccz LpQQ_inia_d
    s_sleep 8
    s_branch LpQQ_inia
LpQQ_inia_d:
    s_barrier
    s_cmp_eq_u32 s63, 0
    s_cbranch_scc1 LpQQ_ini_sk
    s_cmp_lg_u32 s14, 0
    s_cbranch_scc1 LpQQ_inib_d
    v_mov_b32 v5, 160
    s_mov_b32 s16, 0
LpQQ_inib:
    global_load_dword v6, v5, s[12:13] sc1
    s_add_u32 s16, s16, 1
    s_cmp_gt_u32 s16, 100000
    s_cbranch_scc1 L_role_p_abort
    s_waitcnt vmcnt(0)
    v_cmp_gt_u32 vcc, 64, v6
    s_nop 0
    s_cbranch_vccz LpQQ_inib_d
    s_sleep 8
    s_branch LpQQ_inib
LpQQ_inib_d:
    s_barrier
LpQQ_ini_sk:
    s_mul_i32 s41, s37, 36864
    s_add_u32 s41, s41, s64
    s_mul_i32 s60, s37, 22528
    s_add_u32 s60, s60, s61
    s_cmp_lt_u32 s37, 64
    s_cselect_b32 s60, s60, 2883584
    s_branch LpQQ_wait
LpQQ_head:
    s_waitcnt vmcnt(4)
LpQQ_head2:
    s_barrier
    ds_read_b32 v15, v184
    s_xor_b32 s40, s40, 36864
    s_xor_b32 s59, s59, 36864
    s_mov_b32 s35, s37
    s_lshl_b32 s57, s34, 6
    s_add_u32 s57, s57, s35
    s_add_u32 s37, s37, 1
    s_mov_b32 s39, 0
    s_mov_b32 s54, 0
    s_xor_b32 s66, s66, 8192
    s_xor_b32 s71, s71, 8192
    s_mul_i32 s41, s37, 36864
    s_add_u32 s41, s41, s64
    s_mul_i32 s60, s37, 22528
    s_add_u32 s60, s60, s61
    s_cmp_lt_u32 s37, 64
    s_cselect_b32 s60, s60, 2883584
    v_add_u32 v9, s40, v0
    v_add_u32 v5, s71, v10
    ds_read_b128 v[48:51], v9 offset:0
    ds_read_b128 v[52:55], v9 offset:1024
    ds_read_b128 v[56:59], v9 offset:2048
    ds_read_b128 v[64:67], v5 offset:0
    ds_read_b128 v[68:71], v5 offset:512
    ds_read_b128 v[72:75], v5 offset:1024
    ds_read_b128 v[76:79], v5 offset:1536
    ds_read_b128 v[80:83], v5 offset:2048
    s_waitcnt lgkmcnt(7)
    v_mfma_f32_32x32x16_bf16 v[16:31], a[0:3], v[48:51], 0
    ds_read_b128 v[60:63], v9 offset:3072
    v_mfma_f32_32x32x16_bf16 v[32:47], a[144:147], v[48:51], 0
    s_waitcnt lgkmcnt(4)
    v_add_f32 v64, v64, v68
    v_add_f32 v65, v65, v69
    v_add_f32 v66, v66, v70
    v_add_f32 v67, v67, v71
    v_mfma_f32_32x32x16_bf16 v[16:31], a[4:7], v[52:55], v[16:31]
    ds_read_b128 v[48:51], v9 offset:4096
    s_waitcnt lgkmcnt(4)
    v_add_f32 v64, v64, v72
    v_add_f32 v65, v65, v73
    v_add_f32 v66, v66, v74
    v_mfma_f32_32x32x16_bf16 v[32:47], a[148:151], v[52:55], v[32:47]
    v_add_f32 v67, v67, v75
    s_waitcnt lgkmcnt(3)
    v_add_f32 v64, v64, v76
    v_add_f32 v65, v65, v77
    v_add_f32 v66, v66, v78
    v_readfirstlane_b32 s17, v15
    s_nop 0
    s_add_u32 s18, s17, 1
    s_max_i32 s32, s18, s37
    s_add_u32 s39, s37, 1
    s_min_u32 s39, s39, 63
    s_mul_i32 s33, s32, 22528
    s_add_u32 s33, s33, s61
    s_cmp_eq_u32 s14, 0
    s_cselect_b32 s18, s32, 0x7fff
    v_mov_b32 v2, 2
    s_cmp_le_u32 s18, s39
    s_cselect_b64 exec, -1, 0
    buffer_load_dword v2, v1, s[8:11], s33 offen sc1
    s_mov_b64 exec, -1
    s_cmp_ge_i32 s17, s37
    s_cbranch_scc1 LpQQ_f_1
    v_mfma_f32_32x32x16_bf16 v[16:31], a[8:11], v[56:59], v[16:31]
    ds_read_b128 v[52:55], v9 offset:5120
    v_add_f32 v67, v67, v79
    s_waitcnt lgkmcnt(3)
    v_add_f32 v64, v64, v80
    v_add_f32 v65, v65, v81
    v_mfma_f32_32x32x16_bf16 v[32:47], a[152:155], v[56:59], v[32:47]
    v_add_f32 v66, v66, v82
    v_add_f32 v67, v67, v83
    v_add_f32 v64, v64, v66
    v_add_f32 v65, v65, v67
    s_waitcnt lgkmcnt(2)
    v_mfma_f32_32x32x16_bf16 v[16:31], a[12:15], v[60:63], v[16:31]
    ds_read_b128 v[56:59], v9 offset:6144
    v_mov_b32 v66, v64
    v_mov_b32 v67, v65
    s_nop 0
    v_permlane32_swap_b32 v64, v66
    v_mfma_f32_32x32x16_bf16 v[32:47], a[156:159], v[60:63], v[32:47]
    v_permlane32_swap_b32 v65, v67
    v_add_f32 v64, v64, v66
    v_add_f32 v65, v65, v67
    v_mul_f32 v64, 0x3ae38e39, v64
    s_waitcnt lgkmcnt(2)
    v_mfma_f32_32x32x16_bf16 v[16:31], a[16:19], v[48:51], v[16:31]
    ds_read_b128 v[60:63], v9 offset:7168
    v_mul_f32 v65, 0x3ae38e39, v65
    v_fma_f32 v65, -v64, v64, v65
    v_max_f32 v65, 0, v65
    v_mfma_f32_32x32x16_bf16 v[32:47], a[160:163], v[48:51], v[32:47]
    v_add_f32 v65, 0x3727c5ac, v65
    v_rsq_f32 v148, v65
    s_nop 0
    v_mul_f32 v149, v64, v148
    v_mul_f32 v100, v149, v84
    s_waitcnt lgkmcnt(2)
    v_mfma_f32_32x32x16_bf16 v[16:31], a[20:23], v[52:55], v[16:31]
    ds_read_b128 v[48:51], v9 offset:8192
    v_mul_f32 v101, v149, v85
    v_mul_f32 v102, v149, v86
    v_mul_f32 v103, v149, v87
    v_mfma_f32_32x32x16_bf16 v[32:47], a[164:167], v[52:55], v[32:47]
    v_mul_f32 v104, v149, v88
    v_mul_f32 v105, v149, v89
    v_mul_f32 v106, v149, v90
    v_mul_f32 v107, v149, v91
    s_waitcnt lgkmcnt(2)
    v_mfma_f32_32x32x16_bf16 v[16:31], a[24:27], v[56:59], v[16:31]
    ds_read_b128 v[52:55], v9 offset:9216
    v_mul_f32 v108, v149, v92
    v_mul_f32 v109, v149, v93
    v_mul_f32 v110, v149, v94
    v_mfma_f32_32x32x16_bf16 v[32:47], a[168:171], v[56:59], v[32:47]
    v_mul_f32 v111, v149, v95
    v_mul_f32 v112, v149, v96
    v_mul_f32 v113, v149, v97
    v_mul_f32 v114, v149, v98
    s_waitcnt lgkmcnt(2)
    v_mfma_f32_32x32x16_bf16 v[16:31], a[28:31], v[60:63], v[16:31]
    ds_read_b128 v[56:59], v9 offset:10240
    v_mul_f32 v115, v149, v99
    v_mul_f32 v132, v149, v116
    v_mul_f32 v133, v149, v117
    v_mfma_f32_32x32x16_bf16 v[32:47], a[172:175], v[60:63], v[32:47]
    v_mul_f32 v134, v149, v118
    v_mul_f32 v135, v149, v119
    v_mul_f32 v136, v149, v120
    v_mul_f32 v137, v149, v121
    s_waitcnt lgkmcnt(2)
    v_mfma_f32_32x32x16_bf16 v[16:31], a[32:35], v[48:51], v[16:31]
    ds_read_b128 v[60:63], v9 offset:11264
    v_mul_f32 v138, v149, v122
    v_mul_f32 v139, v149, v123
    v_mul_f32 v140, v149, v124
    v_mfma_f32_32x32x16_bf16 v[32:47], a[176:179], v[48:51], v[32:47]
    v_mul_f32 v141, v149, v125
    v_mul_f32 v142, v149, v126
    v_mul_f32 v143, v149, v127
    v_mul_f32 v144, v149, v128
    s_waitcnt lgkmcnt(2)
    v_mfma_f32_32x32x16_bf16 v[16:31], a[36:39], v[52:55], v[16:31]
    ds_read_b128 v[48:51], v9 offset:12288
    v_mul_f32 v145, v149, v129
    v_mul_f32 v146, v149, v130
    v_mul_f32 v147, v149, v131
    v_mfma_f32_32x32x16_bf16 v[32:47], a[180:183], v[52:55], v[32:47]
    s_mul_i32 s46, s34, 50331648
    s_lshl_b32 s51, s35, 18
    s_add_u32 s46, s46, s51
    s_add_u32 s46, s46, s52
    s_waitcnt lgkmcnt(2)
    v_mfma_f32_32x32x16_bf16 v[16:31], a[40:43], v[56:59], v[16:31]
    ds_read_b128 v[52:55], v9 offset:13312
    v_mfma_f32_32x32x16_bf16 v[32:47], a[184:187], v[56:59], v[32:47]
    s_waitcnt lgkmcnt(2)
    v_mfma_f32_32x32x16_bf16 v[16:31], a[44:47], v[60:63], v[16:31]
    ds_read_b128 v[56:59], v9 offset:14336
    v_mfma_f32_32x32x16_bf16 v[32:47], a[188:191], v[60:63], v[32:47]
    s_waitcnt lgkmcnt(2)
    v_mfma_f32_32x32x16_bf16 v[16:31], a[48:51], v[48:51], v[16:31]
    ds_read_b128 v[60:63], v9 offset:15360
    v_mfma_f32_32x32x16_bf16 v[32:47], a[192:195], v[48:51], v[32:47]
    s_waitcnt vmcnt(1)
    s_cmp_lg_u32 s43, 0
    s_cselect_b64 exec, 3, 0
    buffer_store_dword v3, v185, s[8:11], s43 offen sc1
    s_mov_b64 exec, -1
    s_mov_b32 s43, 0
    s_waitcnt lgkmcnt(2)
    v_mfma_f32_32x32x16_bf16 v[16:31], a[52:55], v[52:55], v[16:31]
    ds_read_b128 v[48:51], v9 offset:16384
    v_mfma_f32_32x32x16_bf16 v[32:47], a[196:199], v[52:55], v[32:47]
    s_waitcnt lgkmcnt(2)
    v_mfma_f32_32x32x16_bf16 v[16:31], a[56:59], v[56:59], v[16:31]
    v_cmp_eq_u32 s[76:77], 1, v2
    v_cmp_eq_u32 vcc, 2, v2
    s_cmp_eq_u64 s[76:77], -1
    s_cselect_b32 s38, 1, 0
    ds_read_b128 v[52:55], v9 offset:17408
    v_mfma_f32_32x32x16_bf16 v[32:47], a[200:203], v[56:59], v[32:47]
    s_cmp_lg_u32 s38, 0
    s_cselect_b64 exec, 1, 0
    v_mov_b32 v15, s32
    ds_write_b32 v184, v15
    v_mov_b32 v2, 2
    s_mov_b64 exec, -1
    s_waitcnt lgkmcnt(3)
    v_mfma_f32_32x32x16_bf16 v[16:31], a[60:63], v[60:63], v[16:31]
    s_add_u32 s32, s32, s38
    s_mul_i32 s38, s38, 22528
    s_add_u32 s33, s33, s38
    ds_read_b128 v[56:59], v9 offset:18432
    v_mfma_f32_32x32x16_bf16 v[32:47], a[204:207], v[60:63], v[32:47]
    s_cmp_eq_u64 vcc, 0
    s_cselect_b32 s38, s32, 0x7fff
    s_waitcnt lgkmcnt(3)
    v_mfma_f32_32x32x16_bf16 v[16:31], a[64:67], v[48:51], v[16:31]
    ds_read_b128 v[60:63], v9 offset:19456
    v_mfma_f32_32x32x16_bf16 v[32:47], a[208:211], v[48:51], v[32:47]
    s_cmp_le_u32 s38, s39
    s_cselect_b64 exec, -1, 0
    v_mov_b32 v2, 2
    buffer_load_dword v2, v1, s[8:11], s33 offen sc1
    s_mov_b64 exec, -1
    ds_read_b32 v15, v184
    s_waitcnt lgkmcnt(4)
    v_mfma_f32_32x32x16_bf16 v[16:31], a[68:71], v[52:55], v[16:31]
    ds_read_b128 v[48:51], v9 offset:20480
    v_mfma_f32_32x32x16_bf16 v[32:47], a[212:215], v[52:55], v[32:47]
    s_waitcnt lgkmcnt(3)
    v_mfma_f32_32x32x16_bf16 v[16:31], a[72:75], v[56:59], v[16:31]
    ds_read_b128 v[52:55], v9 offset:21504
    v_mfma_f32_32x32x16_bf16 v[32:47], a[216:219], v[56:59], v[32:47]
    s_waitcnt lgkmcnt(2)
    v_readfirstlane_b32 s17, v15
    s_nop 0
    s_cmp_ge_i32 s17, s37
    s_cbranch_scc1 LpQQ_f_2
    v_mfma_f32_32x32x16_bf16 v[16:31], a[76:79], v[60:63], v[16:31]
    ds_read_b128 v[56:59], v9 offset:22528
    v_mfma_f32_32x32x16_bf16 v[32:47], a[220:223], v[60:63], v[32:47]
    s_waitcnt lgkmcnt(2)
    v_mfma_f32_32x32x16_bf16 v[16:31], a[80:83], v[48:51], v[16:31]
    ds_read_b128 v[60:63], v9 offset:23552
    v_mfma_f32_32x32x16_bf16 v[32:47], a[224:227], v[48:51], v[32:47]
    s_waitcnt lgkmcnt(2)
    v_mfma_f32_32x32x16_bf16 v[16:31], a[84:87], v[52:55], v[16:31]
    ds_read_b128 v[48:51], v9 offset:24576
    v_mfma_f32_32x32x16_bf16 v[32:47], a[228:231], v[52:55], v[32:47]
    s_waitcnt lgkmcnt(2)
    v_mfma_f32_32x32x16_bf16 v[16:31], a[88:91], v[56:59], v[16:31]
    ds_read_b128 v[52:55], v9 offset:25600
    v_mfma_f32_32x32x16_bf16 v[32:47], a[232:235], v[56:59], v[32:47]
    s_waitcnt lgkmcnt(2)
    v_mfma_f32_32x32x16_bf16 v[16:31], a[92:95], v[60:63], v[16:31]
    ds_read_b128 v[56:59], v9 offset:26624
    v_mfma_f32_32x32x16_bf16 v[32:47], a[236:239], v[60:63], v[32:47]
    s_waitcnt lgkmcnt(2)
    v_mfma_f32_32x32x16_bf16 v[16:31], a[96:99], v[48:51], v[16:31]
    ds_read_b128 v[60:63], v9 offset:27648
    v_mfma_f32_32x32x16_bf16 v[32:47], a[240:243], v[48:51], v[32:47]
    s_waitcnt lgkmcnt(2)
    v_mfma_f32_32x32x16_bf16 v[16:31], a[100:103], v[52:55], v[16:31]
    ds_read_b128 v[48:51], v9 offset:28672
    v_mfma_f32_32x32x16_bf16 v[32:47], a[244:247], v[52:55], v[32:47]
    s_waitcnt lgkmcnt(2)
    v_mfma_f32_32x32x16_bf16 v[16:31], a[104:107], v[56:59], v[16:31]
    ds_read_b128 v[52:55], v9 offset:29696
    v_mfma_f32_32x32x16_bf16 v[32:47], a[248:251], v[56:59], v[32:47]
    s_waitcnt lgkmcnt(2)
    v_mfma_f32_32x32x16_bf16 v[16:31], a[108:111], v[60:63], v[16:31]
    ds_read_b128 v[56:59], v9 offset:30720
    v_mfma_f32_32x32x16_bf16 v[32:47], a[252:255], v[60:63], v[32:47]
    s_waitcnt lgkmcnt(2)
    v_mfma_f32_32x32x16_bf16 v[16:31], a[112:115], v[48:51], v[16:31]
    ds_read_b128 v[60:63], v9 offset:31744
    v_mfma_f32_32x32x16_bf16 v[32:47], v[152:155], v[48:51], v[32:47]
    s_waitcnt lgkmcnt(2)
    v_mfma_f32_32x32x16_bf16 v[16:31], a[116:119], v[52:55], v[16:31]
    ds_read_b128 v[48:51], v9 offset:32768
    v_mfma_f32_32x32x16_bf16 v[32:47], v[156:159], v[52:55], v[32:47]
    s_waitcnt lgkmcnt(2)
    v_mfma_f32_32x32x16_bf16 v[16:31], a[120:123], v[56:59], v[16:31]
    ds_read_b128 v[52:55], v9 offset:33792
    v_mfma_f32_32x32x16_bf16 v[32:47], v[160:163], v[56:59], v[32:47]
    s_waitcnt lgkmcnt(2)
    v_mfma_f32_32x32x16_bf16 v[16:31], a[124:127], v[60:63], v[16:31]
    v_cmp_eq_u32 s[76:77], 1, v2
    v_cmp_eq_u32 vcc, 2, v2
    s_cmp_eq_u64 s[76:77], -1
    s_cselect_b32 s38, 1, 0
    ds_read_b128 v[56:59], v9 offset:34816
    v_mfma_f32_32x32x16_bf16 v[32:47], v[164:167], v[60:63], v[32:47]
    s_cmp_lg_u32 s38, 0
    s_cselect_b64 exec, 1, 0
    v_mov_b32 v15, s32
    ds_write_b32 v184, v15
    v_mov_b32 v2, 2
    s_mov_b64 exec, -1
    s_waitcnt lgkmcnt(3)
    v_mfma_f32_32x32x16_bf16 v[16:31], a[128:131], v[48:51], v[16:31]
    s_add_u32 s32, s32, s38
    s_mul_i32 s38, s38, 22528
    s_add_u32 s33, s33, s38
    ds_read_b128 v[60:63], v9 offset:35840
    v_mfma_f32_32x32x16_bf16 v[32:47], v[168:171], v[48:51], v[32:47]
    s_cmp_eq_u64 vcc, 0
    s_cselect_b32 s38, s32, 0x7fff
    s_waitcnt lgkmcnt(3)
    v_mfma_f32_32x32x16_bf16 v[16:31], a[132:135], v[52:55], v[16:31]
    s_cmp_le_u32 s38, s39
    s_cselect_b64 exec, -1, 0
    v_mov_b32 v2, 2
    buffer_load_dword v2, v1, s[8:11], s33 offen sc1
    s_mov_b64 exec, -1
    v_mfma_f32_32x32x16_bf16 v[32:47], v[172:175], v[52:55], v[32:47]
    s_waitcnt lgkmcnt(2)
    v_mfma_f32_32x32x16_bf16 v[16:31], a[136:139], v[56:59], v[16:31]
    v_mfma_f32_32x32x16_bf16 v[32:47], v[176:179], v[56:59], v[32:47]
    s_waitcnt lgkmcnt(0)
    v_mfma_f32_32x32x16_bf16 v[16:31], a[140:143], v[60:63], v[16:31]
    v_mfma_f32_32x32x16_bf16 v[32:47], v[180:183], v[60:63], v[32:47]
    s_add_u32 s51, s46, 8192
    s_nop 2
    v_pk_fma_f32 v[16:17], v[16:17], v[148:149], v[100:101] op_sel_hi:[1,0,1] neg_lo:[0,0,1] neg_hi:[0,0,1]
    v_pk_fma_f32 v[18:19], v[18:19], v[148:149], v[102:103] op_sel_hi:[1,0,1] neg_lo:[0,0,1] neg_hi:[0,0,1]
    v_pk_fma_f32 v[20:21], v[20:21], v[148:149], v[104:105] op_sel_hi:[1,0,1] neg_lo:[0,0,1] neg_hi:[0,0,1]
    v_pk_fma_f32 v[22:23], v[22:23], v[148:149], v[106:107] op_sel_hi:[1,0,1] neg_lo:[0,0,1] neg_hi:[0,0,1]
    v_pk_fma_f32 v[24:25], v[24:25], v[148:149], v[108:109] op_sel_hi:[1,0,1] neg_lo:[0,0,1] neg_hi:[0,0,1]
    v_pk_fma_f32 v[26:27], v[26:27], v[148:149], v[110:111] op_sel_hi:[1,0,1] neg_lo:[0,0,1] neg_hi:[0,0,1]
    v_pk_fma_f32 v[28:29], v[28:29], v[148:149], v[112:113] op_sel_hi:[1,0,1] neg_lo:[0,0,1] neg_hi:[0,0,1]
    v_pk_fma_f32 v[30:31], v[30:31], v[148:149], v[114:115] op_sel_hi:[1,0,1] neg_lo:[0,0,1] neg_hi:[0,0,1]
    v_cvt_pk_bf16_f32 v188, v16, v24
    v_cvt_pk_bf16_f32 v189, v17, v25
    v_cvt_pk_bf16_f32 v190, v18, v26
    v_cvt_pk_bf16_f32 v191, v19, v27
    buffer_store_dwordx4 v[188:191], v14, s[8:11], s46 offen offset:0 sc1
    v_cvt_pk_bf16_f32 v192, v20, v28
    v_cvt_pk_bf16_f32 v193, v21, v29
    v_cvt_pk_bf16_f32 v194, v22, v30
    v_cvt_pk_bf16_f32 v195, v23, v31
    buffer_store_dwordx4 v[192:195], v14, s[8:11], s46 offen offset:512 sc1
    v_pk_fma_f32 v[32:33], v[32:33], v[148:149], v[132:133] op_sel_hi:[1,0,1] neg_lo:[0,0,1] neg_hi:[0,0,1]
    v_pk_fma_f32 v[34:35], v[34:35], v[148:149], v[134:135] op_sel_hi:[1,0,1] neg_lo:[0,0,1] neg_hi:[0,0,1]
    v_pk_fma_f32 v[36:37], v[36:37], v[148:149], v[136:137] op_sel_hi:[1,0,1] neg_lo:[0,0,1] neg_hi:[0,0,1]
    v_pk_fma_f32 v[38:39], v[38:39], v[148:149], v[138:139] op_sel_hi:[1,0,1] neg_lo:[0,0,1] neg_hi:[0,0,1]
    v_pk_fma_f32 v[40:41], v[40:41], v[148:149], v[140:141] op_sel_hi:[1,0,1] neg_lo:[0,0,1] neg_hi:[0,0,1]
    v_pk_fma_f32 v[42:43], v[42:43], v[148:149], v[142:143] op_sel_hi:[1,0,1] neg_lo:[0,0,1] neg_hi:[0,0,1]
    v_pk_fma_f32 v[44:45], v[44:45], v[148:149], v[144:145] op_sel_hi:[1,0,1] neg_lo:[0,0,1] neg_hi:[0,0,1]
    v_pk_fma_f32 v[46:47], v[46:47], v[148:149], v[146:147] op_sel_hi:[1,0,1] neg_lo:[0,0,1] neg_hi:[0,0,1]
    v_cvt_pk_bf16_f32 v196, v32, v40
    v_cvt_pk_bf16_f32 v197, v33, v41
    v_cvt_pk_bf16_f32 v198, v34, v42
    v_cvt_pk_bf16_f32 v199, v35, v43
    buffer_store_dwordx4 v[196:199], v14, s[8:11], s51 offen offset:0 sc1
    v_cvt_pk_bf16_f32 v200, v36, v44
    v_cvt_pk_bf16_f32 v201, v37, v45
    v_cvt_pk_bf16_f32 v202, v38, v46
    v_cvt_pk_bf16_f32 v203, v39, v47
    buffer_store_dwordx4 v[200:203], v14, s[8:11], s51 offen offset:512 sc1
    s_mul_i32 s43, s57, 22528
    s_add_u32 s43, s43, s49
    s_branch LpQQ_none
LpQQ_f_1:
    v_mfma_f32_32x32x16_bf16 v[16:31], a[8:11], v[56:59], v[16:31]
    ds_read_b128 v[52:55], v9 offset:5120
    v_add_f32 v67, v67, v79
    s_waitcnt lgkmcnt(3)
    v_add_f32 v64, v64, v80
    v_add_f32 v65, v65, v81
    v_mfma_f32_32x32x16_bf16 v[32:47], a[152:155], v[56:59], v[32:47]
    v_add_f32 v66, v66, v82
    v_add_f32 v67, v67, v83
    v_add_f32 v64, v64, v66
    v_add_f32 v65, v65, v67
    s_waitcnt lgkmcnt(2)
    v_mfma_f32_32x32x16_bf16 v[16:31], a[12:15], v[60:63], v[16:31]
    ds_read_b128 v[56:59], v9 offset:6144
    v_mov_b32 v66, v64
    v_mov_b32 v67, v65
    s_nop 0
    v_permlane32_swap_b32 v64, v66
    v_mfma_f32_32x32x16_bf16 v[32:47], a[156:159], v[60:63], v[32:47]
    v_permlane32_swap_b32 v65, v67
    v_add_f32 v64, v64, v66
    v_add_f32 v65, v65, v67
    v_mul_f32 v64, 0x3ae38e39, v64
    s_waitcnt lgkmcnt(2)
    v_mfma_f32_32x32x16_bf16 v[16:31], a[16:19], v[48:51], v[16:31]
    ds_read_b128 v[60:63], v9 offset:7168
    v_mul_f32 v65, 0x3ae38e39, v65
    v_fma_f32 v65, -v64, v64, v65
    v_max_f32 v65, 0, v65
    v_mfma_f32_32x32x16_bf16 v[32:47], a[160:163], v[48:51], v[32:47]
    v_add_f32 v65, 0x3727c5ac, v65
    v_rsq_f32 v148, v65
    s_nop 0
    v_mul_f32 v149, v64, v148
    v_mul_f32 v100, v149, v84
    s_waitcnt lgkmcnt(2)
    v_mfma_f32_32x32x16_bf16 v[16:31], a[20:23], v[52:55], v[16:31]
    ds_read_b128 v[48:51], v9 offset:8192
    v_mul_f32 v101, v149, v85
    v_mul_f32 v102, v149, v86
    v_mul_f32 v103, v149, v87
    v_mfma_f32_32x32x16_bf16 v[32:47], a[164:167], v[52:55], v[32:47]
    v_mul_f32 v104, v149, v88
    v_mul_f32 v105, v149, v89
    v_mul_f32 v106, v149, v90
    v_mul_f32 v107, v149, v91
    s_waitcnt lgkmcnt(2)
    v_mfma_f32_32x32x16_bf16 v[16:31], a[24:27], v[56:59], v[16:31]
    ds_read_b128 v[52:55], v9 offset:9216
    v_mul_f32 v108, v149, v92
    v_mul_f32 v109, v149, v93
    v_mul_f32 v110, v149, v94
    v_mfma_f32_32x32x16_bf16 v[32:47], a[168:171], v[56:59], v[32:47]
    v_mul_f32 v111, v149, v95
    v_mul_f32 v112, v149, v96
    v_mul_f32 v113, v149, v97
    v_mul_f32 v114, v149, v98
    s_waitcnt lgkmcnt(2)
    v_mfma_f32_32x32x16_bf16 v[16:31], a[28:31], v[60:63], v[16:31]
    ds_read_b128 v[56:59], v9 offset:10240
    v_mul_f32 v115, v149, v99
    v_mul_f32 v132, v149, v116
    v_mul_f32 v133, v149, v117
    v_mfma_f32_32x32x16_bf16 v[32:47], a[172:175], v[60:63], v[32:47]
    v_mul_f32 v134, v149, v118
    v_mul_f32 v135, v149, v119
    v_mul_f32 v136, v149, v120
    v_mul_f32 v137, v149, v121
    s_waitcnt lgkmcnt(2)
    v_mfma_f32_32x32x16_bf16 v[16:31], a[32:35], v[48:51], v[16:31]
    ds_read_b128 v[60:63], v9 offset:11264
    v_mul_f32 v138, v149, v122
    v_mul_f32 v139, v149, v123
    v_mul_f32 v140, v149, v124
    v_mfma_f32_32x32x16_bf16 v[32:47], a[176:179], v[48:51], v[32:47]
    v_mul_f32 v141, v149, v125
    v_mul_f32 v142, v149, v126
    v_mul_f32 v143, v149, v127
    v_mul_f32 v144, v149, v128
    s_waitcnt lgkmcnt(2)
    v_mfma_f32_32x32x16_bf16 v[16:31], a[36:39], v[52:55], v[16:31]
    ds_read_b128 v[48:51], v9 offset:12288
    v_mul_f32 v145, v149, v129
    v_mul_f32 v146, v149, v130
    v_mul_f32 v147, v149, v131
    v_mfma_f32_32x32x16_bf16 v[32:47], a[180:183], v[52:55], v[32:47]
    s_mul_i32 s46, s34, 50331648
    s_lshl_b32 s51, s35, 18
    s_add_u32 s46, s46, s51
    s_add_u32 s46, s46, s52
    s_waitcnt lgkmcnt(2)
    v_mfma_f32_32x32x16_bf16 v[16:31], a[40:43], v[56:59], v[16:31]
    s_add_u32 m0, s59, 0
    s_add_u32 s47, s41, 0
    buffer_load_dwordx4 v0, s[8:11], s47 offen offset:0 lds
    buffer_load_dwordx4 v0, s[8:11], s47 offen offset:1024 lds
    ds_read_b128 v[52:55], v9 offset:13312
    v_mfma_f32_32x32x16_bf16 v[32:47], a[184:187], v[56:59], v[32:47]
    buffer_load_dwordx4 v0, s[8:11], s47 offen offset:2048 lds
    buffer_load_dwordx4 v0, s[8:11], s47 offen offset:3072 lds
    s_add_u32 m0, s59, 4096
    s_add_u32 s47, s41, 4096
    buffer_load_dwordx4 v0, s[8:11], s47 offen offset:0 lds
    s_waitcnt lgkmcnt(2)
    v_mfma_f32_32x32x16_bf16 v[16:31], a[44:47], v[60:63], v[16:31]
    buffer_load_dwordx4 v0, s[8:11], s47 offen offset:1024 lds
    buffer_load_dwordx4 v0, s[8:11], s47 offen offset:2048 lds
    buffer_load_dwordx4 v0, s[8:11], s47 offen offset:3072 lds
    ds_read_b128 v[56:59], v9 offset:14336
    v_mfma_f32_32x32x16_bf16 v[32:47], a[188:191], v[60:63], v[32:47]
    s_add_u32 m0, s59, 8192
    s_add_u32 s47, s41, 8192
    buffer_load_dwordx4 v0, s[8:11], s47 offen offset:0 lds
    s_waitcnt lgkmcnt(2)
    v_mfma_f32_32x32x16_bf16 v[16:31], a[48:51], v[48:51], v[16:31]
    s_mul_i32 s48, s36, 786432
    s_mul_i32 s18, s37, 6144
    s_add_u32 s48, s48, s18
    s_add_u32 s48, s48, 16125952
    s_add_u32 m0, s66, 4096
    s_nop 0
    buffer_load_dwordx4 v0, s[8:11], s48 offen lds
    ds_read_b128 v[60:63], v9 offset:15360
    v_mfma_f32_32x32x16_bf16 v[32:47], a[192:195], v[48:51], v[32:47]
    s_add_u32 m0, s66, s67
    s_sub_u32 s48, s48, 4096
    s_add_u32 s48, s48, s67
    buffer_load_dwordx4 v0, s[8:11], s48 offen lds
    s_waitcnt vmcnt(12)
    s_cmp_lg_u32 s43, 0
    s_cselect_b64 exec, 3, 0
    buffer_store_dword v3, v185, s[8:11], s43 offen sc1
    s_mov_b64 exec, -1
    s_mov_b32 s43, 0
    s_waitcnt lgkmcnt(2)
    v_mfma_f32_32x32x16_bf16 v[16:31], a[52:55], v[52:55], v[16:31]
    ds_read_b128 v[48:51], v9 offset:16384
    v_mfma_f32_32x32x16_bf16 v[32:47], a[196:199], v[52:55], v[32:47]
    s_waitcnt lgkmcnt(2)
    v_mfma_f32_32x32x16_bf16 v[16:31], a[56:59], v[56:59], v[16:31]
    v_cmp_eq_u32 s[76:77], 1, v2
    v_cmp_eq_u32 vcc, 2, v2
    s_cmp_eq_u64 s[76:77], -1
    s_cselect_b32 s38, 1, 0
    ds_read_b128 v[52:55], v9 offset:17408
    v_mfma_f32_32x32x16_bf16 v[32:47], a[200:203], v[56:59], v[32:47]
    s_cmp_lg_u32 s38, 0
    s_cselect_b64 exec, 1, 0
    v_mov_b32 v15, s32
    ds_write_b32 v184, v15
    v_mov_b32 v2, 2
    s_mov_b64 exec, -1
    s_waitcnt lgkmcnt(3)
    v_mfma_f32_32x32x16_bf16 v[16:31], a[60:63], v[60:63], v[16:31]
    s_add_u32 s32, s32, s38
    s_mul_i32 s38, s38, 22528
    s_add_u32 s33, s33, s38
    ds_read_b128 v[56:59], v9 offset:18432
    v_mfma_f32_32x32x16_bf16 v[32:47], a[204:207], v[60:63], v[32:47]
    s_cmp_eq_u64 vcc, 0
    s_cselect_b32 s38, s32, 0x7fff
    s_waitcnt lgkmcnt(3)
    v_mfma_f32_32x32x16_bf16 v[16:31], a[64:67], v[48:51], v[16:31]
    ds_read_b128 v[60:63], v9 offset:19456
    v_mfma_f32_32x32x16_bf16 v[32:47], a[208:211], v[48:51], v[32:47]
    s_cmp_le_u32 s38, s39
    s_cselect_b64 exec, -1, 0
    v_mov_b32 v2, 2
    buffer_load_dword v2, v1, s[8:11], s33 offen sc1
    s_mov_b64 exec, -1
    s_waitcnt lgkmcnt(3)
    v_mfma_f32_32x32x16_bf16 v[16:31], a[68:71], v[52:55], v[16:31]
    ds_read_b128 v[48:51], v9 offset:20480
    v_mfma_f32_32x32x16_bf16 v[32:47], a[212:215], v[52:55], v[32:47]
    s_waitcnt lgkmcnt(2)
    v_mfma_f32_32x32x16_bf16 v[16:31], a[72:75], v[56:59], v[16:31]
    ds_read_b128 v[52:55], v9 offset:21504
    v_mfma_f32_32x32x16_bf16 v[32:47], a[216:219], v[56:59], v[32:47]
    s_waitcnt lgkmcnt(2)
    v_mfma_f32_32x32x16_bf16 v[16:31], a[76:79], v[60:63], v[16:31]
    ds_read_b128 v[56:59], v9 offset:22528
    v_mfma_f32_32x32x16_bf16 v[32:47], a[220:223], v[60:63], v[32:47]
    s_waitcnt lgkmcnt(2)
    v_mfma_f32_32x32x16_bf16 v[16:31], a[80:83], v[48:51], v[16:31]
    ds_read_b128 v[60:63], v9 offset:23552
    v_mfma_f32_32x32x16_bf16 v[32:47], a[224:227], v[48:51], v[32:47]
    s_waitcnt lgkmcnt(2)
    v_mfma_f32_32x32x16_bf16 v[16:31], a[84:87], v[52:55], v[16:31]
    ds_read_b128 v[48:51], v9 offset:24576
    v_mfma_f32_32x32x16_bf16 v[32:47], a[228:231], v[52:55], v[32:47]
    s_waitcnt lgkmcnt(2)
    v_mfma_f32_32x32x16_bf16 v[16:31], a[88:91], v[56:59], v[16:31]
    ds_read_b128 v[52:55], v9 offset:25600
    v_mfma_f32_32x32x16_bf16 v[32:47], a[232:235], v[56:59], v[32:47]
    s_waitcnt lgkmcnt(2)
    v_mfma_f32_32x32x16_bf16 v[16:31], a[92:95], v[60:63], v[16:31]
    ds_read_b128 v[56:59], v9 offset:26624
    v_mfma_f32_32x32x16_bf16 v[32:47], a[236:239], v[60:63], v[32:47]
    s_waitcnt lgkmcnt(2)
    v_mfma_f32_32x32x16_bf16 v[16:31], a[96:99], v[48:51], v[16:31]
    ds_read_b128 v[60:63], v9 offset:27648
    v_mfma_f32_32x32x16_bf16 v[32:47], a[240:243], v[48:51], v[32:47]
    s_waitcnt lgkmcnt(2)
    v_mfma_f32_32x32x16_bf16 v[16:31], a[100:103], v[52:55], v[16:31]
    ds_read_b128 v[48:51], v9 offset:28672
    v_mfma_f32_32x32x16_bf16 v[32:47], a[244:247], v[52:55], v[32:47]
    s_waitcnt lgkmcnt(2)
    v_mfma_f32_32x32x16_bf16 v[16:31], a[104:107], v[56:59], v[16:31]
    ds_read_b128 v[52:55], v9 offset:29696
    v_mfma_f32_32x32x16_bf16 v[32:47], a[248:251], v[56:59], v[32:47]
    s_waitcnt lgkmcnt(2)
    v_mfma_f32_32x32x16_bf16 v[16:31], a[108:111], v[60:63], v[16:31]
    ds_read_b128 v[56:59], v9 offset:30720
    v_mfma_f32_32x32x16_bf16 v[32:47], a[252:255], v[60:63], v[32:47]
    s_waitcnt lgkmcnt(2)
    v_mfma_f32_32x32x16_bf16 v[16:31], a[112:115], v[48:51], v[16:31]
    ds_read_b128 v[60:63], v9 offset:31744
    v_mfma_f32_32x32x16_bf16 v[32:47], v[152:155], v[48:51], v[32:47]
    s_waitcnt lgkmcnt(2)
    v_mfma_f32_32x32x16_bf16 v[16:31], a[116:119], v[52:55], v[16:31]
    ds_read_b128 v[48:51], v9 offset:32768
    v_mfma_f32_32x32x16_bf16 v[32:47], v[156:159], v[52:55], v[32:47]
    s_waitcnt lgkmcnt(2)
    v_mfma_f32_32x32x16_bf16 v[16:31], a[120:123], v[56:59], v[16:31]
    ds_read_b128 v[52:55], v9 offset:33792
    v_mfma_f32_32x32x16_bf16 v[32:47], v[160:163], v[56:59], v[32:47]
    s_waitcnt lgkmcnt(2)
    v_mfma_f32_32x32x16_bf16 v[16:31], a[124:127], v[60:63], v[16:31]
    v_cmp_eq_u32 s[76:77], 1, v2
    v_cmp_eq_u32 vcc, 2, v2
    s_cmp_eq_u64 s[76:77], -1
    s_cselect_b32 s38, 1, 0
    ds_read_b128 v[56:59], v9 offset:34816
    v_mfma_f32_32x32x16_bf16 v[32:47], v[164:167], v[60:63], v[32:47]
    s_cmp_lg_u32 s38, 0
    s_cselect_b64 exec, 1, 0
    v_mov_b32 v15, s32
    ds_write_b32 v184, v15
    v_mov_b32 v2, 2
    s_mov_b64 exec, -1
    s_waitcnt lgkmcnt(3)
    v_mfma_f32_32x32x16_bf16 v[16:31], a[128:131], v[48:51], v[16:31]
    s_add_u32 s32, s32, s38
    s_mul_i32 s38, s38, 22528
    s_add_u32 s33, s33, s38
    ds_read_b128 v[60:63], v9 offset:35840
    v_mfma_f32_32x32x16_bf16 v[32:47], v[168:171], v[48:51], v[32:47]
    s_cmp_eq_u64 vcc, 0
    s_cselect_b32 s38, s32, 0x7fff
    s_waitcnt lgkmcnt(3)
    v_mfma_f32_32x32x16_bf16 v[16:31], a[132:135], v[52:55], v[16:31]
    s_cmp_le_u32 s38, s39
    s_cselect_b64 exec, -1, 0
    v_mov_b32 v2, 2
    buffer_load_dword v2, v1, s[8:11], s33 offen sc1
    s_mov_b64 exec, -1
    v_mfma_f32_32x32x16_bf16 v[32:47], v[172:175], v[52:55], v[32:47]
    s_waitcnt lgkmcnt(2)
    v_mfma_f32_32x32x16_bf16 v[16:31], a[136:139], v[56:59], v[16:31]
    v_mfma_f32_32x32x16_bf16 v[32:47], v[176:179], v[56:59], v[32:47]
    s_waitcnt lgkmcnt(0)
    v_mfma_f32_32x32x16_bf16 v[16:31], a[140:143], v[60:63], v[16:31]
    v_mfma_f32_32x32x16_bf16 v[32:47], v[180:183], v[60:63], v[32:47]
    s_add_u32 s51, s46, 8192
    s_nop 2
    v_pk_fma_f32 v[16:17], v[16:17], v[148:149], v[100:101] op_sel_hi:[1,0,1] neg_lo:[0,0,1] neg_hi:[0,0,1]
    v_pk_fma_f32 v[18:19], v[18:19], v[148:149], v[102:103] op_sel_hi:[1,0,1] neg_lo:[0,0,1] neg_hi:[0,0,1]
    v_pk_fma_f32 v[20:21], v[20:21], v[148:149], v[104:105] op_sel_hi:[1,0,1] neg_lo:[0,0,1] neg_hi:[0,0,1]
    v_pk_fma_f32 v[22:23], v[22:23], v[148:149], v[106:107] op_sel_hi:[1,0,1] neg_lo:[0,0,1] neg_hi:[0,0,1]
    v_pk_fma_f32 v[24:25], v[24:25], v[148:149], v[108:109] op_sel_hi:[1,0,1] neg_lo:[0,0,1] neg_hi:[0,0,1]
    v_pk_fma_f32 v[26:27], v[26:27], v[148:149], v[110:111] op_sel_hi:[1,0,1] neg_lo:[0,0,1] neg_hi:[0,0,1]
    v_pk_fma_f32 v[28:29], v[28:29], v[148:149], v[112:113] op_sel_hi:[1,0,1] neg_lo:[0,0,1] neg_hi:[0,0,1]
    v_pk_fma_f32 v[30:31], v[30:31], v[148:149], v[114:115] op_sel_hi:[1,0,1] neg_lo:[0,0,1] neg_hi:[0,0,1]
    v_cvt_pk_bf16_f32 v188, v16, v24
    v_cvt_pk_bf16_f32 v189, v17, v25
    v_cvt_pk_bf16_f32 v190, v18, v26
    v_cvt_pk_bf16_f32 v191, v19, v27
    buffer_store_dwordx4 v[188:191], v14, s[8:11], s46 offen offset:0 sc1
    v_cvt_pk_bf16_f32 v192, v20, v28
    v_cvt_pk_bf16_f32 v193, v21, v29
    v_cvt_pk_bf16_f32 v194, v22, v30
    v_cvt_pk_bf16_f32 v195, v23, v31
    buffer_store_dwordx4 v[192:195], v14, s[8:11], s46 offen offset:512 sc1
    v_pk_fma_f32 v[32:33], v[32:33], v[148:149], v[132:133] op_sel_hi:[1,0,1] neg_lo:[0,0,1] neg_hi:[0,0,1]
    v_pk_fma_f32 v[34:35], v[34:35], v[148:149], v[134:135] op_sel_hi:[1,0,1] neg_lo:[0,0,1] neg_hi:[0,0,1]
    v_pk_fma_f32 v[36:37], v[36:37], v[148:149], v[136:137] op_sel_hi:[1,0,1] neg_lo:[0,0,1] neg_hi:[0,0,1]
    v_pk_fma_f32 v[38:39], v[38:39], v[148:149], v[138:139] op_sel_hi:[1,0,1] neg_lo:[0,0,1] neg_hi:[0,0,1]
    v_pk_fma_f32 v[40:41], v[40:41], v[148:149], v[140:141] op_sel_hi:[1,0,1] neg_lo:[0,0,1] neg_hi:[0,0,1]
    v_pk_fma_f32 v[42:43], v[42:43], v[148:149], v[142:143] op_sel_hi:[1,0,1] neg_lo:[0,0,1] neg_hi:[0,0,1]
    v_pk_fma_f32 v[44:45], v[44:45], v[148:149], v[144:145] op_sel_hi:[1,0,1] neg_lo:[0,0,1] neg_hi:[0,0,1]
    v_pk_fma_f32 v[46:47], v[46:47], v[148:149], v[146:147] op_sel_hi:[1,0,1] neg_lo:[0,0,1] neg_hi:[0,0,1]
    v_cvt_pk_bf16_f32 v196, v32, v40
    v_cvt_pk_bf16_f32 v197, v33, v41
    v_cvt_pk_bf16_f32 v198, v34, v42
    v_cvt_pk_bf16_f32 v199, v35, v43
    buffer_store_dwordx4 v[196:199], v14, s[8:11], s51 offen offset:0 sc1
    v_cvt_pk_bf16_f32 v200, v36, v44
    v_cvt_pk_bf16_f32 v201, v37, v45
    v_cvt_pk_bf16_f32 v202, v38, v46
    v_cvt_pk_bf16_f32 v203, v39, v47
    buffer_store_dwordx4 v[200:203], v14, s[8:11], s51 offen offset:512 sc1
    s_mul_i32 s43, s57, 22528
    s_add_u32 s43, s43, s49
    s_branch LpQQ_head
LpQQ_f_2:
    v_mfma_f32_32x32x16_bf16 v[16:31], a[76:79], v[60:63], v[16:31]
    s_add_u32 m0, s59, 0
    s_add_u32 s47, s41, 0
    buffer_load_dwordx4 v0, s[8:11], s47 offen offset:0 lds
    ds_read_b128 v[56:59], v9 offset:22528
    v_mfma_f32_32x32x16_bf16 v[32:47], a[220:223], v[60:63], v[32:47]
    s_waitcnt lgkmcnt(2)
    v_mfma_f32_32x32x16_bf16 v[16:31], a[80:83], v[48:51], v[16:31]
    buffer_load_dwordx4 v0, s[8:11], s47 offen offset:1024 lds
    ds_read_b128 v[60:63], v9 offset:23552
    v_mfma_f32_32x32x16_bf16 v[32:47], a[224:227], v[48:51], v[32:47]
    s_waitcnt lgkmcnt(2)
    v_mfma_f32_32x32x16_bf16 v[16:31], a[84:87], v[52:55], v[16:31]
    buffer_load_dwordx4 v0, s[8:11], s47 offen offset:2048 lds
    ds_read_b128 v[48:51], v9 offset:24576
    v_mfma_f32_32x32x16_bf16 v[32:47], a[228:231], v[52:55], v[32:47]
    s_waitcnt lgkmcnt(2)
    v_mfma_f32_32x32x16_bf16 v[16:31], a[88:91], v[56:59], v[16:31]
    buffer_load_dwordx4 v0, s[8:11], s47 offen offset:3072 lds
    ds_read_b128 v[52:55], v9 offset:25600
    v_mfma_f32_32x32x16_bf16 v[32:47], a[232:235], v[56:59], v[32:47]
    s_waitcnt lgkmcnt(2)
    v_mfma_f32_32x32x16_bf16 v[16:31], a[92:95], v[60:63], v[16:31]
    s_add_u32 m0, s59, 4096
    s_add_u32 s47, s41, 4096
    buffer_load_dwordx4 v0, s[8:11], s47 offen offset:0 lds
    ds_read_b128 v[56:59], v9 offset:26624
    v_mfma_f32_32x32x16_bf16 v[32:47], a[236:239], v[60:63], v[32:47]
    s_waitcnt lgkmcnt(2)
    v_mfma_f32_32x32x16_bf16 v[16:31], a[96:99], v[48:51], v[16:31]
    buffer_load_dwordx4 v0, s[8:11], s47 offen offset:1024 lds
    ds_read_b128 v[60:63], v9 offset:27648
    v_mfma_f32_32x32x16_bf16 v[32:47], a[240:243], v[48:51], v[32:47]
    s_waitcnt lgkmcnt(2)
    v_mfma_f32_32x32x16_bf16 v[16:31], a[100:103], v[52:55], v[16:31]
    buffer_load_dwordx4 v0, s[8:11], s47 offen offset:2048 lds
    ds_read_b128 v[48:51], v9 offset:28672
    v_mfma_f32_32x32x16_bf16 v[32:47], a[244:247], v[52:55], v[32:47]
    s_waitcnt lgkmcnt(2)
    v_mfma_f32_32x32x16_bf16 v[16:31], a[104:107], v[56:59], v[16:31]
    buffer_load_dwordx4 v0, s[8:11], s47 offen offset:3072 lds
    ds_read_b128 v[52:55], v9 offset:29696
    v_mfma_f32_32x32x16_bf16 v[32:47], a[248:251], v[56:59], v[32:47]
    s_waitcnt lgkmcnt(2)
    v_mfma_f32_32x32x16_bf16 v[16:31], a[108:111], v[60:63], v[16:31]
    s_add_u32 m0, s59, 8192
    s_add_u32 s47, s41, 8192
    buffer_load_dwordx4 v0, s[8:11], s47 offen offset:0 lds
    ds_read_b128 v[56:59], v9 offset:30720
    v_mfma_f32_32x32x16_bf16 v[32:47], a[252:255], v[60:63], v[32:47]
    s_waitcnt lgkmcnt(2)
    v_mfma_f32_32x32x16_bf16 v[16:31], a[112:115], v[48:51], v[16:31]
    s_mul_i32 s48, s36, 786432
    s_mul_i32 s18, s37, 6144
    s_add_u32 s48, s48, s18
    s_add_u32 s48, s48, 16125952
    s_add_u32 m0, s66, 4096
    s_nop 0
    buffer_load_dwordx4 v0, s[8:11], s48 offen lds
    ds_read_b128 v[60:63], v9 offset:31744
    v_mfma_f32_32x32x16_bf16 v[32:47], v[152:155], v[48:51], v[32:47]
    s_waitcnt lgkmcnt(2)
    v_mfma_f32_32x32x16_bf16 v[16:31], a[116:119], v[52:55], v[16:31]
    s_add_u32 m0, s66, s67
    s_sub_u32 s48, s48, 4096
    s_add_u32 s48, s48, s67
    buffer_load_dwordx4 v0, s[8:11], s48 offen lds
    ds_read_b128 v[48:51], v9 offset:32768
    v_mfma_f32_32x32x16_bf16 v[32:47], v[156:159], v[52:55], v[32:47]
    s_waitcnt lgkmcnt(2)
    v_mfma_f32_32x32x16_bf16 v[16:31], a[120:123], v[56:59], v[16:31]
    ds_read_b128 v[52:55], v9 offset:33792
    v_mfma_f32_32x32x16_bf16 v[32:47], v[160:163], v[56:59], v[32:47]
    s_waitcnt lgkmcnt(2)
    v_mfma_f32_32x32x16_bf16 v[16:31], a[124:127], v[60:63], v[16:31]
    v_cmp_eq_u32 s[76:77], 1, v2
    v_cmp_eq_u32 vcc, 2, v2
    s_cmp_eq_u64 s[76:77], -1
    s_cselect_b32 s38, 1, 0
    ds_read_b128 v[56:59], v9 offset:34816
    v_mfma_f32_32x32x16_bf16 v[32:47], v[164:167], v[60:63], v[32:47]
    s_cmp_lg_u32 s38, 0
    s_cselect_b64 exec, 1, 0
    v_mov_b32 v15, s32
    ds_write_b32 v184, v15
    v_mov_b32 v2, 2
    s_mov_b64 exec, -1
    s_waitcnt lgkmcnt(3)
    v_mfma_f32_32x32x16_bf16 v[16:31], a[128:131], v[48:51], v[16:31]
    s_add_u32 s32, s32, s38
    s_mul_i32 s38, s38, 22528
    s_add_u32 s33, s33, s38
    ds_read_b128 v[60:63], v9 offset:35840
    v_mfma_f32_32x32x16_bf16 v[32:47], v[168:171], v[48:51], v[32:47]
    s_cmp_eq_u64 vcc, 0
    s_cselect_b32 s38, s32, 0x7fff
    s_waitcnt lgkmcnt(3)
    v_mfma_f32_32x32x16_bf16 v[16:31], a[132:135], v[52:55], v[16:31]
    s_cmp_le_u32 s38, s39
    s_cselect_b64 exec, -1, 0
    v_mov_b32 v2, 2
    buffer_load_dword v2, v1, s[8:11], s33 offen sc1
    s_mov_b64 exec, -1
    v_mfma_f32_32x32x16_bf16 v[32:47], v[172:175], v[52:55], v[32:47]
    s_waitcnt lgkmcnt(2)
    v_mfma_f32_32x32x16_bf16 v[16:31], a[136:139], v[56:59], v[16:31]
    v_mfma_f32_32x32x16_bf16 v[32:47], v[176:179], v[56:59], v[32:47]
    s_waitcnt lgkmcnt(0)
    v_mfma_f32_32x32x16_bf16 v[16:31], a[140:143], v[60:63], v[16:31]
    v_mfma_f32_32x32x16_bf16 v[32:47], v[180:183], v[60:63], v[32:47]
    s_add_u32 s51, s46, 8192
    s_nop 2
    v_pk_fma_f32 v[16:17], v[16:17], v[148:149], v[100:101] op_sel_hi:[1,0,1] neg_lo:[0,0,1] neg_hi:[0,0,1]
    v_pk_fma_f32 v[18:19], v[18:19], v[148:149], v[102:103] op_sel_hi:[1,0,1] neg_lo:[0,0,1] neg_hi:[0,0,1]
    v_pk_fma_f32 v[20:21], v[20:21], v[148:149], v[104:105] op_sel_hi:[1,0,1] neg_lo:[0,0,1] neg_hi:[0,0,1]
    v_pk_fma_f32 v[22:23], v[22:23], v[148:149], v[106:107] op_sel_hi:[1,0,1] neg_lo:[0,0,1] neg_hi:[0,0,1]
    v_pk_fma_f32 v[24:25], v[24:25], v[148:149], v[108:109] op_sel_hi:[1,0,1] neg_lo:[0,0,1] neg_hi:[0,0,1]
    v_pk_fma_f32 v[26:27], v[26:27], v[148:149], v[110:111] op_sel_hi:[1,0,1] neg_lo:[0,0,1] neg_hi:[0,0,1]
    v_pk_fma_f32 v[28:29], v[28:29], v[148:149], v[112:113] op_sel_hi:[1,0,1] neg_lo:[0,0,1] neg_hi:[0,0,1]
    v_pk_fma_f32 v[30:31], v[30:31], v[148:149], v[114:115] op_sel_hi:[1,0,1] neg_lo:[0,0,1] neg_hi:[0,0,1]
    v_cvt_pk_bf16_f32 v188, v16, v24
    v_cvt_pk_bf16_f32 v189, v17, v25
    v_cvt_pk_bf16_f32 v190, v18, v26
    v_cvt_pk_bf16_f32 v191, v19, v27
    buffer_store_dwordx4 v[188:191], v14, s[8:11], s46 offen offset:0 sc1
    v_cvt_pk_bf16_f32 v192, v20, v28
    v_cvt_pk_bf16_f32 v193, v21, v29
    v_cvt_pk_bf16_f32 v194, v22, v30
    v_cvt_pk_bf16_f32 v195, v23, v31
    buffer_store_dwordx4 v[192:195], v14, s[8:11], s46 offen offset:512 sc1
    v_pk_fma_f32 v[32:33], v[32:33], v[148:149], v[132:133] op_sel_hi:[1,0,1] neg_lo:[0,0,1] neg_hi:[0,0,1]
    v_pk_fma_f32 v[34:35], v[34:35], v[148:149], v[134:135] op_sel_hi:[1,0,1] neg_lo:[0,0,1] neg_hi:[0,0,1]
    v_pk_fma_f32 v[36:37], v[36:37], v[148:149], v[136:137] op_sel_hi:[1,0,1] neg_lo:[0,0,1] neg_hi:[0,0,1]
    v_pk_fma_f32 v[38:39], v[38:39], v[148:149], v[138:139] op_sel_hi:[1,0,1] neg_lo:[0,0,1] neg_hi:[0,0,1]
    v_pk_fma_f32 v[40:41], v[40:41], v[148:149], v[140:141] op_sel_hi:[1,0,1] neg_lo:[0,0,1] neg_hi:[0,0,1]
    v_pk_fma_f32 v[42:43], v[42:43], v[148:149], v[142:143] op_sel_hi:[1,0,1] neg_lo:[0,0,1] neg_hi:[0,0,1]
    v_pk_fma_f32 v[44:45], v[44:45], v[148:149], v[144:145] op_sel_hi:[1,0,1] neg_lo:[0,0,1] neg_hi:[0,0,1]
    v_pk_fma_f32 v[46:47], v[46:47], v[148:149], v[146:147] op_sel_hi:[1,0,1] neg_lo:[0,0,1] neg_hi:[0,0,1]
    v_cvt_pk_bf16_f32 v196, v32, v40
    v_cvt_pk_bf16_f32 v197, v33, v41
    v_cvt_pk_bf16_f32 v198, v34, v42
    v_cvt_pk_bf16_f32 v199, v35, v43
    buffer_store_dwordx4 v[196:199], v14, s[8:11], s51 offen offset:0 sc1
    v_cvt_pk_bf16_f32 v200, v36, v44
    v_cvt_pk_bf16_f32 v201, v37, v45
    v_cvt_pk_bf16_f32 v202, v38, v46
    v_cvt_pk_bf16_f32 v203, v39, v47
    buffer_store_dwordx4 v[200:203], v14, s[8:11], s51 offen offset:512 sc1
    s_mul_i32 s43, s57, 22528
    s_add_u32 s43, s43, s49
    s_branch LpQQ_head
LpQQ_none:
    ds_read_b32 v15, v184
    s_waitcnt lgkmcnt(0)
    v_readfirstlane_b32 s17, v15
    s_nop 0
    s_cmp_lt_i32 s17, s37
    s_cbranch_scc1 LpQQ_nopost
    s_add_u32 m0, s59, 0
    s_add_u32 s47, s41, 0
    buffer_load_dwordx4 v0, s[8:11], s47 offen offset:0 lds
    buffer_load_dwordx4 v0, s[8:11], s47 offen offset:1024 lds
    buffer_load_dwordx4 v0, s[8:11], s47 offen offset:2048 lds
    buffer_load_dwordx4 v0, s[8:11], s47 offen offset:3072 lds
    s_add_u32 m0, s59, 4096
    s_add_u32 s47, s41, 4096
    buffer_load_dwordx4 v0, s[8:11], s47 offen offset:0 lds
    buffer_load_dwordx4 v0, s[8:11], s47 offen offset:1024 lds
    buffer_load_dwordx4 v0, s[8:11], s47 offen offset:2048 lds
    buffer_load_dwordx4 v0, s[8:11], s47 offen offset:3072 lds
    s_add_u32 m0, s59, 8192
    s_add_u32 s47, s41, 8192
    buffer_load_dwordx4 v0, s[8:11], s47 offen offset:0 lds
    s_mul_i32 s48, s36, 786432
    s_mul_i32 s18, s37, 6144
    s_add_u32 s48, s48, s18
    s_add_u32 s48, s48, 16125952
    s_add_u32 m0, s66, 4096
    s_nop 0
    buffer_load_dwordx4 v0, s[8:11], s48 offen lds
    s_add_u32 m0, s66, s67
    s_sub_u32 s48, s48, 4096
    s_add_u32 s48, s48, s67
    buffer_load_dwordx4 v0, s[8:11], s48 offen lds
    s_waitcnt vmcnt(11)
    s_cmp_lg_u32 s43, 0
    s_cselect_b64 exec, 3, 0
    buffer_store_dword v3, v185, s[8:11], s43 offen sc1
    s_mov_b64 exec, -1
    s_mov_b32 s43, 0
    s_waitcnt vmcnt(1) lgkmcnt(0)
    s_branch LpQQ_head2
LpQQ_nopost:
    s_waitcnt vmcnt(0)
    s_cmp_lg_u32 s43, 0
    s_cselect_b64 exec, 3, 0
    buffer_store_dword v3, v185, s[8:11], s43 offen sc1
    s_mov_b64 exec, -1
    s_mov_b32 s43, 0
    s_cmp_ge_u32 s37, 64
    s_cbranch_scc1 LpQQ_end
LpQQ_wait:
    s_mov_b32 s16, 0
    s_cmp_lg_u32 s14, 0
    s_cbranch_scc1 LpQQ_wl
LpQQ_wp:
    buffer_load_dword v2, v1, s[8:11], s60 offen sc1
    s_add_u32 s16, s16, 1
    s_cmp_gt_u32 s16, 100000
    s_cbranch_scc1 LpQQ_giveup
    s_waitcnt vmcnt(0)
    v_cmp_eq_u32 vcc, 0, v2
    s_nop 0
    s_cbranch_vccz LpQQ_wok
    s_sleep 4
    s_branch LpQQ_wp
LpQQ_giveup:
    v_mov_b32 v5, -2
    ds_write_b32 v184, v5
    s_waitcnt lgkmcnt(0)
    s_branch L_role_p_abort
LpQQ_wok:
    v_mov_b32 v5, s37
    ds_write_b32 v184, v5
    s_branch LpQQ_go
LpQQ_wl:
    ds_read_b32 v15, v184
    s_add_u32 s16, s16, 1
    s_cmp_gt_u32 s16, 1600000
    s_cbranch_scc1 L_role_p_abort
    s_waitcnt lgkmcnt(0)
    v_readfirstlane_b32 s17, v15
    s_nop 0
    s_cmp_eq_u32 s17, -2
    s_cbranch_scc1 L_role_p_abort
    s_cmp_ge_i32 s17, s37
    s_cbranch_scc1 LpQQ_go
    s_sleep 1
    s_branch LpQQ_wl
LpQQ_go:
    s_add_u32 m0, s59, 0
    s_add_u32 s47, s41, 0
    buffer_load_dwordx4 v0, s[8:11], s47 offen offset:0 lds
    buffer_load_dwordx4 v0, s[8:11], s47 offen offset:1024 lds
    buffer_load_dwordx4 v0, s[8:11], s47 offen offset:2048 lds
    buffer_load_dwordx4 v0, s[8:11], s47 offen offset:3072 lds
    s_add_u32 m0, s59, 4096
    s_add_u32 s47, s41, 4096
    buffer_load_dwordx4 v0, s[8:11], s47 offen offset:0 lds
    buffer_load_dwordx4 v0, s[8:11], s47 offen offset:1024 lds
    buffer_load_dwordx4 v0, s[8:11], s47 offen offset:2048 lds
    buffer_load_dwordx4 v0, s[8:11], s47 offen offset:3072 lds
    s_add_u32 m0, s59, 8192
    s_add_u32 s47, s41, 8192
    buffer_load_dwordx4 v0, s[8:11], s47 offen offset:0 lds
    s_mul_i32 s48, s36, 786432
    s_mul_i32 s18, s37, 6144
    s_add_u32 s48, s48, s18
    s_add_u32 s48, s48, 16125952
    s_add_u32 m0, s66, 4096
    s_nop 0
    buffer_load_dwordx4 v0, s[8:11], s48 offen lds
    s_add_u32 m0, s66, s67
    s_sub_u32 s48, s48, 4096
    s_add_u32 s48, s48, s67
    buffer_load_dwordx4 v0, s[8:11], s48 offen lds
    s_waitcnt vmcnt(0) lgkmcnt(0)
    s_branch LpQQ_head2
LpQQ_end:
    s_branch L_role_p_exit
Lp2_kv:
    v_mfma_f32_32x32x16_bf16 v[84:99], a[0:3], v[48:51], 0
    v_mfma_f32_32x32x16_bf16 v[32:47], v[48:51], a[144:147], 0
    v_mfma_f32_32x32x16_bf16 v[84:99], a[4:7], v[48:51], v[84:99]
    v_mfma_f32_32x32x16_bf16 v[32:47], v[48:51], a[148:151], v[32:47]
    v_mfma_f32_32x32x16_bf16 v[84:99], a[8:11], v[48:51], v[84:99]
    v_mfma_f32_32x32x16_bf16 v[32:47], v[48:51], a[152:155], v[32:47]
    v_mfma_f32_32x32x16_bf16 v[84:99], a[12:15], v[48:51], v[84:99]
    v_mfma_f32_32x32x16_bf16 v[32:47], v[48:51], a[156:159], v[32:47]
    v_mfma_f32_32x32x16_bf16 v[84:99], a[16:19], v[48:51], v[84:99]
    v_mfma_f32_32x32x16_bf16 v[32:47], v[48:51], a[160:163], v[32:47]
    v_mfma_f32_32x32x16_bf16 v[84:99], a[20:23], v[48:51], v[84:99]
    v_mfma_f32_32x32x16_bf16 v[32:47], v[48:51], a[164:167], v[32:47]
    v_mfma_f32_32x32x16_bf16 v[84:99], a[24:27], v[48:51], v[84:99]
    v_mfma_f32_32x32x16_bf16 v[32:47], v[48:51], a[168:171], v[32:47]
    v_mfma_f32_32x32x16_bf16 v[84:99], a[28:31], v[48:51], v[84:99]
    v_mfma_f32_32x32x16_bf16 v[32:47], v[48:51], a[172:175], v[32:47]
    v_mfma_f32_32x32x16_bf16 v[84:99], a[32:35], v[48:51], v[84:99]
    v_mfma_f32_32x32x16_bf16 v[32:47], v[48:51], a[176:179], v[32:47]
    v_mfma_f32_32x32x16_bf16 v[84:99], a[36:39], v[48:51], v[84:99]
    v_mfma_f32_32x32x16_bf16 v[32:47], v[48:51], a[180:183], v[32:47]
    v_mfma_f32_32x32x16_bf16 v[84:99], a[40:43], v[48:51], v[84:99]
    v_mfma_f32_32x32x16_bf16 v[32:47], v[48:51], a[184:187], v[32:47]
    v_mfma_f32_32x32x16_bf16 v[84:99], a[44:47], v[48:51], v[84:99]
    v_mfma_f32_32x32x16_bf16 v[32:47], v[48:51], a[188:191], v[32:47]
    v_mfma_f32_32x32x16_bf16 v[84:99], a[48:51], v[48:51], v[84:99]
    v_mfma_f32_32x32x16_bf16 v[32:47], v[48:51], a[192:195], v[32:47]
    v_mfma_f32_32x32x16_bf16 v[84:99], a[52:55], v[48:51], v[84:99]
    v_mfma_f32_32x32x16_bf16 v[32:47], v[48:51], a[196:199], v[32:47]
    v_mfma_f32_32x32x16_bf16 v[84:99], a[56:59], v[48:51], v[84:99]
    v_mfma_f32_32x32x16_bf16 v[32:47], v[48:51], a[200:203], v[32:47]
    v_mfma_f32_32x32x16_bf16 v[84:99], a[60:63], v[48:51], v[84:99]
    v_mfma_f32_32x32x16_bf16 v[32:47], v[48:51], a[204:207], v[32:47]
    v_mfma_f32_32x32x16_bf16 v[84:99], a[64:67], v[48:51], v[84:99]
    v_mfma_f32_32x32x16_bf16 v[32:47], v[48:51], a[208:211], v[32:47]
    v_mfma_f32_32x32x16_bf16 v[84:99], a[68:71], v[48:51], v[84:99]
    v_mfma_f32_32x32x16_bf16 v[32:47], v[48:51], a[212:215], v[32:47]
    v_mfma_f32_32x32x16_bf16 v[84:99], a[72:75], v[48:51], v[84:99]
    v_mfma_f32_32x32x16_bf16 v[32:47], v[48:51], a[216:219], v[32:47]
    v_mfma_f32_32x32x16_bf16 v[84:99], a[76:79], v[48:51], v[84:99]
    v_mfma_f32_32x32x16_bf16 v[32:47], v[48:51], a[220:223], v[32:47]
    v_mfma_f32_32x32x16_bf16 v[84:99], a[80:83], v[48:51], v[84:99]
    v_mfma_f32_32x32x16_bf16 v[32:47], v[48:51], a[224:227], v[32:47]
    v_mfma_f32_32x32x16_bf16 v[84:99], a[84:87], v[48:51], v[84:99]
    v_mfma_f32_32x32x16_bf16 v[32:47], v[48:51], a[228:231], v[32:47]
    v_mfma_f32_32x32x16_bf16 v[84:99], a[88:91], v[48:51], v[84:99]
    v_mfma_f32_32x32x16_bf16 v[32:47], v[48:51], a[232:235], v[32:47]
    v_mfma_f32_32x32x16_bf16 v[84:99], a[92:95], v[48:51], v[84:99]
    v_mfma_f32_32x32x16_bf16 v[32:47], v[48:51], a[236:239], v[32:47]
    v_mfma_f32_32x32x16_bf16 v[84:99], a[96:99], v[48:51], v[84:99]
    v_mfma_f32_32x32x16_bf16 v[32:47], v[48:51], a[240:243], v[32:47]
    v_mfma_f32_32x32x16_bf16 v[84:99], a[100:103], v[48:51], v[84:99]
    v_mfma_f32_32x32x16_bf16 v[32:47], v[48:51], a[244:247], v[32:47]
    v_mfma_f32_32x32x16_bf16 v[84:99], a[104:107], v[48:51], v[84:99]
    v_mfma_f32_32x32x16_bf16 v[32:47], v[48:51], a[248:251], v[32:47]
    v_mfma_f32_32x32x16_bf16 v[84:99], a[108:111], v[48:51], v[84:99]
    v_mfma_f32_32x32x16_bf16 v[32:47], v[48:51], a[252:255], v[32:47]
    v_mfma_f32_32x32x16_bf16 v[84:99], a[112:115], v[48:51], v[84:99]
    v_mfma_f32_32x32x16_bf16 v[32:47], v[48:51], v[152:155], v[32:47]
    v_mfma_f32_32x32x16_bf16 v[84:99], a[116:119], v[48:51], v[84:99]
    v_mfma_f32_32x32x16_bf16 v[32:47], v[48:51], v[156:159], v[32:47]
    v_mfma_f32_32x32x16_bf16 v[84:99], a[120:123], v[48:51], v[84:99]
    v_mfma_f32_32x32x16_bf16 v[32:47], v[48:51], v[160:163], v[32:47]
    v_mfma_f32_32x32x16_bf16 v[84:99], a[124:127], v[48:51], v[84:99]
    v_mfma_f32_32x32x16_bf16 v[32:47], v[48:51], v[164:167], v[32:47]
    v_mfma_f32_32x32x16_bf16 v[84:99], a[128:131], v[48:51], v[84:99]
    v_mfma_f32_32x32x16_bf16 v[32:47], v[48:51], v[168:171], v[32:47]
    v_mfma_f32_32x32x16_bf16 v[84:99], a[132:135], v[48:51], v[84:99]
    v_mfma_f32_32x32x16_bf16 v[32:47], v[48:51], v[172:175], v[32:47]
    v_mfma_f32_32x32x16_bf16 v[84:99], a[136:139], v[48:51], v[84:99]
    v_mfma_f32_32x32x16_bf16 v[32:47], v[48:51], v[176:179], v[32:47]
    v_mfma_f32_32x32x16_bf16 v[84:99], a[140:143], v[48:51], v[84:99]
    v_mfma_f32_32x32x16_bf16 v[32:47], v[48:51], v[180:183], v[32:47]
    s_nop 11
    v_mov_b32 v11, v32
    s_mov_b32 s66, 114688
    s_mov_b32 s71, 0x2000
    s_mov_b32 s36, s63
    s_mov_b32 s34, s63
    s_mul_i32 s58, s14, 9216
    s_mul_i32 s64, s63, 4718592
    s_add_u32 s64, s64, s58
    s_add_u32 s64, s64, 8650752
    s_mul_i32 s61, s63, 1441792
    s_add_u32 s61, s61, 3584
    s_mov_b32 s37, 0
    s_mov_b32 s40, 36864
    s_mov_b32 s59, s58
    s_mov_b32 s43, 0
    s_mov_b32 s62, 1
    s_mov_b32 s28, s8
    s_mov_b32 s29, s9
    s_mov_b32 s30, 0
    s_mov_b32 s31, 0x00020000
    v_mov_b32 v184, 74752
    v_mov_b32 v5, -1
    ds_write_b32 v184, v5
    s_waitcnt lgkmcnt(0)
    s_cmp_lg_u32 s14, 0
    s_cbranch_scc1 LpKV_inia_d
    v_mov_b32 v5, 40
    s_mov_b32 s16, 0
LpKV_inia:
    global_load_dword v6, v5, s[12:13] sc1
    s_add_u32 s16, s16, 1
    s_cmp_gt_u32 s16, 100000
    s_cbranch_scc1 L_role_p_abort
    s_waitcnt vmcnt(0)
    v_cmp_gt_u32 vcc, 72, v6
    s_nop 0
    s_cbranch_vccz LpKV_inia_d
    s_sleep 8
    s_branch LpKV_inia
LpKV_inia_d:
    s_barrier
    s_cmp_eq_u32 s63, 0
    s_cbranch_scc1 LpKV_ini_sk
    s_cmp_lg_u32 s14, 0
    s_cbranch_scc1 LpKV_inib_d
    v_mov_b32 v5, 160
    s_mov_b32 s16, 0
LpKV_inib:
    global_load_dword v6, v5, s[12:13] sc1
    s_add_u32 s16, s16, 1
    s_cmp_gt_u32 s16, 100000
    s_cbranch_scc1 L_role_p_abort
    s_waitcnt vmcnt(0)
    v_cmp_gt_u32 vcc, 64, v6
    s_nop 0
    s_cbranch_vccz LpKV_inib_d
    s_sleep 8
    s_branch LpKV_inib
LpKV_inib_d:
    s_barrier
LpKV_ini_sk:
    s_mul_i32 s41, s37, 36864
    s_add_u32 s41, s41, s64
    s_mul_i32 s60, s37, 22528
    s_add_u32 s60, s60, s61
    s_cmp_lt_u32 s37, 64
    s_cselect_b32 s60, s60, 2883584
    s_branch LpKV_wait
LpKV_head:
    s_waitcnt vmcnt(4)
LpKV_head2:
    s_barrier
    ds_read_b32 v15, v184
    s_xor_b32 s40, s40, 36864
    s_xor_b32 s59, s59, 36864
    s_mov_b32 s35, s37
    s_lshl_b32 s57, s34, 6
    s_add_u32 s57, s57, s35
    s_add_u32 s37, s37, 1
    s_mov_b32 s39, 0
    s_mov_b32 s54, 0
    s_xor_b32 s66, s66, 8192
    s_xor_b32 s71, s71, 8192
    s_mul_i32 s41, s37, 36864
    s_add_u32 s41, s41, s64
    s_mul_i32 s60, s37, 22528
    s_add_u32 s60, s60, s61
    s_cmp_lt_u32 s37, 64
    s_cselect_b32 s60, s60, 2883584
    v_add_u32 v9, s40, v0
    v_add_u32 v5, s71, v10
    ds_read_b128 v[48:51], v9 offset:0
    ds_read_b128 v[52:55], v9 offset:1024
    ds_read_b128 v[56:59], v9 offset:2048
    ds_read_b128 v[64:67], v5 offset:0
    ds_read_b128 v[68:71], v5 offset:512
    ds_read_b128 v[72:75], v5 offset:1024
    ds_read_b128 v[76:79], v5 offset:1536
    ds_read_b128 v[80:83], v5 offset:2048
    s_waitcnt lgkmcnt(7)
    v_mfma_f32_32x32x16_bf16 v[16:31], a[0:3], v[48:51], 0
    ds_read_b128 v[60:63], v9 offset:3072
    v_mfma_f32_32x32x16_bf16 v[32:47], v[48:51], a[144:147], 0
    s_waitcnt lgkmcnt(4)
    v_add_f32 v64, v64, v68
    v_add_f32 v65, v65, v69
    v_add_f32 v66, v66, v70
    v_add_f32 v67, v67, v71
    v_mfma_f32_32x32x16_bf16 v[16:31], a[4:7], v[52:55], v[16:31]
    ds_read_b128 v[48:51], v9 offset:4096
    s_waitcnt lgkmcnt(4)
    v_add_f32 v64, v64, v72
    v_add_f32 v65, v65, v73
    v_add_f32 v66, v66, v74
    v_mfma_f32_32x32x16_bf16 v[32:47], v[52:55], a[148:151], v[32:47]
    v_add_f32 v67, v67, v75
    s_waitcnt lgkmcnt(3)
    v_add_f32 v64, v64, v76
    v_add_f32 v65, v65, v77
    v_add_f32 v66, v66, v78
    v_readfirstlane_b32 s17, v15
    s_nop 0
    s_add_u32 s18, s17, 1
    s_max_i32 s32, s18, s37
    s_add_u32 s39, s37, 1
    s_min_u32 s39, s39, 63
    s_mul_i32 s33, s32, 22528
    s_add_u32 s33, s33, s61
    s_cmp_eq_u32 s14, 0
    s_cselect_b32 s18, s32, 0x7fff
    v_mov_b32 v2, 2
    s_cmp_le_u32 s18, s39
    s_cselect_b64 exec, -1, 0
    buffer_load_dword v2, v1, s[8:11], s33 offen sc1
    s_mov_b64 exec, -1
    s_cmp_ge_i32 s17, s37
    s_cbranch_scc1 LpKV_f_3
    v_mfma_f32_32x32x16_bf16 v[16:31], a[8:11], v[56:59], v[16:31]
    ds_read_b128 v[52:55], v9 offset:5120
    v_add_f32 v67, v67, v79
    s_waitcnt lgkmcnt(3)
    v_add_f32 v64, v64, v80
    v_add_f32 v65, v65, v81
    v_mfma_f32_32x32x16_bf16 v[32:47], v[56:59], a[152:155], v[32:47]
    v_add_f32 v66, v66, v82
    v_add_f32 v67, v67, v83
    v_add_f32 v64, v64, v66
    v_add_f32 v65, v65, v67
    s_waitcnt lgkmcnt(2)
    v_mfma_f32_32x32x16_bf16 v[16:31], a[12:15], v[60:63], v[16:31]
    ds_read_b128 v[56:59], v9 offset:6144
    v_mov_b32 v66, v64
    v_mov_b32 v67, v65
    s_nop 0
    v_permlane32_swap_b32 v64, v66
    v_mfma_f32_32x32x16_bf16 v[32:47], v[60:63], a[156:159], v[32:47]
    v_permlane32_swap_b32 v65, v67
    v_add_f32 v64, v64, v66
    v_add_f32 v65, v65, v67
    v_mul_f32 v64, 0x3ae38e39, v64
    s_waitcnt lgkmcnt(2)
    v_mfma_f32_32x32x16_bf16 v[16:31], a[16:19], v[48:51], v[16:31]
    ds_read_b128 v[60:63], v9 offset:7168
    v_mul_f32 v65, 0x3ae38e39, v65
    v_fma_f32 v65, -v64, v64, v65
    v_max_f32 v65, 0, v65
    v_mfma_f32_32x32x16_bf16 v[32:47], v[48:51], a[160:163], v[32:47]
    v_add_f32 v65, 0x3727c5ac, v65
    v_rsq_f32 v148, v65
    s_nop 0
    v_mul_f32 v149, v64, v148
    v_mul_f32 v100, v149, v84
    s_waitcnt lgkmcnt(2)
    v_mfma_f32_32x32x16_bf16 v[16:31], a[20:23], v[52:55], v[16:31]
    ds_read_b128 v[48:51], v9 offset:8192
    v_mul_f32 v101, v149, v85
    v_mul_f32 v102, v149, v86
    v_mul_f32 v103, v149, v87
    v_mfma_f32_32x32x16_bf16 v[32:47], v[52:55], a[164:167], v[32:47]
    v_mul_f32 v104, v149, v88
    v_mul_f32 v105, v149, v89
    v_mul_f32 v106, v149, v90
    v_mul_f32 v107, v149, v91
    s_waitcnt lgkmcnt(2)
    v_mfma_f32_32x32x16_bf16 v[16:31], a[24:27], v[56:59], v[16:31]
    ds_read_b128 v[52:55], v9 offset:9216
    v_mul_f32 v108, v149, v92
    v_mul_f32 v109, v149, v93
    v_mul_f32 v110, v149, v94
    v_mfma_f32_32x32x16_bf16 v[32:47], v[56:59], a[168:171], v[32:47]
    v_mul_f32 v111, v149, v95
    v_mul_f32 v112, v149, v96
    v_mul_f32 v113, v149, v97
    v_mul_f32 v114, v149, v98
    s_waitcnt lgkmcnt(2)
    v_mfma_f32_32x32x16_bf16 v[16:31], a[28:31], v[60:63], v[16:31]
    ds_read_b128 v[56:59], v9 offset:10240
    v_mul_f32 v115, v149, v99
    ds_write2_b32 v12, v148, v149 offset0:0 offset1:32
    ds_read_b128 v[116:119], v13 offset:0
    v_mfma_f32_32x32x16_bf16 v[32:47], v[60:63], a[172:175], v[32:47]
    ds_read_b128 v[120:123], v13 offset:32
    ds_read_b128 v[124:127], v13 offset:64
    ds_read_b128 v[128:131], v13 offset:96
    ds_read_b128 v[132:135], v13 offset:128
    s_waitcnt lgkmcnt(8)
    v_mfma_f32_32x32x16_bf16 v[16:31], a[32:35], v[48:51], v[16:31]
    ds_read_b128 v[60:63], v9 offset:11264
    ds_read_b128 v[136:139], v13 offset:160
    ds_read_b128 v[140:143], v13 offset:192
    ds_read_b128 v[144:147], v13 offset:224
    v_mfma_f32_32x32x16_bf16 v[32:47], v[48:51], a[176:179], v[32:47]
    s_waitcnt lgkmcnt(11)
    v_mfma_f32_32x32x16_bf16 v[16:31], a[36:39], v[52:55], v[16:31]
    ds_read_b128 v[48:51], v9 offset:12288
    v_mfma_f32_32x32x16_bf16 v[32:47], v[52:55], a[180:183], v[32:47]
    s_waitcnt lgkmcnt(5)
    v_mul_f32 v132, v11, v132
    v_mul_f32 v133, v11, v133
    v_mfma_f32_32x32x16_bf16 v[16:31], a[40:43], v[56:59], v[16:31]
    ds_read_b128 v[52:55], v9 offset:13312
    v_mul_f32 v134, v11, v134
    v_mul_f32 v135, v11, v135
    s_waitcnt lgkmcnt(4)
    v_mul_f32 v136, v11, v136
    v_mfma_f32_32x32x16_bf16 v[32:47], v[56:59], a[184:187], v[32:47]
    v_mul_f32 v137, v11, v137
    v_mul_f32 v138, v11, v138
    v_mul_f32 v139, v11, v139
    s_waitcnt lgkmcnt(3)
    v_mul_f32 v140, v11, v140
    v_mfma_f32_32x32x16_bf16 v[16:31], a[44:47], v[60:63], v[16:31]
    ds_read_b128 v[56:59], v9 offset:14336
    v_mul_f32 v141, v11, v141
    v_mul_f32 v142, v11, v142
    v_mul_f32 v143, v11, v143
    v_mfma_f32_32x32x16_bf16 v[32:47], v[60:63], a[188:191], v[32:47]
    s_waitcnt lgkmcnt(3)
    v_mul_f32 v144, v11, v144
    v_mul_f32 v145, v11, v145
    v_mul_f32 v146, v11, v146
    v_mul_f32 v147, v11, v147
    s_waitcnt lgkmcnt(2)
    v_mfma_f32_32x32x16_bf16 v[16:31], a[48:51], v[48:51], v[16:31]
    ds_read_b128 v[60:63], v9 offset:15360
    s_mul_i32 s46, s34, 50331648
    s_lshl_b32 s51, s35, 18
    s_add_u32 s46, s46, s51
    v_mfma_f32_32x32x16_bf16 v[32:47], v[48:51], a[192:195], v[32:47]
    s_add_u32 s46, s46, s52
    s_waitcnt vmcnt(1)
    s_cmp_lg_u32 s43, 0
    s_cselect_b64 exec, 3, 0
    buffer_store_dword v3, v185, s[8:11], s43 offen sc1
    s_mov_b64 exec, -1
    s_mov_b32 s43, 0
    s_waitcnt lgkmcnt(2)
    v_mfma_f32_32x32x16_bf16 v[16:31], a[52:55], v[52:55], v[16:31]
    ds_read_b128 v[48:51], v9 offset:16384
    v_mfma_f32_32x32x16_bf16 v[32:47], v[52:55], a[196:199], v[32:47]
    s_waitcnt lgkmcnt(2)
    v_mfma_f32_32x32x16_bf16 v[16:31], a[56:59], v[56:59], v[16:31]
    v_cmp_eq_u32 s[76:77], 1, v2
    v_cmp_eq_u32 vcc, 2, v2
    s_cmp_eq_u64 s[76:77], -1
    s_cselect_b32 s38, 1, 0
    ds_read_b128 v[52:55], v9 offset:17408
    v_mfma_f32_32x32x16_bf16 v[32:47], v[56:59], a[200:203], v[32:47]
    s_cmp_lg_u32 s38, 0
    s_cselect_b64 exec, 1, 0
    v_mov_b32 v15, s32
    ds_write_b32 v184, v15
    v_mov_b32 v2, 2
    s_mov_b64 exec, -1
    s_waitcnt lgkmcnt(3)
    v_mfma_f32_32x32x16_bf16 v[16:31], a[60:63], v[60:63], v[16:31]
    s_add_u32 s32, s32, s38
    s_mul_i32 s38, s38, 22528
    s_add_u32 s33, s33, s38
    ds_read_b128 v[56:59], v9 offset:18432
    v_mfma_f32_32x32x16_bf16 v[32:47], v[60:63], a[204:207], v[32:47]
    s_cmp_eq_u64 vcc, 0
    s_cselect_b32 s38, s32, 0x7fff
    s_waitcnt lgkmcnt(3)
    v_mfma_f32_32x32x16_bf16 v[16:31], a[64:67], v[48:51], v[16:31]
    ds_read_b128 v[60:63], v9 offset:19456
    v_mfma_f32_32x32x16_bf16 v[32:47], v[48:51], a[208:211], v[32:47]
    s_cmp_le_u32 s38, s39
    s_cselect_b64 exec, -1, 0
    v_mov_b32 v2, 2
    buffer_load_dword v2, v1, s[8:11], s33 offen sc1
    s_mov_b64 exec, -1
    ds_read_b32 v15, v184
    s_waitcnt lgkmcnt(4)
    v_mfma_f32_32x32x16_bf16 v[16:31], a[68:71], v[52:55], v[16:31]
    ds_read_b128 v[48:51], v9 offset:20480
    v_mfma_f32_32x32x16_bf16 v[32:47], v[52:55], a[212:215], v[32:47]
    s_waitcnt lgkmcnt(3)
    v_mfma_f32_32x32x16_bf16 v[16:31], a[72:75], v[56:59], v[16:31]
    ds_read_b128 v[52:55], v9 offset:21504
    v_mfma_f32_32x32x16_bf16 v[32:47], v[56:59], a[216:219], v[32:47]
    s_waitcnt lgkmcnt(2)
    v_readfirstlane_b32 s17, v15
    s_nop 0
    s_cmp_ge_i32 s17, s37
    s_cbranch_scc1 LpKV_f_4
    v_mfma_f32_32x32x16_bf16 v[16:31], a[76:79], v[60:63], v[16:31]
    ds_read_b128 v[56:59], v9 offset:22528
    v_mfma_f32_32x32x16_bf16 v[32:47], v[60:63], a[220:223], v[32:47]
    s_waitcnt lgkmcnt(2)
    v_mfma_f32_32x32x16_bf16 v[16:31], a[80:83], v[48:51], v[16:31]
    ds_read_b128 v[60:63], v9 offset:23552
    v_mfma_f32_32x32x16_bf16 v[32:47], v[48:51], a[224:227], v[32:47]
    s_waitcnt lgkmcnt(2)
    v_mfma_f32_32x32x16_bf16 v[16:31], a[84:87], v[52:55], v[16:31]
    ds_read_b128 v[48:51], v9 offset:24576
    v_mfma_f32_32x32x16_bf16 v[32:47], v[52:55], a[228:231], v[32:47]
    s_waitcnt lgkmcnt(2)
    v_mfma_f32_32x32x16_bf16 v[16:31], a[88:91], v[56:59], v[16:31]
    ds_read_b128 v[52:55], v9 offset:25600
    v_mfma_f32_32x32x16_bf16 v[32:47], v[56:59], a[232:235], v[32:47]
    s_waitcnt lgkmcnt(2)
    v_mfma_f32_32x32x16_bf16 v[16:31], a[92:95], v[60:63], v[16:31]
    ds_read_b128 v[56:59], v9 offset:26624
    v_mfma_f32_32x32x16_bf16 v[32:47], v[60:63], a[236:239], v[32:47]
    s_waitcnt lgkmcnt(2)
    v_mfma_f32_32x32x16_bf16 v[16:31], a[96:99], v[48:51], v[16:31]
    ds_read_b128 v[60:63], v9 offset:27648
    v_mfma_f32_32x32x16_bf16 v[32:47], v[48:51], a[240:243], v[32:47]
    s_waitcnt lgkmcnt(2)
    v_mfma_f32_32x32x16_bf16 v[16:31], a[100:103], v[52:55], v[16:31]
    ds_read_b128 v[48:51], v9 offset:28672
    v_mfma_f32_32x32x16_bf16 v[32:47], v[52:55], a[244:247], v[32:47]
    s_waitcnt lgkmcnt(2)
    v_mfma_f32_32x32x16_bf16 v[16:31], a[104:107], v[56:59], v[16:31]
    ds_read_b128 v[52:55], v9 offset:29696
    v_mfma_f32_32x32x16_bf16 v[32:47], v[56:59], a[248:251], v[32:47]
    s_waitcnt lgkmcnt(2)
    v_mfma_f32_32x32x16_bf16 v[16:31], a[108:111], v[60:63], v[16:31]
    ds_read_b128 v[56:59], v9 offset:30720
    v_mfma_f32_32x32x16_bf16 v[32:47], v[60:63], a[252:255], v[32:47]
    s_waitcnt lgkmcnt(2)
    v_mfma_f32_32x32x16_bf16 v[16:31], a[112:115], v[48:51], v[16:31]
    ds_read_b128 v[60:63], v9 offset:31744
    v_mfma_f32_32x32x16_bf16 v[32:47], v[48:51], v[152:155], v[32:47]
    s_waitcnt lgkmcnt(2)
    v_mfma_f32_32x32x16_bf16 v[16:31], a[116:119], v[52:55], v[16:31]
    ds_read_b128 v[48:51], v9 offset:32768
    v_mfma_f32_32x32x16_bf16 v[32:47], v[52:55], v[156:159], v[32:47]
    s_waitcnt lgkmcnt(2)
    v_mfma_f32_32x32x16_bf16 v[16:31], a[120:123], v[56:59], v[16:31]
    ds_read_b128 v[52:55], v9 offset:33792
    v_mfma_f32_32x32x16_bf16 v[32:47], v[56:59], v[160:163], v[32:47]
    s_waitcnt lgkmcnt(2)
    v_mfma_f32_32x32x16_bf16 v[16:31], a[124:127], v[60:63], v[16:31]
    v_cmp_eq_u32 s[76:77], 1, v2
    v_cmp_eq_u32 vcc, 2, v2
    s_cmp_eq_u64 s[76:77], -1
    s_cselect_b32 s38, 1, 0
    ds_read_b128 v[56:59], v9 offset:34816
    v_mfma_f32_32x32x16_bf16 v[32:47], v[60:63], v[164:167], v[32:47]
    s_cmp_lg_u32 s38, 0
    s_cselect_b64 exec, 1, 0
    v_mov_b32 v15, s32
    ds_write_b32 v184, v15
    v_mov_b32 v2, 2
    s_mov_b64 exec, -1
    s_waitcnt lgkmcnt(3)
    v_mfma_f32_32x32x16_bf16 v[16:31], a[128:131], v[48:51], v[16:31]
    s_add_u32 s32, s32, s38
    s_mul_i32 s38, s38, 22528
    s_add_u32 s33, s33, s38
    ds_read_b128 v[60:63], v9 offset:35840
    v_mfma_f32_32x32x16_bf16 v[32:47], v[48:51], v[168:171], v[32:47]
    s_cmp_eq_u64 vcc, 0
    s_cselect_b32 s38, s32, 0x7fff
    s_waitcnt lgkmcnt(3)
    v_mfma_f32_32x32x16_bf16 v[16:31], a[132:135], v[52:55], v[16:31]
    s_cmp_le_u32 s38, s39
    s_cselect_b64 exec, -1, 0
    v_mov_b32 v2, 2
    buffer_load_dword v2, v1, s[8:11], s33 offen sc1
    s_mov_b64 exec, -1
    v_mfma_f32_32x32x16_bf16 v[32:47], v[52:55], v[172:175], v[32:47]
    s_waitcnt lgkmcnt(2)
    v_mfma_f32_32x32x16_bf16 v[16:31], a[136:139], v[56:59], v[16:31]
    v_mfma_f32_32x32x16_bf16 v[32:47], v[56:59], v[176:179], v[32:47]
    s_waitcnt lgkmcnt(0)
    v_mfma_f32_32x32x16_bf16 v[16:31], a[140:143], v[60:63], v[16:31]
    v_mfma_f32_32x32x16_bf16 v[32:47], v[60:63], v[180:183], v[32:47]
    s_add_u32 s51, s46, 16777216
    s_nop 2
    v_pk_fma_f32 v[16:17], v[16:17], v[148:149], v[100:101] op_sel_hi:[1,0,1] neg_lo:[0,0,1] neg_hi:[0,0,1]
    v_pk_fma_f32 v[18:19], v[18:19], v[148:149], v[102:103] op_sel_hi:[1,0,1] neg_lo:[0,0,1] neg_hi:[0,0,1]
    v_pk_fma_f32 v[20:21], v[20:21], v[148:149], v[104:105] op_sel_hi:[1,0,1] neg_lo:[0,0,1] neg_hi:[0,0,1]
    v_pk_fma_f32 v[22:23], v[22:23], v[148:149], v[106:107] op_sel_hi:[1,0,1] neg_lo:[0,0,1] neg_hi:[0,0,1]
    v_pk_fma_f32 v[24:25], v[24:25], v[148:149], v[108:109] op_sel_hi:[1,0,1] neg_lo:[0,0,1] neg_hi:[0,0,1]
    v_pk_fma_f32 v[26:27], v[26:27], v[148:149], v[110:111] op_sel_hi:[1,0,1] neg_lo:[0,0,1] neg_hi:[0,0,1]
    v_pk_fma_f32 v[28:29], v[28:29], v[148:149], v[112:113] op_sel_hi:[1,0,1] neg_lo:[0,0,1] neg_hi:[0,0,1]
    v_pk_fma_f32 v[30:31], v[30:31], v[148:149], v[114:115] op_sel_hi:[1,0,1] neg_lo:[0,0,1] neg_hi:[0,0,1]
    v_cvt_pk_bf16_f32 v188, v16, v24
    v_cvt_pk_bf16_f32 v189, v17, v25
    v_cvt_pk_bf16_f32 v190, v18, v26
    v_cvt_pk_bf16_f32 v191, v19, v27
    buffer_store_dwordx4 v[188:191], v14, s[8:11], s46 offen offset:0 sc1
    v_cvt_pk_bf16_f32 v192, v20, v28
    v_cvt_pk_bf16_f32 v193, v21, v29
    v_cvt_pk_bf16_f32 v194, v22, v30
    v_cvt_pk_bf16_f32 v195, v23, v31
    buffer_store_dwordx4 v[192:195], v14, s[8:11], s46 offen offset:512 sc1
    v_pk_fma_f32 v[32:33], v[32:33], v[116:117], v[132:133] neg_lo:[0,0,1] neg_hi:[0,0,1]
    v_pk_fma_f32 v[34:35], v[34:35], v[118:119], v[134:135] neg_lo:[0,0,1] neg_hi:[0,0,1]
    v_pk_fma_f32 v[36:37], v[36:37], v[120:121], v[136:137] neg_lo:[0,0,1] neg_hi:[0,0,1]
    v_pk_fma_f32 v[38:39], v[38:39], v[122:123], v[138:139] neg_lo:[0,0,1] neg_hi:[0,0,1]
    v_pk_fma_f32 v[40:41], v[40:41], v[124:125], v[140:141] neg_lo:[0,0,1] neg_hi:[0,0,1]
    v_pk_fma_f32 v[42:43], v[42:43], v[126:127], v[142:143] neg_lo:[0,0,1] neg_hi:[0,0,1]
    v_pk_fma_f32 v[44:45], v[44:45], v[128:129], v[144:145] neg_lo:[0,0,1] neg_hi:[0,0,1]
    v_pk_fma_f32 v[46:47], v[46:47], v[130:131], v[146:147] neg_lo:[0,0,1] neg_hi:[0,0,1]
    v_cvt_pk_bf16_f32 v196, v32, v33
    v_cvt_pk_bf16_f32 v197, v34, v35
    v_cvt_pk_bf16_f32 v198, v40, v41
    v_cvt_pk_bf16_f32 v199, v42, v43
    buffer_store_dwordx4 v[196:199], v14, s[8:11], s51 offen offset:0 sc1
    v_cvt_pk_bf16_f32 v200, v36, v37
    v_cvt_pk_bf16_f32 v201, v38, v39
    v_cvt_pk_bf16_f32 v202, v44, v45
    v_cvt_pk_bf16_f32 v203, v46, v47
    buffer_store_dwordx4 v[200:203], v14, s[8:11], s51 offen offset:512 sc1
    s_mul_i32 s43, s57, 22528
    s_add_u32 s43, s43, s49
    s_branch LpKV_none
LpKV_f_3:
    v_mfma_f32_32x32x16_bf16 v[16:31], a[8:11], v[56:59], v[16:31]
    ds_read_b128 v[52:55], v9 offset:5120
    v_add_f32 v67, v67, v79
    s_waitcnt lgkmcnt(3)
    v_add_f32 v64, v64, v80
    v_add_f32 v65, v65, v81
    v_mfma_f32_32x32x16_bf16 v[32:47], v[56:59], a[152:155], v[32:47]
    v_add_f32 v66, v66, v82
    v_add_f32 v67, v67, v83
    v_add_f32 v64, v64, v66
    v_add_f32 v65, v65, v67
    s_waitcnt lgkmcnt(2)
    v_mfma_f32_32x32x16_bf16 v[16:31], a[12:15], v[60:63], v[16:31]
    ds_read_b128 v[56:59], v9 offset:6144
    v_mov_b32 v66, v64
    v_mov_b32 v67, v65
    s_nop 0
    v_permlane32_swap_b32 v64, v66
    v_mfma_f32_32x32x16_bf16 v[32:47], v[60:63], a[156:159], v[32:47]
    v_permlane32_swap_b32 v65, v67
    v_add_f32 v64, v64, v66
    v_add_f32 v65, v65, v67
    v_mul_f32 v64, 0x3ae38e39, v64
    s_waitcnt lgkmcnt(2)
    v_mfma_f32_32x32x16_bf16 v[16:31], a[16:19], v[48:51], v[16:31]
    ds_read_b128 v[60:63], v9 offset:7168
    v_mul_f32 v65, 0x3ae38e39, v65
    v_fma_f32 v65, -v64, v64, v65
    v_max_f32 v65, 0, v65
    v_mfma_f32_32x32x16_bf16 v[32:47], v[48:51], a[160:163], v[32:47]
    v_add_f32 v65, 0x3727c5ac, v65
    v_rsq_f32 v148, v65
    s_nop 0
    v_mul_f32 v149, v64, v148
    v_mul_f32 v100, v149, v84
    s_waitcnt lgkmcnt(2)
    v_mfma_f32_32x32x16_bf16 v[16:31], a[20:23], v[52:55], v[16:31]
    ds_read_b128 v[48:51], v9 offset:8192
    v_mul_f32 v101, v149, v85
    v_mul_f32 v102, v149, v86
    v_mul_f32 v103, v149, v87
    v_mfma_f32_32x32x16_bf16 v[32:47], v[52:55], a[164:167], v[32:47]
    v_mul_f32 v104, v149, v88
    v_mul_f32 v105, v149, v89
    v_mul_f32 v106, v149, v90
    v_mul_f32 v107, v149, v91
    s_waitcnt lgkmcnt(2)
    v_mfma_f32_32x32x16_bf16 v[16:31], a[24:27], v[56:59], v[16:31]
    ds_read_b128 v[52:55], v9 offset:9216
    v_mul_f32 v108, v149, v92
    v_mul_f32 v109, v149, v93
    v_mul_f32 v110, v149, v94
    v_mfma_f32_32x32x16_bf16 v[32:47], v[56:59], a[168:171], v[32:47]
    v_mul_f32 v111, v149, v95
    v_mul_f32 v112, v149, v96
    v_mul_f32 v113, v149, v97
    v_mul_f32 v114, v149, v98
    s_waitcnt lgkmcnt(2)
    v_mfma_f32_32x32x16_bf16 v[16:31], a[28:31], v[60:63], v[16:31]
    ds_read_b128 v[56:59], v9 offset:10240
    v_mul_f32 v115, v149, v99
    ds_write2_b32 v12, v148, v149 offset0:0 offset1:32
    ds_read_b128 v[116:119], v13 offset:0
    v_mfma_f32_32x32x16_bf16 v[32:47], v[60:63], a[172:175], v[32:47]
    ds_read_b128 v[120:123], v13 offset:32
    ds_read_b128 v[124:127], v13 offset:64
    ds_read_b128 v[128:131], v13 offset:96
    ds_read_b128 v[132:135], v13 offset:128
    s_waitcnt lgkmcnt(8)
    v_mfma_f32_32x32x16_bf16 v[16:31], a[32:35], v[48:51], v[16:31]
    ds_read_b128 v[60:63], v9 offset:11264
    ds_read_b128 v[136:139], v13 offset:160
    ds_read_b128 v[140:143], v13 offset:192
    ds_read_b128 v[144:147], v13 offset:224
    v_mfma_f32_32x32x16_bf16 v[32:47], v[48:51], a[176:179], v[32:47]
    s_add_u32 m0, s59, 0
    s_add_u32 s47, s41, 0
    buffer_load_dwordx4 v0, s[8:11], s47 offen offset:0 lds
    buffer_load_dwordx4 v0, s[8:11], s47 offen offset:1024 lds
    buffer_load_dwordx4 v0, s[8:11], s47 offen offset:2048 lds
    s_waitcnt lgkmcnt(11)
    v_mfma_f32_32x32x16_bf16 v[16:31], a[36:39], v[52:55], v[16:31]
    buffer_load_dwordx4 v0, s[8:11], s47 offen offset:3072 lds
    s_add_u32 m0, s59, 4096
    s_add_u32 s47, s41, 4096
    buffer_load_dwordx4 v0, s[8:11], s47 offen offset:0 lds
    ds_read_b128 v[48:51], v9 offset:12288
    v_mfma_f32_32x32x16_bf16 v[32:47], v[52:55], a[180:183], v[32:47]
    buffer_load_dwordx4 v0, s[8:11], s47 offen offset:1024 lds
    buffer_load_dwordx4 v0, s[8:11], s47 offen offset:2048 lds
    buffer_load_dwordx4 v0, s[8:11], s47 offen offset:3072 lds
    s_waitcnt lgkmcnt(5)
    v_mul_f32 v132, v11, v132
    v_mul_f32 v133, v11, v133
    v_mfma_f32_32x32x16_bf16 v[16:31], a[40:43], v[56:59], v[16:31]
    ds_read_b128 v[52:55], v9 offset:13312
    v_mul_f32 v134, v11, v134
    v_mul_f32 v135, v11, v135
    s_waitcnt lgkmcnt(4)
    v_mul_f32 v136, v11, v136
    v_mfma_f32_32x32x16_bf16 v[32:47], v[56:59], a[184:187], v[32:47]
    v_mul_f32 v137, v11, v137
    v_mul_f32 v138, v11, v138
    v_mul_f32 v139, v11, v139
    s_waitcnt lgkmcnt(3)
    v_mul_f32 v140, v11, v140
    v_mfma_f32_32x32x16_bf16 v[16:31], a[44:47], v[60:63], v[16:31]
    ds_read_b128 v[56:59], v9 offset:14336
    v_mul_f32 v141, v11, v141
    v_mul_f32 v142, v11, v142
    v_mul_f32 v143, v11, v143
    v_mfma_f32_32x32x16_bf16 v[32:47], v[60:63], a[188:191], v[32:47]
    s_waitcnt lgkmcnt(3)
    v_mul_f32 v144, v11, v144
    v_mul_f32 v145, v11, v145
    v_mul_f32 v146, v11, v146
    v_mul_f32 v147, v11, v147
    s_waitcnt lgkmcnt(2)
    v_mfma_f32_32x32x16_bf16 v[16:31], a[48:51], v[48:51], v[16:31]
    ds_read_b128 v[60:63], v9 offset:15360
    s_mul_i32 s46, s34, 50331648
    s_lshl_b32 s51, s35, 18
    s_add_u32 s46, s46, s51
    v_mfma_f32_32x32x16_bf16 v[32:47], v[48:51], a[192:195], v[32:47]
    s_add_u32 m0, s59, 8192
    s_add_u32 s47, s41, 8192
    buffer_load_dwordx4 v0, s[8:11], s47 offen offset:0 lds
    s_add_u32 s46, s46, s52
    s_waitcnt vmcnt(10)
    s_cmp_lg_u32 s43, 0
    s_cselect_b64 exec, 3, 0
    buffer_store_dword v3, v185, s[8:11], s43 offen sc1
    s_mov_b64 exec, -1
    s_mov_b32 s43, 0
    s_waitcnt lgkmcnt(2)
    v_mfma_f32_32x32x16_bf16 v[16:31], a[52:55], v[52:55], v[16:31]
    s_mul_i32 s48, s36, 786432
    s_mul_i32 s18, s37, 6144
    s_add_u32 s48, s48, s18
    s_add_u32 s48, s48, 16125952
    s_add_u32 m0, s66, 4096
    s_nop 0
    buffer_load_dwordx4 v0, s[8:11], s48 offen lds
    ds_read_b128 v[48:51], v9 offset:16384
    v_mfma_f32_32x32x16_bf16 v[32:47], v[52:55], a[196:199], v[32:47]
    s_add_u32 m0, s66, s67
    s_sub_u32 s48, s48, 4096
    s_add_u32 s48, s48, s67
    buffer_load_dwordx4 v0, s[8:11], s48 offen lds
    s_waitcnt lgkmcnt(2)
    v_mfma_f32_32x32x16_bf16 v[16:31], a[56:59], v[56:59], v[16:31]
    v_cmp_eq_u32 s[76:77], 1, v2
    v_cmp_eq_u32 vcc, 2, v2
    s_cmp_eq_u64 s[76:77], -1
    s_cselect_b32 s38, 1, 0
    ds_read_b128 v[52:55], v9 offset:17408
    v_mfma_f32_32x32x16_bf16 v[32:47], v[56:59], a[200:203], v[32:47]
    s_cmp_lg_u32 s38, 0
    s_cselect_b64 exec, 1, 0
    v_mov_b32 v15, s32
    ds_write_b32 v184, v15
    v_mov_b32 v2, 2
    s_mov_b64 exec, -1
    s_waitcnt lgkmcnt(3)
    v_mfma_f32_32x32x16_bf16 v[16:31], a[60:63], v[60:63], v[16:31]
    s_add_u32 s32, s32, s38
    s_mul_i32 s38, s38, 22528
    s_add_u32 s33, s33, s38
    ds_read_b128 v[56:59], v9 offset:18432
    v_mfma_f32_32x32x16_bf16 v[32:47], v[60:63], a[204:207], v[32:47]
    s_cmp_eq_u64 vcc, 0
    s_cselect_b32 s38, s32, 0x7fff
    s_waitcnt lgkmcnt(3)
    v_mfma_f32_32x32x16_bf16 v[16:31], a[64:67], v[48:51], v[16:31]
    ds_read_b128 v[60:63], v9 offset:19456
    v_mfma_f32_32x32x16_bf16 v[32:47], v[48:51], a[208:211], v[32:47]
    s_cmp_le_u32 s38, s39
    s_cselect_b64 exec, -1, 0
    v_mov_b32 v2, 2
    buffer_load_dword v2, v1, s[8:11], s33 offen sc1
    s_mov_b64 exec, -1
    s_waitcnt lgkmcnt(3)
    v_mfma_f32_32x32x16_bf16 v[16:31], a[68:71], v[52:55], v[16:31]
    ds_read_b128 v[48:51], v9 offset:20480
    v_mfma_f32_32x32x16_bf16 v[32:47], v[52:55], a[212:215], v[32:47]
    s_waitcnt lgkmcnt(2)
    v_mfma_f32_32x32x16_bf16 v[16:31], a[72:75], v[56:59], v[16:31]
    ds_read_b128 v[52:55], v9 offset:21504
    v_mfma_f32_32x32x16_bf16 v[32:47], v[56:59], a[216:219], v[32:47]
    s_waitcnt lgkmcnt(2)
    v_mfma_f32_32x32x16_bf16 v[16:31], a[76:79], v[60:63], v[16:31]
    ds_read_b128 v[56:59], v9 offset:22528
    v_mfma_f32_32x32x16_bf16 v[32:47], v[60:63], a[220:223], v[32:47]
    s_waitcnt lgkmcnt(2)
    v_mfma_f32_32x32x16_bf16 v[16:31], a[80:83], v[48:51], v[16:31]
    ds_read_b128 v[60:63], v9 offset:23552
    v_mfma_f32_32x32x16_bf16 v[32:47], v[48:51], a[224:227], v[32:47]
    s_waitcnt lgkmcnt(2)
    v_mfma_f32_32x32x16_bf16 v[16:31], a[84:87], v[52:55], v[16:31]
    ds_read_b128 v[48:51], v9 offset:24576
    v_mfma_f32_32x32x16_bf16 v[32:47], v[52:55], a[228:231], v[32:47]
    s_waitcnt lgkmcnt(2)
    v_mfma_f32_32x32x16_bf16 v[16:31], a[88:91], v[56:59], v[16:31]
    ds_read_b128 v[52:55], v9 offset:25600
    v_mfma_f32_32x32x16_bf16 v[32:47], v[56:59], a[232:235], v[32:47]
    s_waitcnt lgkmcnt(2)
    v_mfma_f32_32x32x16_bf16 v[16:31], a[92:95], v[60:63], v[16:31]
    ds_read_b128 v[56:59], v9 offset:26624
    v_mfma_f32_32x32x16_bf16 v[32:47], v[60:63], a[236:239], v[32:47]
    s_waitcnt lgkmcnt(2)
    v_mfma_f32_32x32x16_bf16 v[16:31], a[96:99], v[48:51], v[16:31]
    ds_read_b128 v[60:63], v9 offset:27648
    v_mfma_f32_32x32x16_bf16 v[32:47], v[48:51], a[240:243], v[32:47]
    s_waitcnt lgkmcnt(2)
    v_mfma_f32_32x32x16_bf16 v[16:31], a[100:103], v[52:55], v[16:31]
    ds_read_b128 v[48:51], v9 offset:28672
    v_mfma_f32_32x32x16_bf16 v[32:47], v[52:55], a[244:247], v[32:47]
    s_waitcnt lgkmcnt(2)
    v_mfma_f32_32x32x16_bf16 v[16:31], a[104:107], v[56:59], v[16:31]
    ds_read_b128 v[52:55], v9 offset:29696
    v_mfma_f32_32x32x16_bf16 v[32:47], v[56:59], a[248:251], v[32:47]
    s_waitcnt lgkmcnt(2)
    v_mfma_f32_32x32x16_bf16 v[16:31], a[108:111], v[60:63], v[16:31]
    ds_read_b128 v[56:59], v9 offset:30720
    v_mfma_f32_32x32x16_bf16 v[32:47], v[60:63], a[252:255], v[32:47]
    s_waitcnt lgkmcnt(2)
    v_mfma_f32_32x32x16_bf16 v[16:31], a[112:115], v[48:51], v[16:31]
    ds_read_b128 v[60:63], v9 offset:31744
    v_mfma_f32_32x32x16_bf16 v[32:47], v[48:51], v[152:155], v[32:47]
    s_waitcnt lgkmcnt(2)
    v_mfma_f32_32x32x16_bf16 v[16:31], a[116:119], v[52:55], v[16:31]
    ds_read_b128 v[48:51], v9 offset:32768
    v_mfma_f32_32x32x16_bf16 v[32:47], v[52:55], v[156:159], v[32:47]
    s_waitcnt lgkmcnt(2)
    v_mfma_f32_32x32x16_bf16 v[16:31], a[120:123], v[56:59], v[16:31]
    ds_read_b128 v[52:55], v9 offset:33792
    v_mfma_f32_32x32x16_bf16 v[32:47], v[56:59], v[160:163], v[32:47]
    s_waitcnt lgkmcnt(2)
    v_mfma_f32_32x32x16_bf16 v[16:31], a[124:127], v[60:63], v[16:31]
    v_cmp_eq_u32 s[76:77], 1, v2
    v_cmp_eq_u32 vcc, 2, v2
    s_cmp_eq_u64 s[76:77], -1
    s_cselect_b32 s38, 1, 0
    ds_read_b128 v[56:59], v9 offset:34816
    v_mfma_f32_32x32x16_bf16 v[32:47], v[60:63], v[164:167], v[32:47]
    s_cmp_lg_u32 s38, 0
    s_cselect_b64 exec, 1, 0
    v_mov_b32 v15, s32
    ds_write_b32 v184, v15
    v_mov_b32 v2, 2
    s_mov_b64 exec, -1
    s_waitcnt lgkmcnt(3)
    v_mfma_f32_32x32x16_bf16 v[16:31], a[128:131], v[48:51], v[16:31]
    s_add_u32 s32, s32, s38
    s_mul_i32 s38, s38, 22528
    s_add_u32 s33, s33, s38
    ds_read_b128 v[60:63], v9 offset:35840
    v_mfma_f32_32x32x16_bf16 v[32:47], v[48:51], v[168:171], v[32:47]
    s_cmp_eq_u64 vcc, 0
    s_cselect_b32 s38, s32, 0x7fff
    s_waitcnt lgkmcnt(3)
    v_mfma_f32_32x32x16_bf16 v[16:31], a[132:135], v[52:55], v[16:31]
    s_cmp_le_u32 s38, s39
    s_cselect_b64 exec, -1, 0
    v_mov_b32 v2, 2
    buffer_load_dword v2, v1, s[8:11], s33 offen sc1
    s_mov_b64 exec, -1
    v_mfma_f32_32x32x16_bf16 v[32:47], v[52:55], v[172:175], v[32:47]
    s_waitcnt lgkmcnt(2)
    v_mfma_f32_32x32x16_bf16 v[16:31], a[136:139], v[56:59], v[16:31]
    v_mfma_f32_32x32x16_bf16 v[32:47], v[56:59], v[176:179], v[32:47]
    s_waitcnt lgkmcnt(0)
    v_mfma_f32_32x32x16_bf16 v[16:31], a[140:143], v[60:63], v[16:31]
    v_mfma_f32_32x32x16_bf16 v[32:47], v[60:63], v[180:183], v[32:47]
    s_add_u32 s51, s46, 16777216
    s_nop 2
    v_pk_fma_f32 v[16:17], v[16:17], v[148:149], v[100:101] op_sel_hi:[1,0,1] neg_lo:[0,0,1] neg_hi:[0,0,1]
    v_pk_fma_f32 v[18:19], v[18:19], v[148:149], v[102:103] op_sel_hi:[1,0,1] neg_lo:[0,0,1] neg_hi:[0,0,1]
    v_pk_fma_f32 v[20:21], v[20:21], v[148:149], v[104:105] op_sel_hi:[1,0,1] neg_lo:[0,0,1] neg_hi:[0,0,1]
    v_pk_fma_f32 v[22:23], v[22:23], v[148:149], v[106:107] op_sel_hi:[1,0,1] neg_lo:[0,0,1] neg_hi:[0,0,1]
    v_pk_fma_f32 v[24:25], v[24:25], v[148:149], v[108:109] op_sel_hi:[1,0,1] neg_lo:[0,0,1] neg_hi:[0,0,1]
    v_pk_fma_f32 v[26:27], v[26:27], v[148:149], v[110:111] op_sel_hi:[1,0,1] neg_lo:[0,0,1] neg_hi:[0,0,1]
    v_pk_fma_f32 v[28:29], v[28:29], v[148:149], v[112:113] op_sel_hi:[1,0,1] neg_lo:[0,0,1] neg_hi:[0,0,1]
    v_pk_fma_f32 v[30:31], v[30:31], v[148:149], v[114:115] op_sel_hi:[1,0,1] neg_lo:[0,0,1] neg_hi:[0,0,1]
    v_cvt_pk_bf16_f32 v188, v16, v24
    v_cvt_pk_bf16_f32 v189, v17, v25
    v_cvt_pk_bf16_f32 v190, v18, v26
    v_cvt_pk_bf16_f32 v191, v19, v27
    buffer_store_dwordx4 v[188:191], v14, s[8:11], s46 offen offset:0 sc1
    v_cvt_pk_bf16_f32 v192, v20, v28
    v_cvt_pk_bf16_f32 v193, v21, v29
    v_cvt_pk_bf16_f32 v194, v22, v30
    v_cvt_pk_bf16_f32 v195, v23, v31
    buffer_store_dwordx4 v[192:195], v14, s[8:11], s46 offen offset:512 sc1
    v_pk_fma_f32 v[32:33], v[32:33], v[116:117], v[132:133] neg_lo:[0,0,1] neg_hi:[0,0,1]
    v_pk_fma_f32 v[34:35], v[34:35], v[118:119], v[134:135] neg_lo:[0,0,1] neg_hi:[0,0,1]
    v_pk_fma_f32 v[36:37], v[36:37], v[120:121], v[136:137] neg_lo:[0,0,1] neg_hi:[0,0,1]
    v_pk_fma_f32 v[38:39], v[38:39], v[122:123], v[138:139] neg_lo:[0,0,1] neg_hi:[0,0,1]
    v_pk_fma_f32 v[40:41], v[40:41], v[124:125], v[140:141] neg_lo:[0,0,1] neg_hi:[0,0,1]
    v_pk_fma_f32 v[42:43], v[42:43], v[126:127], v[142:143] neg_lo:[0,0,1] neg_hi:[0,0,1]
    v_pk_fma_f32 v[44:45], v[44:45], v[128:129], v[144:145] neg_lo:[0,0,1] neg_hi:[0,0,1]
    v_pk_fma_f32 v[46:47], v[46:47], v[130:131], v[146:147] neg_lo:[0,0,1] neg_hi:[0,0,1]
    v_cvt_pk_bf16_f32 v196, v32, v33
    v_cvt_pk_bf16_f32 v197, v34, v35
    v_cvt_pk_bf16_f32 v198, v40, v41
    v_cvt_pk_bf16_f32 v199, v42, v43
    buffer_store_dwordx4 v[196:199], v14, s[8:11], s51 offen offset:0 sc1
    v_cvt_pk_bf16_f32 v200, v36, v37
    v_cvt_pk_bf16_f32 v201, v38, v39
    v_cvt_pk_bf16_f32 v202, v44, v45
    v_cvt_pk_bf16_f32 v203, v46, v47
    buffer_store_dwordx4 v[200:203], v14, s[8:11], s51 offen offset:512 sc1
    s_mul_i32 s43, s57, 22528
    s_add_u32 s43, s43, s49
    s_branch LpKV_head
LpKV_f_4:
    v_mfma_f32_32x32x16_bf16 v[16:31], a[76:79], v[60:63], v[16:31]
    s_add_u32 m0, s59, 0
    s_add_u32 s47, s41, 0
    buffer_load_dwordx4 v0, s[8:11], s47 offen offset:0 lds
    ds_read_b128 v[56:59], v9 offset:22528
    v_mfma_f32_32x32x16_bf16 v[32:47], v[60:63], a[220:223], v[32:47]
    s_waitcnt lgkmcnt(2)
    v_mfma_f32_32x32x16_bf16 v[16:31], a[80:83], v[48:51], v[16:31]
    buffer_load_dwordx4 v0, s[8:11], s47 offen offset:1024 lds
    ds_read_b128 v[60:63], v9 offset:23552
    v_mfma_f32_32x32x16_bf16 v[32:47], v[48:51], a[224:227], v[32:47]
    s_waitcnt lgkmcnt(2)
    v_mfma_f32_32x32x16_bf16 v[16:31], a[84:87], v[52:55], v[16:31]
    buffer_load_dwordx4 v0, s[8:11], s47 offen offset:2048 lds
    ds_read_b128 v[48:51], v9 offset:24576
    v_mfma_f32_32x32x16_bf16 v[32:47], v[52:55], a[228:231], v[32:47]
    s_waitcnt lgkmcnt(2)
    v_mfma_f32_32x32x16_bf16 v[16:31], a[88:91], v[56:59], v[16:31]
    buffer_load_dwordx4 v0, s[8:11], s47 offen offset:3072 lds
    ds_read_b128 v[52:55], v9 offset:25600
    v_mfma_f32_32x32x16_bf16 v[32:47], v[56:59], a[232:235], v[32:47]
    s_waitcnt lgkmcnt(2)
    v_mfma_f32_32x32x16_bf16 v[16:31], a[92:95], v[60:63], v[16:31]
    s_add_u32 m0, s59, 4096
    s_add_u32 s47, s41, 4096
    buffer_load_dwordx4 v0, s[8:11], s47 offen offset:0 lds
    ds_read_b128 v[56:59], v9 offset:26624
    v_mfma_f32_32x32x16_bf16 v[32:47], v[60:63], a[236:239], v[32:47]
    s_waitcnt lgkmcnt(2)
    v_mfma_f32_32x32x16_bf16 v[16:31], a[96:99], v[48:51], v[16:31]
    buffer_load_dwordx4 v0, s[8:11], s47 offen offset:1024 lds
    ds_read_b128 v[60:63], v9 offset:27648
    v_mfma_f32_32x32x16_bf16 v[32:47], v[48:51], a[240:243], v[32:47]
    s_waitcnt lgkmcnt(2)
    v_mfma_f32_32x32x16_bf16 v[16:31], a[100:103], v[52:55], v[16:31]
    buffer_load_dwordx4 v0, s[8:11], s47 offen offset:2048 lds
    ds_read_b128 v[48:51], v9 offset:28672
    v_mfma_f32_32x32x16_bf16 v[32:47], v[52:55], a[244:247], v[32:47]
    s_waitcnt lgkmcnt(2)
    v_mfma_f32_32x32x16_bf16 v[16:31], a[104:107], v[56:59], v[16:31]
    buffer_load_dwordx4 v0, s[8:11], s47 offen offset:3072 lds
    ds_read_b128 v[52:55], v9 offset:29696
    v_mfma_f32_32x32x16_bf16 v[32:47], v[56:59], a[248:251], v[32:47]
    s_waitcnt lgkmcnt(2)
    v_mfma_f32_32x32x16_bf16 v[16:31], a[108:111], v[60:63], v[16:31]
    s_add_u32 m0, s59, 8192
    s_add_u32 s47, s41, 8192
    buffer_load_dwordx4 v0, s[8:11], s47 offen offset:0 lds
    ds_read_b128 v[56:59], v9 offset:30720
    v_mfma_f32_32x32x16_bf16 v[32:47], v[60:63], a[252:255], v[32:47]
    s_waitcnt lgkmcnt(2)
    v_mfma_f32_32x32x16_bf16 v[16:31], a[112:115], v[48:51], v[16:31]
    s_mul_i32 s48, s36, 786432
    s_mul_i32 s18, s37, 6144
    s_add_u32 s48, s48, s18
    s_add_u32 s48, s48, 16125952
    s_add_u32 m0, s66, 4096
    s_nop 0
    buffer_load_dwordx4 v0, s[8:11], s48 offen lds
    ds_read_b128 v[60:63], v9 offset:31744
    v_mfma_f32_32x32x16_bf16 v[32:47], v[48:51], v[152:155], v[32:47]
    s_waitcnt lgkmcnt(2)
    v_mfma_f32_32x32x16_bf16 v[16:31], a[116:119], v[52:55], v[16:31]
    s_add_u32 m0, s66, s67
    s_sub_u32 s48, s48, 4096
    s_add_u32 s48, s48, s67
    buffer_load_dwordx4 v0, s[8:11], s48 offen lds
    ds_read_b128 v[48:51], v9 offset:32768
    v_mfma_f32_32x32x16_bf16 v[32:47], v[52:55], v[156:159], v[32:47]
    s_waitcnt lgkmcnt(2)
    v_mfma_f32_32x32x16_bf16 v[16:31], a[120:123], v[56:59], v[16:31]
    ds_read_b128 v[52:55], v9 offset:33792
    v_mfma_f32_32x32x16_bf16 v[32:47], v[56:59], v[160:163], v[32:47]
    s_waitcnt lgkmcnt(2)
    v_mfma_f32_32x32x16_bf16 v[16:31], a[124:127], v[60:63], v[16:31]
    v_cmp_eq_u32 s[76:77], 1, v2
    v_cmp_eq_u32 vcc, 2, v2
    s_cmp_eq_u64 s[76:77], -1
    s_cselect_b32 s38, 1, 0
    ds_read_b128 v[56:59], v9 offset:34816
    v_mfma_f32_32x32x16_bf16 v[32:47], v[60:63], v[164:167], v[32:47]
    s_cmp_lg_u32 s38, 0
    s_cselect_b64 exec, 1, 0
    v_mov_b32 v15, s32
    ds_write_b32 v184, v15
    v_mov_b32 v2, 2
    s_mov_b64 exec, -1
    s_waitcnt lgkmcnt(3)
    v_mfma_f32_32x32x16_bf16 v[16:31], a[128:131], v[48:51], v[16:31]
    s_add_u32 s32, s32, s38
    s_mul_i32 s38, s38, 22528
    s_add_u32 s33, s33, s38
    ds_read_b128 v[60:63], v9 offset:35840
    v_mfma_f32_32x32x16_bf16 v[32:47], v[48:51], v[168:171], v[32:47]
    s_cmp_eq_u64 vcc, 0
    s_cselect_b32 s38, s32, 0x7fff
    s_waitcnt lgkmcnt(3)
    v_mfma_f32_32x32x16_bf16 v[16:31], a[132:135], v[52:55], v[16:31]
    s_cmp_le_u32 s38, s39
    s_cselect_b64 exec, -1, 0
    v_mov_b32 v2, 2
    buffer_load_dword v2, v1, s[8:11], s33 offen sc1
    s_mov_b64 exec, -1
    v_mfma_f32_32x32x16_bf16 v[32:47], v[52:55], v[172:175], v[32:47]
    s_waitcnt lgkmcnt(2)
    v_mfma_f32_32x32x16_bf16 v[16:31], a[136:139], v[56:59], v[16:31]
    v_mfma_f32_32x32x16_bf16 v[32:47], v[56:59], v[176:179], v[32:47]
    s_waitcnt lgkmcnt(0)
    v_mfma_f32_32x32x16_bf16 v[16:31], a[140:143], v[60:63], v[16:31]
    v_mfma_f32_32x32x16_bf16 v[32:47], v[60:63], v[180:183], v[32:47]
    s_add_u32 s51, s46, 16777216
    s_nop 2
    v_pk_fma_f32 v[16:17], v[16:17], v[148:149], v[100:101] op_sel_hi:[1,0,1] neg_lo:[0,0,1] neg_hi:[0,0,1]
    v_pk_fma_f32 v[18:19], v[18:19], v[148:149], v[102:103] op_sel_hi:[1,0,1] neg_lo:[0,0,1] neg_hi:[0,0,1]
    v_pk_fma_f32 v[20:21], v[20:21], v[148:149], v[104:105] op_sel_hi:[1,0,1] neg_lo:[0,0,1] neg_hi:[0,0,1]
    v_pk_fma_f32 v[22:23], v[22:23], v[148:149], v[106:107] op_sel_hi:[1,0,1] neg_lo:[0,0,1] neg_hi:[0,0,1]
    v_pk_fma_f32 v[24:25], v[24:25], v[148:149], v[108:109] op_sel_hi:[1,0,1] neg_lo:[0,0,1] neg_hi:[0,0,1]
    v_pk_fma_f32 v[26:27], v[26:27], v[148:149], v[110:111] op_sel_hi:[1,0,1] neg_lo:[0,0,1] neg_hi:[0,0,1]
    v_pk_fma_f32 v[28:29], v[28:29], v[148:149], v[112:113] op_sel_hi:[1,0,1] neg_lo:[0,0,1] neg_hi:[0,0,1]
    v_pk_fma_f32 v[30:31], v[30:31], v[148:149], v[114:115] op_sel_hi:[1,0,1] neg_lo:[0,0,1] neg_hi:[0,0,1]
    v_cvt_pk_bf16_f32 v188, v16, v24
    v_cvt_pk_bf16_f32 v189, v17, v25
    v_cvt_pk_bf16_f32 v190, v18, v26
    v_cvt_pk_bf16_f32 v191, v19, v27
    buffer_store_dwordx4 v[188:191], v14, s[8:11], s46 offen offset:0 sc1
    v_cvt_pk_bf16_f32 v192, v20, v28
    v_cvt_pk_bf16_f32 v193, v21, v29
    v_cvt_pk_bf16_f32 v194, v22, v30
    v_cvt_pk_bf16_f32 v195, v23, v31
    buffer_store_dwordx4 v[192:195], v14, s[8:11], s46 offen offset:512 sc1
    v_pk_fma_f32 v[32:33], v[32:33], v[116:117], v[132:133] neg_lo:[0,0,1] neg_hi:[0,0,1]
    v_pk_fma_f32 v[34:35], v[34:35], v[118:119], v[134:135] neg_lo:[0,0,1] neg_hi:[0,0,1]
    v_pk_fma_f32 v[36:37], v[36:37], v[120:121], v[136:137] neg_lo:[0,0,1] neg_hi:[0,0,1]
    v_pk_fma_f32 v[38:39], v[38:39], v[122:123], v[138:139] neg_lo:[0,0,1] neg_hi:[0,0,1]
    v_pk_fma_f32 v[40:41], v[40:41], v[124:125], v[140:141] neg_lo:[0,0,1] neg_hi:[0,0,1]
    v_pk_fma_f32 v[42:43], v[42:43], v[126:127], v[142:143] neg_lo:[0,0,1] neg_hi:[0,0,1]
    v_pk_fma_f32 v[44:45], v[44:45], v[128:129], v[144:145] neg_lo:[0,0,1] neg_hi:[0,0,1]
    v_pk_fma_f32 v[46:47], v[46:47], v[130:131], v[146:147] neg_lo:[0,0,1] neg_hi:[0,0,1]
    v_cvt_pk_bf16_f32 v196, v32, v33
    v_cvt_pk_bf16_f32 v197, v34, v35
    v_cvt_pk_bf16_f32 v198, v40, v41
    v_cvt_pk_bf16_f32 v199, v42, v43
    buffer_store_dwordx4 v[196:199], v14, s[8:11], s51 offen offset:0 sc1
    v_cvt_pk_bf16_f32 v200, v36, v37
    v_cvt_pk_bf16_f32 v201, v38, v39
    v_cvt_pk_bf16_f32 v202, v44, v45
    v_cvt_pk_bf16_f32 v203, v46, v47
    buffer_store_dwordx4 v[200:203], v14, s[8:11], s51 offen offset:512 sc1
    s_mul_i32 s43, s57, 22528
    s_add_u32 s43, s43, s49
    s_branch LpKV_head
LpKV_none:
    ds_read_b32 v15, v184
    s_waitcnt lgkmcnt(0)
    v_readfirstlane_b32 s17, v15
    s_nop 0
    s_cmp_lt_i32 s17, s37
    s_cbranch_scc1 LpKV_nopost
    s_add_u32 m0, s59, 0
    s_add_u32 s47, s41, 0
    buffer_load_dwordx4 v0, s[8:11], s47 offen offset:0 lds
    buffer_load_dwordx4 v0, s[8:11], s47 offen offset:1024 lds
    buffer_load_dwordx4 v0, s[8:11], s47 offen offset:2048 lds
    buffer_load_dwordx4 v0, s[8:11], s47 offen offset:3072 lds
    s_add_u32 m0, s59, 4096
    s_add_u32 s47, s41, 4096
    buffer_load_dwordx4 v0, s[8:11], s47 offen offset:0 lds
    buffer_load_dwordx4 v0, s[8:11], s47 offen offset:1024 lds
    buffer_load_dwordx4 v0, s[8:11], s47 offen offset:2048 lds
    buffer_load_dwordx4 v0, s[8:11], s47 offen offset:3072 lds
    s_add_u32 m0, s59, 8192
    s_add_u32 s47, s41, 8192
    buffer_load_dwordx4 v0, s[8:11], s47 offen offset:0 lds
    s_mul_i32 s48, s36, 786432
    s_mul_i32 s18, s37, 6144
    s_add_u32 s48, s48, s18
    s_add_u32 s48, s48, 16125952
    s_add_u32 m0, s66, 4096
    s_nop 0
    buffer_load_dwordx4 v0, s[8:11], s48 offen lds
    s_add_u32 m0, s66, s67
    s_sub_u32 s48, s48, 4096
    s_add_u32 s48, s48, s67
    buffer_load_dwordx4 v0, s[8:11], s48 offen lds
    s_waitcnt vmcnt(11)
    s_cmp_lg_u32 s43, 0
    s_cselect_b64 exec, 3, 0
    buffer_store_dword v3, v185, s[8:11], s43 offen sc1
    s_mov_b64 exec, -1
    s_mov_b32 s43, 0
    s_waitcnt vmcnt(1) lgkmcnt(0)
    s_branch LpKV_head2
LpKV_nopost:
    s_waitcnt vmcnt(0)
    s_cmp_lg_u32 s43, 0
    s_cselect_b64 exec, 3, 0
    buffer_store_dword v3, v185, s[8:11], s43 offen sc1
    s_mov_b64 exec, -1
    s_mov_b32 s43, 0
    s_cmp_ge_u32 s37, 64
    s_cbranch_scc1 LpKV_end
LpKV_wait:
    s_mov_b32 s16, 0
    s_cmp_lg_u32 s14, 0
    s_cbranch_scc1 LpKV_wl
LpKV_wp:
    buffer_load_dword v2, v1, s[8:11], s60 offen sc1
    s_add_u32 s16, s16, 1
    s_cmp_gt_u32 s16, 100000
    s_cbranch_scc1 LpKV_giveup
    s_waitcnt vmcnt(0)
    v_cmp_eq_u32 vcc, 0, v2
    s_nop 0
    s_cbranch_vccz LpKV_wok
    s_sleep 4
    s_branch LpKV_wp
LpKV_giveup:
    v_mov_b32 v5, -2
    ds_write_b32 v184, v5
    s_waitcnt lgkmcnt(0)
    s_branch L_role_p_abort
LpKV_wok:
    v_mov_b32 v5, s37
    ds_write_b32 v184, v5
    s_branch LpKV_go
LpKV_wl:
    ds_read_b32 v15, v184
    s_add_u32 s16, s16, 1
    s_cmp_gt_u32 s16, 1600000
    s_cbranch_scc1 L_role_p_abort
    s_waitcnt lgkmcnt(0)
    v_readfirstlane_b32 s17, v15
    s_nop 0
    s_cmp_eq_u32 s17, -2
    s_cbranch_scc1 L_role_p_abort
    s_cmp_ge_i32 s17, s37
    s_cbranch_scc1 LpKV_go
    s_sleep 1
    s_branch LpKV_wl
LpKV_go:
    s_add_u32 m0, s59, 0
    s_add_u32 s47, s41, 0
    buffer_load_dwordx4 v0, s[8:11], s47 offen offset:0 lds
    buffer_load_dwordx4 v0, s[8:11], s47 offen offset:1024 lds
    buffer_load_dwordx4 v0, s[8:11], s47 offen offset:2048 lds
    buffer_load_dwordx4 v0, s[8:11], s47 offen offset:3072 lds
    s_add_u32 m0, s59, 4096
    s_add_u32 s47, s41, 4096
    buffer_load_dwordx4 v0, s[8:11], s47 offen offset:0 lds
    buffer_load_dwordx4 v0, s[8:11], s47 offen offset:1024 lds
    buffer_load_dwordx4 v0, s[8:11], s47 offen offset:2048 lds
    buffer_load_dwordx4 v0, s[8:11], s47 offen offset:3072 lds
    s_add_u32 m0, s59, 8192
    s_add_u32 s47, s41, 8192
    buffer_load_dwordx4 v0, s[8:11], s47 offen offset:0 lds
    s_mul_i32 s48, s36, 786432
    s_mul_i32 s18, s37, 6144
    s_add_u32 s48, s48, s18
    s_add_u32 s48, s48, 16125952
    s_add_u32 m0, s66, 4096
    s_nop 0
    buffer_load_dwordx4 v0, s[8:11], s48 offen lds
    s_add_u32 m0, s66, s67
    s_sub_u32 s48, s48, 4096
    s_add_u32 s48, s48, s67
    buffer_load_dwordx4 v0, s[8:11], s48 offen lds
    s_waitcnt vmcnt(0) lgkmcnt(0)
    s_branch LpKV_head2
LpKV_end:
    s_branch L_role_p_exit
L_role_p_abort:
    s_waitcnt lgkmcnt(0)
    s_mov_b64 exec, -1
    v_mov_b32 v0, 60
    s_lshl_b32 s5, s3, 8
    s_or_b32 s5, s5, s4
    s_or_b32 s5, s5, 0x10000
    v_mov_b32 v1, s5
    global_store_dword v0, v1, s[12:13]
    s_endpgm
L_role_p_exit:
    s_endpgm
.p2align 6
L_role_awo:
    v_and_b32 v5, 63, v0
    v_lshlrev_b32 v0, 4, v5
    v_and_b32 v7, 15, v5
    v_lshrrev_b32 v8, 4, v5
    v_min_u32 v1, 63, v5
    v_lshrrev_b32 v6, 2, v1
    v_and_b32 v1, 3, v1
    v_lshlrev_b32 v1, 2, v1
    v_lshl_add_u32 v1, v6, 7, v1
    v_mov_b32 v3, 1
    v_mov_b32 v4, 0
    s_mov_b32 s44, 0x05040100
    s_mov_b32 s45, 0x07060302
    s_load_dwordx2 s[20:21], s[0:1], 16
    s_mov_b32 s22, 663552
    s_mov_b32 s23, 0x00020000
    s_waitcnt lgkmcnt(0)
    s_and_b32 s21, s21, 0xffff
    s_cmp_ge_u32 s15, 3
    s_cselect_b32 s63, 1, 0
    s_cselect_b32 s17, 3, 0
    s_sub_u32 s15, s15, s17
    s_mul_i32 s50, s15, 6
    s_lshl_b32 s17, s14, 1
    s_add_u32 s18, s14, 2
    s_cmp_lt_u32 s14, 2
    s_cselect_b32 s17, s17, s18
    s_cselect_b32 s18, 1, 0
    s_add_u32 s50, s50, s17
    s_add_u32 s51, s50, s18
    s_cmp_eq_u32 s63, 0
    s_cbranch_scc1 Lao_gate_ng
    s_cmp_lg_u32 s14, 0
    s_cbranch_scc1 Lao_gate_d
    v_mov_b32 v5, 48
    s_mov_b32 s16, 0
Lao_gate:
    global_load_dword v6, v5, s[12:13] sc1
    s_add_u32 s16, s16, 1
    s_cmp_gt_u32 s16, 100000
    s_cbranch_scc1 L_role_awo_abort
    s_waitcnt vmcnt(0)
    v_cmp_gt_u32 vcc, 32, v6
    s_nop 0
    s_cbranch_vccz Lao_gate_d
    s_sleep 100
    s_branch Lao_gate
Lao_gate_d:
    s_barrier
Lao_gate_ng:
    v_lshrrev_b32 v5, 6, v0
    v_and_b32 v6, 0x30, v0
    v_mul_u32_u24 v16, 1152, v5
    v_add_u32 v16, v16, v6
    v_lshrrev_b32 v17, 1, v5
    v_mul_u32_u24 v17, 18, v17
    v_and_b32 v5, 1, v5
    v_add_u32 v17, v17, v5
    v_add_u32 v17, 16, v17
    v_mul_u32_u24 v17, 1152, v17
    v_add_u32 v17, v17, v6
    v_lshrrev_b32 v5, 2, v7
    v_lshrrev_b32 v6, 1, v8
    v_lshl_add_u32 v5, v6, 3, v5
    v_lshlrev_b32 v18, 6, v5
    v_and_b32 v5, 1, v7
    v_lshl_add_u32 v18, v5, 4, v18
    v_and_b32 v5, 1, v8
    v_lshl_add_u32 v18, v5, 5, v18
    v_bfe_u32 v5, v7, 1, 1
    v_lshl_add_u32 v18, v5, 3, v18
    s_lshl_b32 s46, s14, 15
    v_add_u32 v18, s46, v18
    s_lshl_b32 s49, s50, 6
    s_lshl_b32 s52, s51, 6
    s_add_u32 m0, s46, 0
    s_add_u32 s17, s49, 0
    buffer_load_dwordx4 v16, s[20:23], s17 offen lds
    s_add_u32 m0, s46, 1024
    s_add_u32 s17, s49, 20736
    buffer_load_dwordx4 v16, s[20:23], s17 offen lds
    s_add_u32 m0, s46, 2048
    s_add_u32 s17, s49, 41472
    buffer_load_dwordx4 v16, s[20:23], s17 offen lds
    s_add_u32 m0, s46, 3072
    s_add_u32 s17, s49, 62208
    buffer_load_dwordx4 v16, s[20:23], s17 offen lds
    s_add_u32 m0, s46, 4096
    s_add_u32 s17, s49, 82944
    buffer_load_dwordx4 v16, s[20:23], s17 offen lds
    s_add_u32 m0, s46, 5120
    s_add_u32 s17, s49, 103680
    buffer_load_dwordx4 v16, s[20:23], s17 offen lds
    s_add_u32 m0, s46, 6144
    s_add_u32 s17, s49, 124416
    buffer_load_dwordx4 v16, s[20:23], s17 offen lds
    s_add_u32 m0, s46, 7168
    s_add_u32 s17, s49, 145152
    buffer_load_dwordx4 v16, s[20:23], s17 offen lds
    s_add_u32 m0, s46, 8192
    s_add_u32 s17, s49, 165888
    buffer_load_dwordx4 v16, s[20:23], s17 offen lds
    s_add_u32 m0, s46, 9216
    s_add_u32 s17, s49, 186624
    buffer_load_dwordx4 v16, s[20:23], s17 offen lds
    s_add_u32 m0, s46, 10240
    s_add_u32 s17, s49, 207360
    buffer_load_dwordx4 v16, s[20:23], s17 offen lds
    s_add_u32 m0, s46, 11264
    s_add_u32 s17, s49, 228096
    buffer_load_dwordx4 v16, s[20:23], s17 offen lds
    s_add_u32 m0, s46, 12288
    s_add_u32 s17, s49, 248832
    buffer_load_dwordx4 v16, s[20:23], s17 offen lds
    s_add_u32 m0, s46, 13312
    s_add_u32 s17, s49, 269568
    buffer_load_dwordx4 v16, s[20:23], s17 offen lds
    s_add_u32 m0, s46, 14336
    s_add_u32 s17, s49, 290304
    buffer_load_dwordx4 v16, s[20:23], s17 offen lds
    s_add_u32 m0, s46, 15360
    s_add_u32 s17, s49, 311040
    buffer_load_dwordx4 v16, s[20:23], s17 offen lds
    s_add_u32 m0, s46, 16384
    s_add_u32 s17, s49, 331776
    buffer_load_dwordx4 v16, s[20:23], s17 offen lds
    s_add_u32 m0, s46, 17408
    s_add_u32 s17, s49, 352512
    buffer_load_dwordx4 v16, s[20:23], s17 offen lds
    s_add_u32 m0, s46, 18432
    s_add_u32 s17, s49, 373248
    buffer_load_dwordx4 v16, s[20:23], s17 offen lds
    s_add_u32 m0, s46, 19456
    s_add_u32 s17, s49, 393984
    buffer_load_dwordx4 v16, s[20:23], s17 offen lds
    s_add_u32 m0, s46, 20480
    s_add_u32 s17, s49, 414720
    buffer_load_dwordx4 v16, s[20:23], s17 offen lds
    s_add_u32 m0, s46, 21504
    s_add_u32 s17, s49, 435456
    buffer_load_dwordx4 v16, s[20:23], s17 offen lds
    s_add_u32 m0, s46, 22528
    s_add_u32 s17, s49, 456192
    buffer_load_dwordx4 v16, s[20:23], s17 offen lds
    s_add_u32 m0, s46, 23552
    s_add_u32 s17, s49, 476928
    buffer_load_dwordx4 v16, s[20:23], s17 offen lds
    s_add_u32 m0, s46, 24576
    s_add_u32 s17, s49, 497664
    buffer_load_dwordx4 v16, s[20:23], s17 offen lds
    s_add_u32 m0, s46, 25600
    s_add_u32 s17, s49, 518400
    buffer_load_dwordx4 v16, s[20:23], s17 offen lds
    s_add_u32 m0, s46, 26624
    s_add_u32 s17, s49, 539136
    buffer_load_dwordx4 v16, s[20:23], s17 offen lds
    s_add_u32 m0, s46, 27648
    s_add_u32 s17, s49, 559872
    buffer_load_dwordx4 v16, s[20:23], s17 offen lds
    s_add_u32 m0, s46, 28672
    s_add_u32 s17, s49, 580608
    buffer_load_dwordx4 v16, s[20:23], s17 offen lds
    s_add_u32 m0, s46, 29696
    s_add_u32 s17, s49, 601344
    buffer_load_dwordx4 v16, s[20:23], s17 offen lds
    s_add_u32 m0, s46, 30720
    s_add_u32 s17, s49, 622080
    buffer_load_dwordx4 v16, s[20:23], s17 offen lds
    s_add_u32 m0, s46, 31744
    s_add_u32 s17, s49, 642816
    buffer_load_dwordx4 v16, s[20:23], s17 offen lds
    s_waitcnt vmcnt(28)
    ds_read_b64_tr_b16 a[0:1], v18 offset:0
    ds_read_b64_tr_b16 a[2:3], v18 offset:256
    ds_read_b64_tr_b16 a[4:5], v18 offset:1024
    ds_read_b64_tr_b16 a[6:7], v18 offset:1280
    ds_read_b64_tr_b16 a[8:9], v18 offset:2048
    ds_read_b64_tr_b16 a[10:11], v18 offset:2304
    ds_read_b64_tr_b16 a[12:13], v18 offset:3072
    ds_read_b64_tr_b16 a[14:15], v18 offset:3328
    s_waitcnt lgkmcnt(0)
    s_add_u32 m0, s46, 0
    s_add_u32 s17, s49, 0
    buffer_load_dwordx4 v17, s[20:23], s17 offen lds
    s_add_u32 m0, s46, 1024
    s_add_u32 s17, s49, 165888
    buffer_load_dwordx4 v17, s[20:23], s17 offen lds
    s_add_u32 m0, s46, 2048
    s_add_u32 s17, s49, 331776
    buffer_load_dwordx4 v17, s[20:23], s17 offen lds
    s_add_u32 m0, s46, 3072
    s_add_u32 s17, s49, 497664
    buffer_load_dwordx4 v17, s[20:23], s17 offen lds
    s_waitcnt vmcnt(28)
    ds_read_b64_tr_b16 a[16:17], v18 offset:4096
    ds_read_b64_tr_b16 a[18:19], v18 offset:4352
    ds_read_b64_tr_b16 a[20:21], v18 offset:5120
    ds_read_b64_tr_b16 a[22:23], v18 offset:5376
    ds_read_b64_tr_b16 a[24:25], v18 offset:6144
    ds_read_b64_tr_b16 a[26:27], v18 offset:6400
    ds_read_b64_tr_b16 a[28:29], v18 offset:7168
    ds_read_b64_tr_b16 a[30:31], v18 offset:7424
    s_waitcnt lgkmcnt(0)
    s_add_u32 m0, s46, 4096
    s_add_u32 s17, s52, 0
    buffer_load_dwordx4 v16, s[20:23], s17 offen lds
    s_add_u32 m0, s46, 5120
    s_add_u32 s17, s52, 20736
    buffer_load_dwordx4 v16, s[20:23], s17 offen lds
    s_add_u32 m0, s46, 6144
    s_add_u32 s17, s52, 41472
    buffer_load_dwordx4 v16, s[20:23], s17 offen lds
    s_add_u32 m0, s46, 7168
    s_add_u32 s17, s52, 62208
    buffer_load_dwordx4 v16, s[20:23], s17 offen lds
    s_waitcnt vmcnt(28)
    ds_read_b64_tr_b16 a[32:33], v18 offset:8192
    ds_read_b64_tr_b16 a[34:35], v18 offset:8448
    ds_read_b64_tr_b16 a[36:37], v18 offset:9216
    ds_read_b64_tr_b16 a[38:39], v18 offset:9472
    ds_read_b64_tr_b16 a[40:41], v18 offset:10240
    ds_read_b64_tr_b16 a[42:43], v18 offset:10496
    ds_read_b64_tr_b16 a[44:45], v18 offset:11264
    ds_read_b64_tr_b16 a[46:47], v18 offset:11520
    s_waitcnt lgkmcnt(0)
    s_add_u32 m0, s46, 8192
    s_add_u32 s17, s52, 82944
    buffer_load_dwordx4 v16, s[20:23], s17 offen lds
    s_add_u32 m0, s46, 9216
    s_add_u32 s17, s52, 103680
    buffer_load_dwordx4 v16, s[20:23], s17 offen lds
    s_add_u32 m0, s46, 10240
    s_add_u32 s17, s52, 124416
    buffer_load_dwordx4 v16, s[20:23], s17 offen lds
    s_add_u32 m0, s46, 11264
    s_add_u32 s17, s52, 145152
    buffer_load_dwordx4 v16, s[20:23], s17 offen lds
    s_waitcnt vmcnt(28)
    ds_read_b64_tr_b16 a[48:49], v18 offset:12288
    ds_read_b64_tr_b16 a[50:51], v18 offset:12544
    ds_read_b64_tr_b16 a[52:53], v18 offset:13312
    ds_read_b64_tr_b16 a[54:55], v18 offset:13568
    ds_read_b64_tr_b16 a[56:57], v18 offset:14336
    ds_read_b64_tr_b16 a[58:59], v18 offset:14592
    ds_read_b64_tr_b16 a[60:61], v18 offset:15360
    ds_read_b64_tr_b16 a[62:63], v18 offset:15616
    s_waitcnt lgkmcnt(0)
    s_add_u32 m0, s46, 12288
    s_add_u32 s17, s52, 165888
    buffer_load_dwordx4 v16, s[20:23], s17 offen lds
    s_add_u32 m0, s46, 13312
    s_add_u32 s17, s52, 186624
    buffer_load_dwordx4 v16, s[20:23], s17 offen lds
    s_add_u32 m0, s46, 14336
    s_add_u32 s17, s52, 207360
    buffer_load_dwordx4 v16, s[20:23], s17 offen lds
    s_add_u32 m0, s46, 15360
    s_add_u32 s17, s52, 228096
    buffer_load_dwordx4 v16, s[20:23], s17 offen lds
    s_waitcnt vmcnt(28)
    ds_read_b64_tr_b16 a[64:65], v18 offset:16384
    ds_read_b64_tr_b16 a[66:67], v18 offset:16640
    ds_read_b64_tr_b16 a[68:69], v18 offset:17408
    ds_read_b64_tr_b16 a[70:71], v18 offset:17664
    ds_read_b64_tr_b16 a[72:73], v18 offset:18432
    ds_read_b64_tr_b16 a[74:75], v18 offset:18688
    ds_read_b64_tr_b16 a[76:77], v18 offset:19456
    ds_read_b64_tr_b16 a[78:79], v18 offset:19712
    s_waitcnt lgkmcnt(0)
    s_add_u32 m0, s46, 16384
    s_add_u32 s17, s52, 248832
    buffer_load_dwordx4 v16, s[20:23], s17 offen lds
    s_add_u32 m0, s46, 17408
    s_add_u32 s17, s52, 269568
    buffer_load_dwordx4 v16, s[20:23], s17 offen lds
    s_add_u32 m0, s46, 18432
    s_add_u32 s17, s52, 290304
    buffer_load_dwordx4 v16, s[20:23], s17 offen lds
    s_add_u32 m0, s46, 19456
    s_add_u32 s17, s52, 311040
    buffer_load_dwordx4 v16, s[20:23], s17 offen lds
    s_waitcnt vmcnt(28)
    ds_read_b64_tr_b16 a[80:81], v18 offset:20480
    ds_read_b64_tr_b16 a[82:83], v18 offset:20736
    ds_read_b64_tr_b16 a[84:85], v18 offset:21504
    ds_read_b64_tr_b16 a[86:87], v18 offset:21760
    ds_read_b64_tr_b16 a[88:89], v18 offset:22528
    ds_read_b64_tr_b16 a[90:91], v18 offset:22784
    ds_read_b64_tr_b16 a[92:93], v18 offset:23552
    ds_read_b64_tr_b16 a[94:95], v18 offset:23808
    s_waitcnt lgkmcnt(0)
    s_add_u32 m0, s46, 20480
    s_add_u32 s17, s52, 331776
    buffer_load_dwordx4 v16, s[20:23], s17 offen lds
    s_add_u32 m0, s46, 21504
    s_add_u32 s17, s52, 352512
    buffer_load_dwordx4 v16, s[20:23], s17 offen lds
    s_add_u32 m0, s46, 22528
    s_add_u32 s17, s52, 373248
    buffer_load_dwordx4 v16, s[20:23], s17 offen lds
    s_add_u32 m0, s46, 23552
    s_add_u32 s17, s52, 393984
    buffer_load_dwordx4 v16, s[20:23], s17 offen lds
    s_waitcnt vmcnt(28)
    ds_read_b64_tr_b16 a[96:97], v18 offset:24576
    ds_read_b64_tr_b16 a[98:99], v18 offset:24832
    ds_read_b64_tr_b16 a[100:101], v18 offset:25600
    ds_read_b64_tr_b16 a[102:103], v18 offset:25856
    ds_read_b64_tr_b16 a[104:105], v18 offset:26624
    ds_read_b64_tr_b16 a[106:107], v18 offset:26880
    ds_read_b64_tr_b16 a[108:109], v18 offset:27648
    ds_read_b64_tr_b16 a[110:111], v18 offset:27904
    s_waitcnt lgkmcnt(0)
    s_add_u32 m0, s46, 24576
    s_add_u32 s17, s52, 414720
    buffer_load_dwordx4 v16, s[20:23], s17 offen lds
    s_add_u32 m0, s46, 25600
    s_add_u32 s17, s52, 435456
    buffer_load_dwordx4 v16, s[20:23], s17 offen lds
    s_add_u32 m0, s46, 26624
    s_add_u32 s17, s52, 456192
    buffer_load_dwordx4 v16, s[20:23], s17 offen lds
    s_add_u32 m0, s46, 27648
    s_add_u32 s17, s52, 476928
    buffer_load_dwordx4 v16, s[20:23], s17 offen lds
    s_waitcnt vmcnt(28)
    ds_read_b64_tr_b16 a[112:113], v18 offset:28672
    ds_read_b64_tr_b16 a[114:115], v18 offset:28928
    ds_read_b64_tr_b16 a[116:117], v18 offset:29696
    ds_read_b64_tr_b16 a[118:119], v18 offset:29952
    ds_read_b64_tr_b16 a[120:121], v18 offset:30720
    ds_read_b64_tr_b16 a[122:123], v18 offset:30976
    ds_read_b64_tr_b16 a[124:125], v18 offset:31744
    ds_read_b64_tr_b16 a[126:127], v18 offset:32000
    s_waitcnt lgkmcnt(0)
    s_add_u32 m0, s46, 28672
    s_add_u32 s17, s52, 497664
    buffer_load_dwordx4 v16, s[20:23], s17 offen lds
    s_add_u32 m0, s46, 29696
    s_add_u32 s17, s52, 518400
    buffer_load_dwordx4 v16, s[20:23], s17 offen lds
    s_add_u32 m0, s46, 30720
    s_add_u32 s17, s52, 539136
    buffer_load_dwordx4 v16, s[20:23], s17 offen lds
    s_add_u32 m0, s46, 31744
    s_add_u32 s17, s52, 559872
    buffer_load_dwordx4 v16, s[20:23], s17 offen lds
    s_waitcnt vmcnt(28)
    ds_read_b64_tr_b16 a[128:129], v18 offset:0
    ds_read_b64_tr_b16 a[130:131], v18 offset:256
    ds_read_b64_tr_b16 a[132:133], v18 offset:1024
    ds_read_b64_tr_b16 a[134:135], v18 offset:1280
    ds_read_b64_tr_b16 a[136:137], v18 offset:2048
    ds_read_b64_tr_b16 a[138:139], v18 offset:2304
    ds_read_b64_tr_b16 a[140:141], v18 offset:3072
    ds_read_b64_tr_b16 a[142:143], v18 offset:3328
    s_waitcnt lgkmcnt(0)
    s_add_u32 m0, s46, 0
    s_add_u32 s17, s52, 580608
    buffer_load_dwordx4 v16, s[20:23], s17 offen lds
    s_add_u32 m0, s46, 1024
    s_add_u32 s17, s52, 601344
    buffer_load_dwordx4 v16, s[20:23], s17 offen lds
    s_add_u32 m0, s46, 2048
    s_add_u32 s17, s52, 622080
    buffer_load_dwordx4 v16, s[20:23], s17 offen lds
    s_add_u32 m0, s46, 3072
    s_add_u32 s17, s52, 642816
    buffer_load_dwordx4 v16, s[20:23], s17 offen lds
    s_waitcnt vmcnt(28)
    ds_read_b64_tr_b16 a[144:145], v18 offset:4096
    ds_read_b64_tr_b16 a[146:147], v18 offset:4352
    ds_read_b64_tr_b16 a[148:149], v18 offset:5120
    ds_read_b64_tr_b16 a[150:151], v18 offset:5376
    ds_read_b64_tr_b16 a[152:153], v18 offset:6144
    ds_read_b64_tr_b16 a[154:155], v18 offset:6400
    ds_read_b64_tr_b16 a[156:157], v18 offset:7168
    ds_read_b64_tr_b16 a[158:159], v18 offset:7424
    s_waitcnt lgkmcnt(0)
    s_add_u32 m0, s46, 4096
    s_add_u32 s17, s52, 0
    buffer_load_dwordx4 v17, s[20:23], s17 offen lds
    s_add_u32 m0, s46, 5120
    s_add_u32 s17, s52, 165888
    buffer_load_dwordx4 v17, s[20:23], s17 offen lds
    s_add_u32 m0, s46, 6144
    s_add_u32 s17, s52, 331776
    buffer_load_dwordx4 v17, s[20:23], s17 offen lds
    s_add_u32 m0, s46, 7168
    s_add_u32 s17, s52, 497664
    buffer_load_dwordx4 v17, s[20:23], s17 offen lds
    s_waitcnt vmcnt(28)
    ds_read_b64_tr_b16 a[160:161], v18 offset:8192
    ds_read_b64_tr_b16 a[162:163], v18 offset:8448
    ds_read_b64_tr_b16 a[164:165], v18 offset:9216
    ds_read_b64_tr_b16 a[166:167], v18 offset:9472
    ds_read_b64_tr_b16 a[168:169], v18 offset:10240
    ds_read_b64_tr_b16 a[170:171], v18 offset:10496
    ds_read_b64_tr_b16 a[172:173], v18 offset:11264
    ds_read_b64_tr_b16 a[174:175], v18 offset:11520
    s_waitcnt lgkmcnt(0)
    s_waitcnt vmcnt(24)
    ds_read_b64_tr_b16 a[176:177], v18 offset:12288
    ds_read_b64_tr_b16 a[178:179], v18 offset:12544
    ds_read_b64_tr_b16 a[180:181], v18 offset:13312
    ds_read_b64_tr_b16 a[182:183], v18 offset:13568
    ds_read_b64_tr_b16 a[184:185], v18 offset:14336
    ds_read_b64_tr_b16 a[186:187], v18 offset:14592
    ds_read_b64_tr_b16 a[188:189], v18 offset:15360
    ds_read_b64_tr_b16 a[190:191], v18 offset:15616
    s_waitcnt lgkmcnt(0)
    s_waitcnt vmcnt(20)
    ds_read_b64_tr_b16 a[192:193], v18 offset:16384
    ds_read_b64_tr_b16 a[194:195], v18 offset:16640
    ds_read_b64_tr_b16 a[196:197], v18 offset:17408
    ds_read_b64_tr_b16 a[198:199], v18 offset:17664
    ds_read_b64_tr_b16 a[200:201], v18 offset:18432
    ds_read_b64_tr_b16 a[202:203], v18 offset:18688
    ds_read_b64_tr_b16 a[204:205], v18 offset:19456
    ds_read_b64_tr_b16 a[206:207], v18 offset:19712
    s_waitcnt lgkmcnt(0)
    s_waitcnt vmcnt(16)
    ds_read_b64_tr_b16 a[208:209], v18 offset:20480
    ds_read_b64_tr_b16 a[210:211], v18 offset:20736
    ds_read_b64_tr_b16 a[212:213], v18 offset:21504
    ds_read_b64_tr_b16 a[214:215], v18 offset:21760
    ds_read_b64_tr_b16 a[216:217], v18 offset:22528
    ds_read_b64_tr_b16 a[218:219], v18 offset:22784
    ds_read_b64_tr_b16 a[220:221], v18 offset:23552
    ds_read_b64_tr_b16 a[222:223], v18 offset:23808
    s_waitcnt lgkmcnt(0)
    s_waitcnt vmcnt(12)
    ds_read_b64_tr_b16 a[224:225], v18 offset:24576
    ds_read_b64_tr_b16 a[226:227], v18 offset:24832
    ds_read_b64_tr_b16 a[228:229], v18 offset:25600
    ds_read_b64_tr_b16 a[230:231], v18 offset:25856
    ds_read_b64_tr_b16 a[232:233], v18 offset:26624
    ds_read_b64_tr_b16 a[234:235], v18 offset:26880
    ds_read_b64_tr_b16 a[236:237], v18 offset:27648
    ds_read_b64_tr_b16 a[238:239], v18 offset:27904
    s_waitcnt lgkmcnt(0)
    s_waitcnt vmcnt(8)
    ds_read_b64_tr_b16 a[240:241], v18 offset:28672
    ds_read_b64_tr_b16 a[242:243], v18 offset:28928
    ds_read_b64_tr_b16 a[244:245], v18 offset:29696
    ds_read_b64_tr_b16 a[246:247], v18 offset:29952
    ds_read_b64_tr_b16 a[248:249], v18 offset:30720
    ds_read_b64_tr_b16 a[250:251], v18 offset:30976
    ds_read_b64_tr_b16 a[252:253], v18 offset:31744
    ds_read_b64_tr_b16 a[254:255], v18 offset:32000
    s_waitcnt lgkmcnt(0)
    s_waitcnt vmcnt(4)
    ds_read_b64_tr_b16 v[152:153], v18 offset:0
    ds_read_b64_tr_b16 v[154:155], v18 offset:256
    ds_read_b64_tr_b16 v[156:157], v18 offset:1024
    ds_read_b64_tr_b16 v[158:159], v18 offset:1280
    ds_read_b64_tr_b16 v[160:161], v18 offset:2048
    ds_read_b64_tr_b16 v[162:163], v18 offset:2304
    ds_read_b64_tr_b16 v[164:165], v18 offset:3072
    ds_read_b64_tr_b16 v[166:167], v18 offset:3328
    s_waitcnt lgkmcnt(0)
    s_waitcnt vmcnt(0)
    ds_read_b64_tr_b16 v[168:169], v18 offset:4096
    ds_read_b64_tr_b16 v[170:171], v18 offset:4352
    ds_read_b64_tr_b16 v[172:173], v18 offset:5120
    ds_read_b64_tr_b16 v[174:175], v18 offset:5376
    ds_read_b64_tr_b16 v[176:177], v18 offset:6144
    ds_read_b64_tr_b16 v[178:179], v18 offset:6400
    ds_read_b64_tr_b16 v[180:181], v18 offset:7168
    ds_read_b64_tr_b16 v[182:183], v18 offset:7424
    s_waitcnt lgkmcnt(0)
    s_barrier
    v_bfe_u32 v5, v0, 4, 5
    v_lshlrev_b32 v5, 4, v5
    v_lshrrev_b32 v6, 9, v0
    v_lshl_add_u32 v6, v6, 9, v5
    s_lshl_b32 s17, s50, 11
    v_add_u32 v12, s17, v6
    s_lshr_b32 s17, s50, 1
    s_lshl_b32 s17, s17, 9
    s_and_b32 s18, s50, 1
    s_lshl_b32 s18, s18, 3
    s_add_u32 s17, s17, s18
    v_add_u32 v10, s17, v5
    s_lshl_b32 s17, s51, 11
    v_add_u32 v13, s17, v6
    s_lshr_b32 s17, s51, 1
    s_lshl_b32 s17, s17, 9
    s_and_b32 s18, s51, 1
    s_lshl_b32 s18, s18, 3
    s_add_u32 s17, s17, s18
    v_add_u32 v11, s17, v5
    s_lshr_b32 s49, s50, 2
    s_lshl_b32 s49, s49, 7
    s_and_b32 s17, s50, 3
    s_lshl_b32 s17, s17, 2
    s_add_u32 s49, s49, s17
    s_lshr_b32 s52, s51, 2
    s_lshl_b32 s52, s52, 7
    s_and_b32 s17, s51, 3
    s_lshl_b32 s17, s17, 2
    s_add_u32 s52, s52, s17
    s_sub_u32 s17, s52, s49
    v_lshrrev_b32 v185, 4, v0
    v_mul_lo_u32 v185, v185, s17
    s_add_u32 s49, s49, 3584
    s_mov_b32 s36, s63
    s_mov_b32 s34, s63
    s_mul_i32 s58, s14, 9216
    s_mul_i32 s64, s63, 2359296
    s_add_u32 s64, s64, s58
    s_add_u32 s64, s64, 17301504
    s_mul_i32 s61, s63, 1441792
    s_add_u32 s61, s61, 1536
    s_mov_b32 s37, 0
    s_mov_b32 s40, 36864
    s_mov_b32 s59, s58
    s_mov_b32 s43, 0
    s_mov_b32 s62, 1
    s_mov_b32 s28, s8
    s_mov_b32 s29, s9
    s_mov_b32 s30, 0
    s_mov_b32 s31, 0x00020000
    v_mov_b32 v184, 74752
    v_mov_b32 v5, -1
    ds_write_b32 v184, v5
    s_waitcnt lgkmcnt(0)
    s_cmp_lg_u32 s14, 0
    s_cbranch_scc1 Lawo_inia_d
    v_mov_b32 v5, 40
    s_mov_b32 s16, 0
Lawo_inia:
    global_load_dword v6, v5, s[12:13] sc1
    s_add_u32 s16, s16, 1
    s_cmp_gt_u32 s16, 100000
    s_cbranch_scc1 L_role_awo_abort
    s_waitcnt vmcnt(0)
    v_cmp_gt_u32 vcc, 72, v6
    s_nop 0
    s_cbranch_vccz Lawo_inia_d
    s_sleep 8
    s_branch Lawo_inia
Lawo_inia_d:
    s_barrier
    s_cmp_eq_u32 s63, 0
    s_cbranch_scc1 Lawo_ini_sk
    s_cmp_lg_u32 s14, 0
    s_cbranch_scc1 Lawo_inib_d
    v_mov_b32 v5, 160
    s_mov_b32 s16, 0
Lawo_inib:
    global_load_dword v6, v5, s[12:13] sc1
    s_add_u32 s16, s16, 1
    s_cmp_gt_u32 s16, 100000
    s_cbranch_scc1 L_role_awo_abort
    s_waitcnt vmcnt(0)
    v_cmp_gt_u32 vcc, 64, v6
    s_nop 0
    s_cbranch_vccz Lawo_inib_d
    s_sleep 8
    s_branch Lawo_inib
Lawo_inib_d:
    s_barrier
Lawo_ini_sk:
    s_mul_i32 s41, s37, 36864
    s_add_u32 s41, s41, s64
    s_mul_i32 s60, s37, 22528
    s_add_u32 s60, s60, s61
    s_cmp_lt_u32 s37, 64
    s_cselect_b32 s60, s60, 2883584
    s_branch Lawo_wait
Lawo_head:
    s_waitcnt vmcnt(6)
Lawo_head2:
    s_barrier
    ds_read_b32 v15, v184
    s_xor_b32 s40, s40, 36864
    s_xor_b32 s59, s59, 36864
    s_mov_b32 s35, s37
    s_lshl_b32 s57, s34, 6
    s_add_u32 s57, s57, s35
    s_add_u32 s37, s37, 1
    s_mov_b32 s39, 0
    s_mov_b32 s54, 0
    s_mul_i32 s41, s37, 36864
    s_add_u32 s41, s41, s64
    s_mul_i32 s60, s37, 22528
    s_add_u32 s60, s60, s61
    s_cmp_lt_u32 s37, 64
    s_cselect_b32 s60, s60, 2883584
    v_add_u32 v9, s40, v0
    ds_read_b128 v[48:51], v9 offset:0
    ds_read_b128 v[52:55], v9 offset:1024
    ds_read_b128 v[56:59], v9 offset:2048
    ds_read_b128 v[60:63], v9 offset:3072
    ds_read_b128 v[64:67], v9 offset:4096
    ds_read_b128 v[68:71], v9 offset:5120
    ds_read_b128 v[72:75], v9 offset:6144
    v_lshlrev_b32 v16, 16, v80
    v_and_b32 v17, 0xffff0000, v80
    v_lshlrev_b32 v18, 16, v81
    v_and_b32 v19, 0xffff0000, v81
    v_lshlrev_b32 v20, 16, v82
    v_and_b32 v21, 0xffff0000, v82
    v_lshlrev_b32 v22, 16, v83
    v_and_b32 v23, 0xffff0000, v83
    v_lshlrev_b32 v24, 16, v84
    v_and_b32 v25, 0xffff0000, v84
    v_lshlrev_b32 v26, 16, v85
    v_and_b32 v27, 0xffff0000, v85
    v_lshlrev_b32 v28, 16, v86
    v_and_b32 v29, 0xffff0000, v86
    v_lshlrev_b32 v30, 16, v87
    v_and_b32 v31, 0xffff0000, v87
    v_lshlrev_b32 v32, 16, v88
    v_and_b32 v33, 0xffff0000, v88
    v_lshlrev_b32 v34, 16, v89
    v_and_b32 v35, 0xffff0000, v89
    v_lshlrev_b32 v36, 16, v90
    v_and_b32 v37, 0xffff0000, v90
    v_lshlrev_b32 v38, 16, v91
    v_and_b32 v39, 0xffff0000, v91
    v_lshlrev_b32 v40, 16, v92
    v_and_b32 v41, 0xffff0000, v92
    v_lshlrev_b32 v42, 16, v93
    v_and_b32 v43, 0xffff0000, v93
    v_lshlrev_b32 v44, 16, v94
    v_and_b32 v45, 0xffff0000, v94
    v_lshlrev_b32 v46, 16, v95
    v_and_b32 v47, 0xffff0000, v95
    s_waitcnt lgkmcnt(6)
    v_mfma_f32_32x32x16_bf16 v[16:31], a[0:3], v[48:51], v[16:31]
    ds_read_b128 v[76:79], v9 offset:7168
    v_mfma_f32_32x32x16_bf16 v[32:47], a[144:147], v[48:51], v[32:47]
    s_mul_i32 s46, s34, 4718592
    s_mul_i32 s51, s35, 36864
    s_add_u32 s46, s46, s51
    s_waitcnt lgkmcnt(6)
    v_mfma_f32_32x32x16_bf16 v[16:31], a[4:7], v[52:55], v[16:31]
    ds_read_b128 v[48:51], v9 offset:8192
    v_mfma_f32_32x32x16_bf16 v[32:47], a[148:151], v[52:55], v[32:47]
    s_add_u32 s46, s46, 8650752
    s_mul_i32 s52, s34, 786432
    s_mul_i32 s51, s35, 6144
    v_readfirstlane_b32 s17, v15
    s_nop 0
    s_add_u32 s18, s17, 1
    s_max_i32 s32, s18, s37
    s_add_u32 s39, s37, 1
    s_min_u32 s39, s39, 63
    s_mul_i32 s33, s32, 22528
    s_add_u32 s33, s33, s61
    s_cmp_eq_u32 s14, 0
    s_cselect_b32 s18, s32, 0x7fff
    v_mov_b32 v2, 2
    s_cmp_le_u32 s18, s39
    s_cselect_b64 exec, -1, 0
    buffer_load_dword v2, v1, s[8:11], s33 offen sc1
    s_mov_b64 exec, -1
    s_cmp_ge_i32 s17, s37
    s_cbranch_scc1 Lawo_f_5
    s_waitcnt lgkmcnt(6)
    v_mfma_f32_32x32x16_bf16 v[16:31], a[8:11], v[56:59], v[16:31]
    ds_read_b128 v[52:55], v9 offset:9216
    v_mfma_f32_32x32x16_bf16 v[32:47], a[152:155], v[56:59], v[32:47]
    s_add_u32 s52, s52, s51
    s_add_u32 s52, s52, 16121856
    s_waitcnt lgkmcnt(6)
    v_mfma_f32_32x32x16_bf16 v[16:31], a[12:15], v[60:63], v[16:31]
    ds_read_b128 v[56:59], v9 offset:10240
    v_mfma_f32_32x32x16_bf16 v[32:47], a[156:159], v[60:63], v[32:47]
    s_waitcnt lgkmcnt(6)
    v_mfma_f32_32x32x16_bf16 v[16:31], a[16:19], v[64:67], v[16:31]
    ds_read_b128 v[60:63], v9 offset:11264
    v_mfma_f32_32x32x16_bf16 v[32:47], a[160:163], v[64:67], v[32:47]
    s_waitcnt lgkmcnt(6)
    v_mfma_f32_32x32x16_bf16 v[16:31], a[20:23], v[68:71], v[16:31]
    ds_read_b128 v[64:67], v9 offset:12288
    v_mfma_f32_32x32x16_bf16 v[32:47], a[164:167], v[68:71], v[32:47]
    s_waitcnt lgkmcnt(6)
    v_mfma_f32_32x32x16_bf16 v[16:31], a[24:27], v[72:75], v[16:31]
    ds_read_b128 v[68:71], v9 offset:13312
    v_mfma_f32_32x32x16_bf16 v[32:47], a[168:171], v[72:75], v[32:47]
    s_waitcnt lgkmcnt(6)
    v_mfma_f32_32x32x16_bf16 v[16:31], a[28:31], v[76:79], v[16:31]
    ds_read_b128 v[72:75], v9 offset:14336
    v_mfma_f32_32x32x16_bf16 v[32:47], a[172:175], v[76:79], v[32:47]
    s_waitcnt lgkmcnt(6)
    v_mfma_f32_32x32x16_bf16 v[16:31], a[32:35], v[48:51], v[16:31]
    ds_read_b128 v[76:79], v9 offset:15360
    v_mfma_f32_32x32x16_bf16 v[32:47], a[176:179], v[48:51], v[32:47]
    s_waitcnt lgkmcnt(6)
    v_mfma_f32_32x32x16_bf16 v[16:31], a[36:39], v[52:55], v[16:31]
    ds_read_b128 v[48:51], v9 offset:16384
    v_mfma_f32_32x32x16_bf16 v[32:47], a[180:183], v[52:55], v[32:47]
    s_waitcnt lgkmcnt(6)
    v_mfma_f32_32x32x16_bf16 v[16:31], a[40:43], v[56:59], v[16:31]
    ds_read_b128 v[52:55], v9 offset:17408
    v_mfma_f32_32x32x16_bf16 v[32:47], a[184:187], v[56:59], v[32:47]
    s_waitcnt lgkmcnt(6)
    v_mfma_f32_32x32x16_bf16 v[16:31], a[44:47], v[60:63], v[16:31]
    ds_read_b128 v[56:59], v9 offset:18432
    v_mfma_f32_32x32x16_bf16 v[32:47], a[188:191], v[60:63], v[32:47]
    s_waitcnt lgkmcnt(6)
    v_mfma_f32_32x32x16_bf16 v[16:31], a[48:51], v[64:67], v[16:31]
    ds_read_b128 v[60:63], v9 offset:19456
    v_mfma_f32_32x32x16_bf16 v[32:47], a[192:195], v[64:67], v[32:47]
    s_waitcnt vmcnt(1)
    s_cmp_lg_u32 s43, 0
    s_cselect_b64 exec, 3, 0
    buffer_store_dword v3, v185, s[8:11], s43 offen sc1
    s_mov_b64 exec, -1
    s_mov_b32 s43, 0
    s_waitcnt lgkmcnt(6)
    v_mfma_f32_32x32x16_bf16 v[16:31], a[52:55], v[68:71], v[16:31]
    ds_read_b128 v[64:67], v9 offset:20480
    v_mfma_f32_32x32x16_bf16 v[32:47], a[196:199], v[68:71], v[32:47]
    s_waitcnt lgkmcnt(6)
    v_mfma_f32_32x32x16_bf16 v[16:31], a[56:59], v[72:75], v[16:31]
    v_cmp_eq_u32 s[76:77], 1, v2
    v_cmp_eq_u32 vcc, 2, v2
    s_cmp_eq_u64 s[76:77], -1
    s_cselect_b32 s38, 1, 0
    ds_read_b128 v[68:71], v9 offset:21504
    v_mfma_f32_32x32x16_bf16 v[32:47], a[200:203], v[72:75], v[32:47]
    s_cmp_lg_u32 s38, 0
    s_cselect_b64 exec, 1, 0
    v_mov_b32 v15, s32
    ds_write_b32 v184, v15
    v_mov_b32 v2, 2
    s_mov_b64 exec, -1
    s_waitcnt lgkmcnt(7)
    v_mfma_f32_32x32x16_bf16 v[16:31], a[60:63], v[76:79], v[16:31]
    s_add_u32 s32, s32, s38
    s_mul_i32 s38, s38, 22528
    s_add_u32 s33, s33, s38
    ds_read_b128 v[72:75], v9 offset:22528
    v_mfma_f32_32x32x16_bf16 v[32:47], a[204:207], v[76:79], v[32:47]
    s_cmp_eq_u64 vcc, 0
    s_cselect_b32 s38, s32, 0x7fff
    s_waitcnt lgkmcnt(7)
    v_mfma_f32_32x32x16_bf16 v[16:31], a[64:67], v[48:51], v[16:31]
    ds_read_b128 v[76:79], v9 offset:23552
    v_mfma_f32_32x32x16_bf16 v[32:47], a[208:211], v[48:51], v[32:47]
    s_cmp_le_u32 s38, s39
    s_cselect_b64 exec, -1, 0
    v_mov_b32 v2, 2
    buffer_load_dword v2, v1, s[8:11], s33 offen sc1
    s_mov_b64 exec, -1
    ds_read_b32 v15, v184
    s_waitcnt lgkmcnt(8)
    v_mfma_f32_32x32x16_bf16 v[16:31], a[68:71], v[52:55], v[16:31]
    ds_read_b128 v[48:51], v9 offset:24576
    v_mfma_f32_32x32x16_bf16 v[32:47], a[212:215], v[52:55], v[32:47]
    s_waitcnt lgkmcnt(8)
    v_mfma_f32_32x32x16_bf16 v[16:31], a[72:75], v[56:59], v[16:31]
    ds_read_b128 v[52:55], v9 offset:25600
    v_mfma_f32_32x32x16_bf16 v[32:47], a[216:219], v[56:59], v[32:47]
    s_waitcnt lgkmcnt(2)
    v_readfirstlane_b32 s17, v15
    s_nop 0
    s_cmp_ge_i32 s17, s37
    s_cbranch_scc1 Lawo_f_6
    v_mfma_f32_32x32x16_bf16 v[16:31], a[76:79], v[60:63], v[16:31]
    ds_read_b128 v[56:59], v9 offset:26624
    v_mfma_f32_32x32x16_bf16 v[32:47], a[220:223], v[60:63], v[32:47]
    v_mfma_f32_32x32x16_bf16 v[16:31], a[80:83], v[64:67], v[16:31]
    ds_read_b128 v[60:63], v9 offset:27648
    v_mfma_f32_32x32x16_bf16 v[32:47], a[224:227], v[64:67], v[32:47]
    v_mfma_f32_32x32x16_bf16 v[16:31], a[84:87], v[68:71], v[16:31]
    ds_read_b128 v[64:67], v9 offset:28672
    v_mfma_f32_32x32x16_bf16 v[32:47], a[228:231], v[68:71], v[32:47]
    v_mfma_f32_32x32x16_bf16 v[16:31], a[88:91], v[72:75], v[16:31]
    ds_read_b128 v[68:71], v9 offset:29696
    v_mfma_f32_32x32x16_bf16 v[32:47], a[232:235], v[72:75], v[32:47]
    v_mfma_f32_32x32x16_bf16 v[16:31], a[92:95], v[76:79], v[16:31]
    ds_read_b128 v[72:75], v9 offset:30720
    v_mfma_f32_32x32x16_bf16 v[32:47], a[236:239], v[76:79], v[32:47]
    s_waitcnt lgkmcnt(6)
    v_mfma_f32_32x32x16_bf16 v[16:31], a[96:99], v[48:51], v[16:31]
    ds_read_b128 v[76:79], v9 offset:31744
    v_mfma_f32_32x32x16_bf16 v[32:47], a[240:243], v[48:51], v[32:47]
    s_waitcnt lgkmcnt(6)
    v_mfma_f32_32x32x16_bf16 v[16:31], a[100:103], v[52:55], v[16:31]
    ds_read_b128 v[48:51], v9 offset:32768
    v_mfma_f32_32x32x16_bf16 v[32:47], a[244:247], v[52:55], v[32:47]
    s_waitcnt lgkmcnt(6)
    v_mfma_f32_32x32x16_bf16 v[16:31], a[104:107], v[56:59], v[16:31]
    ds_read_b128 v[52:55], v9 offset:33792
    v_mfma_f32_32x32x16_bf16 v[32:47], a[248:251], v[56:59], v[32:47]
    s_waitcnt lgkmcnt(6)
    v_mfma_f32_32x32x16_bf16 v[16:31], a[108:111], v[60:63], v[16:31]
    ds_read_b128 v[56:59], v9 offset:34816
    v_mfma_f32_32x32x16_bf16 v[32:47], a[252:255], v[60:63], v[32:47]
    s_waitcnt lgkmcnt(6)
    v_mfma_f32_32x32x16_bf16 v[16:31], a[112:115], v[64:67], v[16:31]
    ds_read_b128 v[60:63], v9 offset:35840
    v_mfma_f32_32x32x16_bf16 v[32:47], v[152:155], v[64:67], v[32:47]
    s_waitcnt lgkmcnt(6)
    v_mfma_f32_32x32x16_bf16 v[16:31], a[116:119], v[68:71], v[16:31]
    v_mfma_f32_32x32x16_bf16 v[32:47], v[156:159], v[68:71], v[32:47]
    s_waitcnt lgkmcnt(5)
    v_mfma_f32_32x32x16_bf16 v[16:31], a[120:123], v[72:75], v[16:31]
    v_mfma_f32_32x32x16_bf16 v[32:47], v[160:163], v[72:75], v[32:47]
    s_waitcnt lgkmcnt(4)
    v_mfma_f32_32x32x16_bf16 v[16:31], a[124:127], v[76:79], v[16:31]
    v_cmp_eq_u32 s[76:77], 1, v2
    v_cmp_eq_u32 vcc, 2, v2
    s_cmp_eq_u64 s[76:77], -1
    s_cselect_b32 s38, 1, 0
    v_mfma_f32_32x32x16_bf16 v[32:47], v[164:167], v[76:79], v[32:47]
    s_cmp_lg_u32 s38, 0
    s_cselect_b64 exec, 1, 0
    v_mov_b32 v15, s32
    ds_write_b32 v184, v15
    v_mov_b32 v2, 2
    s_mov_b64 exec, -1
    s_waitcnt lgkmcnt(4)
    v_mfma_f32_32x32x16_bf16 v[16:31], a[128:131], v[48:51], v[16:31]
    s_add_u32 s32, s32, s38
    s_mul_i32 s38, s38, 22528
    s_add_u32 s33, s33, s38
    s_cmp_eq_u64 vcc, 0
    s_cselect_b32 s38, s32, 0x7fff
    v_mfma_f32_32x32x16_bf16 v[32:47], v[168:171], v[48:51], v[32:47]
    s_cmp_le_u32 s38, s39
    s_cselect_b64 exec, -1, 0
    v_mov_b32 v2, 2
    buffer_load_dword v2, v1, s[8:11], s33 offen sc1
    s_mov_b64 exec, -1
    s_waitcnt lgkmcnt(3)
    v_mfma_f32_32x32x16_bf16 v[16:31], a[132:135], v[52:55], v[16:31]
    v_mfma_f32_32x32x16_bf16 v[32:47], v[172:175], v[52:55], v[32:47]
    s_waitcnt lgkmcnt(2)
    v_mfma_f32_32x32x16_bf16 v[16:31], a[136:139], v[56:59], v[16:31]
    v_mfma_f32_32x32x16_bf16 v[32:47], v[176:179], v[56:59], v[32:47]
    s_waitcnt lgkmcnt(1)
    v_mfma_f32_32x32x16_bf16 v[16:31], a[140:143], v[60:63], v[16:31]
    v_mfma_f32_32x32x16_bf16 v[32:47], v[180:183], v[60:63], v[32:47]
    s_nop 3
    v_cvt_pk_bf16_f32 v108, v16, v17
    v_cvt_pk_bf16_f32 v109, v18, v19
    v_cvt_pk_bf16_f32 v110, v20, v21
    v_cvt_pk_bf16_f32 v111, v22, v23
    buffer_store_dwordx4 v[108:111], v12, s[8:11], s46 offen offset:0 sc1
    v_cvt_pk_bf16_f32 v112, v24, v25
    v_cvt_pk_bf16_f32 v113, v26, v27
    v_cvt_pk_bf16_f32 v114, v28, v29
    v_cvt_pk_bf16_f32 v115, v30, v31
    buffer_store_dwordx4 v[112:115], v12, s[8:11], s46 offen offset:1024 sc1
    v_cvt_pk_bf16_f32 v116, v32, v33
    v_cvt_pk_bf16_f32 v117, v34, v35
    v_cvt_pk_bf16_f32 v118, v36, v37
    v_cvt_pk_bf16_f32 v119, v38, v39
    buffer_store_dwordx4 v[116:119], v13, s[8:11], s46 offen offset:0 sc1
    v_cvt_pk_bf16_f32 v120, v40, v41
    v_cvt_pk_bf16_f32 v121, v42, v43
    v_cvt_pk_bf16_f32 v122, v44, v45
    v_cvt_pk_bf16_f32 v123, v46, v47
    buffer_store_dwordx4 v[120:123], v13, s[8:11], s46 offen offset:1024 sc1
    v_mov_b32 v104, 0x3f803f80
    v_mov_b32 v96, 0
    v_mov_b32 v97, 0
    v_mov_b32 v100, 0
    v_mov_b32 v101, 0
    v_dot2c_f32_bf16 v96, v108, v104
    v_dot2c_f32_bf16 v97, v108, v108
    v_dot2c_f32_bf16 v100, v116, v104
    v_dot2c_f32_bf16 v101, v116, v116
    v_dot2c_f32_bf16 v96, v109, v104
    v_dot2c_f32_bf16 v97, v109, v109
    v_dot2c_f32_bf16 v100, v117, v104
    v_dot2c_f32_bf16 v101, v117, v117
    v_dot2c_f32_bf16 v96, v110, v104
    v_dot2c_f32_bf16 v97, v110, v110
    v_dot2c_f32_bf16 v100, v118, v104
    v_dot2c_f32_bf16 v101, v118, v118
    v_dot2c_f32_bf16 v96, v111, v104
    v_dot2c_f32_bf16 v97, v111, v111
    v_dot2c_f32_bf16 v100, v119, v104
    v_dot2c_f32_bf16 v101, v119, v119
    v_dot2c_f32_bf16 v96, v112, v104
    v_dot2c_f32_bf16 v97, v112, v112
    v_dot2c_f32_bf16 v100, v120, v104
    v_dot2c_f32_bf16 v101, v120, v120
    v_dot2c_f32_bf16 v96, v113, v104
    v_dot2c_f32_bf16 v97, v113, v113
    v_dot2c_f32_bf16 v100, v121, v104
    v_dot2c_f32_bf16 v101, v121, v121
    v_dot2c_f32_bf16 v96, v114, v104
    v_dot2c_f32_bf16 v97, v114, v114
    v_dot2c_f32_bf16 v100, v122, v104
    v_dot2c_f32_bf16 v101, v122, v122
    v_dot2c_f32_bf16 v96, v115, v104
    v_dot2c_f32_bf16 v97, v115, v115
    v_dot2c_f32_bf16 v100, v123, v104
    v_dot2c_f32_bf16 v101, v123, v123
    s_nop 2
    v_mov_b32 v98, v96
    v_mov_b32 v99, v97
    v_mov_b32 v102, v100
    v_mov_b32 v103, v101
    v_permlane32_swap_b32 v96, v98
    v_permlane32_swap_b32 v97, v99
    v_permlane32_swap_b32 v100, v102
    v_permlane32_swap_b32 v101, v103
    v_add_f32 v96, v96, v98
    v_add_f32 v97, v97, v99
    buffer_store_dwordx2 v[96:97], v10, s[8:11], s52 offen sc1
    v_add_f32 v100, v100, v102
    v_add_f32 v101, v101, v103
    buffer_store_dwordx2 v[100:101], v11, s[8:11], s52 offen sc1
    s_mul_i32 s43, s57, 22528
    s_add_u32 s43, s43, s49
    s_branch Lawo_none
Lawo_f_5:
    s_waitcnt lgkmcnt(6)
    v_mfma_f32_32x32x16_bf16 v[16:31], a[8:11], v[56:59], v[16:31]
    s_add_u32 m0, s59, 0
    s_add_u32 s47, s41, 0
    buffer_load_dwordx4 v0, s[8:11], s47 offen offset:0 lds
    ds_read_b128 v[52:55], v9 offset:9216
    v_mfma_f32_32x32x16_bf16 v[32:47], a[152:155], v[56:59], v[32:47]
    s_add_u32 s52, s52, s51
    s_add_u32 s52, s52, 16121856
    s_waitcnt lgkmcnt(6)
    v_mfma_f32_32x32x16_bf16 v[16:31], a[12:15], v[60:63], v[16:31]
    buffer_load_dwordx4 v0, s[8:11], s47 offen offset:1024 lds
    ds_read_b128 v[56:59], v9 offset:10240
    v_mfma_f32_32x32x16_bf16 v[32:47], a[156:159], v[60:63], v[32:47]
    s_waitcnt lgkmcnt(6)
    v_mfma_f32_32x32x16_bf16 v[16:31], a[16:19], v[64:67], v[16:31]
    buffer_load_dwordx4 v0, s[8:11], s47 offen offset:2048 lds
    ds_read_b128 v[60:63], v9 offset:11264
    v_mfma_f32_32x32x16_bf16 v[32:47], a[160:163], v[64:67], v[32:47]
    s_waitcnt lgkmcnt(6)
    v_mfma_f32_32x32x16_bf16 v[16:31], a[20:23], v[68:71], v[16:31]
    buffer_load_dwordx4 v0, s[8:11], s47 offen offset:3072 lds
    ds_read_b128 v[64:67], v9 offset:12288
    v_mfma_f32_32x32x16_bf16 v[32:47], a[164:167], v[68:71], v[32:47]
    s_waitcnt lgkmcnt(6)
    v_mfma_f32_32x32x16_bf16 v[16:31], a[24:27], v[72:75], v[16:31]
    s_add_u32 m0, s59, 4096
    s_add_u32 s47, s41, 4096
    buffer_load_dwordx4 v0, s[8:11], s47 offen offset:0 lds
    ds_read_b128 v[68:71], v9 offset:13312
    v_mfma_f32_32x32x16_bf16 v[32:47], a[168:171], v[72:75], v[32:47]
    s_waitcnt lgkmcnt(6)
    v_mfma_f32_32x32x16_bf16 v[16:31], a[28:31], v[76:79], v[16:31]
    buffer_load_dwordx4 v0, s[8:11], s47 offen offset:1024 lds
    ds_read_b128 v[72:75], v9 offset:14336
    v_mfma_f32_32x32x16_bf16 v[32:47], a[172:175], v[76:79], v[32:47]
    s_waitcnt lgkmcnt(6)
    v_mfma_f32_32x32x16_bf16 v[16:31], a[32:35], v[48:51], v[16:31]
    buffer_load_dwordx4 v0, s[8:11], s47 offen offset:2048 lds
    ds_read_b128 v[76:79], v9 offset:15360
    v_mfma_f32_32x32x16_bf16 v[32:47], a[176:179], v[48:51], v[32:47]
    s_waitcnt lgkmcnt(6)
    v_mfma_f32_32x32x16_bf16 v[16:31], a[36:39], v[52:55], v[16:31]
    buffer_load_dwordx4 v0, s[8:11], s47 offen offset:3072 lds
    ds_read_b128 v[48:51], v9 offset:16384
    v_mfma_f32_32x32x16_bf16 v[32:47], a[180:183], v[52:55], v[32:47]
    s_waitcnt lgkmcnt(6)
    v_mfma_f32_32x32x16_bf16 v[16:31], a[40:43], v[56:59], v[16:31]
    s_add_u32 m0, s59, 8192
    s_add_u32 s47, s41, 8192
    buffer_load_dwordx4 v0, s[8:11], s47 offen offset:0 lds
    ds_read_b128 v[52:55], v9 offset:17408
    v_mfma_f32_32x32x16_bf16 v[32:47], a[184:187], v[56:59], v[32:47]
    s_waitcnt lgkmcnt(6)
    v_mfma_f32_32x32x16_bf16 v[16:31], a[44:47], v[60:63], v[16:31]
    ds_read_b128 v[56:59], v9 offset:18432
    v_mfma_f32_32x32x16_bf16 v[32:47], a[188:191], v[60:63], v[32:47]
    s_mul_i32 s48, s36, 4718592
    s_mul_i32 s18, s37, 36864
    s_add_u32 s48, s48, s18
    s_add_u32 s48, s48, 6291456
    buffer_load_dwordx4 v[80:83], v12, s[8:11], s48 offen offset:0
    s_waitcnt lgkmcnt(6)
    v_mfma_f32_32x32x16_bf16 v[16:31], a[48:51], v[64:67], v[16:31]
    buffer_load_dwordx4 v[84:87], v12, s[8:11], s48 offen offset:1024
    ds_read_b128 v[60:63], v9 offset:19456
    v_mfma_f32_32x32x16_bf16 v[32:47], a[192:195], v[64:67], v[32:47]
    s_waitcnt vmcnt(12)
    s_cmp_lg_u32 s43, 0
    s_cselect_b64 exec, 3, 0
    buffer_store_dword v3, v185, s[8:11], s43 offen sc1
    s_mov_b64 exec, -1
    s_mov_b32 s43, 0
    s_waitcnt lgkmcnt(6)
    v_mfma_f32_32x32x16_bf16 v[16:31], a[52:55], v[68:71], v[16:31]
    buffer_load_dwordx4 v[88:91], v13, s[8:11], s48 offen offset:0
    ds_read_b128 v[64:67], v9 offset:20480
    v_mfma_f32_32x32x16_bf16 v[32:47], a[196:199], v[68:71], v[32:47]
    s_waitcnt lgkmcnt(6)
    v_mfma_f32_32x32x16_bf16 v[16:31], a[56:59], v[72:75], v[16:31]
    buffer_load_dwordx4 v[92:95], v13, s[8:11], s48 offen offset:1024
    v_cmp_eq_u32 s[76:77], 1, v2
    v_cmp_eq_u32 vcc, 2, v2
    ds_read_b128 v[68:71], v9 offset:21504
    v_mfma_f32_32x32x16_bf16 v[32:47], a[200:203], v[72:75], v[32:47]
    s_cmp_eq_u64 s[76:77], -1
    s_cselect_b32 s38, 1, 0
    s_waitcnt lgkmcnt(6)
    v_mfma_f32_32x32x16_bf16 v[16:31], a[60:63], v[76:79], v[16:31]
    s_cmp_lg_u32 s38, 0
    s_cselect_b64 exec, 1, 0
    v_mov_b32 v15, s32
    ds_write_b32 v184, v15
    v_mov_b32 v2, 2
    s_mov_b64 exec, -1
    ds_read_b128 v[72:75], v9 offset:22528
    v_mfma_f32_32x32x16_bf16 v[32:47], a[204:207], v[76:79], v[32:47]
    s_add_u32 s32, s32, s38
    s_mul_i32 s38, s38, 22528
    s_add_u32 s33, s33, s38
    s_cmp_eq_u64 vcc, 0
    s_cselect_b32 s38, s32, 0x7fff
    s_waitcnt lgkmcnt(7)
    v_mfma_f32_32x32x16_bf16 v[16:31], a[64:67], v[48:51], v[16:31]
    ds_read_b128 v[76:79], v9 offset:23552
    v_mfma_f32_32x32x16_bf16 v[32:47], a[208:211], v[48:51], v[32:47]
    s_cmp_le_u32 s38, s39
    s_cselect_b64 exec, -1, 0
    v_mov_b32 v2, 2
    buffer_load_dword v2, v1, s[8:11], s33 offen sc1
    s_mov_b64 exec, -1
    s_waitcnt lgkmcnt(7)
    v_mfma_f32_32x32x16_bf16 v[16:31], a[68:71], v[52:55], v[16:31]
    ds_read_b128 v[48:51], v9 offset:24576
    v_mfma_f32_32x32x16_bf16 v[32:47], a[212:215], v[52:55], v[32:47]
    s_waitcnt lgkmcnt(7)
    v_mfma_f32_32x32x16_bf16 v[16:31], a[72:75], v[56:59], v[16:31]
    ds_read_b128 v[52:55], v9 offset:25600
    v_mfma_f32_32x32x16_bf16 v[32:47], a[216:219], v[56:59], v[32:47]
    s_waitcnt lgkmcnt(7)
    v_mfma_f32_32x32x16_bf16 v[16:31], a[76:79], v[60:63], v[16:31]
    ds_read_b128 v[56:59], v9 offset:26624
    v_mfma_f32_32x32x16_bf16 v[32:47], a[220:223], v[60:63], v[32:47]
    s_waitcnt lgkmcnt(7)
    v_mfma_f32_32x32x16_bf16 v[16:31], a[80:83], v[64:67], v[16:31]
    ds_read_b128 v[60:63], v9 offset:27648
    v_mfma_f32_32x32x16_bf16 v[32:47], a[224:227], v[64:67], v[32:47]
    s_waitcnt lgkmcnt(7)
    v_mfma_f32_32x32x16_bf16 v[16:31], a[84:87], v[68:71], v[16:31]
    ds_read_b128 v[64:67], v9 offset:28672
    v_mfma_f32_32x32x16_bf16 v[32:47], a[228:231], v[68:71], v[32:47]
    s_waitcnt lgkmcnt(6)
    v_mfma_f32_32x32x16_bf16 v[16:31], a[88:91], v[72:75], v[16:31]
    ds_read_b128 v[68:71], v9 offset:29696
    v_mfma_f32_32x32x16_bf16 v[32:47], a[232:235], v[72:75], v[32:47]
    s_waitcnt lgkmcnt(6)
    v_mfma_f32_32x32x16_bf16 v[16:31], a[92:95], v[76:79], v[16:31]
    ds_read_b128 v[72:75], v9 offset:30720
    v_mfma_f32_32x32x16_bf16 v[32:47], a[236:239], v[76:79], v[32:47]
    s_waitcnt lgkmcnt(6)
    v_mfma_f32_32x32x16_bf16 v[16:31], a[96:99], v[48:51], v[16:31]
    ds_read_b128 v[76:79], v9 offset:31744
    v_mfma_f32_32x32x16_bf16 v[32:47], a[240:243], v[48:51], v[32:47]
    s_waitcnt lgkmcnt(6)
    v_mfma_f32_32x32x16_bf16 v[16:31], a[100:103], v[52:55], v[16:31]
    ds_read_b128 v[48:51], v9 offset:32768
    v_mfma_f32_32x32x16_bf16 v[32:47], a[244:247], v[52:55], v[32:47]
    s_waitcnt lgkmcnt(6)
    v_mfma_f32_32x32x16_bf16 v[16:31], a[104:107], v[56:59], v[16:31]
    ds_read_b128 v[52:55], v9 offset:33792
    v_mfma_f32_32x32x16_bf16 v[32:47], a[248:251], v[56:59], v[32:47]
    s_waitcnt lgkmcnt(6)
    v_mfma_f32_32x32x16_bf16 v[16:31], a[108:111], v[60:63], v[16:31]
    ds_read_b128 v[56:59], v9 offset:34816
    v_mfma_f32_32x32x16_bf16 v[32:47], a[252:255], v[60:63], v[32:47]
    s_waitcnt lgkmcnt(6)
    v_mfma_f32_32x32x16_bf16 v[16:31], a[112:115], v[64:67], v[16:31]
    ds_read_b128 v[60:63], v9 offset:35840
    v_mfma_f32_32x32x16_bf16 v[32:47], v[152:155], v[64:67], v[32:47]
    s_waitcnt lgkmcnt(6)
    v_mfma_f32_32x32x16_bf16 v[16:31], a[116:119], v[68:71], v[16:31]
    v_mfma_f32_32x32x16_bf16 v[32:47], v[156:159], v[68:71], v[32:47]
    s_waitcnt lgkmcnt(5)
    v_mfma_f32_32x32x16_bf16 v[16:31], a[120:123], v[72:75], v[16:31]
    v_mfma_f32_32x32x16_bf16 v[32:47], v[160:163], v[72:75], v[32:47]
    s_waitcnt lgkmcnt(4)
    v_mfma_f32_32x32x16_bf16 v[16:31], a[124:127], v[76:79], v[16:31]
    v_cmp_eq_u32 s[76:77], 1, v2
    v_cmp_eq_u32 vcc, 2, v2
    s_cmp_eq_u64 s[76:77], -1
    s_cselect_b32 s38, 1, 0
    v_mfma_f32_32x32x16_bf16 v[32:47], v[164:167], v[76:79], v[32:47]
    s_cmp_lg_u32 s38, 0
    s_cselect_b64 exec, 1, 0
    v_mov_b32 v15, s32
    ds_write_b32 v184, v15
    v_mov_b32 v2, 2
    s_mov_b64 exec, -1
    s_waitcnt lgkmcnt(4)
    v_mfma_f32_32x32x16_bf16 v[16:31], a[128:131], v[48:51], v[16:31]
    s_add_u32 s32, s32, s38
    s_mul_i32 s38, s38, 22528
    s_add_u32 s33, s33, s38
    s_cmp_eq_u64 vcc, 0
    s_cselect_b32 s38, s32, 0x7fff
    v_mfma_f32_32x32x16_bf16 v[32:47], v[168:171], v[48:51], v[32:47]
    s_cmp_le_u32 s38, s39
    s_cselect_b64 exec, -1, 0
    v_mov_b32 v2, 2
    buffer_load_dword v2, v1, s[8:11], s33 offen sc1
    s_mov_b64 exec, -1
    s_waitcnt lgkmcnt(3)
    v_mfma_f32_32x32x16_bf16 v[16:31], a[132:135], v[52:55], v[16:31]
    v_mfma_f32_32x32x16_bf16 v[32:47], v[172:175], v[52:55], v[32:47]
    s_waitcnt lgkmcnt(2)
    v_mfma_f32_32x32x16_bf16 v[16:31], a[136:139], v[56:59], v[16:31]
    v_mfma_f32_32x32x16_bf16 v[32:47], v[176:179], v[56:59], v[32:47]
    s_waitcnt lgkmcnt(1)
    v_mfma_f32_32x32x16_bf16 v[16:31], a[140:143], v[60:63], v[16:31]
    v_mfma_f32_32x32x16_bf16 v[32:47], v[180:183], v[60:63], v[32:47]
    s_nop 3
    v_cvt_pk_bf16_f32 v108, v16, v17
    v_cvt_pk_bf16_f32 v109, v18, v19
    v_cvt_pk_bf16_f32 v110, v20, v21
    v_cvt_pk_bf16_f32 v111, v22, v23
    buffer_store_dwordx4 v[108:111], v12, s[8:11], s46 offen offset:0 sc1
    v_cvt_pk_bf16_f32 v112, v24, v25
    v_cvt_pk_bf16_f32 v113, v26, v27
    v_cvt_pk_bf16_f32 v114, v28, v29
    v_cvt_pk_bf16_f32 v115, v30, v31
    buffer_store_dwordx4 v[112:115], v12, s[8:11], s46 offen offset:1024 sc1
    v_cvt_pk_bf16_f32 v116, v32, v33
    v_cvt_pk_bf16_f32 v117, v34, v35
    v_cvt_pk_bf16_f32 v118, v36, v37
    v_cvt_pk_bf16_f32 v119, v38, v39
    buffer_store_dwordx4 v[116:119], v13, s[8:11], s46 offen offset:0 sc1
    v_cvt_pk_bf16_f32 v120, v40, v41
    v_cvt_pk_bf16_f32 v121, v42, v43
    v_cvt_pk_bf16_f32 v122, v44, v45
    v_cvt_pk_bf16_f32 v123, v46, v47
    buffer_store_dwordx4 v[120:123], v13, s[8:11], s46 offen offset:1024 sc1
    v_mov_b32 v104, 0x3f803f80
    v_mov_b32 v96, 0
    v_mov_b32 v97, 0
    v_mov_b32 v100, 0
    v_mov_b32 v101, 0
    v_dot2c_f32_bf16 v96, v108, v104
    v_dot2c_f32_bf16 v97, v108, v108
    v_dot2c_f32_bf16 v100, v116, v104
    v_dot2c_f32_bf16 v101, v116, v116
    v_dot2c_f32_bf16 v96, v109, v104
    v_dot2c_f32_bf16 v97, v109, v109
    v_dot2c_f32_bf16 v100, v117, v104
    v_dot2c_f32_bf16 v101, v117, v117
    v_dot2c_f32_bf16 v96, v110, v104
    v_dot2c_f32_bf16 v97, v110, v110
    v_dot2c_f32_bf16 v100, v118, v104
    v_dot2c_f32_bf16 v101, v118, v118
    v_dot2c_f32_bf16 v96, v111, v104
    v_dot2c_f32_bf16 v97, v111, v111
    v_dot2c_f32_bf16 v100, v119, v104
    v_dot2c_f32_bf16 v101, v119, v119
    v_dot2c_f32_bf16 v96, v112, v104
    v_dot2c_f32_bf16 v97, v112, v112
    v_dot2c_f32_bf16 v100, v120, v104
    v_dot2c_f32_bf16 v101, v120, v120
    v_dot2c_f32_bf16 v96, v113, v104
    v_dot2c_f32_bf16 v97, v113, v113
    v_dot2c_f32_bf16 v100, v121, v104
    v_dot2c_f32_bf16 v101, v121, v121
    v_dot2c_f32_bf16 v96, v114, v104
    v_dot2c_f32_bf16 v97, v114, v114
    v_dot2c_f32_bf16 v100, v122, v104
    v_dot2c_f32_bf16 v101, v122, v122
    v_dot2c_f32_bf16 v96, v115, v104
    v_dot2c_f32_bf16 v97, v115, v115
    v_dot2c_f32_bf16 v100, v123, v104
    v_dot2c_f32_bf16 v101, v123, v123
    s_nop 2
    v_mov_b32 v98, v96
    v_mov_b32 v99, v97
    v_mov_b32 v102, v100
    v_mov_b32 v103, v101
    v_permlane32_swap_b32 v96, v98
    v_permlane32_swap_b32 v97, v99
    v_permlane32_swap_b32 v100, v102
    v_permlane32_swap_b32 v101, v103
    v_add_f32 v96, v96, v98
    v_add_f32 v97, v97, v99
    buffer_store_dwordx2 v[96:97], v10, s[8:11], s52 offen sc1
    v_add_f32 v100, v100, v102
    v_add_f32 v101, v101, v103
    buffer_store_dwordx2 v[100:101], v11, s[8:11], s52 offen sc1
    s_mul_i32 s43, s57, 22528
    s_add_u32 s43, s43, s49
    s_branch Lawo_head
Lawo_f_6:
    v_mfma_f32_32x32x16_bf16 v[16:31], a[76:79], v[60:63], v[16:31]
    s_add_u32 m0, s59, 0
    s_add_u32 s47, s41, 0
    buffer_load_dwordx4 v0, s[8:11], s47 offen offset:0 lds
    ds_read_b128 v[56:59], v9 offset:26624
    v_mfma_f32_32x32x16_bf16 v[32:47], a[220:223], v[60:63], v[32:47]
    v_mfma_f32_32x32x16_bf16 v[16:31], a[80:83], v[64:67], v[16:31]
    buffer_load_dwordx4 v0, s[8:11], s47 offen offset:1024 lds
    ds_read_b128 v[60:63], v9 offset:27648
    v_mfma_f32_32x32x16_bf16 v[32:47], a[224:227], v[64:67], v[32:47]
    v_mfma_f32_32x32x16_bf16 v[16:31], a[84:87], v[68:71], v[16:31]
    buffer_load_dwordx4 v0, s[8:11], s47 offen offset:2048 lds
    ds_read_b128 v[64:67], v9 offset:28672
    v_mfma_f32_32x32x16_bf16 v[32:47], a[228:231], v[68:71], v[32:47]
    v_mfma_f32_32x32x16_bf16 v[16:31], a[88:91], v[72:75], v[16:31]
    buffer_load_dwordx4 v0, s[8:11], s47 offen offset:3072 lds
    ds_read_b128 v[68:71], v9 offset:29696
    v_mfma_f32_32x32x16_bf16 v[32:47], a[232:235], v[72:75], v[32:47]
    v_mfma_f32_32x32x16_bf16 v[16:31], a[92:95], v[76:79], v[16:31]
    s_add_u32 m0, s59, 4096
    s_add_u32 s47, s41, 4096
    buffer_load_dwordx4 v0, s[8:11], s47 offen offset:0 lds
    ds_read_b128 v[72:75], v9 offset:30720
    v_mfma_f32_32x32x16_bf16 v[32:47], a[236:239], v[76:79], v[32:47]
    s_waitcnt lgkmcnt(6)
    v_mfma_f32_32x32x16_bf16 v[16:31], a[96:99], v[48:51], v[16:31]
    buffer_load_dwordx4 v0, s[8:11], s47 offen offset:1024 lds
    ds_read_b128 v[76:79], v9 offset:31744
    v_mfma_f32_32x32x16_bf16 v[32:47], a[240:243], v[48:51], v[32:47]
    s_waitcnt lgkmcnt(6)
    v_mfma_f32_32x32x16_bf16 v[16:31], a[100:103], v[52:55], v[16:31]
    buffer_load_dwordx4 v0, s[8:11], s47 offen offset:2048 lds
    ds_read_b128 v[48:51], v9 offset:32768
    v_mfma_f32_32x32x16_bf16 v[32:47], a[244:247], v[52:55], v[32:47]
    s_waitcnt lgkmcnt(6)
    v_mfma_f32_32x32x16_bf16 v[16:31], a[104:107], v[56:59], v[16:31]
    buffer_load_dwordx4 v0, s[8:11], s47 offen offset:3072 lds
    ds_read_b128 v[52:55], v9 offset:33792
    v_mfma_f32_32x32x16_bf16 v[32:47], a[248:251], v[56:59], v[32:47]
    s_waitcnt lgkmcnt(6)
    v_mfma_f32_32x32x16_bf16 v[16:31], a[108:111], v[60:63], v[16:31]
    s_add_u32 m0, s59, 8192
    s_add_u32 s47, s41, 8192
    buffer_load_dwordx4 v0, s[8:11], s47 offen offset:0 lds
    ds_read_b128 v[56:59], v9 offset:34816
    v_mfma_f32_32x32x16_bf16 v[32:47], a[252:255], v[60:63], v[32:47]
    s_waitcnt lgkmcnt(6)
    v_mfma_f32_32x32x16_bf16 v[16:31], a[112:115], v[64:67], v[16:31]
    ds_read_b128 v[60:63], v9 offset:35840
    v_mfma_f32_32x32x16_bf16 v[32:47], v[152:155], v[64:67], v[32:47]
    s_mul_i32 s48, s36, 4718592
    s_mul_i32 s18, s37, 36864
    s_add_u32 s48, s48, s18
    s_add_u32 s48, s48, 6291456
    buffer_load_dwordx4 v[80:83], v12, s[8:11], s48 offen offset:0
    s_waitcnt lgkmcnt(6)
    v_mfma_f32_32x32x16_bf16 v[16:31], a[116:119], v[68:71], v[16:31]
    buffer_load_dwordx4 v[84:87], v12, s[8:11], s48 offen offset:1024
    v_mfma_f32_32x32x16_bf16 v[32:47], v[156:159], v[68:71], v[32:47]
    s_waitcnt lgkmcnt(5)
    v_mfma_f32_32x32x16_bf16 v[16:31], a[120:123], v[72:75], v[16:31]
    buffer_load_dwordx4 v[88:91], v13, s[8:11], s48 offen offset:0
    v_mfma_f32_32x32x16_bf16 v[32:47], v[160:163], v[72:75], v[32:47]
    s_waitcnt lgkmcnt(4)
    v_mfma_f32_32x32x16_bf16 v[16:31], a[124:127], v[76:79], v[16:31]
    buffer_load_dwordx4 v[92:95], v13, s[8:11], s48 offen offset:1024
    v_cmp_eq_u32 s[76:77], 1, v2
    v_cmp_eq_u32 vcc, 2, v2
    s_cmp_eq_u64 s[76:77], -1
    s_cselect_b32 s38, 1, 0
    v_mfma_f32_32x32x16_bf16 v[32:47], v[164:167], v[76:79], v[32:47]
    s_cmp_lg_u32 s38, 0
    s_cselect_b64 exec, 1, 0
    v_mov_b32 v15, s32
    ds_write_b32 v184, v15
    v_mov_b32 v2, 2
    s_mov_b64 exec, -1
    s_waitcnt lgkmcnt(4)
    v_mfma_f32_32x32x16_bf16 v[16:31], a[128:131], v[48:51], v[16:31]
    s_add_u32 s32, s32, s38
    s_mul_i32 s38, s38, 22528
    s_add_u32 s33, s33, s38
    s_cmp_eq_u64 vcc, 0
    s_cselect_b32 s38, s32, 0x7fff
    v_mfma_f32_32x32x16_bf16 v[32:47], v[168:171], v[48:51], v[32:47]
    s_cmp_le_u32 s38, s39
    s_cselect_b64 exec, -1, 0
    v_mov_b32 v2, 2
    buffer_load_dword v2, v1, s[8:11], s33 offen sc1
    s_mov_b64 exec, -1
    s_waitcnt lgkmcnt(3)
    v_mfma_f32_32x32x16_bf16 v[16:31], a[132:135], v[52:55], v[16:31]
    v_mfma_f32_32x32x16_bf16 v[32:47], v[172:175], v[52:55], v[32:47]
    s_waitcnt lgkmcnt(2)
    v_mfma_f32_32x32x16_bf16 v[16:31], a[136:139], v[56:59], v[16:31]
    v_mfma_f32_32x32x16_bf16 v[32:47], v[176:179], v[56:59], v[32:47]
    s_waitcnt lgkmcnt(1)
    v_mfma_f32_32x32x16_bf16 v[16:31], a[140:143], v[60:63], v[16:31]
    v_mfma_f32_32x32x16_bf16 v[32:47], v[180:183], v[60:63], v[32:47]
    s_nop 3
    v_cvt_pk_bf16_f32 v108, v16, v17
    v_cvt_pk_bf16_f32 v109, v18, v19
    v_cvt_pk_bf16_f32 v110, v20, v21
    v_cvt_pk_bf16_f32 v111, v22, v23
    buffer_store_dwordx4 v[108:111], v12, s[8:11], s46 offen offset:0 sc1
    v_cvt_pk_bf16_f32 v112, v24, v25
    v_cvt_pk_bf16_f32 v113, v26, v27
    v_cvt_pk_bf16_f32 v114, v28, v29
    v_cvt_pk_bf16_f32 v115, v30, v31
    buffer_store_dwordx4 v[112:115], v12, s[8:11], s46 offen offset:1024 sc1
    v_cvt_pk_bf16_f32 v116, v32, v33
    v_cvt_pk_bf16_f32 v117, v34, v35
    v_cvt_pk_bf16_f32 v118, v36, v37
    v_cvt_pk_bf16_f32 v119, v38, v39
    buffer_store_dwordx4 v[116:119], v13, s[8:11], s46 offen offset:0 sc1
    v_cvt_pk_bf16_f32 v120, v40, v41
    v_cvt_pk_bf16_f32 v121, v42, v43
    v_cvt_pk_bf16_f32 v122, v44, v45
    v_cvt_pk_bf16_f32 v123, v46, v47
    buffer_store_dwordx4 v[120:123], v13, s[8:11], s46 offen offset:1024 sc1
    v_mov_b32 v104, 0x3f803f80
    v_mov_b32 v96, 0
    v_mov_b32 v97, 0
    v_mov_b32 v100, 0
    v_mov_b32 v101, 0
    v_dot2c_f32_bf16 v96, v108, v104
    v_dot2c_f32_bf16 v97, v108, v108
    v_dot2c_f32_bf16 v100, v116, v104
    v_dot2c_f32_bf16 v101, v116, v116
    v_dot2c_f32_bf16 v96, v109, v104
    v_dot2c_f32_bf16 v97, v109, v109
    v_dot2c_f32_bf16 v100, v117, v104
    v_dot2c_f32_bf16 v101, v117, v117
    v_dot2c_f32_bf16 v96, v110, v104
    v_dot2c_f32_bf16 v97, v110, v110
    v_dot2c_f32_bf16 v100, v118, v104
    v_dot2c_f32_bf16 v101, v118, v118
    v_dot2c_f32_bf16 v96, v111, v104
    v_dot2c_f32_bf16 v97, v111, v111
    v_dot2c_f32_bf16 v100, v119, v104
    v_dot2c_f32_bf16 v101, v119, v119
    v_dot2c_f32_bf16 v96, v112, v104
    v_dot2c_f32_bf16 v97, v112, v112
    v_dot2c_f32_bf16 v100, v120, v104
    v_dot2c_f32_bf16 v101, v120, v120
    v_dot2c_f32_bf16 v96, v113, v104
    v_dot2c_f32_bf16 v97, v113, v113
    v_dot2c_f32_bf16 v100, v121, v104
    v_dot2c_f32_bf16 v101, v121, v121
    v_dot2c_f32_bf16 v96, v114, v104
    v_dot2c_f32_bf16 v97, v114, v114
    v_dot2c_f32_bf16 v100, v122, v104
    v_dot2c_f32_bf16 v101, v122, v122
    v_dot2c_f32_bf16 v96, v115, v104
    v_dot2c_f32_bf16 v97, v115, v115
    v_dot2c_f32_bf16 v100, v123, v104
    v_dot2c_f32_bf16 v101, v123, v123
    s_nop 2
    v_mov_b32 v98, v96
    v_mov_b32 v99, v97
    v_mov_b32 v102, v100
    v_mov_b32 v103, v101
    v_permlane32_swap_b32 v96, v98
    v_permlane32_swap_b32 v97, v99
    v_permlane32_swap_b32 v100, v102
    v_permlane32_swap_b32 v101, v103
    v_add_f32 v96, v96, v98
    v_add_f32 v97, v97, v99
    buffer_store_dwordx2 v[96:97], v10, s[8:11], s52 offen sc1
    v_add_f32 v100, v100, v102
    v_add_f32 v101, v101, v103
    buffer_store_dwordx2 v[100:101], v11, s[8:11], s52 offen sc1
    s_mul_i32 s43, s57, 22528
    s_add_u32 s43, s43, s49
    s_branch Lawo_head
Lawo_none:
    ds_read_b32 v15, v184
    s_waitcnt lgkmcnt(0)
    v_readfirstlane_b32 s17, v15
    s_nop 0
    s_cmp_lt_i32 s17, s37
    s_cbranch_scc1 Lawo_nopost
    s_add_u32 m0, s59, 0
    s_add_u32 s47, s41, 0
    buffer_load_dwordx4 v0, s[8:11], s47 offen offset:0 lds
    buffer_load_dwordx4 v0, s[8:11], s47 offen offset:1024 lds
    buffer_load_dwordx4 v0, s[8:11], s47 offen offset:2048 lds
    buffer_load_dwordx4 v0, s[8:11], s47 offen offset:3072 lds
    s_add_u32 m0, s59, 4096
    s_add_u32 s47, s41, 4096
    buffer_load_dwordx4 v0, s[8:11], s47 offen offset:0 lds
    buffer_load_dwordx4 v0, s[8:11], s47 offen offset:1024 lds
    buffer_load_dwordx4 v0, s[8:11], s47 offen offset:2048 lds
    buffer_load_dwordx4 v0, s[8:11], s47 offen offset:3072 lds
    s_add_u32 m0, s59, 8192
    s_add_u32 s47, s41, 8192
    buffer_load_dwordx4 v0, s[8:11], s47 offen offset:0 lds
    s_mul_i32 s48, s36, 4718592
    s_mul_i32 s18, s37, 36864
    s_add_u32 s48, s48, s18
    s_add_u32 s48, s48, 6291456
    buffer_load_dwordx4 v[80:83], v12, s[8:11], s48 offen offset:0
    buffer_load_dwordx4 v[84:87], v12, s[8:11], s48 offen offset:1024
    buffer_load_dwordx4 v[88:91], v13, s[8:11], s48 offen offset:0
    buffer_load_dwordx4 v[92:95], v13, s[8:11], s48 offen offset:1024
    s_waitcnt vmcnt(13)
    s_cmp_lg_u32 s43, 0
    s_cselect_b64 exec, 3, 0
    buffer_store_dword v3, v185, s[8:11], s43 offen sc1
    s_mov_b64 exec, -1
    s_mov_b32 s43, 0
    s_waitcnt vmcnt(1) lgkmcnt(0)
    s_branch Lawo_head2
Lawo_nopost:
    s_waitcnt vmcnt(0)
    s_cmp_lg_u32 s43, 0
    s_cselect_b64 exec, 3, 0
    buffer_store_dword v3, v185, s[8:11], s43 offen sc1
    s_mov_b64 exec, -1
    s_mov_b32 s43, 0
    s_cmp_ge_u32 s37, 64
    s_cbranch_scc1 Lawo_end
Lawo_wait:
    s_mov_b32 s16, 0
    s_cmp_lg_u32 s14, 0
    s_cbranch_scc1 Lawo_wl
Lawo_wp:
    buffer_load_dword v2, v1, s[8:11], s60 offen sc1
    s_add_u32 s16, s16, 1
    s_cmp_gt_u32 s16, 100000
    s_cbranch_scc1 Lawo_giveup
    s_waitcnt vmcnt(0)
    v_cmp_eq_u32 vcc, 0, v2
    s_nop 0
    s_cbranch_vccz Lawo_wok
    s_sleep 4
    s_branch Lawo_wp
Lawo_giveup:
    v_mov_b32 v5, -2
    ds_write_b32 v184, v5
    s_waitcnt lgkmcnt(0)
    s_branch L_role_awo_abort
Lawo_wok:
    v_mov_b32 v5, s37
    ds_write_b32 v184, v5
    s_branch Lawo_go
Lawo_wl:
    ds_read_b32 v15, v184
    s_add_u32 s16, s16, 1
    s_cmp_gt_u32 s16, 1600000
    s_cbranch_scc1 L_role_awo_abort
    s_waitcnt lgkmcnt(0)
    v_readfirstlane_b32 s17, v15
    s_nop 0
    s_cmp_eq_u32 s17, -2
    s_cbranch_scc1 L_role_awo_abort
    s_cmp_ge_i32 s17, s37
    s_cbranch_scc1 Lawo_go
    s_sleep 1
    s_branch Lawo_wl
Lawo_go:
    s_add_u32 m0, s59, 0
    s_add_u32 s47, s41, 0
    buffer_load_dwordx4 v0, s[8:11], s47 offen offset:0 lds
    buffer_load_dwordx4 v0, s[8:11], s47 offen offset:1024 lds
    buffer_load_dwordx4 v0, s[8:11], s47 offen offset:2048 lds
    buffer_load_dwordx4 v0, s[8:11], s47 offen offset:3072 lds
    s_add_u32 m0, s59, 4096
    s_add_u32 s47, s41, 4096
    buffer_load_dwordx4 v0, s[8:11], s47 offen offset:0 lds
    buffer_load_dwordx4 v0, s[8:11], s47 offen offset:1024 lds
    buffer_load_dwordx4 v0, s[8:11], s47 offen offset:2048 lds
    buffer_load_dwordx4 v0, s[8:11], s47 offen offset:3072 lds
    s_add_u32 m0, s59, 8192
    s_add_u32 s47, s41, 8192
    buffer_load_dwordx4 v0, s[8:11], s47 offen offset:0 lds
    s_mul_i32 s48, s36, 4718592
    s_mul_i32 s18, s37, 36864
    s_add_u32 s48, s48, s18
    s_add_u32 s48, s48, 6291456
    buffer_load_dwordx4 v[80:83], v12, s[8:11], s48 offen offset:0
    buffer_load_dwordx4 v[84:87], v12, s[8:11], s48 offen offset:1024
    buffer_load_dwordx4 v[88:91], v13, s[8:11], s48 offen offset:0
    buffer_load_dwordx4 v[92:95], v13, s[8:11], s48 offen offset:1024
    s_waitcnt vmcnt(0) lgkmcnt(0)
    s_branch Lawo_head2
Lawo_end:
    s_branch L_role_awo_exit
L_role_awo_abort:
    s_waitcnt lgkmcnt(0)
    s_mov_b64 exec, -1
    v_mov_b32 v0, 60
    s_lshl_b32 s5, s3, 8
    s_or_b32 s5, s5, s4
    s_or_b32 s5, s5, 0x10000
    v_mov_b32 v1, s5
    global_store_dword v0, v1, s[12:13]
    s_endpgm
L_role_awo_exit:
    s_endpgm
.p2align 6
L_role_aq:
    v_and_b32 v5, 63, v0
    v_lshlrev_b32 v0, 4, v5
    v_and_b32 v7, 15, v5
    v_lshrrev_b32 v8, 4, v5
    v_min_u32 v1, 47, v5
    v_lshrrev_b32 v6, 2, v1
    v_and_b32 v1, 3, v1
    v_lshlrev_b32 v1, 2, v1
    v_lshl_add_u32 v1, v6, 7, v1
    v_mov_b32 v3, 1
    v_mov_b32 v4, 0
    s_mov_b32 s44, 0x05040100
    s_mov_b32 s45, 0x07060302
    s_lshr_b32 s63, s15, 4
    s_and_b32 s15, s15, 15
    s_lshr_b32 s50, s15, 1
    s_lshl_b32 s50, s50, 2
    s_and_b32 s17, s15, 1
    s_add_u32 s50, s50, s17
    s_and_b32 s17, s14, 2
    s_add_u32 s50, s50, s17
    s_and_b32 s51, s14, 1
    s_cmp_eq_u32 s63, 0
    s_cbranch_scc1 Laq_gate_ng
    s_cmp_lg_u32 s14, 0
    s_cbranch_scc1 Laq_gate_d
    v_mov_b32 v5, 48
    s_mov_b32 s16, 0
Laq_gate:
    global_load_dword v6, v5, s[12:13] sc1
    s_add_u32 s16, s16, 1
    s_cmp_gt_u32 s16, 100000
    s_cbranch_scc1 L_role_aq_abort
    s_waitcnt vmcnt(0)
    v_cmp_gt_u32 vcc, 32, v6
    s_nop 0
    s_cbranch_vccz Laq_gate_d
    s_sleep 100
    s_branch Laq_gate
Laq_gate_d:
    s_barrier
Laq_gate_ng:
    s_load_dwordx2 s[20:21], s[0:1], 8
    s_mov_b32 s22, 1990656
    s_mov_b32 s23, 0x00020000
    s_waitcnt lgkmcnt(0)
    s_and_b32 s21, s21, 0xffff
    v_lshrrev_b32 v5, 7, v0
    v_mul_u32_u24 v16, 3456, v5
    v_and_b32 v5, 0x70, v0
    v_add_u32 v16, v16, v5
    s_lshr_b32 s17, s14, 1
    s_mul_i32 s46, s17, 72
    v_lshrrev_b32 v5, 2, v7
    v_lshl_add_u32 v5, v8, 3, v5
    v_and_b32 v6, 3, v7
    v_lshlrev_b32 v17, 7, v5
    v_lshl_add_u32 v17, v6, 3, v17
    v_add_u32 v17, s46, v17
    v_lshlrev_b32 v18, 5, v5
    v_min_u32 v6, 1, v6
    v_lshl_add_u32 v18, v6, 4, v18
    s_mul_i32 s17, s17, 3072
    s_add_u32 s17, s17, 36864
    v_add_u32 v18, s17, v18
    s_sub_u32 s17, s50, s14
    s_lshr_b32 s17, s14, 1
    s_lshl_b32 s17, s17, 1
    s_sub_u32 s17, s50, s17
    s_mul_i32 s49, s17, 36
    s_mul_i32 s17, s14, 82944
    s_add_u32 s49, s49, s17
    s_mul_i32 s47, s14, 3072
    v_lshrrev_b32 v21, 4, v0
    s_lshl_b32 s17, s14, 6
    v_add_u32 v21, s17, v21
    v_cmp_le_u32 vcc, 96, v21
    s_nop 1
    v_cndmask_b32 v5, 0, 1, vcc
    v_mul_u32_u24 v6, 96, v5
    v_sub_u32 v6, v21, v6
    v_lshlrev_b32 v19, 7, v6
    v_mul_u32_u24 v20, 72, v5
    v_add_u32 v19, v19, v20
    v_add_u32 v19, 32, v19
    v_lshlrev_b32 v20, 5, v21
    v_add_u32 v20, 36864, v20
    v_mov_b32 v24, 0
    v_mov_b32 v25, 0
    v_mov_b32 v26, 0
    v_mov_b32 v27, 0
    v_mov_b32 v31, 0
    s_cmp_eq_u32 s14, 3
    s_cselect_b64 s[76:77], 0, -1
    s_mov_b64 exec, s[76:77]
    v_add_u32 v22, 0, v20
    ds_write_b128 v22, v[24:27] offset:16
    v_add_u32 v22, 43008, v20
    ds_write_b128 v22, v[24:27] offset:16
    v_add_u32 v22, 86016, v20
    ds_write_b128 v22, v[24:27] offset:16
    s_mov_b64 exec, -1
    s_add_u32 m0, s47, 0
    s_add_u32 s17, s49, 0
    buffer_load_dwordx4 v16, s[20:23], s17 offen lds
    s_add_u32 m0, s47, 1024
    s_add_u32 s17, s49, 27648
    buffer_load_dwordx4 v16, s[20:23], s17 offen lds
    s_add_u32 m0, s47, 2048
    s_add_u32 s17, s49, 55296
    buffer_load_dwordx4 v16, s[20:23], s17 offen lds
    s_add_u32 m0, s47, 12288
    s_add_u32 s17, s49, 1152
    buffer_load_dwordx4 v16, s[20:23], s17 offen lds
    s_add_u32 m0, s47, 13312
    s_add_u32 s17, s49, 28800
    buffer_load_dwordx4 v16, s[20:23], s17 offen lds
    s_add_u32 m0, s47, 14336
    s_add_u32 s17, s49, 56448
    buffer_load_dwordx4 v16, s[20:23], s17 offen lds
    s_add_u32 m0, s47, 24576
    s_add_u32 s17, s49, 2304
    buffer_load_dwordx4 v16, s[20:23], s17 offen lds
    s_add_u32 m0, s47, 25600
    s_add_u32 s17, s49, 29952
    buffer_load_dwordx4 v16, s[20:23], s17 offen lds
    s_add_u32 m0, s47, 26624
    s_add_u32 s17, s49, 57600
    buffer_load_dwordx4 v16, s[20:23], s17 offen lds
    s_add_u32 m0, s47, 43008
    s_add_u32 s17, s49, 331776
    buffer_load_dwordx4 v16, s[20:23], s17 offen lds
    s_add_u32 m0, s47, 44032
    s_add_u32 s17, s49, 359424
    buffer_load_dwordx4 v16, s[20:23], s17 offen lds
    s_add_u32 m0, s47, 45056
    s_add_u32 s17, s49, 387072
    buffer_load_dwordx4 v16, s[20:23], s17 offen lds
    s_add_u32 m0, s47, 55296
    s_add_u32 s17, s49, 332928
    buffer_load_dwordx4 v16, s[20:23], s17 offen lds
    s_add_u32 m0, s47, 56320
    s_add_u32 s17, s49, 360576
    buffer_load_dwordx4 v16, s[20:23], s17 offen lds
    s_add_u32 m0, s47, 57344
    s_add_u32 s17, s49, 388224
    buffer_load_dwordx4 v16, s[20:23], s17 offen lds
    s_add_u32 m0, s47, 67584
    s_add_u32 s17, s49, 334080
    buffer_load_dwordx4 v16, s[20:23], s17 offen lds
    s_add_u32 m0, s47, 68608
    s_add_u32 s17, s49, 361728
    buffer_load_dwordx4 v16, s[20:23], s17 offen lds
    s_add_u32 m0, s47, 69632
    s_add_u32 s17, s49, 389376
    buffer_load_dwordx4 v16, s[20:23], s17 offen lds
    s_add_u32 m0, s47, 86016
    s_add_u32 s17, s49, 663552
    buffer_load_dwordx4 v16, s[20:23], s17 offen lds
    s_add_u32 m0, s47, 87040
    s_add_u32 s17, s49, 691200
    buffer_load_dwordx4 v16, s[20:23], s17 offen lds
    s_add_u32 m0, s47, 88064
    s_add_u32 s17, s49, 718848
    buffer_load_dwordx4 v16, s[20:23], s17 offen lds
    s_add_u32 m0, s47, 98304
    s_add_u32 s17, s49, 664704
    buffer_load_dwordx4 v16, s[20:23], s17 offen lds
    s_add_u32 m0, s47, 99328
    s_add_u32 s17, s49, 692352
    buffer_load_dwordx4 v16, s[20:23], s17 offen lds
    s_add_u32 m0, s47, 100352
    s_add_u32 s17, s49, 720000
    buffer_load_dwordx4 v16, s[20:23], s17 offen lds
    s_add_u32 m0, s47, 110592
    s_add_u32 s17, s49, 665856
    buffer_load_dwordx4 v16, s[20:23], s17 offen lds
    s_add_u32 m0, s47, 111616
    s_add_u32 s17, s49, 693504
    buffer_load_dwordx4 v16, s[20:23], s17 offen lds
    s_add_u32 m0, s47, 112640
    s_add_u32 s17, s49, 721152
    buffer_load_dwordx4 v16, s[20:23], s17 offen lds
    s_waitcnt vmcnt(18) lgkmcnt(0)
    s_barrier
    s_mov_b64 exec, s[76:77]
    v_add_u32 v22, 0, v19
    ds_read_b32 v28, v22 offset:0
    ds_read_b32 v29, v22 offset:12288
    ds_read_b32 v30, v22 offset:24576
    s_waitcnt lgkmcnt(0)
    v_add_u32 v22, 0, v20
    ds_write_b128 v22, v[28:31]
    s_mov_b64 exec, -1
    v_add_u32 v22, 0, v17
    v_add_u32 v23, 0, v18
    ds_read_b64_tr_b16 v[152:153], v22 offset:0
    ds_read_b64_tr_b16 v[154:155], v22 offset:512
    ds_read_b64_tr_b16 v[224:225], v22 offset:12288
    ds_read_b64_tr_b16 v[226:227], v22 offset:12800
    ds_read_b64_tr_b16 a[112:113], v22 offset:24576
    ds_read_b64_tr_b16 a[114:115], v22 offset:25088
    ds_read_b64_tr_b16 v[156:157], v22 offset:4096
    ds_read_b64_tr_b16 v[158:159], v22 offset:4608
    ds_read_b64_tr_b16 v[228:229], v22 offset:16384
    ds_read_b64_tr_b16 v[230:231], v22 offset:16896
    ds_read_b64_tr_b16 a[116:117], v22 offset:28672
    ds_read_b64_tr_b16 a[118:119], v22 offset:29184
    ds_read_b64_tr_b16 v[160:161], v22 offset:8192
    ds_read_b64_tr_b16 v[162:163], v22 offset:8704
    ds_read_b64_tr_b16 v[232:233], v22 offset:20480
    ds_read_b64_tr_b16 v[234:235], v22 offset:20992
    ds_read_b64_tr_b16 a[120:121], v22 offset:32768
    ds_read_b64_tr_b16 a[122:123], v22 offset:33280
    s_waitcnt lgkmcnt(0)
    s_barrier
    ds_read_b64_tr_b16 a[40:41], v23 offset:0
    ds_read_b64_tr_b16 a[42:43], v23 offset:128
    ds_read_b64_tr_b16 a[184:185], v23 offset:8
    ds_read_b64_tr_b16 a[186:187], v23 offset:136
    ds_read_b64_tr_b16 a[44:45], v23 offset:1024
    ds_read_b64_tr_b16 a[46:47], v23 offset:1152
    ds_read_b64_tr_b16 a[188:189], v23 offset:1032
    ds_read_b64_tr_b16 a[190:191], v23 offset:1160
    ds_read_b64_tr_b16 a[48:49], v23 offset:2048
    ds_read_b64_tr_b16 a[50:51], v23 offset:2176
    ds_read_b64_tr_b16 a[192:193], v23 offset:2056
    ds_read_b64_tr_b16 a[194:195], v23 offset:2184
    s_waitcnt vmcnt(9) lgkmcnt(0)
    s_barrier
    s_add_u32 m0, s47, 0
    s_add_u32 s17, s49, 995328
    buffer_load_dwordx4 v16, s[20:23], s17 offen lds
    s_add_u32 m0, s47, 1024
    s_add_u32 s17, s49, 1022976
    buffer_load_dwordx4 v16, s[20:23], s17 offen lds
    s_add_u32 m0, s47, 2048
    s_add_u32 s17, s49, 1050624
    buffer_load_dwordx4 v16, s[20:23], s17 offen lds
    s_add_u32 m0, s47, 12288
    s_add_u32 s17, s49, 996480
    buffer_load_dwordx4 v16, s[20:23], s17 offen lds
    s_add_u32 m0, s47, 13312
    s_add_u32 s17, s49, 1024128
    buffer_load_dwordx4 v16, s[20:23], s17 offen lds
    s_add_u32 m0, s47, 14336
    s_add_u32 s17, s49, 1051776
    buffer_load_dwordx4 v16, s[20:23], s17 offen lds
    s_add_u32 m0, s47, 24576
    s_add_u32 s17, s49, 997632
    buffer_load_dwordx4 v16, s[20:23], s17 offen lds
    s_add_u32 m0, s47, 25600
    s_add_u32 s17, s49, 1025280
    buffer_load_dwordx4 v16, s[20:23], s17 offen lds
    s_add_u32 m0, s47, 26624
    s_add_u32 s17, s49, 1052928
    buffer_load_dwordx4 v16, s[20:23], s17 offen lds
    s_mov_b64 exec, s[76:77]
    v_add_u32 v22, 43008, v19
    ds_read_b32 v28, v22 offset:0
    ds_read_b32 v29, v22 offset:12288
    ds_read_b32 v30, v22 offset:24576
    s_waitcnt lgkmcnt(0)
    v_add_u32 v22, 43008, v20
    ds_write_b128 v22, v[28:31]
    s_mov_b64 exec, -1
    v_add_u32 v22, 43008, v17
    v_add_u32 v23, 43008, v18
    ds_read_b64_tr_b16 v[164:165], v22 offset:0
    ds_read_b64_tr_b16 v[166:167], v22 offset:512
    ds_read_b64_tr_b16 v[236:237], v22 offset:12288
    ds_read_b64_tr_b16 v[238:239], v22 offset:12800
    ds_read_b64_tr_b16 a[124:125], v22 offset:24576
    ds_read_b64_tr_b16 a[126:127], v22 offset:25088
    ds_read_b64_tr_b16 v[168:169], v22 offset:4096
    ds_read_b64_tr_b16 v[170:171], v22 offset:4608
    ds_read_b64_tr_b16 v[240:241], v22 offset:16384
    ds_read_b64_tr_b16 v[242:243], v22 offset:16896
    ds_read_b64_tr_b16 a[128:129], v22 offset:28672
    ds_read_b64_tr_b16 a[130:131], v22 offset:29184
    ds_read_b64_tr_b16 v[172:173], v22 offset:8192
    ds_read_b64_tr_b16 v[174:175], v22 offset:8704
    ds_read_b64_tr_b16 v[244:245], v22 offset:20480
    ds_read_b64_tr_b16 v[246:247], v22 offset:20992
    ds_read_b64_tr_b16 a[132:133], v22 offset:32768
    ds_read_b64_tr_b16 a[134:135], v22 offset:33280
    s_waitcnt lgkmcnt(0)
    s_barrier
    ds_read_b64_tr_b16 a[52:53], v23 offset:0
    ds_read_b64_tr_b16 a[54:55], v23 offset:128
    ds_read_b64_tr_b16 a[196:197], v23 offset:8
    ds_read_b64_tr_b16 a[198:199], v23 offset:136
    ds_read_b64_tr_b16 a[56:57], v23 offset:1024
    ds_read_b64_tr_b16 a[58:59], v23 offset:1152
    ds_read_b64_tr_b16 a[200:201], v23 offset:1032
    ds_read_b64_tr_b16 a[202:203], v23 offset:1160
    ds_read_b64_tr_b16 a[60:61], v23 offset:2048
    ds_read_b64_tr_b16 a[62:63], v23 offset:2176
    ds_read_b64_tr_b16 a[204:205], v23 offset:2056
    ds_read_b64_tr_b16 a[206:207], v23 offset:2184
    s_waitcnt vmcnt(9) lgkmcnt(0)
    s_barrier
    s_add_u32 m0, s47, 43008
    s_add_u32 s17, s49, 1327104
    buffer_load_dwordx4 v16, s[20:23], s17 offen lds
    s_add_u32 m0, s47, 44032
    s_add_u32 s17, s49, 1354752
    buffer_load_dwordx4 v16, s[20:23], s17 offen lds
    s_add_u32 m0, s47, 45056
    s_add_u32 s17, s49, 1382400
    buffer_load_dwordx4 v16, s[20:23], s17 offen lds
    s_add_u32 m0, s47, 55296
    s_add_u32 s17, s49, 1328256
    buffer_load_dwordx4 v16, s[20:23], s17 offen lds
    s_add_u32 m0, s47, 56320
    s_add_u32 s17, s49, 1355904
    buffer_load_dwordx4 v16, s[20:23], s17 offen lds
    s_add_u32 m0, s47, 57344
    s_add_u32 s17, s49, 1383552
    buffer_load_dwordx4 v16, s[20:23], s17 offen lds
    s_add_u32 m0, s47, 67584
    s_add_u32 s17, s49, 1329408
    buffer_load_dwordx4 v16, s[20:23], s17 offen lds
    s_add_u32 m0, s47, 68608
    s_add_u32 s17, s49, 1357056
    buffer_load_dwordx4 v16, s[20:23], s17 offen lds
    s_add_u32 m0, s47, 69632
    s_add_u32 s17, s49, 1384704
    buffer_load_dwordx4 v16, s[20:23], s17 offen lds
    s_mov_b64 exec, s[76:77]
    v_add_u32 v22, 86016, v19
    ds_read_b32 v28, v22 offset:0
    ds_read_b32 v29, v22 offset:12288
    ds_read_b32 v30, v22 offset:24576
    s_waitcnt lgkmcnt(0)
    v_add_u32 v22, 86016, v20
    ds_write_b128 v22, v[28:31]
    s_mov_b64 exec, -1
    v_add_u32 v22, 86016, v17
    v_add_u32 v23, 86016, v18
    ds_read_b64_tr_b16 v[176:177], v22 offset:0
    ds_read_b64_tr_b16 v[178:179], v22 offset:512
    ds_read_b64_tr_b16 v[248:249], v22 offset:12288
    ds_read_b64_tr_b16 v[250:251], v22 offset:12800
    ds_read_b64_tr_b16 a[136:137], v22 offset:24576
    ds_read_b64_tr_b16 a[138:139], v22 offset:25088
    ds_read_b64_tr_b16 v[180:181], v22 offset:4096
    ds_read_b64_tr_b16 v[182:183], v22 offset:4608
    ds_read_b64_tr_b16 v[252:253], v22 offset:16384
    ds_read_b64_tr_b16 v[254:255], v22 offset:16896
    ds_read_b64_tr_b16 a[140:141], v22 offset:28672
    ds_read_b64_tr_b16 a[142:143], v22 offset:29184
    ds_read_b64_tr_b16 v[184:185], v22 offset:8192
    ds_read_b64_tr_b16 v[186:187], v22 offset:8704
    ds_read_b64_tr_b16 a[0:1], v22 offset:20480
    ds_read_b64_tr_b16 a[2:3], v22 offset:20992
    ds_read_b64_tr_b16 a[144:145], v22 offset:32768
    ds_read_b64_tr_b16 a[146:147], v22 offset:33280
    s_waitcnt lgkmcnt(0)
    s_barrier
    ds_read_b64_tr_b16 a[64:65], v23 offset:0
    ds_read_b64_tr_b16 a[66:67], v23 offset:128
    ds_read_b64_tr_b16 a[208:209], v23 offset:8
    ds_read_b64_tr_b16 a[210:211], v23 offset:136
    ds_read_b64_tr_b16 a[68:69], v23 offset:1024
    ds_read_b64_tr_b16 a[70:71], v23 offset:1152
    ds_read_b64_tr_b16 a[212:213], v23 offset:1032
    ds_read_b64_tr_b16 a[214:215], v23 offset:1160
    ds_read_b64_tr_b16 a[72:73], v23 offset:2048
    ds_read_b64_tr_b16 a[74:75], v23 offset:2176
    ds_read_b64_tr_b16 a[216:217], v23 offset:2056
    ds_read_b64_tr_b16 a[218:219], v23 offset:2184
    s_waitcnt vmcnt(9) lgkmcnt(0)
    s_barrier
    s_add_u32 m0, s47, 86016
    s_add_u32 s17, s49, 1658880
    buffer_load_dwordx4 v16, s[20:23], s17 offen lds
    s_add_u32 m0, s47, 87040
    s_add_u32 s17, s49, 1686528
    buffer_load_dwordx4 v16, s[20:23], s17 offen lds
    s_add_u32 m0, s47, 88064
    s_add_u32 s17, s49, 1714176
    buffer_load_dwordx4 v16, s[20:23], s17 offen lds
    s_add_u32 m0, s47, 98304
    s_add_u32 s17, s49, 1660032
    buffer_load_dwordx4 v16, s[20:23], s17 offen lds
    s_add_u32 m0, s47, 99328
    s_add_u32 s17, s49, 1687680
    buffer_load_dwordx4 v16, s[20:23], s17 offen lds
    s_add_u32 m0, s47, 100352
    s_add_u32 s17, s49, 1715328
    buffer_load_dwordx4 v16, s[20:23], s17 offen lds
    s_add_u32 m0, s47, 110592
    s_add_u32 s17, s49, 1661184
    buffer_load_dwordx4 v16, s[20:23], s17 offen lds
    s_add_u32 m0, s47, 111616
    s_add_u32 s17, s49, 1688832
    buffer_load_dwordx4 v16, s[20:23], s17 offen lds
    s_add_u32 m0, s47, 112640
    s_add_u32 s17, s49, 1716480
    buffer_load_dwordx4 v16, s[20:23], s17 offen lds
    s_mov_b64 exec, s[76:77]
    v_add_u32 v22, 0, v19
    ds_read_b32 v28, v22 offset:0
    ds_read_b32 v29, v22 offset:12288
    ds_read_b32 v30, v22 offset:24576
    s_waitcnt lgkmcnt(0)
    v_add_u32 v22, 0, v20
    ds_write_b128 v22, v[28:31]
    s_mov_b64 exec, -1
    v_add_u32 v22, 0, v17
    v_add_u32 v23, 0, v18
    ds_read_b64_tr_b16 v[188:189], v22 offset:0
    ds_read_b64_tr_b16 v[190:191], v22 offset:512
    ds_read_b64_tr_b16 a[4:5], v22 offset:12288
    ds_read_b64_tr_b16 a[6:7], v22 offset:12800
    ds_read_b64_tr_b16 a[148:149], v22 offset:24576
    ds_read_b64_tr_b16 a[150:151], v22 offset:25088
    ds_read_b64_tr_b16 v[192:193], v22 offset:4096
    ds_read_b64_tr_b16 v[194:195], v22 offset:4608
    ds_read_b64_tr_b16 a[8:9], v22 offset:16384
    ds_read_b64_tr_b16 a[10:11], v22 offset:16896
    ds_read_b64_tr_b16 a[152:153], v22 offset:28672
    ds_read_b64_tr_b16 a[154:155], v22 offset:29184
    ds_read_b64_tr_b16 v[196:197], v22 offset:8192
    ds_read_b64_tr_b16 v[198:199], v22 offset:8704
    ds_read_b64_tr_b16 a[12:13], v22 offset:20480
    ds_read_b64_tr_b16 a[14:15], v22 offset:20992
    ds_read_b64_tr_b16 a[156:157], v22 offset:32768
    ds_read_b64_tr_b16 a[158:159], v22 offset:33280
    s_waitcnt lgkmcnt(0)
    s_barrier
    ds_read_b64_tr_b16 a[76:77], v23 offset:0
    ds_read_b64_tr_b16 a[78:79], v23 offset:128
    ds_read_b64_tr_b16 a[220:221], v23 offset:8
    ds_read_b64_tr_b16 a[222:223], v23 offset:136
    ds_read_b64_tr_b16 a[80:81], v23 offset:1024
    ds_read_b64_tr_b16 a[82:83], v23 offset:1152
    ds_read_b64_tr_b16 a[224:225], v23 offset:1032
    ds_read_b64_tr_b16 a[226:227], v23 offset:1160
    ds_read_b64_tr_b16 a[84:85], v23 offset:2048
    ds_read_b64_tr_b16 a[86:87], v23 offset:2176
    ds_read_b64_tr_b16 a[228:229], v23 offset:2056
    ds_read_b64_tr_b16 a[230:231], v23 offset:2184
    s_waitcnt vmcnt(9) lgkmcnt(0)
    s_barrier
    s_mov_b64 exec, s[76:77]
    v_add_u32 v22, 43008, v19
    ds_read_b32 v28, v22 offset:0
    ds_read_b32 v29, v22 offset:12288
    ds_read_b32 v30, v22 offset:24576
    s_waitcnt lgkmcnt(0)
    v_add_u32 v22, 43008, v20
    ds_write_b128 v22, v[28:31]
    s_mov_b64 exec, -1
    v_add_u32 v22, 43008, v17
    v_add_u32 v23, 43008, v18
    ds_read_b64_tr_b16 v[200:201], v22 offset:0
    ds_read_b64_tr_b16 v[202:203], v22 offset:512
    ds_read_b64_tr_b16 a[16:17], v22 offset:12288
    ds_read_b64_tr_b16 a[18:19], v22 offset:12800
    ds_read_b64_tr_b16 a[160:161], v22 offset:24576
    ds_read_b64_tr_b16 a[162:163], v22 offset:25088
    ds_read_b64_tr_b16 v[204:205], v22 offset:4096
    ds_read_b64_tr_b16 v[206:207], v22 offset:4608
    ds_read_b64_tr_b16 a[20:21], v22 offset:16384
    ds_read_b64_tr_b16 a[22:23], v22 offset:16896
    ds_read_b64_tr_b16 a[164:165], v22 offset:28672
    ds_read_b64_tr_b16 a[166:167], v22 offset:29184
    ds_read_b64_tr_b16 v[208:209], v22 offset:8192
    ds_read_b64_tr_b16 v[210:211], v22 offset:8704
    ds_read_b64_tr_b16 a[24:25], v22 offset:20480
    ds_read_b64_tr_b16 a[26:27], v22 offset:20992
    ds_read_b64_tr_b16 a[168:169], v22 offset:32768
    ds_read_b64_tr_b16 a[170:171], v22 offset:33280
    s_waitcnt lgkmcnt(0)
    s_barrier
    ds_read_b64_tr_b16 a[88:89], v23 offset:0
    ds_read_b64_tr_b16 a[90:91], v23 offset:128
    ds_read_b64_tr_b16 a[232:233], v23 offset:8
    ds_read_b64_tr_b16 a[234:235], v23 offset:136
    ds_read_b64_tr_b16 a[92:93], v23 offset:1024
    ds_read_b64_tr_b16 a[94:95], v23 offset:1152
    ds_read_b64_tr_b16 a[236:237], v23 offset:1032
    ds_read_b64_tr_b16 a[238:239], v23 offset:1160
    ds_read_b64_tr_b16 a[96:97], v23 offset:2048
    ds_read_b64_tr_b16 a[98:99], v23 offset:2176
    ds_read_b64_tr_b16 a[240:241], v23 offset:2056
    ds_read_b64_tr_b16 a[242:243], v23 offset:2184
    s_waitcnt vmcnt(0) lgkmcnt(0)
    s_barrier
    s_mov_b64 exec, s[76:77]
    v_add_u32 v22, 86016, v19
    ds_read_b32 v28, v22 offset:0
    ds_read_b32 v29, v22 offset:12288
    ds_read_b32 v30, v22 offset:24576
    s_waitcnt lgkmcnt(0)
    v_add_u32 v22, 86016, v20
    ds_write_b128 v22, v[28:31]
    s_mov_b64 exec, -1
    v_add_u32 v22, 86016, v17
    v_add_u32 v23, 86016, v18
    ds_read_b64_tr_b16 v[212:213], v22 offset:0
    ds_read_b64_tr_b16 v[214:215], v22 offset:512
    ds_read_b64_tr_b16 a[28:29], v22 offset:12288
    ds_read_b64_tr_b16 a[30:31], v22 offset:12800
    ds_read_b64_tr_b16 a[172:173], v22 offset:24576
    ds_read_b64_tr_b16 a[174:175], v22 offset:25088
    ds_read_b64_tr_b16 v[216:217], v22 offset:4096
    ds_read_b64_tr_b16 v[218:219], v22 offset:4608
    ds_read_b64_tr_b16 a[32:33], v22 offset:16384
    ds_read_b64_tr_b16 a[34:35], v22 offset:16896
    ds_read_b64_tr_b16 a[176:177], v22 offset:28672
    ds_read_b64_tr_b16 a[178:179], v22 offset:29184
    ds_read_b64_tr_b16 v[220:221], v22 offset:8192
    ds_read_b64_tr_b16 v[222:223], v22 offset:8704
    ds_read_b64_tr_b16 a[36:37], v22 offset:20480
    ds_read_b64_tr_b16 a[38:39], v22 offset:20992
    ds_read_b64_tr_b16 a[180:181], v22 offset:32768
    ds_read_b64_tr_b16 a[182:183], v22 offset:33280
    s_waitcnt lgkmcnt(0)
    s_barrier
    ds_read_b64_tr_b16 a[100:101], v23 offset:0
    ds_read_b64_tr_b16 a[102:103], v23 offset:128
    ds_read_b64_tr_b16 a[244:245], v23 offset:8
    ds_read_b64_tr_b16 a[246:247], v23 offset:136
    ds_read_b64_tr_b16 a[104:105], v23 offset:1024
    ds_read_b64_tr_b16 a[106:107], v23 offset:1152
    ds_read_b64_tr_b16 a[248:249], v23 offset:1032
    ds_read_b64_tr_b16 a[250:251], v23 offset:1160
    ds_read_b64_tr_b16 a[108:109], v23 offset:2048
    ds_read_b64_tr_b16 a[110:111], v23 offset:2176
    ds_read_b64_tr_b16 a[252:253], v23 offset:2056
    ds_read_b64_tr_b16 a[254:255], v23 offset:2184
    s_waitcnt lgkmcnt(0)
    s_barrier
    v_mov_b32 v56, 0x3f803f80
    v_mov_b32 v57, 0x3f803f80
    v_mov_b32 v58, 0x3f803f80
    v_mov_b32 v59, 0x3f803f80
    s_nop 1
    v_mfma_f32_16x16x32_bf16 v[36:39], v[152:155], v[56:59], 0
    v_mfma_f32_16x16x32_bf16 v[40:43], v[224:227], v[56:59], 0
    v_mfma_f32_16x16x32_bf16 v[44:47], a[40:43], v[56:59], 0
    v_mfma_f32_16x16x32_bf16 v[48:51], v[56:59], a[112:115], 0
    v_mfma_f32_16x16x32_bf16 v[52:55], v[56:59], a[184:187], 0
    v_mfma_f32_16x16x32_bf16 v[36:39], v[156:159], v[56:59], v[36:39]
    v_mfma_f32_16x16x32_bf16 v[40:43], v[228:231], v[56:59], v[40:43]
    v_mfma_f32_16x16x32_bf16 v[44:47], a[44:47], v[56:59], v[44:47]
    v_mfma_f32_16x16x32_bf16 v[48:51], v[56:59], a[116:119], v[48:51]
    v_mfma_f32_16x16x32_bf16 v[52:55], v[56:59], a[188:191], v[52:55]
    v_mfma_f32_16x16x32_bf16 v[36:39], v[160:163], v[56:59], v[36:39]
    v_mfma_f32_16x16x32_bf16 v[40:43], v[232:235], v[56:59], v[40:43]
    v_mfma_f32_16x16x32_bf16 v[44:47], a[48:51], v[56:59], v[44:47]
    v_mfma_f32_16x16x32_bf16 v[48:51], v[56:59], a[120:123], v[48:51]
    v_mfma_f32_16x16x32_bf16 v[52:55], v[56:59], a[192:195], v[52:55]
    v_mfma_f32_16x16x32_bf16 v[36:39], v[164:167], v[56:59], v[36:39]
    v_mfma_f32_16x16x32_bf16 v[40:43], v[236:239], v[56:59], v[40:43]
    v_mfma_f32_16x16x32_bf16 v[44:47], a[52:55], v[56:59], v[44:47]
    v_mfma_f32_16x16x32_bf16 v[48:51], v[56:59], a[124:127], v[48:51]
    v_mfma_f32_16x16x32_bf16 v[52:55], v[56:59], a[196:199], v[52:55]
    v_mfma_f32_16x16x32_bf16 v[36:39], v[168:171], v[56:59], v[36:39]
    v_mfma_f32_16x16x32_bf16 v[40:43], v[240:243], v[56:59], v[40:43]
    v_mfma_f32_16x16x32_bf16 v[44:47], a[56:59], v[56:59], v[44:47]
    v_mfma_f32_16x16x32_bf16 v[48:51], v[56:59], a[128:131], v[48:51]
    v_mfma_f32_16x16x32_bf16 v[52:55], v[56:59], a[200:203], v[52:55]
    v_mfma_f32_16x16x32_bf16 v[36:39], v[172:175], v[56:59], v[36:39]
    v_mfma_f32_16x16x32_bf16 v[40:43], v[244:247], v[56:59], v[40:43]
    v_mfma_f32_16x16x32_bf16 v[44:47], a[60:63], v[56:59], v[44:47]
    v_mfma_f32_16x16x32_bf16 v[48:51], v[56:59], a[132:135], v[48:51]
    v_mfma_f32_16x16x32_bf16 v[52:55], v[56:59], a[204:207], v[52:55]
    v_mfma_f32_16x16x32_bf16 v[36:39], v[176:179], v[56:59], v[36:39]
    v_mfma_f32_16x16x32_bf16 v[40:43], v[248:251], v[56:59], v[40:43]
    v_mfma_f32_16x16x32_bf16 v[44:47], a[64:67], v[56:59], v[44:47]
    v_mfma_f32_16x16x32_bf16 v[48:51], v[56:59], a[136:139], v[48:51]
    v_mfma_f32_16x16x32_bf16 v[52:55], v[56:59], a[208:211], v[52:55]
    v_mfma_f32_16x16x32_bf16 v[36:39], v[180:183], v[56:59], v[36:39]
    v_mfma_f32_16x16x32_bf16 v[40:43], v[252:255], v[56:59], v[40:43]
    v_mfma_f32_16x16x32_bf16 v[44:47], a[68:71], v[56:59], v[44:47]
    v_mfma_f32_16x16x32_bf16 v[48:51], v[56:59], a[140:143], v[48:51]
    v_mfma_f32_16x16x32_bf16 v[52:55], v[56:59], a[212:215], v[52:55]
    v_mfma_f32_16x16x32_bf16 v[36:39], v[184:187], v[56:59], v[36:39]
    v_mfma_f32_16x16x32_bf16 v[40:43], a[0:3], v[56:59], v[40:43]
    v_mfma_f32_16x16x32_bf16 v[44:47], a[72:75], v[56:59], v[44:47]
    v_mfma_f32_16x16x32_bf16 v[48:51], v[56:59], a[144:147], v[48:51]
    v_mfma_f32_16x16x32_bf16 v[52:55], v[56:59], a[216:219], v[52:55]
    v_mfma_f32_16x16x32_bf16 v[36:39], v[188:191], v[56:59], v[36:39]
    v_mfma_f32_16x16x32_bf16 v[40:43], a[4:7], v[56:59], v[40:43]
    v_mfma_f32_16x16x32_bf16 v[44:47], a[76:79], v[56:59], v[44:47]
    v_mfma_f32_16x16x32_bf16 v[48:51], v[56:59], a[148:151], v[48:51]
    v_mfma_f32_16x16x32_bf16 v[52:55], v[56:59], a[220:223], v[52:55]
    v_mfma_f32_16x16x32_bf16 v[36:39], v[192:195], v[56:59], v[36:39]
    v_mfma_f32_16x16x32_bf16 v[40:43], a[8:11], v[56:59], v[40:43]
    v_mfma_f32_16x16x32_bf16 v[44:47], a[80:83], v[56:59], v[44:47]
    v_mfma_f32_16x16x32_bf16 v[48:51], v[56:59], a[152:155], v[48:51]
    v_mfma_f32_16x16x32_bf16 v[52:55], v[56:59], a[224:227], v[52:55]
    v_mfma_f32_16x16x32_bf16 v[36:39], v[196:199], v[56:59], v[36:39]
    v_mfma_f32_16x16x32_bf16 v[40:43], a[12:15], v[56:59], v[40:43]
    v_mfma_f32_16x16x32_bf16 v[44:47], a[84:87], v[56:59], v[44:47]
    v_mfma_f32_16x16x32_bf16 v[48:51], v[56:59], a[156:159], v[48:51]
    v_mfma_f32_16x16x32_bf16 v[52:55], v[56:59], a[228:231], v[52:55]
    v_mfma_f32_16x16x32_bf16 v[36:39], v[200:203], v[56:59], v[36:39]
    v_mfma_f32_16x16x32_bf16 v[40:43], a[16:19], v[56:59], v[40:43]
    v_mfma_f32_16x16x32_bf16 v[44:47], a[88:91], v[56:59], v[44:47]
    v_mfma_f32_16x16x32_bf16 v[48:51], v[56:59], a[160:163], v[48:51]
    v_mfma_f32_16x16x32_bf16 v[52:55], v[56:59], a[232:235], v[52:55]
    v_mfma_f32_16x16x32_bf16 v[36:39], v[204:207], v[56:59], v[36:39]
    v_mfma_f32_16x16x32_bf16 v[40:43], a[20:23], v[56:59], v[40:43]
    v_mfma_f32_16x16x32_bf16 v[44:47], a[92:95], v[56:59], v[44:47]
    v_mfma_f32_16x16x32_bf16 v[48:51], v[56:59], a[164:167], v[48:51]
    v_mfma_f32_16x16x32_bf16 v[52:55], v[56:59], a[236:239], v[52:55]
    v_mfma_f32_16x16x32_bf16 v[36:39], v[208:211], v[56:59], v[36:39]
    v_mfma_f32_16x16x32_bf16 v[40:43], a[24:27], v[56:59], v[40:43]
    v_mfma_f32_16x16x32_bf16 v[44:47], a[96:99], v[56:59], v[44:47]
    v_mfma_f32_16x16x32_bf16 v[48:51], v[56:59], a[168:171], v[48:51]
    v_mfma_f32_16x16x32_bf16 v[52:55], v[56:59], a[240:243], v[52:55]
    v_mfma_f32_16x16x32_bf16 v[36:39], v[212:215], v[56:59], v[36:39]
    v_mfma_f32_16x16x32_bf16 v[40:43], a[28:31], v[56:59], v[40:43]
    v_mfma_f32_16x16x32_bf16 v[44:47], a[100:103], v[56:59], v[44:47]
    v_mfma_f32_16x16x32_bf16 v[48:51], v[56:59], a[172:175], v[48:51]
    v_mfma_f32_16x16x32_bf16 v[52:55], v[56:59], a[244:247], v[52:55]
    v_mfma_f32_16x16x32_bf16 v[36:39], v[216:219], v[56:59], v[36:39]
    v_mfma_f32_16x16x32_bf16 v[40:43], a[32:35], v[56:59], v[40:43]
    v_mfma_f32_16x16x32_bf16 v[44:47], a[104:107], v[56:59], v[44:47]
    v_mfma_f32_16x16x32_bf16 v[48:51], v[56:59], a[176:179], v[48:51]
    v_mfma_f32_16x16x32_bf16 v[52:55], v[56:59], a[248:251], v[52:55]
    v_mfma_f32_16x16x32_bf16 v[36:39], v[220:223], v[56:59], v[36:39]
    v_mfma_f32_16x16x32_bf16 v[40:43], a[36:39], v[56:59], v[40:43]
    v_mfma_f32_16x16x32_bf16 v[44:47], a[108:111], v[56:59], v[44:47]
    v_mfma_f32_16x16x32_bf16 v[48:51], v[56:59], a[180:183], v[48:51]
    v_mfma_f32_16x16x32_bf16 v[52:55], v[56:59], a[252:255], v[52:55]
    v_lshlrev_b32 v10, 5, v7
    s_lshl_b32 s17, s51, 4
    v_add_u32 v10, s17, v10
    v_mul_u32_u24 v6, 1536, v8
    v_add_u32 v10, v10, v6
    s_lshl_b32 s17, s14, 7
    s_add_u32 s17, s17, 73728
    v_lshl_add_u32 v11, v7, 3, s17
    v_lshl_add_u32 v12, v8, 5, s17
    v_lshlrev_b32 v13, 5, v7
    s_lshl_b32 s17, s51, 4
    v_add_u32 v13, s17, v13
    s_lshr_b32 s17, s50, 2
    s_add_u32 s17, s17, 64
    s_lshl_b32 s17, s17, 9
    s_and_b32 s18, s50, 3
    s_lshl_b32 s18, s18, 2
    s_add_u32 s17, s17, s18
    v_add_u32 v14, s17, v13
    v_lshrrev_b32 v5, 1, v8
    v_lshl_add_u32 v13, v5, 9, v13
    v_and_b32 v5, 1, v8
    v_lshl_add_u32 v13, v5, 3, v13
    s_lshl_b32 s17, s50, 10
    v_add_u32 v13, s17, v13
    s_lshl_b32 s49, s15, 7
    s_lshl_b32 s17, s14, 2
    s_add_u32 s49, s49, s17
    s_add_u32 s49, s49, 1536
    s_mov_b32 s52, 0x3eae1a93
    v_mov_b32 v6, 0xf149f2ca
    v_lshl_add_u32 v5, v8, 2, 0
    v_sub_u32 v5, v5, v7
    v_cmp_le_i32 vcc, 9, v5
    s_nop 1
    v_cndmask_b32 v72, v6, v4, vcc
    v_add_u32 v5, 7, v5
    v_cmp_ge_u32 vcc, 7, v5
    s_nop 1
    v_cndmask_b32 v76, v6, v4, vcc
    v_lshl_add_u32 v5, v8, 2, 1
    v_sub_u32 v5, v5, v7
    v_cmp_le_i32 vcc, 9, v5
    s_nop 1
    v_cndmask_b32 v73, v6, v4, vcc
    v_add_u32 v5, 7, v5
    v_cmp_ge_u32 vcc, 7, v5
    s_nop 1
    v_cndmask_b32 v77, v6, v4, vcc
    v_lshl_add_u32 v5, v8, 2, 2
    v_sub_u32 v5, v5, v7
    v_cmp_le_i32 vcc, 9, v5
    s_nop 1
    v_cndmask_b32 v74, v6, v4, vcc
    v_add_u32 v5, 7, v5
    v_cmp_ge_u32 vcc, 7, v5
    s_nop 1
    v_cndmask_b32 v78, v6, v4, vcc
    v_lshl_add_u32 v5, v8, 2, 3
    v_sub_u32 v5, v5, v7
    v_cmp_le_i32 vcc, 9, v5
    s_nop 1
    v_cndmask_b32 v75, v6, v4, vcc
    v_add_u32 v5, 7, v5
    v_cmp_ge_u32 vcc, 7, v5
    s_nop 1
    v_cndmask_b32 v79, v6, v4, vcc
    v_mov_b32 v112, 0
    v_mov_b32 v113, 0
    v_mov_b32 v114, 0
    v_mov_b32 v115, 0
    v_mov_b32 v136, 0
    v_mov_b32 v137, 0
    v_mov_b32 v138, 0
    v_mov_b32 v139, 0
    v_mov_b32 v140, 0
    v_mov_b32 v141, 0
    v_mov_b32 v142, 0
    v_mov_b32 v143, 0
    v_mov_b32 v116, 0x3f803f80
    v_mov_b32 v117, 0x3f803f80
    v_mov_b32 v118, 0x3f803f80
    v_mov_b32 v119, 0x3f803f80
    v_mov_b32 v131, 0
    v_mov_b32 v135, 0
    s_mov_b64 exec, 0xff
    v_lshrrev_b32 v6, 2, v0
    v_lshlrev_b32 v5, 5, v6
    v_and_b32 v5, 128, v5
    v_lshrrev_b32 v6, 1, v6
    v_and_or_b32 v5, v6, 12, v5
    s_mov_b32 s16, 0
Laq_pure:
    global_load_dword v6, v5, s[12:13] sc1
    s_add_u32 s16, s16, 1
    s_cmp_gt_u32 s16, 100000
    s_cbranch_scc1 L_role_aq_abort
    s_mov_b32 s6, 0
    s_waitcnt vmcnt(0)
    v_readlane_b32 s7, v6, 0
    s_nop 0
    s_add_u32 s6, s6, s7
    v_readlane_b32 s7, v6, 1
    s_nop 0
    s_add_u32 s6, s6, s7
    v_readlane_b32 s7, v6, 2
    s_nop 0
    s_add_u32 s6, s6, s7
    v_readlane_b32 s7, v6, 3
    s_nop 0
    s_add_u32 s6, s6, s7
    v_readlane_b32 s7, v6, 4
    s_nop 0
    s_add_u32 s6, s6, s7
    v_readlane_b32 s7, v6, 5
    s_nop 0
    s_add_u32 s6, s6, s7
    v_readlane_b32 s7, v6, 6
    s_nop 0
    s_add_u32 s6, s6, s7
    v_readlane_b32 s7, v6, 7
    s_nop 0
    s_add_u32 s6, s6, s7
    v_readlane_b32 s7, v6, s3
    s_nop 0
    s_cmp_ge_u32 s7, 32
    s_cselect_b32 s78, 0, -1
    s_cselect_b32 s6, 256, s6
    s_cmp_lt_u32 s6, 256
    s_cbranch_scc1 Laq_pure
    s_mov_b32 s79, s78
    s_mov_b64 exec, -1
    s_mov_b32 s36, s63
    s_mov_b32 s34, s63
    s_mul_i32 s58, s14, 9216
    s_mul_i32 s64, s63, 4718592
    s_add_u32 s64, s64, s58
    s_add_u32 s64, s64, 6291456
    s_mul_i32 s61, s63, 1441792
    s_add_u32 s61, s61, 0
    s_mov_b32 s37, 0
    s_mov_b32 s40, 36864
    s_mov_b32 s59, s58
    s_mov_b32 s43, 0
    s_mov_b32 s62, 1
    s_mov_b32 s28, s8
    s_mov_b32 s29, s9
    s_mov_b32 s30, 0
    s_mov_b32 s31, 0x00020000
    v_mov_b32 v110, 74752
    v_mov_b32 v5, -1
    ds_write_b32 v110, v5
    s_waitcnt lgkmcnt(0)
    s_cmp_lg_u32 s14, 0
    s_cbranch_scc1 Laq_inia_d
    v_mov_b32 v5, 40
    s_mov_b32 s16, 0
Laq_inia:
    global_load_dword v6, v5, s[12:13] sc1
    s_add_u32 s16, s16, 1
    s_cmp_gt_u32 s16, 100000
    s_cbranch_scc1 L_role_aq_abort
    s_waitcnt vmcnt(0)
    v_cmp_gt_u32 vcc, 72, v6
    s_nop 0
    s_cbranch_vccz Laq_inia_d
    s_sleep 8
    s_branch Laq_inia
Laq_inia_d:
    s_barrier
    s_cmp_eq_u32 s63, 0
    s_cbranch_scc1 Laq_ini_sk
    s_cmp_lg_u32 s14, 0
    s_cbranch_scc1 Laq_inib_d
    v_mov_b32 v5, 160
    s_mov_b32 s16, 0
Laq_inib:
    global_load_dword v6, v5, s[12:13] sc1
    s_add_u32 s16, s16, 1
    s_cmp_gt_u32 s16, 100000
    s_cbranch_scc1 L_role_aq_abort
    s_waitcnt vmcnt(0)
    v_cmp_gt_u32 vcc, 64, v6
    s_nop 0
    s_cbranch_vccz Laq_inib_d
    s_sleep 8
    s_branch Laq_inib
Laq_inib_d:
    s_barrier
Laq_ini_sk:
    s_mul_i32 s41, s37, 36864
    s_add_u32 s41, s41, s64
    s_mul_i32 s60, s37, 22528
    s_add_u32 s60, s60, s61
    s_cmp_lt_u32 s37, 64
    s_cselect_b32 s60, s60, 2883584
    s_branch Laq_wait
Laq_head:
    s_waitcnt vmcnt(4)
Laq_head2:
    s_barrier
    ds_read_b32 v15, v110
    s_xor_b32 s40, s40, 36864
    s_xor_b32 s59, s59, 36864
    s_mov_b32 s35, s37
    s_lshl_b32 s57, s34, 6
    s_add_u32 s57, s57, s35
    s_add_u32 s37, s37, 1
    s_mov_b32 s39, 0
    s_mov_b32 s54, 0
    s_mul_i32 s41, s37, 36864
    s_add_u32 s41, s41, s64
    s_mul_i32 s60, s37, 22528
    s_add_u32 s60, s60, s61
    s_cmp_lt_u32 s37, 64
    s_cselect_b32 s60, s60, 2883584
    v_lshlrev_b32 v9, 9, v8
    v_lshl_add_u32 v9, v7, 5, v9
    s_lshl_b32 s17, s51, 4
    s_add_u32 s17, s17, s40
    v_add_u32 v9, s17, v9
    ds_read_b128 v[56:59], v9 offset:0
    ds_read_b128 v[60:63], v9 offset:2048
    ds_read_b128 v[64:67], v9 offset:4096
    s_waitcnt lgkmcnt(2)
    v_mfma_f32_16x16x32_bf16 v[16:19], v[152:155], v[56:59], 0
    v_add_f32 v80, v80, v84
    v_mfma_f32_16x16x32_bf16 v[20:23], v[224:227], v[56:59], 0
    v_add_f32 v81, v81, v85
    v_mfma_f32_16x16x32_bf16 v[24:27], a[40:43], v[56:59], 0
    v_add_f32 v82, v82, v86
    ds_read_b128 v[56:59], v9 offset:6144
    s_waitcnt lgkmcnt(2)
    v_mfma_f32_16x16x32_bf16 v[16:19], v[156:159], v[60:63], v[16:19]
    v_add_f32 v83, v83, v87
    v_mfma_f32_16x16x32_bf16 v[20:23], v[228:231], v[60:63], v[20:23]
    v_add_f32 v80, v80, v88
    v_mfma_f32_16x16x32_bf16 v[24:27], a[44:47], v[60:63], v[24:27]
    v_add_f32 v81, v81, v89
    v_readfirstlane_b32 s17, v15
    s_nop 0
    s_add_u32 s18, s17, 1
    s_max_i32 s32, s18, s37
    s_add_u32 s39, s37, 1
    s_min_u32 s39, s39, 63
    s_mul_i32 s33, s32, 22528
    s_add_u32 s33, s33, s61
    s_cmp_eq_u32 s14, 0
    s_cselect_b32 s18, s32, 0x7fff
    v_mov_b32 v2, 2
    s_cmp_le_u32 s18, s39
    s_cselect_b64 exec, -1, 0
    buffer_load_dword v2, v1, s[8:11], s33 offen sc1
    s_mov_b64 exec, -1
    s_cmp_ge_i32 s17, s37
    s_cbranch_scc1 Laq_f_7
    ds_read_b128 v[60:63], v9 offset:8192
    s_waitcnt lgkmcnt(2)
    v_mfma_f32_16x16x32_bf16 v[16:19], v[160:163], v[64:67], v[16:19]
    v_add_f32 v82, v82, v90
    v_mfma_f32_16x16x32_bf16 v[20:23], v[232:235], v[64:67], v[20:23]
    v_add_f32 v83, v83, v91
    v_mfma_f32_16x16x32_bf16 v[24:27], a[48:51], v[64:67], v[24:27]
    v_add_f32 v80, v80, v82
    ds_read_b128 v[64:67], v9 offset:10240
    s_waitcnt lgkmcnt(2)
    v_mfma_f32_16x16x32_bf16 v[16:19], v[164:167], v[56:59], v[16:19]
    v_add_f32 v81, v81, v83
    v_mfma_f32_16x16x32_bf16 v[20:23], v[236:239], v[56:59], v[20:23]
    v_mov_b32 v82, v80
    v_mfma_f32_16x16x32_bf16 v[24:27], a[52:55], v[56:59], v[24:27]
    v_mov_b32 v83, v81
    ds_read_b128 v[56:59], v9 offset:12288
    s_waitcnt lgkmcnt(2)
    v_mfma_f32_16x16x32_bf16 v[16:19], v[168:171], v[60:63], v[16:19]
    v_permlane32_swap_b32 v80, v82
    v_mfma_f32_16x16x32_bf16 v[20:23], v[240:243], v[60:63], v[20:23]
    v_permlane32_swap_b32 v81, v83
    v_mfma_f32_16x16x32_bf16 v[24:27], a[56:59], v[60:63], v[24:27]
    v_add_f32 v80, v80, v82
    ds_read_b128 v[60:63], v9 offset:14336
    s_waitcnt lgkmcnt(2)
    v_mfma_f32_16x16x32_bf16 v[16:19], v[172:175], v[64:67], v[16:19]
    v_add_f32 v81, v81, v83
    v_mfma_f32_16x16x32_bf16 v[20:23], v[244:247], v[64:67], v[20:23]
    v_mov_b32 v82, v80
    v_mfma_f32_16x16x32_bf16 v[24:27], a[60:63], v[64:67], v[24:27]
    v_mov_b32 v83, v81
    s_waitcnt vmcnt(1)
    s_cmp_lg_u32 s43, 0
    s_cselect_b64 exec, 1, 0
    buffer_store_dword v3, v4, s[8:11], s43 offen
    s_and_b64 exec, exec, s[78:79]
    buffer_store_dword v3, v4, s[8:11], s43 offen sc1
    s_mov_b64 exec, -1
    s_mov_b32 s43, 0
    ds_read_b128 v[64:67], v9 offset:16384
    s_waitcnt lgkmcnt(2)
    v_mfma_f32_16x16x32_bf16 v[16:19], v[176:179], v[56:59], v[16:19]
    v_permlane16_swap_b32 v80, v82
    v_mfma_f32_16x16x32_bf16 v[20:23], v[248:251], v[56:59], v[20:23]
    v_permlane16_swap_b32 v81, v83
    v_mfma_f32_16x16x32_bf16 v[24:27], a[64:67], v[56:59], v[24:27]
    v_add_f32 v80, v80, v82
    ds_read_b128 v[56:59], v9 offset:18432
    s_waitcnt lgkmcnt(2)
    v_mfma_f32_16x16x32_bf16 v[16:19], v[180:183], v[60:63], v[16:19]
    v_add_f32 v81, v81, v83
    v_mfma_f32_16x16x32_bf16 v[20:23], v[252:255], v[60:63], v[20:23]
    v_mul_f32 v80, 0x3ae38e39, v80
    v_mfma_f32_16x16x32_bf16 v[24:27], a[68:71], v[60:63], v[24:27]
    v_mul_f32 v81, 0x3ae38e39, v81
    ds_read_b128 v[60:63], v9 offset:20480
    s_waitcnt lgkmcnt(2)
    v_mfma_f32_16x16x32_bf16 v[16:19], v[184:187], v[64:67], v[16:19]
    v_fma_f32 v81, -v80, v80, v81
    v_mfma_f32_16x16x32_bf16 v[20:23], a[0:3], v[64:67], v[20:23]
    v_max_f32 v81, 0, v81
    v_mfma_f32_16x16x32_bf16 v[24:27], a[72:75], v[64:67], v[24:27]
    v_add_f32 v81, 0x3727c5ac, v81
    ds_read_b128 v[64:67], v9 offset:22528
    s_waitcnt lgkmcnt(2)
    v_mfma_f32_16x16x32_bf16 v[16:19], v[188:191], v[56:59], v[16:19]
    v_rsq_f32 v92, v81
    v_mfma_f32_16x16x32_bf16 v[20:23], a[4:7], v[56:59], v[20:23]
    v_mul_f32 v93, v80, v92
    v_mfma_f32_16x16x32_bf16 v[24:27], a[76:79], v[56:59], v[24:27]
    ds_write_b64 v11, v[92:93]
    ds_read_b128 v[56:59], v9 offset:24576
    s_waitcnt lgkmcnt(3)
    v_mfma_f32_16x16x32_bf16 v[16:19], v[192:195], v[60:63], v[16:19]
    ds_read_b128 v[96:99], v12
    v_mfma_f32_16x16x32_bf16 v[20:23], a[8:11], v[60:63], v[20:23]
    ds_read_b128 v[100:103], v12 offset:16
    v_mfma_f32_16x16x32_bf16 v[24:27], a[80:83], v[60:63], v[24:27]
    ds_read_b128 v[60:63], v9 offset:26624
    s_waitcnt lgkmcnt(5)
    v_mfma_f32_16x16x32_bf16 v[16:19], v[196:199], v[64:67], v[16:19]
    v_mfma_f32_16x16x32_bf16 v[20:23], a[12:15], v[64:67], v[20:23]
    v_mfma_f32_16x16x32_bf16 v[24:27], a[84:87], v[64:67], v[24:27]
    ds_read_b128 v[64:67], v9 offset:28672
    s_waitcnt lgkmcnt(4)
    v_mfma_f32_16x16x32_bf16 v[16:19], v[200:203], v[56:59], v[16:19]
    v_mfma_f32_16x16x32_bf16 v[20:23], a[16:19], v[56:59], v[20:23]
    v_mfma_f32_16x16x32_bf16 v[24:27], a[88:91], v[56:59], v[24:27]
    ds_read_b128 v[56:59], v9 offset:30720
    s_waitcnt lgkmcnt(2)
    v_mfma_f32_16x16x32_bf16 v[16:19], v[204:207], v[60:63], v[16:19]
    v_mfma_f32_16x16x32_bf16 v[20:23], a[20:23], v[60:63], v[20:23]
    v_mfma_f32_16x16x32_bf16 v[24:27], a[92:95], v[60:63], v[24:27]
    ds_read_b128 v[60:63], v9 offset:32768
    s_waitcnt lgkmcnt(2)
    v_mfma_f32_16x16x32_bf16 v[16:19], v[208:211], v[64:67], v[16:19]
    v_mfma_f32_16x16x32_bf16 v[20:23], a[24:27], v[64:67], v[20:23]
    v_mfma_f32_16x16x32_bf16 v[24:27], a[96:99], v[64:67], v[24:27]
    ds_read_b128 v[64:67], v9 offset:34816
    s_waitcnt lgkmcnt(2)
    v_mfma_f32_16x16x32_bf16 v[16:19], v[212:215], v[56:59], v[16:19]
    v_cmp_eq_u32 s[76:77], 1, v2
    v_cmp_eq_u32 vcc, 2, v2
    v_mfma_f32_16x16x32_bf16 v[20:23], a[28:31], v[56:59], v[20:23]
    s_cmp_eq_u64 s[76:77], -1
    s_cselect_b32 s38, 1, 0
    v_mfma_f32_16x16x32_bf16 v[24:27], a[100:103], v[56:59], v[24:27]
    s_cmp_lg_u32 s38, 0
    s_cselect_b64 exec, 1, 0
    v_mov_b32 v15, s32
    ds_write_b32 v110, v15
    v_mov_b32 v2, 2
    s_mov_b64 exec, -1
    ds_read_b128 v[56:59], v9 offset:0
    s_waitcnt lgkmcnt(3)
    v_mfma_f32_16x16x32_bf16 v[16:19], v[216:219], v[60:63], v[16:19]
    s_add_u32 s32, s32, s38
    s_mul_i32 s38, s38, 22528
    s_add_u32 s33, s33, s38
    v_mfma_f32_16x16x32_bf16 v[20:23], a[32:35], v[60:63], v[20:23]
    s_cmp_eq_u64 vcc, 0
    s_cselect_b32 s38, s32, 0x7fff
    v_mfma_f32_16x16x32_bf16 v[24:27], a[104:107], v[60:63], v[24:27]
    s_cmp_le_u32 s38, s39
    s_cselect_b64 exec, -1, 0
    v_mov_b32 v2, 2
    buffer_load_dword v2, v1, s[8:11], s33 offen sc1
    s_mov_b64 exec, -1
    ds_read_b128 v[60:63], v9 offset:2048
    s_waitcnt lgkmcnt(3)
    v_mfma_f32_16x16x32_bf16 v[16:19], v[220:223], v[64:67], v[16:19]
    v_mfma_f32_16x16x32_bf16 v[20:23], a[36:39], v[64:67], v[20:23]
    v_mfma_f32_16x16x32_bf16 v[24:27], a[108:111], v[64:67], v[24:27]
    ds_read_b32 v15, v110
    ds_read_b128 v[64:67], v9 offset:4096
    s_waitcnt lgkmcnt(3)
    v_mfma_f32_16x16x32_bf16 v[28:31], v[56:59], a[112:115], 0
    v_mfma_f32_16x16x32_bf16 v[32:35], v[56:59], a[184:187], 0
    ds_read_b128 v[56:59], v9 offset:6144
    s_waitcnt lgkmcnt(3)
    v_mfma_f32_16x16x32_bf16 v[28:31], v[60:63], a[116:119], v[28:31]
    v_mul_f32 v94, v93, v36
    v_fma_f32 v16, v16, v92, -v94
    v_mfma_f32_16x16x32_bf16 v[32:35], v[60:63], a[188:191], v[32:35]
    v_mul_f32 v94, v93, v37
    v_fma_f32 v17, v17, v92, -v94
    s_waitcnt lgkmcnt(2)
    v_readfirstlane_b32 s17, v15
    s_nop 0
    s_cmp_ge_i32 s17, s37
    s_cbranch_scc1 Laq_f_8
    ds_read_b128 v[60:63], v9 offset:8192
    s_waitcnt lgkmcnt(2)
    v_mfma_f32_16x16x32_bf16 v[28:31], v[64:67], a[120:123], v[28:31]
    v_mul_f32 v94, v93, v38
    v_fma_f32 v18, v18, v92, -v94
    v_mfma_f32_16x16x32_bf16 v[32:35], v[64:67], a[192:195], v[32:35]
    v_mul_f32 v94, v93, v39
    v_fma_f32 v19, v19, v92, -v94
    ds_read_b128 v[64:67], v9 offset:10240
    s_waitcnt lgkmcnt(2)
    v_mfma_f32_16x16x32_bf16 v[28:31], v[56:59], a[124:127], v[28:31]
    v_mul_f32 v94, v93, v44
    v_fma_f32 v24, v24, v92, -v94
    v_mfma_f32_16x16x32_bf16 v[32:35], v[56:59], a[196:199], v[32:35]
    v_mul_f32 v94, v93, v45
    v_fma_f32 v25, v25, v92, -v94
    ds_read_b128 v[56:59], v9 offset:12288
    s_waitcnt lgkmcnt(2)
    v_mfma_f32_16x16x32_bf16 v[28:31], v[60:63], a[128:131], v[28:31]
    v_mul_f32 v94, v93, v46
    v_fma_f32 v26, v26, v92, -v94
    v_mfma_f32_16x16x32_bf16 v[32:35], v[60:63], a[200:203], v[32:35]
    v_mul_f32 v94, v93, v47
    v_fma_f32 v27, v27, v92, -v94
    ds_read_b128 v[60:63], v9 offset:14336
    s_waitcnt lgkmcnt(2)
    v_mfma_f32_16x16x32_bf16 v[28:31], v[64:67], a[132:135], v[28:31]
    v_mul_f32 v94, v93, v40
    v_fma_f32 v20, v20, v92, -v94
    v_mfma_f32_16x16x32_bf16 v[32:35], v[64:67], a[204:207], v[32:35]
    v_mul_f32 v94, v93, v41
    v_fma_f32 v21, v21, v92, -v94
    ds_read_b128 v[64:67], v9 offset:16384
    s_waitcnt lgkmcnt(2)
    v_mfma_f32_16x16x32_bf16 v[28:31], v[56:59], a[136:139], v[28:31]
    v_mul_f32 v94, v93, v42
    v_fma_f32 v22, v22, v92, -v94
    v_mfma_f32_16x16x32_bf16 v[32:35], v[56:59], a[208:211], v[32:35]
    v_mul_f32 v94, v93, v43
    v_fma_f32 v23, v23, v92, -v94
    ds_read_b128 v[56:59], v9 offset:18432
    s_waitcnt lgkmcnt(2)
    v_mfma_f32_16x16x32_bf16 v[28:31], v[60:63], a[140:143], v[28:31]
    v_cvt_pk_bf16_f32 v128, v16, v17
    v_cvt_pk_bf16_f32 v129, v18, v19
    v_mfma_f32_16x16x32_bf16 v[32:35], v[60:63], a[212:215], v[32:35]
    v_cvt_pk_bf16_f32 v130, v24, v25
    v_cvt_pk_bf16_f32 v132, v20, v21
    ds_read_b128 v[60:63], v9 offset:20480
    s_waitcnt lgkmcnt(2)
    v_mfma_f32_16x16x32_bf16 v[28:31], v[64:67], a[144:147], v[28:31]
    v_cvt_pk_bf16_f32 v133, v22, v23
    v_cvt_pk_bf16_f32 v134, v26, v27
    v_mfma_f32_16x16x32_bf16 v[32:35], v[64:67], a[216:219], v[32:35]
    s_cmp_eq_u32 s35, 0
    s_cselect_b32 s46, 0xf149f2ca, 0
    ds_read_b128 v[64:67], v9 offset:22528
    s_waitcnt lgkmcnt(2)
    v_mfma_f32_16x16x32_bf16 v[28:31], v[56:59], a[148:151], v[28:31]
    v_mfma_f32_16x16x32_bf16 v[144:147], v[112:115], v[128:131], 0
    v_mfma_f32_16x16x32_bf16 v[32:35], v[56:59], a[220:223], v[32:35]
    v_mfma_f32_16x16x32_bf16 v[148:151], v[132:135], v[128:131], 0
    ds_read_b128 v[56:59], v9 offset:24576
    s_waitcnt lgkmcnt(2)
    v_mfma_f32_16x16x32_bf16 v[28:31], v[60:63], a[152:155], v[28:31]
    v_mov_b32 v112, v132
    v_mfma_f32_16x16x32_bf16 v[32:35], v[60:63], a[224:227], v[32:35]
    v_mov_b32 v113, v133
    v_mov_b32 v114, v134
    ds_read_b128 v[60:63], v9 offset:26624
    s_waitcnt lgkmcnt(2)
    v_mfma_f32_16x16x32_bf16 v[28:31], v[64:67], a[156:159], v[28:31]
    v_mfma_f32_16x16x32_bf16 v[32:35], v[64:67], a[228:231], v[32:35]
    v_fma_f32 v144, v144, s52, v72
    ds_read_b128 v[64:67], v9 offset:28672
    s_waitcnt lgkmcnt(2)
    v_mfma_f32_16x16x32_bf16 v[28:31], v[56:59], a[160:163], v[28:31]
    v_fma_f32 v145, v145, s52, v73
    v_fma_f32 v146, v146, s52, v74
    v_fma_f32 v147, v147, s52, v75
    v_mfma_f32_16x16x32_bf16 v[32:35], v[56:59], a[232:235], v[32:35]
    v_fma_f32 v148, v148, s52, v76
    v_fma_f32 v149, v149, s52, v77
    v_fma_f32 v150, v150, s52, v78
    ds_read_b128 v[56:59], v9 offset:30720
    s_waitcnt lgkmcnt(2)
    v_mfma_f32_16x16x32_bf16 v[28:31], v[60:63], a[164:167], v[28:31]
    v_fma_f32 v151, v151, s52, v79
    v_add_f32 v144, s46, v144
    v_add_f32 v145, s46, v145
    v_mfma_f32_16x16x32_bf16 v[32:35], v[60:63], a[236:239], v[32:35]
    v_add_f32 v146, s46, v146
    v_add_f32 v147, s46, v147
    v_max3_f32 v5, v144, v145, v146
    ds_read_b128 v[60:63], v9 offset:32768
    s_waitcnt lgkmcnt(2)
    v_mfma_f32_16x16x32_bf16 v[28:31], v[64:67], a[168:171], v[28:31]
    v_max3_f32 v5, v5, v147, v148
    v_max3_f32 v5, v5, v149, v150
    v_max_f32 v5, v5, v151
    v_mfma_f32_16x16x32_bf16 v[32:35], v[64:67], a[240:243], v[32:35]
    v_mov_b32 v6, v5
    s_nop 1
    v_permlane32_swap_b32 v5, v6
    ds_read_b128 v[64:67], v9 offset:34816
    s_waitcnt lgkmcnt(2)
    v_mfma_f32_16x16x32_bf16 v[28:31], v[56:59], a[172:175], v[28:31]
    v_max_f32 v5, v5, v6
    v_mov_b32 v6, v5
    v_mfma_f32_16x16x32_bf16 v[32:35], v[56:59], a[244:247], v[32:35]
    s_nop 0
    v_permlane16_swap_b32 v5, v6
    v_max_f32 v5, v5, v6
    v_sub_f32 v144, v144, v5
    s_waitcnt lgkmcnt(1)
    v_mfma_f32_16x16x32_bf16 v[28:31], v[60:63], a[176:179], v[28:31]
    v_sub_f32 v145, v145, v5
    v_sub_f32 v146, v146, v5
    v_sub_f32 v147, v147, v5
    v_mfma_f32_16x16x32_bf16 v[32:35], v[60:63], a[248:251], v[32:35]
    v_sub_f32 v148, v148, v5
    v_sub_f32 v149, v149, v5
    v_sub_f32 v150, v150, v5
    s_waitcnt lgkmcnt(0)
    v_mfma_f32_16x16x32_bf16 v[28:31], v[64:67], a[180:183], v[28:31]
    v_sub_f32 v151, v151, v5
    v_exp_f32 v144, v144
    v_exp_f32 v145, v145
    v_mfma_f32_16x16x32_bf16 v[32:35], v[64:67], a[252:255], v[32:35]
    v_exp_f32 v146, v146
    v_exp_f32 v147, v147
    v_exp_f32 v148, v148
    v_cmp_eq_u32 s[76:77], 1, v2
    v_cmp_eq_u32 vcc, 2, v2
    s_cmp_eq_u64 s[76:77], -1
    s_cselect_b32 s38, 1, 0
    s_cmp_lg_u32 s38, 0
    s_cselect_b64 exec, 1, 0
    v_mov_b32 v15, s32
    ds_write_b32 v110, v15
    v_mov_b32 v2, 2
    s_mov_b64 exec, -1
    s_add_u32 s32, s32, s38
    s_mul_i32 s38, s38, 22528
    s_add_u32 s33, s33, s38
    s_cmp_eq_u64 vcc, 0
    s_cselect_b32 s38, s32, 0x7fff
    s_cmp_le_u32 s38, s39
    s_cselect_b64 exec, -1, 0
    v_mov_b32 v2, 2
    buffer_load_dword v2, v1, s[8:11], s33 offen sc1
    s_mov_b64 exec, -1
    v_exp_f32 v149, v149
    v_exp_f32 v150, v150
    v_exp_f32 v151, v151
    v_cvt_pk_bf16_f32 v68, v144, v145
    v_cvt_pk_bf16_f32 v69, v146, v147
    v_cvt_pk_bf16_f32 v70, v148, v149
    v_cvt_pk_bf16_f32 v71, v150, v151
    s_nop 1
    v_mfma_f32_16x16x32_bf16 v[16:19], v[116:119], v[68:71], 0
    s_mul_i32 s46, s57, 36864
    s_add_u32 s46, s46, 17301504
    s_nop 5
    v_rcp_f32 v6, v16
    v_mul_f32 v94, v97, v48
    v_fma_f32 v28, v28, v96, -v94
    v_mul_f32 v94, v99, v49
    v_fma_f32 v29, v29, v98, -v94
    v_mul_f32 v94, v101, v50
    v_fma_f32 v30, v30, v100, -v94
    v_mul_f32 v94, v103, v51
    v_fma_f32 v31, v31, v102, -v94
    v_cvt_pk_bf16_f32 v138, v28, v29
    v_cvt_pk_bf16_f32 v139, v30, v31
    v_mul_f32 v94, v97, v52
    v_fma_f32 v32, v32, v96, -v94
    v_mfma_f32_16x16x32_bf16 v[20:23], v[136:139], v[68:71], 0
    v_mul_f32 v94, v99, v53
    v_fma_f32 v33, v33, v98, -v94
    v_mul_f32 v94, v101, v54
    v_fma_f32 v34, v34, v100, -v94
    v_mul_f32 v94, v103, v55
    v_fma_f32 v35, v35, v102, -v94
    v_cvt_pk_bf16_f32 v142, v32, v33
    v_cvt_pk_bf16_f32 v143, v34, v35
    v_mov_b32 v136, v138
    v_mov_b32 v137, v139
    v_mfma_f32_16x16x32_bf16 v[24:27], v[140:143], v[68:71], 0
    v_mul_f32 v20, v6, v20
    v_mul_f32 v21, v6, v21
    v_mul_f32 v22, v6, v22
    v_mul_f32 v23, v6, v23
    v_cvt_pk_bf16_f32 v20, v20, v21
    v_cvt_pk_bf16_f32 v21, v22, v23
    s_mov_b64 exec, -1
    buffer_store_dwordx2 v[20:21], v13, s[8:11], s46 offen
    s_and_b64 exec, exec, s[78:79]
    buffer_store_dwordx2 v[20:21], v13, s[8:11], s46 offen sc1
    s_mov_b64 exec, -1
    v_mov_b32 v140, v142
    v_mov_b32 v141, v143
    v_mul_f32 v24, v6, v24
    v_mul_f32 v25, v6, v25
    v_cvt_pk_bf16_f32 v24, v24, v25
    s_mov_b64 exec, 0xffff
    buffer_store_dword v24, v14, s[8:11], s46 offen
    s_and_b64 exec, exec, s[78:79]
    buffer_store_dword v24, v14, s[8:11], s46 offen sc1
    s_mov_b64 exec, -1
    s_mul_i32 s43, s57, 22528
    s_add_u32 s43, s43, s49
    s_branch Laq_none
Laq_f_7:
    ds_read_b128 v[60:63], v9 offset:8192
    s_waitcnt lgkmcnt(2)
    v_mfma_f32_16x16x32_bf16 v[16:19], v[160:163], v[64:67], v[16:19]
    v_add_f32 v82, v82, v90
    v_mfma_f32_16x16x32_bf16 v[20:23], v[232:235], v[64:67], v[20:23]
    v_add_f32 v83, v83, v91
    v_mfma_f32_16x16x32_bf16 v[24:27], a[48:51], v[64:67], v[24:27]
    v_add_f32 v80, v80, v82
    ds_read_b128 v[64:67], v9 offset:10240
    s_waitcnt lgkmcnt(2)
    v_mfma_f32_16x16x32_bf16 v[16:19], v[164:167], v[56:59], v[16:19]
    v_add_f32 v81, v81, v83
    v_mfma_f32_16x16x32_bf16 v[20:23], v[236:239], v[56:59], v[20:23]
    v_mov_b32 v82, v80
    v_mfma_f32_16x16x32_bf16 v[24:27], a[52:55], v[56:59], v[24:27]
    v_mov_b32 v83, v81
    ds_read_b128 v[56:59], v9 offset:12288
    s_waitcnt lgkmcnt(2)
    v_mfma_f32_16x16x32_bf16 v[16:19], v[168:171], v[60:63], v[16:19]
    v_permlane32_swap_b32 v80, v82
    v_mfma_f32_16x16x32_bf16 v[20:23], v[240:243], v[60:63], v[20:23]
    v_permlane32_swap_b32 v81, v83
    v_mfma_f32_16x16x32_bf16 v[24:27], a[56:59], v[60:63], v[24:27]
    v_add_f32 v80, v80, v82
    ds_read_b128 v[60:63], v9 offset:14336
    s_waitcnt lgkmcnt(2)
    v_mfma_f32_16x16x32_bf16 v[16:19], v[172:175], v[64:67], v[16:19]
    v_add_f32 v81, v81, v83
    v_mfma_f32_16x16x32_bf16 v[20:23], v[244:247], v[64:67], v[20:23]
    v_mov_b32 v82, v80
    v_mfma_f32_16x16x32_bf16 v[24:27], a[60:63], v[64:67], v[24:27]
    v_mov_b32 v83, v81
    s_waitcnt vmcnt(1)
    s_cmp_lg_u32 s43, 0
    s_cselect_b64 exec, 1, 0
    buffer_store_dword v3, v4, s[8:11], s43 offen
    s_and_b64 exec, exec, s[78:79]
    buffer_store_dword v3, v4, s[8:11], s43 offen sc1
    s_mov_b64 exec, -1
    s_mov_b32 s43, 0
    ds_read_b128 v[64:67], v9 offset:16384
    s_waitcnt lgkmcnt(2)
    v_mfma_f32_16x16x32_bf16 v[16:19], v[176:179], v[56:59], v[16:19]
    v_permlane16_swap_b32 v80, v82
    v_mfma_f32_16x16x32_bf16 v[20:23], v[248:251], v[56:59], v[20:23]
    v_permlane16_swap_b32 v81, v83
    v_mfma_f32_16x16x32_bf16 v[24:27], a[64:67], v[56:59], v[24:27]
    v_add_f32 v80, v80, v82
    ds_read_b128 v[56:59], v9 offset:18432
    s_waitcnt lgkmcnt(2)
    v_mfma_f32_16x16x32_bf16 v[16:19], v[180:183], v[60:63], v[16:19]
    v_add_f32 v81, v81, v83
    v_mfma_f32_16x16x32_bf16 v[20:23], v[252:255], v[60:63], v[20:23]
    v_mul_f32 v80, 0x3ae38e39, v80
    v_mfma_f32_16x16x32_bf16 v[24:27], a[68:71], v[60:63], v[24:27]
    v_mul_f32 v81, 0x3ae38e39, v81
    ds_read_b128 v[60:63], v9 offset:20480
    s_waitcnt lgkmcnt(2)
    v_mfma_f32_16x16x32_bf16 v[16:19], v[184:187], v[64:67], v[16:19]
    v_fma_f32 v81, -v80, v80, v81
    v_mfma_f32_16x16x32_bf16 v[20:23], a[0:3], v[64:67], v[20:23]
    v_max_f32 v81, 0, v81
    v_mfma_f32_16x16x32_bf16 v[24:27], a[72:75], v[64:67], v[24:27]
    v_add_f32 v81, 0x3727c5ac, v81
    ds_read_b128 v[64:67], v9 offset:22528
    s_waitcnt lgkmcnt(2)
    v_mfma_f32_16x16x32_bf16 v[16:19], v[188:191], v[56:59], v[16:19]
    v_rsq_f32 v92, v81
    v_mfma_f32_16x16x32_bf16 v[20:23], a[4:7], v[56:59], v[20:23]
    v_mul_f32 v93, v80, v92
    v_mfma_f32_16x16x32_bf16 v[24:27], a[76:79], v[56:59], v[24:27]
    ds_write_b64 v11, v[92:93]
    ds_read_b128 v[56:59], v9 offset:24576
    s_waitcnt lgkmcnt(3)
    v_mfma_f32_16x16x32_bf16 v[16:19], v[192:195], v[60:63], v[16:19]
    ds_read_b128 v[96:99], v12
    v_mfma_f32_16x16x32_bf16 v[20:23], a[8:11], v[60:63], v[20:23]
    ds_read_b128 v[100:103], v12 offset:16
    v_mfma_f32_16x16x32_bf16 v[24:27], a[80:83], v[60:63], v[24:27]
    s_add_u32 m0, s59, 0
    s_add_u32 s47, s41, 0
    buffer_load_dwordx4 v0, s[8:11], s47 offen offset:0 lds
    ds_read_b128 v[60:63], v9 offset:26624
    s_waitcnt lgkmcnt(5)
    v_mfma_f32_16x16x32_bf16 v[16:19], v[196:199], v[64:67], v[16:19]
    buffer_load_dwordx4 v0, s[8:11], s47 offen offset:1024 lds
    buffer_load_dwordx4 v0, s[8:11], s47 offen offset:2048 lds
    buffer_load_dwordx4 v0, s[8:11], s47 offen offset:3072 lds
    v_mfma_f32_16x16x32_bf16 v[20:23], a[12:15], v[64:67], v[20:23]
    s_add_u32 m0, s59, 4096
    s_add_u32 s47, s41, 4096
    buffer_load_dwordx4 v0, s[8:11], s47 offen offset:0 lds
    v_mfma_f32_16x16x32_bf16 v[24:27], a[84:87], v[64:67], v[24:27]
    buffer_load_dwordx4 v0, s[8:11], s47 offen offset:1024 lds
    buffer_load_dwordx4 v0, s[8:11], s47 offen offset:2048 lds
    buffer_load_dwordx4 v0, s[8:11], s47 offen offset:3072 lds
    ds_read_b128 v[64:67], v9 offset:28672
    s_waitcnt lgkmcnt(4)
    v_mfma_f32_16x16x32_bf16 v[16:19], v[200:203], v[56:59], v[16:19]
    s_add_u32 m0, s59, 8192
    s_add_u32 s47, s41, 8192
    buffer_load_dwordx4 v0, s[8:11], s47 offen offset:0 lds
    v_mfma_f32_16x16x32_bf16 v[20:23], a[16:19], v[56:59], v[20:23]
    v_mfma_f32_16x16x32_bf16 v[24:27], a[88:91], v[56:59], v[24:27]
    ds_read_b128 v[56:59], v9 offset:30720
    s_waitcnt lgkmcnt(2)
    v_mfma_f32_16x16x32_bf16 v[16:19], v[204:207], v[60:63], v[16:19]
    v_mfma_f32_16x16x32_bf16 v[20:23], a[20:23], v[60:63], v[20:23]
    v_mfma_f32_16x16x32_bf16 v[24:27], a[92:95], v[60:63], v[24:27]
    ds_read_b128 v[60:63], v9 offset:32768
    s_waitcnt lgkmcnt(2)
    v_mfma_f32_16x16x32_bf16 v[16:19], v[208:211], v[64:67], v[16:19]
    v_mfma_f32_16x16x32_bf16 v[20:23], a[24:27], v[64:67], v[20:23]
    v_mfma_f32_16x16x32_bf16 v[24:27], a[96:99], v[64:67], v[24:27]
    ds_read_b128 v[64:67], v9 offset:34816
    s_waitcnt lgkmcnt(2)
    v_mfma_f32_16x16x32_bf16 v[16:19], v[212:215], v[56:59], v[16:19]
    v_cmp_eq_u32 s[76:77], 1, v2
    v_cmp_eq_u32 vcc, 2, v2
    v_mfma_f32_16x16x32_bf16 v[20:23], a[28:31], v[56:59], v[20:23]
    s_cmp_eq_u64 s[76:77], -1
    s_cselect_b32 s38, 1, 0
    v_mfma_f32_16x16x32_bf16 v[24:27], a[100:103], v[56:59], v[24:27]
    s_cmp_lg_u32 s38, 0
    s_cselect_b64 exec, 1, 0
    v_mov_b32 v15, s32
    ds_write_b32 v110, v15
    v_mov_b32 v2, 2
    s_mov_b64 exec, -1
    ds_read_b128 v[56:59], v9 offset:0
    s_waitcnt lgkmcnt(3)
    v_mfma_f32_16x16x32_bf16 v[16:19], v[216:219], v[60:63], v[16:19]
    s_add_u32 s32, s32, s38
    s_mul_i32 s38, s38, 22528
    s_add_u32 s33, s33, s38
    v_mfma_f32_16x16x32_bf16 v[20:23], a[32:35], v[60:63], v[20:23]
    s_cmp_eq_u64 vcc, 0
    s_cselect_b32 s38, s32, 0x7fff
    v_mfma_f32_16x16x32_bf16 v[24:27], a[104:107], v[60:63], v[24:27]
    s_cmp_le_u32 s38, s39
    s_cselect_b64 exec, -1, 0
    v_mov_b32 v2, 2
    buffer_load_dword v2, v1, s[8:11], s33 offen sc1
    s_mov_b64 exec, -1
    ds_read_b128 v[60:63], v9 offset:2048
    s_waitcnt lgkmcnt(3)
    v_mfma_f32_16x16x32_bf16 v[16:19], v[220:223], v[64:67], v[16:19]
    s_mul_i32 s48, s36, 786432
    s_mul_i32 s18, s37, 6144
    s_add_u32 s48, s48, s18
    s_add_u32 s48, s48, 15728640
    buffer_load_dwordx4 v[80:83], v10, s[8:11], s48 offen offset:0
    v_mfma_f32_16x16x32_bf16 v[20:23], a[36:39], v[64:67], v[20:23]
    v_mfma_f32_16x16x32_bf16 v[24:27], a[108:111], v[64:67], v[24:27]
    ds_read_b128 v[64:67], v9 offset:4096
    s_waitcnt lgkmcnt(2)
    v_mfma_f32_16x16x32_bf16 v[28:31], v[56:59], a[112:115], 0
    buffer_load_dwordx4 v[84:87], v10, s[8:11], s48 offen offset:512
    v_mfma_f32_16x16x32_bf16 v[32:35], v[56:59], a[184:187], 0
    ds_read_b128 v[56:59], v9 offset:6144
    s_waitcnt lgkmcnt(2)
    v_mfma_f32_16x16x32_bf16 v[28:31], v[60:63], a[116:119], v[28:31]
    buffer_load_dwordx4 v[88:91], v10, s[8:11], s48 offen offset:1024
    v_mul_f32 v94, v93, v36
    v_fma_f32 v16, v16, v92, -v94
    v_mfma_f32_16x16x32_bf16 v[32:35], v[60:63], a[188:191], v[32:35]
    v_mul_f32 v94, v93, v37
    v_fma_f32 v17, v17, v92, -v94
    ds_read_b128 v[60:63], v9 offset:8192
    s_waitcnt lgkmcnt(2)
    v_mfma_f32_16x16x32_bf16 v[28:31], v[64:67], a[120:123], v[28:31]
    v_mul_f32 v94, v93, v38
    v_fma_f32 v18, v18, v92, -v94
    v_mfma_f32_16x16x32_bf16 v[32:35], v[64:67], a[192:195], v[32:35]
    v_mul_f32 v94, v93, v39
    v_fma_f32 v19, v19, v92, -v94
    ds_read_b128 v[64:67], v9 offset:10240
    s_waitcnt lgkmcnt(2)
    v_mfma_f32_16x16x32_bf16 v[28:31], v[56:59], a[124:127], v[28:31]
    v_mul_f32 v94, v93, v44
    v_fma_f32 v24, v24, v92, -v94
    v_mfma_f32_16x16x32_bf16 v[32:35], v[56:59], a[196:199], v[32:35]
    v_mul_f32 v94, v93, v45
    v_fma_f32 v25, v25, v92, -v94
    ds_read_b128 v[56:59], v9 offset:12288
    s_waitcnt lgkmcnt(2)
    v_mfma_f32_16x16x32_bf16 v[28:31], v[60:63], a[128:131], v[28:31]
    v_mul_f32 v94, v93, v46
    v_fma_f32 v26, v26, v92, -v94
    v_mfma_f32_16x16x32_bf16 v[32:35], v[60:63], a[200:203], v[32:35]
    v_mul_f32 v94, v93, v47
    v_fma_f32 v27, v27, v92, -v94
    ds_read_b128 v[60:63], v9 offset:14336
    s_waitcnt lgkmcnt(2)
    v_mfma_f32_16x16x32_bf16 v[28:31], v[64:67], a[132:135], v[28:31]
    v_mul_f32 v94, v93, v40
    v_fma_f32 v20, v20, v92, -v94
    v_mfma_f32_16x16x32_bf16 v[32:35], v[64:67], a[204:207], v[32:35]
    v_mul_f32 v94, v93, v41
    v_fma_f32 v21, v21, v92, -v94
    ds_read_b128 v[64:67], v9 offset:16384
    s_waitcnt lgkmcnt(2)
    v_mfma_f32_16x16x32_bf16 v[28:31], v[56:59], a[136:139], v[28:31]
    v_mul_f32 v94, v93, v42
    v_fma_f32 v22, v22, v92, -v94
    v_mfma_f32_16x16x32_bf16 v[32:35], v[56:59], a[208:211], v[32:35]
    v_mul_f32 v94, v93, v43
    v_fma_f32 v23, v23, v92, -v94
    ds_read_b128 v[56:59], v9 offset:18432
    s_waitcnt lgkmcnt(2)
    v_mfma_f32_16x16x32_bf16 v[28:31], v[60:63], a[140:143], v[28:31]
    v_cvt_pk_bf16_f32 v128, v16, v17
    v_cvt_pk_bf16_f32 v129, v18, v19
    v_mfma_f32_16x16x32_bf16 v[32:35], v[60:63], a[212:215], v[32:35]
    v_cvt_pk_bf16_f32 v130, v24, v25
    v_cvt_pk_bf16_f32 v132, v20, v21
    ds_read_b128 v[60:63], v9 offset:20480
    s_waitcnt lgkmcnt(2)
    v_mfma_f32_16x16x32_bf16 v[28:31], v[64:67], a[144:147], v[28:31]
    v_cvt_pk_bf16_f32 v133, v22, v23
    v_cvt_pk_bf16_f32 v134, v26, v27
    v_mfma_f32_16x16x32_bf16 v[32:35], v[64:67], a[216:219], v[32:35]
    s_cmp_eq_u32 s35, 0
    s_cselect_b32 s46, 0xf149f2ca, 0
    ds_read_b128 v[64:67], v9 offset:22528
    s_waitcnt lgkmcnt(2)
    v_mfma_f32_16x16x32_bf16 v[28:31], v[56:59], a[148:151], v[28:31]
    v_mfma_f32_16x16x32_bf16 v[144:147], v[112:115], v[128:131], 0
    v_mfma_f32_16x16x32_bf16 v[32:35], v[56:59], a[220:223], v[32:35]
    v_mfma_f32_16x16x32_bf16 v[148:151], v[132:135], v[128:131], 0
    ds_read_b128 v[56:59], v9 offset:24576
    s_waitcnt lgkmcnt(2)
    v_mfma_f32_16x16x32_bf16 v[28:31], v[60:63], a[152:155], v[28:31]
    v_mov_b32 v112, v132
    v_mfma_f32_16x16x32_bf16 v[32:35], v[60:63], a[224:227], v[32:35]
    v_mov_b32 v113, v133
    v_mov_b32 v114, v134
    ds_read_b128 v[60:63], v9 offset:26624
    s_waitcnt lgkmcnt(2)
    v_mfma_f32_16x16x32_bf16 v[28:31], v[64:67], a[156:159], v[28:31]
    v_mfma_f32_16x16x32_bf16 v[32:35], v[64:67], a[228:231], v[32:35]
    v_fma_f32 v144, v144, s52, v72
    ds_read_b128 v[64:67], v9 offset:28672
    s_waitcnt lgkmcnt(2)
    v_mfma_f32_16x16x32_bf16 v[28:31], v[56:59], a[160:163], v[28:31]
    v_fma_f32 v145, v145, s52, v73
    v_fma_f32 v146, v146, s52, v74
    v_fma_f32 v147, v147, s52, v75
    v_mfma_f32_16x16x32_bf16 v[32:35], v[56:59], a[232:235], v[32:35]
    v_fma_f32 v148, v148, s52, v76
    v_fma_f32 v149, v149, s52, v77
    v_fma_f32 v150, v150, s52, v78
    ds_read_b128 v[56:59], v9 offset:30720
    s_waitcnt lgkmcnt(2)
    v_mfma_f32_16x16x32_bf16 v[28:31], v[60:63], a[164:167], v[28:31]
    v_fma_f32 v151, v151, s52, v79
    v_add_f32 v144, s46, v144
    v_add_f32 v145, s46, v145
    v_mfma_f32_16x16x32_bf16 v[32:35], v[60:63], a[236:239], v[32:35]
    v_add_f32 v146, s46, v146
    v_add_f32 v147, s46, v147
    v_max3_f32 v5, v144, v145, v146
    ds_read_b128 v[60:63], v9 offset:32768
    s_waitcnt lgkmcnt(2)
    v_mfma_f32_16x16x32_bf16 v[28:31], v[64:67], a[168:171], v[28:31]
    v_max3_f32 v5, v5, v147, v148
    v_max3_f32 v5, v5, v149, v150
    v_max_f32 v5, v5, v151
    v_mfma_f32_16x16x32_bf16 v[32:35], v[64:67], a[240:243], v[32:35]
    v_mov_b32 v6, v5
    s_nop 1
    v_permlane32_swap_b32 v5, v6
    ds_read_b128 v[64:67], v9 offset:34816
    s_waitcnt lgkmcnt(2)
    v_mfma_f32_16x16x32_bf16 v[28:31], v[56:59], a[172:175], v[28:31]
    v_max_f32 v5, v5, v6
    v_mov_b32 v6, v5
    v_mfma_f32_16x16x32_bf16 v[32:35], v[56:59], a[244:247], v[32:35]
    s_nop 0
    v_permlane16_swap_b32 v5, v6
    v_max_f32 v5, v5, v6
    v_sub_f32 v144, v144, v5
    s_waitcnt lgkmcnt(1)
    v_mfma_f32_16x16x32_bf16 v[28:31], v[60:63], a[176:179], v[28:31]
    v_sub_f32 v145, v145, v5
    v_sub_f32 v146, v146, v5
    v_sub_f32 v147, v147, v5
    v_mfma_f32_16x16x32_bf16 v[32:35], v[60:63], a[248:251], v[32:35]
    v_sub_f32 v148, v148, v5
    v_sub_f32 v149, v149, v5
    v_sub_f32 v150, v150, v5
    s_waitcnt lgkmcnt(0)
    v_mfma_f32_16x16x32_bf16 v[28:31], v[64:67], a[180:183], v[28:31]
    v_sub_f32 v151, v151, v5
    v_exp_f32 v144, v144
    v_exp_f32 v145, v145
    v_mfma_f32_16x16x32_bf16 v[32:35], v[64:67], a[252:255], v[32:35]
    v_exp_f32 v146, v146
    v_exp_f32 v147, v147
    v_exp_f32 v148, v148
    v_cmp_eq_u32 s[76:77], 1, v2
    v_cmp_eq_u32 vcc, 2, v2
    s_cmp_eq_u64 s[76:77], -1
    s_cselect_b32 s38, 1, 0
    s_cmp_lg_u32 s38, 0
    s_cselect_b64 exec, 1, 0
    v_mov_b32 v15, s32
    ds_write_b32 v110, v15
    v_mov_b32 v2, 2
    s_mov_b64 exec, -1
    s_add_u32 s32, s32, s38
    s_mul_i32 s38, s38, 22528
    s_add_u32 s33, s33, s38
    s_cmp_eq_u64 vcc, 0
    s_cselect_b32 s38, s32, 0x7fff
    s_cmp_le_u32 s38, s39
    s_cselect_b64 exec, -1, 0
    v_mov_b32 v2, 2
    buffer_load_dword v2, v1, s[8:11], s33 offen sc1
    s_mov_b64 exec, -1
    v_exp_f32 v149, v149
    v_exp_f32 v150, v150
    v_exp_f32 v151, v151
    v_cvt_pk_bf16_f32 v68, v144, v145
    v_cvt_pk_bf16_f32 v69, v146, v147
    v_cvt_pk_bf16_f32 v70, v148, v149
    v_cvt_pk_bf16_f32 v71, v150, v151
    s_nop 1
    v_mfma_f32_16x16x32_bf16 v[16:19], v[116:119], v[68:71], 0
    s_mul_i32 s46, s57, 36864
    s_add_u32 s46, s46, 17301504
    s_nop 5
    v_rcp_f32 v6, v16
    v_mul_f32 v94, v97, v48
    v_fma_f32 v28, v28, v96, -v94
    v_mul_f32 v94, v99, v49
    v_fma_f32 v29, v29, v98, -v94
    v_mul_f32 v94, v101, v50
    v_fma_f32 v30, v30, v100, -v94
    v_mul_f32 v94, v103, v51
    v_fma_f32 v31, v31, v102, -v94
    v_cvt_pk_bf16_f32 v138, v28, v29
    v_cvt_pk_bf16_f32 v139, v30, v31
    v_mul_f32 v94, v97, v52
    v_fma_f32 v32, v32, v96, -v94
    v_mfma_f32_16x16x32_bf16 v[20:23], v[136:139], v[68:71], 0
    v_mul_f32 v94, v99, v53
    v_fma_f32 v33, v33, v98, -v94
    v_mul_f32 v94, v101, v54
    v_fma_f32 v34, v34, v100, -v94
    v_mul_f32 v94, v103, v55
    v_fma_f32 v35, v35, v102, -v94
    v_cvt_pk_bf16_f32 v142, v32, v33
    v_cvt_pk_bf16_f32 v143, v34, v35
    v_mov_b32 v136, v138
    v_mov_b32 v137, v139
    v_mfma_f32_16x16x32_bf16 v[24:27], v[140:143], v[68:71], 0
    v_mul_f32 v20, v6, v20
    v_mul_f32 v21, v6, v21
    v_mul_f32 v22, v6, v22
    v_mul_f32 v23, v6, v23
    v_cvt_pk_bf16_f32 v20, v20, v21
    v_cvt_pk_bf16_f32 v21, v22, v23
    s_mov_b64 exec, -1
    buffer_store_dwordx2 v[20:21], v13, s[8:11], s46 offen
    s_and_b64 exec, exec, s[78:79]
    buffer_store_dwordx2 v[20:21], v13, s[8:11], s46 offen sc1
    s_mov_b64 exec, -1
    v_mov_b32 v140, v142
    v_mov_b32 v141, v143
    v_mul_f32 v24, v6, v24
    v_mul_f32 v25, v6, v25
    v_cvt_pk_bf16_f32 v24, v24, v25
    s_mov_b64 exec, 0xffff
    buffer_store_dword v24, v14, s[8:11], s46 offen
    s_and_b64 exec, exec, s[78:79]
    buffer_store_dword v24, v14, s[8:11], s46 offen sc1
    s_mov_b64 exec, -1
    s_mul_i32 s43, s57, 22528
    s_add_u32 s43, s43, s49
    s_branch Laq_head
Laq_f_8:
    ds_read_b128 v[60:63], v9 offset:8192
    s_waitcnt lgkmcnt(2)
    v_mfma_f32_16x16x32_bf16 v[28:31], v[64:67], a[120:123], v[28:31]
    v_mul_f32 v94, v93, v38
    v_fma_f32 v18, v18, v92, -v94
    v_mfma_f32_16x16x32_bf16 v[32:35], v[64:67], a[192:195], v[32:35]
    v_mul_f32 v94, v93, v39
    v_fma_f32 v19, v19, v92, -v94
    ds_read_b128 v[64:67], v9 offset:10240
    s_waitcnt lgkmcnt(2)
    v_mfma_f32_16x16x32_bf16 v[28:31], v[56:59], a[124:127], v[28:31]
    v_mul_f32 v94, v93, v44
    v_fma_f32 v24, v24, v92, -v94
    v_mfma_f32_16x16x32_bf16 v[32:35], v[56:59], a[196:199], v[32:35]
    v_mul_f32 v94, v93, v45
    v_fma_f32 v25, v25, v92, -v94
    ds_read_b128 v[56:59], v9 offset:12288
    s_waitcnt lgkmcnt(2)
    v_mfma_f32_16x16x32_bf16 v[28:31], v[60:63], a[128:131], v[28:31]
    v_mul_f32 v94, v93, v46
    v_fma_f32 v26, v26, v92, -v94
    v_mfma_f32_16x16x32_bf16 v[32:35], v[60:63], a[200:203], v[32:35]
    v_mul_f32 v94, v93, v47
    v_fma_f32 v27, v27, v92, -v94
    ds_read_b128 v[60:63], v9 offset:14336
    s_waitcnt lgkmcnt(2)
    v_mfma_f32_16x16x32_bf16 v[28:31], v[64:67], a[132:135], v[28:31]
    v_mul_f32 v94, v93, v40
    v_fma_f32 v20, v20, v92, -v94
    v_mfma_f32_16x16x32_bf16 v[32:35], v[64:67], a[204:207], v[32:35]
    v_mul_f32 v94, v93, v41
    v_fma_f32 v21, v21, v92, -v94
    ds_read_b128 v[64:67], v9 offset:16384
    s_waitcnt lgkmcnt(2)
    v_mfma_f32_16x16x32_bf16 v[28:31], v[56:59], a[136:139], v[28:31]
    v_mul_f32 v94, v93, v42
    v_fma_f32 v22, v22, v92, -v94
    v_mfma_f32_16x16x32_bf16 v[32:35], v[56:59], a[208:211], v[32:35]
    v_mul_f32 v94, v93, v43
    v_fma_f32 v23, v23, v92, -v94
    ds_read_b128 v[56:59], v9 offset:18432
    s_waitcnt lgkmcnt(2)
    v_mfma_f32_16x16x32_bf16 v[28:31], v[60:63], a[140:143], v[28:31]
    v_cvt_pk_bf16_f32 v128, v16, v17
    v_cvt_pk_bf16_f32 v129, v18, v19
    v_mfma_f32_16x16x32_bf16 v[32:35], v[60:63], a[212:215], v[32:35]
    v_cvt_pk_bf16_f32 v130, v24, v25
    v_cvt_pk_bf16_f32 v132, v20, v21
    ds_read_b128 v[60:63], v9 offset:20480
    s_waitcnt lgkmcnt(2)
    v_mfma_f32_16x16x32_bf16 v[28:31], v[64:67], a[144:147], v[28:31]
    v_cvt_pk_bf16_f32 v133, v22, v23
    v_cvt_pk_bf16_f32 v134, v26, v27
    v_mfma_f32_16x16x32_bf16 v[32:35], v[64:67], a[216:219], v[32:35]
    s_cmp_eq_u32 s35, 0
    s_cselect_b32 s46, 0xf149f2ca, 0
    ds_read_b128 v[64:67], v9 offset:22528
    s_waitcnt lgkmcnt(2)
    v_mfma_f32_16x16x32_bf16 v[28:31], v[56:59], a[148:151], v[28:31]
    s_add_u32 m0, s59, 0
    s_add_u32 s47, s41, 0
    buffer_load_dwordx4 v0, s[8:11], s47 offen offset:0 lds
    v_mfma_f32_16x16x32_bf16 v[144:147], v[112:115], v[128:131], 0
    buffer_load_dwordx4 v0, s[8:11], s47 offen offset:1024 lds
    buffer_load_dwordx4 v0, s[8:11], s47 offen offset:2048 lds
    buffer_load_dwordx4 v0, s[8:11], s47 offen offset:3072 lds
    v_mfma_f32_16x16x32_bf16 v[32:35], v[56:59], a[220:223], v[32:35]
    s_add_u32 m0, s59, 4096
    s_add_u32 s47, s41, 4096
    buffer_load_dwordx4 v0, s[8:11], s47 offen offset:0 lds
    v_mfma_f32_16x16x32_bf16 v[148:151], v[132:135], v[128:131], 0
    buffer_load_dwordx4 v0, s[8:11], s47 offen offset:1024 lds
    buffer_load_dwordx4 v0, s[8:11], s47 offen offset:2048 lds
    buffer_load_dwordx4 v0, s[8:11], s47 offen offset:3072 lds
    ds_read_b128 v[56:59], v9 offset:24576
    s_waitcnt lgkmcnt(2)
    v_mfma_f32_16x16x32_bf16 v[28:31], v[60:63], a[152:155], v[28:31]
    v_mov_b32 v112, v132
    v_mfma_f32_16x16x32_bf16 v[32:35], v[60:63], a[224:227], v[32:35]
    v_mov_b32 v113, v133
    v_mov_b32 v114, v134
    ds_read_b128 v[60:63], v9 offset:26624
    s_waitcnt lgkmcnt(2)
    v_mfma_f32_16x16x32_bf16 v[28:31], v[64:67], a[156:159], v[28:31]
    s_add_u32 m0, s59, 8192
    s_add_u32 s47, s41, 8192
    buffer_load_dwordx4 v0, s[8:11], s47 offen offset:0 lds
    v_mfma_f32_16x16x32_bf16 v[32:35], v[64:67], a[228:231], v[32:35]
    s_mul_i32 s48, s36, 786432
    s_mul_i32 s18, s37, 6144
    s_add_u32 s48, s48, s18
    s_add_u32 s48, s48, 15728640
    buffer_load_dwordx4 v[80:83], v10, s[8:11], s48 offen offset:0
    v_fma_f32 v144, v144, s52, v72
    ds_read_b128 v[64:67], v9 offset:28672
    s_waitcnt lgkmcnt(2)
    v_mfma_f32_16x16x32_bf16 v[28:31], v[56:59], a[160:163], v[28:31]
    v_fma_f32 v145, v145, s52, v73
    v_fma_f32 v146, v146, s52, v74
    v_fma_f32 v147, v147, s52, v75
    v_mfma_f32_16x16x32_bf16 v[32:35], v[56:59], a[232:235], v[32:35]
    v_fma_f32 v148, v148, s52, v76
    v_fma_f32 v149, v149, s52, v77
    v_fma_f32 v150, v150, s52, v78
    ds_read_b128 v[56:59], v9 offset:30720
    s_waitcnt lgkmcnt(2)
    v_mfma_f32_16x16x32_bf16 v[28:31], v[60:63], a[164:167], v[28:31]
    v_fma_f32 v151, v151, s52, v79
    v_add_f32 v144, s46, v144
    v_add_f32 v145, s46, v145
    v_mfma_f32_16x16x32_bf16 v[32:35], v[60:63], a[236:239], v[32:35]
    v_add_f32 v146, s46, v146
    v_add_f32 v147, s46, v147
    v_max3_f32 v5, v144, v145, v146
    ds_read_b128 v[60:63], v9 offset:32768
    s_waitcnt lgkmcnt(2)
    v_mfma_f32_16x16x32_bf16 v[28:31], v[64:67], a[168:171], v[28:31]
    v_max3_f32 v5, v5, v147, v148
    v_max3_f32 v5, v5, v149, v150
    v_max_f32 v5, v5, v151
    v_mfma_f32_16x16x32_bf16 v[32:35], v[64:67], a[240:243], v[32:35]
    buffer_load_dwordx4 v[84:87], v10, s[8:11], s48 offen offset:512
    v_mov_b32 v6, v5
    s_nop 1
    v_permlane32_swap_b32 v5, v6
    ds_read_b128 v[64:67], v9 offset:34816
    s_waitcnt lgkmcnt(2)
    v_mfma_f32_16x16x32_bf16 v[28:31], v[56:59], a[172:175], v[28:31]
    buffer_load_dwordx4 v[88:91], v10, s[8:11], s48 offen offset:1024
    v_max_f32 v5, v5, v6
    v_mov_b32 v6, v5
    v_mfma_f32_16x16x32_bf16 v[32:35], v[56:59], a[244:247], v[32:35]
    s_nop 0
    v_permlane16_swap_b32 v5, v6
    v_max_f32 v5, v5, v6
    v_sub_f32 v144, v144, v5
    s_waitcnt lgkmcnt(1)
    v_mfma_f32_16x16x32_bf16 v[28:31], v[60:63], a[176:179], v[28:31]
    v_sub_f32 v145, v145, v5
    v_sub_f32 v146, v146, v5
    v_sub_f32 v147, v147, v5
    v_mfma_f32_16x16x32_bf16 v[32:35], v[60:63], a[248:251], v[32:35]
    v_sub_f32 v148, v148, v5
    v_sub_f32 v149, v149, v5
    v_sub_f32 v150, v150, v5
    s_waitcnt lgkmcnt(0)
    v_mfma_f32_16x16x32_bf16 v[28:31], v[64:67], a[180:183], v[28:31]
    v_sub_f32 v151, v151, v5
    v_exp_f32 v144, v144
    v_exp_f32 v145, v145
    v_mfma_f32_16x16x32_bf16 v[32:35], v[64:67], a[252:255], v[32:35]
    v_exp_f32 v146, v146
    v_exp_f32 v147, v147
    v_exp_f32 v148, v148
    v_cmp_eq_u32 s[76:77], 1, v2
    v_cmp_eq_u32 vcc, 2, v2
    s_cmp_eq_u64 s[76:77], -1
    s_cselect_b32 s38, 1, 0
    s_cmp_lg_u32 s38, 0
    s_cselect_b64 exec, 1, 0
    v_mov_b32 v15, s32
    ds_write_b32 v110, v15
    v_mov_b32 v2, 2
    s_mov_b64 exec, -1
    s_add_u32 s32, s32, s38
    s_mul_i32 s38, s38, 22528
    s_add_u32 s33, s33, s38
    s_cmp_eq_u64 vcc, 0
    s_cselect_b32 s38, s32, 0x7fff
    s_cmp_le_u32 s38, s39
    s_cselect_b64 exec, -1, 0
    v_mov_b32 v2, 2
    buffer_load_dword v2, v1, s[8:11], s33 offen sc1
    s_mov_b64 exec, -1
    v_exp_f32 v149, v149
    v_exp_f32 v150, v150
    v_exp_f32 v151, v151
    v_cvt_pk_bf16_f32 v68, v144, v145
    v_cvt_pk_bf16_f32 v69, v146, v147
    v_cvt_pk_bf16_f32 v70, v148, v149
    v_cvt_pk_bf16_f32 v71, v150, v151
    s_nop 1
    v_mfma_f32_16x16x32_bf16 v[16:19], v[116:119], v[68:71], 0
    s_mul_i32 s46, s57, 36864
    s_add_u32 s46, s46, 17301504
    s_nop 5
    v_rcp_f32 v6, v16
    v_mul_f32 v94, v97, v48
    v_fma_f32 v28, v28, v96, -v94
    v_mul_f32 v94, v99, v49
    v_fma_f32 v29, v29, v98, -v94
    v_mul_f32 v94, v101, v50
    v_fma_f32 v30, v30, v100, -v94
    v_mul_f32 v94, v103, v51
    v_fma_f32 v31, v31, v102, -v94
    v_cvt_pk_bf16_f32 v138, v28, v29
    v_cvt_pk_bf16_f32 v139, v30, v31
    v_mul_f32 v94, v97, v52
    v_fma_f32 v32, v32, v96, -v94
    v_mfma_f32_16x16x32_bf16 v[20:23], v[136:139], v[68:71], 0
    v_mul_f32 v94, v99, v53
    v_fma_f32 v33, v33, v98, -v94
    v_mul_f32 v94, v101, v54
    v_fma_f32 v34, v34, v100, -v94
    v_mul_f32 v94, v103, v55
    v_fma_f32 v35, v35, v102, -v94
    v_cvt_pk_bf16_f32 v142, v32, v33
    v_cvt_pk_bf16_f32 v143, v34, v35
    v_mov_b32 v136, v138
    v_mov_b32 v137, v139
    v_mfma_f32_16x16x32_bf16 v[24:27], v[140:143], v[68:71], 0
    v_mul_f32 v20, v6, v20
    v_mul_f32 v21, v6, v21
    v_mul_f32 v22, v6, v22
    v_mul_f32 v23, v6, v23
    v_cvt_pk_bf16_f32 v20, v20, v21
    v_cvt_pk_bf16_f32 v21, v22, v23
    s_mov_b64 exec, -1
    buffer_store_dwordx2 v[20:21], v13, s[8:11], s46 offen
    s_and_b64 exec, exec, s[78:79]
    buffer_store_dwordx2 v[20:21], v13, s[8:11], s46 offen sc1
    s_mov_b64 exec, -1
    v_mov_b32 v140, v142
    v_mov_b32 v141, v143
    v_mul_f32 v24, v6, v24
    v_mul_f32 v25, v6, v25
    v_cvt_pk_bf16_f32 v24, v24, v25
    s_mov_b64 exec, 0xffff
    buffer_store_dword v24, v14, s[8:11], s46 offen
    s_and_b64 exec, exec, s[78:79]
    buffer_store_dword v24, v14, s[8:11], s46 offen sc1
    s_mov_b64 exec, -1
    s_mul_i32 s43, s57, 22528
    s_add_u32 s43, s43, s49
    s_branch Laq_head
Laq_none:
    ds_read_b32 v15, v110
    s_waitcnt lgkmcnt(0)
    v_readfirstlane_b32 s17, v15
    s_nop 0
    s_cmp_lt_i32 s17, s37
    s_cbranch_scc1 Laq_nopost
    s_add_u32 m0, s59, 0
    s_add_u32 s47, s41, 0
    buffer_load_dwordx4 v0, s[8:11], s47 offen offset:0 lds
    buffer_load_dwordx4 v0, s[8:11], s47 offen offset:1024 lds
    buffer_load_dwordx4 v0, s[8:11], s47 offen offset:2048 lds
    buffer_load_dwordx4 v0, s[8:11], s47 offen offset:3072 lds
    s_add_u32 m0, s59, 4096
    s_add_u32 s47, s41, 4096
    buffer_load_dwordx4 v0, s[8:11], s47 offen offset:0 lds
    buffer_load_dwordx4 v0, s[8:11], s47 offen offset:1024 lds
    buffer_load_dwordx4 v0, s[8:11], s47 offen offset:2048 lds
    buffer_load_dwordx4 v0, s[8:11], s47 offen offset:3072 lds
    s_add_u32 m0, s59, 8192
    s_add_u32 s47, s41, 8192
    buffer_load_dwordx4 v0, s[8:11], s47 offen offset:0 lds
    s_mul_i32 s48, s36, 786432
    s_mul_i32 s18, s37, 6144
    s_add_u32 s48, s48, s18
    s_add_u32 s48, s48, 15728640
    buffer_load_dwordx4 v[80:83], v10, s[8:11], s48 offen offset:0
    buffer_load_dwordx4 v[84:87], v10, s[8:11], s48 offen offset:512
    buffer_load_dwordx4 v[88:91], v10, s[8:11], s48 offen offset:1024
    s_waitcnt vmcnt(12)
    s_cmp_lg_u32 s43, 0
    s_cselect_b64 exec, 1, 0
    buffer_store_dword v3, v4, s[8:11], s43 offen
    s_and_b64 exec, exec, s[78:79]
    buffer_store_dword v3, v4, s[8:11], s43 offen sc1
    s_mov_b64 exec, -1
    s_mov_b32 s43, 0
    s_waitcnt vmcnt(2) lgkmcnt(0)
    s_branch Laq_head2
Laq_nopost:
    s_waitcnt vmcnt(0)
    s_cmp_lg_u32 s43, 0
    s_cselect_b64 exec, 1, 0
    buffer_store_dword v3, v4, s[8:11], s43 offen
    s_and_b64 exec, exec, s[78:79]
    buffer_store_dword v3, v4, s[8:11], s43 offen sc1
    s_mov_b64 exec, -1
    s_mov_b32 s43, 0
    s_cmp_ge_u32 s37, 64
    s_cbranch_scc1 Laq_end
Laq_wait:
    s_mov_b32 s16, 0
    s_cmp_lg_u32 s14, 0
    s_cbranch_scc1 Laq_wl
Laq_wp:
    buffer_load_dword v2, v1, s[8:11], s60 offen sc1
    s_add_u32 s16, s16, 1
    s_cmp_gt_u32 s16, 100000
    s_cbranch_scc1 Laq_giveup
    s_waitcnt vmcnt(0)
    v_cmp_eq_u32 vcc, 0, v2
    s_nop 0
    s_cbranch_vccz Laq_wok
    s_sleep 4
    s_branch Laq_wp
Laq_giveup:
    v_mov_b32 v5, -2
    ds_write_b32 v110, v5
    s_waitcnt lgkmcnt(0)
    s_branch L_role_aq_abort
Laq_wok:
    v_mov_b32 v5, s37
    ds_write_b32 v110, v5
    s_branch Laq_go
Laq_wl:
    ds_read_b32 v15, v110
    s_add_u32 s16, s16, 1
    s_cmp_gt_u32 s16, 1600000
    s_cbranch_scc1 L_role_aq_abort
    s_waitcnt lgkmcnt(0)
    v_readfirstlane_b32 s17, v15
    s_nop 0
    s_cmp_eq_u32 s17, -2
    s_cbranch_scc1 L_role_aq_abort
    s_cmp_ge_i32 s17, s37
    s_cbranch_scc1 Laq_go
    s_sleep 1
    s_branch Laq_wl
Laq_go:
    s_add_u32 m0, s59, 0
    s_add_u32 s47, s41, 0
    buffer_load_dwordx4 v0, s[8:11], s47 offen offset:0 lds
    buffer_load_dwordx4 v0, s[8:11], s47 offen offset:1024 lds
    buffer_load_dwordx4 v0, s[8:11], s47 offen offset:2048 lds
    buffer_load_dwordx4 v0, s[8:11], s47 offen offset:3072 lds
    s_add_u32 m0, s59, 4096
    s_add_u32 s47, s41, 4096
    buffer_load_dwordx4 v0, s[8:11], s47 offen offset:0 lds
    buffer_load_dwordx4 v0, s[8:11], s47 offen offset:1024 lds
    buffer_load_dwordx4 v0, s[8:11], s47 offen offset:2048 lds
    buffer_load_dwordx4 v0, s[8:11], s47 offen offset:3072 lds
    s_add_u32 m0, s59, 8192
    s_add_u32 s47, s41, 8192
    buffer_load_dwordx4 v0, s[8:11], s47 offen offset:0 lds
    s_mul_i32 s48, s36, 786432
    s_mul_i32 s18, s37, 6144
    s_add_u32 s48, s48, s18
    s_add_u32 s48, s48, 15728640
    buffer_load_dwordx4 v[80:83], v10, s[8:11], s48 offen offset:0
    buffer_load_dwordx4 v[84:87], v10, s[8:11], s48 offen offset:512
    buffer_load_dwordx4 v[88:91], v10, s[8:11], s48 offen offset:1024
    s_waitcnt vmcnt(0) lgkmcnt(0)
    s_branch Laq_head2
Laq_end:
    s_branch L_role_aq_exit
L_role_aq_abort:
    s_waitcnt lgkmcnt(0)
    s_mov_b64 exec, -1
    v_mov_b32 v0, 60
    s_lshl_b32 s5, s3, 8
    s_or_b32 s5, s5, s4
    s_or_b32 s5, s5, 0x10000
    v_mov_b32 v1, s5
    global_store_dword v0, v1, s[12:13]
    s_endpgm
L_role_aq_exit:
    s_endpgm
.p2align 6
L_role_ta:
    v_and_b32 v5, 63, v0
    v_lshlrev_b32 v0, 4, v5
    v_and_b32 v7, 15, v5
    v_lshrrev_b32 v8, 4, v5
    v_min_u32 v1, 12, v5
    v_lshrrev_b32 v6, 2, v1
    v_and_b32 v1, 3, v1
    v_lshlrev_b32 v1, 2, v1
    v_lshl_add_u32 v1, v6, 7, v1
    v_mov_b32 v3, 1
    v_mov_b32 v4, 0
    s_mov_b32 s44, 0x05040100
    s_mov_b32 s45, 0x07060302
    s_cmp_ge_u32 s15, 11
    s_cselect_b32 s36, 1, 0
    s_cselect_b32 s17, 11, 0
    s_sub_u32 s17, s15, s17
    s_mul_i32 s50, s17, 3
    s_add_u32 s50, s50, s14
    s_cmp_eq_u32 s14, 3
    s_cselect_b32 s50, 32, s50
    s_mov_b32 s40, s50
    s_mov_b32 s37, 0
    s_mov_b32 s52, 0x3e0293ee
    v_lshrrev_b32 v5, 2, v7
    v_and_b32 v6, 1, v7
    v_lshl_add_u32 v5, v5, 1, v6
    v_lshlrev_b32 v9, 8, v5
    v_lshl_add_u32 v9, v8, 4, v9
    v_lshrrev_b32 v10, 1, v0
    v_mov_b32 v11, 384
    v_mov_b32 v6, 0xf149f2ca
    v_mov_b32 v21, 0
    v_mov_b32 v22, 0
    s_mul_i32 s42, s36, 1441792
    s_lshl_b32 s17, s50, 9
    s_add_u32 s42, s42, s17
    s_add_u32 s42, s42, 5376
    s_mul_i32 s51, s36, 50331648
    s_lshl_b32 s17, s50, 13
    s_add_u32 s51, s51, s17
    s_add_u32 s51, s51, 44040192
    s_lshl_b32 s47, s36, 11
    s_add_u32 s47, s47, s50
    s_lshl_b32 s48, s47, 13
    s_add_u32 s48, s48, 144703488
    s_lshl_b32 s47, s47, 12
    s_add_u32 s47, s47, 27262976
    s_mul_i32 s43, s36, 1441792
    s_lshr_b32 s17, s50, 2
    s_lshl_b32 s17, s17, 7
    s_add_u32 s43, s43, s17
    s_and_b32 s17, s50, 3
    s_lshl_b32 s17, s17, 2
    s_add_u32 s43, s43, s17
    s_add_u32 s43, s43, 4224
    s_mov_b32 s28, s8
    s_mov_b32 s29, s9
    s_mov_b32 s30, 0
    s_mov_b32 s31, 0x00020000
    s_mov_b32 s39, 0
    s_mov_b32 s38, 0
    s_mov_b32 s49, 0
    s_mov_b32 s20, s8
    s_mov_b32 s21, s9
    s_mov_b32 s22, 0
    s_mov_b32 s23, 0x00020000
    v_mov_b32 v16, 0x3f803f80
    v_lshl_add_u32 v5, v8, 2, 0
    v_cmp_le_u32 vcc, v5, v7
    s_nop 1
    v_cndmask_b32 v236, v6, v4, vcc
    v_mov_b32 v17, 0x3f803f80
    v_lshl_add_u32 v5, v8, 2, 1
    v_cmp_le_u32 vcc, v5, v7
    s_nop 1
    v_cndmask_b32 v237, v6, v4, vcc
    v_mov_b32 v18, 0x3f803f80
    v_lshl_add_u32 v5, v8, 2, 2
    v_cmp_le_u32 vcc, v5, v7
    s_nop 1
    v_cndmask_b32 v238, v6, v4, vcc
    v_mov_b32 v19, 0x3f803f80
    v_lshl_add_u32 v5, v8, 2, 3
    v_cmp_le_u32 vcc, v5, v7
    s_nop 1
    v_cndmask_b32 v239, v6, v4, vcc
    v_mov_b32 v15, 0
    s_cmp_lg_u32 s14, 0
    s_cbranch_scc1 Lta_inia_d
    v_mov_b32 v5, 40
    s_mov_b32 s16, 0
Lta_inia:
    global_load_dword v6, v5, s[12:13] sc1
    s_add_u32 s16, s16, 1
    s_cmp_gt_u32 s16, 100000
    s_cbranch_scc1 L_role_ta_abort
    s_waitcnt vmcnt(0)
    v_cmp_gt_u32 vcc, 72, v6
    s_nop 0
    s_cbranch_vccz Lta_inia_d
    s_sleep 8
    s_branch Lta_inia
Lta_inia_d:
    s_barrier
    s_cmp_eq_u32 s36, 0
    s_cbranch_scc1 Lta_ini_sk
    s_cmp_lg_u32 s14, 0
    s_cbranch_scc1 Lta_inib_d
    v_mov_b32 v5, 160
    s_mov_b32 s16, 0
Lta_inib:
    global_load_dword v6, v5, s[12:13] sc1
    s_add_u32 s16, s16, 1
    s_cmp_gt_u32 s16, 100000
    s_cbranch_scc1 L_role_ta_abort
    s_waitcnt vmcnt(0)
    v_cmp_gt_u32 vcc, 64, v6
    s_nop 0
    s_cbranch_vccz Lta_inib_d
    s_sleep 8
    s_branch Lta_inib
Lta_inib_d:
    s_barrier
Lta_ini_sk:
    s_cmp_ge_u32 s40, 32
    s_cbranch_scc1 L_role_ta_exit
Lta0:
    s_cmp_eq_u32 s39, 1
    s_cbranch_scc1 Lta0_have
    s_waitcnt vmcnt(0)
    s_cmp_lg_u32 s49, 0
    s_cselect_b64 exec, 1, 0
    buffer_store_dword v3, v4, s[8:11], s43 offen sc1
    s_mov_b64 exec, -1
    s_add_u32 s43, s43, s49
    s_mov_b32 s49, 0
    s_mov_b32 s16, 0
Lta0_f:
    buffer_load_dword v2, v1, s[8:11], s42 offen sc1
    s_add_u32 s16, s16, 1
    s_cmp_gt_u32 s16, 100000
    s_cbranch_scc1 L_role_ta_abort
    s_waitcnt vmcnt(0)
    v_cmp_eq_u32 vcc, 0, v2
    s_nop 0
    s_and_b32 s17, vcc_lo, 0xfff
    s_cbranch_scc0 Lta0_fd
    s_sleep 4
    s_branch Lta0_f
Lta0_fd:
    s_add_u32 s46, s51, 0
    buffer_load_dwordx4 v[140:143], v0, s[8:11], s46 offen offset:0
    buffer_load_dwordx4 v[144:147], v0, s[8:11], s46 offen offset:1024
    buffer_load_dwordx4 v[148:151], v0, s[8:11], s46 offen offset:2048
    buffer_load_dwordx4 v[152:155], v0, s[8:11], s46 offen offset:3072
    s_add_u32 s46, s51, 4096
    buffer_load_dwordx4 v[156:159], v0, s[8:11], s46 offen offset:0
    buffer_load_dwordx4 v[160:163], v0, s[8:11], s46 offen offset:1024
    buffer_load_dwordx4 v[164:167], v0, s[8:11], s46 offen offset:2048
    buffer_load_dwordx4 v[168:171], v0, s[8:11], s46 offen offset:3072
    s_add_u32 s46, s51, 16777216
    buffer_load_dwordx4 v[172:175], v0, s[8:11], s46 offen offset:0
    buffer_load_dwordx4 v[176:179], v0, s[8:11], s46 offen offset:1024
    buffer_load_dwordx4 v[180:183], v0, s[8:11], s46 offen offset:2048
    buffer_load_dwordx4 v[184:187], v0, s[8:11], s46 offen offset:3072
    s_add_u32 s46, s51, 16781312
    buffer_load_dwordx4 v[188:191], v0, s[8:11], s46 offen offset:0
    buffer_load_dwordx4 v[192:195], v0, s[8:11], s46 offen offset:1024
    buffer_load_dwordx4 v[196:199], v0, s[8:11], s46 offen offset:2048
    buffer_load_dwordx4 v[200:203], v0, s[8:11], s46 offen offset:3072
    s_add_u32 s46, s51, 33554432
    buffer_load_dwordx4 v[204:207], v0, s[8:11], s46 offen offset:0
    buffer_load_dwordx4 v[208:211], v0, s[8:11], s46 offen offset:1024
    buffer_load_dwordx4 v[212:215], v0, s[8:11], s46 offen offset:2048
    buffer_load_dwordx4 v[216:219], v0, s[8:11], s46 offen offset:3072
    s_add_u32 s46, s51, 33558528
    buffer_load_dwordx4 v[220:223], v0, s[8:11], s46 offen offset:0
    buffer_load_dwordx4 v[224:227], v0, s[8:11], s46 offen offset:1024
    buffer_load_dwordx4 v[228:231], v0, s[8:11], s46 offen offset:2048
    buffer_load_dwordx4 v[232:235], v0, s[8:11], s46 offen offset:3072
    s_waitcnt vmcnt(0)
Lta0_have:
    buffer_load_dword v2, v11, s[8:11], s42 offen sc1
    s_waitcnt vmcnt(5)
    v_cmp_eq_u32 vcc, 0, v15
    s_add_u32 s51, s51, 262144
    s_add_u32 s37, s37, 1
    s_mov_b32 s62, s38
    s_and_b32 s17, vcc_lo, 0xfff
    s_cselect_b32 s39, 0, 1
    s_cmp_eq_u64 vcc, 0
    s_cselect_b32 s38, 1, 0
    s_cmp_lt_u32 s37, 64
    s_cselect_b32 s39, s39, 0
    s_cselect_b32 s38, s38, 0
    s_cmp_eq_u32 s39, 1
    s_cselect_b32 s30, 268435456, 0
    s_cmp_eq_u32 s38, 1
    s_cselect_b32 s22, 268435456, 0
    v_mfma_f32_16x16x32_bf16 v[32:35], v[172:175], v[140:143], 0
    s_add_u32 s46, s51, 0
    buffer_load_dwordx4 a[0:3], v0, s[28:31], s46 offen offset:0
    v_mfma_f32_16x16x32_bf16 v[36:39], v[172:175], v[144:147], 0
    buffer_load_dwordx4 a[4:7], v0, s[28:31], s46 offen offset:1024
    v_mfma_f32_16x16x32_bf16 v[40:43], v[176:179], v[144:147], 0
    buffer_load_dwordx4 a[8:11], v0, s[28:31], s46 offen offset:2048
    v_mfma_f32_16x16x32_bf16 v[32:35], v[180:183], v[148:151], v[32:35]
    buffer_load_dwordx4 a[12:15], v0, s[28:31], s46 offen offset:3072
    v_mfma_f32_16x16x32_bf16 v[36:39], v[180:183], v[152:155], v[36:39]
    s_add_u32 s46, s51, 4096
    buffer_load_dwordx4 a[16:19], v0, s[28:31], s46 offen offset:0
    v_mfma_f32_16x16x32_bf16 v[40:43], v[184:187], v[152:155], v[40:43]
    buffer_load_dwordx4 a[20:23], v0, s[28:31], s46 offen offset:1024
    v_mfma_f32_16x16x32_bf16 v[32:35], v[188:191], v[156:159], v[32:35]
    v_mfma_f32_16x16x32_bf16 v[36:39], v[188:191], v[160:163], v[36:39]
    v_mfma_f32_16x16x32_bf16 v[40:43], v[192:195], v[160:163], v[40:43]
    v_mfma_f32_16x16x32_bf16 v[32:35], v[196:199], v[164:167], v[32:35]
    v_mfma_f32_16x16x32_bf16 v[36:39], v[196:199], v[168:171], v[36:39]
    v_mfma_f32_16x16x32_bf16 v[40:43], v[200:203], v[168:171], v[40:43]
    s_waitcnt vmcnt(7)
    s_cmp_lg_u32 s49, 0
    s_cselect_b64 exec, 1, 0
    buffer_store_dword v3, v4, s[8:11], s43 offen sc1
    s_mov_b64 exec, -1
    s_add_u32 s43, s43, s49
    s_mov_b32 s49, 0
    s_cmp_eq_u32 s62, 1
    s_cbranch_scc1 Lta0_km
    s_waitcnt vmcnt(6)
    v_cmp_eq_u32 vcc, 0, v2
    s_nop 0
    s_cbranch_vccz Lta0_r
    s_mov_b32 s16, 0
Lta0_rp:
    buffer_load_dword v2, v11, s[8:11], s42 offen sc1
    s_add_u32 s16, s16, 1
    s_cmp_gt_u32 s16, 100000
    s_cbranch_scc1 L_role_ta_abort
    s_waitcnt vmcnt(0)
    v_cmp_eq_u32 vcc, 0, v2
    s_nop 0
    s_cbranch_vccnz Lta0_rp
Lta0_r:
    buffer_load_dwordx4 a[96:99], v9, s[8:11], s47 offen offset:0
    buffer_load_dwordx4 a[100:103], v9, s[8:11], s47 offen offset:64
    buffer_load_dwordx4 a[104:107], v9, s[8:11], s47 offen offset:128
    buffer_load_dwordx4 a[108:111], v9, s[8:11], s47 offen offset:192
    buffer_load_dwordx2 a[112:113], v10, s[8:11], s47 offen offset:2048
    buffer_load_dwordx2 a[114:115], v10, s[8:11], s47 offen offset:2560
    buffer_load_dwordx2 a[116:117], v10, s[8:11], s47 offen offset:3072
    buffer_load_dwordx2 a[118:119], v10, s[8:11], s47 offen offset:3584
Lta0_km:
    s_add_u32 s42, s42, 22528
    s_add_u32 s47, s47, 131072
    v_fma_f32 v32, v32, s52, v236
    v_fma_f32 v33, v33, s52, v237
    v_fma_f32 v34, v34, s52, v238
    v_fma_f32 v35, v35, s52, v239
    buffer_load_dwordx4 a[24:27], v0, s[28:31], s46 offen offset:2048
    buffer_load_dwordx4 a[28:31], v0, s[28:31], s46 offen offset:3072
    v_mul_f32 v36, s52, v36
    v_mul_f32 v37, s52, v37
    v_mul_f32 v38, s52, v38
    v_mul_f32 v39, s52, v39
    s_add_u32 s46, s51, 16777216
    buffer_load_dwordx4 a[32:35], v0, s[28:31], s46 offen offset:0
    buffer_load_dwordx4 a[36:39], v0, s[28:31], s46 offen offset:1024
    v_fma_f32 v40, v40, s52, v236
    v_fma_f32 v41, v41, s52, v237
    v_fma_f32 v42, v42, s52, v238
    v_fma_f32 v43, v43, s52, v239
    buffer_load_dwordx4 a[40:43], v0, s[28:31], s46 offen offset:2048
    buffer_load_dwordx4 a[44:47], v0, s[28:31], s46 offen offset:3072
    s_waitcnt vmcnt(13)
    v_mfma_f32_16x16x32_bf16 v[44:47], a[96:99], v[140:143], 0
    v_mfma_f32_16x16x32_bf16 v[48:51], a[96:99], v[144:147], 0
    s_add_u32 s46, s51, 16781312
    buffer_load_dwordx4 a[48:51], v0, s[28:31], s46 offen offset:0
    s_waitcnt vmcnt(13)
    v_mfma_f32_16x16x32_bf16 v[44:47], a[100:103], v[148:151], v[44:47]
    v_mfma_f32_16x16x32_bf16 v[48:51], a[100:103], v[152:155], v[48:51]
    buffer_load_dwordx4 a[52:55], v0, s[28:31], s46 offen offset:1024
    s_waitcnt vmcnt(13)
    v_mfma_f32_16x16x32_bf16 v[44:47], a[104:107], v[156:159], v[44:47]
    v_mfma_f32_16x16x32_bf16 v[48:51], a[104:107], v[160:163], v[48:51]
    buffer_load_dwordx4 a[56:59], v0, s[28:31], s46 offen offset:2048
    s_waitcnt vmcnt(13)
    v_mfma_f32_16x16x32_bf16 v[44:47], a[108:111], v[164:167], v[44:47]
    v_mfma_f32_16x16x32_bf16 v[48:51], a[108:111], v[168:171], v[48:51]
    buffer_load_dwordx4 a[60:63], v0, s[28:31], s46 offen offset:3072
    v_max3_f32 v5, v32, v33, v34
    v_max_f32 v5, v5, v35
    s_nop 0
    v_mul_f32 v44, s52, v44
    v_mul_f32 v45, s52, v45
    v_max3_f32 v5, v5, v44, v45
    v_mov_b32 v6, v5
    s_add_u32 s46, s51, 33554432
    buffer_load_dwordx4 a[64:67], v0, s[28:31], s46 offen offset:0
    v_permlane32_swap_b32 v5, v6
    v_max_f32 v5, v5, v6
    v_mov_b32 v6, v5
    buffer_load_dwordx4 a[68:71], v0, s[28:31], s46 offen offset:1024
    s_nop 0
    v_permlane16_swap_b32 v5, v6
    v_max_f32 v5, v5, v6
    v_sub_f32 v32, v32, v5
    v_sub_f32 v33, v33, v5
    v_sub_f32 v34, v34, v5
    v_sub_f32 v35, v35, v5
    v_sub_f32 v44, v44, v5
    v_sub_f32 v45, v45, v5
    v_exp_f32 v32, v32
    v_exp_f32 v33, v33
    v_exp_f32 v34, v34
    v_exp_f32 v35, v35
    v_exp_f32 v44, v44
    v_exp_f32 v45, v45
    v_cvt_pk_bf16_f32 v24, v32, v33
    v_cvt_pk_bf16_f32 v25, v34, v35
    v_mov_b32 v26, 0
    v_mov_b32 v27, 0
    v_cvt_pk_bf16_f32 v20, v44, v45
    v_cvt_pk_bf16_f32 v23, v44, v45
    v_mfma_f32_16x16x32_bf16 v[28:31], v[16:19], v[24:27], 0
    v_mfma_f32_16x16x32_bf16 v[76:79], v[204:207], v[24:27], 0
    v_mfma_f32_16x16x32_bf16 v[80:83], v[208:211], v[24:27], 0
    s_add_u32 s17, s42, 22528
    buffer_load_dword v15, v1, s[8:11], s17 offen sc1
    v_mfma_f32_16x16x32_bf16 v[84:87], v[212:215], v[24:27], 0
    v_mfma_f32_16x16x32_bf16 v[88:91], v[216:219], v[24:27], 0
    buffer_load_dwordx4 a[72:75], v0, s[28:31], s46 offen offset:2048
    v_mfma_f32_16x16x32_bf16 v[92:95], v[220:223], v[24:27], 0
    v_mfma_f32_16x16x32_bf16 v[96:99], v[224:227], v[24:27], 0
    buffer_load_dwordx4 a[76:79], v0, s[28:31], s46 offen offset:3072
    v_mfma_f32_16x16x16_bf16 v[28:31], v[16:17], v[20:21], v[28:31]
    v_mfma_f32_16x16x32_bf16 v[100:103], v[228:231], v[24:27], 0
    v_mfma_f32_16x16x32_bf16 v[104:107], v[232:235], v[24:27], 0
    s_add_u32 s46, s51, 33558528
    buffer_load_dwordx4 a[80:83], v0, s[28:31], s46 offen offset:0
    s_waitcnt vmcnt(19)
    v_mfma_f32_16x16x16_bf16 v[76:79], a[112:113], v[20:21], v[76:79]
    v_mfma_f32_16x16x16_bf16 v[80:83], a[112:113], v[22:23], v[80:83]
    v_rcp_f32 v6, v28
    s_waitcnt vmcnt(18)
    v_mfma_f32_16x16x16_bf16 v[84:87], a[114:115], v[20:21], v[84:87]
    v_mfma_f32_16x16x16_bf16 v[88:91], a[114:115], v[22:23], v[88:91]
    v_mul_f32 v76, v6, v76
    v_mul_f32 v80, v6, v80
    v_cvt_pk_bf16_f32 v108, v76, v80
    v_mul_f32 v77, v6, v77
    v_mul_f32 v81, v6, v81
    v_cvt_pk_bf16_f32 v109, v77, v81
    v_mul_f32 v78, v6, v78
    v_mul_f32 v82, v6, v82
    v_cvt_pk_bf16_f32 v110, v78, v82
    v_mul_f32 v79, v6, v79
    v_mul_f32 v83, v6, v83
    v_cvt_pk_bf16_f32 v111, v79, v83
    s_add_u32 s17, s48, 0
    buffer_store_dwordx4 v[108:111], v0, s[8:11], s17 offen offset:0 sc1
    buffer_load_dwordx4 a[84:87], v0, s[28:31], s46 offen offset:1024
    s_waitcnt vmcnt(19)
    v_mfma_f32_16x16x16_bf16 v[92:95], a[116:117], v[20:21], v[92:95]
    v_mfma_f32_16x16x16_bf16 v[96:99], a[116:117], v[22:23], v[96:99]
    v_mul_f32 v84, v6, v84
    v_mul_f32 v88, v6, v88
    v_cvt_pk_bf16_f32 v112, v84, v88
    v_mul_f32 v85, v6, v85
    v_mul_f32 v89, v6, v89
    v_cvt_pk_bf16_f32 v113, v85, v89
    v_mul_f32 v86, v6, v86
    v_mul_f32 v90, v6, v90
    v_cvt_pk_bf16_f32 v114, v86, v90
    v_mul_f32 v87, v6, v87
    v_mul_f32 v91, v6, v91
    v_cvt_pk_bf16_f32 v115, v87, v91
    buffer_store_dwordx4 v[112:115], v0, s[8:11], s17 offen offset:2048 sc1
    buffer_load_dwordx4 a[88:91], v0, s[28:31], s46 offen offset:2048
    s_waitcnt vmcnt(20)
    v_mfma_f32_16x16x16_bf16 v[100:103], a[118:119], v[20:21], v[100:103]
    v_mfma_f32_16x16x16_bf16 v[104:107], a[118:119], v[22:23], v[104:107]
    v_mul_f32 v92, v6, v92
    v_mul_f32 v96, v6, v96
    v_cvt_pk_bf16_f32 v116, v92, v96
    v_mul_f32 v93, v6, v93
    v_mul_f32 v97, v6, v97
    v_cvt_pk_bf16_f32 v117, v93, v97
    v_mul_f32 v94, v6, v94
    v_mul_f32 v98, v6, v98
    v_cvt_pk_bf16_f32 v118, v94, v98
    v_mul_f32 v95, v6, v95
    v_mul_f32 v99, v6, v99
    v_cvt_pk_bf16_f32 v119, v95, v99
    s_add_u32 s17, s48, 4096
    buffer_store_dwordx4 v[116:119], v0, s[8:11], s17 offen offset:0 sc1
    buffer_load_dwordx4 a[92:95], v0, s[28:31], s46 offen offset:3072
    v_mul_f32 v100, v6, v100
    v_mul_f32 v104, v6, v104
    v_cvt_pk_bf16_f32 v120, v100, v104
    v_mul_f32 v101, v6, v101
    v_mul_f32 v105, v6, v105
    v_cvt_pk_bf16_f32 v121, v101, v105
    v_mul_f32 v102, v6, v102
    v_mul_f32 v106, v6, v106
    v_cvt_pk_bf16_f32 v122, v102, v106
    v_mul_f32 v103, v6, v103
    v_mul_f32 v107, v6, v107
    v_cvt_pk_bf16_f32 v123, v103, v107
    buffer_store_dwordx4 v[120:123], v0, s[8:11], s17 offen offset:2048 sc1
    buffer_load_dwordx4 a[120:123], v9, s[20:23], s47 offen offset:0
    v_max3_f32 v5, v36, v37, v38
    v_max_f32 v5, v5, v39
    v_max3_f32 v5, v5, v40, v41
    v_max3_f32 v5, v5, v42, v43
    v_mul_f32 v48, s52, v48
    v_mul_f32 v49, s52, v49
    v_max3_f32 v5, v5, v48, v49
    v_mov_b32 v6, v5
    buffer_load_dwordx4 a[124:127], v9, s[20:23], s47 offen offset:64
    s_nop 0
    v_permlane32_swap_b32 v5, v6
    v_max_f32 v5, v5, v6
    v_mov_b32 v6, v5
    buffer_load_dwordx4 a[128:131], v9, s[20:23], s47 offen offset:128
    s_nop 0
    v_permlane16_swap_b32 v5, v6
    v_max_f32 v5, v5, v6
    v_sub_f32 v36, v36, v5
    v_sub_f32 v37, v37, v5
    v_sub_f32 v38, v38, v5
    v_sub_f32 v39, v39, v5
    v_sub_f32 v40, v40, v5
    v_sub_f32 v41, v41, v5
    v_sub_f32 v42, v42, v5
    v_sub_f32 v43, v43, v5
    v_sub_f32 v48, v48, v5
    v_sub_f32 v49, v49, v5
    v_exp_f32 v36, v36
    v_exp_f32 v37, v37
    v_exp_f32 v38, v38
    v_exp_f32 v39, v39
    v_exp_f32 v40, v40
    v_exp_f32 v41, v41
    v_exp_f32 v42, v42
    v_exp_f32 v43, v43
    v_exp_f32 v48, v48
    v_exp_f32 v49, v49
    v_cvt_pk_bf16_f32 v24, v36, v37
    v_cvt_pk_bf16_f32 v25, v38, v39
    v_cvt_pk_bf16_f32 v26, v40, v41
    v_cvt_pk_bf16_f32 v27, v42, v43
    v_cvt_pk_bf16_f32 v20, v48, v49
    v_cvt_pk_bf16_f32 v23, v48, v49
    v_mfma_f32_16x16x32_bf16 v[28:31], v[16:19], v[24:27], 0
    v_mfma_f32_16x16x32_bf16 v[76:79], v[204:207], v[24:27], 0
    v_mfma_f32_16x16x32_bf16 v[80:83], v[208:211], v[24:27], 0
    buffer_load_dwordx4 a[132:135], v9, s[20:23], s47 offen offset:192
    v_mfma_f32_16x16x32_bf16 v[84:87], v[212:215], v[24:27], 0
    v_mfma_f32_16x16x32_bf16 v[88:91], v[216:219], v[24:27], 0
    buffer_load_dwordx2 a[136:137], v10, s[20:23], s47 offen offset:2048
    v_mfma_f32_16x16x32_bf16 v[92:95], v[220:223], v[24:27], 0
    v_mfma_f32_16x16x32_bf16 v[96:99], v[224:227], v[24:27], 0
    buffer_load_dwordx2 a[138:139], v10, s[20:23], s47 offen offset:2560
    v_mfma_f32_16x16x16_bf16 v[28:31], v[16:17], v[20:21], v[28:31]
    v_mfma_f32_16x16x32_bf16 v[100:103], v[228:231], v[24:27], 0
    v_mfma_f32_16x16x32_bf16 v[104:107], v[232:235], v[24:27], 0
    buffer_load_dwordx2 a[140:141], v10, s[20:23], s47 offen offset:3072
    buffer_load_dwordx2 a[142:143], v10, s[20:23], s47 offen offset:3584
    v_mfma_f32_16x16x16_bf16 v[76:79], a[112:113], v[20:21], v[76:79]
    v_mfma_f32_16x16x16_bf16 v[80:83], a[112:113], v[22:23], v[80:83]
    v_rcp_f32 v6, v28
    v_mfma_f32_16x16x16_bf16 v[84:87], a[114:115], v[20:21], v[84:87]
    v_mfma_f32_16x16x16_bf16 v[88:91], a[114:115], v[22:23], v[88:91]
    v_mul_f32 v76, v6, v76
    v_mul_f32 v80, v6, v80
    v_cvt_pk_bf16_f32 v124, v76, v80
    v_mul_f32 v77, v6, v77
    v_mul_f32 v81, v6, v81
    v_cvt_pk_bf16_f32 v125, v77, v81
    v_mul_f32 v78, v6, v78
    v_mul_f32 v82, v6, v82
    v_cvt_pk_bf16_f32 v126, v78, v82
    v_mul_f32 v79, v6, v79
    v_mul_f32 v83, v6, v83
    v_cvt_pk_bf16_f32 v127, v79, v83
    s_add_u32 s17, s48, 0
    buffer_store_dwordx4 v[124:127], v0, s[8:11], s17 offen offset:1024 sc1
    v_mfma_f32_16x16x16_bf16 v[92:95], a[116:117], v[20:21], v[92:95]
    v_mfma_f32_16x16x16_bf16 v[96:99], a[116:117], v[22:23], v[96:99]
    v_mul_f32 v84, v6, v84
    v_mul_f32 v88, v6, v88
    v_cvt_pk_bf16_f32 v128, v84, v88
    v_mul_f32 v85, v6, v85
    v_mul_f32 v89, v6, v89
    v_cvt_pk_bf16_f32 v129, v85, v89
    v_mul_f32 v86, v6, v86
    v_mul_f32 v90, v6, v90
    v_cvt_pk_bf16_f32 v130, v86, v90
    v_mul_f32 v87, v6, v87
    v_mul_f32 v91, v6, v91
    v_cvt_pk_bf16_f32 v131, v87, v91
    buffer_store_dwordx4 v[128:131], v0, s[8:11], s17 offen offset:3072 sc1
    v_mfma_f32_16x16x16_bf16 v[100:103], a[118:119], v[20:21], v[100:103]
    v_mfma_f32_16x16x16_bf16 v[104:107], a[118:119], v[22:23], v[104:107]
    v_mul_f32 v92, v6, v92
    v_mul_f32 v96, v6, v96
    v_cvt_pk_bf16_f32 v132, v92, v96
    v_mul_f32 v93, v6, v93
    v_mul_f32 v97, v6, v97
    v_cvt_pk_bf16_f32 v133, v93, v97
    v_mul_f32 v94, v6, v94
    v_mul_f32 v98, v6, v98
    v_cvt_pk_bf16_f32 v134, v94, v98
    v_mul_f32 v95, v6, v95
    v_mul_f32 v99, v6, v99
    v_cvt_pk_bf16_f32 v135, v95, v99
    s_add_u32 s17, s48, 4096
    buffer_store_dwordx4 v[132:135], v0, s[8:11], s17 offen offset:1024 sc1
    v_mul_f32 v100, v6, v100
    v_mul_f32 v104, v6, v104
    v_cvt_pk_bf16_f32 v136, v100, v104
    v_mul_f32 v101, v6, v101
    v_mul_f32 v105, v6, v105
    v_cvt_pk_bf16_f32 v137, v101, v105
    v_mul_f32 v102, v6, v102
    v_mul_f32 v106, v6, v106
    v_cvt_pk_bf16_f32 v138, v102, v106
    v_mul_f32 v103, v6, v103
    v_mul_f32 v107, v6, v107
    v_cvt_pk_bf16_f32 v139, v103, v107
    buffer_store_dwordx4 v[136:139], v0, s[8:11], s17 offen offset:3072 sc1
    s_add_u32 s48, s48, 262144
    s_mov_b32 s49, 22528
    s_cmp_ge_u32 s37, 64
    s_cbranch_scc1 Lta_end
Lta1:
    s_cmp_eq_u32 s39, 1
    s_cbranch_scc1 Lta1_have
    s_waitcnt vmcnt(0)
    s_cmp_lg_u32 s49, 0
    s_cselect_b64 exec, 1, 0
    buffer_store_dword v3, v4, s[8:11], s43 offen sc1
    s_mov_b64 exec, -1
    s_add_u32 s43, s43, s49
    s_mov_b32 s49, 0
    s_mov_b32 s16, 0
Lta1_f:
    buffer_load_dword v2, v1, s[8:11], s42 offen sc1
    s_add_u32 s16, s16, 1
    s_cmp_gt_u32 s16, 100000
    s_cbranch_scc1 L_role_ta_abort
    s_waitcnt vmcnt(0)
    v_cmp_eq_u32 vcc, 0, v2
    s_nop 0
    s_and_b32 s17, vcc_lo, 0xfff
    s_cbranch_scc0 Lta1_fd
    s_sleep 4
    s_branch Lta1_f
Lta1_fd:
    s_add_u32 s46, s51, 0
    buffer_load_dwordx4 a[0:3], v0, s[8:11], s46 offen offset:0
    buffer_load_dwordx4 a[4:7], v0, s[8:11], s46 offen offset:1024
    buffer_load_dwordx4 a[8:11], v0, s[8:11], s46 offen offset:2048
    buffer_load_dwordx4 a[12:15], v0, s[8:11], s46 offen offset:3072
    s_add_u32 s46, s51, 4096
    buffer_load_dwordx4 a[16:19], v0, s[8:11], s46 offen offset:0
    buffer_load_dwordx4 a[20:23], v0, s[8:11], s46 offen offset:1024
    buffer_load_dwordx4 a[24:27], v0, s[8:11], s46 offen offset:2048
    buffer_load_dwordx4 a[28:31], v0, s[8:11], s46 offen offset:3072
    s_add_u32 s46, s51, 16777216
    buffer_load_dwordx4 a[32:35], v0, s[8:11], s46 offen offset:0
    buffer_load_dwordx4 a[36:39], v0, s[8:11], s46 offen offset:1024
    buffer_load_dwordx4 a[40:43], v0, s[8:11], s46 offen offset:2048
    buffer_load_dwordx4 a[44:47], v0, s[8:11], s46 offen offset:3072
    s_add_u32 s46, s51, 16781312
    buffer_load_dwordx4 a[48:51], v0, s[8:11], s46 offen offset:0
    buffer_load_dwordx4 a[52:55], v0, s[8:11], s46 offen offset:1024
    buffer_load_dwordx4 a[56:59], v0, s[8:11], s46 offen offset:2048
    buffer_load_dwordx4 a[60:63], v0, s[8:11], s46 offen offset:3072
    s_add_u32 s46, s51, 33554432
    buffer_load_dwordx4 a[64:67], v0, s[8:11], s46 offen offset:0
    buffer_load_dwordx4 a[68:71], v0, s[8:11], s46 offen offset:1024
    buffer_load_dwordx4 a[72:75], v0, s[8:11], s46 offen offset:2048
    buffer_load_dwordx4 a[76:79], v0, s[8:11], s46 offen offset:3072
    s_add_u32 s46, s51, 33558528
    buffer_load_dwordx4 a[80:83], v0, s[8:11], s46 offen offset:0
    buffer_load_dwordx4 a[84:87], v0, s[8:11], s46 offen offset:1024
    buffer_load_dwordx4 a[88:91], v0, s[8:11], s46 offen offset:2048
    buffer_load_dwordx4 a[92:95], v0, s[8:11], s46 offen offset:3072
    s_waitcnt vmcnt(0)
Lta1_have:
    buffer_load_dword v2, v11, s[8:11], s42 offen sc1
    s_waitcnt vmcnt(5)
    v_cmp_eq_u32 vcc, 0, v15
    s_add_u32 s51, s51, 262144
    s_add_u32 s37, s37, 1
    s_mov_b32 s62, s38
    s_and_b32 s17, vcc_lo, 0xfff
    s_cselect_b32 s39, 0, 1
    s_cmp_eq_u64 vcc, 0
    s_cselect_b32 s38, 1, 0
    s_cmp_lt_u32 s37, 64
    s_cselect_b32 s39, s39, 0
    s_cselect_b32 s38, s38, 0
    s_cmp_eq_u32 s39, 1
    s_cselect_b32 s30, 268435456, 0
    s_cmp_eq_u32 s38, 1
    s_cselect_b32 s22, 268435456, 0
    v_mfma_f32_16x16x32_bf16 v[32:35], a[32:35], a[0:3], 0
    s_add_u32 s46, s51, 0
    buffer_load_dwordx4 v[140:143], v0, s[28:31], s46 offen offset:0
    v_mfma_f32_16x16x32_bf16 v[36:39], a[32:35], a[4:7], 0
    buffer_load_dwordx4 v[144:147], v0, s[28:31], s46 offen offset:1024
    v_mfma_f32_16x16x32_bf16 v[40:43], a[36:39], a[4:7], 0
    buffer_load_dwordx4 v[148:151], v0, s[28:31], s46 offen offset:2048
    v_mfma_f32_16x16x32_bf16 v[32:35], a[40:43], a[8:11], v[32:35]
    buffer_load_dwordx4 v[152:155], v0, s[28:31], s46 offen offset:3072
    v_mfma_f32_16x16x32_bf16 v[36:39], a[40:43], a[12:15], v[36:39]
    s_add_u32 s46, s51, 4096
    buffer_load_dwordx4 v[156:159], v0, s[28:31], s46 offen offset:0
    v_mfma_f32_16x16x32_bf16 v[40:43], a[44:47], a[12:15], v[40:43]
    buffer_load_dwordx4 v[160:163], v0, s[28:31], s46 offen offset:1024
    v_mfma_f32_16x16x32_bf16 v[32:35], a[48:51], a[16:19], v[32:35]
    v_mfma_f32_16x16x32_bf16 v[36:39], a[48:51], a[20:23], v[36:39]
    v_mfma_f32_16x16x32_bf16 v[40:43], a[52:55], a[20:23], v[40:43]
    v_mfma_f32_16x16x32_bf16 v[32:35], a[56:59], a[24:27], v[32:35]
    v_mfma_f32_16x16x32_bf16 v[36:39], a[56:59], a[28:31], v[36:39]
    v_mfma_f32_16x16x32_bf16 v[40:43], a[60:63], a[28:31], v[40:43]
    s_waitcnt vmcnt(7)
    s_cmp_lg_u32 s49, 0
    s_cselect_b64 exec, 1, 0
    buffer_store_dword v3, v4, s[8:11], s43 offen sc1
    s_mov_b64 exec, -1
    s_add_u32 s43, s43, s49
    s_mov_b32 s49, 0
    s_cmp_eq_u32 s62, 1
    s_cbranch_scc1 Lta1_km
    s_waitcnt vmcnt(6)
    v_cmp_eq_u32 vcc, 0, v2
    s_nop 0
    s_cbranch_vccz Lta1_r
    s_mov_b32 s16, 0
Lta1_rp:
    buffer_load_dword v2, v11, s[8:11], s42 offen sc1
    s_add_u32 s16, s16, 1
    s_cmp_gt_u32 s16, 100000
    s_cbranch_scc1 L_role_ta_abort
    s_waitcnt vmcnt(0)
    v_cmp_eq_u32 vcc, 0, v2
    s_nop 0
    s_cbranch_vccnz Lta1_rp
Lta1_r:
    buffer_load_dwordx4 a[120:123], v9, s[8:11], s47 offen offset:0
    buffer_load_dwordx4 a[124:127], v9, s[8:11], s47 offen offset:64
    buffer_load_dwordx4 a[128:131], v9, s[8:11], s47 offen offset:128
    buffer_load_dwordx4 a[132:135], v9, s[8:11], s47 offen offset:192
    buffer_load_dwordx2 a[136:137], v10, s[8:11], s47 offen offset:2048
    buffer_load_dwordx2 a[138:139], v10, s[8:11], s47 offen offset:2560
    buffer_load_dwordx2 a[140:141], v10, s[8:11], s47 offen offset:3072
    buffer_load_dwordx2 a[142:143], v10, s[8:11], s47 offen offset:3584
Lta1_km:
    s_add_u32 s42, s42, 22528
    s_add_u32 s47, s47, 131072
    v_fma_f32 v32, v32, s52, v236
    v_fma_f32 v33, v33, s52, v237
    v_fma_f32 v34, v34, s52, v238
    v_fma_f32 v35, v35, s52, v239
    buffer_load_dwordx4 v[164:167], v0, s[28:31], s46 offen offset:2048
    buffer_load_dwordx4 v[168:171], v0, s[28:31], s46 offen offset:3072
    v_mul_f32 v36, s52, v36
    v_mul_f32 v37, s52, v37
    v_mul_f32 v38, s52, v38
    v_mul_f32 v39, s52, v39
    s_add_u32 s46, s51, 16777216
    buffer_load_dwordx4 v[172:175], v0, s[28:31], s46 offen offset:0
    buffer_load_dwordx4 v[176:179], v0, s[28:31], s46 offen offset:1024
    v_fma_f32 v40, v40, s52, v236
    v_fma_f32 v41, v41, s52, v237
    v_fma_f32 v42, v42, s52, v238
    v_fma_f32 v43, v43, s52, v239
    buffer_load_dwordx4 v[180:183], v0, s[28:31], s46 offen offset:2048
    buffer_load_dwordx4 v[184:187], v0, s[28:31], s46 offen offset:3072
    s_waitcnt vmcnt(13)
    v_mfma_f32_16x16x32_bf16 v[44:47], a[120:123], a[0:3], 0
    v_mfma_f32_16x16x32_bf16 v[48:51], a[120:123], a[4:7], 0
    s_add_u32 s46, s51, 16781312
    buffer_load_dwordx4 v[188:191], v0, s[28:31], s46 offen offset:0
    s_waitcnt vmcnt(13)
    v_mfma_f32_16x16x32_bf16 v[44:47], a[124:127], a[8:11], v[44:47]
    v_mfma_f32_16x16x32_bf16 v[48:51], a[124:127], a[12:15], v[48:51]
    buffer_load_dwordx4 v[192:195], v0, s[28:31], s46 offen offset:1024
    s_waitcnt vmcnt(13)
    v_mfma_f32_16x16x32_bf16 v[44:47], a[128:131], a[16:19], v[44:47]
    v_mfma_f32_16x16x32_bf16 v[48:51], a[128:131], a[20:23], v[48:51]
    buffer_load_dwordx4 v[196:199], v0, s[28:31], s46 offen offset:2048
    s_waitcnt vmcnt(13)
    v_mfma_f32_16x16x32_bf16 v[44:47], a[132:135], a[24:27], v[44:47]
    v_mfma_f32_16x16x32_bf16 v[48:51], a[132:135], a[28:31], v[48:51]
    buffer_load_dwordx4 v[200:203], v0, s[28:31], s46 offen offset:3072
    v_max3_f32 v5, v32, v33, v34
    v_max_f32 v5, v5, v35
    s_nop 0
    v_mul_f32 v44, s52, v44
    v_mul_f32 v45, s52, v45
    v_max3_f32 v5, v5, v44, v45
    v_mov_b32 v6, v5
    s_add_u32 s46, s51, 33554432
    buffer_load_dwordx4 v[204:207], v0, s[28:31], s46 offen offset:0
    v_permlane32_swap_b32 v5, v6
    v_max_f32 v5, v5, v6
    v_mov_b32 v6, v5
    buffer_load_dwordx4 v[208:211], v0, s[28:31], s46 offen offset:1024
    s_nop 0
    v_permlane16_swap_b32 v5, v6
    v_max_f32 v5, v5, v6
    v_sub_f32 v32, v32, v5
    v_sub_f32 v33, v33, v5
    v_sub_f32 v34, v34, v5
    v_sub_f32 v35, v35, v5
    v_sub_f32 v44, v44, v5
    v_sub_f32 v45, v45, v5
    v_exp_f32 v32, v32
    v_exp_f32 v33, v33
    v_exp_f32 v34, v34
    v_exp_f32 v35, v35
    v_exp_f32 v44, v44
    v_exp_f32 v45, v45
    v_cvt_pk_bf16_f32 v24, v32, v33
    v_cvt_pk_bf16_f32 v25, v34, v35
    v_mov_b32 v26, 0
    v_mov_b32 v27, 0
    v_cvt_pk_bf16_f32 v20, v44, v45
    v_cvt_pk_bf16_f32 v23, v44, v45
    v_mfma_f32_16x16x32_bf16 v[28:31], v[16:19], v[24:27], 0
    v_mfma_f32_16x16x32_bf16 v[76:79], a[64:67], v[24:27], 0
    v_mfma_f32_16x16x32_bf16 v[80:83], a[68:71], v[24:27], 0
    s_add_u32 s17, s42, 22528
    buffer_load_dword v15, v1, s[8:11], s17 offen sc1
    v_mfma_f32_16x16x32_bf16 v[84:87], a[72:75], v[24:27], 0
    v_mfma_f32_16x16x32_bf16 v[88:91], a[76:79], v[24:27], 0
    buffer_load_dwordx4 v[212:215], v0, s[28:31], s46 offen offset:2048
    v_mfma_f32_16x16x32_bf16 v[92:95], a[80:83], v[24:27], 0
    v_mfma_f32_16x16x32_bf16 v[96:99], a[84:87], v[24:27], 0
    buffer_load_dwordx4 v[216:219], v0, s[28:31], s46 offen offset:3072
    v_mfma_f32_16x16x16_bf16 v[28:31], v[16:17], v[20:21], v[28:31]
    v_mfma_f32_16x16x32_bf16 v[100:103], a[88:91], v[24:27], 0
    v_mfma_f32_16x16x32_bf16 v[104:107], a[92:95], v[24:27], 0
    s_add_u32 s46, s51, 33558528
    buffer_load_dwordx4 v[220:223], v0, s[28:31], s46 offen offset:0
    s_waitcnt vmcnt(19)
    v_mfma_f32_16x16x16_bf16 v[76:79], a[136:137], v[20:21], v[76:79]
    v_mfma_f32_16x16x16_bf16 v[80:83], a[136:137], v[22:23], v[80:83]
    v_rcp_f32 v6, v28
    s_waitcnt vmcnt(18)
    v_mfma_f32_16x16x16_bf16 v[84:87], a[138:139], v[20:21], v[84:87]
    v_mfma_f32_16x16x16_bf16 v[88:91], a[138:139], v[22:23], v[88:91]
    v_mul_f32 v76, v6, v76
    v_mul_f32 v80, v6, v80
    v_cvt_pk_bf16_f32 v108, v76, v80
    v_mul_f32 v77, v6, v77
    v_mul_f32 v81, v6, v81
    v_cvt_pk_bf16_f32 v109, v77, v81
    v_mul_f32 v78, v6, v78
    v_mul_f32 v82, v6, v82
    v_cvt_pk_bf16_f32 v110, v78, v82
    v_mul_f32 v79, v6, v79
    v_mul_f32 v83, v6, v83
    v_cvt_pk_bf16_f32 v111, v79, v83
    s_add_u32 s17, s48, 0
    buffer_store_dwordx4 v[108:111], v0, s[8:11], s17 offen offset:0 sc1
    buffer_load_dwordx4 v[224:227], v0, s[28:31], s46 offen offset:1024
    s_waitcnt vmcnt(19)
    v_mfma_f32_16x16x16_bf16 v[92:95], a[140:141], v[20:21], v[92:95]
    v_mfma_f32_16x16x16_bf16 v[96:99], a[140:141], v[22:23], v[96:99]
    v_mul_f32 v84, v6, v84
    v_mul_f32 v88, v6, v88
    v_cvt_pk_bf16_f32 v112, v84, v88
    v_mul_f32 v85, v6, v85
    v_mul_f32 v89, v6, v89
    v_cvt_pk_bf16_f32 v113, v85, v89
    v_mul_f32 v86, v6, v86
    v_mul_f32 v90, v6, v90
    v_cvt_pk_bf16_f32 v114, v86, v90
    v_mul_f32 v87, v6, v87
    v_mul_f32 v91, v6, v91
    v_cvt_pk_bf16_f32 v115, v87, v91
    buffer_store_dwordx4 v[112:115], v0, s[8:11], s17 offen offset:2048 sc1
    buffer_load_dwordx4 v[228:231], v0, s[28:31], s46 offen offset:2048
    s_waitcnt vmcnt(20)
    v_mfma_f32_16x16x16_bf16 v[100:103], a[142:143], v[20:21], v[100:103]
    v_mfma_f32_16x16x16_bf16 v[104:107], a[142:143], v[22:23], v[104:107]
    v_mul_f32 v92, v6, v92
    v_mul_f32 v96, v6, v96
    v_cvt_pk_bf16_f32 v116, v92, v96
    v_mul_f32 v93, v6, v93
    v_mul_f32 v97, v6, v97
    v_cvt_pk_bf16_f32 v117, v93, v97
    v_mul_f32 v94, v6, v94
    v_mul_f32 v98, v6, v98
    v_cvt_pk_bf16_f32 v118, v94, v98
    v_mul_f32 v95, v6, v95
    v_mul_f32 v99, v6, v99
    v_cvt_pk_bf16_f32 v119, v95, v99
    s_add_u32 s17, s48, 4096
    buffer_store_dwordx4 v[116:119], v0, s[8:11], s17 offen offset:0 sc1
    buffer_load_dwordx4 v[232:235], v0, s[28:31], s46 offen offset:3072
    v_mul_f32 v100, v6, v100
    v_mul_f32 v104, v6, v104
    v_cvt_pk_bf16_f32 v120, v100, v104
    v_mul_f32 v101, v6, v101
    v_mul_f32 v105, v6, v105
    v_cvt_pk_bf16_f32 v121, v101, v105
    v_mul_f32 v102, v6, v102
    v_mul_f32 v106, v6, v106
    v_cvt_pk_bf16_f32 v122, v102, v106
    v_mul_f32 v103, v6, v103
    v_mul_f32 v107, v6, v107
    v_cvt_pk_bf16_f32 v123, v103, v107
    buffer_store_dwordx4 v[120:123], v0, s[8:11], s17 offen offset:2048 sc1
    buffer_load_dwordx4 a[96:99], v9, s[20:23], s47 offen offset:0
    v_max3_f32 v5, v36, v37, v38
    v_max_f32 v5, v5, v39
    v_max3_f32 v5, v5, v40, v41
    v_max3_f32 v5, v5, v42, v43
    v_mul_f32 v48, s52, v48
    v_mul_f32 v49, s52, v49
    v_max3_f32 v5, v5, v48, v49
    v_mov_b32 v6, v5
    buffer_load_dwordx4 a[100:103], v9, s[20:23], s47 offen offset:64
    s_nop 0
    v_permlane32_swap_b32 v5, v6
    v_max_f32 v5, v5, v6
    v_mov_b32 v6, v5
    buffer_load_dwordx4 a[104:107], v9, s[20:23], s47 offen offset:128
    s_nop 0
    v_permlane16_swap_b32 v5, v6
    v_max_f32 v5, v5, v6
    v_sub_f32 v36, v36, v5
    v_sub_f32 v37, v37, v5
    v_sub_f32 v38, v38, v5
    v_sub_f32 v39, v39, v5
    v_sub_f32 v40, v40, v5
    v_sub_f32 v41, v41, v5
    v_sub_f32 v42, v42, v5
    v_sub_f32 v43, v43, v5
    v_sub_f32 v48, v48, v5
    v_sub_f32 v49, v49, v5
    v_exp_f32 v36, v36
    v_exp_f32 v37, v37
    v_exp_f32 v38, v38
    v_exp_f32 v39, v39
    v_exp_f32 v40, v40
    v_exp_f32 v41, v41
    v_exp_f32 v42, v42
    v_exp_f32 v43, v43
    v_exp_f32 v48, v48
    v_exp_f32 v49, v49
    v_cvt_pk_bf16_f32 v24, v36, v37
    v_cvt_pk_bf16_f32 v25, v38, v39
    v_cvt_pk_bf16_f32 v26, v40, v41
    v_cvt_pk_bf16_f32 v27, v42, v43
    v_cvt_pk_bf16_f32 v20, v48, v49
    v_cvt_pk_bf16_f32 v23, v48, v49
    v_mfma_f32_16x16x32_bf16 v[28:31], v[16:19], v[24:27], 0
    v_mfma_f32_16x16x32_bf16 v[76:79], a[64:67], v[24:27], 0
    v_mfma_f32_16x16x32_bf16 v[80:83], a[68:71], v[24:27], 0
    buffer_load_dwordx4 a[108:111], v9, s[20:23], s47 offen offset:192
    v_mfma_f32_16x16x32_bf16 v[84:87], a[72:75], v[24:27], 0
    v_mfma_f32_16x16x32_bf16 v[88:91], a[76:79], v[24:27], 0
    buffer_load_dwordx2 a[112:113], v10, s[20:23], s47 offen offset:2048
    v_mfma_f32_16x16x32_bf16 v[92:95], a[80:83], v[24:27], 0
    v_mfma_f32_16x16x32_bf16 v[96:99], a[84:87], v[24:27], 0
    buffer_load_dwordx2 a[114:115], v10, s[20:23], s47 offen offset:2560
    v_mfma_f32_16x16x16_bf16 v[28:31], v[16:17], v[20:21], v[28:31]
    v_mfma_f32_16x16x32_bf16 v[100:103], a[88:91], v[24:27], 0
    v_mfma_f32_16x16x32_bf16 v[104:107], a[92:95], v[24:27], 0
    buffer_load_dwordx2 a[116:117], v10, s[20:23], s47 offen offset:3072
    buffer_load_dwordx2 a[118:119], v10, s[20:23], s47 offen offset:3584
    v_mfma_f32_16x16x16_bf16 v[76:79], a[136:137], v[20:21], v[76:79]
    v_mfma_f32_16x16x16_bf16 v[80:83], a[136:137], v[22:23], v[80:83]
    v_rcp_f32 v6, v28
    v_mfma_f32_16x16x16_bf16 v[84:87], a[138:139], v[20:21], v[84:87]
    v_mfma_f32_16x16x16_bf16 v[88:91], a[138:139], v[22:23], v[88:91]
    v_mul_f32 v76, v6, v76
    v_mul_f32 v80, v6, v80
    v_cvt_pk_bf16_f32 v124, v76, v80
    v_mul_f32 v77, v6, v77
    v_mul_f32 v81, v6, v81
    v_cvt_pk_bf16_f32 v125, v77, v81
    v_mul_f32 v78, v6, v78
    v_mul_f32 v82, v6, v82
    v_cvt_pk_bf16_f32 v126, v78, v82
    v_mul_f32 v79, v6, v79
    v_mul_f32 v83, v6, v83
    v_cvt_pk_bf16_f32 v127, v79, v83
    s_add_u32 s17, s48, 0
    buffer_store_dwordx4 v[124:127], v0, s[8:11], s17 offen offset:1024 sc1
    v_mfma_f32_16x16x16_bf16 v[92:95], a[140:141], v[20:21], v[92:95]
    v_mfma_f32_16x16x16_bf16 v[96:99], a[140:141], v[22:23], v[96:99]
    v_mul_f32 v84, v6, v84
    v_mul_f32 v88, v6, v88
    v_cvt_pk_bf16_f32 v128, v84, v88
    v_mul_f32 v85, v6, v85
    v_mul_f32 v89, v6, v89
    v_cvt_pk_bf16_f32 v129, v85, v89
    v_mul_f32 v86, v6, v86
    v_mul_f32 v90, v6, v90
    v_cvt_pk_bf16_f32 v130, v86, v90
    v_mul_f32 v87, v6, v87
    v_mul_f32 v91, v6, v91
    v_cvt_pk_bf16_f32 v131, v87, v91
    buffer_store_dwordx4 v[128:131], v0, s[8:11], s17 offen offset:3072 sc1
    v_mfma_f32_16x16x16_bf16 v[100:103], a[142:143], v[20:21], v[100:103]
    v_mfma_f32_16x16x16_bf16 v[104:107], a[142:143], v[22:23], v[104:107]
    v_mul_f32 v92, v6, v92
    v_mul_f32 v96, v6, v96
    v_cvt_pk_bf16_f32 v132, v92, v96
    v_mul_f32 v93, v6, v93
    v_mul_f32 v97, v6, v97
    v_cvt_pk_bf16_f32 v133, v93, v97
    v_mul_f32 v94, v6, v94
    v_mul_f32 v98, v6, v98
    v_cvt_pk_bf16_f32 v134, v94, v98
    v_mul_f32 v95, v6, v95
    v_mul_f32 v99, v6, v99
    v_cvt_pk_bf16_f32 v135, v95, v99
    s_add_u32 s17, s48, 4096
    buffer_store_dwordx4 v[132:135], v0, s[8:11], s17 offen offset:1024 sc1
    v_mul_f32 v100, v6, v100
    v_mul_f32 v104, v6, v104
    v_cvt_pk_bf16_f32 v136, v100, v104
    v_mul_f32 v101, v6, v101
    v_mul_f32 v105, v6, v105
    v_cvt_pk_bf16_f32 v137, v101, v105
    v_mul_f32 v102, v6, v102
    v_mul_f32 v106, v6, v106
    v_cvt_pk_bf16_f32 v138, v102, v106
    v_mul_f32 v103, v6, v103
    v_mul_f32 v107, v6, v107
    v_cvt_pk_bf16_f32 v139, v103, v107
    buffer_store_dwordx4 v[136:139], v0, s[8:11], s17 offen offset:3072 sc1
    s_add_u32 s48, s48, 262144
    s_mov_b32 s49, 22528
    s_cmp_ge_u32 s37, 64
    s_cbranch_scc1 Lta_end
    s_branch Lta0
Lta_end:
    s_waitcnt vmcnt(0)
    s_mov_b64 exec, 1
    buffer_store_dword v3, v4, s[8:11], s43 offen sc1
    s_mov_b64 exec, -1
    s_branch L_role_ta_exit
L_role_ta_abort:
    s_waitcnt lgkmcnt(0)
    s_mov_b64 exec, -1
    v_mov_b32 v0, 60
    s_lshl_b32 s5, s3, 8
    s_or_b32 s5, s5, s4
    s_or_b32 s5, s5, 0x10000
    v_mov_b32 v1, s5
    global_store_dword v0, v1, s[12:13]
    s_endpgm
L_role_ta_exit:
    s_endpgm
.p2align 6
L_role_tw:
    v_and_b32 v5, 63, v0
    v_lshlrev_b32 v0, 4, v5
    v_and_b32 v7, 15, v5
    v_lshrrev_b32 v8, 4, v5
    v_min_u32 v1, 31, v5
    v_lshrrev_b32 v6, 2, v1
    v_and_b32 v1, 3, v1
    v_lshlrev_b32 v1, 2, v1
    v_lshl_add_u32 v1, v6, 7, v1
    v_mov_b32 v3, 1
    v_mov_b32 v4, 0
    s_mov_b32 s44, 0x05040100
    s_mov_b32 s45, 0x07060302
    s_cmp_lg_u32 s14, 0
    s_cbranch_scc1 Ltw_gate_d
    v_mov_b32 v5, 48
    s_mov_b32 s16, 0
Ltw_gate:
    global_load_dword v6, v5, s[12:13] sc1
    s_add_u32 s16, s16, 1
    s_cmp_gt_u32 s16, 100000
    s_cbranch_scc1 L_role_tw_abort
    s_waitcnt vmcnt(0)
    v_cmp_gt_u32 vcc, 32, v6
    s_nop 0
    s_cbranch_vccz Ltw_gate_d
    s_sleep 100
    s_branch Ltw_gate
Ltw_gate_d:
    s_barrier
    s_load_dwordx2 s[20:21], s[0:1], 64
    s_mov_b32 s22, 4718592
    s_mov_b32 s23, 0x00020000
    s_waitcnt lgkmcnt(0)
    s_and_b32 s21, s21, 0xffff
    s_load_dwordx2 s[24:25], s[0:1], 80
    s_mov_b32 s26, 2359296
    s_mov_b32 s27, 0x00020000
    s_waitcnt lgkmcnt(0)
    s_and_b32 s25, s25, 0xffff
    s_mul_i32 s17, s15, 43
    s_lshr_b32 s32, s17, 9
    s_mul_i32 s17, s32, 12
    s_sub_u32 s50, s15, s17
    s_add_u32 s33, s32, 30
    s_cmp_eq_u32 s32, 2
    s_cselect_b32 s33, 0, s33
    s_cselect_b32 s32, 64, s32
    s_mul_i32 s49, s50, 96
    s_mul_i32 s17, s14, 1179648
    s_add_u32 s49, s49, s17
    v_mul_u32_u24 v5, 4608, v8
    v_lshl_add_u32 v9, v7, 2, v5
    v_add_u32 v10, 18432, v9
    v_and_b32 v6, 14, v7
    v_lshl_add_u32 v12, v6, 1, v5
    v_add_u32 v12, 64, v12
    v_add_u32 v13, 18432, v12
    v_and_b32 v5, 1, v7
    v_mov_b32 v11, s44
    v_mov_b32 v6, s45
    v_cmp_eq_u32 vcc, 1, v5
    s_nop 1
    v_cndmask_b32 v11, v11, v6, vcc
    s_add_u32 s17, s49, 0
    buffer_load_dword v16, v9, s[20:23], s17 offen
    buffer_load_dword v17, v10, s[20:23], s17 offen
    buffer_load_dword v18, v12, s[20:23], s17 offen
    buffer_load_dword v19, v13, s[20:23], s17 offen
    s_add_u32 s17, s49, 1152
    buffer_load_dword v20, v9, s[20:23], s17 offen
    buffer_load_dword v21, v10, s[20:23], s17 offen
    buffer_load_dword v22, v12, s[20:23], s17 offen
    buffer_load_dword v23, v13, s[20:23], s17 offen
    s_add_u32 s17, s49, 2304
    buffer_load_dword v24, v9, s[20:23], s17 offen
    buffer_load_dword v25, v10, s[20:23], s17 offen
    buffer_load_dword v26, v12, s[20:23], s17 offen
    buffer_load_dword v27, v13, s[20:23], s17 offen
    s_add_u32 s17, s49, 3456
    buffer_load_dword v28, v9, s[20:23], s17 offen
    buffer_load_dword v29, v10, s[20:23], s17 offen
    buffer_load_dword v30, v12, s[20:23], s17 offen
    buffer_load_dword v31, v13, s[20:23], s17 offen
    s_add_u32 s17, s49, 36864
    buffer_load_dword v32, v9, s[20:23], s17 offen
    buffer_load_dword v33, v10, s[20:23], s17 offen
    buffer_load_dword v34, v12, s[20:23], s17 offen
    buffer_load_dword v35, v13, s[20:23], s17 offen
    s_add_u32 s17, s49, 38016
    buffer_load_dword v36, v9, s[20:23], s17 offen
    buffer_load_dword v37, v10, s[20:23], s17 offen
    buffer_load_dword v38, v12, s[20:23], s17 offen
    buffer_load_dword v39, v13, s[20:23], s17 offen
    s_add_u32 s17, s49, 39168
    buffer_load_dword v40, v9, s[20:23], s17 offen
    buffer_load_dword v41, v10, s[20:23], s17 offen
    buffer_load_dword v42, v12, s[20:23], s17 offen
    buffer_load_dword v43, v13, s[20:23], s17 offen
    s_add_u32 s17, s49, 40320
    buffer_load_dword v44, v9, s[20:23], s17 offen
    buffer_load_dword v45, v10, s[20:23], s17 offen
    buffer_load_dword v46, v12, s[20:23], s17 offen
    buffer_load_dword v47, v13, s[20:23], s17 offen
    s_add_u32 s17, s49, 73728
    buffer_load_dword v48, v9, s[20:23], s17 offen
    buffer_load_dword v49, v10, s[20:23], s17 offen
    buffer_load_dword v50, v12, s[20:23], s17 offen
    buffer_load_dword v51, v13, s[20:23], s17 offen
    s_add_u32 s17, s49, 74880
    buffer_load_dword v52, v9, s[20:23], s17 offen
    buffer_load_dword v53, v10, s[20:23], s17 offen
    buffer_load_dword v54, v12, s[20:23], s17 offen
    buffer_load_dword v55, v13, s[20:23], s17 offen
    s_add_u32 s17, s49, 76032
    buffer_load_dword v56, v9, s[20:23], s17 offen
    buffer_load_dword v57, v10, s[20:23], s17 offen
    buffer_load_dword v58, v12, s[20:23], s17 offen
    buffer_load_dword v59, v13, s[20:23], s17 offen
    s_add_u32 s17, s49, 77184
    buffer_load_dword v60, v9, s[20:23], s17 offen
    buffer_load_dword v61, v10, s[20:23], s17 offen
    buffer_load_dword v62, v12, s[20:23], s17 offen
    buffer_load_dword v63, v13, s[20:23], s17 offen
    s_add_u32 s17, s49, 110592
    buffer_load_dword v64, v9, s[20:23], s17 offen
    buffer_load_dword v65, v10, s[20:23], s17 offen
    buffer_load_dword v66, v12, s[20:23], s17 offen
    buffer_load_dword v67, v13, s[20:23], s17 offen
    s_add_u32 s17, s49, 111744
    buffer_load_dword v68, v9, s[20:23], s17 offen
    buffer_load_dword v69, v10, s[20:23], s17 offen
    buffer_load_dword v70, v12, s[20:23], s17 offen
    buffer_load_dword v71, v13, s[20:23], s17 offen
    s_add_u32 s17, s49, 112896
    buffer_load_dword v72, v9, s[20:23], s17 offen
    buffer_load_dword v73, v10, s[20:23], s17 offen
    buffer_load_dword v74, v12, s[20:23], s17 offen
    buffer_load_dword v75, v13, s[20:23], s17 offen
    s_waitcnt vmcnt(58)
    v_perm_b32 v5, v17, v16, s44
    v_perm_b32 v6, v17, v16, s45
    s_waitcnt vmcnt(56)
    v_perm_b32 v128, v19, v18, v11
    v_accvgpr_write_b32 a0, v5
    v_accvgpr_write_b32 a4, v6
    s_add_u32 s17, s49, 114048
    buffer_load_dword v76, v9, s[20:23], s17 offen
    buffer_load_dword v77, v10, s[20:23], s17 offen
    buffer_load_dword v78, v12, s[20:23], s17 offen
    buffer_load_dword v79, v13, s[20:23], s17 offen
    s_waitcnt vmcnt(58)
    v_perm_b32 v5, v21, v20, s44
    v_perm_b32 v6, v21, v20, s45
    s_waitcnt vmcnt(56)
    v_perm_b32 v129, v23, v22, v11
    v_accvgpr_write_b32 a1, v5
    v_accvgpr_write_b32 a5, v6
    s_add_u32 s17, s49, 147456
    buffer_load_dword v80, v9, s[20:23], s17 offen
    buffer_load_dword v81, v10, s[20:23], s17 offen
    buffer_load_dword v82, v12, s[20:23], s17 offen
    buffer_load_dword v83, v13, s[20:23], s17 offen
    s_waitcnt vmcnt(58)
    v_perm_b32 v5, v25, v24, s44
    v_perm_b32 v6, v25, v24, s45
    s_waitcnt vmcnt(56)
    v_perm_b32 v130, v27, v26, v11
    v_accvgpr_write_b32 a2, v5
    v_accvgpr_write_b32 a6, v6
    s_add_u32 s17, s49, 148608
    buffer_load_dword v84, v9, s[20:23], s17 offen
    buffer_load_dword v85, v10, s[20:23], s17 offen
    buffer_load_dword v86, v12, s[20:23], s17 offen
    buffer_load_dword v87, v13, s[20:23], s17 offen
    s_waitcnt vmcnt(58)
    v_perm_b32 v5, v29, v28, s44
    v_perm_b32 v6, v29, v28, s45
    s_waitcnt vmcnt(56)
    v_perm_b32 v131, v31, v30, v11
    v_accvgpr_write_b32 a3, v5
    v_accvgpr_write_b32 a7, v6
    s_add_u32 s17, s49, 149760
    buffer_load_dword v88, v9, s[20:23], s17 offen
    buffer_load_dword v89, v10, s[20:23], s17 offen
    buffer_load_dword v90, v12, s[20:23], s17 offen
    buffer_load_dword v91, v13, s[20:23], s17 offen
    s_waitcnt vmcnt(58)
    v_perm_b32 v5, v33, v32, s44
    v_perm_b32 v6, v33, v32, s45
    s_waitcnt vmcnt(56)
    v_perm_b32 v132, v35, v34, v11
    v_accvgpr_write_b32 a8, v5
    v_accvgpr_write_b32 a12, v6
    s_add_u32 s17, s49, 150912
    buffer_load_dword v92, v9, s[20:23], s17 offen
    buffer_load_dword v93, v10, s[20:23], s17 offen
    buffer_load_dword v94, v12, s[20:23], s17 offen
    buffer_load_dword v95, v13, s[20:23], s17 offen
    s_waitcnt vmcnt(58)
    v_perm_b32 v5, v37, v36, s44
    v_perm_b32 v6, v37, v36, s45
    s_waitcnt vmcnt(56)
    v_perm_b32 v133, v39, v38, v11
    v_accvgpr_write_b32 a9, v5
    v_accvgpr_write_b32 a13, v6
    s_add_u32 s17, s49, 184320
    buffer_load_dword v96, v9, s[20:23], s17 offen
    buffer_load_dword v97, v10, s[20:23], s17 offen
    buffer_load_dword v98, v12, s[20:23], s17 offen
    buffer_load_dword v99, v13, s[20:23], s17 offen
    s_waitcnt vmcnt(58)
    v_perm_b32 v5, v41, v40, s44
    v_perm_b32 v6, v41, v40, s45
    s_waitcnt vmcnt(56)
    v_perm_b32 v134, v43, v42, v11
    v_accvgpr_write_b32 a10, v5
    v_accvgpr_write_b32 a14, v6
    s_add_u32 s17, s49, 185472
    buffer_load_dword v100, v9, s[20:23], s17 offen
    buffer_load_dword v101, v10, s[20:23], s17 offen
    buffer_load_dword v102, v12, s[20:23], s17 offen
    buffer_load_dword v103, v13, s[20:23], s17 offen
    s_waitcnt vmcnt(58)
    v_perm_b32 v5, v45, v44, s44
    v_perm_b32 v6, v45, v44, s45
    s_waitcnt vmcnt(56)
    v_perm_b32 v135, v47, v46, v11
    v_accvgpr_write_b32 a11, v5
    v_accvgpr_write_b32 a15, v6
    s_add_u32 s17, s49, 186624
    buffer_load_dword v104, v9, s[20:23], s17 offen
    buffer_load_dword v105, v10, s[20:23], s17 offen
    buffer_load_dword v106, v12, s[20:23], s17 offen
    buffer_load_dword v107, v13, s[20:23], s17 offen
    s_waitcnt vmcnt(58)
    v_perm_b32 v5, v49, v48, s44
    v_perm_b32 v6, v49, v48, s45
    s_waitcnt vmcnt(56)
    v_perm_b32 v136, v51, v50, v11
    v_accvgpr_write_b32 a16, v5
    v_accvgpr_write_b32 a20, v6
    s_add_u32 s17, s49, 187776
    buffer_load_dword v108, v9, s[20:23], s17 offen
    buffer_load_dword v109, v10, s[20:23], s17 offen
    buffer_load_dword v110, v12, s[20:23], s17 offen
    buffer_load_dword v111, v13, s[20:23], s17 offen
    s_waitcnt vmcnt(58)
    v_perm_b32 v5, v53, v52, s44
    v_perm_b32 v6, v53, v52, s45
    s_waitcnt vmcnt(56)
    v_perm_b32 v137, v55, v54, v11
    v_accvgpr_write_b32 a17, v5
    v_accvgpr_write_b32 a21, v6
    s_add_u32 s17, s49, 221184
    buffer_load_dword v112, v9, s[20:23], s17 offen
    buffer_load_dword v113, v10, s[20:23], s17 offen
    buffer_load_dword v114, v12, s[20:23], s17 offen
    buffer_load_dword v115, v13, s[20:23], s17 offen
    s_waitcnt vmcnt(58)
    v_perm_b32 v5, v57, v56, s44
    v_perm_b32 v6, v57, v56, s45
    s_waitcnt vmcnt(56)
    v_perm_b32 v138, v59, v58, v11
    v_accvgpr_write_b32 a18, v5
    v_accvgpr_write_b32 a22, v6
    s_add_u32 s17, s49, 222336
    buffer_load_dword v116, v9, s[20:23], s17 offen
    buffer_load_dword v117, v10, s[20:23], s17 offen
    buffer_load_dword v118, v12, s[20:23], s17 offen
    buffer_load_dword v119, v13, s[20:23], s17 offen
    s_waitcnt vmcnt(58)
    v_perm_b32 v5, v61, v60, s44
    v_perm_b32 v6, v61, v60, s45
    s_waitcnt vmcnt(56)
    v_perm_b32 v139, v63, v62, v11
    v_accvgpr_write_b32 a19, v5
    v_accvgpr_write_b32 a23, v6
    s_add_u32 s17, s49, 223488
    buffer_load_dword v120, v9, s[20:23], s17 offen
    buffer_load_dword v121, v10, s[20:23], s17 offen
    buffer_load_dword v122, v12, s[20:23], s17 offen
    buffer_load_dword v123, v13, s[20:23], s17 offen
    s_waitcnt vmcnt(58)
    v_perm_b32 v5, v65, v64, s44
    v_perm_b32 v6, v65, v64, s45
    s_waitcnt vmcnt(56)
    v_perm_b32 v140, v67, v66, v11
    v_accvgpr_write_b32 a24, v5
    v_accvgpr_write_b32 a28, v6
    s_add_u32 s17, s49, 224640
    buffer_load_dword v124, v9, s[20:23], s17 offen
    buffer_load_dword v125, v10, s[20:23], s17 offen
    buffer_load_dword v126, v12, s[20:23], s17 offen
    buffer_load_dword v127, v13, s[20:23], s17 offen
    s_waitcnt vmcnt(58)
    v_perm_b32 v5, v69, v68, s44
    v_perm_b32 v6, v69, v68, s45
    s_waitcnt vmcnt(56)
    v_perm_b32 v141, v71, v70, v11
    v_accvgpr_write_b32 a25, v5
    v_accvgpr_write_b32 a29, v6
    s_add_u32 s17, s49, 258048
    buffer_load_dword v16, v9, s[20:23], s17 offen
    buffer_load_dword v17, v10, s[20:23], s17 offen
    buffer_load_dword v18, v12, s[20:23], s17 offen
    buffer_load_dword v19, v13, s[20:23], s17 offen
    s_waitcnt vmcnt(58)
    v_perm_b32 v5, v73, v72, s44
    v_perm_b32 v6, v73, v72, s45
    s_waitcnt vmcnt(56)
    v_perm_b32 v142, v75, v74, v11
    v_accvgpr_write_b32 a26, v5
    v_accvgpr_write_b32 a30, v6
    s_add_u32 s17, s49, 259200
    buffer_load_dword v20, v9, s[20:23], s17 offen
    buffer_load_dword v21, v10, s[20:23], s17 offen
    buffer_load_dword v22, v12, s[20:23], s17 offen
    buffer_load_dword v23, v13, s[20:23], s17 offen
    s_waitcnt vmcnt(58)
    v_perm_b32 v5, v77, v76, s44
    v_perm_b32 v6, v77, v76, s45
    s_waitcnt vmcnt(56)
    v_perm_b32 v143, v79, v78, v11
    v_accvgpr_write_b32 a27, v5
    v_accvgpr_write_b32 a31, v6
    s_add_u32 s17, s49, 260352
    buffer_load_dword v24, v9, s[20:23], s17 offen
    buffer_load_dword v25, v10, s[20:23], s17 offen
    buffer_load_dword v26, v12, s[20:23], s17 offen
    buffer_load_dword v27, v13, s[20:23], s17 offen
    s_waitcnt vmcnt(58)
    v_perm_b32 v5, v81, v80, s44
    v_perm_b32 v6, v81, v80, s45
    s_waitcnt vmcnt(56)
    v_perm_b32 v144, v83, v82, v11
    v_accvgpr_write_b32 a32, v5
    v_accvgpr_write_b32 a36, v6
    s_add_u32 s17, s49, 261504
    buffer_load_dword v28, v9, s[20:23], s17 offen
    buffer_load_dword v29, v10, s[20:23], s17 offen
    buffer_load_dword v30, v12, s[20:23], s17 offen
    buffer_load_dword v31, v13, s[20:23], s17 offen
    s_waitcnt vmcnt(58)
    v_perm_b32 v5, v85, v84, s44
    v_perm_b32 v6, v85, v84, s45
    s_waitcnt vmcnt(56)
    v_perm_b32 v145, v87, v86, v11
    v_accvgpr_write_b32 a33, v5
    v_accvgpr_write_b32 a37, v6
    s_add_u32 s17, s49, 294912
    buffer_load_dword v32, v9, s[20:23], s17 offen
    buffer_load_dword v33, v10, s[20:23], s17 offen
    buffer_load_dword v34, v12, s[20:23], s17 offen
    buffer_load_dword v35, v13, s[20:23], s17 offen
    s_waitcnt vmcnt(58)
    v_perm_b32 v5, v89, v88, s44
    v_perm_b32 v6, v89, v88, s45
    s_waitcnt vmcnt(56)
    v_perm_b32 v146, v91, v90, v11
    v_accvgpr_write_b32 a34, v5
    v_accvgpr_write_b32 a38, v6
    s_add_u32 s17, s49, 296064
    buffer_load_dword v36, v9, s[20:23], s17 offen
    buffer_load_dword v37, v10, s[20:23], s17 offen
    buffer_load_dword v38, v12, s[20:23], s17 offen
    buffer_load_dword v39, v13, s[20:23], s17 offen
    s_waitcnt vmcnt(58)
    v_perm_b32 v5, v93, v92, s44
    v_perm_b32 v6, v93, v92, s45
    s_waitcnt vmcnt(56)
    v_perm_b32 v147, v95, v94, v11
    v_accvgpr_write_b32 a35, v5
    v_accvgpr_write_b32 a39, v6
    s_add_u32 s17, s49, 297216
    buffer_load_dword v40, v9, s[20:23], s17 offen
    buffer_load_dword v41, v10, s[20:23], s17 offen
    buffer_load_dword v42, v12, s[20:23], s17 offen
    buffer_load_dword v43, v13, s[20:23], s17 offen
    s_waitcnt vmcnt(58)
    v_perm_b32 v5, v97, v96, s44
    v_perm_b32 v6, v97, v96, s45
    s_waitcnt vmcnt(56)
    v_perm_b32 v148, v99, v98, v11
    v_accvgpr_write_b32 a40, v5
    v_accvgpr_write_b32 a44, v6
    s_add_u32 s17, s49, 298368
    buffer_load_dword v44, v9, s[20:23], s17 offen
    buffer_load_dword v45, v10, s[20:23], s17 offen
    buffer_load_dword v46, v12, s[20:23], s17 offen
    buffer_load_dword v47, v13, s[20:23], s17 offen
    s_waitcnt vmcnt(58)
    v_perm_b32 v5, v101, v100, s44
    v_perm_b32 v6, v101, v100, s45
    s_waitcnt vmcnt(56)
    v_perm_b32 v149, v103, v102, v11
    v_accvgpr_write_b32 a41, v5
    v_accvgpr_write_b32 a45, v6
    s_add_u32 s17, s49, 331776
    buffer_load_dword v48, v9, s[20:23], s17 offen
    buffer_load_dword v49, v10, s[20:23], s17 offen
    buffer_load_dword v50, v12, s[20:23], s17 offen
    buffer_load_dword v51, v13, s[20:23], s17 offen
    s_waitcnt vmcnt(58)
    v_perm_b32 v5, v105, v104, s44
    v_perm_b32 v6, v105, v104, s45
    s_waitcnt vmcnt(56)
    v_perm_b32 v150, v107, v106, v11
    v_accvgpr_write_b32 a42, v5
    v_accvgpr_write_b32 a46, v6
    s_add_u32 s17, s49, 332928
    buffer_load_dword v52, v9, s[20:23], s17 offen
    buffer_load_dword v53, v10, s[20:23], s17 offen
    buffer_load_dword v54, v12, s[20:23], s17 offen
    buffer_load_dword v55, v13, s[20:23], s17 offen
    s_waitcnt vmcnt(58)
    v_perm_b32 v5, v109, v108, s44
    v_perm_b32 v6, v109, v108, s45
    s_waitcnt vmcnt(56)
    v_perm_b32 v151, v111, v110, v11
    v_accvgpr_write_b32 a43, v5
    v_accvgpr_write_b32 a47, v6
    s_add_u32 s17, s49, 334080
    buffer_load_dword v56, v9, s[20:23], s17 offen
    buffer_load_dword v57, v10, s[20:23], s17 offen
    buffer_load_dword v58, v12, s[20:23], s17 offen
    buffer_load_dword v59, v13, s[20:23], s17 offen
    s_waitcnt vmcnt(58)
    v_perm_b32 v5, v113, v112, s44
    v_perm_b32 v6, v113, v112, s45
    s_waitcnt vmcnt(56)
    v_perm_b32 v152, v115, v114, v11
    v_accvgpr_write_b32 a48, v5
    v_accvgpr_write_b32 a52, v6
    s_add_u32 s17, s49, 335232
    buffer_load_dword v60, v9, s[20:23], s17 offen
    buffer_load_dword v61, v10, s[20:23], s17 offen
    buffer_load_dword v62, v12, s[20:23], s17 offen
    buffer_load_dword v63, v13, s[20:23], s17 offen
    s_waitcnt vmcnt(58)
    v_perm_b32 v5, v117, v116, s44
    v_perm_b32 v6, v117, v116, s45
    s_waitcnt vmcnt(56)
    v_perm_b32 v153, v119, v118, v11
    v_accvgpr_write_b32 a49, v5
    v_accvgpr_write_b32 a53, v6
    s_add_u32 s17, s49, 368640
    buffer_load_dword v64, v9, s[20:23], s17 offen
    buffer_load_dword v65, v10, s[20:23], s17 offen
    buffer_load_dword v66, v12, s[20:23], s17 offen
    buffer_load_dword v67, v13, s[20:23], s17 offen
    s_waitcnt vmcnt(58)
    v_perm_b32 v5, v121, v120, s44
    v_perm_b32 v6, v121, v120, s45
    s_waitcnt vmcnt(56)
    v_perm_b32 v154, v123, v122, v11
    v_accvgpr_write_b32 a50, v5
    v_accvgpr_write_b32 a54, v6
    s_add_u32 s17, s49, 369792
    buffer_load_dword v68, v9, s[20:23], s17 offen
    buffer_load_dword v69, v10, s[20:23], s17 offen
    buffer_load_dword v70, v12, s[20:23], s17 offen
    buffer_load_dword v71, v13, s[20:23], s17 offen
    s_waitcnt vmcnt(58)
    v_perm_b32 v5, v125, v124, s44
    v_perm_b32 v6, v125, v124, s45
    s_waitcnt vmcnt(56)
    v_perm_b32 v155, v127, v126, v11
    v_accvgpr_write_b32 a51, v5
    v_accvgpr_write_b32 a55, v6
    s_add_u32 s17, s49, 370944
    buffer_load_dword v72, v9, s[20:23], s17 offen
    buffer_load_dword v73, v10, s[20:23], s17 offen
    buffer_load_dword v74, v12, s[20:23], s17 offen
    buffer_load_dword v75, v13, s[20:23], s17 offen
    s_waitcnt vmcnt(58)
    v_perm_b32 v5, v17, v16, s44
    v_perm_b32 v6, v17, v16, s45
    s_waitcnt vmcnt(56)
    v_perm_b32 v156, v19, v18, v11
    v_accvgpr_write_b32 a56, v5
    v_accvgpr_write_b32 a60, v6
    s_add_u32 s17, s49, 372096
    buffer_load_dword v76, v9, s[20:23], s17 offen
    buffer_load_dword v77, v10, s[20:23], s17 offen
    buffer_load_dword v78, v12, s[20:23], s17 offen
    buffer_load_dword v79, v13, s[20:23], s17 offen
    s_waitcnt vmcnt(58)
    v_perm_b32 v5, v21, v20, s44
    v_perm_b32 v6, v21, v20, s45
    s_waitcnt vmcnt(56)
    v_perm_b32 v157, v23, v22, v11
    v_accvgpr_write_b32 a57, v5
    v_accvgpr_write_b32 a61, v6
    s_add_u32 s17, s49, 405504
    buffer_load_dword v80, v9, s[20:23], s17 offen
    buffer_load_dword v81, v10, s[20:23], s17 offen
    buffer_load_dword v82, v12, s[20:23], s17 offen
    buffer_load_dword v83, v13, s[20:23], s17 offen
    s_waitcnt vmcnt(58)
    v_perm_b32 v5, v25, v24, s44
    v_perm_b32 v6, v25, v24, s45
    s_waitcnt vmcnt(56)
    v_perm_b32 v158, v27, v26, v11
    v_accvgpr_write_b32 a58, v5
    v_accvgpr_write_b32 a62, v6
    s_add_u32 s17, s49, 406656
    buffer_load_dword v84, v9, s[20:23], s17 offen
    buffer_load_dword v85, v10, s[20:23], s17 offen
    buffer_load_dword v86, v12, s[20:23], s17 offen
    buffer_load_dword v87, v13, s[20:23], s17 offen
    s_waitcnt vmcnt(58)
    v_perm_b32 v5, v29, v28, s44
    v_perm_b32 v6, v29, v28, s45
    s_waitcnt vmcnt(56)
    v_perm_b32 v159, v31, v30, v11
    v_accvgpr_write_b32 a59, v5
    v_accvgpr_write_b32 a63, v6
    s_add_u32 s17, s49, 407808
    buffer_load_dword v88, v9, s[20:23], s17 offen
    buffer_load_dword v89, v10, s[20:23], s17 offen
    buffer_load_dword v90, v12, s[20:23], s17 offen
    buffer_load_dword v91, v13, s[20:23], s17 offen
    s_waitcnt vmcnt(58)
    v_perm_b32 v5, v33, v32, s44
    v_perm_b32 v6, v33, v32, s45
    s_waitcnt vmcnt(56)
    v_perm_b32 v160, v35, v34, v11
    v_accvgpr_write_b32 a64, v5
    v_accvgpr_write_b32 a68, v6
    s_add_u32 s17, s49, 408960
    buffer_load_dword v92, v9, s[20:23], s17 offen
    buffer_load_dword v93, v10, s[20:23], s17 offen
    buffer_load_dword v94, v12, s[20:23], s17 offen
    buffer_load_dword v95, v13, s[20:23], s17 offen
    s_waitcnt vmcnt(58)
    v_perm_b32 v5, v37, v36, s44
    v_perm_b32 v6, v37, v36, s45
    s_waitcnt vmcnt(56)
    v_perm_b32 v161, v39, v38, v11
    v_accvgpr_write_b32 a65, v5
    v_accvgpr_write_b32 a69, v6
    s_add_u32 s17, s49, 442368
    buffer_load_dword v96, v9, s[20:23], s17 offen
    buffer_load_dword v97, v10, s[20:23], s17 offen
    buffer_load_dword v98, v12, s[20:23], s17 offen
    buffer_load_dword v99, v13, s[20:23], s17 offen
    s_waitcnt vmcnt(58)
    v_perm_b32 v5, v41, v40, s44
    v_perm_b32 v6, v41, v40, s45
    s_waitcnt vmcnt(56)
    v_perm_b32 v162, v43, v42, v11
    v_accvgpr_write_b32 a66, v5
    v_accvgpr_write_b32 a70, v6
    s_add_u32 s17, s49, 443520
    buffer_load_dword v100, v9, s[20:23], s17 offen
    buffer_load_dword v101, v10, s[20:23], s17 offen
    buffer_load_dword v102, v12, s[20:23], s17 offen
    buffer_load_dword v103, v13, s[20:23], s17 offen
    s_waitcnt vmcnt(58)
    v_perm_b32 v5, v45, v44, s44
    v_perm_b32 v6, v45, v44, s45
    s_waitcnt vmcnt(56)
    v_perm_b32 v163, v47, v46, v11
    v_accvgpr_write_b32 a67, v5
    v_accvgpr_write_b32 a71, v6
    s_add_u32 s17, s49, 444672
    buffer_load_dword v104, v9, s[20:23], s17 offen
    buffer_load_dword v105, v10, s[20:23], s17 offen
    buffer_load_dword v106, v12, s[20:23], s17 offen
    buffer_load_dword v107, v13, s[20:23], s17 offen
    s_waitcnt vmcnt(58)
    v_perm_b32 v5, v49, v48, s44
    v_perm_b32 v6, v49, v48, s45
    s_waitcnt vmcnt(56)
    v_perm_b32 v164, v51, v50, v11
    v_accvgpr_write_b32 a72, v5
    v_accvgpr_write_b32 a76, v6
    s_add_u32 s17, s49, 445824
    buffer_load_dword v108, v9, s[20:23], s17 offen
    buffer_load_dword v109, v10, s[20:23], s17 offen
    buffer_load_dword v110, v12, s[20:23], s17 offen
    buffer_load_dword v111, v13, s[20:23], s17 offen
    s_waitcnt vmcnt(58)
    v_perm_b32 v5, v53, v52, s44
    v_perm_b32 v6, v53, v52, s45
    s_waitcnt vmcnt(56)
    v_perm_b32 v165, v55, v54, v11
    v_accvgpr_write_b32 a73, v5
    v_accvgpr_write_b32 a77, v6
    s_add_u32 s17, s49, 479232
    buffer_load_dword v112, v9, s[20:23], s17 offen
    buffer_load_dword v113, v10, s[20:23], s17 offen
    buffer_load_dword v114, v12, s[20:23], s17 offen
    buffer_load_dword v115, v13, s[20:23], s17 offen
    s_waitcnt vmcnt(58)
    v_perm_b32 v5, v57, v56, s44
    v_perm_b32 v6, v57, v56, s45
    s_waitcnt vmcnt(56)
    v_perm_b32 v166, v59, v58, v11
    v_accvgpr_write_b32 a74, v5
    v_accvgpr_write_b32 a78, v6
    s_add_u32 s17, s49, 480384
    buffer_load_dword v116, v9, s[20:23], s17 offen
    buffer_load_dword v117, v10, s[20:23], s17 offen
    buffer_load_dword v118, v12, s[20:23], s17 offen
    buffer_load_dword v119, v13, s[20:23], s17 offen
    s_waitcnt vmcnt(58)
    v_perm_b32 v5, v61, v60, s44
    v_perm_b32 v6, v61, v60, s45
    s_waitcnt vmcnt(56)
    v_perm_b32 v167, v63, v62, v11
    v_accvgpr_write_b32 a75, v5
    v_accvgpr_write_b32 a79, v6
    s_add_u32 s17, s49, 481536
    buffer_load_dword v120, v9, s[20:23], s17 offen
    buffer_load_dword v121, v10, s[20:23], s17 offen
    buffer_load_dword v122, v12, s[20:23], s17 offen
    buffer_load_dword v123, v13, s[20:23], s17 offen
    s_waitcnt vmcnt(58)
    v_perm_b32 v5, v65, v64, s44
    v_perm_b32 v6, v65, v64, s45
    s_waitcnt vmcnt(56)
    v_perm_b32 v168, v67, v66, v11
    v_accvgpr_write_b32 a80, v5
    v_accvgpr_write_b32 a84, v6
    s_add_u32 s17, s49, 482688
    buffer_load_dword v124, v9, s[20:23], s17 offen
    buffer_load_dword v125, v10, s[20:23], s17 offen
    buffer_load_dword v126, v12, s[20:23], s17 offen
    buffer_load_dword v127, v13, s[20:23], s17 offen
    s_waitcnt vmcnt(58)
    v_perm_b32 v5, v69, v68, s44
    v_perm_b32 v6, v69, v68, s45
    s_waitcnt vmcnt(56)
    v_perm_b32 v169, v71, v70, v11
    v_accvgpr_write_b32 a81, v5
    v_accvgpr_write_b32 a85, v6
    s_add_u32 s17, s49, 516096
    buffer_load_dword v16, v9, s[20:23], s17 offen
    buffer_load_dword v17, v10, s[20:23], s17 offen
    buffer_load_dword v18, v12, s[20:23], s17 offen
    buffer_load_dword v19, v13, s[20:23], s17 offen
    s_waitcnt vmcnt(58)
    v_perm_b32 v5, v73, v72, s44
    v_perm_b32 v6, v73, v72, s45
    s_waitcnt vmcnt(56)
    v_perm_b32 v170, v75, v74, v11
    v_accvgpr_write_b32 a82, v5
    v_accvgpr_write_b32 a86, v6
    s_add_u32 s17, s49, 517248
    buffer_load_dword v20, v9, s[20:23], s17 offen
    buffer_load_dword v21, v10, s[20:23], s17 offen
    buffer_load_dword v22, v12, s[20:23], s17 offen
    buffer_load_dword v23, v13, s[20:23], s17 offen
    s_waitcnt vmcnt(58)
    v_perm_b32 v5, v77, v76, s44
    v_perm_b32 v6, v77, v76, s45
    s_waitcnt vmcnt(56)
    v_perm_b32 v171, v79, v78, v11
    v_accvgpr_write_b32 a83, v5
    v_accvgpr_write_b32 a87, v6
    s_add_u32 s17, s49, 518400
    buffer_load_dword v24, v9, s[20:23], s17 offen
    buffer_load_dword v25, v10, s[20:23], s17 offen
    buffer_load_dword v26, v12, s[20:23], s17 offen
    buffer_load_dword v27, v13, s[20:23], s17 offen
    s_waitcnt vmcnt(58)
    v_perm_b32 v5, v81, v80, s44
    v_perm_b32 v6, v81, v80, s45
    s_waitcnt vmcnt(56)
    v_perm_b32 v172, v83, v82, v11
    v_accvgpr_write_b32 a88, v5
    v_accvgpr_write_b32 a92, v6
    s_add_u32 s17, s49, 519552
    buffer_load_dword v28, v9, s[20:23], s17 offen
    buffer_load_dword v29, v10, s[20:23], s17 offen
    buffer_load_dword v30, v12, s[20:23], s17 offen
    buffer_load_dword v31, v13, s[20:23], s17 offen
    s_waitcnt vmcnt(58)
    v_perm_b32 v5, v85, v84, s44
    v_perm_b32 v6, v85, v84, s45
    s_waitcnt vmcnt(56)
    v_perm_b32 v173, v87, v86, v11
    v_accvgpr_write_b32 a89, v5
    v_accvgpr_write_b32 a93, v6
    s_add_u32 s17, s49, 552960
    buffer_load_dword v32, v9, s[20:23], s17 offen
    buffer_load_dword v33, v10, s[20:23], s17 offen
    buffer_load_dword v34, v12, s[20:23], s17 offen
    buffer_load_dword v35, v13, s[20:23], s17 offen
    s_waitcnt vmcnt(58)
    v_perm_b32 v5, v89, v88, s44
    v_perm_b32 v6, v89, v88, s45
    s_waitcnt vmcnt(56)
    v_perm_b32 v174, v91, v90, v11
    v_accvgpr_write_b32 a90, v5
    v_accvgpr_write_b32 a94, v6
    s_add_u32 s17, s49, 554112
    buffer_load_dword v36, v9, s[20:23], s17 offen
    buffer_load_dword v37, v10, s[20:23], s17 offen
    buffer_load_dword v38, v12, s[20:23], s17 offen
    buffer_load_dword v39, v13, s[20:23], s17 offen
    s_waitcnt vmcnt(58)
    v_perm_b32 v5, v93, v92, s44
    v_perm_b32 v6, v93, v92, s45
    s_waitcnt vmcnt(56)
    v_perm_b32 v175, v95, v94, v11
    v_accvgpr_write_b32 a91, v5
    v_accvgpr_write_b32 a95, v6
    s_add_u32 s17, s49, 555264
    buffer_load_dword v40, v9, s[20:23], s17 offen
    buffer_load_dword v41, v10, s[20:23], s17 offen
    buffer_load_dword v42, v12, s[20:23], s17 offen
    buffer_load_dword v43, v13, s[20:23], s17 offen
    s_waitcnt vmcnt(58)
    v_perm_b32 v5, v97, v96, s44
    v_perm_b32 v6, v97, v96, s45
    s_waitcnt vmcnt(56)
    v_perm_b32 v176, v99, v98, v11
    v_accvgpr_write_b32 a96, v5
    v_accvgpr_write_b32 a100, v6
    s_add_u32 s17, s49, 556416
    buffer_load_dword v44, v9, s[20:23], s17 offen
    buffer_load_dword v45, v10, s[20:23], s17 offen
    buffer_load_dword v46, v12, s[20:23], s17 offen
    buffer_load_dword v47, v13, s[20:23], s17 offen
    s_waitcnt vmcnt(58)
    v_perm_b32 v5, v101, v100, s44
    v_perm_b32 v6, v101, v100, s45
    s_waitcnt vmcnt(56)
    v_perm_b32 v177, v103, v102, v11
    v_accvgpr_write_b32 a97, v5
    v_accvgpr_write_b32 a101, v6
    s_add_u32 s17, s49, 589824
    buffer_load_dword v48, v9, s[20:23], s17 offen
    buffer_load_dword v49, v10, s[20:23], s17 offen
    buffer_load_dword v50, v12, s[20:23], s17 offen
    buffer_load_dword v51, v13, s[20:23], s17 offen
    s_waitcnt vmcnt(58)
    v_perm_b32 v5, v105, v104, s44
    v_perm_b32 v6, v105, v104, s45
    s_waitcnt vmcnt(56)
    v_perm_b32 v178, v107, v106, v11
    v_accvgpr_write_b32 a98, v5
    v_accvgpr_write_b32 a102, v6
    s_add_u32 s17, s49, 590976
    buffer_load_dword v52, v9, s[20:23], s17 offen
    buffer_load_dword v53, v10, s[20:23], s17 offen
    buffer_load_dword v54, v12, s[20:23], s17 offen
    buffer_load_dword v55, v13, s[20:23], s17 offen
    s_waitcnt vmcnt(58)
    v_perm_b32 v5, v109, v108, s44
    v_perm_b32 v6, v109, v108, s45
    s_waitcnt vmcnt(56)
    v_perm_b32 v179, v111, v110, v11
    v_accvgpr_write_b32 a99, v5
    v_accvgpr_write_b32 a103, v6
    s_add_u32 s17, s49, 592128
    buffer_load_dword v56, v9, s[20:23], s17 offen
    buffer_load_dword v57, v10, s[20:23], s17 offen
    buffer_load_dword v58, v12, s[20:23], s17 offen
    buffer_load_dword v59, v13, s[20:23], s17 offen
    s_waitcnt vmcnt(58)
    v_perm_b32 v5, v113, v112, s44
    v_perm_b32 v6, v113, v112, s45
    s_waitcnt vmcnt(56)
    v_perm_b32 v180, v115, v114, v11
    v_accvgpr_write_b32 a104, v5
    v_accvgpr_write_b32 a108, v6
    s_add_u32 s17, s49, 593280
    buffer_load_dword v60, v9, s[20:23], s17 offen
    buffer_load_dword v61, v10, s[20:23], s17 offen
    buffer_load_dword v62, v12, s[20:23], s17 offen
    buffer_load_dword v63, v13, s[20:23], s17 offen
    s_waitcnt vmcnt(58)
    v_perm_b32 v5, v117, v116, s44
    v_perm_b32 v6, v117, v116, s45
    s_waitcnt vmcnt(56)
    v_perm_b32 v181, v119, v118, v11
    v_accvgpr_write_b32 a105, v5
    v_accvgpr_write_b32 a109, v6
    s_add_u32 s17, s49, 626688
    buffer_load_dword v64, v9, s[20:23], s17 offen
    buffer_load_dword v65, v10, s[20:23], s17 offen
    buffer_load_dword v66, v12, s[20:23], s17 offen
    buffer_load_dword v67, v13, s[20:23], s17 offen
    s_waitcnt vmcnt(58)
    v_perm_b32 v5, v121, v120, s44
    v_perm_b32 v6, v121, v120, s45
    s_waitcnt vmcnt(56)
    v_perm_b32 v182, v123, v122, v11
    v_accvgpr_write_b32 a106, v5
    v_accvgpr_write_b32 a110, v6
    s_add_u32 s17, s49, 627840
    buffer_load_dword v68, v9, s[20:23], s17 offen
    buffer_load_dword v69, v10, s[20:23], s17 offen
    buffer_load_dword v70, v12, s[20:23], s17 offen
    buffer_load_dword v71, v13, s[20:23], s17 offen
    s_waitcnt vmcnt(58)
    v_perm_b32 v5, v125, v124, s44
    v_perm_b32 v6, v125, v124, s45
    s_waitcnt vmcnt(56)
    v_perm_b32 v183, v127, v126, v11
    v_accvgpr_write_b32 a107, v5
    v_accvgpr_write_b32 a111, v6
    s_add_u32 s17, s49, 628992
    buffer_load_dword v72, v9, s[20:23], s17 offen
    buffer_load_dword v73, v10, s[20:23], s17 offen
    buffer_load_dword v74, v12, s[20:23], s17 offen
    buffer_load_dword v75, v13, s[20:23], s17 offen
    s_waitcnt vmcnt(58)
    v_perm_b32 v5, v17, v16, s44
    v_perm_b32 v6, v17, v16, s45
    s_waitcnt vmcnt(56)
    v_perm_b32 v184, v19, v18, v11
    v_accvgpr_write_b32 a112, v5
    v_accvgpr_write_b32 a116, v6
    s_add_u32 s17, s49, 630144
    buffer_load_dword v76, v9, s[20:23], s17 offen
    buffer_load_dword v77, v10, s[20:23], s17 offen
    buffer_load_dword v78, v12, s[20:23], s17 offen
    buffer_load_dword v79, v13, s[20:23], s17 offen
    s_waitcnt vmcnt(58)
    v_perm_b32 v5, v21, v20, s44
    v_perm_b32 v6, v21, v20, s45
    s_waitcnt vmcnt(56)
    v_perm_b32 v185, v23, v22, v11
    v_accvgpr_write_b32 a113, v5
    v_accvgpr_write_b32 a117, v6
    s_add_u32 s17, s49, 663552
    buffer_load_dword v80, v9, s[20:23], s17 offen
    buffer_load_dword v81, v10, s[20:23], s17 offen
    buffer_load_dword v82, v12, s[20:23], s17 offen
    buffer_load_dword v83, v13, s[20:23], s17 offen
    s_waitcnt vmcnt(58)
    v_perm_b32 v5, v25, v24, s44
    v_perm_b32 v6, v25, v24, s45
    s_waitcnt vmcnt(56)
    v_perm_b32 v186, v27, v26, v11
    v_accvgpr_write_b32 a114, v5
    v_accvgpr_write_b32 a118, v6
    s_add_u32 s17, s49, 664704
    buffer_load_dword v84, v9, s[20:23], s17 offen
    buffer_load_dword v85, v10, s[20:23], s17 offen
    buffer_load_dword v86, v12, s[20:23], s17 offen
    buffer_load_dword v87, v13, s[20:23], s17 offen
    s_waitcnt vmcnt(58)
    v_perm_b32 v5, v29, v28, s44
    v_perm_b32 v6, v29, v28, s45
    s_waitcnt vmcnt(56)
    v_perm_b32 v187, v31, v30, v11
    v_accvgpr_write_b32 a115, v5
    v_accvgpr_write_b32 a119, v6
    s_add_u32 s17, s49, 665856
    buffer_load_dword v88, v9, s[20:23], s17 offen
    buffer_load_dword v89, v10, s[20:23], s17 offen
    buffer_load_dword v90, v12, s[20:23], s17 offen
    buffer_load_dword v91, v13, s[20:23], s17 offen
    s_waitcnt vmcnt(58)
    v_perm_b32 v5, v33, v32, s44
    v_perm_b32 v6, v33, v32, s45
    s_waitcnt vmcnt(56)
    v_perm_b32 v188, v35, v34, v11
    v_accvgpr_write_b32 a120, v5
    v_accvgpr_write_b32 a124, v6
    s_add_u32 s17, s49, 667008
    buffer_load_dword v92, v9, s[20:23], s17 offen
    buffer_load_dword v93, v10, s[20:23], s17 offen
    buffer_load_dword v94, v12, s[20:23], s17 offen
    buffer_load_dword v95, v13, s[20:23], s17 offen
    s_waitcnt vmcnt(58)
    v_perm_b32 v5, v37, v36, s44
    v_perm_b32 v6, v37, v36, s45
    s_waitcnt vmcnt(56)
    v_perm_b32 v189, v39, v38, v11
    v_accvgpr_write_b32 a121, v5
    v_accvgpr_write_b32 a125, v6
    s_add_u32 s17, s49, 700416
    buffer_load_dword v96, v9, s[20:23], s17 offen
    buffer_load_dword v97, v10, s[20:23], s17 offen
    buffer_load_dword v98, v12, s[20:23], s17 offen
    buffer_load_dword v99, v13, s[20:23], s17 offen
    s_waitcnt vmcnt(58)
    v_perm_b32 v5, v41, v40, s44
    v_perm_b32 v6, v41, v40, s45
    s_waitcnt vmcnt(56)
    v_perm_b32 v190, v43, v42, v11
    v_accvgpr_write_b32 a122, v5
    v_accvgpr_write_b32 a126, v6
    s_add_u32 s17, s49, 701568
    buffer_load_dword v100, v9, s[20:23], s17 offen
    buffer_load_dword v101, v10, s[20:23], s17 offen
    buffer_load_dword v102, v12, s[20:23], s17 offen
    buffer_load_dword v103, v13, s[20:23], s17 offen
    s_waitcnt vmcnt(58)
    v_perm_b32 v5, v45, v44, s44
    v_perm_b32 v6, v45, v44, s45
    s_waitcnt vmcnt(56)
    v_perm_b32 v191, v47, v46, v11
    v_accvgpr_write_b32 a123, v5
    v_accvgpr_write_b32 a127, v6
    s_add_u32 s17, s49, 702720
    buffer_load_dword v104, v9, s[20:23], s17 offen
    buffer_load_dword v105, v10, s[20:23], s17 offen
    buffer_load_dword v106, v12, s[20:23], s17 offen
    buffer_load_dword v107, v13, s[20:23], s17 offen
    s_waitcnt vmcnt(58)
    v_perm_b32 v5, v49, v48, s44
    v_perm_b32 v6, v49, v48, s45
    s_waitcnt vmcnt(56)
    v_perm_b32 v192, v51, v50, v11
    v_accvgpr_write_b32 a128, v5
    v_accvgpr_write_b32 a132, v6
    s_add_u32 s17, s49, 703872
    buffer_load_dword v108, v9, s[20:23], s17 offen
    buffer_load_dword v109, v10, s[20:23], s17 offen
    buffer_load_dword v110, v12, s[20:23], s17 offen
    buffer_load_dword v111, v13, s[20:23], s17 offen
    s_waitcnt vmcnt(58)
    v_perm_b32 v5, v53, v52, s44
    v_perm_b32 v6, v53, v52, s45
    s_waitcnt vmcnt(56)
    v_perm_b32 v193, v55, v54, v11
    v_accvgpr_write_b32 a129, v5
    v_accvgpr_write_b32 a133, v6
    s_add_u32 s17, s49, 737280
    buffer_load_dword v112, v9, s[20:23], s17 offen
    buffer_load_dword v113, v10, s[20:23], s17 offen
    buffer_load_dword v114, v12, s[20:23], s17 offen
    buffer_load_dword v115, v13, s[20:23], s17 offen
    s_waitcnt vmcnt(58)
    v_perm_b32 v5, v57, v56, s44
    v_perm_b32 v6, v57, v56, s45
    s_waitcnt vmcnt(56)
    v_perm_b32 v194, v59, v58, v11
    v_accvgpr_write_b32 a130, v5
    v_accvgpr_write_b32 a134, v6
    s_add_u32 s17, s49, 738432
    buffer_load_dword v116, v9, s[20:23], s17 offen
    buffer_load_dword v117, v10, s[20:23], s17 offen
    buffer_load_dword v118, v12, s[20:23], s17 offen
    buffer_load_dword v119, v13, s[20:23], s17 offen
    s_waitcnt vmcnt(58)
    v_perm_b32 v5, v61, v60, s44
    v_perm_b32 v6, v61, v60, s45
    s_waitcnt vmcnt(56)
    v_perm_b32 v195, v63, v62, v11
    v_accvgpr_write_b32 a131, v5
    v_accvgpr_write_b32 a135, v6
    s_add_u32 s17, s49, 739584
    buffer_load_dword v120, v9, s[20:23], s17 offen
    buffer_load_dword v121, v10, s[20:23], s17 offen
    buffer_load_dword v122, v12, s[20:23], s17 offen
    buffer_load_dword v123, v13, s[20:23], s17 offen
    s_waitcnt vmcnt(58)
    v_perm_b32 v5, v65, v64, s44
    v_perm_b32 v6, v65, v64, s45
    s_waitcnt vmcnt(56)
    v_perm_b32 v196, v67, v66, v11
    v_accvgpr_write_b32 a136, v5
    v_accvgpr_write_b32 a140, v6
    s_add_u32 s17, s49, 740736
    buffer_load_dword v124, v9, s[20:23], s17 offen
    buffer_load_dword v125, v10, s[20:23], s17 offen
    buffer_load_dword v126, v12, s[20:23], s17 offen
    buffer_load_dword v127, v13, s[20:23], s17 offen
    s_waitcnt vmcnt(58)
    v_perm_b32 v5, v69, v68, s44
    v_perm_b32 v6, v69, v68, s45
    s_waitcnt vmcnt(56)
    v_perm_b32 v197, v71, v70, v11
    v_accvgpr_write_b32 a137, v5
    v_accvgpr_write_b32 a141, v6
    s_add_u32 s17, s49, 774144
    buffer_load_dword v16, v9, s[20:23], s17 offen
    buffer_load_dword v17, v10, s[20:23], s17 offen
    buffer_load_dword v18, v12, s[20:23], s17 offen
    buffer_load_dword v19, v13, s[20:23], s17 offen
    s_waitcnt vmcnt(58)
    v_perm_b32 v5, v73, v72, s44
    v_perm_b32 v6, v73, v72, s45
    s_waitcnt vmcnt(56)
    v_perm_b32 v198, v75, v74, v11
    v_accvgpr_write_b32 a138, v5
    v_accvgpr_write_b32 a142, v6
    s_add_u32 s17, s49, 775296
    buffer_load_dword v20, v9, s[20:23], s17 offen
    buffer_load_dword v21, v10, s[20:23], s17 offen
    buffer_load_dword v22, v12, s[20:23], s17 offen
    buffer_load_dword v23, v13, s[20:23], s17 offen
    s_waitcnt vmcnt(58)
    v_perm_b32 v5, v77, v76, s44
    v_perm_b32 v6, v77, v76, s45
    s_waitcnt vmcnt(56)
    v_perm_b32 v199, v79, v78, v11
    v_accvgpr_write_b32 a139, v5
    v_accvgpr_write_b32 a143, v6
    s_add_u32 s17, s49, 776448
    buffer_load_dword v24, v9, s[20:23], s17 offen
    buffer_load_dword v25, v10, s[20:23], s17 offen
    buffer_load_dword v26, v12, s[20:23], s17 offen
    buffer_load_dword v27, v13, s[20:23], s17 offen
    s_waitcnt vmcnt(58)
    v_perm_b32 v5, v81, v80, s44
    v_perm_b32 v6, v81, v80, s45
    s_waitcnt vmcnt(56)
    v_perm_b32 v200, v83, v82, v11
    v_accvgpr_write_b32 a144, v5
    v_accvgpr_write_b32 a148, v6
    s_add_u32 s17, s49, 777600
    buffer_load_dword v28, v9, s[20:23], s17 offen
    buffer_load_dword v29, v10, s[20:23], s17 offen
    buffer_load_dword v30, v12, s[20:23], s17 offen
    buffer_load_dword v31, v13, s[20:23], s17 offen
    s_waitcnt vmcnt(58)
    v_perm_b32 v5, v85, v84, s44
    v_perm_b32 v6, v85, v84, s45
    s_waitcnt vmcnt(56)
    v_perm_b32 v201, v87, v86, v11
    v_accvgpr_write_b32 a145, v5
    v_accvgpr_write_b32 a149, v6
    s_add_u32 s17, s49, 811008
    buffer_load_dword v32, v9, s[20:23], s17 offen
    buffer_load_dword v33, v10, s[20:23], s17 offen
    buffer_load_dword v34, v12, s[20:23], s17 offen
    buffer_load_dword v35, v13, s[20:23], s17 offen
    s_waitcnt vmcnt(58)
    v_perm_b32 v5, v89, v88, s44
    v_perm_b32 v6, v89, v88, s45
    s_waitcnt vmcnt(56)
    v_perm_b32 v202, v91, v90, v11
    v_accvgpr_write_b32 a146, v5
    v_accvgpr_write_b32 a150, v6
    s_add_u32 s17, s49, 812160
    buffer_load_dword v36, v9, s[20:23], s17 offen
    buffer_load_dword v37, v10, s[20:23], s17 offen
    buffer_load_dword v38, v12, s[20:23], s17 offen
    buffer_load_dword v39, v13, s[20:23], s17 offen
    s_waitcnt vmcnt(58)
    v_perm_b32 v5, v93, v92, s44
    v_perm_b32 v6, v93, v92, s45
    s_waitcnt vmcnt(56)
    v_perm_b32 v203, v95, v94, v11
    v_accvgpr_write_b32 a147, v5
    v_accvgpr_write_b32 a151, v6
    s_add_u32 s17, s49, 813312
    buffer_load_dword v40, v9, s[20:23], s17 offen
    buffer_load_dword v41, v10, s[20:23], s17 offen
    buffer_load_dword v42, v12, s[20:23], s17 offen
    buffer_load_dword v43, v13, s[20:23], s17 offen
    s_waitcnt vmcnt(58)
    v_perm_b32 v5, v97, v96, s44
    v_perm_b32 v6, v97, v96, s45
    s_waitcnt vmcnt(56)
    v_perm_b32 v204, v99, v98, v11
    v_accvgpr_write_b32 a152, v5
    v_accvgpr_write_b32 a156, v6
    s_add_u32 s17, s49, 814464
    buffer_load_dword v44, v9, s[20:23], s17 offen
    buffer_load_dword v45, v10, s[20:23], s17 offen
    buffer_load_dword v46, v12, s[20:23], s17 offen
    buffer_load_dword v47, v13, s[20:23], s17 offen
    s_waitcnt vmcnt(58)
    v_perm_b32 v5, v101, v100, s44
    v_perm_b32 v6, v101, v100, s45
    s_waitcnt vmcnt(56)
    v_perm_b32 v205, v103, v102, v11
    v_accvgpr_write_b32 a153, v5
    v_accvgpr_write_b32 a157, v6
    s_add_u32 s17, s49, 847872
    buffer_load_dword v48, v9, s[20:23], s17 offen
    buffer_load_dword v49, v10, s[20:23], s17 offen
    buffer_load_dword v50, v12, s[20:23], s17 offen
    buffer_load_dword v51, v13, s[20:23], s17 offen
    s_waitcnt vmcnt(58)
    v_perm_b32 v5, v105, v104, s44
    v_perm_b32 v6, v105, v104, s45
    s_waitcnt vmcnt(56)
    v_perm_b32 v206, v107, v106, v11
    v_accvgpr_write_b32 a154, v5
    v_accvgpr_write_b32 a158, v6
    s_add_u32 s17, s49, 849024
    buffer_load_dword v52, v9, s[20:23], s17 offen
    buffer_load_dword v53, v10, s[20:23], s17 offen
    buffer_load_dword v54, v12, s[20:23], s17 offen
    buffer_load_dword v55, v13, s[20:23], s17 offen
    s_waitcnt vmcnt(58)
    v_perm_b32 v5, v109, v108, s44
    v_perm_b32 v6, v109, v108, s45
    s_waitcnt vmcnt(56)
    v_perm_b32 v207, v111, v110, v11
    v_accvgpr_write_b32 a155, v5
    v_accvgpr_write_b32 a159, v6
    s_add_u32 s17, s49, 850176
    buffer_load_dword v56, v9, s[20:23], s17 offen
    buffer_load_dword v57, v10, s[20:23], s17 offen
    buffer_load_dword v58, v12, s[20:23], s17 offen
    buffer_load_dword v59, v13, s[20:23], s17 offen
    s_waitcnt vmcnt(58)
    v_perm_b32 v5, v113, v112, s44
    v_perm_b32 v6, v113, v112, s45
    s_waitcnt vmcnt(56)
    v_perm_b32 v208, v115, v114, v11
    v_accvgpr_write_b32 a160, v5
    v_accvgpr_write_b32 a164, v6
    s_add_u32 s17, s49, 851328
    buffer_load_dword v60, v9, s[20:23], s17 offen
    buffer_load_dword v61, v10, s[20:23], s17 offen
    buffer_load_dword v62, v12, s[20:23], s17 offen
    buffer_load_dword v63, v13, s[20:23], s17 offen
    s_waitcnt vmcnt(58)
    v_perm_b32 v5, v117, v116, s44
    v_perm_b32 v6, v117, v116, s45
    s_waitcnt vmcnt(56)
    v_perm_b32 v209, v119, v118, v11
    v_accvgpr_write_b32 a161, v5
    v_accvgpr_write_b32 a165, v6
    s_add_u32 s17, s49, 884736
    buffer_load_dword v64, v9, s[20:23], s17 offen
    buffer_load_dword v65, v10, s[20:23], s17 offen
    buffer_load_dword v66, v12, s[20:23], s17 offen
    buffer_load_dword v67, v13, s[20:23], s17 offen
    s_waitcnt vmcnt(58)
    v_perm_b32 v5, v121, v120, s44
    v_perm_b32 v6, v121, v120, s45
    s_waitcnt vmcnt(56)
    v_perm_b32 v210, v123, v122, v11
    v_accvgpr_write_b32 a162, v5
    v_accvgpr_write_b32 a166, v6
    s_add_u32 s17, s49, 885888
    buffer_load_dword v68, v9, s[20:23], s17 offen
    buffer_load_dword v69, v10, s[20:23], s17 offen
    buffer_load_dword v70, v12, s[20:23], s17 offen
    buffer_load_dword v71, v13, s[20:23], s17 offen
    s_waitcnt vmcnt(58)
    v_perm_b32 v5, v125, v124, s44
    v_perm_b32 v6, v125, v124, s45
    s_waitcnt vmcnt(56)
    v_perm_b32 v211, v127, v126, v11
    v_accvgpr_write_b32 a163, v5
    v_accvgpr_write_b32 a167, v6
    s_add_u32 s17, s49, 887040
    buffer_load_dword v72, v9, s[20:23], s17 offen
    buffer_load_dword v73, v10, s[20:23], s17 offen
    buffer_load_dword v74, v12, s[20:23], s17 offen
    buffer_load_dword v75, v13, s[20:23], s17 offen
    s_waitcnt vmcnt(58)
    v_perm_b32 v5, v17, v16, s44
    v_perm_b32 v6, v17, v16, s45
    s_waitcnt vmcnt(56)
    v_perm_b32 v212, v19, v18, v11
    v_accvgpr_write_b32 a168, v5
    v_accvgpr_write_b32 a172, v6
    s_add_u32 s17, s49, 888192
    buffer_load_dword v76, v9, s[20:23], s17 offen
    buffer_load_dword v77, v10, s[20:23], s17 offen
    buffer_load_dword v78, v12, s[20:23], s17 offen
    buffer_load_dword v79, v13, s[20:23], s17 offen
    s_waitcnt vmcnt(58)
    v_perm_b32 v5, v21, v20, s44
    v_perm_b32 v6, v21, v20, s45
    s_waitcnt vmcnt(56)
    v_perm_b32 v213, v23, v22, v11
    v_accvgpr_write_b32 a169, v5
    v_accvgpr_write_b32 a173, v6
    s_add_u32 s17, s49, 921600
    buffer_load_dword v80, v9, s[20:23], s17 offen
    buffer_load_dword v81, v10, s[20:23], s17 offen
    buffer_load_dword v82, v12, s[20:23], s17 offen
    buffer_load_dword v83, v13, s[20:23], s17 offen
    s_waitcnt vmcnt(58)
    v_perm_b32 v5, v25, v24, s44
    v_perm_b32 v6, v25, v24, s45
    s_waitcnt vmcnt(56)
    v_perm_b32 v214, v27, v26, v11
    v_accvgpr_write_b32 a170, v5
    v_accvgpr_write_b32 a174, v6
    s_add_u32 s17, s49, 922752
    buffer_load_dword v84, v9, s[20:23], s17 offen
    buffer_load_dword v85, v10, s[20:23], s17 offen
    buffer_load_dword v86, v12, s[20:23], s17 offen
    buffer_load_dword v87, v13, s[20:23], s17 offen
    s_waitcnt vmcnt(58)
    v_perm_b32 v5, v29, v28, s44
    v_perm_b32 v6, v29, v28, s45
    s_waitcnt vmcnt(56)
    v_perm_b32 v215, v31, v30, v11
    v_accvgpr_write_b32 a171, v5
    v_accvgpr_write_b32 a175, v6
    s_add_u32 s17, s49, 923904
    buffer_load_dword v88, v9, s[20:23], s17 offen
    buffer_load_dword v89, v10, s[20:23], s17 offen
    buffer_load_dword v90, v12, s[20:23], s17 offen
    buffer_load_dword v91, v13, s[20:23], s17 offen
    s_waitcnt vmcnt(58)
    v_perm_b32 v5, v33, v32, s44
    v_perm_b32 v6, v33, v32, s45
    s_waitcnt vmcnt(56)
    v_perm_b32 v216, v35, v34, v11
    v_accvgpr_write_b32 a176, v5
    v_accvgpr_write_b32 a180, v6
    s_add_u32 s17, s49, 925056
    buffer_load_dword v92, v9, s[20:23], s17 offen
    buffer_load_dword v93, v10, s[20:23], s17 offen
    buffer_load_dword v94, v12, s[20:23], s17 offen
    buffer_load_dword v95, v13, s[20:23], s17 offen
    s_waitcnt vmcnt(58)
    v_perm_b32 v5, v37, v36, s44
    v_perm_b32 v6, v37, v36, s45
    s_waitcnt vmcnt(56)
    v_perm_b32 v217, v39, v38, v11
    v_accvgpr_write_b32 a177, v5
    v_accvgpr_write_b32 a181, v6
    s_add_u32 s17, s49, 958464
    buffer_load_dword v96, v9, s[20:23], s17 offen
    buffer_load_dword v97, v10, s[20:23], s17 offen
    buffer_load_dword v98, v12, s[20:23], s17 offen
    buffer_load_dword v99, v13, s[20:23], s17 offen
    s_waitcnt vmcnt(58)
    v_perm_b32 v5, v41, v40, s44
    v_perm_b32 v6, v41, v40, s45
    s_waitcnt vmcnt(56)
    v_perm_b32 v218, v43, v42, v11
    v_accvgpr_write_b32 a178, v5
    v_accvgpr_write_b32 a182, v6
    s_add_u32 s17, s49, 959616
    buffer_load_dword v100, v9, s[20:23], s17 offen
    buffer_load_dword v101, v10, s[20:23], s17 offen
    buffer_load_dword v102, v12, s[20:23], s17 offen
    buffer_load_dword v103, v13, s[20:23], s17 offen
    s_waitcnt vmcnt(58)
    v_perm_b32 v5, v45, v44, s44
    v_perm_b32 v6, v45, v44, s45
    s_waitcnt vmcnt(56)
    v_perm_b32 v219, v47, v46, v11
    v_accvgpr_write_b32 a179, v5
    v_accvgpr_write_b32 a183, v6
    s_add_u32 s17, s49, 960768
    buffer_load_dword v104, v9, s[20:23], s17 offen
    buffer_load_dword v105, v10, s[20:23], s17 offen
    buffer_load_dword v106, v12, s[20:23], s17 offen
    buffer_load_dword v107, v13, s[20:23], s17 offen
    s_waitcnt vmcnt(58)
    v_perm_b32 v5, v49, v48, s44
    v_perm_b32 v6, v49, v48, s45
    s_waitcnt vmcnt(56)
    v_perm_b32 v220, v51, v50, v11
    v_accvgpr_write_b32 a184, v5
    v_accvgpr_write_b32 a188, v6
    s_add_u32 s17, s49, 961920
    buffer_load_dword v108, v9, s[20:23], s17 offen
    buffer_load_dword v109, v10, s[20:23], s17 offen
    buffer_load_dword v110, v12, s[20:23], s17 offen
    buffer_load_dword v111, v13, s[20:23], s17 offen
    s_waitcnt vmcnt(58)
    v_perm_b32 v5, v53, v52, s44
    v_perm_b32 v6, v53, v52, s45
    s_waitcnt vmcnt(56)
    v_perm_b32 v221, v55, v54, v11
    v_accvgpr_write_b32 a185, v5
    v_accvgpr_write_b32 a189, v6
    s_add_u32 s17, s49, 995328
    buffer_load_dword v112, v9, s[20:23], s17 offen
    buffer_load_dword v113, v10, s[20:23], s17 offen
    buffer_load_dword v114, v12, s[20:23], s17 offen
    buffer_load_dword v115, v13, s[20:23], s17 offen
    s_waitcnt vmcnt(58)
    v_perm_b32 v5, v57, v56, s44
    v_perm_b32 v6, v57, v56, s45
    s_waitcnt vmcnt(56)
    v_perm_b32 v222, v59, v58, v11
    v_accvgpr_write_b32 a186, v5
    v_accvgpr_write_b32 a190, v6
    s_add_u32 s17, s49, 996480
    buffer_load_dword v116, v9, s[20:23], s17 offen
    buffer_load_dword v117, v10, s[20:23], s17 offen
    buffer_load_dword v118, v12, s[20:23], s17 offen
    buffer_load_dword v119, v13, s[20:23], s17 offen
    s_waitcnt vmcnt(58)
    v_perm_b32 v5, v61, v60, s44
    v_perm_b32 v6, v61, v60, s45
    s_waitcnt vmcnt(56)
    v_perm_b32 v223, v63, v62, v11
    v_accvgpr_write_b32 a187, v5
    v_accvgpr_write_b32 a191, v6
    s_add_u32 s17, s49, 997632
    buffer_load_dword v120, v9, s[20:23], s17 offen
    buffer_load_dword v121, v10, s[20:23], s17 offen
    buffer_load_dword v122, v12, s[20:23], s17 offen
    buffer_load_dword v123, v13, s[20:23], s17 offen
    s_waitcnt vmcnt(58)
    v_perm_b32 v5, v65, v64, s44
    v_perm_b32 v6, v65, v64, s45
    s_waitcnt vmcnt(56)
    v_perm_b32 v224, v67, v66, v11
    v_accvgpr_write_b32 a192, v5
    v_accvgpr_write_b32 a196, v6
    s_add_u32 s17, s49, 998784
    buffer_load_dword v124, v9, s[20:23], s17 offen
    buffer_load_dword v125, v10, s[20:23], s17 offen
    buffer_load_dword v126, v12, s[20:23], s17 offen
    buffer_load_dword v127, v13, s[20:23], s17 offen
    s_waitcnt vmcnt(58)
    v_perm_b32 v5, v69, v68, s44
    v_perm_b32 v6, v69, v68, s45
    s_waitcnt vmcnt(56)
    v_perm_b32 v225, v71, v70, v11
    v_accvgpr_write_b32 a193, v5
    v_accvgpr_write_b32 a197, v6
    s_add_u32 s17, s49, 1032192
    buffer_load_dword v16, v9, s[20:23], s17 offen
    buffer_load_dword v17, v10, s[20:23], s17 offen
    buffer_load_dword v18, v12, s[20:23], s17 offen
    buffer_load_dword v19, v13, s[20:23], s17 offen
    s_waitcnt vmcnt(58)
    v_perm_b32 v5, v73, v72, s44
    v_perm_b32 v6, v73, v72, s45
    s_waitcnt vmcnt(56)
    v_perm_b32 v226, v75, v74, v11
    v_accvgpr_write_b32 a194, v5
    v_accvgpr_write_b32 a198, v6
    s_add_u32 s17, s49, 1033344
    buffer_load_dword v20, v9, s[20:23], s17 offen
    buffer_load_dword v21, v10, s[20:23], s17 offen
    buffer_load_dword v22, v12, s[20:23], s17 offen
    buffer_load_dword v23, v13, s[20:23], s17 offen
    s_waitcnt vmcnt(58)
    v_perm_b32 v5, v77, v76, s44
    v_perm_b32 v6, v77, v76, s45
    s_waitcnt vmcnt(56)
    v_perm_b32 v227, v79, v78, v11
    v_accvgpr_write_b32 a195, v5
    v_accvgpr_write_b32 a199, v6
    s_add_u32 s17, s49, 1034496
    buffer_load_dword v24, v9, s[20:23], s17 offen
    buffer_load_dword v25, v10, s[20:23], s17 offen
    buffer_load_dword v26, v12, s[20:23], s17 offen
    buffer_load_dword v27, v13, s[20:23], s17 offen
    s_waitcnt vmcnt(58)
    v_perm_b32 v5, v81, v80, s44
    v_perm_b32 v6, v81, v80, s45
    s_waitcnt vmcnt(56)
    v_perm_b32 v228, v83, v82, v11
    v_accvgpr_write_b32 a200, v5
    v_accvgpr_write_b32 a204, v6
    s_add_u32 s17, s49, 1035648
    buffer_load_dword v28, v9, s[20:23], s17 offen
    buffer_load_dword v29, v10, s[20:23], s17 offen
    buffer_load_dword v30, v12, s[20:23], s17 offen
    buffer_load_dword v31, v13, s[20:23], s17 offen
    s_waitcnt vmcnt(58)
    v_perm_b32 v5, v85, v84, s44
    v_perm_b32 v6, v85, v84, s45
    s_waitcnt vmcnt(56)
    v_perm_b32 v229, v87, v86, v11
    v_accvgpr_write_b32 a201, v5
    v_accvgpr_write_b32 a205, v6
    s_add_u32 s17, s49, 1069056
    buffer_load_dword v32, v9, s[20:23], s17 offen
    buffer_load_dword v33, v10, s[20:23], s17 offen
    buffer_load_dword v34, v12, s[20:23], s17 offen
    buffer_load_dword v35, v13, s[20:23], s17 offen
    s_waitcnt vmcnt(58)
    v_perm_b32 v5, v89, v88, s44
    v_perm_b32 v6, v89, v88, s45
    s_waitcnt vmcnt(56)
    v_perm_b32 v230, v91, v90, v11
    v_accvgpr_write_b32 a202, v5
    v_accvgpr_write_b32 a206, v6
    s_add_u32 s17, s49, 1070208
    buffer_load_dword v36, v9, s[20:23], s17 offen
    buffer_load_dword v37, v10, s[20:23], s17 offen
    buffer_load_dword v38, v12, s[20:23], s17 offen
    buffer_load_dword v39, v13, s[20:23], s17 offen
    s_waitcnt vmcnt(58)
    v_perm_b32 v5, v93, v92, s44
    v_perm_b32 v6, v93, v92, s45
    s_waitcnt vmcnt(56)
    v_perm_b32 v231, v95, v94, v11
    v_accvgpr_write_b32 a203, v5
    v_accvgpr_write_b32 a207, v6
    s_add_u32 s17, s49, 1071360
    buffer_load_dword v40, v9, s[20:23], s17 offen
    buffer_load_dword v41, v10, s[20:23], s17 offen
    buffer_load_dword v42, v12, s[20:23], s17 offen
    buffer_load_dword v43, v13, s[20:23], s17 offen
    s_waitcnt vmcnt(58)
    v_perm_b32 v5, v97, v96, s44
    v_perm_b32 v6, v97, v96, s45
    s_waitcnt vmcnt(56)
    v_perm_b32 v232, v99, v98, v11
    v_accvgpr_write_b32 a208, v5
    v_accvgpr_write_b32 a212, v6
    s_add_u32 s17, s49, 1072512
    buffer_load_dword v44, v9, s[20:23], s17 offen
    buffer_load_dword v45, v10, s[20:23], s17 offen
    buffer_load_dword v46, v12, s[20:23], s17 offen
    buffer_load_dword v47, v13, s[20:23], s17 offen
    s_waitcnt vmcnt(58)
    v_perm_b32 v5, v101, v100, s44
    v_perm_b32 v6, v101, v100, s45
    s_waitcnt vmcnt(56)
    v_perm_b32 v233, v103, v102, v11
    v_accvgpr_write_b32 a209, v5
    v_accvgpr_write_b32 a213, v6
    s_add_u32 s17, s49, 1105920
    buffer_load_dword v48, v9, s[20:23], s17 offen
    buffer_load_dword v49, v10, s[20:23], s17 offen
    buffer_load_dword v50, v12, s[20:23], s17 offen
    buffer_load_dword v51, v13, s[20:23], s17 offen
    s_waitcnt vmcnt(58)
    v_perm_b32 v5, v105, v104, s44
    v_perm_b32 v6, v105, v104, s45
    s_waitcnt vmcnt(56)
    v_perm_b32 v234, v107, v106, v11
    v_accvgpr_write_b32 a210, v5
    v_accvgpr_write_b32 a214, v6
    s_add_u32 s17, s49, 1107072
    buffer_load_dword v52, v9, s[20:23], s17 offen
    buffer_load_dword v53, v10, s[20:23], s17 offen
    buffer_load_dword v54, v12, s[20:23], s17 offen
    buffer_load_dword v55, v13, s[20:23], s17 offen
    s_waitcnt vmcnt(58)
    v_perm_b32 v5, v109, v108, s44
    v_perm_b32 v6, v109, v108, s45
    s_waitcnt vmcnt(56)
    v_perm_b32 v235, v111, v110, v11
    v_accvgpr_write_b32 a211, v5
    v_accvgpr_write_b32 a215, v6
    s_add_u32 s17, s49, 1108224
    buffer_load_dword v56, v9, s[20:23], s17 offen
    buffer_load_dword v57, v10, s[20:23], s17 offen
    buffer_load_dword v58, v12, s[20:23], s17 offen
    buffer_load_dword v59, v13, s[20:23], s17 offen
    s_waitcnt vmcnt(58)
    v_perm_b32 v5, v113, v112, s44
    v_perm_b32 v6, v113, v112, s45
    s_waitcnt vmcnt(56)
    v_perm_b32 v236, v115, v114, v11
    v_accvgpr_write_b32 a216, v5
    v_accvgpr_write_b32 a220, v6
    s_add_u32 s17, s49, 1109376
    buffer_load_dword v60, v9, s[20:23], s17 offen
    buffer_load_dword v61, v10, s[20:23], s17 offen
    buffer_load_dword v62, v12, s[20:23], s17 offen
    buffer_load_dword v63, v13, s[20:23], s17 offen
    s_waitcnt vmcnt(58)
    v_perm_b32 v5, v117, v116, s44
    v_perm_b32 v6, v117, v116, s45
    s_waitcnt vmcnt(56)
    v_perm_b32 v237, v119, v118, v11
    v_accvgpr_write_b32 a217, v5
    v_accvgpr_write_b32 a221, v6
    s_add_u32 s17, s49, 1142784
    buffer_load_dword v64, v9, s[20:23], s17 offen
    buffer_load_dword v65, v10, s[20:23], s17 offen
    buffer_load_dword v66, v12, s[20:23], s17 offen
    buffer_load_dword v67, v13, s[20:23], s17 offen
    s_waitcnt vmcnt(58)
    v_perm_b32 v5, v121, v120, s44
    v_perm_b32 v6, v121, v120, s45
    s_waitcnt vmcnt(56)
    v_perm_b32 v238, v123, v122, v11
    v_accvgpr_write_b32 a218, v5
    v_accvgpr_write_b32 a222, v6
    s_add_u32 s17, s49, 1143936
    buffer_load_dword v68, v9, s[20:23], s17 offen
    buffer_load_dword v69, v10, s[20:23], s17 offen
    buffer_load_dword v70, v12, s[20:23], s17 offen
    buffer_load_dword v71, v13, s[20:23], s17 offen
    s_waitcnt vmcnt(58)
    v_perm_b32 v5, v125, v124, s44
    v_perm_b32 v6, v125, v124, s45
    s_waitcnt vmcnt(56)
    v_perm_b32 v239, v127, v126, v11
    v_accvgpr_write_b32 a219, v5
    v_accvgpr_write_b32 a223, v6
    s_add_u32 s17, s49, 1145088
    buffer_load_dword v72, v9, s[20:23], s17 offen
    buffer_load_dword v73, v10, s[20:23], s17 offen
    buffer_load_dword v74, v12, s[20:23], s17 offen
    buffer_load_dword v75, v13, s[20:23], s17 offen
    s_waitcnt vmcnt(58)
    v_perm_b32 v5, v17, v16, s44
    v_perm_b32 v6, v17, v16, s45
    s_waitcnt vmcnt(56)
    v_perm_b32 v240, v19, v18, v11
    v_accvgpr_write_b32 a224, v5
    v_accvgpr_write_b32 a228, v6
    s_add_u32 s17, s49, 1146240
    buffer_load_dword v76, v9, s[20:23], s17 offen
    buffer_load_dword v77, v10, s[20:23], s17 offen
    buffer_load_dword v78, v12, s[20:23], s17 offen
    buffer_load_dword v79, v13, s[20:23], s17 offen
    s_waitcnt vmcnt(58)
    v_perm_b32 v5, v21, v20, s44
    v_perm_b32 v6, v21, v20, s45
    s_waitcnt vmcnt(56)
    v_perm_b32 v241, v23, v22, v11
    v_accvgpr_write_b32 a225, v5
    v_accvgpr_write_b32 a229, v6
    s_waitcnt vmcnt(54)
    v_perm_b32 v5, v25, v24, s44
    v_perm_b32 v6, v25, v24, s45
    s_waitcnt vmcnt(52)
    v_perm_b32 v242, v27, v26, v11
    v_accvgpr_write_b32 a226, v5
    v_accvgpr_write_b32 a230, v6
    s_waitcnt vmcnt(50)
    v_perm_b32 v5, v29, v28, s44
    v_perm_b32 v6, v29, v28, s45
    s_waitcnt vmcnt(48)
    v_perm_b32 v243, v31, v30, v11
    v_accvgpr_write_b32 a227, v5
    v_accvgpr_write_b32 a231, v6
    s_waitcnt vmcnt(46)
    v_perm_b32 v5, v33, v32, s44
    v_perm_b32 v6, v33, v32, s45
    s_waitcnt vmcnt(44)
    v_perm_b32 v244, v35, v34, v11
    v_accvgpr_write_b32 a232, v5
    v_accvgpr_write_b32 a236, v6
    s_waitcnt vmcnt(42)
    v_perm_b32 v5, v37, v36, s44
    v_perm_b32 v6, v37, v36, s45
    s_waitcnt vmcnt(40)
    v_perm_b32 v245, v39, v38, v11
    v_accvgpr_write_b32 a233, v5
    v_accvgpr_write_b32 a237, v6
    s_waitcnt vmcnt(38)
    v_perm_b32 v5, v41, v40, s44
    v_perm_b32 v6, v41, v40, s45
    s_waitcnt vmcnt(36)
    v_perm_b32 v246, v43, v42, v11
    v_accvgpr_write_b32 a234, v5
    v_accvgpr_write_b32 a238, v6
    s_waitcnt vmcnt(34)
    v_perm_b32 v5, v45, v44, s44
    v_perm_b32 v6, v45, v44, s45
    s_waitcnt vmcnt(32)
    v_perm_b32 v247, v47, v46, v11
    v_accvgpr_write_b32 a235, v5
    v_accvgpr_write_b32 a239, v6
    s_waitcnt vmcnt(30)
    v_perm_b32 v5, v49, v48, s44
    v_perm_b32 v6, v49, v48, s45
    s_waitcnt vmcnt(28)
    v_perm_b32 v248, v51, v50, v11
    v_accvgpr_write_b32 a240, v5
    v_accvgpr_write_b32 a244, v6
    s_waitcnt vmcnt(26)
    v_perm_b32 v5, v53, v52, s44
    v_perm_b32 v6, v53, v52, s45
    s_waitcnt vmcnt(24)
    v_perm_b32 v249, v55, v54, v11
    v_accvgpr_write_b32 a241, v5
    v_accvgpr_write_b32 a245, v6
    s_waitcnt vmcnt(22)
    v_perm_b32 v5, v57, v56, s44
    v_perm_b32 v6, v57, v56, s45
    s_waitcnt vmcnt(20)
    v_perm_b32 v250, v59, v58, v11
    v_accvgpr_write_b32 a242, v5
    v_accvgpr_write_b32 a246, v6
    s_waitcnt vmcnt(18)
    v_perm_b32 v5, v61, v60, s44
    v_perm_b32 v6, v61, v60, s45
    s_waitcnt vmcnt(16)
    v_perm_b32 v251, v63, v62, v11
    v_accvgpr_write_b32 a243, v5
    v_accvgpr_write_b32 a247, v6
    s_waitcnt vmcnt(14)
    v_perm_b32 v5, v65, v64, s44
    v_perm_b32 v6, v65, v64, s45
    s_waitcnt vmcnt(12)
    v_perm_b32 v252, v67, v66, v11
    v_accvgpr_write_b32 a248, v5
    v_accvgpr_write_b32 a252, v6
    s_waitcnt vmcnt(10)
    v_perm_b32 v5, v69, v68, s44
    v_perm_b32 v6, v69, v68, s45
    s_waitcnt vmcnt(8)
    v_perm_b32 v253, v71, v70, v11
    v_accvgpr_write_b32 a249, v5
    v_accvgpr_write_b32 a253, v6
    s_waitcnt vmcnt(6)
    v_perm_b32 v5, v73, v72, s44
    v_perm_b32 v6, v73, v72, s45
    s_waitcnt vmcnt(4)
    v_perm_b32 v254, v75, v74, v11
    v_accvgpr_write_b32 a250, v5
    v_accvgpr_write_b32 a254, v6
    s_waitcnt vmcnt(2)
    v_perm_b32 v5, v77, v76, s44
    v_perm_b32 v6, v77, v76, s45
    s_waitcnt vmcnt(0)
    v_perm_b32 v255, v79, v78, v11
    v_accvgpr_write_b32 a251, v5
    v_accvgpr_write_b32 a255, v6
    s_and_b32 s51, s14, 1
    s_lshl_b32 s17, s51, 4
    v_add_u32 v5, s17, v7
    v_lshlrev_b32 v14, 4, v5
    v_mul_u32_u24 v13, 1152, v5
    s_mul_i32 s17, s50, 96
    v_add_u32 v13, s17, v13
    s_mul_i32 s17, s50, 3072
    v_add_u32 v12, s17, v14
    s_lshl_b32 s17, s50, 9
    v_add_u32 v14, s17, v14
    s_lshl_b32 s49, s50, 7
    s_lshl_b32 s17, s14, 2
    s_add_u32 s49, s49, s17
    s_add_u32 s49, s49, 1441792
    s_mul_i32 s17, s14, 6144
    v_add_u32 v48, s17, v0
    v_mov_b32 v49, 0x10000
    s_mul_i32 s17, s50, 43
    v_lshrrev_b32 v10, 4, v0
    v_add_u32 v10, s17, v10
    v_min_u32 v10, 511, v10
    v_lshlrev_b32 v10, 7, v10
    s_cmp_gt_u32 s14, 1
    s_cbranch_scc1 Ltw_z
    v_lshl_add_u32 v12, v8, 9, v12
    v_lshl_add_u32 v13, v8, 4, v13
    s_lshl_b32 s58, s14, 16
    s_add_u32 s58, s58, 144703488
    s_mov_b32 s43, 0
    s_mov_b32 s28, s8
    s_mov_b32 s29, s9
    s_mov_b32 s30, 0
    s_mov_b32 s31, 0x00020000
    s_mul_i32 s17, s51, 3072
    v_add_u32 v50, s17, v0
    ds_write2_b32 v49, v4, v4 offset0:0 offset1:1
    s_waitcnt lgkmcnt(0)
    s_cmp_lg_u32 s14, 0
    s_cbranch_scc1 LtwX_inia_d
    v_mov_b32 v5, 40
    s_mov_b32 s16, 0
LtwX_inia:
    global_load_dword v6, v5, s[12:13] sc1
    s_add_u32 s16, s16, 1
    s_cmp_gt_u32 s16, 100000
    s_cbranch_scc1 L_role_tw_abort
    s_waitcnt vmcnt(0)
    v_cmp_gt_u32 vcc, 72, v6
    s_nop 0
    s_cbranch_vccz LtwX_inia_d
    s_sleep 8
    s_branch LtwX_inia
LtwX_inia_d:
    s_barrier
    s_cmp_lg_u32 s14, 0
    s_cbranch_scc1 LtwX_inib_d
    v_mov_b32 v5, 160
    s_mov_b32 s16, 0
LtwX_inib:
    global_load_dword v6, v5, s[12:13] sc1
    s_add_u32 s16, s16, 1
    s_cmp_gt_u32 s16, 100000
    s_cbranch_scc1 L_role_tw_abort
    s_waitcnt vmcnt(0)
    v_cmp_gt_u32 vcc, 64, v6
    s_nop 0
    s_cbranch_vccz LtwX_inib_d
    s_sleep 8
    s_branch LtwX_inib
LtwX_inib_d:
    s_barrier
LtwX_idle:
    s_cmp_lg_u32 s14, 0
    s_cbranch_scc1 LtwX_nw0
    s_mul_i32 s60, s32, 22528
    s_add_u32 s60, s60, 4224
    s_cmp_lt_u32 s32, 64
    s_cselect_b32 s60, s60, 2883584
    s_mul_i32 s61, s33, 22528
    s_add_u32 s61, s61, 1446016
    s_cmp_lt_u32 s33, 64
    s_cselect_b32 s61, s61, 2883584
    s_mov_b32 s16, 0
LtwX_p_9:
    buffer_load_dword v2, v1, s[8:11], s60 offen sc1
    buffer_load_dword v15, v1, s[8:11], s61 offen sc1
    s_add_u32 s16, s16, 1
    s_cmp_gt_u32 s16, 100000
    s_cbranch_scc1 L_role_tw_abort
    s_waitcnt vmcnt(1)
    v_cmp_eq_u32 vcc, 0, v2
    s_waitcnt vmcnt(0)
    v_cmp_eq_u32 s[54:55], 0, v15
    s_nop 0
    s_cmp_eq_u64 s[54:55], 0
    s_cselect_b32 s62, 2, 0
    s_cmp_eq_u64 vcc, 0
    s_cselect_b32 s62, 1, s62
    s_cmp_lg_u32 s62, 0
    s_cbranch_scc1 LtwX_p_9d
    s_sleep 4
    s_branch LtwX_p_9
LtwX_p_9d:
    v_mov_b32 v5, s62
    ds_write_b32 v49, v5
    s_waitcnt lgkmcnt(0)
LtwX_nw0:
    s_barrier
    ds_read_b32 v6, v49
    v_xor_b32 v49, 4, v49
    s_waitcnt lgkmcnt(0)
    v_readfirstlane_b32 s62, v6
    s_nop 0
    s_cmp_eq_u32 s62, 0
    s_cbranch_scc1 L_role_tw_abort
    s_cmp_lt_u32 s33, 29
    s_cselect_b32 s38, 1, 3
    s_cmp_eq_u32 s62, 2
    s_cselect_b32 s36, 1, 0
    s_cselect_b32 s37, s33, s32
    s_cselect_b32 s17, s38, 0
    s_add_u32 s33, s33, s17
    s_cmp_eq_u32 s62, 1
    s_cselect_b32 s17, 2, 0
    s_add_u32 s32, s32, s17
    s_lshl_b32 s56, s36, 6
    s_add_u32 s56, s56, s37
    s_lshl_b32 s46, s56, 18
    s_add_u32 s46, s46, s58
    s_mul_i32 s41, s36, 4718592
    s_mul_i32 s17, s37, 36864
    s_add_u32 s41, s41, s17
    s_add_u32 s41, s41, 8650752
    s_cmp_ge_u32 s37, 64
    s_cbranch_scc1 L_role_tw_abort
    buffer_load_dword v9, v10, s[8:11], s46 offen
    s_add_u32 s48, s46, 0
    buffer_load_dwordx4 v[64:67], v0, s[8:11], s48 offen offset:0
    buffer_load_dwordx4 v[68:71], v0, s[8:11], s48 offen offset:1024
    buffer_load_dwordx4 v[72:75], v0, s[8:11], s48 offen offset:2048
    buffer_load_dwordx4 v[76:79], v0, s[8:11], s48 offen offset:3072
    s_add_u32 s48, s46, 4096
    buffer_load_dwordx4 v[80:83], v0, s[8:11], s48 offen offset:0
    buffer_load_dwordx4 v[84:87], v0, s[8:11], s48 offen offset:1024
    buffer_load_dwordx4 v[88:91], v0, s[8:11], s48 offen offset:2048
    buffer_load_dwordx4 v[92:95], v0, s[8:11], s48 offen offset:3072
    s_add_u32 s48, s46, 8192
    buffer_load_dwordx4 v[96:99], v0, s[8:11], s48 offen offset:0
    buffer_load_dwordx4 v[100:103], v0, s[8:11], s48 offen offset:1024
    buffer_load_dwordx4 v[104:107], v0, s[8:11], s48 offen offset:2048
    buffer_load_dwordx4 v[108:111], v0, s[8:11], s48 offen offset:3072
    s_add_u32 s48, s46, 12288
    buffer_load_dwordx4 v[112:115], v0, s[8:11], s48 offen offset:0
    buffer_load_dwordx4 v[116:119], v0, s[8:11], s48 offen offset:1024
    buffer_load_dwordx4 v[120:123], v0, s[8:11], s48 offen offset:2048
    buffer_load_dwordx4 v[40:43], v12, s[8:11], s41 offen
LtwX_item:
    s_mov_b32 s34, s36
    s_mov_b32 s35, s37
    s_mov_b32 s47, s41
    buffer_load_dwordx4 v[124:127], v0, s[8:11], s48 offen offset:3072
    s_waitcnt vmcnt(15)
    v_mfma_f32_16x16x32_bf16 v[16:19], a[0:3], v[64:67], 0
    v_mfma_f32_16x16x32_bf16 v[20:23], a[4:7], v[64:67], 0
    v_mfma_f32_16x16x32_bf16 v[24:27], v[128:131], v[64:67], 0
    s_add_u32 s48, s46, 16384
    buffer_load_dwordx4 v[64:67], v0, s[8:11], s48 offen offset:0
    s_waitcnt vmcnt(15)
    v_mfma_f32_16x16x32_bf16 v[28:31], a[0:3], v[68:71], 0
    v_mfma_f32_16x16x32_bf16 v[32:35], a[4:7], v[68:71], 0
    v_mfma_f32_16x16x32_bf16 v[36:39], v[128:131], v[68:71], 0
    buffer_load_dwordx4 v[68:71], v0, s[8:11], s48 offen offset:1024
    s_waitcnt vmcnt(15)
    v_mfma_f32_16x16x32_bf16 v[16:19], a[8:11], v[72:75], v[16:19]
    v_mfma_f32_16x16x32_bf16 v[20:23], a[12:15], v[72:75], v[20:23]
    v_mfma_f32_16x16x32_bf16 v[24:27], v[132:135], v[72:75], v[24:27]
    buffer_load_dwordx4 v[72:75], v0, s[8:11], s48 offen offset:2048
    s_waitcnt vmcnt(15)
    v_mfma_f32_16x16x32_bf16 v[28:31], a[8:11], v[76:79], v[28:31]
    v_mfma_f32_16x16x32_bf16 v[32:35], a[12:15], v[76:79], v[32:35]
    v_mfma_f32_16x16x32_bf16 v[36:39], v[132:135], v[76:79], v[36:39]
    buffer_load_dwordx4 v[76:79], v0, s[8:11], s48 offen offset:3072
    s_waitcnt vmcnt(15)
    v_mfma_f32_16x16x32_bf16 v[16:19], a[16:19], v[80:83], v[16:19]
    v_mfma_f32_16x16x32_bf16 v[20:23], a[20:23], v[80:83], v[20:23]
    v_mfma_f32_16x16x32_bf16 v[24:27], v[136:139], v[80:83], v[24:27]
    s_add_u32 s48, s46, 20480
    buffer_load_dwordx4 v[80:83], v0, s[8:11], s48 offen offset:0
    s_waitcnt vmcnt(15)
    v_mfma_f32_16x16x32_bf16 v[28:31], a[16:19], v[84:87], v[28:31]
    v_mfma_f32_16x16x32_bf16 v[32:35], a[20:23], v[84:87], v[32:35]
    v_mfma_f32_16x16x32_bf16 v[36:39], v[136:139], v[84:87], v[36:39]
    buffer_load_dwordx4 v[84:87], v0, s[8:11], s48 offen offset:1024
    s_waitcnt vmcnt(15)
    v_mfma_f32_16x16x32_bf16 v[16:19], a[24:27], v[88:91], v[16:19]
    v_mfma_f32_16x16x32_bf16 v[20:23], a[28:31], v[88:91], v[20:23]
    v_mfma_f32_16x16x32_bf16 v[24:27], v[140:143], v[88:91], v[24:27]
    buffer_load_dwordx4 v[88:91], v0, s[8:11], s48 offen offset:2048
    s_waitcnt vmcnt(15)
    v_mfma_f32_16x16x32_bf16 v[28:31], a[24:27], v[92:95], v[28:31]
    v_mfma_f32_16x16x32_bf16 v[32:35], a[28:31], v[92:95], v[32:35]
    v_mfma_f32_16x16x32_bf16 v[36:39], v[140:143], v[92:95], v[36:39]
    buffer_load_dwordx4 v[92:95], v0, s[8:11], s48 offen offset:3072
    s_waitcnt vmcnt(15)
    v_mfma_f32_16x16x32_bf16 v[16:19], a[32:35], v[96:99], v[16:19]
    v_mfma_f32_16x16x32_bf16 v[20:23], a[36:39], v[96:99], v[20:23]
    v_mfma_f32_16x16x32_bf16 v[24:27], v[144:147], v[96:99], v[24:27]
    s_add_u32 s48, s46, 24576
    buffer_load_dwordx4 v[96:99], v0, s[8:11], s48 offen offset:0
    s_waitcnt vmcnt(15)
    v_mfma_f32_16x16x32_bf16 v[28:31], a[32:35], v[100:103], v[28:31]
    v_mfma_f32_16x16x32_bf16 v[32:35], a[36:39], v[100:103], v[32:35]
    v_mfma_f32_16x16x32_bf16 v[36:39], v[144:147], v[100:103], v[36:39]
    buffer_load_dwordx4 v[100:103], v0, s[8:11], s48 offen offset:1024
    s_waitcnt vmcnt(15)
    v_mfma_f32_16x16x32_bf16 v[16:19], a[40:43], v[104:107], v[16:19]
    v_mfma_f32_16x16x32_bf16 v[20:23], a[44:47], v[104:107], v[20:23]
    v_mfma_f32_16x16x32_bf16 v[24:27], v[148:151], v[104:107], v[24:27]
    buffer_load_dwordx4 v[104:107], v0, s[8:11], s48 offen offset:2048
    s_waitcnt vmcnt(15)
    v_mfma_f32_16x16x32_bf16 v[28:31], a[40:43], v[108:111], v[28:31]
    v_mfma_f32_16x16x32_bf16 v[32:35], a[44:47], v[108:111], v[32:35]
    v_mfma_f32_16x16x32_bf16 v[36:39], v[148:151], v[108:111], v[36:39]
    buffer_load_dwordx4 v[108:111], v0, s[8:11], s48 offen offset:3072
    s_waitcnt vmcnt(15)
    v_mfma_f32_16x16x32_bf16 v[16:19], a[48:51], v[112:115], v[16:19]
    v_mfma_f32_16x16x32_bf16 v[20:23], a[52:55], v[112:115], v[20:23]
    v_mfma_f32_16x16x32_bf16 v[24:27], v[152:155], v[112:115], v[24:27]
    s_add_u32 s48, s46, 28672
    buffer_load_dwordx4 v[112:115], v0, s[8:11], s48 offen offset:0
    s_waitcnt vmcnt(15)
    v_mfma_f32_16x16x32_bf16 v[28:31], a[48:51], v[116:119], v[28:31]
    v_mfma_f32_16x16x32_bf16 v[32:35], a[52:55], v[116:119], v[32:35]
    v_mfma_f32_16x16x32_bf16 v[36:39], v[152:155], v[116:119], v[36:39]
    buffer_load_dwordx4 v[116:119], v0, s[8:11], s48 offen offset:1024
    s_waitcnt vmcnt(15)
    v_mfma_f32_16x16x32_bf16 v[16:19], a[56:59], v[120:123], v[16:19]
    v_mfma_f32_16x16x32_bf16 v[20:23], a[60:63], v[120:123], v[20:23]
    v_mfma_f32_16x16x32_bf16 v[24:27], v[156:159], v[120:123], v[24:27]
    buffer_load_dwordx4 v[120:123], v0, s[8:11], s48 offen offset:2048
    s_waitcnt vmcnt(15)
    v_mfma_f32_16x16x32_bf16 v[28:31], a[56:59], v[124:127], v[28:31]
    v_mfma_f32_16x16x32_bf16 v[32:35], a[60:63], v[124:127], v[32:35]
    v_mfma_f32_16x16x32_bf16 v[36:39], v[156:159], v[124:127], v[36:39]
    buffer_load_dwordx4 v[124:127], v0, s[8:11], s48 offen offset:3072
    s_waitcnt vmcnt(15)
    v_mfma_f32_16x16x32_bf16 v[16:19], a[64:67], v[64:67], v[16:19]
    v_mfma_f32_16x16x32_bf16 v[20:23], a[68:71], v[64:67], v[20:23]
    v_mfma_f32_16x16x32_bf16 v[24:27], v[160:163], v[64:67], v[24:27]
    s_add_u32 s48, s46, 32768
    buffer_load_dwordx4 v[64:67], v0, s[8:11], s48 offen offset:0
    s_waitcnt vmcnt(15)
    v_mfma_f32_16x16x32_bf16 v[28:31], a[64:67], v[68:71], v[28:31]
    v_mfma_f32_16x16x32_bf16 v[32:35], a[68:71], v[68:71], v[32:35]
    v_mfma_f32_16x16x32_bf16 v[36:39], v[160:163], v[68:71], v[36:39]
    s_cmp_lg_u32 s43, 0
    s_cselect_b64 exec, 1, 0
    buffer_store_dword v3, v4, s[8:11], s43 offen sc1
    s_mov_b64 exec, -1
    s_mov_b32 s43, 0
    buffer_load_dwordx4 v[68:71], v0, s[8:11], s48 offen offset:1024
    s_waitcnt vmcnt(16)
    v_mfma_f32_16x16x32_bf16 v[16:19], a[72:75], v[72:75], v[16:19]
    v_mfma_f32_16x16x32_bf16 v[20:23], a[76:79], v[72:75], v[20:23]
    v_mfma_f32_16x16x32_bf16 v[24:27], v[164:167], v[72:75], v[24:27]
    buffer_load_dwordx4 v[72:75], v0, s[8:11], s48 offen offset:2048
    s_waitcnt vmcnt(16)
    v_mfma_f32_16x16x32_bf16 v[28:31], a[72:75], v[76:79], v[28:31]
    v_mfma_f32_16x16x32_bf16 v[32:35], a[76:79], v[76:79], v[32:35]
    v_mfma_f32_16x16x32_bf16 v[36:39], v[164:167], v[76:79], v[36:39]
    buffer_load_dwordx4 v[76:79], v0, s[8:11], s48 offen offset:3072
    s_waitcnt vmcnt(16)
    v_mfma_f32_16x16x32_bf16 v[16:19], a[80:83], v[80:83], v[16:19]
    v_mfma_f32_16x16x32_bf16 v[20:23], a[84:87], v[80:83], v[20:23]
    v_mfma_f32_16x16x32_bf16 v[24:27], v[168:171], v[80:83], v[24:27]
    s_add_u32 s48, s46, 36864
    buffer_load_dwordx4 v[80:83], v0, s[8:11], s48 offen offset:0
    s_waitcnt vmcnt(16)
    v_mfma_f32_16x16x32_bf16 v[28:31], a[80:83], v[84:87], v[28:31]
    v_mfma_f32_16x16x32_bf16 v[32:35], a[84:87], v[84:87], v[32:35]
    v_mfma_f32_16x16x32_bf16 v[36:39], v[168:171], v[84:87], v[36:39]
    buffer_load_dwordx4 v[84:87], v0, s[8:11], s48 offen offset:1024
    s_waitcnt vmcnt(16)
    v_mfma_f32_16x16x32_bf16 v[16:19], a[88:91], v[88:91], v[16:19]
    v_mfma_f32_16x16x32_bf16 v[20:23], a[92:95], v[88:91], v[20:23]
    v_mfma_f32_16x16x32_bf16 v[24:27], v[172:175], v[88:91], v[24:27]
    buffer_load_dwordx4 v[88:91], v0, s[8:11], s48 offen offset:2048
    s_waitcnt vmcnt(16)
    v_mfma_f32_16x16x32_bf16 v[28:31], a[88:91], v[92:95], v[28:31]
    v_mfma_f32_16x16x32_bf16 v[32:35], a[92:95], v[92:95], v[32:35]
    v_mfma_f32_16x16x32_bf16 v[36:39], v[172:175], v[92:95], v[36:39]
    buffer_load_dwordx4 v[92:95], v0, s[8:11], s48 offen offset:3072
    s_waitcnt vmcnt(16)
    v_mfma_f32_16x16x32_bf16 v[16:19], a[96:99], v[96:99], v[16:19]
    v_mfma_f32_16x16x32_bf16 v[20:23], a[100:103], v[96:99], v[20:23]
    v_mfma_f32_16x16x32_bf16 v[24:27], v[176:179], v[96:99], v[24:27]
    s_add_u32 s48, s46, 40960
    buffer_load_dwordx4 v[96:99], v0, s[8:11], s48 offen offset:0
    s_waitcnt vmcnt(16)
    v_mfma_f32_16x16x32_bf16 v[28:31], a[96:99], v[100:103], v[28:31]
    v_mfma_f32_16x16x32_bf16 v[32:35], a[100:103], v[100:103], v[32:35]
    v_mfma_f32_16x16x32_bf16 v[36:39], v[176:179], v[100:103], v[36:39]
    buffer_load_dwordx4 v[100:103], v0, s[8:11], s48 offen offset:1024
    s_waitcnt vmcnt(16)
    v_mfma_f32_16x16x32_bf16 v[16:19], a[104:107], v[104:107], v[16:19]
    v_mfma_f32_16x16x32_bf16 v[20:23], a[108:111], v[104:107], v[20:23]
    v_mfma_f32_16x16x32_bf16 v[24:27], v[180:183], v[104:107], v[24:27]
    s_cmp_lg_u32 s14, 0
    s_cbranch_scc1 LtwX_nw1
    s_mul_i32 s60, s32, 22528
    s_add_u32 s60, s60, 4224
    s_cmp_lt_u32 s32, 64
    s_cselect_b32 s60, s60, 2883584
    s_mul_i32 s61, s33, 22528
    s_add_u32 s61, s61, 1446016
    s_cmp_lt_u32 s33, 64
    s_cselect_b32 s61, s61, 2883584
    buffer_load_dword v2, v1, s[8:11], s60 offen sc1
    buffer_load_dword v15, v1, s[8:11], s61 offen sc1
LtwX_nw1:
    buffer_load_dwordx4 v[104:107], v0, s[8:11], s48 offen offset:2048
    s_waitcnt vmcnt(16)
    v_mfma_f32_16x16x32_bf16 v[28:31], a[104:107], v[108:111], v[28:31]
    v_mfma_f32_16x16x32_bf16 v[32:35], a[108:111], v[108:111], v[32:35]
    v_mfma_f32_16x16x32_bf16 v[36:39], v[180:183], v[108:111], v[36:39]
    buffer_load_dwordx4 v[108:111], v0, s[8:11], s48 offen offset:3072
    s_waitcnt vmcnt(16)
    v_mfma_f32_16x16x32_bf16 v[16:19], a[112:115], v[112:115], v[16:19]
    v_mfma_f32_16x16x32_bf16 v[20:23], a[116:119], v[112:115], v[20:23]
    v_mfma_f32_16x16x32_bf16 v[24:27], v[184:187], v[112:115], v[24:27]
    s_add_u32 s48, s46, 45056
    buffer_load_dwordx4 v[112:115], v0, s[8:11], s48 offen offset:0
    s_waitcnt vmcnt(16)
    v_mfma_f32_16x16x32_bf16 v[28:31], a[112:115], v[116:119], v[28:31]
    v_mfma_f32_16x16x32_bf16 v[32:35], a[116:119], v[116:119], v[32:35]
    v_mfma_f32_16x16x32_bf16 v[36:39], v[184:187], v[116:119], v[36:39]
    buffer_load_dwordx4 v[116:119], v0, s[8:11], s48 offen offset:1024
    s_waitcnt vmcnt(16)
    v_mfma_f32_16x16x32_bf16 v[16:19], a[120:123], v[120:123], v[16:19]
    v_mfma_f32_16x16x32_bf16 v[20:23], a[124:127], v[120:123], v[20:23]
    v_mfma_f32_16x16x32_bf16 v[24:27], v[188:191], v[120:123], v[24:27]
    buffer_load_dwordx4 v[120:123], v0, s[8:11], s48 offen offset:2048
    s_waitcnt vmcnt(16)
    v_mfma_f32_16x16x32_bf16 v[28:31], a[120:123], v[124:127], v[28:31]
    v_mfma_f32_16x16x32_bf16 v[32:35], a[124:127], v[124:127], v[32:35]
    v_mfma_f32_16x16x32_bf16 v[36:39], v[188:191], v[124:127], v[36:39]
    buffer_load_dwordx4 v[124:127], v0, s[8:11], s48 offen offset:3072
    s_waitcnt vmcnt(16)
    v_mfma_f32_16x16x32_bf16 v[16:19], a[128:131], v[64:67], v[16:19]
    v_mfma_f32_16x16x32_bf16 v[20:23], a[132:135], v[64:67], v[20:23]
    v_mfma_f32_16x16x32_bf16 v[24:27], v[192:195], v[64:67], v[24:27]
    s_add_u32 s48, s46, 49152
    buffer_load_dwordx4 v[64:67], v0, s[8:11], s48 offen offset:0
    s_waitcnt vmcnt(15)
    v_mfma_f32_16x16x32_bf16 v[28:31], a[128:131], v[68:71], v[28:31]
    v_mfma_f32_16x16x32_bf16 v[32:35], a[132:135], v[68:71], v[32:35]
    v_mfma_f32_16x16x32_bf16 v[36:39], v[192:195], v[68:71], v[36:39]
    buffer_load_dwordx4 v[68:71], v0, s[8:11], s48 offen offset:1024
    s_waitcnt vmcnt(15)
    v_mfma_f32_16x16x32_bf16 v[16:19], a[136:139], v[72:75], v[16:19]
    v_mfma_f32_16x16x32_bf16 v[20:23], a[140:143], v[72:75], v[20:23]
    v_mfma_f32_16x16x32_bf16 v[24:27], v[196:199], v[72:75], v[24:27]
    buffer_load_dwordx4 v[72:75], v0, s[8:11], s48 offen offset:2048
    s_waitcnt vmcnt(15)
    v_mfma_f32_16x16x32_bf16 v[28:31], a[136:139], v[76:79], v[28:31]
    v_mfma_f32_16x16x32_bf16 v[32:35], a[140:143], v[76:79], v[32:35]
    v_mfma_f32_16x16x32_bf16 v[36:39], v[196:199], v[76:79], v[36:39]
    buffer_load_dwordx4 v[76:79], v0, s[8:11], s48 offen offset:3072
    s_waitcnt vmcnt(15)
    v_mfma_f32_16x16x32_bf16 v[16:19], a[144:147], v[80:83], v[16:19]
    v_mfma_f32_16x16x32_bf16 v[20:23], a[148:151], v[80:83], v[20:23]
    v_mfma_f32_16x16x32_bf16 v[24:27], v[200:203], v[80:83], v[24:27]
    s_add_u32 s48, s46, 53248
    buffer_load_dwordx4 v[80:83], v0, s[8:11], s48 offen offset:0
    s_waitcnt vmcnt(15)
    v_mfma_f32_16x16x32_bf16 v[28:31], a[144:147], v[84:87], v[28:31]
    v_mfma_f32_16x16x32_bf16 v[32:35], a[148:151], v[84:87], v[32:35]
    v_mfma_f32_16x16x32_bf16 v[36:39], v[200:203], v[84:87], v[36:39]
    buffer_load_dwordx4 v[84:87], v0, s[8:11], s48 offen offset:1024
    s_waitcnt vmcnt(15)
    v_mfma_f32_16x16x32_bf16 v[16:19], a[152:155], v[88:91], v[16:19]
    v_mfma_f32_16x16x32_bf16 v[20:23], a[156:159], v[88:91], v[20:23]
    v_mfma_f32_16x16x32_bf16 v[24:27], v[204:207], v[88:91], v[24:27]
    buffer_load_dwordx4 v[88:91], v0, s[8:11], s48 offen offset:2048
    s_waitcnt vmcnt(15)
    v_mfma_f32_16x16x32_bf16 v[28:31], a[152:155], v[92:95], v[28:31]
    v_mfma_f32_16x16x32_bf16 v[32:35], a[156:159], v[92:95], v[32:35]
    v_mfma_f32_16x16x32_bf16 v[36:39], v[204:207], v[92:95], v[36:39]
    buffer_load_dwordx4 v[92:95], v0, s[8:11], s48 offen offset:3072
    s_waitcnt vmcnt(15)
    v_mfma_f32_16x16x32_bf16 v[16:19], a[160:163], v[96:99], v[16:19]
    v_mfma_f32_16x16x32_bf16 v[20:23], a[164:167], v[96:99], v[20:23]
    v_mfma_f32_16x16x32_bf16 v[24:27], v[208:211], v[96:99], v[24:27]
    s_add_u32 s48, s46, 57344
    buffer_load_dwordx4 v[96:99], v0, s[8:11], s48 offen offset:0
    s_waitcnt vmcnt(15)
    v_mfma_f32_16x16x32_bf16 v[28:31], a[160:163], v[100:103], v[28:31]
    v_mfma_f32_16x16x32_bf16 v[32:35], a[164:167], v[100:103], v[32:35]
    v_mfma_f32_16x16x32_bf16 v[36:39], v[208:211], v[100:103], v[36:39]
    buffer_load_dwordx4 v[100:103], v0, s[8:11], s48 offen offset:1024
    s_waitcnt vmcnt(15)
    v_mfma_f32_16x16x32_bf16 v[16:19], a[168:171], v[104:107], v[16:19]
    v_mfma_f32_16x16x32_bf16 v[20:23], a[172:175], v[104:107], v[20:23]
    v_mfma_f32_16x16x32_bf16 v[24:27], v[212:215], v[104:107], v[24:27]
    buffer_load_dwordx4 v[104:107], v0, s[8:11], s48 offen offset:2048
    s_waitcnt vmcnt(15)
    v_mfma_f32_16x16x32_bf16 v[28:31], a[168:171], v[108:111], v[28:31]
    v_mfma_f32_16x16x32_bf16 v[32:35], a[172:175], v[108:111], v[32:35]
    v_mfma_f32_16x16x32_bf16 v[36:39], v[212:215], v[108:111], v[36:39]
    buffer_load_dwordx4 v[108:111], v0, s[8:11], s48 offen offset:3072
    s_waitcnt vmcnt(15)
    v_mfma_f32_16x16x32_bf16 v[16:19], a[176:179], v[112:115], v[16:19]
    v_mfma_f32_16x16x32_bf16 v[20:23], a[180:183], v[112:115], v[20:23]
    v_mfma_f32_16x16x32_bf16 v[24:27], v[216:219], v[112:115], v[24:27]
    s_cmp_lg_u32 s14, 0
    s_cbranch_scc1 LtwX_nw2
    v_cmp_eq_u32 vcc, 0, v2
    v_cmp_eq_u32 s[54:55], 0, v15
    s_nop 0
    s_cmp_eq_u64 s[54:55], 0
    s_cselect_b32 s62, 2, 0
    s_cmp_eq_u64 vcc, 0
    s_cselect_b32 s62, 1, s62
    v_mov_b32 v5, s62
    ds_write_b32 v49, v5
    s_waitcnt lgkmcnt(0)
LtwX_nw2:
    s_barrier
    ds_read_b32 v6, v49
    v_xor_b32 v49, 4, v49
    s_add_u32 s48, s46, 61440
    buffer_load_dwordx4 v[112:115], v0, s[8:11], s48 offen offset:0
    s_waitcnt vmcnt(15)
    v_mfma_f32_16x16x32_bf16 v[28:31], a[176:179], v[116:119], v[28:31]
    v_mfma_f32_16x16x32_bf16 v[32:35], a[180:183], v[116:119], v[32:35]
    v_mfma_f32_16x16x32_bf16 v[36:39], v[216:219], v[116:119], v[36:39]
    buffer_load_dwordx4 v[116:119], v0, s[8:11], s48 offen offset:1024
    s_waitcnt vmcnt(15)
    v_mfma_f32_16x16x32_bf16 v[16:19], a[184:187], v[120:123], v[16:19]
    v_mfma_f32_16x16x32_bf16 v[20:23], a[188:191], v[120:123], v[20:23]
    v_mfma_f32_16x16x32_bf16 v[24:27], v[220:223], v[120:123], v[24:27]
    buffer_load_dwordx4 v[120:123], v0, s[8:11], s48 offen offset:2048
    s_waitcnt vmcnt(15)
    v_mfma_f32_16x16x32_bf16 v[28:31], a[184:187], v[124:127], v[28:31]
    v_mfma_f32_16x16x32_bf16 v[32:35], a[188:191], v[124:127], v[32:35]
    v_mfma_f32_16x16x32_bf16 v[36:39], v[220:223], v[124:127], v[36:39]
    s_waitcnt lgkmcnt(0)
    v_readfirstlane_b32 s62, v6
    s_cmp_lt_u32 s33, 29
    s_cselect_b32 s38, 1, 3
    s_cmp_eq_u32 s62, 2
    s_cselect_b32 s36, 1, 0
    s_cselect_b32 s37, s33, s32
    s_cselect_b32 s17, s38, 0
    s_add_u32 s33, s33, s17
    s_cmp_eq_u32 s62, 1
    s_cselect_b32 s17, 2, 0
    s_add_u32 s32, s32, s17
    s_lshl_b32 s56, s36, 6
    s_add_u32 s56, s56, s37
    buffer_load_dwordx4 v[124:127], v0, s[8:11], s48 offen offset:3072
    s_waitcnt vmcnt(15)
    v_mfma_f32_16x16x32_bf16 v[16:19], a[192:195], v[64:67], v[16:19]
    v_mfma_f32_16x16x32_bf16 v[20:23], a[196:199], v[64:67], v[20:23]
    v_mfma_f32_16x16x32_bf16 v[24:27], v[224:227], v[64:67], v[24:27]
    s_cmp_lt_u32 s37, 64
    s_cselect_b32 s62, s62, 0
    s_lshl_b32 s46, s56, 18
    s_add_u32 s46, s46, s58
    s_mul_i32 s41, s36, 4718592
    s_mul_i32 s17, s37, 36864
    s_add_u32 s41, s41, s17
    s_add_u32 s41, s41, 8650752
    s_cmp_lg_u32 s62, 0
    s_cselect_b32 s30, 268435456, 0
    buffer_load_dword v9, v10, s[28:31], s46 offen
    s_add_u32 s48, s46, 0
    buffer_load_dwordx4 v[64:67], v0, s[28:31], s48 offen offset:0
    s_waitcnt vmcnt(16)
    v_mfma_f32_16x16x32_bf16 v[28:31], a[192:195], v[68:71], v[28:31]
    v_mfma_f32_16x16x32_bf16 v[32:35], a[196:199], v[68:71], v[32:35]
    v_mfma_f32_16x16x32_bf16 v[36:39], v[224:227], v[68:71], v[36:39]
    buffer_load_dwordx4 v[68:71], v0, s[28:31], s48 offen offset:1024
    s_waitcnt vmcnt(16)
    v_mfma_f32_16x16x32_bf16 v[16:19], a[200:203], v[72:75], v[16:19]
    v_mfma_f32_16x16x32_bf16 v[20:23], a[204:207], v[72:75], v[20:23]
    v_mfma_f32_16x16x32_bf16 v[24:27], v[228:231], v[72:75], v[24:27]
    buffer_load_dwordx4 v[72:75], v0, s[28:31], s48 offen offset:2048
    s_waitcnt vmcnt(16)
    v_mfma_f32_16x16x32_bf16 v[28:31], a[200:203], v[76:79], v[28:31]
    v_mfma_f32_16x16x32_bf16 v[32:35], a[204:207], v[76:79], v[32:35]
    v_mfma_f32_16x16x32_bf16 v[36:39], v[228:231], v[76:79], v[36:39]
    buffer_load_dwordx4 v[76:79], v0, s[28:31], s48 offen offset:3072
    s_waitcnt vmcnt(16)
    v_mfma_f32_16x16x32_bf16 v[16:19], a[208:211], v[80:83], v[16:19]
    v_mfma_f32_16x16x32_bf16 v[20:23], a[212:215], v[80:83], v[20:23]
    v_mfma_f32_16x16x32_bf16 v[24:27], v[232:235], v[80:83], v[24:27]
    s_add_u32 s48, s46, 4096
    buffer_load_dwordx4 v[80:83], v0, s[28:31], s48 offen offset:0
    s_waitcnt vmcnt(16)
    v_mfma_f32_16x16x32_bf16 v[28:31], a[208:211], v[84:87], v[28:31]
    v_mfma_f32_16x16x32_bf16 v[32:35], a[212:215], v[84:87], v[32:35]
    v_mfma_f32_16x16x32_bf16 v[36:39], v[232:235], v[84:87], v[36:39]
    buffer_load_dwordx4 v[84:87], v0, s[28:31], s48 offen offset:1024
    s_waitcnt vmcnt(16)
    v_mfma_f32_16x16x32_bf16 v[16:19], a[216:219], v[88:91], v[16:19]
    v_mfma_f32_16x16x32_bf16 v[20:23], a[220:223], v[88:91], v[20:23]
    v_mfma_f32_16x16x32_bf16 v[24:27], v[236:239], v[88:91], v[24:27]
    buffer_load_dwordx4 v[88:91], v0, s[28:31], s48 offen offset:2048
    s_waitcnt vmcnt(16)
    v_mfma_f32_16x16x32_bf16 v[28:31], a[216:219], v[92:95], v[28:31]
    v_mfma_f32_16x16x32_bf16 v[32:35], a[220:223], v[92:95], v[32:35]
    v_mfma_f32_16x16x32_bf16 v[36:39], v[236:239], v[92:95], v[36:39]
    buffer_load_dwordx4 v[92:95], v0, s[28:31], s48 offen offset:3072
    s_waitcnt vmcnt(16)
    v_mfma_f32_16x16x32_bf16 v[16:19], a[224:227], v[96:99], v[16:19]
    v_mfma_f32_16x16x32_bf16 v[20:23], a[228:231], v[96:99], v[20:23]
    v_mfma_f32_16x16x32_bf16 v[24:27], v[240:243], v[96:99], v[24:27]
    s_add_u32 s48, s46, 8192
    buffer_load_dwordx4 v[96:99], v0, s[28:31], s48 offen offset:0
    s_waitcnt vmcnt(16)
    v_mfma_f32_16x16x32_bf16 v[28:31], a[224:227], v[100:103], v[28:31]
    v_mfma_f32_16x16x32_bf16 v[32:35], a[228:231], v[100:103], v[32:35]
    v_mfma_f32_16x16x32_bf16 v[36:39], v[240:243], v[100:103], v[36:39]
    buffer_load_dwordx4 v[100:103], v0, s[28:31], s48 offen offset:1024
    s_waitcnt vmcnt(16)
    v_mfma_f32_16x16x32_bf16 v[16:19], a[232:235], v[104:107], v[16:19]
    v_mfma_f32_16x16x32_bf16 v[20:23], a[236:239], v[104:107], v[20:23]
    v_mfma_f32_16x16x32_bf16 v[24:27], v[244:247], v[104:107], v[24:27]
    buffer_load_dwordx4 v[104:107], v0, s[28:31], s48 offen offset:2048
    s_waitcnt vmcnt(16)
    v_mfma_f32_16x16x32_bf16 v[28:31], a[232:235], v[108:111], v[28:31]
    v_mfma_f32_16x16x32_bf16 v[32:35], a[236:239], v[108:111], v[32:35]
    v_mfma_f32_16x16x32_bf16 v[36:39], v[244:247], v[108:111], v[36:39]
    buffer_load_dwordx4 v[108:111], v0, s[28:31], s48 offen offset:3072
    s_waitcnt vmcnt(16)
    v_mfma_f32_16x16x32_bf16 v[16:19], a[240:243], v[112:115], v[16:19]
    v_mfma_f32_16x16x32_bf16 v[20:23], a[244:247], v[112:115], v[20:23]
    v_mfma_f32_16x16x32_bf16 v[24:27], v[248:251], v[112:115], v[24:27]
    s_add_u32 s48, s46, 12288
    buffer_load_dwordx4 v[112:115], v0, s[28:31], s48 offen offset:0
    s_waitcnt vmcnt(16)
    v_mfma_f32_16x16x32_bf16 v[28:31], a[240:243], v[116:119], v[28:31]
    v_mfma_f32_16x16x32_bf16 v[32:35], a[244:247], v[116:119], v[32:35]
    v_mfma_f32_16x16x32_bf16 v[36:39], v[248:251], v[116:119], v[36:39]
    buffer_load_dwordx4 v[116:119], v0, s[28:31], s48 offen offset:1024
    s_waitcnt vmcnt(16)
    v_mfma_f32_16x16x32_bf16 v[16:19], a[248:251], v[120:123], v[16:19]
    v_mfma_f32_16x16x32_bf16 v[20:23], a[252:255], v[120:123], v[20:23]
    v_mfma_f32_16x16x32_bf16 v[24:27], v[252:255], v[120:123], v[24:27]
    buffer_load_dwordx4 v[120:123], v0, s[28:31], s48 offen offset:2048
    s_waitcnt vmcnt(16)
    v_mfma_f32_16x16x32_bf16 v[28:31], a[248:251], v[124:127], v[28:31]
    v_mfma_f32_16x16x32_bf16 v[32:35], a[252:255], v[124:127], v[32:35]
    v_mfma_f32_16x16x32_bf16 v[36:39], v[252:255], v[124:127], v[36:39]
    s_nop 5
    ds_write_b128 v48, v[16:19] offset:0
    ds_write_b128 v48, v[20:23] offset:1024
    ds_write_b128 v48, v[24:27] offset:2048
    ds_write_b128 v48, v[28:31] offset:3072
    ds_write_b128 v48, v[32:35] offset:4096
    ds_write_b128 v48, v[36:39] offset:5120
    s_waitcnt lgkmcnt(0)
    s_barrier
    ds_read_b128 v[24:27], v50 offset:0
    ds_read_b128 v[28:31], v50 offset:1024
    ds_read_b128 v[32:35], v50 offset:6144
    ds_read_b128 v[36:39], v50 offset:7168
    ds_read_b128 v[56:59], v50 offset:12288
    ds_read_b128 v[60:63], v50 offset:13312
    ds_read_b128 v[124:127], v50 offset:18432
    ds_read_b128 v[52:55], v50 offset:19456
    v_xor_b32 v48, 0x8000, v48
    v_xor_b32 v50, 0x8000, v50
    v_lshlrev_b32 v16, 16, v40
    v_and_b32 v20, 0xffff0000, v40
    v_lshlrev_b32 v17, 16, v41
    v_and_b32 v21, 0xffff0000, v41
    v_lshlrev_b32 v18, 16, v42
    v_and_b32 v22, 0xffff0000, v42
    v_lshlrev_b32 v19, 16, v43
    v_and_b32 v23, 0xffff0000, v43
    buffer_load_dwordx4 v[40:43], v12, s[28:31], s41 offen
    s_waitcnt lgkmcnt(7)
    v_add_f32 v16, v16, v24
    v_add_f32 v17, v17, v25
    v_add_f32 v18, v18, v26
    v_add_f32 v19, v19, v27
    s_waitcnt lgkmcnt(6)
    v_add_f32 v20, v20, v28
    v_add_f32 v21, v21, v29
    v_add_f32 v22, v22, v30
    v_add_f32 v23, v23, v31
    s_waitcnt lgkmcnt(5)
    v_add_f32 v16, v16, v32
    v_add_f32 v17, v17, v33
    v_add_f32 v18, v18, v34
    v_add_f32 v19, v19, v35
    s_waitcnt lgkmcnt(4)
    v_add_f32 v20, v20, v36
    v_add_f32 v21, v21, v37
    v_add_f32 v22, v22, v38
    v_add_f32 v23, v23, v39
    s_waitcnt lgkmcnt(3)
    v_add_f32 v16, v16, v56
    v_add_f32 v17, v17, v57
    v_add_f32 v18, v18, v58
    v_add_f32 v19, v19, v59
    s_waitcnt lgkmcnt(2)
    v_add_f32 v20, v20, v60
    v_add_f32 v21, v21, v61
    v_add_f32 v22, v22, v62
    v_add_f32 v23, v23, v63
    s_waitcnt lgkmcnt(1)
    v_add_f32 v16, v16, v124
    v_add_f32 v17, v17, v125
    v_add_f32 v18, v18, v126
    v_add_f32 v19, v19, v127
    s_waitcnt lgkmcnt(0)
    v_add_f32 v20, v20, v52
    v_add_f32 v21, v21, v53
    v_add_f32 v22, v22, v54
    v_add_f32 v23, v23, v55
    v_cvt_pk_bf16_f32 v52, v16, v20
    v_cvt_pk_bf16_f32 v53, v17, v21
    v_cvt_pk_bf16_f32 v54, v18, v22
    v_cvt_pk_bf16_f32 v55, v19, v23
    s_cmp_eq_u32 s34, 0
    s_cbranch_scc1 LtwX_l0
    s_mul_i32 s17, s35, 36864
    buffer_store_dwordx4 v[52:55], v13, s[24:27], s17 offen sc1
    s_cmp_lg_u32 s62, 0
    s_cbranch_scc1 LtwX_item
LtwX_chk:
    s_min_u32 s17, s32, s33
    s_cmp_lt_u32 s17, 64
    s_cbranch_scc1 LtwX_idle
    s_branch L_role_tw_exit
LtwX_l0:
    s_add_u32 s47, s47, 2359296
    buffer_store_dwordx4 v[52:55], v12, s[8:11], s47 offen sc1
    v_add_f32 v44, v16, v17
    v_mul_f32 v45, v16, v16
    v_fmac_f32 v45, v17, v17
    v_add_f32 v44, v44, v18
    v_fmac_f32 v45, v18, v18
    v_add_f32 v44, v44, v19
    v_fmac_f32 v45, v19, v19
    v_add_f32 v44, v44, v20
    v_fmac_f32 v45, v20, v20
    v_add_f32 v44, v44, v21
    v_fmac_f32 v45, v21, v21
    v_add_f32 v44, v44, v22
    v_fmac_f32 v45, v22, v22
    v_add_f32 v44, v44, v23
    v_fmac_f32 v45, v23, v23
    v_mov_b32 v46, v44
    v_mov_b32 v47, v45
    s_nop 0
    v_permlane32_swap_b32 v44, v46
    v_permlane32_swap_b32 v45, v47
    v_add_f32 v44, v44, v46
    v_add_f32 v45, v45, v47
    v_mov_b32 v46, v44
    v_mov_b32 v47, v45
    s_nop 0
    v_permlane16_swap_b32 v44, v46
    v_permlane16_swap_b32 v45, v47
    v_add_f32 v44, v44, v46
    v_add_f32 v45, v45, v47
    s_mul_i32 s17, s35, 6144
    s_add_u32 s17, s17, 16515072
    s_mov_b64 exec, 0xffff
    buffer_store_dwordx2 v[44:45], v14, s[8:11], s17 offen sc1
    s_mov_b64 exec, -1
    s_mul_i32 s43, s35, 22528
    s_add_u32 s43, s43, s49
    s_cmp_lg_u32 s62, 0
    s_cbranch_scc1 LtwX_item
    s_waitcnt vmcnt(0)
    s_mov_b64 exec, 1
    buffer_store_dword v3, v4, s[8:11], s43 offen sc1
    s_mov_b64 exec, -1
    s_mov_b32 s43, 0
    s_branch LtwX_chk
Ltw_z:
    v_lshrrev_b32 v5, 1, v8
    v_lshl_add_u32 v12, v5, 9, v12
    v_and_b32 v5, 1, v8
    v_lshl_add_u32 v12, v5, 3, v12
    v_add_u32 v12, 2048, v12
    v_lshl_add_u32 v13, v8, 3, v13
    v_add_u32 v13, 64, v13
    v_add_u32 v14, 8, v14
    s_lshl_b32 s58, s14, 16
    s_add_u32 s58, s58, 144703488
    s_mov_b32 s43, 0
    s_mov_b32 s28, s8
    s_mov_b32 s29, s9
    s_mov_b32 s30, 0
    s_mov_b32 s31, 0x00020000
    s_mul_i32 s17, s51, 3072
    v_add_u32 v50, s17, v0
    ds_write2_b32 v49, v4, v4 offset0:0 offset1:1
    s_waitcnt lgkmcnt(0)
    s_cmp_lg_u32 s14, 0
    s_cbranch_scc1 LtwZ_inia_d
    v_mov_b32 v5, 40
    s_mov_b32 s16, 0
LtwZ_inia:
    global_load_dword v6, v5, s[12:13] sc1
    s_add_u32 s16, s16, 1
    s_cmp_gt_u32 s16, 100000
    s_cbranch_scc1 L_role_tw_abort
    s_waitcnt vmcnt(0)
    v_cmp_gt_u32 vcc, 72, v6
    s_nop 0
    s_cbranch_vccz LtwZ_inia_d
    s_sleep 8
    s_branch LtwZ_inia
LtwZ_inia_d:
    s_barrier
    s_cmp_lg_u32 s14, 0
    s_cbranch_scc1 LtwZ_inib_d
    v_mov_b32 v5, 160
    s_mov_b32 s16, 0
LtwZ_inib:
    global_load_dword v6, v5, s[12:13] sc1
    s_add_u32 s16, s16, 1
    s_cmp_gt_u32 s16, 100000
    s_cbranch_scc1 L_role_tw_abort
    s_waitcnt vmcnt(0)
    v_cmp_gt_u32 vcc, 64, v6
    s_nop 0
    s_cbranch_vccz LtwZ_inib_d
    s_sleep 8
    s_branch LtwZ_inib
LtwZ_inib_d:
    s_barrier
LtwZ_idle:
    s_barrier
    ds_read_b32 v6, v49
    v_xor_b32 v49, 4, v49
    s_waitcnt lgkmcnt(0)
    v_readfirstlane_b32 s62, v6
    s_nop 0
    s_cmp_eq_u32 s62, 0
    s_cbranch_scc1 L_role_tw_abort
    s_cmp_lt_u32 s33, 29
    s_cselect_b32 s38, 1, 3
    s_cmp_eq_u32 s62, 2
    s_cselect_b32 s36, 1, 0
    s_cselect_b32 s37, s33, s32
    s_cselect_b32 s17, s38, 0
    s_add_u32 s33, s33, s17
    s_cmp_eq_u32 s62, 1
    s_cselect_b32 s17, 2, 0
    s_add_u32 s32, s32, s17
    s_lshl_b32 s56, s36, 6
    s_add_u32 s56, s56, s37
    s_lshl_b32 s46, s56, 18
    s_add_u32 s46, s46, s58
    s_mul_i32 s41, s36, 4718592
    s_mul_i32 s17, s37, 36864
    s_add_u32 s41, s41, s17
    s_add_u32 s41, s41, 8650752
    s_cmp_ge_u32 s37, 64
    s_cbranch_scc1 L_role_tw_abort
    buffer_load_dword v9, v10, s[8:11], s46 offen
    s_add_u32 s48, s46, 0
    buffer_load_dwordx4 v[64:67], v0, s[8:11], s48 offen offset:0
    buffer_load_dwordx4 v[68:71], v0, s[8:11], s48 offen offset:1024
    buffer_load_dwordx4 v[72:75], v0, s[8:11], s48 offen offset:2048
    buffer_load_dwordx4 v[76:79], v0, s[8:11], s48 offen offset:3072
    s_add_u32 s48, s46, 4096
    buffer_load_dwordx4 v[80:83], v0, s[8:11], s48 offen offset:0
    buffer_load_dwordx4 v[84:87], v0, s[8:11], s48 offen offset:1024
    buffer_load_dwordx4 v[88:91], v0, s[8:11], s48 offen offset:2048
    buffer_load_dwordx4 v[92:95], v0, s[8:11], s48 offen offset:3072
    s_add_u32 s48, s46, 8192
    buffer_load_dwordx4 v[96:99], v0, s[8:11], s48 offen offset:0
    buffer_load_dwordx4 v[100:103], v0, s[8:11], s48 offen offset:1024
    buffer_load_dwordx4 v[104:107], v0, s[8:11], s48 offen offset:2048
    buffer_load_dwordx4 v[108:111], v0, s[8:11], s48 offen offset:3072
    s_add_u32 s48, s46, 12288
    buffer_load_dwordx4 v[112:115], v0, s[8:11], s48 offen offset:0
    buffer_load_dwordx4 v[116:119], v0, s[8:11], s48 offen offset:1024
    buffer_load_dwordx4 v[120:123], v0, s[8:11], s48 offen offset:2048
    buffer_load_dwordx2 v[40:41], v12, s[8:11], s41 offen
LtwZ_item:
    s_mov_b32 s34, s36
    s_mov_b32 s35, s37
    s_mov_b32 s47, s41
    buffer_load_dwordx4 v[124:127], v0, s[8:11], s48 offen offset:3072
    s_waitcnt vmcnt(15)
    v_mfma_f32_16x16x32_bf16 v[16:19], a[0:3], v[64:67], 0
    v_mfma_f32_16x16x32_bf16 v[20:23], a[4:7], v[64:67], 0
    v_mfma_f32_16x16x32_bf16 v[24:27], v[128:131], v[64:67], 0
    s_add_u32 s48, s46, 16384
    buffer_load_dwordx4 v[64:67], v0, s[8:11], s48 offen offset:0
    s_waitcnt vmcnt(15)
    v_mfma_f32_16x16x32_bf16 v[28:31], a[0:3], v[68:71], 0
    v_mfma_f32_16x16x32_bf16 v[32:35], a[4:7], v[68:71], 0
    v_mfma_f32_16x16x32_bf16 v[36:39], v[128:131], v[68:71], 0
    buffer_load_dwordx4 v[68:71], v0, s[8:11], s48 offen offset:1024
    s_waitcnt vmcnt(15)
    v_mfma_f32_16x16x32_bf16 v[16:19], a[8:11], v[72:75], v[16:19]
    v_mfma_f32_16x16x32_bf16 v[20:23], a[12:15], v[72:75], v[20:23]
    v_mfma_f32_16x16x32_bf16 v[24:27], v[132:135], v[72:75], v[24:27]
    buffer_load_dwordx4 v[72:75], v0, s[8:11], s48 offen offset:2048
    s_waitcnt vmcnt(15)
    v_mfma_f32_16x16x32_bf16 v[28:31], a[8:11], v[76:79], v[28:31]
    v_mfma_f32_16x16x32_bf16 v[32:35], a[12:15], v[76:79], v[32:35]
    v_mfma_f32_16x16x32_bf16 v[36:39], v[132:135], v[76:79], v[36:39]
    buffer_load_dwordx4 v[76:79], v0, s[8:11], s48 offen offset:3072
    s_waitcnt vmcnt(15)
    v_mfma_f32_16x16x32_bf16 v[16:19], a[16:19], v[80:83], v[16:19]
    v_mfma_f32_16x16x32_bf16 v[20:23], a[20:23], v[80:83], v[20:23]
    v_mfma_f32_16x16x32_bf16 v[24:27], v[136:139], v[80:83], v[24:27]
    s_add_u32 s48, s46, 20480
    buffer_load_dwordx4 v[80:83], v0, s[8:11], s48 offen offset:0
    s_waitcnt vmcnt(15)
    v_mfma_f32_16x16x32_bf16 v[28:31], a[16:19], v[84:87], v[28:31]
    v_mfma_f32_16x16x32_bf16 v[32:35], a[20:23], v[84:87], v[32:35]
    v_mfma_f32_16x16x32_bf16 v[36:39], v[136:139], v[84:87], v[36:39]
    buffer_load_dwordx4 v[84:87], v0, s[8:11], s48 offen offset:1024
    s_waitcnt vmcnt(15)
    v_mfma_f32_16x16x32_bf16 v[16:19], a[24:27], v[88:91], v[16:19]
    v_mfma_f32_16x16x32_bf16 v[20:23], a[28:31], v[88:91], v[20:23]
    v_mfma_f32_16x16x32_bf16 v[24:27], v[140:143], v[88:91], v[24:27]
    buffer_load_dwordx4 v[88:91], v0, s[8:11], s48 offen offset:2048
    s_waitcnt vmcnt(15)
    v_mfma_f32_16x16x32_bf16 v[28:31], a[24:27], v[92:95], v[28:31]
    v_mfma_f32_16x16x32_bf16 v[32:35], a[28:31], v[92:95], v[32:35]
    v_mfma_f32_16x16x32_bf16 v[36:39], v[140:143], v[92:95], v[36:39]
    buffer_load_dwordx4 v[92:95], v0, s[8:11], s48 offen offset:3072
    s_waitcnt vmcnt(15)
    v_mfma_f32_16x16x32_bf16 v[16:19], a[32:35], v[96:99], v[16:19]
    v_mfma_f32_16x16x32_bf16 v[20:23], a[36:39], v[96:99], v[20:23]
    v_mfma_f32_16x16x32_bf16 v[24:27], v[144:147], v[96:99], v[24:27]
    s_add_u32 s48, s46, 24576
    buffer_load_dwordx4 v[96:99], v0, s[8:11], s48 offen offset:0
    s_waitcnt vmcnt(15)
    v_mfma_f32_16x16x32_bf16 v[28:31], a[32:35], v[100:103], v[28:31]
    v_mfma_f32_16x16x32_bf16 v[32:35], a[36:39], v[100:103], v[32:35]
    v_mfma_f32_16x16x32_bf16 v[36:39], v[144:147], v[100:103], v[36:39]
    buffer_load_dwordx4 v[100:103], v0, s[8:11], s48 offen offset:1024
    s_waitcnt vmcnt(15)
    v_mfma_f32_16x16x32_bf16 v[16:19], a[40:43], v[104:107], v[16:19]
    v_mfma_f32_16x16x32_bf16 v[20:23], a[44:47], v[104:107], v[20:23]
    v_mfma_f32_16x16x32_bf16 v[24:27], v[148:151], v[104:107], v[24:27]
    buffer_load_dwordx4 v[104:107], v0, s[8:11], s48 offen offset:2048
    s_waitcnt vmcnt(15)
    v_mfma_f32_16x16x32_bf16 v[28:31], a[40:43], v[108:111], v[28:31]
    v_mfma_f32_16x16x32_bf16 v[32:35], a[44:47], v[108:111], v[32:35]
    v_mfma_f32_16x16x32_bf16 v[36:39], v[148:151], v[108:111], v[36:39]
    buffer_load_dwordx4 v[108:111], v0, s[8:11], s48 offen offset:3072
    s_waitcnt vmcnt(15)
    v_mfma_f32_16x16x32_bf16 v[16:19], a[48:51], v[112:115], v[16:19]
    v_mfma_f32_16x16x32_bf16 v[20:23], a[52:55], v[112:115], v[20:23]
    v_mfma_f32_16x16x32_bf16 v[24:27], v[152:155], v[112:115], v[24:27]
    s_add_u32 s48, s46, 28672
    buffer_load_dwordx4 v[112:115], v0, s[8:11], s48 offen offset:0
    s_waitcnt vmcnt(15)
    v_mfma_f32_16x16x32_bf16 v[28:31], a[48:51], v[116:119], v[28:31]
    v_mfma_f32_16x16x32_bf16 v[32:35], a[52:55], v[116:119], v[32:35]
    v_mfma_f32_16x16x32_bf16 v[36:39], v[152:155], v[116:119], v[36:39]
    buffer_load_dwordx4 v[116:119], v0, s[8:11], s48 offen offset:1024
    s_waitcnt vmcnt(15)
    v_mfma_f32_16x16x32_bf16 v[16:19], a[56:59], v[120:123], v[16:19]
    v_mfma_f32_16x16x32_bf16 v[20:23], a[60:63], v[120:123], v[20:23]
    v_mfma_f32_16x16x32_bf16 v[24:27], v[156:159], v[120:123], v[24:27]
    buffer_load_dwordx4 v[120:123], v0, s[8:11], s48 offen offset:2048
    s_waitcnt vmcnt(15)
    v_mfma_f32_16x16x32_bf16 v[28:31], a[56:59], v[124:127], v[28:31]
    v_mfma_f32_16x16x32_bf16 v[32:35], a[60:63], v[124:127], v[32:35]
    v_mfma_f32_16x16x32_bf16 v[36:39], v[156:159], v[124:127], v[36:39]
    buffer_load_dwordx4 v[124:127], v0, s[8:11], s48 offen offset:3072
    s_waitcnt vmcnt(15)
    v_mfma_f32_16x16x32_bf16 v[16:19], a[64:67], v[64:67], v[16:19]
    v_mfma_f32_16x16x32_bf16 v[20:23], a[68:71], v[64:67], v[20:23]
    v_mfma_f32_16x16x32_bf16 v[24:27], v[160:163], v[64:67], v[24:27]
    s_add_u32 s48, s46, 32768
    buffer_load_dwordx4 v[64:67], v0, s[8:11], s48 offen offset:0
    s_waitcnt vmcnt(15)
    v_mfma_f32_16x16x32_bf16 v[28:31], a[64:67], v[68:71], v[28:31]
    v_mfma_f32_16x16x32_bf16 v[32:35], a[68:71], v[68:71], v[32:35]
    v_mfma_f32_16x16x32_bf16 v[36:39], v[160:163], v[68:71], v[36:39]
    s_cmp_lg_u32 s43, 0
    s_cselect_b64 exec, 1, 0
    buffer_store_dword v3, v4, s[8:11], s43 offen sc1
    s_mov_b64 exec, -1
    s_mov_b32 s43, 0
    buffer_load_dwordx4 v[68:71], v0, s[8:11], s48 offen offset:1024
    s_waitcnt vmcnt(16)
    v_mfma_f32_16x16x32_bf16 v[16:19], a[72:75], v[72:75], v[16:19]
    v_mfma_f32_16x16x32_bf16 v[20:23], a[76:79], v[72:75], v[20:23]
    v_mfma_f32_16x16x32_bf16 v[24:27], v[164:167], v[72:75], v[24:27]
    buffer_load_dwordx4 v[72:75], v0, s[8:11], s48 offen offset:2048
    s_waitcnt vmcnt(16)
    v_mfma_f32_16x16x32_bf16 v[28:31], a[72:75], v[76:79], v[28:31]
    v_mfma_f32_16x16x32_bf16 v[32:35], a[76:79], v[76:79], v[32:35]
    v_mfma_f32_16x16x32_bf16 v[36:39], v[164:167], v[76:79], v[36:39]
    buffer_load_dwordx4 v[76:79], v0, s[8:11], s48 offen offset:3072
    s_waitcnt vmcnt(16)
    v_mfma_f32_16x16x32_bf16 v[16:19], a[80:83], v[80:83], v[16:19]
    v_mfma_f32_16x16x32_bf16 v[20:23], a[84:87], v[80:83], v[20:23]
    v_mfma_f32_16x16x32_bf16 v[24:27], v[168:171], v[80:83], v[24:27]
    s_add_u32 s48, s46, 36864
    buffer_load_dwordx4 v[80:83], v0, s[8:11], s48 offen offset:0
    s_waitcnt vmcnt(16)
    v_mfma_f32_16x16x32_bf16 v[28:31], a[80:83], v[84:87], v[28:31]
    v_mfma_f32_16x16x32_bf16 v[32:35], a[84:87], v[84:87], v[32:35]
    v_mfma_f32_16x16x32_bf16 v[36:39], v[168:171], v[84:87], v[36:39]
    buffer_load_dwordx4 v[84:87], v0, s[8:11], s48 offen offset:1024
    s_waitcnt vmcnt(16)
    v_mfma_f32_16x16x32_bf16 v[16:19], a[88:91], v[88:91], v[16:19]
    v_mfma_f32_16x16x32_bf16 v[20:23], a[92:95], v[88:91], v[20:23]
    v_mfma_f32_16x16x32_bf16 v[24:27], v[172:175], v[88:91], v[24:27]
    buffer_load_dwordx4 v[88:91], v0, s[8:11], s48 offen offset:2048
    s_waitcnt vmcnt(16)
    v_mfma_f32_16x16x32_bf16 v[28:31], a[88:91], v[92:95], v[28:31]
    v_mfma_f32_16x16x32_bf16 v[32:35], a[92:95], v[92:95], v[32:35]
    v_mfma_f32_16x16x32_bf16 v[36:39], v[172:175], v[92:95], v[36:39]
    buffer_load_dwordx4 v[92:95], v0, s[8:11], s48 offen offset:3072
    s_waitcnt vmcnt(16)
    v_mfma_f32_16x16x32_bf16 v[16:19], a[96:99], v[96:99], v[16:19]
    v_mfma_f32_16x16x32_bf16 v[20:23], a[100:103], v[96:99], v[20:23]
    v_mfma_f32_16x16x32_bf16 v[24:27], v[176:179], v[96:99], v[24:27]
    s_add_u32 s48, s46, 40960
    buffer_load_dwordx4 v[96:99], v0, s[8:11], s48 offen offset:0
    s_waitcnt vmcnt(16)
    v_mfma_f32_16x16x32_bf16 v[28:31], a[96:99], v[100:103], v[28:31]
    v_mfma_f32_16x16x32_bf16 v[32:35], a[100:103], v[100:103], v[32:35]
    v_mfma_f32_16x16x32_bf16 v[36:39], v[176:179], v[100:103], v[36:39]
    buffer_load_dwordx4 v[100:103], v0, s[8:11], s48 offen offset:1024
    s_waitcnt vmcnt(16)
    v_mfma_f32_16x16x32_bf16 v[16:19], a[104:107], v[104:107], v[16:19]
    v_mfma_f32_16x16x32_bf16 v[20:23], a[108:111], v[104:107], v[20:23]
    v_mfma_f32_16x16x32_bf16 v[24:27], v[180:183], v[104:107], v[24:27]
    buffer_load_dwordx4 v[104:107], v0, s[8:11], s48 offen offset:2048
    s_waitcnt vmcnt(16)
    v_mfma_f32_16x16x32_bf16 v[28:31], a[104:107], v[108:111], v[28:31]
    v_mfma_f32_16x16x32_bf16 v[32:35], a[108:111], v[108:111], v[32:35]
    v_mfma_f32_16x16x32_bf16 v[36:39], v[180:183], v[108:111], v[36:39]
    buffer_load_dwordx4 v[108:111], v0, s[8:11], s48 offen offset:3072
    s_waitcnt vmcnt(16)
    v_mfma_f32_16x16x32_bf16 v[16:19], a[112:115], v[112:115], v[16:19]
    v_mfma_f32_16x16x32_bf16 v[20:23], a[116:119], v[112:115], v[20:23]
    v_mfma_f32_16x16x32_bf16 v[24:27], v[184:187], v[112:115], v[24:27]
    s_add_u32 s48, s46, 45056
    buffer_load_dwordx4 v[112:115], v0, s[8:11], s48 offen offset:0
    s_waitcnt vmcnt(16)
    v_mfma_f32_16x16x32_bf16 v[28:31], a[112:115], v[116:119], v[28:31]
    v_mfma_f32_16x16x32_bf16 v[32:35], a[116:119], v[116:119], v[32:35]
    v_mfma_f32_16x16x32_bf16 v[36:39], v[184:187], v[116:119], v[36:39]
    buffer_load_dwordx4 v[116:119], v0, s[8:11], s48 offen offset:1024
    s_waitcnt vmcnt(16)
    v_mfma_f32_16x16x32_bf16 v[16:19], a[120:123], v[120:123], v[16:19]
    v_mfma_f32_16x16x32_bf16 v[20:23], a[124:127], v[120:123], v[20:23]
    v_mfma_f32_16x16x32_bf16 v[24:27], v[188:191], v[120:123], v[24:27]
    buffer_load_dwordx4 v[120:123], v0, s[8:11], s48 offen offset:2048
    s_waitcnt vmcnt(16)
    v_mfma_f32_16x16x32_bf16 v[28:31], a[120:123], v[124:127], v[28:31]
    v_mfma_f32_16x16x32_bf16 v[32:35], a[124:127], v[124:127], v[32:35]
    v_mfma_f32_16x16x32_bf16 v[36:39], v[188:191], v[124:127], v[36:39]
    buffer_load_dwordx4 v[124:127], v0, s[8:11], s48 offen offset:3072
    s_waitcnt vmcnt(16)
    v_mfma_f32_16x16x32_bf16 v[16:19], a[128:131], v[64:67], v[16:19]
    v_mfma_f32_16x16x32_bf16 v[20:23], a[132:135], v[64:67], v[20:23]
    v_mfma_f32_16x16x32_bf16 v[24:27], v[192:195], v[64:67], v[24:27]
    s_add_u32 s48, s46, 49152
    buffer_load_dwordx4 v[64:67], v0, s[8:11], s48 offen offset:0
    s_waitcnt vmcnt(15)
    v_mfma_f32_16x16x32_bf16 v[28:31], a[128:131], v[68:71], v[28:31]
    v_mfma_f32_16x16x32_bf16 v[32:35], a[132:135], v[68:71], v[32:35]
    v_mfma_f32_16x16x32_bf16 v[36:39], v[192:195], v[68:71], v[36:39]
    buffer_load_dwordx4 v[68:71], v0, s[8:11], s48 offen offset:1024
    s_waitcnt vmcnt(15)
    v_mfma_f32_16x16x32_bf16 v[16:19], a[136:139], v[72:75], v[16:19]
    v_mfma_f32_16x16x32_bf16 v[20:23], a[140:143], v[72:75], v[20:23]
    v_mfma_f32_16x16x32_bf16 v[24:27], v[196:199], v[72:75], v[24:27]
    buffer_load_dwordx4 v[72:75], v0, s[8:11], s48 offen offset:2048
    s_waitcnt vmcnt(15)
    v_mfma_f32_16x16x32_bf16 v[28:31], a[136:139], v[76:79], v[28:31]
    v_mfma_f32_16x16x32_bf16 v[32:35], a[140:143], v[76:79], v[32:35]
    v_mfma_f32_16x16x32_bf16 v[36:39], v[196:199], v[76:79], v[36:39]
    buffer_load_dwordx4 v[76:79], v0, s[8:11], s48 offen offset:3072
    s_waitcnt vmcnt(15)
    v_mfma_f32_16x16x32_bf16 v[16:19], a[144:147], v[80:83], v[16:19]
    v_mfma_f32_16x16x32_bf16 v[20:23], a[148:151], v[80:83], v[20:23]
    v_mfma_f32_16x16x32_bf16 v[24:27], v[200:203], v[80:83], v[24:27]
    s_add_u32 s48, s46, 53248
    buffer_load_dwordx4 v[80:83], v0, s[8:11], s48 offen offset:0
    s_waitcnt vmcnt(15)
    v_mfma_f32_16x16x32_bf16 v[28:31], a[144:147], v[84:87], v[28:31]
    v_mfma_f32_16x16x32_bf16 v[32:35], a[148:151], v[84:87], v[32:35]
    v_mfma_f32_16x16x32_bf16 v[36:39], v[200:203], v[84:87], v[36:39]
    buffer_load_dwordx4 v[84:87], v0, s[8:11], s48 offen offset:1024
    s_waitcnt vmcnt(15)
    v_mfma_f32_16x16x32_bf16 v[16:19], a[152:155], v[88:91], v[16:19]
    v_mfma_f32_16x16x32_bf16 v[20:23], a[156:159], v[88:91], v[20:23]
    v_mfma_f32_16x16x32_bf16 v[24:27], v[204:207], v[88:91], v[24:27]
    buffer_load_dwordx4 v[88:91], v0, s[8:11], s48 offen offset:2048
    s_waitcnt vmcnt(15)
    v_mfma_f32_16x16x32_bf16 v[28:31], a[152:155], v[92:95], v[28:31]
    v_mfma_f32_16x16x32_bf16 v[32:35], a[156:159], v[92:95], v[32:35]
    v_mfma_f32_16x16x32_bf16 v[36:39], v[204:207], v[92:95], v[36:39]
    buffer_load_dwordx4 v[92:95], v0, s[8:11], s48 offen offset:3072
    s_waitcnt vmcnt(15)
    v_mfma_f32_16x16x32_bf16 v[16:19], a[160:163], v[96:99], v[16:19]
    v_mfma_f32_16x16x32_bf16 v[20:23], a[164:167], v[96:99], v[20:23]
    v_mfma_f32_16x16x32_bf16 v[24:27], v[208:211], v[96:99], v[24:27]
    s_add_u32 s48, s46, 57344
    buffer_load_dwordx4 v[96:99], v0, s[8:11], s48 offen offset:0
    s_waitcnt vmcnt(15)
    v_mfma_f32_16x16x32_bf16 v[28:31], a[160:163], v[100:103], v[28:31]
    v_mfma_f32_16x16x32_bf16 v[32:35], a[164:167], v[100:103], v[32:35]
    v_mfma_f32_16x16x32_bf16 v[36:39], v[208:211], v[100:103], v[36:39]
    buffer_load_dwordx4 v[100:103], v0, s[8:11], s48 offen offset:1024
    s_waitcnt vmcnt(15)
    v_mfma_f32_16x16x32_bf16 v[16:19], a[168:171], v[104:107], v[16:19]
    v_mfma_f32_16x16x32_bf16 v[20:23], a[172:175], v[104:107], v[20:23]
    v_mfma_f32_16x16x32_bf16 v[24:27], v[212:215], v[104:107], v[24:27]
    buffer_load_dwordx4 v[104:107], v0, s[8:11], s48 offen offset:2048
    s_waitcnt vmcnt(15)
    v_mfma_f32_16x16x32_bf16 v[28:31], a[168:171], v[108:111], v[28:31]
    v_mfma_f32_16x16x32_bf16 v[32:35], a[172:175], v[108:111], v[32:35]
    v_mfma_f32_16x16x32_bf16 v[36:39], v[212:215], v[108:111], v[36:39]
    buffer_load_dwordx4 v[108:111], v0, s[8:11], s48 offen offset:3072
    s_waitcnt vmcnt(15)
    v_mfma_f32_16x16x32_bf16 v[16:19], a[176:179], v[112:115], v[16:19]
    v_mfma_f32_16x16x32_bf16 v[20:23], a[180:183], v[112:115], v[20:23]
    v_mfma_f32_16x16x32_bf16 v[24:27], v[216:219], v[112:115], v[24:27]
    s_barrier
    ds_read_b32 v6, v49
    v_xor_b32 v49, 4, v49
    s_add_u32 s48, s46, 61440
    buffer_load_dwordx4 v[112:115], v0, s[8:11], s48 offen offset:0
    s_waitcnt vmcnt(15)
    v_mfma_f32_16x16x32_bf16 v[28:31], a[176:179], v[116:119], v[28:31]
    v_mfma_f32_16x16x32_bf16 v[32:35], a[180:183], v[116:119], v[32:35]
    v_mfma_f32_16x16x32_bf16 v[36:39], v[216:219], v[116:119], v[36:39]
    buffer_load_dwordx4 v[116:119], v0, s[8:11], s48 offen offset:1024
    s_waitcnt vmcnt(15)
    v_mfma_f32_16x16x32_bf16 v[16:19], a[184:187], v[120:123], v[16:19]
    v_mfma_f32_16x16x32_bf16 v[20:23], a[188:191], v[120:123], v[20:23]
    v_mfma_f32_16x16x32_bf16 v[24:27], v[220:223], v[120:123], v[24:27]
    buffer_load_dwordx4 v[120:123], v0, s[8:11], s48 offen offset:2048
    s_waitcnt vmcnt(15)
    v_mfma_f32_16x16x32_bf16 v[28:31], a[184:187], v[124:127], v[28:31]
    v_mfma_f32_16x16x32_bf16 v[32:35], a[188:191], v[124:127], v[32:35]
    v_mfma_f32_16x16x32_bf16 v[36:39], v[220:223], v[124:127], v[36:39]
    s_waitcnt lgkmcnt(0)
    v_readfirstlane_b32 s62, v6
    s_cmp_lt_u32 s33, 29
    s_cselect_b32 s38, 1, 3
    s_cmp_eq_u32 s62, 2
    s_cselect_b32 s36, 1, 0
    s_cselect_b32 s37, s33, s32
    s_cselect_b32 s17, s38, 0
    s_add_u32 s33, s33, s17
    s_cmp_eq_u32 s62, 1
    s_cselect_b32 s17, 2, 0
    s_add_u32 s32, s32, s17
    s_lshl_b32 s56, s36, 6
    s_add_u32 s56, s56, s37
    buffer_load_dwordx4 v[124:127], v0, s[8:11], s48 offen offset:3072
    s_waitcnt vmcnt(15)
    v_mfma_f32_16x16x32_bf16 v[16:19], a[192:195], v[64:67], v[16:19]
    v_mfma_f32_16x16x32_bf16 v[20:23], a[196:199], v[64:67], v[20:23]
    v_mfma_f32_16x16x32_bf16 v[24:27], v[224:227], v[64:67], v[24:27]
    s_cmp_lt_u32 s37, 64
    s_cselect_b32 s62, s62, 0
    s_lshl_b32 s46, s56, 18
    s_add_u32 s46, s46, s58
    s_mul_i32 s41, s36, 4718592
    s_mul_i32 s17, s37, 36864
    s_add_u32 s41, s41, s17
    s_add_u32 s41, s41, 8650752
    s_cmp_lg_u32 s62, 0
    s_cselect_b32 s30, 268435456, 0
    buffer_load_dword v9, v10, s[28:31], s46 offen
    s_add_u32 s48, s46, 0
    buffer_load_dwordx4 v[64:67], v0, s[28:31], s48 offen offset:0
    s_waitcnt vmcnt(16)
    v_mfma_f32_16x16x32_bf16 v[28:31], a[192:195], v[68:71], v[28:31]
    v_mfma_f32_16x16x32_bf16 v[32:35], a[196:199], v[68:71], v[32:35]
    v_mfma_f32_16x16x32_bf16 v[36:39], v[224:227], v[68:71], v[36:39]
    buffer_load_dwordx4 v[68:71], v0, s[28:31], s48 offen offset:1024
    s_waitcnt vmcnt(16)
    v_mfma_f32_16x16x32_bf16 v[16:19], a[200:203], v[72:75], v[16:19]
    v_mfma_f32_16x16x32_bf16 v[20:23], a[204:207], v[72:75], v[20:23]
    v_mfma_f32_16x16x32_bf16 v[24:27], v[228:231], v[72:75], v[24:27]
    buffer_load_dwordx4 v[72:75], v0, s[28:31], s48 offen offset:2048
    s_waitcnt vmcnt(16)
    v_mfma_f32_16x16x32_bf16 v[28:31], a[200:203], v[76:79], v[28:31]
    v_mfma_f32_16x16x32_bf16 v[32:35], a[204:207], v[76:79], v[32:35]
    v_mfma_f32_16x16x32_bf16 v[36:39], v[228:231], v[76:79], v[36:39]
    buffer_load_dwordx4 v[76:79], v0, s[28:31], s48 offen offset:3072
    s_waitcnt vmcnt(16)
    v_mfma_f32_16x16x32_bf16 v[16:19], a[208:211], v[80:83], v[16:19]
    v_mfma_f32_16x16x32_bf16 v[20:23], a[212:215], v[80:83], v[20:23]
    v_mfma_f32_16x16x32_bf16 v[24:27], v[232:235], v[80:83], v[24:27]
    s_add_u32 s48, s46, 4096
    buffer_load_dwordx4 v[80:83], v0, s[28:31], s48 offen offset:0
    s_waitcnt vmcnt(16)
    v_mfma_f32_16x16x32_bf16 v[28:31], a[208:211], v[84:87], v[28:31]
    v_mfma_f32_16x16x32_bf16 v[32:35], a[212:215], v[84:87], v[32:35]
    v_mfma_f32_16x16x32_bf16 v[36:39], v[232:235], v[84:87], v[36:39]
    buffer_load_dwordx4 v[84:87], v0, s[28:31], s48 offen offset:1024
    s_waitcnt vmcnt(16)
    v_mfma_f32_16x16x32_bf16 v[16:19], a[216:219], v[88:91], v[16:19]
    v_mfma_f32_16x16x32_bf16 v[20:23], a[220:223], v[88:91], v[20:23]
    v_mfma_f32_16x16x32_bf16 v[24:27], v[236:239], v[88:91], v[24:27]
    buffer_load_dwordx4 v[88:91], v0, s[28:31], s48 offen offset:2048
    s_waitcnt vmcnt(16)
    v_mfma_f32_16x16x32_bf16 v[28:31], a[216:219], v[92:95], v[28:31]
    v_mfma_f32_16x16x32_bf16 v[32:35], a[220:223], v[92:95], v[32:35]
    v_mfma_f32_16x16x32_bf16 v[36:39], v[236:239], v[92:95], v[36:39]
    buffer_load_dwordx4 v[92:95], v0, s[28:31], s48 offen offset:3072
    s_waitcnt vmcnt(16)
    v_mfma_f32_16x16x32_bf16 v[16:19], a[224:227], v[96:99], v[16:19]
    v_mfma_f32_16x16x32_bf16 v[20:23], a[228:231], v[96:99], v[20:23]
    v_mfma_f32_16x16x32_bf16 v[24:27], v[240:243], v[96:99], v[24:27]
    s_add_u32 s48, s46, 8192
    buffer_load_dwordx4 v[96:99], v0, s[28:31], s48 offen offset:0
    s_waitcnt vmcnt(16)
    v_mfma_f32_16x16x32_bf16 v[28:31], a[224:227], v[100:103], v[28:31]
    v_mfma_f32_16x16x32_bf16 v[32:35], a[228:231], v[100:103], v[32:35]
    v_mfma_f32_16x16x32_bf16 v[36:39], v[240:243], v[100:103], v[36:39]
    buffer_load_dwordx4 v[100:103], v0, s[28:31], s48 offen offset:1024
    s_waitcnt vmcnt(16)
    v_mfma_f32_16x16x32_bf16 v[16:19], a[232:235], v[104:107], v[16:19]
    v_mfma_f32_16x16x32_bf16 v[20:23], a[236:239], v[104:107], v[20:23]
    v_mfma_f32_16x16x32_bf16 v[24:27], v[244:247], v[104:107], v[24:27]
    buffer_load_dwordx4 v[104:107], v0, s[28:31], s48 offen offset:2048
    s_waitcnt vmcnt(16)
    v_mfma_f32_16x16x32_bf16 v[28:31], a[232:235], v[108:111], v[28:31]
    v_mfma_f32_16x16x32_bf16 v[32:35], a[236:239], v[108:111], v[32:35]
    v_mfma_f32_16x16x32_bf16 v[36:39], v[244:247], v[108:111], v[36:39]
    buffer_load_dwordx4 v[108:111], v0, s[28:31], s48 offen offset:3072
    s_waitcnt vmcnt(16)
    v_mfma_f32_16x16x32_bf16 v[16:19], a[240:243], v[112:115], v[16:19]
    v_mfma_f32_16x16x32_bf16 v[20:23], a[244:247], v[112:115], v[20:23]
    v_mfma_f32_16x16x32_bf16 v[24:27], v[248:251], v[112:115], v[24:27]
    s_add_u32 s48, s46, 12288
    buffer_load_dwordx4 v[112:115], v0, s[28:31], s48 offen offset:0
    s_waitcnt vmcnt(16)
    v_mfma_f32_16x16x32_bf16 v[28:31], a[240:243], v[116:119], v[28:31]
    v_mfma_f32_16x16x32_bf16 v[32:35], a[244:247], v[116:119], v[32:35]
    v_mfma_f32_16x16x32_bf16 v[36:39], v[248:251], v[116:119], v[36:39]
    buffer_load_dwordx4 v[116:119], v0, s[28:31], s48 offen offset:1024
    s_waitcnt vmcnt(16)
    v_mfma_f32_16x16x32_bf16 v[16:19], a[248:251], v[120:123], v[16:19]
    v_mfma_f32_16x16x32_bf16 v[20:23], a[252:255], v[120:123], v[20:23]
    v_mfma_f32_16x16x32_bf16 v[24:27], v[252:255], v[120:123], v[24:27]
    buffer_load_dwordx4 v[120:123], v0, s[28:31], s48 offen offset:2048
    s_waitcnt vmcnt(16)
    v_mfma_f32_16x16x32_bf16 v[28:31], a[248:251], v[124:127], v[28:31]
    v_mfma_f32_16x16x32_bf16 v[32:35], a[252:255], v[124:127], v[32:35]
    v_mfma_f32_16x16x32_bf16 v[36:39], v[252:255], v[124:127], v[36:39]
    s_nop 5
    ds_write_b128 v48, v[16:19] offset:0
    ds_write_b128 v48, v[20:23] offset:1024
    ds_write_b128 v48, v[24:27] offset:2048
    ds_write_b128 v48, v[28:31] offset:3072
    ds_write_b128 v48, v[32:35] offset:4096
    ds_write_b128 v48, v[36:39] offset:5120
    s_waitcnt lgkmcnt(0)
    s_barrier
    ds_read_b128 v[24:27], v50 offset:2048
    ds_read_b128 v[28:31], v50 offset:8192
    ds_read_b128 v[32:35], v50 offset:14336
    ds_read_b128 v[36:39], v50 offset:20480
    v_xor_b32 v48, 0x8000, v48
    v_xor_b32 v50, 0x8000, v50
    v_lshlrev_b32 v16, 16, v40
    v_and_b32 v17, 0xffff0000, v40
    v_lshlrev_b32 v18, 16, v41
    v_and_b32 v19, 0xffff0000, v41
    buffer_load_dwordx2 v[40:41], v12, s[28:31], s41 offen
    s_waitcnt lgkmcnt(3)
    v_add_f32 v16, v16, v24
    v_add_f32 v17, v17, v25
    v_add_f32 v18, v18, v26
    v_add_f32 v19, v19, v27
    s_waitcnt lgkmcnt(2)
    v_add_f32 v16, v16, v28
    v_add_f32 v17, v17, v29
    v_add_f32 v18, v18, v30
    v_add_f32 v19, v19, v31
    s_waitcnt lgkmcnt(1)
    v_add_f32 v16, v16, v32
    v_add_f32 v17, v17, v33
    v_add_f32 v18, v18, v34
    v_add_f32 v19, v19, v35
    s_waitcnt lgkmcnt(0)
    v_add_f32 v16, v16, v36
    v_add_f32 v17, v17, v37
    v_add_f32 v18, v18, v38
    v_add_f32 v19, v19, v39
    v_cvt_pk_bf16_f32 v52, v16, v17
    v_cvt_pk_bf16_f32 v53, v18, v19
    s_cmp_eq_u32 s34, 0
    s_cbranch_scc1 LtwZ_l0
    s_mul_i32 s17, s35, 36864
    buffer_store_dwordx2 v[52:53], v13, s[24:27], s17 offen sc1
    s_cmp_lg_u32 s62, 0
    s_cbranch_scc1 LtwZ_item
LtwZ_chk:
    s_min_u32 s17, s32, s33
    s_cmp_lt_u32 s17, 64
    s_cbranch_scc1 LtwZ_idle
    s_branch L_role_tw_exit
LtwZ_l0:
    s_add_u32 s47, s47, 2359296
    buffer_store_dwordx2 v[52:53], v12, s[8:11], s47 offen sc1
    v_add_f32 v44, v16, v17
    v_mul_f32 v45, v16, v16
    v_fmac_f32 v45, v17, v17
    v_add_f32 v44, v44, v18
    v_fmac_f32 v45, v18, v18
    v_add_f32 v44, v44, v19
    v_fmac_f32 v45, v19, v19
    v_mov_b32 v46, v44
    v_mov_b32 v47, v45
    s_nop 0
    v_permlane32_swap_b32 v44, v46
    v_permlane32_swap_b32 v45, v47
    v_add_f32 v44, v44, v46
    v_add_f32 v45, v45, v47
    v_mov_b32 v46, v44
    v_mov_b32 v47, v45
    s_nop 0
    v_permlane16_swap_b32 v44, v46
    v_permlane16_swap_b32 v45, v47
    v_add_f32 v44, v44, v46
    v_add_f32 v45, v45, v47
    s_mul_i32 s17, s35, 6144
    s_add_u32 s17, s17, 16515072
    s_mov_b64 exec, 0xffff
    buffer_store_dwordx2 v[44:45], v14, s[8:11], s17 offen sc1
    s_mov_b64 exec, -1
    s_mul_i32 s43, s35, 22528
    s_add_u32 s43, s43, s49
    s_cmp_lg_u32 s62, 0
    s_cbranch_scc1 LtwZ_item
    s_waitcnt vmcnt(0)
    s_mov_b64 exec, 1
    buffer_store_dword v3, v4, s[8:11], s43 offen sc1
    s_mov_b64 exec, -1
    s_mov_b32 s43, 0
    s_branch LtwZ_chk
L_role_tw_abort:
    s_waitcnt lgkmcnt(0)
    s_mov_b64 exec, -1
    v_mov_b32 v0, 60
    s_lshl_b32 s5, s3, 8
    s_or_b32 s5, s5, s4
    s_or_b32 s5, s5, 0x10000
    v_mov_b32 v1, s5
    global_store_dword v0, v1, s[12:13]
    s_endpgm
L_role_tw_exit:
    s_endpgm
.p2align 6
L_role_r:
    s_mov_b32 s32, s3
    s_mov_b32 s15, s4
    v_and_b32 v60, 63, v0
    v_and_b32 v61, 15, v60
    v_lshrrev_b32 v62, 4, v60
    v_lshlrev_b32 v0, 4, v60
    s_mul_i32 s17, s14, 34816
    s_add_u32 s17, s17, 23296
    v_add_u32 v8, s17, v0
    s_mov_b32 s50, 0xfffffffe
    s_mov_b32 s44, 0x3e0293ee
    s_mov_b32 s45, 0x3e0293ee
    s_mov_b32 s52, 0x3f803f80
    s_mov_b32 s53, 0x3f803f80
    s_mov_b32 s40, 1
    s_mov_b32 s46, 0x00ff00ff
    s_cmp_eq_u32 s14, 2
    s_cselect_b32 s46, 0x00030003, s46
    s_mov_b32 s47, s46
    v_bfe_u32 v63, v61, 1, 1
    v_mov_b32 v1, 0x4444
    v_mov_b32 v64, 0xeeee
    v_cmp_eq_u32 vcc, 0, v63
    s_nop 1
    v_cndmask_b32 v1, v64, v1, vcc
    v_mul_u32_u24 v64, 1152, v62
    v_lshl_add_u32 v2, v61, 2, v64
    s_lshl_b32 s17, s14, 6
    s_add_u32 s18, s17, 0
    v_add_u32 v2, s18, v2
    v_mul_u32_u24 v64, 288, v61
    v_lshl_add_u32 v3, v62, 4, v64
    v_add_u32 v3, 0, v3
    v_lshrrev_b32 v64, 2, v61
    v_and_b32 v65, 1, v61
    v_lshl_add_u32 v64, v64, 1, v65
    v_mul_u32_u24 v65, 288, v64
    v_lshl_add_u32 v4, v62, 5, v65
    v_lshl_add_u32 v4, v63, 4, v4
    v_add_u32 v4, 4608, v4
    v_xor_b32 v63, 1, v63
    v_mul_u32_u24 v63, 2304, v63
    v_add_u32 v5, v65, v63
    v_lshl_add_u32 v5, v62, 4, v5
    s_add_u32 s18, s17, 4608
    v_add_u32 v5, s18, v5
    s_lshr_b32 s70, s15, 3
    s_bfe_u32 s71, s15, 0x20001
    s_and_b32 s72, s15, 1
    v_bfe_u32 v64, v61, 2, 1
    v_lshl_add_u32 v63, v64, 2, v62
    v_mul_u32_u24 v63, 9216, v63
    v_lshrrev_b32 v65, 3, v61
    v_lshlrev_b32 v65, 2, v65
    v_and_b32 v64, 3, v61
    v_add_u32 v65, v65, v64
    s_lshl_b32 s73, s71, 4
    s_lshl_b32 s17, s72, 3
    s_add_u32 s73, s73, s17
    v_add_u32 v65, s73, v65
    s_lshl_b32 s17, s70, 6
    v_add_u32 v65, s17, v65
    s_cmp_eq_u32 s14, 2
    s_cselect_b32 s17, 2, 4
    v_lshlrev_b32 v65, s17, v65
    v_add_u32 v6, v63, v65
    s_lshl_b32 s17, s14, 12
    v_add_u32 v6, s17, v6
    v_lshrrev_b32 v66, 1, v61
    s_lshl_b32 s17, s14, 2
    v_add_u32 v66, s17, v66
    v_and_b32 v64, 1, v61
    s_lshl_b32 s17, s70, 4
    s_lshl_b32 s18, s71, 2
    s_add_u32 s17, s17, s18
    s_lshl_b32 s18, s72, 1
    s_add_u32 s17, s17, s18
    v_add_u32 v65, s17, v64
    v_lshl_add_u32 v65, v66, 6, v65
    v_lshlrev_b32 v65, 4, v65
    v_lshl_add_u32 v7, v62, 2, v65
    s_lshl_b32 s17, s71, 1
    v_add_u32 v64, s17, v64
    v_mul_u32_u24 v64, 576, v64
    v_lshl_add_u32 v64, v66, 4, v64
    v_lshl_add_u32 v64, v62, 1, v64
    s_mul_i32 s17, s70, 144
    s_lshl_b32 s18, s72, 3
    s_add_u32 s17, s17, s18
    v_add_u32 v64, s17, v64
    v_lshlrev_b32 v67, 1, v64
    s_mul_i32 s48, s32, 1048576
    s_add_u32 s48, s48, 4194304
    s_mul_i32 s17, s15, 9216
    s_add_u32 s17, s17, s48
    s_lshl_b32 s18, s14, 10
    s_add_u32 s38, s17, s18
    s_lshl_b32 s19, s14, 8
    s_add_u32 s39, s17, s19
    s_add_u32 s39, s39, 8192
    s_add_u32 s37, s48, 983040
    s_xor_b32 s36, s37, 16384
    s_add_u32 s34, s37, s18
    s_add_u32 s35, s37, 8192
    s_mul_i32 s17, s32, 50331648
    s_lshl_b32 s19, s15, 13
    s_add_u32 s17, s17, s19
    s_add_u32 s68, s17, 77594624
    s_lshl_b32 s18, s14, 11
    s_add_u32 s17, s17, s18
    s_add_u32 s41, s17, 60817408
    s_add_u32 s42, s17, 77594624
    s_mul_i32 s17, s32, 8388608
    s_lshl_b32 s19, s15, 12
    s_add_u32 s17, s17, s19
    s_add_u32 s43, s17, 27262976
    s_mul_i32 s17, s32, 1441792
    s_lshl_b32 s19, s15, 9
    s_add_u32 s17, s17, s19
    s_add_u32 s66, s17, 5376
    s_mov_b32 s33, 0
    s_add_u32 s62, s48, 0
    s_add_u32 s63, s48, 73728
    s_add_u32 s64, s48, 147456
    s_add_u32 s65, s48, 221184
    s_load_dwordx2 s[20:21], s[0:1], 32
    s_mov_b32 s22, 9216
    s_mov_b32 s23, 0x00020000
    s_waitcnt lgkmcnt(0)
    s_and_b32 s21, s21, 0xffff
    s_cmp_gt_u32 s14, 2
    s_cbranch_scc1 Lr_mem0_done
    s_mov_b64 exec, s[46:47]
    buffer_load_dword v64, v67, s[20:23], 0 offen
    s_waitcnt vmcnt(0)
    v_min_u32 v64, s50, v64
    buffer_store_dword v64, v7, s[8:11], s37 offen sc1
    v_mov_b32 v64, -1
    buffer_store_dword v64, v7, s[8:11], s36 offen sc1
    s_mov_b64 exec, -1
Lr_mem0_done:
    v_mov_b32 v64, 0
    v_mov_b32 v65, 0
    v_mov_b32 v66, 0
    v_mov_b32 v67, 0
    v_lshrrev_b32 v63, 2, v0
    buffer_store_dwordx4 v[64:67], v0, s[8:11], s38 offen sc1
    s_add_u32 s17, s38, 4096
    buffer_store_dwordx4 v[64:67], v0, s[8:11], s17 offen sc1
    buffer_store_dword v64, v63, s[8:11], s39 offen sc1
    s_waitcnt vmcnt(0)
    s_barrier
    s_cmp_lg_u32 s14, 0
    s_cbranch_scc1 Lr_noadd
    s_lshl_b32 s17, s32, 2
    s_add_u32 s17, s17, 192
    v_mov_b32 v63, s17
    v_mov_b32 v64, 1
    s_mov_b64 exec, 1
    global_atomic_add v63, v64, s[12:13]
    s_mov_b64 exec, -1
Lr_noadd:
    s_cmp_lt_u32 s14, 3
    s_cbranch_scc1 Lr_not_w3
    v_lshlrev_b32 v6, 3, v0
    v_lshrrev_b32 v63, 2, v0
    v_and_b32 v7, 12, v63
    v_and_b32 v63, 16, v63
    v_lshl_add_u32 v7, v63, 3, v7
Lr_not_w3:
    s_cmp_eq_u32 s32, 0
    s_cbranch_scc1 Lr_gate_ng
    s_cmp_lg_u32 s14, 0
    s_cbranch_scc1 Lr_gate_d
    v_mov_b32 v63, 48
    s_mov_b32 s16, 0
Lr_gate:
    global_load_dword v64, v63, s[12:13] sc1
    s_add_u32 s16, s16, 1
    s_cmp_gt_u32 s16, 100000
    s_cbranch_scc1 Lr_abort
    s_waitcnt vmcnt(0)
    v_cmp_gt_u32 vcc, 32, v64
    s_nop 0
    s_cbranch_vccz Lr_gate_d
    s_sleep 100
    s_branch Lr_gate
Lr_gate_d:
    s_barrier
Lr_gate_ng:
    s_load_dwordx2 s[20:21], s[0:1], 40
    s_mov_b32 s22, 4718592
    s_mov_b32 s23, 0x00020000
    s_waitcnt lgkmcnt(0)
    s_and_b32 s21, s21, 0xffff
    s_load_dwordx2 s[24:25], s[0:1], 48
    s_mov_b32 s26, 4718592
    s_mov_b32 s27, 0x00020000
    s_waitcnt lgkmcnt(0)
    s_and_b32 s25, s25, 0xffff
    s_load_dwordx2 s[28:29], s[0:1], 56
    s_mov_b32 s30, 4718592
    s_mov_b32 s31, 0x00020000
    s_waitcnt lgkmcnt(0)
    s_and_b32 s29, s29, 0xffff
    s_load_dwordx2 s[76:77], s[0:1], 64
    s_mov_b32 s78, 4718592
    s_mov_b32 s79, 0x00020000
    s_waitcnt lgkmcnt(0)
    s_and_b32 s77, s77, 0xffff
    v_lshrrev_b32 v60, 4, v0
    v_and_b32 v61, 15, v60
    v_lshrrev_b32 v62, 4, v60
    s_mul_i32 s72, s14, 34816
    s_add_u32 s72, s72, 23296
    s_mul_i32 s70, s14, 1179648
    s_lshl_b32 s17, s15, 8
    s_add_u32 s70, s70, s17
    s_mul_i32 s71, s15, 147456
    s_mul_i32 s17, s14, 288
    s_add_u32 s71, s71, s17
    v_and_b32 v63, 1, v62
    v_lshrrev_b32 v64, 1, v61
    v_xor_b32 v64, v64, v63
    v_lshlrev_b32 v64, 5, v64
    v_and_b32 v65, 1, v61
    v_lshl_add_u32 v64, v65, 4, v64
    v_lshl_add_u32 v12, v62, 13, v64
    v_xor_b32 v13, 128, v12
    v_xor_b32 v14, 64, v12
    v_xor_b32 v15, 192, v12
    v_lshrrev_b32 v63, 2, v60
    v_mul_u32_u24 v63, 1152, v63
    v_and_b32 v64, 3, v60
    v_lshl_add_u32 v16, v64, 4, v63
    v_lshrrev_b32 v63, 1, v60
    v_mul_u32_u24 v63, 1152, v63
    v_and_b32 v64, 1, v60
    v_lshl_add_u32 v17, v64, 4, v63
    v_lshrrev_b32 v40, 2, v61
    v_and_b32 v41, 3, v61
    v_and_b32 v63, 1, v62
    v_lshl_add_u32 v42, v63, 2, v40
    v_and_b32 v64, 1, v40
    v_lshl_add_u32 v64, v63, 2, v64
    v_lshrrev_b32 v65, 1, v40
    v_lshl_add_u32 v64, v65, 3, v64
    v_lshlrev_b32 v64, 8, v64
    v_lshl_add_u32 v64, v41, 3, v64
    v_lshrrev_b32 v65, 1, v62
    v_mul_u32_u24 v65, 34816, v65
    v_add_u32 v64, v64, v65
    v_add_u32 v64, 23296, v64
    s_lshl_b32 s17, s14, 1
    s_add_u32 s18, s17, 0
    v_xor_b32 v65, s18, v42
    v_lshl_add_u32 v18, v65, 5, v64
    v_add_u32 v19, 69632, v18
    s_add_u32 s18, s17, 1
    v_xor_b32 v65, s18, v42
    v_lshl_add_u32 v20, v65, 5, v64
    v_add_u32 v21, 69632, v20
    v_lshrrev_b32 v63, 1, v62
    v_lshlrev_b32 v63, 3, v63
    v_and_b32 v64, 1, v62
    v_lshl_add_u32 v63, v64, 1, v63
    v_and_b32 v64, 1, v40
    v_lshl_add_u32 v63, v64, 4, v63
    v_lshrrev_b32 v64, 1, v40
    v_lshl_add_u32 v63, v64, 2, v63
    v_lshlrev_b32 v64, 3, v41
    v_lshl_add_u32 v22, v63, 6, v64
    v_add_u32 v22, s72, v22
    v_lshl_add_u32 v23, v63, 5, v64
    v_add_u32 v23, s72, v23
    s_add_u32 m0, s72, 0
    s_add_u32 s17, s70, 0
    buffer_load_dwordx4 v12, s[20:23], s17 offen lds
    s_add_u32 m0, m0, 1024
    s_add_u32 s17, s70, 32768
    buffer_load_dwordx4 v13, s[20:23], s17 offen lds
    s_add_u32 m0, m0, 1024
    s_add_u32 s17, s70, 65536
    buffer_load_dwordx4 v14, s[20:23], s17 offen lds
    s_add_u32 m0, m0, 1024
    s_add_u32 s17, s70, 98304
    buffer_load_dwordx4 v15, s[20:23], s17 offen lds
    s_add_u32 m0, s72, 4096
    s_add_u32 s17, s70, 0
    buffer_load_dwordx4 v12, s[24:27], s17 offen lds
    s_add_u32 m0, m0, 1024
    s_add_u32 s17, s70, 32768
    buffer_load_dwordx4 v13, s[24:27], s17 offen lds
    s_add_u32 m0, m0, 1024
    s_add_u32 s17, s70, 65536
    buffer_load_dwordx4 v14, s[24:27], s17 offen lds
    s_add_u32 m0, m0, 1024
    s_add_u32 s17, s70, 98304
    buffer_load_dwordx4 v15, s[24:27], s17 offen lds
    s_add_u32 m0, s72, 8192
    s_add_u32 s17, s70, 131072
    buffer_load_dwordx4 v12, s[20:23], s17 offen lds
    s_add_u32 m0, m0, 1024
    s_add_u32 s17, s70, 163840
    buffer_load_dwordx4 v13, s[20:23], s17 offen lds
    s_add_u32 m0, m0, 1024
    s_add_u32 s17, s70, 196608
    buffer_load_dwordx4 v14, s[20:23], s17 offen lds
    s_add_u32 m0, m0, 1024
    s_add_u32 s17, s70, 229376
    buffer_load_dwordx4 v15, s[20:23], s17 offen lds
    s_add_u32 m0, s72, 12288
    s_add_u32 s17, s70, 131072
    buffer_load_dwordx4 v12, s[24:27], s17 offen lds
    s_add_u32 m0, m0, 1024
    s_add_u32 s17, s70, 163840
    buffer_load_dwordx4 v13, s[24:27], s17 offen lds
    s_add_u32 m0, m0, 1024
    s_add_u32 s17, s70, 196608
    buffer_load_dwordx4 v14, s[24:27], s17 offen lds
    s_add_u32 m0, m0, 1024
    s_add_u32 s17, s70, 229376
    buffer_load_dwordx4 v15, s[24:27], s17 offen lds
    s_add_u32 m0, s72, 16384
    s_add_u32 s17, s70, 131072
    buffer_load_dwordx4 v12, s[28:31], s17 offen lds
    s_add_u32 m0, m0, 1024
    s_add_u32 s17, s70, 163840
    buffer_load_dwordx4 v13, s[28:31], s17 offen lds
    s_add_u32 m0, m0, 1024
    s_add_u32 s17, s70, 196608
    buffer_load_dwordx4 v14, s[28:31], s17 offen lds
    s_add_u32 m0, m0, 1024
    s_add_u32 s17, s70, 229376
    buffer_load_dwordx4 v15, s[28:31], s17 offen lds
    s_add_u32 m0, s72, 20480
    s_add_u32 s17, s70, 262144
    buffer_load_dwordx4 v12, s[20:23], s17 offen lds
    s_add_u32 m0, m0, 1024
    s_add_u32 s17, s70, 294912
    buffer_load_dwordx4 v13, s[20:23], s17 offen lds
    s_add_u32 m0, m0, 1024
    s_add_u32 s17, s70, 327680
    buffer_load_dwordx4 v14, s[20:23], s17 offen lds
    s_add_u32 m0, m0, 1024
    s_add_u32 s17, s70, 360448
    buffer_load_dwordx4 v15, s[20:23], s17 offen lds
    s_add_u32 m0, s72, 24576
    s_add_u32 s17, s70, 262144
    buffer_load_dwordx4 v12, s[24:27], s17 offen lds
    s_add_u32 m0, m0, 1024
    s_add_u32 s17, s70, 294912
    buffer_load_dwordx4 v13, s[24:27], s17 offen lds
    s_add_u32 m0, m0, 1024
    s_add_u32 s17, s70, 327680
    buffer_load_dwordx4 v14, s[24:27], s17 offen lds
    s_add_u32 m0, m0, 1024
    s_add_u32 s17, s70, 360448
    buffer_load_dwordx4 v15, s[24:27], s17 offen lds
    s_add_u32 m0, s72, 28672
    s_add_u32 s17, s70, 393216
    buffer_load_dwordx4 v12, s[20:23], s17 offen lds
    s_add_u32 m0, m0, 1024
    s_add_u32 s17, s70, 425984
    buffer_load_dwordx4 v13, s[20:23], s17 offen lds
    s_add_u32 m0, m0, 1024
    s_add_u32 s17, s70, 458752
    buffer_load_dwordx4 v14, s[20:23], s17 offen lds
    s_add_u32 m0, m0, 1024
    s_add_u32 s17, s70, 491520
    buffer_load_dwordx4 v15, s[20:23], s17 offen lds
    s_add_u32 m0, s72, 32768
    s_add_u32 s17, s71, 256
    buffer_load_dwordx4 v17, s[76:79], s17 offen lds
    s_add_u32 m0, m0, 1024
    s_add_u32 s17, s71, 37120
    buffer_load_dwordx4 v17, s[76:79], s17 offen lds
    s_waitcnt vmcnt(30)
    s_barrier
    ds_read_b64_tr_b16 v[72:73], v18 offset:0
    ds_read_b64_tr_b16 v[74:75], v18 offset:512
    ds_read_b64_tr_b16 v[76:77], v19 offset:0
    ds_read_b64_tr_b16 v[78:79], v19 offset:512
    ds_read_b64_tr_b16 v[80:81], v20 offset:0
    ds_read_b64_tr_b16 v[82:83], v20 offset:512
    ds_read_b64_tr_b16 v[84:85], v21 offset:0
    ds_read_b64_tr_b16 v[86:87], v21 offset:512
    s_waitcnt lgkmcnt(0)
    s_waitcnt vmcnt(26)
    s_barrier
    s_add_u32 m0, s72, 0
    s_add_u32 s17, s70, 393216
    buffer_load_dwordx4 v12, s[24:27], s17 offen lds
    s_add_u32 m0, m0, 1024
    s_add_u32 s17, s70, 425984
    buffer_load_dwordx4 v13, s[24:27], s17 offen lds
    s_add_u32 m0, m0, 1024
    s_add_u32 s17, s70, 458752
    buffer_load_dwordx4 v14, s[24:27], s17 offen lds
    s_add_u32 m0, m0, 1024
    s_add_u32 s17, s70, 491520
    buffer_load_dwordx4 v15, s[24:27], s17 offen lds
    ds_read_b64_tr_b16 v[184:185], v18 offset:4096
    ds_read_b64_tr_b16 v[186:187], v18 offset:4608
    ds_read_b64_tr_b16 v[188:189], v19 offset:4096
    ds_read_b64_tr_b16 v[190:191], v19 offset:4608
    ds_read_b64_tr_b16 v[192:193], v20 offset:4096
    ds_read_b64_tr_b16 v[194:195], v20 offset:4608
    ds_read_b64_tr_b16 v[196:197], v21 offset:4096
    ds_read_b64_tr_b16 v[198:199], v21 offset:4608
    s_waitcnt lgkmcnt(0)
    s_waitcnt vmcnt(26)
    s_barrier
    s_add_u32 m0, s72, 4096
    s_add_u32 s17, s70, 393216
    buffer_load_dwordx4 v12, s[28:31], s17 offen lds
    s_add_u32 m0, m0, 1024
    s_add_u32 s17, s70, 425984
    buffer_load_dwordx4 v13, s[28:31], s17 offen lds
    s_add_u32 m0, m0, 1024
    s_add_u32 s17, s70, 458752
    buffer_load_dwordx4 v14, s[28:31], s17 offen lds
    s_add_u32 m0, m0, 1024
    s_add_u32 s17, s70, 491520
    buffer_load_dwordx4 v15, s[28:31], s17 offen lds
    ds_read_b64_tr_b16 v[88:89], v18 offset:8192
    ds_read_b64_tr_b16 v[90:91], v18 offset:8704
    ds_read_b64_tr_b16 v[92:93], v19 offset:8192
    ds_read_b64_tr_b16 v[94:95], v19 offset:8704
    ds_read_b64_tr_b16 v[96:97], v20 offset:8192
    ds_read_b64_tr_b16 v[98:99], v20 offset:8704
    ds_read_b64_tr_b16 v[100:101], v21 offset:8192
    ds_read_b64_tr_b16 v[102:103], v21 offset:8704
    s_waitcnt lgkmcnt(0)
    s_waitcnt vmcnt(26)
    s_barrier
    s_add_u32 m0, s72, 8192
    s_add_u32 s17, s70, 524288
    buffer_load_dwordx4 v12, s[24:27], s17 offen lds
    s_add_u32 m0, m0, 1024
    s_add_u32 s17, s70, 557056
    buffer_load_dwordx4 v13, s[24:27], s17 offen lds
    s_add_u32 m0, m0, 1024
    s_add_u32 s17, s70, 589824
    buffer_load_dwordx4 v14, s[24:27], s17 offen lds
    s_add_u32 m0, m0, 1024
    s_add_u32 s17, s70, 622592
    buffer_load_dwordx4 v15, s[24:27], s17 offen lds
    ds_read_b64_tr_b16 v[200:201], v18 offset:12288
    ds_read_b64_tr_b16 v[202:203], v18 offset:12800
    ds_read_b64_tr_b16 v[204:205], v19 offset:12288
    ds_read_b64_tr_b16 v[206:207], v19 offset:12800
    ds_read_b64_tr_b16 v[208:209], v20 offset:12288
    ds_read_b64_tr_b16 v[210:211], v20 offset:12800
    ds_read_b64_tr_b16 v[212:213], v21 offset:12288
    ds_read_b64_tr_b16 v[214:215], v21 offset:12800
    s_waitcnt lgkmcnt(0)
    s_waitcnt vmcnt(26)
    s_barrier
    s_add_u32 m0, s72, 12288
    s_add_u32 s17, s70, 524288
    buffer_load_dwordx4 v12, s[28:31], s17 offen lds
    s_add_u32 m0, m0, 1024
    s_add_u32 s17, s70, 557056
    buffer_load_dwordx4 v13, s[28:31], s17 offen lds
    s_add_u32 m0, m0, 1024
    s_add_u32 s17, s70, 589824
    buffer_load_dwordx4 v14, s[28:31], s17 offen lds
    s_add_u32 m0, m0, 1024
    s_add_u32 s17, s70, 622592
    buffer_load_dwordx4 v15, s[28:31], s17 offen lds
    ds_read_b64_tr_b16 a[72:73], v18 offset:16384
    ds_read_b64_tr_b16 a[74:75], v18 offset:16896
    ds_read_b64_tr_b16 a[76:77], v19 offset:16384
    ds_read_b64_tr_b16 a[78:79], v19 offset:16896
    ds_read_b64_tr_b16 a[80:81], v20 offset:16384
    ds_read_b64_tr_b16 a[82:83], v20 offset:16896
    ds_read_b64_tr_b16 a[84:85], v21 offset:16384
    ds_read_b64_tr_b16 a[86:87], v21 offset:16896
    s_waitcnt lgkmcnt(0)
    s_waitcnt vmcnt(26)
    s_barrier
    s_add_u32 m0, s72, 16384
    s_add_u32 s17, s70, 655360
    buffer_load_dwordx4 v12, s[20:23], s17 offen lds
    s_add_u32 m0, m0, 1024
    s_add_u32 s17, s70, 688128
    buffer_load_dwordx4 v13, s[20:23], s17 offen lds
    s_add_u32 m0, m0, 1024
    s_add_u32 s17, s70, 720896
    buffer_load_dwordx4 v14, s[20:23], s17 offen lds
    s_add_u32 m0, m0, 1024
    s_add_u32 s17, s70, 753664
    buffer_load_dwordx4 v15, s[20:23], s17 offen lds
    ds_read_b64_tr_b16 v[104:105], v18 offset:20480
    ds_read_b64_tr_b16 v[106:107], v18 offset:20992
    ds_read_b64_tr_b16 v[108:109], v19 offset:20480
    ds_read_b64_tr_b16 v[110:111], v19 offset:20992
    ds_read_b64_tr_b16 v[112:113], v20 offset:20480
    ds_read_b64_tr_b16 v[114:115], v20 offset:20992
    ds_read_b64_tr_b16 v[116:117], v21 offset:20480
    ds_read_b64_tr_b16 v[118:119], v21 offset:20992
    s_waitcnt lgkmcnt(0)
    s_waitcnt vmcnt(26)
    s_barrier
    s_add_u32 m0, s72, 20480
    s_add_u32 s17, s70, 655360
    buffer_load_dwordx4 v12, s[24:27], s17 offen lds
    s_add_u32 m0, m0, 1024
    s_add_u32 s17, s70, 688128
    buffer_load_dwordx4 v13, s[24:27], s17 offen lds
    s_add_u32 m0, m0, 1024
    s_add_u32 s17, s70, 720896
    buffer_load_dwordx4 v14, s[24:27], s17 offen lds
    s_add_u32 m0, m0, 1024
    s_add_u32 s17, s70, 753664
    buffer_load_dwordx4 v15, s[24:27], s17 offen lds
    ds_read_b64_tr_b16 v[216:217], v18 offset:24576
    ds_read_b64_tr_b16 v[218:219], v18 offset:25088
    ds_read_b64_tr_b16 v[220:221], v19 offset:24576
    ds_read_b64_tr_b16 v[222:223], v19 offset:25088
    ds_read_b64_tr_b16 v[224:225], v20 offset:24576
    ds_read_b64_tr_b16 v[226:227], v20 offset:25088
    ds_read_b64_tr_b16 v[228:229], v21 offset:24576
    ds_read_b64_tr_b16 v[230:231], v21 offset:25088
    s_waitcnt lgkmcnt(0)
    s_waitcnt vmcnt(26)
    s_barrier
    s_add_u32 m0, s72, 24576
    s_add_u32 s17, s70, 655360
    buffer_load_dwordx4 v12, s[28:31], s17 offen lds
    s_add_u32 m0, m0, 1024
    s_add_u32 s17, s70, 688128
    buffer_load_dwordx4 v13, s[28:31], s17 offen lds
    s_add_u32 m0, m0, 1024
    s_add_u32 s17, s70, 720896
    buffer_load_dwordx4 v14, s[28:31], s17 offen lds
    s_add_u32 m0, m0, 1024
    s_add_u32 s17, s70, 753664
    buffer_load_dwordx4 v15, s[28:31], s17 offen lds
    ds_read_b64_tr_b16 v[120:121], v18 offset:28672
    ds_read_b64_tr_b16 v[122:123], v18 offset:29184
    ds_read_b64_tr_b16 v[124:125], v19 offset:28672
    ds_read_b64_tr_b16 v[126:127], v19 offset:29184
    ds_read_b64_tr_b16 v[128:129], v20 offset:28672
    ds_read_b64_tr_b16 v[130:131], v20 offset:29184
    ds_read_b64_tr_b16 v[132:133], v21 offset:28672
    ds_read_b64_tr_b16 v[134:135], v21 offset:29184
    s_waitcnt lgkmcnt(0)
    s_waitcnt vmcnt(24)
    s_barrier
    s_add_u32 m0, s72, 28672
    s_add_u32 s17, s70, 786432
    buffer_load_dwordx4 v12, s[24:27], s17 offen lds
    s_add_u32 m0, m0, 1024
    s_add_u32 s17, s70, 819200
    buffer_load_dwordx4 v13, s[24:27], s17 offen lds
    s_add_u32 m0, m0, 1024
    s_add_u32 s17, s70, 851968
    buffer_load_dwordx4 v14, s[24:27], s17 offen lds
    s_add_u32 m0, m0, 1024
    s_add_u32 s17, s70, 884736
    buffer_load_dwordx4 v15, s[24:27], s17 offen lds
    ds_read_b64_tr_b16 v[232:233], v18 offset:0
    ds_read_b64_tr_b16 v[234:235], v18 offset:512
    ds_read_b64_tr_b16 v[236:237], v19 offset:0
    ds_read_b64_tr_b16 v[238:239], v19 offset:512
    ds_read_b64_tr_b16 v[240:241], v20 offset:0
    ds_read_b64_tr_b16 v[242:243], v20 offset:512
    ds_read_b64_tr_b16 v[244:245], v21 offset:0
    ds_read_b64_tr_b16 v[246:247], v21 offset:512
    s_waitcnt lgkmcnt(0)
    s_waitcnt vmcnt(24)
    s_barrier
    s_add_u32 m0, s72, 0
    s_add_u32 s17, s70, 786432
    buffer_load_dwordx4 v12, s[28:31], s17 offen lds
    s_add_u32 m0, m0, 1024
    s_add_u32 s17, s70, 819200
    buffer_load_dwordx4 v13, s[28:31], s17 offen lds
    s_add_u32 m0, m0, 1024
    s_add_u32 s17, s70, 851968
    buffer_load_dwordx4 v14, s[28:31], s17 offen lds
    s_add_u32 m0, m0, 1024
    s_add_u32 s17, s70, 884736
    buffer_load_dwordx4 v15, s[28:31], s17 offen lds
    ds_read_b64_tr_b16 a[88:89], v18 offset:4096
    ds_read_b64_tr_b16 a[90:91], v18 offset:4608
    ds_read_b64_tr_b16 a[92:93], v19 offset:4096
    ds_read_b64_tr_b16 a[94:95], v19 offset:4608
    ds_read_b64_tr_b16 a[96:97], v20 offset:4096
    ds_read_b64_tr_b16 a[98:99], v20 offset:4608
    ds_read_b64_tr_b16 a[100:101], v21 offset:4096
    ds_read_b64_tr_b16 a[102:103], v21 offset:4608
    s_waitcnt lgkmcnt(0)
    s_waitcnt vmcnt(24)
    s_barrier
    s_add_u32 m0, s72, 4096
    s_add_u32 s17, s70, 917504
    buffer_load_dwordx4 v12, s[20:23], s17 offen lds
    s_add_u32 m0, m0, 1024
    s_add_u32 s17, s70, 950272
    buffer_load_dwordx4 v13, s[20:23], s17 offen lds
    s_add_u32 m0, m0, 1024
    s_add_u32 s17, s70, 983040
    buffer_load_dwordx4 v14, s[20:23], s17 offen lds
    s_add_u32 m0, m0, 1024
    s_add_u32 s17, s70, 1015808
    buffer_load_dwordx4 v15, s[20:23], s17 offen lds
    ds_read_b64_tr_b16 v[248:249], v18 offset:8192
    ds_read_b64_tr_b16 v[250:251], v18 offset:8704
    ds_read_b64_tr_b16 v[252:253], v19 offset:8192
    ds_read_b64_tr_b16 v[254:255], v19 offset:8704
    ds_read_b64_tr_b16 a[0:1], v20 offset:8192
    ds_read_b64_tr_b16 a[2:3], v20 offset:8704
    ds_read_b64_tr_b16 a[4:5], v21 offset:8192
    ds_read_b64_tr_b16 a[6:7], v21 offset:8704
    s_waitcnt lgkmcnt(0)
    s_waitcnt vmcnt(24)
    s_barrier
    s_add_u32 m0, s72, 8192
    s_add_u32 s17, s70, 917504
    buffer_load_dwordx4 v12, s[24:27], s17 offen lds
    s_add_u32 m0, m0, 1024
    s_add_u32 s17, s70, 950272
    buffer_load_dwordx4 v13, s[24:27], s17 offen lds
    s_add_u32 m0, m0, 1024
    s_add_u32 s17, s70, 983040
    buffer_load_dwordx4 v14, s[24:27], s17 offen lds
    s_add_u32 m0, m0, 1024
    s_add_u32 s17, s70, 1015808
    buffer_load_dwordx4 v15, s[24:27], s17 offen lds
    ds_read_b64_tr_b16 a[104:105], v18 offset:12288
    ds_read_b64_tr_b16 a[106:107], v18 offset:12800
    ds_read_b64_tr_b16 a[108:109], v19 offset:12288
    ds_read_b64_tr_b16 a[110:111], v19 offset:12800
    ds_read_b64_tr_b16 a[112:113], v20 offset:12288
    ds_read_b64_tr_b16 a[114:115], v20 offset:12800
    ds_read_b64_tr_b16 a[116:117], v21 offset:12288
    ds_read_b64_tr_b16 a[118:119], v21 offset:12800
    s_waitcnt lgkmcnt(0)
    s_waitcnt vmcnt(24)
    s_barrier
    s_add_u32 m0, s72, 12288
    s_add_u32 s17, s70, 917504
    buffer_load_dwordx4 v12, s[28:31], s17 offen lds
    s_add_u32 m0, m0, 1024
    s_add_u32 s17, s70, 950272
    buffer_load_dwordx4 v13, s[28:31], s17 offen lds
    s_add_u32 m0, m0, 1024
    s_add_u32 s17, s70, 983040
    buffer_load_dwordx4 v14, s[28:31], s17 offen lds
    s_add_u32 m0, m0, 1024
    s_add_u32 s17, s70, 1015808
    buffer_load_dwordx4 v15, s[28:31], s17 offen lds
    ds_read_b64_tr_b16 v[136:137], v18 offset:16384
    ds_read_b64_tr_b16 v[138:139], v18 offset:16896
    ds_read_b64_tr_b16 v[140:141], v19 offset:16384
    ds_read_b64_tr_b16 v[142:143], v19 offset:16896
    ds_read_b64_tr_b16 v[144:145], v20 offset:16384
    ds_read_b64_tr_b16 v[146:147], v20 offset:16896
    ds_read_b64_tr_b16 v[148:149], v21 offset:16384
    ds_read_b64_tr_b16 v[150:151], v21 offset:16896
    s_waitcnt lgkmcnt(0)
    s_add_u32 s17, s32, s14
    s_cmp_lg_u32 s17, 0
    s_cbranch_scc1 Lr_nold
    v_mov_b32 v63, 48
    v_mov_b32 v64, 1
    s_mov_b64 exec, 1
    global_atomic_add v63, v64, s[12:13]
    s_mov_b64 exec, -1
Lr_nold:
    s_waitcnt vmcnt(24)
    s_barrier
    s_add_u32 m0, s72, 16384
    s_add_u32 s17, s70, 1048576
    buffer_load_dwordx4 v12, s[20:23], s17 offen lds
    s_add_u32 m0, m0, 1024
    s_add_u32 s17, s70, 1081344
    buffer_load_dwordx4 v13, s[20:23], s17 offen lds
    s_add_u32 m0, m0, 1024
    s_add_u32 s17, s70, 1114112
    buffer_load_dwordx4 v14, s[20:23], s17 offen lds
    s_add_u32 m0, m0, 1024
    s_add_u32 s17, s70, 1146880
    buffer_load_dwordx4 v15, s[20:23], s17 offen lds
    ds_read_b64_tr_b16 a[8:9], v18 offset:20480
    ds_read_b64_tr_b16 a[10:11], v18 offset:20992
    ds_read_b64_tr_b16 a[12:13], v19 offset:20480
    ds_read_b64_tr_b16 a[14:15], v19 offset:20992
    ds_read_b64_tr_b16 a[16:17], v20 offset:20480
    ds_read_b64_tr_b16 a[18:19], v20 offset:20992
    ds_read_b64_tr_b16 a[20:21], v21 offset:20480
    ds_read_b64_tr_b16 a[22:23], v21 offset:20992
    s_waitcnt lgkmcnt(0)
    s_waitcnt vmcnt(24)
    s_barrier
    s_add_u32 m0, s72, 20480
    s_add_u32 s17, s70, 1048576
    buffer_load_dwordx4 v12, s[24:27], s17 offen lds
    s_add_u32 m0, m0, 1024
    s_add_u32 s17, s70, 1081344
    buffer_load_dwordx4 v13, s[24:27], s17 offen lds
    s_add_u32 m0, m0, 1024
    s_add_u32 s17, s70, 1114112
    buffer_load_dwordx4 v14, s[24:27], s17 offen lds
    s_add_u32 m0, m0, 1024
    s_add_u32 s17, s70, 1146880
    buffer_load_dwordx4 v15, s[24:27], s17 offen lds
    ds_read_b64_tr_b16 a[120:121], v18 offset:24576
    ds_read_b64_tr_b16 a[122:123], v18 offset:25088
    ds_read_b64_tr_b16 a[124:125], v19 offset:24576
    ds_read_b64_tr_b16 a[126:127], v19 offset:25088
    ds_read_b64_tr_b16 a[128:129], v20 offset:24576
    ds_read_b64_tr_b16 a[130:131], v20 offset:25088
    ds_read_b64_tr_b16 a[132:133], v21 offset:24576
    ds_read_b64_tr_b16 a[134:135], v21 offset:25088
    s_waitcnt lgkmcnt(0)
    s_waitcnt vmcnt(24)
    s_barrier
    s_add_u32 m0, s72, 24576
    s_add_u32 s17, s70, 1048576
    buffer_load_dwordx4 v12, s[28:31], s17 offen lds
    s_add_u32 m0, m0, 1024
    s_add_u32 s17, s70, 1081344
    buffer_load_dwordx4 v13, s[28:31], s17 offen lds
    s_add_u32 m0, m0, 1024
    s_add_u32 s17, s70, 1114112
    buffer_load_dwordx4 v14, s[28:31], s17 offen lds
    s_add_u32 m0, m0, 1024
    s_add_u32 s17, s70, 1146880
    buffer_load_dwordx4 v15, s[28:31], s17 offen lds
    ds_read_b64_tr_b16 a[24:25], v18 offset:28672
    ds_read_b64_tr_b16 a[26:27], v18 offset:29184
    ds_read_b64_tr_b16 a[28:29], v19 offset:28672
    ds_read_b64_tr_b16 a[30:31], v19 offset:29184
    ds_read_b64_tr_b16 a[32:33], v20 offset:28672
    ds_read_b64_tr_b16 a[34:35], v20 offset:29184
    ds_read_b64_tr_b16 a[36:37], v21 offset:28672
    ds_read_b64_tr_b16 a[38:39], v21 offset:29184
    s_waitcnt lgkmcnt(0)
    s_waitcnt vmcnt(24)
    s_barrier
    ds_read_b64_tr_b16 a[136:137], v18 offset:0
    ds_read_b64_tr_b16 a[138:139], v18 offset:512
    ds_read_b64_tr_b16 a[140:141], v19 offset:0
    ds_read_b64_tr_b16 a[142:143], v19 offset:512
    ds_read_b64_tr_b16 a[144:145], v20 offset:0
    ds_read_b64_tr_b16 a[146:147], v20 offset:512
    ds_read_b64_tr_b16 a[148:149], v21 offset:0
    ds_read_b64_tr_b16 a[150:151], v21 offset:512
    s_waitcnt lgkmcnt(0)
    s_waitcnt vmcnt(20)
    s_barrier
    s_add_u32 m0, s72, 0
    s_add_u32 s17, s70, 0
    buffer_load_dwordx4 v12, s[28:31], s17 offen lds
    s_add_u32 m0, m0, 1024
    s_add_u32 s17, s70, 32768
    buffer_load_dwordx4 v13, s[28:31], s17 offen lds
    s_add_u32 m0, m0, 1024
    s_add_u32 s17, s70, 65536
    buffer_load_dwordx4 v14, s[28:31], s17 offen lds
    s_add_u32 m0, m0, 1024
    s_add_u32 s17, s70, 98304
    buffer_load_dwordx4 v15, s[28:31], s17 offen lds
    ds_read_b64_tr_b16 v[152:153], v18 offset:4096
    ds_read_b64_tr_b16 v[154:155], v18 offset:4608
    ds_read_b64_tr_b16 v[156:157], v19 offset:4096
    ds_read_b64_tr_b16 v[158:159], v19 offset:4608
    ds_read_b64_tr_b16 v[160:161], v20 offset:4096
    ds_read_b64_tr_b16 v[162:163], v20 offset:4608
    ds_read_b64_tr_b16 v[164:165], v21 offset:4096
    ds_read_b64_tr_b16 v[166:167], v21 offset:4608
    s_waitcnt lgkmcnt(0)
    s_waitcnt vmcnt(20)
    s_barrier
    s_add_u32 m0, s72, 4096
    s_add_u32 s17, s70, 262144
    buffer_load_dwordx4 v12, s[28:31], s17 offen lds
    s_add_u32 m0, m0, 1024
    s_add_u32 s17, s70, 294912
    buffer_load_dwordx4 v13, s[28:31], s17 offen lds
    s_add_u32 m0, m0, 1024
    s_add_u32 s17, s70, 327680
    buffer_load_dwordx4 v14, s[28:31], s17 offen lds
    s_add_u32 m0, m0, 1024
    s_add_u32 s17, s70, 360448
    buffer_load_dwordx4 v15, s[28:31], s17 offen lds
    ds_read_b64_tr_b16 a[40:41], v18 offset:8192
    ds_read_b64_tr_b16 a[42:43], v18 offset:8704
    ds_read_b64_tr_b16 a[44:45], v19 offset:8192
    ds_read_b64_tr_b16 a[46:47], v19 offset:8704
    ds_read_b64_tr_b16 a[48:49], v20 offset:8192
    ds_read_b64_tr_b16 a[50:51], v20 offset:8704
    ds_read_b64_tr_b16 a[52:53], v21 offset:8192
    ds_read_b64_tr_b16 a[54:55], v21 offset:8704
    s_waitcnt lgkmcnt(0)
    s_waitcnt vmcnt(20)
    s_barrier
    s_add_u32 m0, s72, 8192
    s_add_u32 s17, s70, 524288
    buffer_load_dwordx4 v12, s[20:23], s17 offen lds
    s_add_u32 m0, m0, 1024
    s_add_u32 s17, s70, 557056
    buffer_load_dwordx4 v13, s[20:23], s17 offen lds
    s_add_u32 m0, m0, 1024
    s_add_u32 s17, s70, 589824
    buffer_load_dwordx4 v14, s[20:23], s17 offen lds
    s_add_u32 m0, m0, 1024
    s_add_u32 s17, s70, 622592
    buffer_load_dwordx4 v15, s[20:23], s17 offen lds
    ds_read_b64_tr_b16 a[152:153], v18 offset:12288
    ds_read_b64_tr_b16 a[154:155], v18 offset:12800
    ds_read_b64_tr_b16 a[156:157], v19 offset:12288
    ds_read_b64_tr_b16 a[158:159], v19 offset:12800
    ds_read_b64_tr_b16 a[160:161], v20 offset:12288
    ds_read_b64_tr_b16 a[162:163], v20 offset:12800
    ds_read_b64_tr_b16 a[164:165], v21 offset:12288
    ds_read_b64_tr_b16 a[166:167], v21 offset:12800
    s_waitcnt lgkmcnt(0)
    s_waitcnt vmcnt(20)
    s_barrier
    s_add_u32 m0, s72, 12288
    s_add_u32 s17, s70, 786432
    buffer_load_dwordx4 v12, s[20:23], s17 offen lds
    s_add_u32 m0, m0, 1024
    s_add_u32 s17, s70, 819200
    buffer_load_dwordx4 v13, s[20:23], s17 offen lds
    s_add_u32 m0, m0, 1024
    s_add_u32 s17, s70, 851968
    buffer_load_dwordx4 v14, s[20:23], s17 offen lds
    s_add_u32 m0, m0, 1024
    s_add_u32 s17, s70, 884736
    buffer_load_dwordx4 v15, s[20:23], s17 offen lds
    ds_read_b64_tr_b16 v[168:169], v18 offset:16384
    ds_read_b64_tr_b16 v[170:171], v18 offset:16896
    ds_read_b64_tr_b16 v[172:173], v19 offset:16384
    ds_read_b64_tr_b16 v[174:175], v19 offset:16896
    ds_read_b64_tr_b16 v[176:177], v20 offset:16384
    ds_read_b64_tr_b16 v[178:179], v20 offset:16896
    ds_read_b64_tr_b16 v[180:181], v21 offset:16384
    ds_read_b64_tr_b16 v[182:183], v21 offset:16896
    s_waitcnt lgkmcnt(0)
    s_waitcnt vmcnt(20)
    s_barrier
    s_add_u32 m0, s72, 16384
    s_add_u32 s17, s71, 0
    buffer_load_dwordx4 v16, s[76:79], s17 offen lds
    s_add_u32 m0, m0, 1024
    s_add_u32 s17, s71, 18432
    buffer_load_dwordx4 v16, s[76:79], s17 offen lds
    s_add_u32 m0, m0, 1024
    s_add_u32 s17, s71, 36864
    buffer_load_dwordx4 v16, s[76:79], s17 offen lds
    s_add_u32 m0, m0, 1024
    s_add_u32 s17, s71, 55296
    buffer_load_dwordx4 v16, s[76:79], s17 offen lds
    ds_read_b64_tr_b16 a[56:57], v18 offset:20480
    ds_read_b64_tr_b16 a[58:59], v18 offset:20992
    ds_read_b64_tr_b16 a[60:61], v19 offset:20480
    ds_read_b64_tr_b16 a[62:63], v19 offset:20992
    ds_read_b64_tr_b16 a[64:65], v20 offset:20480
    ds_read_b64_tr_b16 a[66:67], v20 offset:20992
    ds_read_b64_tr_b16 a[68:69], v21 offset:20480
    ds_read_b64_tr_b16 a[70:71], v21 offset:20992
    s_waitcnt lgkmcnt(0)
    s_waitcnt vmcnt(20)
    s_barrier
    s_add_u32 m0, s72, 20480
    s_add_u32 s17, s71, 73728
    buffer_load_dwordx4 v16, s[76:79], s17 offen lds
    s_add_u32 m0, m0, 1024
    s_add_u32 s17, s71, 92160
    buffer_load_dwordx4 v16, s[76:79], s17 offen lds
    s_add_u32 m0, m0, 1024
    s_add_u32 s17, s71, 110592
    buffer_load_dwordx4 v16, s[76:79], s17 offen lds
    s_add_u32 m0, m0, 1024
    s_add_u32 s17, s71, 129024
    buffer_load_dwordx4 v16, s[76:79], s17 offen lds
    ds_read_b64_tr_b16 a[168:169], v18 offset:24576
    ds_read_b64_tr_b16 a[170:171], v18 offset:25088
    ds_read_b64_tr_b16 a[172:173], v19 offset:24576
    ds_read_b64_tr_b16 a[174:175], v19 offset:25088
    ds_read_b64_tr_b16 a[176:177], v20 offset:24576
    ds_read_b64_tr_b16 a[178:179], v20 offset:25088
    ds_read_b64_tr_b16 a[180:181], v21 offset:24576
    ds_read_b64_tr_b16 a[182:183], v21 offset:25088
    s_waitcnt lgkmcnt(0)
    s_waitcnt vmcnt(20)
    s_barrier
    s_add_u32 m0, s72, 24576
    s_add_u32 s17, s71, 64
    buffer_load_dwordx4 v16, s[76:79], s17 offen lds
    s_add_u32 m0, m0, 1024
    s_add_u32 s17, s71, 18496
    buffer_load_dwordx4 v16, s[76:79], s17 offen lds
    s_add_u32 m0, m0, 1024
    s_add_u32 s17, s71, 36928
    buffer_load_dwordx4 v16, s[76:79], s17 offen lds
    s_add_u32 m0, m0, 1024
    s_add_u32 s17, s71, 55360
    buffer_load_dwordx4 v16, s[76:79], s17 offen lds
    s_add_u32 m0, s72, 28672
    s_add_u32 s17, s71, 73792
    buffer_load_dwordx4 v16, s[76:79], s17 offen lds
    s_add_u32 m0, m0, 1024
    s_add_u32 s17, s71, 92224
    buffer_load_dwordx4 v16, s[76:79], s17 offen lds
    s_add_u32 m0, m0, 1024
    s_add_u32 s17, s71, 110656
    buffer_load_dwordx4 v16, s[76:79], s17 offen lds
    s_add_u32 m0, m0, 1024
    s_add_u32 s17, s71, 129088
    buffer_load_dwordx4 v16, s[76:79], s17 offen lds
    ds_read_b64_tr_b16 v[24:25], v18 offset:0
    ds_read_b64_tr_b16 v[26:27], v18 offset:512
    ds_read_b64_tr_b16 v[28:29], v19 offset:0
    ds_read_b64_tr_b16 v[30:31], v19 offset:512
    ds_read_b64_tr_b16 v[32:33], v20 offset:0
    ds_read_b64_tr_b16 v[34:35], v20 offset:512
    ds_read_b64_tr_b16 v[36:37], v21 offset:0
    ds_read_b64_tr_b16 v[38:39], v21 offset:512
    s_waitcnt lgkmcnt(0)
    s_barrier
    ds_write_b128 v8, v[24:27] offset:0
    ds_write_b128 v8, v[28:31] offset:1024
    ds_write_b128 v8, v[32:35] offset:2048
    ds_write_b128 v8, v[36:39] offset:3072
    s_waitcnt lgkmcnt(0)
    s_waitcnt vmcnt(24)
    s_barrier
    ds_read_b64_tr_b16 v[24:25], v18 offset:4096
    ds_read_b64_tr_b16 v[26:27], v18 offset:4608
    ds_read_b64_tr_b16 v[28:29], v19 offset:4096
    ds_read_b64_tr_b16 v[30:31], v19 offset:4608
    ds_read_b64_tr_b16 v[32:33], v20 offset:4096
    ds_read_b64_tr_b16 v[34:35], v20 offset:4608
    ds_read_b64_tr_b16 v[36:37], v21 offset:4096
    ds_read_b64_tr_b16 v[38:39], v21 offset:4608
    s_waitcnt lgkmcnt(0)
    s_barrier
    ds_write_b128 v8, v[24:27] offset:4096
    ds_write_b128 v8, v[28:31] offset:5120
    ds_write_b128 v8, v[32:35] offset:6144
    ds_write_b128 v8, v[36:39] offset:7168
    s_waitcnt lgkmcnt(0)
    s_waitcnt vmcnt(20)
    s_barrier
    ds_read_b64_tr_b16 v[24:25], v18 offset:8192
    ds_read_b64_tr_b16 v[26:27], v18 offset:8704
    ds_read_b64_tr_b16 v[28:29], v19 offset:8192
    ds_read_b64_tr_b16 v[30:31], v19 offset:8704
    ds_read_b64_tr_b16 v[32:33], v20 offset:8192
    ds_read_b64_tr_b16 v[34:35], v20 offset:8704
    ds_read_b64_tr_b16 v[36:37], v21 offset:8192
    ds_read_b64_tr_b16 v[38:39], v21 offset:8704
    s_waitcnt lgkmcnt(0)
    s_barrier
    ds_write_b128 v8, v[24:27] offset:8192
    ds_write_b128 v8, v[28:31] offset:9216
    ds_write_b128 v8, v[32:35] offset:10240
    ds_write_b128 v8, v[36:39] offset:11264
    s_waitcnt lgkmcnt(0)
    s_waitcnt vmcnt(16)
    s_barrier
    ds_read_b64_tr_b16 v[24:25], v18 offset:12288
    ds_read_b64_tr_b16 v[26:27], v18 offset:12800
    ds_read_b64_tr_b16 v[28:29], v19 offset:12288
    ds_read_b64_tr_b16 v[30:31], v19 offset:12800
    ds_read_b64_tr_b16 v[32:33], v20 offset:12288
    ds_read_b64_tr_b16 v[34:35], v20 offset:12800
    ds_read_b64_tr_b16 v[36:37], v21 offset:12288
    ds_read_b64_tr_b16 v[38:39], v21 offset:12800
    s_waitcnt lgkmcnt(0)
    s_barrier
    ds_write_b128 v8, v[24:27] offset:12288
    ds_write_b128 v8, v[28:31] offset:13312
    ds_write_b128 v8, v[32:35] offset:14336
    ds_write_b128 v8, v[36:39] offset:15360
    s_waitcnt lgkmcnt(0)
    s_barrier
    s_waitcnt vmcnt(12)
    ds_read_b64_tr_b16 a[184:185], v22 offset:16384
    ds_read_b64_tr_b16 a[186:187], v22 offset:16448
    ds_read_b64_tr_b16 a[188:189], v22 offset:18432
    ds_read_b64_tr_b16 a[190:191], v22 offset:18496
    ds_read_b64_tr_b16 a[200:201], v22 offset:16416
    ds_read_b64_tr_b16 a[202:203], v22 offset:16480
    ds_read_b64_tr_b16 a[204:205], v22 offset:18464
    ds_read_b64_tr_b16 a[206:207], v22 offset:18528
    s_waitcnt lgkmcnt(0)
    s_add_u32 m0, s72, 16384
    s_add_u32 s17, s71, 128
    buffer_load_dwordx4 v16, s[76:79], s17 offen lds
    s_add_u32 m0, m0, 1024
    s_add_u32 s17, s71, 18560
    buffer_load_dwordx4 v16, s[76:79], s17 offen lds
    s_add_u32 m0, m0, 1024
    s_add_u32 s17, s71, 36992
    buffer_load_dwordx4 v16, s[76:79], s17 offen lds
    s_add_u32 m0, m0, 1024
    s_add_u32 s17, s71, 55424
    buffer_load_dwordx4 v16, s[76:79], s17 offen lds
    s_waitcnt vmcnt(12)
    ds_read_b64_tr_b16 a[192:193], v22 offset:20480
    ds_read_b64_tr_b16 a[194:195], v22 offset:20544
    ds_read_b64_tr_b16 a[196:197], v22 offset:22528
    ds_read_b64_tr_b16 a[198:199], v22 offset:22592
    ds_read_b64_tr_b16 a[208:209], v22 offset:20512
    ds_read_b64_tr_b16 a[210:211], v22 offset:20576
    ds_read_b64_tr_b16 a[212:213], v22 offset:22560
    ds_read_b64_tr_b16 a[214:215], v22 offset:22624
    s_waitcnt lgkmcnt(0)
    s_add_u32 m0, s72, 20480
    s_add_u32 s17, s71, 73856
    buffer_load_dwordx4 v16, s[76:79], s17 offen lds
    s_add_u32 m0, m0, 1024
    s_add_u32 s17, s71, 92288
    buffer_load_dwordx4 v16, s[76:79], s17 offen lds
    s_add_u32 m0, m0, 1024
    s_add_u32 s17, s71, 110720
    buffer_load_dwordx4 v16, s[76:79], s17 offen lds
    s_add_u32 m0, m0, 1024
    s_add_u32 s17, s71, 129152
    buffer_load_dwordx4 v16, s[76:79], s17 offen lds
    s_waitcnt vmcnt(12)
    ds_read_b64_tr_b16 a[216:217], v22 offset:24576
    ds_read_b64_tr_b16 a[218:219], v22 offset:24640
    ds_read_b64_tr_b16 a[220:221], v22 offset:26624
    ds_read_b64_tr_b16 a[222:223], v22 offset:26688
    ds_read_b64_tr_b16 a[232:233], v22 offset:24608
    ds_read_b64_tr_b16 a[234:235], v22 offset:24672
    ds_read_b64_tr_b16 a[236:237], v22 offset:26656
    ds_read_b64_tr_b16 a[238:239], v22 offset:26720
    s_waitcnt lgkmcnt(0)
    s_add_u32 m0, s72, 24576
    s_add_u32 s17, s71, 192
    buffer_load_dwordx4 v16, s[76:79], s17 offen lds
    s_add_u32 m0, m0, 1024
    s_add_u32 s17, s71, 18624
    buffer_load_dwordx4 v16, s[76:79], s17 offen lds
    s_add_u32 m0, m0, 1024
    s_add_u32 s17, s71, 37056
    buffer_load_dwordx4 v16, s[76:79], s17 offen lds
    s_add_u32 m0, m0, 1024
    s_add_u32 s17, s71, 55488
    buffer_load_dwordx4 v16, s[76:79], s17 offen lds
    s_waitcnt vmcnt(12)
    ds_read_b64_tr_b16 a[224:225], v22 offset:28672
    ds_read_b64_tr_b16 a[226:227], v22 offset:28736
    ds_read_b64_tr_b16 a[228:229], v22 offset:30720
    ds_read_b64_tr_b16 a[230:231], v22 offset:30784
    ds_read_b64_tr_b16 a[240:241], v22 offset:28704
    ds_read_b64_tr_b16 a[242:243], v22 offset:28768
    ds_read_b64_tr_b16 a[244:245], v22 offset:30752
    ds_read_b64_tr_b16 a[246:247], v22 offset:30816
    s_waitcnt lgkmcnt(0)
    s_add_u32 m0, s72, 28672
    s_add_u32 s17, s71, 73920
    buffer_load_dwordx4 v16, s[76:79], s17 offen lds
    s_add_u32 m0, m0, 1024
    s_add_u32 s17, s71, 92352
    buffer_load_dwordx4 v16, s[76:79], s17 offen lds
    s_add_u32 m0, m0, 1024
    s_add_u32 s17, s71, 110784
    buffer_load_dwordx4 v16, s[76:79], s17 offen lds
    s_add_u32 m0, m0, 1024
    s_add_u32 s17, s71, 129216
    buffer_load_dwordx4 v16, s[76:79], s17 offen lds
    s_waitcnt vmcnt(63)
    ds_read_b64_tr_b16 a[248:249], v23 offset:32768
    ds_read_b64_tr_b16 a[250:251], v23 offset:32800
    ds_read_b64_tr_b16 a[252:253], v23 offset:33792
    ds_read_b64_tr_b16 a[254:255], v23 offset:33824
    s_waitcnt lgkmcnt(0)
    s_add_u32 m0, s72, 32768
    s_add_u32 s17, s71, 73984
    buffer_load_dwordx4 v17, s[76:79], s17 offen lds
    s_add_u32 m0, m0, 1024
    s_add_u32 s17, s71, 110848
    buffer_load_dwordx4 v17, s[76:79], s17 offen lds
    s_waitcnt vmcnt(14)
    ds_read_b64_tr_b16 v[24:25], v22 offset:16384
    ds_read_b64_tr_b16 v[26:27], v22 offset:16448
    ds_read_b64_tr_b16 v[28:29], v22 offset:18432
    ds_read_b64_tr_b16 v[30:31], v22 offset:18496
    ds_read_b64_tr_b16 v[32:33], v22 offset:16416
    ds_read_b64_tr_b16 v[34:35], v22 offset:16480
    ds_read_b64_tr_b16 v[36:37], v22 offset:18464
    ds_read_b64_tr_b16 v[38:39], v22 offset:18528
    s_waitcnt lgkmcnt(0)
    ds_write_b128 v8, v[24:27] offset:16384
    ds_write_b128 v8, v[28:31] offset:17408
    ds_write_b128 v8, v[32:35] offset:18432
    ds_write_b128 v8, v[36:39] offset:19456
    s_waitcnt lgkmcnt(0)
    s_waitcnt vmcnt(10)
    ds_read_b64_tr_b16 v[24:25], v22 offset:20480
    ds_read_b64_tr_b16 v[26:27], v22 offset:20544
    ds_read_b64_tr_b16 v[28:29], v22 offset:22528
    ds_read_b64_tr_b16 v[30:31], v22 offset:22592
    ds_read_b64_tr_b16 v[32:33], v22 offset:20512
    ds_read_b64_tr_b16 v[34:35], v22 offset:20576
    ds_read_b64_tr_b16 v[36:37], v22 offset:22560
    ds_read_b64_tr_b16 v[38:39], v22 offset:22624
    s_waitcnt lgkmcnt(0)
    ds_write_b128 v8, v[24:27] offset:20480
    ds_write_b128 v8, v[28:31] offset:21504
    ds_write_b128 v8, v[32:35] offset:22528
    ds_write_b128 v8, v[36:39] offset:23552
    s_waitcnt lgkmcnt(0)
    s_waitcnt vmcnt(6)
    ds_read_b64_tr_b16 v[24:25], v22 offset:24576
    ds_read_b64_tr_b16 v[26:27], v22 offset:24640
    ds_read_b64_tr_b16 v[28:29], v22 offset:26624
    ds_read_b64_tr_b16 v[30:31], v22 offset:26688
    ds_read_b64_tr_b16 v[32:33], v22 offset:24608
    ds_read_b64_tr_b16 v[34:35], v22 offset:24672
    ds_read_b64_tr_b16 v[36:37], v22 offset:26656
    ds_read_b64_tr_b16 v[38:39], v22 offset:26720
    s_waitcnt lgkmcnt(0)
    ds_write_b128 v8, v[24:27] offset:24576
    ds_write_b128 v8, v[28:31] offset:25600
    ds_write_b128 v8, v[32:35] offset:26624
    ds_write_b128 v8, v[36:39] offset:27648
    s_waitcnt lgkmcnt(0)
    s_waitcnt vmcnt(2)
    ds_read_b64_tr_b16 v[24:25], v22 offset:28672
    ds_read_b64_tr_b16 v[26:27], v22 offset:28736
    ds_read_b64_tr_b16 v[28:29], v22 offset:30720
    ds_read_b64_tr_b16 v[30:31], v22 offset:30784
    ds_read_b64_tr_b16 v[32:33], v22 offset:28704
    ds_read_b64_tr_b16 v[34:35], v22 offset:28768
    ds_read_b64_tr_b16 v[36:37], v22 offset:30752
    ds_read_b64_tr_b16 v[38:39], v22 offset:30816
    s_waitcnt lgkmcnt(0)
    ds_write_b128 v8, v[24:27] offset:28672
    ds_write_b128 v8, v[28:31] offset:29696
    ds_write_b128 v8, v[32:35] offset:30720
    ds_write_b128 v8, v[36:39] offset:31744
    s_waitcnt lgkmcnt(0)
    s_waitcnt vmcnt(0)
    ds_read_b64_tr_b16 v[24:25], v23 offset:32768
    ds_read_b64_tr_b16 v[26:27], v23 offset:32800
    ds_read_b64_tr_b16 v[28:29], v23 offset:33792
    ds_read_b64_tr_b16 v[30:31], v23 offset:33824
    s_waitcnt lgkmcnt(0)
    ds_write_b128 v8, v[24:27] offset:32768
    ds_write_b128 v8, v[28:31] offset:33792
    s_waitcnt lgkmcnt(0)
    v_bfe_u32 v9, v0, 4, 4
    v_mov_b32 v10, 0x3f80
    v_mov_b32 v16, 0x3f800000
    v_cmp_eq_u32 vcc, 0, v9
    v_cmp_eq_u32 s[48:49], 1, v9
    s_nop 0
    v_cndmask_b32 v12, 0, v10, vcc
    v_cndmask_b32 v12, v12, v16, s[48:49]
    v_cmp_eq_u32 vcc, 2, v9
    v_cmp_eq_u32 s[48:49], 3, v9
    s_nop 0
    v_cndmask_b32 v13, 0, v10, vcc
    v_cndmask_b32 v13, v13, v16, s[48:49]
    v_cmp_eq_u32 vcc, 4, v9
    v_cmp_eq_u32 s[48:49], 5, v9
    s_nop 0
    v_cndmask_b32 v14, 0, v10, vcc
    v_cndmask_b32 v14, v14, v16, s[48:49]
    v_cmp_eq_u32 vcc, 6, v9
    v_cmp_eq_u32 s[48:49], 7, v9
    s_nop 0
    v_cndmask_b32 v15, 0, v10, vcc
    v_cndmask_b32 v15, v15, v16, s[48:49]
    v_add_u32 v9, 162560, v0
    ds_write_b128 v9, v[12:15]
    s_waitcnt lgkmcnt(0)
    s_mov_b64 exec, 0xff
    v_lshrrev_b32 v14, 2, v0
    v_lshlrev_b32 v12, 5, v14
    v_and_b32 v12, 128, v12
    v_lshrrev_b32 v13, 1, v14
    v_and_or_b32 v12, v13, 12, v12
    s_mov_b32 s16, 0
L_pure:
    global_load_dword v13, v12, s[12:13] sc1
    s_add_u32 s16, s16, 1
    s_cmp_gt_u32 s16, 100000
    s_cbranch_scc1 Lr_abort
    s_mov_b32 s6, 0
    s_waitcnt vmcnt(0)
    v_readlane_b32 s7, v13, 0
    s_nop 0
    s_add_u32 s6, s6, s7
    v_readlane_b32 s7, v13, 1
    s_nop 0
    s_add_u32 s6, s6, s7
    v_readlane_b32 s7, v13, 2
    s_nop 0
    s_add_u32 s6, s6, s7
    v_readlane_b32 s7, v13, 3
    s_nop 0
    s_add_u32 s6, s6, s7
    v_readlane_b32 s7, v13, 4
    s_nop 0
    s_add_u32 s6, s6, s7
    v_readlane_b32 s7, v13, 5
    s_nop 0
    s_add_u32 s6, s6, s7
    v_readlane_b32 s7, v13, 6
    s_nop 0
    s_add_u32 s6, s6, s7
    v_readlane_b32 s7, v13, 7
    s_nop 0
    s_add_u32 s6, s6, s7
    v_readlane_b32 s7, v13, s32
    s_nop 0
    s_cmp_ge_u32 s7, 32
    s_cselect_b32 s51, 1, 0
    s_cselect_b32 s6, 256, s6
    s_cmp_lt_u32 s6, 256
    s_cbranch_scc1 L_pure
    s_mov_b64 exec, -1
    s_lshl_b32 s6, s32, 2
    s_add_u32 s6, s6, 192
    s_cmp_lg_u32 s14, 0
    s_cbranch_scc1 L_team_d
    v_mov_b32 v12, s6
    s_mov_b32 s16, 0
L_team:
    global_load_dword v13, v12, s[12:13] sc1
    s_add_u32 s16, s16, 1
    s_cmp_gt_u32 s16, 100000
    s_cbranch_scc1 Lr_abort
    s_waitcnt vmcnt(0)
    v_cmp_gt_u32 vcc, 32, v13
    s_nop 0
    s_cbranch_vccz L_team_d
    s_sleep 8
    s_branch L_team
L_team_d:
    s_barrier
    s_cmp_lg_u32 s14, 0
    s_cbranch_scc1 L_rpoola_d
    v_mov_b32 v12, 40
    s_mov_b32 s16, 0
L_rpoola:
    global_load_dword v13, v12, s[12:13] sc1
    s_add_u32 s16, s16, 1
    s_cmp_gt_u32 s16, 100000
    s_cbranch_scc1 Lr_abort
    s_waitcnt vmcnt(0)
    v_cmp_gt_u32 vcc, 72, v13
    s_nop 0
    s_cbranch_vccz L_rpoola_d
    s_sleep 8
    s_branch L_rpoola
L_rpoola_d:
    s_barrier
    s_cmp_eq_u32 s32, 0
    s_cbranch_scc1 L_rpool_skip
    s_cmp_lg_u32 s14, 0
    s_cbranch_scc1 L_rpool_d
    v_mov_b32 v12, 160
    s_mov_b32 s16, 0
L_rpool:
    global_load_dword v13, v12, s[12:13] sc1
    s_add_u32 s16, s16, 1
    s_cmp_gt_u32 s16, 100000
    s_cbranch_scc1 Lr_abort
    s_waitcnt vmcnt(0)
    v_cmp_gt_u32 vcc, 64, v13
    s_nop 0
    s_cbranch_vccz L_rpool_d
    s_sleep 8
    s_branch L_rpool
L_rpool_d:
    s_barrier
L_rpool_skip:
    s_barrier
    s_cmp_eq_u32 s51, 0
    s_cbranch_scc1 L_slow
    s_cmp_lg_u32 s14, 0
    s_cbranch_scc1 L_w1_1
    s_mov_b32 s16, 0
    s_add_u32 s17, s66, 128
    v_lshrrev_b32 v10, 2, v0
    v_and_b32 v9, 16, v10
    v_lshlrev_b32 v9, 3, v9
    v_and_or_b32 v10, v10, 12, v9
Lr0f_fw_10:
    buffer_load_dword v9, v10, s[8:11], s17 offen sc1
    s_add_u32 s16, s16, 1
    s_cmp_gt_u32 s16, 100000
    s_cbranch_scc1 Lr_abort
    s_waitcnt vmcnt(0)
    v_cmp_eq_u32 vcc, 0, v9
    s_nop 0
    s_cbranch_vccnz Lr0f_fw_10
    s_mov_b32 m0, 15104
    s_nop 0
    buffer_load_dwordx4 v0, s[8:11], s41 offen offset:0 lds
    buffer_load_dwordx4 v0, s[8:11], s41 offen offset:1024 lds
    s_add_u32 s41, s41, 262144
    s_add_u32 s68, s68, 4278452224
    s_waitcnt vmcnt(0)
    ds_read_b128 v[56:59], v8 offset:0
    ds_read_b128 v[60:63], v8 offset:1024
    ds_read_b128 v[64:67], v8 offset:2048
    ds_read_b128 v[68:71], v8 offset:3072
    v_mov_b64 v[12:13], 0
    v_mov_b64 v[14:15], 0
    v_mov_b64 v[16:17], 0
    v_mov_b64 v[18:19], 0
    v_mov_b64 v[20:21], 0
    v_mov_b64 v[22:23], 0
    v_mov_b64 v[24:25], 0
    v_mov_b64 v[26:27], 0
    v_mov_b64 v[28:29], 0
    v_mov_b64 v[30:31], 0
    v_mov_b64 v[32:33], 0
    v_mov_b64 v[34:35], 0
    buffer_load_dwordx4 v[36:39], v0, s[8:11], s34 offen sc1
    s_waitcnt vmcnt(0) lgkmcnt(0)
Lr0f_step:
    s_mov_b32 s16, 0
Lr0f_alp:
    s_waitcnt vmcnt(2)
    v_max3_u32 v10, v36, v37, v38
    v_max_u32 v10, v10, v39
    v_cmp_eq_u32 vcc, -1, v10
    s_nop 0
    s_cbranch_vccz Lr0f_aok
    buffer_load_dwordx4 v[36:39], v0, s[8:11], s34 offen sc1
    s_add_u32 s16, s16, 1
    s_cmp_gt_u32 s16, 100000
    s_cbranch_scc1 Lr_abort
    s_branch Lr0f_alp
Lr0f_aok:
    ds_write_b128 v0, v[36:39] offset:6912
    v_smfmac_f32_16x16x64_bf16 v[12:15], v[36:39], v[72:79], v1
    v_smfmac_f32_16x16x64_bf16 v[16:19], v[36:39], v[80:87], v1
    v_smfmac_f32_16x16x64_bf16 v[20:23], v[36:39], v[184:191], v1
    s_waitcnt lgkmcnt(0)
    s_barrier
    ds_read_b128 v[48:51], v0 offset:7936
    ds_read_b128 v[52:55], v0 offset:8960
    v_smfmac_f32_16x16x64_bf16 v[28:31], v[36:39], v[56:63], v1
    ds_read_b128 v[56:59], v8 offset:4096
    ds_read_b128 v[60:63], v8 offset:5120
    s_add_u32 s17, s34, 4096
    buffer_load_dwordx4 v[40:43], v0, s[8:11], s17 offen sc1
    v_smfmac_f32_16x16x64_bf16 v[24:27], v[36:39], v[192:199], v1
    v_smfmac_f32_16x16x64_bf16 v[32:35], v[36:39], v[64:71], v1
    ds_read_b128 v[64:67], v8 offset:6144
    ds_read_b128 v[68:71], v8 offset:7168
    s_waitcnt vmcnt(1)
    ds_read_b128 v[36:39], v0 offset:9984
    s_waitcnt lgkmcnt(6)
    v_smfmac_f32_16x16x64_bf16 v[28:31], v[48:51], a[72:79], v1
    v_smfmac_f32_16x16x64_bf16 v[12:15], v[48:51], v[88:95], v1
    buffer_load_dwordx4 v[44:47], v0, s[8:11], s35 offen sc1
    v_smfmac_f32_16x16x64_bf16 v[16:19], v[48:51], v[96:103], v1
    v_smfmac_f32_16x16x64_bf16 v[32:35], v[48:51], a[80:87], v1
    v_smfmac_f32_16x16x64_bf16 v[20:23], v[48:51], v[200:207], v1
    v_smfmac_f32_16x16x64_bf16 v[24:27], v[48:51], v[208:215], v1
    s_waitcnt lgkmcnt(3)
    v_smfmac_f32_16x16x64_bf16 v[28:31], v[52:55], v[56:63], v1
    ds_read_b128 v[56:59], v8 offset:8192
    ds_read_b128 v[60:63], v8 offset:9216
    v_smfmac_f32_16x16x64_bf16 v[12:15], v[52:55], v[104:111], v1
    v_smfmac_f32_16x16x64_bf16 v[16:19], v[52:55], v[112:119], v1
    s_waitcnt lgkmcnt(3)
    v_smfmac_f32_16x16x64_bf16 v[32:35], v[52:55], v[64:71], v1
    ds_read_b128 v[64:67], v8 offset:10240
    ds_read_b128 v[68:71], v8 offset:11264
    v_smfmac_f32_16x16x64_bf16 v[20:23], v[52:55], v[216:223], v1
    v_smfmac_f32_16x16x64_bf16 v[24:27], v[52:55], v[224:231], v1
    s_waitcnt lgkmcnt(4)
    v_smfmac_f32_16x16x64_bf16 v[28:31], v[36:39], a[88:95], v1
    v_smfmac_f32_16x16x64_bf16 v[12:15], v[36:39], v[120:127], v1
    v_smfmac_f32_16x16x64_bf16 v[16:19], v[36:39], v[128:135], v1
    v_smfmac_f32_16x16x64_bf16 v[32:35], v[36:39], a[96:103], v1
    v_smfmac_f32_16x16x64_bf16 v[20:23], v[36:39], v[232:239], v1
    v_smfmac_f32_16x16x64_bf16 v[24:27], v[36:39], v[240:247], v1
    s_waitcnt vmcnt(1)
    v_max3_u32 v10, v40, v41, v42
    v_max_u32 v10, v10, v43
    v_cmp_eq_u32 vcc, -1, v10
    s_nop 0
    s_cbranch_vccnz Lr0f_pb_re
Lr0f_pb_ok:
    ds_write_b128 v0, v[40:43] offset:11008
    s_waitcnt lgkmcnt(3)
    v_smfmac_f32_16x16x64_bf16 v[12:15], v[40:43], v[56:63], v1
    ds_read_b128 v[56:59], v8 offset:12288
    ds_read_b128 v[60:63], v8 offset:13312
    v_smfmac_f32_16x16x64_bf16 v[20:23], v[40:43], v[248:255], v1
    s_waitcnt lgkmcnt(3)
    v_smfmac_f32_16x16x64_bf16 v[16:19], v[40:43], v[64:71], v1
    ds_read_b128 v[64:67], v8 offset:14336
    ds_read_b128 v[68:71], v8 offset:15360
    v_smfmac_f32_16x16x64_bf16 v[24:27], v[40:43], a[0:7], v1
    s_waitcnt lgkmcnt(4)
    s_barrier
    ds_read_b128 v[48:51], v0 offset:13056
    ds_read_b128 v[52:55], v0 offset:12032
    ds_read_b128 v[36:39], v0 offset:14080
    v_smfmac_f32_16x16x64_bf16 v[28:31], v[40:43], a[104:111], v1
    v_smfmac_f32_16x16x64_bf16 v[32:35], v[40:43], a[112:119], v1
    s_waitcnt lgkmcnt(2)
    v_smfmac_f32_16x16x64_bf16 v[12:15], v[48:51], v[56:63], v1
    v_smfmac_f32_16x16x64_bf16 v[16:19], v[48:51], v[64:71], v1
    s_waitcnt lgkmcnt(1)
    v_smfmac_f32_16x16x64_bf16 v[12:15], v[52:55], v[136:143], v1
    v_smfmac_f32_16x16x64_bf16 v[16:19], v[52:55], v[144:151], v1
    s_waitcnt lgkmcnt(0)
    v_smfmac_f32_16x16x64_bf16 v[12:15], v[36:39], v[152:159], v1
    v_smfmac_f32_16x16x64_bf16 v[16:19], v[36:39], v[160:167], v1
    s_waitcnt vmcnt(0)
    v_max3_u32 v10, v44, v45, v46
    v_max_u32 v10, v10, v47
    v_cmp_eq_u32 vcc, -1, v10
    s_nop 0
    s_cbranch_vccnz Lr0f_pc_re
Lr0f_pc_ok:
    v_smfmac_f32_16x16x64_bf16 v[12:15], v[44:47], v[168:175], v1
    v_smfmac_f32_16x16x64_bf16 v[16:19], v[44:47], v[176:183], v1
    v_smfmac_f32_16x16x64_bf16 v[20:23], v[48:51], a[24:31], v1
    buffer_load_dwordx4 v[64:67], v0, s[8:11], s42 offen
    v_smfmac_f32_16x16x64_bf16 v[24:27], v[48:51], a[32:39], v1
    v_smfmac_f32_16x16x64_bf16 v[20:23], v[52:55], a[8:15], v1
    v_add_f32 v12, v12, v14
    v_smfmac_f32_16x16x64_bf16 v[24:27], v[52:55], a[16:23], v1
    v_add_f32 v16, v16, v18
    v_smfmac_f32_16x16x64_bf16 v[20:23], v[36:39], a[40:47], v1
    v_add_f32 v13, v13, v15
    buffer_load_dwordx4 v[68:71], v0, s[8:11], s42 offen offset:1024
    v_smfmac_f32_16x16x64_bf16 v[24:27], v[36:39], a[48:55], v1
    v_add_f32 v17, v17, v19
    v_smfmac_f32_16x16x64_bf16 v[20:23], v[44:47], a[56:63], v1
    v_cvt_pk_bf16_f32 v14, v12, v16
    ds_read_b128 v[56:59], v0 offset:15104
    v_smfmac_f32_16x16x64_bf16 v[24:27], v[44:47], a[64:71], v1
    v_cvt_pk_bf16_f32 v15, v13, v17
    ds_read_b128 v[60:63], v0 offset:16128
    ds_write_b32 v2, v14 offset:576
    ds_write_b32 v2, v15 offset:864
    v_smfmac_f32_16x16x64_bf16 v[28:31], v[48:51], a[136:143], v1
    v_smfmac_f32_16x16x64_bf16 v[32:35], v[48:51], a[144:151], v1
    v_add_f32 v20, v20, v22
    v_add_f32 v24, v24, v26
    v_add_f32 v21, v21, v23
    v_add_f32 v25, v25, v27
    v_cvt_pk_bf16_f32 v22, v20, v24
    v_cvt_pk_bf16_f32 v23, v21, v25
    ds_write_b32 v2, v22 offset:0
    ds_write_b32 v2, v23 offset:288
    v_smfmac_f32_16x16x64_bf16 v[28:31], v[52:55], a[120:127], v1
    v_smfmac_f32_16x16x64_bf16 v[32:35], v[52:55], a[128:135], v1
    s_waitcnt lgkmcnt(0)
    s_barrier
    ds_read_b128 v[40:43], v3 offset:0
    ds_read_b128 v[48:51], v3 offset:64
    ds_read_b128 v[20:23], v3 offset:128
    ds_read_b128 v[52:55], v3 offset:192
    v_smfmac_f32_16x16x64_bf16 v[28:31], v[36:39], a[152:159], v1
    v_smfmac_f32_16x16x64_bf16 v[32:35], v[36:39], a[160:167], v1
    ds_read_b128 v[36:39], v0 offset:17152
    v_lshlrev_b32 v9, 3, v0
    buffer_load_dword v11, v9, s[8:11], s68 offen
    v_smfmac_f32_16x16x64_bf16 v[28:31], v[44:47], a[168:175], v1
    v_smfmac_f32_16x16x64_bf16 v[32:35], v[44:47], a[176:183], v1
    ds_read_b128 v[44:47], v0 offset:18176
    s_waitcnt lgkmcnt(5)
    v_mfma_f32_16x16x32_bf16 v[12:15], v[56:59], v[40:43], 0
    v_mfma_f32_16x16x32_bf16 v[16:19], v[60:63], v[40:43], 0
    v_mfma_f32_16x16x32_bf16 v[24:27], v[40:43], v[40:43], 0
    ds_read_b128 v[56:59], v0 offset:19200
    ds_read_b128 v[60:63], v0 offset:20224
    s_waitcnt lgkmcnt(3)
    v_mfma_f32_16x16x32_bf16 v[12:15], v[36:39], v[48:51], v[12:15]
    v_lshrrev_b32 v10, 1, v0
    v_lshrrev_b32 v9, 9, v0
    s_waitcnt lgkmcnt(2)
    v_mfma_f32_16x16x32_bf16 v[16:19], v[44:47], v[48:51], v[16:19]
    v_lshl_add_u32 v9, v9, 5, v10
    v_add_f32 v28, v28, v30
    v_mfma_f32_16x16x32_bf16 v[24:27], v[48:51], v[48:51], v[24:27]
    v_add_f32 v32, v32, v34
    v_add_f32 v29, v29, v31
    ds_read_b128 v[36:39], v0 offset:21248
    ds_read_b128 v[44:47], v0 offset:22272
    s_waitcnt lgkmcnt(3)
    v_mfma_f32_16x16x32_bf16 v[12:15], v[56:59], v[20:23], v[12:15]
    v_add_f32 v33, v33, v35
    v_cvt_pk_bf16_f32 v30, v28, v29
    s_waitcnt lgkmcnt(2)
    v_mfma_f32_16x16x32_bf16 v[16:19], v[60:63], v[20:23], v[16:19]
    v_cvt_pk_bf16_f32 v31, v32, v33
    ds_read_b64 v[34:35], v9 offset:0
    v_mfma_f32_16x16x32_bf16 v[24:27], v[20:23], v[20:23], v[24:27]
    s_add_u32 s17, s43, 2048
    buffer_store_dwordx2 v[30:31], v10, s[8:11], s17 offen sc1
    s_waitcnt lgkmcnt(2)
    v_mfma_f32_16x16x32_bf16 v[12:15], v[36:39], v[52:55], v[12:15]
    s_waitcnt lgkmcnt(1)
    v_mfma_f32_16x16x32_bf16 v[16:19], v[44:47], v[52:55], v[16:19]
    v_mfma_f32_16x16x32_bf16 v[24:27], v[52:55], v[52:55], v[24:27]
    s_add_u32 s17, s43, 0
    s_waitcnt lgkmcnt(0)
    buffer_store_dwordx2 v[34:35], v10, s[8:11], s17 offen sc1
    s_cmp_eq_u32 s33, 63
    s_cbranch_scc1 Lr0f_last
    ds_read_b128 v[56:59], v8 offset:16384
    ds_read_b128 v[60:63], v8 offset:17408
    v_mov_b64 v[20:21], s[52:53]
    v_mov_b64 v[22:23], s[52:53]
    v_mov_b32 v41, 0
    v_mov_b32 v42, 0
    v_max3_f32 v9, v12, v13, v14
    v_max3_f32 v9, v9, v15, v16
    v_max3_f32 v9, v9, v17, v18
    v_max3_f32 v9, v9, v19, v24
    v_max_f32 v9, v9, v25
    v_mov_b32 v10, v9
    v_mov_b64 v[32:33], 0
    v_mov_b64 v[34:35], 0
    v_permlane32_swap_b32 v9, v10
    v_max_f32 v9, v9, v10
    v_mov_b32 v10, v9
    s_nop 1
    v_permlane16_swap_b32 v9, v10
    v_max_f32 v9, v9, v10
    v_mul_f32 v28, s44, v9
    v_fma_f32 v12, v12, s44, -v28
    v_fma_f32 v13, v13, s44, -v28
    v_fma_f32 v14, v14, s44, -v28
    v_fma_f32 v15, v15, s44, -v28
    v_exp_f32 v12, v12
    v_exp_f32 v13, v13
    v_fma_f32 v16, v16, s44, -v28
    v_fma_f32 v17, v17, s44, -v28
    v_exp_f32 v14, v14
    v_exp_f32 v15, v15
    v_cvt_pk_bf16_f32 v36, v12, v13
    v_fma_f32 v18, v18, s44, -v28
    v_fma_f32 v19, v19, s44, -v28
    v_exp_f32 v16, v16
    v_exp_f32 v17, v17
    v_cvt_pk_bf16_f32 v37, v14, v15
    v_fma_f32 v24, v24, s44, -v28
    v_fma_f32 v25, v25, s44, -v28
    v_exp_f32 v18, v18
    v_exp_f32 v19, v19
    v_cvt_pk_bf16_f32 v38, v16, v17
    v_exp_f32 v24, v24
    v_exp_f32 v25, v25
    v_cvt_pk_bf16_f32 v39, v18, v19
    v_cvt_pk_bf16_f32 v40, v24, v25
    v_cvt_pk_bf16_f32 v43, v24, v25
    v_mfma_f32_16x16x32_bf16 v[52:55], v[20:23], v[36:39], 0
    v_mov_b64 v[12:13], 0
    v_mov_b64 v[14:15], 0
    s_waitcnt vmcnt(4)
    v_mfma_f32_16x16x32_bf16 v[44:47], v[64:67], v[36:39], 0
    v_mov_b64 v[24:25], 0
    v_mov_b64 v[26:27], 0
    s_waitcnt vmcnt(3)
    v_mfma_f32_16x16x32_bf16 v[48:51], v[68:71], v[36:39], 0
    ds_read_b128 v[64:67], v8 offset:20480
    ds_read_b128 v[68:71], v8 offset:21504
    v_mfma_f32_16x16x16_bf16 v[52:55], v[20:21], v[40:41], v[52:55]
    v_mfma_f32_16x16x16_bf16 v[44:47], v[30:31], v[40:41], v[44:47]
    v_mov_b64 v[20:21], 0
    v_mov_b64 v[22:23], 0
    v_mfma_f32_16x16x16_bf16 v[48:51], v[30:31], v[42:43], v[48:51]
    v_mov_b64 v[36:37], 0
    v_mov_b64 v[38:39], 0
    v_mov_b64 v[40:41], 0
    v_mov_b64 v[42:43], 0
    v_rcp_f32 v9, v52
    v_mov_b64 v[52:53], 0
    v_mov_b64 v[54:55], 0
    v_mul_f32 v44, v9, v44
    v_mul_f32 v48, v9, v48
    v_cvt_pk_bf16_f32 v16, v44, v48
    v_mul_f32 v45, v9, v45
    v_mul_f32 v49, v9, v49
    v_cvt_pk_bf16_f32 v17, v45, v49
    v_mul_f32 v46, v9, v46
    v_mul_f32 v50, v9, v50
    v_cvt_pk_bf16_f32 v18, v46, v50
    v_mul_f32 v47, v9, v47
    v_mul_f32 v51, v9, v51
    v_cvt_pk_bf16_f32 v19, v47, v51
    ds_write_b128 v5, v[16:19]
    v_mov_b64 v[28:29], 0
    v_mov_b64 v[30:31], 0
    s_waitcnt lgkmcnt(0)
    s_barrier
    ds_read_b128 v[44:47], v4 offset:0
    ds_read_b128 v[48:51], v4 offset:128
    v_mov_b64 v[16:17], 0
    v_mov_b64 v[18:19], 0
    buffer_load_dwordx4 v0, s[8:11], s41 offen offset:0 lds
    buffer_load_dwordx4 v0, s[8:11], s41 offen offset:1024 lds
    s_waitcnt lgkmcnt(1)
    v_smfmac_f32_16x16x64_bf16 v[12:15], v[44:47], a[184:191], v1
    s_waitcnt lgkmcnt(0)
    v_smfmac_f32_16x16x64_bf16 v[12:15], v[48:51], a[192:199], v1
    v_smfmac_f32_16x16x64_bf16 v[24:27], v[44:47], a[200:207], v1
    v_smfmac_f32_16x16x64_bf16 v[24:27], v[48:51], a[208:215], v1
    v_add_f32 v12, v12, v14
    v_smfmac_f32_16x16x64_bf16 v[20:23], v[44:47], a[216:223], v1
    v_add_f32 v13, v13, v15
    v_smfmac_f32_16x16x64_bf16 v[20:23], v[48:51], a[224:231], v1
    v_cvt_pk_bf16_f32 v12, v12, v13
    v_smfmac_f32_16x16x64_bf16 v[16:19], v[44:47], a[232:239], v1
    v_add_f32 v24, v24, v26
    v_smfmac_f32_16x16x64_bf16 v[16:19], v[48:51], a[240:247], v1
    v_add_f32 v25, v25, v27
    v_smfmac_f32_16x16x64_bf16 v[36:39], v[44:47], v[56:63], v1
    v_cvt_pk_bf16_f32 v13, v24, v25
    v_smfmac_f32_16x16x64_bf16 v[36:39], v[48:51], v[64:71], v1
    v_add_f32 v20, v20, v22
    v_add_f32 v21, v21, v23
    v_cvt_pk_bf16_f32 v14, v20, v21
    v_add_f32 v16, v16, v18
    v_add_f32 v17, v17, v19
    v_cvt_pk_bf16_f32 v15, v16, v17
    v_and_or_b32 v15, v15, -2, s40
    buffer_store_dwordx4 v[12:15], v0, s[8:11], s38 offen
    s_nop 0
    ds_read_b128 v[12:15], v8 offset:18432
    ds_read_b128 v[16:19], v8 offset:19456
    ds_read_b128 v[20:23], v8 offset:22528
    ds_read_b128 v[24:27], v8 offset:23552
    ds_read_b128 v[56:59], v8 offset:24576
    ds_read_b128 v[60:63], v8 offset:25600
    ds_read_b128 v[64:67], v8 offset:28672
    ds_read_b128 v[68:71], v8 offset:29696
    s_waitcnt lgkmcnt(6)
    v_smfmac_f32_16x16x64_bf16 v[40:43], v[44:47], v[12:19], v1
    ds_read_b128 v[12:15], v8 offset:26624
    ds_read_b128 v[16:19], v8 offset:27648
    s_waitcnt lgkmcnt(6)
    v_smfmac_f32_16x16x64_bf16 v[40:43], v[48:51], v[20:27], v1
    ds_read_b128 v[20:23], v8 offset:30720
    ds_read_b128 v[24:27], v8 offset:31744
    s_waitcnt lgkmcnt(6)
    v_smfmac_f32_16x16x64_bf16 v[52:55], v[44:47], v[56:63], v1
    ds_read_b128 v[56:59], v8 offset:32768
    ds_read_b128 v[60:63], v8 offset:33792
    s_waitcnt lgkmcnt(6)
    v_smfmac_f32_16x16x64_bf16 v[52:55], v[48:51], v[64:71], v1
    s_waitcnt lgkmcnt(4)
    v_smfmac_f32_16x16x64_bf16 v[32:35], v[44:47], v[12:19], v1
    s_waitcnt lgkmcnt(2)
    v_smfmac_f32_16x16x64_bf16 v[32:35], v[48:51], v[20:27], v1
    v_smfmac_f32_16x16x64_bf16 v[28:31], v[44:47], a[248:255], v1
    s_waitcnt lgkmcnt(0)
    v_smfmac_f32_16x16x64_bf16 v[28:31], v[48:51], v[56:63], v1
    buffer_load_dwordx4 v[12:15], v6, s[8:11], s62 offen sc1
    buffer_load_dwordx4 v[16:19], v6, s[8:11], s63 offen sc1
    buffer_load_dwordx4 v[20:23], v6, s[8:11], s64 offen sc1
    buffer_load_dwordx4 v[24:27], v6, s[8:11], s65 offen sc1
    v_add_f32 v36, v36, v38
    v_add_f32 v37, v37, v39
    v_cvt_pk_bf16_f32 v36, v36, v37
    v_add_f32 v40, v40, v42
    v_add_f32 v41, v41, v43
    v_cvt_pk_bf16_f32 v37, v40, v41
    v_add_f32 v52, v52, v54
    v_add_f32 v53, v53, v55
    v_cvt_pk_bf16_f32 v38, v52, v53
    v_add_f32 v32, v32, v34
    v_add_f32 v33, v33, v35
    v_cvt_pk_bf16_f32 v39, v32, v33
    v_and_or_b32 v39, v39, -2, s40
    s_add_u32 s17, s38, 4096
    buffer_store_dwordx4 v[36:39], v0, s[8:11], s17 offen
    v_add_f32 v28, v28, v30
    v_add_f32 v29, v29, v31
    v_cvt_pk_bf16_f32 v28, v28, v29
    v_and_or_b32 v28, v28, -2, s40
    v_lshrrev_b32 v9, 2, v0
    buffer_store_dword v28, v9, s[8:11], s39 offen
    v_add_u32 v10, 162560, v0
    ds_read_b128 v[64:67], v10
    s_nop 9
    buffer_load_dwordx4 v[40:43], v6, s[8:11], s62 offen sc1
    buffer_load_dwordx4 v[44:47], v6, s[8:11], s63 offen sc1
    buffer_load_dwordx4 v[48:51], v6, s[8:11], s64 offen sc1
    buffer_load_dwordx4 v[52:55], v6, s[8:11], s65 offen sc1
    s_add_u32 s33, s33, 1
    s_add_u32 s42, s42, 262144
    s_add_u32 s41, s41, 262144
    s_add_u32 s43, s43, 131072
    s_add_u32 s68, s68, 262144
    s_add_u32 s66, s66, 22528
    ds_read_b128 v[56:59], v8 offset:0
    ds_read_b128 v[60:63], v8 offset:1024
    s_waitcnt lgkmcnt(2)
    s_waitcnt vmcnt(9)
    v_mfma_f32_16x16x32_bf16 v[68:71], v[12:15], v[64:67], 0
    v_and_b32 v10, 1, v15
    v_cmp_ne_u32 s[54:55], s40, v10
    s_waitcnt vmcnt(8)
    v_mfma_f32_16x16x32_bf16 v[68:71], v[16:19], v[64:67], v[68:71]
    v_and_b32 v10, 1, v19
    v_cmp_ne_u32 s[56:57], s40, v10
    s_waitcnt vmcnt(7)
    v_mfma_f32_16x16x32_bf16 v[68:71], v[20:23], v[64:67], v[68:71]
    v_and_b32 v10, 1, v23
    v_cmp_ne_u32 s[58:59], s40, v10
    s_waitcnt vmcnt(6)
    v_mfma_f32_16x16x32_bf16 v[68:71], v[24:27], v[64:67], v[68:71]
    v_and_b32 v10, 1, v27
    v_cmp_ne_u32 s[60:61], s40, v10
    s_or_b64 vcc, s[54:55], s[56:57]
    s_or_b64 vcc, vcc, s[58:59]
    s_or_b64 vcc, vcc, s[60:61]
    s_cbranch_scc0 Lr0f_red
    s_mov_b32 s16, 0
Lr0f_p1:
    buffer_load_dwordx4 v[12:15], v6, s[8:11], s62 offen sc1
    buffer_load_dwordx4 v[16:19], v6, s[8:11], s63 offen sc1
    buffer_load_dwordx4 v[20:23], v6, s[8:11], s64 offen sc1
    buffer_load_dwordx4 v[24:27], v6, s[8:11], s65 offen sc1
    s_waitcnt vmcnt(7)
    v_mfma_f32_16x16x32_bf16 v[68:71], v[40:43], v[64:67], 0
    v_and_b32 v10, 1, v43
    v_cmp_ne_u32 s[54:55], s40, v10
    s_waitcnt vmcnt(6)
    v_mfma_f32_16x16x32_bf16 v[68:71], v[44:47], v[64:67], v[68:71]
    v_and_b32 v10, 1, v47
    v_cmp_ne_u32 s[56:57], s40, v10
    s_waitcnt vmcnt(5)
    v_mfma_f32_16x16x32_bf16 v[68:71], v[48:51], v[64:67], v[68:71]
    v_and_b32 v10, 1, v51
    v_cmp_ne_u32 s[58:59], s40, v10
    s_waitcnt vmcnt(4)
    v_mfma_f32_16x16x32_bf16 v[68:71], v[52:55], v[64:67], v[68:71]
    v_and_b32 v10, 1, v55
    v_cmp_ne_u32 s[60:61], s40, v10
    s_or_b64 vcc, s[54:55], s[56:57]
    s_or_b64 vcc, vcc, s[58:59]
    s_or_b64 vcc, vcc, s[60:61]
    s_cbranch_scc0 Lr0f_red
    buffer_load_dwordx4 v[40:43], v6, s[8:11], s62 offen sc1
    buffer_load_dwordx4 v[44:47], v6, s[8:11], s63 offen sc1
    buffer_load_dwordx4 v[48:51], v6, s[8:11], s64 offen sc1
    buffer_load_dwordx4 v[52:55], v6, s[8:11], s65 offen sc1
    s_add_u32 s16, s16, 1
    s_cmp_gt_u32 s16, 100000
    s_cbranch_scc1 Lr_abort
    s_waitcnt vmcnt(7)
    v_mfma_f32_16x16x32_bf16 v[68:71], v[12:15], v[64:67], 0
    v_and_b32 v10, 1, v15
    v_cmp_ne_u32 s[54:55], s40, v10
    s_waitcnt vmcnt(6)
    v_mfma_f32_16x16x32_bf16 v[68:71], v[16:19], v[64:67], v[68:71]
    v_and_b32 v10, 1, v19
    v_cmp_ne_u32 s[56:57], s40, v10
    s_waitcnt vmcnt(5)
    v_mfma_f32_16x16x32_bf16 v[68:71], v[20:23], v[64:67], v[68:71]
    v_and_b32 v10, 1, v23
    v_cmp_ne_u32 s[58:59], s40, v10
    s_waitcnt vmcnt(4)
    v_mfma_f32_16x16x32_bf16 v[68:71], v[24:27], v[64:67], v[68:71]
    v_and_b32 v10, 1, v27
    v_cmp_ne_u32 s[60:61], s40, v10
    s_or_b64 vcc, s[54:55], s[56:57]
    s_or_b64 vcc, vcc, s[58:59]
    s_or_b64 vcc, vcc, s[60:61]
    s_cbranch_scc1 Lr0f_p1
Lr0f_red:
    s_nop 1
    v_permlane16_swap_b32 v68, v70
    v_permlane16_swap_b32 v69, v71
    s_mov_b64 exec, s[46:47]
    v_add_f32 v68, v68, v70
    v_add_f32 v69, v69, v71
    v_cvt_pk_bf16_f32 v68, v68, v69
    v_min_u32 v68, s50, v68
    buffer_store_dword v68, v7, s[8:11], s36 offen
    v_mov_b32 v69, -1
    buffer_store_dword v69, v7, s[8:11], s37 offen
    s_mov_b64 exec, -1
    s_xor_b32 s34, s34, 16384
    s_xor_b32 s35, s35, 16384
    s_xor_b32 s40, s40, 1
    s_xor_b32 s36, s36, 16384
    s_xor_b32 s37, s37, 16384
    s_nop 15
    s_nop 3
    buffer_load_dwordx4 v[36:39], v0, s[8:11], s34 offen sc1
    s_waitcnt vmcnt(3)
    ds_read_b128 v[64:67], v8 offset:2048
    ds_read_b128 v[68:71], v8 offset:3072
    v_mov_b64 v[12:13], 0
    v_mov_b64 v[14:15], 0
    v_mov_b64 v[16:17], 0
    v_mov_b64 v[18:19], 0
    v_mov_b64 v[20:21], 0
    v_mov_b64 v[22:23], 0
    v_mov_b64 v[24:25], 0
    v_mov_b64 v[26:27], 0
    v_mov_b64 v[28:29], 0
    v_mov_b64 v[30:31], 0
    v_mov_b64 v[32:33], 0
    v_mov_b64 v[34:35], 0
    s_nop 9
    buffer_load_dwordx4 v[36:39], v0, s[8:11], s34 offen sc1
    s_nop 15
    s_nop 8
    buffer_load_dwordx4 v[36:39], v0, s[8:11], s34 offen sc1
    s_waitcnt lgkmcnt(0)
    s_branch Lr0f_step
Lr0f_pb_re:
    s_mov_b32 s16, 0
Lr0f_pb_lp:
    s_add_u32 s17, s34, 4096
    buffer_load_dwordx4 v[40:43], v0, s[8:11], s17 offen sc1
    s_add_u32 s16, s16, 1
    s_cmp_gt_u32 s16, 100000
    s_cbranch_scc1 Lr_abort
    s_waitcnt vmcnt(0)
    v_max3_u32 v10, v40, v41, v42
    v_max_u32 v10, v10, v43
    v_cmp_eq_u32 vcc, -1, v10
    s_nop 0
    s_cbranch_vccnz Lr0f_pb_lp
    s_branch Lr0f_pb_ok
Lr0f_pc_re:
    s_mov_b32 s16, 0
Lr0f_pc_lp:
    buffer_load_dwordx4 v[44:47], v0, s[8:11], s35 offen sc1
    s_add_u32 s16, s16, 1
    s_cmp_gt_u32 s16, 100000
    s_cbranch_scc1 Lr_abort
    s_waitcnt vmcnt(0)
    v_max3_u32 v10, v44, v45, v46
    v_max_u32 v10, v10, v47
    v_cmp_eq_u32 vcc, -1, v10
    s_nop 0
    s_cbranch_vccnz Lr0f_pc_lp
    s_branch Lr0f_pc_ok
Lr0f_last:
    s_waitcnt vmcnt(0) lgkmcnt(0)
    s_barrier
    s_branch Lr_exit
L_w1_1:
    s_cmp_lg_u32 s14, 1
    s_cbranch_scc1 L_w2_1
    s_mov_b32 s16, 0
    s_add_u32 s17, s66, 128
    v_lshrrev_b32 v10, 2, v0
    v_and_b32 v9, 16, v10
    v_lshlrev_b32 v9, 3, v9
    v_and_or_b32 v10, v10, 12, v9
Lr1f_fw_11:
    buffer_load_dword v9, v10, s[8:11], s17 offen sc1
    s_add_u32 s16, s16, 1
    s_cmp_gt_u32 s16, 100000
    s_cbranch_scc1 Lr_abort
    s_waitcnt vmcnt(0)
    v_cmp_eq_u32 vcc, 0, v9
    s_nop 0
    s_cbranch_vccnz Lr1f_fw_11
    s_lshl_b32 s67, s32, 5
    s_add_u32 s67, s67, s15
    s_lshl_b32 s67, s67, 12
    s_add_u32 s67, s67, 3145728
    s_mov_b32 m0, 17152
    s_nop 0
    buffer_load_dwordx4 v0, s[8:11], s41 offen offset:0 lds
    buffer_load_dwordx4 v0, s[8:11], s41 offen offset:1024 lds
    s_add_u32 s41, s41, 262144
    s_add_u32 s68, s68, 262144
    s_waitcnt vmcnt(0)
    ds_read_b128 v[56:59], v8 offset:4096
    ds_read_b128 v[60:63], v8 offset:5120
    ds_read_b128 v[64:67], v8 offset:6144
    ds_read_b128 v[68:71], v8 offset:7168
    v_mov_b64 v[12:13], 0
    v_mov_b64 v[14:15], 0
    v_mov_b64 v[16:17], 0
    v_mov_b64 v[18:19], 0
    v_mov_b64 v[20:21], 0
    v_mov_b64 v[22:23], 0
    v_mov_b64 v[24:25], 0
    v_mov_b64 v[26:27], 0
    v_mov_b64 v[28:29], 0
    v_mov_b64 v[30:31], 0
    v_mov_b64 v[32:33], 0
    v_mov_b64 v[34:35], 0
    buffer_load_dwordx4 v[36:39], v0, s[8:11], s34 offen sc1
    s_waitcnt vmcnt(0) lgkmcnt(0)
Lr1f_step:
    s_waitcnt vmcnt(3)
    v_max3_u32 v10, v36, v37, v38
    v_max_u32 v10, v10, v39
    v_cmp_eq_u32 vcc, -1, v10
    s_nop 0
    s_cbranch_vccz Lr1f_aok
    buffer_load_dwordx4 v[36:39], v0, s[8:11], s34 offen sc1
    s_nop 15
    s_nop 8
    buffer_load_dwordx4 v[36:39], v0, s[8:11], s34 offen sc1
    s_mov_b32 s16, 0
Lr1f_alp:
    s_waitcnt vmcnt(2)
    v_max3_u32 v10, v36, v37, v38
    v_max_u32 v10, v10, v39
    v_cmp_eq_u32 vcc, -1, v10
    s_nop 0
    s_cbranch_vccz Lr1f_aok
    buffer_load_dwordx4 v[36:39], v0, s[8:11], s34 offen sc1
    s_add_u32 s16, s16, 1
    s_cmp_gt_u32 s16, 100000
    s_cbranch_scc1 Lr_abort
    s_branch Lr1f_alp
Lr1f_aok:
    ds_write_b128 v0, v[36:39] offset:7936
    v_smfmac_f32_16x16x64_bf16 v[12:15], v[36:39], v[88:95], v1
    v_smfmac_f32_16x16x64_bf16 v[16:19], v[36:39], v[96:103], v1
    v_smfmac_f32_16x16x64_bf16 v[20:23], v[36:39], v[200:207], v1
    s_waitcnt lgkmcnt(0)
    s_barrier
    ds_read_b128 v[48:51], v0 offset:8960
    ds_read_b128 v[52:55], v0 offset:9984
    v_smfmac_f32_16x16x64_bf16 v[28:31], v[36:39], a[72:79], v1
    v_smfmac_f32_16x16x64_bf16 v[24:27], v[36:39], v[208:215], v1
    s_add_u32 s17, s34, 4096
    buffer_load_dwordx4 v[40:43], v0, s[8:11], s17 offen sc1
    v_smfmac_f32_16x16x64_bf16 v[32:35], v[36:39], a[80:87], v1
    s_waitcnt vmcnt(1)
    ds_read_b128 v[36:39], v0 offset:6912
    s_waitcnt lgkmcnt(2)
    v_smfmac_f32_16x16x64_bf16 v[28:31], v[48:51], v[56:63], v1
    ds_read_b128 v[56:59], v8 offset:0
    ds_read_b128 v[60:63], v8 offset:1024
    v_smfmac_f32_16x16x64_bf16 v[12:15], v[48:51], v[104:111], v1
    v_smfmac_f32_16x16x64_bf16 v[16:19], v[48:51], v[112:119], v1
    buffer_load_dwordx4 v[44:47], v0, s[8:11], s35 offen sc1
    v_smfmac_f32_16x16x64_bf16 v[32:35], v[48:51], v[64:71], v1
    ds_read_b128 v[64:67], v8 offset:2048
    ds_read_b128 v[68:71], v8 offset:3072
    v_smfmac_f32_16x16x64_bf16 v[20:23], v[48:51], v[216:223], v1
    v_smfmac_f32_16x16x64_bf16 v[24:27], v[48:51], v[224:231], v1
    s_waitcnt lgkmcnt(5)
    v_smfmac_f32_16x16x64_bf16 v[28:31], v[52:55], a[88:95], v1
    v_smfmac_f32_16x16x64_bf16 v[12:15], v[52:55], v[120:127], v1
    v_smfmac_f32_16x16x64_bf16 v[16:19], v[52:55], v[128:135], v1
    v_smfmac_f32_16x16x64_bf16 v[32:35], v[52:55], a[96:103], v1
    v_smfmac_f32_16x16x64_bf16 v[20:23], v[52:55], v[232:239], v1
    v_smfmac_f32_16x16x64_bf16 v[24:27], v[52:55], v[240:247], v1
    s_waitcnt lgkmcnt(2)
    v_smfmac_f32_16x16x64_bf16 v[28:31], v[36:39], v[56:63], v1
    ds_read_b128 v[56:59], v8 offset:12288
    ds_read_b128 v[60:63], v8 offset:13312
    v_smfmac_f32_16x16x64_bf16 v[12:15], v[36:39], v[72:79], v1
    v_smfmac_f32_16x16x64_bf16 v[16:19], v[36:39], v[80:87], v1
    s_waitcnt lgkmcnt(2)
    v_smfmac_f32_16x16x64_bf16 v[32:35], v[36:39], v[64:71], v1
    ds_read_b128 v[64:67], v8 offset:14336
    ds_read_b128 v[68:71], v8 offset:15360
    v_smfmac_f32_16x16x64_bf16 v[20:23], v[36:39], v[184:191], v1
    v_smfmac_f32_16x16x64_bf16 v[24:27], v[36:39], v[192:199], v1
    s_waitcnt vmcnt(1)
    v_max3_u32 v10, v40, v41, v42
    v_max_u32 v10, v10, v43
    v_cmp_eq_u32 vcc, -1, v10
    s_nop 0
    s_cbranch_vccnz Lr1f_pb_re
Lr1f_pb_ok:
    ds_write_b128 v0, v[40:43] offset:12032
    v_mov_b32 v9, 1
    v_mov_b32 v10, 0
    s_mov_b64 exec, 1
    buffer_store_dword v9, v10, s[8:11], s67 offen offset:384 sc1
    s_mov_b64 exec, -1
    v_smfmac_f32_16x16x64_bf16 v[12:15], v[40:43], v[136:143], v1
    v_smfmac_f32_16x16x64_bf16 v[20:23], v[40:43], a[8:15], v1
    v_smfmac_f32_16x16x64_bf16 v[16:19], v[40:43], v[144:151], v1
    v_smfmac_f32_16x16x64_bf16 v[24:27], v[40:43], a[16:23], v1
    s_waitcnt lgkmcnt(0)
    s_barrier
    ds_read_b128 v[48:51], v0 offset:13056
    ds_read_b128 v[52:55], v0 offset:14080
    ds_read_b128 v[36:39], v0 offset:11008
    v_smfmac_f32_16x16x64_bf16 v[28:31], v[40:43], a[120:127], v1
    v_smfmac_f32_16x16x64_bf16 v[32:35], v[40:43], a[128:135], v1
    s_waitcnt lgkmcnt(2)
    v_smfmac_f32_16x16x64_bf16 v[12:15], v[48:51], v[56:63], v1
    ds_read_b128 v[56:59], v8 offset:8192
    ds_read_b128 v[60:63], v8 offset:9216
    v_smfmac_f32_16x16x64_bf16 v[16:19], v[48:51], v[64:71], v1
    ds_read_b128 v[64:67], v8 offset:10240
    ds_read_b128 v[68:71], v8 offset:11264
    s_waitcnt lgkmcnt(5)
    v_smfmac_f32_16x16x64_bf16 v[12:15], v[52:55], v[152:159], v1
    v_smfmac_f32_16x16x64_bf16 v[16:19], v[52:55], v[160:167], v1
    s_waitcnt vmcnt(1)
    v_max3_u32 v10, v44, v45, v46
    v_max_u32 v10, v10, v47
    v_cmp_eq_u32 vcc, -1, v10
    s_nop 0
    s_cbranch_vccnz Lr1f_pc_re
Lr1f_pc_ok:
    v_smfmac_f32_16x16x64_bf16 v[12:15], v[44:47], v[168:175], v1
    v_smfmac_f32_16x16x64_bf16 v[16:19], v[44:47], v[176:183], v1
    s_waitcnt lgkmcnt(2)
    v_smfmac_f32_16x16x64_bf16 v[12:15], v[36:39], v[56:63], v1
    s_waitcnt lgkmcnt(0)
    v_smfmac_f32_16x16x64_bf16 v[16:19], v[36:39], v[64:71], v1
    v_smfmac_f32_16x16x64_bf16 v[20:23], v[48:51], a[24:31], v1
    v_smfmac_f32_16x16x64_bf16 v[24:27], v[48:51], a[32:39], v1
    buffer_load_dwordx4 v[64:67], v0, s[8:11], s42 offen
    v_smfmac_f32_16x16x64_bf16 v[20:23], v[52:55], a[40:47], v1
    v_add_f32 v12, v12, v14
    v_smfmac_f32_16x16x64_bf16 v[24:27], v[52:55], a[48:55], v1
    v_add_f32 v16, v16, v18
    v_smfmac_f32_16x16x64_bf16 v[20:23], v[36:39], v[248:255], v1
    v_add_f32 v13, v13, v15
    v_smfmac_f32_16x16x64_bf16 v[24:27], v[36:39], a[0:7], v1
    v_add_f32 v17, v17, v19
    buffer_load_dwordx4 v[68:71], v0, s[8:11], s42 offen offset:1024
    v_smfmac_f32_16x16x64_bf16 v[20:23], v[44:47], a[56:63], v1
    v_cvt_pk_bf16_f32 v14, v12, v16
    ds_read_b128 v[56:59], v0 offset:15104
    v_smfmac_f32_16x16x64_bf16 v[24:27], v[44:47], a[64:71], v1
    v_cvt_pk_bf16_f32 v15, v13, v17
    ds_read_b128 v[60:63], v0 offset:16128
    ds_write_b32 v2, v14 offset:576
    ds_write_b32 v2, v15 offset:864
    v_smfmac_f32_16x16x64_bf16 v[28:31], v[48:51], a[136:143], v1
    v_smfmac_f32_16x16x64_bf16 v[32:35], v[48:51], a[144:151], v1
    v_add_f32 v20, v20, v22
    v_add_f32 v24, v24, v26
    v_add_f32 v21, v21, v23
    v_add_f32 v25, v25, v27
    v_cvt_pk_bf16_f32 v22, v20, v24
    v_cvt_pk_bf16_f32 v23, v21, v25
    ds_write_b32 v2, v22 offset:0
    ds_write_b32 v2, v23 offset:288
    v_smfmac_f32_16x16x64_bf16 v[28:31], v[52:55], a[152:159], v1
    v_smfmac_f32_16x16x64_bf16 v[32:35], v[52:55], a[160:167], v1
    s_waitcnt lgkmcnt(0)
    s_barrier
    ds_read_b128 v[40:43], v3 offset:0
    ds_read_b128 v[48:51], v3 offset:64
    ds_read_b128 v[20:23], v3 offset:128
    ds_read_b128 v[52:55], v3 offset:192
    v_smfmac_f32_16x16x64_bf16 v[28:31], v[36:39], a[104:111], v1
    v_smfmac_f32_16x16x64_bf16 v[32:35], v[36:39], a[112:119], v1
    ds_read_b128 v[36:39], v0 offset:17152
    v_smfmac_f32_16x16x64_bf16 v[28:31], v[44:47], a[168:175], v1
    v_smfmac_f32_16x16x64_bf16 v[32:35], v[44:47], a[176:183], v1
    ds_read_b128 v[44:47], v0 offset:18176
    s_waitcnt lgkmcnt(5)
    v_mfma_f32_16x16x32_bf16 v[12:15], v[56:59], v[40:43], 0
    v_mfma_f32_16x16x32_bf16 v[16:19], v[60:63], v[40:43], 0
    v_mfma_f32_16x16x32_bf16 v[24:27], v[40:43], v[40:43], 0
    ds_read_b128 v[56:59], v0 offset:19200
    ds_read_b128 v[60:63], v0 offset:20224
    s_waitcnt lgkmcnt(3)
    v_mfma_f32_16x16x32_bf16 v[12:15], v[36:39], v[48:51], v[12:15]
    v_lshrrev_b32 v10, 1, v0
    v_lshrrev_b32 v9, 9, v0
    s_waitcnt lgkmcnt(2)
    v_mfma_f32_16x16x32_bf16 v[16:19], v[44:47], v[48:51], v[16:19]
    v_lshl_add_u32 v9, v9, 5, v10
    v_add_f32 v28, v28, v30
    v_mfma_f32_16x16x32_bf16 v[24:27], v[48:51], v[48:51], v[24:27]
    v_add_f32 v32, v32, v34
    v_add_f32 v29, v29, v31
    ds_read_b128 v[36:39], v0 offset:21248
    ds_read_b128 v[44:47], v0 offset:22272
    s_waitcnt lgkmcnt(3)
    v_mfma_f32_16x16x32_bf16 v[12:15], v[56:59], v[20:23], v[12:15]
    v_add_f32 v33, v33, v35
    v_cvt_pk_bf16_f32 v30, v28, v29
    s_waitcnt lgkmcnt(2)
    v_mfma_f32_16x16x32_bf16 v[16:19], v[60:63], v[20:23], v[16:19]
    v_cvt_pk_bf16_f32 v31, v32, v33
    ds_read_b64 v[34:35], v9 offset:1152
    v_mfma_f32_16x16x32_bf16 v[24:27], v[20:23], v[20:23], v[24:27]
    s_add_u32 s17, s43, 2560
    buffer_store_dwordx2 v[30:31], v10, s[8:11], s17 offen sc1
    s_waitcnt lgkmcnt(2)
    v_mfma_f32_16x16x32_bf16 v[12:15], v[36:39], v[52:55], v[12:15]
    s_waitcnt lgkmcnt(1)
    v_mfma_f32_16x16x32_bf16 v[16:19], v[44:47], v[52:55], v[16:19]
    v_mfma_f32_16x16x32_bf16 v[24:27], v[52:55], v[52:55], v[24:27]
    s_add_u32 s17, s43, 512
    s_waitcnt lgkmcnt(0)
    buffer_store_dwordx2 v[34:35], v10, s[8:11], s17 offen sc1
    s_cmp_eq_u32 s33, 63
    s_cbranch_scc1 Lr1f_last
    ds_read_b128 v[56:59], v8 offset:16384
    ds_read_b128 v[60:63], v8 offset:17408
    v_mov_b64 v[20:21], s[52:53]
    v_mov_b64 v[22:23], s[52:53]
    v_mov_b32 v41, 0
    v_mov_b32 v42, 0
    v_max3_f32 v9, v12, v13, v14
    v_max3_f32 v9, v9, v15, v16
    v_max3_f32 v9, v9, v17, v18
    v_max3_f32 v9, v9, v19, v24
    v_max_f32 v9, v9, v25
    v_mov_b32 v10, v9
    v_mov_b64 v[32:33], 0
    v_mov_b64 v[34:35], 0
    v_permlane32_swap_b32 v9, v10
    v_max_f32 v9, v9, v10
    v_mov_b32 v10, v9
    s_nop 1
    v_permlane16_swap_b32 v9, v10
    v_max_f32 v9, v9, v10
    v_mul_f32 v28, s44, v9
    v_fma_f32 v12, v12, s44, -v28
    v_fma_f32 v13, v13, s44, -v28
    v_fma_f32 v14, v14, s44, -v28
    v_fma_f32 v15, v15, s44, -v28
    v_exp_f32 v12, v12
    v_exp_f32 v13, v13
    v_fma_f32 v16, v16, s44, -v28
    v_fma_f32 v17, v17, s44, -v28
    v_exp_f32 v14, v14
    v_exp_f32 v15, v15
    v_cvt_pk_bf16_f32 v36, v12, v13
    v_fma_f32 v18, v18, s44, -v28
    v_fma_f32 v19, v19, s44, -v28
    v_exp_f32 v16, v16
    v_exp_f32 v17, v17
    v_cvt_pk_bf16_f32 v37, v14, v15
    v_fma_f32 v24, v24, s44, -v28
    v_fma_f32 v25, v25, s44, -v28
    v_exp_f32 v18, v18
    v_exp_f32 v19, v19
    v_cvt_pk_bf16_f32 v38, v16, v17
    v_exp_f32 v24, v24
    v_exp_f32 v25, v25
    v_cvt_pk_bf16_f32 v39, v18, v19
    v_cvt_pk_bf16_f32 v40, v24, v25
    v_cvt_pk_bf16_f32 v43, v24, v25
    v_mfma_f32_16x16x32_bf16 v[52:55], v[20:23], v[36:39], 0
    v_mov_b64 v[12:13], 0
    v_mov_b64 v[14:15], 0
    s_waitcnt vmcnt(3)
    v_mfma_f32_16x16x32_bf16 v[44:47], v[64:67], v[36:39], 0
    v_mov_b64 v[24:25], 0
    v_mov_b64 v[26:27], 0
    s_waitcnt vmcnt(2)
    v_mfma_f32_16x16x32_bf16 v[48:51], v[68:71], v[36:39], 0
    ds_read_b128 v[64:67], v8 offset:20480
    ds_read_b128 v[68:71], v8 offset:21504
    v_mfma_f32_16x16x16_bf16 v[52:55], v[20:21], v[40:41], v[52:55]
    v_mfma_f32_16x16x16_bf16 v[44:47], v[30:31], v[40:41], v[44:47]
    v_mov_b64 v[20:21], 0
    v_mov_b64 v[22:23], 0
    v_mfma_f32_16x16x16_bf16 v[48:51], v[30:31], v[42:43], v[48:51]
    v_mov_b64 v[36:37], 0
    v_mov_b64 v[38:39], 0
    v_mov_b64 v[40:41], 0
    v_mov_b64 v[42:43], 0
    v_rcp_f32 v9, v52
    v_mov_b64 v[52:53], 0
    v_mov_b64 v[54:55], 0
    v_mul_f32 v44, v9, v44
    v_mul_f32 v48, v9, v48
    v_cvt_pk_bf16_f32 v16, v44, v48
    v_mul_f32 v45, v9, v45
    v_mul_f32 v49, v9, v49
    v_cvt_pk_bf16_f32 v17, v45, v49
    v_mul_f32 v46, v9, v46
    v_mul_f32 v50, v9, v50
    v_cvt_pk_bf16_f32 v18, v46, v50
    v_mul_f32 v47, v9, v47
    v_mul_f32 v51, v9, v51
    v_cvt_pk_bf16_f32 v19, v47, v51
    ds_write_b128 v5, v[16:19]
    v_mov_b64 v[28:29], 0
    v_mov_b64 v[30:31], 0
    s_waitcnt lgkmcnt(0)
    s_barrier
    ds_read_b128 v[44:47], v4 offset:0
    ds_read_b128 v[48:51], v4 offset:128
    v_mov_b64 v[16:17], 0
    v_mov_b64 v[18:19], 0
    buffer_load_dwordx4 v0, s[8:11], s41 offen offset:0 lds
    buffer_load_dwordx4 v0, s[8:11], s41 offen offset:1024 lds
    s_waitcnt lgkmcnt(1)
    v_smfmac_f32_16x16x64_bf16 v[12:15], v[44:47], a[184:191], v1
    s_waitcnt lgkmcnt(0)
    v_smfmac_f32_16x16x64_bf16 v[12:15], v[48:51], a[192:199], v1
    v_smfmac_f32_16x16x64_bf16 v[24:27], v[44:47], a[200:207], v1
    v_smfmac_f32_16x16x64_bf16 v[24:27], v[48:51], a[208:215], v1
    v_add_f32 v12, v12, v14
    v_smfmac_f32_16x16x64_bf16 v[20:23], v[44:47], a[216:223], v1
    v_add_f32 v13, v13, v15
    v_smfmac_f32_16x16x64_bf16 v[20:23], v[48:51], a[224:231], v1
    v_cvt_pk_bf16_f32 v12, v12, v13
    v_smfmac_f32_16x16x64_bf16 v[16:19], v[44:47], a[232:239], v1
    v_add_f32 v24, v24, v26
    v_smfmac_f32_16x16x64_bf16 v[16:19], v[48:51], a[240:247], v1
    v_add_f32 v25, v25, v27
    v_smfmac_f32_16x16x64_bf16 v[36:39], v[44:47], v[56:63], v1
    v_cvt_pk_bf16_f32 v13, v24, v25
    v_smfmac_f32_16x16x64_bf16 v[36:39], v[48:51], v[64:71], v1
    v_add_f32 v20, v20, v22
    v_add_f32 v21, v21, v23
    v_cvt_pk_bf16_f32 v14, v20, v21
    v_add_f32 v16, v16, v18
    v_add_f32 v17, v17, v19
    v_cvt_pk_bf16_f32 v15, v16, v17
    v_and_or_b32 v15, v15, -2, s40
    buffer_store_dwordx4 v[12:15], v0, s[8:11], s38 offen
    s_nop 0
    ds_read_b128 v[12:15], v8 offset:18432
    ds_read_b128 v[16:19], v8 offset:19456
    ds_read_b128 v[20:23], v8 offset:22528
    ds_read_b128 v[24:27], v8 offset:23552
    ds_read_b128 v[56:59], v8 offset:24576
    ds_read_b128 v[60:63], v8 offset:25600
    ds_read_b128 v[64:67], v8 offset:28672
    ds_read_b128 v[68:71], v8 offset:29696
    s_waitcnt lgkmcnt(6)
    v_smfmac_f32_16x16x64_bf16 v[40:43], v[44:47], v[12:19], v1
    ds_read_b128 v[12:15], v8 offset:26624
    ds_read_b128 v[16:19], v8 offset:27648
    s_waitcnt lgkmcnt(6)
    v_smfmac_f32_16x16x64_bf16 v[40:43], v[48:51], v[20:27], v1
    ds_read_b128 v[20:23], v8 offset:30720
    ds_read_b128 v[24:27], v8 offset:31744
    s_waitcnt lgkmcnt(6)
    v_smfmac_f32_16x16x64_bf16 v[52:55], v[44:47], v[56:63], v1
    ds_read_b128 v[56:59], v8 offset:32768
    ds_read_b128 v[60:63], v8 offset:33792
    s_waitcnt lgkmcnt(6)
    v_smfmac_f32_16x16x64_bf16 v[52:55], v[48:51], v[64:71], v1
    s_waitcnt lgkmcnt(4)
    v_smfmac_f32_16x16x64_bf16 v[32:35], v[44:47], v[12:19], v1
    s_waitcnt lgkmcnt(2)
    v_smfmac_f32_16x16x64_bf16 v[32:35], v[48:51], v[20:27], v1
    v_smfmac_f32_16x16x64_bf16 v[28:31], v[44:47], a[248:255], v1
    s_waitcnt lgkmcnt(0)
    v_smfmac_f32_16x16x64_bf16 v[28:31], v[48:51], v[56:63], v1
    v_add_f32 v36, v36, v38
    v_add_f32 v37, v37, v39
    v_cvt_pk_bf16_f32 v36, v36, v37
    v_add_f32 v40, v40, v42
    v_add_f32 v41, v41, v43
    v_cvt_pk_bf16_f32 v37, v40, v41
    v_add_f32 v52, v52, v54
    v_add_f32 v53, v53, v55
    v_cvt_pk_bf16_f32 v38, v52, v53
    v_add_f32 v32, v32, v34
    v_add_f32 v33, v33, v35
    v_cvt_pk_bf16_f32 v39, v32, v33
    v_and_or_b32 v39, v39, -2, s40
    s_add_u32 s17, s38, 4096
    buffer_store_dwordx4 v[36:39], v0, s[8:11], s17 offen
    v_add_f32 v28, v28, v30
    v_add_f32 v29, v29, v31
    v_cvt_pk_bf16_f32 v28, v28, v29
    v_and_or_b32 v28, v28, -2, s40
    v_lshrrev_b32 v9, 2, v0
    buffer_store_dword v28, v9, s[8:11], s39 offen
    v_add_u32 v10, 162560, v0
    ds_read_b128 v[64:67], v10
    s_add_u32 s33, s33, 1
    s_add_u32 s42, s42, 262144
    s_add_u32 s41, s41, 262144
    s_add_u32 s43, s43, 131072
    s_mov_b32 s67, s66
    s_add_u32 s68, s68, 262144
    s_add_u32 s66, s66, 22528
    ds_read_b128 v[56:59], v8 offset:4096
    ds_read_b128 v[60:63], v8 offset:5120
    v_mov_b64 v[12:13], 0
    v_mov_b64 v[14:15], 0
    v_mov_b64 v[16:17], 0
    v_mov_b64 v[18:19], 0
    v_mov_b64 v[20:21], 0
    v_mov_b64 v[22:23], 0
    v_mov_b64 v[24:25], 0
    v_mov_b64 v[26:27], 0
    v_mov_b64 v[28:29], 0
    v_mov_b64 v[30:31], 0
    v_mov_b64 v[32:33], 0
    v_mov_b64 v[34:35], 0
    s_nop 15
    s_nop 15
    s_nop 15
    s_nop 11
    buffer_load_dwordx4 v[40:43], v6, s[8:11], s62 offen sc1
    buffer_load_dwordx4 v[44:47], v6, s[8:11], s63 offen sc1
    buffer_load_dwordx4 v[48:51], v6, s[8:11], s64 offen sc1
    buffer_load_dwordx4 v[52:55], v6, s[8:11], s65 offen sc1
    s_waitcnt lgkmcnt(0)
    s_waitcnt vmcnt(3)
    v_mfma_f32_16x16x32_bf16 v[68:71], v[40:43], v[64:67], 0
    v_and_b32 v10, 1, v43
    v_cmp_ne_u32 s[54:55], s40, v10
    s_waitcnt vmcnt(2)
    v_mfma_f32_16x16x32_bf16 v[68:71], v[44:47], v[64:67], v[68:71]
    v_and_b32 v10, 1, v47
    v_cmp_ne_u32 s[56:57], s40, v10
    s_waitcnt vmcnt(1)
    v_mfma_f32_16x16x32_bf16 v[68:71], v[48:51], v[64:67], v[68:71]
    v_and_b32 v10, 1, v51
    v_cmp_ne_u32 s[58:59], s40, v10
    s_waitcnt vmcnt(0)
    v_mfma_f32_16x16x32_bf16 v[68:71], v[52:55], v[64:67], v[68:71]
    v_and_b32 v10, 1, v55
    v_cmp_ne_u32 s[60:61], s40, v10
    s_or_b64 vcc, s[54:55], s[56:57]
    s_or_b64 vcc, vcc, s[58:59]
    s_or_b64 vcc, vcc, s[60:61]
    s_cbranch_scc0 Lr1f_red
    s_mov_b32 s16, 0
Lr1f_p1:
    s_mov_b64 exec, s[54:55]
    buffer_load_dwordx4 v[40:43], v6, s[8:11], s62 offen sc1
    s_mov_b64 exec, s[56:57]
    buffer_load_dwordx4 v[44:47], v6, s[8:11], s63 offen sc1
    s_mov_b64 exec, s[58:59]
    buffer_load_dwordx4 v[48:51], v6, s[8:11], s64 offen sc1
    s_mov_b64 exec, s[60:61]
    buffer_load_dwordx4 v[52:55], v6, s[8:11], s65 offen sc1
    s_mov_b64 exec, -1
    s_add_u32 s16, s16, 1
    s_cmp_gt_u32 s16, 100000
    s_cbranch_scc1 Lr_abort
    s_waitcnt vmcnt(3)
    v_mfma_f32_16x16x32_bf16 v[68:71], v[40:43], v[64:67], 0
    v_and_b32 v10, 1, v43
    v_cmp_ne_u32 s[54:55], s40, v10
    s_waitcnt vmcnt(2)
    v_mfma_f32_16x16x32_bf16 v[68:71], v[44:47], v[64:67], v[68:71]
    v_and_b32 v10, 1, v47
    v_cmp_ne_u32 s[56:57], s40, v10
    s_waitcnt vmcnt(1)
    v_mfma_f32_16x16x32_bf16 v[68:71], v[48:51], v[64:67], v[68:71]
    v_and_b32 v10, 1, v51
    v_cmp_ne_u32 s[58:59], s40, v10
    s_waitcnt vmcnt(0)
    v_mfma_f32_16x16x32_bf16 v[68:71], v[52:55], v[64:67], v[68:71]
    v_and_b32 v10, 1, v55
    v_cmp_ne_u32 s[60:61], s40, v10
    s_or_b64 vcc, s[54:55], s[56:57]
    s_or_b64 vcc, vcc, s[58:59]
    s_or_b64 vcc, vcc, s[60:61]
    s_cbranch_scc1 Lr1f_p1
Lr1f_red:
    s_xor_b32 s34, s34, 16384
    s_xor_b32 s35, s35, 16384
    buffer_load_dwordx4 v[36:39], v0, s[8:11], s34 offen sc1
    v_permlane16_swap_b32 v68, v70
    v_permlane16_swap_b32 v69, v71
    s_mov_b64 exec, s[46:47]
    v_add_f32 v68, v68, v70
    v_add_f32 v69, v69, v71
    v_cvt_pk_bf16_f32 v68, v68, v69
    v_min_u32 v68, s50, v68
    buffer_store_dword v68, v7, s[8:11], s36 offen
    v_mov_b32 v69, -1
    buffer_store_dword v69, v7, s[8:11], s37 offen
    s_mov_b64 exec, -1
    buffer_load_dwordx4 v[36:39], v0, s[8:11], s34 offen sc1
    s_xor_b32 s40, s40, 1
    s_xor_b32 s36, s36, 16384
    s_xor_b32 s37, s37, 16384
    ds_read_b128 v[64:67], v8 offset:6144
    ds_read_b128 v[68:71], v8 offset:7168
    s_waitcnt lgkmcnt(0)
    s_branch Lr1f_step
Lr1f_pb_re:
    s_mov_b32 s16, 0
Lr1f_pb_lp:
    s_add_u32 s17, s34, 4096
    buffer_load_dwordx4 v[40:43], v0, s[8:11], s17 offen sc1
    s_add_u32 s16, s16, 1
    s_cmp_gt_u32 s16, 100000
    s_cbranch_scc1 Lr_abort
    s_waitcnt vmcnt(0)
    v_max3_u32 v10, v40, v41, v42
    v_max_u32 v10, v10, v43
    v_cmp_eq_u32 vcc, -1, v10
    s_nop 0
    s_cbranch_vccnz Lr1f_pb_lp
    s_branch Lr1f_pb_ok
Lr1f_pc_re:
    s_mov_b32 s16, 0
Lr1f_pc_lp:
    buffer_load_dwordx4 v[44:47], v0, s[8:11], s35 offen sc1
    s_add_u32 s16, s16, 1
    s_cmp_gt_u32 s16, 100000
    s_cbranch_scc1 Lr_abort
    s_waitcnt vmcnt(0)
    v_max3_u32 v10, v44, v45, v46
    v_max_u32 v10, v10, v47
    v_cmp_eq_u32 vcc, -1, v10
    s_nop 0
    s_cbranch_vccnz Lr1f_pc_lp
    s_branch Lr1f_pc_ok
Lr1f_last:
    s_waitcnt vmcnt(0) lgkmcnt(0)
    s_barrier
    s_mov_b32 s67, s66
    v_mov_b32 v9, 1
    v_mov_b32 v10, 0
    s_mov_b64 exec, 1
    buffer_store_dword v9, v10, s[8:11], s67 offen offset:384 sc1
    s_mov_b64 exec, -1
    s_branch Lr_exit
L_w2_1:
    s_cmp_lg_u32 s14, 2
    s_cbranch_scc1 L_w3_1
    s_mov_b32 s16, 0
    s_add_u32 s17, s66, 128
    v_lshrrev_b32 v10, 2, v0
    v_and_b32 v9, 16, v10
    v_lshlrev_b32 v9, 3, v9
    v_and_or_b32 v10, v10, 12, v9
Lr2f_fw_12:
    buffer_load_dword v9, v10, s[8:11], s17 offen sc1
    s_add_u32 s16, s16, 1
    s_cmp_gt_u32 s16, 100000
    s_cbranch_scc1 Lr_abort
    s_waitcnt vmcnt(0)
    v_cmp_eq_u32 vcc, 0, v9
    s_nop 0
    s_cbranch_vccnz Lr2f_fw_12
    s_mov_b32 m0, 19200
    s_nop 0
    buffer_load_dwordx4 v0, s[8:11], s41 offen offset:0 lds
    buffer_load_dwordx4 v0, s[8:11], s41 offen offset:1024 lds
    s_add_u32 s41, s41, 262144
    s_add_u32 s68, s68, 262144
    s_waitcnt vmcnt(0)
    ds_read_b128 v[56:59], v8 offset:4096
    ds_read_b128 v[60:63], v8 offset:5120
    ds_read_b128 v[64:67], v8 offset:6144
    ds_read_b128 v[68:71], v8 offset:7168
    v_mov_b64 v[12:13], 0
    v_mov_b64 v[14:15], 0
    v_mov_b64 v[16:17], 0
    v_mov_b64 v[18:19], 0
    v_mov_b64 v[20:21], 0
    v_mov_b64 v[22:23], 0
    v_mov_b64 v[24:25], 0
    v_mov_b64 v[26:27], 0
    v_mov_b64 v[28:29], 0
    v_mov_b64 v[30:31], 0
    v_mov_b64 v[32:33], 0
    v_mov_b64 v[34:35], 0
    buffer_load_dwordx4 v[36:39], v0, s[8:11], s34 offen sc1
    s_waitcnt vmcnt(0) lgkmcnt(0)
Lr2f_step:
    s_waitcnt vmcnt(3)
    v_max3_u32 v10, v36, v37, v38
    v_max_u32 v10, v10, v39
    v_cmp_eq_u32 vcc, -1, v10
    s_nop 0
    s_cbranch_vccz Lr2f_aok
    buffer_load_dwordx4 v[36:39], v0, s[8:11], s34 offen sc1
    s_nop 15
    s_nop 8
    buffer_load_dwordx4 v[36:39], v0, s[8:11], s34 offen sc1
    s_mov_b32 s16, 0
Lr2f_alp:
    s_waitcnt vmcnt(2)
    v_max3_u32 v10, v36, v37, v38
    v_max_u32 v10, v10, v39
    v_cmp_eq_u32 vcc, -1, v10
    s_nop 0
    s_cbranch_vccz Lr2f_aok
    buffer_load_dwordx4 v[36:39], v0, s[8:11], s34 offen sc1
    s_add_u32 s16, s16, 1
    s_cmp_gt_u32 s16, 100000
    s_cbranch_scc1 Lr_abort
    s_branch Lr2f_alp
Lr2f_aok:
    ds_write_b128 v0, v[36:39] offset:8960
    v_smfmac_f32_16x16x64_bf16 v[12:15], v[36:39], v[104:111], v1
    v_smfmac_f32_16x16x64_bf16 v[16:19], v[36:39], v[112:119], v1
    v_smfmac_f32_16x16x64_bf16 v[20:23], v[36:39], v[216:223], v1
    s_waitcnt lgkmcnt(0)
    s_barrier
    ds_read_b128 v[48:51], v0 offset:9984
    ds_read_b128 v[52:55], v0 offset:6912
    v_smfmac_f32_16x16x64_bf16 v[28:31], v[36:39], v[56:63], v1
    ds_read_b128 v[56:59], v8 offset:0
    ds_read_b128 v[60:63], v8 offset:1024
    v_smfmac_f32_16x16x64_bf16 v[24:27], v[36:39], v[224:231], v1
    v_smfmac_f32_16x16x64_bf16 v[32:35], v[36:39], v[64:71], v1
    ds_read_b128 v[64:67], v8 offset:2048
    ds_read_b128 v[68:71], v8 offset:3072
    s_add_u32 s17, s34, 4096
    buffer_load_dwordx4 v[40:43], v0, s[8:11], s17 offen sc1
    s_waitcnt vmcnt(1)
    ds_read_b128 v[36:39], v0 offset:7936
    s_waitcnt lgkmcnt(6)
    v_smfmac_f32_16x16x64_bf16 v[28:31], v[48:51], a[88:95], v1
    v_smfmac_f32_16x16x64_bf16 v[12:15], v[48:51], v[120:127], v1
    v_smfmac_f32_16x16x64_bf16 v[16:19], v[48:51], v[128:135], v1
    v_smfmac_f32_16x16x64_bf16 v[32:35], v[48:51], a[96:103], v1
    buffer_load_dwordx4 v[44:47], v0, s[8:11], s35 offen sc1
    v_smfmac_f32_16x16x64_bf16 v[20:23], v[48:51], v[232:239], v1
    v_lshrrev_b32 v10, 2, v0
    v_and_b32 v9, 16, v10
    v_lshlrev_b32 v9, 3, v9
    v_and_or_b32 v10, v10, 12, v9
    s_add_u32 s17, s66, 22656
    v_mov_b32 v11, 2
    buffer_load_dword v11, v10, s[8:11], s17 offen sc1
    v_smfmac_f32_16x16x64_bf16 v[24:27], v[48:51], v[240:247], v1
    s_waitcnt lgkmcnt(3)
    v_smfmac_f32_16x16x64_bf16 v[28:31], v[52:55], v[56:63], v1
    ds_read_b128 v[56:59], v8 offset:12288
    ds_read_b128 v[60:63], v8 offset:13312
    v_smfmac_f32_16x16x64_bf16 v[12:15], v[52:55], v[72:79], v1
    v_smfmac_f32_16x16x64_bf16 v[16:19], v[52:55], v[80:87], v1
    s_waitcnt lgkmcnt(3)
    v_smfmac_f32_16x16x64_bf16 v[32:35], v[52:55], v[64:71], v1
    ds_read_b128 v[64:67], v8 offset:14336
    ds_read_b128 v[68:71], v8 offset:15360
    v_smfmac_f32_16x16x64_bf16 v[20:23], v[52:55], v[184:191], v1
    v_smfmac_f32_16x16x64_bf16 v[24:27], v[52:55], v[192:199], v1
    s_waitcnt lgkmcnt(4)
    v_smfmac_f32_16x16x64_bf16 v[28:31], v[36:39], a[72:79], v1
    v_smfmac_f32_16x16x64_bf16 v[12:15], v[36:39], v[88:95], v1
    v_smfmac_f32_16x16x64_bf16 v[16:19], v[36:39], v[96:103], v1
    v_smfmac_f32_16x16x64_bf16 v[32:35], v[36:39], a[80:87], v1
    v_smfmac_f32_16x16x64_bf16 v[20:23], v[36:39], v[200:207], v1
    v_smfmac_f32_16x16x64_bf16 v[24:27], v[36:39], v[208:215], v1
    s_waitcnt vmcnt(2)
    v_max3_u32 v10, v40, v41, v42
    v_max_u32 v10, v10, v43
    v_cmp_eq_u32 vcc, -1, v10
    s_nop 0
    s_cbranch_vccnz Lr2f_pb_re
Lr2f_pb_ok:
    ds_write_b128 v0, v[40:43] offset:13056
    s_waitcnt lgkmcnt(3)
    v_smfmac_f32_16x16x64_bf16 v[12:15], v[40:43], v[56:63], v1
    ds_read_b128 v[56:59], v8 offset:8192
    ds_read_b128 v[60:63], v8 offset:9216
    v_smfmac_f32_16x16x64_bf16 v[20:23], v[40:43], a[24:31], v1
    s_waitcnt lgkmcnt(3)
    v_smfmac_f32_16x16x64_bf16 v[16:19], v[40:43], v[64:71], v1
    ds_read_b128 v[64:67], v8 offset:10240
    ds_read_b128 v[68:71], v8 offset:11264
    v_smfmac_f32_16x16x64_bf16 v[24:27], v[40:43], a[32:39], v1
    s_waitcnt lgkmcnt(4)
    s_barrier
    ds_read_b128 v[48:51], v0 offset:11008
    ds_read_b128 v[52:55], v0 offset:14080
    ds_read_b128 v[36:39], v0 offset:12032
    v_smfmac_f32_16x16x64_bf16 v[28:31], v[40:43], a[136:143], v1
    v_smfmac_f32_16x16x64_bf16 v[32:35], v[40:43], a[144:151], v1
    s_waitcnt lgkmcnt(2)
    v_smfmac_f32_16x16x64_bf16 v[12:15], v[48:51], v[56:63], v1
    v_smfmac_f32_16x16x64_bf16 v[16:19], v[48:51], v[64:71], v1
    s_waitcnt lgkmcnt(1)
    v_smfmac_f32_16x16x64_bf16 v[12:15], v[52:55], v[152:159], v1
    v_smfmac_f32_16x16x64_bf16 v[16:19], v[52:55], v[160:167], v1
    s_waitcnt lgkmcnt(0)
    v_smfmac_f32_16x16x64_bf16 v[12:15], v[36:39], v[136:143], v1
    v_smfmac_f32_16x16x64_bf16 v[16:19], v[36:39], v[144:151], v1
    s_waitcnt vmcnt(1)
    v_max3_u32 v10, v44, v45, v46
    v_max_u32 v10, v10, v47
    v_cmp_eq_u32 vcc, -1, v10
    s_nop 0
    s_cbranch_vccnz Lr2f_pc_re
Lr2f_pc_ok:
    v_smfmac_f32_16x16x64_bf16 v[12:15], v[44:47], v[168:175], v1
    v_smfmac_f32_16x16x64_bf16 v[16:19], v[44:47], v[176:183], v1
    v_smfmac_f32_16x16x64_bf16 v[20:23], v[48:51], v[248:255], v1
    v_smfmac_f32_16x16x64_bf16 v[24:27], v[48:51], a[0:7], v1
    v_smfmac_f32_16x16x64_bf16 v[20:23], v[52:55], a[40:47], v1
    v_add_f32 v12, v12, v14
    buffer_load_dwordx4 v[64:67], v0, s[8:11], s42 offen
    v_smfmac_f32_16x16x64_bf16 v[24:27], v[52:55], a[48:55], v1
    v_add_f32 v16, v16, v18
    v_smfmac_f32_16x16x64_bf16 v[20:23], v[36:39], a[8:15], v1
    v_add_f32 v13, v13, v15
    v_smfmac_f32_16x16x64_bf16 v[24:27], v[36:39], a[16:23], v1
    v_add_f32 v17, v17, v19
    v_smfmac_f32_16x16x64_bf16 v[20:23], v[44:47], a[56:63], v1
    v_cvt_pk_bf16_f32 v14, v12, v16
    ds_read_b128 v[56:59], v0 offset:15104
    buffer_load_dwordx4 v[68:71], v0, s[8:11], s42 offen offset:1024
    v_smfmac_f32_16x16x64_bf16 v[24:27], v[44:47], a[64:71], v1
    v_cvt_pk_bf16_f32 v15, v13, v17
    ds_read_b128 v[60:63], v0 offset:16128
    ds_write_b32 v2, v14 offset:576
    ds_write_b32 v2, v15 offset:864
    v_smfmac_f32_16x16x64_bf16 v[28:31], v[48:51], a[104:111], v1
    v_smfmac_f32_16x16x64_bf16 v[32:35], v[48:51], a[112:119], v1
    v_add_f32 v20, v20, v22
    v_add_f32 v24, v24, v26
    v_add_f32 v21, v21, v23
    v_add_f32 v25, v25, v27
    v_cvt_pk_bf16_f32 v22, v20, v24
    v_cvt_pk_bf16_f32 v23, v21, v25
    ds_write_b32 v2, v22 offset:0
    ds_write_b32 v2, v23 offset:288
    v_smfmac_f32_16x16x64_bf16 v[28:31], v[52:55], a[152:159], v1
    v_smfmac_f32_16x16x64_bf16 v[32:35], v[52:55], a[160:167], v1
    s_waitcnt vmcnt(2)
    v_cmp_eq_u32 vcc, 0, v11
    s_nop 0
    s_cbranch_vccnz Lr2f_flbad
Lr2f_flok:
    s_waitcnt lgkmcnt(0)
    s_barrier
    ds_read_b128 v[40:43], v3 offset:0
    ds_read_b128 v[48:51], v3 offset:64
    ds_read_b128 v[20:23], v3 offset:128
    ds_read_b128 v[52:55], v3 offset:192
    v_smfmac_f32_16x16x64_bf16 v[28:31], v[36:39], a[120:127], v1
    v_smfmac_f32_16x16x64_bf16 v[32:35], v[36:39], a[128:135], v1
    ds_read_b128 v[36:39], v0 offset:17152
    v_smfmac_f32_16x16x64_bf16 v[28:31], v[44:47], a[168:175], v1
    v_smfmac_f32_16x16x64_bf16 v[32:35], v[44:47], a[176:183], v1
    ds_read_b128 v[44:47], v0 offset:18176
    s_waitcnt lgkmcnt(5)
    v_mfma_f32_16x16x32_bf16 v[12:15], v[56:59], v[40:43], 0
    v_mfma_f32_16x16x32_bf16 v[16:19], v[60:63], v[40:43], 0
    v_mfma_f32_16x16x32_bf16 v[24:27], v[40:43], v[40:43], 0
    ds_read_b128 v[56:59], v0 offset:19200
    ds_read_b128 v[60:63], v0 offset:20224
    s_waitcnt lgkmcnt(3)
    v_mfma_f32_16x16x32_bf16 v[12:15], v[36:39], v[48:51], v[12:15]
    v_lshrrev_b32 v10, 1, v0
    v_lshrrev_b32 v9, 9, v0
    s_waitcnt lgkmcnt(2)
    v_mfma_f32_16x16x32_bf16 v[16:19], v[44:47], v[48:51], v[16:19]
    v_lshl_add_u32 v9, v9, 5, v10
    v_add_f32 v28, v28, v30
    v_mfma_f32_16x16x32_bf16 v[24:27], v[48:51], v[48:51], v[24:27]
    v_add_f32 v32, v32, v34
    v_add_f32 v29, v29, v31
    ds_read_b128 v[36:39], v0 offset:21248
    ds_read_b128 v[44:47], v0 offset:22272
    s_waitcnt lgkmcnt(3)
    v_mfma_f32_16x16x32_bf16 v[12:15], v[56:59], v[20:23], v[12:15]
    v_add_f32 v33, v33, v35
    v_cvt_pk_bf16_f32 v30, v28, v29
    s_waitcnt lgkmcnt(2)
    v_mfma_f32_16x16x32_bf16 v[16:19], v[60:63], v[20:23], v[16:19]
    v_cvt_pk_bf16_f32 v31, v32, v33
    ds_read_b64 v[34:35], v9 offset:2304
    v_mfma_f32_16x16x32_bf16 v[24:27], v[20:23], v[20:23], v[24:27]
    s_add_u32 s17, s43, 3072
    buffer_store_dwordx2 v[30:31], v10, s[8:11], s17 offen sc1
    s_waitcnt lgkmcnt(2)
    v_mfma_f32_16x16x32_bf16 v[12:15], v[36:39], v[52:55], v[12:15]
    s_waitcnt lgkmcnt(1)
    v_mfma_f32_16x16x32_bf16 v[16:19], v[44:47], v[52:55], v[16:19]
    v_mfma_f32_16x16x32_bf16 v[24:27], v[52:55], v[52:55], v[24:27]
    s_add_u32 s17, s43, 1024
    s_waitcnt lgkmcnt(0)
    buffer_store_dwordx2 v[34:35], v10, s[8:11], s17 offen sc1
    s_cmp_eq_u32 s33, 63
    s_cbranch_scc1 Lr2f_last
    ds_read_b128 v[56:59], v8 offset:16384
    ds_read_b128 v[60:63], v8 offset:17408
    v_mov_b64 v[20:21], s[52:53]
    v_mov_b64 v[22:23], s[52:53]
    v_mov_b32 v41, 0
    v_mov_b32 v42, 0
    v_max3_f32 v9, v12, v13, v14
    v_max3_f32 v9, v9, v15, v16
    v_max3_f32 v9, v9, v17, v18
    v_max3_f32 v9, v9, v19, v24
    v_max_f32 v9, v9, v25
    v_mov_b32 v10, v9
    v_mov_b64 v[32:33], 0
    v_mov_b64 v[34:35], 0
    v_permlane32_swap_b32 v9, v10
    v_max_f32 v9, v9, v10
    v_mov_b32 v10, v9
    s_nop 1
    v_permlane16_swap_b32 v9, v10
    v_max_f32 v9, v9, v10
    v_mul_f32 v28, s44, v9
    v_fma_f32 v12, v12, s44, -v28
    v_fma_f32 v13, v13, s44, -v28
    v_fma_f32 v14, v14, s44, -v28
    v_fma_f32 v15, v15, s44, -v28
    v_exp_f32 v12, v12
    v_exp_f32 v13, v13
    v_fma_f32 v16, v16, s44, -v28
    v_fma_f32 v17, v17, s44, -v28
    v_exp_f32 v14, v14
    v_exp_f32 v15, v15
    v_cvt_pk_bf16_f32 v36, v12, v13
    v_fma_f32 v18, v18, s44, -v28
    v_fma_f32 v19, v19, s44, -v28
    v_exp_f32 v16, v16
    v_exp_f32 v17, v17
    v_cvt_pk_bf16_f32 v37, v14, v15
    v_fma_f32 v24, v24, s44, -v28
    v_fma_f32 v25, v25, s44, -v28
    v_exp_f32 v18, v18
    v_exp_f32 v19, v19
    v_cvt_pk_bf16_f32 v38, v16, v17
    v_exp_f32 v24, v24
    v_exp_f32 v25, v25
    v_cvt_pk_bf16_f32 v39, v18, v19
    v_cvt_pk_bf16_f32 v40, v24, v25
    v_cvt_pk_bf16_f32 v43, v24, v25
    v_mfma_f32_16x16x32_bf16 v[52:55], v[20:23], v[36:39], 0
    v_mov_b64 v[12:13], 0
    v_mov_b64 v[14:15], 0
    s_waitcnt vmcnt(3)
    v_mfma_f32_16x16x32_bf16 v[44:47], v[64:67], v[36:39], 0
    v_mov_b64 v[24:25], 0
    v_mov_b64 v[26:27], 0
    s_waitcnt vmcnt(2)
    v_mfma_f32_16x16x32_bf16 v[48:51], v[68:71], v[36:39], 0
    ds_read_b128 v[64:67], v8 offset:20480
    ds_read_b128 v[68:71], v8 offset:21504
    v_mfma_f32_16x16x16_bf16 v[52:55], v[20:21], v[40:41], v[52:55]
    v_mfma_f32_16x16x16_bf16 v[44:47], v[30:31], v[40:41], v[44:47]
    v_mov_b64 v[20:21], 0
    v_mov_b64 v[22:23], 0
    v_mfma_f32_16x16x16_bf16 v[48:51], v[30:31], v[42:43], v[48:51]
    v_mov_b64 v[36:37], 0
    v_mov_b64 v[38:39], 0
    v_mov_b64 v[40:41], 0
    v_mov_b64 v[42:43], 0
    v_rcp_f32 v9, v52
    v_mov_b64 v[52:53], 0
    v_mov_b64 v[54:55], 0
    v_mul_f32 v44, v9, v44
    v_mul_f32 v48, v9, v48
    v_cvt_pk_bf16_f32 v16, v44, v48
    v_mul_f32 v45, v9, v45
    v_mul_f32 v49, v9, v49
    v_cvt_pk_bf16_f32 v17, v45, v49
    v_mul_f32 v46, v9, v46
    v_mul_f32 v50, v9, v50
    v_cvt_pk_bf16_f32 v18, v46, v50
    v_mul_f32 v47, v9, v47
    v_mul_f32 v51, v9, v51
    v_cvt_pk_bf16_f32 v19, v47, v51
    ds_write_b128 v5, v[16:19]
    v_mov_b64 v[28:29], 0
    v_mov_b64 v[30:31], 0
    s_waitcnt lgkmcnt(0)
    s_barrier
    ds_read_b128 v[44:47], v4 offset:0
    ds_read_b128 v[48:51], v4 offset:128
    v_mov_b64 v[16:17], 0
    v_mov_b64 v[18:19], 0
    buffer_load_dwordx4 v0, s[8:11], s41 offen offset:0 lds
    buffer_load_dwordx4 v0, s[8:11], s41 offen offset:1024 lds
    s_waitcnt lgkmcnt(1)
    v_smfmac_f32_16x16x64_bf16 v[12:15], v[44:47], a[184:191], v1
    s_waitcnt lgkmcnt(0)
    v_smfmac_f32_16x16x64_bf16 v[12:15], v[48:51], a[192:199], v1
    v_smfmac_f32_16x16x64_bf16 v[24:27], v[44:47], a[200:207], v1
    v_smfmac_f32_16x16x64_bf16 v[24:27], v[48:51], a[208:215], v1
    v_add_f32 v12, v12, v14
    v_smfmac_f32_16x16x64_bf16 v[20:23], v[44:47], a[216:223], v1
    v_add_f32 v13, v13, v15
    v_smfmac_f32_16x16x64_bf16 v[20:23], v[48:51], a[224:231], v1
    v_cvt_pk_bf16_f32 v12, v12, v13
    v_smfmac_f32_16x16x64_bf16 v[16:19], v[44:47], a[232:239], v1
    v_add_f32 v24, v24, v26
    v_smfmac_f32_16x16x64_bf16 v[16:19], v[48:51], a[240:247], v1
    v_add_f32 v25, v25, v27
    v_smfmac_f32_16x16x64_bf16 v[36:39], v[44:47], v[56:63], v1
    v_cvt_pk_bf16_f32 v13, v24, v25
    v_smfmac_f32_16x16x64_bf16 v[36:39], v[48:51], v[64:71], v1
    v_add_f32 v20, v20, v22
    v_add_f32 v21, v21, v23
    v_cvt_pk_bf16_f32 v14, v20, v21
    v_add_f32 v16, v16, v18
    v_add_f32 v17, v17, v19
    v_cvt_pk_bf16_f32 v15, v16, v17
    v_and_or_b32 v15, v15, -2, s40
    buffer_store_dwordx4 v[12:15], v0, s[8:11], s38 offen
    s_nop 0
    ds_read_b128 v[12:15], v8 offset:18432
    ds_read_b128 v[16:19], v8 offset:19456
    ds_read_b128 v[20:23], v8 offset:22528
    ds_read_b128 v[24:27], v8 offset:23552
    ds_read_b128 v[56:59], v8 offset:24576
    ds_read_b128 v[60:63], v8 offset:25600
    ds_read_b128 v[64:67], v8 offset:28672
    ds_read_b128 v[68:71], v8 offset:29696
    s_waitcnt lgkmcnt(6)
    v_smfmac_f32_16x16x64_bf16 v[40:43], v[44:47], v[12:19], v1
    ds_read_b128 v[12:15], v8 offset:26624
    ds_read_b128 v[16:19], v8 offset:27648
    s_waitcnt lgkmcnt(6)
    v_smfmac_f32_16x16x64_bf16 v[40:43], v[48:51], v[20:27], v1
    ds_read_b128 v[20:23], v8 offset:30720
    ds_read_b128 v[24:27], v8 offset:31744
    s_waitcnt lgkmcnt(6)
    v_smfmac_f32_16x16x64_bf16 v[52:55], v[44:47], v[56:63], v1
    ds_read_b128 v[56:59], v8 offset:32768
    ds_read_b128 v[60:63], v8 offset:33792
    s_waitcnt lgkmcnt(6)
    v_smfmac_f32_16x16x64_bf16 v[52:55], v[48:51], v[64:71], v1
    s_waitcnt lgkmcnt(4)
    v_smfmac_f32_16x16x64_bf16 v[32:35], v[44:47], v[12:19], v1
    s_waitcnt lgkmcnt(2)
    v_smfmac_f32_16x16x64_bf16 v[32:35], v[48:51], v[20:27], v1
    v_smfmac_f32_16x16x64_bf16 v[28:31], v[44:47], a[248:255], v1
    s_waitcnt lgkmcnt(0)
    v_smfmac_f32_16x16x64_bf16 v[28:31], v[48:51], v[56:63], v1
    v_add_f32 v36, v36, v38
    v_add_f32 v37, v37, v39
    v_cvt_pk_bf16_f32 v36, v36, v37
    v_add_f32 v40, v40, v42
    v_add_f32 v41, v41, v43
    v_cvt_pk_bf16_f32 v37, v40, v41
    v_add_f32 v52, v52, v54
    v_add_f32 v53, v53, v55
    v_cvt_pk_bf16_f32 v38, v52, v53
    v_add_f32 v32, v32, v34
    v_add_f32 v33, v33, v35
    v_cvt_pk_bf16_f32 v39, v32, v33
    v_and_or_b32 v39, v39, -2, s40
    s_add_u32 s17, s38, 4096
    buffer_store_dwordx4 v[36:39], v0, s[8:11], s17 offen
    v_add_f32 v28, v28, v30
    v_add_f32 v29, v29, v31
    v_cvt_pk_bf16_f32 v28, v28, v29
    v_and_or_b32 v28, v28, -2, s40
    v_lshrrev_b32 v9, 2, v0
    buffer_store_dword v28, v9, s[8:11], s39 offen
    v_add_u32 v10, 162560, v0
    ds_read_b32 v64, v10
    v_mov_b32 v65, 0
    v_mov_b32 v41, 0
    v_mov_b32 v45, 0
    v_mov_b32 v49, 0
    v_mov_b32 v53, 0
    s_add_u32 s33, s33, 1
    s_add_u32 s42, s42, 262144
    s_add_u32 s41, s41, 262144
    s_add_u32 s43, s43, 131072
    s_add_u32 s68, s68, 262144
    s_add_u32 s66, s66, 22528
    ds_read_b128 v[56:59], v8 offset:4096
    ds_read_b128 v[60:63], v8 offset:5120
    v_mov_b64 v[12:13], 0
    v_mov_b64 v[14:15], 0
    v_mov_b64 v[16:17], 0
    v_mov_b64 v[18:19], 0
    v_mov_b64 v[20:21], 0
    v_mov_b64 v[22:23], 0
    v_mov_b64 v[24:25], 0
    v_mov_b64 v[26:27], 0
    v_mov_b64 v[28:29], 0
    v_mov_b64 v[30:31], 0
    v_mov_b64 v[32:33], 0
    v_mov_b64 v[34:35], 0
    s_nop 15
    s_nop 15
    s_nop 15
    s_nop 1
    buffer_load_dword v40, v6, s[8:11], s62 offen sc1
    buffer_load_dword v44, v6, s[8:11], s63 offen sc1
    buffer_load_dword v48, v6, s[8:11], s64 offen sc1
    buffer_load_dword v52, v6, s[8:11], s65 offen sc1
    s_waitcnt lgkmcnt(0)
    s_waitcnt vmcnt(3)
    v_mfma_f32_16x16x16_bf16 v[68:71], v[40:41], v[64:65], 0
    v_and_b32 v10, 1, v40
    v_cmp_ne_u32 s[54:55], s40, v10
    s_waitcnt vmcnt(2)
    v_mfma_f32_16x16x16_bf16 v[68:71], v[44:45], v[64:65], v[68:71]
    v_and_b32 v10, 1, v44
    v_cmp_ne_u32 s[56:57], s40, v10
    s_waitcnt vmcnt(1)
    v_mfma_f32_16x16x16_bf16 v[68:71], v[48:49], v[64:65], v[68:71]
    v_and_b32 v10, 1, v48
    v_cmp_ne_u32 s[58:59], s40, v10
    s_waitcnt vmcnt(0)
    v_mfma_f32_16x16x16_bf16 v[68:71], v[52:53], v[64:65], v[68:71]
    v_and_b32 v10, 1, v52
    v_cmp_ne_u32 s[60:61], s40, v10
    s_or_b64 vcc, s[54:55], s[56:57]
    s_or_b64 vcc, vcc, s[58:59]
    s_or_b64 vcc, vcc, s[60:61]
    s_cbranch_scc0 Lr2f_red
    s_mov_b32 s16, 0
Lr2f_p1:
    s_mov_b64 exec, s[54:55]
    buffer_load_dword v40, v6, s[8:11], s62 offen sc1
    s_mov_b64 exec, s[56:57]
    buffer_load_dword v44, v6, s[8:11], s63 offen sc1
    s_mov_b64 exec, s[58:59]
    buffer_load_dword v48, v6, s[8:11], s64 offen sc1
    s_mov_b64 exec, s[60:61]
    buffer_load_dword v52, v6, s[8:11], s65 offen sc1
    s_mov_b64 exec, -1
    s_add_u32 s16, s16, 1
    s_cmp_gt_u32 s16, 100000
    s_cbranch_scc1 Lr_abort
    s_waitcnt vmcnt(3)
    v_mfma_f32_16x16x16_bf16 v[68:71], v[40:41], v[64:65], 0
    v_and_b32 v10, 1, v40
    v_cmp_ne_u32 s[54:55], s40, v10
    s_waitcnt vmcnt(2)
    v_mfma_f32_16x16x16_bf16 v[68:71], v[44:45], v[64:65], v[68:71]
    v_and_b32 v10, 1, v44
    v_cmp_ne_u32 s[56:57], s40, v10
    s_waitcnt vmcnt(1)
    v_mfma_f32_16x16x16_bf16 v[68:71], v[48:49], v[64:65], v[68:71]
    v_and_b32 v10, 1, v48
    v_cmp_ne_u32 s[58:59], s40, v10
    s_waitcnt vmcnt(0)
    v_mfma_f32_16x16x16_bf16 v[68:71], v[52:53], v[64:65], v[68:71]
    v_and_b32 v10, 1, v52
    v_cmp_ne_u32 s[60:61], s40, v10
    s_or_b64 vcc, s[54:55], s[56:57]
    s_or_b64 vcc, vcc, s[58:59]
    s_or_b64 vcc, vcc, s[60:61]
    s_cbranch_scc1 Lr2f_p1
Lr2f_red:
    s_xor_b32 s34, s34, 16384
    s_xor_b32 s35, s35, 16384
    buffer_load_dwordx4 v[36:39], v0, s[8:11], s34 offen sc1
    v_permlane16_swap_b32 v68, v70
    v_permlane16_swap_b32 v69, v71
    s_mov_b64 exec, s[46:47]
    v_add_f32 v68, v68, v70
    v_add_f32 v69, v69, v71
    v_cvt_pk_bf16_f32 v68, v68, v69
    v_min_u32 v68, s50, v68
    buffer_store_dword v68, v7, s[8:11], s36 offen
    v_mov_b32 v69, -1
    buffer_store_dword v69, v7, s[8:11], s37 offen
    s_mov_b64 exec, -1
    buffer_load_dwordx4 v[36:39], v0, s[8:11], s34 offen sc1
    s_xor_b32 s40, s40, 1
    s_xor_b32 s36, s36, 16384
    s_xor_b32 s37, s37, 16384
    ds_read_b128 v[64:67], v8 offset:6144
    ds_read_b128 v[68:71], v8 offset:7168
    s_waitcnt lgkmcnt(0)
    s_branch Lr2f_step
Lr2f_pb_re:
    s_mov_b32 s16, 0
Lr2f_pb_lp:
    s_add_u32 s17, s34, 4096
    buffer_load_dwordx4 v[40:43], v0, s[8:11], s17 offen sc1
    s_add_u32 s16, s16, 1
    s_cmp_gt_u32 s16, 100000
    s_cbranch_scc1 Lr_abort
    s_waitcnt vmcnt(0)
    v_max3_u32 v10, v40, v41, v42
    v_max_u32 v10, v10, v43
    v_cmp_eq_u32 vcc, -1, v10
    s_nop 0
    s_cbranch_vccnz Lr2f_pb_lp
    s_branch Lr2f_pb_ok
Lr2f_pc_re:
    s_mov_b32 s16, 0
Lr2f_pc_lp:
    buffer_load_dwordx4 v[44:47], v0, s[8:11], s35 offen sc1
    s_add_u32 s16, s16, 1
    s_cmp_gt_u32 s16, 100000
    s_cbranch_scc1 Lr_abort
    s_waitcnt vmcnt(0)
    v_max3_u32 v10, v44, v45, v46
    v_max_u32 v10, v10, v47
    v_cmp_eq_u32 vcc, -1, v10
    s_nop 0
    s_cbranch_vccnz Lr2f_pc_lp
    s_branch Lr2f_pc_ok
Lr2f_flbad:
    s_cmp_eq_u32 s33, 63
    s_cbranch_scc1 Lr2f_flok
    s_mov_b32 s16, 0
    s_add_u32 s17, s66, 22656
    v_lshrrev_b32 v10, 2, v0
    v_and_b32 v9, 16, v10
    v_lshlrev_b32 v9, 3, v9
    v_and_or_b32 v10, v10, 12, v9
Lr2f_fw_13:
    buffer_load_dword v9, v10, s[8:11], s17 offen sc1
    s_add_u32 s16, s16, 1
    s_cmp_gt_u32 s16, 100000
    s_cbranch_scc1 Lr_abort
    s_waitcnt vmcnt(0)
    v_cmp_eq_u32 vcc, 0, v9
    s_nop 0
    s_cbranch_vccnz Lr2f_fw_13
    s_branch Lr2f_flok
Lr2f_last:
    s_waitcnt vmcnt(0) lgkmcnt(0)
    s_barrier
    s_branch Lr_exit
L_w3_1:
    s_mov_b32 s16, 0
    s_add_u32 s17, s66, 128
    v_lshrrev_b32 v10, 2, v0
    v_and_b32 v9, 16, v10
    v_lshlrev_b32 v9, 3, v9
    v_and_or_b32 v10, v10, 12, v9
Lr3f_fw_14:
    buffer_load_dword v9, v10, s[8:11], s17 offen sc1
    s_add_u32 s16, s16, 1
    s_cmp_gt_u32 s16, 100000
    s_cbranch_scc1 Lr_abort
    s_waitcnt vmcnt(0)
    v_cmp_eq_u32 vcc, 0, v9
    s_nop 0
    s_cbranch_vccnz Lr3f_fw_14
    s_mov_b32 m0, 21248
    s_nop 0
    buffer_load_dwordx4 v0, s[8:11], s41 offen offset:0 lds
    buffer_load_dwordx4 v0, s[8:11], s41 offen offset:1024 lds
    s_add_u32 s41, s41, 262144
    s_add_u32 s68, s68, 262144
    s_waitcnt vmcnt(0)
    ds_read_b128 v[56:59], v8 offset:0
    ds_read_b128 v[60:63], v8 offset:1024
    ds_read_b128 v[64:67], v8 offset:2048
    ds_read_b128 v[68:71], v8 offset:3072
    v_mov_b64 v[12:13], 0
    v_mov_b64 v[14:15], 0
    v_mov_b64 v[16:17], 0
    v_mov_b64 v[18:19], 0
    v_mov_b64 v[20:21], 0
    v_mov_b64 v[22:23], 0
    v_mov_b64 v[24:25], 0
    v_mov_b64 v[26:27], 0
    v_mov_b64 v[28:29], 0
    v_mov_b64 v[30:31], 0
    v_mov_b64 v[32:33], 0
    v_mov_b64 v[34:35], 0
    buffer_load_dwordx4 v[36:39], v0, s[8:11], s34 offen sc1
    s_waitcnt vmcnt(0) lgkmcnt(0)
Lr3f_step:
    s_mov_b32 s16, 0
Lr3f_alp:
    s_waitcnt vmcnt(2)
    v_max3_u32 v10, v36, v37, v38
    v_max_u32 v10, v10, v39
    v_cmp_eq_u32 vcc, -1, v10
    s_nop 0
    s_cbranch_vccz Lr3f_aok
    buffer_load_dwordx4 v[36:39], v0, s[8:11], s34 offen sc1
    s_add_u32 s16, s16, 1
    s_cmp_gt_u32 s16, 100000
    s_cbranch_scc1 Lr_abort
    s_branch Lr3f_alp
Lr3f_aok:
    ds_write_b128 v0, v[36:39] offset:9984
    v_smfmac_f32_16x16x64_bf16 v[12:15], v[36:39], v[120:127], v1
    v_smfmac_f32_16x16x64_bf16 v[16:19], v[36:39], v[128:135], v1
    v_smfmac_f32_16x16x64_bf16 v[20:23], v[36:39], v[232:239], v1
    s_waitcnt lgkmcnt(0)
    s_barrier
    ds_read_b128 v[48:51], v0 offset:6912
    ds_read_b128 v[52:55], v0 offset:7936
    v_smfmac_f32_16x16x64_bf16 v[28:31], v[36:39], a[88:95], v1
    v_smfmac_f32_16x16x64_bf16 v[24:27], v[36:39], v[240:247], v1
    v_smfmac_f32_16x16x64_bf16 v[32:35], v[36:39], a[96:103], v1
    s_waitcnt vmcnt(0)
    ds_read_b128 v[36:39], v0 offset:8960
    s_waitcnt lgkmcnt(2)
    v_smfmac_f32_16x16x64_bf16 v[28:31], v[48:51], v[56:63], v1
    ds_read_b128 v[56:59], v8 offset:4096
    ds_read_b128 v[60:63], v8 offset:5120
    s_add_u32 s17, s34, 4096
    buffer_load_dwordx4 v[40:43], v0, s[8:11], s17 offen sc1
    v_smfmac_f32_16x16x64_bf16 v[12:15], v[48:51], v[72:79], v1
    v_smfmac_f32_16x16x64_bf16 v[16:19], v[48:51], v[80:87], v1
    v_smfmac_f32_16x16x64_bf16 v[32:35], v[48:51], v[64:71], v1
    ds_read_b128 v[64:67], v8 offset:6144
    ds_read_b128 v[68:71], v8 offset:7168
    v_smfmac_f32_16x16x64_bf16 v[20:23], v[48:51], v[184:191], v1
    buffer_load_dwordx4 v[44:47], v0, s[8:11], s35 offen sc1
    v_smfmac_f32_16x16x64_bf16 v[24:27], v[48:51], v[192:199], v1
    s_waitcnt lgkmcnt(5)
    v_smfmac_f32_16x16x64_bf16 v[28:31], v[52:55], a[72:79], v1
    v_smfmac_f32_16x16x64_bf16 v[12:15], v[52:55], v[88:95], v1
    v_smfmac_f32_16x16x64_bf16 v[16:19], v[52:55], v[96:103], v1
    v_smfmac_f32_16x16x64_bf16 v[32:35], v[52:55], a[80:87], v1
    v_smfmac_f32_16x16x64_bf16 v[20:23], v[52:55], v[200:207], v1
    v_smfmac_f32_16x16x64_bf16 v[24:27], v[52:55], v[208:215], v1
    s_waitcnt lgkmcnt(2)
    v_smfmac_f32_16x16x64_bf16 v[28:31], v[36:39], v[56:63], v1
    ds_read_b128 v[56:59], v8 offset:8192
    ds_read_b128 v[60:63], v8 offset:9216
    v_smfmac_f32_16x16x64_bf16 v[12:15], v[36:39], v[104:111], v1
    v_smfmac_f32_16x16x64_bf16 v[16:19], v[36:39], v[112:119], v1
    s_waitcnt lgkmcnt(2)
    v_smfmac_f32_16x16x64_bf16 v[32:35], v[36:39], v[64:71], v1
    ds_read_b128 v[64:67], v8 offset:10240
    ds_read_b128 v[68:71], v8 offset:11264
    v_smfmac_f32_16x16x64_bf16 v[20:23], v[36:39], v[216:223], v1
    v_smfmac_f32_16x16x64_bf16 v[24:27], v[36:39], v[224:231], v1
    s_waitcnt vmcnt(1)
    v_max3_u32 v10, v40, v41, v42
    v_max_u32 v10, v10, v43
    v_cmp_eq_u32 vcc, -1, v10
    s_nop 0
    s_cbranch_vccnz Lr3f_pb_re
Lr3f_pb_ok:
    ds_write_b128 v0, v[40:43] offset:14080
    v_smfmac_f32_16x16x64_bf16 v[12:15], v[40:43], v[152:159], v1
    v_smfmac_f32_16x16x64_bf16 v[20:23], v[40:43], a[40:47], v1
    v_smfmac_f32_16x16x64_bf16 v[16:19], v[40:43], v[160:167], v1
    v_smfmac_f32_16x16x64_bf16 v[24:27], v[40:43], a[48:55], v1
    s_waitcnt lgkmcnt(0)
    s_barrier
    ds_read_b128 v[48:51], v0 offset:11008
    ds_read_b128 v[52:55], v0 offset:12032
    ds_read_b128 v[36:39], v0 offset:13056
    v_smfmac_f32_16x16x64_bf16 v[28:31], v[40:43], a[152:159], v1
    v_smfmac_f32_16x16x64_bf16 v[32:35], v[40:43], a[160:167], v1
    s_waitcnt lgkmcnt(2)
    v_smfmac_f32_16x16x64_bf16 v[12:15], v[48:51], v[56:63], v1
    ds_read_b128 v[56:59], v8 offset:12288
    ds_read_b128 v[60:63], v8 offset:13312
    v_smfmac_f32_16x16x64_bf16 v[16:19], v[48:51], v[64:71], v1
    ds_read_b128 v[64:67], v8 offset:14336
    ds_read_b128 v[68:71], v8 offset:15360
    s_waitcnt lgkmcnt(5)
    v_smfmac_f32_16x16x64_bf16 v[12:15], v[52:55], v[136:143], v1
    v_smfmac_f32_16x16x64_bf16 v[16:19], v[52:55], v[144:151], v1
    s_waitcnt vmcnt(0)
    v_max3_u32 v10, v44, v45, v46
    v_max_u32 v10, v10, v47
    v_cmp_eq_u32 vcc, -1, v10
    s_nop 0
    s_cbranch_vccnz Lr3f_pc_re
Lr3f_pc_ok:
    v_smfmac_f32_16x16x64_bf16 v[12:15], v[44:47], v[168:175], v1
    v_smfmac_f32_16x16x64_bf16 v[16:19], v[44:47], v[176:183], v1
    s_waitcnt lgkmcnt(2)
    v_smfmac_f32_16x16x64_bf16 v[12:15], v[36:39], v[56:63], v1
    s_waitcnt lgkmcnt(0)
    v_smfmac_f32_16x16x64_bf16 v[16:19], v[36:39], v[64:71], v1
    v_smfmac_f32_16x16x64_bf16 v[20:23], v[48:51], v[248:255], v1
    v_smfmac_f32_16x16x64_bf16 v[24:27], v[48:51], a[0:7], v1
    v_smfmac_f32_16x16x64_bf16 v[20:23], v[52:55], a[8:15], v1
    v_add_f32 v12, v12, v14
    v_smfmac_f32_16x16x64_bf16 v[24:27], v[52:55], a[16:23], v1
    v_add_f32 v16, v16, v18
    buffer_load_dwordx4 v[64:67], v0, s[8:11], s42 offen
    v_smfmac_f32_16x16x64_bf16 v[20:23], v[36:39], a[24:31], v1
    v_add_f32 v13, v13, v15
    v_smfmac_f32_16x16x64_bf16 v[24:27], v[36:39], a[32:39], v1
    v_add_f32 v17, v17, v19
    v_smfmac_f32_16x16x64_bf16 v[20:23], v[44:47], a[56:63], v1
    v_cvt_pk_bf16_f32 v14, v12, v16
    ds_read_b128 v[56:59], v0 offset:15104
    v_smfmac_f32_16x16x64_bf16 v[24:27], v[44:47], a[64:71], v1
    v_cvt_pk_bf16_f32 v15, v13, v17
    ds_read_b128 v[60:63], v0 offset:16128
    buffer_load_dwordx4 v[68:71], v0, s[8:11], s42 offen offset:1024
    ds_write_b32 v2, v14 offset:576
    ds_write_b32 v2, v15 offset:864
    v_smfmac_f32_16x16x64_bf16 v[28:31], v[48:51], a[104:111], v1
    v_smfmac_f32_16x16x64_bf16 v[32:35], v[48:51], a[112:119], v1
    v_add_f32 v20, v20, v22
    v_add_f32 v24, v24, v26
    v_add_f32 v21, v21, v23
    v_add_f32 v25, v25, v27
    v_cvt_pk_bf16_f32 v22, v20, v24
    v_cvt_pk_bf16_f32 v23, v21, v25
    ds_write_b32 v2, v22 offset:0
    ds_write_b32 v2, v23 offset:288
    v_smfmac_f32_16x16x64_bf16 v[28:31], v[52:55], a[120:127], v1
    v_smfmac_f32_16x16x64_bf16 v[32:35], v[52:55], a[128:135], v1
    s_waitcnt lgkmcnt(0)
    s_barrier
    ds_read_b128 v[40:43], v3 offset:0
    ds_read_b128 v[48:51], v3 offset:64
    ds_read_b128 v[20:23], v3 offset:128
    ds_read_b128 v[52:55], v3 offset:192
    v_smfmac_f32_16x16x64_bf16 v[28:31], v[36:39], a[136:143], v1
    v_smfmac_f32_16x16x64_bf16 v[32:35], v[36:39], a[144:151], v1
    ds_read_b128 v[36:39], v0 offset:17152
    v_lshlrev_b32 v9, 3, v0
    buffer_load_dword v11, v9, s[8:11], s68 offen
    v_smfmac_f32_16x16x64_bf16 v[28:31], v[44:47], a[168:175], v1
    v_smfmac_f32_16x16x64_bf16 v[32:35], v[44:47], a[176:183], v1
    ds_read_b128 v[44:47], v0 offset:18176
    s_waitcnt lgkmcnt(5)
    v_mfma_f32_16x16x32_bf16 v[12:15], v[56:59], v[40:43], 0
    v_mfma_f32_16x16x32_bf16 v[16:19], v[60:63], v[40:43], 0
    v_mfma_f32_16x16x32_bf16 v[24:27], v[40:43], v[40:43], 0
    ds_read_b128 v[56:59], v0 offset:19200
    ds_read_b128 v[60:63], v0 offset:20224
    s_waitcnt lgkmcnt(3)
    v_mfma_f32_16x16x32_bf16 v[12:15], v[36:39], v[48:51], v[12:15]
    v_lshrrev_b32 v10, 1, v0
    v_lshrrev_b32 v9, 9, v0
    s_waitcnt lgkmcnt(2)
    v_mfma_f32_16x16x32_bf16 v[16:19], v[44:47], v[48:51], v[16:19]
    v_lshl_add_u32 v9, v9, 5, v10
    v_add_f32 v28, v28, v30
    v_mfma_f32_16x16x32_bf16 v[24:27], v[48:51], v[48:51], v[24:27]
    v_add_f32 v32, v32, v34
    v_add_f32 v29, v29, v31
    ds_read_b128 v[36:39], v0 offset:21248
    ds_read_b128 v[44:47], v0 offset:22272
    s_waitcnt lgkmcnt(3)
    v_mfma_f32_16x16x32_bf16 v[12:15], v[56:59], v[20:23], v[12:15]
    v_add_f32 v33, v33, v35
    v_cvt_pk_bf16_f32 v30, v28, v29
    s_waitcnt lgkmcnt(2)
    v_mfma_f32_16x16x32_bf16 v[16:19], v[60:63], v[20:23], v[16:19]
    v_cvt_pk_bf16_f32 v31, v32, v33
    ds_read_b64 v[34:35], v9 offset:3456
    v_mfma_f32_16x16x32_bf16 v[24:27], v[20:23], v[20:23], v[24:27]
    s_add_u32 s17, s43, 3584
    buffer_store_dwordx2 v[30:31], v10, s[8:11], s17 offen sc1
    s_waitcnt lgkmcnt(2)
    v_mfma_f32_16x16x32_bf16 v[12:15], v[36:39], v[52:55], v[12:15]
    s_waitcnt lgkmcnt(1)
    v_mfma_f32_16x16x32_bf16 v[16:19], v[44:47], v[52:55], v[16:19]
    v_mfma_f32_16x16x32_bf16 v[24:27], v[52:55], v[52:55], v[24:27]
    s_add_u32 s17, s43, 1536
    s_waitcnt lgkmcnt(0)
    buffer_store_dwordx2 v[34:35], v10, s[8:11], s17 offen sc1
    s_cmp_eq_u32 s33, 63
    s_cbranch_scc1 Lr3f_last
    ds_read_b128 v[56:59], v8 offset:16384
    ds_read_b128 v[60:63], v8 offset:17408
    v_mov_b64 v[20:21], s[52:53]
    v_mov_b64 v[22:23], s[52:53]
    v_mov_b32 v41, 0
    v_mov_b32 v42, 0
    v_max3_f32 v9, v12, v13, v14
    v_max3_f32 v9, v9, v15, v16
    v_max3_f32 v9, v9, v17, v18
    v_max3_f32 v9, v9, v19, v24
    v_max_f32 v9, v9, v25
    v_mov_b32 v10, v9
    v_mov_b64 v[32:33], 0
    v_mov_b64 v[34:35], 0
    v_permlane32_swap_b32 v9, v10
    v_max_f32 v9, v9, v10
    v_mov_b32 v10, v9
    s_nop 1
    v_permlane16_swap_b32 v9, v10
    v_max_f32 v9, v9, v10
    v_mul_f32 v28, s44, v9
    v_fma_f32 v12, v12, s44, -v28
    v_fma_f32 v13, v13, s44, -v28
    v_fma_f32 v14, v14, s44, -v28
    v_fma_f32 v15, v15, s44, -v28
    v_exp_f32 v12, v12
    v_exp_f32 v13, v13
    v_fma_f32 v16, v16, s44, -v28
    v_fma_f32 v17, v17, s44, -v28
    v_exp_f32 v14, v14
    v_exp_f32 v15, v15
    v_cvt_pk_bf16_f32 v36, v12, v13
    v_fma_f32 v18, v18, s44, -v28
    v_fma_f32 v19, v19, s44, -v28
    v_exp_f32 v16, v16
    v_exp_f32 v17, v17
    v_cvt_pk_bf16_f32 v37, v14, v15
    v_fma_f32 v24, v24, s44, -v28
    v_fma_f32 v25, v25, s44, -v28
    v_exp_f32 v18, v18
    v_exp_f32 v19, v19
    v_cvt_pk_bf16_f32 v38, v16, v17
    v_exp_f32 v24, v24
    v_exp_f32 v25, v25
    v_cvt_pk_bf16_f32 v39, v18, v19
    v_cvt_pk_bf16_f32 v40, v24, v25
    v_cvt_pk_bf16_f32 v43, v24, v25
    v_mfma_f32_16x16x32_bf16 v[52:55], v[20:23], v[36:39], 0
    v_mov_b64 v[12:13], 0
    v_mov_b64 v[14:15], 0
    s_waitcnt vmcnt(4)
    v_mfma_f32_16x16x32_bf16 v[44:47], v[64:67], v[36:39], 0
    v_mov_b64 v[24:25], 0
    v_mov_b64 v[26:27], 0
    s_waitcnt vmcnt(3)
    v_mfma_f32_16x16x32_bf16 v[48:51], v[68:71], v[36:39], 0
    ds_read_b128 v[64:67], v8 offset:20480
    ds_read_b128 v[68:71], v8 offset:21504
    v_mfma_f32_16x16x16_bf16 v[52:55], v[20:21], v[40:41], v[52:55]
    v_mfma_f32_16x16x16_bf16 v[44:47], v[30:31], v[40:41], v[44:47]
    v_mov_b64 v[20:21], 0
    v_mov_b64 v[22:23], 0
    v_mfma_f32_16x16x16_bf16 v[48:51], v[30:31], v[42:43], v[48:51]
    v_mov_b64 v[36:37], 0
    v_mov_b64 v[38:39], 0
    v_mov_b64 v[40:41], 0
    v_mov_b64 v[42:43], 0
    v_rcp_f32 v9, v52
    v_mov_b64 v[52:53], 0
    v_mov_b64 v[54:55], 0
    v_mul_f32 v44, v9, v44
    v_mul_f32 v48, v9, v48
    v_cvt_pk_bf16_f32 v16, v44, v48
    v_mul_f32 v45, v9, v45
    v_mul_f32 v49, v9, v49
    v_cvt_pk_bf16_f32 v17, v45, v49
    v_mul_f32 v46, v9, v46
    v_mul_f32 v50, v9, v50
    v_cvt_pk_bf16_f32 v18, v46, v50
    v_mul_f32 v47, v9, v47
    v_mul_f32 v51, v9, v51
    v_cvt_pk_bf16_f32 v19, v47, v51
    ds_write_b128 v5, v[16:19]
    v_mov_b64 v[28:29], 0
    v_mov_b64 v[30:31], 0
    s_waitcnt lgkmcnt(0)
    s_barrier
    ds_read_b128 v[44:47], v4 offset:0
    ds_read_b128 v[48:51], v4 offset:128
    v_mov_b64 v[16:17], 0
    v_mov_b64 v[18:19], 0
    buffer_load_dwordx4 v0, s[8:11], s41 offen offset:0 lds
    buffer_load_dwordx4 v0, s[8:11], s41 offen offset:1024 lds
    s_waitcnt lgkmcnt(1)
    v_smfmac_f32_16x16x64_bf16 v[12:15], v[44:47], a[184:191], v1
    s_waitcnt lgkmcnt(0)
    v_smfmac_f32_16x16x64_bf16 v[12:15], v[48:51], a[192:199], v1
    v_smfmac_f32_16x16x64_bf16 v[24:27], v[44:47], a[200:207], v1
    v_smfmac_f32_16x16x64_bf16 v[24:27], v[48:51], a[208:215], v1
    v_add_f32 v12, v12, v14
    v_smfmac_f32_16x16x64_bf16 v[20:23], v[44:47], a[216:223], v1
    v_add_f32 v13, v13, v15
    v_smfmac_f32_16x16x64_bf16 v[20:23], v[48:51], a[224:231], v1
    v_cvt_pk_bf16_f32 v12, v12, v13
    v_smfmac_f32_16x16x64_bf16 v[16:19], v[44:47], a[232:239], v1
    v_add_f32 v24, v24, v26
    v_smfmac_f32_16x16x64_bf16 v[16:19], v[48:51], a[240:247], v1
    v_add_f32 v25, v25, v27
    v_smfmac_f32_16x16x64_bf16 v[36:39], v[44:47], v[56:63], v1
    v_cvt_pk_bf16_f32 v13, v24, v25
    v_smfmac_f32_16x16x64_bf16 v[36:39], v[48:51], v[64:71], v1
    v_add_f32 v20, v20, v22
    v_add_f32 v21, v21, v23
    v_cvt_pk_bf16_f32 v14, v20, v21
    v_add_f32 v16, v16, v18
    v_add_f32 v17, v17, v19
    v_cvt_pk_bf16_f32 v15, v16, v17
    v_and_or_b32 v15, v15, -2, s40
    buffer_store_dwordx4 v[12:15], v0, s[8:11], s38 offen
    s_nop 0
    ds_read_b128 v[12:15], v8 offset:18432
    ds_read_b128 v[16:19], v8 offset:19456
    ds_read_b128 v[20:23], v8 offset:22528
    ds_read_b128 v[24:27], v8 offset:23552
    ds_read_b128 v[56:59], v8 offset:24576
    ds_read_b128 v[60:63], v8 offset:25600
    ds_read_b128 v[64:67], v8 offset:28672
    ds_read_b128 v[68:71], v8 offset:29696
    s_waitcnt lgkmcnt(6)
    v_smfmac_f32_16x16x64_bf16 v[40:43], v[44:47], v[12:19], v1
    ds_read_b128 v[12:15], v8 offset:26624
    ds_read_b128 v[16:19], v8 offset:27648
    s_waitcnt lgkmcnt(6)
    v_smfmac_f32_16x16x64_bf16 v[40:43], v[48:51], v[20:27], v1
    ds_read_b128 v[20:23], v8 offset:30720
    ds_read_b128 v[24:27], v8 offset:31744
    s_waitcnt lgkmcnt(6)
    v_smfmac_f32_16x16x64_bf16 v[52:55], v[44:47], v[56:63], v1
    ds_read_b128 v[56:59], v8 offset:32768
    ds_read_b128 v[60:63], v8 offset:33792
    s_waitcnt lgkmcnt(6)
    v_smfmac_f32_16x16x64_bf16 v[52:55], v[48:51], v[64:71], v1
    s_waitcnt lgkmcnt(4)
    v_smfmac_f32_16x16x64_bf16 v[32:35], v[44:47], v[12:19], v1
    s_waitcnt lgkmcnt(2)
    v_smfmac_f32_16x16x64_bf16 v[32:35], v[48:51], v[20:27], v1
    v_smfmac_f32_16x16x64_bf16 v[28:31], v[44:47], a[248:255], v1
    s_waitcnt lgkmcnt(0)
    v_smfmac_f32_16x16x64_bf16 v[28:31], v[48:51], v[56:63], v1
    v_add_f32 v36, v36, v38
    v_add_f32 v37, v37, v39
    v_cvt_pk_bf16_f32 v36, v36, v37
    v_add_f32 v40, v40, v42
    v_add_f32 v41, v41, v43
    v_cvt_pk_bf16_f32 v37, v40, v41
    v_add_f32 v52, v52, v54
    v_add_f32 v53, v53, v55
    v_cvt_pk_bf16_f32 v38, v52, v53
    v_add_f32 v32, v32, v34
    v_add_f32 v33, v33, v35
    v_cvt_pk_bf16_f32 v39, v32, v33
    v_and_or_b32 v39, v39, -2, s40
    s_add_u32 s17, s38, 4096
    buffer_store_dwordx4 v[36:39], v0, s[8:11], s17 offen
    v_add_f32 v28, v28, v30
    v_add_f32 v29, v29, v31
    v_cvt_pk_bf16_f32 v28, v28, v29
    v_and_or_b32 v28, v28, -2, s40
    v_lshrrev_b32 v9, 2, v0
    buffer_store_dword v28, v9, s[8:11], s39 offen
    s_xor_b32 s34, s34, 16384
    s_xor_b32 s35, s35, 16384
    s_add_u32 s33, s33, 1
    s_add_u32 s42, s42, 262144
    s_add_u32 s41, s41, 262144
    s_add_u32 s43, s43, 131072
    s_add_u32 s68, s68, 262144
    s_add_u32 s66, s66, 22528
    s_xor_b32 s40, s40, 1
    ds_read_b128 v[56:59], v8 offset:0
    ds_read_b128 v[60:63], v8 offset:1024
    ds_read_b128 v[64:67], v8 offset:2048
    ds_read_b128 v[68:71], v8 offset:3072
    v_mov_b64 v[12:13], 0
    v_mov_b64 v[14:15], 0
    v_mov_b64 v[16:17], 0
    v_mov_b64 v[18:19], 0
    v_mov_b64 v[20:21], 0
    v_mov_b64 v[22:23], 0
    v_mov_b64 v[24:25], 0
    v_mov_b64 v[26:27], 0
    v_mov_b64 v[28:29], 0
    v_mov_b64 v[30:31], 0
    v_mov_b64 v[32:33], 0
    v_mov_b64 v[34:35], 0
    s_sleep 5
    s_nop 9
    buffer_load_dwordx4 v[36:39], v0, s[8:11], s34 offen sc1
    s_nop 15
    s_nop 8
    buffer_load_dwordx4 v[36:39], v0, s[8:11], s34 offen sc1
    s_nop 15
    s_nop 8
    buffer_load_dwordx4 v[36:39], v0, s[8:11], s34 offen sc1
    s_waitcnt lgkmcnt(0)
    s_branch Lr3f_step
Lr3f_pb_re:
    s_mov_b32 s16, 0
Lr3f_pb_lp:
    s_add_u32 s17, s34, 4096
    buffer_load_dwordx4 v[40:43], v0, s[8:11], s17 offen sc1
    s_add_u32 s16, s16, 1
    s_cmp_gt_u32 s16, 100000
    s_cbranch_scc1 Lr_abort
    s_waitcnt vmcnt(0)
    v_max3_u32 v10, v40, v41, v42
    v_max_u32 v10, v10, v43
    v_cmp_eq_u32 vcc, -1, v10
    s_nop 0
    s_cbranch_vccnz Lr3f_pb_lp
    s_branch Lr3f_pb_ok
Lr3f_pc_re:
    s_mov_b32 s16, 0
Lr3f_pc_lp:
    buffer_load_dwordx4 v[44:47], v0, s[8:11], s35 offen sc1
    s_add_u32 s16, s16, 1
    s_cmp_gt_u32 s16, 100000
    s_cbranch_scc1 Lr_abort
    s_waitcnt vmcnt(0)
    v_max3_u32 v10, v44, v45, v46
    v_max_u32 v10, v10, v47
    v_cmp_eq_u32 vcc, -1, v10
    s_nop 0
    s_cbranch_vccnz Lr3f_pc_lp
    s_branch Lr3f_pc_ok
Lr3f_last:
    s_waitcnt vmcnt(0) lgkmcnt(0)
    s_barrier
    s_branch Lr_exit
L_slow:
    s_cmp_lg_u32 s14, 0
    s_cbranch_scc1 L_w1_0
    s_mov_b32 s16, 0
    s_add_u32 s17, s66, 128
    v_lshrrev_b32 v10, 2, v0
    v_and_b32 v9, 16, v10
    v_lshlrev_b32 v9, 3, v9
    v_and_or_b32 v10, v10, 12, v9
Lr0s_fw_15:
    buffer_load_dword v9, v10, s[8:11], s17 offen sc1
    s_add_u32 s16, s16, 1
    s_cmp_gt_u32 s16, 100000
    s_cbranch_scc1 Lr_abort
    s_waitcnt vmcnt(0)
    v_cmp_eq_u32 vcc, 0, v9
    s_nop 0
    s_cbranch_vccnz Lr0s_fw_15
    s_mov_b32 m0, 15104
    s_nop 0
    buffer_load_dwordx4 v0, s[8:11], s41 offen offset:0 lds
    buffer_load_dwordx4 v0, s[8:11], s41 offen offset:1024 lds
    s_add_u32 s41, s41, 262144
    s_add_u32 s68, s68, 4278452224
    s_waitcnt vmcnt(0)
    ds_read_b128 v[56:59], v8 offset:0
    ds_read_b128 v[60:63], v8 offset:1024
    ds_read_b128 v[64:67], v8 offset:2048
    ds_read_b128 v[68:71], v8 offset:3072
    v_mov_b64 v[12:13], 0
    v_mov_b64 v[14:15], 0
    v_mov_b64 v[16:17], 0
    v_mov_b64 v[18:19], 0
    v_mov_b64 v[20:21], 0
    v_mov_b64 v[22:23], 0
    v_mov_b64 v[24:25], 0
    v_mov_b64 v[26:27], 0
    v_mov_b64 v[28:29], 0
    v_mov_b64 v[30:31], 0
    v_mov_b64 v[32:33], 0
    v_mov_b64 v[34:35], 0
    buffer_load_dwordx4 v[36:39], v0, s[8:11], s34 offen sc1
    s_waitcnt vmcnt(0) lgkmcnt(0)
Lr0s_step:
    s_mov_b32 s16, 0
Lr0s_alp:
    s_waitcnt vmcnt(2)
    v_max3_u32 v10, v36, v37, v38
    v_max_u32 v10, v10, v39
    v_cmp_eq_u32 vcc, -1, v10
    s_nop 0
    s_cbranch_vccz Lr0s_aok
    buffer_load_dwordx4 v[36:39], v0, s[8:11], s34 offen sc1
    s_add_u32 s16, s16, 1
    s_cmp_gt_u32 s16, 100000
    s_cbranch_scc1 Lr_abort
    s_branch Lr0s_alp
Lr0s_aok:
    ds_write_b128 v0, v[36:39] offset:6912
    v_smfmac_f32_16x16x64_bf16 v[12:15], v[36:39], v[72:79], v1
    v_smfmac_f32_16x16x64_bf16 v[16:19], v[36:39], v[80:87], v1
    v_smfmac_f32_16x16x64_bf16 v[20:23], v[36:39], v[184:191], v1
    s_waitcnt lgkmcnt(0)
    s_barrier
    ds_read_b128 v[48:51], v0 offset:7936
    ds_read_b128 v[52:55], v0 offset:8960
    v_smfmac_f32_16x16x64_bf16 v[28:31], v[36:39], v[56:63], v1
    ds_read_b128 v[56:59], v8 offset:4096
    ds_read_b128 v[60:63], v8 offset:5120
    s_add_u32 s17, s34, 4096
    buffer_load_dwordx4 v[40:43], v0, s[8:11], s17 offen sc1
    v_smfmac_f32_16x16x64_bf16 v[24:27], v[36:39], v[192:199], v1
    v_smfmac_f32_16x16x64_bf16 v[32:35], v[36:39], v[64:71], v1
    ds_read_b128 v[64:67], v8 offset:6144
    ds_read_b128 v[68:71], v8 offset:7168
    s_waitcnt vmcnt(1)
    ds_read_b128 v[36:39], v0 offset:9984
    s_waitcnt lgkmcnt(6)
    v_smfmac_f32_16x16x64_bf16 v[28:31], v[48:51], a[72:79], v1
    v_smfmac_f32_16x16x64_bf16 v[12:15], v[48:51], v[88:95], v1
    buffer_load_dwordx4 v[44:47], v0, s[8:11], s35 offen sc1
    v_smfmac_f32_16x16x64_bf16 v[16:19], v[48:51], v[96:103], v1
    v_smfmac_f32_16x16x64_bf16 v[32:35], v[48:51], a[80:87], v1
    v_smfmac_f32_16x16x64_bf16 v[20:23], v[48:51], v[200:207], v1
    v_smfmac_f32_16x16x64_bf16 v[24:27], v[48:51], v[208:215], v1
    s_waitcnt lgkmcnt(3)
    v_smfmac_f32_16x16x64_bf16 v[28:31], v[52:55], v[56:63], v1
    ds_read_b128 v[56:59], v8 offset:8192
    ds_read_b128 v[60:63], v8 offset:9216
    v_smfmac_f32_16x16x64_bf16 v[12:15], v[52:55], v[104:111], v1
    v_smfmac_f32_16x16x64_bf16 v[16:19], v[52:55], v[112:119], v1
    s_waitcnt lgkmcnt(3)
    v_smfmac_f32_16x16x64_bf16 v[32:35], v[52:55], v[64:71], v1
    ds_read_b128 v[64:67], v8 offset:10240
    ds_read_b128 v[68:71], v8 offset:11264
    v_smfmac_f32_16x16x64_bf16 v[20:23], v[52:55], v[216:223], v1
    v_smfmac_f32_16x16x64_bf16 v[24:27], v[52:55], v[224:231], v1
    s_waitcnt lgkmcnt(4)
    v_smfmac_f32_16x16x64_bf16 v[28:31], v[36:39], a[88:95], v1
    v_smfmac_f32_16x16x64_bf16 v[12:15], v[36:39], v[120:127], v1
    v_smfmac_f32_16x16x64_bf16 v[16:19], v[36:39], v[128:135], v1
    v_smfmac_f32_16x16x64_bf16 v[32:35], v[36:39], a[96:103], v1
    v_smfmac_f32_16x16x64_bf16 v[20:23], v[36:39], v[232:239], v1
    v_smfmac_f32_16x16x64_bf16 v[24:27], v[36:39], v[240:247], v1
    s_waitcnt vmcnt(1)
    v_max3_u32 v10, v40, v41, v42
    v_max_u32 v10, v10, v43
    v_cmp_eq_u32 vcc, -1, v10
    s_nop 0
    s_cbranch_vccnz Lr0s_pb_re
Lr0s_pb_ok:
    ds_write_b128 v0, v[40:43] offset:11008
    s_waitcnt lgkmcnt(3)
    v_smfmac_f32_16x16x64_bf16 v[12:15], v[40:43], v[56:63], v1
    ds_read_b128 v[56:59], v8 offset:12288
    ds_read_b128 v[60:63], v8 offset:13312
    v_smfmac_f32_16x16x64_bf16 v[20:23], v[40:43], v[248:255], v1
    s_waitcnt lgkmcnt(3)
    v_smfmac_f32_16x16x64_bf16 v[16:19], v[40:43], v[64:71], v1
    ds_read_b128 v[64:67], v8 offset:14336
    ds_read_b128 v[68:71], v8 offset:15360
    v_smfmac_f32_16x16x64_bf16 v[24:27], v[40:43], a[0:7], v1
    s_waitcnt lgkmcnt(4)
    s_barrier
    ds_read_b128 v[48:51], v0 offset:13056
    ds_read_b128 v[52:55], v0 offset:12032
    ds_read_b128 v[36:39], v0 offset:14080
    v_smfmac_f32_16x16x64_bf16 v[28:31], v[40:43], a[104:111], v1
    v_smfmac_f32_16x16x64_bf16 v[32:35], v[40:43], a[112:119], v1
    s_waitcnt lgkmcnt(2)
    v_smfmac_f32_16x16x64_bf16 v[12:15], v[48:51], v[56:63], v1
    v_smfmac_f32_16x16x64_bf16 v[16:19], v[48:51], v[64:71], v1
    s_waitcnt lgkmcnt(1)
    v_smfmac_f32_16x16x64_bf16 v[12:15], v[52:55], v[136:143], v1
    v_smfmac_f32_16x16x64_bf16 v[16:19], v[52:55], v[144:151], v1
    s_waitcnt lgkmcnt(0)
    v_smfmac_f32_16x16x64_bf16 v[12:15], v[36:39], v[152:159], v1
    v_smfmac_f32_16x16x64_bf16 v[16:19], v[36:39], v[160:167], v1
    s_waitcnt vmcnt(0)
    v_max3_u32 v10, v44, v45, v46
    v_max_u32 v10, v10, v47
    v_cmp_eq_u32 vcc, -1, v10
    s_nop 0
    s_cbranch_vccnz Lr0s_pc_re
Lr0s_pc_ok:
    v_smfmac_f32_16x16x64_bf16 v[12:15], v[44:47], v[168:175], v1
    v_smfmac_f32_16x16x64_bf16 v[16:19], v[44:47], v[176:183], v1
    v_smfmac_f32_16x16x64_bf16 v[20:23], v[48:51], a[24:31], v1
    buffer_load_dwordx4 v[64:67], v0, s[8:11], s42 offen
    v_smfmac_f32_16x16x64_bf16 v[24:27], v[48:51], a[32:39], v1
    v_smfmac_f32_16x16x64_bf16 v[20:23], v[52:55], a[8:15], v1
    v_add_f32 v12, v12, v14
    v_smfmac_f32_16x16x64_bf16 v[24:27], v[52:55], a[16:23], v1
    v_add_f32 v16, v16, v18
    v_smfmac_f32_16x16x64_bf16 v[20:23], v[36:39], a[40:47], v1
    v_add_f32 v13, v13, v15
    buffer_load_dwordx4 v[68:71], v0, s[8:11], s42 offen offset:1024
    v_smfmac_f32_16x16x64_bf16 v[24:27], v[36:39], a[48:55], v1
    v_add_f32 v17, v17, v19
    v_smfmac_f32_16x16x64_bf16 v[20:23], v[44:47], a[56:63], v1
    v_cvt_pk_bf16_f32 v14, v12, v16
    ds_read_b128 v[56:59], v0 offset:15104
    v_smfmac_f32_16x16x64_bf16 v[24:27], v[44:47], a[64:71], v1
    v_cvt_pk_bf16_f32 v15, v13, v17
    ds_read_b128 v[60:63], v0 offset:16128
    ds_write_b32 v2, v14 offset:576
    ds_write_b32 v2, v15 offset:864
    v_smfmac_f32_16x16x64_bf16 v[28:31], v[48:51], a[136:143], v1
    v_smfmac_f32_16x16x64_bf16 v[32:35], v[48:51], a[144:151], v1
    v_add_f32 v20, v20, v22
    v_add_f32 v24, v24, v26
    v_add_f32 v21, v21, v23
    v_add_f32 v25, v25, v27
    v_cvt_pk_bf16_f32 v22, v20, v24
    v_cvt_pk_bf16_f32 v23, v21, v25
    ds_write_b32 v2, v22 offset:0
    ds_write_b32 v2, v23 offset:288
    v_smfmac_f32_16x16x64_bf16 v[28:31], v[52:55], a[120:127], v1
    v_smfmac_f32_16x16x64_bf16 v[32:35], v[52:55], a[128:135], v1
    s_waitcnt lgkmcnt(0)
    s_barrier
    ds_read_b128 v[40:43], v3 offset:0
    ds_read_b128 v[48:51], v3 offset:64
    ds_read_b128 v[20:23], v3 offset:128
    ds_read_b128 v[52:55], v3 offset:192
    v_smfmac_f32_16x16x64_bf16 v[28:31], v[36:39], a[152:159], v1
    v_smfmac_f32_16x16x64_bf16 v[32:35], v[36:39], a[160:167], v1
    ds_read_b128 v[36:39], v0 offset:17152
    v_lshlrev_b32 v9, 3, v0
    buffer_load_dword v11, v9, s[8:11], s68 offen
    v_smfmac_f32_16x16x64_bf16 v[28:31], v[44:47], a[168:175], v1
    v_smfmac_f32_16x16x64_bf16 v[32:35], v[44:47], a[176:183], v1
    ds_read_b128 v[44:47], v0 offset:18176
    s_waitcnt lgkmcnt(5)
    v_mfma_f32_16x16x32_bf16 v[12:15], v[56:59], v[40:43], 0
    v_mfma_f32_16x16x32_bf16 v[16:19], v[60:63], v[40:43], 0
    v_mfma_f32_16x16x32_bf16 v[24:27], v[40:43], v[40:43], 0
    ds_read_b128 v[56:59], v0 offset:19200
    ds_read_b128 v[60:63], v0 offset:20224
    s_waitcnt lgkmcnt(3)
    v_mfma_f32_16x16x32_bf16 v[12:15], v[36:39], v[48:51], v[12:15]
    v_lshrrev_b32 v10, 1, v0
    v_lshrrev_b32 v9, 9, v0
    s_waitcnt lgkmcnt(2)
    v_mfma_f32_16x16x32_bf16 v[16:19], v[44:47], v[48:51], v[16:19]
    v_lshl_add_u32 v9, v9, 5, v10
    v_add_f32 v28, v28, v30
    v_mfma_f32_16x16x32_bf16 v[24:27], v[48:51], v[48:51], v[24:27]
    v_add_f32 v32, v32, v34
    v_add_f32 v29, v29, v31
    ds_read_b128 v[36:39], v0 offset:21248
    ds_read_b128 v[44:47], v0 offset:22272
    s_waitcnt lgkmcnt(3)
    v_mfma_f32_16x16x32_bf16 v[12:15], v[56:59], v[20:23], v[12:15]
    v_add_f32 v33, v33, v35
    v_cvt_pk_bf16_f32 v30, v28, v29
    s_waitcnt lgkmcnt(2)
    v_mfma_f32_16x16x32_bf16 v[16:19], v[60:63], v[20:23], v[16:19]
    v_cvt_pk_bf16_f32 v31, v32, v33
    ds_read_b64 v[34:35], v9 offset:0
    v_mfma_f32_16x16x32_bf16 v[24:27], v[20:23], v[20:23], v[24:27]
    s_add_u32 s17, s43, 2048
    buffer_store_dwordx2 v[30:31], v10, s[8:11], s17 offen sc1
    s_waitcnt lgkmcnt(2)
    v_mfma_f32_16x16x32_bf16 v[12:15], v[36:39], v[52:55], v[12:15]
    s_waitcnt lgkmcnt(1)
    v_mfma_f32_16x16x32_bf16 v[16:19], v[44:47], v[52:55], v[16:19]
    v_mfma_f32_16x16x32_bf16 v[24:27], v[52:55], v[52:55], v[24:27]
    s_add_u32 s17, s43, 0
    s_waitcnt lgkmcnt(0)
    buffer_store_dwordx2 v[34:35], v10, s[8:11], s17 offen sc1
    s_cmp_eq_u32 s33, 63
    s_cbranch_scc1 Lr0s_last
    ds_read_b128 v[56:59], v8 offset:16384
    ds_read_b128 v[60:63], v8 offset:17408
    v_mov_b64 v[20:21], s[52:53]
    v_mov_b64 v[22:23], s[52:53]
    v_mov_b32 v41, 0
    v_mov_b32 v42, 0
    v_max3_f32 v9, v12, v13, v14
    v_max3_f32 v9, v9, v15, v16
    v_max3_f32 v9, v9, v17, v18
    v_max3_f32 v9, v9, v19, v24
    v_max_f32 v9, v9, v25
    v_mov_b32 v10, v9
    v_mov_b64 v[32:33], 0
    v_mov_b64 v[34:35], 0
    v_permlane32_swap_b32 v9, v10
    v_max_f32 v9, v9, v10
    v_mov_b32 v10, v9
    s_nop 1
    v_permlane16_swap_b32 v9, v10
    v_max_f32 v9, v9, v10
    v_mul_f32 v28, s44, v9
    v_fma_f32 v12, v12, s44, -v28
    v_fma_f32 v13, v13, s44, -v28
    v_fma_f32 v14, v14, s44, -v28
    v_fma_f32 v15, v15, s44, -v28
    v_exp_f32 v12, v12
    v_exp_f32 v13, v13
    v_fma_f32 v16, v16, s44, -v28
    v_fma_f32 v17, v17, s44, -v28
    v_exp_f32 v14, v14
    v_exp_f32 v15, v15
    v_cvt_pk_bf16_f32 v36, v12, v13
    v_fma_f32 v18, v18, s44, -v28
    v_fma_f32 v19, v19, s44, -v28
    v_exp_f32 v16, v16
    v_exp_f32 v17, v17
    v_cvt_pk_bf16_f32 v37, v14, v15
    v_fma_f32 v24, v24, s44, -v28
    v_fma_f32 v25, v25, s44, -v28
    v_exp_f32 v18, v18
    v_exp_f32 v19, v19
    v_cvt_pk_bf16_f32 v38, v16, v17
    v_exp_f32 v24, v24
    v_exp_f32 v25, v25
    v_cvt_pk_bf16_f32 v39, v18, v19
    v_cvt_pk_bf16_f32 v40, v24, v25
    v_cvt_pk_bf16_f32 v43, v24, v25
    v_mfma_f32_16x16x32_bf16 v[52:55], v[20:23], v[36:39], 0
    v_mov_b64 v[12:13], 0
    v_mov_b64 v[14:15], 0
    s_waitcnt vmcnt(4)
    v_mfma_f32_16x16x32_bf16 v[44:47], v[64:67], v[36:39], 0
    v_mov_b64 v[24:25], 0
    v_mov_b64 v[26:27], 0
    s_waitcnt vmcnt(3)
    v_mfma_f32_16x16x32_bf16 v[48:51], v[68:71], v[36:39], 0
    ds_read_b128 v[64:67], v8 offset:20480
    ds_read_b128 v[68:71], v8 offset:21504
    v_mfma_f32_16x16x16_bf16 v[52:55], v[20:21], v[40:41], v[52:55]
    v_mfma_f32_16x16x16_bf16 v[44:47], v[30:31], v[40:41], v[44:47]
    v_mov_b64 v[20:21], 0
    v_mov_b64 v[22:23], 0
    v_mfma_f32_16x16x16_bf16 v[48:51], v[30:31], v[42:43], v[48:51]
    v_mov_b64 v[36:37], 0
    v_mov_b64 v[38:39], 0
    v_mov_b64 v[40:41], 0
    v_mov_b64 v[42:43], 0
    v_rcp_f32 v9, v52
    v_mov_b64 v[52:53], 0
    v_mov_b64 v[54:55], 0
    v_mul_f32 v44, v9, v44
    v_mul_f32 v48, v9, v48
    v_cvt_pk_bf16_f32 v16, v44, v48
    v_mul_f32 v45, v9, v45
    v_mul_f32 v49, v9, v49
    v_cvt_pk_bf16_f32 v17, v45, v49
    v_mul_f32 v46, v9, v46
    v_mul_f32 v50, v9, v50
    v_cvt_pk_bf16_f32 v18, v46, v50
    v_mul_f32 v47, v9, v47
    v_mul_f32 v51, v9, v51
    v_cvt_pk_bf16_f32 v19, v47, v51
    ds_write_b128 v5, v[16:19]
    v_mov_b64 v[28:29], 0
    v_mov_b64 v[30:31], 0
    s_waitcnt lgkmcnt(0)
    s_barrier
    ds_read_b128 v[44:47], v4 offset:0
    ds_read_b128 v[48:51], v4 offset:128
    v_mov_b64 v[16:17], 0
    v_mov_b64 v[18:19], 0
    buffer_load_dwordx4 v0, s[8:11], s41 offen offset:0 lds
    buffer_load_dwordx4 v0, s[8:11], s41 offen offset:1024 lds
    s_waitcnt lgkmcnt(1)
    v_smfmac_f32_16x16x64_bf16 v[12:15], v[44:47], a[184:191], v1
    s_waitcnt lgkmcnt(0)
    v_smfmac_f32_16x16x64_bf16 v[12:15], v[48:51], a[192:199], v1
    v_smfmac_f32_16x16x64_bf16 v[24:27], v[44:47], a[200:207], v1
    v_smfmac_f32_16x16x64_bf16 v[24:27], v[48:51], a[208:215], v1
    v_add_f32 v12, v12, v14
    v_smfmac_f32_16x16x64_bf16 v[20:23], v[44:47], a[216:223], v1
    v_add_f32 v13, v13, v15
    v_smfmac_f32_16x16x64_bf16 v[20:23], v[48:51], a[224:231], v1
    v_cvt_pk_bf16_f32 v12, v12, v13
    v_smfmac_f32_16x16x64_bf16 v[16:19], v[44:47], a[232:239], v1
    v_add_f32 v24, v24, v26
    v_smfmac_f32_16x16x64_bf16 v[16:19], v[48:51], a[240:247], v1
    v_add_f32 v25, v25, v27
    v_smfmac_f32_16x16x64_bf16 v[36:39], v[44:47], v[56:63], v1
    v_cvt_pk_bf16_f32 v13, v24, v25
    v_smfmac_f32_16x16x64_bf16 v[36:39], v[48:51], v[64:71], v1
    v_add_f32 v20, v20, v22
    v_add_f32 v21, v21, v23
    v_cvt_pk_bf16_f32 v14, v20, v21
    v_add_f32 v16, v16, v18
    v_add_f32 v17, v17, v19
    v_cvt_pk_bf16_f32 v15, v16, v17
    v_and_or_b32 v15, v15, -2, s40
    buffer_store_dwordx4 v[12:15], v0, s[8:11], s38 offen sc1
    s_nop 0
    ds_read_b128 v[12:15], v8 offset:18432
    ds_read_b128 v[16:19], v8 offset:19456
    ds_read_b128 v[20:23], v8 offset:22528
    ds_read_b128 v[24:27], v8 offset:23552
    ds_read_b128 v[56:59], v8 offset:24576
    ds_read_b128 v[60:63], v8 offset:25600
    ds_read_b128 v[64:67], v8 offset:28672
    ds_read_b128 v[68:71], v8 offset:29696
    s_waitcnt lgkmcnt(6)
    v_smfmac_f32_16x16x64_bf16 v[40:43], v[44:47], v[12:19], v1
    ds_read_b128 v[12:15], v8 offset:26624
    ds_read_b128 v[16:19], v8 offset:27648
    s_waitcnt lgkmcnt(6)
    v_smfmac_f32_16x16x64_bf16 v[40:43], v[48:51], v[20:27], v1
    ds_read_b128 v[20:23], v8 offset:30720
    ds_read_b128 v[24:27], v8 offset:31744
    s_waitcnt lgkmcnt(6)
    v_smfmac_f32_16x16x64_bf16 v[52:55], v[44:47], v[56:63], v1
    ds_read_b128 v[56:59], v8 offset:32768
    ds_read_b128 v[60:63], v8 offset:33792
    s_waitcnt lgkmcnt(6)
    v_smfmac_f32_16x16x64_bf16 v[52:55], v[48:51], v[64:71], v1
    s_waitcnt lgkmcnt(4)
    v_smfmac_f32_16x16x64_bf16 v[32:35], v[44:47], v[12:19], v1
    s_waitcnt lgkmcnt(2)
    v_smfmac_f32_16x16x64_bf16 v[32:35], v[48:51], v[20:27], v1
    v_smfmac_f32_16x16x64_bf16 v[28:31], v[44:47], a[248:255], v1
    s_waitcnt lgkmcnt(0)
    v_smfmac_f32_16x16x64_bf16 v[28:31], v[48:51], v[56:63], v1
    buffer_load_dwordx4 v[12:15], v6, s[8:11], s62 offen sc1
    buffer_load_dwordx4 v[16:19], v6, s[8:11], s63 offen sc1
    buffer_load_dwordx4 v[20:23], v6, s[8:11], s64 offen sc1
    buffer_load_dwordx4 v[24:27], v6, s[8:11], s65 offen sc1
    v_add_f32 v36, v36, v38
    v_add_f32 v37, v37, v39
    v_cvt_pk_bf16_f32 v36, v36, v37
    v_add_f32 v40, v40, v42
    v_add_f32 v41, v41, v43
    v_cvt_pk_bf16_f32 v37, v40, v41
    v_add_f32 v52, v52, v54
    v_add_f32 v53, v53, v55
    v_cvt_pk_bf16_f32 v38, v52, v53
    v_add_f32 v32, v32, v34
    v_add_f32 v33, v33, v35
    v_cvt_pk_bf16_f32 v39, v32, v33
    v_and_or_b32 v39, v39, -2, s40
    s_add_u32 s17, s38, 4096
    buffer_store_dwordx4 v[36:39], v0, s[8:11], s17 offen sc1
    v_add_f32 v28, v28, v30
    v_add_f32 v29, v29, v31
    v_cvt_pk_bf16_f32 v28, v28, v29
    v_and_or_b32 v28, v28, -2, s40
    v_lshrrev_b32 v9, 2, v0
    buffer_store_dword v28, v9, s[8:11], s39 offen sc1
    v_add_u32 v10, 162560, v0
    ds_read_b128 v[64:67], v10
    s_nop 9
    buffer_load_dwordx4 v[40:43], v6, s[8:11], s62 offen sc1
    buffer_load_dwordx4 v[44:47], v6, s[8:11], s63 offen sc1
    buffer_load_dwordx4 v[48:51], v6, s[8:11], s64 offen sc1
    buffer_load_dwordx4 v[52:55], v6, s[8:11], s65 offen sc1
    s_add_u32 s33, s33, 1
    s_add_u32 s42, s42, 262144
    s_add_u32 s41, s41, 262144
    s_add_u32 s43, s43, 131072
    s_add_u32 s68, s68, 262144
    s_add_u32 s66, s66, 22528
    ds_read_b128 v[56:59], v8 offset:0
    ds_read_b128 v[60:63], v8 offset:1024
    s_waitcnt lgkmcnt(2)
    s_waitcnt vmcnt(9)
    v_mfma_f32_16x16x32_bf16 v[68:71], v[12:15], v[64:67], 0
    v_and_b32 v10, 1, v15
    v_cmp_ne_u32 s[54:55], s40, v10
    s_waitcnt vmcnt(8)
    v_mfma_f32_16x16x32_bf16 v[68:71], v[16:19], v[64:67], v[68:71]
    v_and_b32 v10, 1, v19
    v_cmp_ne_u32 s[56:57], s40, v10
    s_waitcnt vmcnt(7)
    v_mfma_f32_16x16x32_bf16 v[68:71], v[20:23], v[64:67], v[68:71]
    v_and_b32 v10, 1, v23
    v_cmp_ne_u32 s[58:59], s40, v10
    s_waitcnt vmcnt(6)
    v_mfma_f32_16x16x32_bf16 v[68:71], v[24:27], v[64:67], v[68:71]
    v_and_b32 v10, 1, v27
    v_cmp_ne_u32 s[60:61], s40, v10
    s_or_b64 vcc, s[54:55], s[56:57]
    s_or_b64 vcc, vcc, s[58:59]
    s_or_b64 vcc, vcc, s[60:61]
    s_cbranch_scc0 Lr0s_red
    s_mov_b32 s16, 0
Lr0s_p1:
    buffer_load_dwordx4 v[12:15], v6, s[8:11], s62 offen sc1
    buffer_load_dwordx4 v[16:19], v6, s[8:11], s63 offen sc1
    buffer_load_dwordx4 v[20:23], v6, s[8:11], s64 offen sc1
    buffer_load_dwordx4 v[24:27], v6, s[8:11], s65 offen sc1
    s_waitcnt vmcnt(7)
    v_mfma_f32_16x16x32_bf16 v[68:71], v[40:43], v[64:67], 0
    v_and_b32 v10, 1, v43
    v_cmp_ne_u32 s[54:55], s40, v10
    s_waitcnt vmcnt(6)
    v_mfma_f32_16x16x32_bf16 v[68:71], v[44:47], v[64:67], v[68:71]
    v_and_b32 v10, 1, v47
    v_cmp_ne_u32 s[56:57], s40, v10
    s_waitcnt vmcnt(5)
    v_mfma_f32_16x16x32_bf16 v[68:71], v[48:51], v[64:67], v[68:71]
    v_and_b32 v10, 1, v51
    v_cmp_ne_u32 s[58:59], s40, v10
    s_waitcnt vmcnt(4)
    v_mfma_f32_16x16x32_bf16 v[68:71], v[52:55], v[64:67], v[68:71]
    v_and_b32 v10, 1, v55
    v_cmp_ne_u32 s[60:61], s40, v10
    s_or_b64 vcc, s[54:55], s[56:57]
    s_or_b64 vcc, vcc, s[58:59]
    s_or_b64 vcc, vcc, s[60:61]
    s_cbranch_scc0 Lr0s_red
    buffer_load_dwordx4 v[40:43], v6, s[8:11], s62 offen sc1
    buffer_load_dwordx4 v[44:47], v6, s[8:11], s63 offen sc1
    buffer_load_dwordx4 v[48:51], v6, s[8:11], s64 offen sc1
    buffer_load_dwordx4 v[52:55], v6, s[8:11], s65 offen sc1
    s_add_u32 s16, s16, 1
    s_cmp_gt_u32 s16, 100000
    s_cbranch_scc1 Lr_abort
    s_waitcnt vmcnt(7)
    v_mfma_f32_16x16x32_bf16 v[68:71], v[12:15], v[64:67], 0
    v_and_b32 v10, 1, v15
    v_cmp_ne_u32 s[54:55], s40, v10
    s_waitcnt vmcnt(6)
    v_mfma_f32_16x16x32_bf16 v[68:71], v[16:19], v[64:67], v[68:71]
    v_and_b32 v10, 1, v19
    v_cmp_ne_u32 s[56:57], s40, v10
    s_waitcnt vmcnt(5)
    v_mfma_f32_16x16x32_bf16 v[68:71], v[20:23], v[64:67], v[68:71]
    v_and_b32 v10, 1, v23
    v_cmp_ne_u32 s[58:59], s40, v10
    s_waitcnt vmcnt(4)
    v_mfma_f32_16x16x32_bf16 v[68:71], v[24:27], v[64:67], v[68:71]
    v_and_b32 v10, 1, v27
    v_cmp_ne_u32 s[60:61], s40, v10
    s_or_b64 vcc, s[54:55], s[56:57]
    s_or_b64 vcc, vcc, s[58:59]
    s_or_b64 vcc, vcc, s[60:61]
    s_cbranch_scc1 Lr0s_p1
Lr0s_red:
    s_nop 1
    v_permlane16_swap_b32 v68, v70
    v_permlane16_swap_b32 v69, v71
    s_mov_b64 exec, s[46:47]
    v_add_f32 v68, v68, v70
    v_add_f32 v69, v69, v71
    v_cvt_pk_bf16_f32 v68, v68, v69
    v_min_u32 v68, s50, v68
    buffer_store_dword v68, v7, s[8:11], s36 offen sc1
    v_mov_b32 v69, -1
    buffer_store_dword v69, v7, s[8:11], s37 offen sc1
    s_mov_b64 exec, -1
    s_xor_b32 s34, s34, 16384
    s_xor_b32 s35, s35, 16384
    s_xor_b32 s40, s40, 1
    s_xor_b32 s36, s36, 16384
    s_xor_b32 s37, s37, 16384
    s_nop 15
    s_nop 3
    buffer_load_dwordx4 v[36:39], v0, s[8:11], s34 offen sc1
    s_waitcnt vmcnt(3)
    ds_read_b128 v[64:67], v8 offset:2048
    ds_read_b128 v[68:71], v8 offset:3072
    v_mov_b64 v[12:13], 0
    v_mov_b64 v[14:15], 0
    v_mov_b64 v[16:17], 0
    v_mov_b64 v[18:19], 0
    v_mov_b64 v[20:21], 0
    v_mov_b64 v[22:23], 0
    v_mov_b64 v[24:25], 0
    v_mov_b64 v[26:27], 0
    v_mov_b64 v[28:29], 0
    v_mov_b64 v[30:31], 0
    v_mov_b64 v[32:33], 0
    v_mov_b64 v[34:35], 0
    s_nop 9
    buffer_load_dwordx4 v[36:39], v0, s[8:11], s34 offen sc1
    s_nop 15
    s_nop 8
    buffer_load_dwordx4 v[36:39], v0, s[8:11], s34 offen sc1
    s_waitcnt lgkmcnt(0)
    s_branch Lr0s_step
Lr0s_pb_re:
    s_mov_b32 s16, 0
Lr0s_pb_lp:
    s_add_u32 s17, s34, 4096
    buffer_load_dwordx4 v[40:43], v0, s[8:11], s17 offen sc1
    s_add_u32 s16, s16, 1
    s_cmp_gt_u32 s16, 100000
    s_cbranch_scc1 Lr_abort
    s_waitcnt vmcnt(0)
    v_max3_u32 v10, v40, v41, v42
    v_max_u32 v10, v10, v43
    v_cmp_eq_u32 vcc, -1, v10
    s_nop 0
    s_cbranch_vccnz Lr0s_pb_lp
    s_branch Lr0s_pb_ok
Lr0s_pc_re:
    s_mov_b32 s16, 0
Lr0s_pc_lp:
    buffer_load_dwordx4 v[44:47], v0, s[8:11], s35 offen sc1
    s_add_u32 s16, s16, 1
    s_cmp_gt_u32 s16, 100000
    s_cbranch_scc1 Lr_abort
    s_waitcnt vmcnt(0)
    v_max3_u32 v10, v44, v45, v46
    v_max_u32 v10, v10, v47
    v_cmp_eq_u32 vcc, -1, v10
    s_nop 0
    s_cbranch_vccnz Lr0s_pc_lp
    s_branch Lr0s_pc_ok
Lr0s_last:
    s_waitcnt vmcnt(0) lgkmcnt(0)
    s_barrier
    s_branch Lr_exit
L_w1_0:
    s_cmp_lg_u32 s14, 1
    s_cbranch_scc1 L_w2_0
    s_mov_b32 s16, 0
    s_add_u32 s17, s66, 128
    v_lshrrev_b32 v10, 2, v0
    v_and_b32 v9, 16, v10
    v_lshlrev_b32 v9, 3, v9
    v_and_or_b32 v10, v10, 12, v9
Lr1s_fw_16:
    buffer_load_dword v9, v10, s[8:11], s17 offen sc1
    s_add_u32 s16, s16, 1
    s_cmp_gt_u32 s16, 100000
    s_cbranch_scc1 Lr_abort
    s_waitcnt vmcnt(0)
    v_cmp_eq_u32 vcc, 0, v9
    s_nop 0
    s_cbranch_vccnz Lr1s_fw_16
    s_lshl_b32 s67, s32, 5
    s_add_u32 s67, s67, s15
    s_lshl_b32 s67, s67, 12
    s_add_u32 s67, s67, 3145728
    s_mov_b32 m0, 17152
    s_nop 0
    buffer_load_dwordx4 v0, s[8:11], s41 offen offset:0 lds
    buffer_load_dwordx4 v0, s[8:11], s41 offen offset:1024 lds
    s_add_u32 s41, s41, 262144
    s_add_u32 s68, s68, 262144
    s_waitcnt vmcnt(0)
    ds_read_b128 v[56:59], v8 offset:4096
    ds_read_b128 v[60:63], v8 offset:5120
    ds_read_b128 v[64:67], v8 offset:6144
    ds_read_b128 v[68:71], v8 offset:7168
    v_mov_b64 v[12:13], 0
    v_mov_b64 v[14:15], 0
    v_mov_b64 v[16:17], 0
    v_mov_b64 v[18:19], 0
    v_mov_b64 v[20:21], 0
    v_mov_b64 v[22:23], 0
    v_mov_b64 v[24:25], 0
    v_mov_b64 v[26:27], 0
    v_mov_b64 v[28:29], 0
    v_mov_b64 v[30:31], 0
    v_mov_b64 v[32:33], 0
    v_mov_b64 v[34:35], 0
    buffer_load_dwordx4 v[36:39], v0, s[8:11], s34 offen sc1
    s_waitcnt vmcnt(0) lgkmcnt(0)
Lr1s_step:
    s_waitcnt vmcnt(3)
    v_max3_u32 v10, v36, v37, v38
    v_max_u32 v10, v10, v39
    v_cmp_eq_u32 vcc, -1, v10
    s_nop 0
    s_cbranch_vccz Lr1s_aok
    buffer_load_dwordx4 v[36:39], v0, s[8:11], s34 offen sc1
    s_nop 15
    s_nop 8
    buffer_load_dwordx4 v[36:39], v0, s[8:11], s34 offen sc1
    s_mov_b32 s16, 0
Lr1s_alp:
    s_waitcnt vmcnt(2)
    v_max3_u32 v10, v36, v37, v38
    v_max_u32 v10, v10, v39
    v_cmp_eq_u32 vcc, -1, v10
    s_nop 0
    s_cbranch_vccz Lr1s_aok
    buffer_load_dwordx4 v[36:39], v0, s[8:11], s34 offen sc1
    s_add_u32 s16, s16, 1
    s_cmp_gt_u32 s16, 100000
    s_cbranch_scc1 Lr_abort
    s_branch Lr1s_alp
Lr1s_aok:
    ds_write_b128 v0, v[36:39] offset:7936
    v_smfmac_f32_16x16x64_bf16 v[12:15], v[36:39], v[88:95], v1
    v_smfmac_f32_16x16x64_bf16 v[16:19], v[36:39], v[96:103], v1
    v_smfmac_f32_16x16x64_bf16 v[20:23], v[36:39], v[200:207], v1
    s_waitcnt lgkmcnt(0)
    s_barrier
    ds_read_b128 v[48:51], v0 offset:8960
    ds_read_b128 v[52:55], v0 offset:9984
    v_smfmac_f32_16x16x64_bf16 v[28:31], v[36:39], a[72:79], v1
    v_smfmac_f32_16x16x64_bf16 v[24:27], v[36:39], v[208:215], v1
    s_add_u32 s17, s34, 4096
    buffer_load_dwordx4 v[40:43], v0, s[8:11], s17 offen sc1
    v_smfmac_f32_16x16x64_bf16 v[32:35], v[36:39], a[80:87], v1
    s_waitcnt vmcnt(1)
    ds_read_b128 v[36:39], v0 offset:6912
    s_waitcnt lgkmcnt(2)
    v_smfmac_f32_16x16x64_bf16 v[28:31], v[48:51], v[56:63], v1
    ds_read_b128 v[56:59], v8 offset:0
    ds_read_b128 v[60:63], v8 offset:1024
    v_smfmac_f32_16x16x64_bf16 v[12:15], v[48:51], v[104:111], v1
    v_smfmac_f32_16x16x64_bf16 v[16:19], v[48:51], v[112:119], v1
    buffer_load_dwordx4 v[44:47], v0, s[8:11], s35 offen sc1
    v_smfmac_f32_16x16x64_bf16 v[32:35], v[48:51], v[64:71], v1
    ds_read_b128 v[64:67], v8 offset:2048
    ds_read_b128 v[68:71], v8 offset:3072
    v_smfmac_f32_16x16x64_bf16 v[20:23], v[48:51], v[216:223], v1
    v_smfmac_f32_16x16x64_bf16 v[24:27], v[48:51], v[224:231], v1
    s_waitcnt lgkmcnt(5)
    v_smfmac_f32_16x16x64_bf16 v[28:31], v[52:55], a[88:95], v1
    v_smfmac_f32_16x16x64_bf16 v[12:15], v[52:55], v[120:127], v1
    v_smfmac_f32_16x16x64_bf16 v[16:19], v[52:55], v[128:135], v1
    v_smfmac_f32_16x16x64_bf16 v[32:35], v[52:55], a[96:103], v1
    v_smfmac_f32_16x16x64_bf16 v[20:23], v[52:55], v[232:239], v1
    v_smfmac_f32_16x16x64_bf16 v[24:27], v[52:55], v[240:247], v1
    s_waitcnt lgkmcnt(2)
    v_smfmac_f32_16x16x64_bf16 v[28:31], v[36:39], v[56:63], v1
    ds_read_b128 v[56:59], v8 offset:12288
    ds_read_b128 v[60:63], v8 offset:13312
    v_smfmac_f32_16x16x64_bf16 v[12:15], v[36:39], v[72:79], v1
    v_smfmac_f32_16x16x64_bf16 v[16:19], v[36:39], v[80:87], v1
    s_waitcnt lgkmcnt(2)
    v_smfmac_f32_16x16x64_bf16 v[32:35], v[36:39], v[64:71], v1
    ds_read_b128 v[64:67], v8 offset:14336
    ds_read_b128 v[68:71], v8 offset:15360
    v_smfmac_f32_16x16x64_bf16 v[20:23], v[36:39], v[184:191], v1
    v_smfmac_f32_16x16x64_bf16 v[24:27], v[36:39], v[192:199], v1
    s_waitcnt vmcnt(1)
    v_max3_u32 v10, v40, v41, v42
    v_max_u32 v10, v10, v43
    v_cmp_eq_u32 vcc, -1, v10
    s_nop 0
    s_cbranch_vccnz Lr1s_pb_re
Lr1s_pb_ok:
    ds_write_b128 v0, v[40:43] offset:12032
    v_mov_b32 v9, 1
    v_mov_b32 v10, 0
    s_mov_b64 exec, 1
    buffer_store_dword v9, v10, s[8:11], s67 offen offset:384 sc1
    s_mov_b64 exec, -1
    v_smfmac_f32_16x16x64_bf16 v[12:15], v[40:43], v[136:143], v1
    v_smfmac_f32_16x16x64_bf16 v[20:23], v[40:43], a[8:15], v1
    v_smfmac_f32_16x16x64_bf16 v[16:19], v[40:43], v[144:151], v1
    v_smfmac_f32_16x16x64_bf16 v[24:27], v[40:43], a[16:23], v1
    s_waitcnt lgkmcnt(0)
    s_barrier
    ds_read_b128 v[48:51], v0 offset:13056
    ds_read_b128 v[52:55], v0 offset:14080
    ds_read_b128 v[36:39], v0 offset:11008
    v_smfmac_f32_16x16x64_bf16 v[28:31], v[40:43], a[120:127], v1
    v_smfmac_f32_16x16x64_bf16 v[32:35], v[40:43], a[128:135], v1
    s_waitcnt lgkmcnt(2)
    v_smfmac_f32_16x16x64_bf16 v[12:15], v[48:51], v[56:63], v1
    ds_read_b128 v[56:59], v8 offset:8192
    ds_read_b128 v[60:63], v8 offset:9216
    v_smfmac_f32_16x16x64_bf16 v[16:19], v[48:51], v[64:71], v1
    ds_read_b128 v[64:67], v8 offset:10240
    ds_read_b128 v[68:71], v8 offset:11264
    s_waitcnt lgkmcnt(5)
    v_smfmac_f32_16x16x64_bf16 v[12:15], v[52:55], v[152:159], v1
    v_smfmac_f32_16x16x64_bf16 v[16:19], v[52:55], v[160:167], v1
    s_waitcnt vmcnt(1)
    v_max3_u32 v10, v44, v45, v46
    v_max_u32 v10, v10, v47
    v_cmp_eq_u32 vcc, -1, v10
    s_nop 0
    s_cbranch_vccnz Lr1s_pc_re
Lr1s_pc_ok:
    v_smfmac_f32_16x16x64_bf16 v[12:15], v[44:47], v[168:175], v1
    v_smfmac_f32_16x16x64_bf16 v[16:19], v[44:47], v[176:183], v1
    s_waitcnt lgkmcnt(2)
    v_smfmac_f32_16x16x64_bf16 v[12:15], v[36:39], v[56:63], v1
    s_waitcnt lgkmcnt(0)
    v_smfmac_f32_16x16x64_bf16 v[16:19], v[36:39], v[64:71], v1
    v_smfmac_f32_16x16x64_bf16 v[20:23], v[48:51], a[24:31], v1
    v_smfmac_f32_16x16x64_bf16 v[24:27], v[48:51], a[32:39], v1
    buffer_load_dwordx4 v[64:67], v0, s[8:11], s42 offen
    v_smfmac_f32_16x16x64_bf16 v[20:23], v[52:55], a[40:47], v1
    v_add_f32 v12, v12, v14
    v_smfmac_f32_16x16x64_bf16 v[24:27], v[52:55], a[48:55], v1
    v_add_f32 v16, v16, v18
    v_smfmac_f32_16x16x64_bf16 v[20:23], v[36:39], v[248:255], v1
    v_add_f32 v13, v13, v15
    v_smfmac_f32_16x16x64_bf16 v[24:27], v[36:39], a[0:7], v1
    v_add_f32 v17, v17, v19
    buffer_load_dwordx4 v[68:71], v0, s[8:11], s42 offen offset:1024
    v_smfmac_f32_16x16x64_bf16 v[20:23], v[44:47], a[56:63], v1
    v_cvt_pk_bf16_f32 v14, v12, v16
    ds_read_b128 v[56:59], v0 offset:15104
    v_smfmac_f32_16x16x64_bf16 v[24:27], v[44:47], a[64:71], v1
    v_cvt_pk_bf16_f32 v15, v13, v17
    ds_read_b128 v[60:63], v0 offset:16128
    ds_write_b32 v2, v14 offset:576
    ds_write_b32 v2, v15 offset:864
    v_smfmac_f32_16x16x64_bf16 v[28:31], v[48:51], a[136:143], v1
    v_smfmac_f32_16x16x64_bf16 v[32:35], v[48:51], a[144:151], v1
    v_add_f32 v20, v20, v22
    v_add_f32 v24, v24, v26
    v_add_f32 v21, v21, v23
    v_add_f32 v25, v25, v27
    v_cvt_pk_bf16_f32 v22, v20, v24
    v_cvt_pk_bf16_f32 v23, v21, v25
    ds_write_b32 v2, v22 offset:0
    ds_write_b32 v2, v23 offset:288
    v_smfmac_f32_16x16x64_bf16 v[28:31], v[52:55], a[152:159], v1
    v_smfmac_f32_16x16x64_bf16 v[32:35], v[52:55], a[160:167], v1
    s_waitcnt lgkmcnt(0)
    s_barrier
    ds_read_b128 v[40:43], v3 offset:0
    ds_read_b128 v[48:51], v3 offset:64
    ds_read_b128 v[20:23], v3 offset:128
    ds_read_b128 v[52:55], v3 offset:192
    v_smfmac_f32_16x16x64_bf16 v[28:31], v[36:39], a[104:111], v1
    v_smfmac_f32_16x16x64_bf16 v[32:35], v[36:39], a[112:119], v1
    ds_read_b128 v[36:39], v0 offset:17152
    v_smfmac_f32_16x16x64_bf16 v[28:31], v[44:47], a[168:175], v1
    v_smfmac_f32_16x16x64_bf16 v[32:35], v[44:47], a[176:183], v1
    ds_read_b128 v[44:47], v0 offset:18176
    s_waitcnt lgkmcnt(5)
    v_mfma_f32_16x16x32_bf16 v[12:15], v[56:59], v[40:43], 0
    v_mfma_f32_16x16x32_bf16 v[16:19], v[60:63], v[40:43], 0
    v_mfma_f32_16x16x32_bf16 v[24:27], v[40:43], v[40:43], 0
    ds_read_b128 v[56:59], v0 offset:19200
    ds_read_b128 v[60:63], v0 offset:20224
    s_waitcnt lgkmcnt(3)
    v_mfma_f32_16x16x32_bf16 v[12:15], v[36:39], v[48:51], v[12:15]
    v_lshrrev_b32 v10, 1, v0
    v_lshrrev_b32 v9, 9, v0
    s_waitcnt lgkmcnt(2)
    v_mfma_f32_16x16x32_bf16 v[16:19], v[44:47], v[48:51], v[16:19]
    v_lshl_add_u32 v9, v9, 5, v10
    v_add_f32 v28, v28, v30
    v_mfma_f32_16x16x32_bf16 v[24:27], v[48:51], v[48:51], v[24:27]
    v_add_f32 v32, v32, v34
    v_add_f32 v29, v29, v31
    ds_read_b128 v[36:39], v0 offset:21248
    ds_read_b128 v[44:47], v0 offset:22272
    s_waitcnt lgkmcnt(3)
    v_mfma_f32_16x16x32_bf16 v[12:15], v[56:59], v[20:23], v[12:15]
    v_add_f32 v33, v33, v35
    v_cvt_pk_bf16_f32 v30, v28, v29
    s_waitcnt lgkmcnt(2)
    v_mfma_f32_16x16x32_bf16 v[16:19], v[60:63], v[20:23], v[16:19]
    v_cvt_pk_bf16_f32 v31, v32, v33
    ds_read_b64 v[34:35], v9 offset:1152
    v_mfma_f32_16x16x32_bf16 v[24:27], v[20:23], v[20:23], v[24:27]
    s_add_u32 s17, s43, 2560
    buffer_store_dwordx2 v[30:31], v10, s[8:11], s17 offen sc1
    s_waitcnt lgkmcnt(2)
    v_mfma_f32_16x16x32_bf16 v[12:15], v[36:39], v[52:55], v[12:15]
    s_waitcnt lgkmcnt(1)
    v_mfma_f32_16x16x32_bf16 v[16:19], v[44:47], v[52:55], v[16:19]
    v_mfma_f32_16x16x32_bf16 v[24:27], v[52:55], v[52:55], v[24:27]
    s_add_u32 s17, s43, 512
    s_waitcnt lgkmcnt(0)
    buffer_store_dwordx2 v[34:35], v10, s[8:11], s17 offen sc1
    s_cmp_eq_u32 s33, 63
    s_cbranch_scc1 Lr1s_last
    ds_read_b128 v[56:59], v8 offset:16384
    ds_read_b128 v[60:63], v8 offset:17408
    v_mov_b64 v[20:21], s[52:53]
    v_mov_b64 v[22:23], s[52:53]
    v_mov_b32 v41, 0
    v_mov_b32 v42, 0
    v_max3_f32 v9, v12, v13, v14
    v_max3_f32 v9, v9, v15, v16
    v_max3_f32 v9, v9, v17, v18
    v_max3_f32 v9, v9, v19, v24
    v_max_f32 v9, v9, v25
    v_mov_b32 v10, v9
    v_mov_b64 v[32:33], 0
    v_mov_b64 v[34:35], 0
    v_permlane32_swap_b32 v9, v10
    v_max_f32 v9, v9, v10
    v_mov_b32 v10, v9
    s_nop 1
    v_permlane16_swap_b32 v9, v10
    v_max_f32 v9, v9, v10
    v_mul_f32 v28, s44, v9
    v_fma_f32 v12, v12, s44, -v28
    v_fma_f32 v13, v13, s44, -v28
    v_fma_f32 v14, v14, s44, -v28
    v_fma_f32 v15, v15, s44, -v28
    v_exp_f32 v12, v12
    v_exp_f32 v13, v13
    v_fma_f32 v16, v16, s44, -v28
    v_fma_f32 v17, v17, s44, -v28
    v_exp_f32 v14, v14
    v_exp_f32 v15, v15
    v_cvt_pk_bf16_f32 v36, v12, v13
    v_fma_f32 v18, v18, s44, -v28
    v_fma_f32 v19, v19, s44, -v28
    v_exp_f32 v16, v16
    v_exp_f32 v17, v17
    v_cvt_pk_bf16_f32 v37, v14, v15
    v_fma_f32 v24, v24, s44, -v28
    v_fma_f32 v25, v25, s44, -v28
    v_exp_f32 v18, v18
    v_exp_f32 v19, v19
    v_cvt_pk_bf16_f32 v38, v16, v17
    v_exp_f32 v24, v24
    v_exp_f32 v25, v25
    v_cvt_pk_bf16_f32 v39, v18, v19
    v_cvt_pk_bf16_f32 v40, v24, v25
    v_cvt_pk_bf16_f32 v43, v24, v25
    v_mfma_f32_16x16x32_bf16 v[52:55], v[20:23], v[36:39], 0
    v_mov_b64 v[12:13], 0
    v_mov_b64 v[14:15], 0
    s_waitcnt vmcnt(3)
    v_mfma_f32_16x16x32_bf16 v[44:47], v[64:67], v[36:39], 0
    v_mov_b64 v[24:25], 0
    v_mov_b64 v[26:27], 0
    s_waitcnt vmcnt(2)
    v_mfma_f32_16x16x32_bf16 v[48:51], v[68:71], v[36:39], 0
    ds_read_b128 v[64:67], v8 offset:20480
    ds_read_b128 v[68:71], v8 offset:21504
    v_mfma_f32_16x16x16_bf16 v[52:55], v[20:21], v[40:41], v[52:55]
    v_mfma_f32_16x16x16_bf16 v[44:47], v[30:31], v[40:41], v[44:47]
    v_mov_b64 v[20:21], 0
    v_mov_b64 v[22:23], 0
    v_mfma_f32_16x16x16_bf16 v[48:51], v[30:31], v[42:43], v[48:51]
    v_mov_b64 v[36:37], 0
    v_mov_b64 v[38:39], 0
    v_mov_b64 v[40:41], 0
    v_mov_b64 v[42:43], 0
    v_rcp_f32 v9, v52
    v_mov_b64 v[52:53], 0
    v_mov_b64 v[54:55], 0
    v_mul_f32 v44, v9, v44
    v_mul_f32 v48, v9, v48
    v_cvt_pk_bf16_f32 v16, v44, v48
    v_mul_f32 v45, v9, v45
    v_mul_f32 v49, v9, v49
    v_cvt_pk_bf16_f32 v17, v45, v49
    v_mul_f32 v46, v9, v46
    v_mul_f32 v50, v9, v50
    v_cvt_pk_bf16_f32 v18, v46, v50
    v_mul_f32 v47, v9, v47
    v_mul_f32 v51, v9, v51
    v_cvt_pk_bf16_f32 v19, v47, v51
    ds_write_b128 v5, v[16:19]
    v_mov_b64 v[28:29], 0
    v_mov_b64 v[30:31], 0
    s_waitcnt lgkmcnt(0)
    s_barrier
    ds_read_b128 v[44:47], v4 offset:0
    ds_read_b128 v[48:51], v4 offset:128
    v_mov_b64 v[16:17], 0
    v_mov_b64 v[18:19], 0
    buffer_load_dwordx4 v0, s[8:11], s41 offen offset:0 lds
    buffer_load_dwordx4 v0, s[8:11], s41 offen offset:1024 lds
    s_waitcnt lgkmcnt(1)
    v_smfmac_f32_16x16x64_bf16 v[12:15], v[44:47], a[184:191], v1
    s_waitcnt lgkmcnt(0)
    v_smfmac_f32_16x16x64_bf16 v[12:15], v[48:51], a[192:199], v1
    v_smfmac_f32_16x16x64_bf16 v[24:27], v[44:47], a[200:207], v1
    v_smfmac_f32_16x16x64_bf16 v[24:27], v[48:51], a[208:215], v1
    v_add_f32 v12, v12, v14
    v_smfmac_f32_16x16x64_bf16 v[20:23], v[44:47], a[216:223], v1
    v_add_f32 v13, v13, v15
    v_smfmac_f32_16x16x64_bf16 v[20:23], v[48:51], a[224:231], v1
    v_cvt_pk_bf16_f32 v12, v12, v13
    v_smfmac_f32_16x16x64_bf16 v[16:19], v[44:47], a[232:239], v1
    v_add_f32 v24, v24, v26
    v_smfmac_f32_16x16x64_bf16 v[16:19], v[48:51], a[240:247], v1
    v_add_f32 v25, v25, v27
    v_smfmac_f32_16x16x64_bf16 v[36:39], v[44:47], v[56:63], v1
    v_cvt_pk_bf16_f32 v13, v24, v25
    v_smfmac_f32_16x16x64_bf16 v[36:39], v[48:51], v[64:71], v1
    v_add_f32 v20, v20, v22
    v_add_f32 v21, v21, v23
    v_cvt_pk_bf16_f32 v14, v20, v21
    v_add_f32 v16, v16, v18
    v_add_f32 v17, v17, v19
    v_cvt_pk_bf16_f32 v15, v16, v17
    v_and_or_b32 v15, v15, -2, s40
    buffer_store_dwordx4 v[12:15], v0, s[8:11], s38 offen sc1
    s_nop 0
    ds_read_b128 v[12:15], v8 offset:18432
    ds_read_b128 v[16:19], v8 offset:19456
    ds_read_b128 v[20:23], v8 offset:22528
    ds_read_b128 v[24:27], v8 offset:23552
    ds_read_b128 v[56:59], v8 offset:24576
    ds_read_b128 v[60:63], v8 offset:25600
    ds_read_b128 v[64:67], v8 offset:28672
    ds_read_b128 v[68:71], v8 offset:29696
    s_waitcnt lgkmcnt(6)
    v_smfmac_f32_16x16x64_bf16 v[40:43], v[44:47], v[12:19], v1
    ds_read_b128 v[12:15], v8 offset:26624
    ds_read_b128 v[16:19], v8 offset:27648
    s_waitcnt lgkmcnt(6)
    v_smfmac_f32_16x16x64_bf16 v[40:43], v[48:51], v[20:27], v1
    ds_read_b128 v[20:23], v8 offset:30720
    ds_read_b128 v[24:27], v8 offset:31744
    s_waitcnt lgkmcnt(6)
    v_smfmac_f32_16x16x64_bf16 v[52:55], v[44:47], v[56:63], v1
    ds_read_b128 v[56:59], v8 offset:32768
    ds_read_b128 v[60:63], v8 offset:33792
    s_waitcnt lgkmcnt(6)
    v_smfmac_f32_16x16x64_bf16 v[52:55], v[48:51], v[64:71], v1
    s_waitcnt lgkmcnt(4)
    v_smfmac_f32_16x16x64_bf16 v[32:35], v[44:47], v[12:19], v1
    s_waitcnt lgkmcnt(2)
    v_smfmac_f32_16x16x64_bf16 v[32:35], v[48:51], v[20:27], v1
    v_smfmac_f32_16x16x64_bf16 v[28:31], v[44:47], a[248:255], v1
    s_waitcnt lgkmcnt(0)
    v_smfmac_f32_16x16x64_bf16 v[28:31], v[48:51], v[56:63], v1
    v_add_f32 v36, v36, v38
    v_add_f32 v37, v37, v39
    v_cvt_pk_bf16_f32 v36, v36, v37
    v_add_f32 v40, v40, v42
    v_add_f32 v41, v41, v43
    v_cvt_pk_bf16_f32 v37, v40, v41
    v_add_f32 v52, v52, v54
    v_add_f32 v53, v53, v55
    v_cvt_pk_bf16_f32 v38, v52, v53
    v_add_f32 v32, v32, v34
    v_add_f32 v33, v33, v35
    v_cvt_pk_bf16_f32 v39, v32, v33
    v_and_or_b32 v39, v39, -2, s40
    s_add_u32 s17, s38, 4096
    buffer_store_dwordx4 v[36:39], v0, s[8:11], s17 offen sc1
    v_add_f32 v28, v28, v30
    v_add_f32 v29, v29, v31
    v_cvt_pk_bf16_f32 v28, v28, v29
    v_and_or_b32 v28, v28, -2, s40
    v_lshrrev_b32 v9, 2, v0
    buffer_store_dword v28, v9, s[8:11], s39 offen sc1
    v_add_u32 v10, 162560, v0
    ds_read_b128 v[64:67], v10
    s_add_u32 s33, s33, 1
    s_add_u32 s42, s42, 262144
    s_add_u32 s41, s41, 262144
    s_add_u32 s43, s43, 131072
    s_mov_b32 s67, s66
    s_add_u32 s68, s68, 262144
    s_add_u32 s66, s66, 22528
    ds_read_b128 v[56:59], v8 offset:4096
    ds_read_b128 v[60:63], v8 offset:5120
    v_mov_b64 v[12:13], 0
    v_mov_b64 v[14:15], 0
    v_mov_b64 v[16:17], 0
    v_mov_b64 v[18:19], 0
    v_mov_b64 v[20:21], 0
    v_mov_b64 v[22:23], 0
    v_mov_b64 v[24:25], 0
    v_mov_b64 v[26:27], 0
    v_mov_b64 v[28:29], 0
    v_mov_b64 v[30:31], 0
    v_mov_b64 v[32:33], 0
    v_mov_b64 v[34:35], 0
    s_nop 15
    s_nop 15
    s_nop 15
    s_nop 11
    buffer_load_dwordx4 v[40:43], v6, s[8:11], s62 offen sc1
    buffer_load_dwordx4 v[44:47], v6, s[8:11], s63 offen sc1
    buffer_load_dwordx4 v[48:51], v6, s[8:11], s64 offen sc1
    buffer_load_dwordx4 v[52:55], v6, s[8:11], s65 offen sc1
    s_waitcnt lgkmcnt(0)
    s_waitcnt vmcnt(3)
    v_mfma_f32_16x16x32_bf16 v[68:71], v[40:43], v[64:67], 0
    v_and_b32 v10, 1, v43
    v_cmp_ne_u32 s[54:55], s40, v10
    s_waitcnt vmcnt(2)
    v_mfma_f32_16x16x32_bf16 v[68:71], v[44:47], v[64:67], v[68:71]
    v_and_b32 v10, 1, v47
    v_cmp_ne_u32 s[56:57], s40, v10
    s_waitcnt vmcnt(1)
    v_mfma_f32_16x16x32_bf16 v[68:71], v[48:51], v[64:67], v[68:71]
    v_and_b32 v10, 1, v51
    v_cmp_ne_u32 s[58:59], s40, v10
    s_waitcnt vmcnt(0)
    v_mfma_f32_16x16x32_bf16 v[68:71], v[52:55], v[64:67], v[68:71]
    v_and_b32 v10, 1, v55
    v_cmp_ne_u32 s[60:61], s40, v10
    s_or_b64 vcc, s[54:55], s[56:57]
    s_or_b64 vcc, vcc, s[58:59]
    s_or_b64 vcc, vcc, s[60:61]
    s_cbranch_scc0 Lr1s_red
    s_mov_b32 s16, 0
Lr1s_p1:
    s_mov_b64 exec, s[54:55]
    buffer_load_dwordx4 v[40:43], v6, s[8:11], s62 offen sc1
    s_mov_b64 exec, s[56:57]
    buffer_load_dwordx4 v[44:47], v6, s[8:11], s63 offen sc1
    s_mov_b64 exec, s[58:59]
    buffer_load_dwordx4 v[48:51], v6, s[8:11], s64 offen sc1
    s_mov_b64 exec, s[60:61]
    buffer_load_dwordx4 v[52:55], v6, s[8:11], s65 offen sc1
    s_mov_b64 exec, -1
    s_add_u32 s16, s16, 1
    s_cmp_gt_u32 s16, 100000
    s_cbranch_scc1 Lr_abort
    s_waitcnt vmcnt(3)
    v_mfma_f32_16x16x32_bf16 v[68:71], v[40:43], v[64:67], 0
    v_and_b32 v10, 1, v43
    v_cmp_ne_u32 s[54:55], s40, v10
    s_waitcnt vmcnt(2)
    v_mfma_f32_16x16x32_bf16 v[68:71], v[44:47], v[64:67], v[68:71]
    v_and_b32 v10, 1, v47
    v_cmp_ne_u32 s[56:57], s40, v10
    s_waitcnt vmcnt(1)
    v_mfma_f32_16x16x32_bf16 v[68:71], v[48:51], v[64:67], v[68:71]
    v_and_b32 v10, 1, v51
    v_cmp_ne_u32 s[58:59], s40, v10
    s_waitcnt vmcnt(0)
    v_mfma_f32_16x16x32_bf16 v[68:71], v[52:55], v[64:67], v[68:71]
    v_and_b32 v10, 1, v55
    v_cmp_ne_u32 s[60:61], s40, v10
    s_or_b64 vcc, s[54:55], s[56:57]
    s_or_b64 vcc, vcc, s[58:59]
    s_or_b64 vcc, vcc, s[60:61]
    s_cbranch_scc1 Lr1s_p1
Lr1s_red:
    s_xor_b32 s34, s34, 16384
    s_xor_b32 s35, s35, 16384
    buffer_load_dwordx4 v[36:39], v0, s[8:11], s34 offen sc1
    v_permlane16_swap_b32 v68, v70
    v_permlane16_swap_b32 v69, v71
    s_mov_b64 exec, s[46:47]
    v_add_f32 v68, v68, v70
    v_add_f32 v69, v69, v71
    v_cvt_pk_bf16_f32 v68, v68, v69
    v_min_u32 v68, s50, v68
    buffer_store_dword v68, v7, s[8:11], s36 offen sc1
    v_mov_b32 v69, -1
    buffer_store_dword v69, v7, s[8:11], s37 offen sc1
    s_mov_b64 exec, -1
    buffer_load_dwordx4 v[36:39], v0, s[8:11], s34 offen sc1
    s_xor_b32 s40, s40, 1
    s_xor_b32 s36, s36, 16384
    s_xor_b32 s37, s37, 16384
    ds_read_b128 v[64:67], v8 offset:6144
    ds_read_b128 v[68:71], v8 offset:7168
    s_waitcnt lgkmcnt(0)
    s_branch Lr1s_step
Lr1s_pb_re:
    s_mov_b32 s16, 0
Lr1s_pb_lp:
    s_add_u32 s17, s34, 4096
    buffer_load_dwordx4 v[40:43], v0, s[8:11], s17 offen sc1
    s_add_u32 s16, s16, 1
    s_cmp_gt_u32 s16, 100000
    s_cbranch_scc1 Lr_abort
    s_waitcnt vmcnt(0)
    v_max3_u32 v10, v40, v41, v42
    v_max_u32 v10, v10, v43
    v_cmp_eq_u32 vcc, -1, v10
    s_nop 0
    s_cbranch_vccnz Lr1s_pb_lp
    s_branch Lr1s_pb_ok
Lr1s_pc_re:
    s_mov_b32 s16, 0
Lr1s_pc_lp:
    buffer_load_dwordx4 v[44:47], v0, s[8:11], s35 offen sc1
    s_add_u32 s16, s16, 1
    s_cmp_gt_u32 s16, 100000
    s_cbranch_scc1 Lr_abort
    s_waitcnt vmcnt(0)
    v_max3_u32 v10, v44, v45, v46
    v_max_u32 v10, v10, v47
    v_cmp_eq_u32 vcc, -1, v10
    s_nop 0
    s_cbranch_vccnz Lr1s_pc_lp
    s_branch Lr1s_pc_ok
Lr1s_last:
    s_waitcnt vmcnt(0) lgkmcnt(0)
    s_barrier
    s_mov_b32 s67, s66
    v_mov_b32 v9, 1
    v_mov_b32 v10, 0
    s_mov_b64 exec, 1
    buffer_store_dword v9, v10, s[8:11], s67 offen offset:384 sc1
    s_mov_b64 exec, -1
    s_branch Lr_exit
L_w2_0:
    s_cmp_lg_u32 s14, 2
    s_cbranch_scc1 L_w3_0
    s_mov_b32 s16, 0
    s_add_u32 s17, s66, 128
    v_lshrrev_b32 v10, 2, v0
    v_and_b32 v9, 16, v10
    v_lshlrev_b32 v9, 3, v9
    v_and_or_b32 v10, v10, 12, v9
Lr2s_fw_17:
    buffer_load_dword v9, v10, s[8:11], s17 offen sc1
    s_add_u32 s16, s16, 1
    s_cmp_gt_u32 s16, 100000
    s_cbranch_scc1 Lr_abort
    s_waitcnt vmcnt(0)
    v_cmp_eq_u32 vcc, 0, v9
    s_nop 0
    s_cbranch_vccnz Lr2s_fw_17
    s_mov_b32 m0, 19200
    s_nop 0
    buffer_load_dwordx4 v0, s[8:11], s41 offen offset:0 lds
    buffer_load_dwordx4 v0, s[8:11], s41 offen offset:1024 lds
    s_add_u32 s41, s41, 262144
    s_add_u32 s68, s68, 262144
    s_waitcnt vmcnt(0)
    ds_read_b128 v[56:59], v8 offset:4096
    ds_read_b128 v[60:63], v8 offset:5120
    ds_read_b128 v[64:67], v8 offset:6144
    ds_read_b128 v[68:71], v8 offset:7168
    v_mov_b64 v[12:13], 0
    v_mov_b64 v[14:15], 0
    v_mov_b64 v[16:17], 0
    v_mov_b64 v[18:19], 0
    v_mov_b64 v[20:21], 0
    v_mov_b64 v[22:23], 0
    v_mov_b64 v[24:25], 0
    v_mov_b64 v[26:27], 0
    v_mov_b64 v[28:29], 0
    v_mov_b64 v[30:31], 0
    v_mov_b64 v[32:33], 0
    v_mov_b64 v[34:35], 0
    buffer_load_dwordx4 v[36:39], v0, s[8:11], s34 offen sc1
    s_waitcnt vmcnt(0) lgkmcnt(0)
Lr2s_step:
    s_waitcnt vmcnt(3)
    v_max3_u32 v10, v36, v37, v38
    v_max_u32 v10, v10, v39
    v_cmp_eq_u32 vcc, -1, v10
    s_nop 0
    s_cbranch_vccz Lr2s_aok
    buffer_load_dwordx4 v[36:39], v0, s[8:11], s34 offen sc1
    s_nop 15
    s_nop 8
    buffer_load_dwordx4 v[36:39], v0, s[8:11], s34 offen sc1
    s_mov_b32 s16, 0
Lr2s_alp:
    s_waitcnt vmcnt(2)
    v_max3_u32 v10, v36, v37, v38
    v_max_u32 v10, v10, v39
    v_cmp_eq_u32 vcc, -1, v10
    s_nop 0
    s_cbranch_vccz Lr2s_aok
    buffer_load_dwordx4 v[36:39], v0, s[8:11], s34 offen sc1
    s_add_u32 s16, s16, 1
    s_cmp_gt_u32 s16, 100000
    s_cbranch_scc1 Lr_abort
    s_branch Lr2s_alp
Lr2s_aok:
    ds_write_b128 v0, v[36:39] offset:8960
    v_smfmac_f32_16x16x64_bf16 v[12:15], v[36:39], v[104:111], v1
    v_smfmac_f32_16x16x64_bf16 v[16:19], v[36:39], v[112:119], v1
    v_smfmac_f32_16x16x64_bf16 v[20:23], v[36:39], v[216:223], v1
    s_waitcnt lgkmcnt(0)
    s_barrier
    ds_read_b128 v[48:51], v0 offset:9984
    ds_read_b128 v[52:55], v0 offset:6912
    v_smfmac_f32_16x16x64_bf16 v[28:31], v[36:39], v[56:63], v1
    ds_read_b128 v[56:59], v8 offset:0
    ds_read_b128 v[60:63], v8 offset:1024
    v_smfmac_f32_16x16x64_bf16 v[24:27], v[36:39], v[224:231], v1
    v_smfmac_f32_16x16x64_bf16 v[32:35], v[36:39], v[64:71], v1
    ds_read_b128 v[64:67], v8 offset:2048
    ds_read_b128 v[68:71], v8 offset:3072
    s_add_u32 s17, s34, 4096
    buffer_load_dwordx4 v[40:43], v0, s[8:11], s17 offen sc1
    s_waitcnt vmcnt(1)
    ds_read_b128 v[36:39], v0 offset:7936
    s_waitcnt lgkmcnt(6)
    v_smfmac_f32_16x16x64_bf16 v[28:31], v[48:51], a[88:95], v1
    v_smfmac_f32_16x16x64_bf16 v[12:15], v[48:51], v[120:127], v1
    v_smfmac_f32_16x16x64_bf16 v[16:19], v[48:51], v[128:135], v1
    v_smfmac_f32_16x16x64_bf16 v[32:35], v[48:51], a[96:103], v1
    buffer_load_dwordx4 v[44:47], v0, s[8:11], s35 offen sc1
    v_smfmac_f32_16x16x64_bf16 v[20:23], v[48:51], v[232:239], v1
    v_lshrrev_b32 v10, 2, v0
    v_and_b32 v9, 16, v10
    v_lshlrev_b32 v9, 3, v9
    v_and_or_b32 v10, v10, 12, v9
    s_add_u32 s17, s66, 22656
    v_mov_b32 v11, 2
    buffer_load_dword v11, v10, s[8:11], s17 offen sc1
    v_smfmac_f32_16x16x64_bf16 v[24:27], v[48:51], v[240:247], v1
    s_waitcnt lgkmcnt(3)
    v_smfmac_f32_16x16x64_bf16 v[28:31], v[52:55], v[56:63], v1
    ds_read_b128 v[56:59], v8 offset:12288
    ds_read_b128 v[60:63], v8 offset:13312
    v_smfmac_f32_16x16x64_bf16 v[12:15], v[52:55], v[72:79], v1
    v_smfmac_f32_16x16x64_bf16 v[16:19], v[52:55], v[80:87], v1
    s_waitcnt lgkmcnt(3)
    v_smfmac_f32_16x16x64_bf16 v[32:35], v[52:55], v[64:71], v1
    ds_read_b128 v[64:67], v8 offset:14336
    ds_read_b128 v[68:71], v8 offset:15360
    v_smfmac_f32_16x16x64_bf16 v[20:23], v[52:55], v[184:191], v1
    v_smfmac_f32_16x16x64_bf16 v[24:27], v[52:55], v[192:199], v1
    s_waitcnt lgkmcnt(4)
    v_smfmac_f32_16x16x64_bf16 v[28:31], v[36:39], a[72:79], v1
    v_smfmac_f32_16x16x64_bf16 v[12:15], v[36:39], v[88:95], v1
    v_smfmac_f32_16x16x64_bf16 v[16:19], v[36:39], v[96:103], v1
    v_smfmac_f32_16x16x64_bf16 v[32:35], v[36:39], a[80:87], v1
    v_smfmac_f32_16x16x64_bf16 v[20:23], v[36:39], v[200:207], v1
    v_smfmac_f32_16x16x64_bf16 v[24:27], v[36:39], v[208:215], v1
    s_waitcnt vmcnt(2)
    v_max3_u32 v10, v40, v41, v42
    v_max_u32 v10, v10, v43
    v_cmp_eq_u32 vcc, -1, v10
    s_nop 0
    s_cbranch_vccnz Lr2s_pb_re
Lr2s_pb_ok:
    ds_write_b128 v0, v[40:43] offset:13056
    s_waitcnt lgkmcnt(3)
    v_smfmac_f32_16x16x64_bf16 v[12:15], v[40:43], v[56:63], v1
    ds_read_b128 v[56:59], v8 offset:8192
    ds_read_b128 v[60:63], v8 offset:9216
    v_smfmac_f32_16x16x64_bf16 v[20:23], v[40:43], a[24:31], v1
    s_waitcnt lgkmcnt(3)
    v_smfmac_f32_16x16x64_bf16 v[16:19], v[40:43], v[64:71], v1
    ds_read_b128 v[64:67], v8 offset:10240
    ds_read_b128 v[68:71], v8 offset:11264
    v_smfmac_f32_16x16x64_bf16 v[24:27], v[40:43], a[32:39], v1
    s_waitcnt lgkmcnt(4)
    s_barrier
    ds_read_b128 v[48:51], v0 offset:11008
    ds_read_b128 v[52:55], v0 offset:14080
    ds_read_b128 v[36:39], v0 offset:12032
    v_smfmac_f32_16x16x64_bf16 v[28:31], v[40:43], a[136:143], v1
    v_smfmac_f32_16x16x64_bf16 v[32:35], v[40:43], a[144:151], v1
    s_waitcnt lgkmcnt(2)
    v_smfmac_f32_16x16x64_bf16 v[12:15], v[48:51], v[56:63], v1
    v_smfmac_f32_16x16x64_bf16 v[16:19], v[48:51], v[64:71], v1
    s_waitcnt lgkmcnt(1)
    v_smfmac_f32_16x16x64_bf16 v[12:15], v[52:55], v[152:159], v1
    v_smfmac_f32_16x16x64_bf16 v[16:19], v[52:55], v[160:167], v1
    s_waitcnt lgkmcnt(0)
    v_smfmac_f32_16x16x64_bf16 v[12:15], v[36:39], v[136:143], v1
    v_smfmac_f32_16x16x64_bf16 v[16:19], v[36:39], v[144:151], v1
    s_waitcnt vmcnt(1)
    v_max3_u32 v10, v44, v45, v46
    v_max_u32 v10, v10, v47
    v_cmp_eq_u32 vcc, -1, v10
    s_nop 0
    s_cbranch_vccnz Lr2s_pc_re
Lr2s_pc_ok:
    v_smfmac_f32_16x16x64_bf16 v[12:15], v[44:47], v[168:175], v1
    v_smfmac_f32_16x16x64_bf16 v[16:19], v[44:47], v[176:183], v1
    v_smfmac_f32_16x16x64_bf16 v[20:23], v[48:51], v[248:255], v1
    v_smfmac_f32_16x16x64_bf16 v[24:27], v[48:51], a[0:7], v1
    v_smfmac_f32_16x16x64_bf16 v[20:23], v[52:55], a[40:47], v1
    v_add_f32 v12, v12, v14
    buffer_load_dwordx4 v[64:67], v0, s[8:11], s42 offen
    v_smfmac_f32_16x16x64_bf16 v[24:27], v[52:55], a[48:55], v1
    v_add_f32 v16, v16, v18
    v_smfmac_f32_16x16x64_bf16 v[20:23], v[36:39], a[8:15], v1
    v_add_f32 v13, v13, v15
    v_smfmac_f32_16x16x64_bf16 v[24:27], v[36:39], a[16:23], v1
    v_add_f32 v17, v17, v19
    v_smfmac_f32_16x16x64_bf16 v[20:23], v[44:47], a[56:63], v1
    v_cvt_pk_bf16_f32 v14, v12, v16
    ds_read_b128 v[56:59], v0 offset:15104
    buffer_load_dwordx4 v[68:71], v0, s[8:11], s42 offen offset:1024
    v_smfmac_f32_16x16x64_bf16 v[24:27], v[44:47], a[64:71], v1
    v_cvt_pk_bf16_f32 v15, v13, v17
    ds_read_b128 v[60:63], v0 offset:16128
    ds_write_b32 v2, v14 offset:576
    ds_write_b32 v2, v15 offset:864
    v_smfmac_f32_16x16x64_bf16 v[28:31], v[48:51], a[104:111], v1
    v_smfmac_f32_16x16x64_bf16 v[32:35], v[48:51], a[112:119], v1
    v_add_f32 v20, v20, v22
    v_add_f32 v24, v24, v26
    v_add_f32 v21, v21, v23
    v_add_f32 v25, v25, v27
    v_cvt_pk_bf16_f32 v22, v20, v24
    v_cvt_pk_bf16_f32 v23, v21, v25
    ds_write_b32 v2, v22 offset:0
    ds_write_b32 v2, v23 offset:288
    v_smfmac_f32_16x16x64_bf16 v[28:31], v[52:55], a[152:159], v1
    v_smfmac_f32_16x16x64_bf16 v[32:35], v[52:55], a[160:167], v1
    s_waitcnt vmcnt(2)
    v_cmp_eq_u32 vcc, 0, v11
    s_nop 0
    s_cbranch_vccnz Lr2s_flbad
Lr2s_flok:
    s_waitcnt lgkmcnt(0)
    s_barrier
    ds_read_b128 v[40:43], v3 offset:0
    ds_read_b128 v[48:51], v3 offset:64
    ds_read_b128 v[20:23], v3 offset:128
    ds_read_b128 v[52:55], v3 offset:192
    v_smfmac_f32_16x16x64_bf16 v[28:31], v[36:39], a[120:127], v1
    v_smfmac_f32_16x16x64_bf16 v[32:35], v[36:39], a[128:135], v1
    ds_read_b128 v[36:39], v0 offset:17152
    v_smfmac_f32_16x16x64_bf16 v[28:31], v[44:47], a[168:175], v1
    v_smfmac_f32_16x16x64_bf16 v[32:35], v[44:47], a[176:183], v1
    ds_read_b128 v[44:47], v0 offset:18176
    s_waitcnt lgkmcnt(5)
    v_mfma_f32_16x16x32_bf16 v[12:15], v[56:59], v[40:43], 0
    v_mfma_f32_16x16x32_bf16 v[16:19], v[60:63], v[40:43], 0
    v_mfma_f32_16x16x32_bf16 v[24:27], v[40:43], v[40:43], 0
    ds_read_b128 v[56:59], v0 offset:19200
    ds_read_b128 v[60:63], v0 offset:20224
    s_waitcnt lgkmcnt(3)
    v_mfma_f32_16x16x32_bf16 v[12:15], v[36:39], v[48:51], v[12:15]
    v_lshrrev_b32 v10, 1, v0
    v_lshrrev_b32 v9, 9, v0
    s_waitcnt lgkmcnt(2)
    v_mfma_f32_16x16x32_bf16 v[16:19], v[44:47], v[48:51], v[16:19]
    v_lshl_add_u32 v9, v9, 5, v10
    v_add_f32 v28, v28, v30
    v_mfma_f32_16x16x32_bf16 v[24:27], v[48:51], v[48:51], v[24:27]
    v_add_f32 v32, v32, v34
    v_add_f32 v29, v29, v31
    ds_read_b128 v[36:39], v0 offset:21248
    ds_read_b128 v[44:47], v0 offset:22272
    s_waitcnt lgkmcnt(3)
    v_mfma_f32_16x16x32_bf16 v[12:15], v[56:59], v[20:23], v[12:15]
    v_add_f32 v33, v33, v35
    v_cvt_pk_bf16_f32 v30, v28, v29
    s_waitcnt lgkmcnt(2)
    v_mfma_f32_16x16x32_bf16 v[16:19], v[60:63], v[20:23], v[16:19]
    v_cvt_pk_bf16_f32 v31, v32, v33
    ds_read_b64 v[34:35], v9 offset:2304
    v_mfma_f32_16x16x32_bf16 v[24:27], v[20:23], v[20:23], v[24:27]
    s_add_u32 s17, s43, 3072
    buffer_store_dwordx2 v[30:31], v10, s[8:11], s17 offen sc1
    s_waitcnt lgkmcnt(2)
    v_mfma_f32_16x16x32_bf16 v[12:15], v[36:39], v[52:55], v[12:15]
    s_waitcnt lgkmcnt(1)
    v_mfma_f32_16x16x32_bf16 v[16:19], v[44:47], v[52:55], v[16:19]
    v_mfma_f32_16x16x32_bf16 v[24:27], v[52:55], v[52:55], v[24:27]
    s_add_u32 s17, s43, 1024
    s_waitcnt lgkmcnt(0)
    buffer_store_dwordx2 v[34:35], v10, s[8:11], s17 offen sc1
    s_cmp_eq_u32 s33, 63
    s_cbranch_scc1 Lr2s_last
    ds_read_b128 v[56:59], v8 offset:16384
    ds_read_b128 v[60:63], v8 offset:17408
    v_mov_b64 v[20:21], s[52:53]
    v_mov_b64 v[22:23], s[52:53]
    v_mov_b32 v41, 0
    v_mov_b32 v42, 0
    v_max3_f32 v9, v12, v13, v14
    v_max3_f32 v9, v9, v15, v16
    v_max3_f32 v9, v9, v17, v18
    v_max3_f32 v9, v9, v19, v24
    v_max_f32 v9, v9, v25
    v_mov_b32 v10, v9
    v_mov_b64 v[32:33], 0
    v_mov_b64 v[34:35], 0
    v_permlane32_swap_b32 v9, v10
    v_max_f32 v9, v9, v10
    v_mov_b32 v10, v9
    s_nop 1
    v_permlane16_swap_b32 v9, v10
    v_max_f32 v9, v9, v10
    v_mul_f32 v28, s44, v9
    v_fma_f32 v12, v12, s44, -v28
    v_fma_f32 v13, v13, s44, -v28
    v_fma_f32 v14, v14, s44, -v28
    v_fma_f32 v15, v15, s44, -v28
    v_exp_f32 v12, v12
    v_exp_f32 v13, v13
    v_fma_f32 v16, v16, s44, -v28
    v_fma_f32 v17, v17, s44, -v28
    v_exp_f32 v14, v14
    v_exp_f32 v15, v15
    v_cvt_pk_bf16_f32 v36, v12, v13
    v_fma_f32 v18, v18, s44, -v28
    v_fma_f32 v19, v19, s44, -v28
    v_exp_f32 v16, v16
    v_exp_f32 v17, v17
    v_cvt_pk_bf16_f32 v37, v14, v15
    v_fma_f32 v24, v24, s44, -v28
    v_fma_f32 v25, v25, s44, -v28
    v_exp_f32 v18, v18
    v_exp_f32 v19, v19
    v_cvt_pk_bf16_f32 v38, v16, v17
    v_exp_f32 v24, v24
    v_exp_f32 v25, v25
    v_cvt_pk_bf16_f32 v39, v18, v19
    v_cvt_pk_bf16_f32 v40, v24, v25
    v_cvt_pk_bf16_f32 v43, v24, v25
    v_mfma_f32_16x16x32_bf16 v[52:55], v[20:23], v[36:39], 0
    v_mov_b64 v[12:13], 0
    v_mov_b64 v[14:15], 0
    s_waitcnt vmcnt(3)
    v_mfma_f32_16x16x32_bf16 v[44:47], v[64:67], v[36:39], 0
    v_mov_b64 v[24:25], 0
    v_mov_b64 v[26:27], 0
    s_waitcnt vmcnt(2)
    v_mfma_f32_16x16x32_bf16 v[48:51], v[68:71], v[36:39], 0
    ds_read_b128 v[64:67], v8 offset:20480
    ds_read_b128 v[68:71], v8 offset:21504
    v_mfma_f32_16x16x16_bf16 v[52:55], v[20:21], v[40:41], v[52:55]
    v_mfma_f32_16x16x16_bf16 v[44:47], v[30:31], v[40:41], v[44:47]
    v_mov_b64 v[20:21], 0
    v_mov_b64 v[22:23], 0
    v_mfma_f32_16x16x16_bf16 v[48:51], v[30:31], v[42:43], v[48:51]
    v_mov_b64 v[36:37], 0
    v_mov_b64 v[38:39], 0
    v_mov_b64 v[40:41], 0
    v_mov_b64 v[42:43], 0
    v_rcp_f32 v9, v52
    v_mov_b64 v[52:53], 0
    v_mov_b64 v[54:55], 0
    v_mul_f32 v44, v9, v44
    v_mul_f32 v48, v9, v48
    v_cvt_pk_bf16_f32 v16, v44, v48
    v_mul_f32 v45, v9, v45
    v_mul_f32 v49, v9, v49
    v_cvt_pk_bf16_f32 v17, v45, v49
    v_mul_f32 v46, v9, v46
    v_mul_f32 v50, v9, v50
    v_cvt_pk_bf16_f32 v18, v46, v50
    v_mul_f32 v47, v9, v47
    v_mul_f32 v51, v9, v51
    v_cvt_pk_bf16_f32 v19, v47, v51
    ds_write_b128 v5, v[16:19]
    v_mov_b64 v[28:29], 0
    v_mov_b64 v[30:31], 0
    s_waitcnt lgkmcnt(0)
    s_barrier
    ds_read_b128 v[44:47], v4 offset:0
    ds_read_b128 v[48:51], v4 offset:128
    v_mov_b64 v[16:17], 0
    v_mov_b64 v[18:19], 0
    buffer_load_dwordx4 v0, s[8:11], s41 offen offset:0 lds
    buffer_load_dwordx4 v0, s[8:11], s41 offen offset:1024 lds
    s_waitcnt lgkmcnt(1)
    v_smfmac_f32_16x16x64_bf16 v[12:15], v[44:47], a[184:191], v1
    s_waitcnt lgkmcnt(0)
    v_smfmac_f32_16x16x64_bf16 v[12:15], v[48:51], a[192:199], v1
    v_smfmac_f32_16x16x64_bf16 v[24:27], v[44:47], a[200:207], v1
    v_smfmac_f32_16x16x64_bf16 v[24:27], v[48:51], a[208:215], v1
    v_add_f32 v12, v12, v14
    v_smfmac_f32_16x16x64_bf16 v[20:23], v[44:47], a[216:223], v1
    v_add_f32 v13, v13, v15
    v_smfmac_f32_16x16x64_bf16 v[20:23], v[48:51], a[224:231], v1
    v_cvt_pk_bf16_f32 v12, v12, v13
    v_smfmac_f32_16x16x64_bf16 v[16:19], v[44:47], a[232:239], v1
    v_add_f32 v24, v24, v26
    v_smfmac_f32_16x16x64_bf16 v[16:19], v[48:51], a[240:247], v1
    v_add_f32 v25, v25, v27
    v_smfmac_f32_16x16x64_bf16 v[36:39], v[44:47], v[56:63], v1
    v_cvt_pk_bf16_f32 v13, v24, v25
    v_smfmac_f32_16x16x64_bf16 v[36:39], v[48:51], v[64:71], v1
    v_add_f32 v20, v20, v22
    v_add_f32 v21, v21, v23
    v_cvt_pk_bf16_f32 v14, v20, v21
    v_add_f32 v16, v16, v18
    v_add_f32 v17, v17, v19
    v_cvt_pk_bf16_f32 v15, v16, v17
    v_and_or_b32 v15, v15, -2, s40
    buffer_store_dwordx4 v[12:15], v0, s[8:11], s38 offen sc1
    s_nop 0
    ds_read_b128 v[12:15], v8 offset:18432
    ds_read_b128 v[16:19], v8 offset:19456
    ds_read_b128 v[20:23], v8 offset:22528
    ds_read_b128 v[24:27], v8 offset:23552
    ds_read_b128 v[56:59], v8 offset:24576
    ds_read_b128 v[60:63], v8 offset:25600
    ds_read_b128 v[64:67], v8 offset:28672
    ds_read_b128 v[68:71], v8 offset:29696
    s_waitcnt lgkmcnt(6)
    v_smfmac_f32_16x16x64_bf16 v[40:43], v[44:47], v[12:19], v1
    ds_read_b128 v[12:15], v8 offset:26624
    ds_read_b128 v[16:19], v8 offset:27648
    s_waitcnt lgkmcnt(6)
    v_smfmac_f32_16x16x64_bf16 v[40:43], v[48:51], v[20:27], v1
    ds_read_b128 v[20:23], v8 offset:30720
    ds_read_b128 v[24:27], v8 offset:31744
    s_waitcnt lgkmcnt(6)
    v_smfmac_f32_16x16x64_bf16 v[52:55], v[44:47], v[56:63], v1
    ds_read_b128 v[56:59], v8 offset:32768
    ds_read_b128 v[60:63], v8 offset:33792
    s_waitcnt lgkmcnt(6)
    v_smfmac_f32_16x16x64_bf16 v[52:55], v[48:51], v[64:71], v1
    s_waitcnt lgkmcnt(4)
    v_smfmac_f32_16x16x64_bf16 v[32:35], v[44:47], v[12:19], v1
    s_waitcnt lgkmcnt(2)
    v_smfmac_f32_16x16x64_bf16 v[32:35], v[48:51], v[20:27], v1
    v_smfmac_f32_16x16x64_bf16 v[28:31], v[44:47], a[248:255], v1
    s_waitcnt lgkmcnt(0)
    v_smfmac_f32_16x16x64_bf16 v[28:31], v[48:51], v[56:63], v1
    v_add_f32 v36, v36, v38
    v_add_f32 v37, v37, v39
    v_cvt_pk_bf16_f32 v36, v36, v37
    v_add_f32 v40, v40, v42
    v_add_f32 v41, v41, v43
    v_cvt_pk_bf16_f32 v37, v40, v41
    v_add_f32 v52, v52, v54
    v_add_f32 v53, v53, v55
    v_cvt_pk_bf16_f32 v38, v52, v53
    v_add_f32 v32, v32, v34
    v_add_f32 v33, v33, v35
    v_cvt_pk_bf16_f32 v39, v32, v33
    v_and_or_b32 v39, v39, -2, s40
    s_add_u32 s17, s38, 4096
    buffer_store_dwordx4 v[36:39], v0, s[8:11], s17 offen sc1
    v_add_f32 v28, v28, v30
    v_add_f32 v29, v29, v31
    v_cvt_pk_bf16_f32 v28, v28, v29
    v_and_or_b32 v28, v28, -2, s40
    v_lshrrev_b32 v9, 2, v0
    buffer_store_dword v28, v9, s[8:11], s39 offen sc1
    v_add_u32 v10, 162560, v0
    ds_read_b32 v64, v10
    v_mov_b32 v65, 0
    v_mov_b32 v41, 0
    v_mov_b32 v45, 0
    v_mov_b32 v49, 0
    v_mov_b32 v53, 0
    s_add_u32 s33, s33, 1
    s_add_u32 s42, s42, 262144
    s_add_u32 s41, s41, 262144
    s_add_u32 s43, s43, 131072
    s_add_u32 s68, s68, 262144
    s_add_u32 s66, s66, 22528
    ds_read_b128 v[56:59], v8 offset:4096
    ds_read_b128 v[60:63], v8 offset:5120
    v_mov_b64 v[12:13], 0
    v_mov_b64 v[14:15], 0
    v_mov_b64 v[16:17], 0
    v_mov_b64 v[18:19], 0
    v_mov_b64 v[20:21], 0
    v_mov_b64 v[22:23], 0
    v_mov_b64 v[24:25], 0
    v_mov_b64 v[26:27], 0
    v_mov_b64 v[28:29], 0
    v_mov_b64 v[30:31], 0
    v_mov_b64 v[32:33], 0
    v_mov_b64 v[34:35], 0
    s_nop 15
    s_nop 15
    s_nop 15
    s_nop 1
    buffer_load_dword v40, v6, s[8:11], s62 offen sc1
    buffer_load_dword v44, v6, s[8:11], s63 offen sc1
    buffer_load_dword v48, v6, s[8:11], s64 offen sc1
    buffer_load_dword v52, v6, s[8:11], s65 offen sc1
    s_waitcnt lgkmcnt(0)
    s_waitcnt vmcnt(3)
    v_mfma_f32_16x16x16_bf16 v[68:71], v[40:41], v[64:65], 0
    v_and_b32 v10, 1, v40
    v_cmp_ne_u32 s[54:55], s40, v10
    s_waitcnt vmcnt(2)
    v_mfma_f32_16x16x16_bf16 v[68:71], v[44:45], v[64:65], v[68:71]
    v_and_b32 v10, 1, v44
    v_cmp_ne_u32 s[56:57], s40, v10
    s_waitcnt vmcnt(1)
    v_mfma_f32_16x16x16_bf16 v[68:71], v[48:49], v[64:65], v[68:71]
    v_and_b32 v10, 1, v48
    v_cmp_ne_u32 s[58:59], s40, v10
    s_waitcnt vmcnt(0)
    v_mfma_f32_16x16x16_bf16 v[68:71], v[52:53], v[64:65], v[68:71]
    v_and_b32 v10, 1, v52
    v_cmp_ne_u32 s[60:61], s40, v10
    s_or_b64 vcc, s[54:55], s[56:57]
    s_or_b64 vcc, vcc, s[58:59]
    s_or_b64 vcc, vcc, s[60:61]
    s_cbranch_scc0 Lr2s_red
    s_mov_b32 s16, 0
Lr2s_p1:
    s_mov_b64 exec, s[54:55]
    buffer_load_dword v40, v6, s[8:11], s62 offen sc1
    s_mov_b64 exec, s[56:57]
    buffer_load_dword v44, v6, s[8:11], s63 offen sc1
    s_mov_b64 exec, s[58:59]
    buffer_load_dword v48, v6, s[8:11], s64 offen sc1
    s_mov_b64 exec, s[60:61]
    buffer_load_dword v52, v6, s[8:11], s65 offen sc1
    s_mov_b64 exec, -1
    s_add_u32 s16, s16, 1
    s_cmp_gt_u32 s16, 100000
    s_cbranch_scc1 Lr_abort
    s_waitcnt vmcnt(3)
    v_mfma_f32_16x16x16_bf16 v[68:71], v[40:41], v[64:65], 0
    v_and_b32 v10, 1, v40
    v_cmp_ne_u32 s[54:55], s40, v10
    s_waitcnt vmcnt(2)
    v_mfma_f32_16x16x16_bf16 v[68:71], v[44:45], v[64:65], v[68:71]
    v_and_b32 v10, 1, v44
    v_cmp_ne_u32 s[56:57], s40, v10
    s_waitcnt vmcnt(1)
    v_mfma_f32_16x16x16_bf16 v[68:71], v[48:49], v[64:65], v[68:71]
    v_and_b32 v10, 1, v48
    v_cmp_ne_u32 s[58:59], s40, v10
    s_waitcnt vmcnt(0)
    v_mfma_f32_16x16x16_bf16 v[68:71], v[52:53], v[64:65], v[68:71]
    v_and_b32 v10, 1, v52
    v_cmp_ne_u32 s[60:61], s40, v10
    s_or_b64 vcc, s[54:55], s[56:57]
    s_or_b64 vcc, vcc, s[58:59]
    s_or_b64 vcc, vcc, s[60:61]
    s_cbranch_scc1 Lr2s_p1
Lr2s_red:
    s_xor_b32 s34, s34, 16384
    s_xor_b32 s35, s35, 16384
    buffer_load_dwordx4 v[36:39], v0, s[8:11], s34 offen sc1
    v_permlane16_swap_b32 v68, v70
    v_permlane16_swap_b32 v69, v71
    s_mov_b64 exec, s[46:47]
    v_add_f32 v68, v68, v70
    v_add_f32 v69, v69, v71
    v_cvt_pk_bf16_f32 v68, v68, v69
    v_min_u32 v68, s50, v68
    buffer_store_dword v68, v7, s[8:11], s36 offen sc1
    v_mov_b32 v69, -1
    buffer_store_dword v69, v7, s[8:11], s37 offen sc1
    s_mov_b64 exec, -1
    buffer_load_dwordx4 v[36:39], v0, s[8:11], s34 offen sc1
    s_xor_b32 s40, s40, 1
    s_xor_b32 s36, s36, 16384
    s_xor_b32 s37, s37, 16384
    ds_read_b128 v[64:67], v8 offset:6144
    ds_read_b128 v[68:71], v8 offset:7168
    s_waitcnt lgkmcnt(0)
    s_branch Lr2s_step
Lr2s_pb_re:
    s_mov_b32 s16, 0
Lr2s_pb_lp:
    s_add_u32 s17, s34, 4096
    buffer_load_dwordx4 v[40:43], v0, s[8:11], s17 offen sc1
    s_add_u32 s16, s16, 1
    s_cmp_gt_u32 s16, 100000
    s_cbranch_scc1 Lr_abort
    s_waitcnt vmcnt(0)
    v_max3_u32 v10, v40, v41, v42
    v_max_u32 v10, v10, v43
    v_cmp_eq_u32 vcc, -1, v10
    s_nop 0
    s_cbranch_vccnz Lr2s_pb_lp
    s_branch Lr2s_pb_ok
Lr2s_pc_re:
    s_mov_b32 s16, 0
Lr2s_pc_lp:
    buffer_load_dwordx4 v[44:47], v0, s[8:11], s35 offen sc1
    s_add_u32 s16, s16, 1
    s_cmp_gt_u32 s16, 100000
    s_cbranch_scc1 Lr_abort
    s_waitcnt vmcnt(0)
    v_max3_u32 v10, v44, v45, v46
    v_max_u32 v10, v10, v47
    v_cmp_eq_u32 vcc, -1, v10
    s_nop 0
    s_cbranch_vccnz Lr2s_pc_lp
    s_branch Lr2s_pc_ok
Lr2s_flbad:
    s_cmp_eq_u32 s33, 63
    s_cbranch_scc1 Lr2s_flok
    s_mov_b32 s16, 0
    s_add_u32 s17, s66, 22656
    v_lshrrev_b32 v10, 2, v0
    v_and_b32 v9, 16, v10
    v_lshlrev_b32 v9, 3, v9
    v_and_or_b32 v10, v10, 12, v9
Lr2s_fw_18:
    buffer_load_dword v9, v10, s[8:11], s17 offen sc1
    s_add_u32 s16, s16, 1
    s_cmp_gt_u32 s16, 100000
    s_cbranch_scc1 Lr_abort
    s_waitcnt vmcnt(0)
    v_cmp_eq_u32 vcc, 0, v9
    s_nop 0
    s_cbranch_vccnz Lr2s_fw_18
    s_branch Lr2s_flok
Lr2s_last:
    s_waitcnt vmcnt(0) lgkmcnt(0)
    s_barrier
    s_branch Lr_exit
L_w3_0:
    s_mov_b32 s16, 0
    s_add_u32 s17, s66, 128
    v_lshrrev_b32 v10, 2, v0
    v_and_b32 v9, 16, v10
    v_lshlrev_b32 v9, 3, v9
    v_and_or_b32 v10, v10, 12, v9
Lr3s_fw_19:
    buffer_load_dword v9, v10, s[8:11], s17 offen sc1
    s_add_u32 s16, s16, 1
    s_cmp_gt_u32 s16, 100000
    s_cbranch_scc1 Lr_abort
    s_waitcnt vmcnt(0)
    v_cmp_eq_u32 vcc, 0, v9
    s_nop 0
    s_cbranch_vccnz Lr3s_fw_19
    s_mov_b32 m0, 21248
    s_nop 0
    buffer_load_dwordx4 v0, s[8:11], s41 offen offset:0 lds
    buffer_load_dwordx4 v0, s[8:11], s41 offen offset:1024 lds
    s_add_u32 s41, s41, 262144
    s_add_u32 s68, s68, 262144
    s_waitcnt vmcnt(0)
    ds_read_b128 v[56:59], v8 offset:0
    ds_read_b128 v[60:63], v8 offset:1024
    ds_read_b128 v[64:67], v8 offset:2048
    ds_read_b128 v[68:71], v8 offset:3072
    v_mov_b64 v[12:13], 0
    v_mov_b64 v[14:15], 0
    v_mov_b64 v[16:17], 0
    v_mov_b64 v[18:19], 0
    v_mov_b64 v[20:21], 0
    v_mov_b64 v[22:23], 0
    v_mov_b64 v[24:25], 0
    v_mov_b64 v[26:27], 0
    v_mov_b64 v[28:29], 0
    v_mov_b64 v[30:31], 0
    v_mov_b64 v[32:33], 0
    v_mov_b64 v[34:35], 0
    buffer_load_dwordx4 v[36:39], v0, s[8:11], s34 offen sc1
    s_waitcnt vmcnt(0) lgkmcnt(0)
Lr3s_step:
    s_mov_b32 s16, 0
Lr3s_alp:
    s_waitcnt vmcnt(2)
    v_max3_u32 v10, v36, v37, v38
    v_max_u32 v10, v10, v39
    v_cmp_eq_u32 vcc, -1, v10
    s_nop 0
    s_cbranch_vccz Lr3s_aok
    buffer_load_dwordx4 v[36:39], v0, s[8:11], s34 offen sc1
    s_add_u32 s16, s16, 1
    s_cmp_gt_u32 s16, 100000
    s_cbranch_scc1 Lr_abort
    s_branch Lr3s_alp
Lr3s_aok:
    ds_write_b128 v0, v[36:39] offset:9984
    v_smfmac_f32_16x16x64_bf16 v[12:15], v[36:39], v[120:127], v1
    v_smfmac_f32_16x16x64_bf16 v[16:19], v[36:39], v[128:135], v1
    v_smfmac_f32_16x16x64_bf16 v[20:23], v[36:39], v[232:239], v1
    s_waitcnt lgkmcnt(0)
    s_barrier
    ds_read_b128 v[48:51], v0 offset:6912
    ds_read_b128 v[52:55], v0 offset:7936
    v_smfmac_f32_16x16x64_bf16 v[28:31], v[36:39], a[88:95], v1
    v_smfmac_f32_16x16x64_bf16 v[24:27], v[36:39], v[240:247], v1
    v_smfmac_f32_16x16x64_bf16 v[32:35], v[36:39], a[96:103], v1
    s_waitcnt vmcnt(0)
    ds_read_b128 v[36:39], v0 offset:8960
    s_waitcnt lgkmcnt(2)
    v_smfmac_f32_16x16x64_bf16 v[28:31], v[48:51], v[56:63], v1
    ds_read_b128 v[56:59], v8 offset:4096
    ds_read_b128 v[60:63], v8 offset:5120
    s_add_u32 s17, s34, 4096
    buffer_load_dwordx4 v[40:43], v0, s[8:11], s17 offen sc1
    v_smfmac_f32_16x16x64_bf16 v[12:15], v[48:51], v[72:79], v1
    v_smfmac_f32_16x16x64_bf16 v[16:19], v[48:51], v[80:87], v1
    v_smfmac_f32_16x16x64_bf16 v[32:35], v[48:51], v[64:71], v1
    ds_read_b128 v[64:67], v8 offset:6144
    ds_read_b128 v[68:71], v8 offset:7168
    v_smfmac_f32_16x16x64_bf16 v[20:23], v[48:51], v[184:191], v1
    buffer_load_dwordx4 v[44:47], v0, s[8:11], s35 offen sc1
    v_smfmac_f32_16x16x64_bf16 v[24:27], v[48:51], v[192:199], v1
    s_waitcnt lgkmcnt(5)
    v_smfmac_f32_16x16x64_bf16 v[28:31], v[52:55], a[72:79], v1
    v_smfmac_f32_16x16x64_bf16 v[12:15], v[52:55], v[88:95], v1
    v_smfmac_f32_16x16x64_bf16 v[16:19], v[52:55], v[96:103], v1
    v_smfmac_f32_16x16x64_bf16 v[32:35], v[52:55], a[80:87], v1
    v_smfmac_f32_16x16x64_bf16 v[20:23], v[52:55], v[200:207], v1
    v_smfmac_f32_16x16x64_bf16 v[24:27], v[52:55], v[208:215], v1
    s_waitcnt lgkmcnt(2)
    v_smfmac_f32_16x16x64_bf16 v[28:31], v[36:39], v[56:63], v1
    ds_read_b128 v[56:59], v8 offset:8192
    ds_read_b128 v[60:63], v8 offset:9216
    v_smfmac_f32_16x16x64_bf16 v[12:15], v[36:39], v[104:111], v1
    v_smfmac_f32_16x16x64_bf16 v[16:19], v[36:39], v[112:119], v1
    s_waitcnt lgkmcnt(2)
    v_smfmac_f32_16x16x64_bf16 v[32:35], v[36:39], v[64:71], v1
    ds_read_b128 v[64:67], v8 offset:10240
    ds_read_b128 v[68:71], v8 offset:11264
    v_smfmac_f32_16x16x64_bf16 v[20:23], v[36:39], v[216:223], v1
    v_smfmac_f32_16x16x64_bf16 v[24:27], v[36:39], v[224:231], v1
    s_waitcnt vmcnt(1)
    v_max3_u32 v10, v40, v41, v42
    v_max_u32 v10, v10, v43
    v_cmp_eq_u32 vcc, -1, v10
    s_nop 0
    s_cbranch_vccnz Lr3s_pb_re
Lr3s_pb_ok:
    ds_write_b128 v0, v[40:43] offset:14080
    v_smfmac_f32_16x16x64_bf16 v[12:15], v[40:43], v[152:159], v1
    v_smfmac_f32_16x16x64_bf16 v[20:23], v[40:43], a[40:47], v1
    v_smfmac_f32_16x16x64_bf16 v[16:19], v[40:43], v[160:167], v1
    v_smfmac_f32_16x16x64_bf16 v[24:27], v[40:43], a[48:55], v1
    s_waitcnt lgkmcnt(0)
    s_barrier
    ds_read_b128 v[48:51], v0 offset:11008
    ds_read_b128 v[52:55], v0 offset:12032
    ds_read_b128 v[36:39], v0 offset:13056
    v_smfmac_f32_16x16x64_bf16 v[28:31], v[40:43], a[152:159], v1
    v_smfmac_f32_16x16x64_bf16 v[32:35], v[40:43], a[160:167], v1
    s_waitcnt lgkmcnt(2)
    v_smfmac_f32_16x16x64_bf16 v[12:15], v[48:51], v[56:63], v1
    ds_read_b128 v[56:59], v8 offset:12288
    ds_read_b128 v[60:63], v8 offset:13312
    v_smfmac_f32_16x16x64_bf16 v[16:19], v[48:51], v[64:71], v1
    ds_read_b128 v[64:67], v8 offset:14336
    ds_read_b128 v[68:71], v8 offset:15360
    s_waitcnt lgkmcnt(5)
    v_smfmac_f32_16x16x64_bf16 v[12:15], v[52:55], v[136:143], v1
    v_smfmac_f32_16x16x64_bf16 v[16:19], v[52:55], v[144:151], v1
    s_waitcnt vmcnt(0)
    v_max3_u32 v10, v44, v45, v46
    v_max_u32 v10, v10, v47
    v_cmp_eq_u32 vcc, -1, v10
    s_nop 0
    s_cbranch_vccnz Lr3s_pc_re
Lr3s_pc_ok:
    v_smfmac_f32_16x16x64_bf16 v[12:15], v[44:47], v[168:175], v1
    v_smfmac_f32_16x16x64_bf16 v[16:19], v[44:47], v[176:183], v1
    s_waitcnt lgkmcnt(2)
    v_smfmac_f32_16x16x64_bf16 v[12:15], v[36:39], v[56:63], v1
    s_waitcnt lgkmcnt(0)
    v_smfmac_f32_16x16x64_bf16 v[16:19], v[36:39], v[64:71], v1
    v_smfmac_f32_16x16x64_bf16 v[20:23], v[48:51], v[248:255], v1
    v_smfmac_f32_16x16x64_bf16 v[24:27], v[48:51], a[0:7], v1
    v_smfmac_f32_16x16x64_bf16 v[20:23], v[52:55], a[8:15], v1
    v_add_f32 v12, v12, v14
    v_smfmac_f32_16x16x64_bf16 v[24:27], v[52:55], a[16:23], v1
    v_add_f32 v16, v16, v18
    buffer_load_dwordx4 v[64:67], v0, s[8:11], s42 offen
    v_smfmac_f32_16x16x64_bf16 v[20:23], v[36:39], a[24:31], v1
    v_add_f32 v13, v13, v15
    v_smfmac_f32_16x16x64_bf16 v[24:27], v[36:39], a[32:39], v1
    v_add_f32 v17, v17, v19
    v_smfmac_f32_16x16x64_bf16 v[20:23], v[44:47], a[56:63], v1
    v_cvt_pk_bf16_f32 v14, v12, v16
    ds_read_b128 v[56:59], v0 offset:15104
    v_smfmac_f32_16x16x64_bf16 v[24:27], v[44:47], a[64:71], v1
    v_cvt_pk_bf16_f32 v15, v13, v17
    ds_read_b128 v[60:63], v0 offset:16128
    buffer_load_dwordx4 v[68:71], v0, s[8:11], s42 offen offset:1024
    ds_write_b32 v2, v14 offset:576
    ds_write_b32 v2, v15 offset:864
    v_smfmac_f32_16x16x64_bf16 v[28:31], v[48:51], a[104:111], v1
    v_smfmac_f32_16x16x64_bf16 v[32:35], v[48:51], a[112:119], v1
    v_add_f32 v20, v20, v22
    v_add_f32 v24, v24, v26
    v_add_f32 v21, v21, v23
    v_add_f32 v25, v25, v27
    v_cvt_pk_bf16_f32 v22, v20, v24
    v_cvt_pk_bf16_f32 v23, v21, v25
    ds_write_b32 v2, v22 offset:0
    ds_write_b32 v2, v23 offset:288
    v_smfmac_f32_16x16x64_bf16 v[28:31], v[52:55], a[120:127], v1
    v_smfmac_f32_16x16x64_bf16 v[32:35], v[52:55], a[128:135], v1
    s_waitcnt lgkmcnt(0)
    s_barrier
    ds_read_b128 v[40:43], v3 offset:0
    ds_read_b128 v[48:51], v3 offset:64
    ds_read_b128 v[20:23], v3 offset:128
    ds_read_b128 v[52:55], v3 offset:192
    v_smfmac_f32_16x16x64_bf16 v[28:31], v[36:39], a[136:143], v1
    v_smfmac_f32_16x16x64_bf16 v[32:35], v[36:39], a[144:151], v1
    ds_read_b128 v[36:39], v0 offset:17152
    v_lshlrev_b32 v9, 3, v0
    buffer_load_dword v11, v9, s[8:11], s68 offen
    v_smfmac_f32_16x16x64_bf16 v[28:31], v[44:47], a[168:175], v1
    v_smfmac_f32_16x16x64_bf16 v[32:35], v[44:47], a[176:183], v1
    ds_read_b128 v[44:47], v0 offset:18176
    s_waitcnt lgkmcnt(5)
    v_mfma_f32_16x16x32_bf16 v[12:15], v[56:59], v[40:43], 0
    v_mfma_f32_16x16x32_bf16 v[16:19], v[60:63], v[40:43], 0
    v_mfma_f32_16x16x32_bf16 v[24:27], v[40:43], v[40:43], 0
    ds_read_b128 v[56:59], v0 offset:19200
    ds_read_b128 v[60:63], v0 offset:20224
    s_waitcnt lgkmcnt(3)
    v_mfma_f32_16x16x32_bf16 v[12:15], v[36:39], v[48:51], v[12:15]
    v_lshrrev_b32 v10, 1, v0
    v_lshrrev_b32 v9, 9, v0
    s_waitcnt lgkmcnt(2)
    v_mfma_f32_16x16x32_bf16 v[16:19], v[44:47], v[48:51], v[16:19]
    v_lshl_add_u32 v9, v9, 5, v10
    v_add_f32 v28, v28, v30
    v_mfma_f32_16x16x32_bf16 v[24:27], v[48:51], v[48:51], v[24:27]
    v_add_f32 v32, v32, v34
    v_add_f32 v29, v29, v31
    ds_read_b128 v[36:39], v0 offset:21248
    ds_read_b128 v[44:47], v0 offset:22272
    s_waitcnt lgkmcnt(3)
    v_mfma_f32_16x16x32_bf16 v[12:15], v[56:59], v[20:23], v[12:15]
    v_add_f32 v33, v33, v35
    v_cvt_pk_bf16_f32 v30, v28, v29
    s_waitcnt lgkmcnt(2)
    v_mfma_f32_16x16x32_bf16 v[16:19], v[60:63], v[20:23], v[16:19]
    v_cvt_pk_bf16_f32 v31, v32, v33
    ds_read_b64 v[34:35], v9 offset:3456
    v_mfma_f32_16x16x32_bf16 v[24:27], v[20:23], v[20:23], v[24:27]
    s_add_u32 s17, s43, 3584
    buffer_store_dwordx2 v[30:31], v10, s[8:11], s17 offen sc1
    s_waitcnt lgkmcnt(2)
    v_mfma_f32_16x16x32_bf16 v[12:15], v[36:39], v[52:55], v[12:15]
    s_waitcnt lgkmcnt(1)
    v_mfma_f32_16x16x32_bf16 v[16:19], v[44:47], v[52:55], v[16:19]
    v_mfma_f32_16x16x32_bf16 v[24:27], v[52:55], v[52:55], v[24:27]
    s_add_u32 s17, s43, 1536
    s_waitcnt lgkmcnt(0)
    buffer_store_dwordx2 v[34:35], v10, s[8:11], s17 offen sc1
    s_cmp_eq_u32 s33, 63
    s_cbranch_scc1 Lr3s_last
    ds_read_b128 v[56:59], v8 offset:16384
    ds_read_b128 v[60:63], v8 offset:17408
    v_mov_b64 v[20:21], s[52:53]
    v_mov_b64 v[22:23], s[52:53]
    v_mov_b32 v41, 0
    v_mov_b32 v42, 0
    v_max3_f32 v9, v12, v13, v14
    v_max3_f32 v9, v9, v15, v16
    v_max3_f32 v9, v9, v17, v18
    v_max3_f32 v9, v9, v19, v24
    v_max_f32 v9, v9, v25
    v_mov_b32 v10, v9
    v_mov_b64 v[32:33], 0
    v_mov_b64 v[34:35], 0
    v_permlane32_swap_b32 v9, v10
    v_max_f32 v9, v9, v10
    v_mov_b32 v10, v9
    s_nop 1
    v_permlane16_swap_b32 v9, v10
    v_max_f32 v9, v9, v10
    v_mul_f32 v28, s44, v9
    v_fma_f32 v12, v12, s44, -v28
    v_fma_f32 v13, v13, s44, -v28
    v_fma_f32 v14, v14, s44, -v28
    v_fma_f32 v15, v15, s44, -v28
    v_exp_f32 v12, v12
    v_exp_f32 v13, v13
    v_fma_f32 v16, v16, s44, -v28
    v_fma_f32 v17, v17, s44, -v28
    v_exp_f32 v14, v14
    v_exp_f32 v15, v15
    v_cvt_pk_bf16_f32 v36, v12, v13
    v_fma_f32 v18, v18, s44, -v28
    v_fma_f32 v19, v19, s44, -v28
    v_exp_f32 v16, v16
    v_exp_f32 v17, v17
    v_cvt_pk_bf16_f32 v37, v14, v15
    v_fma_f32 v24, v24, s44, -v28
    v_fma_f32 v25, v25, s44, -v28
    v_exp_f32 v18, v18
    v_exp_f32 v19, v19
    v_cvt_pk_bf16_f32 v38, v16, v17
    v_exp_f32 v24, v24
    v_exp_f32 v25, v25
    v_cvt_pk_bf16_f32 v39, v18, v19
    v_cvt_pk_bf16_f32 v40, v24, v25
    v_cvt_pk_bf16_f32 v43, v24, v25
    v_mfma_f32_16x16x32_bf16 v[52:55], v[20:23], v[36:39], 0
    v_mov_b64 v[12:13], 0
    v_mov_b64 v[14:15], 0
    s_waitcnt vmcnt(4)
    v_mfma_f32_16x16x32_bf16 v[44:47], v[64:67], v[36:39], 0
    v_mov_b64 v[24:25], 0
    v_mov_b64 v[26:27], 0
    s_waitcnt vmcnt(3)
    v_mfma_f32_16x16x32_bf16 v[48:51], v[68:71], v[36:39], 0
    ds_read_b128 v[64:67], v8 offset:20480
    ds_read_b128 v[68:71], v8 offset:21504
    v_mfma_f32_16x16x16_bf16 v[52:55], v[20:21], v[40:41], v[52:55]
    v_mfma_f32_16x16x16_bf16 v[44:47], v[30:31], v[40:41], v[44:47]
    v_mov_b64 v[20:21], 0
    v_mov_b64 v[22:23], 0
    v_mfma_f32_16x16x16_bf16 v[48:51], v[30:31], v[42:43], v[48:51]
    v_mov_b64 v[36:37], 0
    v_mov_b64 v[38:39], 0
    v_mov_b64 v[40:41], 0
    v_mov_b64 v[42:43], 0
    v_rcp_f32 v9, v52
    v_mov_b64 v[52:53], 0
    v_mov_b64 v[54:55], 0
    v_mul_f32 v44, v9, v44
    v_mul_f32 v48, v9, v48
    v_cvt_pk_bf16_f32 v16, v44, v48
    v_mul_f32 v45, v9, v45
    v_mul_f32 v49, v9, v49
    v_cvt_pk_bf16_f32 v17, v45, v49
    v_mul_f32 v46, v9, v46
    v_mul_f32 v50, v9, v50
    v_cvt_pk_bf16_f32 v18, v46, v50
    v_mul_f32 v47, v9, v47
    v_mul_f32 v51, v9, v51
    v_cvt_pk_bf16_f32 v19, v47, v51
    ds_write_b128 v5, v[16:19]
    v_mov_b64 v[28:29], 0
    v_mov_b64 v[30:31], 0
    s_waitcnt lgkmcnt(0)
    s_barrier
    ds_read_b128 v[44:47], v4 offset:0
    ds_read_b128 v[48:51], v4 offset:128
    v_mov_b64 v[16:17], 0
    v_mov_b64 v[18:19], 0
    buffer_load_dwordx4 v0, s[8:11], s41 offen offset:0 lds
    buffer_load_dwordx4 v0, s[8:11], s41 offen offset:1024 lds
    s_waitcnt lgkmcnt(1)
    v_smfmac_f32_16x16x64_bf16 v[12:15], v[44:47], a[184:191], v1
    s_waitcnt lgkmcnt(0)
    v_smfmac_f32_16x16x64_bf16 v[12:15], v[48:51], a[192:199], v1
    v_smfmac_f32_16x16x64_bf16 v[24:27], v[44:47], a[200:207], v1
    v_smfmac_f32_16x16x64_bf16 v[24:27], v[48:51], a[208:215], v1
    v_add_f32 v12, v12, v14
    v_smfmac_f32_16x16x64_bf16 v[20:23], v[44:47], a[216:223], v1
    v_add_f32 v13, v13, v15
    v_smfmac_f32_16x16x64_bf16 v[20:23], v[48:51], a[224:231], v1
    v_cvt_pk_bf16_f32 v12, v12, v13
    v_smfmac_f32_16x16x64_bf16 v[16:19], v[44:47], a[232:239], v1
    v_add_f32 v24, v24, v26
    v_smfmac_f32_16x16x64_bf16 v[16:19], v[48:51], a[240:247], v1
    v_add_f32 v25, v25, v27
    v_smfmac_f32_16x16x64_bf16 v[36:39], v[44:47], v[56:63], v1
    v_cvt_pk_bf16_f32 v13, v24, v25
    v_smfmac_f32_16x16x64_bf16 v[36:39], v[48:51], v[64:71], v1
    v_add_f32 v20, v20, v22
    v_add_f32 v21, v21, v23
    v_cvt_pk_bf16_f32 v14, v20, v21
    v_add_f32 v16, v16, v18
    v_add_f32 v17, v17, v19
    v_cvt_pk_bf16_f32 v15, v16, v17
    v_and_or_b32 v15, v15, -2, s40
    buffer_store_dwordx4 v[12:15], v0, s[8:11], s38 offen sc1
    s_nop 0
    ds_read_b128 v[12:15], v8 offset:18432
    ds_read_b128 v[16:19], v8 offset:19456
    ds_read_b128 v[20:23], v8 offset:22528
    ds_read_b128 v[24:27], v8 offset:23552
    ds_read_b128 v[56:59], v8 offset:24576
    ds_read_b128 v[60:63], v8 offset:25600
    ds_read_b128 v[64:67], v8 offset:28672
    ds_read_b128 v[68:71], v8 offset:29696
    s_waitcnt lgkmcnt(6)
    v_smfmac_f32_16x16x64_bf16 v[40:43], v[44:47], v[12:19], v1
    ds_read_b128 v[12:15], v8 offset:26624
    ds_read_b128 v[16:19], v8 offset:27648
    s_waitcnt lgkmcnt(6)
    v_smfmac_f32_16x16x64_bf16 v[40:43], v[48:51], v[20:27], v1
    ds_read_b128 v[20:23], v8 offset:30720
    ds_read_b128 v[24:27], v8 offset:31744
    s_waitcnt lgkmcnt(6)
    v_smfmac_f32_16x16x64_bf16 v[52:55], v[44:47], v[56:63], v1
    ds_read_b128 v[56:59], v8 offset:32768
    ds_read_b128 v[60:63], v8 offset:33792
    s_waitcnt lgkmcnt(6)
    v_smfmac_f32_16x16x64_bf16 v[52:55], v[48:51], v[64:71], v1
    s_waitcnt lgkmcnt(4)
    v_smfmac_f32_16x16x64_bf16 v[32:35], v[44:47], v[12:19], v1
    s_waitcnt lgkmcnt(2)
    v_smfmac_f32_16x16x64_bf16 v[32:35], v[48:51], v[20:27], v1
    v_smfmac_f32_16x16x64_bf16 v[28:31], v[44:47], a[248:255], v1
    s_waitcnt lgkmcnt(0)
    v_smfmac_f32_16x16x64_bf16 v[28:31], v[48:51], v[56:63], v1
    v_add_f32 v36, v36, v38
    v_add_f32 v37, v37, v39
    v_cvt_pk_bf16_f32 v36, v36, v37
    v_add_f32 v40, v40, v42
    v_add_f32 v41, v41, v43
    v_cvt_pk_bf16_f32 v37, v40, v41
    v_add_f32 v52, v52, v54
    v_add_f32 v53, v53, v55
    v_cvt_pk_bf16_f32 v38, v52, v53
    v_add_f32 v32, v32, v34
    v_add_f32 v33, v33, v35
    v_cvt_pk_bf16_f32 v39, v32, v33
    v_and_or_b32 v39, v39, -2, s40
    s_add_u32 s17, s38, 4096
    buffer_store_dwordx4 v[36:39], v0, s[8:11], s17 offen sc1
    v_add_f32 v28, v28, v30
    v_add_f32 v29, v29, v31
    v_cvt_pk_bf16_f32 v28, v28, v29
    v_and_or_b32 v28, v28, -2, s40
    v_lshrrev_b32 v9, 2, v0
    buffer_store_dword v28, v9, s[8:11], s39 offen sc1
    s_xor_b32 s34, s34, 16384
    s_xor_b32 s35, s35, 16384
    s_add_u32 s33, s33, 1
    s_add_u32 s42, s42, 262144
    s_add_u32 s41, s41, 262144
    s_add_u32 s43, s43, 131072
    s_add_u32 s68, s68, 262144
    s_add_u32 s66, s66, 22528
    s_xor_b32 s40, s40, 1
    ds_read_b128 v[56:59], v8 offset:0
    ds_read_b128 v[60:63], v8 offset:1024
    ds_read_b128 v[64:67], v8 offset:2048
    ds_read_b128 v[68:71], v8 offset:3072
    v_mov_b64 v[12:13], 0
    v_mov_b64 v[14:15], 0
    v_mov_b64 v[16:17], 0
    v_mov_b64 v[18:19], 0
    v_mov_b64 v[20:21], 0
    v_mov_b64 v[22:23], 0
    v_mov_b64 v[24:25], 0
    v_mov_b64 v[26:27], 0
    v_mov_b64 v[28:29], 0
    v_mov_b64 v[30:31], 0
    v_mov_b64 v[32:33], 0
    v_mov_b64 v[34:35], 0
    s_sleep 5
    s_nop 9
    buffer_load_dwordx4 v[36:39], v0, s[8:11], s34 offen sc1
    s_nop 15
    s_nop 8
    buffer_load_dwordx4 v[36:39], v0, s[8:11], s34 offen sc1
    s_nop 15
    s_nop 8
    buffer_load_dwordx4 v[36:39], v0, s[8:11], s34 offen sc1
    s_waitcnt lgkmcnt(0)
    s_branch Lr3s_step
Lr3s_pb_re:
    s_mov_b32 s16, 0
Lr3s_pb_lp:
    s_add_u32 s17, s34, 4096
    buffer_load_dwordx4 v[40:43], v0, s[8:11], s17 offen sc1
    s_add_u32 s16, s16, 1
    s_cmp_gt_u32 s16, 100000
    s_cbranch_scc1 Lr_abort
    s_waitcnt vmcnt(0)
    v_max3_u32 v10, v40, v41, v42
    v_max_u32 v10, v10, v43
    v_cmp_eq_u32 vcc, -1, v10
    s_nop 0
    s_cbranch_vccnz Lr3s_pb_lp
    s_branch Lr3s_pb_ok
Lr3s_pc_re:
    s_mov_b32 s16, 0
Lr3s_pc_lp:
    buffer_load_dwordx4 v[44:47], v0, s[8:11], s35 offen sc1
    s_add_u32 s16, s16, 1
    s_cmp_gt_u32 s16, 100000
    s_cbranch_scc1 Lr_abort
    s_waitcnt vmcnt(0)
    v_max3_u32 v10, v44, v45, v46
    v_max_u32 v10, v10, v47
    v_cmp_eq_u32 vcc, -1, v10
    s_nop 0
    s_cbranch_vccnz Lr3s_pc_lp
    s_branch Lr3s_pc_ok
Lr3s_last:
    s_waitcnt vmcnt(0) lgkmcnt(0)
    s_barrier
    s_branch Lr_exit
Lr_abort:
    s_waitcnt lgkmcnt(0)
    s_mov_b64 exec, -1
    v_mov_b32 v0, 60
    s_lshl_b32 s5, s3, 8
    s_or_b32 s5, s5, s4
    s_or_b32 s5, s5, 0x10000
    v_mov_b32 v1, s5
    global_store_dword v0, v1, s[12:13]
    s_endpgm
Lr_exit:
    s_endpgm
.section .rodata,"a"
.p2align 6
.amdhsa_kernel interleave_layers__sliding_local_dilated__memory_aug_recurrent_mem_tr__prompt_kernel
  .amdhsa_next_free_vgpr 512
  .amdhsa_next_free_sgpr 102
  .amdhsa_accum_offset 256
  .amdhsa_group_segment_fixed_size 0
  .amdhsa_kernarg_size 104
  .amdhsa_user_sgpr_count 2
  .amdhsa_user_sgpr_kernarg_segment_ptr 1
  .amdhsa_system_sgpr_workgroup_id_x 1
.end_amdhsa_kernel
```

```asm
; @launch grid=(256,1,1) block=(256,1,1) lds=163840
.amdgcn_target "amdgcn-amd-amdhsa--gfx950"
.text
.globl interleave_layers__sliding_local_dilated__memory_aug_recurrent_mem_tr__prompt_kernel
.p2align 8
.type interleave_layers__sliding_local_dilated__memory_aug_recurrent_mem_tr__prompt_kernel,@function
interleave_layers__sliding_local_dilated__memory_aug_recurrent_mem_tr__prompt_kernel:
    s_cmp_ge_u32 s2, 256
    s_cbranch_scc1 L_exit
    s_load_dwordx2 s[8:9], s[0:1], 96
    s_mov_b32 s10, 268435456
    s_mov_b32 s11, 0x00020000
    s_waitcnt lgkmcnt(0)
    s_and_b32 s9, s9, 0xffff
    s_load_dwordx2 s[12:13], s[0:1], 88
    v_lshrrev_b32 v1, 6, v0
    s_getreg_b32 s3, hwreg(HW_REG_XCC_ID)
    v_readfirstlane_b32 s14, v1
    s_and_b32 s3, s3, 7
    s_and_b32 s17, s3, 1
    s_lshl_b32 s17, s17, 7
    s_lshl_b32 s18, s3, 1
    s_and_b32 s18, s18, 12
    s_add_u32 s17, s17, s18
    v_mov_b32 v2, 0
    v_mov_b32 v3, 1
    v_mov_b32 v4, s17
    s_mov_b32 s33, 0
    s_waitcnt lgkmcnt(0)
    s_cmp_lg_u32 s14, 0
    s_cbranch_scc1 L_tk_wait
    s_mov_b64 exec, 1
    global_atomic_add v3, v4, v3, s[12:13] sc0
    s_waitcnt vmcnt(0)
    v_readfirstlane_b32 s4, v3
    s_nop 0
    s_cmp_lt_u32 s4, 32
    s_cbranch_scc1 L_tk_have
    v_mov_b32 v3, 1
    v_mov_b32 v4, 32
    global_atomic_add v3, v4, v3, s[12:13] sc0
    s_waitcnt vmcnt(0)
    v_readfirstlane_b32 s5, v3
    s_mov_b64 exec, 0xff
    v_and_b32 v4, 1, v0
    v_lshlrev_b32 v4, 7, v4
    v_lshlrev_b32 v5, 1, v0
    v_and_or_b32 v4, v5, 12, v4
    s_mov_b32 s16, 0
L_hl_poll:
    global_load_dword v5, v4, s[12:13] sc1
    s_add_u32 s16, s16, 1
    s_cmp_gt_u32 s16, 100000
    s_cbranch_scc1 L_abort
    s_mov_b32 s6, 0
    s_waitcnt vmcnt(0)
    v_readlane_b32 s40, v5, 0
    s_nop 0
    s_add_u32 s6, s6, s40
    v_readlane_b32 s41, v5, 1
    s_nop 0
    s_add_u32 s6, s6, s41
    v_readlane_b32 s42, v5, 2
    s_nop 0
    s_add_u32 s6, s6, s42
    v_readlane_b32 s43, v5, 3
    s_nop 0
    s_add_u32 s6, s6, s43
    v_readlane_b32 s44, v5, 4
    s_nop 0
    s_add_u32 s6, s6, s44
    v_readlane_b32 s45, v5, 5
    s_nop 0
    s_add_u32 s6, s6, s45
    v_readlane_b32 s46, v5, 6
    s_nop 0
    s_add_u32 s6, s6, s46
    v_readlane_b32 s47, v5, 7
    s_nop 0
    s_add_u32 s6, s6, s47
    s_cmp_lt_u32 s6, 256
    s_cbranch_scc1 L_hl_poll
    s_mov_b32 s3, 0
    s_mov_b32 s4, 0
    s_min_u32 s6, s47, 32
    s_sub_u32 s7, 32, s6
    s_cmp_lt_u32 s5, s7
    s_cselect_b32 s3, 7, s3
    s_add_u32 s6, s6, s5
    s_cmp_lt_u32 s5, s7
    s_cselect_b32 s4, s6, s4
    s_sub_u32 s5, s5, s7
    s_min_u32 s6, s46, 32
    s_sub_u32 s7, 32, s6
    s_cmp_lt_u32 s5, s7
    s_cselect_b32 s3, 6, s3
    s_add_u32 s6, s6, s5
    s_cmp_lt_u32 s5, s7
    s_cselect_b32 s4, s6, s4
    s_sub_u32 s5, s5, s7
    s_min_u32 s6, s45, 32
    s_sub_u32 s7, 32, s6
    s_cmp_lt_u32 s5, s7
    s_cselect_b32 s3, 5, s3
    s_add_u32 s6, s6, s5
    s_cmp_lt_u32 s5, s7
    s_cselect_b32 s4, s6, s4
    s_sub_u32 s5, s5, s7
    s_min_u32 s6, s44, 32
    s_sub_u32 s7, 32, s6
    s_cmp_lt_u32 s5, s7
    s_cselect_b32 s3, 4, s3
    s_add_u32 s6, s6, s5
    s_cmp_lt_u32 s5, s7
    s_cselect_b32 s4, s6, s4
    s_sub_u32 s5, s5, s7
    s_min_u32 s6, s43, 32
    s_sub_u32 s7, 32, s6
    s_cmp_lt_u32 s5, s7
    s_cselect_b32 s3, 3, s3
    s_add_u32 s6, s6, s5
    s_cmp_lt_u32 s5, s7
    s_cselect_b32 s4, s6, s4
    s_sub_u32 s5, s5, s7
    s_min_u32 s6, s42, 32
    s_sub_u32 s7, 32, s6
    s_cmp_lt_u32 s5, s7
    s_cselect_b32 s3, 2, s3
    s_add_u32 s6, s6, s5
    s_cmp_lt_u32 s5, s7
    s_cselect_b32 s4, s6, s4
    s_sub_u32 s5, s5, s7
    s_min_u32 s6, s41, 32
    s_sub_u32 s7, 32, s6
    s_cmp_lt_u32 s5, s7
    s_cselect_b32 s3, 1, s3
    s_add_u32 s6, s6, s5
    s_cmp_lt_u32 s5, s7
    s_cselect_b32 s4, s6, s4
    s_sub_u32 s5, s5, s7
    s_min_u32 s6, s40, 32
    s_sub_u32 s7, 32, s6
    s_cmp_lt_u32 s5, s7
    s_cselect_b32 s3, 0, s3
    s_add_u32 s6, s6, s5
    s_cmp_lt_u32 s5, s7
    s_cselect_b32 s4, s6, s4
    s_sub_u32 s5, s5, s7
L_tk_have:
    s_lshl_b32 s5, s3, 8
    s_or_b32 s5, s5, s4
    v_mov_b32 v3, s5
    s_mov_b64 exec, 1
    ds_write_b32 v2, v3
    s_mov_b64 exec, -1
L_tk_wait:
    s_waitcnt vmcnt(0) lgkmcnt(0)
    s_barrier
    ds_read_b32 v3, v2
    s_waitcnt lgkmcnt(0)
    v_readfirstlane_b32 s5, v3
    s_nop 0
    s_lshr_b32 s3, s5, 8
    s_and_b32 s4, s5, 255
    s_barrier
    s_cmp_lt_u32 s3, 2
    s_cbranch_scc1 L_role_r
    s_sub_u32 s6, s3, 2
    s_lshl_b32 s6, s6, 5
    s_add_u32 s6, s6, s4
    s_load_dwordx2 s[20:21], s[0:1], 8
    s_mov_b32 s22, 1990656
    s_mov_b32 s23, 0x00020000
    s_waitcnt lgkmcnt(0)
    s_and_b32 s21, s21, 0xffff
    s_load_dwordx2 s[24:25], s[0:1], 16
    s_mov_b32 s26, 663552
    s_mov_b32 s27, 0x00020000
    s_waitcnt lgkmcnt(0)
    s_and_b32 s25, s25, 0xffff
    s_sub_u32 s41, 191, s6
    s_lshl_b32 s41, s41, 15
    v_lshlrev_b32 v254, 7, v0
    buffer_load_dword v255, v254, s[20:23], s41 offen
    s_sub_u32 s41, s41, 1998848
    s_cmp_lt_u32 s41, 688128
    s_cselect_b32 s41, s41, 0x7f000000
    s_waitcnt vmcnt(0)
    buffer_load_dword v255, v254, s[24:27], s41 offen
    s_cmp_ge_u32 s6, 136
    s_cbranch_scc1 Li_end
    v_lshlrev_b32 v7, 4, v0
    v_mov_b32 v12, 0
    v_mov_b32 v13, 0
    v_mov_b32 v14, 0
    v_mov_b32 v15, 0
    s_cmp_ge_u32 s6, 64
    s_cbranch_scc1 Li_rest
    s_load_dwordx2 s[20:21], s[0:1], 0
    s_mov_b32 s22, 2359296
    s_mov_b32 s23, 0x00020000
    s_waitcnt lgkmcnt(0)
    s_and_b32 s21, s21, 0xffff
    v_and_b32 v1, 31, v0
    v_lshrrev_b32 v2, 5, v0
    v_mul_u32_u24 v3, 1152, v1
    v_mul_u32_u24 v5, 144, v2
    v_add_u32 v3, v3, v5
    s_mul_i32 s41, s6, 36864
    buffer_load_dwordx4 v[64:67], v3, s[20:23], s41 offen offset:0
    buffer_load_dwordx4 v[68:71], v3, s[20:23], s41 offen offset:16
    buffer_load_dwordx4 v[72:75], v3, s[20:23], s41 offen offset:32
    buffer_load_dwordx4 v[76:79], v3, s[20:23], s41 offen offset:48
    buffer_load_dwordx4 v[80:83], v3, s[20:23], s41 offen offset:64
    buffer_load_dwordx4 v[84:87], v3, s[20:23], s41 offen offset:80
    buffer_load_dwordx4 v[88:91], v3, s[20:23], s41 offen offset:96
    buffer_load_dwordx4 v[92:95], v3, s[20:23], s41 offen offset:112
    buffer_load_dwordx4 v[96:99], v3, s[20:23], s41 offen offset:128
    v_mul_u32_u24 v4, 4608, v2
    v_lshl_add_u32 v4, v1, 4, v4
    s_mul_i32 s41, s6, 36864
    s_add_u32 s41, s41, 6291456
    s_mul_i32 s42, s6, 6144
    s_add_u32 s42, s42, 15728640
    s_add_u32 s43, s42, 2048
    s_add_u32 s44, s42, 396288
    v_mov_b32 v60, 0
    v_mov_b32 v61, 0
    s_waitcnt vmcnt(8)
    buffer_store_dwordx4 v[64:67], v4, s[8:11], s41 offen offset:0 sc1
    s_waitcnt vmcnt(8)
    buffer_store_dwordx4 v[68:71], v4, s[8:11], s41 offen offset:512 sc1
    s_waitcnt vmcnt(8)
    buffer_store_dwordx4 v[72:75], v4, s[8:11], s41 offen offset:1024 sc1
    s_waitcnt vmcnt(8)
    buffer_store_dwordx4 v[76:79], v4, s[8:11], s41 offen offset:1536 sc1
    s_waitcnt vmcnt(8)
    buffer_store_dwordx4 v[80:83], v4, s[8:11], s41 offen offset:2048 sc1
    s_waitcnt vmcnt(8)
    buffer_store_dwordx4 v[84:87], v4, s[8:11], s41 offen offset:2560 sc1
    s_waitcnt vmcnt(8)
    buffer_store_dwordx4 v[88:91], v4, s[8:11], s41 offen offset:3072 sc1
    s_waitcnt vmcnt(8)
    buffer_store_dwordx4 v[92:95], v4, s[8:11], s41 offen offset:3584 sc1
    v_add_u32 v4, 4096, v4
    s_waitcnt vmcnt(8)
    buffer_store_dwordx4 v[96:99], v4, s[8:11], s41 offen offset:0 sc1
    buffer_store_dwordx4 v[12:15], v7, s[8:11], s43 offen sc1
    v_cmp_gt_u32 vcc, 192, v0
    s_nop 0
    s_and_saveexec_b64 s[46:47], vcc
    s_cbranch_execz Li_z1
    buffer_store_dwordx4 v[12:15], v7, s[8:11], s44 offen sc1
Li_z1:
    s_mov_b64 exec, s[46:47]
    v_mov_b32 v62, 0x3f803f80
    v_dot2c_f32_bf16 v60, v64, v62
    v_dot2c_f32_bf16 v61, v64, v64
    v_dot2c_f32_bf16 v60, v65, v62
    v_dot2c_f32_bf16 v61, v65, v65
    v_dot2c_f32_bf16 v60, v66, v62
    v_dot2c_f32_bf16 v61, v66, v66
    v_dot2c_f32_bf16 v60, v67, v62
    v_dot2c_f32_bf16 v61, v67, v67
    v_dot2c_f32_bf16 v60, v68, v62
    v_dot2c_f32_bf16 v61, v68, v68
    v_dot2c_f32_bf16 v60, v69, v62
    v_dot2c_f32_bf16 v61, v69, v69
    v_dot2c_f32_bf16 v60, v70, v62
    v_dot2c_f32_bf16 v61, v70, v70
    v_dot2c_f32_bf16 v60, v71, v62
    v_dot2c_f32_bf16 v61, v71, v71
    v_dot2c_f32_bf16 v60, v72, v62
    v_dot2c_f32_bf16 v61, v72, v72
    v_dot2c_f32_bf16 v60, v73, v62
    v_dot2c_f32_bf16 v61, v73, v73
    v_dot2c_f32_bf16 v60, v74, v62
    v_dot2c_f32_bf16 v61, v74, v74
    v_dot2c_f32_bf16 v60, v75, v62
    v_dot2c_f32_bf16 v61, v75, v75
    v_dot2c_f32_bf16 v60, v76, v62
    v_dot2c_f32_bf16 v61, v76, v76
    v_dot2c_f32_bf16 v60, v77, v62
    v_dot2c_f32_bf16 v61, v77, v77
    v_dot2c_f32_bf16 v60, v78, v62
    v_dot2c_f32_bf16 v61, v78, v78
    v_dot2c_f32_bf16 v60, v79, v62
    v_dot2c_f32_bf16 v61, v79, v79
    v_dot2c_f32_bf16 v60, v80, v62
    v_dot2c_f32_bf16 v61, v80, v80
    v_dot2c_f32_bf16 v60, v81, v62
    v_dot2c_f32_bf16 v61, v81, v81
    v_dot2c_f32_bf16 v60, v82, v62
    v_dot2c_f32_bf16 v61, v82, v82
    v_dot2c_f32_bf16 v60, v83, v62
    v_dot2c_f32_bf16 v61, v83, v83
    v_dot2c_f32_bf16 v60, v84, v62
    v_dot2c_f32_bf16 v61, v84, v84
    v_dot2c_f32_bf16 v60, v85, v62
    v_dot2c_f32_bf16 v61, v85, v85
    v_dot2c_f32_bf16 v60, v86, v62
    v_dot2c_f32_bf16 v61, v86, v86
    v_dot2c_f32_bf16 v60, v87, v62
    v_dot2c_f32_bf16 v61, v87, v87
    v_dot2c_f32_bf16 v60, v88, v62
    v_dot2c_f32_bf16 v61, v88, v88
    v_dot2c_f32_bf16 v60, v89, v62
    v_dot2c_f32_bf16 v61, v89, v89
    v_dot2c_f32_bf16 v60, v90, v62
    v_dot2c_f32_bf16 v61, v90, v90
    v_dot2c_f32_bf16 v60, v91, v62
    v_dot2c_f32_bf16 v61, v91, v91
    v_dot2c_f32_bf16 v60, v92, v62
    v_dot2c_f32_bf16 v61, v92, v92
    v_dot2c_f32_bf16 v60, v93, v62
    v_dot2c_f32_bf16 v61, v93, v93
    v_dot2c_f32_bf16 v60, v94, v62
    v_dot2c_f32_bf16 v61, v94, v94
    v_dot2c_f32_bf16 v60, v95, v62
    v_dot2c_f32_bf16 v61, v95, v95
    v_dot2c_f32_bf16 v60, v96, v62
    v_dot2c_f32_bf16 v61, v96, v96
    v_dot2c_f32_bf16 v60, v97, v62
    v_dot2c_f32_bf16 v61, v97, v97
    v_dot2c_f32_bf16 v60, v98, v62
    v_dot2c_f32_bf16 v61, v98, v98
    v_dot2c_f32_bf16 v60, v99, v62
    v_dot2c_f32_bf16 v61, v99, v99
    s_nop 3
    v_lshrrev_b32 v5, 1, v2
    v_lshlrev_b32 v5, 9, v5
    v_lshl_add_u32 v5, v1, 4, v5
    v_and_b32 v6, 1, v2
    v_lshl_add_u32 v5, v6, 3, v5
    buffer_store_dwordx2 v[60:61], v5, s[8:11], s42 offen sc1
    s_branch Li_flags
Li_rest:
    s_cmp_ge_u32 s6, 128
    s_cbranch_scc1 Li_flags
    s_sub_u32 s41, s6, 64
    s_mul_i32 s41, s41, 6144
    s_add_u32 s41, s41, 16911360
    v_cmp_gt_u32 vcc, 192, v0
    s_nop 0
    s_and_saveexec_b64 s[42:43], vcc
    s_cbranch_execz Li_rest2
    buffer_store_dwordx4 v[12:15], v7, s[8:11], s41 offen sc1
Li_rest2:
    s_mov_b64 exec, s[42:43]
Li_flags:
    v_cmp_gt_u32 vcc, 96, v0
    s_cmp_lt_u32 s6, 64
    s_cselect_b64 s[42:43], -1, 0
    s_and_b64 vcc, vcc, s[42:43]
    s_cmp_lt_u32 s6, 128
    s_cselect_b32 s44, 0, 0
    v_mov_b32 v12, s44
    v_mov_b32 v13, s44
    v_mov_b32 v14, s44
    v_mov_b32 v15, s44
    v_mov_b32 v9, 1
    v_cndmask_b32 v8, v12, v9, vcc
    v_mov_b32 v9, v8
    v_mov_b32 v10, v8
    v_mov_b32 v11, v8
    s_mul_i32 s41, s6, 22528
    s_sub_u32 s42, s6, 128
    s_lshl_b32 s42, s42, 12
    s_add_u32 s42, s42, 2883584
    s_cmp_ge_u32 s6, 128
    s_cselect_b32 s41, s42, s41
    buffer_store_dwordx4 v[8:11], v7, s[8:11], s41 offen sc1
    s_cbranch_scc1 Li_nofl
    s_add_u32 s41, s41, 4096
    buffer_store_dwordx4 v[12:15], v7, s[8:11], s41 offen sc1
    s_add_u32 s41, s41, 4096
    buffer_store_dwordx4 v[12:15], v7, s[8:11], s41 offen sc1
    s_add_u32 s41, s41, 4096
    buffer_store_dwordx4 v[12:15], v7, s[8:11], s41 offen sc1
    s_add_u32 s41, s41, 4096
    buffer_store_dwordx4 v[12:15], v7, s[8:11], s41 offen sc1
    s_add_u32 s41, s41, 4096
    v_cmp_gt_u32 vcc, 128, v0
    s_nop 0
    s_and_saveexec_b64 s[42:43], vcc
    s_cbranch_execz Li_fl5
    buffer_store_dwordx4 v[12:15], v7, s[8:11], s41 offen sc1
Li_fl5:
    s_mov_b64 exec, s[42:43]
Li_nofl:
    s_waitcnt vmcnt(0)
    s_barrier
    s_cmp_lg_u32 s14, 0
    s_cbranch_scc1 Li_end
    s_sub_u32 s41, s6, 64
    s_cmp_lt_u32 s41, 64
    s_cbranch_scc1 Li_l1
    v_mov_b32 v2, 40
    v_mov_b32 v3, 1
    s_mov_b64 exec, 1
    global_atomic_add v2, v3, s[12:13]
    s_mov_b64 exec, -1
    s_branch Li_end
Li_l1:
    v_mov_b32 v2, 160
    v_mov_b32 v3, 1
    s_mov_b64 exec, 1
    global_atomic_add v2, v3, s[12:13]
    s_mov_b64 exec, -1
Li_end:
    s_cmp_lg_u32 s3, 2
    s_cbranch_scc1 L_cls2_no
    s_add_u32 s15, s4, 0
    s_cmp_lt_u32 s4, 24
    s_cbranch_scc1 L_role_tw
    s_add_u32 s15, s4, 4294967272
    s_cmp_lt_u32 s4, 32
    s_cbranch_scc1 L_role_p
    s_endpgm
L_cls2_no:
    s_cmp_lg_u32 s3, 3
    s_cbranch_scc1 L_cls3_no
    s_add_u32 s15, s4, 24
    s_cmp_lt_u32 s4, 12
    s_cbranch_scc1 L_role_tw
    s_add_u32 s15, s4, 4294967292
    s_cmp_lt_u32 s4, 32
    s_cbranch_scc1 L_role_p
    s_endpgm
L_cls3_no:
    s_cmp_lg_u32 s3, 4
    s_cbranch_scc1 L_cls4_no
    s_add_u32 s15, s4, 0
    s_cmp_lt_u32 s4, 16
    s_cbranch_scc1 L_role_aq
    s_add_u32 s15, s4, 4294967280
    s_cmp_lt_u32 s4, 19
    s_cbranch_scc1 L_role_awo
    s_add_u32 s15, s4, 9
    s_cmp_lt_u32 s4, 32
    s_cbranch_scc1 L_role_p
    s_endpgm
L_cls4_no:
    s_cmp_lg_u32 s3, 5
    s_cbranch_scc1 L_cls5_no
    s_add_u32 s15, s4, 16
    s_cmp_lt_u32 s4, 16
    s_cbranch_scc1 L_role_aq
    s_add_u32 s15, s4, 4294967283
    s_cmp_lt_u32 s4, 19
    s_cbranch_scc1 L_role_awo
    s_add_u32 s15, s4, 22
    s_cmp_lt_u32 s4, 32
    s_cbranch_scc1 L_role_p
    s_endpgm
L_cls5_no:
    s_cmp_lg_u32 s3, 6
    s_cbranch_scc1 L_cls6_no
    s_add_u32 s15, s4, 0
    s_cmp_lt_u32 s4, 11
    s_cbranch_scc1 L_role_ta
    s_add_u32 s15, s4, 43
    s_cmp_lt_u32 s4, 32
    s_cbranch_scc1 L_role_p
    s_endpgm
L_cls6_no:
    s_cmp_lg_u32 s3, 7
    s_cbranch_scc1 L_cls7_no
    s_add_u32 s15, s4, 11
    s_cmp_lt_u32 s4, 11
    s_cbranch_scc1 L_role_ta
    s_add_u32 s15, s4, 64
    s_cmp_lt_u32 s4, 32
    s_cbranch_scc1 L_role_p
    s_endpgm
L_cls7_no:
L_exit:
    s_endpgm
L_abort:
    s_waitcnt lgkmcnt(0)
    s_mov_b64 exec, -1
    v_mov_b32 v0, 60
    s_lshl_b32 s5, s3, 8
    s_or_b32 s5, s5, s4
    s_or_b32 s5, s5, 0x10000
    v_mov_b32 v1, s5
    global_store_dword v0, v1, s[12:13]
    s_endpgm
.p2align 6
L_role_p:
    v_and_b32 v5, 63, v0
    v_lshlrev_b32 v0, 4, v5
    v_and_b32 v7, 15, v5
    v_lshrrev_b32 v8, 4, v5
    v_min_u32 v1, 11, v5
    v_lshrrev_b32 v6, 2, v1
    v_and_b32 v1, 3, v1
    v_lshlrev_b32 v1, 2, v1
    v_lshl_add_u32 v1, v6, 7, v1
    v_mov_b32 v3, 1
    v_mov_b32 v4, 0
    s_mov_b32 s44, 0x05040100
    s_mov_b32 s45, 0x07060302
    s_cmp_ge_u32 s15, 48
    s_cselect_b32 s63, 1, 0
    s_cselect_b32 s17, 48, 0
    s_sub_u32 s15, s15, s17
    s_cmp_lt_u32 s15, 32
    s_cselect_b32 s50, 1, 0
    s_sub_u32 s17, s15, 32
    s_lshl_b32 s17, s17, 1
    s_cmp_eq_u32 s50, 1
    s_cselect_b32 s51, s15, s17
    s_cselect_b32 s17, 48, 40
    s_cselect_b32 s18, 56, 40
    s_load_dwordx2 s[20:21], s[0:1], s17
    s_load_dwordx2 s[24:25], s[0:1], s18
    s_mov_b32 s22, 4718592
    s_mov_b32 s23, 0x00020000
    s_mov_b32 s26, 4718592
    s_mov_b32 s27, 0x00020000
    s_lshl_b32 s49, s51, 8
    s_mul_i32 s17, s14, 131072
    s_add_u32 s49, s49, s17
    s_cmp_eq_u32 s50, 1
    s_cselect_b32 s17, 0, 256
    s_add_u32 s52, s49, s17
    s_waitcnt lgkmcnt(0)
    s_and_b32 s21, s21, 0xffff
    s_and_b32 s25, s25, 0xffff
    s_cmp_eq_u32 s63, 0
    s_cbranch_scc1 Lp2_gate_ng
    s_cmp_lg_u32 s14, 0
    s_cbranch_scc1 Lp2_gate_d
    v_mov_b32 v5, 48
    s_mov_b32 s16, 0
Lp2_gate:
    global_load_dword v6, v5, s[12:13] sc1
    s_add_u32 s16, s16, 1
    s_cmp_gt_u32 s16, 100000
    s_cbranch_scc1 L_role_p_abort
    s_waitcnt vmcnt(0)
    v_cmp_gt_u32 vcc, 32, v6
    s_nop 0
    s_cbranch_vccz Lp2_gate_d
    s_sleep 100
    s_branch Lp2_gate
Lp2_gate_d:
    s_barrier
Lp2_gate_ng:
    v_lshrrev_b32 v5, 8, v0
    v_bfe_u32 v6, v0, 6, 2
    v_xor_b32 v6, v6, v5
    v_lshlrev_b32 v6, 6, v6
    v_and_b32 v16, 0x30, v0
    v_add_u32 v16, v16, v6
    v_lshl_add_u32 v16, v5, 13, v16
    v_lshrrev_b32 v5, 2, v7
    v_xor_b32 v6, s14, v5
    v_lshlrev_b32 v17, 6, v6
    v_lshrrev_b32 v6, 1, v8
    v_lshl_add_u32 v5, v6, 3, v5
    v_lshl_add_u32 v17, v5, 8, v17
    v_and_b32 v5, 1, v8
    v_lshl_add_u32 v17, v5, 5, v17
    v_and_b32 v5, 3, v7
    v_lshl_add_u32 v17, v5, 3, v17
    v_add_u32 v18, 65536, v17
    s_lshl_b32 s46, s14, 12
    s_add_u32 m0, s46, 0
    s_add_u32 s17, s49, 0
    buffer_load_dwordx4 v16, s[20:23], s17 offen lds
    s_add_u32 m0, m0, 1024
    s_add_u32 s17, s49, 32768
    buffer_load_dwordx4 v16, s[20:23], s17 offen lds
    s_add_u32 m0, m0, 1024
    s_add_u32 s17, s49, 65536
    buffer_load_dwordx4 v16, s[20:23], s17 offen lds
    s_add_u32 m0, m0, 1024
    s_add_u32 s17, s49, 98304
    buffer_load_dwordx4 v16, s[20:23], s17 offen lds
    s_add_u32 m0, s46, 16384
    s_add_u32 s17, s49, 524288
    buffer_load_dwordx4 v16, s[20:23], s17 offen lds
    s_add_u32 m0, m0, 1024
    s_add_u32 s17, s49, 557056
    buffer_load_dwordx4 v16, s[20:23], s17 offen lds
    s_add_u32 m0, m0, 1024
    s_add_u32 s17, s49, 589824
    buffer_load_dwordx4 v16, s[20:23], s17 offen lds
    s_add_u32 m0, m0, 1024
    s_add_u32 s17, s49, 622592
    buffer_load_dwordx4 v16, s[20:23], s17 offen lds
    s_add_u32 m0, s46, 32768
    s_add_u32 s17, s49, 1048576
    buffer_load_dwordx4 v16, s[20:23], s17 offen lds
    s_add_u32 m0, m0, 1024
    s_add_u32 s17, s49, 1081344
    buffer_load_dwordx4 v16, s[20:23], s17 offen lds
    s_add_u32 m0, m0, 1024
    s_add_u32 s17, s49, 1114112
    buffer_load_dwordx4 v16, s[20:23], s17 offen lds
    s_add_u32 m0, m0, 1024
    s_add_u32 s17, s49, 1146880
    buffer_load_dwordx4 v16, s[20:23], s17 offen lds
    s_add_u32 m0, s46, 49152
    s_add_u32 s17, s49, 1572864
    buffer_load_dwordx4 v16, s[20:23], s17 offen lds
    s_add_u32 m0, m0, 1024
    s_add_u32 s17, s49, 1605632
    buffer_load_dwordx4 v16, s[20:23], s17 offen lds
    s_add_u32 m0, m0, 1024
    s_add_u32 s17, s49, 1638400
    buffer_load_dwordx4 v16, s[20:23], s17 offen lds
    s_add_u32 m0, m0, 1024
    s_add_u32 s17, s49, 1671168
    buffer_load_dwordx4 v16, s[20:23], s17 offen lds
    s_add_u32 m0, s46, 65536
    s_add_u32 s17, s49, 2097152
    buffer_load_dwordx4 v16, s[20:23], s17 offen lds
    s_add_u32 m0, m0, 1024
    s_add_u32 s17, s49, 2129920
    buffer_load_dwordx4 v16, s[20:23], s17 offen lds
    s_add_u32 m0, m0, 1024
    s_add_u32 s17, s49, 2162688
    buffer_load_dwordx4 v16, s[20:23], s17 offen lds
    s_add_u32 m0, m0, 1024
    s_add_u32 s17, s49, 2195456
    buffer_load_dwordx4 v16, s[20:23], s17 offen lds
    s_add_u32 m0, s46, 81920
    s_add_u32 s17, s49, 2621440
    buffer_load_dwordx4 v16, s[20:23], s17 offen lds
    s_add_u32 m0, m0, 1024
    s_add_u32 s17, s49, 2654208
    buffer_load_dwordx4 v16, s[20:23], s17 offen lds
    s_add_u32 m0, m0, 1024
    s_add_u32 s17, s49, 2686976
    buffer_load_dwordx4 v16, s[20:23], s17 offen lds
    s_add_u32 m0, m0, 1024
    s_add_u32 s17, s49, 2719744
    buffer_load_dwordx4 v16, s[20:23], s17 offen lds
    s_add_u32 m0, s46, 98304
    s_add_u32 s17, s49, 3145728
    buffer_load_dwordx4 v16, s[20:23], s17 offen lds
    s_add_u32 m0, m0, 1024
    s_add_u32 s17, s49, 3178496
    buffer_load_dwordx4 v16, s[20:23], s17 offen lds
    s_add_u32 m0, m0, 1024
    s_add_u32 s17, s49, 3211264
    buffer_load_dwordx4 v16, s[20:23], s17 offen lds
    s_add_u32 m0, m0, 1024
    s_add_u32 s17, s49, 3244032
    buffer_load_dwordx4 v16, s[20:23], s17 offen lds
    s_waitcnt vmcnt(24)
    s_barrier
    s_add_u32 m0, s46, 114688
    s_add_u32 s17, s49, 3670016
    buffer_load_dwordx4 v16, s[20:23], s17 offen lds
    s_add_u32 m0, m0, 1024
    s_add_u32 s17, s49, 3702784
    buffer_load_dwordx4 v16, s[20:23], s17 offen lds
    s_add_u32 m0, m0, 1024
    s_add_u32 s17, s49, 3735552
    buffer_load_dwordx4 v16, s[20:23], s17 offen lds
    s_add_u32 m0, m0, 1024
    s_add_u32 s17, s49, 3768320
    buffer_load_dwordx4 v16, s[20:23], s17 offen lds
    ds_read_b64_tr_b16 a[0:1], v17 offset:0
    ds_read_b64_tr_b16 a[2:3], v17 offset:1024
    ds_read_b64_tr_b16 a[4:5], v17 offset:4096
    ds_read_b64_tr_b16 a[6:7], v17 offset:5120
    ds_read_b64_tr_b16 a[8:9], v17 offset:8192
    ds_read_b64_tr_b16 a[10:11], v17 offset:9216
    ds_read_b64_tr_b16 a[12:13], v17 offset:12288
    ds_read_b64_tr_b16 a[14:15], v17 offset:13312
    s_waitcnt lgkmcnt(0)
    s_waitcnt vmcnt(24)
    s_barrier
    s_add_u32 m0, s46, 0
    s_add_u32 s17, s49, 4194304
    buffer_load_dwordx4 v16, s[20:23], s17 offen lds
    s_add_u32 m0, m0, 1024
    s_add_u32 s17, s49, 4227072
    buffer_load_dwordx4 v16, s[20:23], s17 offen lds
    s_add_u32 m0, m0, 1024
    s_add_u32 s17, s49, 4259840
    buffer_load_dwordx4 v16, s[20:23], s17 offen lds
    s_add_u32 m0, m0, 1024
    s_add_u32 s17, s49, 4292608
    buffer_load_dwordx4 v16, s[20:23], s17 offen lds
    ds_read_b64_tr_b16 a[16:17], v17 offset:16384
    ds_read_b64_tr_b16 a[18:19], v17 offset:17408
    ds_read_b64_tr_b16 a[20:21], v17 offset:20480
    ds_read_b64_tr_b16 a[22:23], v17 offset:21504
    ds_read_b64_tr_b16 a[24:25], v17 offset:24576
    ds_read_b64_tr_b16 a[26:27], v17 offset:25600
    ds_read_b64_tr_b16 a[28:29], v17 offset:28672
    ds_read_b64_tr_b16 a[30:31], v17 offset:29696
    s_waitcnt lgkmcnt(0)
    s_waitcnt vmcnt(24)
    s_barrier
    s_add_u32 m0, s46, 16384
    s_add_u32 s17, s52, 0
    buffer_load_dwordx4 v16, s[24:27], s17 offen lds
    s_add_u32 m0, m0, 1024
    s_add_u32 s17, s52, 32768
    buffer_load_dwordx4 v16, s[24:27], s17 offen lds
    s_add_u32 m0, m0, 1024
    s_add_u32 s17, s52, 65536
    buffer_load_dwordx4 v16, s[24:27], s17 offen lds
    s_add_u32 m0, m0, 1024
    s_add_u32 s17, s52, 98304
    buffer_load_dwordx4 v16, s[24:27], s17 offen lds
    ds_read_b64_tr_b16 a[32:33], v17 offset:32768
    ds_read_b64_tr_b16 a[34:35], v17 offset:33792
    ds_read_b64_tr_b16 a[36:37], v17 offset:36864
    ds_read_b64_tr_b16 a[38:39], v17 offset:37888
    ds_read_b64_tr_b16 a[40:41], v17 offset:40960
    ds_read_b64_tr_b16 a[42:43], v17 offset:41984
    ds_read_b64_tr_b16 a[44:45], v17 offset:45056
    ds_read_b64_tr_b16 a[46:47], v17 offset:46080
    s_waitcnt lgkmcnt(0)
    s_waitcnt vmcnt(24)
    s_barrier
    s_add_u32 m0, s46, 32768
    s_add_u32 s17, s52, 524288
    buffer_load_dwordx4 v16, s[24:27], s17 offen lds
    s_add_u32 m0, m0, 1024
    s_add_u32 s17, s52, 557056
    buffer_load_dwordx4 v16, s[24:27], s17 offen lds
    s_add_u32 m0, m0, 1024
    s_add_u32 s17, s52, 589824
    buffer_load_dwordx4 v16, s[24:27], s17 offen lds
    s_add_u32 m0, m0, 1024
    s_add_u32 s17, s52, 622592
    buffer_load_dwordx4 v16, s[24:27], s17 offen lds
    ds_read_b64_tr_b16 a[48:49], v17 offset:49152
    ds_read_b64_tr_b16 a[50:51], v17 offset:50176
    ds_read_b64_tr_b16 a[52:53], v17 offset:53248
    ds_read_b64_tr_b16 a[54:55], v17 offset:54272
    ds_read_b64_tr_b16 a[56:57], v17 offset:57344
    ds_read_b64_tr_b16 a[58:59], v17 offset:58368
    ds_read_b64_tr_b16 a[60:61], v17 offset:61440
    ds_read_b64_tr_b16 a[62:63], v17 offset:62464
    s_waitcnt lgkmcnt(0)
    s_waitcnt vmcnt(24)
    s_barrier
    s_add_u32 m0, s46, 49152
    s_add_u32 s17, s52, 1048576
    buffer_load_dwordx4 v16, s[24:27], s17 offen lds
    s_add_u32 m0, m0, 1024
    s_add_u32 s17, s52, 1081344
    buffer_load_dwordx4 v16, s[24:27], s17 offen lds
    s_add_u32 m0, m0, 1024
    s_add_u32 s17, s52, 1114112
    buffer_load_dwordx4 v16, s[24:27], s17 offen lds
    s_add_u32 m0, m0, 1024
    s_add_u32 s17, s52, 1146880
    buffer_load_dwordx4 v16, s[24:27], s17 offen lds
    ds_read_b64_tr_b16 a[64:65], v18 offset:0
    ds_read_b64_tr_b16 a[66:67], v18 offset:1024
    ds_read_b64_tr_b16 a[68:69], v18 offset:4096
    ds_read_b64_tr_b16 a[70:71], v18 offset:5120
    ds_read_b64_tr_b16 a[72:73], v18 offset:8192
    ds_read_b64_tr_b16 a[74:75], v18 offset:9216
    ds_read_b64_tr_b16 a[76:77], v18 offset:12288
    ds_read_b64_tr_b16 a[78:79], v18 offset:13312
    s_waitcnt lgkmcnt(0)
    s_waitcnt vmcnt(24)
    s_barrier
    s_add_u32 m0, s46, 65536
    s_add_u32 s17, s52, 1572864
    buffer_load_dwordx4 v16, s[24:27], s17 offen lds
    s_add_u32 m0, m0, 1024
    s_add_u32 s17, s52, 1605632
    buffer_load_dwordx4 v16, s[24:27], s17 offen lds
    s_add_u32 m0, m0, 1024
    s_add_u32 s17, s52, 1638400
    buffer_load_dwordx4 v16, s[24:27], s17 offen lds
    s_add_u32 m0, m0, 1024
    s_add_u32 s17, s52, 1671168
    buffer_load_dwordx4 v16, s[24:27], s17 offen lds
    ds_read_b64_tr_b16 a[80:81], v18 offset:16384
    ds_read_b64_tr_b16 a[82:83], v18 offset:17408
    ds_read_b64_tr_b16 a[84:85], v18 offset:20480
    ds_read_b64_tr_b16 a[86:87], v18 offset:21504
    ds_read_b64_tr_b16 a[88:89], v18 offset:24576
    ds_read_b64_tr_b16 a[90:91], v18 offset:25600
    ds_read_b64_tr_b16 a[92:93], v18 offset:28672
    ds_read_b64_tr_b16 a[94:95], v18 offset:29696
    s_waitcnt lgkmcnt(0)
    s_waitcnt vmcnt(24)
    s_barrier
    s_add_u32 m0, s46, 81920
    s_add_u32 s17, s52, 2097152
    buffer_load_dwordx4 v16, s[24:27], s17 offen lds
    s_add_u32 m0, m0, 1024
    s_add_u32 s17, s52, 2129920
    buffer_load_dwordx4 v16, s[24:27], s17 offen lds
    s_add_u32 m0, m0, 1024
    s_add_u32 s17, s52, 2162688
    buffer_load_dwordx4 v16, s[24:27], s17 offen lds
    s_add_u32 m0, m0, 1024
    s_add_u32 s17, s52, 2195456
    buffer_load_dwordx4 v16, s[24:27], s17 offen lds
    ds_read_b64_tr_b16 a[96:97], v18 offset:32768
    ds_read_b64_tr_b16 a[98:99], v18 offset:33792
    ds_read_b64_tr_b16 a[100:101], v18 offset:36864
    ds_read_b64_tr_b16 a[102:103], v18 offset:37888
    ds_read_b64_tr_b16 a[104:105], v18 offset:40960
    ds_read_b64_tr_b16 a[106:107], v18 offset:41984
    ds_read_b64_tr_b16 a[108:109], v18 offset:45056
    ds_read_b64_tr_b16 a[110:111], v18 offset:46080
    s_waitcnt lgkmcnt(0)
    s_waitcnt vmcnt(24)
    s_barrier
    s_add_u32 m0, s46, 98304
    s_add_u32 s17, s52, 2621440
    buffer_load_dwordx4 v16, s[24:27], s17 offen lds
    s_add_u32 m0, m0, 1024
    s_add_u32 s17, s52, 2654208
    buffer_load_dwordx4 v16, s[24:27], s17 offen lds
    s_add_u32 m0, m0, 1024
    s_add_u32 s17, s52, 2686976
    buffer_load_dwordx4 v16, s[24:27], s17 offen lds
    s_add_u32 m0, m0, 1024
    s_add_u32 s17, s52, 2719744
    buffer_load_dwordx4 v16, s[24:27], s17 offen lds
    ds_read_b64_tr_b16 a[112:113], v18 offset:49152
    ds_read_b64_tr_b16 a[114:115], v18 offset:50176
    ds_read_b64_tr_b16 a[116:117], v18 offset:53248
    ds_read_b64_tr_b16 a[118:119], v18 offset:54272
    ds_read_b64_tr_b16 a[120:121], v18 offset:57344
    ds_read_b64_tr_b16 a[122:123], v18 offset:58368
    ds_read_b64_tr_b16 a[124:125], v18 offset:61440
    ds_read_b64_tr_b16 a[126:127], v18 offset:62464
    s_waitcnt lgkmcnt(0)
    s_waitcnt vmcnt(24)
    s_barrier
    s_add_u32 m0, s46, 114688
    s_add_u32 s17, s52, 3145728
    buffer_load_dwordx4 v16, s[24:27], s17 offen lds
    s_add_u32 m0, m0, 1024
    s_add_u32 s17, s52, 3178496
    buffer_load_dwordx4 v16, s[24:27], s17 offen lds
    s_add_u32 m0, m0, 1024
    s_add_u32 s17, s52, 3211264
    buffer_load_dwordx4 v16, s[24:27], s17 offen lds
    s_add_u32 m0, m0, 1024
    s_add_u32 s17, s52, 3244032
    buffer_load_dwordx4 v16, s[24:27], s17 offen lds
    ds_read_b64_tr_b16 a[128:129], v17 offset:0
    ds_read_b64_tr_b16 a[130:131], v17 offset:1024
    ds_read_b64_tr_b16 a[132:133], v17 offset:4096
    ds_read_b64_tr_b16 a[134:135], v17 offset:5120
    ds_read_b64_tr_b16 a[136:137], v17 offset:8192
    ds_read_b64_tr_b16 a[138:139], v17 offset:9216
    ds_read_b64_tr_b16 a[140:141], v17 offset:12288
    ds_read_b64_tr_b16 a[142:143], v17 offset:13312
    s_waitcnt lgkmcnt(0)
    s_waitcnt vmcnt(24)
    s_barrier
    s_add_u32 m0, s46, 0
    s_add_u32 s17, s52, 3670016
    buffer_load_dwordx4 v16, s[24:27], s17 offen lds
    s_add_u32 m0, m0, 1024
    s_add_u32 s17, s52, 3702784
    buffer_load_dwordx4 v16, s[24:27], s17 offen lds
    s_add_u32 m0, m0, 1024
    s_add_u32 s17, s52, 3735552
    buffer_load_dwordx4 v16, s[24:27], s17 offen lds
    s_add_u32 m0, m0, 1024
    s_add_u32 s17, s52, 3768320
    buffer_load_dwordx4 v16, s[24:27], s17 offen lds
    ds_read_b64_tr_b16 a[144:145], v17 offset:16384
    ds_read_b64_tr_b16 a[146:147], v17 offset:17408
    ds_read_b64_tr_b16 a[148:149], v17 offset:20480
    ds_read_b64_tr_b16 a[150:151], v17 offset:21504
    ds_read_b64_tr_b16 a[152:153], v17 offset:24576
    ds_read_b64_tr_b16 a[154:155], v17 offset:25600
    ds_read_b64_tr_b16 a[156:157], v17 offset:28672
    ds_read_b64_tr_b16 a[158:159], v17 offset:29696
    s_waitcnt lgkmcnt(0)
    s_waitcnt vmcnt(24)
    s_barrier
    s_add_u32 m0, s46, 16384
    s_add_u32 s17, s52, 4194304
    buffer_load_dwordx4 v16, s[24:27], s17 offen lds
    s_add_u32 m0, m0, 1024
    s_add_u32 s17, s52, 4227072
    buffer_load_dwordx4 v16, s[24:27], s17 offen lds
    s_add_u32 m0, m0, 1024
    s_add_u32 s17, s52, 4259840
    buffer_load_dwordx4 v16, s[24:27], s17 offen lds
    s_add_u32 m0, m0, 1024
    s_add_u32 s17, s52, 4292608
    buffer_load_dwordx4 v16, s[24:27], s17 offen lds
    ds_read_b64_tr_b16 a[160:161], v17 offset:32768
    ds_read_b64_tr_b16 a[162:163], v17 offset:33792
    ds_read_b64_tr_b16 a[164:165], v17 offset:36864
    ds_read_b64_tr_b16 a[166:167], v17 offset:37888
    ds_read_b64_tr_b16 a[168:169], v17 offset:40960
    ds_read_b64_tr_b16 a[170:171], v17 offset:41984
    ds_read_b64_tr_b16 a[172:173], v17 offset:45056
    ds_read_b64_tr_b16 a[174:175], v17 offset:46080
    s_waitcnt lgkmcnt(0)
    s_waitcnt vmcnt(24)
    s_barrier
    ds_read_b64_tr_b16 a[176:177], v17 offset:49152
    ds_read_b64_tr_b16 a[178:179], v17 offset:50176
    ds_read_b64_tr_b16 a[180:181], v17 offset:53248
    ds_read_b64_tr_b16 a[182:183], v17 offset:54272
    ds_read_b64_tr_b16 a[184:185], v17 offset:57344
    ds_read_b64_tr_b16 a[186:187], v17 offset:58368
    ds_read_b64_tr_b16 a[188:189], v17 offset:61440
    ds_read_b64_tr_b16 a[190:191], v17 offset:62464
    s_waitcnt lgkmcnt(0)
    s_waitcnt vmcnt(20)
    s_barrier
    ds_read_b64_tr_b16 a[192:193], v18 offset:0
    ds_read_b64_tr_b16 a[194:195], v18 offset:1024
    ds_read_b64_tr_b16 a[196:197], v18 offset:4096
    ds_read_b64_tr_b16 a[198:199], v18 offset:5120
    ds_read_b64_tr_b16 a[200:201], v18 offset:8192
    ds_read_b64_tr_b16 a[202:203], v18 offset:9216
    ds_read_b64_tr_b16 a[204:205], v18 offset:12288
    ds_read_b64_tr_b16 a[206:207], v18 offset:13312
    s_waitcnt lgkmcnt(0)
    s_waitcnt vmcnt(16)
    s_barrier
    ds_read_b64_tr_b16 a[208:209], v18 offset:16384
    ds_read_b64_tr_b16 a[210:211], v18 offset:17408
    ds_read_b64_tr_b16 a[212:213], v18 offset:20480
    ds_read_b64_tr_b16 a[214:215], v18 offset:21504
    ds_read_b64_tr_b16 a[216:217], v18 offset:24576
    ds_read_b64_tr_b16 a[218:219], v18 offset:25600
    ds_read_b64_tr_b16 a[220:221], v18 offset:28672
    ds_read_b64_tr_b16 a[222:223], v18 offset:29696
    s_waitcnt lgkmcnt(0)
    s_waitcnt vmcnt(12)
    s_barrier
    ds_read_b64_tr_b16 a[224:225], v18 offset:32768
    ds_read_b64_tr_b16 a[226:227], v18 offset:33792
    ds_read_b64_tr_b16 a[228:229], v18 offset:36864
    ds_read_b64_tr_b16 a[230:231], v18 offset:37888
    ds_read_b64_tr_b16 a[232:233], v18 offset:40960
    ds_read_b64_tr_b16 a[234:235], v18 offset:41984
    ds_read_b64_tr_b16 a[236:237], v18 offset:45056
    ds_read_b64_tr_b16 a[238:239], v18 offset:46080
    s_waitcnt lgkmcnt(0)
    s_waitcnt vmcnt(8)
    s_barrier
    ds_read_b64_tr_b16 a[240:241], v18 offset:49152
    ds_read_b64_tr_b16 a[242:243], v18 offset:50176
    ds_read_b64_tr_b16 a[244:245], v18 offset:53248
    ds_read_b64_tr_b16 a[246:247], v18 offset:54272
    ds_read_b64_tr_b16 a[248:249], v18 offset:57344
    ds_read_b64_tr_b16 a[250:251], v18 offset:58368
    ds_read_b64_tr_b16 a[252:253], v18 offset:61440
    ds_read_b64_tr_b16 a[254:255], v18 offset:62464
    s_waitcnt lgkmcnt(0)
    s_waitcnt vmcnt(4)
    s_barrier
    ds_read_b64_tr_b16 v[152:153], v17 offset:0
    ds_read_b64_tr_b16 v[154:155], v17 offset:1024
    ds_read_b64_tr_b16 v[156:157], v17 offset:4096
    ds_read_b64_tr_b16 v[158:159], v17 offset:5120
    ds_read_b64_tr_b16 v[160:161], v17 offset:8192
    ds_read_b64_tr_b16 v[162:163], v17 offset:9216
    ds_read_b64_tr_b16 v[164:165], v17 offset:12288
    ds_read_b64_tr_b16 v[166:167], v17 offset:13312
    s_waitcnt lgkmcnt(0)
    s_waitcnt vmcnt(0)
    s_barrier
    ds_read_b64_tr_b16 v[168:169], v17 offset:16384
    ds_read_b64_tr_b16 v[170:171], v17 offset:17408
    ds_read_b64_tr_b16 v[172:173], v17 offset:20480
    ds_read_b64_tr_b16 v[174:175], v17 offset:21504
    ds_read_b64_tr_b16 v[176:177], v17 offset:24576
    ds_read_b64_tr_b16 v[178:179], v17 offset:25600
    ds_read_b64_tr_b16 v[180:181], v17 offset:28672
    ds_read_b64_tr_b16 v[182:183], v17 offset:29696
    s_waitcnt lgkmcnt(0)
    s_barrier
    v_bfe_u32 v10, v0, 4, 5
    v_lshrrev_b32 v5, 9, v0
    v_lshlrev_b32 v10, 4, v10
    v_mul_u32_u24 v6, 2560, v5
    v_add_u32 v10, v10, v6
    v_add_u32 v10, 114688, v10
    s_lshl_b32 s67, s14, 10
    v_bfe_u32 v6, v0, 8, 1
    v_lshlrev_b32 v14, 10, v6
    v_lshl_add_u32 v14, v7, 4, v14
    v_lshl_add_u32 v14, v5, 8, v14
    s_lshl_b32 s17, s51, 13
    s_lshl_b32 s18, s14, 11
    s_add_u32 s52, s17, s18
    s_add_u32 s52, s52, 44040192
    s_lshl_b32 s49, s51, 9
    s_lshl_b32 s17, s14, 2
    s_add_u32 s49, s49, s17
    s_add_u32 s49, s49, 5376
    s_cmp_eq_u32 s50, 1
    s_cselect_b32 s17, 16777216, 0
    s_cselect_b32 s18, 128, 0
    s_add_u32 s52, s52, s17
    s_add_u32 s49, s49, s18
    s_cmp_eq_u32 s50, 1
    s_cselect_b32 s17, 0, 384
    s_add_u32 s17, s17, 128
    v_lshrrev_b32 v185, 4, v0
    v_mul_lo_u32 v185, v185, s17
    v_mov_b32 v48, 0x3f803f80
    v_mov_b32 v49, 0x3f803f80
    v_mov_b32 v50, 0x3f803f80
    v_mov_b32 v51, 0x3f803f80
    s_lshl_b32 s17, s14, 8
    s_add_u32 s17, s17, 110592
    v_bfe_u32 v5, v0, 4, 5
    v_lshl_add_u32 v12, v5, 2, s17
    v_lshrrev_b32 v5, 9, v0
    v_lshl_add_u32 v13, v5, 4, s17
    s_cmp_eq_u32 s50, 1
    s_cbranch_scc1 Lp2_kv
    v_mfma_f32_32x32x16_bf16 v[84:99], a[0:3], v[48:51], 0
    v_mfma_f32_32x32x16_bf16 v[116:131], a[144:147], v[48:51], 0
    v_mfma_f32_32x32x16_bf16 v[84:99], a[4:7], v[48:51], v[84:99]
    v_mfma_f32_32x32x16_bf16 v[116:131], a[148:151], v[48:51], v[116:131]
    v_mfma_f32_32x32x16_bf16 v[84:99], a[8:11], v[48:51], v[84:99]
    v_mfma_f32_32x32x16_bf16 v[116:131], a[152:155], v[48:51], v[116:131]
    v_mfma_f32_32x32x16_bf16 v[84:99], a[12:15], v[48:51], v[84:99]
    v_mfma_f32_32x32x16_bf16 v[116:131], a[156:159], v[48:51], v[116:131]
    v_mfma_f32_32x32x16_bf16 v[84:99], a[16:19], v[48:51], v[84:99]
    v_mfma_f32_32x32x16_bf16 v[116:131], a[160:163], v[48:51], v[116:131]
    v_mfma_f32_32x32x16_bf16 v[84:99], a[20:23], v[48:51], v[84:99]
    v_mfma_f32_32x32x16_bf16 v[116:131], a[164:167], v[48:51], v[116:131]
    v_mfma_f32_32x32x16_bf16 v[84:99], a[24:27], v[48:51], v[84:99]
    v_mfma_f32_32x32x16_bf16 v[116:131], a[168:171], v[48:51], v[116:131]
    v_mfma_f32_32x32x16_bf16 v[84:99], a[28:31], v[48:51], v[84:99]
    v_mfma_f32_32x32x16_bf16 v[116:131], a[172:175], v[48:51], v[116:131]
    v_mfma_f32_32x32x16_bf16 v[84:99], a[32:35], v[48:51], v[84:99]
    v_mfma_f32_32x32x16_bf16 v[116:131], a[176:179], v[48:51], v[116:131]
    v_mfma_f32_32x32x16_bf16 v[84:99], a[36:39], v[48:51], v[84:99]
    v_mfma_f32_32x32x16_bf16 v[116:131], a[180:183], v[48:51], v[116:131]
    v_mfma_f32_32x32x16_bf16 v[84:99], a[40:43], v[48:51], v[84:99]
    v_mfma_f32_32x32x16_bf16 v[116:131], a[184:187], v[48:51], v[116:131]
    v_mfma_f32_32x32x16_bf16 v[84:99], a[44:47], v[48:51], v[84:99]
    v_mfma_f32_32x32x16_bf16 v[116:131], a[188:191], v[48:51], v[116:131]
    v_mfma_f32_32x32x16_bf16 v[84:99], a[48:51], v[48:51], v[84:99]
    v_mfma_f32_32x32x16_bf16 v[116:131], a[192:195], v[48:51], v[116:131]
    v_mfma_f32_32x32x16_bf16 v[84:99], a[52:55], v[48:51], v[84:99]
    v_mfma_f32_32x32x16_bf16 v[116:131], a[196:199], v[48:51], v[116:131]
    v_mfma_f32_32x32x16_bf16 v[84:99], a[56:59], v[48:51], v[84:99]
    v_mfma_f32_32x32x16_bf16 v[116:131], a[200:203], v[48:51], v[116:131]
    v_mfma_f32_32x32x16_bf16 v[84:99], a[60:63], v[48:51], v[84:99]
    v_mfma_f32_32x32x16_bf16 v[116:131], a[204:207], v[48:51], v[116:131]
    v_mfma_f32_32x32x16_bf16 v[84:99], a[64:67], v[48:51], v[84:99]
    v_mfma_f32_32x32x16_bf16 v[116:131], a[208:211], v[48:51], v[116:131]
    v_mfma_f32_32x32x16_bf16 v[84:99], a[68:71], v[48:51], v[84:99]
    v_mfma_f32_32x32x16_bf16 v[116:131], a[212:215], v[48:51], v[116:131]
    v_mfma_f32_32x32x16_bf16 v[84:99], a[72:75], v[48:51], v[84:99]
    v_mfma_f32_32x32x16_bf16 v[116:131], a[216:219], v[48:51], v[116:131]
    v_mfma_f32_32x32x16_bf16 v[84:99], a[76:79], v[48:51], v[84:99]
    v_mfma_f32_32x32x16_bf16 v[116:131], a[220:223], v[48:51], v[116:131]
    v_mfma_f32_32x32x16_bf16 v[84:99], a[80:83], v[48:51], v[84:99]
    v_mfma_f32_32x32x16_bf16 v[116:131], a[224:227], v[48:51], v[116:131]
    v_mfma_f32_32x32x16_bf16 v[84:99], a[84:87], v[48:51], v[84:99]
    v_mfma_f32_32x32x16_bf16 v[116:131], a[228:231], v[48:51], v[116:131]
    v_mfma_f32_32x32x16_bf16 v[84:99], a[88:91], v[48:51], v[84:99]
    v_mfma_f32_32x32x16_bf16 v[116:131], a[232:235], v[48:51], v[116:131]
    v_mfma_f32_32x32x16_bf16 v[84:99], a[92:95], v[48:51], v[84:99]
    v_mfma_f32_32x32x16_bf16 v[116:131], a[236:239], v[48:51], v[116:131]
    v_mfma_f32_32x32x16_bf16 v[84:99], a[96:99], v[48:51], v[84:99]
    v_mfma_f32_32x32x16_bf16 v[116:131], a[240:243], v[48:51], v[116:131]
    v_mfma_f32_32x32x16_bf16 v[84:99], a[100:103], v[48:51], v[84:99]
    v_mfma_f32_32x32x16_bf16 v[116:131], a[244:247], v[48:51], v[116:131]
    v_mfma_f32_32x32x16_bf16 v[84:99], a[104:107], v[48:51], v[84:99]
    v_mfma_f32_32x32x16_bf16 v[116:131], a[248:251], v[48:51], v[116:131]
    v_mfma_f32_32x32x16_bf16 v[84:99], a[108:111], v[48:51], v[84:99]
    v_mfma_f32_32x32x16_bf16 v[116:131], a[252:255], v[48:51], v[116:131]
    v_mfma_f32_32x32x16_bf16 v[84:99], a[112:115], v[48:51], v[84:99]
    v_mfma_f32_32x32x16_bf16 v[116:131], v[152:155], v[48:51], v[116:131]
    v_mfma_f32_32x32x16_bf16 v[84:99], a[116:119], v[48:51], v[84:99]
    v_mfma_f32_32x32x16_bf16 v[116:131], v[156:159], v[48:51], v[116:131]
    v_mfma_f32_32x32x16_bf16 v[84:99], a[120:123], v[48:51], v[84:99]
    v_mfma_f32_32x32x16_bf16 v[116:131], v[160:163], v[48:51], v[116:131]
    v_mfma_f32_32x32x16_bf16 v[84:99], a[124:127], v[48:51], v[84:99]
    v_mfma_f32_32x32x16_bf16 v[116:131], v[164:167], v[48:51], v[116:131]
    v_mfma_f32_32x32x16_bf16 v[84:99], a[128:131], v[48:51], v[84:99]
    v_mfma_f32_32x32x16_bf16 v[116:131], v[168:171], v[48:51], v[116:131]
    v_mfma_f32_32x32x16_bf16 v[84:99], a[132:135], v[48:51], v[84:99]
    v_mfma_f32_32x32x16_bf16 v[116:131], v[172:175], v[48:51], v[116:131]
    v_mfma_f32_32x32x16_bf16 v[84:99], a[136:139], v[48:51], v[84:99]
    v_mfma_f32_32x32x16_bf16 v[116:131], v[176:179], v[48:51], v[116:131]
    v_mfma_f32_32x32x16_bf16 v[84:99], a[140:143], v[48:51], v[84:99]
    v_mfma_f32_32x32x16_bf16 v[116:131], v[180:183], v[48:51], v[116:131]
    s_mov_b32 s66, 114688
    s_mov_b32 s71, 0x2000
    s_mov_b32 s36, s63
    s_mov_b32 s34, s63
    s_mul_i32 s58, s14, 9216
    s_mul_i32 s64, s63, 4718592
    s_add_u32 s64, s64, s58
    s_add_u32 s64, s64, 8650752
    s_mul_i32 s61, s63, 1441792
    s_add_u32 s61, s61, 3584
    s_mov_b32 s37, 0
    s_mov_b32 s40, 36864
    s_mov_b32 s59, s58
    s_mov_b32 s43, 0
    s_mov_b32 s62, 1
    s_mov_b32 s28, s8
    s_mov_b32 s29, s9
    s_mov_b32 s30, 0
    s_mov_b32 s31, 0x00020000
    v_mov_b32 v184, 74752
    v_mov_b32 v5, -1
    ds_write_b32 v184, v5
    s_waitcnt lgkmcnt(0)
    s_cmp_lg_u32 s14, 0
    s_cbranch_scc1 LpQQ_inia_d
    v_mov_b32 v5, 40
    s_mov_b32 s16, 0
LpQQ_inia:
    global_load_dword v6, v5, s[12:13] sc1
    s_add_u32 s16, s16, 1
    s_cmp_gt_u32 s16, 100000
    s_cbranch_scc1 L_role_p_abort
    s_waitcnt vmcnt(0)
    v_cmp_gt_u32 vcc, 72, v6
    s_nop 0
    s_cbranch_vccz LpQQ_inia_d
    s_sleep 8
    s_branch LpQQ_inia
LpQQ_inia_d:
    s_barrier
    s_cmp_eq_u32 s63, 0
    s_cbranch_scc1 LpQQ_ini_sk
    s_cmp_lg_u32 s14, 0
    s_cbranch_scc1 LpQQ_inib_d
    v_mov_b32 v5, 160
    s_mov_b32 s16, 0
LpQQ_inib:
    global_load_dword v6, v5, s[12:13] sc1
    s_add_u32 s16, s16, 1
    s_cmp_gt_u32 s16, 100000
    s_cbranch_scc1 L_role_p_abort
    s_waitcnt vmcnt(0)
    v_cmp_gt_u32 vcc, 64, v6
    s_nop 0
    s_cbranch_vccz LpQQ_inib_d
    s_sleep 8
    s_branch LpQQ_inib
LpQQ_inib_d:
    s_barrier
LpQQ_ini_sk:
    s_mul_i32 s41, s37, 36864
    s_add_u32 s41, s41, s64
    s_mul_i32 s60, s37, 22528
    s_add_u32 s60, s60, s61
    s_cmp_lt_u32 s37, 64
    s_cselect_b32 s60, s60, 2883584
    s_branch LpQQ_wait
LpQQ_head:
    s_waitcnt vmcnt(4)
LpQQ_head2:
    s_barrier
    ds_read_b32 v15, v184
    s_xor_b32 s40, s40, 36864
    s_xor_b32 s59, s59, 36864
    s_mov_b32 s35, s37
    s_lshl_b32 s57, s34, 6
    s_add_u32 s57, s57, s35
    s_add_u32 s37, s37, 1
    s_mov_b32 s39, 0
    s_mov_b32 s54, 0
    s_xor_b32 s66, s66, 8192
    s_xor_b32 s71, s71, 8192
    s_mul_i32 s41, s37, 36864
    s_add_u32 s41, s41, s64
    s_mul_i32 s60, s37, 22528
    s_add_u32 s60, s60, s61
    s_cmp_lt_u32 s37, 64
    s_cselect_b32 s60, s60, 2883584
    v_add_u32 v9, s40, v0
    v_add_u32 v5, s71, v10
    ds_read_b128 v[48:51], v9 offset:0
    ds_read_b128 v[52:55], v9 offset:1024
    ds_read_b128 v[56:59], v9 offset:2048
    ds_read_b128 v[64:67], v5 offset:0
    ds_read_b128 v[68:71], v5 offset:512
    ds_read_b128 v[72:75], v5 offset:1024
    ds_read_b128 v[76:79], v5 offset:1536
    ds_read_b128 v[80:83], v5 offset:2048
    s_waitcnt lgkmcnt(7)
    v_mfma_f32_32x32x16_bf16 v[16:31], a[0:3], v[48:51], 0
    ds_read_b128 v[60:63], v9 offset:3072
    v_mfma_f32_32x32x16_bf16 v[32:47], a[144:147], v[48:51], 0
    s_waitcnt lgkmcnt(4)
    v_add_f32 v64, v64, v68
    v_add_f32 v65, v65, v69
    v_add_f32 v66, v66, v70
    v_add_f32 v67, v67, v71
    v_mfma_f32_32x32x16_bf16 v[16:31], a[4:7], v[52:55], v[16:31]
    ds_read_b128 v[48:51], v9 offset:4096
    s_waitcnt lgkmcnt(4)
    v_add_f32 v64, v64, v72
    v_add_f32 v65, v65, v73
    v_add_f32 v66, v66, v74
    v_mfma_f32_32x32x16_bf16 v[32:47], a[148:151], v[52:55], v[32:47]
    v_add_f32 v67, v67, v75
    s_waitcnt lgkmcnt(3)
    v_add_f32 v64, v64, v76
    v_add_f32 v65, v65, v77
    v_add_f32 v66, v66, v78
    v_readfirstlane_b32 s17, v15
    s_nop 0
    s_add_u32 s18, s17, 1
    s_max_i32 s32, s18, s37
    s_add_u32 s39, s37, 1
    s_min_u32 s39, s39, 63
    s_mul_i32 s33, s32, 22528
    s_add_u32 s33, s33, s61
    s_cmp_eq_u32 s14, 0
    s_cselect_b32 s18, s32, 0x7fff
    v_mov_b32 v2, 2
    s_cmp_le_u32 s18, s39
    s_cselect_b64 exec, -1, 0
    buffer_load_dword v2, v1, s[8:11], s33 offen sc1
    s_mov_b64 exec, -1
    s_cmp_ge_i32 s17, s37
    s_cbranch_scc1 LpQQ_f_1
    v_mfma_f32_32x32x16_bf16 v[16:31], a[8:11], v[56:59], v[16:31]
    ds_read_b128 v[52:55], v9 offset:5120
    v_add_f32 v67, v67, v79
    s_waitcnt lgkmcnt(3)
    v_add_f32 v64, v64, v80
    v_add_f32 v65, v65, v81
    v_mfma_f32_32x32x16_bf16 v[32:47], a[152:155], v[56:59], v[32:47]
    v_add_f32 v66, v66, v82
    v_add_f32 v67, v67, v83
    v_add_f32 v64, v64, v66
    v_add_f32 v65, v65, v67
    s_waitcnt lgkmcnt(2)
    v_mfma_f32_32x32x16_bf16 v[16:31], a[12:15], v[60:63], v[16:31]
    ds_read_b128 v[56:59], v9 offset:6144
    v_mov_b32 v66, v64
    v_mov_b32 v67, v65
    s_nop 0
    v_permlane32_swap_b32 v64, v66
    v_mfma_f32_32x32x16_bf16 v[32:47], a[156:159], v[60:63], v[32:47]
    v_permlane32_swap_b32 v65, v67
    v_add_f32 v64, v64, v66
    v_add_f32 v65, v65, v67
    v_mul_f32 v64, 0x3ae38e39, v64
    s_waitcnt lgkmcnt(2)
    v_mfma_f32_32x32x16_bf16 v[16:31], a[16:19], v[48:51], v[16:31]
    ds_read_b128 v[60:63], v9 offset:7168
    v_mul_f32 v65, 0x3ae38e39, v65
    v_fma_f32 v65, -v64, v64, v65
    v_max_f32 v65, 0, v65
    v_mfma_f32_32x32x16_bf16 v[32:47], a[160:163], v[48:51], v[32:47]
    v_add_f32 v65, 0x3727c5ac, v65
    v_rsq_f32 v148, v65
    s_nop 0
    v_mul_f32 v149, v64, v148
    v_mul_f32 v100, v149, v84
    s_waitcnt lgkmcnt(2)
    v_mfma_f32_32x32x16_bf16 v[16:31], a[20:23], v[52:55], v[16:31]
    ds_read_b128 v[48:51], v9 offset:8192
    v_mul_f32 v101, v149, v85
    v_mul_f32 v102, v149, v86
    v_mul_f32 v103, v149, v87
    v_mfma_f32_32x32x16_bf16 v[32:47], a[164:167], v[52:55], v[32:47]
    v_mul_f32 v104, v149, v88
    v_mul_f32 v105, v149, v89
    v_mul_f32 v106, v149, v90
    v_mul_f32 v107, v149, v91
    s_waitcnt lgkmcnt(2)
    v_mfma_f32_32x32x16_bf16 v[16:31], a[24:27], v[56:59], v[16:31]
    ds_read_b128 v[52:55], v9 offset:9216
    v_mul_f32 v108, v149, v92
    v_mul_f32 v109, v149, v93
    v_mul_f32 v110, v149, v94
    v_mfma_f32_32x32x16_bf16 v[32:47], a[168:171], v[56:59], v[32:47]
    v_mul_f32 v111, v149, v95
    v_mul_f32 v112, v149, v96
    v_mul_f32 v113, v149, v97
    v_mul_f32 v114, v149, v98
    s_waitcnt lgkmcnt(2)
    v_mfma_f32_32x32x16_bf16 v[16:31], a[28:31], v[60:63], v[16:31]
    ds_read_b128 v[56:59], v9 offset:10240
    v_mul_f32 v115, v149, v99
    v_mul_f32 v132, v149, v116
    v_mul_f32 v133, v149, v117
    v_mfma_f32_32x32x16_bf16 v[32:47], a[172:175], v[60:63], v[32:47]
    v_mul_f32 v134, v149, v118
    v_mul_f32 v135, v149, v119
    v_mul_f32 v136, v149, v120
    v_mul_f32 v137, v149, v121
    s_waitcnt lgkmcnt(2)
    v_mfma_f32_32x32x16_bf16 v[16:31], a[32:35], v[48:51], v[16:31]
    ds_read_b128 v[60:63], v9 offset:11264
    v_mul_f32 v138, v149, v122
    v_mul_f32 v139, v149, v123
    v_mul_f32 v140, v149, v124
    v_mfma_f32_32x32x16_bf16 v[32:47], a[176:179], v[48:51], v[32:47]
    v_mul_f32 v141, v149, v125
    v_mul_f32 v142, v149, v126
    v_mul_f32 v143, v149, v127
    v_mul_f32 v144, v149, v128
    s_waitcnt lgkmcnt(2)
    v_mfma_f32_32x32x16_bf16 v[16:31], a[36:39], v[52:55], v[16:31]
    ds_read_b128 v[48:51], v9 offset:12288
    v_mul_f32 v145, v149, v129
    v_mul_f32 v146, v149, v130
    v_mul_f32 v147, v149, v131
    v_mfma_f32_32x32x16_bf16 v[32:47], a[180:183], v[52:55], v[32:47]
    s_mul_i32 s46, s34, 50331648
    s_lshl_b32 s51, s35, 18
    s_add_u32 s46, s46, s51
    s_add_u32 s46, s46, s52
    s_waitcnt lgkmcnt(2)
    v_mfma_f32_32x32x16_bf16 v[16:31], a[40:43], v[56:59], v[16:31]
    ds_read_b128 v[52:55], v9 offset:13312
    v_mfma_f32_32x32x16_bf16 v[32:47], a[184:187], v[56:59], v[32:47]
    s_waitcnt lgkmcnt(2)
    v_mfma_f32_32x32x16_bf16 v[16:31], a[44:47], v[60:63], v[16:31]
    ds_read_b128 v[56:59], v9 offset:14336
    v_mfma_f32_32x32x16_bf16 v[32:47], a[188:191], v[60:63], v[32:47]
    s_waitcnt lgkmcnt(2)
    v_mfma_f32_32x32x16_bf16 v[16:31], a[48:51], v[48:51], v[16:31]
    ds_read_b128 v[60:63], v9 offset:15360
    v_mfma_f32_32x32x16_bf16 v[32:47], a[192:195], v[48:51], v[32:47]
    s_waitcnt vmcnt(1)
    s_cmp_lg_u32 s43, 0
    s_cselect_b64 exec, 3, 0
    buffer_store_dword v3, v185, s[8:11], s43 offen sc1
    s_mov_b64 exec, -1
    s_mov_b32 s43, 0
    s_waitcnt lgkmcnt(2)
    v_mfma_f32_32x32x16_bf16 v[16:31], a[52:55], v[52:55], v[16:31]
    ds_read_b128 v[48:51], v9 offset:16384
    v_mfma_f32_32x32x16_bf16 v[32:47], a[196:199], v[52:55], v[32:47]
    s_waitcnt lgkmcnt(2)
    v_mfma_f32_32x32x16_bf16 v[16:31], a[56:59], v[56:59], v[16:31]
    v_cmp_eq_u32 s[76:77], 1, v2
    v_cmp_eq_u32 vcc, 2, v2
    s_cmp_eq_u64 s[76:77], -1
    s_cselect_b32 s38, 1, 0
    ds_read_b128 v[52:55], v9 offset:17408
    v_mfma_f32_32x32x16_bf16 v[32:47], a[200:203], v[56:59], v[32:47]
    s_cmp_lg_u32 s38, 0
    s_cselect_b64 exec, 1, 0
    v_mov_b32 v15, s32
    ds_write_b32 v184, v15
    v_mov_b32 v2, 2
    s_mov_b64 exec, -1
    s_waitcnt lgkmcnt(3)
    v_mfma_f32_32x32x16_bf16 v[16:31], a[60:63], v[60:63], v[16:31]
    s_add_u32 s32, s32, s38
    s_mul_i32 s38, s38, 22528
    s_add_u32 s33, s33, s38
    ds_read_b128 v[56:59], v9 offset:18432
    v_mfma_f32_32x32x16_bf16 v[32:47], a[204:207], v[60:63], v[32:47]
    s_cmp_eq_u64 vcc, 0
    s_cselect_b32 s38, s32, 0x7fff
    s_waitcnt lgkmcnt(3)
    v_mfma_f32_32x32x16_bf16 v[16:31], a[64:67], v[48:51], v[16:31]
    ds_read_b128 v[60:63], v9 offset:19456
    v_mfma_f32_32x32x16_bf16 v[32:47], a[208:211], v[48:51], v[32:47]
    s_cmp_le_u32 s38, s39
    s_cselect_b64 exec, -1, 0
    v_mov_b32 v2, 2
    buffer_load_dword v2, v1, s[8:11], s33 offen sc1
    s_mov_b64 exec, -1
    ds_read_b32 v15, v184
    s_waitcnt lgkmcnt(4)
    v_mfma_f32_32x32x16_bf16 v[16:31], a[68:71], v[52:55], v[16:31]
    ds_read_b128 v[48:51], v9 offset:20480
    v_mfma_f32_32x32x16_bf16 v[32:47], a[212:215], v[52:55], v[32:47]
    s_waitcnt lgkmcnt(3)
    v_mfma_f32_32x32x16_bf16 v[16:31], a[72:75], v[56:59], v[16:31]
    ds_read_b128 v[52:55], v9 offset:21504
    v_mfma_f32_32x32x16_bf16 v[32:47], a[216:219], v[56:59], v[32:47]
    s_waitcnt lgkmcnt(2)
    v_readfirstlane_b32 s17, v15
    s_nop 0
    s_cmp_ge_i32 s17, s37
    s_cbranch_scc1 LpQQ_f_2
    v_mfma_f32_32x32x16_bf16 v[16:31], a[76:79], v[60:63], v[16:31]
    ds_read_b128 v[56:59], v9 offset:22528
    v_mfma_f32_32x32x16_bf16 v[32:47], a[220:223], v[60:63], v[32:47]
    s_waitcnt lgkmcnt(2)
    v_mfma_f32_32x32x16_bf16 v[16:31], a[80:83], v[48:51], v[16:31]
    ds_read_b128 v[60:63], v9 offset:23552
    v_mfma_f32_32x32x16_bf16 v[32:47], a[224:227], v[48:51], v[32:47]
    s_waitcnt lgkmcnt(2)
    v_mfma_f32_32x32x16_bf16 v[16:31], a[84:87], v[52:55], v[16:31]
    ds_read_b128 v[48:51], v9 offset:24576
    v_mfma_f32_32x32x16_bf16 v[32:47], a[228:231], v[52:55], v[32:47]
    s_waitcnt lgkmcnt(2)
    v_mfma_f32_32x32x16_bf16 v[16:31], a[88:91], v[56:59], v[16:31]
    ds_read_b128 v[52:55], v9 offset:25600
    v_mfma_f32_32x32x16_bf16 v[32:47], a[232:235], v[56:59], v[32:47]
    s_waitcnt lgkmcnt(2)
    v_mfma_f32_32x32x16_bf16 v[16:31], a[92:95], v[60:63], v[16:31]
    ds_read_b128 v[56:59], v9 offset:26624
    v_mfma_f32_32x32x16_bf16 v[32:47], a[236:239], v[60:63], v[32:47]
    s_waitcnt lgkmcnt(2)
    v_mfma_f32_32x32x16_bf16 v[16:31], a[96:99], v[48:51], v[16:31]
    ds_read_b128 v[60:63], v9 offset:27648
    v_mfma_f32_32x32x16_bf16 v[32:47], a[240:243], v[48:51], v[32:47]
    s_waitcnt lgkmcnt(2)
    v_mfma_f32_32x32x16_bf16 v[16:31], a[100:103], v[52:55], v[16:31]
    ds_read_b128 v[48:51], v9 offset:28672
    v_mfma_f32_32x32x16_bf16 v[32:47], a[244:247], v[52:55], v[32:47]
    s_waitcnt lgkmcnt(2)
    v_mfma_f32_32x32x16_bf16 v[16:31], a[104:107], v[56:59], v[16:31]
    ds_read_b128 v[52:55], v9 offset:29696
    v_mfma_f32_32x32x16_bf16 v[32:47], a[248:251], v[56:59], v[32:47]
    s_waitcnt lgkmcnt(2)
    v_mfma_f32_32x32x16_bf16 v[16:31], a[108:111], v[60:63], v[16:31]
    ds_read_b128 v[56:59], v9 offset:30720
    v_mfma_f32_32x32x16_bf16 v[32:47], a[252:255], v[60:63], v[32:47]
    s_waitcnt lgkmcnt(2)
    v_mfma_f32_32x32x16_bf16 v[16:31], a[112:115], v[48:51], v[16:31]
    ds_read_b128 v[60:63], v9 offset:31744
    v_mfma_f32_32x32x16_bf16 v[32:47], v[152:155], v[48:51], v[32:47]
    s_waitcnt lgkmcnt(2)
    v_mfma_f32_32x32x16_bf16 v[16:31], a[116:119], v[52:55], v[16:31]
    ds_read_b128 v[48:51], v9 offset:32768
    v_mfma_f32_32x32x16_bf16 v[32:47], v[156:159], v[52:55], v[32:47]
    s_waitcnt lgkmcnt(2)
    v_mfma_f32_32x32x16_bf16 v[16:31], a[120:123], v[56:59], v[16:31]
    ds_read_b128 v[52:55], v9 offset:33792
    v_mfma_f32_32x32x16_bf16 v[32:47], v[160:163], v[56:59], v[32:47]
    s_waitcnt lgkmcnt(2)
    v_mfma_f32_32x32x16_bf16 v[16:31], a[124:127], v[60:63], v[16:31]
    v_cmp_eq_u32 s[76:77], 1, v2
    v_cmp_eq_u32 vcc, 2, v2
    s_cmp_eq_u64 s[76:77], -1
    s_cselect_b32 s38, 1, 0
    ds_read_b128 v[56:59], v9 offset:34816
    v_mfma_f32_32x32x16_bf16 v[32:47], v[164:167], v[60:63], v[32:47]
    s_cmp_lg_u32 s38, 0
    s_cselect_b64 exec, 1, 0
    v_mov_b32 v15, s32
    ds_write_b32 v184, v15
    v_mov_b32 v2, 2
    s_mov_b64 exec, -1
    s_waitcnt lgkmcnt(3)
    v_mfma_f32_32x32x16_bf16 v[16:31], a[128:131], v[48:51], v[16:31]
    s_add_u32 s32, s32, s38
    s_mul_i32 s38, s38, 22528
    s_add_u32 s33, s33, s38
    ds_read_b128 v[60:63], v9 offset:35840
    v_mfma_f32_32x32x16_bf16 v[32:47], v[168:171], v[48:51], v[32:47]
    s_cmp_eq_u64 vcc, 0
    s_cselect_b32 s38, s32, 0x7fff
    s_waitcnt lgkmcnt(3)
    v_mfma_f32_32x32x16_bf16 v[16:31], a[132:135], v[52:55], v[16:31]
    s_cmp_le_u32 s38, s39
    s_cselect_b64 exec, -1, 0
    v_mov_b32 v2, 2
    buffer_load_dword v2, v1, s[8:11], s33 offen sc1
    s_mov_b64 exec, -1
    v_mfma_f32_32x32x16_bf16 v[32:47], v[172:175], v[52:55], v[32:47]
    s_waitcnt lgkmcnt(2)
    v_mfma_f32_32x32x16_bf16 v[16:31], a[136:139], v[56:59], v[16:31]
    v_mfma_f32_32x32x16_bf16 v[32:47], v[176:179], v[56:59], v[32:47]
    s_waitcnt lgkmcnt(0)
    v_mfma_f32_32x32x16_bf16 v[16:31], a[140:143], v[60:63], v[16:31]
    v_mfma_f32_32x32x16_bf16 v[32:47], v[180:183], v[60:63], v[32:47]
    s_add_u32 s51, s46, 8192
    s_nop 2
    v_pk_fma_f32 v[16:17], v[16:17], v[148:149], v[100:101] op_sel_hi:[1,0,1] neg_lo:[0,0,1] neg_hi:[0,0,1]
    v_pk_fma_f32 v[18:19], v[18:19], v[148:149], v[102:103] op_sel_hi:[1,0,1] neg_lo:[0,0,1] neg_hi:[0,0,1]
    v_pk_fma_f32 v[20:21], v[20:21], v[148:149], v[104:105] op_sel_hi:[1,0,1] neg_lo:[0,0,1] neg_hi:[0,0,1]
    v_pk_fma_f32 v[22:23], v[22:23], v[148:149], v[106:107] op_sel_hi:[1,0,1] neg_lo:[0,0,1] neg_hi:[0,0,1]
    v_pk_fma_f32 v[24:25], v[24:25], v[148:149], v[108:109] op_sel_hi:[1,0,1] neg_lo:[0,0,1] neg_hi:[0,0,1]
    v_pk_fma_f32 v[26:27], v[26:27], v[148:149], v[110:111] op_sel_hi:[1,0,1] neg_lo:[0,0,1] neg_hi:[0,0,1]
    v_pk_fma_f32 v[28:29], v[28:29], v[148:149], v[112:113] op_sel_hi:[1,0,1] neg_lo:[0,0,1] neg_hi:[0,0,1]
    v_pk_fma_f32 v[30:31], v[30:31], v[148:149], v[114:115] op_sel_hi:[1,0,1] neg_lo:[0,0,1] neg_hi:[0,0,1]
    v_cvt_pk_bf16_f32 v188, v16, v24
    v_cvt_pk_bf16_f32 v189, v17, v25
    v_cvt_pk_bf16_f32 v190, v18, v26
    v_cvt_pk_bf16_f32 v191, v19, v27
    buffer_store_dwordx4 v[188:191], v14, s[8:11], s46 offen offset:0 sc1
    v_cvt_pk_bf16_f32 v192, v20, v28
    v_cvt_pk_bf16_f32 v193, v21, v29
    v_cvt_pk_bf16_f32 v194, v22, v30
    v_cvt_pk_bf16_f32 v195, v23, v31
    buffer_store_dwordx4 v[192:195], v14, s[8:11], s46 offen offset:512 sc1
    v_pk_fma_f32 v[32:33], v[32:33], v[148:149], v[132:133] op_sel_hi:[1,0,1] neg_lo:[0,0,1] neg_hi:[0,0,1]
    v_pk_fma_f32 v[34:35], v[34:35], v[148:149], v[134:135] op_sel_hi:[1,0,1] neg_lo:[0,0,1] neg_hi:[0,0,1]
    v_pk_fma_f32 v[36:37], v[36:37], v[148:149], v[136:137] op_sel_hi:[1,0,1] neg_lo:[0,0,1] neg_hi:[0,0,1]
    v_pk_fma_f32 v[38:39], v[38:39], v[148:149], v[138:139] op_sel_hi:[1,0,1] neg_lo:[0,0,1] neg_hi:[0,0,1]
    v_pk_fma_f32 v[40:41], v[40:41], v[148:149], v[140:141] op_sel_hi:[1,0,1] neg_lo:[0,0,1] neg_hi:[0,0,1]
    v_pk_fma_f32 v[42:43], v[42:43], v[148:149], v[142:143] op_sel_hi:[1,0,1] neg_lo:[0,0,1] neg_hi:[0,0,1]
    v_pk_fma_f32 v[44:45], v[44:45], v[148:149], v[144:145] op_sel_hi:[1,0,1] neg_lo:[0,0,1] neg_hi:[0,0,1]
    v_pk_fma_f32 v[46:47], v[46:47], v[148:149], v[146:147] op_sel_hi:[1,0,1] neg_lo:[0,0,1] neg_hi:[0,0,1]
    v_cvt_pk_bf16_f32 v196, v32, v40
    v_cvt_pk_bf16_f32 v197, v33, v41
    v_cvt_pk_bf16_f32 v198, v34, v42
    v_cvt_pk_bf16_f32 v199, v35, v43
    buffer_store_dwordx4 v[196:199], v14, s[8:11], s51 offen offset:0 sc1
    v_cvt_pk_bf16_f32 v200, v36, v44
    v_cvt_pk_bf16_f32 v201, v37, v45
    v_cvt_pk_bf16_f32 v202, v38, v46
    v_cvt_pk_bf16_f32 v203, v39, v47
    buffer_store_dwordx4 v[200:203], v14, s[8:11], s51 offen offset:512 sc1
    s_mul_i32 s43, s57, 22528
    s_add_u32 s43, s43, s49
    s_branch LpQQ_none
LpQQ_f_1:
    v_mfma_f32_32x32x16_bf16 v[16:31], a[8:11], v[56:59], v[16:31]
    ds_read_b128 v[52:55], v9 offset:5120
    v_add_f32 v67, v67, v79
    s_waitcnt lgkmcnt(3)
    v_add_f32 v64, v64, v80
    v_add_f32 v65, v65, v81
    v_mfma_f32_32x32x16_bf16 v[32:47], a[152:155], v[56:59], v[32:47]
    v_add_f32 v66, v66, v82
    v_add_f32 v67, v67, v83
    v_add_f32 v64, v64, v66
    v_add_f32 v65, v65, v67
    s_waitcnt lgkmcnt(2)
    v_mfma_f32_32x32x16_bf16 v[16:31], a[12:15], v[60:63], v[16:31]
    ds_read_b128 v[56:59], v9 offset:6144
    v_mov_b32 v66, v64
    v_mov_b32 v67, v65
    s_nop 0
    v_permlane32_swap_b32 v64, v66
    v_mfma_f32_32x32x16_bf16 v[32:47], a[156:159], v[60:63], v[32:47]
    v_permlane32_swap_b32 v65, v67
    v_add_f32 v64, v64, v66
    v_add_f32 v65, v65, v67
    v_mul_f32 v64, 0x3ae38e39, v64
    s_waitcnt lgkmcnt(2)
    v_mfma_f32_32x32x16_bf16 v[16:31], a[16:19], v[48:51], v[16:31]
    ds_read_b128 v[60:63], v9 offset:7168
    v_mul_f32 v65, 0x3ae38e39, v65
    v_fma_f32 v65, -v64, v64, v65
    v_max_f32 v65, 0, v65
    v_mfma_f32_32x32x16_bf16 v[32:47], a[160:163], v[48:51], v[32:47]
    v_add_f32 v65, 0x3727c5ac, v65
    v_rsq_f32 v148, v65
    s_nop 0
    v_mul_f32 v149, v64, v148
    v_mul_f32 v100, v149, v84
    s_waitcnt lgkmcnt(2)
    v_mfma_f32_32x32x16_bf16 v[16:31], a[20:23], v[52:55], v[16:31]
    ds_read_b128 v[48:51], v9 offset:8192
    v_mul_f32 v101, v149, v85
    v_mul_f32 v102, v149, v86
    v_mul_f32 v103, v149, v87
    v_mfma_f32_32x32x16_bf16 v[32:47], a[164:167], v[52:55], v[32:47]
    v_mul_f32 v104, v149, v88
    v_mul_f32 v105, v149, v89
    v_mul_f32 v106, v149, v90
    v_mul_f32 v107, v149, v91
    s_waitcnt lgkmcnt(2)
    v_mfma_f32_32x32x16_bf16 v[16:31], a[24:27], v[56:59], v[16:31]
    ds_read_b128 v[52:55], v9 offset:9216
    v_mul_f32 v108, v149, v92
    v_mul_f32 v109, v149, v93
    v_mul_f32 v110, v149, v94
    v_mfma_f32_32x32x16_bf16 v[32:47], a[168:171], v[56:59], v[32:47]
    v_mul_f32 v111, v149, v95
    v_mul_f32 v112, v149, v96
    v_mul_f32 v113, v149, v97
    v_mul_f32 v114, v149, v98
    s_waitcnt lgkmcnt(2)
    v_mfma_f32_32x32x16_bf16 v[16:31], a[28:31], v[60:63], v[16:31]
    ds_read_b128 v[56:59], v9 offset:10240
    v_mul_f32 v115, v149, v99
    v_mul_f32 v132, v149, v116
    v_mul_f32 v133, v149, v117
    v_mfma_f32_32x32x16_bf16 v[32:47], a[172:175], v[60:63], v[32:47]
    v_mul_f32 v134, v149, v118
    v_mul_f32 v135, v149, v119
    v_mul_f32 v136, v149, v120
    v_mul_f32 v137, v149, v121
    s_waitcnt lgkmcnt(2)
    v_mfma_f32_32x32x16_bf16 v[16:31], a[32:35], v[48:51], v[16:31]
    ds_read_b128 v[60:63], v9 offset:11264
    v_mul_f32 v138, v149, v122
    v_mul_f32 v139, v149, v123
    v_mul_f32 v140, v149, v124
    v_mfma_f32_32x32x16_bf16 v[32:47], a[176:179], v[48:51], v[32:47]
    v_mul_f32 v141, v149, v125
    v_mul_f32 v142, v149, v126
    v_mul_f32 v143, v149, v127
    v_mul_f32 v144, v149, v128
    s_waitcnt lgkmcnt(2)
    v_mfma_f32_32x32x16_bf16 v[16:31], a[36:39], v[52:55], v[16:31]
    ds_read_b128 v[48:51], v9 offset:12288
    v_mul_f32 v145, v149, v129
    v_mul_f32 v146, v149, v130
    v_mul_f32 v147, v149, v131
    v_mfma_f32_32x32x16_bf16 v[32:47], a[180:183], v[52:55], v[32:47]
    s_mul_i32 s46, s34, 50331648
    s_lshl_b32 s51, s35, 18
    s_add_u32 s46, s46, s51
    s_add_u32 s46, s46, s52
    s_waitcnt lgkmcnt(2)
    v_mfma_f32_32x32x16_bf16 v[16:31], a[40:43], v[56:59], v[16:31]
    s_add_u32 m0, s59, 0
    s_add_u32 s47, s41, 0
    buffer_load_dwordx4 v0, s[8:11], s47 offen offset:0 lds
    buffer_load_dwordx4 v0, s[8:11], s47 offen offset:1024 lds
    ds_read_b128 v[52:55], v9 offset:13312
    v_mfma_f32_32x32x16_bf16 v[32:47], a[184:187], v[56:59], v[32:47]
    buffer_load_dwordx4 v0, s[8:11], s47 offen offset:2048 lds
    buffer_load_dwordx4 v0, s[8:11], s47 offen offset:3072 lds
    s_add_u32 m0, s59, 4096
    s_add_u32 s47, s41, 4096
    buffer_load_dwordx4 v0, s[8:11], s47 offen offset:0 lds
    s_waitcnt lgkmcnt(2)
    v_mfma_f32_32x32x16_bf16 v[16:31], a[44:47], v[60:63], v[16:31]
    buffer_load_dwordx4 v0, s[8:11], s47 offen offset:1024 lds
    buffer_load_dwordx4 v0, s[8:11], s47 offen offset:2048 lds
    buffer_load_dwordx4 v0, s[8:11], s47 offen offset:3072 lds
    ds_read_b128 v[56:59], v9 offset:14336
    v_mfma_f32_32x32x16_bf16 v[32:47], a[188:191], v[60:63], v[32:47]
    s_add_u32 m0, s59, 8192
    s_add_u32 s47, s41, 8192
    buffer_load_dwordx4 v0, s[8:11], s47 offen offset:0 lds
    s_waitcnt lgkmcnt(2)
    v_mfma_f32_32x32x16_bf16 v[16:31], a[48:51], v[48:51], v[16:31]
    s_mul_i32 s48, s36, 786432
    s_mul_i32 s18, s37, 6144
    s_add_u32 s48, s48, s18
    s_add_u32 s48, s48, 16125952
    s_add_u32 m0, s66, 4096
    s_nop 0
    buffer_load_dwordx4 v0, s[8:11], s48 offen lds
    ds_read_b128 v[60:63], v9 offset:15360
    v_mfma_f32_32x32x16_bf16 v[32:47], a[192:195], v[48:51], v[32:47]
    s_add_u32 m0, s66, s67
    s_sub_u32 s48, s48, 4096
    s_add_u32 s48, s48, s67
    buffer_load_dwordx4 v0, s[8:11], s48 offen lds
    s_waitcnt vmcnt(12)
    s_cmp_lg_u32 s43, 0
    s_cselect_b64 exec, 3, 0
    buffer_store_dword v3, v185, s[8:11], s43 offen sc1
    s_mov_b64 exec, -1
    s_mov_b32 s43, 0
    s_waitcnt lgkmcnt(2)
    v_mfma_f32_32x32x16_bf16 v[16:31], a[52:55], v[52:55], v[16:31]
    ds_read_b128 v[48:51], v9 offset:16384
    v_mfma_f32_32x32x16_bf16 v[32:47], a[196:199], v[52:55], v[32:47]
    s_waitcnt lgkmcnt(2)
    v_mfma_f32_32x32x16_bf16 v[16:31], a[56:59], v[56:59], v[16:31]
    v_cmp_eq_u32 s[76:77], 1, v2
    v_cmp_eq_u32 vcc, 2, v2
    s_cmp_eq_u64 s[76:77], -1
    s_cselect_b32 s38, 1, 0
    ds_read_b128 v[52:55], v9 offset:17408
    v_mfma_f32_32x32x16_bf16 v[32:47], a[200:203], v[56:59], v[32:47]
    s_cmp_lg_u32 s38, 0
    s_cselect_b64 exec, 1, 0
    v_mov_b32 v15, s32
    ds_write_b32 v184, v15
    v_mov_b32 v2, 2
    s_mov_b64 exec, -1
    s_waitcnt lgkmcnt(3)
    v_mfma_f32_32x32x16_bf16 v[16:31], a[60:63], v[60:63], v[16:31]
    s_add_u32 s32, s32, s38
    s_mul_i32 s38, s38, 22528
    s_add_u32 s33, s33, s38
    ds_read_b128 v[56:59], v9 offset:18432
    v_mfma_f32_32x32x16_bf16 v[32:47], a[204:207], v[60:63], v[32:47]
    s_cmp_eq_u64 vcc, 0
    s_cselect_b32 s38, s32, 0x7fff
    s_waitcnt lgkmcnt(3)
    v_mfma_f32_32x32x16_bf16 v[16:31], a[64:67], v[48:51], v[16:31]
    ds_read_b128 v[60:63], v9 offset:19456
    v_mfma_f32_32x32x16_bf16 v[32:47], a[208:211], v[48:51], v[32:47]
    s_cmp_le_u32 s38, s39
    s_cselect_b64 exec, -1, 0
    v_mov_b32 v2, 2
    buffer_load_dword v2, v1, s[8:11], s33 offen sc1
    s_mov_b64 exec, -1
    s_waitcnt lgkmcnt(3)
    v_mfma_f32_32x32x16_bf16 v[16:31], a[68:71], v[52:55], v[16:31]
    ds_read_b128 v[48:51], v9 offset:20480
    v_mfma_f32_32x32x16_bf16 v[32:47], a[212:215], v[52:55], v[32:47]
    s_waitcnt lgkmcnt(2)
    v_mfma_f32_32x32x16_bf16 v[16:31], a[72:75], v[56:59], v[16:31]
    ds_read_b128 v[52:55], v9 offset:21504
    v_mfma_f32_32x32x16_bf16 v[32:47], a[216:219], v[56:59], v[32:47]
    s_waitcnt lgkmcnt(2)
    v_mfma_f32_32x32x16_bf16 v[16:31], a[76:79], v[60:63], v[16:31]
    ds_read_b128 v[56:59], v9 offset:22528
    v_mfma_f32_32x32x16_bf16 v[32:47], a[220:223], v[60:63], v[32:47]
    s_waitcnt lgkmcnt(2)
    v_mfma_f32_32x32x16_bf16 v[16:31], a[80:83], v[48:51], v[16:31]
    ds_read_b128 v[60:63], v9 offset:23552
    v_mfma_f32_32x32x16_bf16 v[32:47], a[224:227], v[48:51], v[32:47]
    s_waitcnt lgkmcnt(2)
    v_mfma_f32_32x32x16_bf16 v[16:31], a[84:87], v[52:55], v[16:31]
    ds_read_b128 v[48:51], v9 offset:24576
    v_mfma_f32_32x32x16_bf16 v[32:47], a[228:231], v[52:55], v[32:47]
    s_waitcnt lgkmcnt(2)
    v_mfma_f32_32x32x16_bf16 v[16:31], a[88:91], v[56:59], v[16:31]
    ds_read_b128 v[52:55], v9 offset:25600
    v_mfma_f32_32x32x16_bf16 v[32:47], a[232:235], v[56:59], v[32:47]
    s_waitcnt lgkmcnt(2)
    v_mfma_f32_32x32x16_bf16 v[16:31], a[92:95], v[60:63], v[16:31]
    ds_read_b128 v[56:59], v9 offset:26624
    v_mfma_f32_32x32x16_bf16 v[32:47], a[236:239], v[60:63], v[32:47]
    s_waitcnt lgkmcnt(2)
    v_mfma_f32_32x32x16_bf16 v[16:31], a[96:99], v[48:51], v[16:31]
    ds_read_b128 v[60:63], v9 offset:27648
    v_mfma_f32_32x32x16_bf16 v[32:47], a[240:243], v[48:51], v[32:47]
    s_waitcnt lgkmcnt(2)
    v_mfma_f32_32x32x16_bf16 v[16:31], a[100:103], v[52:55], v[16:31]
    ds_read_b128 v[48:51], v9 offset:28672
    v_mfma_f32_32x32x16_bf16 v[32:47], a[244:247], v[52:55], v[32:47]
    s_waitcnt lgkmcnt(2)
    v_mfma_f32_32x32x16_bf16 v[16:31], a[104:107], v[56:59], v[16:31]
    ds_read_b128 v[52:55], v9 offset:29696
    v_mfma_f32_32x32x16_bf16 v[32:47], a[248:251], v[56:59], v[32:47]
    s_waitcnt lgkmcnt(2)
    v_mfma_f32_32x32x16_bf16 v[16:31], a[108:111], v[60:63], v[16:31]
    ds_read_b128 v[56:59], v9 offset:30720
    v_mfma_f32_32x32x16_bf16 v[32:47], a[252:255], v[60:63], v[32:47]
    s_waitcnt lgkmcnt(2)
    v_mfma_f32_32x32x16_bf16 v[16:31], a[112:115], v[48:51], v[16:31]
    ds_read_b128 v[60:63], v9 offset:31744
    v_mfma_f32_32x32x16_bf16 v[32:47], v[152:155], v[48:51], v[32:47]
    s_waitcnt lgkmcnt(2)
    v_mfma_f32_32x32x16_bf16 v[16:31], a[116:119], v[52:55], v[16:31]
    ds_read_b128 v[48:51], v9 offset:32768
    v_mfma_f32_32x32x16_bf16 v[32:47], v[156:159], v[52:55], v[32:47]
    s_waitcnt lgkmcnt(2)
    v_mfma_f32_32x32x16_bf16 v[16:31], a[120:123], v[56:59], v[16:31]
    ds_read_b128 v[52:55], v9 offset:33792
    v_mfma_f32_32x32x16_bf16 v[32:47], v[160:163], v[56:59], v[32:47]
    s_waitcnt lgkmcnt(2)
    v_mfma_f32_32x32x16_bf16 v[16:31], a[124:127], v[60:63], v[16:31]
    v_cmp_eq_u32 s[76:77], 1, v2
    v_cmp_eq_u32 vcc, 2, v2
    s_cmp_eq_u64 s[76:77], -1
    s_cselect_b32 s38, 1, 0
    ds_read_b128 v[56:59], v9 offset:34816
    v_mfma_f32_32x32x16_bf16 v[32:47], v[164:167], v[60:63], v[32:47]
    s_cmp_lg_u32 s38, 0
    s_cselect_b64 exec, 1, 0
    v_mov_b32 v15, s32
    ds_write_b32 v184, v15
    v_mov_b32 v2, 2
    s_mov_b64 exec, -1
    s_waitcnt lgkmcnt(3)
    v_mfma_f32_32x32x16_bf16 v[16:31], a[128:131], v[48:51], v[16:31]
    s_add_u32 s32, s32, s38
    s_mul_i32 s38, s38, 22528
    s_add_u32 s33, s33, s38
    ds_read_b128 v[60:63], v9 offset:35840
    v_mfma_f32_32x32x16_bf16 v[32:47], v[168:171], v[48:51], v[32:47]
    s_cmp_eq_u64 vcc, 0
    s_cselect_b32 s38, s32, 0x7fff
    s_waitcnt lgkmcnt(3)
    v_mfma_f32_32x32x16_bf16 v[16:31], a[132:135], v[52:55], v[16:31]
    s_cmp_le_u32 s38, s39
    s_cselect_b64 exec, -1, 0
    v_mov_b32 v2, 2
    buffer_load_dword v2, v1, s[8:11], s33 offen sc1
    s_mov_b64 exec, -1
    v_mfma_f32_32x32x16_bf16 v[32:47], v[172:175], v[52:55], v[32:47]
    s_waitcnt lgkmcnt(2)
    v_mfma_f32_32x32x16_bf16 v[16:31], a[136:139], v[56:59], v[16:31]
    v_mfma_f32_32x32x16_bf16 v[32:47], v[176:179], v[56:59], v[32:47]
    s_waitcnt lgkmcnt(0)
    v_mfma_f32_32x32x16_bf16 v[16:31], a[140:143], v[60:63], v[16:31]
    v_mfma_f32_32x32x16_bf16 v[32:47], v[180:183], v[60:63], v[32:47]
    s_add_u32 s51, s46, 8192
    s_nop 2
    v_pk_fma_f32 v[16:17], v[16:17], v[148:149], v[100:101] op_sel_hi:[1,0,1] neg_lo:[0,0,1] neg_hi:[0,0,1]
    v_pk_fma_f32 v[18:19], v[18:19], v[148:149], v[102:103] op_sel_hi:[1,0,1] neg_lo:[0,0,1] neg_hi:[0,0,1]
    v_pk_fma_f32 v[20:21], v[20:21], v[148:149], v[104:105] op_sel_hi:[1,0,1] neg_lo:[0,0,1] neg_hi:[0,0,1]
    v_pk_fma_f32 v[22:23], v[22:23], v[148:149], v[106:107] op_sel_hi:[1,0,1] neg_lo:[0,0,1] neg_hi:[0,0,1]
    v_pk_fma_f32 v[24:25], v[24:25], v[148:149], v[108:109] op_sel_hi:[1,0,1] neg_lo:[0,0,1] neg_hi:[0,0,1]
    v_pk_fma_f32 v[26:27], v[26:27], v[148:149], v[110:111] op_sel_hi:[1,0,1] neg_lo:[0,0,1] neg_hi:[0,0,1]
    v_pk_fma_f32 v[28:29], v[28:29], v[148:149], v[112:113] op_sel_hi:[1,0,1] neg_lo:[0,0,1] neg_hi:[0,0,1]
    v_pk_fma_f32 v[30:31], v[30:31], v[148:149], v[114:115] op_sel_hi:[1,0,1] neg_lo:[0,0,1] neg_hi:[0,0,1]
    v_cvt_pk_bf16_f32 v188, v16, v24
    v_cvt_pk_bf16_f32 v189, v17, v25
    v_cvt_pk_bf16_f32 v190, v18, v26
    v_cvt_pk_bf16_f32 v191, v19, v27
    buffer_store_dwordx4 v[188:191], v14, s[8:11], s46 offen offset:0 sc1
    v_cvt_pk_bf16_f32 v192, v20, v28
    v_cvt_pk_bf16_f32 v193, v21, v29
    v_cvt_pk_bf16_f32 v194, v22, v30
    v_cvt_pk_bf16_f32 v195, v23, v31
    buffer_store_dwordx4 v[192:195], v14, s[8:11], s46 offen offset:512 sc1
    v_pk_fma_f32 v[32:33], v[32:33], v[148:149], v[132:133] op_sel_hi:[1,0,1] neg_lo:[0,0,1] neg_hi:[0,0,1]
    v_pk_fma_f32 v[34:35], v[34:35], v[148:149], v[134:135] op_sel_hi:[1,0,1] neg_lo:[0,0,1] neg_hi:[0,0,1]
    v_pk_fma_f32 v[36:37], v[36:37], v[148:149], v[136:137] op_sel_hi:[1,0,1] neg_lo:[0,0,1] neg_hi:[0,0,1]
    v_pk_fma_f32 v[38:39], v[38:39], v[148:149], v[138:139] op_sel_hi:[1,0,1] neg_lo:[0,0,1] neg_hi:[0,0,1]
    v_pk_fma_f32 v[40:41], v[40:41], v[148:149], v[140:141] op_sel_hi:[1,0,1] neg_lo:[0,0,1] neg_hi:[0,0,1]
    v_pk_fma_f32 v[42:43], v[42:43], v[148:149], v[142:143] op_sel_hi:[1,0,1] neg_lo:[0,0,1] neg_hi:[0,0,1]
    v_pk_fma_f32 v[44:45], v[44:45], v[148:149], v[144:145] op_sel_hi:[1,0,1] neg_lo:[0,0,1] neg_hi:[0,0,1]
    v_pk_fma_f32 v[46:47], v[46:47], v[148:149], v[146:147] op_sel_hi:[1,0,1] neg_lo:[0,0,1] neg_hi:[0,0,1]
    v_cvt_pk_bf16_f32 v196, v32, v40
    v_cvt_pk_bf16_f32 v197, v33, v41
    v_cvt_pk_bf16_f32 v198, v34, v42
    v_cvt_pk_bf16_f32 v199, v35, v43
    buffer_store_dwordx4 v[196:199], v14, s[8:11], s51 offen offset:0 sc1
    v_cvt_pk_bf16_f32 v200, v36, v44
    v_cvt_pk_bf16_f32 v201, v37, v45
    v_cvt_pk_bf16_f32 v202, v38, v46
    v_cvt_pk_bf16_f32 v203, v39, v47
    buffer_store_dwordx4 v[200:203], v14, s[8:11], s51 offen offset:512 sc1
    s_mul_i32 s43, s57, 22528
    s_add_u32 s43, s43, s49
    s_branch LpQQ_head
LpQQ_f_2:
    v_mfma_f32_32x32x16_bf16 v[16:31], a[76:79], v[60:63], v[16:31]
    s_add_u32 m0, s59, 0
    s_add_u32 s47, s41, 0
    buffer_load_dwordx4 v0, s[8:11], s47 offen offset:0 lds
    ds_read_b128 v[56:59], v9 offset:22528
    v_mfma_f32_32x32x16_bf16 v[32:47], a[220:223], v[60:63], v[32:47]
    s_waitcnt lgkmcnt(2)
    v_mfma_f32_32x32x16_bf16 v[16:31], a[80:83], v[48:51], v[16:31]
    buffer_load_dwordx4 v0, s[8:11], s47 offen offset:1024 lds
    ds_read_b128 v[60:63], v9 offset:23552
    v_mfma_f32_32x32x16_bf16 v[32:47], a[224:227], v[48:51], v[32:47]
    s_waitcnt lgkmcnt(2)
    v_mfma_f32_32x32x16_bf16 v[16:31], a[84:87], v[52:55], v[16:31]
    buffer_load_dwordx4 v0, s[8:11], s47 offen offset:2048 lds
    ds_read_b128 v[48:51], v9 offset:24576
    v_mfma_f32_32x32x16_bf16 v[32:47], a[228:231], v[52:55], v[32:47]
    s_waitcnt lgkmcnt(2)
    v_mfma_f32_32x32x16_bf16 v[16:31], a[88:91], v[56:59], v[16:31]
    buffer_load_dwordx4 v0, s[8:11], s47 offen offset:3072 lds
    ds_read_b128 v[52:55], v9 offset:25600
    v_mfma_f32_32x32x16_bf16 v[32:47], a[232:235], v[56:59], v[32:47]
    s_waitcnt lgkmcnt(2)
    v_mfma_f32_32x32x16_bf16 v[16:31], a[92:95], v[60:63], v[16:31]
    s_add_u32 m0, s59, 4096
    s_add_u32 s47, s41, 4096
    buffer_load_dwordx4 v0, s[8:11], s47 offen offset:0 lds
    ds_read_b128 v[56:59], v9 offset:26624
    v_mfma_f32_32x32x16_bf16 v[32:47], a[236:239], v[60:63], v[32:47]
    s_waitcnt lgkmcnt(2)
    v_mfma_f32_32x32x16_bf16 v[16:31], a[96:99], v[48:51], v[16:31]
    buffer_load_dwordx4 v0, s[8:11], s47 offen offset:1024 lds
    ds_read_b128 v[60:63], v9 offset:27648
    v_mfma_f32_32x32x16_bf16 v[32:47], a[240:243], v[48:51], v[32:47]
    s_waitcnt lgkmcnt(2)
    v_mfma_f32_32x32x16_bf16 v[16:31], a[100:103], v[52:55], v[16:31]
    buffer_load_dwordx4 v0, s[8:11], s47 offen offset:2048 lds
    ds_read_b128 v[48:51], v9 offset:28672
    v_mfma_f32_32x32x16_bf16 v[32:47], a[244:247], v[52:55], v[32:47]
    s_waitcnt lgkmcnt(2)
    v_mfma_f32_32x32x16_bf16 v[16:31], a[104:107], v[56:59], v[16:31]
    buffer_load_dwordx4 v0, s[8:11], s47 offen offset:3072 lds
    ds_read_b128 v[52:55], v9 offset:29696
    v_mfma_f32_32x32x16_bf16 v[32:47], a[248:251], v[56:59], v[32:47]
    s_waitcnt lgkmcnt(2)
    v_mfma_f32_32x32x16_bf16 v[16:31], a[108:111], v[60:63], v[16:31]
    s_add_u32 m0, s59, 8192
    s_add_u32 s47, s41, 8192
    buffer_load_dwordx4 v0, s[8:11], s47 offen offset:0 lds
    ds_read_b128 v[56:59], v9 offset:30720
    v_mfma_f32_32x32x16_bf16 v[32:47], a[252:255], v[60:63], v[32:47]
    s_waitcnt lgkmcnt(2)
    v_mfma_f32_32x32x16_bf16 v[16:31], a[112:115], v[48:51], v[16:31]
    s_mul_i32 s48, s36, 786432
    s_mul_i32 s18, s37, 6144
    s_add_u32 s48, s48, s18
    s_add_u32 s48, s48, 16125952
    s_add_u32 m0, s66, 4096
    s_nop 0
    buffer_load_dwordx4 v0, s[8:11], s48 offen lds
    ds_read_b128 v[60:63], v9 offset:31744
    v_mfma_f32_32x32x16_bf16 v[32:47], v[152:155], v[48:51], v[32:47]
    s_waitcnt lgkmcnt(2)
    v_mfma_f32_32x32x16_bf16 v[16:31], a[116:119], v[52:55], v[16:31]
    s_add_u32 m0, s66, s67
    s_sub_u32 s48, s48, 4096
    s_add_u32 s48, s48, s67
    buffer_load_dwordx4 v0, s[8:11], s48 offen lds
    ds_read_b128 v[48:51], v9 offset:32768
    v_mfma_f32_32x32x16_bf16 v[32:47], v[156:159], v[52:55], v[32:47]
    s_waitcnt lgkmcnt(2)
    v_mfma_f32_32x32x16_bf16 v[16:31], a[120:123], v[56:59], v[16:31]
    ds_read_b128 v[52:55], v9 offset:33792
    v_mfma_f32_32x32x16_bf16 v[32:47], v[160:163], v[56:59], v[32:47]
    s_waitcnt lgkmcnt(2)
    v_mfma_f32_32x32x16_bf16 v[16:31], a[124:127], v[60:63], v[16:31]
    v_cmp_eq_u32 s[76:77], 1, v2
    v_cmp_eq_u32 vcc, 2, v2
    s_cmp_eq_u64 s[76:77], -1
    s_cselect_b32 s38, 1, 0
    ds_read_b128 v[56:59], v9 offset:34816
    v_mfma_f32_32x32x16_bf16 v[32:47], v[164:167], v[60:63], v[32:47]
    s_cmp_lg_u32 s38, 0
    s_cselect_b64 exec, 1, 0
    v_mov_b32 v15, s32
    ds_write_b32 v184, v15
    v_mov_b32 v2, 2
    s_mov_b64 exec, -1
    s_waitcnt lgkmcnt(3)
    v_mfma_f32_32x32x16_bf16 v[16:31], a[128:131], v[48:51], v[16:31]
    s_add_u32 s32, s32, s38
    s_mul_i32 s38, s38, 22528
    s_add_u32 s33, s33, s38
    ds_read_b128 v[60:63], v9 offset:35840
    v_mfma_f32_32x32x16_bf16 v[32:47], v[168:171], v[48:51], v[32:47]
    s_cmp_eq_u64 vcc, 0
    s_cselect_b32 s38, s32, 0x7fff
    s_waitcnt lgkmcnt(3)
    v_mfma_f32_32x32x16_bf16 v[16:31], a[132:135], v[52:55], v[16:31]
    s_cmp_le_u32 s38, s39
    s_cselect_b64 exec, -1, 0
    v_mov_b32 v2, 2
    buffer_load_dword v2, v1, s[8:11], s33 offen sc1
    s_mov_b64 exec, -1
    v_mfma_f32_32x32x16_bf16 v[32:47], v[172:175], v[52:55], v[32:47]
    s_waitcnt lgkmcnt(2)
    v_mfma_f32_32x32x16_bf16 v[16:31], a[136:139], v[56:59], v[16:31]
    v_mfma_f32_32x32x16_bf16 v[32:47], v[176:179], v[56:59], v[32:47]
    s_waitcnt lgkmcnt(0)
    v_mfma_f32_32x32x16_bf16 v[16:31], a[140:143], v[60:63], v[16:31]
    v_mfma_f32_32x32x16_bf16 v[32:47], v[180:183], v[60:63], v[32:47]
    s_add_u32 s51, s46, 8192
    s_nop 2
    v_pk_fma_f32 v[16:17], v[16:17], v[148:149], v[100:101] op_sel_hi:[1,0,1] neg_lo:[0,0,1] neg_hi:[0,0,1]
    v_pk_fma_f32 v[18:19], v[18:19], v[148:149], v[102:103] op_sel_hi:[1,0,1] neg_lo:[0,0,1] neg_hi:[0,0,1]
    v_pk_fma_f32 v[20:21], v[20:21], v[148:149], v[104:105] op_sel_hi:[1,0,1] neg_lo:[0,0,1] neg_hi:[0,0,1]
    v_pk_fma_f32 v[22:23], v[22:23], v[148:149], v[106:107] op_sel_hi:[1,0,1] neg_lo:[0,0,1] neg_hi:[0,0,1]
    v_pk_fma_f32 v[24:25], v[24:25], v[148:149], v[108:109] op_sel_hi:[1,0,1] neg_lo:[0,0,1] neg_hi:[0,0,1]
    v_pk_fma_f32 v[26:27], v[26:27], v[148:149], v[110:111] op_sel_hi:[1,0,1] neg_lo:[0,0,1] neg_hi:[0,0,1]
    v_pk_fma_f32 v[28:29], v[28:29], v[148:149], v[112:113] op_sel_hi:[1,0,1] neg_lo:[0,0,1] neg_hi:[0,0,1]
    v_pk_fma_f32 v[30:31], v[30:31], v[148:149], v[114:115] op_sel_hi:[1,0,1] neg_lo:[0,0,1] neg_hi:[0,0,1]
    v_cvt_pk_bf16_f32 v188, v16, v24
    v_cvt_pk_bf16_f32 v189, v17, v25
    v_cvt_pk_bf16_f32 v190, v18, v26
    v_cvt_pk_bf16_f32 v191, v19, v27
    buffer_store_dwordx4 v[188:191], v14, s[8:11], s46 offen offset:0 sc1
    v_cvt_pk_bf16_f32 v192, v20, v28
    v_cvt_pk_bf16_f32 v193, v21, v29
    v_cvt_pk_bf16_f32 v194, v22, v30
    v_cvt_pk_bf16_f32 v195, v23, v31
    buffer_store_dwordx4 v[192:195], v14, s[8:11], s46 offen offset:512 sc1
    v_pk_fma_f32 v[32:33], v[32:33], v[148:149], v[132:133] op_sel_hi:[1,0,1] neg_lo:[0,0,1] neg_hi:[0,0,1]
    v_pk_fma_f32 v[34:35], v[34:35], v[148:149], v[134:135] op_sel_hi:[1,0,1] neg_lo:[0,0,1] neg_hi:[0,0,1]
    v_pk_fma_f32 v[36:37], v[36:37], v[148:149], v[136:137] op_sel_hi:[1,0,1] neg_lo:[0,0,1] neg_hi:[0,0,1]
    v_pk_fma_f32 v[38:39], v[38:39], v[148:149], v[138:139] op_sel_hi:[1,0,1] neg_lo:[0,0,1] neg_hi:[0,0,1]
    v_pk_fma_f32 v[40:41], v[40:41], v[148:149], v[140:141] op_sel_hi:[1,0,1] neg_lo:[0,0,1] neg_hi:[0,0,1]
    v_pk_fma_f32 v[42:43], v[42:43], v[148:149], v[142:143] op_sel_hi:[1,0,1] neg_lo:[0,0,1] neg_hi:[0,0,1]
    v_pk_fma_f32 v[44:45], v[44:45], v[148:149], v[144:145] op_sel_hi:[1,0,1] neg_lo:[0,0,1] neg_hi:[0,0,1]
    v_pk_fma_f32 v[46:47], v[46:47], v[148:149], v[146:147] op_sel_hi:[1,0,1] neg_lo:[0,0,1] neg_hi:[0,0,1]
    v_cvt_pk_bf16_f32 v196, v32, v40
    v_cvt_pk_bf16_f32 v197, v33, v41
    v_cvt_pk_bf16_f32 v198, v34, v42
    v_cvt_pk_bf16_f32 v199, v35, v43
    buffer_store_dwordx4 v[196:199], v14, s[8:11], s51 offen offset:0 sc1
    v_cvt_pk_bf16_f32 v200, v36, v44
    v_cvt_pk_bf16_f32 v201, v37, v45
    v_cvt_pk_bf16_f32 v202, v38, v46
    v_cvt_pk_bf16_f32 v203, v39, v47
    buffer_store_dwordx4 v[200:203], v14, s[8:11], s51 offen offset:512 sc1
    s_mul_i32 s43, s57, 22528
    s_add_u32 s43, s43, s49
    s_branch LpQQ_head
LpQQ_none:
    ds_read_b32 v15, v184
    s_waitcnt lgkmcnt(0)
    v_readfirstlane_b32 s17, v15
    s_nop 0
    s_cmp_lt_i32 s17, s37
    s_cbranch_scc1 LpQQ_nopost
    s_add_u32 m0, s59, 0
    s_add_u32 s47, s41, 0
    buffer_load_dwordx4 v0, s[8:11], s47 offen offset:0 lds
    buffer_load_dwordx4 v0, s[8:11], s47 offen offset:1024 lds
    buffer_load_dwordx4 v0, s[8:11], s47 offen offset:2048 lds
    buffer_load_dwordx4 v0, s[8:11], s47 offen offset:3072 lds
    s_add_u32 m0, s59, 4096
    s_add_u32 s47, s41, 4096
    buffer_load_dwordx4 v0, s[8:11], s47 offen offset:0 lds
    buffer_load_dwordx4 v0, s[8:11], s47 offen offset:1024 lds
    buffer_load_dwordx4 v0, s[8:11], s47 offen offset:2048 lds
    buffer_load_dwordx4 v0, s[8:11], s47 offen offset:3072 lds
    s_add_u32 m0, s59, 8192
    s_add_u32 s47, s41, 8192
    buffer_load_dwordx4 v0, s[8:11], s47 offen offset:0 lds
    s_mul_i32 s48, s36, 786432
    s_mul_i32 s18, s37, 6144
    s_add_u32 s48, s48, s18
    s_add_u32 s48, s48, 16125952
    s_add_u32 m0, s66, 4096
    s_nop 0
    buffer_load_dwordx4 v0, s[8:11], s48 offen lds
    s_add_u32 m0, s66, s67
    s_sub_u32 s48, s48, 4096
    s_add_u32 s48, s48, s67
    buffer_load_dwordx4 v0, s[8:11], s48 offen lds
    s_waitcnt vmcnt(11)
    s_cmp_lg_u32 s43, 0
    s_cselect_b64 exec, 3, 0
    buffer_store_dword v3, v185, s[8:11], s43 offen sc1
    s_mov_b64 exec, -1
    s_mov_b32 s43, 0
    s_waitcnt vmcnt(1) lgkmcnt(0)
    s_branch LpQQ_head2
LpQQ_nopost:
    s_waitcnt vmcnt(0)
    s_cmp_lg_u32 s43, 0
    s_cselect_b64 exec, 3, 0
    buffer_store_dword v3, v185, s[8:11], s43 offen sc1
    s_mov_b64 exec, -1
    s_mov_b32 s43, 0
    s_cmp_ge_u32 s37, 64
    s_cbranch_scc1 LpQQ_end
LpQQ_wait:
    s_mov_b32 s16, 0
    s_cmp_lg_u32 s14, 0
    s_cbranch_scc1 LpQQ_wl
LpQQ_wp:
    buffer_load_dword v2, v1, s[8:11], s60 offen sc1
    s_add_u32 s16, s16, 1
    s_cmp_gt_u32 s16, 100000
    s_cbranch_scc1 LpQQ_giveup
    s_waitcnt vmcnt(0)
    v_cmp_eq_u32 vcc, 0, v2
    s_nop 0
    s_cbranch_vccz LpQQ_wok
    s_sleep 4
    s_branch LpQQ_wp
LpQQ_giveup:
    v_mov_b32 v5, -2
    ds_write_b32 v184, v5
    s_waitcnt lgkmcnt(0)
    s_branch L_role_p_abort
LpQQ_wok:
    v_mov_b32 v5, s37
    ds_write_b32 v184, v5
    s_branch LpQQ_go
LpQQ_wl:
    ds_read_b32 v15, v184
    s_add_u32 s16, s16, 1
    s_cmp_gt_u32 s16, 1600000
    s_cbranch_scc1 L_role_p_abort
    s_waitcnt lgkmcnt(0)
    v_readfirstlane_b32 s17, v15
    s_nop 0
    s_cmp_eq_u32 s17, -2
    s_cbranch_scc1 L_role_p_abort
    s_cmp_ge_i32 s17, s37
    s_cbranch_scc1 LpQQ_go
    s_sleep 1
    s_branch LpQQ_wl
LpQQ_go:
    s_add_u32 m0, s59, 0
    s_add_u32 s47, s41, 0
    buffer_load_dwordx4 v0, s[8:11], s47 offen offset:0 lds
    buffer_load_dwordx4 v0, s[8:11], s47 offen offset:1024 lds
    buffer_load_dwordx4 v0, s[8:11], s47 offen offset:2048 lds
    buffer_load_dwordx4 v0, s[8:11], s47 offen offset:3072 lds
    s_add_u32 m0, s59, 4096
    s_add_u32 s47, s41, 4096
    buffer_load_dwordx4 v0, s[8:11], s47 offen offset:0 lds
    buffer_load_dwordx4 v0, s[8:11], s47 offen offset:1024 lds
    buffer_load_dwordx4 v0, s[8:11], s47 offen offset:2048 lds
    buffer_load_dwordx4 v0, s[8:11], s47 offen offset:3072 lds
    s_add_u32 m0, s59, 8192
    s_add_u32 s47, s41, 8192
    buffer_load_dwordx4 v0, s[8:11], s47 offen offset:0 lds
    s_mul_i32 s48, s36, 786432
    s_mul_i32 s18, s37, 6144
    s_add_u32 s48, s48, s18
    s_add_u32 s48, s48, 16125952
    s_add_u32 m0, s66, 4096
    s_nop 0
    buffer_load_dwordx4 v0, s[8:11], s48 offen lds
    s_add_u32 m0, s66, s67
    s_sub_u32 s48, s48, 4096
    s_add_u32 s48, s48, s67
    buffer_load_dwordx4 v0, s[8:11], s48 offen lds
    s_waitcnt vmcnt(0) lgkmcnt(0)
    s_branch LpQQ_head2
LpQQ_end:
    s_branch L_role_p_exit
Lp2_kv:
    v_mfma_f32_32x32x16_bf16 v[84:99], a[0:3], v[48:51], 0
    v_mfma_f32_32x32x16_bf16 v[32:47], v[48:51], a[144:147], 0
    v_mfma_f32_32x32x16_bf16 v[84:99], a[4:7], v[48:51], v[84:99]
    v_mfma_f32_32x32x16_bf16 v[32:47], v[48:51], a[148:151], v[32:47]
    v_mfma_f32_32x32x16_bf16 v[84:99], a[8:11], v[48:51], v[84:99]
    v_mfma_f32_32x32x16_bf16 v[32:47], v[48:51], a[152:155], v[32:47]
    v_mfma_f32_32x32x16_bf16 v[84:99], a[12:15], v[48:51], v[84:99]
    v_mfma_f32_32x32x16_bf16 v[32:47], v[48:51], a[156:159], v[32:47]
    v_mfma_f32_32x32x16_bf16 v[84:99], a[16:19], v[48:51], v[84:99]
    v_mfma_f32_32x32x16_bf16 v[32:47], v[48:51], a[160:163], v[32:47]
    v_mfma_f32_32x32x16_bf16 v[84:99], a[20:23], v[48:51], v[84:99]
    v_mfma_f32_32x32x16_bf16 v[32:47], v[48:51], a[164:167], v[32:47]
    v_mfma_f32_32x32x16_bf16 v[84:99], a[24:27], v[48:51], v[84:99]
    v_mfma_f32_32x32x16_bf16 v[32:47], v[48:51], a[168:171], v[32:47]
    v_mfma_f32_32x32x16_bf16 v[84:99], a[28:31], v[48:51], v[84:99]
    v_mfma_f32_32x32x16_bf16 v[32:47], v[48:51], a[172:175], v[32:47]
    v_mfma_f32_32x32x16_bf16 v[84:99], a[32:35], v[48:51], v[84:99]
    v_mfma_f32_32x32x16_bf16 v[32:47], v[48:51], a[176:179], v[32:47]
    v_mfma_f32_32x32x16_bf16 v[84:99], a[36:39], v[48:51], v[84:99]
    v_mfma_f32_32x32x16_bf16 v[32:47], v[48:51], a[180:183], v[32:47]
    v_mfma_f32_32x32x16_bf16 v[84:99], a[40:43], v[48:51], v[84:99]
    v_mfma_f32_32x32x16_bf16 v[32:47], v[48:51], a[184:187], v[32:47]
    v_mfma_f32_32x32x16_bf16 v[84:99], a[44:47], v[48:51], v[84:99]
    v_mfma_f32_32x32x16_bf16 v[32:47], v[48:51], a[188:191], v[32:47]
    v_mfma_f32_32x32x16_bf16 v[84:99], a[48:51], v[48:51], v[84:99]
    v_mfma_f32_32x32x16_bf16 v[32:47], v[48:51], a[192:195], v[32:47]
    v_mfma_f32_32x32x16_bf16 v[84:99], a[52:55], v[48:51], v[84:99]
    v_mfma_f32_32x32x16_bf16 v[32:47], v[48:51], a[196:199], v[32:47]
    v_mfma_f32_32x32x16_bf16 v[84:99], a[56:59], v[48:51], v[84:99]
    v_mfma_f32_32x32x16_bf16 v[32:47], v[48:51], a[200:203], v[32:47]
    v_mfma_f32_32x32x16_bf16 v[84:99], a[60:63], v[48:51], v[84:99]
    v_mfma_f32_32x32x16_bf16 v[32:47], v[48:51], a[204:207], v[32:47]
    v_mfma_f32_32x32x16_bf16 v[84:99], a[64:67], v[48:51], v[84:99]
    v_mfma_f32_32x32x16_bf16 v[32:47], v[48:51], a[208:211], v[32:47]
    v_mfma_f32_32x32x16_bf16 v[84:99], a[68:71], v[48:51], v[84:99]
    v_mfma_f32_32x32x16_bf16 v[32:47], v[48:51], a[212:215], v[32:47]
    v_mfma_f32_32x32x16_bf16 v[84:99], a[72:75], v[48:51], v[84:99]
    v_mfma_f32_32x32x16_bf16 v[32:47], v[48:51], a[216:219], v[32:47]
    v_mfma_f32_32x32x16_bf16 v[84:99], a[76:79], v[48:51], v[84:99]
    v_mfma_f32_32x32x16_bf16 v[32:47], v[48:51], a[220:223], v[32:47]
    v_mfma_f32_32x32x16_bf16 v[84:99], a[80:83], v[48:51], v[84:99]
    v_mfma_f32_32x32x16_bf16 v[32:47], v[48:51], a[224:227], v[32:47]
    v_mfma_f32_32x32x16_bf16 v[84:99], a[84:87], v[48:51], v[84:99]
    v_mfma_f32_32x32x16_bf16 v[32:47], v[48:51], a[228:231], v[32:47]
    v_mfma_f32_32x32x16_bf16 v[84:99], a[88:91], v[48:51], v[84:99]
    v_mfma_f32_32x32x16_bf16 v[32:47], v[48:51], a[232:235], v[32:47]
    v_mfma_f32_32x32x16_bf16 v[84:99], a[92:95], v[48:51], v[84:99]
    v_mfma_f32_32x32x16_bf16 v[32:47], v[48:51], a[236:239], v[32:47]
    v_mfma_f32_32x32x16_bf16 v[84:99], a[96:99], v[48:51], v[84:99]
    v_mfma_f32_32x32x16_bf16 v[32:47], v[48:51], a[240:243], v[32:47]
    v_mfma_f32_32x32x16_bf16 v[84:99], a[100:103], v[48:51], v[84:99]
    v_mfma_f32_32x32x16_bf16 v[32:47], v[48:51], a[244:247], v[32:47]
    v_mfma_f32_32x32x16_bf16 v[84:99], a[104:107], v[48:51], v[84:99]
    v_mfma_f32_32x32x16_bf16 v[32:47], v[48:51], a[248:251], v[32:47]
    v_mfma_f32_32x32x16_bf16 v[84:99], a[108:111], v[48:51], v[84:99]
    v_mfma_f32_32x32x16_bf16 v[32:47], v[48:51], a[252:255], v[32:47]
    v_mfma_f32_32x32x16_bf16 v[84:99], a[112:115], v[48:51], v[84:99]
    v_mfma_f32_32x32x16_bf16 v[32:47], v[48:51], v[152:155], v[32:47]
    v_mfma_f32_32x32x16_bf16 v[84:99], a[116:119], v[48:51], v[84:99]
    v_mfma_f32_32x32x16_bf16 v[32:47], v[48:51], v[156:159], v[32:47]
    v_mfma_f32_32x32x16_bf16 v[84:99], a[120:123], v[48:51], v[84:99]
    v_mfma_f32_32x32x16_bf16 v[32:47], v[48:51], v[160:163], v[32:47]
    v_mfma_f32_32x32x16_bf16 v[84:99], a[124:127], v[48:51], v[84:99]
    v_mfma_f32_32x32x16_bf16 v[32:47], v[48:51], v[164:167], v[32:47]
    v_mfma_f32_32x32x16_bf16 v[84:99], a[128:131], v[48:51], v[84:99]
    v_mfma_f32_32x32x16_bf16 v[32:47], v[48:51], v[168:171], v[32:47]
    v_mfma_f32_32x32x16_bf16 v[84:99], a[132:135], v[48:51], v[84:99]
    v_mfma_f32_32x32x16_bf16 v[32:47], v[48:51], v[172:175], v[32:47]
    v_mfma_f32_32x32x16_bf16 v[84:99], a[136:139], v[48:51], v[84:99]
    v_mfma_f32_32x32x16_bf16 v[32:47], v[48:51], v[176:179], v[32:47]
    v_mfma_f32_32x32x16_bf16 v[84:99], a[140:143], v[48:51], v[84:99]
    v_mfma_f32_32x32x16_bf16 v[32:47], v[48:51], v[180:183], v[32:47]
    s_nop 11
    v_mov_b32 v11, v32
    s_mov_b32 s66, 114688
    s_mov_b32 s71, 0x2000
    s_mov_b32 s36, s63
    s_mov_b32 s34, s63
    s_mul_i32 s58, s14, 9216
    s_mul_i32 s64, s63, 4718592
    s_add_u32 s64, s64, s58
    s_add_u32 s64, s64, 8650752
    s_mul_i32 s61, s63, 1441792
    s_add_u32 s61, s61, 3584
    s_mov_b32 s37, 0
    s_mov_b32 s40, 36864
    s_mov_b32 s59, s58
    s_mov_b32 s43, 0
    s_mov_b32 s62, 1
    s_mov_b32 s28, s8
    s_mov_b32 s29, s9
    s_mov_b32 s30, 0
    s_mov_b32 s31, 0x00020000
    v_mov_b32 v184, 74752
    v_mov_b32 v5, -1
    ds_write_b32 v184, v5
    s_waitcnt lgkmcnt(0)
    s_cmp_lg_u32 s14, 0
    s_cbranch_scc1 LpKV_inia_d
    v_mov_b32 v5, 40
    s_mov_b32 s16, 0
LpKV_inia:
    global_load_dword v6, v5, s[12:13] sc1
    s_add_u32 s16, s16, 1
    s_cmp_gt_u32 s16, 100000
    s_cbranch_scc1 L_role_p_abort
    s_waitcnt vmcnt(0)
    v_cmp_gt_u32 vcc, 72, v6
    s_nop 0
    s_cbranch_vccz LpKV_inia_d
    s_sleep 8
    s_branch LpKV_inia
LpKV_inia_d:
    s_barrier
    s_cmp_eq_u32 s63, 0
    s_cbranch_scc1 LpKV_ini_sk
    s_cmp_lg_u32 s14, 0
    s_cbranch_scc1 LpKV_inib_d
    v_mov_b32 v5, 160
    s_mov_b32 s16, 0
LpKV_inib:
    global_load_dword v6, v5, s[12:13] sc1
    s_add_u32 s16, s16, 1
    s_cmp_gt_u32 s16, 100000
    s_cbranch_scc1 L_role_p_abort
    s_waitcnt vmcnt(0)
    v_cmp_gt_u32 vcc, 64, v6
    s_nop 0
    s_cbranch_vccz LpKV_inib_d
    s_sleep 8
    s_branch LpKV_inib
LpKV_inib_d:
    s_barrier
LpKV_ini_sk:
    s_mul_i32 s41, s37, 36864
    s_add_u32 s41, s41, s64
    s_mul_i32 s60, s37, 22528
    s_add_u32 s60, s60, s61
    s_cmp_lt_u32 s37, 64
    s_cselect_b32 s60, s60, 2883584
    s_branch LpKV_wait
LpKV_head:
    s_waitcnt vmcnt(4)
LpKV_head2:
    s_barrier
    ds_read_b32 v15, v184
    s_xor_b32 s40, s40, 36864
    s_xor_b32 s59, s59, 36864
    s_mov_b32 s35, s37
    s_lshl_b32 s57, s34, 6
    s_add_u32 s57, s57, s35
    s_add_u32 s37, s37, 1
    s_mov_b32 s39, 0
    s_mov_b32 s54, 0
    s_xor_b32 s66, s66, 8192
    s_xor_b32 s71, s71, 8192
    s_mul_i32 s41, s37, 36864
    s_add_u32 s41, s41, s64
    s_mul_i32 s60, s37, 22528
    s_add_u32 s60, s60, s61
    s_cmp_lt_u32 s37, 64
    s_cselect_b32 s60, s60, 2883584
    v_add_u32 v9, s40, v0
    v_add_u32 v5, s71, v10
    ds_read_b128 v[48:51], v9 offset:0
    ds_read_b128 v[52:55], v9 offset:1024
    ds_read_b128 v[56:59], v9 offset:2048
    ds_read_b128 v[64:67], v5 offset:0
    ds_read_b128 v[68:71], v5 offset:512
    ds_read_b128 v[72:75], v5 offset:1024
    ds_read_b128 v[76:79], v5 offset:1536
    ds_read_b128 v[80:83], v5 offset:2048
    s_waitcnt lgkmcnt(7)
    v_mfma_f32_32x32x16_bf16 v[16:31], a[0:3], v[48:51], 0
    ds_read_b128 v[60:63], v9 offset:3072
    v_mfma_f32_32x32x16_bf16 v[32:47], v[48:51], a[144:147], 0
    s_waitcnt lgkmcnt(4)
    v_add_f32 v64, v64, v68
    v_add_f32 v65, v65, v69
    v_add_f32 v66, v66, v70
    v_add_f32 v67, v67, v71
    v_mfma_f32_32x32x16_bf16 v[16:31], a[4:7], v[52:55], v[16:31]
    ds_read_b128 v[48:51], v9 offset:4096
    s_waitcnt lgkmcnt(4)
    v_add_f32 v64, v64, v72
    v_add_f32 v65, v65, v73
    v_add_f32 v66, v66, v74
    v_mfma_f32_32x32x16_bf16 v[32:47], v[52:55], a[148:151], v[32:47]
    v_add_f32 v67, v67, v75
    s_waitcnt lgkmcnt(3)
    v_add_f32 v64, v64, v76
    v_add_f32 v65, v65, v77
    v_add_f32 v66, v66, v78
    v_readfirstlane_b32 s17, v15
    s_nop 0
    s_add_u32 s18, s17, 1
    s_max_i32 s32, s18, s37
    s_add_u32 s39, s37, 1
    s_min_u32 s39, s39, 63
    s_mul_i32 s33, s32, 22528
    s_add_u32 s33, s33, s61
    s_cmp_eq_u32 s14, 0
    s_cselect_b32 s18, s32, 0x7fff
    v_mov_b32 v2, 2
    s_cmp_le_u32 s18, s39
    s_cselect_b64 exec, -1, 0
    buffer_load_dword v2, v1, s[8:11], s33 offen sc1
    s_mov_b64 exec, -1
    s_cmp_ge_i32 s17, s37
    s_cbranch_scc1 LpKV_f_3
    v_mfma_f32_32x32x16_bf16 v[16:31], a[8:11], v[56:59], v[16:31]
    ds_read_b128 v[52:55], v9 offset:5120
    v_add_f32 v67, v67, v79
    s_waitcnt lgkmcnt(3)
    v_add_f32 v64, v64, v80
    v_add_f32 v65, v65, v81
    v_mfma_f32_32x32x16_bf16 v[32:47], v[56:59], a[152:155], v[32:47]
    v_add_f32 v66, v66, v82
    v_add_f32 v67, v67, v83
    v_add_f32 v64, v64, v66
    v_add_f32 v65, v65, v67
    s_waitcnt lgkmcnt(2)
    v_mfma_f32_32x32x16_bf16 v[16:31], a[12:15], v[60:63], v[16:31]
    ds_read_b128 v[56:59], v9 offset:6144
    v_mov_b32 v66, v64
    v_mov_b32 v67, v65
    s_nop 0
    v_permlane32_swap_b32 v64, v66
    v_mfma_f32_32x32x16_bf16 v[32:47], v[60:63], a[156:159], v[32:47]
    v_permlane32_swap_b32 v65, v67
    v_add_f32 v64, v64, v66
    v_add_f32 v65, v65, v67
    v_mul_f32 v64, 0x3ae38e39, v64
    s_waitcnt lgkmcnt(2)
    v_mfma_f32_32x32x16_bf16 v[16:31], a[16:19], v[48:51], v[16:31]
    ds_read_b128 v[60:63], v9 offset:7168
    v_mul_f32 v65, 0x3ae38e39, v65
    v_fma_f32 v65, -v64, v64, v65
    v_max_f32 v65, 0, v65
    v_mfma_f32_32x32x16_bf16 v[32:47], v[48:51], a[160:163], v[32:47]
    v_add_f32 v65, 0x3727c5ac, v65
    v_rsq_f32 v148, v65
    s_nop 0
    v_mul_f32 v149, v64, v148
    v_mul_f32 v100, v149, v84
    s_waitcnt lgkmcnt(2)
    v_mfma_f32_32x32x16_bf16 v[16:31], a[20:23], v[52:55], v[16:31]
    ds_read_b128 v[48:51], v9 offset:8192
    v_mul_f32 v101, v149, v85
    v_mul_f32 v102, v149, v86
    v_mul_f32 v103, v149, v87
    v_mfma_f32_32x32x16_bf16 v[32:47], v[52:55], a[164:167], v[32:47]
    v_mul_f32 v104, v149, v88
    v_mul_f32 v105, v149, v89
    v_mul_f32 v106, v149, v90
    v_mul_f32 v107, v149, v91
    s_waitcnt lgkmcnt(2)
    v_mfma_f32_32x32x16_bf16 v[16:31], a[24:27], v[56:59], v[16:31]
    ds_read_b128 v[52:55], v9 offset:9216
    v_mul_f32 v108, v149, v92
    v_mul_f32 v109, v149, v93
    v_mul_f32 v110, v149, v94
    v_mfma_f32_32x32x16_bf16 v[32:47], v[56:59], a[168:171], v[32:47]
    v_mul_f32 v111, v149, v95
    v_mul_f32 v112, v149, v96
    v_mul_f32 v113, v149, v97
    v_mul_f32 v114, v149, v98
    s_waitcnt lgkmcnt(2)
    v_mfma_f32_32x32x16_bf16 v[16:31], a[28:31], v[60:63], v[16:31]
    ds_read_b128 v[56:59], v9 offset:10240
    v_mul_f32 v115, v149, v99
    ds_write2_b32 v12, v148, v149 offset0:0 offset1:32
    ds_read_b128 v[116:119], v13 offset:0
    v_mfma_f32_32x32x16_bf16 v[32:47], v[60:63], a[172:175], v[32:47]
    ds_read_b128 v[120:123], v13 offset:32
    ds_read_b128 v[124:127], v13 offset:64
    ds_read_b128 v[128:131], v13 offset:96
    ds_read_b128 v[132:135], v13 offset:128
    s_waitcnt lgkmcnt(8)
    v_mfma_f32_32x32x16_bf16 v[16:31], a[32:35], v[48:51], v[16:31]
    ds_read_b128 v[60:63], v9 offset:11264
    ds_read_b128 v[136:139], v13 offset:160
    ds_read_b128 v[140:143], v13 offset:192
    ds_read_b128 v[144:147], v13 offset:224
    v_mfma_f32_32x32x16_bf16 v[32:47], v[48:51], a[176:179], v[32:47]
    s_waitcnt lgkmcnt(11)
    v_mfma_f32_32x32x16_bf16 v[16:31], a[36:39], v[52:55], v[16:31]
    ds_read_b128 v[48:51], v9 offset:12288
    v_mfma_f32_32x32x16_bf16 v[32:47], v[52:55], a[180:183], v[32:47]
    s_waitcnt lgkmcnt(5)
    v_mul_f32 v132, v11, v132
    v_mul_f32 v133, v11, v133
    v_mfma_f32_32x32x16_bf16 v[16:31], a[40:43], v[56:59], v[16:31]
    ds_read_b128 v[52:55], v9 offset:13312
    v_mul_f32 v134, v11, v134
    v_mul_f32 v135, v11, v135
    s_waitcnt lgkmcnt(4)
    v_mul_f32 v136, v11, v136
    v_mfma_f32_32x32x16_bf16 v[32:47], v[56:59], a[184:187], v[32:47]
    v_mul_f32 v137, v11, v137
    v_mul_f32 v138, v11, v138
    v_mul_f32 v139, v11, v139
    s_waitcnt lgkmcnt(3)
    v_mul_f32 v140, v11, v140
    v_mfma_f32_32x32x16_bf16 v[16:31], a[44:47], v[60:63], v[16:31]
    ds_read_b128 v[56:59], v9 offset:14336
    v_mul_f32 v141, v11, v141
    v_mul_f32 v142, v11, v142
    v_mul_f32 v143, v11, v143
    v_mfma_f32_32x32x16_bf16 v[32:47], v[60:63], a[188:191], v[32:47]
    s_waitcnt lgkmcnt(3)
    v_mul_f32 v144, v11, v144
    v_mul_f32 v145, v11, v145
    v_mul_f32 v146, v11, v146
    v_mul_f32 v147, v11, v147
    s_waitcnt lgkmcnt(2)
    v_mfma_f32_32x32x16_bf16 v[16:31], a[48:51], v[48:51], v[16:31]
    ds_read_b128 v[60:63], v9 offset:15360
    s_mul_i32 s46, s34, 50331648
    s_lshl_b32 s51, s35, 18
    s_add_u32 s46, s46, s51
    v_mfma_f32_32x32x16_bf16 v[32:47], v[48:51], a[192:195], v[32:47]
    s_add_u32 s46, s46, s52
    s_waitcnt vmcnt(1)
    s_cmp_lg_u32 s43, 0
    s_cselect_b64 exec, 3, 0
    buffer_store_dword v3, v185, s[8:11], s43 offen sc1
    s_mov_b64 exec, -1
    s_mov_b32 s43, 0
    s_waitcnt lgkmcnt(2)
    v_mfma_f32_32x32x16_bf16 v[16:31], a[52:55], v[52:55], v[16:31]
    ds_read_b128 v[48:51], v9 offset:16384
    v_mfma_f32_32x32x16_bf16 v[32:47], v[52:55], a[196:199], v[32:47]
    s_waitcnt lgkmcnt(2)
    v_mfma_f32_32x32x16_bf16 v[16:31], a[56:59], v[56:59], v[16:31]
    v_cmp_eq_u32 s[76:77], 1, v2
    v_cmp_eq_u32 vcc, 2, v2
    s_cmp_eq_u64 s[76:77], -1
    s_cselect_b32 s38, 1, 0
    ds_read_b128 v[52:55], v9 offset:17408
    v_mfma_f32_32x32x16_bf16 v[32:47], v[56:59], a[200:203], v[32:47]
    s_cmp_lg_u32 s38, 0
    s_cselect_b64 exec, 1, 0
    v_mov_b32 v15, s32
    ds_write_b32 v184, v15
    v_mov_b32 v2, 2
    s_mov_b64 exec, -1
    s_waitcnt lgkmcnt(3)
    v_mfma_f32_32x32x16_bf16 v[16:31], a[60:63], v[60:63], v[16:31]
    s_add_u32 s32, s32, s38
    s_mul_i32 s38, s38, 22528
    s_add_u32 s33, s33, s38
    ds_read_b128 v[56:59], v9 offset:18432
    v_mfma_f32_32x32x16_bf16 v[32:47], v[60:63], a[204:207], v[32:47]
    s_cmp_eq_u64 vcc, 0
    s_cselect_b32 s38, s32, 0x7fff
    s_waitcnt lgkmcnt(3)
    v_mfma_f32_32x32x16_bf16 v[16:31], a[64:67], v[48:51], v[16:31]
    ds_read_b128 v[60:63], v9 offset:19456
    v_mfma_f32_32x32x16_bf16 v[32:47], v[48:51], a[208:211], v[32:47]
    s_cmp_le_u32 s38, s39
    s_cselect_b64 exec, -1, 0
    v_mov_b32 v2, 2
    buffer_load_dword v2, v1, s[8:11], s33 offen sc1
    s_mov_b64 exec, -1
    ds_read_b32 v15, v184
    s_waitcnt lgkmcnt(4)
    v_mfma_f32_32x32x16_bf16 v[16:31], a[68:71], v[52:55], v[16:31]
    ds_read_b128 v[48:51], v9 offset:20480
    v_mfma_f32_32x32x16_bf16 v[32:47], v[52:55], a[212:215], v[32:47]
    s_waitcnt lgkmcnt(3)
    v_mfma_f32_32x32x16_bf16 v[16:31], a[72:75], v[56:59], v[16:31]
    ds_read_b128 v[52:55], v9 offset:21504
    v_mfma_f32_32x32x16_bf16 v[32:47], v[56:59], a[216:219], v[32:47]
    s_waitcnt lgkmcnt(2)
    v_readfirstlane_b32 s17, v15
    s_nop 0
    s_cmp_ge_i32 s17, s37
    s_cbranch_scc1 LpKV_f_4
    v_mfma_f32_32x32x16_bf16 v[16:31], a[76:79], v[60:63], v[16:31]
    ds_read_b128 v[56:59], v9 offset:22528
    v_mfma_f32_32x32x16_bf16 v[32:47], v[60:63], a[220:223], v[32:47]
    s_waitcnt lgkmcnt(2)
    v_mfma_f32_32x32x16_bf16 v[16:31], a[80:83], v[48:51], v[16:31]
    ds_read_b128 v[60:63], v9 offset:23552
    v_mfma_f32_32x32x16_bf16 v[32:47], v[48:51], a[224:227], v[32:47]
    s_waitcnt lgkmcnt(2)
    v_mfma_f32_32x32x16_bf16 v[16:31], a[84:87], v[52:55], v[16:31]
    ds_read_b128 v[48:51], v9 offset:24576
    v_mfma_f32_32x32x16_bf16 v[32:47], v[52:55], a[228:231], v[32:47]
    s_waitcnt lgkmcnt(2)
    v_mfma_f32_32x32x16_bf16 v[16:31], a[88:91], v[56:59], v[16:31]
    ds_read_b128 v[52:55], v9 offset:25600
    v_mfma_f32_32x32x16_bf16 v[32:47], v[56:59], a[232:235], v[32:47]
    s_waitcnt lgkmcnt(2)
    v_mfma_f32_32x32x16_bf16 v[16:31], a[92:95], v[60:63], v[16:31]
    ds_read_b128 v[56:59], v9 offset:26624
    v_mfma_f32_32x32x16_bf16 v[32:47], v[60:63], a[236:239], v[32:47]
    s_waitcnt lgkmcnt(2)
    v_mfma_f32_32x32x16_bf16 v[16:31], a[96:99], v[48:51], v[16:31]
    ds_read_b128 v[60:63], v9 offset:27648
    v_mfma_f32_32x32x16_bf16 v[32:47], v[48:51], a[240:243], v[32:47]
    s_waitcnt lgkmcnt(2)
    v_mfma_f32_32x32x16_bf16 v[16:31], a[100:103], v[52:55], v[16:31]
    ds_read_b128 v[48:51], v9 offset:28672
    v_mfma_f32_32x32x16_bf16 v[32:47], v[52:55], a[244:247], v[32:47]
    s_waitcnt lgkmcnt(2)
    v_mfma_f32_32x32x16_bf16 v[16:31], a[104:107], v[56:59], v[16:31]
    ds_read_b128 v[52:55], v9 offset:29696
    v_mfma_f32_32x32x16_bf16 v[32:47], v[56:59], a[248:251], v[32:47]
    s_waitcnt lgkmcnt(2)
    v_mfma_f32_32x32x16_bf16 v[16:31], a[108:111], v[60:63], v[16:31]
    ds_read_b128 v[56:59], v9 offset:30720
    v_mfma_f32_32x32x16_bf16 v[32:47], v[60:63], a[252:255], v[32:47]
    s_waitcnt lgkmcnt(2)
    v_mfma_f32_32x32x16_bf16 v[16:31], a[112:115], v[48:51], v[16:31]
    ds_read_b128 v[60:63], v9 offset:31744
    v_mfma_f32_32x32x16_bf16 v[32:47], v[48:51], v[152:155], v[32:47]
    s_waitcnt lgkmcnt(2)
    v_mfma_f32_32x32x16_bf16 v[16:31], a[116:119], v[52:55], v[16:31]
    ds_read_b128 v[48:51], v9 offset:32768
    v_mfma_f32_32x32x16_bf16 v[32:47], v[52:55], v[156:159], v[32:47]
    s_waitcnt lgkmcnt(2)
    v_mfma_f32_32x32x16_bf16 v[16:31], a[120:123], v[56:59], v[16:31]
    ds_read_b128 v[52:55], v9 offset:33792
    v_mfma_f32_32x32x16_bf16 v[32:47], v[56:59], v[160:163], v[32:47]
    s_waitcnt lgkmcnt(2)
    v_mfma_f32_32x32x16_bf16 v[16:31], a[124:127], v[60:63], v[16:31]
    v_cmp_eq_u32 s[76:77], 1, v2
    v_cmp_eq_u32 vcc, 2, v2
    s_cmp_eq_u64 s[76:77], -1
    s_cselect_b32 s38, 1, 0
    ds_read_b128 v[56:59], v9 offset:34816
    v_mfma_f32_32x32x16_bf16 v[32:47], v[60:63], v[164:167], v[32:47]
    s_cmp_lg_u32 s38, 0
    s_cselect_b64 exec, 1, 0
    v_mov_b32 v15, s32
    ds_write_b32 v184, v15
    v_mov_b32 v2, 2
    s_mov_b64 exec, -1
    s_waitcnt lgkmcnt(3)
    v_mfma_f32_32x32x16_bf16 v[16:31], a[128:131], v[48:51], v[16:31]
    s_add_u32 s32, s32, s38
    s_mul_i32 s38, s38, 22528
    s_add_u32 s33, s33, s38
    ds_read_b128 v[60:63], v9 offset:35840
    v_mfma_f32_32x32x16_bf16 v[32:47], v[48:51], v[168:171], v[32:47]
    s_cmp_eq_u64 vcc, 0
    s_cselect_b32 s38, s32, 0x7fff
    s_waitcnt lgkmcnt(3)
    v_mfma_f32_32x32x16_bf16 v[16:31], a[132:135], v[52:55], v[16:31]
    s_cmp_le_u32 s38, s39
    s_cselect_b64 exec, -1, 0
    v_mov_b32 v2, 2
    buffer_load_dword v2, v1, s[8:11], s33 offen sc1
    s_mov_b64 exec, -1
    v_mfma_f32_32x32x16_bf16 v[32:47], v[52:55], v[172:175], v[32:47]
    s_waitcnt lgkmcnt(2)
    v_mfma_f32_32x32x16_bf16 v[16:31], a[136:139], v[56:59], v[16:31]
    v_mfma_f32_32x32x16_bf16 v[32:47], v[56:59], v[176:179], v[32:47]
    s_waitcnt lgkmcnt(0)
    v_mfma_f32_32x32x16_bf16 v[16:31], a[140:143], v[60:63], v[16:31]
    v_mfma_f32_32x32x16_bf16 v[32:47], v[60:63], v[180:183], v[32:47]
    s_add_u32 s51, s46, 16777216
    s_nop 2
    v_pk_fma_f32 v[16:17], v[16:17], v[148:149], v[100:101] op_sel_hi:[1,0,1] neg_lo:[0,0,1] neg_hi:[0,0,1]
    v_pk_fma_f32 v[18:19], v[18:19], v[148:149], v[102:103] op_sel_hi:[1,0,1] neg_lo:[0,0,1] neg_hi:[0,0,1]
    v_pk_fma_f32 v[20:21], v[20:21], v[148:149], v[104:105] op_sel_hi:[1,0,1] neg_lo:[0,0,1] neg_hi:[0,0,1]
    v_pk_fma_f32 v[22:23], v[22:23], v[148:149], v[106:107] op_sel_hi:[1,0,1] neg_lo:[0,0,1] neg_hi:[0,0,1]
    v_pk_fma_f32 v[24:25], v[24:25], v[148:149], v[108:109] op_sel_hi:[1,0,1] neg_lo:[0,0,1] neg_hi:[0,0,1]
    v_pk_fma_f32 v[26:27], v[26:27], v[148:149], v[110:111] op_sel_hi:[1,0,1] neg_lo:[0,0,1] neg_hi:[0,0,1]
    v_pk_fma_f32 v[28:29], v[28:29], v[148:149], v[112:113] op_sel_hi:[1,0,1] neg_lo:[0,0,1] neg_hi:[0,0,1]
    v_pk_fma_f32 v[30:31], v[30:31], v[148:149], v[114:115] op_sel_hi:[1,0,1] neg_lo:[0,0,1] neg_hi:[0,0,1]
    v_cvt_pk_bf16_f32 v188, v16, v24
    v_cvt_pk_bf16_f32 v189, v17, v25
    v_cvt_pk_bf16_f32 v190, v18, v26
    v_cvt_pk_bf16_f32 v191, v19, v27
    buffer_store_dwordx4 v[188:191], v14, s[8:11], s46 offen offset:0 sc1
    v_cvt_pk_bf16_f32 v192, v20, v28
    v_cvt_pk_bf16_f32 v193, v21, v29
    v_cvt_pk_bf16_f32 v194, v22, v30
    v_cvt_pk_bf16_f32 v195, v23, v31
    buffer_store_dwordx4 v[192:195], v14, s[8:11], s46 offen offset:512 sc1
    v_pk_fma_f32 v[32:33], v[32:33], v[116:117], v[132:133] neg_lo:[0,0,1] neg_hi:[0,0,1]
    v_pk_fma_f32 v[34:35], v[34:35], v[118:119], v[134:135] neg_lo:[0,0,1] neg_hi:[0,0,1]
    v_pk_fma_f32 v[36:37], v[36:37], v[120:121], v[136:137] neg_lo:[0,0,1] neg_hi:[0,0,1]
    v_pk_fma_f32 v[38:39], v[38:39], v[122:123], v[138:139] neg_lo:[0,0,1] neg_hi:[0,0,1]
    v_pk_fma_f32 v[40:41], v[40:41], v[124:125], v[140:141] neg_lo:[0,0,1] neg_hi:[0,0,1]
    v_pk_fma_f32 v[42:43], v[42:43], v[126:127], v[142:143] neg_lo:[0,0,1] neg_hi:[0,0,1]
    v_pk_fma_f32 v[44:45], v[44:45], v[128:129], v[144:145] neg_lo:[0,0,1] neg_hi:[0,0,1]
    v_pk_fma_f32 v[46:47], v[46:47], v[130:131], v[146:147] neg_lo:[0,0,1] neg_hi:[0,0,1]
    v_cvt_pk_bf16_f32 v196, v32, v33
    v_cvt_pk_bf16_f32 v197, v34, v35
    v_cvt_pk_bf16_f32 v198, v40, v41
    v_cvt_pk_bf16_f32 v199, v42, v43
    buffer_store_dwordx4 v[196:199], v14, s[8:11], s51 offen offset:0 sc1
    v_cvt_pk_bf16_f32 v200, v36, v37
    v_cvt_pk_bf16_f32 v201, v38, v39
    v_cvt_pk_bf16_f32 v202, v44, v45
    v_cvt_pk_bf16_f32 v203, v46, v47
    buffer_store_dwordx4 v[200:203], v14, s[8:11], s51 offen offset:512 sc1
    s_mul_i32 s43, s57, 22528
    s_add_u32 s43, s43, s49
    s_branch LpKV_none
LpKV_f_3:
    v_mfma_f32_32x32x16_bf16 v[16:31], a[8:11], v[56:59], v[16:31]
    ds_read_b128 v[52:55], v9 offset:5120
    v_add_f32 v67, v67, v79
    s_waitcnt lgkmcnt(3)
    v_add_f32 v64, v64, v80
    v_add_f32 v65, v65, v81
    v_mfma_f32_32x32x16_bf16 v[32:47], v[56:59], a[152:155], v[32:47]
    v_add_f32 v66, v66, v82
    v_add_f32 v67, v67, v83
    v_add_f32 v64, v64, v66
    v_add_f32 v65, v65, v67
    s_waitcnt lgkmcnt(2)
    v_mfma_f32_32x32x16_bf16 v[16:31], a[12:15], v[60:63], v[16:31]
    ds_read_b128 v[56:59], v9 offset:6144
    v_mov_b32 v66, v64
    v_mov_b32 v67, v65
    s_nop 0
    v_permlane32_swap_b32 v64, v66
    v_mfma_f32_32x32x16_bf16 v[32:47], v[60:63], a[156:159], v[32:47]
    v_permlane32_swap_b32 v65, v67
    v_add_f32 v64, v64, v66
    v_add_f32 v65, v65, v67
    v_mul_f32 v64, 0x3ae38e39, v64
    s_waitcnt lgkmcnt(2)
    v_mfma_f32_32x32x16_bf16 v[16:31], a[16:19], v[48:51], v[16:31]
    ds_read_b128 v[60:63], v9 offset:7168
    v_mul_f32 v65, 0x3ae38e39, v65
    v_fma_f32 v65, -v64, v64, v65
    v_max_f32 v65, 0, v65
    v_mfma_f32_32x32x16_bf16 v[32:47], v[48:51], a[160:163], v[32:47]
    v_add_f32 v65, 0x3727c5ac, v65
    v_rsq_f32 v148, v65
    s_nop 0
    v_mul_f32 v149, v64, v148
    v_mul_f32 v100, v149, v84
    s_waitcnt lgkmcnt(2)
    v_mfma_f32_32x32x16_bf16 v[16:31], a[20:23], v[52:55], v[16:31]
    ds_read_b128 v[48:51], v9 offset:8192
    v_mul_f32 v101, v149, v85
    v_mul_f32 v102, v149, v86
    v_mul_f32 v103, v149, v87
    v_mfma_f32_32x32x16_bf16 v[32:47], v[52:55], a[164:167], v[32:47]
    v_mul_f32 v104, v149, v88
    v_mul_f32 v105, v149, v89
    v_mul_f32 v106, v149, v90
    v_mul_f32 v107, v149, v91
    s_waitcnt lgkmcnt(2)
    v_mfma_f32_32x32x16_bf16 v[16:31], a[24:27], v[56:59], v[16:31]
    ds_read_b128 v[52:55], v9 offset:9216
    v_mul_f32 v108, v149, v92
    v_mul_f32 v109, v149, v93
    v_mul_f32 v110, v149, v94
    v_mfma_f32_32x32x16_bf16 v[32:47], v[56:59], a[168:171], v[32:47]
    v_mul_f32 v111, v149, v95
    v_mul_f32 v112, v149, v96
    v_mul_f32 v113, v149, v97
    v_mul_f32 v114, v149, v98
    s_waitcnt lgkmcnt(2)
    v_mfma_f32_32x32x16_bf16 v[16:31], a[28:31], v[60:63], v[16:31]
    ds_read_b128 v[56:59], v9 offset:10240
    v_mul_f32 v115, v149, v99
    ds_write2_b32 v12, v148, v149 offset0:0 offset1:32
    ds_read_b128 v[116:119], v13 offset:0
    v_mfma_f32_32x32x16_bf16 v[32:47], v[60:63], a[172:175], v[32:47]
    ds_read_b128 v[120:123], v13 offset:32
    ds_read_b128 v[124:127], v13 offset:64
    ds_read_b128 v[128:131], v13 offset:96
    ds_read_b128 v[132:135], v13 offset:128
    s_waitcnt lgkmcnt(8)
    v_mfma_f32_32x32x16_bf16 v[16:31], a[32:35], v[48:51], v[16:31]
    ds_read_b128 v[60:63], v9 offset:11264
    ds_read_b128 v[136:139], v13 offset:160
    ds_read_b128 v[140:143], v13 offset:192
    ds_read_b128 v[144:147], v13 offset:224
    v_mfma_f32_32x32x16_bf16 v[32:47], v[48:51], a[176:179], v[32:47]
    s_add_u32 m0, s59, 0
    s_add_u32 s47, s41, 0
    buffer_load_dwordx4 v0, s[8:11], s47 offen offset:0 lds
    buffer_load_dwordx4 v0, s[8:11], s47 offen offset:1024 lds
    buffer_load_dwordx4 v0, s[8:11], s47 offen offset:2048 lds
    s_waitcnt lgkmcnt(11)
    v_mfma_f32_32x32x16_bf16 v[16:31], a[36:39], v[52:55], v[16:31]
    buffer_load_dwordx4 v0, s[8:11], s47 offen offset:3072 lds
    s_add_u32 m0, s59, 4096
    s_add_u32 s47, s41, 4096
    buffer_load_dwordx4 v0, s[8:11], s47 offen offset:0 lds
    ds_read_b128 v[48:51], v9 offset:12288
    v_mfma_f32_32x32x16_bf16 v[32:47], v[52:55], a[180:183], v[32:47]
    buffer_load_dwordx4 v0, s[8:11], s47 offen offset:1024 lds
    buffer_load_dwordx4 v0, s[8:11], s47 offen offset:2048 lds
    buffer_load_dwordx4 v0, s[8:11], s47 offen offset:3072 lds
    s_waitcnt lgkmcnt(5)
    v_mul_f32 v132, v11, v132
    v_mul_f32 v133, v11, v133
    v_mfma_f32_32x32x16_bf16 v[16:31], a[40:43], v[56:59], v[16:31]
    ds_read_b128 v[52:55], v9 offset:13312
    v_mul_f32 v134, v11, v134
    v_mul_f32 v135, v11, v135
    s_waitcnt lgkmcnt(4)
    v_mul_f32 v136, v11, v136
    v_mfma_f32_32x32x16_bf16 v[32:47], v[56:59], a[184:187], v[32:47]
    v_mul_f32 v137, v11, v137
    v_mul_f32 v138, v11, v138
    v_mul_f32 v139, v11, v139
    s_waitcnt lgkmcnt(3)
    v_mul_f32 v140, v11, v140
    v_mfma_f32_32x32x16_bf16 v[16:31], a[44:47], v[60:63], v[16:31]
    ds_read_b128 v[56:59], v9 offset:14336
    v_mul_f32 v141, v11, v141
    v_mul_f32 v142, v11, v142
    v_mul_f32 v143, v11, v143
    v_mfma_f32_32x32x16_bf16 v[32:47], v[60:63], a[188:191], v[32:47]
    s_waitcnt lgkmcnt(3)
    v_mul_f32 v144, v11, v144
    v_mul_f32 v145, v11, v145
    v_mul_f32 v146, v11, v146
    v_mul_f32 v147, v11, v147
    s_waitcnt lgkmcnt(2)
    v_mfma_f32_32x32x16_bf16 v[16:31], a[48:51], v[48:51], v[16:31]
    ds_read_b128 v[60:63], v9 offset:15360
    s_mul_i32 s46, s34, 50331648
    s_lshl_b32 s51, s35, 18
    s_add_u32 s46, s46, s51
    v_mfma_f32_32x32x16_bf16 v[32:47], v[48:51], a[192:195], v[32:47]
    s_add_u32 m0, s59, 8192
    s_add_u32 s47, s41, 8192
    buffer_load_dwordx4 v0, s[8:11], s47 offen offset:0 lds
    s_add_u32 s46, s46, s52
    s_waitcnt vmcnt(10)
    s_cmp_lg_u32 s43, 0
    s_cselect_b64 exec, 3, 0
    buffer_store_dword v3, v185, s[8:11], s43 offen sc1
    s_mov_b64 exec, -1
    s_mov_b32 s43, 0
    s_waitcnt lgkmcnt(2)
    v_mfma_f32_32x32x16_bf16 v[16:31], a[52:55], v[52:55], v[16:31]
    s_mul_i32 s48, s36, 786432
    s_mul_i32 s18, s37, 6144
    s_add_u32 s48, s48, s18
    s_add_u32 s48, s48, 16125952
    s_add_u32 m0, s66, 4096
    s_nop 0
    buffer_load_dwordx4 v0, s[8:11], s48 offen lds
    ds_read_b128 v[48:51], v9 offset:16384
    v_mfma_f32_32x32x16_bf16 v[32:47], v[52:55], a[196:199], v[32:47]
    s_add_u32 m0, s66, s67
    s_sub_u32 s48, s48, 4096
    s_add_u32 s48, s48, s67
    buffer_load_dwordx4 v0, s[8:11], s48 offen lds
    s_waitcnt lgkmcnt(2)
    v_mfma_f32_32x32x16_bf16 v[16:31], a[56:59], v[56:59], v[16:31]
    v_cmp_eq_u32 s[76:77], 1, v2
    v_cmp_eq_u32 vcc, 2, v2
    s_cmp_eq_u64 s[76:77], -1
    s_cselect_b32 s38, 1, 0
    ds_read_b128 v[52:55], v9 offset:17408
    v_mfma_f32_32x32x16_bf16 v[32:47], v[56:59], a[200:203], v[32:47]
    s_cmp_lg_u32 s38, 0
    s_cselect_b64 exec, 1, 0
    v_mov_b32 v15, s32
    ds_write_b32 v184, v15
    v_mov_b32 v2, 2
    s_mov_b64 exec, -1
    s_waitcnt lgkmcnt(3)
    v_mfma_f32_32x32x16_bf16 v[16:31], a[60:63], v[60:63], v[16:31]
    s_add_u32 s32, s32, s38
    s_mul_i32 s38, s38, 22528
    s_add_u32 s33, s33, s38
    ds_read_b128 v[56:59], v9 offset:18432
    v_mfma_f32_32x32x16_bf16 v[32:47], v[60:63], a[204:207], v[32:47]
    s_cmp_eq_u64 vcc, 0
    s_cselect_b32 s38, s32, 0x7fff
    s_waitcnt lgkmcnt(3)
    v_mfma_f32_32x32x16_bf16 v[16:31], a[64:67], v[48:51], v[16:31]
    ds_read_b128 v[60:63], v9 offset:19456
    v_mfma_f32_32x32x16_bf16 v[32:47], v[48:51], a[208:211], v[32:47]
    s_cmp_le_u32 s38, s39
    s_cselect_b64 exec, -1, 0
    v_mov_b32 v2, 2
    buffer_load_dword v2, v1, s[8:11], s33 offen sc1
    s_mov_b64 exec, -1
    s_waitcnt lgkmcnt(3)
    v_mfma_f32_32x32x16_bf16 v[16:31], a[68:71], v[52:55], v[16:31]
    ds_read_b128 v[48:51], v9 offset:20480
    v_mfma_f32_32x32x16_bf16 v[32:47], v[52:55], a[212:215], v[32:47]
    s_waitcnt lgkmcnt(2)
    v_mfma_f32_32x32x16_bf16 v[16:31], a[72:75], v[56:59], v[16:31]
    ds_read_b128 v[52:55], v9 offset:21504
    v_mfma_f32_32x32x16_bf16 v[32:47], v[56:59], a[216:219], v[32:47]
    s_waitcnt lgkmcnt(2)
    v_mfma_f32_32x32x16_bf16 v[16:31], a[76:79], v[60:63], v[16:31]
    ds_read_b128 v[56:59], v9 offset:22528
    v_mfma_f32_32x32x16_bf16 v[32:47], v[60:63], a[220:223], v[32:47]
    s_waitcnt lgkmcnt(2)
    v_mfma_f32_32x32x16_bf16 v[16:31], a[80:83], v[48:51], v[16:31]
    ds_read_b128 v[60:63], v9 offset:23552
    v_mfma_f32_32x32x16_bf16 v[32:47], v[48:51], a[224:227], v[32:47]
    s_waitcnt lgkmcnt(2)
    v_mfma_f32_32x32x16_bf16 v[16:31], a[84:87], v[52:55], v[16:31]
    ds_read_b128 v[48:51], v9 offset:24576
    v_mfma_f32_32x32x16_bf16 v[32:47], v[52:55], a[228:231], v[32:47]
    s_waitcnt lgkmcnt(2)
    v_mfma_f32_32x32x16_bf16 v[16:31], a[88:91], v[56:59], v[16:31]
    ds_read_b128 v[52:55], v9 offset:25600
    v_mfma_f32_32x32x16_bf16 v[32:47], v[56:59], a[232:235], v[32:47]
    s_waitcnt lgkmcnt(2)
    v_mfma_f32_32x32x16_bf16 v[16:31], a[92:95], v[60:63], v[16:31]
    ds_read_b128 v[56:59], v9 offset:26624
    v_mfma_f32_32x32x16_bf16 v[32:47], v[60:63], a[236:239], v[32:47]
    s_waitcnt lgkmcnt(2)
    v_mfma_f32_32x32x16_bf16 v[16:31], a[96:99], v[48:51], v[16:31]
    ds_read_b128 v[60:63], v9 offset:27648
    v_mfma_f32_32x32x16_bf16 v[32:47], v[48:51], a[240:243], v[32:47]
    s_waitcnt lgkmcnt(2)
    v_mfma_f32_32x32x16_bf16 v[16:31], a[100:103], v[52:55], v[16:31]
    ds_read_b128 v[48:51], v9 offset:28672
    v_mfma_f32_32x32x16_bf16 v[32:47], v[52:55], a[244:247], v[32:47]
    s_waitcnt lgkmcnt(2)
    v_mfma_f32_32x32x16_bf16 v[16:31], a[104:107], v[56:59], v[16:31]
    ds_read_b128 v[52:55], v9 offset:29696
    v_mfma_f32_32x32x16_bf16 v[32:47], v[56:59], a[248:251], v[32:47]
    s_waitcnt lgkmcnt(2)
    v_mfma_f32_32x32x16_bf16 v[16:31], a[108:111], v[60:63], v[16:31]
    ds_read_b128 v[56:59], v9 offset:30720
    v_mfma_f32_32x32x16_bf16 v[32:47], v[60:63], a[252:255], v[32:47]
    s_waitcnt lgkmcnt(2)
    v_mfma_f32_32x32x16_bf16 v[16:31], a[112:115], v[48:51], v[16:31]
    ds_read_b128 v[60:63], v9 offset:31744
    v_mfma_f32_32x32x16_bf16 v[32:47], v[48:51], v[152:155], v[32:47]
    s_waitcnt lgkmcnt(2)
    v_mfma_f32_32x32x16_bf16 v[16:31], a[116:119], v[52:55], v[16:31]
    ds_read_b128 v[48:51], v9 offset:32768
    v_mfma_f32_32x32x16_bf16 v[32:47], v[52:55], v[156:159], v[32:47]
    s_waitcnt lgkmcnt(2)
    v_mfma_f32_32x32x16_bf16 v[16:31], a[120:123], v[56:59], v[16:31]
    ds_read_b128 v[52:55], v9 offset:33792
    v_mfma_f32_32x32x16_bf16 v[32:47], v[56:59], v[160:163], v[32:47]
    s_waitcnt lgkmcnt(2)
    v_mfma_f32_32x32x16_bf16 v[16:31], a[124:127], v[60:63], v[16:31]
    v_cmp_eq_u32 s[76:77], 1, v2
    v_cmp_eq_u32 vcc, 2, v2
    s_cmp_eq_u64 s[76:77], -1
    s_cselect_b32 s38, 1, 0
    ds_read_b128 v[56:59], v9 offset:34816
    v_mfma_f32_32x32x16_bf16 v[32:47], v[60:63], v[164:167], v[32:47]
    s_cmp_lg_u32 s38, 0
    s_cselect_b64 exec, 1, 0
    v_mov_b32 v15, s32
    ds_write_b32 v184, v15
    v_mov_b32 v2, 2
    s_mov_b64 exec, -1
    s_waitcnt lgkmcnt(3)
    v_mfma_f32_32x32x16_bf16 v[16:31], a[128:131], v[48:51], v[16:31]
    s_add_u32 s32, s32, s38
    s_mul_i32 s38, s38, 22528
    s_add_u32 s33, s33, s38
    ds_read_b128 v[60:63], v9 offset:35840
    v_mfma_f32_32x32x16_bf16 v[32:47], v[48:51], v[168:171], v[32:47]
    s_cmp_eq_u64 vcc, 0
    s_cselect_b32 s38, s32, 0x7fff
    s_waitcnt lgkmcnt(3)
    v_mfma_f32_32x32x16_bf16 v[16:31], a[132:135], v[52:55], v[16:31]
    s_cmp_le_u32 s38, s39
    s_cselect_b64 exec, -1, 0
    v_mov_b32 v2, 2
    buffer_load_dword v2, v1, s[8:11], s33 offen sc1
    s_mov_b64 exec, -1
    v_mfma_f32_32x32x16_bf16 v[32:47], v[52:55], v[172:175], v[32:47]
    s_waitcnt lgkmcnt(2)
    v_mfma_f32_32x32x16_bf16 v[16:31], a[136:139], v[56:59], v[16:31]
    v_mfma_f32_32x32x16_bf16 v[32:47], v[56:59], v[176:179], v[32:47]
    s_waitcnt lgkmcnt(0)
    v_mfma_f32_32x32x16_bf16 v[16:31], a[140:143], v[60:63], v[16:31]
    v_mfma_f32_32x32x16_bf16 v[32:47], v[60:63], v[180:183], v[32:47]
    s_add_u32 s51, s46, 16777216
    s_nop 2
    v_pk_fma_f32 v[16:17], v[16:17], v[148:149], v[100:101] op_sel_hi:[1,0,1] neg_lo:[0,0,1] neg_hi:[0,0,1]
    v_pk_fma_f32 v[18:19], v[18:19], v[148:149], v[102:103] op_sel_hi:[1,0,1] neg_lo:[0,0,1] neg_hi:[0,0,1]
    v_pk_fma_f32 v[20:21], v[20:21], v[148:149], v[104:105] op_sel_hi:[1,0,1] neg_lo:[0,0,1] neg_hi:[0,0,1]
    v_pk_fma_f32 v[22:23], v[22:23], v[148:149], v[106:107] op_sel_hi:[1,0,1] neg_lo:[0,0,1] neg_hi:[0,0,1]
    v_pk_fma_f32 v[24:25], v[24:25], v[148:149], v[108:109] op_sel_hi:[1,0,1] neg_lo:[0,0,1] neg_hi:[0,0,1]
    v_pk_fma_f32 v[26:27], v[26:27], v[148:149], v[110:111] op_sel_hi:[1,0,1] neg_lo:[0,0,1] neg_hi:[0,0,1]
    v_pk_fma_f32 v[28:29], v[28:29], v[148:149], v[112:113] op_sel_hi:[1,0,1] neg_lo:[0,0,1] neg_hi:[0,0,1]
    v_pk_fma_f32 v[30:31], v[30:31], v[148:149], v[114:115] op_sel_hi:[1,0,1] neg_lo:[0,0,1] neg_hi:[0,0,1]
    v_cvt_pk_bf16_f32 v188, v16, v24
    v_cvt_pk_bf16_f32 v189, v17, v25
    v_cvt_pk_bf16_f32 v190, v18, v26
    v_cvt_pk_bf16_f32 v191, v19, v27
    buffer_store_dwordx4 v[188:191], v14, s[8:11], s46 offen offset:0 sc1
    v_cvt_pk_bf16_f32 v192, v20, v28
    v_cvt_pk_bf16_f32 v193, v21, v29
    v_cvt_pk_bf16_f32 v194, v22, v30
    v_cvt_pk_bf16_f32 v195, v23, v31
    buffer_store_dwordx4 v[192:195], v14, s[8:11], s46 offen offset:512 sc1
    v_pk_fma_f32 v[32:33], v[32:33], v[116:117], v[132:133] neg_lo:[0,0,1] neg_hi:[0,0,1]
    v_pk_fma_f32 v[34:35], v[34:35], v[118:119], v[134:135] neg_lo:[0,0,1] neg_hi:[0,0,1]
    v_pk_fma_f32 v[36:37], v[36:37], v[120:121], v[136:137] neg_lo:[0,0,1] neg_hi:[0,0,1]
    v_pk_fma_f32 v[38:39], v[38:39], v[122:123], v[138:139] neg_lo:[0,0,1] neg_hi:[0,0,1]
    v_pk_fma_f32 v[40:41], v[40:41], v[124:125], v[140:141] neg_lo:[0,0,1] neg_hi:[0,0,1]
    v_pk_fma_f32 v[42:43], v[42:43], v[126:127], v[142:143] neg_lo:[0,0,1] neg_hi:[0,0,1]
    v_pk_fma_f32 v[44:45], v[44:45], v[128:129], v[144:145] neg_lo:[0,0,1] neg_hi:[0,0,1]
    v_pk_fma_f32 v[46:47], v[46:47], v[130:131], v[146:147] neg_lo:[0,0,1] neg_hi:[0,0,1]
    v_cvt_pk_bf16_f32 v196, v32, v33
    v_cvt_pk_bf16_f32 v197, v34, v35
    v_cvt_pk_bf16_f32 v198, v40, v41
    v_cvt_pk_bf16_f32 v199, v42, v43
    buffer_store_dwordx4 v[196:199], v14, s[8:11], s51 offen offset:0 sc1
    v_cvt_pk_bf16_f32 v200, v36, v37
    v_cvt_pk_bf16_f32 v201, v38, v39
    v_cvt_pk_bf16_f32 v202, v44, v45
    v_cvt_pk_bf16_f32 v203, v46, v47
    buffer_store_dwordx4 v[200:203], v14, s[8:11], s51 offen offset:512 sc1
    s_mul_i32 s43, s57, 22528
    s_add_u32 s43, s43, s49
    s_branch LpKV_head
LpKV_f_4:
    v_mfma_f32_32x32x16_bf16 v[16:31], a[76:79], v[60:63], v[16:31]
    s_add_u32 m0, s59, 0
    s_add_u32 s47, s41, 0
    buffer_load_dwordx4 v0, s[8:11], s47 offen offset:0 lds
    ds_read_b128 v[56:59], v9 offset:22528
    v_mfma_f32_32x32x16_bf16 v[32:47], v[60:63], a[220:223], v[32:47]
    s_waitcnt lgkmcnt(2)
    v_mfma_f32_32x32x16_bf16 v[16:31], a[80:83], v[48:51], v[16:31]
    buffer_load_dwordx4 v0, s[8:11], s47 offen offset:1024 lds
    ds_read_b128 v[60:63], v9 offset:23552
    v_mfma_f32_32x32x16_bf16 v[32:47], v[48:51], a[224:227], v[32:47]
    s_waitcnt lgkmcnt(2)
    v_mfma_f32_32x32x16_bf16 v[16:31], a[84:87], v[52:55], v[16:31]
    buffer_load_dwordx4 v0, s[8:11], s47 offen offset:2048 lds
    ds_read_b128 v[48:51], v9 offset:24576
    v_mfma_f32_32x32x16_bf16 v[32:47], v[52:55], a[228:231], v[32:47]
    s_waitcnt lgkmcnt(2)
    v_mfma_f32_32x32x16_bf16 v[16:31], a[88:91], v[56:59], v[16:31]
    buffer_load_dwordx4 v0, s[8:11], s47 offen offset:3072 lds
    ds_read_b128 v[52:55], v9 offset:25600
    v_mfma_f32_32x32x16_bf16 v[32:47], v[56:59], a[232:235], v[32:47]
    s_waitcnt lgkmcnt(2)
    v_mfma_f32_32x32x16_bf16 v[16:31], a[92:95], v[60:63], v[16:31]
    s_add_u32 m0, s59, 4096
    s_add_u32 s47, s41, 4096
    buffer_load_dwordx4 v0, s[8:11], s47 offen offset:0 lds
    ds_read_b128 v[56:59], v9 offset:26624
    v_mfma_f32_32x32x16_bf16 v[32:47], v[60:63], a[236:239], v[32:47]
    s_waitcnt lgkmcnt(2)
    v_mfma_f32_32x32x16_bf16 v[16:31], a[96:99], v[48:51], v[16:31]
    buffer_load_dwordx4 v0, s[8:11], s47 offen offset:1024 lds
    ds_read_b128 v[60:63], v9 offset:27648
    v_mfma_f32_32x32x16_bf16 v[32:47], v[48:51], a[240:243], v[32:47]
    s_waitcnt lgkmcnt(2)
    v_mfma_f32_32x32x16_bf16 v[16:31], a[100:103], v[52:55], v[16:31]
    buffer_load_dwordx4 v0, s[8:11], s47 offen offset:2048 lds
    ds_read_b128 v[48:51], v9 offset:28672
    v_mfma_f32_32x32x16_bf16 v[32:47], v[52:55], a[244:247], v[32:47]
    s_waitcnt lgkmcnt(2)
    v_mfma_f32_32x32x16_bf16 v[16:31], a[104:107], v[56:59], v[16:31]
    buffer_load_dwordx4 v0, s[8:11], s47 offen offset:3072 lds
    ds_read_b128 v[52:55], v9 offset:29696
    v_mfma_f32_32x32x16_bf16 v[32:47], v[56:59], a[248:251], v[32:47]
    s_waitcnt lgkmcnt(2)
    v_mfma_f32_32x32x16_bf16 v[16:31], a[108:111], v[60:63], v[16:31]
    s_add_u32 m0, s59, 8192
    s_add_u32 s47, s41, 8192
    buffer_load_dwordx4 v0, s[8:11], s47 offen offset:0 lds
    ds_read_b128 v[56:59], v9 offset:30720
    v_mfma_f32_32x32x16_bf16 v[32:47], v[60:63], a[252:255], v[32:47]
    s_waitcnt lgkmcnt(2)
    v_mfma_f32_32x32x16_bf16 v[16:31], a[112:115], v[48:51], v[16:31]
    s_mul_i32 s48, s36, 786432
    s_mul_i32 s18, s37, 6144
    s_add_u32 s48, s48, s18
    s_add_u32 s48, s48, 16125952
    s_add_u32 m0, s66, 4096
    s_nop 0
    buffer_load_dwordx4 v0, s[8:11], s48 offen lds
    ds_read_b128 v[60:63], v9 offset:31744
    v_mfma_f32_32x32x16_bf16 v[32:47], v[48:51], v[152:155], v[32:47]
    s_waitcnt lgkmcnt(2)
    v_mfma_f32_32x32x16_bf16 v[16:31], a[116:119], v[52:55], v[16:31]
    s_add_u32 m0, s66, s67
    s_sub_u32 s48, s48, 4096
    s_add_u32 s48, s48, s67
    buffer_load_dwordx4 v0, s[8:11], s48 offen lds
    ds_read_b128 v[48:51], v9 offset:32768
    v_mfma_f32_32x32x16_bf16 v[32:47], v[52:55], v[156:159], v[32:47]
    s_waitcnt lgkmcnt(2)
    v_mfma_f32_32x32x16_bf16 v[16:31], a[120:123], v[56:59], v[16:31]
    ds_read_b128 v[52:55], v9 offset:33792
    v_mfma_f32_32x32x16_bf16 v[32:47], v[56:59], v[160:163], v[32:47]
    s_waitcnt lgkmcnt(2)
    v_mfma_f32_32x32x16_bf16 v[16:31], a[124:127], v[60:63], v[16:31]
    v_cmp_eq_u32 s[76:77], 1, v2
    v_cmp_eq_u32 vcc, 2, v2
    s_cmp_eq_u64 s[76:77], -1
    s_cselect_b32 s38, 1, 0
    ds_read_b128 v[56:59], v9 offset:34816
    v_mfma_f32_32x32x16_bf16 v[32:47], v[60:63], v[164:167], v[32:47]
    s_cmp_lg_u32 s38, 0
    s_cselect_b64 exec, 1, 0
    v_mov_b32 v15, s32
    ds_write_b32 v184, v15
    v_mov_b32 v2, 2
    s_mov_b64 exec, -1
    s_waitcnt lgkmcnt(3)
    v_mfma_f32_32x32x16_bf16 v[16:31], a[128:131], v[48:51], v[16:31]
    s_add_u32 s32, s32, s38
    s_mul_i32 s38, s38, 22528
    s_add_u32 s33, s33, s38
    ds_read_b128 v[60:63], v9 offset:35840
    v_mfma_f32_32x32x16_bf16 v[32:47], v[48:51], v[168:171], v[32:47]
    s_cmp_eq_u64 vcc, 0
    s_cselect_b32 s38, s32, 0x7fff
    s_waitcnt lgkmcnt(3)
    v_mfma_f32_32x32x16_bf16 v[16:31], a[132:135], v[52:55], v[16:31]
    s_cmp_le_u32 s38, s39
    s_cselect_b64 exec, -1, 0
    v_mov_b32 v2, 2
    buffer_load_dword v2, v1, s[8:11], s33 offen sc1
    s_mov_b64 exec, -1
    v_mfma_f32_32x32x16_bf16 v[32:47], v[52:55], v[172:175], v[32:47]
    s_waitcnt lgkmcnt(2)
    v_mfma_f32_32x32x16_bf16 v[16:31], a[136:139], v[56:59], v[16:31]
    v_mfma_f32_32x32x16_bf16 v[32:47], v[56:59], v[176:179], v[32:47]
    s_waitcnt lgkmcnt(0)
    v_mfma_f32_32x32x16_bf16 v[16:31], a[140:143], v[60:63], v[16:31]
    v_mfma_f32_32x32x16_bf16 v[32:47], v[60:63], v[180:183], v[32:47]
    s_add_u32 s51, s46, 16777216
    s_nop 2
    v_pk_fma_f32 v[16:17], v[16:17], v[148:149], v[100:101] op_sel_hi:[1,0,1] neg_lo:[0,0,1] neg_hi:[0,0,1]
    v_pk_fma_f32 v[18:19], v[18:19], v[148:149], v[102:103] op_sel_hi:[1,0,1] neg_lo:[0,0,1] neg_hi:[0,0,1]
    v_pk_fma_f32 v[20:21], v[20:21], v[148:149], v[104:105] op_sel_hi:[1,0,1] neg_lo:[0,0,1] neg_hi:[0,0,1]
    v_pk_fma_f32 v[22:23], v[22:23], v[148:149], v[106:107] op_sel_hi:[1,0,1] neg_lo:[0,0,1] neg_hi:[0,0,1]
    v_pk_fma_f32 v[24:25], v[24:25], v[148:149], v[108:109] op_sel_hi:[1,0,1] neg_lo:[0,0,1] neg_hi:[0,0,1]
    v_pk_fma_f32 v[26:27], v[26:27], v[148:149], v[110:111] op_sel_hi:[1,0,1] neg_lo:[0,0,1] neg_hi:[0,0,1]
    v_pk_fma_f32 v[28:29], v[28:29], v[148:149], v[112:113] op_sel_hi:[1,0,1] neg_lo:[0,0,1] neg_hi:[0,0,1]
    v_pk_fma_f32 v[30:31], v[30:31], v[148:149], v[114:115] op_sel_hi:[1,0,1] neg_lo:[0,0,1] neg_hi:[0,0,1]
    v_cvt_pk_bf16_f32 v188, v16, v24
    v_cvt_pk_bf16_f32 v189, v17, v25
    v_cvt_pk_bf16_f32 v190, v18, v26
    v_cvt_pk_bf16_f32 v191, v19, v27
    buffer_store_dwordx4 v[188:191], v14, s[8:11], s46 offen offset:0 sc1
    v_cvt_pk_bf16_f32 v192, v20, v28
    v_cvt_pk_bf16_f32 v193, v21, v29
    v_cvt_pk_bf16_f32 v194, v22, v30
    v_cvt_pk_bf16_f32 v195, v23, v31
    buffer_store_dwordx4 v[192:195], v14, s[8:11], s46 offen offset:512 sc1
    v_pk_fma_f32 v[32:33], v[32:33], v[116:117], v[132:133] neg_lo:[0,0,1] neg_hi:[0,0,1]
    v_pk_fma_f32 v[34:35], v[34:35], v[118:119], v[134:135] neg_lo:[0,0,1] neg_hi:[0,0,1]
    v_pk_fma_f32 v[36:37], v[36:37], v[120:121], v[136:137] neg_lo:[0,0,1] neg_hi:[0,0,1]
    v_pk_fma_f32 v[38:39], v[38:39], v[122:123], v[138:139] neg_lo:[0,0,1] neg_hi:[0,0,1]
    v_pk_fma_f32 v[40:41], v[40:41], v[124:125], v[140:141] neg_lo:[0,0,1] neg_hi:[0,0,1]
    v_pk_fma_f32 v[42:43], v[42:43], v[126:127], v[142:143] neg_lo:[0,0,1] neg_hi:[0,0,1]
    v_pk_fma_f32 v[44:45], v[44:45], v[128:129], v[144:145] neg_lo:[0,0,1] neg_hi:[0,0,1]
    v_pk_fma_f32 v[46:47], v[46:47], v[130:131], v[146:147] neg_lo:[0,0,1] neg_hi:[0,0,1]
    v_cvt_pk_bf16_f32 v196, v32, v33
    v_cvt_pk_bf16_f32 v197, v34, v35
    v_cvt_pk_bf16_f32 v198, v40, v41
    v_cvt_pk_bf16_f32 v199, v42, v43
    buffer_store_dwordx4 v[196:199], v14, s[8:11], s51 offen offset:0 sc1
    v_cvt_pk_bf16_f32 v200, v36, v37
    v_cvt_pk_bf16_f32 v201, v38, v39
    v_cvt_pk_bf16_f32 v202, v44, v45
    v_cvt_pk_bf16_f32 v203, v46, v47
    buffer_store_dwordx4 v[200:203], v14, s[8:11], s51 offen offset:512 sc1
    s_mul_i32 s43, s57, 22528
    s_add_u32 s43, s43, s49
    s_branch LpKV_head
LpKV_none:
    ds_read_b32 v15, v184
    s_waitcnt lgkmcnt(0)
    v_readfirstlane_b32 s17, v15
    s_nop 0
    s_cmp_lt_i32 s17, s37
    s_cbranch_scc1 LpKV_nopost
    s_add_u32 m0, s59, 0
    s_add_u32 s47, s41, 0
    buffer_load_dwordx4 v0, s[8:11], s47 offen offset:0 lds
    buffer_load_dwordx4 v0, s[8:11], s47 offen offset:1024 lds
    buffer_load_dwordx4 v0, s[8:11], s47 offen offset:2048 lds
    buffer_load_dwordx4 v0, s[8:11], s47 offen offset:3072 lds
    s_add_u32 m0, s59, 4096
    s_add_u32 s47, s41, 4096
    buffer_load_dwordx4 v0, s[8:11], s47 offen offset:0 lds
    buffer_load_dwordx4 v0, s[8:11], s47 offen offset:1024 lds
    buffer_load_dwordx4 v0, s[8:11], s47 offen offset:2048 lds
    buffer_load_dwordx4 v0, s[8:11], s47 offen offset:3072 lds
    s_add_u32 m0, s59, 8192
    s_add_u32 s47, s41, 8192
    buffer_load_dwordx4 v0, s[8:11], s47 offen offset:0 lds
    s_mul_i32 s48, s36, 786432
    s_mul_i32 s18, s37, 6144
    s_add_u32 s48, s48, s18
    s_add_u32 s48, s48, 16125952
    s_add_u32 m0, s66, 4096
    s_nop 0
    buffer_load_dwordx4 v0, s[8:11], s48 offen lds
    s_add_u32 m0, s66, s67
    s_sub_u32 s48, s48, 4096
    s_add_u32 s48, s48, s67
    buffer_load_dwordx4 v0, s[8:11], s48 offen lds
    s_waitcnt vmcnt(11)
    s_cmp_lg_u32 s43, 0
    s_cselect_b64 exec, 3, 0
    buffer_store_dword v3, v185, s[8:11], s43 offen sc1
    s_mov_b64 exec, -1
    s_mov_b32 s43, 0
    s_waitcnt vmcnt(1) lgkmcnt(0)
    s_branch LpKV_head2
LpKV_nopost:
    s_waitcnt vmcnt(0)
    s_cmp_lg_u32 s43, 0
    s_cselect_b64 exec, 3, 0
    buffer_store_dword v3, v185, s[8:11], s43 offen sc1
    s_mov_b64 exec, -1
    s_mov_b32 s43, 0
    s_cmp_ge_u32 s37, 64
    s_cbranch_scc1 LpKV_end
LpKV_wait:
    s_mov_b32 s16, 0
    s_cmp_lg_u32 s14, 0
    s_cbranch_scc1 LpKV_wl
LpKV_wp:
    buffer_load_dword v2, v1, s[8:11], s60 offen sc1
    s_add_u32 s16, s16, 1
    s_cmp_gt_u32 s16, 100000
    s_cbranch_scc1 LpKV_giveup
    s_waitcnt vmcnt(0)
    v_cmp_eq_u32 vcc, 0, v2
    s_nop 0
    s_cbranch_vccz LpKV_wok
    s_sleep 4
    s_branch LpKV_wp
LpKV_giveup:
    v_mov_b32 v5, -2
    ds_write_b32 v184, v5
    s_waitcnt lgkmcnt(0)
    s_branch L_role_p_abort
LpKV_wok:
    v_mov_b32 v5, s37
    ds_write_b32 v184, v5
    s_branch LpKV_go
LpKV_wl:
    ds_read_b32 v15, v184
    s_add_u32 s16, s16, 1
    s_cmp_gt_u32 s16, 1600000
    s_cbranch_scc1 L_role_p_abort
    s_waitcnt lgkmcnt(0)
    v_readfirstlane_b32 s17, v15
    s_nop 0
    s_cmp_eq_u32 s17, -2
    s_cbranch_scc1 L_role_p_abort
    s_cmp_ge_i32 s17, s37
    s_cbranch_scc1 LpKV_go
    s_sleep 1
    s_branch LpKV_wl
LpKV_go:
    s_add_u32 m0, s59, 0
    s_add_u32 s47, s41, 0
    buffer_load_dwordx4 v0, s[8:11], s47 offen offset:0 lds
    buffer_load_dwordx4 v0, s[8:11], s47 offen offset:1024 lds
    buffer_load_dwordx4 v0, s[8:11], s47 offen offset:2048 lds
    buffer_load_dwordx4 v0, s[8:11], s47 offen offset:3072 lds
    s_add_u32 m0, s59, 4096
    s_add_u32 s47, s41, 4096
    buffer_load_dwordx4 v0, s[8:11], s47 offen offset:0 lds
    buffer_load_dwordx4 v0, s[8:11], s47 offen offset:1024 lds
    buffer_load_dwordx4 v0, s[8:11], s47 offen offset:2048 lds
    buffer_load_dwordx4 v0, s[8:11], s47 offen offset:3072 lds
    s_add_u32 m0, s59, 8192
    s_add_u32 s47, s41, 8192
    buffer_load_dwordx4 v0, s[8:11], s47 offen offset:0 lds
    s_mul_i32 s48, s36, 786432
    s_mul_i32 s18, s37, 6144
    s_add_u32 s48, s48, s18
    s_add_u32 s48, s48, 16125952
    s_add_u32 m0, s66, 4096
    s_nop 0
    buffer_load_dwordx4 v0, s[8:11], s48 offen lds
    s_add_u32 m0, s66, s67
    s_sub_u32 s48, s48, 4096
    s_add_u32 s48, s48, s67
    buffer_load_dwordx4 v0, s[8:11], s48 offen lds
    s_waitcnt vmcnt(0) lgkmcnt(0)
    s_branch LpKV_head2
LpKV_end:
    s_branch L_role_p_exit
L_role_p_abort:
    s_waitcnt lgkmcnt(0)
    s_mov_b64 exec, -1
    v_mov_b32 v0, 60
    s_lshl_b32 s5, s3, 8
    s_or_b32 s5, s5, s4
    s_or_b32 s5, s5, 0x10000
    v_mov_b32 v1, s5
    global_store_dword v0, v1, s[12:13]
    s_endpgm
L_role_p_exit:
    s_endpgm
.p2align 6
L_role_awo:
    v_and_b32 v5, 63, v0
    v_lshlrev_b32 v0, 4, v5
    v_and_b32 v7, 15, v5
    v_lshrrev_b32 v8, 4, v5
    v_min_u32 v1, 63, v5
    v_lshrrev_b32 v6, 2, v1
    v_and_b32 v1, 3, v1
    v_lshlrev_b32 v1, 2, v1
    v_lshl_add_u32 v1, v6, 7, v1
    v_mov_b32 v3, 1
    v_mov_b32 v4, 0
    s_mov_b32 s44, 0x05040100
    s_mov_b32 s45, 0x07060302
    s_load_dwordx2 s[20:21], s[0:1], 16
    s_mov_b32 s22, 663552
    s_mov_b32 s23, 0x00020000
    s_waitcnt lgkmcnt(0)
    s_and_b32 s21, s21, 0xffff
    s_cmp_ge_u32 s15, 3
    s_cselect_b32 s63, 1, 0
    s_cselect_b32 s17, 3, 0
    s_sub_u32 s15, s15, s17
    s_lshl_b32 s50, s15, 2
    s_add_u32 s50, s50, s14
    s_cmp_eq_u32 s63, 0
    s_cbranch_scc1 Lao_gate_ng
    s_cmp_lg_u32 s14, 0
    s_cbranch_scc1 Lao_gate_d
    v_mov_b32 v5, 48
    s_mov_b32 s16, 0
Lao_gate:
    global_load_dword v6, v5, s[12:13] sc1
    s_add_u32 s16, s16, 1
    s_cmp_gt_u32 s16, 100000
    s_cbranch_scc1 L_role_awo_abort
    s_waitcnt vmcnt(0)
    v_cmp_gt_u32 vcc, 32, v6
    s_nop 0
    s_cbranch_vccz Lao_gate_d
    s_sleep 100
    s_branch Lao_gate
Lao_gate_d:
    s_barrier
Lao_gate_ng:
    v_lshrrev_b32 v5, 7, v0
    v_and_b32 v6, 0x70, v0
    v_mul_u32_u24 v16, 1152, v5
    v_add_u32 v16, v16, v6
    v_lshrrev_b32 v17, 1, v5
    v_mul_u32_u24 v17, 18, v17
    v_and_b32 v5, 1, v5
    v_add_u32 v17, v17, v5
    v_add_u32 v17, 16, v17
    v_mul_u32_u24 v17, 1152, v17
    v_add_u32 v17, v17, v6
    v_lshrrev_b32 v5, 2, v7
    v_lshl_add_u32 v5, v8, 3, v5
    v_lshlrev_b32 v18, 7, v5
    v_and_b32 v5, 3, v7
    v_lshl_add_u32 v19, v5, 3, v18
    v_lshl_add_u32 v18, v5, 4, v18
    s_lshl_b32 s46, s14, 15
    v_add_u32 v18, s46, v18
    v_add_u32 v19, s46, v19
    s_mul_i32 s49, s50, 96
    s_add_u32 m0, s46, 0
    s_add_u32 s17, s49, 0
    buffer_load_dwordx4 v16, s[20:23], s17 offen lds
    s_add_u32 m0, s46, 1024
    s_add_u32 s17, s49, 9216
    buffer_load_dwordx4 v16, s[20:23], s17 offen lds
    s_add_u32 m0, s46, 2048
    s_add_u32 s17, s49, 20736
    buffer_load_dwordx4 v16, s[20:23], s17 offen lds
    s_add_u32 m0, s46, 3072
    s_add_u32 s17, s49, 29952
    buffer_load_dwordx4 v16, s[20:23], s17 offen lds
    s_add_u32 m0, s46, 4096
    s_add_u32 s17, s49, 41472
    buffer_load_dwordx4 v16, s[20:23], s17 offen lds
    s_add_u32 m0, s46, 5120
    s_add_u32 s17, s49, 50688
    buffer_load_dwordx4 v16, s[20:23], s17 offen lds
    s_add_u32 m0, s46, 6144
    s_add_u32 s17, s49, 62208
    buffer_load_dwordx4 v16, s[20:23], s17 offen lds
    s_add_u32 m0, s46, 7168
    s_add_u32 s17, s49, 71424
    buffer_load_dwordx4 v16, s[20:23], s17 offen lds
    s_add_u32 m0, s46, 8192
    s_add_u32 s17, s49, 82944
    buffer_load_dwordx4 v16, s[20:23], s17 offen lds
    s_add_u32 m0, s46, 9216
    s_add_u32 s17, s49, 92160
    buffer_load_dwordx4 v16, s[20:23], s17 offen lds
    s_add_u32 m0, s46, 10240
    s_add_u32 s17, s49, 103680
    buffer_load_dwordx4 v16, s[20:23], s17 offen lds
    s_add_u32 m0, s46, 11264
    s_add_u32 s17, s49, 112896
    buffer_load_dwordx4 v16, s[20:23], s17 offen lds
    s_add_u32 m0, s46, 12288
    s_add_u32 s17, s49, 124416
    buffer_load_dwordx4 v16, s[20:23], s17 offen lds
    s_add_u32 m0, s46, 13312
    s_add_u32 s17, s49, 133632
    buffer_load_dwordx4 v16, s[20:23], s17 offen lds
    s_add_u32 m0, s46, 14336
    s_add_u32 s17, s49, 145152
    buffer_load_dwordx4 v16, s[20:23], s17 offen lds
    s_add_u32 m0, s46, 15360
    s_add_u32 s17, s49, 154368
    buffer_load_dwordx4 v16, s[20:23], s17 offen lds
    s_add_u32 m0, s46, 16384
    s_add_u32 s17, s49, 165888
    buffer_load_dwordx4 v16, s[20:23], s17 offen lds
    s_add_u32 m0, s46, 17408
    s_add_u32 s17, s49, 175104
    buffer_load_dwordx4 v16, s[20:23], s17 offen lds
    s_add_u32 m0, s46, 18432
    s_add_u32 s17, s49, 186624
    buffer_load_dwordx4 v16, s[20:23], s17 offen lds
    s_add_u32 m0, s46, 19456
    s_add_u32 s17, s49, 195840
    buffer_load_dwordx4 v16, s[20:23], s17 offen lds
    s_add_u32 m0, s46, 20480
    s_add_u32 s17, s49, 207360
    buffer_load_dwordx4 v16, s[20:23], s17 offen lds
    s_add_u32 m0, s46, 21504
    s_add_u32 s17, s49, 216576
    buffer_load_dwordx4 v16, s[20:23], s17 offen lds
    s_add_u32 m0, s46, 22528
    s_add_u32 s17, s49, 228096
    buffer_load_dwordx4 v16, s[20:23], s17 offen lds
    s_add_u32 m0, s46, 23552
    s_add_u32 s17, s49, 237312
    buffer_load_dwordx4 v16, s[20:23], s17 offen lds
    s_add_u32 m0, s46, 24576
    s_add_u32 s17, s49, 248832
    buffer_load_dwordx4 v16, s[20:23], s17 offen lds
    s_add_u32 m0, s46, 25600
    s_add_u32 s17, s49, 258048
    buffer_load_dwordx4 v16, s[20:23], s17 offen lds
    s_add_u32 m0, s46, 26624
    s_add_u32 s17, s49, 269568
    buffer_load_dwordx4 v16, s[20:23], s17 offen lds
    s_add_u32 m0, s46, 27648
    s_add_u32 s17, s49, 278784
    buffer_load_dwordx4 v16, s[20:23], s17 offen lds
    s_add_u32 m0, s46, 28672
    s_add_u32 s17, s49, 290304
    buffer_load_dwordx4 v16, s[20:23], s17 offen lds
    s_add_u32 m0, s46, 29696
    s_add_u32 s17, s49, 299520
    buffer_load_dwordx4 v16, s[20:23], s17 offen lds
    s_add_u32 m0, s46, 30720
    s_add_u32 s17, s49, 311040
    buffer_load_dwordx4 v16, s[20:23], s17 offen lds
    s_add_u32 m0, s46, 31744
    s_add_u32 s17, s49, 320256
    buffer_load_dwordx4 v16, s[20:23], s17 offen lds
    s_waitcnt vmcnt(28)
    ds_read_b64_tr_b16 a[0:1], v18 offset:0
    ds_read_b64_tr_b16 a[2:3], v18 offset:512
    ds_read_b64_tr_b16 a[4:5], v18 offset:8
    ds_read_b64_tr_b16 a[6:7], v18 offset:520
    ds_read_b64_tr_b16 a[8:9], v19 offset:64
    ds_read_b64_tr_b16 a[10:11], v19 offset:576
    s_waitcnt lgkmcnt(0)
    s_add_u32 m0, s46, 0
    s_add_u32 s17, s49, 331776
    buffer_load_dwordx4 v16, s[20:23], s17 offen lds
    s_add_u32 m0, s46, 1024
    s_add_u32 s17, s49, 340992
    buffer_load_dwordx4 v16, s[20:23], s17 offen lds
    s_add_u32 m0, s46, 2048
    s_add_u32 s17, s49, 352512
    buffer_load_dwordx4 v16, s[20:23], s17 offen lds
    s_add_u32 m0, s46, 3072
    s_add_u32 s17, s49, 361728
    buffer_load_dwordx4 v16, s[20:23], s17 offen lds
    s_waitcnt vmcnt(28)
    ds_read_b64_tr_b16 a[12:13], v18 offset:4096
    ds_read_b64_tr_b16 a[14:15], v18 offset:4608
    ds_read_b64_tr_b16 a[16:17], v18 offset:4104
    ds_read_b64_tr_b16 a[18:19], v18 offset:4616
    ds_read_b64_tr_b16 a[20:21], v19 offset:4160
    ds_read_b64_tr_b16 a[22:23], v19 offset:4672
    s_waitcnt lgkmcnt(0)
    s_add_u32 m0, s46, 4096
    s_add_u32 s17, s49, 373248
    buffer_load_dwordx4 v16, s[20:23], s17 offen lds
    s_add_u32 m0, s46, 5120
    s_add_u32 s17, s49, 382464
    buffer_load_dwordx4 v16, s[20:23], s17 offen lds
    s_add_u32 m0, s46, 6144
    s_add_u32 s17, s49, 393984
    buffer_load_dwordx4 v16, s[20:23], s17 offen lds
    s_add_u32 m0, s46, 7168
    s_add_u32 s17, s49, 403200
    buffer_load_dwordx4 v16, s[20:23], s17 offen lds
    s_waitcnt vmcnt(28)
    ds_read_b64_tr_b16 a[24:25], v18 offset:8192
    ds_read_b64_tr_b16 a[26:27], v18 offset:8704
    ds_read_b64_tr_b16 a[28:29], v18 offset:8200
    ds_read_b64_tr_b16 a[30:31], v18 offset:8712
    ds_read_b64_tr_b16 a[32:33], v19 offset:8256
    ds_read_b64_tr_b16 a[34:35], v19 offset:8768
    s_waitcnt lgkmcnt(0)
    s_add_u32 m0, s46, 8192
    s_add_u32 s17, s49, 414720
    buffer_load_dwordx4 v16, s[20:23], s17 offen lds
    s_add_u32 m0, s46, 9216
    s_add_u32 s17, s49, 423936
    buffer_load_dwordx4 v16, s[20:23], s17 offen lds
    s_add_u32 m0, s46, 10240
    s_add_u32 s17, s49, 435456
    buffer_load_dwordx4 v16, s[20:23], s17 offen lds
    s_add_u32 m0, s46, 11264
    s_add_u32 s17, s49, 444672
    buffer_load_dwordx4 v16, s[20:23], s17 offen lds
    s_waitcnt vmcnt(28)
    ds_read_b64_tr_b16 a[36:37], v18 offset:12288
    ds_read_b64_tr_b16 a[38:39], v18 offset:12800
    ds_read_b64_tr_b16 a[40:41], v18 offset:12296
    ds_read_b64_tr_b16 a[42:43], v18 offset:12808
    ds_read_b64_tr_b16 a[44:45], v19 offset:12352
    ds_read_b64_tr_b16 a[46:47], v19 offset:12864
    s_waitcnt lgkmcnt(0)
    s_add_u32 m0, s46, 12288
    s_add_u32 s17, s49, 456192
    buffer_load_dwordx4 v16, s[20:23], s17 offen lds
    s_add_u32 m0, s46, 13312
    s_add_u32 s17, s49, 465408
    buffer_load_dwordx4 v16, s[20:23], s17 offen lds
    s_add_u32 m0, s46, 14336
    s_add_u32 s17, s49, 476928
    buffer_load_dwordx4 v16, s[20:23], s17 offen lds
    s_add_u32 m0, s46, 15360
    s_add_u32 s17, s49, 486144
    buffer_load_dwordx4 v16, s[20:23], s17 offen lds
    s_waitcnt vmcnt(28)
    ds_read_b64_tr_b16 a[48:49], v18 offset:16384
    ds_read_b64_tr_b16 a[50:51], v18 offset:16896
    ds_read_b64_tr_b16 a[52:53], v18 offset:16392
    ds_read_b64_tr_b16 a[54:55], v18 offset:16904
    ds_read_b64_tr_b16 a[56:57], v19 offset:16448
    ds_read_b64_tr_b16 a[58:59], v19 offset:16960
    s_waitcnt lgkmcnt(0)
    s_add_u32 m0, s46, 16384
    s_add_u32 s17, s49, 497664
    buffer_load_dwordx4 v16, s[20:23], s17 offen lds
    s_add_u32 m0, s46, 17408
    s_add_u32 s17, s49, 506880
    buffer_load_dwordx4 v16, s[20:23], s17 offen lds
    s_add_u32 m0, s46, 18432
    s_add_u32 s17, s49, 518400
    buffer_load_dwordx4 v16, s[20:23], s17 offen lds
    s_add_u32 m0, s46, 19456
    s_add_u32 s17, s49, 527616
    buffer_load_dwordx4 v16, s[20:23], s17 offen lds
    s_waitcnt vmcnt(28)
    ds_read_b64_tr_b16 a[60:61], v18 offset:20480
    ds_read_b64_tr_b16 a[62:63], v18 offset:20992
    ds_read_b64_tr_b16 a[64:65], v18 offset:20488
    ds_read_b64_tr_b16 a[66:67], v18 offset:21000
    ds_read_b64_tr_b16 a[68:69], v19 offset:20544
    ds_read_b64_tr_b16 a[70:71], v19 offset:21056
    s_waitcnt lgkmcnt(0)
    s_add_u32 m0, s46, 20480
    s_add_u32 s17, s49, 539136
    buffer_load_dwordx4 v16, s[20:23], s17 offen lds
    s_add_u32 m0, s46, 21504
    s_add_u32 s17, s49, 548352
    buffer_load_dwordx4 v16, s[20:23], s17 offen lds
    s_add_u32 m0, s46, 22528
    s_add_u32 s17, s49, 559872
    buffer_load_dwordx4 v16, s[20:23], s17 offen lds
    s_add_u32 m0, s46, 23552
    s_add_u32 s17, s49, 569088
    buffer_load_dwordx4 v16, s[20:23], s17 offen lds
    s_waitcnt vmcnt(28)
    ds_read_b64_tr_b16 a[72:73], v18 offset:24576
    ds_read_b64_tr_b16 a[74:75], v18 offset:25088
    ds_read_b64_tr_b16 a[76:77], v18 offset:24584
    ds_read_b64_tr_b16 a[78:79], v18 offset:25096
    ds_read_b64_tr_b16 a[80:81], v19 offset:24640
    ds_read_b64_tr_b16 a[82:83], v19 offset:25152
    s_waitcnt lgkmcnt(0)
    s_add_u32 m0, s46, 24576
    s_add_u32 s17, s49, 580608
    buffer_load_dwordx4 v16, s[20:23], s17 offen lds
    s_add_u32 m0, s46, 25600
    s_add_u32 s17, s49, 589824
    buffer_load_dwordx4 v16, s[20:23], s17 offen lds
    s_add_u32 m0, s46, 26624
    s_add_u32 s17, s49, 601344
    buffer_load_dwordx4 v16, s[20:23], s17 offen lds
    s_add_u32 m0, s46, 27648
    s_add_u32 s17, s49, 610560
    buffer_load_dwordx4 v16, s[20:23], s17 offen lds
    s_waitcnt vmcnt(28)
    ds_read_b64_tr_b16 a[84:85], v18 offset:28672
    ds_read_b64_tr_b16 a[86:87], v18 offset:29184
    ds_read_b64_tr_b16 a[88:89], v18 offset:28680
    ds_read_b64_tr_b16 a[90:91], v18 offset:29192
    ds_read_b64_tr_b16 a[92:93], v19 offset:28736
    ds_read_b64_tr_b16 a[94:95], v19 offset:29248
    s_waitcnt lgkmcnt(0)
    s_add_u32 m0, s46, 28672
    s_add_u32 s17, s49, 622080
    buffer_load_dwordx4 v16, s[20:23], s17 offen lds
    s_add_u32 m0, s46, 29696
    s_add_u32 s17, s49, 631296
    buffer_load_dwordx4 v16, s[20:23], s17 offen lds
    s_add_u32 m0, s46, 30720
    s_add_u32 s17, s49, 642816
    buffer_load_dwordx4 v16, s[20:23], s17 offen lds
    s_add_u32 m0, s46, 31744
    s_add_u32 s17, s49, 652032
    buffer_load_dwordx4 v16, s[20:23], s17 offen lds
    s_waitcnt vmcnt(28)
    ds_read_b64_tr_b16 a[96:97], v18 offset:0
    ds_read_b64_tr_b16 a[98:99], v18 offset:512
    ds_read_b64_tr_b16 a[100:101], v18 offset:8
    ds_read_b64_tr_b16 a[102:103], v18 offset:520
    ds_read_b64_tr_b16 a[104:105], v19 offset:64
    ds_read_b64_tr_b16 a[106:107], v19 offset:576
    s_waitcnt lgkmcnt(0)
    s_add_u32 m0, s46, 0
    s_add_u32 s17, s49, 0
    buffer_load_dwordx4 v17, s[20:23], s17 offen lds
    s_add_u32 m0, s46, 1024
    s_add_u32 s17, s49, 82944
    buffer_load_dwordx4 v17, s[20:23], s17 offen lds
    s_add_u32 m0, s46, 2048
    s_add_u32 s17, s49, 165888
    buffer_load_dwordx4 v17, s[20:23], s17 offen lds
    s_add_u32 m0, s46, 3072
    s_add_u32 s17, s49, 248832
    buffer_load_dwordx4 v17, s[20:23], s17 offen lds
    s_waitcnt vmcnt(28)
    ds_read_b64_tr_b16 a[108:109], v18 offset:4096
    ds_read_b64_tr_b16 a[110:111], v18 offset:4608
    ds_read_b64_tr_b16 a[112:113], v18 offset:4104
    ds_read_b64_tr_b16 a[114:115], v18 offset:4616
    ds_read_b64_tr_b16 a[116:117], v19 offset:4160
    ds_read_b64_tr_b16 a[118:119], v19 offset:4672
    s_waitcnt lgkmcnt(0)
    s_add_u32 m0, s46, 4096
    s_add_u32 s17, s49, 331776
    buffer_load_dwordx4 v17, s[20:23], s17 offen lds
    s_add_u32 m0, s46, 5120
    s_add_u32 s17, s49, 414720
    buffer_load_dwordx4 v17, s[20:23], s17 offen lds
    s_add_u32 m0, s46, 6144
    s_add_u32 s17, s49, 497664
    buffer_load_dwordx4 v17, s[20:23], s17 offen lds
    s_add_u32 m0, s46, 7168
    s_add_u32 s17, s49, 580608
    buffer_load_dwordx4 v17, s[20:23], s17 offen lds
    s_waitcnt vmcnt(28)
    ds_read_b64_tr_b16 a[120:121], v18 offset:8192
    ds_read_b64_tr_b16 a[122:123], v18 offset:8704
    ds_read_b64_tr_b16 a[124:125], v18 offset:8200
    ds_read_b64_tr_b16 a[126:127], v18 offset:8712
    ds_read_b64_tr_b16 a[128:129], v19 offset:8256
    ds_read_b64_tr_b16 a[130:131], v19 offset:8768
    s_waitcnt lgkmcnt(0)
    s_waitcnt vmcnt(24)
    ds_read_b64_tr_b16 a[132:133], v18 offset:12288
    ds_read_b64_tr_b16 a[134:135], v18 offset:12800
    ds_read_b64_tr_b16 a[136:137], v18 offset:12296
    ds_read_b64_tr_b16 a[138:139], v18 offset:12808
    ds_read_b64_tr_b16 a[140:141], v19 offset:12352
    ds_read_b64_tr_b16 a[142:143], v19 offset:12864
    s_waitcnt lgkmcnt(0)
    s_waitcnt vmcnt(20)
    ds_read_b64_tr_b16 a[144:145], v18 offset:16384
    ds_read_b64_tr_b16 a[146:147], v18 offset:16896
    ds_read_b64_tr_b16 a[148:149], v18 offset:16392
    ds_read_b64_tr_b16 a[150:151], v18 offset:16904
    ds_read_b64_tr_b16 a[152:153], v19 offset:16448
    ds_read_b64_tr_b16 a[154:155], v19 offset:16960
    s_waitcnt lgkmcnt(0)
    s_waitcnt vmcnt(16)
    ds_read_b64_tr_b16 a[156:157], v18 offset:20480
    ds_read_b64_tr_b16 a[158:159], v18 offset:20992
    ds_read_b64_tr_b16 a[160:161], v18 offset:20488
    ds_read_b64_tr_b16 a[162:163], v18 offset:21000
    ds_read_b64_tr_b16 a[164:165], v19 offset:20544
    ds_read_b64_tr_b16 a[166:167], v19 offset:21056
    s_waitcnt lgkmcnt(0)
    s_waitcnt vmcnt(12)
    ds_read_b64_tr_b16 a[168:169], v18 offset:24576
    ds_read_b64_tr_b16 a[170:171], v18 offset:25088
    ds_read_b64_tr_b16 a[172:173], v18 offset:24584
    ds_read_b64_tr_b16 a[174:175], v18 offset:25096
    ds_read_b64_tr_b16 a[176:177], v19 offset:24640
    ds_read_b64_tr_b16 a[178:179], v19 offset:25152
    s_waitcnt lgkmcnt(0)
    s_waitcnt vmcnt(8)
    ds_read_b64_tr_b16 a[180:181], v18 offset:28672
    ds_read_b64_tr_b16 a[182:183], v18 offset:29184
    ds_read_b64_tr_b16 a[184:185], v18 offset:28680
    ds_read_b64_tr_b16 a[186:187], v18 offset:29192
    ds_read_b64_tr_b16 a[188:189], v19 offset:28736
    ds_read_b64_tr_b16 a[190:191], v19 offset:29248
    s_waitcnt lgkmcnt(0)
    s_waitcnt vmcnt(4)
    ds_read_b64_tr_b16 a[192:193], v18 offset:0
    ds_read_b64_tr_b16 a[194:195], v18 offset:512
    ds_read_b64_tr_b16 a[196:197], v18 offset:8
    ds_read_b64_tr_b16 a[198:199], v18 offset:520
    ds_read_b64_tr_b16 a[200:201], v19 offset:64
    ds_read_b64_tr_b16 a[202:203], v19 offset:576
    s_waitcnt lgkmcnt(0)
    s_waitcnt vmcnt(0)
    ds_read_b64_tr_b16 a[204:205], v18 offset:4096
    ds_read_b64_tr_b16 a[206:207], v18 offset:4608
    ds_read_b64_tr_b16 a[208:209], v18 offset:4104
    ds_read_b64_tr_b16 a[210:211], v18 offset:4616
    ds_read_b64_tr_b16 a[212:213], v19 offset:4160
    ds_read_b64_tr_b16 a[214:215], v19 offset:4672
    s_waitcnt lgkmcnt(0)
    s_barrier
    v_lshlrev_b32 v5, 4, v7
    v_lshl_add_u32 v10, v8, 9, v5
    s_mul_i32 s17, s50, 3072
    v_add_u32 v10, s17, v10
    v_lshrrev_b32 v6, 1, v8
    v_lshl_add_u32 v12, v6, 9, v5
    v_and_b32 v6, 1, v8
    v_lshl_add_u32 v12, v6, 3, v12
    s_add_u32 s17, s17, 2048
    v_add_u32 v12, s17, v12
    s_lshr_b32 s17, s50, 1
    s_lshl_b32 s17, s17, 9
    s_and_b32 s18, s50, 1
    s_lshl_b32 s18, s18, 3
    s_add_u32 s17, s17, s18
    v_add_u32 v11, s17, v5
    s_lshl_b32 s49, s15, 7
    s_lshl_b32 s17, s14, 2
    s_add_u32 s49, s49, s17
    s_add_u32 s49, s49, 3584
    s_mov_b32 s36, s63
    s_mov_b32 s34, s63
    s_mul_i32 s58, s14, 9216
    s_mul_i32 s64, s63, 2359296
    s_add_u32 s64, s64, s58
    s_add_u32 s64, s64, 17301504
    s_mul_i32 s61, s63, 1441792
    s_add_u32 s61, s61, 1536
    s_mov_b32 s37, 0
    s_mov_b32 s40, 36864
    s_mov_b32 s59, s58
    s_mov_b32 s43, 0
    s_mov_b32 s62, 1
    s_mov_b32 s28, s8
    s_mov_b32 s29, s9
    s_mov_b32 s30, 0
    s_mov_b32 s31, 0x00020000
    v_mov_b32 v184, 74752
    v_mov_b32 v5, -1
    ds_write_b32 v184, v5
    s_waitcnt lgkmcnt(0)
    s_cmp_lg_u32 s14, 0
    s_cbranch_scc1 Lawo_inia_d
    v_mov_b32 v5, 40
    s_mov_b32 s16, 0
Lawo_inia:
    global_load_dword v6, v5, s[12:13] sc1
    s_add_u32 s16, s16, 1
    s_cmp_gt_u32 s16, 100000
    s_cbranch_scc1 L_role_awo_abort
    s_waitcnt vmcnt(0)
    v_cmp_gt_u32 vcc, 72, v6
    s_nop 0
    s_cbranch_vccz Lawo_inia_d
    s_sleep 8
    s_branch Lawo_inia
Lawo_inia_d:
    s_barrier
    s_cmp_eq_u32 s63, 0
    s_cbranch_scc1 Lawo_ini_sk
    s_cmp_lg_u32 s14, 0
    s_cbranch_scc1 Lawo_inib_d
    v_mov_b32 v5, 160
    s_mov_b32 s16, 0
Lawo_inib:
    global_load_dword v6, v5, s[12:13] sc1
    s_add_u32 s16, s16, 1
    s_cmp_gt_u32 s16, 100000
    s_cbranch_scc1 L_role_awo_abort
    s_waitcnt vmcnt(0)
    v_cmp_gt_u32 vcc, 64, v6
    s_nop 0
    s_cbranch_vccz Lawo_inib_d
    s_sleep 8
    s_branch Lawo_inib
Lawo_inib_d:
    s_barrier
Lawo_ini_sk:
    s_mul_i32 s41, s37, 36864
    s_add_u32 s41, s41, s64
    s_mul_i32 s60, s37, 22528
    s_add_u32 s60, s60, s61
    s_cmp_lt_u32 s37, 64
    s_cselect_b32 s60, s60, 2883584
    s_branch Lawo_wait
Lawo_head:
    s_waitcnt vmcnt(6)
Lawo_head2:
    s_barrier
    ds_read_b32 v15, v184
    s_xor_b32 s40, s40, 36864
    s_xor_b32 s59, s59, 36864
    s_mov_b32 s35, s37
    s_lshl_b32 s57, s34, 6
    s_add_u32 s57, s57, s35
    s_add_u32 s37, s37, 1
    s_mov_b32 s39, 0
    s_mov_b32 s54, 0
    s_mul_i32 s41, s37, 36864
    s_add_u32 s41, s41, s64
    s_mul_i32 s60, s37, 22528
    s_add_u32 s60, s60, s61
    s_cmp_lt_u32 s37, 64
    s_cselect_b32 s60, s60, 2883584
    v_lshlrev_b32 v9, 9, v8
    v_lshl_add_u32 v9, v7, 4, v9
    v_add_u32 v9, s40, v9
    ds_read_b128 v[40:43], v9 offset:0
    ds_read_b128 v[44:47], v9 offset:256
    ds_read_b128 v[48:51], v9 offset:2048
    ds_read_b128 v[52:55], v9 offset:2304
    ds_read_b128 v[56:59], v9 offset:4096
    v_lshlrev_b32 v16, 16, v64
    v_and_b32 v17, 0xffff0000, v64
    v_lshlrev_b32 v18, 16, v65
    v_and_b32 v19, 0xffff0000, v65
    v_lshlrev_b32 v20, 16, v66
    v_and_b32 v21, 0xffff0000, v66
    v_lshlrev_b32 v22, 16, v67
    v_and_b32 v23, 0xffff0000, v67
    v_lshlrev_b32 v24, 16, v68
    v_and_b32 v25, 0xffff0000, v68
    v_lshlrev_b32 v26, 16, v69
    v_and_b32 v27, 0xffff0000, v69
    v_lshlrev_b32 v28, 16, v72
    v_and_b32 v29, 0xffff0000, v72
    v_lshlrev_b32 v30, 16, v73
    v_and_b32 v31, 0xffff0000, v73
    v_lshlrev_b32 v32, 16, v74
    v_and_b32 v33, 0xffff0000, v74
    v_lshlrev_b32 v34, 16, v75
    v_and_b32 v35, 0xffff0000, v75
    v_lshlrev_b32 v36, 16, v76
    v_and_b32 v37, 0xffff0000, v76
    v_lshlrev_b32 v38, 16, v77
    v_and_b32 v39, 0xffff0000, v77
    s_waitcnt lgkmcnt(4)
    v_mfma_f32_16x16x32_bf16 v[16:19], a[0:3], v[40:43], v[16:19]
    ds_read_b128 v[60:63], v9 offset:4352
    v_mfma_f32_16x16x32_bf16 v[20:23], a[4:7], v[40:43], v[20:23]
    s_mul_i32 s46, s34, 4718592
    v_mfma_f32_16x16x32_bf16 v[24:27], a[8:11], v[40:43], v[24:27]
    s_waitcnt lgkmcnt(4)
    v_mfma_f32_16x16x32_bf16 v[28:31], a[0:3], v[44:47], v[28:31]
    ds_read_b128 v[40:43], v9 offset:6144
    v_mfma_f32_16x16x32_bf16 v[32:35], a[4:7], v[44:47], v[32:35]
    s_mul_i32 s51, s35, 36864
    v_mfma_f32_16x16x32_bf16 v[36:39], a[8:11], v[44:47], v[36:39]
    v_readfirstlane_b32 s17, v15
    s_nop 0
    s_add_u32 s18, s17, 1
    s_max_i32 s32, s18, s37
    s_add_u32 s39, s37, 1
    s_min_u32 s39, s39, 63
    s_mul_i32 s33, s32, 22528
    s_add_u32 s33, s33, s61
    s_cmp_eq_u32 s14, 0
    s_cselect_b32 s18, s32, 0x7fff
    v_mov_b32 v2, 2
    s_cmp_le_u32 s18, s39
    s_cselect_b64 exec, -1, 0
    buffer_load_dword v2, v1, s[8:11], s33 offen sc1
    s_mov_b64 exec, -1
    s_cmp_ge_i32 s17, s37
    s_cbranch_scc1 Lawo_f_5
    s_waitcnt lgkmcnt(4)
    v_mfma_f32_16x16x32_bf16 v[16:19], a[12:15], v[48:51], v[16:19]
    ds_read_b128 v[44:47], v9 offset:6400
    v_mfma_f32_16x16x32_bf16 v[20:23], a[16:19], v[48:51], v[20:23]
    s_add_u32 s46, s46, s51
    v_mfma_f32_16x16x32_bf16 v[24:27], a[20:23], v[48:51], v[24:27]
    s_waitcnt lgkmcnt(4)
    v_mfma_f32_16x16x32_bf16 v[28:31], a[12:15], v[52:55], v[28:31]
    ds_read_b128 v[48:51], v9 offset:8192
    v_mfma_f32_16x16x32_bf16 v[32:35], a[16:19], v[52:55], v[32:35]
    s_add_u32 s46, s46, 8650752
    v_mfma_f32_16x16x32_bf16 v[36:39], a[20:23], v[52:55], v[36:39]
    s_waitcnt lgkmcnt(4)
    v_mfma_f32_16x16x32_bf16 v[16:19], a[24:27], v[56:59], v[16:19]
    ds_read_b128 v[52:55], v9 offset:8448
    v_mfma_f32_16x16x32_bf16 v[20:23], a[28:31], v[56:59], v[20:23]
    s_mul_i32 s52, s34, 786432
    v_mfma_f32_16x16x32_bf16 v[24:27], a[32:35], v[56:59], v[24:27]
    s_waitcnt lgkmcnt(4)
    v_mfma_f32_16x16x32_bf16 v[28:31], a[24:27], v[60:63], v[28:31]
    ds_read_b128 v[56:59], v9 offset:10240
    v_mfma_f32_16x16x32_bf16 v[32:35], a[28:31], v[60:63], v[32:35]
    s_mul_i32 s51, s35, 6144
    v_mfma_f32_16x16x32_bf16 v[36:39], a[32:35], v[60:63], v[36:39]
    s_waitcnt lgkmcnt(4)
    v_mfma_f32_16x16x32_bf16 v[16:19], a[36:39], v[40:43], v[16:19]
    ds_read_b128 v[60:63], v9 offset:10496
    v_mfma_f32_16x16x32_bf16 v[20:23], a[40:43], v[40:43], v[20:23]
    s_add_u32 s52, s52, s51
    v_mfma_f32_16x16x32_bf16 v[24:27], a[44:47], v[40:43], v[24:27]
    s_waitcnt lgkmcnt(4)
    v_mfma_f32_16x16x32_bf16 v[28:31], a[36:39], v[44:47], v[28:31]
    ds_read_b128 v[40:43], v9 offset:12288
    v_mfma_f32_16x16x32_bf16 v[32:35], a[40:43], v[44:47], v[32:35]
    s_add_u32 s52, s52, 16121856
    v_mfma_f32_16x16x32_bf16 v[36:39], a[44:47], v[44:47], v[36:39]
    s_waitcnt lgkmcnt(4)
    v_mfma_f32_16x16x32_bf16 v[16:19], a[48:51], v[48:51], v[16:19]
    ds_read_b128 v[44:47], v9 offset:12544
    v_mfma_f32_16x16x32_bf16 v[20:23], a[52:55], v[48:51], v[20:23]
    v_mfma_f32_16x16x32_bf16 v[24:27], a[56:59], v[48:51], v[24:27]
    s_waitcnt lgkmcnt(4)
    v_mfma_f32_16x16x32_bf16 v[28:31], a[48:51], v[52:55], v[28:31]
    ds_read_b128 v[48:51], v9 offset:14336
    v_mfma_f32_16x16x32_bf16 v[32:35], a[52:55], v[52:55], v[32:35]
    v_mfma_f32_16x16x32_bf16 v[36:39], a[56:59], v[52:55], v[36:39]
    s_waitcnt lgkmcnt(4)
    v_mfma_f32_16x16x32_bf16 v[16:19], a[60:63], v[56:59], v[16:19]
    ds_read_b128 v[52:55], v9 offset:14592
    v_mfma_f32_16x16x32_bf16 v[20:23], a[64:67], v[56:59], v[20:23]
    v_mfma_f32_16x16x32_bf16 v[24:27], a[68:71], v[56:59], v[24:27]
    s_waitcnt lgkmcnt(4)
    v_mfma_f32_16x16x32_bf16 v[28:31], a[60:63], v[60:63], v[28:31]
    v_cmp_eq_u32 s[76:77], 1, v2
    v_cmp_eq_u32 vcc, 2, v2
    ds_read_b128 v[56:59], v9 offset:16384
    v_mfma_f32_16x16x32_bf16 v[32:35], a[64:67], v[60:63], v[32:35]
    s_cmp_eq_u64 s[76:77], -1
    s_cselect_b32 s38, 1, 0
    v_mfma_f32_16x16x32_bf16 v[36:39], a[68:71], v[60:63], v[36:39]
    s_cmp_lg_u32 s38, 0
    s_cselect_b64 exec, 1, 0
    v_mov_b32 v15, s32
    ds_write_b32 v184, v15
    v_mov_b32 v2, 2
    s_mov_b64 exec, -1
    s_waitcnt lgkmcnt(5)
    v_mfma_f32_16x16x32_bf16 v[16:19], a[72:75], v[40:43], v[16:19]
    ds_read_b128 v[60:63], v9 offset:16640
    v_mfma_f32_16x16x32_bf16 v[20:23], a[76:79], v[40:43], v[20:23]
    s_add_u32 s32, s32, s38
    s_mul_i32 s38, s38, 22528
    s_add_u32 s33, s33, s38
    v_mfma_f32_16x16x32_bf16 v[24:27], a[80:83], v[40:43], v[24:27]
    s_cmp_eq_u64 vcc, 0
    s_cselect_b32 s38, s32, 0x7fff
    s_waitcnt lgkmcnt(5)
    v_mfma_f32_16x16x32_bf16 v[28:31], a[72:75], v[44:47], v[28:31]
    s_cmp_le_u32 s38, s39
    s_cselect_b64 exec, -1, 0
    v_mov_b32 v2, 2
    buffer_load_dword v2, v1, s[8:11], s33 offen sc1
    s_mov_b64 exec, -1
    ds_read_b128 v[40:43], v9 offset:18432
    v_mfma_f32_16x16x32_bf16 v[32:35], a[76:79], v[44:47], v[32:35]
    v_mfma_f32_16x16x32_bf16 v[36:39], a[80:83], v[44:47], v[36:39]
    ds_read_b32 v15, v184
    s_waitcnt lgkmcnt(6)
    v_mfma_f32_16x16x32_bf16 v[16:19], a[84:87], v[48:51], v[16:19]
    ds_read_b128 v[44:47], v9 offset:18688
    v_mfma_f32_16x16x32_bf16 v[20:23], a[88:91], v[48:51], v[20:23]
    v_mfma_f32_16x16x32_bf16 v[24:27], a[92:95], v[48:51], v[24:27]
    s_waitcnt lgkmcnt(6)
    v_mfma_f32_16x16x32_bf16 v[28:31], a[84:87], v[52:55], v[28:31]
    ds_read_b128 v[48:51], v9 offset:20480
    v_mfma_f32_16x16x32_bf16 v[32:35], a[88:91], v[52:55], v[32:35]
    v_mfma_f32_16x16x32_bf16 v[36:39], a[92:95], v[52:55], v[36:39]
    s_waitcnt lgkmcnt(2)
    v_readfirstlane_b32 s17, v15
    s_nop 0
    s_cmp_ge_i32 s17, s37
    s_cbranch_scc1 Lawo_f_6
    v_mfma_f32_16x16x32_bf16 v[16:19], a[96:99], v[56:59], v[16:19]
    ds_read_b128 v[52:55], v9 offset:20736
    v_mfma_f32_16x16x32_bf16 v[20:23], a[100:103], v[56:59], v[20:23]
    v_mfma_f32_16x16x32_bf16 v[24:27], a[104:107], v[56:59], v[24:27]
    v_mfma_f32_16x16x32_bf16 v[28:31], a[96:99], v[60:63], v[28:31]
    ds_read_b128 v[56:59], v9 offset:22528
    v_mfma_f32_16x16x32_bf16 v[32:35], a[100:103], v[60:63], v[32:35]
    v_mfma_f32_16x16x32_bf16 v[36:39], a[104:107], v[60:63], v[36:39]
    s_waitcnt vmcnt(2)
    s_cmp_lg_u32 s43, 0
    s_cselect_b64 exec, 1, 0
    buffer_store_dword v3, v4, s[8:11], s43 offen sc1
    s_mov_b64 exec, -1
    s_mov_b32 s43, 0
    v_mfma_f32_16x16x32_bf16 v[16:19], a[108:111], v[40:43], v[16:19]
    ds_read_b128 v[60:63], v9 offset:22784
    v_mfma_f32_16x16x32_bf16 v[20:23], a[112:115], v[40:43], v[20:23]
    v_mfma_f32_16x16x32_bf16 v[24:27], a[116:119], v[40:43], v[24:27]
    s_waitcnt lgkmcnt(4)
    v_mfma_f32_16x16x32_bf16 v[28:31], a[108:111], v[44:47], v[28:31]
    ds_read_b128 v[40:43], v9 offset:24576
    v_mfma_f32_16x16x32_bf16 v[32:35], a[112:115], v[44:47], v[32:35]
    v_mfma_f32_16x16x32_bf16 v[36:39], a[116:119], v[44:47], v[36:39]
    s_waitcnt lgkmcnt(4)
    v_mfma_f32_16x16x32_bf16 v[16:19], a[120:123], v[48:51], v[16:19]
    ds_read_b128 v[44:47], v9 offset:24832
    v_mfma_f32_16x16x32_bf16 v[20:23], a[124:127], v[48:51], v[20:23]
    v_mfma_f32_16x16x32_bf16 v[24:27], a[128:131], v[48:51], v[24:27]
    s_waitcnt lgkmcnt(4)
    v_mfma_f32_16x16x32_bf16 v[28:31], a[120:123], v[52:55], v[28:31]
    ds_read_b128 v[48:51], v9 offset:26624
    v_mfma_f32_16x16x32_bf16 v[32:35], a[124:127], v[52:55], v[32:35]
    v_mfma_f32_16x16x32_bf16 v[36:39], a[128:131], v[52:55], v[36:39]
    s_waitcnt lgkmcnt(4)
    v_mfma_f32_16x16x32_bf16 v[16:19], a[132:135], v[56:59], v[16:19]
    ds_read_b128 v[52:55], v9 offset:26880
    v_mfma_f32_16x16x32_bf16 v[20:23], a[136:139], v[56:59], v[20:23]
    v_mfma_f32_16x16x32_bf16 v[24:27], a[140:143], v[56:59], v[24:27]
    s_waitcnt lgkmcnt(4)
    v_mfma_f32_16x16x32_bf16 v[28:31], a[132:135], v[60:63], v[28:31]
    ds_read_b128 v[56:59], v9 offset:28672
    v_mfma_f32_16x16x32_bf16 v[32:35], a[136:139], v[60:63], v[32:35]
    v_mfma_f32_16x16x32_bf16 v[36:39], a[140:143], v[60:63], v[36:39]
    s_waitcnt lgkmcnt(4)
    v_mfma_f32_16x16x32_bf16 v[16:19], a[144:147], v[40:43], v[16:19]
    ds_read_b128 v[60:63], v9 offset:28928
    v_mfma_f32_16x16x32_bf16 v[20:23], a[148:151], v[40:43], v[20:23]
    v_mfma_f32_16x16x32_bf16 v[24:27], a[152:155], v[40:43], v[24:27]
    s_waitcnt lgkmcnt(4)
    v_mfma_f32_16x16x32_bf16 v[28:31], a[144:147], v[44:47], v[28:31]
    ds_read_b128 v[40:43], v9 offset:30720
    v_mfma_f32_16x16x32_bf16 v[32:35], a[148:151], v[44:47], v[32:35]
    v_mfma_f32_16x16x32_bf16 v[36:39], a[152:155], v[44:47], v[36:39]
    s_waitcnt lgkmcnt(4)
    v_mfma_f32_16x16x32_bf16 v[16:19], a[156:159], v[48:51], v[16:19]
    ds_read_b128 v[44:47], v9 offset:30976
    v_mfma_f32_16x16x32_bf16 v[20:23], a[160:163], v[48:51], v[20:23]
    v_mfma_f32_16x16x32_bf16 v[24:27], a[164:167], v[48:51], v[24:27]
    s_waitcnt lgkmcnt(4)
    v_mfma_f32_16x16x32_bf16 v[28:31], a[156:159], v[52:55], v[28:31]
    ds_read_b128 v[48:51], v9 offset:32768
    v_mfma_f32_16x16x32_bf16 v[32:35], a[160:163], v[52:55], v[32:35]
    v_mfma_f32_16x16x32_bf16 v[36:39], a[164:167], v[52:55], v[36:39]
    s_waitcnt lgkmcnt(4)
    v_mfma_f32_16x16x32_bf16 v[16:19], a[168:171], v[56:59], v[16:19]
    ds_read_b128 v[52:55], v9 offset:33024
    v_mfma_f32_16x16x32_bf16 v[20:23], a[172:175], v[56:59], v[20:23]
    v_mfma_f32_16x16x32_bf16 v[24:27], a[176:179], v[56:59], v[24:27]
    s_waitcnt lgkmcnt(4)
    v_mfma_f32_16x16x32_bf16 v[28:31], a[168:171], v[60:63], v[28:31]
    v_cmp_eq_u32 s[76:77], 1, v2
    v_cmp_eq_u32 vcc, 2, v2
    ds_read_b128 v[56:59], v9 offset:34816
    v_mfma_f32_16x16x32_bf16 v[32:35], a[172:175], v[60:63], v[32:35]
    s_cmp_eq_u64 s[76:77], -1
    s_cselect_b32 s38, 1, 0
    v_mfma_f32_16x16x32_bf16 v[36:39], a[176:179], v[60:63], v[36:39]
    s_cmp_lg_u32 s38, 0
    s_cselect_b64 exec, 1, 0
    v_mov_b32 v15, s32
    ds_write_b32 v184, v15
    v_mov_b32 v2, 2
    s_mov_b64 exec, -1
    s_waitcnt lgkmcnt(5)
    v_mfma_f32_16x16x32_bf16 v[16:19], a[180:183], v[40:43], v[16:19]
    ds_read_b128 v[60:63], v9 offset:35072
    v_mfma_f32_16x16x32_bf16 v[20:23], a[184:187], v[40:43], v[20:23]
    s_add_u32 s32, s32, s38
    s_mul_i32 s38, s38, 22528
    s_add_u32 s33, s33, s38
    v_mfma_f32_16x16x32_bf16 v[24:27], a[188:191], v[40:43], v[24:27]
    s_cmp_eq_u64 vcc, 0
    s_cselect_b32 s38, s32, 0x7fff
    s_waitcnt lgkmcnt(5)
    v_mfma_f32_16x16x32_bf16 v[28:31], a[180:183], v[44:47], v[28:31]
    s_cmp_le_u32 s38, s39
    s_cselect_b64 exec, -1, 0
    v_mov_b32 v2, 2
    buffer_load_dword v2, v1, s[8:11], s33 offen sc1
    s_mov_b64 exec, -1
    v_mfma_f32_16x16x32_bf16 v[32:35], a[184:187], v[44:47], v[32:35]
    v_mfma_f32_16x16x32_bf16 v[36:39], a[188:191], v[44:47], v[36:39]
    s_waitcnt lgkmcnt(4)
    v_mfma_f32_16x16x32_bf16 v[16:19], a[192:195], v[48:51], v[16:19]
    v_mfma_f32_16x16x32_bf16 v[20:23], a[196:199], v[48:51], v[20:23]
    v_mfma_f32_16x16x32_bf16 v[24:27], a[200:203], v[48:51], v[24:27]
    s_waitcnt lgkmcnt(3)
    v_mfma_f32_16x16x32_bf16 v[28:31], a[192:195], v[52:55], v[28:31]
    v_mfma_f32_16x16x32_bf16 v[32:35], a[196:199], v[52:55], v[32:35]
    v_mfma_f32_16x16x32_bf16 v[36:39], a[200:203], v[52:55], v[36:39]
    s_waitcnt lgkmcnt(2)
    v_mfma_f32_16x16x32_bf16 v[16:19], a[204:207], v[56:59], v[16:19]
    v_mfma_f32_16x16x32_bf16 v[20:23], a[208:211], v[56:59], v[20:23]
    v_mfma_f32_16x16x32_bf16 v[24:27], a[212:215], v[56:59], v[24:27]
    s_waitcnt lgkmcnt(0)
    v_mfma_f32_16x16x32_bf16 v[28:31], a[204:207], v[60:63], v[28:31]
    v_mfma_f32_16x16x32_bf16 v[32:35], a[208:211], v[60:63], v[32:35]
    v_mfma_f32_16x16x32_bf16 v[36:39], a[212:215], v[60:63], v[36:39]
    v_mov_b32 v88, 0x3f803f80
    v_cvt_pk_bf16_f32 v96, v16, v17
    v_cvt_pk_bf16_f32 v97, v18, v19
    v_cvt_pk_bf16_f32 v98, v20, v21
    v_cvt_pk_bf16_f32 v99, v22, v23
    v_cvt_pk_bf16_f32 v100, v24, v25
    v_cvt_pk_bf16_f32 v101, v26, v27
    buffer_store_dwordx4 v[96:99], v10, s[8:11], s46 offen offset:0 sc1
    buffer_store_dwordx2 v[100:101], v12, s[8:11], s46 offen offset:0 sc1
    v_cvt_pk_bf16_f32 v104, v28, v29
    v_cvt_pk_bf16_f32 v105, v30, v31
    v_cvt_pk_bf16_f32 v106, v32, v33
    v_cvt_pk_bf16_f32 v107, v34, v35
    v_cvt_pk_bf16_f32 v108, v36, v37
    v_cvt_pk_bf16_f32 v109, v38, v39
    buffer_store_dwordx4 v[104:107], v10, s[8:11], s46 offen offset:256 sc1
    buffer_store_dwordx2 v[108:109], v12, s[8:11], s46 offen offset:256 sc1
    v_mov_b32 v80, 0
    v_mov_b32 v81, 0
    v_mov_b32 v84, 0
    v_mov_b32 v85, 0
    v_dot2c_f32_bf16 v80, v96, v88
    v_dot2c_f32_bf16 v81, v96, v96
    v_dot2c_f32_bf16 v84, v104, v88
    v_dot2c_f32_bf16 v85, v104, v104
    v_dot2c_f32_bf16 v80, v97, v88
    v_dot2c_f32_bf16 v81, v97, v97
    v_dot2c_f32_bf16 v84, v105, v88
    v_dot2c_f32_bf16 v85, v105, v105
    v_dot2c_f32_bf16 v80, v98, v88
    v_dot2c_f32_bf16 v81, v98, v98
    v_dot2c_f32_bf16 v84, v106, v88
    v_dot2c_f32_bf16 v85, v106, v106
    v_dot2c_f32_bf16 v80, v99, v88
    v_dot2c_f32_bf16 v81, v99, v99
    v_dot2c_f32_bf16 v84, v107, v88
    v_dot2c_f32_bf16 v85, v107, v107
    v_dot2c_f32_bf16 v80, v100, v88
    v_dot2c_f32_bf16 v81, v100, v100
    v_dot2c_f32_bf16 v84, v108, v88
    v_dot2c_f32_bf16 v85, v108, v108
    v_dot2c_f32_bf16 v80, v101, v88
    v_dot2c_f32_bf16 v81, v101, v101
    v_dot2c_f32_bf16 v84, v109, v88
    v_dot2c_f32_bf16 v85, v109, v109
    s_nop 2
    v_mov_b32 v82, v80
    v_mov_b32 v83, v81
    v_mov_b32 v86, v84
    v_mov_b32 v87, v85
    v_permlane32_swap_b32 v80, v82
    v_permlane32_swap_b32 v81, v83
    v_permlane32_swap_b32 v84, v86
    v_permlane32_swap_b32 v85, v87
    v_add_f32 v80, v80, v82
    v_add_f32 v81, v81, v83
    v_add_f32 v84, v84, v86
    v_add_f32 v85, v85, v87
    v_mov_b32 v82, v80
    v_mov_b32 v83, v81
    v_mov_b32 v86, v84
    v_mov_b32 v87, v85
    v_permlane16_swap_b32 v80, v82
    v_permlane16_swap_b32 v81, v83
    v_permlane16_swap_b32 v84, v86
    v_permlane16_swap_b32 v85, v87
    v_add_f32 v80, v80, v82
    v_add_f32 v81, v81, v83
    v_add_f32 v84, v84, v86
    v_add_f32 v85, v85, v87
    s_mov_b64 exec, 0xffff
    buffer_store_dwordx2 v[80:81], v11, s[8:11], s52 offen offset:0 sc1
    buffer_store_dwordx2 v[84:85], v11, s[8:11], s52 offen offset:256 sc1
    s_mov_b64 exec, -1
    s_mul_i32 s43, s57, 22528
    s_add_u32 s43, s43, s49
    s_branch Lawo_none
Lawo_f_5:
    s_waitcnt lgkmcnt(4)
    v_mfma_f32_16x16x32_bf16 v[16:19], a[12:15], v[48:51], v[16:19]
    ds_read_b128 v[44:47], v9 offset:6400
    v_mfma_f32_16x16x32_bf16 v[20:23], a[16:19], v[48:51], v[20:23]
    s_add_u32 s46, s46, s51
    v_mfma_f32_16x16x32_bf16 v[24:27], a[20:23], v[48:51], v[24:27]
    s_add_u32 m0, s59, 0
    s_add_u32 s47, s41, 0
    buffer_load_dwordx4 v0, s[8:11], s47 offen offset:0 lds
    s_waitcnt lgkmcnt(4)
    v_mfma_f32_16x16x32_bf16 v[28:31], a[12:15], v[52:55], v[28:31]
    buffer_load_dwordx4 v0, s[8:11], s47 offen offset:1024 lds
    ds_read_b128 v[48:51], v9 offset:8192
    v_mfma_f32_16x16x32_bf16 v[32:35], a[16:19], v[52:55], v[32:35]
    s_add_u32 s46, s46, 8650752
    v_mfma_f32_16x16x32_bf16 v[36:39], a[20:23], v[52:55], v[36:39]
    s_waitcnt lgkmcnt(4)
    v_mfma_f32_16x16x32_bf16 v[16:19], a[24:27], v[56:59], v[16:19]
    buffer_load_dwordx4 v0, s[8:11], s47 offen offset:2048 lds
    ds_read_b128 v[52:55], v9 offset:8448
    v_mfma_f32_16x16x32_bf16 v[20:23], a[28:31], v[56:59], v[20:23]
    s_mul_i32 s52, s34, 786432
    v_mfma_f32_16x16x32_bf16 v[24:27], a[32:35], v[56:59], v[24:27]
    s_waitcnt lgkmcnt(4)
    v_mfma_f32_16x16x32_bf16 v[28:31], a[24:27], v[60:63], v[28:31]
    buffer_load_dwordx4 v0, s[8:11], s47 offen offset:3072 lds
    ds_read_b128 v[56:59], v9 offset:10240
    v_mfma_f32_16x16x32_bf16 v[32:35], a[28:31], v[60:63], v[32:35]
    s_mul_i32 s51, s35, 6144
    v_mfma_f32_16x16x32_bf16 v[36:39], a[32:35], v[60:63], v[36:39]
    s_waitcnt lgkmcnt(4)
    v_mfma_f32_16x16x32_bf16 v[16:19], a[36:39], v[40:43], v[16:19]
    ds_read_b128 v[60:63], v9 offset:10496
    v_mfma_f32_16x16x32_bf16 v[20:23], a[40:43], v[40:43], v[20:23]
    s_add_u32 s52, s52, s51
    v_mfma_f32_16x16x32_bf16 v[24:27], a[44:47], v[40:43], v[24:27]
    s_add_u32 m0, s59, 4096
    s_add_u32 s47, s41, 4096
    buffer_load_dwordx4 v0, s[8:11], s47 offen offset:0 lds
    s_waitcnt lgkmcnt(4)
    v_mfma_f32_16x16x32_bf16 v[28:31], a[36:39], v[44:47], v[28:31]
    buffer_load_dwordx4 v0, s[8:11], s47 offen offset:1024 lds
    ds_read_b128 v[40:43], v9 offset:12288
    v_mfma_f32_16x16x32_bf16 v[32:35], a[40:43], v[44:47], v[32:35]
    s_add_u32 s52, s52, 16121856
    v_mfma_f32_16x16x32_bf16 v[36:39], a[44:47], v[44:47], v[36:39]
    s_waitcnt lgkmcnt(4)
    v_mfma_f32_16x16x32_bf16 v[16:19], a[48:51], v[48:51], v[16:19]
    buffer_load_dwordx4 v0, s[8:11], s47 offen offset:2048 lds
    ds_read_b128 v[44:47], v9 offset:12544
    v_mfma_f32_16x16x32_bf16 v[20:23], a[52:55], v[48:51], v[20:23]
    v_mfma_f32_16x16x32_bf16 v[24:27], a[56:59], v[48:51], v[24:27]
    s_waitcnt lgkmcnt(4)
    v_mfma_f32_16x16x32_bf16 v[28:31], a[48:51], v[52:55], v[28:31]
    buffer_load_dwordx4 v0, s[8:11], s47 offen offset:3072 lds
    ds_read_b128 v[48:51], v9 offset:14336
    v_mfma_f32_16x16x32_bf16 v[32:35], a[52:55], v[52:55], v[32:35]
    v_mfma_f32_16x16x32_bf16 v[36:39], a[56:59], v[52:55], v[36:39]
    s_waitcnt lgkmcnt(4)
    v_mfma_f32_16x16x32_bf16 v[16:19], a[60:63], v[56:59], v[16:19]
    ds_read_b128 v[52:55], v9 offset:14592
    v_mfma_f32_16x16x32_bf16 v[20:23], a[64:67], v[56:59], v[20:23]
    s_add_u32 m0, s59, 8192
    s_add_u32 s47, s41, 8192
    buffer_load_dwordx4 v0, s[8:11], s47 offen offset:0 lds
    v_mfma_f32_16x16x32_bf16 v[24:27], a[68:71], v[56:59], v[24:27]
    s_waitcnt lgkmcnt(4)
    v_mfma_f32_16x16x32_bf16 v[28:31], a[60:63], v[60:63], v[28:31]
    s_mul_i32 s48, s36, 4718592
    s_mul_i32 s18, s37, 36864
    s_add_u32 s48, s48, s18
    s_add_u32 s48, s48, 6291456
    buffer_load_dwordx4 v[64:67], v10, s[8:11], s48 offen offset:0
    ds_read_b128 v[56:59], v9 offset:16384
    v_mfma_f32_16x16x32_bf16 v[32:35], a[64:67], v[60:63], v[32:35]
    v_cmp_eq_u32 s[76:77], 1, v2
    v_cmp_eq_u32 vcc, 2, v2
    v_mfma_f32_16x16x32_bf16 v[36:39], a[68:71], v[60:63], v[36:39]
    s_cmp_eq_u64 s[76:77], -1
    s_cselect_b32 s38, 1, 0
    s_waitcnt lgkmcnt(4)
    v_mfma_f32_16x16x32_bf16 v[16:19], a[72:75], v[40:43], v[16:19]
    s_cmp_lg_u32 s38, 0
    s_cselect_b64 exec, 1, 0
    v_mov_b32 v15, s32
    ds_write_b32 v184, v15
    v_mov_b32 v2, 2
    s_mov_b64 exec, -1
    ds_read_b128 v[60:63], v9 offset:16640
    v_mfma_f32_16x16x32_bf16 v[20:23], a[76:79], v[40:43], v[20:23]
    s_add_u32 s32, s32, s38
    s_mul_i32 s38, s38, 22528
    s_add_u32 s33, s33, s38
    v_mfma_f32_16x16x32_bf16 v[24:27], a[80:83], v[40:43], v[24:27]
    s_cmp_eq_u64 vcc, 0
    s_cselect_b32 s38, s32, 0x7fff
    s_waitcnt lgkmcnt(5)
    v_mfma_f32_16x16x32_bf16 v[28:31], a[72:75], v[44:47], v[28:31]
    s_cmp_le_u32 s38, s39
    s_cselect_b64 exec, -1, 0
    v_mov_b32 v2, 2
    buffer_load_dword v2, v1, s[8:11], s33 offen sc1
    s_mov_b64 exec, -1
    ds_read_b128 v[40:43], v9 offset:18432
    v_mfma_f32_16x16x32_bf16 v[32:35], a[76:79], v[44:47], v[32:35]
    buffer_load_dwordx2 v[68:69], v12, s[8:11], s48 offen offset:0
    buffer_load_dwordx4 v[72:75], v10, s[8:11], s48 offen offset:256
    v_mfma_f32_16x16x32_bf16 v[36:39], a[80:83], v[44:47], v[36:39]
    s_waitcnt lgkmcnt(5)
    v_mfma_f32_16x16x32_bf16 v[16:19], a[84:87], v[48:51], v[16:19]
    buffer_load_dwordx2 v[76:77], v12, s[8:11], s48 offen offset:256
    ds_read_b128 v[44:47], v9 offset:18688
    v_mfma_f32_16x16x32_bf16 v[20:23], a[88:91], v[48:51], v[20:23]
    v_mfma_f32_16x16x32_bf16 v[24:27], a[92:95], v[48:51], v[24:27]
    s_waitcnt lgkmcnt(5)
    v_mfma_f32_16x16x32_bf16 v[28:31], a[84:87], v[52:55], v[28:31]
    ds_read_b128 v[48:51], v9 offset:20480
    v_mfma_f32_16x16x32_bf16 v[32:35], a[88:91], v[52:55], v[32:35]
    v_mfma_f32_16x16x32_bf16 v[36:39], a[92:95], v[52:55], v[36:39]
    s_waitcnt lgkmcnt(5)
    v_mfma_f32_16x16x32_bf16 v[16:19], a[96:99], v[56:59], v[16:19]
    ds_read_b128 v[52:55], v9 offset:20736
    v_mfma_f32_16x16x32_bf16 v[20:23], a[100:103], v[56:59], v[20:23]
    v_mfma_f32_16x16x32_bf16 v[24:27], a[104:107], v[56:59], v[24:27]
    s_waitcnt lgkmcnt(4)
    v_mfma_f32_16x16x32_bf16 v[28:31], a[96:99], v[60:63], v[28:31]
    ds_read_b128 v[56:59], v9 offset:22528
    v_mfma_f32_16x16x32_bf16 v[32:35], a[100:103], v[60:63], v[32:35]
    v_mfma_f32_16x16x32_bf16 v[36:39], a[104:107], v[60:63], v[36:39]
    s_waitcnt vmcnt(15)
    s_cmp_lg_u32 s43, 0
    s_cselect_b64 exec, 1, 0
    buffer_store_dword v3, v4, s[8:11], s43 offen sc1
    s_mov_b64 exec, -1
    s_mov_b32 s43, 0
    s_waitcnt lgkmcnt(4)
    v_mfma_f32_16x16x32_bf16 v[16:19], a[108:111], v[40:43], v[16:19]
    ds_read_b128 v[60:63], v9 offset:22784
    v_mfma_f32_16x16x32_bf16 v[20:23], a[112:115], v[40:43], v[20:23]
    v_mfma_f32_16x16x32_bf16 v[24:27], a[116:119], v[40:43], v[24:27]
    s_waitcnt lgkmcnt(4)
    v_mfma_f32_16x16x32_bf16 v[28:31], a[108:111], v[44:47], v[28:31]
    ds_read_b128 v[40:43], v9 offset:24576
    v_mfma_f32_16x16x32_bf16 v[32:35], a[112:115], v[44:47], v[32:35]
    v_mfma_f32_16x16x32_bf16 v[36:39], a[116:119], v[44:47], v[36:39]
    s_waitcnt lgkmcnt(4)
    v_mfma_f32_16x16x32_bf16 v[16:19], a[120:123], v[48:51], v[16:19]
    ds_read_b128 v[44:47], v9 offset:24832
    v_mfma_f32_16x16x32_bf16 v[20:23], a[124:127], v[48:51], v[20:23]
    v_mfma_f32_16x16x32_bf16 v[24:27], a[128:131], v[48:51], v[24:27]
    s_waitcnt lgkmcnt(4)
    v_mfma_f32_16x16x32_bf16 v[28:31], a[120:123], v[52:55], v[28:31]
    ds_read_b128 v[48:51], v9 offset:26624
    v_mfma_f32_16x16x32_bf16 v[32:35], a[124:127], v[52:55], v[32:35]
    v_mfma_f32_16x16x32_bf16 v[36:39], a[128:131], v[52:55], v[36:39]
    s_waitcnt lgkmcnt(4)
    v_mfma_f32_16x16x32_bf16 v[16:19], a[132:135], v[56:59], v[16:19]
    ds_read_b128 v[52:55], v9 offset:26880
    v_mfma_f32_16x16x32_bf16 v[20:23], a[136:139], v[56:59], v[20:23]
    v_mfma_f32_16x16x32_bf16 v[24:27], a[140:143], v[56:59], v[24:27]
    s_waitcnt lgkmcnt(4)
    v_mfma_f32_16x16x32_bf16 v[28:31], a[132:135], v[60:63], v[28:31]
    ds_read_b128 v[56:59], v9 offset:28672
    v_mfma_f32_16x16x32_bf16 v[32:35], a[136:139], v[60:63], v[32:35]
    v_mfma_f32_16x16x32_bf16 v[36:39], a[140:143], v[60:63], v[36:39]
    s_waitcnt lgkmcnt(4)
    v_mfma_f32_16x16x32_bf16 v[16:19], a[144:147], v[40:43], v[16:19]
    ds_read_b128 v[60:63], v9 offset:28928
    v_mfma_f32_16x16x32_bf16 v[20:23], a[148:151], v[40:43], v[20:23]
    v_mfma_f32_16x16x32_bf16 v[24:27], a[152:155], v[40:43], v[24:27]
    s_waitcnt lgkmcnt(4)
    v_mfma_f32_16x16x32_bf16 v[28:31], a[144:147], v[44:47], v[28:31]
    ds_read_b128 v[40:43], v9 offset:30720
    v_mfma_f32_16x16x32_bf16 v[32:35], a[148:151], v[44:47], v[32:35]
    v_mfma_f32_16x16x32_bf16 v[36:39], a[152:155], v[44:47], v[36:39]
    s_waitcnt lgkmcnt(4)
    v_mfma_f32_16x16x32_bf16 v[16:19], a[156:159], v[48:51], v[16:19]
    ds_read_b128 v[44:47], v9 offset:30976
    v_mfma_f32_16x16x32_bf16 v[20:23], a[160:163], v[48:51], v[20:23]
    v_mfma_f32_16x16x32_bf16 v[24:27], a[164:167], v[48:51], v[24:27]
    s_waitcnt lgkmcnt(4)
    v_mfma_f32_16x16x32_bf16 v[28:31], a[156:159], v[52:55], v[28:31]
    ds_read_b128 v[48:51], v9 offset:32768
    v_mfma_f32_16x16x32_bf16 v[32:35], a[160:163], v[52:55], v[32:35]
    v_mfma_f32_16x16x32_bf16 v[36:39], a[164:167], v[52:55], v[36:39]
    s_waitcnt lgkmcnt(4)
    v_mfma_f32_16x16x32_bf16 v[16:19], a[168:171], v[56:59], v[16:19]
    ds_read_b128 v[52:55], v9 offset:33024
    v_mfma_f32_16x16x32_bf16 v[20:23], a[172:175], v[56:59], v[20:23]
    v_mfma_f32_16x16x32_bf16 v[24:27], a[176:179], v[56:59], v[24:27]
    s_waitcnt lgkmcnt(4)
    v_mfma_f32_16x16x32_bf16 v[28:31], a[168:171], v[60:63], v[28:31]
    v_cmp_eq_u32 s[76:77], 1, v2
    v_cmp_eq_u32 vcc, 2, v2
    ds_read_b128 v[56:59], v9 offset:34816
    v_mfma_f32_16x16x32_bf16 v[32:35], a[172:175], v[60:63], v[32:35]
    s_cmp_eq_u64 s[76:77], -1
    s_cselect_b32 s38, 1, 0
    v_mfma_f32_16x16x32_bf16 v[36:39], a[176:179], v[60:63], v[36:39]
    s_cmp_lg_u32 s38, 0
    s_cselect_b64 exec, 1, 0
    v_mov_b32 v15, s32
    ds_write_b32 v184, v15
    v_mov_b32 v2, 2
    s_mov_b64 exec, -1
    s_waitcnt lgkmcnt(5)
    v_mfma_f32_16x16x32_bf16 v[16:19], a[180:183], v[40:43], v[16:19]
    ds_read_b128 v[60:63], v9 offset:35072
    v_mfma_f32_16x16x32_bf16 v[20:23], a[184:187], v[40:43], v[20:23]
    s_add_u32 s32, s32, s38
    s_mul_i32 s38, s38, 22528
    s_add_u32 s33, s33, s38
    v_mfma_f32_16x16x32_bf16 v[24:27], a[188:191], v[40:43], v[24:27]
    s_cmp_eq_u64 vcc, 0
    s_cselect_b32 s38, s32, 0x7fff
    s_waitcnt lgkmcnt(5)
    v_mfma_f32_16x16x32_bf16 v[28:31], a[180:183], v[44:47], v[28:31]
    s_cmp_le_u32 s38, s39
    s_cselect_b64 exec, -1, 0
    v_mov_b32 v2, 2
    buffer_load_dword v2, v1, s[8:11], s33 offen sc1
    s_mov_b64 exec, -1
    v_mfma_f32_16x16x32_bf16 v[32:35], a[184:187], v[44:47], v[32:35]
    v_mfma_f32_16x16x32_bf16 v[36:39], a[188:191], v[44:47], v[36:39]
    s_waitcnt lgkmcnt(4)
    v_mfma_f32_16x16x32_bf16 v[16:19], a[192:195], v[48:51], v[16:19]
    v_mfma_f32_16x16x32_bf16 v[20:23], a[196:199], v[48:51], v[20:23]
    v_mfma_f32_16x16x32_bf16 v[24:27], a[200:203], v[48:51], v[24:27]
    s_waitcnt lgkmcnt(3)
    v_mfma_f32_16x16x32_bf16 v[28:31], a[192:195], v[52:55], v[28:31]
    v_mfma_f32_16x16x32_bf16 v[32:35], a[196:199], v[52:55], v[32:35]
    v_mfma_f32_16x16x32_bf16 v[36:39], a[200:203], v[52:55], v[36:39]
    s_waitcnt lgkmcnt(2)
    v_mfma_f32_16x16x32_bf16 v[16:19], a[204:207], v[56:59], v[16:19]
    v_mfma_f32_16x16x32_bf16 v[20:23], a[208:211], v[56:59], v[20:23]
    v_mfma_f32_16x16x32_bf16 v[24:27], a[212:215], v[56:59], v[24:27]
    s_waitcnt lgkmcnt(0)
    v_mfma_f32_16x16x32_bf16 v[28:31], a[204:207], v[60:63], v[28:31]
    v_mfma_f32_16x16x32_bf16 v[32:35], a[208:211], v[60:63], v[32:35]
    v_mfma_f32_16x16x32_bf16 v[36:39], a[212:215], v[60:63], v[36:39]
    v_mov_b32 v88, 0x3f803f80
    v_cvt_pk_bf16_f32 v96, v16, v17
    v_cvt_pk_bf16_f32 v97, v18, v19
    v_cvt_pk_bf16_f32 v98, v20, v21
    v_cvt_pk_bf16_f32 v99, v22, v23
    v_cvt_pk_bf16_f32 v100, v24, v25
    v_cvt_pk_bf16_f32 v101, v26, v27
    buffer_store_dwordx4 v[96:99], v10, s[8:11], s46 offen offset:0 sc1
    buffer_store_dwordx2 v[100:101], v12, s[8:11], s46 offen offset:0 sc1
    v_cvt_pk_bf16_f32 v104, v28, v29
    v_cvt_pk_bf16_f32 v105, v30, v31
    v_cvt_pk_bf16_f32 v106, v32, v33
    v_cvt_pk_bf16_f32 v107, v34, v35
    v_cvt_pk_bf16_f32 v108, v36, v37
    v_cvt_pk_bf16_f32 v109, v38, v39
    buffer_store_dwordx4 v[104:107], v10, s[8:11], s46 offen offset:256 sc1
    buffer_store_dwordx2 v[108:109], v12, s[8:11], s46 offen offset:256 sc1
    v_mov_b32 v80, 0
    v_mov_b32 v81, 0
    v_mov_b32 v84, 0
    v_mov_b32 v85, 0
    v_dot2c_f32_bf16 v80, v96, v88
    v_dot2c_f32_bf16 v81, v96, v96
    v_dot2c_f32_bf16 v84, v104, v88
    v_dot2c_f32_bf16 v85, v104, v104
    v_dot2c_f32_bf16 v80, v97, v88
    v_dot2c_f32_bf16 v81, v97, v97
    v_dot2c_f32_bf16 v84, v105, v88
    v_dot2c_f32_bf16 v85, v105, v105
    v_dot2c_f32_bf16 v80, v98, v88
    v_dot2c_f32_bf16 v81, v98, v98
    v_dot2c_f32_bf16 v84, v106, v88
    v_dot2c_f32_bf16 v85, v106, v106
    v_dot2c_f32_bf16 v80, v99, v88
    v_dot2c_f32_bf16 v81, v99, v99
    v_dot2c_f32_bf16 v84, v107, v88
    v_dot2c_f32_bf16 v85, v107, v107
    v_dot2c_f32_bf16 v80, v100, v88
    v_dot2c_f32_bf16 v81, v100, v100
    v_dot2c_f32_bf16 v84, v108, v88
    v_dot2c_f32_bf16 v85, v108, v108
    v_dot2c_f32_bf16 v80, v101, v88
    v_dot2c_f32_bf16 v81, v101, v101
    v_dot2c_f32_bf16 v84, v109, v88
    v_dot2c_f32_bf16 v85, v109, v109
    s_nop 2
    v_mov_b32 v82, v80
    v_mov_b32 v83, v81
    v_mov_b32 v86, v84
    v_mov_b32 v87, v85
    v_permlane32_swap_b32 v80, v82
    v_permlane32_swap_b32 v81, v83
    v_permlane32_swap_b32 v84, v86
    v_permlane32_swap_b32 v85, v87
    v_add_f32 v80, v80, v82
    v_add_f32 v81, v81, v83
    v_add_f32 v84, v84, v86
    v_add_f32 v85, v85, v87
    v_mov_b32 v82, v80
    v_mov_b32 v83, v81
    v_mov_b32 v86, v84
    v_mov_b32 v87, v85
    v_permlane16_swap_b32 v80, v82
    v_permlane16_swap_b32 v81, v83
    v_permlane16_swap_b32 v84, v86
    v_permlane16_swap_b32 v85, v87
    v_add_f32 v80, v80, v82
    v_add_f32 v81, v81, v83
    v_add_f32 v84, v84, v86
    v_add_f32 v85, v85, v87
    s_mov_b64 exec, 0xffff
    buffer_store_dwordx2 v[80:81], v11, s[8:11], s52 offen offset:0 sc1
    buffer_store_dwordx2 v[84:85], v11, s[8:11], s52 offen offset:256 sc1
    s_mov_b64 exec, -1
    s_mul_i32 s43, s57, 22528
    s_add_u32 s43, s43, s49
    s_branch Lawo_head
Lawo_f_6:
    v_mfma_f32_16x16x32_bf16 v[16:19], a[96:99], v[56:59], v[16:19]
    ds_read_b128 v[52:55], v9 offset:20736
    v_mfma_f32_16x16x32_bf16 v[20:23], a[100:103], v[56:59], v[20:23]
    s_add_u32 m0, s59, 0
    s_add_u32 s47, s41, 0
    buffer_load_dwordx4 v0, s[8:11], s47 offen offset:0 lds
    v_mfma_f32_16x16x32_bf16 v[24:27], a[104:107], v[56:59], v[24:27]
    v_mfma_f32_16x16x32_bf16 v[28:31], a[96:99], v[60:63], v[28:31]
    buffer_load_dwordx4 v0, s[8:11], s47 offen offset:1024 lds
    ds_read_b128 v[56:59], v9 offset:22528
    v_mfma_f32_16x16x32_bf16 v[32:35], a[100:103], v[60:63], v[32:35]
    v_mfma_f32_16x16x32_bf16 v[36:39], a[104:107], v[60:63], v[36:39]
    s_waitcnt vmcnt(4)
    s_cmp_lg_u32 s43, 0
    s_cselect_b64 exec, 1, 0
    buffer_store_dword v3, v4, s[8:11], s43 offen sc1
    s_mov_b64 exec, -1
    s_mov_b32 s43, 0
    v_mfma_f32_16x16x32_bf16 v[16:19], a[108:111], v[40:43], v[16:19]
    buffer_load_dwordx4 v0, s[8:11], s47 offen offset:2048 lds
    ds_read_b128 v[60:63], v9 offset:22784
    v_mfma_f32_16x16x32_bf16 v[20:23], a[112:115], v[40:43], v[20:23]
    v_mfma_f32_16x16x32_bf16 v[24:27], a[116:119], v[40:43], v[24:27]
    s_waitcnt lgkmcnt(4)
    v_mfma_f32_16x16x32_bf16 v[28:31], a[108:111], v[44:47], v[28:31]
    buffer_load_dwordx4 v0, s[8:11], s47 offen offset:3072 lds
    ds_read_b128 v[40:43], v9 offset:24576
    v_mfma_f32_16x16x32_bf16 v[32:35], a[112:115], v[44:47], v[32:35]
    v_mfma_f32_16x16x32_bf16 v[36:39], a[116:119], v[44:47], v[36:39]
    s_waitcnt lgkmcnt(4)
    v_mfma_f32_16x16x32_bf16 v[16:19], a[120:123], v[48:51], v[16:19]
    ds_read_b128 v[44:47], v9 offset:24832
    v_mfma_f32_16x16x32_bf16 v[20:23], a[124:127], v[48:51], v[20:23]
    s_add_u32 m0, s59, 4096
    s_add_u32 s47, s41, 4096
    buffer_load_dwordx4 v0, s[8:11], s47 offen offset:0 lds
    v_mfma_f32_16x16x32_bf16 v[24:27], a[128:131], v[48:51], v[24:27]
    s_waitcnt lgkmcnt(4)
    v_mfma_f32_16x16x32_bf16 v[28:31], a[120:123], v[52:55], v[28:31]
    buffer_load_dwordx4 v0, s[8:11], s47 offen offset:1024 lds
    ds_read_b128 v[48:51], v9 offset:26624
    v_mfma_f32_16x16x32_bf16 v[32:35], a[124:127], v[52:55], v[32:35]
    v_mfma_f32_16x16x32_bf16 v[36:39], a[128:131], v[52:55], v[36:39]
    s_waitcnt lgkmcnt(4)
    v_mfma_f32_16x16x32_bf16 v[16:19], a[132:135], v[56:59], v[16:19]
    buffer_load_dwordx4 v0, s[8:11], s47 offen offset:2048 lds
    ds_read_b128 v[52:55], v9 offset:26880
    v_mfma_f32_16x16x32_bf16 v[20:23], a[136:139], v[56:59], v[20:23]
    v_mfma_f32_16x16x32_bf16 v[24:27], a[140:143], v[56:59], v[24:27]
    s_waitcnt lgkmcnt(4)
    v_mfma_f32_16x16x32_bf16 v[28:31], a[132:135], v[60:63], v[28:31]
    buffer_load_dwordx4 v0, s[8:11], s47 offen offset:3072 lds
    ds_read_b128 v[56:59], v9 offset:28672
    v_mfma_f32_16x16x32_bf16 v[32:35], a[136:139], v[60:63], v[32:35]
    v_mfma_f32_16x16x32_bf16 v[36:39], a[140:143], v[60:63], v[36:39]
    s_waitcnt lgkmcnt(4)
    v_mfma_f32_16x16x32_bf16 v[16:19], a[144:147], v[40:43], v[16:19]
    ds_read_b128 v[60:63], v9 offset:28928
    v_mfma_f32_16x16x32_bf16 v[20:23], a[148:151], v[40:43], v[20:23]
    s_add_u32 m0, s59, 8192
    s_add_u32 s47, s41, 8192
    buffer_load_dwordx4 v0, s[8:11], s47 offen offset:0 lds
    v_mfma_f32_16x16x32_bf16 v[24:27], a[152:155], v[40:43], v[24:27]
    s_waitcnt lgkmcnt(4)
    v_mfma_f32_16x16x32_bf16 v[28:31], a[144:147], v[44:47], v[28:31]
    s_mul_i32 s48, s36, 4718592
    s_mul_i32 s18, s37, 36864
    s_add_u32 s48, s48, s18
    s_add_u32 s48, s48, 6291456
    buffer_load_dwordx4 v[64:67], v10, s[8:11], s48 offen offset:0
    ds_read_b128 v[40:43], v9 offset:30720
    v_mfma_f32_16x16x32_bf16 v[32:35], a[148:151], v[44:47], v[32:35]
    v_mfma_f32_16x16x32_bf16 v[36:39], a[152:155], v[44:47], v[36:39]
    s_waitcnt lgkmcnt(4)
    v_mfma_f32_16x16x32_bf16 v[16:19], a[156:159], v[48:51], v[16:19]
    buffer_load_dwordx2 v[68:69], v12, s[8:11], s48 offen offset:0
    ds_read_b128 v[44:47], v9 offset:30976
    v_mfma_f32_16x16x32_bf16 v[20:23], a[160:163], v[48:51], v[20:23]
    v_mfma_f32_16x16x32_bf16 v[24:27], a[164:167], v[48:51], v[24:27]
    s_waitcnt lgkmcnt(4)
    v_mfma_f32_16x16x32_bf16 v[28:31], a[156:159], v[52:55], v[28:31]
    buffer_load_dwordx4 v[72:75], v10, s[8:11], s48 offen offset:256
    ds_read_b128 v[48:51], v9 offset:32768
    v_mfma_f32_16x16x32_bf16 v[32:35], a[160:163], v[52:55], v[32:35]
    v_mfma_f32_16x16x32_bf16 v[36:39], a[164:167], v[52:55], v[36:39]
    s_waitcnt lgkmcnt(4)
    v_mfma_f32_16x16x32_bf16 v[16:19], a[168:171], v[56:59], v[16:19]
    buffer_load_dwordx2 v[76:77], v12, s[8:11], s48 offen offset:256
    ds_read_b128 v[52:55], v9 offset:33024
    v_mfma_f32_16x16x32_bf16 v[20:23], a[172:175], v[56:59], v[20:23]
    v_mfma_f32_16x16x32_bf16 v[24:27], a[176:179], v[56:59], v[24:27]
    s_waitcnt lgkmcnt(4)
    v_mfma_f32_16x16x32_bf16 v[28:31], a[168:171], v[60:63], v[28:31]
    v_cmp_eq_u32 s[76:77], 1, v2
    v_cmp_eq_u32 vcc, 2, v2
    ds_read_b128 v[56:59], v9 offset:34816
    v_mfma_f32_16x16x32_bf16 v[32:35], a[172:175], v[60:63], v[32:35]
    s_cmp_eq_u64 s[76:77], -1
    s_cselect_b32 s38, 1, 0
    v_mfma_f32_16x16x32_bf16 v[36:39], a[176:179], v[60:63], v[36:39]
    s_cmp_lg_u32 s38, 0
    s_cselect_b64 exec, 1, 0
    v_mov_b32 v15, s32
    ds_write_b32 v184, v15
    v_mov_b32 v2, 2
    s_mov_b64 exec, -1
    s_waitcnt lgkmcnt(5)
    v_mfma_f32_16x16x32_bf16 v[16:19], a[180:183], v[40:43], v[16:19]
    ds_read_b128 v[60:63], v9 offset:35072
    v_mfma_f32_16x16x32_bf16 v[20:23], a[184:187], v[40:43], v[20:23]
    s_add_u32 s32, s32, s38
    s_mul_i32 s38, s38, 22528
    s_add_u32 s33, s33, s38
    v_mfma_f32_16x16x32_bf16 v[24:27], a[188:191], v[40:43], v[24:27]
    s_cmp_eq_u64 vcc, 0
    s_cselect_b32 s38, s32, 0x7fff
    s_waitcnt lgkmcnt(5)
    v_mfma_f32_16x16x32_bf16 v[28:31], a[180:183], v[44:47], v[28:31]
    s_cmp_le_u32 s38, s39
    s_cselect_b64 exec, -1, 0
    v_mov_b32 v2, 2
    buffer_load_dword v2, v1, s[8:11], s33 offen sc1
    s_mov_b64 exec, -1
    v_mfma_f32_16x16x32_bf16 v[32:35], a[184:187], v[44:47], v[32:35]
    v_mfma_f32_16x16x32_bf16 v[36:39], a[188:191], v[44:47], v[36:39]
    s_waitcnt lgkmcnt(4)
    v_mfma_f32_16x16x32_bf16 v[16:19], a[192:195], v[48:51], v[16:19]
    v_mfma_f32_16x16x32_bf16 v[20:23], a[196:199], v[48:51], v[20:23]
    v_mfma_f32_16x16x32_bf16 v[24:27], a[200:203], v[48:51], v[24:27]
    s_waitcnt lgkmcnt(3)
    v_mfma_f32_16x16x32_bf16 v[28:31], a[192:195], v[52:55], v[28:31]
    v_mfma_f32_16x16x32_bf16 v[32:35], a[196:199], v[52:55], v[32:35]
    v_mfma_f32_16x16x32_bf16 v[36:39], a[200:203], v[52:55], v[36:39]
    s_waitcnt lgkmcnt(2)
    v_mfma_f32_16x16x32_bf16 v[16:19], a[204:207], v[56:59], v[16:19]
    v_mfma_f32_16x16x32_bf16 v[20:23], a[208:211], v[56:59], v[20:23]
    v_mfma_f32_16x16x32_bf16 v[24:27], a[212:215], v[56:59], v[24:27]
    s_waitcnt lgkmcnt(0)
    v_mfma_f32_16x16x32_bf16 v[28:31], a[204:207], v[60:63], v[28:31]
    v_mfma_f32_16x16x32_bf16 v[32:35], a[208:211], v[60:63], v[32:35]
    v_mfma_f32_16x16x32_bf16 v[36:39], a[212:215], v[60:63], v[36:39]
    v_mov_b32 v88, 0x3f803f80
    v_cvt_pk_bf16_f32 v96, v16, v17
    v_cvt_pk_bf16_f32 v97, v18, v19
    v_cvt_pk_bf16_f32 v98, v20, v21
    v_cvt_pk_bf16_f32 v99, v22, v23
    v_cvt_pk_bf16_f32 v100, v24, v25
    v_cvt_pk_bf16_f32 v101, v26, v27
    buffer_store_dwordx4 v[96:99], v10, s[8:11], s46 offen offset:0 sc1
    buffer_store_dwordx2 v[100:101], v12, s[8:11], s46 offen offset:0 sc1
    v_cvt_pk_bf16_f32 v104, v28, v29
    v_cvt_pk_bf16_f32 v105, v30, v31
    v_cvt_pk_bf16_f32 v106, v32, v33
    v_cvt_pk_bf16_f32 v107, v34, v35
    v_cvt_pk_bf16_f32 v108, v36, v37
    v_cvt_pk_bf16_f32 v109, v38, v39
    buffer_store_dwordx4 v[104:107], v10, s[8:11], s46 offen offset:256 sc1
    buffer_store_dwordx2 v[108:109], v12, s[8:11], s46 offen offset:256 sc1
    v_mov_b32 v80, 0
    v_mov_b32 v81, 0
    v_mov_b32 v84, 0
    v_mov_b32 v85, 0
    v_dot2c_f32_bf16 v80, v96, v88
    v_dot2c_f32_bf16 v81, v96, v96
    v_dot2c_f32_bf16 v84, v104, v88
    v_dot2c_f32_bf16 v85, v104, v104
    v_dot2c_f32_bf16 v80, v97, v88
    v_dot2c_f32_bf16 v81, v97, v97
    v_dot2c_f32_bf16 v84, v105, v88
    v_dot2c_f32_bf16 v85, v105, v105
    v_dot2c_f32_bf16 v80, v98, v88
    v_dot2c_f32_bf16 v81, v98, v98
    v_dot2c_f32_bf16 v84, v106, v88
    v_dot2c_f32_bf16 v85, v106, v106
    v_dot2c_f32_bf16 v80, v99, v88
    v_dot2c_f32_bf16 v81, v99, v99
    v_dot2c_f32_bf16 v84, v107, v88
    v_dot2c_f32_bf16 v85, v107, v107
    v_dot2c_f32_bf16 v80, v100, v88
    v_dot2c_f32_bf16 v81, v100, v100
    v_dot2c_f32_bf16 v84, v108, v88
    v_dot2c_f32_bf16 v85, v108, v108
    v_dot2c_f32_bf16 v80, v101, v88
    v_dot2c_f32_bf16 v81, v101, v101
    v_dot2c_f32_bf16 v84, v109, v88
    v_dot2c_f32_bf16 v85, v109, v109
    s_nop 2
    v_mov_b32 v82, v80
    v_mov_b32 v83, v81
    v_mov_b32 v86, v84
    v_mov_b32 v87, v85
    v_permlane32_swap_b32 v80, v82
    v_permlane32_swap_b32 v81, v83
    v_permlane32_swap_b32 v84, v86
    v_permlane32_swap_b32 v85, v87
    v_add_f32 v80, v80, v82
    v_add_f32 v81, v81, v83
    v_add_f32 v84, v84, v86
    v_add_f32 v85, v85, v87
    v_mov_b32 v82, v80
    v_mov_b32 v83, v81
    v_mov_b32 v86, v84
    v_mov_b32 v87, v85
    v_permlane16_swap_b32 v80, v82
    v_permlane16_swap_b32 v81, v83
    v_permlane16_swap_b32 v84, v86
    v_permlane16_swap_b32 v85, v87
    v_add_f32 v80, v80, v82
    v_add_f32 v81, v81, v83
    v_add_f32 v84, v84, v86
    v_add_f32 v85, v85, v87
    s_mov_b64 exec, 0xffff
    buffer_store_dwordx2 v[80:81], v11, s[8:11], s52 offen offset:0 sc1
    buffer_store_dwordx2 v[84:85], v11, s[8:11], s52 offen offset:256 sc1
    s_mov_b64 exec, -1
    s_mul_i32 s43, s57, 22528
    s_add_u32 s43, s43, s49
    s_branch Lawo_head
Lawo_none:
    ds_read_b32 v15, v184
    s_waitcnt lgkmcnt(0)
    v_readfirstlane_b32 s17, v15
    s_nop 0
    s_cmp_lt_i32 s17, s37
    s_cbranch_scc1 Lawo_nopost
    s_add_u32 m0, s59, 0
    s_add_u32 s47, s41, 0
    buffer_load_dwordx4 v0, s[8:11], s47 offen offset:0 lds
    buffer_load_dwordx4 v0, s[8:11], s47 offen offset:1024 lds
    buffer_load_dwordx4 v0, s[8:11], s47 offen offset:2048 lds
    buffer_load_dwordx4 v0, s[8:11], s47 offen offset:3072 lds
    s_add_u32 m0, s59, 4096
    s_add_u32 s47, s41, 4096
    buffer_load_dwordx4 v0, s[8:11], s47 offen offset:0 lds
    buffer_load_dwordx4 v0, s[8:11], s47 offen offset:1024 lds
    buffer_load_dwordx4 v0, s[8:11], s47 offen offset:2048 lds
    buffer_load_dwordx4 v0, s[8:11], s47 offen offset:3072 lds
    s_add_u32 m0, s59, 8192
    s_add_u32 s47, s41, 8192
    buffer_load_dwordx4 v0, s[8:11], s47 offen offset:0 lds
    s_mul_i32 s48, s36, 4718592
    s_mul_i32 s18, s37, 36864
    s_add_u32 s48, s48, s18
    s_add_u32 s48, s48, 6291456
    buffer_load_dwordx4 v[64:67], v10, s[8:11], s48 offen offset:0
    buffer_load_dwordx2 v[68:69], v12, s[8:11], s48 offen offset:0
    buffer_load_dwordx4 v[72:75], v10, s[8:11], s48 offen offset:256
    buffer_load_dwordx2 v[76:77], v12, s[8:11], s48 offen offset:256
    s_waitcnt vmcnt(13)
    s_cmp_lg_u32 s43, 0
    s_cselect_b64 exec, 1, 0
    buffer_store_dword v3, v4, s[8:11], s43 offen sc1
    s_mov_b64 exec, -1
    s_mov_b32 s43, 0
    s_waitcnt vmcnt(1) lgkmcnt(0)
    s_branch Lawo_head2
Lawo_nopost:
    s_waitcnt vmcnt(0)
    s_cmp_lg_u32 s43, 0
    s_cselect_b64 exec, 1, 0
    buffer_store_dword v3, v4, s[8:11], s43 offen sc1
    s_mov_b64 exec, -1
    s_mov_b32 s43, 0
    s_cmp_ge_u32 s37, 64
    s_cbranch_scc1 Lawo_end
Lawo_wait:
    s_mov_b32 s16, 0
    s_cmp_lg_u32 s14, 0
    s_cbranch_scc1 Lawo_wl
Lawo_wp:
    buffer_load_dword v2, v1, s[8:11], s60 offen sc1
    s_add_u32 s16, s16, 1
    s_cmp_gt_u32 s16, 100000
    s_cbranch_scc1 Lawo_giveup
    s_waitcnt vmcnt(0)
    v_cmp_eq_u32 vcc, 0, v2
    s_nop 0
    s_cbranch_vccz Lawo_wok
    s_sleep 4
    s_branch Lawo_wp
Lawo_giveup:
    v_mov_b32 v5, -2
    ds_write_b32 v184, v5
    s_waitcnt lgkmcnt(0)
    s_branch L_role_awo_abort
Lawo_wok:
    v_mov_b32 v5, s37
    ds_write_b32 v184, v5
    s_branch Lawo_go
Lawo_wl:
    ds_read_b32 v15, v184
    s_add_u32 s16, s16, 1
    s_cmp_gt_u32 s16, 1600000
    s_cbranch_scc1 L_role_awo_abort
    s_waitcnt lgkmcnt(0)
    v_readfirstlane_b32 s17, v15
    s_nop 0
    s_cmp_eq_u32 s17, -2
    s_cbranch_scc1 L_role_awo_abort
    s_cmp_ge_i32 s17, s37
    s_cbranch_scc1 Lawo_go
    s_sleep 1
    s_branch Lawo_wl
Lawo_go:
    s_add_u32 m0, s59, 0
    s_add_u32 s47, s41, 0
    buffer_load_dwordx4 v0, s[8:11], s47 offen offset:0 lds
    buffer_load_dwordx4 v0, s[8:11], s47 offen offset:1024 lds
    buffer_load_dwordx4 v0, s[8:11], s47 offen offset:2048 lds
    buffer_load_dwordx4 v0, s[8:11], s47 offen offset:3072 lds
    s_add_u32 m0, s59, 4096
    s_add_u32 s47, s41, 4096
    buffer_load_dwordx4 v0, s[8:11], s47 offen offset:0 lds
    buffer_load_dwordx4 v0, s[8:11], s47 offen offset:1024 lds
    buffer_load_dwordx4 v0, s[8:11], s47 offen offset:2048 lds
    buffer_load_dwordx4 v0, s[8:11], s47 offen offset:3072 lds
    s_add_u32 m0, s59, 8192
    s_add_u32 s47, s41, 8192
    buffer_load_dwordx4 v0, s[8:11], s47 offen offset:0 lds
    s_mul_i32 s48, s36, 4718592
    s_mul_i32 s18, s37, 36864
    s_add_u32 s48, s48, s18
    s_add_u32 s48, s48, 6291456
    buffer_load_dwordx4 v[64:67], v10, s[8:11], s48 offen offset:0
    buffer_load_dwordx2 v[68:69], v12, s[8:11], s48 offen offset:0
    buffer_load_dwordx4 v[72:75], v10, s[8:11], s48 offen offset:256
    buffer_load_dwordx2 v[76:77], v12, s[8:11], s48 offen offset:256
    s_waitcnt vmcnt(0) lgkmcnt(0)
    s_branch Lawo_head2
Lawo_end:
    s_branch L_role_awo_exit
L_role_awo_abort:
    s_waitcnt lgkmcnt(0)
    s_mov_b64 exec, -1
    v_mov_b32 v0, 60
    s_lshl_b32 s5, s3, 8
    s_or_b32 s5, s5, s4
    s_or_b32 s5, s5, 0x10000
    v_mov_b32 v1, s5
    global_store_dword v0, v1, s[12:13]
    s_endpgm
L_role_awo_exit:
    s_endpgm
.p2align 6
L_role_aq:
    v_and_b32 v5, 63, v0
    v_lshlrev_b32 v0, 4, v5
    v_and_b32 v7, 15, v5
    v_lshrrev_b32 v8, 4, v5
    v_min_u32 v1, 47, v5
    v_lshrrev_b32 v6, 2, v1
    v_and_b32 v1, 3, v1
    v_lshlrev_b32 v1, 2, v1
    v_lshl_add_u32 v1, v6, 7, v1
    v_mov_b32 v3, 1
    v_mov_b32 v4, 0
    s_mov_b32 s44, 0x05040100
    s_mov_b32 s45, 0x07060302
    s_lshr_b32 s63, s15, 4
    s_and_b32 s15, s15, 15
    s_lshr_b32 s50, s15, 1
    s_lshl_b32 s50, s50, 2
    s_and_b32 s17, s15, 1
    s_add_u32 s50, s50, s17
    s_and_b32 s17, s14, 2
    s_add_u32 s50, s50, s17
    s_and_b32 s51, s14, 1
    s_cmp_eq_u32 s63, 0
    s_cbranch_scc1 Laq_gate_ng
    s_cmp_lg_u32 s14, 0
    s_cbranch_scc1 Laq_gate_d
    v_mov_b32 v5, 48
    s_mov_b32 s16, 0
Laq_gate:
    global_load_dword v6, v5, s[12:13] sc1
    s_add_u32 s16, s16, 1
    s_cmp_gt_u32 s16, 100000
    s_cbranch_scc1 L_role_aq_abort
    s_waitcnt vmcnt(0)
    v_cmp_gt_u32 vcc, 32, v6
    s_nop 0
    s_cbranch_vccz Laq_gate_d
    s_sleep 100
    s_branch Laq_gate
Laq_gate_d:
    s_barrier
Laq_gate_ng:
    s_load_dwordx2 s[20:21], s[0:1], 8
    s_mov_b32 s22, 1990656
    s_mov_b32 s23, 0x00020000
    s_waitcnt lgkmcnt(0)
    s_and_b32 s21, s21, 0xffff
    v_lshrrev_b32 v5, 7, v0
    v_mul_u32_u24 v16, 3456, v5
    v_and_b32 v5, 0x70, v0
    v_add_u32 v16, v16, v5
    s_lshr_b32 s17, s14, 1
    s_mul_i32 s46, s17, 72
    v_lshrrev_b32 v5, 2, v7
    v_lshl_add_u32 v5, v8, 3, v5
    v_and_b32 v6, 3, v7
    v_lshlrev_b32 v17, 7, v5
    v_lshl_add_u32 v17, v6, 3, v17
    v_add_u32 v17, s46, v17
    v_lshlrev_b32 v18, 5, v5
    v_min_u32 v6, 1, v6
    v_lshl_add_u32 v18, v6, 4, v18
    s_mul_i32 s17, s17, 3072
    s_add_u32 s17, s17, 36864
    v_add_u32 v18, s17, v18
    s_sub_u32 s17, s50, s14
    s_lshr_b32 s17, s14, 1
    s_lshl_b32 s17, s17, 1
    s_sub_u32 s17, s50, s17
    s_mul_i32 s49, s17, 36
    s_mul_i32 s17, s14, 82944
    s_add_u32 s49, s49, s17
    s_mul_i32 s47, s14, 3072
    v_lshrrev_b32 v21, 4, v0
    s_lshl_b32 s17, s14, 6
    v_add_u32 v21, s17, v21
    v_cmp_le_u32 vcc, 96, v21
    s_nop 1
    v_cndmask_b32 v5, 0, 1, vcc
    v_mul_u32_u24 v6, 96, v5
    v_sub_u32 v6, v21, v6
    v_lshlrev_b32 v19, 7, v6
    v_mul_u32_u24 v20, 72, v5
    v_add_u32 v19, v19, v20
    v_add_u32 v19, 32, v19
    v_lshlrev_b32 v20, 5, v21
    v_add_u32 v20, 36864, v20
    v_mov_b32 v24, 0
    v_mov_b32 v25, 0
    v_mov_b32 v26, 0
    v_mov_b32 v27, 0
    v_mov_b32 v31, 0
    s_cmp_eq_u32 s14, 3
    s_cselect_b64 s[76:77], 0, -1
    s_mov_b64 exec, s[76:77]
    v_add_u32 v22, 0, v20
    ds_write_b128 v22, v[24:27] offset:16
    v_add_u32 v22, 43008, v20
    ds_write_b128 v22, v[24:27] offset:16
    v_add_u32 v22, 86016, v20
    ds_write_b128 v22, v[24:27] offset:16
    s_mov_b64 exec, -1
    s_add_u32 m0, s47, 0
    s_add_u32 s17, s49, 0
    buffer_load_dwordx4 v16, s[20:23], s17 offen lds
    s_add_u32 m0, s47, 1024
    s_add_u32 s17, s49, 27648
    buffer_load_dwordx4 v16, s[20:23], s17 offen lds
    s_add_u32 m0, s47, 2048
    s_add_u32 s17, s49, 55296
    buffer_load_dwordx4 v16, s[20:23], s17 offen lds
    s_add_u32 m0, s47, 12288
    s_add_u32 s17, s49, 1152
    buffer_load_dwordx4 v16, s[20:23], s17 offen lds
    s_add_u32 m0, s47, 13312
    s_add_u32 s17, s49, 28800
    buffer_load_dwordx4 v16, s[20:23], s17 offen lds
    s_add_u32 m0, s47, 14336
    s_add_u32 s17, s49, 56448
    buffer_load_dwordx4 v16, s[20:23], s17 offen lds
    s_add_u32 m0, s47, 24576
    s_add_u32 s17, s49, 2304
    buffer_load_dwordx4 v16, s[20:23], s17 offen lds
    s_add_u32 m0, s47, 25600
    s_add_u32 s17, s49, 29952
    buffer_load_dwordx4 v16, s[20:23], s17 offen lds
    s_add_u32 m0, s47, 26624
    s_add_u32 s17, s49, 57600
    buffer_load_dwordx4 v16, s[20:23], s17 offen lds
    s_add_u32 m0, s47, 43008
    s_add_u32 s17, s49, 331776
    buffer_load_dwordx4 v16, s[20:23], s17 offen lds
    s_add_u32 m0, s47, 44032
    s_add_u32 s17, s49, 359424
    buffer_load_dwordx4 v16, s[20:23], s17 offen lds
    s_add_u32 m0, s47, 45056
    s_add_u32 s17, s49, 387072
    buffer_load_dwordx4 v16, s[20:23], s17 offen lds
    s_add_u32 m0, s47, 55296
    s_add_u32 s17, s49, 332928
    buffer_load_dwordx4 v16, s[20:23], s17 offen lds
    s_add_u32 m0, s47, 56320
    s_add_u32 s17, s49, 360576
    buffer_load_dwordx4 v16, s[20:23], s17 offen lds
    s_add_u32 m0, s47, 57344
    s_add_u32 s17, s49, 388224
    buffer_load_dwordx4 v16, s[20:23], s17 offen lds
    s_add_u32 m0, s47, 67584
    s_add_u32 s17, s49, 334080
    buffer_load_dwordx4 v16, s[20:23], s17 offen lds
    s_add_u32 m0, s47, 68608
    s_add_u32 s17, s49, 361728
    buffer_load_dwordx4 v16, s[20:23], s17 offen lds
    s_add_u32 m0, s47, 69632
    s_add_u32 s17, s49, 389376
    buffer_load_dwordx4 v16, s[20:23], s17 offen lds
    s_add_u32 m0, s47, 86016
    s_add_u32 s17, s49, 663552
    buffer_load_dwordx4 v16, s[20:23], s17 offen lds
    s_add_u32 m0, s47, 87040
    s_add_u32 s17, s49, 691200
    buffer_load_dwordx4 v16, s[20:23], s17 offen lds
    s_add_u32 m0, s47, 88064
    s_add_u32 s17, s49, 718848
    buffer_load_dwordx4 v16, s[20:23], s17 offen lds
    s_add_u32 m0, s47, 98304
    s_add_u32 s17, s49, 664704
    buffer_load_dwordx4 v16, s[20:23], s17 offen lds
    s_add_u32 m0, s47, 99328
    s_add_u32 s17, s49, 692352
    buffer_load_dwordx4 v16, s[20:23], s17 offen lds
    s_add_u32 m0, s47, 100352
    s_add_u32 s17, s49, 720000
    buffer_load_dwordx4 v16, s[20:23], s17 offen lds
    s_add_u32 m0, s47, 110592
    s_add_u32 s17, s49, 665856
    buffer_load_dwordx4 v16, s[20:23], s17 offen lds
    s_add_u32 m0, s47, 111616
    s_add_u32 s17, s49, 693504
    buffer_load_dwordx4 v16, s[20:23], s17 offen lds
    s_add_u32 m0, s47, 112640
    s_add_u32 s17, s49, 721152
    buffer_load_dwordx4 v16, s[20:23], s17 offen lds
    s_waitcnt vmcnt(18) lgkmcnt(0)
    s_barrier
    s_mov_b64 exec, s[76:77]
    v_add_u32 v22, 0, v19
    ds_read_b32 v28, v22 offset:0
    ds_read_b32 v29, v22 offset:12288
    ds_read_b32 v30, v22 offset:24576
    s_waitcnt lgkmcnt(0)
    v_add_u32 v22, 0, v20
    ds_write_b128 v22, v[28:31]
    s_mov_b64 exec, -1
    v_add_u32 v22, 0, v17
    v_add_u32 v23, 0, v18
    ds_read_b64_tr_b16 v[152:153], v22 offset:0
    ds_read_b64_tr_b16 v[154:155], v22 offset:512
    ds_read_b64_tr_b16 v[224:225], v22 offset:12288
    ds_read_b64_tr_b16 v[226:227], v22 offset:12800
    ds_read_b64_tr_b16 a[112:113], v22 offset:24576
    ds_read_b64_tr_b16 a[114:115], v22 offset:25088
    ds_read_b64_tr_b16 v[156:157], v22 offset:4096
    ds_read_b64_tr_b16 v[158:159], v22 offset:4608
    ds_read_b64_tr_b16 v[228:229], v22 offset:16384
    ds_read_b64_tr_b16 v[230:231], v22 offset:16896
    ds_read_b64_tr_b16 a[116:117], v22 offset:28672
    ds_read_b64_tr_b16 a[118:119], v22 offset:29184
    ds_read_b64_tr_b16 v[160:161], v22 offset:8192
    ds_read_b64_tr_b16 v[162:163], v22 offset:8704
    ds_read_b64_tr_b16 v[232:233], v22 offset:20480
    ds_read_b64_tr_b16 v[234:235], v22 offset:20992
    ds_read_b64_tr_b16 a[120:121], v22 offset:32768
    ds_read_b64_tr_b16 a[122:123], v22 offset:33280
    s_waitcnt lgkmcnt(0)
    s_barrier
    ds_read_b64_tr_b16 a[40:41], v23 offset:0
    ds_read_b64_tr_b16 a[42:43], v23 offset:128
    ds_read_b64_tr_b16 a[184:185], v23 offset:8
    ds_read_b64_tr_b16 a[186:187], v23 offset:136
    ds_read_b64_tr_b16 a[44:45], v23 offset:1024
    ds_read_b64_tr_b16 a[46:47], v23 offset:1152
    ds_read_b64_tr_b16 a[188:189], v23 offset:1032
    ds_read_b64_tr_b16 a[190:191], v23 offset:1160
    ds_read_b64_tr_b16 a[48:49], v23 offset:2048
    ds_read_b64_tr_b16 a[50:51], v23 offset:2176
    ds_read_b64_tr_b16 a[192:193], v23 offset:2056
    ds_read_b64_tr_b16 a[194:195], v23 offset:2184
    s_waitcnt vmcnt(9) lgkmcnt(0)
    s_barrier
    s_add_u32 m0, s47, 0
    s_add_u32 s17, s49, 995328
    buffer_load_dwordx4 v16, s[20:23], s17 offen lds
    s_add_u32 m0, s47, 1024
    s_add_u32 s17, s49, 1022976
    buffer_load_dwordx4 v16, s[20:23], s17 offen lds
    s_add_u32 m0, s47, 2048
    s_add_u32 s17, s49, 1050624
    buffer_load_dwordx4 v16, s[20:23], s17 offen lds
    s_add_u32 m0, s47, 12288
    s_add_u32 s17, s49, 996480
    buffer_load_dwordx4 v16, s[20:23], s17 offen lds
    s_add_u32 m0, s47, 13312
    s_add_u32 s17, s49, 1024128
    buffer_load_dwordx4 v16, s[20:23], s17 offen lds
    s_add_u32 m0, s47, 14336
    s_add_u32 s17, s49, 1051776
    buffer_load_dwordx4 v16, s[20:23], s17 offen lds
    s_add_u32 m0, s47, 24576
    s_add_u32 s17, s49, 997632
    buffer_load_dwordx4 v16, s[20:23], s17 offen lds
    s_add_u32 m0, s47, 25600
    s_add_u32 s17, s49, 1025280
    buffer_load_dwordx4 v16, s[20:23], s17 offen lds
    s_add_u32 m0, s47, 26624
    s_add_u32 s17, s49, 1052928
    buffer_load_dwordx4 v16, s[20:23], s17 offen lds
    s_mov_b64 exec, s[76:77]
    v_add_u32 v22, 43008, v19
    ds_read_b32 v28, v22 offset:0
    ds_read_b32 v29, v22 offset:12288
    ds_read_b32 v30, v22 offset:24576
    s_waitcnt lgkmcnt(0)
    v_add_u32 v22, 43008, v20
    ds_write_b128 v22, v[28:31]
    s_mov_b64 exec, -1
    v_add_u32 v22, 43008, v17
    v_add_u32 v23, 43008, v18
    ds_read_b64_tr_b16 v[164:165], v22 offset:0
    ds_read_b64_tr_b16 v[166:167], v22 offset:512
    ds_read_b64_tr_b16 v[236:237], v22 offset:12288
    ds_read_b64_tr_b16 v[238:239], v22 offset:12800
    ds_read_b64_tr_b16 a[124:125], v22 offset:24576
    ds_read_b64_tr_b16 a[126:127], v22 offset:25088
    ds_read_b64_tr_b16 v[168:169], v22 offset:4096
    ds_read_b64_tr_b16 v[170:171], v22 offset:4608
    ds_read_b64_tr_b16 v[240:241], v22 offset:16384
    ds_read_b64_tr_b16 v[242:243], v22 offset:16896
    ds_read_b64_tr_b16 a[128:129], v22 offset:28672
    ds_read_b64_tr_b16 a[130:131], v22 offset:29184
    ds_read_b64_tr_b16 v[172:173], v22 offset:8192
    ds_read_b64_tr_b16 v[174:175], v22 offset:8704
    ds_read_b64_tr_b16 v[244:245], v22 offset:20480
    ds_read_b64_tr_b16 v[246:247], v22 offset:20992
    ds_read_b64_tr_b16 a[132:133], v22 offset:32768
    ds_read_b64_tr_b16 a[134:135], v22 offset:33280
    s_waitcnt lgkmcnt(0)
    s_barrier
    ds_read_b64_tr_b16 a[52:53], v23 offset:0
    ds_read_b64_tr_b16 a[54:55], v23 offset:128
    ds_read_b64_tr_b16 a[196:197], v23 offset:8
    ds_read_b64_tr_b16 a[198:199], v23 offset:136
    ds_read_b64_tr_b16 a[56:57], v23 offset:1024
    ds_read_b64_tr_b16 a[58:59], v23 offset:1152
    ds_read_b64_tr_b16 a[200:201], v23 offset:1032
    ds_read_b64_tr_b16 a[202:203], v23 offset:1160
    ds_read_b64_tr_b16 a[60:61], v23 offset:2048
    ds_read_b64_tr_b16 a[62:63], v23 offset:2176
    ds_read_b64_tr_b16 a[204:205], v23 offset:2056
    ds_read_b64_tr_b16 a[206:207], v23 offset:2184
    s_waitcnt vmcnt(9) lgkmcnt(0)
    s_barrier
    s_add_u32 m0, s47, 43008
    s_add_u32 s17, s49, 1327104
    buffer_load_dwordx4 v16, s[20:23], s17 offen lds
    s_add_u32 m0, s47, 44032
    s_add_u32 s17, s49, 1354752
    buffer_load_dwordx4 v16, s[20:23], s17 offen lds
    s_add_u32 m0, s47, 45056
    s_add_u32 s17, s49, 1382400
    buffer_load_dwordx4 v16, s[20:23], s17 offen lds
    s_add_u32 m0, s47, 55296
    s_add_u32 s17, s49, 1328256
    buffer_load_dwordx4 v16, s[20:23], s17 offen lds
    s_add_u32 m0, s47, 56320
    s_add_u32 s17, s49, 1355904
    buffer_load_dwordx4 v16, s[20:23], s17 offen lds
    s_add_u32 m0, s47, 57344
    s_add_u32 s17, s49, 1383552
    buffer_load_dwordx4 v16, s[20:23], s17 offen lds
    s_add_u32 m0, s47, 67584
    s_add_u32 s17, s49, 1329408
    buffer_load_dwordx4 v16, s[20:23], s17 offen lds
    s_add_u32 m0, s47, 68608
    s_add_u32 s17, s49, 1357056
    buffer_load_dwordx4 v16, s[20:23], s17 offen lds
    s_add_u32 m0, s47, 69632
    s_add_u32 s17, s49, 1384704
    buffer_load_dwordx4 v16, s[20:23], s17 offen lds
    s_mov_b64 exec, s[76:77]
    v_add_u32 v22, 86016, v19
    ds_read_b32 v28, v22 offset:0
    ds_read_b32 v29, v22 offset:12288
    ds_read_b32 v30, v22 offset:24576
    s_waitcnt lgkmcnt(0)
    v_add_u32 v22, 86016, v20
    ds_write_b128 v22, v[28:31]
    s_mov_b64 exec, -1
    v_add_u32 v22, 86016, v17
    v_add_u32 v23, 86016, v18
    ds_read_b64_tr_b16 v[176:177], v22 offset:0
    ds_read_b64_tr_b16 v[178:179], v22 offset:512
    ds_read_b64_tr_b16 v[248:249], v22 offset:12288
    ds_read_b64_tr_b16 v[250:251], v22 offset:12800
    ds_read_b64_tr_b16 a[136:137], v22 offset:24576
    ds_read_b64_tr_b16 a[138:139], v22 offset:25088
    ds_read_b64_tr_b16 v[180:181], v22 offset:4096
    ds_read_b64_tr_b16 v[182:183], v22 offset:4608
    ds_read_b64_tr_b16 v[252:253], v22 offset:16384
    ds_read_b64_tr_b16 v[254:255], v22 offset:16896
    ds_read_b64_tr_b16 a[140:141], v22 offset:28672
    ds_read_b64_tr_b16 a[142:143], v22 offset:29184
    ds_read_b64_tr_b16 v[184:185], v22 offset:8192
    ds_read_b64_tr_b16 v[186:187], v22 offset:8704
    ds_read_b64_tr_b16 a[0:1], v22 offset:20480
    ds_read_b64_tr_b16 a[2:3], v22 offset:20992
    ds_read_b64_tr_b16 a[144:145], v22 offset:32768
    ds_read_b64_tr_b16 a[146:147], v22 offset:33280
    s_waitcnt lgkmcnt(0)
    s_barrier
    ds_read_b64_tr_b16 a[64:65], v23 offset:0
    ds_read_b64_tr_b16 a[66:67], v23 offset:128
    ds_read_b64_tr_b16 a[208:209], v23 offset:8
    ds_read_b64_tr_b16 a[210:211], v23 offset:136
    ds_read_b64_tr_b16 a[68:69], v23 offset:1024
    ds_read_b64_tr_b16 a[70:71], v23 offset:1152
    ds_read_b64_tr_b16 a[212:213], v23 offset:1032
    ds_read_b64_tr_b16 a[214:215], v23 offset:1160
    ds_read_b64_tr_b16 a[72:73], v23 offset:2048
    ds_read_b64_tr_b16 a[74:75], v23 offset:2176
    ds_read_b64_tr_b16 a[216:217], v23 offset:2056
    ds_read_b64_tr_b16 a[218:219], v23 offset:2184
    s_waitcnt vmcnt(9) lgkmcnt(0)
    s_barrier
    s_add_u32 m0, s47, 86016
    s_add_u32 s17, s49, 1658880
    buffer_load_dwordx4 v16, s[20:23], s17 offen lds
    s_add_u32 m0, s47, 87040
    s_add_u32 s17, s49, 1686528
    buffer_load_dwordx4 v16, s[20:23], s17 offen lds
    s_add_u32 m0, s47, 88064
    s_add_u32 s17, s49, 1714176
    buffer_load_dwordx4 v16, s[20:23], s17 offen lds
    s_add_u32 m0, s47, 98304
    s_add_u32 s17, s49, 1660032
    buffer_load_dwordx4 v16, s[20:23], s17 offen lds
    s_add_u32 m0, s47, 99328
    s_add_u32 s17, s49, 1687680
    buffer_load_dwordx4 v16, s[20:23], s17 offen lds
    s_add_u32 m0, s47, 100352
    s_add_u32 s17, s49, 1715328
    buffer_load_dwordx4 v16, s[20:23], s17 offen lds
    s_add_u32 m0, s47, 110592
    s_add_u32 s17, s49, 1661184
    buffer_load_dwordx4 v16, s[20:23], s17 offen lds
    s_add_u32 m0, s47, 111616
    s_add_u32 s17, s49, 1688832
    buffer_load_dwordx4 v16, s[20:23], s17 offen lds
    s_add_u32 m0, s47, 112640
    s_add_u32 s17, s49, 1716480
    buffer_load_dwordx4 v16, s[20:23], s17 offen lds
    s_mov_b64 exec, s[76:77]
    v_add_u32 v22, 0, v19
    ds_read_b32 v28, v22 offset:0
    ds_read_b32 v29, v22 offset:12288
    ds_read_b32 v30, v22 offset:24576
    s_waitcnt lgkmcnt(0)
    v_add_u32 v22, 0, v20
    ds_write_b128 v22, v[28:31]
    s_mov_b64 exec, -1
    v_add_u32 v22, 0, v17
    v_add_u32 v23, 0, v18
    ds_read_b64_tr_b16 v[188:189], v22 offset:0
    ds_read_b64_tr_b16 v[190:191], v22 offset:512
    ds_read_b64_tr_b16 a[4:5], v22 offset:12288
    ds_read_b64_tr_b16 a[6:7], v22 offset:12800
    ds_read_b64_tr_b16 a[148:149], v22 offset:24576
    ds_read_b64_tr_b16 a[150:151], v22 offset:25088
    ds_read_b64_tr_b16 v[192:193], v22 offset:4096
    ds_read_b64_tr_b16 v[194:195], v22 offset:4608
    ds_read_b64_tr_b16 a[8:9], v22 offset:16384
    ds_read_b64_tr_b16 a[10:11], v22 offset:16896
    ds_read_b64_tr_b16 a[152:153], v22 offset:28672
    ds_read_b64_tr_b16 a[154:155], v22 offset:29184
    ds_read_b64_tr_b16 v[196:197], v22 offset:8192
    ds_read_b64_tr_b16 v[198:199], v22 offset:8704
    ds_read_b64_tr_b16 a[12:13], v22 offset:20480
    ds_read_b64_tr_b16 a[14:15], v22 offset:20992
    ds_read_b64_tr_b16 a[156:157], v22 offset:32768
    ds_read_b64_tr_b16 a[158:159], v22 offset:33280
    s_waitcnt lgkmcnt(0)
    s_barrier
    ds_read_b64_tr_b16 a[76:77], v23 offset:0
    ds_read_b64_tr_b16 a[78:79], v23 offset:128
    ds_read_b64_tr_b16 a[220:221], v23 offset:8
    ds_read_b64_tr_b16 a[222:223], v23 offset:136
    ds_read_b64_tr_b16 a[80:81], v23 offset:1024
    ds_read_b64_tr_b16 a[82:83], v23 offset:1152
    ds_read_b64_tr_b16 a[224:225], v23 offset:1032
    ds_read_b64_tr_b16 a[226:227], v23 offset:1160
    ds_read_b64_tr_b16 a[84:85], v23 offset:2048
    ds_read_b64_tr_b16 a[86:87], v23 offset:2176
    ds_read_b64_tr_b16 a[228:229], v23 offset:2056
    ds_read_b64_tr_b16 a[230:231], v23 offset:2184
    s_waitcnt vmcnt(9) lgkmcnt(0)
    s_barrier
    s_mov_b64 exec, s[76:77]
    v_add_u32 v22, 43008, v19
    ds_read_b32 v28, v22 offset:0
    ds_read_b32 v29, v22 offset:12288
    ds_read_b32 v30, v22 offset:24576
    s_waitcnt lgkmcnt(0)
    v_add_u32 v22, 43008, v20
    ds_write_b128 v22, v[28:31]
    s_mov_b64 exec, -1
    v_add_u32 v22, 43008, v17
    v_add_u32 v23, 43008, v18
    ds_read_b64_tr_b16 v[200:201], v22 offset:0
    ds_read_b64_tr_b16 v[202:203], v22 offset:512
    ds_read_b64_tr_b16 a[16:17], v22 offset:12288
    ds_read_b64_tr_b16 a[18:19], v22 offset:12800
    ds_read_b64_tr_b16 a[160:161], v22 offset:24576
    ds_read_b64_tr_b16 a[162:163], v22 offset:25088
    ds_read_b64_tr_b16 v[204:205], v22 offset:4096
    ds_read_b64_tr_b16 v[206:207], v22 offset:4608
    ds_read_b64_tr_b16 a[20:21], v22 offset:16384
    ds_read_b64_tr_b16 a[22:23], v22 offset:16896
    ds_read_b64_tr_b16 a[164:165], v22 offset:28672
    ds_read_b64_tr_b16 a[166:167], v22 offset:29184
    ds_read_b64_tr_b16 v[208:209], v22 offset:8192
    ds_read_b64_tr_b16 v[210:211], v22 offset:8704
    ds_read_b64_tr_b16 a[24:25], v22 offset:20480
    ds_read_b64_tr_b16 a[26:27], v22 offset:20992
    ds_read_b64_tr_b16 a[168:169], v22 offset:32768
    ds_read_b64_tr_b16 a[170:171], v22 offset:33280
    s_waitcnt lgkmcnt(0)
    s_barrier
    ds_read_b64_tr_b16 a[88:89], v23 offset:0
    ds_read_b64_tr_b16 a[90:91], v23 offset:128
    ds_read_b64_tr_b16 a[232:233], v23 offset:8
    ds_read_b64_tr_b16 a[234:235], v23 offset:136
    ds_read_b64_tr_b16 a[92:93], v23 offset:1024
    ds_read_b64_tr_b16 a[94:95], v23 offset:1152
    ds_read_b64_tr_b16 a[236:237], v23 offset:1032
    ds_read_b64_tr_b16 a[238:239], v23 offset:1160
    ds_read_b64_tr_b16 a[96:97], v23 offset:2048
    ds_read_b64_tr_b16 a[98:99], v23 offset:2176
    ds_read_b64_tr_b16 a[240:241], v23 offset:2056
    ds_read_b64_tr_b16 a[242:243], v23 offset:2184
    s_waitcnt vmcnt(0) lgkmcnt(0)
    s_barrier
    s_mov_b64 exec, s[76:77]
    v_add_u32 v22, 86016, v19
    ds_read_b32 v28, v22 offset:0
    ds_read_b32 v29, v22 offset:12288
    ds_read_b32 v30, v22 offset:24576
    s_waitcnt lgkmcnt(0)
    v_add_u32 v22, 86016, v20
    ds_write_b128 v22, v[28:31]
    s_mov_b64 exec, -1
    v_add_u32 v22, 86016, v17
    v_add_u32 v23, 86016, v18
    ds_read_b64_tr_b16 v[212:213], v22 offset:0
    ds_read_b64_tr_b16 v[214:215], v22 offset:512
    ds_read_b64_tr_b16 a[28:29], v22 offset:12288
    ds_read_b64_tr_b16 a[30:31], v22 offset:12800
    ds_read_b64_tr_b16 a[172:173], v22 offset:24576
    ds_read_b64_tr_b16 a[174:175], v22 offset:25088
    ds_read_b64_tr_b16 v[216:217], v22 offset:4096
    ds_read_b64_tr_b16 v[218:219], v22 offset:4608
    ds_read_b64_tr_b16 a[32:33], v22 offset:16384
    ds_read_b64_tr_b16 a[34:35], v22 offset:16896
    ds_read_b64_tr_b16 a[176:177], v22 offset:28672
    ds_read_b64_tr_b16 a[178:179], v22 offset:29184
    ds_read_b64_tr_b16 v[220:221], v22 offset:8192
    ds_read_b64_tr_b16 v[222:223], v22 offset:8704
    ds_read_b64_tr_b16 a[36:37], v22 offset:20480
    ds_read_b64_tr_b16 a[38:39], v22 offset:20992
    ds_read_b64_tr_b16 a[180:181], v22 offset:32768
    ds_read_b64_tr_b16 a[182:183], v22 offset:33280
    s_waitcnt lgkmcnt(0)
    s_barrier
    ds_read_b64_tr_b16 a[100:101], v23 offset:0
    ds_read_b64_tr_b16 a[102:103], v23 offset:128
    ds_read_b64_tr_b16 a[244:245], v23 offset:8
    ds_read_b64_tr_b16 a[246:247], v23 offset:136
    ds_read_b64_tr_b16 a[104:105], v23 offset:1024
    ds_read_b64_tr_b16 a[106:107], v23 offset:1152
    ds_read_b64_tr_b16 a[248:249], v23 offset:1032
    ds_read_b64_tr_b16 a[250:251], v23 offset:1160
    ds_read_b64_tr_b16 a[108:109], v23 offset:2048
    ds_read_b64_tr_b16 a[110:111], v23 offset:2176
    ds_read_b64_tr_b16 a[252:253], v23 offset:2056
    ds_read_b64_tr_b16 a[254:255], v23 offset:2184
    s_waitcnt lgkmcnt(0)
    s_barrier
    v_mov_b32 v56, 0x3f803f80
    v_mov_b32 v57, 0x3f803f80
    v_mov_b32 v58, 0x3f803f80
    v_mov_b32 v59, 0x3f803f80
    s_nop 1
    v_mfma_f32_16x16x32_bf16 v[36:39], v[152:155], v[56:59], 0
    v_mfma_f32_16x16x32_bf16 v[40:43], v[224:227], v[56:59], 0
    v_mfma_f32_16x16x32_bf16 v[44:47], a[40:43], v[56:59], 0
    v_mfma_f32_16x16x32_bf16 v[48:51], v[56:59], a[112:115], 0
    v_mfma_f32_16x16x32_bf16 v[52:55], v[56:59], a[184:187], 0
    v_mfma_f32_16x16x32_bf16 v[36:39], v[156:159], v[56:59], v[36:39]
    v_mfma_f32_16x16x32_bf16 v[40:43], v[228:231], v[56:59], v[40:43]
    v_mfma_f32_16x16x32_bf16 v[44:47], a[44:47], v[56:59], v[44:47]
    v_mfma_f32_16x16x32_bf16 v[48:51], v[56:59], a[116:119], v[48:51]
    v_mfma_f32_16x16x32_bf16 v[52:55], v[56:59], a[188:191], v[52:55]
    v_mfma_f32_16x16x32_bf16 v[36:39], v[160:163], v[56:59], v[36:39]
    v_mfma_f32_16x16x32_bf16 v[40:43], v[232:235], v[56:59], v[40:43]
    v_mfma_f32_16x16x32_bf16 v[44:47], a[48:51], v[56:59], v[44:47]
    v_mfma_f32_16x16x32_bf16 v[48:51], v[56:59], a[120:123], v[48:51]
    v_mfma_f32_16x16x32_bf16 v[52:55], v[56:59], a[192:195], v[52:55]
    v_mfma_f32_16x16x32_bf16 v[36:39], v[164:167], v[56:59], v[36:39]
    v_mfma_f32_16x16x32_bf16 v[40:43], v[236:239], v[56:59], v[40:43]
    v_mfma_f32_16x16x32_bf16 v[44:47], a[52:55], v[56:59], v[44:47]
    v_mfma_f32_16x16x32_bf16 v[48:51], v[56:59], a[124:127], v[48:51]
    v_mfma_f32_16x16x32_bf16 v[52:55], v[56:59], a[196:199], v[52:55]
    v_mfma_f32_16x16x32_bf16 v[36:39], v[168:171], v[56:59], v[36:39]
    v_mfma_f32_16x16x32_bf16 v[40:43], v[240:243], v[56:59], v[40:43]
    v_mfma_f32_16x16x32_bf16 v[44:47], a[56:59], v[56:59], v[44:47]
    v_mfma_f32_16x16x32_bf16 v[48:51], v[56:59], a[128:131], v[48:51]
    v_mfma_f32_16x16x32_bf16 v[52:55], v[56:59], a[200:203], v[52:55]
    v_mfma_f32_16x16x32_bf16 v[36:39], v[172:175], v[56:59], v[36:39]
    v_mfma_f32_16x16x32_bf16 v[40:43], v[244:247], v[56:59], v[40:43]
    v_mfma_f32_16x16x32_bf16 v[44:47], a[60:63], v[56:59], v[44:47]
    v_mfma_f32_16x16x32_bf16 v[48:51], v[56:59], a[132:135], v[48:51]
    v_mfma_f32_16x16x32_bf16 v[52:55], v[56:59], a[204:207], v[52:55]
    v_mfma_f32_16x16x32_bf16 v[36:39], v[176:179], v[56:59], v[36:39]
    v_mfma_f32_16x16x32_bf16 v[40:43], v[248:251], v[56:59], v[40:43]
    v_mfma_f32_16x16x32_bf16 v[44:47], a[64:67], v[56:59], v[44:47]
    v_mfma_f32_16x16x32_bf16 v[48:51], v[56:59], a[136:139], v[48:51]
    v_mfma_f32_16x16x32_bf16 v[52:55], v[56:59], a[208:211], v[52:55]
    v_mfma_f32_16x16x32_bf16 v[36:39], v[180:183], v[56:59], v[36:39]
    v_mfma_f32_16x16x32_bf16 v[40:43], v[252:255], v[56:59], v[40:43]
    v_mfma_f32_16x16x32_bf16 v[44:47], a[68:71], v[56:59], v[44:47]
    v_mfma_f32_16x16x32_bf16 v[48:51], v[56:59], a[140:143], v[48:51]
    v_mfma_f32_16x16x32_bf16 v[52:55], v[56:59], a[212:215], v[52:55]
    v_mfma_f32_16x16x32_bf16 v[36:39], v[184:187], v[56:59], v[36:39]
    v_mfma_f32_16x16x32_bf16 v[40:43], a[0:3], v[56:59], v[40:43]
    v_mfma_f32_16x16x32_bf16 v[44:47], a[72:75], v[56:59], v[44:47]
    v_mfma_f32_16x16x32_bf16 v[48:51], v[56:59], a[144:147], v[48:51]
    v_mfma_f32_16x16x32_bf16 v[52:55], v[56:59], a[216:219], v[52:55]
    v_mfma_f32_16x16x32_bf16 v[36:39], v[188:191], v[56:59], v[36:39]
    v_mfma_f32_16x16x32_bf16 v[40:43], a[4:7], v[56:59], v[40:43]
    v_mfma_f32_16x16x32_bf16 v[44:47], a[76:79], v[56:59], v[44:47]
    v_mfma_f32_16x16x32_bf16 v[48:51], v[56:59], a[148:151], v[48:51]
    v_mfma_f32_16x16x32_bf16 v[52:55], v[56:59], a[220:223], v[52:55]
    v_mfma_f32_16x16x32_bf16 v[36:39], v[192:195], v[56:59], v[36:39]
    v_mfma_f32_16x16x32_bf16 v[40:43], a[8:11], v[56:59], v[40:43]
    v_mfma_f32_16x16x32_bf16 v[44:47], a[80:83], v[56:59], v[44:47]
    v_mfma_f32_16x16x32_bf16 v[48:51], v[56:59], a[152:155], v[48:51]
    v_mfma_f32_16x16x32_bf16 v[52:55], v[56:59], a[224:227], v[52:55]
    v_mfma_f32_16x16x32_bf16 v[36:39], v[196:199], v[56:59], v[36:39]
    v_mfma_f32_16x16x32_bf16 v[40:43], a[12:15], v[56:59], v[40:43]
    v_mfma_f32_16x16x32_bf16 v[44:47], a[84:87], v[56:59], v[44:47]
    v_mfma_f32_16x16x32_bf16 v[48:51], v[56:59], a[156:159], v[48:51]
    v_mfma_f32_16x16x32_bf16 v[52:55], v[56:59], a[228:231], v[52:55]
    v_mfma_f32_16x16x32_bf16 v[36:39], v[200:203], v[56:59], v[36:39]
    v_mfma_f32_16x16x32_bf16 v[40:43], a[16:19], v[56:59], v[40:43]
    v_mfma_f32_16x16x32_bf16 v[44:47], a[88:91], v[56:59], v[44:47]
    v_mfma_f32_16x16x32_bf16 v[48:51], v[56:59], a[160:163], v[48:51]
    v_mfma_f32_16x16x32_bf16 v[52:55], v[56:59], a[232:235], v[52:55]
    v_mfma_f32_16x16x32_bf16 v[36:39], v[204:207], v[56:59], v[36:39]
    v_mfma_f32_16x16x32_bf16 v[40:43], a[20:23], v[56:59], v[40:43]
    v_mfma_f32_16x16x32_bf16 v[44:47], a[92:95], v[56:59], v[44:47]
    v_mfma_f32_16x16x32_bf16 v[48:51], v[56:59], a[164:167], v[48:51]
    v_mfma_f32_16x16x32_bf16 v[52:55], v[56:59], a[236:239], v[52:55]
    v_mfma_f32_16x16x32_bf16 v[36:39], v[208:211], v[56:59], v[36:39]
    v_mfma_f32_16x16x32_bf16 v[40:43], a[24:27], v[56:59], v[40:43]
    v_mfma_f32_16x16x32_bf16 v[44:47], a[96:99], v[56:59], v[44:47]
    v_mfma_f32_16x16x32_bf16 v[48:51], v[56:59], a[168:171], v[48:51]
    v_mfma_f32_16x16x32_bf16 v[52:55], v[56:59], a[240:243], v[52:55]
    v_mfma_f32_16x16x32_bf16 v[36:39], v[212:215], v[56:59], v[36:39]
    v_mfma_f32_16x16x32_bf16 v[40:43], a[28:31], v[56:59], v[40:43]
    v_mfma_f32_16x16x32_bf16 v[44:47], a[100:103], v[56:59], v[44:47]
    v_mfma_f32_16x16x32_bf16 v[48:51], v[56:59], a[172:175], v[48:51]
    v_mfma_f32_16x16x32_bf16 v[52:55], v[56:59], a[244:247], v[52:55]
    v_mfma_f32_16x16x32_bf16 v[36:39], v[216:219], v[56:59], v[36:39]
    v_mfma_f32_16x16x32_bf16 v[40:43], a[32:35], v[56:59], v[40:43]
    v_mfma_f32_16x16x32_bf16 v[44:47], a[104:107], v[56:59], v[44:47]
    v_mfma_f32_16x16x32_bf16 v[48:51], v[56:59], a[176:179], v[48:51]
    v_mfma_f32_16x16x32_bf16 v[52:55], v[56:59], a[248:251], v[52:55]
    v_mfma_f32_16x16x32_bf16 v[36:39], v[220:223], v[56:59], v[36:39]
    v_mfma_f32_16x16x32_bf16 v[40:43], a[36:39], v[56:59], v[40:43]
    v_mfma_f32_16x16x32_bf16 v[44:47], a[108:111], v[56:59], v[44:47]
    v_mfma_f32_16x16x32_bf16 v[48:51], v[56:59], a[180:183], v[48:51]
    v_mfma_f32_16x16x32_bf16 v[52:55], v[56:59], a[252:255], v[52:55]
    v_lshlrev_b32 v10, 5, v7
    s_lshl_b32 s17, s51, 4
    v_add_u32 v10, s17, v10
    v_mul_u32_u24 v6, 1536, v8
    v_add_u32 v10, v10, v6
    s_lshl_b32 s17, s14, 7
    s_add_u32 s17, s17, 73728
    v_lshl_add_u32 v11, v7, 3, s17
    v_lshl_add_u32 v12, v8, 5, s17
    v_lshlrev_b32 v13, 5, v7
    s_lshl_b32 s17, s51, 4
    v_add_u32 v13, s17, v13
    s_lshr_b32 s17, s50, 2
    s_add_u32 s17, s17, 64
    s_lshl_b32 s17, s17, 9
    s_and_b32 s18, s50, 3
    s_lshl_b32 s18, s18, 2
    s_add_u32 s17, s17, s18
    v_add_u32 v14, s17, v13
    v_lshrrev_b32 v5, 1, v8
    v_lshl_add_u32 v13, v5, 9, v13
    v_and_b32 v5, 1, v8
    v_lshl_add_u32 v13, v5, 3, v13
    s_lshl_b32 s17, s50, 10
    v_add_u32 v13, s17, v13
    s_lshl_b32 s49, s15, 7
    s_lshl_b32 s17, s14, 2
    s_add_u32 s49, s49, s17
    s_add_u32 s49, s49, 1536
    s_mov_b32 s52, 0x3eae1a93
    v_mov_b32 v6, 0xf149f2ca
    v_lshl_add_u32 v5, v8, 2, 0
    v_sub_u32 v5, v5, v7
    v_cmp_le_i32 vcc, 9, v5
    s_nop 1
    v_cndmask_b32 v72, v6, v4, vcc
    v_add_u32 v5, 7, v5
    v_cmp_ge_u32 vcc, 7, v5
    s_nop 1
    v_cndmask_b32 v76, v6, v4, vcc
    v_lshl_add_u32 v5, v8, 2, 1
    v_sub_u32 v5, v5, v7
    v_cmp_le_i32 vcc, 9, v5
    s_nop 1
    v_cndmask_b32 v73, v6, v4, vcc
    v_add_u32 v5, 7, v5
    v_cmp_ge_u32 vcc, 7, v5
    s_nop 1
    v_cndmask_b32 v77, v6, v4, vcc
    v_lshl_add_u32 v5, v8, 2, 2
    v_sub_u32 v5, v5, v7
    v_cmp_le_i32 vcc, 9, v5
    s_nop 1
    v_cndmask_b32 v74, v6, v4, vcc
    v_add_u32 v5, 7, v5
    v_cmp_ge_u32 vcc, 7, v5
    s_nop 1
    v_cndmask_b32 v78, v6, v4, vcc
    v_lshl_add_u32 v5, v8, 2, 3
    v_sub_u32 v5, v5, v7
    v_cmp_le_i32 vcc, 9, v5
    s_nop 1
    v_cndmask_b32 v75, v6, v4, vcc
    v_add_u32 v5, 7, v5
    v_cmp_ge_u32 vcc, 7, v5
    s_nop 1
    v_cndmask_b32 v79, v6, v4, vcc
    v_mov_b32 v112, 0
    v_mov_b32 v113, 0
    v_mov_b32 v114, 0
    v_mov_b32 v115, 0
    v_mov_b32 v136, 0
    v_mov_b32 v137, 0
    v_mov_b32 v138, 0
    v_mov_b32 v139, 0
    v_mov_b32 v140, 0
    v_mov_b32 v141, 0
    v_mov_b32 v142, 0
    v_mov_b32 v143, 0
    v_mov_b32 v116, 0x3f803f80
    v_mov_b32 v117, 0x3f803f80
    v_mov_b32 v118, 0x3f803f80
    v_mov_b32 v119, 0x3f803f80
    v_mov_b32 v131, 0
    v_mov_b32 v135, 0
    s_mov_b64 exec, 0xff
    v_lshrrev_b32 v6, 2, v0
    v_lshlrev_b32 v5, 5, v6
    v_and_b32 v5, 128, v5
    v_lshrrev_b32 v6, 1, v6
    v_and_or_b32 v5, v6, 12, v5
    s_mov_b32 s16, 0
Laq_pure:
    global_load_dword v6, v5, s[12:13] sc1
    s_add_u32 s16, s16, 1
    s_cmp_gt_u32 s16, 100000
    s_cbranch_scc1 L_role_aq_abort
    s_mov_b32 s6, 0
    s_waitcnt vmcnt(0)
    v_readlane_b32 s7, v6, 0
    s_nop 0
    s_add_u32 s6, s6, s7
    v_readlane_b32 s7, v6, 1
    s_nop 0
    s_add_u32 s6, s6, s7
    v_readlane_b32 s7, v6, 2
    s_nop 0
    s_add_u32 s6, s6, s7
    v_readlane_b32 s7, v6, 3
    s_nop 0
    s_add_u32 s6, s6, s7
    v_readlane_b32 s7, v6, 4
    s_nop 0
    s_add_u32 s6, s6, s7
    v_readlane_b32 s7, v6, 5
    s_nop 0
    s_add_u32 s6, s6, s7
    v_readlane_b32 s7, v6, 6
    s_nop 0
    s_add_u32 s6, s6, s7
    v_readlane_b32 s7, v6, 7
    s_nop 0
    s_add_u32 s6, s6, s7
    v_readlane_b32 s7, v6, s3
    s_nop 0
    s_cmp_ge_u32 s7, 32
    s_cselect_b32 s78, 0, -1
    s_cselect_b32 s6, 256, s6
    s_cmp_lt_u32 s6, 256
    s_cbranch_scc1 Laq_pure
    s_mov_b32 s79, s78
    s_mov_b64 exec, -1
    s_mov_b32 s36, s63
    s_mov_b32 s34, s63
    s_mul_i32 s58, s14, 9216
    s_mul_i32 s64, s63, 4718592
    s_add_u32 s64, s64, s58
    s_add_u32 s64, s64, 6291456
    s_mul_i32 s61, s63, 1441792
    s_add_u32 s61, s61, 0
    s_mov_b32 s37, 0
    s_mov_b32 s40, 36864
    s_mov_b32 s59, s58
    s_mov_b32 s43, 0
    s_mov_b32 s62, 1
    s_mov_b32 s28, s8
    s_mov_b32 s29, s9
    s_mov_b32 s30, 0
    s_mov_b32 s31, 0x00020000
    v_mov_b32 v110, 74752
    v_mov_b32 v5, -1
    ds_write_b32 v110, v5
    s_waitcnt lgkmcnt(0)
    s_cmp_lg_u32 s14, 0
    s_cbranch_scc1 Laq_inia_d
    v_mov_b32 v5, 40
    s_mov_b32 s16, 0
Laq_inia:
    global_load_dword v6, v5, s[12:13] sc1
    s_add_u32 s16, s16, 1
    s_cmp_gt_u32 s16, 100000
    s_cbranch_scc1 L_role_aq_abort
    s_waitcnt vmcnt(0)
    v_cmp_gt_u32 vcc, 72, v6
    s_nop 0
    s_cbranch_vccz Laq_inia_d
    s_sleep 8
    s_branch Laq_inia
Laq_inia_d:
    s_barrier
    s_cmp_eq_u32 s63, 0
    s_cbranch_scc1 Laq_ini_sk
    s_cmp_lg_u32 s14, 0
    s_cbranch_scc1 Laq_inib_d
    v_mov_b32 v5, 160
    s_mov_b32 s16, 0
Laq_inib:
    global_load_dword v6, v5, s[12:13] sc1
    s_add_u32 s16, s16, 1
    s_cmp_gt_u32 s16, 100000
    s_cbranch_scc1 L_role_aq_abort
    s_waitcnt vmcnt(0)
    v_cmp_gt_u32 vcc, 64, v6
    s_nop 0
    s_cbranch_vccz Laq_inib_d
    s_sleep 8
    s_branch Laq_inib
Laq_inib_d:
    s_barrier
Laq_ini_sk:
    s_mul_i32 s41, s37, 36864
    s_add_u32 s41, s41, s64
    s_mul_i32 s60, s37, 22528
    s_add_u32 s60, s60, s61
    s_cmp_lt_u32 s37, 64
    s_cselect_b32 s60, s60, 2883584
    s_branch Laq_wait
Laq_head:
    s_waitcnt vmcnt(4)
Laq_head2:
    s_barrier
    ds_read_b32 v15, v110
    s_xor_b32 s40, s40, 36864
    s_xor_b32 s59, s59, 36864
    s_mov_b32 s35, s37
    s_lshl_b32 s57, s34, 6
    s_add_u32 s57, s57, s35
    s_add_u32 s37, s37, 1
    s_mov_b32 s39, 0
    s_mov_b32 s54, 0
    s_mul_i32 s41, s37, 36864
    s_add_u32 s41, s41, s64
    s_mul_i32 s60, s37, 22528
    s_add_u32 s60, s60, s61
    s_cmp_lt_u32 s37, 64
    s_cselect_b32 s60, s60, 2883584
    v_lshlrev_b32 v9, 9, v8
    v_lshl_add_u32 v9, v7, 5, v9
    s_lshl_b32 s17, s51, 4
    s_add_u32 s17, s17, s40
    v_add_u32 v9, s17, v9
    ds_read_b128 v[56:59], v9 offset:0
    ds_read_b128 v[60:63], v9 offset:2048
    ds_read_b128 v[64:67], v9 offset:4096
    s_waitcnt lgkmcnt(2)
    v_mfma_f32_16x16x32_bf16 v[16:19], v[152:155], v[56:59], 0
    v_add_f32 v80, v80, v84
    v_mfma_f32_16x16x32_bf16 v[20:23], v[224:227], v[56:59], 0
    v_add_f32 v81, v81, v85
    v_mfma_f32_16x16x32_bf16 v[24:27], a[40:43], v[56:59], 0
    v_add_f32 v82, v82, v86
    ds_read_b128 v[56:59], v9 offset:6144
    s_waitcnt lgkmcnt(2)
    v_mfma_f32_16x16x32_bf16 v[16:19], v[156:159], v[60:63], v[16:19]
    v_add_f32 v83, v83, v87
    v_mfma_f32_16x16x32_bf16 v[20:23], v[228:231], v[60:63], v[20:23]
    v_add_f32 v80, v80, v88
    v_mfma_f32_16x16x32_bf16 v[24:27], a[44:47], v[60:63], v[24:27]
    v_add_f32 v81, v81, v89
    v_readfirstlane_b32 s17, v15
    s_nop 0
    s_add_u32 s18, s17, 1
    s_max_i32 s32, s18, s37
    s_add_u32 s39, s37, 1
    s_min_u32 s39, s39, 63
    s_mul_i32 s33, s32, 22528
    s_add_u32 s33, s33, s61
    s_cmp_eq_u32 s14, 0
    s_cselect_b32 s18, s32, 0x7fff
    v_mov_b32 v2, 2
    s_cmp_le_u32 s18, s39
    s_cselect_b64 exec, -1, 0
    buffer_load_dword v2, v1, s[8:11], s33 offen sc1
    s_mov_b64 exec, -1
    s_cmp_ge_i32 s17, s37
    s_cbranch_scc1 Laq_f_7
    ds_read_b128 v[60:63], v9 offset:8192
    s_waitcnt lgkmcnt(2)
    v_mfma_f32_16x16x32_bf16 v[16:19], v[160:163], v[64:67], v[16:19]
    v_add_f32 v82, v82, v90
    v_mfma_f32_16x16x32_bf16 v[20:23], v[232:235], v[64:67], v[20:23]
    v_add_f32 v83, v83, v91
    v_mfma_f32_16x16x32_bf16 v[24:27], a[48:51], v[64:67], v[24:27]
    v_add_f32 v80, v80, v82
    ds_read_b128 v[64:67], v9 offset:10240
    s_waitcnt lgkmcnt(2)
    v_mfma_f32_16x16x32_bf16 v[16:19], v[164:167], v[56:59], v[16:19]
    v_add_f32 v81, v81, v83
    v_mfma_f32_16x16x32_bf16 v[20:23], v[236:239], v[56:59], v[20:23]
    v_mov_b32 v82, v80
    v_mfma_f32_16x16x32_bf16 v[24:27], a[52:55], v[56:59], v[24:27]
    v_mov_b32 v83, v81
    ds_read_b128 v[56:59], v9 offset:12288
    s_waitcnt lgkmcnt(2)
    v_mfma_f32_16x16x32_bf16 v[16:19], v[168:171], v[60:63], v[16:19]
    v_permlane32_swap_b32 v80, v82
    v_mfma_f32_16x16x32_bf16 v[20:23], v[240:243], v[60:63], v[20:23]
    v_permlane32_swap_b32 v81, v83
    v_mfma_f32_16x16x32_bf16 v[24:27], a[56:59], v[60:63], v[24:27]
    v_add_f32 v80, v80, v82
    ds_read_b128 v[60:63], v9 offset:14336
    s_waitcnt lgkmcnt(2)
    v_mfma_f32_16x16x32_bf16 v[16:19], v[172:175], v[64:67], v[16:19]
    v_add_f32 v81, v81, v83
    v_mfma_f32_16x16x32_bf16 v[20:23], v[244:247], v[64:67], v[20:23]
    v_mov_b32 v82, v80
    v_mfma_f32_16x16x32_bf16 v[24:27], a[60:63], v[64:67], v[24:27]
    v_mov_b32 v83, v81
    s_waitcnt vmcnt(1)
    s_cmp_lg_u32 s43, 0
    s_cselect_b64 exec, 1, 0
    buffer_store_dword v3, v4, s[8:11], s43 offen
    s_and_b64 exec, exec, s[78:79]
    buffer_store_dword v3, v4, s[8:11], s43 offen sc1
    s_mov_b64 exec, -1
    s_mov_b32 s43, 0
    ds_read_b128 v[64:67], v9 offset:16384
    s_waitcnt lgkmcnt(2)
    v_mfma_f32_16x16x32_bf16 v[16:19], v[176:179], v[56:59], v[16:19]
    v_permlane16_swap_b32 v80, v82
    v_mfma_f32_16x16x32_bf16 v[20:23], v[248:251], v[56:59], v[20:23]
    v_permlane16_swap_b32 v81, v83
    v_mfma_f32_16x16x32_bf16 v[24:27], a[64:67], v[56:59], v[24:27]
    v_add_f32 v80, v80, v82
    ds_read_b128 v[56:59], v9 offset:18432
    s_waitcnt lgkmcnt(2)
    v_mfma_f32_16x16x32_bf16 v[16:19], v[180:183], v[60:63], v[16:19]
    v_add_f32 v81, v81, v83
    v_mfma_f32_16x16x32_bf16 v[20:23], v[252:255], v[60:63], v[20:23]
    v_mul_f32 v80, 0x3ae38e39, v80
    v_mfma_f32_16x16x32_bf16 v[24:27], a[68:71], v[60:63], v[24:27]
    v_mul_f32 v81, 0x3ae38e39, v81
    ds_read_b128 v[60:63], v9 offset:20480
    s_waitcnt lgkmcnt(2)
    v_mfma_f32_16x16x32_bf16 v[16:19], v[184:187], v[64:67], v[16:19]
    v_fma_f32 v81, -v80, v80, v81
    v_mfma_f32_16x16x32_bf16 v[20:23], a[0:3], v[64:67], v[20:23]
    v_max_f32 v81, 0, v81
    v_mfma_f32_16x16x32_bf16 v[24:27], a[72:75], v[64:67], v[24:27]
    v_add_f32 v81, 0x3727c5ac, v81
    ds_read_b128 v[64:67], v9 offset:22528
    s_waitcnt lgkmcnt(2)
    v_mfma_f32_16x16x32_bf16 v[16:19], v[188:191], v[56:59], v[16:19]
    v_rsq_f32 v92, v81
    v_mfma_f32_16x16x32_bf16 v[20:23], a[4:7], v[56:59], v[20:23]
    v_mul_f32 v93, v80, v92
    v_mfma_f32_16x16x32_bf16 v[24:27], a[76:79], v[56:59], v[24:27]
    ds_write_b64 v11, v[92:93]
    ds_read_b128 v[56:59], v9 offset:24576
    s_waitcnt lgkmcnt(3)
    v_mfma_f32_16x16x32_bf16 v[16:19], v[192:195], v[60:63], v[16:19]
    ds_read_b128 v[96:99], v12
    v_mfma_f32_16x16x32_bf16 v[20:23], a[8:11], v[60:63], v[20:23]
    ds_read_b128 v[100:103], v12 offset:16
    v_mfma_f32_16x16x32_bf16 v[24:27], a[80:83], v[60:63], v[24:27]
    ds_read_b128 v[60:63], v9 offset:26624
    s_waitcnt lgkmcnt(5)
    v_mfma_f32_16x16x32_bf16 v[16:19], v[196:199], v[64:67], v[16:19]
    v_mfma_f32_16x16x32_bf16 v[20:23], a[12:15], v[64:67], v[20:23]
    v_mfma_f32_16x16x32_bf16 v[24:27], a[84:87], v[64:67], v[24:27]
    ds_read_b128 v[64:67], v9 offset:28672
    s_waitcnt lgkmcnt(4)
    v_mfma_f32_16x16x32_bf16 v[16:19], v[200:203], v[56:59], v[16:19]
    v_mfma_f32_16x16x32_bf16 v[20:23], a[16:19], v[56:59], v[20:23]
    v_mfma_f32_16x16x32_bf16 v[24:27], a[88:91], v[56:59], v[24:27]
    ds_read_b128 v[56:59], v9 offset:30720
    s_waitcnt lgkmcnt(2)
    v_mfma_f32_16x16x32_bf16 v[16:19], v[204:207], v[60:63], v[16:19]
    v_mfma_f32_16x16x32_bf16 v[20:23], a[20:23], v[60:63], v[20:23]
    v_mfma_f32_16x16x32_bf16 v[24:27], a[92:95], v[60:63], v[24:27]
    ds_read_b128 v[60:63], v9 offset:32768
    s_waitcnt lgkmcnt(2)
    v_mfma_f32_16x16x32_bf16 v[16:19], v[208:211], v[64:67], v[16:19]
    v_mfma_f32_16x16x32_bf16 v[20:23], a[24:27], v[64:67], v[20:23]
    v_mfma_f32_16x16x32_bf16 v[24:27], a[96:99], v[64:67], v[24:27]
    ds_read_b128 v[64:67], v9 offset:34816
    s_waitcnt lgkmcnt(2)
    v_mfma_f32_16x16x32_bf16 v[16:19], v[212:215], v[56:59], v[16:19]
    v_cmp_eq_u32 s[76:77], 1, v2
    v_cmp_eq_u32 vcc, 2, v2
    v_mfma_f32_16x16x32_bf16 v[20:23], a[28:31], v[56:59], v[20:23]
    s_cmp_eq_u64 s[76:77], -1
    s_cselect_b32 s38, 1, 0
    v_mfma_f32_16x16x32_bf16 v[24:27], a[100:103], v[56:59], v[24:27]
    s_cmp_lg_u32 s38, 0
    s_cselect_b64 exec, 1, 0
    v_mov_b32 v15, s32
    ds_write_b32 v110, v15
    v_mov_b32 v2, 2
    s_mov_b64 exec, -1
    ds_read_b128 v[56:59], v9 offset:0
    s_waitcnt lgkmcnt(3)
    v_mfma_f32_16x16x32_bf16 v[16:19], v[216:219], v[60:63], v[16:19]
    s_add_u32 s32, s32, s38
    s_mul_i32 s38, s38, 22528
    s_add_u32 s33, s33, s38
    v_mfma_f32_16x16x32_bf16 v[20:23], a[32:35], v[60:63], v[20:23]
    s_cmp_eq_u64 vcc, 0
    s_cselect_b32 s38, s32, 0x7fff
    v_mfma_f32_16x16x32_bf16 v[24:27], a[104:107], v[60:63], v[24:27]
    s_cmp_le_u32 s38, s39
    s_cselect_b64 exec, -1, 0
    v_mov_b32 v2, 2
    buffer_load_dword v2, v1, s[8:11], s33 offen sc1
    s_mov_b64 exec, -1
    ds_read_b128 v[60:63], v9 offset:2048
    s_waitcnt lgkmcnt(3)
    v_mfma_f32_16x16x32_bf16 v[16:19], v[220:223], v[64:67], v[16:19]
    v_mfma_f32_16x16x32_bf16 v[20:23], a[36:39], v[64:67], v[20:23]
    v_mfma_f32_16x16x32_bf16 v[24:27], a[108:111], v[64:67], v[24:27]
    ds_read_b32 v15, v110
    ds_read_b128 v[64:67], v9 offset:4096
    s_waitcnt lgkmcnt(3)
    v_mfma_f32_16x16x32_bf16 v[28:31], v[56:59], a[112:115], 0
    v_mfma_f32_16x16x32_bf16 v[32:35], v[56:59], a[184:187], 0
    ds_read_b128 v[56:59], v9 offset:6144
    s_waitcnt lgkmcnt(3)
    v_mfma_f32_16x16x32_bf16 v[28:31], v[60:63], a[116:119], v[28:31]
    v_mul_f32 v94, v93, v36
    v_fma_f32 v16, v16, v92, -v94
    v_mfma_f32_16x16x32_bf16 v[32:35], v[60:63], a[188:191], v[32:35]
    v_mul_f32 v94, v93, v37
    v_fma_f32 v17, v17, v92, -v94
    s_waitcnt lgkmcnt(2)
    v_readfirstlane_b32 s17, v15
    s_nop 0
    s_cmp_ge_i32 s17, s37
    s_cbranch_scc1 Laq_f_8
    ds_read_b128 v[60:63], v9 offset:8192
    s_waitcnt lgkmcnt(2)
    v_mfma_f32_16x16x32_bf16 v[28:31], v[64:67], a[120:123], v[28:31]
    v_mul_f32 v94, v93, v38
    v_fma_f32 v18, v18, v92, -v94
    v_mfma_f32_16x16x32_bf16 v[32:35], v[64:67], a[192:195], v[32:35]
    v_mul_f32 v94, v93, v39
    v_fma_f32 v19, v19, v92, -v94
    ds_read_b128 v[64:67], v9 offset:10240
    s_waitcnt lgkmcnt(2)
    v_mfma_f32_16x16x32_bf16 v[28:31], v[56:59], a[124:127], v[28:31]
    v_mul_f32 v94, v93, v44
    v_fma_f32 v24, v24, v92, -v94
    v_mfma_f32_16x16x32_bf16 v[32:35], v[56:59], a[196:199], v[32:35]
    v_mul_f32 v94, v93, v45
    v_fma_f32 v25, v25, v92, -v94
    ds_read_b128 v[56:59], v9 offset:12288
    s_waitcnt lgkmcnt(2)
    v_mfma_f32_16x16x32_bf16 v[28:31], v[60:63], a[128:131], v[28:31]
    v_mul_f32 v94, v93, v46
    v_fma_f32 v26, v26, v92, -v94
    v_mfma_f32_16x16x32_bf16 v[32:35], v[60:63], a[200:203], v[32:35]
    v_mul_f32 v94, v93, v47
    v_fma_f32 v27, v27, v92, -v94
    ds_read_b128 v[60:63], v9 offset:14336
    s_waitcnt lgkmcnt(2)
    v_mfma_f32_16x16x32_bf16 v[28:31], v[64:67], a[132:135], v[28:31]
    v_mul_f32 v94, v93, v40
    v_fma_f32 v20, v20, v92, -v94
    v_mfma_f32_16x16x32_bf16 v[32:35], v[64:67], a[204:207], v[32:35]
    v_mul_f32 v94, v93, v41
    v_fma_f32 v21, v21, v92, -v94
    ds_read_b128 v[64:67], v9 offset:16384
    s_waitcnt lgkmcnt(2)
    v_mfma_f32_16x16x32_bf16 v[28:31], v[56:59], a[136:139], v[28:31]
    v_mul_f32 v94, v93, v42
    v_fma_f32 v22, v22, v92, -v94
    v_mfma_f32_16x16x32_bf16 v[32:35], v[56:59], a[208:211], v[32:35]
    v_mul_f32 v94, v93, v43
    v_fma_f32 v23, v23, v92, -v94
    ds_read_b128 v[56:59], v9 offset:18432
    s_waitcnt lgkmcnt(2)
    v_mfma_f32_16x16x32_bf16 v[28:31], v[60:63], a[140:143], v[28:31]
    v_cvt_pk_bf16_f32 v128, v16, v17
    v_cvt_pk_bf16_f32 v129, v18, v19
    v_mfma_f32_16x16x32_bf16 v[32:35], v[60:63], a[212:215], v[32:35]
    v_cvt_pk_bf16_f32 v130, v24, v25
    v_cvt_pk_bf16_f32 v132, v20, v21
    ds_read_b128 v[60:63], v9 offset:20480
    s_waitcnt lgkmcnt(2)
    v_mfma_f32_16x16x32_bf16 v[28:31], v[64:67], a[144:147], v[28:31]
    v_cvt_pk_bf16_f32 v133, v22, v23
    v_cvt_pk_bf16_f32 v134, v26, v27
    v_mfma_f32_16x16x32_bf16 v[32:35], v[64:67], a[216:219], v[32:35]
    s_cmp_eq_u32 s35, 0
    s_cselect_b32 s46, 0xf149f2ca, 0
    ds_read_b128 v[64:67], v9 offset:22528
    s_waitcnt lgkmcnt(2)
    v_mfma_f32_16x16x32_bf16 v[28:31], v[56:59], a[148:151], v[28:31]
    v_mfma_f32_16x16x32_bf16 v[144:147], v[112:115], v[128:131], 0
    v_mfma_f32_16x16x32_bf16 v[32:35], v[56:59], a[220:223], v[32:35]
    v_mfma_f32_16x16x32_bf16 v[148:151], v[132:135], v[128:131], 0
    ds_read_b128 v[56:59], v9 offset:24576
    s_waitcnt lgkmcnt(2)
    v_mfma_f32_16x16x32_bf16 v[28:31], v[60:63], a[152:155], v[28:31]
    v_mov_b32 v112, v132
    v_mfma_f32_16x16x32_bf16 v[32:35], v[60:63], a[224:227], v[32:35]
    v_mov_b32 v113, v133
    v_mov_b32 v114, v134
    ds_read_b128 v[60:63], v9 offset:26624
    s_waitcnt lgkmcnt(2)
    v_mfma_f32_16x16x32_bf16 v[28:31], v[64:67], a[156:159], v[28:31]
    v_mfma_f32_16x16x32_bf16 v[32:35], v[64:67], a[228:231], v[32:35]
    v_fma_f32 v144, v144, s52, v72
    ds_read_b128 v[64:67], v9 offset:28672
    s_waitcnt lgkmcnt(2)
    v_mfma_f32_16x16x32_bf16 v[28:31], v[56:59], a[160:163], v[28:31]
    v_fma_f32 v145, v145, s52, v73
    v_fma_f32 v146, v146, s52, v74
    v_fma_f32 v147, v147, s52, v75
    v_mfma_f32_16x16x32_bf16 v[32:35], v[56:59], a[232:235], v[32:35]
    v_fma_f32 v148, v148, s52, v76
    v_fma_f32 v149, v149, s52, v77
    v_fma_f32 v150, v150, s52, v78
    ds_read_b128 v[56:59], v9 offset:30720
    s_waitcnt lgkmcnt(2)
    v_mfma_f32_16x16x32_bf16 v[28:31], v[60:63], a[164:167], v[28:31]
    v_fma_f32 v151, v151, s52, v79
    v_add_f32 v144, s46, v144
    v_add_f32 v145, s46, v145
    v_mfma_f32_16x16x32_bf16 v[32:35], v[60:63], a[236:239], v[32:35]
    v_add_f32 v146, s46, v146
    v_add_f32 v147, s46, v147
    v_max3_f32 v5, v144, v145, v146
    ds_read_b128 v[60:63], v9 offset:32768
    s_waitcnt lgkmcnt(2)
    v_mfma_f32_16x16x32_bf16 v[28:31], v[64:67], a[168:171], v[28:31]
    v_max3_f32 v5, v5, v147, v148
    v_max3_f32 v5, v5, v149, v150
    v_max_f32 v5, v5, v151
    v_mfma_f32_16x16x32_bf16 v[32:35], v[64:67], a[240:243], v[32:35]
    v_mov_b32 v6, v5
    s_nop 1
    v_permlane32_swap_b32 v5, v6
    ds_read_b128 v[64:67], v9 offset:34816
    s_waitcnt lgkmcnt(2)
    v_mfma_f32_16x16x32_bf16 v[28:31], v[56:59], a[172:175], v[28:31]
    v_max_f32 v5, v5, v6
    v_mov_b32 v6, v5
    v_mfma_f32_16x16x32_bf16 v[32:35], v[56:59], a[244:247], v[32:35]
    s_nop 0
    v_permlane16_swap_b32 v5, v6
    v_max_f32 v5, v5, v6
    v_sub_f32 v144, v144, v5
    s_waitcnt lgkmcnt(1)
    v_mfma_f32_16x16x32_bf16 v[28:31], v[60:63], a[176:179], v[28:31]
    v_sub_f32 v145, v145, v5
    v_sub_f32 v146, v146, v5
    v_sub_f32 v147, v147, v5
    v_mfma_f32_16x16x32_bf16 v[32:35], v[60:63], a[248:251], v[32:35]
    v_sub_f32 v148, v148, v5
    v_sub_f32 v149, v149, v5
    v_sub_f32 v150, v150, v5
    s_waitcnt lgkmcnt(0)
    v_mfma_f32_16x16x32_bf16 v[28:31], v[64:67], a[180:183], v[28:31]
    v_sub_f32 v151, v151, v5
    v_exp_f32 v144, v144
    v_exp_f32 v145, v145
    v_mfma_f32_16x16x32_bf16 v[32:35], v[64:67], a[252:255], v[32:35]
    v_exp_f32 v146, v146
    v_exp_f32 v147, v147
    v_exp_f32 v148, v148
    v_cmp_eq_u32 s[76:77], 1, v2
    v_cmp_eq_u32 vcc, 2, v2
    s_cmp_eq_u64 s[76:77], -1
    s_cselect_b32 s38, 1, 0
    s_cmp_lg_u32 s38, 0
    s_cselect_b64 exec, 1, 0
    v_mov_b32 v15, s32
    ds_write_b32 v110, v15
    v_mov_b32 v2, 2
    s_mov_b64 exec, -1
    s_add_u32 s32, s32, s38
    s_mul_i32 s38, s38, 22528
    s_add_u32 s33, s33, s38
    s_cmp_eq_u64 vcc, 0
    s_cselect_b32 s38, s32, 0x7fff
    s_cmp_le_u32 s38, s39
    s_cselect_b64 exec, -1, 0
    v_mov_b32 v2, 2
    buffer_load_dword v2, v1, s[8:11], s33 offen sc1
    s_mov_b64 exec, -1
    v_exp_f32 v149, v149
    v_exp_f32 v150, v150
    v_exp_f32 v151, v151
    v_cvt_pk_bf16_f32 v68, v144, v145
    v_cvt_pk_bf16_f32 v69, v146, v147
    v_cvt_pk_bf16_f32 v70, v148, v149
    v_cvt_pk_bf16_f32 v71, v150, v151
    s_nop 1
    v_mfma_f32_16x16x32_bf16 v[16:19], v[116:119], v[68:71], 0
    s_mul_i32 s46, s57, 36864
    s_add_u32 s46, s46, 17301504
    s_nop 5
    v_rcp_f32 v6, v16
    v_mul_f32 v94, v97, v48
    v_fma_f32 v28, v28, v96, -v94
    v_mul_f32 v94, v99, v49
    v_fma_f32 v29, v29, v98, -v94
    v_mul_f32 v94, v101, v50
    v_fma_f32 v30, v30, v100, -v94
    v_mul_f32 v94, v103, v51
    v_fma_f32 v31, v31, v102, -v94
    v_cvt_pk_bf16_f32 v138, v28, v29
    v_cvt_pk_bf16_f32 v139, v30, v31
    v_mul_f32 v94, v97, v52
    v_fma_f32 v32, v32, v96, -v94
    v_mfma_f32_16x16x32_bf16 v[20:23], v[136:139], v[68:71], 0
    v_mul_f32 v94, v99, v53
    v_fma_f32 v33, v33, v98, -v94
    v_mul_f32 v94, v101, v54
    v_fma_f32 v34, v34, v100, -v94
    v_mul_f32 v94, v103, v55
    v_fma_f32 v35, v35, v102, -v94
    v_cvt_pk_bf16_f32 v142, v32, v33
    v_cvt_pk_bf16_f32 v143, v34, v35
    v_mov_b32 v136, v138
    v_mov_b32 v137, v139
    v_mfma_f32_16x16x32_bf16 v[24:27], v[140:143], v[68:71], 0
    v_mul_f32 v20, v6, v20
    v_mul_f32 v21, v6, v21
    v_mul_f32 v22, v6, v22
    v_mul_f32 v23, v6, v23
    v_cvt_pk_bf16_f32 v20, v20, v21
    v_cvt_pk_bf16_f32 v21, v22, v23
    s_mov_b64 exec, -1
    buffer_store_dwordx2 v[20:21], v13, s[8:11], s46 offen
    s_and_b64 exec, exec, s[78:79]
    buffer_store_dwordx2 v[20:21], v13, s[8:11], s46 offen sc1
    s_mov_b64 exec, -1
    v_mov_b32 v140, v142
    v_mov_b32 v141, v143
    v_mul_f32 v24, v6, v24
    v_mul_f32 v25, v6, v25
    v_cvt_pk_bf16_f32 v24, v24, v25
    s_mov_b64 exec, 0xffff
    buffer_store_dword v24, v14, s[8:11], s46 offen
    s_and_b64 exec, exec, s[78:79]
    buffer_store_dword v24, v14, s[8:11], s46 offen sc1
    s_mov_b64 exec, -1
    s_mul_i32 s43, s57, 22528
    s_add_u32 s43, s43, s49
    s_branch Laq_none
Laq_f_7:
    ds_read_b128 v[60:63], v9 offset:8192
    s_waitcnt lgkmcnt(2)
    v_mfma_f32_16x16x32_bf16 v[16:19], v[160:163], v[64:67], v[16:19]
    v_add_f32 v82, v82, v90
    v_mfma_f32_16x16x32_bf16 v[20:23], v[232:235], v[64:67], v[20:23]
    v_add_f32 v83, v83, v91
    v_mfma_f32_16x16x32_bf16 v[24:27], a[48:51], v[64:67], v[24:27]
    v_add_f32 v80, v80, v82
    ds_read_b128 v[64:67], v9 offset:10240
    s_waitcnt lgkmcnt(2)
    v_mfma_f32_16x16x32_bf16 v[16:19], v[164:167], v[56:59], v[16:19]
    v_add_f32 v81, v81, v83
    v_mfma_f32_16x16x32_bf16 v[20:23], v[236:239], v[56:59], v[20:23]
    v_mov_b32 v82, v80
    v_mfma_f32_16x16x32_bf16 v[24:27], a[52:55], v[56:59], v[24:27]
    v_mov_b32 v83, v81
    ds_read_b128 v[56:59], v9 offset:12288
    s_waitcnt lgkmcnt(2)
    v_mfma_f32_16x16x32_bf16 v[16:19], v[168:171], v[60:63], v[16:19]
    v_permlane32_swap_b32 v80, v82
    v_mfma_f32_16x16x32_bf16 v[20:23], v[240:243], v[60:63], v[20:23]
    v_permlane32_swap_b32 v81, v83
    v_mfma_f32_16x16x32_bf16 v[24:27], a[56:59], v[60:63], v[24:27]
    v_add_f32 v80, v80, v82
    ds_read_b128 v[60:63], v9 offset:14336
    s_waitcnt lgkmcnt(2)
    v_mfma_f32_16x16x32_bf16 v[16:19], v[172:175], v[64:67], v[16:19]
    v_add_f32 v81, v81, v83
    v_mfma_f32_16x16x32_bf16 v[20:23], v[244:247], v[64:67], v[20:23]
    v_mov_b32 v82, v80
    v_mfma_f32_16x16x32_bf16 v[24:27], a[60:63], v[64:67], v[24:27]
    v_mov_b32 v83, v81
    s_waitcnt vmcnt(1)
    s_cmp_lg_u32 s43, 0
    s_cselect_b64 exec, 1, 0
    buffer_store_dword v3, v4, s[8:11], s43 offen
    s_and_b64 exec, exec, s[78:79]
    buffer_store_dword v3, v4, s[8:11], s43 offen sc1
    s_mov_b64 exec, -1
    s_mov_b32 s43, 0
    ds_read_b128 v[64:67], v9 offset:16384
    s_waitcnt lgkmcnt(2)
    v_mfma_f32_16x16x32_bf16 v[16:19], v[176:179], v[56:59], v[16:19]
    v_permlane16_swap_b32 v80, v82
    v_mfma_f32_16x16x32_bf16 v[20:23], v[248:251], v[56:59], v[20:23]
    v_permlane16_swap_b32 v81, v83
    v_mfma_f32_16x16x32_bf16 v[24:27], a[64:67], v[56:59], v[24:27]
    v_add_f32 v80, v80, v82
    ds_read_b128 v[56:59], v9 offset:18432
    s_waitcnt lgkmcnt(2)
    v_mfma_f32_16x16x32_bf16 v[16:19], v[180:183], v[60:63], v[16:19]
    v_add_f32 v81, v81, v83
    v_mfma_f32_16x16x32_bf16 v[20:23], v[252:255], v[60:63], v[20:23]
    v_mul_f32 v80, 0x3ae38e39, v80
    v_mfma_f32_16x16x32_bf16 v[24:27], a[68:71], v[60:63], v[24:27]
    v_mul_f32 v81, 0x3ae38e39, v81
    ds_read_b128 v[60:63], v9 offset:20480
    s_waitcnt lgkmcnt(2)
    v_mfma_f32_16x16x32_bf16 v[16:19], v[184:187], v[64:67], v[16:19]
    v_fma_f32 v81, -v80, v80, v81
    v_mfma_f32_16x16x32_bf16 v[20:23], a[0:3], v[64:67], v[20:23]
    v_max_f32 v81, 0, v81
    v_mfma_f32_16x16x32_bf16 v[24:27], a[72:75], v[64:67], v[24:27]
    v_add_f32 v81, 0x3727c5ac, v81
    ds_read_b128 v[64:67], v9 offset:22528
    s_waitcnt lgkmcnt(2)
    v_mfma_f32_16x16x32_bf16 v[16:19], v[188:191], v[56:59], v[16:19]
    v_rsq_f32 v92, v81
    v_mfma_f32_16x16x32_bf16 v[20:23], a[4:7], v[56:59], v[20:23]
    v_mul_f32 v93, v80, v92
    v_mfma_f32_16x16x32_bf16 v[24:27], a[76:79], v[56:59], v[24:27]
    ds_write_b64 v11, v[92:93]
    ds_read_b128 v[56:59], v9 offset:24576
    s_waitcnt lgkmcnt(3)
    v_mfma_f32_16x16x32_bf16 v[16:19], v[192:195], v[60:63], v[16:19]
    ds_read_b128 v[96:99], v12
    v_mfma_f32_16x16x32_bf16 v[20:23], a[8:11], v[60:63], v[20:23]
    ds_read_b128 v[100:103], v12 offset:16
    v_mfma_f32_16x16x32_bf16 v[24:27], a[80:83], v[60:63], v[24:27]
    s_add_u32 m0, s59, 0
    s_add_u32 s47, s41, 0
    buffer_load_dwordx4 v0, s[8:11], s47 offen offset:0 lds
    ds_read_b128 v[60:63], v9 offset:26624
    s_waitcnt lgkmcnt(5)
    v_mfma_f32_16x16x32_bf16 v[16:19], v[196:199], v[64:67], v[16:19]
    buffer_load_dwordx4 v0, s[8:11], s47 offen offset:1024 lds
    buffer_load_dwordx4 v0, s[8:11], s47 offen offset:2048 lds
    buffer_load_dwordx4 v0, s[8:11], s47 offen offset:3072 lds
    v_mfma_f32_16x16x32_bf16 v[20:23], a[12:15], v[64:67], v[20:23]
    s_add_u32 m0, s59, 4096
    s_add_u32 s47, s41, 4096
    buffer_load_dwordx4 v0, s[8:11], s47 offen offset:0 lds
    v_mfma_f32_16x16x32_bf16 v[24:27], a[84:87], v[64:67], v[24:27]
    buffer_load_dwordx4 v0, s[8:11], s47 offen offset:1024 lds
    buffer_load_dwordx4 v0, s[8:11], s47 offen offset:2048 lds
    buffer_load_dwordx4 v0, s[8:11], s47 offen offset:3072 lds
    ds_read_b128 v[64:67], v9 offset:28672
    s_waitcnt lgkmcnt(4)
    v_mfma_f32_16x16x32_bf16 v[16:19], v[200:203], v[56:59], v[16:19]
    s_add_u32 m0, s59, 8192
    s_add_u32 s47, s41, 8192
    buffer_load_dwordx4 v0, s[8:11], s47 offen offset:0 lds
    v_mfma_f32_16x16x32_bf16 v[20:23], a[16:19], v[56:59], v[20:23]
    v_mfma_f32_16x16x32_bf16 v[24:27], a[88:91], v[56:59], v[24:27]
    ds_read_b128 v[56:59], v9 offset:30720
    s_waitcnt lgkmcnt(2)
    v_mfma_f32_16x16x32_bf16 v[16:19], v[204:207], v[60:63], v[16:19]
    v_mfma_f32_16x16x32_bf16 v[20:23], a[20:23], v[60:63], v[20:23]
    v_mfma_f32_16x16x32_bf16 v[24:27], a[92:95], v[60:63], v[24:27]
    ds_read_b128 v[60:63], v9 offset:32768
    s_waitcnt lgkmcnt(2)
    v_mfma_f32_16x16x32_bf16 v[16:19], v[208:211], v[64:67], v[16:19]
    v_mfma_f32_16x16x32_bf16 v[20:23], a[24:27], v[64:67], v[20:23]
    v_mfma_f32_16x16x32_bf16 v[24:27], a[96:99], v[64:67], v[24:27]
    ds_read_b128 v[64:67], v9 offset:34816
    s_waitcnt lgkmcnt(2)
    v_mfma_f32_16x16x32_bf16 v[16:19], v[212:215], v[56:59], v[16:19]
    v_cmp_eq_u32 s[76:77], 1, v2
    v_cmp_eq_u32 vcc, 2, v2
    v_mfma_f32_16x16x32_bf16 v[20:23], a[28:31], v[56:59], v[20:23]
    s_cmp_eq_u64 s[76:77], -1
    s_cselect_b32 s38, 1, 0
    v_mfma_f32_16x16x32_bf16 v[24:27], a[100:103], v[56:59], v[24:27]
    s_cmp_lg_u32 s38, 0
    s_cselect_b64 exec, 1, 0
    v_mov_b32 v15, s32
    ds_write_b32 v110, v15
    v_mov_b32 v2, 2
    s_mov_b64 exec, -1
    ds_read_b128 v[56:59], v9 offset:0
    s_waitcnt lgkmcnt(3)
    v_mfma_f32_16x16x32_bf16 v[16:19], v[216:219], v[60:63], v[16:19]
    s_add_u32 s32, s32, s38
    s_mul_i32 s38, s38, 22528
    s_add_u32 s33, s33, s38
    v_mfma_f32_16x16x32_bf16 v[20:23], a[32:35], v[60:63], v[20:23]
    s_cmp_eq_u64 vcc, 0
    s_cselect_b32 s38, s32, 0x7fff
    v_mfma_f32_16x16x32_bf16 v[24:27], a[104:107], v[60:63], v[24:27]
    s_cmp_le_u32 s38, s39
    s_cselect_b64 exec, -1, 0
    v_mov_b32 v2, 2
    buffer_load_dword v2, v1, s[8:11], s33 offen sc1
    s_mov_b64 exec, -1
    ds_read_b128 v[60:63], v9 offset:2048
    s_waitcnt lgkmcnt(3)
    v_mfma_f32_16x16x32_bf16 v[16:19], v[220:223], v[64:67], v[16:19]
    s_mul_i32 s48, s36, 786432
    s_mul_i32 s18, s37, 6144
    s_add_u32 s48, s48, s18
    s_add_u32 s48, s48, 15728640
    buffer_load_dwordx4 v[80:83], v10, s[8:11], s48 offen offset:0
    v_mfma_f32_16x16x32_bf16 v[20:23], a[36:39], v[64:67], v[20:23]
    v_mfma_f32_16x16x32_bf16 v[24:27], a[108:111], v[64:67], v[24:27]
    ds_read_b128 v[64:67], v9 offset:4096
    s_waitcnt lgkmcnt(2)
    v_mfma_f32_16x16x32_bf16 v[28:31], v[56:59], a[112:115], 0
    buffer_load_dwordx4 v[84:87], v10, s[8:11], s48 offen offset:512
    v_mfma_f32_16x16x32_bf16 v[32:35], v[56:59], a[184:187], 0
    ds_read_b128 v[56:59], v9 offset:6144
    s_waitcnt lgkmcnt(2)
    v_mfma_f32_16x16x32_bf16 v[28:31], v[60:63], a[116:119], v[28:31]
    buffer_load_dwordx4 v[88:91], v10, s[8:11], s48 offen offset:1024
    v_mul_f32 v94, v93, v36
    v_fma_f32 v16, v16, v92, -v94
    v_mfma_f32_16x16x32_bf16 v[32:35], v[60:63], a[188:191], v[32:35]
    v_mul_f32 v94, v93, v37
    v_fma_f32 v17, v17, v92, -v94
    ds_read_b128 v[60:63], v9 offset:8192
    s_waitcnt lgkmcnt(2)
    v_mfma_f32_16x16x32_bf16 v[28:31], v[64:67], a[120:123], v[28:31]
    v_mul_f32 v94, v93, v38
    v_fma_f32 v18, v18, v92, -v94
    v_mfma_f32_16x16x32_bf16 v[32:35], v[64:67], a[192:195], v[32:35]
    v_mul_f32 v94, v93, v39
    v_fma_f32 v19, v19, v92, -v94
    ds_read_b128 v[64:67], v9 offset:10240
    s_waitcnt lgkmcnt(2)
    v_mfma_f32_16x16x32_bf16 v[28:31], v[56:59], a[124:127], v[28:31]
    v_mul_f32 v94, v93, v44
    v_fma_f32 v24, v24, v92, -v94
    v_mfma_f32_16x16x32_bf16 v[32:35], v[56:59], a[196:199], v[32:35]
    v_mul_f32 v94, v93, v45
    v_fma_f32 v25, v25, v92, -v94
    ds_read_b128 v[56:59], v9 offset:12288
    s_waitcnt lgkmcnt(2)
    v_mfma_f32_16x16x32_bf16 v[28:31], v[60:63], a[128:131], v[28:31]
    v_mul_f32 v94, v93, v46
    v_fma_f32 v26, v26, v92, -v94
    v_mfma_f32_16x16x32_bf16 v[32:35], v[60:63], a[200:203], v[32:35]
    v_mul_f32 v94, v93, v47
    v_fma_f32 v27, v27, v92, -v94
    ds_read_b128 v[60:63], v9 offset:14336
    s_waitcnt lgkmcnt(2)
    v_mfma_f32_16x16x32_bf16 v[28:31], v[64:67], a[132:135], v[28:31]
    v_mul_f32 v94, v93, v40
    v_fma_f32 v20, v20, v92, -v94
    v_mfma_f32_16x16x32_bf16 v[32:35], v[64:67], a[204:207], v[32:35]
    v_mul_f32 v94, v93, v41
    v_fma_f32 v21, v21, v92, -v94
    ds_read_b128 v[64:67], v9 offset:16384
    s_waitcnt lgkmcnt(2)
    v_mfma_f32_16x16x32_bf16 v[28:31], v[56:59], a[136:139], v[28:31]
    v_mul_f32 v94, v93, v42
    v_fma_f32 v22, v22, v92, -v94
    v_mfma_f32_16x16x32_bf16 v[32:35], v[56:59], a[208:211], v[32:35]
    v_mul_f32 v94, v93, v43
    v_fma_f32 v23, v23, v92, -v94
    ds_read_b128 v[56:59], v9 offset:18432
    s_waitcnt lgkmcnt(2)
    v_mfma_f32_16x16x32_bf16 v[28:31], v[60:63], a[140:143], v[28:31]
    v_cvt_pk_bf16_f32 v128, v16, v17
    v_cvt_pk_bf16_f32 v129, v18, v19
    v_mfma_f32_16x16x32_bf16 v[32:35], v[60:63], a[212:215], v[32:35]
    v_cvt_pk_bf16_f32 v130, v24, v25
    v_cvt_pk_bf16_f32 v132, v20, v21
    ds_read_b128 v[60:63], v9 offset:20480
    s_waitcnt lgkmcnt(2)
    v_mfma_f32_16x16x32_bf16 v[28:31], v[64:67], a[144:147], v[28:31]
    v_cvt_pk_bf16_f32 v133, v22, v23
    v_cvt_pk_bf16_f32 v134, v26, v27
    v_mfma_f32_16x16x32_bf16 v[32:35], v[64:67], a[216:219], v[32:35]
    s_cmp_eq_u32 s35, 0
    s_cselect_b32 s46, 0xf149f2ca, 0
    ds_read_b128 v[64:67], v9 offset:22528
    s_waitcnt lgkmcnt(2)
    v_mfma_f32_16x16x32_bf16 v[28:31], v[56:59], a[148:151], v[28:31]
    v_mfma_f32_16x16x32_bf16 v[144:147], v[112:115], v[128:131], 0
    v_mfma_f32_16x16x32_bf16 v[32:35], v[56:59], a[220:223], v[32:35]
    v_mfma_f32_16x16x32_bf16 v[148:151], v[132:135], v[128:131], 0
    ds_read_b128 v[56:59], v9 offset:24576
    s_waitcnt lgkmcnt(2)
    v_mfma_f32_16x16x32_bf16 v[28:31], v[60:63], a[152:155], v[28:31]
    v_mov_b32 v112, v132
    v_mfma_f32_16x16x32_bf16 v[32:35], v[60:63], a[224:227], v[32:35]
    v_mov_b32 v113, v133
    v_mov_b32 v114, v134
    ds_read_b128 v[60:63], v9 offset:26624
    s_waitcnt lgkmcnt(2)
    v_mfma_f32_16x16x32_bf16 v[28:31], v[64:67], a[156:159], v[28:31]
    v_mfma_f32_16x16x32_bf16 v[32:35], v[64:67], a[228:231], v[32:35]
    v_fma_f32 v144, v144, s52, v72
    ds_read_b128 v[64:67], v9 offset:28672
    s_waitcnt lgkmcnt(2)
    v_mfma_f32_16x16x32_bf16 v[28:31], v[56:59], a[160:163], v[28:31]
    v_fma_f32 v145, v145, s52, v73
    v_fma_f32 v146, v146, s52, v74
    v_fma_f32 v147, v147, s52, v75
    v_mfma_f32_16x16x32_bf16 v[32:35], v[56:59], a[232:235], v[32:35]
    v_fma_f32 v148, v148, s52, v76
    v_fma_f32 v149, v149, s52, v77
    v_fma_f32 v150, v150, s52, v78
    ds_read_b128 v[56:59], v9 offset:30720
    s_waitcnt lgkmcnt(2)
    v_mfma_f32_16x16x32_bf16 v[28:31], v[60:63], a[164:167], v[28:31]
    v_fma_f32 v151, v151, s52, v79
    v_add_f32 v144, s46, v144
    v_add_f32 v145, s46, v145
    v_mfma_f32_16x16x32_bf16 v[32:35], v[60:63], a[236:239], v[32:35]
    v_add_f32 v146, s46, v146
    v_add_f32 v147, s46, v147
    v_max3_f32 v5, v144, v145, v146
    ds_read_b128 v[60:63], v9 offset:32768
    s_waitcnt lgkmcnt(2)
    v_mfma_f32_16x16x32_bf16 v[28:31], v[64:67], a[168:171], v[28:31]
    v_max3_f32 v5, v5, v147, v148
    v_max3_f32 v5, v5, v149, v150
    v_max_f32 v5, v5, v151
    v_mfma_f32_16x16x32_bf16 v[32:35], v[64:67], a[240:243], v[32:35]
    v_mov_b32 v6, v5
    s_nop 1
    v_permlane32_swap_b32 v5, v6
    ds_read_b128 v[64:67], v9 offset:34816
    s_waitcnt lgkmcnt(2)
    v_mfma_f32_16x16x32_bf16 v[28:31], v[56:59], a[172:175], v[28:31]
    v_max_f32 v5, v5, v6
    v_mov_b32 v6, v5
    v_mfma_f32_16x16x32_bf16 v[32:35], v[56:59], a[244:247], v[32:35]
    s_nop 0
    v_permlane16_swap_b32 v5, v6
    v_max_f32 v5, v5, v6
    v_sub_f32 v144, v144, v5
    s_waitcnt lgkmcnt(1)
    v_mfma_f32_16x16x32_bf16 v[28:31], v[60:63], a[176:179], v[28:31]
    v_sub_f32 v145, v145, v5
    v_sub_f32 v146, v146, v5
    v_sub_f32 v147, v147, v5
    v_mfma_f32_16x16x32_bf16 v[32:35], v[60:63], a[248:251], v[32:35]
    v_sub_f32 v148, v148, v5
    v_sub_f32 v149, v149, v5
    v_sub_f32 v150, v150, v5
    s_waitcnt lgkmcnt(0)
    v_mfma_f32_16x16x32_bf16 v[28:31], v[64:67], a[180:183], v[28:31]
    v_sub_f32 v151, v151, v5
    v_exp_f32 v144, v144
    v_exp_f32 v145, v145
    v_mfma_f32_16x16x32_bf16 v[32:35], v[64:67], a[252:255], v[32:35]
    v_exp_f32 v146, v146
    v_exp_f32 v147, v147
    v_exp_f32 v148, v148
    v_cmp_eq_u32 s[76:77], 1, v2
    v_cmp_eq_u32 vcc, 2, v2
    s_cmp_eq_u64 s[76:77], -1
    s_cselect_b32 s38, 1, 0
    s_cmp_lg_u32 s38, 0
    s_cselect_b64 exec, 1, 0
    v_mov_b32 v15, s32
    ds_write_b32 v110, v15
    v_mov_b32 v2, 2
    s_mov_b64 exec, -1
    s_add_u32 s32, s32, s38
    s_mul_i32 s38, s38, 22528
    s_add_u32 s33, s33, s38
    s_cmp_eq_u64 vcc, 0
    s_cselect_b32 s38, s32, 0x7fff
    s_cmp_le_u32 s38, s39
    s_cselect_b64 exec, -1, 0
    v_mov_b32 v2, 2
    buffer_load_dword v2, v1, s[8:11], s33 offen sc1
    s_mov_b64 exec, -1
    v_exp_f32 v149, v149
    v_exp_f32 v150, v150
    v_exp_f32 v151, v151
    v_cvt_pk_bf16_f32 v68, v144, v145
    v_cvt_pk_bf16_f32 v69, v146, v147
    v_cvt_pk_bf16_f32 v70, v148, v149
    v_cvt_pk_bf16_f32 v71, v150, v151
    s_nop 1
    v_mfma_f32_16x16x32_bf16 v[16:19], v[116:119], v[68:71], 0
    s_mul_i32 s46, s57, 36864
    s_add_u32 s46, s46, 17301504
    s_nop 5
    v_rcp_f32 v6, v16
    v_mul_f32 v94, v97, v48
    v_fma_f32 v28, v28, v96, -v94
    v_mul_f32 v94, v99, v49
    v_fma_f32 v29, v29, v98, -v94
    v_mul_f32 v94, v101, v50
    v_fma_f32 v30, v30, v100, -v94
    v_mul_f32 v94, v103, v51
    v_fma_f32 v31, v31, v102, -v94
    v_cvt_pk_bf16_f32 v138, v28, v29
    v_cvt_pk_bf16_f32 v139, v30, v31
    v_mul_f32 v94, v97, v52
    v_fma_f32 v32, v32, v96, -v94
    v_mfma_f32_16x16x32_bf16 v[20:23], v[136:139], v[68:71], 0
    v_mul_f32 v94, v99, v53
    v_fma_f32 v33, v33, v98, -v94
    v_mul_f32 v94, v101, v54
    v_fma_f32 v34, v34, v100, -v94
    v_mul_f32 v94, v103, v55
    v_fma_f32 v35, v35, v102, -v94
    v_cvt_pk_bf16_f32 v142, v32, v33
    v_cvt_pk_bf16_f32 v143, v34, v35
    v_mov_b32 v136, v138
    v_mov_b32 v137, v139
    v_mfma_f32_16x16x32_bf16 v[24:27], v[140:143], v[68:71], 0
    v_mul_f32 v20, v6, v20
    v_mul_f32 v21, v6, v21
    v_mul_f32 v22, v6, v22
    v_mul_f32 v23, v6, v23
    v_cvt_pk_bf16_f32 v20, v20, v21
    v_cvt_pk_bf16_f32 v21, v22, v23
    s_mov_b64 exec, -1
    buffer_store_dwordx2 v[20:21], v13, s[8:11], s46 offen
    s_and_b64 exec, exec, s[78:79]
    buffer_store_dwordx2 v[20:21], v13, s[8:11], s46 offen sc1
    s_mov_b64 exec, -1
    v_mov_b32 v140, v142
    v_mov_b32 v141, v143
    v_mul_f32 v24, v6, v24
    v_mul_f32 v25, v6, v25
    v_cvt_pk_bf16_f32 v24, v24, v25
    s_mov_b64 exec, 0xffff
    buffer_store_dword v24, v14, s[8:11], s46 offen
    s_and_b64 exec, exec, s[78:79]
    buffer_store_dword v24, v14, s[8:11], s46 offen sc1
    s_mov_b64 exec, -1
    s_mul_i32 s43, s57, 22528
    s_add_u32 s43, s43, s49
    s_branch Laq_head
Laq_f_8:
    ds_read_b128 v[60:63], v9 offset:8192
    s_waitcnt lgkmcnt(2)
    v_mfma_f32_16x16x32_bf16 v[28:31], v[64:67], a[120:123], v[28:31]
    v_mul_f32 v94, v93, v38
    v_fma_f32 v18, v18, v92, -v94
    v_mfma_f32_16x16x32_bf16 v[32:35], v[64:67], a[192:195], v[32:35]
    v_mul_f32 v94, v93, v39
    v_fma_f32 v19, v19, v92, -v94
    ds_read_b128 v[64:67], v9 offset:10240
    s_waitcnt lgkmcnt(2)
    v_mfma_f32_16x16x32_bf16 v[28:31], v[56:59], a[124:127], v[28:31]
    v_mul_f32 v94, v93, v44
    v_fma_f32 v24, v24, v92, -v94
    v_mfma_f32_16x16x32_bf16 v[32:35], v[56:59], a[196:199], v[32:35]
    v_mul_f32 v94, v93, v45
    v_fma_f32 v25, v25, v92, -v94
    ds_read_b128 v[56:59], v9 offset:12288
    s_waitcnt lgkmcnt(2)
    v_mfma_f32_16x16x32_bf16 v[28:31], v[60:63], a[128:131], v[28:31]
    v_mul_f32 v94, v93, v46
    v_fma_f32 v26, v26, v92, -v94
    v_mfma_f32_16x16x32_bf16 v[32:35], v[60:63], a[200:203], v[32:35]
    v_mul_f32 v94, v93, v47
    v_fma_f32 v27, v27, v92, -v94
    ds_read_b128 v[60:63], v9 offset:14336
    s_waitcnt lgkmcnt(2)
    v_mfma_f32_16x16x32_bf16 v[28:31], v[64:67], a[132:135], v[28:31]
    v_mul_f32 v94, v93, v40
    v_fma_f32 v20, v20, v92, -v94
    v_mfma_f32_16x16x32_bf16 v[32:35], v[64:67], a[204:207], v[32:35]
    v_mul_f32 v94, v93, v41
    v_fma_f32 v21, v21, v92, -v94
    ds_read_b128 v[64:67], v9 offset:16384
    s_waitcnt lgkmcnt(2)
    v_mfma_f32_16x16x32_bf16 v[28:31], v[56:59], a[136:139], v[28:31]
    v_mul_f32 v94, v93, v42
    v_fma_f32 v22, v22, v92, -v94
    v_mfma_f32_16x16x32_bf16 v[32:35], v[56:59], a[208:211], v[32:35]
    v_mul_f32 v94, v93, v43
    v_fma_f32 v23, v23, v92, -v94
    ds_read_b128 v[56:59], v9 offset:18432
    s_waitcnt lgkmcnt(2)
    v_mfma_f32_16x16x32_bf16 v[28:31], v[60:63], a[140:143], v[28:31]
    v_cvt_pk_bf16_f32 v128, v16, v17
    v_cvt_pk_bf16_f32 v129, v18, v19
    v_mfma_f32_16x16x32_bf16 v[32:35], v[60:63], a[212:215], v[32:35]
    v_cvt_pk_bf16_f32 v130, v24, v25
    v_cvt_pk_bf16_f32 v132, v20, v21
    ds_read_b128 v[60:63], v9 offset:20480
    s_waitcnt lgkmcnt(2)
    v_mfma_f32_16x16x32_bf16 v[28:31], v[64:67], a[144:147], v[28:31]
    v_cvt_pk_bf16_f32 v133, v22, v23
    v_cvt_pk_bf16_f32 v134, v26, v27
    v_mfma_f32_16x16x32_bf16 v[32:35], v[64:67], a[216:219], v[32:35]
    s_cmp_eq_u32 s35, 0
    s_cselect_b32 s46, 0xf149f2ca, 0
    ds_read_b128 v[64:67], v9 offset:22528
    s_waitcnt lgkmcnt(2)
    v_mfma_f32_16x16x32_bf16 v[28:31], v[56:59], a[148:151], v[28:31]
    s_add_u32 m0, s59, 0
    s_add_u32 s47, s41, 0
    buffer_load_dwordx4 v0, s[8:11], s47 offen offset:0 lds
    v_mfma_f32_16x16x32_bf16 v[144:147], v[112:115], v[128:131], 0
    buffer_load_dwordx4 v0, s[8:11], s47 offen offset:1024 lds
    buffer_load_dwordx4 v0, s[8:11], s47 offen offset:2048 lds
    buffer_load_dwordx4 v0, s[8:11], s47 offen offset:3072 lds
    v_mfma_f32_16x16x32_bf16 v[32:35], v[56:59], a[220:223], v[32:35]
    s_add_u32 m0, s59, 4096
    s_add_u32 s47, s41, 4096
    buffer_load_dwordx4 v0, s[8:11], s47 offen offset:0 lds
    v_mfma_f32_16x16x32_bf16 v[148:151], v[132:135], v[128:131], 0
    buffer_load_dwordx4 v0, s[8:11], s47 offen offset:1024 lds
    buffer_load_dwordx4 v0, s[8:11], s47 offen offset:2048 lds
    buffer_load_dwordx4 v0, s[8:11], s47 offen offset:3072 lds
    ds_read_b128 v[56:59], v9 offset:24576
    s_waitcnt lgkmcnt(2)
    v_mfma_f32_16x16x32_bf16 v[28:31], v[60:63], a[152:155], v[28:31]
    v_mov_b32 v112, v132
    v_mfma_f32_16x16x32_bf16 v[32:35], v[60:63], a[224:227], v[32:35]
    v_mov_b32 v113, v133
    v_mov_b32 v114, v134
    ds_read_b128 v[60:63], v9 offset:26624
    s_waitcnt lgkmcnt(2)
    v_mfma_f32_16x16x32_bf16 v[28:31], v[64:67], a[156:159], v[28:31]
    s_add_u32 m0, s59, 8192
    s_add_u32 s47, s41, 8192
    buffer_load_dwordx4 v0, s[8:11], s47 offen offset:0 lds
    v_mfma_f32_16x16x32_bf16 v[32:35], v[64:67], a[228:231], v[32:35]
    s_mul_i32 s48, s36, 786432
    s_mul_i32 s18, s37, 6144
    s_add_u32 s48, s48, s18
    s_add_u32 s48, s48, 15728640
    buffer_load_dwordx4 v[80:83], v10, s[8:11], s48 offen offset:0
    v_fma_f32 v144, v144, s52, v72
    ds_read_b128 v[64:67], v9 offset:28672
    s_waitcnt lgkmcnt(2)
    v_mfma_f32_16x16x32_bf16 v[28:31], v[56:59], a[160:163], v[28:31]
    v_fma_f32 v145, v145, s52, v73
    v_fma_f32 v146, v146, s52, v74
    v_fma_f32 v147, v147, s52, v75
    v_mfma_f32_16x16x32_bf16 v[32:35], v[56:59], a[232:235], v[32:35]
    v_fma_f32 v148, v148, s52, v76
    v_fma_f32 v149, v149, s52, v77
    v_fma_f32 v150, v150, s52, v78
    ds_read_b128 v[56:59], v9 offset:30720
    s_waitcnt lgkmcnt(2)
    v_mfma_f32_16x16x32_bf16 v[28:31], v[60:63], a[164:167], v[28:31]
    v_fma_f32 v151, v151, s52, v79
    v_add_f32 v144, s46, v144
    v_add_f32 v145, s46, v145
    v_mfma_f32_16x16x32_bf16 v[32:35], v[60:63], a[236:239], v[32:35]
    v_add_f32 v146, s46, v146
    v_add_f32 v147, s46, v147
    v_max3_f32 v5, v144, v145, v146
    ds_read_b128 v[60:63], v9 offset:32768
    s_waitcnt lgkmcnt(2)
    v_mfma_f32_16x16x32_bf16 v[28:31], v[64:67], a[168:171], v[28:31]
    v_max3_f32 v5, v5, v147, v148
    v_max3_f32 v5, v5, v149, v150
    v_max_f32 v5, v5, v151
    v_mfma_f32_16x16x32_bf16 v[32:35], v[64:67], a[240:243], v[32:35]
    buffer_load_dwordx4 v[84:87], v10, s[8:11], s48 offen offset:512
    v_mov_b32 v6, v5
    s_nop 1
    v_permlane32_swap_b32 v5, v6
    ds_read_b128 v[64:67], v9 offset:34816
    s_waitcnt lgkmcnt(2)
    v_mfma_f32_16x16x32_bf16 v[28:31], v[56:59], a[172:175], v[28:31]
    buffer_load_dwordx4 v[88:91], v10, s[8:11], s48 offen offset:1024
    v_max_f32 v5, v5, v6
    v_mov_b32 v6, v5
    v_mfma_f32_16x16x32_bf16 v[32:35], v[56:59], a[244:247], v[32:35]
    s_nop 0
    v_permlane16_swap_b32 v5, v6
    v_max_f32 v5, v5, v6
    v_sub_f32 v144, v144, v5
    s_waitcnt lgkmcnt(1)
    v_mfma_f32_16x16x32_bf16 v[28:31], v[60:63], a[176:179], v[28:31]
    v_sub_f32 v145, v145, v5
    v_sub_f32 v146, v146, v5
    v_sub_f32 v147, v147, v5
    v_mfma_f32_16x16x32_bf16 v[32:35], v[60:63], a[248:251], v[32:35]
    v_sub_f32 v148, v148, v5
    v_sub_f32 v149, v149, v5
    v_sub_f32 v150, v150, v5
    s_waitcnt lgkmcnt(0)
    v_mfma_f32_16x16x32_bf16 v[28:31], v[64:67], a[180:183], v[28:31]
    v_sub_f32 v151, v151, v5
    v_exp_f32 v144, v144
    v_exp_f32 v145, v145
    v_mfma_f32_16x16x32_bf16 v[32:35], v[64:67], a[252:255], v[32:35]
    v_exp_f32 v146, v146
    v_exp_f32 v147, v147
    v_exp_f32 v148, v148
    v_cmp_eq_u32 s[76:77], 1, v2
    v_cmp_eq_u32 vcc, 2, v2
    s_cmp_eq_u64 s[76:77], -1
    s_cselect_b32 s38, 1, 0
    s_cmp_lg_u32 s38, 0
    s_cselect_b64 exec, 1, 0
    v_mov_b32 v15, s32
    ds_write_b32 v110, v15
    v_mov_b32 v2, 2
    s_mov_b64 exec, -1
    s_add_u32 s32, s32, s38
    s_mul_i32 s38, s38, 22528
    s_add_u32 s33, s33, s38
    s_cmp_eq_u64 vcc, 0
    s_cselect_b32 s38, s32, 0x7fff
    s_cmp_le_u32 s38, s39
    s_cselect_b64 exec, -1, 0
    v_mov_b32 v2, 2
    buffer_load_dword v2, v1, s[8:11], s33 offen sc1
    s_mov_b64 exec, -1
    v_exp_f32 v149, v149
    v_exp_f32 v150, v150
    v_exp_f32 v151, v151
    v_cvt_pk_bf16_f32 v68, v144, v145
    v_cvt_pk_bf16_f32 v69, v146, v147
    v_cvt_pk_bf16_f32 v70, v148, v149
    v_cvt_pk_bf16_f32 v71, v150, v151
    s_nop 1
    v_mfma_f32_16x16x32_bf16 v[16:19], v[116:119], v[68:71], 0
    s_mul_i32 s46, s57, 36864
    s_add_u32 s46, s46, 17301504
    s_nop 5
    v_rcp_f32 v6, v16
    v_mul_f32 v94, v97, v48
    v_fma_f32 v28, v28, v96, -v94
    v_mul_f32 v94, v99, v49
    v_fma_f32 v29, v29, v98, -v94
    v_mul_f32 v94, v101, v50
    v_fma_f32 v30, v30, v100, -v94
    v_mul_f32 v94, v103, v51
    v_fma_f32 v31, v31, v102, -v94
    v_cvt_pk_bf16_f32 v138, v28, v29
    v_cvt_pk_bf16_f32 v139, v30, v31
    v_mul_f32 v94, v97, v52
    v_fma_f32 v32, v32, v96, -v94
    v_mfma_f32_16x16x32_bf16 v[20:23], v[136:139], v[68:71], 0
    v_mul_f32 v94, v99, v53
    v_fma_f32 v33, v33, v98, -v94
    v_mul_f32 v94, v101, v54
    v_fma_f32 v34, v34, v100, -v94
    v_mul_f32 v94, v103, v55
    v_fma_f32 v35, v35, v102, -v94
    v_cvt_pk_bf16_f32 v142, v32, v33
    v_cvt_pk_bf16_f32 v143, v34, v35
    v_mov_b32 v136, v138
    v_mov_b32 v137, v139
    v_mfma_f32_16x16x32_bf16 v[24:27], v[140:143], v[68:71], 0
    v_mul_f32 v20, v6, v20
    v_mul_f32 v21, v6, v21
    v_mul_f32 v22, v6, v22
    v_mul_f32 v23, v6, v23
    v_cvt_pk_bf16_f32 v20, v20, v21
    v_cvt_pk_bf16_f32 v21, v22, v23
    s_mov_b64 exec, -1
    buffer_store_dwordx2 v[20:21], v13, s[8:11], s46 offen
    s_and_b64 exec, exec, s[78:79]
    buffer_store_dwordx2 v[20:21], v13, s[8:11], s46 offen sc1
    s_mov_b64 exec, -1
    v_mov_b32 v140, v142
    v_mov_b32 v141, v143
    v_mul_f32 v24, v6, v24
    v_mul_f32 v25, v6, v25
    v_cvt_pk_bf16_f32 v24, v24, v25
    s_mov_b64 exec, 0xffff
    buffer_store_dword v24, v14, s[8:11], s46 offen
    s_and_b64 exec, exec, s[78:79]
    buffer_store_dword v24, v14, s[8:11], s46 offen sc1
    s_mov_b64 exec, -1
    s_mul_i32 s43, s57, 22528
    s_add_u32 s43, s43, s49
    s_branch Laq_head
Laq_none:
    ds_read_b32 v15, v110
    s_waitcnt lgkmcnt(0)
    v_readfirstlane_b32 s17, v15
    s_nop 0
    s_cmp_lt_i32 s17, s37
    s_cbranch_scc1 Laq_nopost
    s_add_u32 m0, s59, 0
    s_add_u32 s47, s41, 0
    buffer_load_dwordx4 v0, s[8:11], s47 offen offset:0 lds
    buffer_load_dwordx4 v0, s[8:11], s47 offen offset:1024 lds
    buffer_load_dwordx4 v0, s[8:11], s47 offen offset:2048 lds
    buffer_load_dwordx4 v0, s[8:11], s47 offen offset:3072 lds
    s_add_u32 m0, s59, 4096
    s_add_u32 s47, s41, 4096
    buffer_load_dwordx4 v0, s[8:11], s47 offen offset:0 lds
    buffer_load_dwordx4 v0, s[8:11], s47 offen offset:1024 lds
    buffer_load_dwordx4 v0, s[8:11], s47 offen offset:2048 lds
    buffer_load_dwordx4 v0, s[8:11], s47 offen offset:3072 lds
    s_add_u32 m0, s59, 8192
    s_add_u32 s47, s41, 8192
    buffer_load_dwordx4 v0, s[8:11], s47 offen offset:0 lds
    s_mul_i32 s48, s36, 786432
    s_mul_i32 s18, s37, 6144
    s_add_u32 s48, s48, s18
    s_add_u32 s48, s48, 15728640
    buffer_load_dwordx4 v[80:83], v10, s[8:11], s48 offen offset:0
    buffer_load_dwordx4 v[84:87], v10, s[8:11], s48 offen offset:512
    buffer_load_dwordx4 v[88:91], v10, s[8:11], s48 offen offset:1024
    s_waitcnt vmcnt(12)
    s_cmp_lg_u32 s43, 0
    s_cselect_b64 exec, 1, 0
    buffer_store_dword v3, v4, s[8:11], s43 offen
    s_and_b64 exec, exec, s[78:79]
    buffer_store_dword v3, v4, s[8:11], s43 offen sc1
    s_mov_b64 exec, -1
    s_mov_b32 s43, 0
    s_waitcnt vmcnt(2) lgkmcnt(0)
    s_branch Laq_head2
Laq_nopost:
    s_waitcnt vmcnt(0)
    s_cmp_lg_u32 s43, 0
    s_cselect_b64 exec, 1, 0
    buffer_store_dword v3, v4, s[8:11], s43 offen
    s_and_b64 exec, exec, s[78:79]
    buffer_store_dword v3, v4, s[8:11], s43 offen sc1
    s_mov_b64 exec, -1
    s_mov_b32 s43, 0
    s_cmp_ge_u32 s37, 64
    s_cbranch_scc1 Laq_end
Laq_wait:
    s_mov_b32 s16, 0
    s_cmp_lg_u32 s14, 0
    s_cbranch_scc1 Laq_wl
Laq_wp:
    buffer_load_dword v2, v1, s[8:11], s60 offen sc1
    s_add_u32 s16, s16, 1
    s_cmp_gt_u32 s16, 100000
    s_cbranch_scc1 Laq_giveup
    s_waitcnt vmcnt(0)
    v_cmp_eq_u32 vcc, 0, v2
    s_nop 0
    s_cbranch_vccz Laq_wok
    s_sleep 4
    s_branch Laq_wp
Laq_giveup:
    v_mov_b32 v5, -2
    ds_write_b32 v110, v5
    s_waitcnt lgkmcnt(0)
    s_branch L_role_aq_abort
Laq_wok:
    v_mov_b32 v5, s37
    ds_write_b32 v110, v5
    s_branch Laq_go
Laq_wl:
    ds_read_b32 v15, v110
    s_add_u32 s16, s16, 1
    s_cmp_gt_u32 s16, 1600000
    s_cbranch_scc1 L_role_aq_abort
    s_waitcnt lgkmcnt(0)
    v_readfirstlane_b32 s17, v15
    s_nop 0
    s_cmp_eq_u32 s17, -2
    s_cbranch_scc1 L_role_aq_abort
    s_cmp_ge_i32 s17, s37
    s_cbranch_scc1 Laq_go
    s_sleep 1
    s_branch Laq_wl
Laq_go:
    s_add_u32 m0, s59, 0
    s_add_u32 s47, s41, 0
    buffer_load_dwordx4 v0, s[8:11], s47 offen offset:0 lds
    buffer_load_dwordx4 v0, s[8:11], s47 offen offset:1024 lds
    buffer_load_dwordx4 v0, s[8:11], s47 offen offset:2048 lds
    buffer_load_dwordx4 v0, s[8:11], s47 offen offset:3072 lds
    s_add_u32 m0, s59, 4096
    s_add_u32 s47, s41, 4096
    buffer_load_dwordx4 v0, s[8:11], s47 offen offset:0 lds
    buffer_load_dwordx4 v0, s[8:11], s47 offen offset:1024 lds
    buffer_load_dwordx4 v0, s[8:11], s47 offen offset:2048 lds
    buffer_load_dwordx4 v0, s[8:11], s47 offen offset:3072 lds
    s_add_u32 m0, s59, 8192
    s_add_u32 s47, s41, 8192
    buffer_load_dwordx4 v0, s[8:11], s47 offen offset:0 lds
    s_mul_i32 s48, s36, 786432
    s_mul_i32 s18, s37, 6144
    s_add_u32 s48, s48, s18
    s_add_u32 s48, s48, 15728640
    buffer_load_dwordx4 v[80:83], v10, s[8:11], s48 offen offset:0
    buffer_load_dwordx4 v[84:87], v10, s[8:11], s48 offen offset:512
    buffer_load_dwordx4 v[88:91], v10, s[8:11], s48 offen offset:1024
    s_waitcnt vmcnt(0) lgkmcnt(0)
    s_branch Laq_head2
Laq_end:
    s_branch L_role_aq_exit
L_role_aq_abort:
    s_waitcnt lgkmcnt(0)
    s_mov_b64 exec, -1
    v_mov_b32 v0, 60
    s_lshl_b32 s5, s3, 8
    s_or_b32 s5, s5, s4
    s_or_b32 s5, s5, 0x10000
    v_mov_b32 v1, s5
    global_store_dword v0, v1, s[12:13]
    s_endpgm
L_role_aq_exit:
    s_endpgm
.p2align 6
L_role_ta:
    v_and_b32 v5, 63, v0
    v_lshlrev_b32 v0, 4, v5
    v_and_b32 v7, 15, v5
    v_lshrrev_b32 v8, 4, v5
    v_min_u32 v1, 12, v5
    v_lshrrev_b32 v6, 2, v1
    v_and_b32 v1, 3, v1
    v_lshlrev_b32 v1, 2, v1
    v_lshl_add_u32 v1, v6, 7, v1
    v_mov_b32 v3, 1
    v_mov_b32 v4, 0
    s_mov_b32 s44, 0x05040100
    s_mov_b32 s45, 0x07060302
    s_cmp_ge_u32 s15, 11
    s_cselect_b32 s36, 1, 0
    s_cselect_b32 s17, 11, 0
    s_sub_u32 s17, s15, s17
    s_mul_i32 s50, s17, 3
    s_add_u32 s50, s50, s14
    s_cmp_eq_u32 s14, 3
    s_cselect_b32 s50, 32, s50
    s_mov_b32 s40, s50
    s_mov_b32 s37, 0
    s_mov_b32 s52, 0x3e0293ee
    v_lshrrev_b32 v5, 2, v7
    v_and_b32 v6, 1, v7
    v_lshl_add_u32 v5, v5, 1, v6
    v_lshlrev_b32 v9, 8, v5
    v_lshl_add_u32 v9, v8, 4, v9
    v_lshrrev_b32 v10, 1, v0
    v_mov_b32 v11, 384
    v_mov_b32 v6, 0xf149f2ca
    v_mov_b32 v21, 0
    v_mov_b32 v22, 0
    s_mul_i32 s42, s36, 1441792
    s_lshl_b32 s17, s50, 9
    s_add_u32 s42, s42, s17
    s_add_u32 s42, s42, 5376
    s_mul_i32 s51, s36, 50331648
    s_lshl_b32 s17, s50, 13
    s_add_u32 s51, s51, s17
    s_add_u32 s51, s51, 44040192
    s_lshl_b32 s47, s36, 11
    s_add_u32 s47, s47, s50
    s_lshl_b32 s48, s47, 13
    s_add_u32 s48, s48, 144703488
    s_lshl_b32 s47, s47, 12
    s_add_u32 s47, s47, 27262976
    s_mul_i32 s43, s36, 1441792
    s_lshr_b32 s17, s50, 2
    s_lshl_b32 s17, s17, 7
    s_add_u32 s43, s43, s17
    s_and_b32 s17, s50, 3
    s_lshl_b32 s17, s17, 2
    s_add_u32 s43, s43, s17
    s_add_u32 s43, s43, 4224
    s_mov_b32 s28, s8
    s_mov_b32 s29, s9
    s_mov_b32 s30, 0
    s_mov_b32 s31, 0x00020000
    s_mov_b32 s39, 0
    s_mov_b32 s38, 0
    s_mov_b32 s49, 0
    s_mov_b32 s20, s8
    s_mov_b32 s21, s9
    s_mov_b32 s22, 0
    s_mov_b32 s23, 0x00020000
    v_mov_b32 v16, 0x3f803f80
    v_lshl_add_u32 v5, v8, 2, 0
    v_cmp_le_u32 vcc, v5, v7
    s_nop 1
    v_cndmask_b32 v236, v6, v4, vcc
    v_mov_b32 v17, 0x3f803f80
    v_lshl_add_u32 v5, v8, 2, 1
    v_cmp_le_u32 vcc, v5, v7
    s_nop 1
    v_cndmask_b32 v237, v6, v4, vcc
    v_mov_b32 v18, 0x3f803f80
    v_lshl_add_u32 v5, v8, 2, 2
    v_cmp_le_u32 vcc, v5, v7
    s_nop 1
    v_cndmask_b32 v238, v6, v4, vcc
    v_mov_b32 v19, 0x3f803f80
    v_lshl_add_u32 v5, v8, 2, 3
    v_cmp_le_u32 vcc, v5, v7
    s_nop 1
    v_cndmask_b32 v239, v6, v4, vcc
    v_mov_b32 v15, 0
    s_cmp_lg_u32 s14, 0
    s_cbranch_scc1 Lta_inia_d
    v_mov_b32 v5, 40
    s_mov_b32 s16, 0
Lta_inia:
    global_load_dword v6, v5, s[12:13] sc1
    s_add_u32 s16, s16, 1
    s_cmp_gt_u32 s16, 100000
    s_cbranch_scc1 L_role_ta_abort
    s_waitcnt vmcnt(0)
    v_cmp_gt_u32 vcc, 72, v6
    s_nop 0
    s_cbranch_vccz Lta_inia_d
    s_sleep 8
    s_branch Lta_inia
Lta_inia_d:
    s_barrier
    s_cmp_eq_u32 s36, 0
    s_cbranch_scc1 Lta_ini_sk
    s_cmp_lg_u32 s14, 0
    s_cbranch_scc1 Lta_inib_d
    v_mov_b32 v5, 160
    s_mov_b32 s16, 0
Lta_inib:
    global_load_dword v6, v5, s[12:13] sc1
    s_add_u32 s16, s16, 1
    s_cmp_gt_u32 s16, 100000
    s_cbranch_scc1 L_role_ta_abort
    s_waitcnt vmcnt(0)
    v_cmp_gt_u32 vcc, 64, v6
    s_nop 0
    s_cbranch_vccz Lta_inib_d
    s_sleep 8
    s_branch Lta_inib
Lta_inib_d:
    s_barrier
Lta_ini_sk:
    s_cmp_ge_u32 s40, 32
    s_cbranch_scc1 L_role_ta_exit
Lta0:
    s_cmp_eq_u32 s39, 1
    s_cbranch_scc1 Lta0_have
    s_waitcnt vmcnt(0)
    s_cmp_lg_u32 s49, 0
    s_cselect_b64 exec, 1, 0
    buffer_store_dword v3, v4, s[8:11], s43 offen sc1
    s_mov_b64 exec, -1
    s_add_u32 s43, s43, s49
    s_mov_b32 s49, 0
    s_mov_b32 s16, 0
Lta0_f:
    buffer_load_dword v2, v1, s[8:11], s42 offen sc1
    s_add_u32 s16, s16, 1
    s_cmp_gt_u32 s16, 100000
    s_cbranch_scc1 L_role_ta_abort
    s_waitcnt vmcnt(0)
    v_cmp_eq_u32 vcc, 0, v2
    s_nop 0
    s_and_b32 s17, vcc_lo, 0xfff
    s_cbranch_scc0 Lta0_fd
    s_sleep 4
    s_branch Lta0_f
Lta0_fd:
    s_add_u32 s46, s51, 0
    buffer_load_dwordx4 v[140:143], v0, s[8:11], s46 offen offset:0
    buffer_load_dwordx4 v[144:147], v0, s[8:11], s46 offen offset:1024
    buffer_load_dwordx4 v[148:151], v0, s[8:11], s46 offen offset:2048
    buffer_load_dwordx4 v[152:155], v0, s[8:11], s46 offen offset:3072
    s_add_u32 s46, s51, 4096
    buffer_load_dwordx4 v[156:159], v0, s[8:11], s46 offen offset:0
    buffer_load_dwordx4 v[160:163], v0, s[8:11], s46 offen offset:1024
    buffer_load_dwordx4 v[164:167], v0, s[8:11], s46 offen offset:2048
    buffer_load_dwordx4 v[168:171], v0, s[8:11], s46 offen offset:3072
    s_add_u32 s46, s51, 16777216
    buffer_load_dwordx4 v[172:175], v0, s[8:11], s46 offen offset:0
    buffer_load_dwordx4 v[176:179], v0, s[8:11], s46 offen offset:1024
    buffer_load_dwordx4 v[180:183], v0, s[8:11], s46 offen offset:2048
    buffer_load_dwordx4 v[184:187], v0, s[8:11], s46 offen offset:3072
    s_add_u32 s46, s51, 16781312
    buffer_load_dwordx4 v[188:191], v0, s[8:11], s46 offen offset:0
    buffer_load_dwordx4 v[192:195], v0, s[8:11], s46 offen offset:1024
    buffer_load_dwordx4 v[196:199], v0, s[8:11], s46 offen offset:2048
    buffer_load_dwordx4 v[200:203], v0, s[8:11], s46 offen offset:3072
    s_add_u32 s46, s51, 33554432
    buffer_load_dwordx4 v[204:207], v0, s[8:11], s46 offen offset:0
    buffer_load_dwordx4 v[208:211], v0, s[8:11], s46 offen offset:1024
    buffer_load_dwordx4 v[212:215], v0, s[8:11], s46 offen offset:2048
    buffer_load_dwordx4 v[216:219], v0, s[8:11], s46 offen offset:3072
    s_add_u32 s46, s51, 33558528
    buffer_load_dwordx4 v[220:223], v0, s[8:11], s46 offen offset:0
    buffer_load_dwordx4 v[224:227], v0, s[8:11], s46 offen offset:1024
    buffer_load_dwordx4 v[228:231], v0, s[8:11], s46 offen offset:2048
    buffer_load_dwordx4 v[232:235], v0, s[8:11], s46 offen offset:3072
    s_waitcnt vmcnt(0)
Lta0_have:
    buffer_load_dword v2, v11, s[8:11], s42 offen sc1
    s_waitcnt vmcnt(5)
    v_cmp_eq_u32 vcc, 0, v15
    s_add_u32 s51, s51, 262144
    s_add_u32 s37, s37, 1
    s_mov_b32 s62, s38
    s_and_b32 s17, vcc_lo, 0xfff
    s_cselect_b32 s39, 0, 1
    s_cmp_eq_u64 vcc, 0
    s_cselect_b32 s38, 1, 0
    s_cmp_lt_u32 s37, 64
    s_cselect_b32 s39, s39, 0
    s_cselect_b32 s38, s38, 0
    s_cmp_eq_u32 s39, 1
    s_cselect_b32 s30, 268435456, 0
    s_cmp_eq_u32 s38, 1
    s_cselect_b32 s22, 268435456, 0
    v_mfma_f32_16x16x32_bf16 v[32:35], v[172:175], v[140:143], 0
    s_add_u32 s46, s51, 0
    buffer_load_dwordx4 a[0:3], v0, s[28:31], s46 offen offset:0
    v_mfma_f32_16x16x32_bf16 v[36:39], v[172:175], v[144:147], 0
    buffer_load_dwordx4 a[4:7], v0, s[28:31], s46 offen offset:1024
    v_mfma_f32_16x16x32_bf16 v[40:43], v[176:179], v[144:147], 0
    buffer_load_dwordx4 a[8:11], v0, s[28:31], s46 offen offset:2048
    v_mfma_f32_16x16x32_bf16 v[32:35], v[180:183], v[148:151], v[32:35]
    buffer_load_dwordx4 a[12:15], v0, s[28:31], s46 offen offset:3072
    v_mfma_f32_16x16x32_bf16 v[36:39], v[180:183], v[152:155], v[36:39]
    s_add_u32 s46, s51, 4096
    buffer_load_dwordx4 a[16:19], v0, s[28:31], s46 offen offset:0
    v_mfma_f32_16x16x32_bf16 v[40:43], v[184:187], v[152:155], v[40:43]
    buffer_load_dwordx4 a[20:23], v0, s[28:31], s46 offen offset:1024
    v_mfma_f32_16x16x32_bf16 v[32:35], v[188:191], v[156:159], v[32:35]
    v_mfma_f32_16x16x32_bf16 v[36:39], v[188:191], v[160:163], v[36:39]
    v_mfma_f32_16x16x32_bf16 v[40:43], v[192:195], v[160:163], v[40:43]
    v_mfma_f32_16x16x32_bf16 v[32:35], v[196:199], v[164:167], v[32:35]
    v_mfma_f32_16x16x32_bf16 v[36:39], v[196:199], v[168:171], v[36:39]
    v_mfma_f32_16x16x32_bf16 v[40:43], v[200:203], v[168:171], v[40:43]
    s_waitcnt vmcnt(7)
    s_cmp_lg_u32 s49, 0
    s_cselect_b64 exec, 1, 0
    buffer_store_dword v3, v4, s[8:11], s43 offen sc1
    s_mov_b64 exec, -1
    s_add_u32 s43, s43, s49
    s_mov_b32 s49, 0
    s_cmp_eq_u32 s62, 1
    s_cbranch_scc1 Lta0_km
    s_waitcnt vmcnt(6)
    v_cmp_eq_u32 vcc, 0, v2
    s_nop 0
    s_cbranch_vccz Lta0_r
    s_mov_b32 s16, 0
Lta0_rp:
    buffer_load_dword v2, v11, s[8:11], s42 offen sc1
    s_add_u32 s16, s16, 1
    s_cmp_gt_u32 s16, 100000
    s_cbranch_scc1 L_role_ta_abort
    s_waitcnt vmcnt(0)
    v_cmp_eq_u32 vcc, 0, v2
    s_nop 0
    s_cbranch_vccnz Lta0_rp
Lta0_r:
    buffer_load_dwordx4 a[96:99], v9, s[8:11], s47 offen offset:0
    buffer_load_dwordx4 a[100:103], v9, s[8:11], s47 offen offset:64
    buffer_load_dwordx4 a[104:107], v9, s[8:11], s47 offen offset:128
    buffer_load_dwordx4 a[108:111], v9, s[8:11], s47 offen offset:192
    buffer_load_dwordx2 a[112:113], v10, s[8:11], s47 offen offset:2048
    buffer_load_dwordx2 a[114:115], v10, s[8:11], s47 offen offset:2560
    buffer_load_dwordx2 a[116:117], v10, s[8:11], s47 offen offset:3072
    buffer_load_dwordx2 a[118:119], v10, s[8:11], s47 offen offset:3584
Lta0_km:
    s_add_u32 s42, s42, 22528
    s_add_u32 s47, s47, 131072
    v_fma_f32 v32, v32, s52, v236
    v_fma_f32 v33, v33, s52, v237
    v_fma_f32 v34, v34, s52, v238
    v_fma_f32 v35, v35, s52, v239
    buffer_load_dwordx4 a[24:27], v0, s[28:31], s46 offen offset:2048
    buffer_load_dwordx4 a[28:31], v0, s[28:31], s46 offen offset:3072
    v_mul_f32 v36, s52, v36
    v_mul_f32 v37, s52, v37
    v_mul_f32 v38, s52, v38
    v_mul_f32 v39, s52, v39
    s_add_u32 s46, s51, 16777216
    buffer_load_dwordx4 a[32:35], v0, s[28:31], s46 offen offset:0
    buffer_load_dwordx4 a[36:39], v0, s[28:31], s46 offen offset:1024
    v_fma_f32 v40, v40, s52, v236
    v_fma_f32 v41, v41, s52, v237
    v_fma_f32 v42, v42, s52, v238
    v_fma_f32 v43, v43, s52, v239
    buffer_load_dwordx4 a[40:43], v0, s[28:31], s46 offen offset:2048
    buffer_load_dwordx4 a[44:47], v0, s[28:31], s46 offen offset:3072
    s_waitcnt vmcnt(13)
    v_mfma_f32_16x16x32_bf16 v[44:47], a[96:99], v[140:143], 0
    v_mfma_f32_16x16x32_bf16 v[48:51], a[96:99], v[144:147], 0
    s_add_u32 s46, s51, 16781312
    buffer_load_dwordx4 a[48:51], v0, s[28:31], s46 offen offset:0
    s_waitcnt vmcnt(13)
    v_mfma_f32_16x16x32_bf16 v[44:47], a[100:103], v[148:151], v[44:47]
    v_mfma_f32_16x16x32_bf16 v[48:51], a[100:103], v[152:155], v[48:51]
    buffer_load_dwordx4 a[52:55], v0, s[28:31], s46 offen offset:1024
    s_waitcnt vmcnt(13)
    v_mfma_f32_16x16x32_bf16 v[44:47], a[104:107], v[156:159], v[44:47]
    v_mfma_f32_16x16x32_bf16 v[48:51], a[104:107], v[160:163], v[48:51]
    buffer_load_dwordx4 a[56:59], v0, s[28:31], s46 offen offset:2048
    s_waitcnt vmcnt(13)
    v_mfma_f32_16x16x32_bf16 v[44:47], a[108:111], v[164:167], v[44:47]
    v_mfma_f32_16x16x32_bf16 v[48:51], a[108:111], v[168:171], v[48:51]
    buffer_load_dwordx4 a[60:63], v0, s[28:31], s46 offen offset:3072
    v_max3_f32 v5, v32, v33, v34
    v_max_f32 v5, v5, v35
    s_nop 0
    v_mul_f32 v44, s52, v44
    v_mul_f32 v45, s52, v45
    v_max3_f32 v5, v5, v44, v45
    v_mov_b32 v6, v5
    s_add_u32 s46, s51, 33554432
    buffer_load_dwordx4 a[64:67], v0, s[28:31], s46 offen offset:0
    v_permlane32_swap_b32 v5, v6
    v_max_f32 v5, v5, v6
    v_mov_b32 v6, v5
    buffer_load_dwordx4 a[68:71], v0, s[28:31], s46 offen offset:1024
    s_nop 0
    v_permlane16_swap_b32 v5, v6
    v_max_f32 v5, v5, v6
    v_sub_f32 v32, v32, v5
    v_sub_f32 v33, v33, v5
    v_sub_f32 v34, v34, v5
    v_sub_f32 v35, v35, v5
    v_sub_f32 v44, v44, v5
    v_sub_f32 v45, v45, v5
    v_exp_f32 v32, v32
    v_exp_f32 v33, v33
    v_exp_f32 v34, v34
    v_exp_f32 v35, v35
    v_exp_f32 v44, v44
    v_exp_f32 v45, v45
    v_cvt_pk_bf16_f32 v24, v32, v33
    v_cvt_pk_bf16_f32 v25, v34, v35
    v_mov_b32 v26, 0
    v_mov_b32 v27, 0
    v_cvt_pk_bf16_f32 v20, v44, v45
    v_cvt_pk_bf16_f32 v23, v44, v45
    v_mfma_f32_16x16x32_bf16 v[28:31], v[16:19], v[24:27], 0
    v_mfma_f32_16x16x32_bf16 v[76:79], v[204:207], v[24:27], 0
    v_mfma_f32_16x16x32_bf16 v[80:83], v[208:211], v[24:27], 0
    s_add_u32 s17, s42, 22528
    buffer_load_dword v15, v1, s[8:11], s17 offen sc1
    v_mfma_f32_16x16x32_bf16 v[84:87], v[212:215], v[24:27], 0
    v_mfma_f32_16x16x32_bf16 v[88:91], v[216:219], v[24:27], 0
    buffer_load_dwordx4 a[72:75], v0, s[28:31], s46 offen offset:2048
    v_mfma_f32_16x16x32_bf16 v[92:95], v[220:223], v[24:27], 0
    v_mfma_f32_16x16x32_bf16 v[96:99], v[224:227], v[24:27], 0
    buffer_load_dwordx4 a[76:79], v0, s[28:31], s46 offen offset:3072
    v_mfma_f32_16x16x16_bf16 v[28:31], v[16:17], v[20:21], v[28:31]
    v_mfma_f32_16x16x32_bf16 v[100:103], v[228:231], v[24:27], 0
    v_mfma_f32_16x16x32_bf16 v[104:107], v[232:235], v[24:27], 0
    s_add_u32 s46, s51, 33558528
    buffer_load_dwordx4 a[80:83], v0, s[28:31], s46 offen offset:0
    s_waitcnt vmcnt(19)
    v_mfma_f32_16x16x16_bf16 v[76:79], a[112:113], v[20:21], v[76:79]
    v_mfma_f32_16x16x16_bf16 v[80:83], a[112:113], v[22:23], v[80:83]
    v_rcp_f32 v6, v28
    s_waitcnt vmcnt(18)
    v_mfma_f32_16x16x16_bf16 v[84:87], a[114:115], v[20:21], v[84:87]
    v_mfma_f32_16x16x16_bf16 v[88:91], a[114:115], v[22:23], v[88:91]
    v_mul_f32 v76, v6, v76
    v_mul_f32 v80, v6, v80
    v_cvt_pk_bf16_f32 v108, v76, v80
    v_mul_f32 v77, v6, v77
    v_mul_f32 v81, v6, v81
    v_cvt_pk_bf16_f32 v109, v77, v81
    v_mul_f32 v78, v6, v78
    v_mul_f32 v82, v6, v82
    v_cvt_pk_bf16_f32 v110, v78, v82
    v_mul_f32 v79, v6, v79
    v_mul_f32 v83, v6, v83
    v_cvt_pk_bf16_f32 v111, v79, v83
    s_add_u32 s17, s48, 0
    buffer_store_dwordx4 v[108:111], v0, s[8:11], s17 offen offset:0 sc1
    buffer_load_dwordx4 a[84:87], v0, s[28:31], s46 offen offset:1024
    s_waitcnt vmcnt(19)
    v_mfma_f32_16x16x16_bf16 v[92:95], a[116:117], v[20:21], v[92:95]
    v_mfma_f32_16x16x16_bf16 v[96:99], a[116:117], v[22:23], v[96:99]
    v_mul_f32 v84, v6, v84
    v_mul_f32 v88, v6, v88
    v_cvt_pk_bf16_f32 v112, v84, v88
    v_mul_f32 v85, v6, v85
    v_mul_f32 v89, v6, v89
    v_cvt_pk_bf16_f32 v113, v85, v89
    v_mul_f32 v86, v6, v86
    v_mul_f32 v90, v6, v90
    v_cvt_pk_bf16_f32 v114, v86, v90
    v_mul_f32 v87, v6, v87
    v_mul_f32 v91, v6, v91
    v_cvt_pk_bf16_f32 v115, v87, v91
    buffer_store_dwordx4 v[112:115], v0, s[8:11], s17 offen offset:2048 sc1
    buffer_load_dwordx4 a[88:91], v0, s[28:31], s46 offen offset:2048
    s_waitcnt vmcnt(20)
    v_mfma_f32_16x16x16_bf16 v[100:103], a[118:119], v[20:21], v[100:103]
    v_mfma_f32_16x16x16_bf16 v[104:107], a[118:119], v[22:23], v[104:107]
    v_mul_f32 v92, v6, v92
    v_mul_f32 v96, v6, v96
    v_cvt_pk_bf16_f32 v116, v92, v96
    v_mul_f32 v93, v6, v93
    v_mul_f32 v97, v6, v97
    v_cvt_pk_bf16_f32 v117, v93, v97
    v_mul_f32 v94, v6, v94
    v_mul_f32 v98, v6, v98
    v_cvt_pk_bf16_f32 v118, v94, v98
    v_mul_f32 v95, v6, v95
    v_mul_f32 v99, v6, v99
    v_cvt_pk_bf16_f32 v119, v95, v99
    s_add_u32 s17, s48, 4096
    buffer_store_dwordx4 v[116:119], v0, s[8:11], s17 offen offset:0 sc1
    buffer_load_dwordx4 a[92:95], v0, s[28:31], s46 offen offset:3072
    v_mul_f32 v100, v6, v100
    v_mul_f32 v104, v6, v104
    v_cvt_pk_bf16_f32 v120, v100, v104
    v_mul_f32 v101, v6, v101
    v_mul_f32 v105, v6, v105
    v_cvt_pk_bf16_f32 v121, v101, v105
    v_mul_f32 v102, v6, v102
    v_mul_f32 v106, v6, v106
    v_cvt_pk_bf16_f32 v122, v102, v106
    v_mul_f32 v103, v6, v103
    v_mul_f32 v107, v6, v107
    v_cvt_pk_bf16_f32 v123, v103, v107
    buffer_store_dwordx4 v[120:123], v0, s[8:11], s17 offen offset:2048 sc1
    buffer_load_dwordx4 a[120:123], v9, s[20:23], s47 offen offset:0
    v_max3_f32 v5, v36, v37, v38
    v_max_f32 v5, v5, v39
    v_max3_f32 v5, v5, v40, v41
    v_max3_f32 v5, v5, v42, v43
    v_mul_f32 v48, s52, v48
    v_mul_f32 v49, s52, v49
    v_max3_f32 v5, v5, v48, v49
    v_mov_b32 v6, v5
    buffer_load_dwordx4 a[124:127], v9, s[20:23], s47 offen offset:64
    s_nop 0
    v_permlane32_swap_b32 v5, v6
    v_max_f32 v5, v5, v6
    v_mov_b32 v6, v5
    buffer_load_dwordx4 a[128:131], v9, s[20:23], s47 offen offset:128
    s_nop 0
    v_permlane16_swap_b32 v5, v6
    v_max_f32 v5, v5, v6
    v_sub_f32 v36, v36, v5
    v_sub_f32 v37, v37, v5
    v_sub_f32 v38, v38, v5
    v_sub_f32 v39, v39, v5
    v_sub_f32 v40, v40, v5
    v_sub_f32 v41, v41, v5
    v_sub_f32 v42, v42, v5
    v_sub_f32 v43, v43, v5
    v_sub_f32 v48, v48, v5
    v_sub_f32 v49, v49, v5
    v_exp_f32 v36, v36
    v_exp_f32 v37, v37
    v_exp_f32 v38, v38
    v_exp_f32 v39, v39
    v_exp_f32 v40, v40
    v_exp_f32 v41, v41
    v_exp_f32 v42, v42
    v_exp_f32 v43, v43
    v_exp_f32 v48, v48
    v_exp_f32 v49, v49
    v_cvt_pk_bf16_f32 v24, v36, v37
    v_cvt_pk_bf16_f32 v25, v38, v39
    v_cvt_pk_bf16_f32 v26, v40, v41
    v_cvt_pk_bf16_f32 v27, v42, v43
    v_cvt_pk_bf16_f32 v20, v48, v49
    v_cvt_pk_bf16_f32 v23, v48, v49
    v_mfma_f32_16x16x32_bf16 v[28:31], v[16:19], v[24:27], 0
    v_mfma_f32_16x16x32_bf16 v[76:79], v[204:207], v[24:27], 0
    v_mfma_f32_16x16x32_bf16 v[80:83], v[208:211], v[24:27], 0
    buffer_load_dwordx4 a[132:135], v9, s[20:23], s47 offen offset:192
    v_mfma_f32_16x16x32_bf16 v[84:87], v[212:215], v[24:27], 0
    v_mfma_f32_16x16x32_bf16 v[88:91], v[216:219], v[24:27], 0
    buffer_load_dwordx2 a[136:137], v10, s[20:23], s47 offen offset:2048
    v_mfma_f32_16x16x32_bf16 v[92:95], v[220:223], v[24:27], 0
    v_mfma_f32_16x16x32_bf16 v[96:99], v[224:227], v[24:27], 0
    buffer_load_dwordx2 a[138:139], v10, s[20:23], s47 offen offset:2560
    v_mfma_f32_16x16x16_bf16 v[28:31], v[16:17], v[20:21], v[28:31]
    v_mfma_f32_16x16x32_bf16 v[100:103], v[228:231], v[24:27], 0
    v_mfma_f32_16x16x32_bf16 v[104:107], v[232:235], v[24:27], 0
    buffer_load_dwordx2 a[140:141], v10, s[20:23], s47 offen offset:3072
    buffer_load_dwordx2 a[142:143], v10, s[20:23], s47 offen offset:3584
    v_mfma_f32_16x16x16_bf16 v[76:79], a[112:113], v[20:21], v[76:79]
    v_mfma_f32_16x16x16_bf16 v[80:83], a[112:113], v[22:23], v[80:83]
    v_rcp_f32 v6, v28
    v_mfma_f32_16x16x16_bf16 v[84:87], a[114:115], v[20:21], v[84:87]
    v_mfma_f32_16x16x16_bf16 v[88:91], a[114:115], v[22:23], v[88:91]
    v_mul_f32 v76, v6, v76
    v_mul_f32 v80, v6, v80
    v_cvt_pk_bf16_f32 v124, v76, v80
    v_mul_f32 v77, v6, v77
    v_mul_f32 v81, v6, v81
    v_cvt_pk_bf16_f32 v125, v77, v81
    v_mul_f32 v78, v6, v78
    v_mul_f32 v82, v6, v82
    v_cvt_pk_bf16_f32 v126, v78, v82
    v_mul_f32 v79, v6, v79
    v_mul_f32 v83, v6, v83
    v_cvt_pk_bf16_f32 v127, v79, v83
    s_add_u32 s17, s48, 0
    buffer_store_dwordx4 v[124:127], v0, s[8:11], s17 offen offset:1024 sc1
    v_mfma_f32_16x16x16_bf16 v[92:95], a[116:117], v[20:21], v[92:95]
    v_mfma_f32_16x16x16_bf16 v[96:99], a[116:117], v[22:23], v[96:99]
    v_mul_f32 v84, v6, v84
    v_mul_f32 v88, v6, v88
    v_cvt_pk_bf16_f32 v128, v84, v88
    v_mul_f32 v85, v6, v85
    v_mul_f32 v89, v6, v89
    v_cvt_pk_bf16_f32 v129, v85, v89
    v_mul_f32 v86, v6, v86
    v_mul_f32 v90, v6, v90
    v_cvt_pk_bf16_f32 v130, v86, v90
    v_mul_f32 v87, v6, v87
    v_mul_f32 v91, v6, v91
    v_cvt_pk_bf16_f32 v131, v87, v91
    buffer_store_dwordx4 v[128:131], v0, s[8:11], s17 offen offset:3072 sc1
    v_mfma_f32_16x16x16_bf16 v[100:103], a[118:119], v[20:21], v[100:103]
    v_mfma_f32_16x16x16_bf16 v[104:107], a[118:119], v[22:23], v[104:107]
    v_mul_f32 v92, v6, v92
    v_mul_f32 v96, v6, v96
    v_cvt_pk_bf16_f32 v132, v92, v96
    v_mul_f32 v93, v6, v93
    v_mul_f32 v97, v6, v97
    v_cvt_pk_bf16_f32 v133, v93, v97
    v_mul_f32 v94, v6, v94
    v_mul_f32 v98, v6, v98
    v_cvt_pk_bf16_f32 v134, v94, v98
    v_mul_f32 v95, v6, v95
    v_mul_f32 v99, v6, v99
    v_cvt_pk_bf16_f32 v135, v95, v99
    s_add_u32 s17, s48, 4096
    buffer_store_dwordx4 v[132:135], v0, s[8:11], s17 offen offset:1024 sc1
    v_mul_f32 v100, v6, v100
    v_mul_f32 v104, v6, v104
    v_cvt_pk_bf16_f32 v136, v100, v104
    v_mul_f32 v101, v6, v101
    v_mul_f32 v105, v6, v105
    v_cvt_pk_bf16_f32 v137, v101, v105
    v_mul_f32 v102, v6, v102
    v_mul_f32 v106, v6, v106
    v_cvt_pk_bf16_f32 v138, v102, v106
    v_mul_f32 v103, v6, v103
    v_mul_f32 v107, v6, v107
    v_cvt_pk_bf16_f32 v139, v103, v107
    buffer_store_dwordx4 v[136:139], v0, s[8:11], s17 offen offset:3072 sc1
    s_add_u32 s48, s48, 262144
    s_mov_b32 s49, 22528
    s_cmp_ge_u32 s37, 64
    s_cbranch_scc1 Lta_end
Lta1:
    s_cmp_eq_u32 s39, 1
    s_cbranch_scc1 Lta1_have
    s_waitcnt vmcnt(0)
    s_cmp_lg_u32 s49, 0
    s_cselect_b64 exec, 1, 0
    buffer_store_dword v3, v4, s[8:11], s43 offen sc1
    s_mov_b64 exec, -1
    s_add_u32 s43, s43, s49
    s_mov_b32 s49, 0
    s_mov_b32 s16, 0
Lta1_f:
    buffer_load_dword v2, v1, s[8:11], s42 offen sc1
    s_add_u32 s16, s16, 1
    s_cmp_gt_u32 s16, 100000
    s_cbranch_scc1 L_role_ta_abort
    s_waitcnt vmcnt(0)
    v_cmp_eq_u32 vcc, 0, v2
    s_nop 0
    s_and_b32 s17, vcc_lo, 0xfff
    s_cbranch_scc0 Lta1_fd
    s_sleep 4
    s_branch Lta1_f
Lta1_fd:
    s_add_u32 s46, s51, 0
    buffer_load_dwordx4 a[0:3], v0, s[8:11], s46 offen offset:0
    buffer_load_dwordx4 a[4:7], v0, s[8:11], s46 offen offset:1024
    buffer_load_dwordx4 a[8:11], v0, s[8:11], s46 offen offset:2048
    buffer_load_dwordx4 a[12:15], v0, s[8:11], s46 offen offset:3072
    s_add_u32 s46, s51, 4096
    buffer_load_dwordx4 a[16:19], v0, s[8:11], s46 offen offset:0
    buffer_load_dwordx4 a[20:23], v0, s[8:11], s46 offen offset:1024
    buffer_load_dwordx4 a[24:27], v0, s[8:11], s46 offen offset:2048
    buffer_load_dwordx4 a[28:31], v0, s[8:11], s46 offen offset:3072
    s_add_u32 s46, s51, 16777216
    buffer_load_dwordx4 a[32:35], v0, s[8:11], s46 offen offset:0
    buffer_load_dwordx4 a[36:39], v0, s[8:11], s46 offen offset:1024
    buffer_load_dwordx4 a[40:43], v0, s[8:11], s46 offen offset:2048
    buffer_load_dwordx4 a[44:47], v0, s[8:11], s46 offen offset:3072
    s_add_u32 s46, s51, 16781312
    buffer_load_dwordx4 a[48:51], v0, s[8:11], s46 offen offset:0
    buffer_load_dwordx4 a[52:55], v0, s[8:11], s46 offen offset:1024
    buffer_load_dwordx4 a[56:59], v0, s[8:11], s46 offen offset:2048
    buffer_load_dwordx4 a[60:63], v0, s[8:11], s46 offen offset:3072
    s_add_u32 s46, s51, 33554432
    buffer_load_dwordx4 a[64:67], v0, s[8:11], s46 offen offset:0
    buffer_load_dwordx4 a[68:71], v0, s[8:11], s46 offen offset:1024
    buffer_load_dwordx4 a[72:75], v0, s[8:11], s46 offen offset:2048
    buffer_load_dwordx4 a[76:79], v0, s[8:11], s46 offen offset:3072
    s_add_u32 s46, s51, 33558528
    buffer_load_dwordx4 a[80:83], v0, s[8:11], s46 offen offset:0
    buffer_load_dwordx4 a[84:87], v0, s[8:11], s46 offen offset:1024
    buffer_load_dwordx4 a[88:91], v0, s[8:11], s46 offen offset:2048
    buffer_load_dwordx4 a[92:95], v0, s[8:11], s46 offen offset:3072
    s_waitcnt vmcnt(0)
Lta1_have:
    buffer_load_dword v2, v11, s[8:11], s42 offen sc1
    s_waitcnt vmcnt(5)
    v_cmp_eq_u32 vcc, 0, v15
    s_add_u32 s51, s51, 262144
    s_add_u32 s37, s37, 1
    s_mov_b32 s62, s38
    s_and_b32 s17, vcc_lo, 0xfff
    s_cselect_b32 s39, 0, 1
    s_cmp_eq_u64 vcc, 0
    s_cselect_b32 s38, 1, 0
    s_cmp_lt_u32 s37, 64
    s_cselect_b32 s39, s39, 0
    s_cselect_b32 s38, s38, 0
    s_cmp_eq_u32 s39, 1
    s_cselect_b32 s30, 268435456, 0
    s_cmp_eq_u32 s38, 1
    s_cselect_b32 s22, 268435456, 0
    v_mfma_f32_16x16x32_bf16 v[32:35], a[32:35], a[0:3], 0
    s_add_u32 s46, s51, 0
    buffer_load_dwordx4 v[140:143], v0, s[28:31], s46 offen offset:0
    v_mfma_f32_16x16x32_bf16 v[36:39], a[32:35], a[4:7], 0
    buffer_load_dwordx4 v[144:147], v0, s[28:31], s46 offen offset:1024
    v_mfma_f32_16x16x32_bf16 v[40:43], a[36:39], a[4:7], 0
    buffer_load_dwordx4 v[148:151], v0, s[28:31], s46 offen offset:2048
    v_mfma_f32_16x16x32_bf16 v[32:35], a[40:43], a[8:11], v[32:35]
    buffer_load_dwordx4 v[152:155], v0, s[28:31], s46 offen offset:3072
    v_mfma_f32_16x16x32_bf16 v[36:39], a[40:43], a[12:15], v[36:39]
    s_add_u32 s46, s51, 4096
    buffer_load_dwordx4 v[156:159], v0, s[28:31], s46 offen offset:0
    v_mfma_f32_16x16x32_bf16 v[40:43], a[44:47], a[12:15], v[40:43]
    buffer_load_dwordx4 v[160:163], v0, s[28:31], s46 offen offset:1024
    v_mfma_f32_16x16x32_bf16 v[32:35], a[48:51], a[16:19], v[32:35]
    v_mfma_f32_16x16x32_bf16 v[36:39], a[48:51], a[20:23], v[36:39]
    v_mfma_f32_16x16x32_bf16 v[40:43], a[52:55], a[20:23], v[40:43]
    v_mfma_f32_16x16x32_bf16 v[32:35], a[56:59], a[24:27], v[32:35]
    v_mfma_f32_16x16x32_bf16 v[36:39], a[56:59], a[28:31], v[36:39]
    v_mfma_f32_16x16x32_bf16 v[40:43], a[60:63], a[28:31], v[40:43]
    s_waitcnt vmcnt(7)
    s_cmp_lg_u32 s49, 0
    s_cselect_b64 exec, 1, 0
    buffer_store_dword v3, v4, s[8:11], s43 offen sc1
    s_mov_b64 exec, -1
    s_add_u32 s43, s43, s49
    s_mov_b32 s49, 0
    s_cmp_eq_u32 s62, 1
    s_cbranch_scc1 Lta1_km
    s_waitcnt vmcnt(6)
    v_cmp_eq_u32 vcc, 0, v2
    s_nop 0
    s_cbranch_vccz Lta1_r
    s_mov_b32 s16, 0
Lta1_rp:
    buffer_load_dword v2, v11, s[8:11], s42 offen sc1
    s_add_u32 s16, s16, 1
    s_cmp_gt_u32 s16, 100000
    s_cbranch_scc1 L_role_ta_abort
    s_waitcnt vmcnt(0)
    v_cmp_eq_u32 vcc, 0, v2
    s_nop 0
    s_cbranch_vccnz Lta1_rp
Lta1_r:
    buffer_load_dwordx4 a[120:123], v9, s[8:11], s47 offen offset:0
    buffer_load_dwordx4 a[124:127], v9, s[8:11], s47 offen offset:64
    buffer_load_dwordx4 a[128:131], v9, s[8:11], s47 offen offset:128
    buffer_load_dwordx4 a[132:135], v9, s[8:11], s47 offen offset:192
    buffer_load_dwordx2 a[136:137], v10, s[8:11], s47 offen offset:2048
    buffer_load_dwordx2 a[138:139], v10, s[8:11], s47 offen offset:2560
    buffer_load_dwordx2 a[140:141], v10, s[8:11], s47 offen offset:3072
    buffer_load_dwordx2 a[142:143], v10, s[8:11], s47 offen offset:3584
Lta1_km:
    s_add_u32 s42, s42, 22528
    s_add_u32 s47, s47, 131072
    v_fma_f32 v32, v32, s52, v236
    v_fma_f32 v33, v33, s52, v237
    v_fma_f32 v34, v34, s52, v238
    v_fma_f32 v35, v35, s52, v239
    buffer_load_dwordx4 v[164:167], v0, s[28:31], s46 offen offset:2048
    buffer_load_dwordx4 v[168:171], v0, s[28:31], s46 offen offset:3072
    v_mul_f32 v36, s52, v36
    v_mul_f32 v37, s52, v37
    v_mul_f32 v38, s52, v38
    v_mul_f32 v39, s52, v39
    s_add_u32 s46, s51, 16777216
    buffer_load_dwordx4 v[172:175], v0, s[28:31], s46 offen offset:0
    buffer_load_dwordx4 v[176:179], v0, s[28:31], s46 offen offset:1024
    v_fma_f32 v40, v40, s52, v236
    v_fma_f32 v41, v41, s52, v237
    v_fma_f32 v42, v42, s52, v238
    v_fma_f32 v43, v43, s52, v239
    buffer_load_dwordx4 v[180:183], v0, s[28:31], s46 offen offset:2048
    buffer_load_dwordx4 v[184:187], v0, s[28:31], s46 offen offset:3072
    s_waitcnt vmcnt(13)
    v_mfma_f32_16x16x32_bf16 v[44:47], a[120:123], a[0:3], 0
    v_mfma_f32_16x16x32_bf16 v[48:51], a[120:123], a[4:7], 0
    s_add_u32 s46, s51, 16781312
    buffer_load_dwordx4 v[188:191], v0, s[28:31], s46 offen offset:0
    s_waitcnt vmcnt(13)
    v_mfma_f32_16x16x32_bf16 v[44:47], a[124:127], a[8:11], v[44:47]
    v_mfma_f32_16x16x32_bf16 v[48:51], a[124:127], a[12:15], v[48:51]
    buffer_load_dwordx4 v[192:195], v0, s[28:31], s46 offen offset:1024
    s_waitcnt vmcnt(13)
    v_mfma_f32_16x16x32_bf16 v[44:47], a[128:131], a[16:19], v[44:47]
    v_mfma_f32_16x16x32_bf16 v[48:51], a[128:131], a[20:23], v[48:51]
    buffer_load_dwordx4 v[196:199], v0, s[28:31], s46 offen offset:2048
    s_waitcnt vmcnt(13)
    v_mfma_f32_16x16x32_bf16 v[44:47], a[132:135], a[24:27], v[44:47]
    v_mfma_f32_16x16x32_bf16 v[48:51], a[132:135], a[28:31], v[48:51]
    buffer_load_dwordx4 v[200:203], v0, s[28:31], s46 offen offset:3072
    v_max3_f32 v5, v32, v33, v34
    v_max_f32 v5, v5, v35
    s_nop 0
    v_mul_f32 v44, s52, v44
    v_mul_f32 v45, s52, v45
    v_max3_f32 v5, v5, v44, v45
    v_mov_b32 v6, v5
    s_add_u32 s46, s51, 33554432
    buffer_load_dwordx4 v[204:207], v0, s[28:31], s46 offen offset:0
    v_permlane32_swap_b32 v5, v6
    v_max_f32 v5, v5, v6
    v_mov_b32 v6, v5
    buffer_load_dwordx4 v[208:211], v0, s[28:31], s46 offen offset:1024
    s_nop 0
    v_permlane16_swap_b32 v5, v6
    v_max_f32 v5, v5, v6
    v_sub_f32 v32, v32, v5
    v_sub_f32 v33, v33, v5
    v_sub_f32 v34, v34, v5
    v_sub_f32 v35, v35, v5
    v_sub_f32 v44, v44, v5
    v_sub_f32 v45, v45, v5
    v_exp_f32 v32, v32
    v_exp_f32 v33, v33
    v_exp_f32 v34, v34
    v_exp_f32 v35, v35
    v_exp_f32 v44, v44
    v_exp_f32 v45, v45
    v_cvt_pk_bf16_f32 v24, v32, v33
    v_cvt_pk_bf16_f32 v25, v34, v35
    v_mov_b32 v26, 0
    v_mov_b32 v27, 0
    v_cvt_pk_bf16_f32 v20, v44, v45
    v_cvt_pk_bf16_f32 v23, v44, v45
    v_mfma_f32_16x16x32_bf16 v[28:31], v[16:19], v[24:27], 0
    v_mfma_f32_16x16x32_bf16 v[76:79], a[64:67], v[24:27], 0
    v_mfma_f32_16x16x32_bf16 v[80:83], a[68:71], v[24:27], 0
    s_add_u32 s17, s42, 22528
    buffer_load_dword v15, v1, s[8:11], s17 offen sc1
    v_mfma_f32_16x16x32_bf16 v[84:87], a[72:75], v[24:27], 0
    v_mfma_f32_16x16x32_bf16 v[88:91], a[76:79], v[24:27], 0
    buffer_load_dwordx4 v[212:215], v0, s[28:31], s46 offen offset:2048
    v_mfma_f32_16x16x32_bf16 v[92:95], a[80:83], v[24:27], 0
    v_mfma_f32_16x16x32_bf16 v[96:99], a[84:87], v[24:27], 0
    buffer_load_dwordx4 v[216:219], v0, s[28:31], s46 offen offset:3072
    v_mfma_f32_16x16x16_bf16 v[28:31], v[16:17], v[20:21], v[28:31]
    v_mfma_f32_16x16x32_bf16 v[100:103], a[88:91], v[24:27], 0
    v_mfma_f32_16x16x32_bf16 v[104:107], a[92:95], v[24:27], 0
    s_add_u32 s46, s51, 33558528
    buffer_load_dwordx4 v[220:223], v0, s[28:31], s46 offen offset:0
    s_waitcnt vmcnt(19)
    v_mfma_f32_16x16x16_bf16 v[76:79], a[136:137], v[20:21], v[76:79]
    v_mfma_f32_16x16x16_bf16 v[80:83], a[136:137], v[22:23], v[80:83]
    v_rcp_f32 v6, v28
    s_waitcnt vmcnt(18)
    v_mfma_f32_16x16x16_bf16 v[84:87], a[138:139], v[20:21], v[84:87]
    v_mfma_f32_16x16x16_bf16 v[88:91], a[138:139], v[22:23], v[88:91]
    v_mul_f32 v76, v6, v76
    v_mul_f32 v80, v6, v80
    v_cvt_pk_bf16_f32 v108, v76, v80
    v_mul_f32 v77, v6, v77
    v_mul_f32 v81, v6, v81
    v_cvt_pk_bf16_f32 v109, v77, v81
    v_mul_f32 v78, v6, v78
    v_mul_f32 v82, v6, v82
    v_cvt_pk_bf16_f32 v110, v78, v82
    v_mul_f32 v79, v6, v79
    v_mul_f32 v83, v6, v83
    v_cvt_pk_bf16_f32 v111, v79, v83
    s_add_u32 s17, s48, 0
    buffer_store_dwordx4 v[108:111], v0, s[8:11], s17 offen offset:0 sc1
    buffer_load_dwordx4 v[224:227], v0, s[28:31], s46 offen offset:1024
    s_waitcnt vmcnt(19)
    v_mfma_f32_16x16x16_bf16 v[92:95], a[140:141], v[20:21], v[92:95]
    v_mfma_f32_16x16x16_bf16 v[96:99], a[140:141], v[22:23], v[96:99]
    v_mul_f32 v84, v6, v84
    v_mul_f32 v88, v6, v88
    v_cvt_pk_bf16_f32 v112, v84, v88
    v_mul_f32 v85, v6, v85
    v_mul_f32 v89, v6, v89
    v_cvt_pk_bf16_f32 v113, v85, v89
    v_mul_f32 v86, v6, v86
    v_mul_f32 v90, v6, v90
    v_cvt_pk_bf16_f32 v114, v86, v90
    v_mul_f32 v87, v6, v87
    v_mul_f32 v91, v6, v91
    v_cvt_pk_bf16_f32 v115, v87, v91
    buffer_store_dwordx4 v[112:115], v0, s[8:11], s17 offen offset:2048 sc1
    buffer_load_dwordx4 v[228:231], v0, s[28:31], s46 offen offset:2048
    s_waitcnt vmcnt(20)
    v_mfma_f32_16x16x16_bf16 v[100:103], a[142:143], v[20:21], v[100:103]
    v_mfma_f32_16x16x16_bf16 v[104:107], a[142:143], v[22:23], v[104:107]
    v_mul_f32 v92, v6, v92
    v_mul_f32 v96, v6, v96
    v_cvt_pk_bf16_f32 v116, v92, v96
    v_mul_f32 v93, v6, v93
    v_mul_f32 v97, v6, v97
    v_cvt_pk_bf16_f32 v117, v93, v97
    v_mul_f32 v94, v6, v94
    v_mul_f32 v98, v6, v98
    v_cvt_pk_bf16_f32 v118, v94, v98
    v_mul_f32 v95, v6, v95
    v_mul_f32 v99, v6, v99
    v_cvt_pk_bf16_f32 v119, v95, v99
    s_add_u32 s17, s48, 4096
    buffer_store_dwordx4 v[116:119], v0, s[8:11], s17 offen offset:0 sc1
    buffer_load_dwordx4 v[232:235], v0, s[28:31], s46 offen offset:3072
    v_mul_f32 v100, v6, v100
    v_mul_f32 v104, v6, v104
    v_cvt_pk_bf16_f32 v120, v100, v104
    v_mul_f32 v101, v6, v101
    v_mul_f32 v105, v6, v105
    v_cvt_pk_bf16_f32 v121, v101, v105
    v_mul_f32 v102, v6, v102
    v_mul_f32 v106, v6, v106
    v_cvt_pk_bf16_f32 v122, v102, v106
    v_mul_f32 v103, v6, v103
    v_mul_f32 v107, v6, v107
    v_cvt_pk_bf16_f32 v123, v103, v107
    buffer_store_dwordx4 v[120:123], v0, s[8:11], s17 offen offset:2048 sc1
    buffer_load_dwordx4 a[96:99], v9, s[20:23], s47 offen offset:0
    v_max3_f32 v5, v36, v37, v38
    v_max_f32 v5, v5, v39
    v_max3_f32 v5, v5, v40, v41
    v_max3_f32 v5, v5, v42, v43
    v_mul_f32 v48, s52, v48
    v_mul_f32 v49, s52, v49
    v_max3_f32 v5, v5, v48, v49
    v_mov_b32 v6, v5
    buffer_load_dwordx4 a[100:103], v9, s[20:23], s47 offen offset:64
    s_nop 0
    v_permlane32_swap_b32 v5, v6
    v_max_f32 v5, v5, v6
    v_mov_b32 v6, v5
    buffer_load_dwordx4 a[104:107], v9, s[20:23], s47 offen offset:128
    s_nop 0
    v_permlane16_swap_b32 v5, v6
    v_max_f32 v5, v5, v6
    v_sub_f32 v36, v36, v5
    v_sub_f32 v37, v37, v5
    v_sub_f32 v38, v38, v5
    v_sub_f32 v39, v39, v5
    v_sub_f32 v40, v40, v5
    v_sub_f32 v41, v41, v5
    v_sub_f32 v42, v42, v5
    v_sub_f32 v43, v43, v5
    v_sub_f32 v48, v48, v5
    v_sub_f32 v49, v49, v5
    v_exp_f32 v36, v36
    v_exp_f32 v37, v37
    v_exp_f32 v38, v38
    v_exp_f32 v39, v39
    v_exp_f32 v40, v40
    v_exp_f32 v41, v41
    v_exp_f32 v42, v42
    v_exp_f32 v43, v43
    v_exp_f32 v48, v48
    v_exp_f32 v49, v49
    v_cvt_pk_bf16_f32 v24, v36, v37
    v_cvt_pk_bf16_f32 v25, v38, v39
    v_cvt_pk_bf16_f32 v26, v40, v41
    v_cvt_pk_bf16_f32 v27, v42, v43
    v_cvt_pk_bf16_f32 v20, v48, v49
    v_cvt_pk_bf16_f32 v23, v48, v49
    v_mfma_f32_16x16x32_bf16 v[28:31], v[16:19], v[24:27], 0
    v_mfma_f32_16x16x32_bf16 v[76:79], a[64:67], v[24:27], 0
    v_mfma_f32_16x16x32_bf16 v[80:83], a[68:71], v[24:27], 0
    buffer_load_dwordx4 a[108:111], v9, s[20:23], s47 offen offset:192
    v_mfma_f32_16x16x32_bf16 v[84:87], a[72:75], v[24:27], 0
    v_mfma_f32_16x16x32_bf16 v[88:91], a[76:79], v[24:27], 0
    buffer_load_dwordx2 a[112:113], v10, s[20:23], s47 offen offset:2048
    v_mfma_f32_16x16x32_bf16 v[92:95], a[80:83], v[24:27], 0
    v_mfma_f32_16x16x32_bf16 v[96:99], a[84:87], v[24:27], 0
    buffer_load_dwordx2 a[114:115], v10, s[20:23], s47 offen offset:2560
    v_mfma_f32_16x16x16_bf16 v[28:31], v[16:17], v[20:21], v[28:31]
    v_mfma_f32_16x16x32_bf16 v[100:103], a[88:91], v[24:27], 0
    v_mfma_f32_16x16x32_bf16 v[104:107], a[92:95], v[24:27], 0
    buffer_load_dwordx2 a[116:117], v10, s[20:23], s47 offen offset:3072
    buffer_load_dwordx2 a[118:119], v10, s[20:23], s47 offen offset:3584
    v_mfma_f32_16x16x16_bf16 v[76:79], a[136:137], v[20:21], v[76:79]
    v_mfma_f32_16x16x16_bf16 v[80:83], a[136:137], v[22:23], v[80:83]
    v_rcp_f32 v6, v28
    v_mfma_f32_16x16x16_bf16 v[84:87], a[138:139], v[20:21], v[84:87]
    v_mfma_f32_16x16x16_bf16 v[88:91], a[138:139], v[22:23], v[88:91]
    v_mul_f32 v76, v6, v76
    v_mul_f32 v80, v6, v80
    v_cvt_pk_bf16_f32 v124, v76, v80
    v_mul_f32 v77, v6, v77
    v_mul_f32 v81, v6, v81
    v_cvt_pk_bf16_f32 v125, v77, v81
    v_mul_f32 v78, v6, v78
    v_mul_f32 v82, v6, v82
    v_cvt_pk_bf16_f32 v126, v78, v82
    v_mul_f32 v79, v6, v79
    v_mul_f32 v83, v6, v83
    v_cvt_pk_bf16_f32 v127, v79, v83
    s_add_u32 s17, s48, 0
    buffer_store_dwordx4 v[124:127], v0, s[8:11], s17 offen offset:1024 sc1
    v_mfma_f32_16x16x16_bf16 v[92:95], a[140:141], v[20:21], v[92:95]
    v_mfma_f32_16x16x16_bf16 v[96:99], a[140:141], v[22:23], v[96:99]
    v_mul_f32 v84, v6, v84
    v_mul_f32 v88, v6, v88
    v_cvt_pk_bf16_f32 v128, v84, v88
    v_mul_f32 v85, v6, v85
    v_mul_f32 v89, v6, v89
    v_cvt_pk_bf16_f32 v129, v85, v89
    v_mul_f32 v86, v6, v86
    v_mul_f32 v90, v6, v90
    v_cvt_pk_bf16_f32 v130, v86, v90
    v_mul_f32 v87, v6, v87
    v_mul_f32 v91, v6, v91
    v_cvt_pk_bf16_f32 v131, v87, v91
    buffer_store_dwordx4 v[128:131], v0, s[8:11], s17 offen offset:3072 sc1
    v_mfma_f32_16x16x16_bf16 v[100:103], a[142:143], v[20:21], v[100:103]
    v_mfma_f32_16x16x16_bf16 v[104:107], a[142:143], v[22:23], v[104:107]
    v_mul_f32 v92, v6, v92
    v_mul_f32 v96, v6, v96
    v_cvt_pk_bf16_f32 v132, v92, v96
    v_mul_f32 v93, v6, v93
    v_mul_f32 v97, v6, v97
    v_cvt_pk_bf16_f32 v133, v93, v97
    v_mul_f32 v94, v6, v94
    v_mul_f32 v98, v6, v98
    v_cvt_pk_bf16_f32 v134, v94, v98
    v_mul_f32 v95, v6, v95
    v_mul_f32 v99, v6, v99
    v_cvt_pk_bf16_f32 v135, v95, v99
    s_add_u32 s17, s48, 4096
    buffer_store_dwordx4 v[132:135], v0, s[8:11], s17 offen offset:1024 sc1
    v_mul_f32 v100, v6, v100
    v_mul_f32 v104, v6, v104
    v_cvt_pk_bf16_f32 v136, v100, v104
    v_mul_f32 v101, v6, v101
    v_mul_f32 v105, v6, v105
    v_cvt_pk_bf16_f32 v137, v101, v105
    v_mul_f32 v102, v6, v102
    v_mul_f32 v106, v6, v106
    v_cvt_pk_bf16_f32 v138, v102, v106
    v_mul_f32 v103, v6, v103
    v_mul_f32 v107, v6, v107
    v_cvt_pk_bf16_f32 v139, v103, v107
    buffer_store_dwordx4 v[136:139], v0, s[8:11], s17 offen offset:3072 sc1
    s_add_u32 s48, s48, 262144
    s_mov_b32 s49, 22528
    s_cmp_ge_u32 s37, 64
    s_cbranch_scc1 Lta_end
    s_branch Lta0
Lta_end:
    s_waitcnt vmcnt(0)
    s_mov_b64 exec, 1
    buffer_store_dword v3, v4, s[8:11], s43 offen sc1
    s_mov_b64 exec, -1
    s_branch L_role_ta_exit
L_role_ta_abort:
    s_waitcnt lgkmcnt(0)
    s_mov_b64 exec, -1
    v_mov_b32 v0, 60
    s_lshl_b32 s5, s3, 8
    s_or_b32 s5, s5, s4
    s_or_b32 s5, s5, 0x10000
    v_mov_b32 v1, s5
    global_store_dword v0, v1, s[12:13]
    s_endpgm
L_role_ta_exit:
    s_endpgm
.p2align 6
L_role_tw:
    v_and_b32 v5, 63, v0
    v_lshlrev_b32 v0, 4, v5
    v_and_b32 v7, 15, v5
    v_lshrrev_b32 v8, 4, v5
    v_min_u32 v1, 31, v5
    v_lshrrev_b32 v6, 2, v1
    v_and_b32 v1, 3, v1
    v_lshlrev_b32 v1, 2, v1
    v_lshl_add_u32 v1, v6, 7, v1
    v_mov_b32 v3, 1
    v_mov_b32 v4, 0
    s_mov_b32 s44, 0x05040100
    s_mov_b32 s45, 0x07060302
    s_cmp_lg_u32 s14, 0
    s_cbranch_scc1 Ltw_gate_d
    v_mov_b32 v5, 48
    s_mov_b32 s16, 0
Ltw_gate:
    global_load_dword v6, v5, s[12:13] sc1
    s_add_u32 s16, s16, 1
    s_cmp_gt_u32 s16, 100000
    s_cbranch_scc1 L_role_tw_abort
    s_waitcnt vmcnt(0)
    v_cmp_gt_u32 vcc, 32, v6
    s_nop 0
    s_cbranch_vccz Ltw_gate_d
    s_sleep 100
    s_branch Ltw_gate
Ltw_gate_d:
    s_barrier
    s_load_dwordx2 s[20:21], s[0:1], 64
    s_mov_b32 s22, 4718592
    s_mov_b32 s23, 0x00020000
    s_waitcnt lgkmcnt(0)
    s_and_b32 s21, s21, 0xffff
    s_load_dwordx2 s[24:25], s[0:1], 80
    s_mov_b32 s26, 2359296
    s_mov_b32 s27, 0x00020000
    s_waitcnt lgkmcnt(0)
    s_and_b32 s25, s25, 0xffff
    s_mul_i32 s17, s15, 43
    s_lshr_b32 s32, s17, 9
    s_mul_i32 s17, s32, 12
    s_sub_u32 s50, s15, s17
    s_add_u32 s33, s32, 30
    s_cmp_eq_u32 s32, 2
    s_cselect_b32 s33, 0, s33
    s_cselect_b32 s32, 64, s32
    s_mul_i32 s49, s50, 96
    s_mul_i32 s17, s14, 1179648
    s_add_u32 s49, s49, s17
    v_mul_u32_u24 v5, 4608, v8
    v_lshl_add_u32 v9, v7, 2, v5
    v_add_u32 v10, 18432, v9
    v_and_b32 v6, 14, v7
    v_lshl_add_u32 v12, v6, 1, v5
    v_add_u32 v12, 64, v12
    v_add_u32 v13, 18432, v12
    v_and_b32 v5, 1, v7
    v_mov_b32 v11, s44
    v_mov_b32 v6, s45
    v_cmp_eq_u32 vcc, 1, v5
    s_nop 1
    v_cndmask_b32 v11, v11, v6, vcc
    s_add_u32 s17, s49, 0
    buffer_load_dword v16, v9, s[20:23], s17 offen
    buffer_load_dword v17, v10, s[20:23], s17 offen
    buffer_load_dword v18, v12, s[20:23], s17 offen
    buffer_load_dword v19, v13, s[20:23], s17 offen
    s_add_u32 s17, s49, 1152
    buffer_load_dword v20, v9, s[20:23], s17 offen
    buffer_load_dword v21, v10, s[20:23], s17 offen
    buffer_load_dword v22, v12, s[20:23], s17 offen
    buffer_load_dword v23, v13, s[20:23], s17 offen
    s_add_u32 s17, s49, 2304
    buffer_load_dword v24, v9, s[20:23], s17 offen
    buffer_load_dword v25, v10, s[20:23], s17 offen
    buffer_load_dword v26, v12, s[20:23], s17 offen
    buffer_load_dword v27, v13, s[20:23], s17 offen
    s_add_u32 s17, s49, 3456
    buffer_load_dword v28, v9, s[20:23], s17 offen
    buffer_load_dword v29, v10, s[20:23], s17 offen
    buffer_load_dword v30, v12, s[20:23], s17 offen
    buffer_load_dword v31, v13, s[20:23], s17 offen
    s_add_u32 s17, s49, 36864
    buffer_load_dword v32, v9, s[20:23], s17 offen
    buffer_load_dword v33, v10, s[20:23], s17 offen
    buffer_load_dword v34, v12, s[20:23], s17 offen
    buffer_load_dword v35, v13, s[20:23], s17 offen
    s_add_u32 s17, s49, 38016
    buffer_load_dword v36, v9, s[20:23], s17 offen
    buffer_load_dword v37, v10, s[20:23], s17 offen
    buffer_load_dword v38, v12, s[20:23], s17 offen
    buffer_load_dword v39, v13, s[20:23], s17 offen
    s_add_u32 s17, s49, 39168
    buffer_load_dword v40, v9, s[20:23], s17 offen
    buffer_load_dword v41, v10, s[20:23], s17 offen
    buffer_load_dword v42, v12, s[20:23], s17 offen
    buffer_load_dword v43, v13, s[20:23], s17 offen
    s_add_u32 s17, s49, 40320
    buffer_load_dword v44, v9, s[20:23], s17 offen
    buffer_load_dword v45, v10, s[20:23], s17 offen
    buffer_load_dword v46, v12, s[20:23], s17 offen
    buffer_load_dword v47, v13, s[20:23], s17 offen
    s_add_u32 s17, s49, 73728
    buffer_load_dword v48, v9, s[20:23], s17 offen
    buffer_load_dword v49, v10, s[20:23], s17 offen
    buffer_load_dword v50, v12, s[20:23], s17 offen
    buffer_load_dword v51, v13, s[20:23], s17 offen
    s_add_u32 s17, s49, 74880
    buffer_load_dword v52, v9, s[20:23], s17 offen
    buffer_load_dword v53, v10, s[20:23], s17 offen
    buffer_load_dword v54, v12, s[20:23], s17 offen
    buffer_load_dword v55, v13, s[20:23], s17 offen
    s_add_u32 s17, s49, 76032
    buffer_load_dword v56, v9, s[20:23], s17 offen
    buffer_load_dword v57, v10, s[20:23], s17 offen
    buffer_load_dword v58, v12, s[20:23], s17 offen
    buffer_load_dword v59, v13, s[20:23], s17 offen
    s_add_u32 s17, s49, 77184
    buffer_load_dword v60, v9, s[20:23], s17 offen
    buffer_load_dword v61, v10, s[20:23], s17 offen
    buffer_load_dword v62, v12, s[20:23], s17 offen
    buffer_load_dword v63, v13, s[20:23], s17 offen
    s_add_u32 s17, s49, 110592
    buffer_load_dword v64, v9, s[20:23], s17 offen
    buffer_load_dword v65, v10, s[20:23], s17 offen
    buffer_load_dword v66, v12, s[20:23], s17 offen
    buffer_load_dword v67, v13, s[20:23], s17 offen
    s_add_u32 s17, s49, 111744
    buffer_load_dword v68, v9, s[20:23], s17 offen
    buffer_load_dword v69, v10, s[20:23], s17 offen
    buffer_load_dword v70, v12, s[20:23], s17 offen
    buffer_load_dword v71, v13, s[20:23], s17 offen
    s_add_u32 s17, s49, 112896
    buffer_load_dword v72, v9, s[20:23], s17 offen
    buffer_load_dword v73, v10, s[20:23], s17 offen
    buffer_load_dword v74, v12, s[20:23], s17 offen
    buffer_load_dword v75, v13, s[20:23], s17 offen
    s_waitcnt vmcnt(58)
    v_perm_b32 v5, v17, v16, s44
    v_perm_b32 v6, v17, v16, s45
    s_waitcnt vmcnt(56)
    v_perm_b32 v128, v19, v18, v11
    v_accvgpr_write_b32 a0, v5
    v_accvgpr_write_b32 a4, v6
    s_add_u32 s17, s49, 114048
    buffer_load_dword v76, v9, s[20:23], s17 offen
    buffer_load_dword v77, v10, s[20:23], s17 offen
    buffer_load_dword v78, v12, s[20:23], s17 offen
    buffer_load_dword v79, v13, s[20:23], s17 offen
    s_waitcnt vmcnt(58)
    v_perm_b32 v5, v21, v20, s44
    v_perm_b32 v6, v21, v20, s45
    s_waitcnt vmcnt(56)
    v_perm_b32 v129, v23, v22, v11
    v_accvgpr_write_b32 a1, v5
    v_accvgpr_write_b32 a5, v6
    s_add_u32 s17, s49, 147456
    buffer_load_dword v80, v9, s[20:23], s17 offen
    buffer_load_dword v81, v10, s[20:23], s17 offen
    buffer_load_dword v82, v12, s[20:23], s17 offen
    buffer_load_dword v83, v13, s[20:23], s17 offen
    s_waitcnt vmcnt(58)
    v_perm_b32 v5, v25, v24, s44
    v_perm_b32 v6, v25, v24, s45
    s_waitcnt vmcnt(56)
    v_perm_b32 v130, v27, v26, v11
    v_accvgpr_write_b32 a2, v5
    v_accvgpr_write_b32 a6, v6
    s_add_u32 s17, s49, 148608
    buffer_load_dword v84, v9, s[20:23], s17 offen
    buffer_load_dword v85, v10, s[20:23], s17 offen
    buffer_load_dword v86, v12, s[20:23], s17 offen
    buffer_load_dword v87, v13, s[20:23], s17 offen
    s_waitcnt vmcnt(58)
    v_perm_b32 v5, v29, v28, s44
    v_perm_b32 v6, v29, v28, s45
    s_waitcnt vmcnt(56)
    v_perm_b32 v131, v31, v30, v11
    v_accvgpr_write_b32 a3, v5
    v_accvgpr_write_b32 a7, v6
    s_add_u32 s17, s49, 149760
    buffer_load_dword v88, v9, s[20:23], s17 offen
    buffer_load_dword v89, v10, s[20:23], s17 offen
    buffer_load_dword v90, v12, s[20:23], s17 offen
    buffer_load_dword v91, v13, s[20:23], s17 offen
    s_waitcnt vmcnt(58)
    v_perm_b32 v5, v33, v32, s44
    v_perm_b32 v6, v33, v32, s45
    s_waitcnt vmcnt(56)
    v_perm_b32 v132, v35, v34, v11
    v_accvgpr_write_b32 a8, v5
    v_accvgpr_write_b32 a12, v6
    s_add_u32 s17, s49, 150912
    buffer_load_dword v92, v9, s[20:23], s17 offen
    buffer_load_dword v93, v10, s[20:23], s17 offen
    buffer_load_dword v94, v12, s[20:23], s17 offen
    buffer_load_dword v95, v13, s[20:23], s17 offen
    s_waitcnt vmcnt(58)
    v_perm_b32 v5, v37, v36, s44
    v_perm_b32 v6, v37, v36, s45
    s_waitcnt vmcnt(56)
    v_perm_b32 v133, v39, v38, v11
    v_accvgpr_write_b32 a9, v5
    v_accvgpr_write_b32 a13, v6
    s_add_u32 s17, s49, 184320
    buffer_load_dword v96, v9, s[20:23], s17 offen
    buffer_load_dword v97, v10, s[20:23], s17 offen
    buffer_load_dword v98, v12, s[20:23], s17 offen
    buffer_load_dword v99, v13, s[20:23], s17 offen
    s_waitcnt vmcnt(58)
    v_perm_b32 v5, v41, v40, s44
    v_perm_b32 v6, v41, v40, s45
    s_waitcnt vmcnt(56)
    v_perm_b32 v134, v43, v42, v11
    v_accvgpr_write_b32 a10, v5
    v_accvgpr_write_b32 a14, v6
    s_add_u32 s17, s49, 185472
    buffer_load_dword v100, v9, s[20:23], s17 offen
    buffer_load_dword v101, v10, s[20:23], s17 offen
    buffer_load_dword v102, v12, s[20:23], s17 offen
    buffer_load_dword v103, v13, s[20:23], s17 offen
    s_waitcnt vmcnt(58)
    v_perm_b32 v5, v45, v44, s44
    v_perm_b32 v6, v45, v44, s45
    s_waitcnt vmcnt(56)
    v_perm_b32 v135, v47, v46, v11
    v_accvgpr_write_b32 a11, v5
    v_accvgpr_write_b32 a15, v6
    s_add_u32 s17, s49, 186624
    buffer_load_dword v104, v9, s[20:23], s17 offen
    buffer_load_dword v105, v10, s[20:23], s17 offen
    buffer_load_dword v106, v12, s[20:23], s17 offen
    buffer_load_dword v107, v13, s[20:23], s17 offen
    s_waitcnt vmcnt(58)
    v_perm_b32 v5, v49, v48, s44
    v_perm_b32 v6, v49, v48, s45
    s_waitcnt vmcnt(56)
    v_perm_b32 v136, v51, v50, v11
    v_accvgpr_write_b32 a16, v5
    v_accvgpr_write_b32 a20, v6
    s_add_u32 s17, s49, 187776
    buffer_load_dword v108, v9, s[20:23], s17 offen
    buffer_load_dword v109, v10, s[20:23], s17 offen
    buffer_load_dword v110, v12, s[20:23], s17 offen
    buffer_load_dword v111, v13, s[20:23], s17 offen
    s_waitcnt vmcnt(58)
    v_perm_b32 v5, v53, v52, s44
    v_perm_b32 v6, v53, v52, s45
    s_waitcnt vmcnt(56)
    v_perm_b32 v137, v55, v54, v11
    v_accvgpr_write_b32 a17, v5
    v_accvgpr_write_b32 a21, v6
    s_add_u32 s17, s49, 221184
    buffer_load_dword v112, v9, s[20:23], s17 offen
    buffer_load_dword v113, v10, s[20:23], s17 offen
    buffer_load_dword v114, v12, s[20:23], s17 offen
    buffer_load_dword v115, v13, s[20:23], s17 offen
    s_waitcnt vmcnt(58)
    v_perm_b32 v5, v57, v56, s44
    v_perm_b32 v6, v57, v56, s45
    s_waitcnt vmcnt(56)
    v_perm_b32 v138, v59, v58, v11
    v_accvgpr_write_b32 a18, v5
    v_accvgpr_write_b32 a22, v6
    s_add_u32 s17, s49, 222336
    buffer_load_dword v116, v9, s[20:23], s17 offen
    buffer_load_dword v117, v10, s[20:23], s17 offen
    buffer_load_dword v118, v12, s[20:23], s17 offen
    buffer_load_dword v119, v13, s[20:23], s17 offen
    s_waitcnt vmcnt(58)
    v_perm_b32 v5, v61, v60, s44
    v_perm_b32 v6, v61, v60, s45
    s_waitcnt vmcnt(56)
    v_perm_b32 v139, v63, v62, v11
    v_accvgpr_write_b32 a19, v5
    v_accvgpr_write_b32 a23, v6
    s_add_u32 s17, s49, 223488
    buffer_load_dword v120, v9, s[20:23], s17 offen
    buffer_load_dword v121, v10, s[20:23], s17 offen
    buffer_load_dword v122, v12, s[20:23], s17 offen
    buffer_load_dword v123, v13, s[20:23], s17 offen
    s_waitcnt vmcnt(58)
    v_perm_b32 v5, v65, v64, s44
    v_perm_b32 v6, v65, v64, s45
    s_waitcnt vmcnt(56)
    v_perm_b32 v140, v67, v66, v11
    v_accvgpr_write_b32 a24, v5
    v_accvgpr_write_b32 a28, v6
    s_add_u32 s17, s49, 224640
    buffer_load_dword v124, v9, s[20:23], s17 offen
    buffer_load_dword v125, v10, s[20:23], s17 offen
    buffer_load_dword v126, v12, s[20:23], s17 offen
    buffer_load_dword v127, v13, s[20:23], s17 offen
    s_waitcnt vmcnt(58)
    v_perm_b32 v5, v69, v68, s44
    v_perm_b32 v6, v69, v68, s45
    s_waitcnt vmcnt(56)
    v_perm_b32 v141, v71, v70, v11
    v_accvgpr_write_b32 a25, v5
    v_accvgpr_write_b32 a29, v6
    s_add_u32 s17, s49, 258048
    buffer_load_dword v16, v9, s[20:23], s17 offen
    buffer_load_dword v17, v10, s[20:23], s17 offen
    buffer_load_dword v18, v12, s[20:23], s17 offen
    buffer_load_dword v19, v13, s[20:23], s17 offen
    s_waitcnt vmcnt(58)
    v_perm_b32 v5, v73, v72, s44
    v_perm_b32 v6, v73, v72, s45
    s_waitcnt vmcnt(56)
    v_perm_b32 v142, v75, v74, v11
    v_accvgpr_write_b32 a26, v5
    v_accvgpr_write_b32 a30, v6
    s_add_u32 s17, s49, 259200
    buffer_load_dword v20, v9, s[20:23], s17 offen
    buffer_load_dword v21, v10, s[20:23], s17 offen
    buffer_load_dword v22, v12, s[20:23], s17 offen
    buffer_load_dword v23, v13, s[20:23], s17 offen
    s_waitcnt vmcnt(58)
    v_perm_b32 v5, v77, v76, s44
    v_perm_b32 v6, v77, v76, s45
    s_waitcnt vmcnt(56)
    v_perm_b32 v143, v79, v78, v11
    v_accvgpr_write_b32 a27, v5
    v_accvgpr_write_b32 a31, v6
    s_add_u32 s17, s49, 260352
    buffer_load_dword v24, v9, s[20:23], s17 offen
    buffer_load_dword v25, v10, s[20:23], s17 offen
    buffer_load_dword v26, v12, s[20:23], s17 offen
    buffer_load_dword v27, v13, s[20:23], s17 offen
    s_waitcnt vmcnt(58)
    v_perm_b32 v5, v81, v80, s44
    v_perm_b32 v6, v81, v80, s45
    s_waitcnt vmcnt(56)
    v_perm_b32 v144, v83, v82, v11
    v_accvgpr_write_b32 a32, v5
    v_accvgpr_write_b32 a36, v6
    s_add_u32 s17, s49, 261504
    buffer_load_dword v28, v9, s[20:23], s17 offen
    buffer_load_dword v29, v10, s[20:23], s17 offen
    buffer_load_dword v30, v12, s[20:23], s17 offen
    buffer_load_dword v31, v13, s[20:23], s17 offen
    s_waitcnt vmcnt(58)
    v_perm_b32 v5, v85, v84, s44
    v_perm_b32 v6, v85, v84, s45
    s_waitcnt vmcnt(56)
    v_perm_b32 v145, v87, v86, v11
    v_accvgpr_write_b32 a33, v5
    v_accvgpr_write_b32 a37, v6
    s_add_u32 s17, s49, 294912
    buffer_load_dword v32, v9, s[20:23], s17 offen
    buffer_load_dword v33, v10, s[20:23], s17 offen
    buffer_load_dword v34, v12, s[20:23], s17 offen
    buffer_load_dword v35, v13, s[20:23], s17 offen
    s_waitcnt vmcnt(58)
    v_perm_b32 v5, v89, v88, s44
    v_perm_b32 v6, v89, v88, s45
    s_waitcnt vmcnt(56)
    v_perm_b32 v146, v91, v90, v11
    v_accvgpr_write_b32 a34, v5
    v_accvgpr_write_b32 a38, v6
    s_add_u32 s17, s49, 296064
    buffer_load_dword v36, v9, s[20:23], s17 offen
    buffer_load_dword v37, v10, s[20:23], s17 offen
    buffer_load_dword v38, v12, s[20:23], s17 offen
    buffer_load_dword v39, v13, s[20:23], s17 offen
    s_waitcnt vmcnt(58)
    v_perm_b32 v5, v93, v92, s44
    v_perm_b32 v6, v93, v92, s45
    s_waitcnt vmcnt(56)
    v_perm_b32 v147, v95, v94, v11
    v_accvgpr_write_b32 a35, v5
    v_accvgpr_write_b32 a39, v6
    s_add_u32 s17, s49, 297216
    buffer_load_dword v40, v9, s[20:23], s17 offen
    buffer_load_dword v41, v10, s[20:23], s17 offen
    buffer_load_dword v42, v12, s[20:23], s17 offen
    buffer_load_dword v43, v13, s[20:23], s17 offen
    s_waitcnt vmcnt(58)
    v_perm_b32 v5, v97, v96, s44
    v_perm_b32 v6, v97, v96, s45
    s_waitcnt vmcnt(56)
    v_perm_b32 v148, v99, v98, v11
    v_accvgpr_write_b32 a40, v5
    v_accvgpr_write_b32 a44, v6
    s_add_u32 s17, s49, 298368
    buffer_load_dword v44, v9, s[20:23], s17 offen
    buffer_load_dword v45, v10, s[20:23], s17 offen
    buffer_load_dword v46, v12, s[20:23], s17 offen
    buffer_load_dword v47, v13, s[20:23], s17 offen
    s_waitcnt vmcnt(58)
    v_perm_b32 v5, v101, v100, s44
    v_perm_b32 v6, v101, v100, s45
    s_waitcnt vmcnt(56)
    v_perm_b32 v149, v103, v102, v11
    v_accvgpr_write_b32 a41, v5
    v_accvgpr_write_b32 a45, v6
    s_add_u32 s17, s49, 331776
    buffer_load_dword v48, v9, s[20:23], s17 offen
    buffer_load_dword v49, v10, s[20:23], s17 offen
    buffer_load_dword v50, v12, s[20:23], s17 offen
    buffer_load_dword v51, v13, s[20:23], s17 offen
    s_waitcnt vmcnt(58)
    v_perm_b32 v5, v105, v104, s44
    v_perm_b32 v6, v105, v104, s45
    s_waitcnt vmcnt(56)
    v_perm_b32 v150, v107, v106, v11
    v_accvgpr_write_b32 a42, v5
    v_accvgpr_write_b32 a46, v6
    s_add_u32 s17, s49, 332928
    buffer_load_dword v52, v9, s[20:23], s17 offen
    buffer_load_dword v53, v10, s[20:23], s17 offen
    buffer_load_dword v54, v12, s[20:23], s17 offen
    buffer_load_dword v55, v13, s[20:23], s17 offen
    s_waitcnt vmcnt(58)
    v_perm_b32 v5, v109, v108, s44
    v_perm_b32 v6, v109, v108, s45
    s_waitcnt vmcnt(56)
    v_perm_b32 v151, v111, v110, v11
    v_accvgpr_write_b32 a43, v5
    v_accvgpr_write_b32 a47, v6
    s_add_u32 s17, s49, 334080
    buffer_load_dword v56, v9, s[20:23], s17 offen
    buffer_load_dword v57, v10, s[20:23], s17 offen
    buffer_load_dword v58, v12, s[20:23], s17 offen
    buffer_load_dword v59, v13, s[20:23], s17 offen
    s_waitcnt vmcnt(58)
    v_perm_b32 v5, v113, v112, s44
    v_perm_b32 v6, v113, v112, s45
    s_waitcnt vmcnt(56)
    v_perm_b32 v152, v115, v114, v11
    v_accvgpr_write_b32 a48, v5
    v_accvgpr_write_b32 a52, v6
    s_add_u32 s17, s49, 335232
    buffer_load_dword v60, v9, s[20:23], s17 offen
    buffer_load_dword v61, v10, s[20:23], s17 offen
    buffer_load_dword v62, v12, s[20:23], s17 offen
    buffer_load_dword v63, v13, s[20:23], s17 offen
    s_waitcnt vmcnt(58)
    v_perm_b32 v5, v117, v116, s44
    v_perm_b32 v6, v117, v116, s45
    s_waitcnt vmcnt(56)
    v_perm_b32 v153, v119, v118, v11
    v_accvgpr_write_b32 a49, v5
    v_accvgpr_write_b32 a53, v6
    s_add_u32 s17, s49, 368640
    buffer_load_dword v64, v9, s[20:23], s17 offen
    buffer_load_dword v65, v10, s[20:23], s17 offen
    buffer_load_dword v66, v12, s[20:23], s17 offen
    buffer_load_dword v67, v13, s[20:23], s17 offen
    s_waitcnt vmcnt(58)
    v_perm_b32 v5, v121, v120, s44
    v_perm_b32 v6, v121, v120, s45
    s_waitcnt vmcnt(56)
    v_perm_b32 v154, v123, v122, v11
    v_accvgpr_write_b32 a50, v5
    v_accvgpr_write_b32 a54, v6
    s_add_u32 s17, s49, 369792
    buffer_load_dword v68, v9, s[20:23], s17 offen
    buffer_load_dword v69, v10, s[20:23], s17 offen
    buffer_load_dword v70, v12, s[20:23], s17 offen
    buffer_load_dword v71, v13, s[20:23], s17 offen
    s_waitcnt vmcnt(58)
    v_perm_b32 v5, v125, v124, s44
    v_perm_b32 v6, v125, v124, s45
    s_waitcnt vmcnt(56)
    v_perm_b32 v155, v127, v126, v11
    v_accvgpr_write_b32 a51, v5
    v_accvgpr_write_b32 a55, v6
    s_add_u32 s17, s49, 370944
    buffer_load_dword v72, v9, s[20:23], s17 offen
    buffer_load_dword v73, v10, s[20:23], s17 offen
    buffer_load_dword v74, v12, s[20:23], s17 offen
    buffer_load_dword v75, v13, s[20:23], s17 offen
    s_waitcnt vmcnt(58)
    v_perm_b32 v5, v17, v16, s44
    v_perm_b32 v6, v17, v16, s45
    s_waitcnt vmcnt(56)
    v_perm_b32 v156, v19, v18, v11
    v_accvgpr_write_b32 a56, v5
    v_accvgpr_write_b32 a60, v6
    s_add_u32 s17, s49, 372096
    buffer_load_dword v76, v9, s[20:23], s17 offen
    buffer_load_dword v77, v10, s[20:23], s17 offen
    buffer_load_dword v78, v12, s[20:23], s17 offen
    buffer_load_dword v79, v13, s[20:23], s17 offen
    s_waitcnt vmcnt(58)
    v_perm_b32 v5, v21, v20, s44
    v_perm_b32 v6, v21, v20, s45
    s_waitcnt vmcnt(56)
    v_perm_b32 v157, v23, v22, v11
    v_accvgpr_write_b32 a57, v5
    v_accvgpr_write_b32 a61, v6
    s_add_u32 s17, s49, 405504
    buffer_load_dword v80, v9, s[20:23], s17 offen
    buffer_load_dword v81, v10, s[20:23], s17 offen
    buffer_load_dword v82, v12, s[20:23], s17 offen
    buffer_load_dword v83, v13, s[20:23], s17 offen
    s_waitcnt vmcnt(58)
    v_perm_b32 v5, v25, v24, s44
    v_perm_b32 v6, v25, v24, s45
    s_waitcnt vmcnt(56)
    v_perm_b32 v158, v27, v26, v11
    v_accvgpr_write_b32 a58, v5
    v_accvgpr_write_b32 a62, v6
    s_add_u32 s17, s49, 406656
    buffer_load_dword v84, v9, s[20:23], s17 offen
    buffer_load_dword v85, v10, s[20:23], s17 offen
    buffer_load_dword v86, v12, s[20:23], s17 offen
    buffer_load_dword v87, v13, s[20:23], s17 offen
    s_waitcnt vmcnt(58)
    v_perm_b32 v5, v29, v28, s44
    v_perm_b32 v6, v29, v28, s45
    s_waitcnt vmcnt(56)
    v_perm_b32 v159, v31, v30, v11
    v_accvgpr_write_b32 a59, v5
    v_accvgpr_write_b32 a63, v6
    s_add_u32 s17, s49, 407808
    buffer_load_dword v88, v9, s[20:23], s17 offen
    buffer_load_dword v89, v10, s[20:23], s17 offen
    buffer_load_dword v90, v12, s[20:23], s17 offen
    buffer_load_dword v91, v13, s[20:23], s17 offen
    s_waitcnt vmcnt(58)
    v_perm_b32 v5, v33, v32, s44
    v_perm_b32 v6, v33, v32, s45
    s_waitcnt vmcnt(56)
    v_perm_b32 v160, v35, v34, v11
    v_accvgpr_write_b32 a64, v5
    v_accvgpr_write_b32 a68, v6
    s_add_u32 s17, s49, 408960
    buffer_load_dword v92, v9, s[20:23], s17 offen
    buffer_load_dword v93, v10, s[20:23], s17 offen
    buffer_load_dword v94, v12, s[20:23], s17 offen
    buffer_load_dword v95, v13, s[20:23], s17 offen
    s_waitcnt vmcnt(58)
    v_perm_b32 v5, v37, v36, s44
    v_perm_b32 v6, v37, v36, s45
    s_waitcnt vmcnt(56)
    v_perm_b32 v161, v39, v38, v11
    v_accvgpr_write_b32 a65, v5
    v_accvgpr_write_b32 a69, v6
    s_add_u32 s17, s49, 442368
    buffer_load_dword v96, v9, s[20:23], s17 offen
    buffer_load_dword v97, v10, s[20:23], s17 offen
    buffer_load_dword v98, v12, s[20:23], s17 offen
    buffer_load_dword v99, v13, s[20:23], s17 offen
    s_waitcnt vmcnt(58)
    v_perm_b32 v5, v41, v40, s44
    v_perm_b32 v6, v41, v40, s45
    s_waitcnt vmcnt(56)
    v_perm_b32 v162, v43, v42, v11
    v_accvgpr_write_b32 a66, v5
    v_accvgpr_write_b32 a70, v6
    s_add_u32 s17, s49, 443520
    buffer_load_dword v100, v9, s[20:23], s17 offen
    buffer_load_dword v101, v10, s[20:23], s17 offen
    buffer_load_dword v102, v12, s[20:23], s17 offen
    buffer_load_dword v103, v13, s[20:23], s17 offen
    s_waitcnt vmcnt(58)
    v_perm_b32 v5, v45, v44, s44
    v_perm_b32 v6, v45, v44, s45
    s_waitcnt vmcnt(56)
    v_perm_b32 v163, v47, v46, v11
    v_accvgpr_write_b32 a67, v5
    v_accvgpr_write_b32 a71, v6
    s_add_u32 s17, s49, 444672
    buffer_load_dword v104, v9, s[20:23], s17 offen
    buffer_load_dword v105, v10, s[20:23], s17 offen
    buffer_load_dword v106, v12, s[20:23], s17 offen
    buffer_load_dword v107, v13, s[20:23], s17 offen
    s_waitcnt vmcnt(58)
    v_perm_b32 v5, v49, v48, s44
    v_perm_b32 v6, v49, v48, s45
    s_waitcnt vmcnt(56)
    v_perm_b32 v164, v51, v50, v11
    v_accvgpr_write_b32 a72, v5
    v_accvgpr_write_b32 a76, v6
    s_add_u32 s17, s49, 445824
    buffer_load_dword v108, v9, s[20:23], s17 offen
    buffer_load_dword v109, v10, s[20:23], s17 offen
    buffer_load_dword v110, v12, s[20:23], s17 offen
    buffer_load_dword v111, v13, s[20:23], s17 offen
    s_waitcnt vmcnt(58)
    v_perm_b32 v5, v53, v52, s44
    v_perm_b32 v6, v53, v52, s45
    s_waitcnt vmcnt(56)
    v_perm_b32 v165, v55, v54, v11
    v_accvgpr_write_b32 a73, v5
    v_accvgpr_write_b32 a77, v6
    s_add_u32 s17, s49, 479232
    buffer_load_dword v112, v9, s[20:23], s17 offen
    buffer_load_dword v113, v10, s[20:23], s17 offen
    buffer_load_dword v114, v12, s[20:23], s17 offen
    buffer_load_dword v115, v13, s[20:23], s17 offen
    s_waitcnt vmcnt(58)
    v_perm_b32 v5, v57, v56, s44
    v_perm_b32 v6, v57, v56, s45
    s_waitcnt vmcnt(56)
    v_perm_b32 v166, v59, v58, v11
    v_accvgpr_write_b32 a74, v5
    v_accvgpr_write_b32 a78, v6
    s_add_u32 s17, s49, 480384
    buffer_load_dword v116, v9, s[20:23], s17 offen
    buffer_load_dword v117, v10, s[20:23], s17 offen
    buffer_load_dword v118, v12, s[20:23], s17 offen
    buffer_load_dword v119, v13, s[20:23], s17 offen
    s_waitcnt vmcnt(58)
    v_perm_b32 v5, v61, v60, s44
    v_perm_b32 v6, v61, v60, s45
    s_waitcnt vmcnt(56)
    v_perm_b32 v167, v63, v62, v11
    v_accvgpr_write_b32 a75, v5
    v_accvgpr_write_b32 a79, v6
    s_add_u32 s17, s49, 481536
    buffer_load_dword v120, v9, s[20:23], s17 offen
    buffer_load_dword v121, v10, s[20:23], s17 offen
    buffer_load_dword v122, v12, s[20:23], s17 offen
    buffer_load_dword v123, v13, s[20:23], s17 offen
    s_waitcnt vmcnt(58)
    v_perm_b32 v5, v65, v64, s44
    v_perm_b32 v6, v65, v64, s45
    s_waitcnt vmcnt(56)
    v_perm_b32 v168, v67, v66, v11
    v_accvgpr_write_b32 a80, v5
    v_accvgpr_write_b32 a84, v6
    s_add_u32 s17, s49, 482688
    buffer_load_dword v124, v9, s[20:23], s17 offen
    buffer_load_dword v125, v10, s[20:23], s17 offen
    buffer_load_dword v126, v12, s[20:23], s17 offen
    buffer_load_dword v127, v13, s[20:23], s17 offen
    s_waitcnt vmcnt(58)
    v_perm_b32 v5, v69, v68, s44
    v_perm_b32 v6, v69, v68, s45
    s_waitcnt vmcnt(56)
    v_perm_b32 v169, v71, v70, v11
    v_accvgpr_write_b32 a81, v5
    v_accvgpr_write_b32 a85, v6
    s_add_u32 s17, s49, 516096
    buffer_load_dword v16, v9, s[20:23], s17 offen
    buffer_load_dword v17, v10, s[20:23], s17 offen
    buffer_load_dword v18, v12, s[20:23], s17 offen
    buffer_load_dword v19, v13, s[20:23], s17 offen
    s_waitcnt vmcnt(58)
    v_perm_b32 v5, v73, v72, s44
    v_perm_b32 v6, v73, v72, s45
    s_waitcnt vmcnt(56)
    v_perm_b32 v170, v75, v74, v11
    v_accvgpr_write_b32 a82, v5
    v_accvgpr_write_b32 a86, v6
    s_add_u32 s17, s49, 517248
    buffer_load_dword v20, v9, s[20:23], s17 offen
    buffer_load_dword v21, v10, s[20:23], s17 offen
    buffer_load_dword v22, v12, s[20:23], s17 offen
    buffer_load_dword v23, v13, s[20:23], s17 offen
    s_waitcnt vmcnt(58)
    v_perm_b32 v5, v77, v76, s44
    v_perm_b32 v6, v77, v76, s45
    s_waitcnt vmcnt(56)
    v_perm_b32 v171, v79, v78, v11
    v_accvgpr_write_b32 a83, v5
    v_accvgpr_write_b32 a87, v6
    s_add_u32 s17, s49, 518400
    buffer_load_dword v24, v9, s[20:23], s17 offen
    buffer_load_dword v25, v10, s[20:23], s17 offen
    buffer_load_dword v26, v12, s[20:23], s17 offen
    buffer_load_dword v27, v13, s[20:23], s17 offen
    s_waitcnt vmcnt(58)
    v_perm_b32 v5, v81, v80, s44
    v_perm_b32 v6, v81, v80, s45
    s_waitcnt vmcnt(56)
    v_perm_b32 v172, v83, v82, v11
    v_accvgpr_write_b32 a88, v5
    v_accvgpr_write_b32 a92, v6
    s_add_u32 s17, s49, 519552
    buffer_load_dword v28, v9, s[20:23], s17 offen
    buffer_load_dword v29, v10, s[20:23], s17 offen
    buffer_load_dword v30, v12, s[20:23], s17 offen
    buffer_load_dword v31, v13, s[20:23], s17 offen
    s_waitcnt vmcnt(58)
    v_perm_b32 v5, v85, v84, s44
    v_perm_b32 v6, v85, v84, s45
    s_waitcnt vmcnt(56)
    v_perm_b32 v173, v87, v86, v11
    v_accvgpr_write_b32 a89, v5
    v_accvgpr_write_b32 a93, v6
    s_add_u32 s17, s49, 552960
    buffer_load_dword v32, v9, s[20:23], s17 offen
    buffer_load_dword v33, v10, s[20:23], s17 offen
    buffer_load_dword v34, v12, s[20:23], s17 offen
    buffer_load_dword v35, v13, s[20:23], s17 offen
    s_waitcnt vmcnt(58)
    v_perm_b32 v5, v89, v88, s44
    v_perm_b32 v6, v89, v88, s45
    s_waitcnt vmcnt(56)
    v_perm_b32 v174, v91, v90, v11
    v_accvgpr_write_b32 a90, v5
    v_accvgpr_write_b32 a94, v6
    s_add_u32 s17, s49, 554112
    buffer_load_dword v36, v9, s[20:23], s17 offen
    buffer_load_dword v37, v10, s[20:23], s17 offen
    buffer_load_dword v38, v12, s[20:23], s17 offen
    buffer_load_dword v39, v13, s[20:23], s17 offen
    s_waitcnt vmcnt(58)
    v_perm_b32 v5, v93, v92, s44
    v_perm_b32 v6, v93, v92, s45
    s_waitcnt vmcnt(56)
    v_perm_b32 v175, v95, v94, v11
    v_accvgpr_write_b32 a91, v5
    v_accvgpr_write_b32 a95, v6
    s_add_u32 s17, s49, 555264
    buffer_load_dword v40, v9, s[20:23], s17 offen
    buffer_load_dword v41, v10, s[20:23], s17 offen
    buffer_load_dword v42, v12, s[20:23], s17 offen
    buffer_load_dword v43, v13, s[20:23], s17 offen
    s_waitcnt vmcnt(58)
    v_perm_b32 v5, v97, v96, s44
    v_perm_b32 v6, v97, v96, s45
    s_waitcnt vmcnt(56)
    v_perm_b32 v176, v99, v98, v11
    v_accvgpr_write_b32 a96, v5
    v_accvgpr_write_b32 a100, v6
    s_add_u32 s17, s49, 556416
    buffer_load_dword v44, v9, s[20:23], s17 offen
    buffer_load_dword v45, v10, s[20:23], s17 offen
    buffer_load_dword v46, v12, s[20:23], s17 offen
    buffer_load_dword v47, v13, s[20:23], s17 offen
    s_waitcnt vmcnt(58)
    v_perm_b32 v5, v101, v100, s44
    v_perm_b32 v6, v101, v100, s45
    s_waitcnt vmcnt(56)
    v_perm_b32 v177, v103, v102, v11
    v_accvgpr_write_b32 a97, v5
    v_accvgpr_write_b32 a101, v6
    s_add_u32 s17, s49, 589824
    buffer_load_dword v48, v9, s[20:23], s17 offen
    buffer_load_dword v49, v10, s[20:23], s17 offen
    buffer_load_dword v50, v12, s[20:23], s17 offen
    buffer_load_dword v51, v13, s[20:23], s17 offen
    s_waitcnt vmcnt(58)
    v_perm_b32 v5, v105, v104, s44
    v_perm_b32 v6, v105, v104, s45
    s_waitcnt vmcnt(56)
    v_perm_b32 v178, v107, v106, v11
    v_accvgpr_write_b32 a98, v5
    v_accvgpr_write_b32 a102, v6
    s_add_u32 s17, s49, 590976
    buffer_load_dword v52, v9, s[20:23], s17 offen
    buffer_load_dword v53, v10, s[20:23], s17 offen
    buffer_load_dword v54, v12, s[20:23], s17 offen
    buffer_load_dword v55, v13, s[20:23], s17 offen
    s_waitcnt vmcnt(58)
    v_perm_b32 v5, v109, v108, s44
    v_perm_b32 v6, v109, v108, s45
    s_waitcnt vmcnt(56)
    v_perm_b32 v179, v111, v110, v11
    v_accvgpr_write_b32 a99, v5
    v_accvgpr_write_b32 a103, v6
    s_add_u32 s17, s49, 592128
    buffer_load_dword v56, v9, s[20:23], s17 offen
    buffer_load_dword v57, v10, s[20:23], s17 offen
    buffer_load_dword v58, v12, s[20:23], s17 offen
    buffer_load_dword v59, v13, s[20:23], s17 offen
    s_waitcnt vmcnt(58)
    v_perm_b32 v5, v113, v112, s44
    v_perm_b32 v6, v113, v112, s45
    s_waitcnt vmcnt(56)
    v_perm_b32 v180, v115, v114, v11
    v_accvgpr_write_b32 a104, v5
    v_accvgpr_write_b32 a108, v6
    s_add_u32 s17, s49, 593280
    buffer_load_dword v60, v9, s[20:23], s17 offen
    buffer_load_dword v61, v10, s[20:23], s17 offen
    buffer_load_dword v62, v12, s[20:23], s17 offen
    buffer_load_dword v63, v13, s[20:23], s17 offen
    s_waitcnt vmcnt(58)
    v_perm_b32 v5, v117, v116, s44
    v_perm_b32 v6, v117, v116, s45
    s_waitcnt vmcnt(56)
    v_perm_b32 v181, v119, v118, v11
    v_accvgpr_write_b32 a105, v5
    v_accvgpr_write_b32 a109, v6
    s_add_u32 s17, s49, 626688
    buffer_load_dword v64, v9, s[20:23], s17 offen
    buffer_load_dword v65, v10, s[20:23], s17 offen
    buffer_load_dword v66, v12, s[20:23], s17 offen
    buffer_load_dword v67, v13, s[20:23], s17 offen
    s_waitcnt vmcnt(58)
    v_perm_b32 v5, v121, v120, s44
    v_perm_b32 v6, v121, v120, s45
    s_waitcnt vmcnt(56)
    v_perm_b32 v182, v123, v122, v11
    v_accvgpr_write_b32 a106, v5
    v_accvgpr_write_b32 a110, v6
    s_add_u32 s17, s49, 627840
    buffer_load_dword v68, v9, s[20:23], s17 offen
    buffer_load_dword v69, v10, s[20:23], s17 offen
    buffer_load_dword v70, v12, s[20:23], s17 offen
    buffer_load_dword v71, v13, s[20:23], s17 offen
    s_waitcnt vmcnt(58)
    v_perm_b32 v5, v125, v124, s44
    v_perm_b32 v6, v125, v124, s45
    s_waitcnt vmcnt(56)
    v_perm_b32 v183, v127, v126, v11
    v_accvgpr_write_b32 a107, v5
    v_accvgpr_write_b32 a111, v6
    s_add_u32 s17, s49, 628992
    buffer_load_dword v72, v9, s[20:23], s17 offen
    buffer_load_dword v73, v10, s[20:23], s17 offen
    buffer_load_dword v74, v12, s[20:23], s17 offen
    buffer_load_dword v75, v13, s[20:23], s17 offen
    s_waitcnt vmcnt(58)
    v_perm_b32 v5, v17, v16, s44
    v_perm_b32 v6, v17, v16, s45
    s_waitcnt vmcnt(56)
    v_perm_b32 v184, v19, v18, v11
    v_accvgpr_write_b32 a112, v5
    v_accvgpr_write_b32 a116, v6
    s_add_u32 s17, s49, 630144
    buffer_load_dword v76, v9, s[20:23], s17 offen
    buffer_load_dword v77, v10, s[20:23], s17 offen
    buffer_load_dword v78, v12, s[20:23], s17 offen
    buffer_load_dword v79, v13, s[20:23], s17 offen
    s_waitcnt vmcnt(58)
    v_perm_b32 v5, v21, v20, s44
    v_perm_b32 v6, v21, v20, s45
    s_waitcnt vmcnt(56)
    v_perm_b32 v185, v23, v22, v11
    v_accvgpr_write_b32 a113, v5
    v_accvgpr_write_b32 a117, v6
    s_add_u32 s17, s49, 663552
    buffer_load_dword v80, v9, s[20:23], s17 offen
    buffer_load_dword v81, v10, s[20:23], s17 offen
    buffer_load_dword v82, v12, s[20:23], s17 offen
    buffer_load_dword v83, v13, s[20:23], s17 offen
    s_waitcnt vmcnt(58)
    v_perm_b32 v5, v25, v24, s44
    v_perm_b32 v6, v25, v24, s45
    s_waitcnt vmcnt(56)
    v_perm_b32 v186, v27, v26, v11
    v_accvgpr_write_b32 a114, v5
    v_accvgpr_write_b32 a118, v6
    s_add_u32 s17, s49, 664704
    buffer_load_dword v84, v9, s[20:23], s17 offen
    buffer_load_dword v85, v10, s[20:23], s17 offen
    buffer_load_dword v86, v12, s[20:23], s17 offen
    buffer_load_dword v87, v13, s[20:23], s17 offen
    s_waitcnt vmcnt(58)
    v_perm_b32 v5, v29, v28, s44
    v_perm_b32 v6, v29, v28, s45
    s_waitcnt vmcnt(56)
    v_perm_b32 v187, v31, v30, v11
    v_accvgpr_write_b32 a115, v5
    v_accvgpr_write_b32 a119, v6
    s_add_u32 s17, s49, 665856
    buffer_load_dword v88, v9, s[20:23], s17 offen
    buffer_load_dword v89, v10, s[20:23], s17 offen
    buffer_load_dword v90, v12, s[20:23], s17 offen
    buffer_load_dword v91, v13, s[20:23], s17 offen
    s_waitcnt vmcnt(58)
    v_perm_b32 v5, v33, v32, s44
    v_perm_b32 v6, v33, v32, s45
    s_waitcnt vmcnt(56)
    v_perm_b32 v188, v35, v34, v11
    v_accvgpr_write_b32 a120, v5
    v_accvgpr_write_b32 a124, v6
    s_add_u32 s17, s49, 667008
    buffer_load_dword v92, v9, s[20:23], s17 offen
    buffer_load_dword v93, v10, s[20:23], s17 offen
    buffer_load_dword v94, v12, s[20:23], s17 offen
    buffer_load_dword v95, v13, s[20:23], s17 offen
    s_waitcnt vmcnt(58)
    v_perm_b32 v5, v37, v36, s44
    v_perm_b32 v6, v37, v36, s45
    s_waitcnt vmcnt(56)
    v_perm_b32 v189, v39, v38, v11
    v_accvgpr_write_b32 a121, v5
    v_accvgpr_write_b32 a125, v6
    s_add_u32 s17, s49, 700416
    buffer_load_dword v96, v9, s[20:23], s17 offen
    buffer_load_dword v97, v10, s[20:23], s17 offen
    buffer_load_dword v98, v12, s[20:23], s17 offen
    buffer_load_dword v99, v13, s[20:23], s17 offen
    s_waitcnt vmcnt(58)
    v_perm_b32 v5, v41, v40, s44
    v_perm_b32 v6, v41, v40, s45
    s_waitcnt vmcnt(56)
    v_perm_b32 v190, v43, v42, v11
    v_accvgpr_write_b32 a122, v5
    v_accvgpr_write_b32 a126, v6
    s_add_u32 s17, s49, 701568
    buffer_load_dword v100, v9, s[20:23], s17 offen
    buffer_load_dword v101, v10, s[20:23], s17 offen
    buffer_load_dword v102, v12, s[20:23], s17 offen
    buffer_load_dword v103, v13, s[20:23], s17 offen
    s_waitcnt vmcnt(58)
    v_perm_b32 v5, v45, v44, s44
    v_perm_b32 v6, v45, v44, s45
    s_waitcnt vmcnt(56)
    v_perm_b32 v191, v47, v46, v11
    v_accvgpr_write_b32 a123, v5
    v_accvgpr_write_b32 a127, v6
    s_add_u32 s17, s49, 702720
    buffer_load_dword v104, v9, s[20:23], s17 offen
    buffer_load_dword v105, v10, s[20:23], s17 offen
    buffer_load_dword v106, v12, s[20:23], s17 offen
    buffer_load_dword v107, v13, s[20:23], s17 offen
    s_waitcnt vmcnt(58)
    v_perm_b32 v5, v49, v48, s44
    v_perm_b32 v6, v49, v48, s45
    s_waitcnt vmcnt(56)
    v_perm_b32 v192, v51, v50, v11
    v_accvgpr_write_b32 a128, v5
    v_accvgpr_write_b32 a132, v6
    s_add_u32 s17, s49, 703872
    buffer_load_dword v108, v9, s[20:23], s17 offen
    buffer_load_dword v109, v10, s[20:23], s17 offen
    buffer_load_dword v110, v12, s[20:23], s17 offen
    buffer_load_dword v111, v13, s[20:23], s17 offen
    s_waitcnt vmcnt(58)
    v_perm_b32 v5, v53, v52, s44
    v_perm_b32 v6, v53, v52, s45
    s_waitcnt vmcnt(56)
    v_perm_b32 v193, v55, v54, v11
    v_accvgpr_write_b32 a129, v5
    v_accvgpr_write_b32 a133, v6
    s_add_u32 s17, s49, 737280
    buffer_load_dword v112, v9, s[20:23], s17 offen
    buffer_load_dword v113, v10, s[20:23], s17 offen
    buffer_load_dword v114, v12, s[20:23], s17 offen
    buffer_load_dword v115, v13, s[20:23], s17 offen
    s_waitcnt vmcnt(58)
    v_perm_b32 v5, v57, v56, s44
    v_perm_b32 v6, v57, v56, s45
    s_waitcnt vmcnt(56)
    v_perm_b32 v194, v59, v58, v11
    v_accvgpr_write_b32 a130, v5
    v_accvgpr_write_b32 a134, v6
    s_add_u32 s17, s49, 738432
    buffer_load_dword v116, v9, s[20:23], s17 offen
    buffer_load_dword v117, v10, s[20:23], s17 offen
    buffer_load_dword v118, v12, s[20:23], s17 offen
    buffer_load_dword v119, v13, s[20:23], s17 offen
    s_waitcnt vmcnt(58)
    v_perm_b32 v5, v61, v60, s44
    v_perm_b32 v6, v61, v60, s45
    s_waitcnt vmcnt(56)
    v_perm_b32 v195, v63, v62, v11
    v_accvgpr_write_b32 a131, v5
    v_accvgpr_write_b32 a135, v6
    s_add_u32 s17, s49, 739584
    buffer_load_dword v120, v9, s[20:23], s17 offen
    buffer_load_dword v121, v10, s[20:23], s17 offen
    buffer_load_dword v122, v12, s[20:23], s17 offen
    buffer_load_dword v123, v13, s[20:23], s17 offen
    s_waitcnt vmcnt(58)
    v_perm_b32 v5, v65, v64, s44
    v_perm_b32 v6, v65, v64, s45
    s_waitcnt vmcnt(56)
    v_perm_b32 v196, v67, v66, v11
    v_accvgpr_write_b32 a136, v5
    v_accvgpr_write_b32 a140, v6
    s_add_u32 s17, s49, 740736
    buffer_load_dword v124, v9, s[20:23], s17 offen
    buffer_load_dword v125, v10, s[20:23], s17 offen
    buffer_load_dword v126, v12, s[20:23], s17 offen
    buffer_load_dword v127, v13, s[20:23], s17 offen
    s_waitcnt vmcnt(58)
    v_perm_b32 v5, v69, v68, s44
    v_perm_b32 v6, v69, v68, s45
    s_waitcnt vmcnt(56)
    v_perm_b32 v197, v71, v70, v11
    v_accvgpr_write_b32 a137, v5
    v_accvgpr_write_b32 a141, v6
    s_add_u32 s17, s49, 774144
    buffer_load_dword v16, v9, s[20:23], s17 offen
    buffer_load_dword v17, v10, s[20:23], s17 offen
    buffer_load_dword v18, v12, s[20:23], s17 offen
    buffer_load_dword v19, v13, s[20:23], s17 offen
    s_waitcnt vmcnt(58)
    v_perm_b32 v5, v73, v72, s44
    v_perm_b32 v6, v73, v72, s45
    s_waitcnt vmcnt(56)
    v_perm_b32 v198, v75, v74, v11
    v_accvgpr_write_b32 a138, v5
    v_accvgpr_write_b32 a142, v6
    s_add_u32 s17, s49, 775296
    buffer_load_dword v20, v9, s[20:23], s17 offen
    buffer_load_dword v21, v10, s[20:23], s17 offen
    buffer_load_dword v22, v12, s[20:23], s17 offen
    buffer_load_dword v23, v13, s[20:23], s17 offen
    s_waitcnt vmcnt(58)
    v_perm_b32 v5, v77, v76, s44
    v_perm_b32 v6, v77, v76, s45
    s_waitcnt vmcnt(56)
    v_perm_b32 v199, v79, v78, v11
    v_accvgpr_write_b32 a139, v5
    v_accvgpr_write_b32 a143, v6
    s_add_u32 s17, s49, 776448
    buffer_load_dword v24, v9, s[20:23], s17 offen
    buffer_load_dword v25, v10, s[20:23], s17 offen
    buffer_load_dword v26, v12, s[20:23], s17 offen
    buffer_load_dword v27, v13, s[20:23], s17 offen
    s_waitcnt vmcnt(58)
    v_perm_b32 v5, v81, v80, s44
    v_perm_b32 v6, v81, v80, s45
    s_waitcnt vmcnt(56)
    v_perm_b32 v200, v83, v82, v11
    v_accvgpr_write_b32 a144, v5
    v_accvgpr_write_b32 a148, v6
    s_add_u32 s17, s49, 777600
    buffer_load_dword v28, v9, s[20:23], s17 offen
    buffer_load_dword v29, v10, s[20:23], s17 offen
    buffer_load_dword v30, v12, s[20:23], s17 offen
    buffer_load_dword v31, v13, s[20:23], s17 offen
    s_waitcnt vmcnt(58)
    v_perm_b32 v5, v85, v84, s44
    v_perm_b32 v6, v85, v84, s45
    s_waitcnt vmcnt(56)
    v_perm_b32 v201, v87, v86, v11
    v_accvgpr_write_b32 a145, v5
    v_accvgpr_write_b32 a149, v6
    s_add_u32 s17, s49, 811008
    buffer_load_dword v32, v9, s[20:23], s17 offen
    buffer_load_dword v33, v10, s[20:23], s17 offen
    buffer_load_dword v34, v12, s[20:23], s17 offen
    buffer_load_dword v35, v13, s[20:23], s17 offen
    s_waitcnt vmcnt(58)
    v_perm_b32 v5, v89, v88, s44
    v_perm_b32 v6, v89, v88, s45
    s_waitcnt vmcnt(56)
    v_perm_b32 v202, v91, v90, v11
    v_accvgpr_write_b32 a146, v5
    v_accvgpr_write_b32 a150, v6
    s_add_u32 s17, s49, 812160
    buffer_load_dword v36, v9, s[20:23], s17 offen
    buffer_load_dword v37, v10, s[20:23], s17 offen
    buffer_load_dword v38, v12, s[20:23], s17 offen
    buffer_load_dword v39, v13, s[20:23], s17 offen
    s_waitcnt vmcnt(58)
    v_perm_b32 v5, v93, v92, s44
    v_perm_b32 v6, v93, v92, s45
    s_waitcnt vmcnt(56)
    v_perm_b32 v203, v95, v94, v11
    v_accvgpr_write_b32 a147, v5
    v_accvgpr_write_b32 a151, v6
    s_add_u32 s17, s49, 813312
    buffer_load_dword v40, v9, s[20:23], s17 offen
    buffer_load_dword v41, v10, s[20:23], s17 offen
    buffer_load_dword v42, v12, s[20:23], s17 offen
    buffer_load_dword v43, v13, s[20:23], s17 offen
    s_waitcnt vmcnt(58)
    v_perm_b32 v5, v97, v96, s44
    v_perm_b32 v6, v97, v96, s45
    s_waitcnt vmcnt(56)
    v_perm_b32 v204, v99, v98, v11
    v_accvgpr_write_b32 a152, v5
    v_accvgpr_write_b32 a156, v6
    s_add_u32 s17, s49, 814464
    buffer_load_dword v44, v9, s[20:23], s17 offen
    buffer_load_dword v45, v10, s[20:23], s17 offen
    buffer_load_dword v46, v12, s[20:23], s17 offen
    buffer_load_dword v47, v13, s[20:23], s17 offen
    s_waitcnt vmcnt(58)
    v_perm_b32 v5, v101, v100, s44
    v_perm_b32 v6, v101, v100, s45
    s_waitcnt vmcnt(56)
    v_perm_b32 v205, v103, v102, v11
    v_accvgpr_write_b32 a153, v5
    v_accvgpr_write_b32 a157, v6
    s_add_u32 s17, s49, 847872
    buffer_load_dword v48, v9, s[20:23], s17 offen
    buffer_load_dword v49, v10, s[20:23], s17 offen
    buffer_load_dword v50, v12, s[20:23], s17 offen
    buffer_load_dword v51, v13, s[20:23], s17 offen
    s_waitcnt vmcnt(58)
    v_perm_b32 v5, v105, v104, s44
    v_perm_b32 v6, v105, v104, s45
    s_waitcnt vmcnt(56)
    v_perm_b32 v206, v107, v106, v11
    v_accvgpr_write_b32 a154, v5
    v_accvgpr_write_b32 a158, v6
    s_add_u32 s17, s49, 849024
    buffer_load_dword v52, v9, s[20:23], s17 offen
    buffer_load_dword v53, v10, s[20:23], s17 offen
    buffer_load_dword v54, v12, s[20:23], s17 offen
    buffer_load_dword v55, v13, s[20:23], s17 offen
    s_waitcnt vmcnt(58)
    v_perm_b32 v5, v109, v108, s44
    v_perm_b32 v6, v109, v108, s45
    s_waitcnt vmcnt(56)
    v_perm_b32 v207, v111, v110, v11
    v_accvgpr_write_b32 a155, v5
    v_accvgpr_write_b32 a159, v6
    s_add_u32 s17, s49, 850176
    buffer_load_dword v56, v9, s[20:23], s17 offen
    buffer_load_dword v57, v10, s[20:23], s17 offen
    buffer_load_dword v58, v12, s[20:23], s17 offen
    buffer_load_dword v59, v13, s[20:23], s17 offen
    s_waitcnt vmcnt(58)
    v_perm_b32 v5, v113, v112, s44
    v_perm_b32 v6, v113, v112, s45
    s_waitcnt vmcnt(56)
    v_perm_b32 v208, v115, v114, v11
    v_accvgpr_write_b32 a160, v5
    v_accvgpr_write_b32 a164, v6
    s_add_u32 s17, s49, 851328
    buffer_load_dword v60, v9, s[20:23], s17 offen
    buffer_load_dword v61, v10, s[20:23], s17 offen
    buffer_load_dword v62, v12, s[20:23], s17 offen
    buffer_load_dword v63, v13, s[20:23], s17 offen
    s_waitcnt vmcnt(58)
    v_perm_b32 v5, v117, v116, s44
    v_perm_b32 v6, v117, v116, s45
    s_waitcnt vmcnt(56)
    v_perm_b32 v209, v119, v118, v11
    v_accvgpr_write_b32 a161, v5
    v_accvgpr_write_b32 a165, v6
    s_add_u32 s17, s49, 884736
    buffer_load_dword v64, v9, s[20:23], s17 offen
    buffer_load_dword v65, v10, s[20:23], s17 offen
    buffer_load_dword v66, v12, s[20:23], s17 offen
    buffer_load_dword v67, v13, s[20:23], s17 offen
    s_waitcnt vmcnt(58)
    v_perm_b32 v5, v121, v120, s44
    v_perm_b32 v6, v121, v120, s45
    s_waitcnt vmcnt(56)
    v_perm_b32 v210, v123, v122, v11
    v_accvgpr_write_b32 a162, v5
    v_accvgpr_write_b32 a166, v6
    s_add_u32 s17, s49, 885888
    buffer_load_dword v68, v9, s[20:23], s17 offen
    buffer_load_dword v69, v10, s[20:23], s17 offen
    buffer_load_dword v70, v12, s[20:23], s17 offen
    buffer_load_dword v71, v13, s[20:23], s17 offen
    s_waitcnt vmcnt(58)
    v_perm_b32 v5, v125, v124, s44
    v_perm_b32 v6, v125, v124, s45
    s_waitcnt vmcnt(56)
    v_perm_b32 v211, v127, v126, v11
    v_accvgpr_write_b32 a163, v5
    v_accvgpr_write_b32 a167, v6
    s_add_u32 s17, s49, 887040
    buffer_load_dword v72, v9, s[20:23], s17 offen
    buffer_load_dword v73, v10, s[20:23], s17 offen
    buffer_load_dword v74, v12, s[20:23], s17 offen
    buffer_load_dword v75, v13, s[20:23], s17 offen
    s_waitcnt vmcnt(58)
    v_perm_b32 v5, v17, v16, s44
    v_perm_b32 v6, v17, v16, s45
    s_waitcnt vmcnt(56)
    v_perm_b32 v212, v19, v18, v11
    v_accvgpr_write_b32 a168, v5
    v_accvgpr_write_b32 a172, v6
    s_add_u32 s17, s49, 888192
    buffer_load_dword v76, v9, s[20:23], s17 offen
    buffer_load_dword v77, v10, s[20:23], s17 offen
    buffer_load_dword v78, v12, s[20:23], s17 offen
    buffer_load_dword v79, v13, s[20:23], s17 offen
    s_waitcnt vmcnt(58)
    v_perm_b32 v5, v21, v20, s44
    v_perm_b32 v6, v21, v20, s45
    s_waitcnt vmcnt(56)
    v_perm_b32 v213, v23, v22, v11
    v_accvgpr_write_b32 a169, v5
    v_accvgpr_write_b32 a173, v6
    s_add_u32 s17, s49, 921600
    buffer_load_dword v80, v9, s[20:23], s17 offen
    buffer_load_dword v81, v10, s[20:23], s17 offen
    buffer_load_dword v82, v12, s[20:23], s17 offen
    buffer_load_dword v83, v13, s[20:23], s17 offen
    s_waitcnt vmcnt(58)
    v_perm_b32 v5, v25, v24, s44
    v_perm_b32 v6, v25, v24, s45
    s_waitcnt vmcnt(56)
    v_perm_b32 v214, v27, v26, v11
    v_accvgpr_write_b32 a170, v5
    v_accvgpr_write_b32 a174, v6
    s_add_u32 s17, s49, 922752
    buffer_load_dword v84, v9, s[20:23], s17 offen
    buffer_load_dword v85, v10, s[20:23], s17 offen
    buffer_load_dword v86, v12, s[20:23], s17 offen
    buffer_load_dword v87, v13, s[20:23], s17 offen
    s_waitcnt vmcnt(58)
    v_perm_b32 v5, v29, v28, s44
    v_perm_b32 v6, v29, v28, s45
    s_waitcnt vmcnt(56)
    v_perm_b32 v215, v31, v30, v11
    v_accvgpr_write_b32 a171, v5
    v_accvgpr_write_b32 a175, v6
    s_add_u32 s17, s49, 923904
    buffer_load_dword v88, v9, s[20:23], s17 offen
    buffer_load_dword v89, v10, s[20:23], s17 offen
    buffer_load_dword v90, v12, s[20:23], s17 offen
    buffer_load_dword v91, v13, s[20:23], s17 offen
    s_waitcnt vmcnt(58)
    v_perm_b32 v5, v33, v32, s44
    v_perm_b32 v6, v33, v32, s45
    s_waitcnt vmcnt(56)
    v_perm_b32 v216, v35, v34, v11
    v_accvgpr_write_b32 a176, v5
    v_accvgpr_write_b32 a180, v6
    s_add_u32 s17, s49, 925056
    buffer_load_dword v92, v9, s[20:23], s17 offen
    buffer_load_dword v93, v10, s[20:23], s17 offen
    buffer_load_dword v94, v12, s[20:23], s17 offen
    buffer_load_dword v95, v13, s[20:23], s17 offen
    s_waitcnt vmcnt(58)
    v_perm_b32 v5, v37, v36, s44
    v_perm_b32 v6, v37, v36, s45
    s_waitcnt vmcnt(56)
    v_perm_b32 v217, v39, v38, v11
    v_accvgpr_write_b32 a177, v5
    v_accvgpr_write_b32 a181, v6
    s_add_u32 s17, s49, 958464
    buffer_load_dword v96, v9, s[20:23], s17 offen
    buffer_load_dword v97, v10, s[20:23], s17 offen
    buffer_load_dword v98, v12, s[20:23], s17 offen
    buffer_load_dword v99, v13, s[20:23], s17 offen
    s_waitcnt vmcnt(58)
    v_perm_b32 v5, v41, v40, s44
    v_perm_b32 v6, v41, v40, s45
    s_waitcnt vmcnt(56)
    v_perm_b32 v218, v43, v42, v11
    v_accvgpr_write_b32 a178, v5
    v_accvgpr_write_b32 a182, v6
    s_add_u32 s17, s49, 959616
    buffer_load_dword v100, v9, s[20:23], s17 offen
    buffer_load_dword v101, v10, s[20:23], s17 offen
    buffer_load_dword v102, v12, s[20:23], s17 offen
    buffer_load_dword v103, v13, s[20:23], s17 offen
    s_waitcnt vmcnt(58)
    v_perm_b32 v5, v45, v44, s44
    v_perm_b32 v6, v45, v44, s45
    s_waitcnt vmcnt(56)
    v_perm_b32 v219, v47, v46, v11
    v_accvgpr_write_b32 a179, v5
    v_accvgpr_write_b32 a183, v6
    s_add_u32 s17, s49, 960768
    buffer_load_dword v104, v9, s[20:23], s17 offen
    buffer_load_dword v105, v10, s[20:23], s17 offen
    buffer_load_dword v106, v12, s[20:23], s17 offen
    buffer_load_dword v107, v13, s[20:23], s17 offen
    s_waitcnt vmcnt(58)
    v_perm_b32 v5, v49, v48, s44
    v_perm_b32 v6, v49, v48, s45
    s_waitcnt vmcnt(56)
    v_perm_b32 v220, v51, v50, v11
    v_accvgpr_write_b32 a184, v5
    v_accvgpr_write_b32 a188, v6
    s_add_u32 s17, s49, 961920
    buffer_load_dword v108, v9, s[20:23], s17 offen
    buffer_load_dword v109, v10, s[20:23], s17 offen
    buffer_load_dword v110, v12, s[20:23], s17 offen
    buffer_load_dword v111, v13, s[20:23], s17 offen
    s_waitcnt vmcnt(58)
    v_perm_b32 v5, v53, v52, s44
    v_perm_b32 v6, v53, v52, s45
    s_waitcnt vmcnt(56)
    v_perm_b32 v221, v55, v54, v11
    v_accvgpr_write_b32 a185, v5
    v_accvgpr_write_b32 a189, v6
    s_add_u32 s17, s49, 995328
    buffer_load_dword v112, v9, s[20:23], s17 offen
    buffer_load_dword v113, v10, s[20:23], s17 offen
    buffer_load_dword v114, v12, s[20:23], s17 offen
    buffer_load_dword v115, v13, s[20:23], s17 offen
    s_waitcnt vmcnt(58)
    v_perm_b32 v5, v57, v56, s44
    v_perm_b32 v6, v57, v56, s45
    s_waitcnt vmcnt(56)
    v_perm_b32 v222, v59, v58, v11
    v_accvgpr_write_b32 a186, v5
    v_accvgpr_write_b32 a190, v6
    s_add_u32 s17, s49, 996480
    buffer_load_dword v116, v9, s[20:23], s17 offen
    buffer_load_dword v117, v10, s[20:23], s17 offen
    buffer_load_dword v118, v12, s[20:23], s17 offen
    buffer_load_dword v119, v13, s[20:23], s17 offen
    s_waitcnt vmcnt(58)
    v_perm_b32 v5, v61, v60, s44
    v_perm_b32 v6, v61, v60, s45
    s_waitcnt vmcnt(56)
    v_perm_b32 v223, v63, v62, v11
    v_accvgpr_write_b32 a187, v5
    v_accvgpr_write_b32 a191, v6
    s_add_u32 s17, s49, 997632
    buffer_load_dword v120, v9, s[20:23], s17 offen
    buffer_load_dword v121, v10, s[20:23], s17 offen
    buffer_load_dword v122, v12, s[20:23], s17 offen
    buffer_load_dword v123, v13, s[20:23], s17 offen
    s_waitcnt vmcnt(58)
    v_perm_b32 v5, v65, v64, s44
    v_perm_b32 v6, v65, v64, s45
    s_waitcnt vmcnt(56)
    v_perm_b32 v224, v67, v66, v11
    v_accvgpr_write_b32 a192, v5
    v_accvgpr_write_b32 a196, v6
    s_add_u32 s17, s49, 998784
    buffer_load_dword v124, v9, s[20:23], s17 offen
    buffer_load_dword v125, v10, s[20:23], s17 offen
    buffer_load_dword v126, v12, s[20:23], s17 offen
    buffer_load_dword v127, v13, s[20:23], s17 offen
    s_waitcnt vmcnt(58)
    v_perm_b32 v5, v69, v68, s44
    v_perm_b32 v6, v69, v68, s45
    s_waitcnt vmcnt(56)
    v_perm_b32 v225, v71, v70, v11
    v_accvgpr_write_b32 a193, v5
    v_accvgpr_write_b32 a197, v6
    s_add_u32 s17, s49, 1032192
    buffer_load_dword v16, v9, s[20:23], s17 offen
    buffer_load_dword v17, v10, s[20:23], s17 offen
    buffer_load_dword v18, v12, s[20:23], s17 offen
    buffer_load_dword v19, v13, s[20:23], s17 offen
    s_waitcnt vmcnt(58)
    v_perm_b32 v5, v73, v72, s44
    v_perm_b32 v6, v73, v72, s45
    s_waitcnt vmcnt(56)
    v_perm_b32 v226, v75, v74, v11
    v_accvgpr_write_b32 a194, v5
    v_accvgpr_write_b32 a198, v6
    s_add_u32 s17, s49, 1033344
    buffer_load_dword v20, v9, s[20:23], s17 offen
    buffer_load_dword v21, v10, s[20:23], s17 offen
    buffer_load_dword v22, v12, s[20:23], s17 offen
    buffer_load_dword v23, v13, s[20:23], s17 offen
    s_waitcnt vmcnt(58)
    v_perm_b32 v5, v77, v76, s44
    v_perm_b32 v6, v77, v76, s45
    s_waitcnt vmcnt(56)
    v_perm_b32 v227, v79, v78, v11
    v_accvgpr_write_b32 a195, v5
    v_accvgpr_write_b32 a199, v6
    s_add_u32 s17, s49, 1034496
    buffer_load_dword v24, v9, s[20:23], s17 offen
    buffer_load_dword v25, v10, s[20:23], s17 offen
    buffer_load_dword v26, v12, s[20:23], s17 offen
    buffer_load_dword v27, v13, s[20:23], s17 offen
    s_waitcnt vmcnt(58)
    v_perm_b32 v5, v81, v80, s44
    v_perm_b32 v6, v81, v80, s45
    s_waitcnt vmcnt(56)
    v_perm_b32 v228, v83, v82, v11
    v_accvgpr_write_b32 a200, v5
    v_accvgpr_write_b32 a204, v6
    s_add_u32 s17, s49, 1035648
    buffer_load_dword v28, v9, s[20:23], s17 offen
    buffer_load_dword v29, v10, s[20:23], s17 offen
    buffer_load_dword v30, v12, s[20:23], s17 offen
    buffer_load_dword v31, v13, s[20:23], s17 offen
    s_waitcnt vmcnt(58)
    v_perm_b32 v5, v85, v84, s44
    v_perm_b32 v6, v85, v84, s45
    s_waitcnt vmcnt(56)
    v_perm_b32 v229, v87, v86, v11
    v_accvgpr_write_b32 a201, v5
    v_accvgpr_write_b32 a205, v6
    s_add_u32 s17, s49, 1069056
    buffer_load_dword v32, v9, s[20:23], s17 offen
    buffer_load_dword v33, v10, s[20:23], s17 offen
    buffer_load_dword v34, v12, s[20:23], s17 offen
    buffer_load_dword v35, v13, s[20:23], s17 offen
    s_waitcnt vmcnt(58)
    v_perm_b32 v5, v89, v88, s44
    v_perm_b32 v6, v89, v88, s45
    s_waitcnt vmcnt(56)
    v_perm_b32 v230, v91, v90, v11
    v_accvgpr_write_b32 a202, v5
    v_accvgpr_write_b32 a206, v6
    s_add_u32 s17, s49, 1070208
    buffer_load_dword v36, v9, s[20:23], s17 offen
    buffer_load_dword v37, v10, s[20:23], s17 offen
    buffer_load_dword v38, v12, s[20:23], s17 offen
    buffer_load_dword v39, v13, s[20:23], s17 offen
    s_waitcnt vmcnt(58)
    v_perm_b32 v5, v93, v92, s44
    v_perm_b32 v6, v93, v92, s45
    s_waitcnt vmcnt(56)
    v_perm_b32 v231, v95, v94, v11
    v_accvgpr_write_b32 a203, v5
    v_accvgpr_write_b32 a207, v6
    s_add_u32 s17, s49, 1071360
    buffer_load_dword v40, v9, s[20:23], s17 offen
    buffer_load_dword v41, v10, s[20:23], s17 offen
    buffer_load_dword v42, v12, s[20:23], s17 offen
    buffer_load_dword v43, v13, s[20:23], s17 offen
    s_waitcnt vmcnt(58)
    v_perm_b32 v5, v97, v96, s44
    v_perm_b32 v6, v97, v96, s45
    s_waitcnt vmcnt(56)
    v_perm_b32 v232, v99, v98, v11
    v_accvgpr_write_b32 a208, v5
    v_accvgpr_write_b32 a212, v6
    s_add_u32 s17, s49, 1072512
    buffer_load_dword v44, v9, s[20:23], s17 offen
    buffer_load_dword v45, v10, s[20:23], s17 offen
    buffer_load_dword v46, v12, s[20:23], s17 offen
    buffer_load_dword v47, v13, s[20:23], s17 offen
    s_waitcnt vmcnt(58)
    v_perm_b32 v5, v101, v100, s44
    v_perm_b32 v6, v101, v100, s45
    s_waitcnt vmcnt(56)
    v_perm_b32 v233, v103, v102, v11
    v_accvgpr_write_b32 a209, v5
    v_accvgpr_write_b32 a213, v6
    s_add_u32 s17, s49, 1105920
    buffer_load_dword v48, v9, s[20:23], s17 offen
    buffer_load_dword v49, v10, s[20:23], s17 offen
    buffer_load_dword v50, v12, s[20:23], s17 offen
    buffer_load_dword v51, v13, s[20:23], s17 offen
    s_waitcnt vmcnt(58)
    v_perm_b32 v5, v105, v104, s44
    v_perm_b32 v6, v105, v104, s45
    s_waitcnt vmcnt(56)
    v_perm_b32 v234, v107, v106, v11
    v_accvgpr_write_b32 a210, v5
    v_accvgpr_write_b32 a214, v6
    s_add_u32 s17, s49, 1107072
    buffer_load_dword v52, v9, s[20:23], s17 offen
    buffer_load_dword v53, v10, s[20:23], s17 offen
    buffer_load_dword v54, v12, s[20:23], s17 offen
    buffer_load_dword v55, v13, s[20:23], s17 offen
    s_waitcnt vmcnt(58)
    v_perm_b32 v5, v109, v108, s44
    v_perm_b32 v6, v109, v108, s45
    s_waitcnt vmcnt(56)
    v_perm_b32 v235, v111, v110, v11
    v_accvgpr_write_b32 a211, v5
    v_accvgpr_write_b32 a215, v6
    s_add_u32 s17, s49, 1108224
    buffer_load_dword v56, v9, s[20:23], s17 offen
    buffer_load_dword v57, v10, s[20:23], s17 offen
    buffer_load_dword v58, v12, s[20:23], s17 offen
    buffer_load_dword v59, v13, s[20:23], s17 offen
    s_waitcnt vmcnt(58)
    v_perm_b32 v5, v113, v112, s44
    v_perm_b32 v6, v113, v112, s45
    s_waitcnt vmcnt(56)
    v_perm_b32 v236, v115, v114, v11
    v_accvgpr_write_b32 a216, v5
    v_accvgpr_write_b32 a220, v6
    s_add_u32 s17, s49, 1109376
    buffer_load_dword v60, v9, s[20:23], s17 offen
    buffer_load_dword v61, v10, s[20:23], s17 offen
    buffer_load_dword v62, v12, s[20:23], s17 offen
    buffer_load_dword v63, v13, s[20:23], s17 offen
    s_waitcnt vmcnt(58)
    v_perm_b32 v5, v117, v116, s44
    v_perm_b32 v6, v117, v116, s45
    s_waitcnt vmcnt(56)
    v_perm_b32 v237, v119, v118, v11
    v_accvgpr_write_b32 a217, v5
    v_accvgpr_write_b32 a221, v6
    s_add_u32 s17, s49, 1142784
    buffer_load_dword v64, v9, s[20:23], s17 offen
    buffer_load_dword v65, v10, s[20:23], s17 offen
    buffer_load_dword v66, v12, s[20:23], s17 offen
    buffer_load_dword v67, v13, s[20:23], s17 offen
    s_waitcnt vmcnt(58)
    v_perm_b32 v5, v121, v120, s44
    v_perm_b32 v6, v121, v120, s45
    s_waitcnt vmcnt(56)
    v_perm_b32 v238, v123, v122, v11
    v_accvgpr_write_b32 a218, v5
    v_accvgpr_write_b32 a222, v6
    s_add_u32 s17, s49, 1143936
    buffer_load_dword v68, v9, s[20:23], s17 offen
    buffer_load_dword v69, v10, s[20:23], s17 offen
    buffer_load_dword v70, v12, s[20:23], s17 offen
    buffer_load_dword v71, v13, s[20:23], s17 offen
    s_waitcnt vmcnt(58)
    v_perm_b32 v5, v125, v124, s44
    v_perm_b32 v6, v125, v124, s45
    s_waitcnt vmcnt(56)
    v_perm_b32 v239, v127, v126, v11
    v_accvgpr_write_b32 a219, v5
    v_accvgpr_write_b32 a223, v6
    s_add_u32 s17, s49, 1145088
    buffer_load_dword v72, v9, s[20:23], s17 offen
    buffer_load_dword v73, v10, s[20:23], s17 offen
    buffer_load_dword v74, v12, s[20:23], s17 offen
    buffer_load_dword v75, v13, s[20:23], s17 offen
    s_waitcnt vmcnt(58)
    v_perm_b32 v5, v17, v16, s44
    v_perm_b32 v6, v17, v16, s45
    s_waitcnt vmcnt(56)
    v_perm_b32 v240, v19, v18, v11
    v_accvgpr_write_b32 a224, v5
    v_accvgpr_write_b32 a228, v6
    s_add_u32 s17, s49, 1146240
    buffer_load_dword v76, v9, s[20:23], s17 offen
    buffer_load_dword v77, v10, s[20:23], s17 offen
    buffer_load_dword v78, v12, s[20:23], s17 offen
    buffer_load_dword v79, v13, s[20:23], s17 offen
    s_waitcnt vmcnt(58)
    v_perm_b32 v5, v21, v20, s44
    v_perm_b32 v6, v21, v20, s45
    s_waitcnt vmcnt(56)
    v_perm_b32 v241, v23, v22, v11
    v_accvgpr_write_b32 a225, v5
    v_accvgpr_write_b32 a229, v6
    s_waitcnt vmcnt(54)
    v_perm_b32 v5, v25, v24, s44
    v_perm_b32 v6, v25, v24, s45
    s_waitcnt vmcnt(52)
    v_perm_b32 v242, v27, v26, v11
    v_accvgpr_write_b32 a226, v5
    v_accvgpr_write_b32 a230, v6
    s_waitcnt vmcnt(50)
    v_perm_b32 v5, v29, v28, s44
    v_perm_b32 v6, v29, v28, s45
    s_waitcnt vmcnt(48)
    v_perm_b32 v243, v31, v30, v11
    v_accvgpr_write_b32 a227, v5
    v_accvgpr_write_b32 a231, v6
    s_waitcnt vmcnt(46)
    v_perm_b32 v5, v33, v32, s44
    v_perm_b32 v6, v33, v32, s45
    s_waitcnt vmcnt(44)
    v_perm_b32 v244, v35, v34, v11
    v_accvgpr_write_b32 a232, v5
    v_accvgpr_write_b32 a236, v6
    s_waitcnt vmcnt(42)
    v_perm_b32 v5, v37, v36, s44
    v_perm_b32 v6, v37, v36, s45
    s_waitcnt vmcnt(40)
    v_perm_b32 v245, v39, v38, v11
    v_accvgpr_write_b32 a233, v5
    v_accvgpr_write_b32 a237, v6
    s_waitcnt vmcnt(38)
    v_perm_b32 v5, v41, v40, s44
    v_perm_b32 v6, v41, v40, s45
    s_waitcnt vmcnt(36)
    v_perm_b32 v246, v43, v42, v11
    v_accvgpr_write_b32 a234, v5
    v_accvgpr_write_b32 a238, v6
    s_waitcnt vmcnt(34)
    v_perm_b32 v5, v45, v44, s44
    v_perm_b32 v6, v45, v44, s45
    s_waitcnt vmcnt(32)
    v_perm_b32 v247, v47, v46, v11
    v_accvgpr_write_b32 a235, v5
    v_accvgpr_write_b32 a239, v6
    s_waitcnt vmcnt(30)
    v_perm_b32 v5, v49, v48, s44
    v_perm_b32 v6, v49, v48, s45
    s_waitcnt vmcnt(28)
    v_perm_b32 v248, v51, v50, v11
    v_accvgpr_write_b32 a240, v5
    v_accvgpr_write_b32 a244, v6
    s_waitcnt vmcnt(26)
    v_perm_b32 v5, v53, v52, s44
    v_perm_b32 v6, v53, v52, s45
    s_waitcnt vmcnt(24)
    v_perm_b32 v249, v55, v54, v11
    v_accvgpr_write_b32 a241, v5
    v_accvgpr_write_b32 a245, v6
    s_waitcnt vmcnt(22)
    v_perm_b32 v5, v57, v56, s44
    v_perm_b32 v6, v57, v56, s45
    s_waitcnt vmcnt(20)
    v_perm_b32 v250, v59, v58, v11
    v_accvgpr_write_b32 a242, v5
    v_accvgpr_write_b32 a246, v6
    s_waitcnt vmcnt(18)
    v_perm_b32 v5, v61, v60, s44
    v_perm_b32 v6, v61, v60, s45
    s_waitcnt vmcnt(16)
    v_perm_b32 v251, v63, v62, v11
    v_accvgpr_write_b32 a243, v5
    v_accvgpr_write_b32 a247, v6
    s_waitcnt vmcnt(14)
    v_perm_b32 v5, v65, v64, s44
    v_perm_b32 v6, v65, v64, s45
    s_waitcnt vmcnt(12)
    v_perm_b32 v252, v67, v66, v11
    v_accvgpr_write_b32 a248, v5
    v_accvgpr_write_b32 a252, v6
    s_waitcnt vmcnt(10)
    v_perm_b32 v5, v69, v68, s44
    v_perm_b32 v6, v69, v68, s45
    s_waitcnt vmcnt(8)
    v_perm_b32 v253, v71, v70, v11
    v_accvgpr_write_b32 a249, v5
    v_accvgpr_write_b32 a253, v6
    s_waitcnt vmcnt(6)
    v_perm_b32 v5, v73, v72, s44
    v_perm_b32 v6, v73, v72, s45
    s_waitcnt vmcnt(4)
    v_perm_b32 v254, v75, v74, v11
    v_accvgpr_write_b32 a250, v5
    v_accvgpr_write_b32 a254, v6
    s_waitcnt vmcnt(2)
    v_perm_b32 v5, v77, v76, s44
    v_perm_b32 v6, v77, v76, s45
    s_waitcnt vmcnt(0)
    v_perm_b32 v255, v79, v78, v11
    v_accvgpr_write_b32 a251, v5
    v_accvgpr_write_b32 a255, v6
    s_and_b32 s51, s14, 1
    s_lshl_b32 s17, s51, 4
    v_add_u32 v5, s17, v7
    v_lshlrev_b32 v14, 4, v5
    v_mul_u32_u24 v13, 1152, v5
    s_mul_i32 s17, s50, 96
    v_add_u32 v13, s17, v13
    s_mul_i32 s17, s50, 3072
    v_add_u32 v12, s17, v14
    s_lshl_b32 s17, s50, 9
    v_add_u32 v14, s17, v14
    s_lshl_b32 s49, s50, 7
    s_lshl_b32 s17, s14, 2
    s_add_u32 s49, s49, s17
    s_add_u32 s49, s49, 1441792
    s_mul_i32 s17, s14, 6144
    v_add_u32 v48, s17, v0
    v_mov_b32 v49, 0x10000
    s_mul_i32 s17, s50, 43
    v_lshrrev_b32 v10, 4, v0
    v_add_u32 v10, s17, v10
    v_min_u32 v10, 511, v10
    v_lshlrev_b32 v10, 7, v10
    s_cmp_gt_u32 s14, 1
    s_cbranch_scc1 Ltw_z
    v_lshl_add_u32 v12, v8, 9, v12
    v_lshl_add_u32 v13, v8, 4, v13
    s_lshl_b32 s58, s14, 16
    s_add_u32 s58, s58, 144703488
    s_mov_b32 s43, 0
    s_mov_b32 s28, s8
    s_mov_b32 s29, s9
    s_mov_b32 s30, 0
    s_mov_b32 s31, 0x00020000
    s_mul_i32 s17, s51, 3072
    v_add_u32 v50, s17, v0
    ds_write2_b32 v49, v4, v4 offset0:0 offset1:1
    s_waitcnt lgkmcnt(0)
    s_cmp_lg_u32 s14, 0
    s_cbranch_scc1 LtwX_inia_d
    v_mov_b32 v5, 40
    s_mov_b32 s16, 0
LtwX_inia:
    global_load_dword v6, v5, s[12:13] sc1
    s_add_u32 s16, s16, 1
    s_cmp_gt_u32 s16, 100000
    s_cbranch_scc1 L_role_tw_abort
    s_waitcnt vmcnt(0)
    v_cmp_gt_u32 vcc, 72, v6
    s_nop 0
    s_cbranch_vccz LtwX_inia_d
    s_sleep 8
    s_branch LtwX_inia
LtwX_inia_d:
    s_barrier
    s_cmp_lg_u32 s14, 0
    s_cbranch_scc1 LtwX_inib_d
    v_mov_b32 v5, 160
    s_mov_b32 s16, 0
LtwX_inib:
    global_load_dword v6, v5, s[12:13] sc1
    s_add_u32 s16, s16, 1
    s_cmp_gt_u32 s16, 100000
    s_cbranch_scc1 L_role_tw_abort
    s_waitcnt vmcnt(0)
    v_cmp_gt_u32 vcc, 64, v6
    s_nop 0
    s_cbranch_vccz LtwX_inib_d
    s_sleep 8
    s_branch LtwX_inib
LtwX_inib_d:
    s_barrier
LtwX_idle:
    s_cmp_lg_u32 s14, 0
    s_cbranch_scc1 LtwX_nw0
    s_mul_i32 s60, s32, 22528
    s_add_u32 s60, s60, 4224
    s_cmp_lt_u32 s32, 64
    s_cselect_b32 s60, s60, 2883584
    s_mul_i32 s61, s33, 22528
    s_add_u32 s61, s61, 1446016
    s_cmp_lt_u32 s33, 64
    s_cselect_b32 s61, s61, 2883584
    s_mov_b32 s16, 0
LtwX_p_9:
    buffer_load_dword v2, v1, s[8:11], s60 offen sc1
    buffer_load_dword v15, v1, s[8:11], s61 offen sc1
    s_add_u32 s16, s16, 1
    s_cmp_gt_u32 s16, 100000
    s_cbranch_scc1 L_role_tw_abort
    s_waitcnt vmcnt(1)
    v_cmp_eq_u32 vcc, 0, v2
    s_waitcnt vmcnt(0)
    v_cmp_eq_u32 s[54:55], 0, v15
    s_nop 0
    s_cmp_eq_u64 s[54:55], 0
    s_cselect_b32 s62, 2, 0
    s_cmp_eq_u64 vcc, 0
    s_cselect_b32 s62, 1, s62
    s_cmp_lg_u32 s62, 0
    s_cbranch_scc1 LtwX_p_9d
    s_sleep 4
    s_branch LtwX_p_9
LtwX_p_9d:
    v_mov_b32 v5, s62
    ds_write_b32 v49, v5
    s_waitcnt lgkmcnt(0)
LtwX_nw0:
    s_barrier
    ds_read_b32 v6, v49
    v_xor_b32 v49, 4, v49
    s_waitcnt lgkmcnt(0)
    v_readfirstlane_b32 s62, v6
    s_nop 0
    s_cmp_eq_u32 s62, 0
    s_cbranch_scc1 L_role_tw_abort
    s_cmp_lt_u32 s33, 29
    s_cselect_b32 s38, 1, 3
    s_cmp_eq_u32 s62, 2
    s_cselect_b32 s36, 1, 0
    s_cselect_b32 s37, s33, s32
    s_cselect_b32 s17, s38, 0
    s_add_u32 s33, s33, s17
    s_cmp_eq_u32 s62, 1
    s_cselect_b32 s17, 2, 0
    s_add_u32 s32, s32, s17
    s_lshl_b32 s56, s36, 6
    s_add_u32 s56, s56, s37
    s_lshl_b32 s46, s56, 18
    s_add_u32 s46, s46, s58
    s_mul_i32 s41, s36, 4718592
    s_mul_i32 s17, s37, 36864
    s_add_u32 s41, s41, s17
    s_add_u32 s41, s41, 8650752
    s_cmp_ge_u32 s37, 64
    s_cbranch_scc1 L_role_tw_abort
    buffer_load_dword v9, v10, s[8:11], s46 offen
    s_add_u32 s48, s46, 0
    buffer_load_dwordx4 v[64:67], v0, s[8:11], s48 offen offset:0
    buffer_load_dwordx4 v[68:71], v0, s[8:11], s48 offen offset:1024
    buffer_load_dwordx4 v[72:75], v0, s[8:11], s48 offen offset:2048
    buffer_load_dwordx4 v[76:79], v0, s[8:11], s48 offen offset:3072
    s_add_u32 s48, s46, 4096
    buffer_load_dwordx4 v[80:83], v0, s[8:11], s48 offen offset:0
    buffer_load_dwordx4 v[84:87], v0, s[8:11], s48 offen offset:1024
    buffer_load_dwordx4 v[88:91], v0, s[8:11], s48 offen offset:2048
    buffer_load_dwordx4 v[92:95], v0, s[8:11], s48 offen offset:3072
    s_add_u32 s48, s46, 8192
    buffer_load_dwordx4 v[96:99], v0, s[8:11], s48 offen offset:0
    buffer_load_dwordx4 v[100:103], v0, s[8:11], s48 offen offset:1024
    buffer_load_dwordx4 v[104:107], v0, s[8:11], s48 offen offset:2048
    buffer_load_dwordx4 v[108:111], v0, s[8:11], s48 offen offset:3072
    s_add_u32 s48, s46, 12288
    buffer_load_dwordx4 v[112:115], v0, s[8:11], s48 offen offset:0
    buffer_load_dwordx4 v[116:119], v0, s[8:11], s48 offen offset:1024
    buffer_load_dwordx4 v[120:123], v0, s[8:11], s48 offen offset:2048
    buffer_load_dwordx4 v[40:43], v12, s[8:11], s41 offen
LtwX_item:
    s_mov_b32 s34, s36
    s_mov_b32 s35, s37
    s_mov_b32 s47, s41
    buffer_load_dwordx4 v[124:127], v0, s[8:11], s48 offen offset:3072
    s_waitcnt vmcnt(15)
    v_mfma_f32_16x16x32_bf16 v[16:19], a[0:3], v[64:67], 0
    v_mfma_f32_16x16x32_bf16 v[20:23], a[4:7], v[64:67], 0
    v_mfma_f32_16x16x32_bf16 v[24:27], v[128:131], v[64:67], 0
    s_add_u32 s48, s46, 16384
    buffer_load_dwordx4 v[64:67], v0, s[8:11], s48 offen offset:0
    s_waitcnt vmcnt(15)
    v_mfma_f32_16x16x32_bf16 v[28:31], a[0:3], v[68:71], 0
    v_mfma_f32_16x16x32_bf16 v[32:35], a[4:7], v[68:71], 0
    v_mfma_f32_16x16x32_bf16 v[36:39], v[128:131], v[68:71], 0
    buffer_load_dwordx4 v[68:71], v0, s[8:11], s48 offen offset:1024
    s_waitcnt vmcnt(15)
    v_mfma_f32_16x16x32_bf16 v[16:19], a[8:11], v[72:75], v[16:19]
    v_mfma_f32_16x16x32_bf16 v[20:23], a[12:15], v[72:75], v[20:23]
    v_mfma_f32_16x16x32_bf16 v[24:27], v[132:135], v[72:75], v[24:27]
    buffer_load_dwordx4 v[72:75], v0, s[8:11], s48 offen offset:2048
    s_waitcnt vmcnt(15)
    v_mfma_f32_16x16x32_bf16 v[28:31], a[8:11], v[76:79], v[28:31]
    v_mfma_f32_16x16x32_bf16 v[32:35], a[12:15], v[76:79], v[32:35]
    v_mfma_f32_16x16x32_bf16 v[36:39], v[132:135], v[76:79], v[36:39]
    buffer_load_dwordx4 v[76:79], v0, s[8:11], s48 offen offset:3072
    s_waitcnt vmcnt(15)
    v_mfma_f32_16x16x32_bf16 v[16:19], a[16:19], v[80:83], v[16:19]
    v_mfma_f32_16x16x32_bf16 v[20:23], a[20:23], v[80:83], v[20:23]
    v_mfma_f32_16x16x32_bf16 v[24:27], v[136:139], v[80:83], v[24:27]
    s_add_u32 s48, s46, 20480
    buffer_load_dwordx4 v[80:83], v0, s[8:11], s48 offen offset:0
    s_waitcnt vmcnt(15)
    v_mfma_f32_16x16x32_bf16 v[28:31], a[16:19], v[84:87], v[28:31]
    v_mfma_f32_16x16x32_bf16 v[32:35], a[20:23], v[84:87], v[32:35]
    v_mfma_f32_16x16x32_bf16 v[36:39], v[136:139], v[84:87], v[36:39]
    buffer_load_dwordx4 v[84:87], v0, s[8:11], s48 offen offset:1024
    s_waitcnt vmcnt(15)
    v_mfma_f32_16x16x32_bf16 v[16:19], a[24:27], v[88:91], v[16:19]
    v_mfma_f32_16x16x32_bf16 v[20:23], a[28:31], v[88:91], v[20:23]
    v_mfma_f32_16x16x32_bf16 v[24:27], v[140:143], v[88:91], v[24:27]
    buffer_load_dwordx4 v[88:91], v0, s[8:11], s48 offen offset:2048
    s_waitcnt vmcnt(15)
    v_mfma_f32_16x16x32_bf16 v[28:31], a[24:27], v[92:95], v[28:31]
    v_mfma_f32_16x16x32_bf16 v[32:35], a[28:31], v[92:95], v[32:35]
    v_mfma_f32_16x16x32_bf16 v[36:39], v[140:143], v[92:95], v[36:39]
    buffer_load_dwordx4 v[92:95], v0, s[8:11], s48 offen offset:3072
    s_waitcnt vmcnt(15)
    v_mfma_f32_16x16x32_bf16 v[16:19], a[32:35], v[96:99], v[16:19]
    v_mfma_f32_16x16x32_bf16 v[20:23], a[36:39], v[96:99], v[20:23]
    v_mfma_f32_16x16x32_bf16 v[24:27], v[144:147], v[96:99], v[24:27]
    s_add_u32 s48, s46, 24576
    buffer_load_dwordx4 v[96:99], v0, s[8:11], s48 offen offset:0
    s_waitcnt vmcnt(15)
    v_mfma_f32_16x16x32_bf16 v[28:31], a[32:35], v[100:103], v[28:31]
    v_mfma_f32_16x16x32_bf16 v[32:35], a[36:39], v[100:103], v[32:35]
    v_mfma_f32_16x16x32_bf16 v[36:39], v[144:147], v[100:103], v[36:39]
    buffer_load_dwordx4 v[100:103], v0, s[8:11], s48 offen offset:1024
    s_waitcnt vmcnt(15)
    v_mfma_f32_16x16x32_bf16 v[16:19], a[40:43], v[104:107], v[16:19]
    v_mfma_f32_16x16x32_bf16 v[20:23], a[44:47], v[104:107], v[20:23]
    v_mfma_f32_16x16x32_bf16 v[24:27], v[148:151], v[104:107], v[24:27]
    buffer_load_dwordx4 v[104:107], v0, s[8:11], s48 offen offset:2048
    s_waitcnt vmcnt(15)
    v_mfma_f32_16x16x32_bf16 v[28:31], a[40:43], v[108:111], v[28:31]
    v_mfma_f32_16x16x32_bf16 v[32:35], a[44:47], v[108:111], v[32:35]
    v_mfma_f32_16x16x32_bf16 v[36:39], v[148:151], v[108:111], v[36:39]
    buffer_load_dwordx4 v[108:111], v0, s[8:11], s48 offen offset:3072
    s_waitcnt vmcnt(15)
    v_mfma_f32_16x16x32_bf16 v[16:19], a[48:51], v[112:115], v[16:19]
    v_mfma_f32_16x16x32_bf16 v[20:23], a[52:55], v[112:115], v[20:23]
    v_mfma_f32_16x16x32_bf16 v[24:27], v[152:155], v[112:115], v[24:27]
    s_add_u32 s48, s46, 28672
    buffer_load_dwordx4 v[112:115], v0, s[8:11], s48 offen offset:0
    s_waitcnt vmcnt(15)
    v_mfma_f32_16x16x32_bf16 v[28:31], a[48:51], v[116:119], v[28:31]
    v_mfma_f32_16x16x32_bf16 v[32:35], a[52:55], v[116:119], v[32:35]
    v_mfma_f32_16x16x32_bf16 v[36:39], v[152:155], v[116:119], v[36:39]
    buffer_load_dwordx4 v[116:119], v0, s[8:11], s48 offen offset:1024
    s_waitcnt vmcnt(15)
    v_mfma_f32_16x16x32_bf16 v[16:19], a[56:59], v[120:123], v[16:19]
    v_mfma_f32_16x16x32_bf16 v[20:23], a[60:63], v[120:123], v[20:23]
    v_mfma_f32_16x16x32_bf16 v[24:27], v[156:159], v[120:123], v[24:27]
    buffer_load_dwordx4 v[120:123], v0, s[8:11], s48 offen offset:2048
    s_waitcnt vmcnt(15)
    v_mfma_f32_16x16x32_bf16 v[28:31], a[56:59], v[124:127], v[28:31]
    v_mfma_f32_16x16x32_bf16 v[32:35], a[60:63], v[124:127], v[32:35]
    v_mfma_f32_16x16x32_bf16 v[36:39], v[156:159], v[124:127], v[36:39]
    buffer_load_dwordx4 v[124:127], v0, s[8:11], s48 offen offset:3072
    s_waitcnt vmcnt(15)
    v_mfma_f32_16x16x32_bf16 v[16:19], a[64:67], v[64:67], v[16:19]
    v_mfma_f32_16x16x32_bf16 v[20:23], a[68:71], v[64:67], v[20:23]
    v_mfma_f32_16x16x32_bf16 v[24:27], v[160:163], v[64:67], v[24:27]
    s_add_u32 s48, s46, 32768
    buffer_load_dwordx4 v[64:67], v0, s[8:11], s48 offen offset:0
    s_waitcnt vmcnt(15)
    v_mfma_f32_16x16x32_bf16 v[28:31], a[64:67], v[68:71], v[28:31]
    v_mfma_f32_16x16x32_bf16 v[32:35], a[68:71], v[68:71], v[32:35]
    v_mfma_f32_16x16x32_bf16 v[36:39], v[160:163], v[68:71], v[36:39]
    s_cmp_lg_u32 s43, 0
    s_cselect_b64 exec, 1, 0
    buffer_store_dword v3, v4, s[8:11], s43 offen sc1
    s_mov_b64 exec, -1
    s_mov_b32 s43, 0
    buffer_load_dwordx4 v[68:71], v0, s[8:11], s48 offen offset:1024
    s_waitcnt vmcnt(16)
    v_mfma_f32_16x16x32_bf16 v[16:19], a[72:75], v[72:75], v[16:19]
    v_mfma_f32_16x16x32_bf16 v[20:23], a[76:79], v[72:75], v[20:23]
    v_mfma_f32_16x16x32_bf16 v[24:27], v[164:167], v[72:75], v[24:27]
    buffer_load_dwordx4 v[72:75], v0, s[8:11], s48 offen offset:2048
    s_waitcnt vmcnt(16)
    v_mfma_f32_16x16x32_bf16 v[28:31], a[72:75], v[76:79], v[28:31]
    v_mfma_f32_16x16x32_bf16 v[32:35], a[76:79], v[76:79], v[32:35]
    v_mfma_f32_16x16x32_bf16 v[36:39], v[164:167], v[76:79], v[36:39]
    buffer_load_dwordx4 v[76:79], v0, s[8:11], s48 offen offset:3072
    s_waitcnt vmcnt(16)
    v_mfma_f32_16x16x32_bf16 v[16:19], a[80:83], v[80:83], v[16:19]
    v_mfma_f32_16x16x32_bf16 v[20:23], a[84:87], v[80:83], v[20:23]
    v_mfma_f32_16x16x32_bf16 v[24:27], v[168:171], v[80:83], v[24:27]
    s_add_u32 s48, s46, 36864
    buffer_load_dwordx4 v[80:83], v0, s[8:11], s48 offen offset:0
    s_waitcnt vmcnt(16)
    v_mfma_f32_16x16x32_bf16 v[28:31], a[80:83], v[84:87], v[28:31]
    v_mfma_f32_16x16x32_bf16 v[32:35], a[84:87], v[84:87], v[32:35]
    v_mfma_f32_16x16x32_bf16 v[36:39], v[168:171], v[84:87], v[36:39]
    buffer_load_dwordx4 v[84:87], v0, s[8:11], s48 offen offset:1024
    s_waitcnt vmcnt(16)
    v_mfma_f32_16x16x32_bf16 v[16:19], a[88:91], v[88:91], v[16:19]
    v_mfma_f32_16x16x32_bf16 v[20:23], a[92:95], v[88:91], v[20:23]
    v_mfma_f32_16x16x32_bf16 v[24:27], v[172:175], v[88:91], v[24:27]
    buffer_load_dwordx4 v[88:91], v0, s[8:11], s48 offen offset:2048
    s_waitcnt vmcnt(16)
    v_mfma_f32_16x16x32_bf16 v[28:31], a[88:91], v[92:95], v[28:31]
    v_mfma_f32_16x16x32_bf16 v[32:35], a[92:95], v[92:95], v[32:35]
    v_mfma_f32_16x16x32_bf16 v[36:39], v[172:175], v[92:95], v[36:39]
    buffer_load_dwordx4 v[92:95], v0, s[8:11], s48 offen offset:3072
    s_waitcnt vmcnt(16)
    v_mfma_f32_16x16x32_bf16 v[16:19], a[96:99], v[96:99], v[16:19]
    v_mfma_f32_16x16x32_bf16 v[20:23], a[100:103], v[96:99], v[20:23]
    v_mfma_f32_16x16x32_bf16 v[24:27], v[176:179], v[96:99], v[24:27]
    s_add_u32 s48, s46, 40960
    buffer_load_dwordx4 v[96:99], v0, s[8:11], s48 offen offset:0
    s_waitcnt vmcnt(16)
    v_mfma_f32_16x16x32_bf16 v[28:31], a[96:99], v[100:103], v[28:31]
    v_mfma_f32_16x16x32_bf16 v[32:35], a[100:103], v[100:103], v[32:35]
    v_mfma_f32_16x16x32_bf16 v[36:39], v[176:179], v[100:103], v[36:39]
    buffer_load_dwordx4 v[100:103], v0, s[8:11], s48 offen offset:1024
    s_waitcnt vmcnt(16)
    v_mfma_f32_16x16x32_bf16 v[16:19], a[104:107], v[104:107], v[16:19]
    v_mfma_f32_16x16x32_bf16 v[20:23], a[108:111], v[104:107], v[20:23]
    v_mfma_f32_16x16x32_bf16 v[24:27], v[180:183], v[104:107], v[24:27]
    s_cmp_lg_u32 s14, 0
    s_cbranch_scc1 LtwX_nw1
    s_mul_i32 s60, s32, 22528
    s_add_u32 s60, s60, 4224
    s_cmp_lt_u32 s32, 64
    s_cselect_b32 s60, s60, 2883584
    s_mul_i32 s61, s33, 22528
    s_add_u32 s61, s61, 1446016
    s_cmp_lt_u32 s33, 64
    s_cselect_b32 s61, s61, 2883584
    buffer_load_dword v2, v1, s[8:11], s60 offen sc1
    buffer_load_dword v15, v1, s[8:11], s61 offen sc1
LtwX_nw1:
    buffer_load_dwordx4 v[104:107], v0, s[8:11], s48 offen offset:2048
    s_waitcnt vmcnt(16)
    v_mfma_f32_16x16x32_bf16 v[28:31], a[104:107], v[108:111], v[28:31]
    v_mfma_f32_16x16x32_bf16 v[32:35], a[108:111], v[108:111], v[32:35]
    v_mfma_f32_16x16x32_bf16 v[36:39], v[180:183], v[108:111], v[36:39]
    buffer_load_dwordx4 v[108:111], v0, s[8:11], s48 offen offset:3072
    s_waitcnt vmcnt(16)
    v_mfma_f32_16x16x32_bf16 v[16:19], a[112:115], v[112:115], v[16:19]
    v_mfma_f32_16x16x32_bf16 v[20:23], a[116:119], v[112:115], v[20:23]
    v_mfma_f32_16x16x32_bf16 v[24:27], v[184:187], v[112:115], v[24:27]
    s_add_u32 s48, s46, 45056
    buffer_load_dwordx4 v[112:115], v0, s[8:11], s48 offen offset:0
    s_waitcnt vmcnt(16)
    v_mfma_f32_16x16x32_bf16 v[28:31], a[112:115], v[116:119], v[28:31]
    v_mfma_f32_16x16x32_bf16 v[32:35], a[116:119], v[116:119], v[32:35]
    v_mfma_f32_16x16x32_bf16 v[36:39], v[184:187], v[116:119], v[36:39]
    buffer_load_dwordx4 v[116:119], v0, s[8:11], s48 offen offset:1024
    s_waitcnt vmcnt(16)
    v_mfma_f32_16x16x32_bf16 v[16:19], a[120:123], v[120:123], v[16:19]
    v_mfma_f32_16x16x32_bf16 v[20:23], a[124:127], v[120:123], v[20:23]
    v_mfma_f32_16x16x32_bf16 v[24:27], v[188:191], v[120:123], v[24:27]
    buffer_load_dwordx4 v[120:123], v0, s[8:11], s48 offen offset:2048
    s_waitcnt vmcnt(16)
    v_mfma_f32_16x16x32_bf16 v[28:31], a[120:123], v[124:127], v[28:31]
    v_mfma_f32_16x16x32_bf16 v[32:35], a[124:127], v[124:127], v[32:35]
    v_mfma_f32_16x16x32_bf16 v[36:39], v[188:191], v[124:127], v[36:39]
    buffer_load_dwordx4 v[124:127], v0, s[8:11], s48 offen offset:3072
    s_waitcnt vmcnt(16)
    v_mfma_f32_16x16x32_bf16 v[16:19], a[128:131], v[64:67], v[16:19]
    v_mfma_f32_16x16x32_bf16 v[20:23], a[132:135], v[64:67], v[20:23]
    v_mfma_f32_16x16x32_bf16 v[24:27], v[192:195], v[64:67], v[24:27]
    s_add_u32 s48, s46, 49152
    buffer_load_dwordx4 v[64:67], v0, s[8:11], s48 offen offset:0
    s_waitcnt vmcnt(15)
    v_mfma_f32_16x16x32_bf16 v[28:31], a[128:131], v[68:71], v[28:31]
    v_mfma_f32_16x16x32_bf16 v[32:35], a[132:135], v[68:71], v[32:35]
    v_mfma_f32_16x16x32_bf16 v[36:39], v[192:195], v[68:71], v[36:39]
    buffer_load_dwordx4 v[68:71], v0, s[8:11], s48 offen offset:1024
    s_waitcnt vmcnt(15)
    v_mfma_f32_16x16x32_bf16 v[16:19], a[136:139], v[72:75], v[16:19]
    v_mfma_f32_16x16x32_bf16 v[20:23], a[140:143], v[72:75], v[20:23]
    v_mfma_f32_16x16x32_bf16 v[24:27], v[196:199], v[72:75], v[24:27]
    buffer_load_dwordx4 v[72:75], v0, s[8:11], s48 offen offset:2048
    s_waitcnt vmcnt(15)
    v_mfma_f32_16x16x32_bf16 v[28:31], a[136:139], v[76:79], v[28:31]
    v_mfma_f32_16x16x32_bf16 v[32:35], a[140:143], v[76:79], v[32:35]
    v_mfma_f32_16x16x32_bf16 v[36:39], v[196:199], v[76:79], v[36:39]
    buffer_load_dwordx4 v[76:79], v0, s[8:11], s48 offen offset:3072
    s_waitcnt vmcnt(15)
    v_mfma_f32_16x16x32_bf16 v[16:19], a[144:147], v[80:83], v[16:19]
    v_mfma_f32_16x16x32_bf16 v[20:23], a[148:151], v[80:83], v[20:23]
    v_mfma_f32_16x16x32_bf16 v[24:27], v[200:203], v[80:83], v[24:27]
    s_add_u32 s48, s46, 53248
    buffer_load_dwordx4 v[80:83], v0, s[8:11], s48 offen offset:0
    s_waitcnt vmcnt(15)
    v_mfma_f32_16x16x32_bf16 v[28:31], a[144:147], v[84:87], v[28:31]
    v_mfma_f32_16x16x32_bf16 v[32:35], a[148:151], v[84:87], v[32:35]
    v_mfma_f32_16x16x32_bf16 v[36:39], v[200:203], v[84:87], v[36:39]
    buffer_load_dwordx4 v[84:87], v0, s[8:11], s48 offen offset:1024
    s_waitcnt vmcnt(15)
    v_mfma_f32_16x16x32_bf16 v[16:19], a[152:155], v[88:91], v[16:19]
    v_mfma_f32_16x16x32_bf16 v[20:23], a[156:159], v[88:91], v[20:23]
    v_mfma_f32_16x16x32_bf16 v[24:27], v[204:207], v[88:91], v[24:27]
    buffer_load_dwordx4 v[88:91], v0, s[8:11], s48 offen offset:2048
    s_waitcnt vmcnt(15)
    v_mfma_f32_16x16x32_bf16 v[28:31], a[152:155], v[92:95], v[28:31]
    v_mfma_f32_16x16x32_bf16 v[32:35], a[156:159], v[92:95], v[32:35]
    v_mfma_f32_16x16x32_bf16 v[36:39], v[204:207], v[92:95], v[36:39]
    buffer_load_dwordx4 v[92:95], v0, s[8:11], s48 offen offset:3072
    s_waitcnt vmcnt(15)
    v_mfma_f32_16x16x32_bf16 v[16:19], a[160:163], v[96:99], v[16:19]
    v_mfma_f32_16x16x32_bf16 v[20:23], a[164:167], v[96:99], v[20:23]
    v_mfma_f32_16x16x32_bf16 v[24:27], v[208:211], v[96:99], v[24:27]
    s_add_u32 s48, s46, 57344
    buffer_load_dwordx4 v[96:99], v0, s[8:11], s48 offen offset:0
    s_waitcnt vmcnt(15)
    v_mfma_f32_16x16x32_bf16 v[28:31], a[160:163], v[100:103], v[28:31]
    v_mfma_f32_16x16x32_bf16 v[32:35], a[164:167], v[100:103], v[32:35]
    v_mfma_f32_16x16x32_bf16 v[36:39], v[208:211], v[100:103], v[36:39]
    buffer_load_dwordx4 v[100:103], v0, s[8:11], s48 offen offset:1024
    s_waitcnt vmcnt(15)
    v_mfma_f32_16x16x32_bf16 v[16:19], a[168:171], v[104:107], v[16:19]
    v_mfma_f32_16x16x32_bf16 v[20:23], a[172:175], v[104:107], v[20:23]
    v_mfma_f32_16x16x32_bf16 v[24:27], v[212:215], v[104:107], v[24:27]
    buffer_load_dwordx4 v[104:107], v0, s[8:11], s48 offen offset:2048
    s_waitcnt vmcnt(15)
    v_mfma_f32_16x16x32_bf16 v[28:31], a[168:171], v[108:111], v[28:31]
    v_mfma_f32_16x16x32_bf16 v[32:35], a[172:175], v[108:111], v[32:35]
    v_mfma_f32_16x16x32_bf16 v[36:39], v[212:215], v[108:111], v[36:39]
    buffer_load_dwordx4 v[108:111], v0, s[8:11], s48 offen offset:3072
    s_waitcnt vmcnt(15)
    v_mfma_f32_16x16x32_bf16 v[16:19], a[176:179], v[112:115], v[16:19]
    v_mfma_f32_16x16x32_bf16 v[20:23], a[180:183], v[112:115], v[20:23]
    v_mfma_f32_16x16x32_bf16 v[24:27], v[216:219], v[112:115], v[24:27]
    s_cmp_lg_u32 s14, 0
    s_cbranch_scc1 LtwX_nw2
    v_cmp_eq_u32 vcc, 0, v2
    v_cmp_eq_u32 s[54:55], 0, v15
    s_nop 0
    s_cmp_eq_u64 s[54:55], 0
    s_cselect_b32 s62, 2, 0
    s_cmp_eq_u64 vcc, 0
    s_cselect_b32 s62, 1, s62
    v_mov_b32 v5, s62
    ds_write_b32 v49, v5
    s_waitcnt lgkmcnt(0)
LtwX_nw2:
    s_barrier
    ds_read_b32 v6, v49
    v_xor_b32 v49, 4, v49
    s_add_u32 s48, s46, 61440
    buffer_load_dwordx4 v[112:115], v0, s[8:11], s48 offen offset:0
    s_waitcnt vmcnt(15)
    v_mfma_f32_16x16x32_bf16 v[28:31], a[176:179], v[116:119], v[28:31]
    v_mfma_f32_16x16x32_bf16 v[32:35], a[180:183], v[116:119], v[32:35]
    v_mfma_f32_16x16x32_bf16 v[36:39], v[216:219], v[116:119], v[36:39]
    buffer_load_dwordx4 v[116:119], v0, s[8:11], s48 offen offset:1024
    s_waitcnt vmcnt(15)
    v_mfma_f32_16x16x32_bf16 v[16:19], a[184:187], v[120:123], v[16:19]
    v_mfma_f32_16x16x32_bf16 v[20:23], a[188:191], v[120:123], v[20:23]
    v_mfma_f32_16x16x32_bf16 v[24:27], v[220:223], v[120:123], v[24:27]
    buffer_load_dwordx4 v[120:123], v0, s[8:11], s48 offen offset:2048
    s_waitcnt vmcnt(15)
    v_mfma_f32_16x16x32_bf16 v[28:31], a[184:187], v[124:127], v[28:31]
    v_mfma_f32_16x16x32_bf16 v[32:35], a[188:191], v[124:127], v[32:35]
    v_mfma_f32_16x16x32_bf16 v[36:39], v[220:223], v[124:127], v[36:39]
    s_waitcnt lgkmcnt(0)
    v_readfirstlane_b32 s62, v6
    s_cmp_lt_u32 s33, 29
    s_cselect_b32 s38, 1, 3
    s_cmp_eq_u32 s62, 2
    s_cselect_b32 s36, 1, 0
    s_cselect_b32 s37, s33, s32
    s_cselect_b32 s17, s38, 0
    s_add_u32 s33, s33, s17
    s_cmp_eq_u32 s62, 1
    s_cselect_b32 s17, 2, 0
    s_add_u32 s32, s32, s17
    s_lshl_b32 s56, s36, 6
    s_add_u32 s56, s56, s37
    buffer_load_dwordx4 v[124:127], v0, s[8:11], s48 offen offset:3072
    s_waitcnt vmcnt(15)
    v_mfma_f32_16x16x32_bf16 v[16:19], a[192:195], v[64:67], v[16:19]
    v_mfma_f32_16x16x32_bf16 v[20:23], a[196:199], v[64:67], v[20:23]
    v_mfma_f32_16x16x32_bf16 v[24:27], v[224:227], v[64:67], v[24:27]
    s_cmp_lt_u32 s37, 64
    s_cselect_b32 s62, s62, 0
    s_lshl_b32 s46, s56, 18
    s_add_u32 s46, s46, s58
    s_mul_i32 s41, s36, 4718592
    s_mul_i32 s17, s37, 36864
    s_add_u32 s41, s41, s17
    s_add_u32 s41, s41, 8650752
    s_cmp_lg_u32 s62, 0
    s_cselect_b32 s30, 268435456, 0
    buffer_load_dword v9, v10, s[28:31], s46 offen
    s_add_u32 s48, s46, 0
    buffer_load_dwordx4 v[64:67], v0, s[28:31], s48 offen offset:0
    s_waitcnt vmcnt(16)
    v_mfma_f32_16x16x32_bf16 v[28:31], a[192:195], v[68:71], v[28:31]
    v_mfma_f32_16x16x32_bf16 v[32:35], a[196:199], v[68:71], v[32:35]
    v_mfma_f32_16x16x32_bf16 v[36:39], v[224:227], v[68:71], v[36:39]
    buffer_load_dwordx4 v[68:71], v0, s[28:31], s48 offen offset:1024
    s_waitcnt vmcnt(16)
    v_mfma_f32_16x16x32_bf16 v[16:19], a[200:203], v[72:75], v[16:19]
    v_mfma_f32_16x16x32_bf16 v[20:23], a[204:207], v[72:75], v[20:23]
    v_mfma_f32_16x16x32_bf16 v[24:27], v[228:231], v[72:75], v[24:27]
    buffer_load_dwordx4 v[72:75], v0, s[28:31], s48 offen offset:2048
    s_waitcnt vmcnt(16)
    v_mfma_f32_16x16x32_bf16 v[28:31], a[200:203], v[76:79], v[28:31]
    v_mfma_f32_16x16x32_bf16 v[32:35], a[204:207], v[76:79], v[32:35]
    v_mfma_f32_16x16x32_bf16 v[36:39], v[228:231], v[76:79], v[36:39]
    buffer_load_dwordx4 v[76:79], v0, s[28:31], s48 offen offset:3072
    s_waitcnt vmcnt(16)
    v_mfma_f32_16x16x32_bf16 v[16:19], a[208:211], v[80:83], v[16:19]
    v_mfma_f32_16x16x32_bf16 v[20:23], a[212:215], v[80:83], v[20:23]
    v_mfma_f32_16x16x32_bf16 v[24:27], v[232:235], v[80:83], v[24:27]
    s_add_u32 s48, s46, 4096
    buffer_load_dwordx4 v[80:83], v0, s[28:31], s48 offen offset:0
    s_waitcnt vmcnt(16)
    v_mfma_f32_16x16x32_bf16 v[28:31], a[208:211], v[84:87], v[28:31]
    v_mfma_f32_16x16x32_bf16 v[32:35], a[212:215], v[84:87], v[32:35]
    v_mfma_f32_16x16x32_bf16 v[36:39], v[232:235], v[84:87], v[36:39]
    buffer_load_dwordx4 v[84:87], v0, s[28:31], s48 offen offset:1024
    s_waitcnt vmcnt(16)
    v_mfma_f32_16x16x32_bf16 v[16:19], a[216:219], v[88:91], v[16:19]
    v_mfma_f32_16x16x32_bf16 v[20:23], a[220:223], v[88:91], v[20:23]
    v_mfma_f32_16x16x32_bf16 v[24:27], v[236:239], v[88:91], v[24:27]
    buffer_load_dwordx4 v[88:91], v0, s[28:31], s48 offen offset:2048
    s_waitcnt vmcnt(16)
    v_mfma_f32_16x16x32_bf16 v[28:31], a[216:219], v[92:95], v[28:31]
    v_mfma_f32_16x16x32_bf16 v[32:35], a[220:223], v[92:95], v[32:35]
    v_mfma_f32_16x16x32_bf16 v[36:39], v[236:239], v[92:95], v[36:39]
    buffer_load_dwordx4 v[92:95], v0, s[28:31], s48 offen offset:3072
    s_waitcnt vmcnt(16)
    v_mfma_f32_16x16x32_bf16 v[16:19], a[224:227], v[96:99], v[16:19]
    v_mfma_f32_16x16x32_bf16 v[20:23], a[228:231], v[96:99], v[20:23]
    v_mfma_f32_16x16x32_bf16 v[24:27], v[240:243], v[96:99], v[24:27]
    s_add_u32 s48, s46, 8192
    buffer_load_dwordx4 v[96:99], v0, s[28:31], s48 offen offset:0
    s_waitcnt vmcnt(16)
    v_mfma_f32_16x16x32_bf16 v[28:31], a[224:227], v[100:103], v[28:31]
    v_mfma_f32_16x16x32_bf16 v[32:35], a[228:231], v[100:103], v[32:35]
    v_mfma_f32_16x16x32_bf16 v[36:39], v[240:243], v[100:103], v[36:39]
    buffer_load_dwordx4 v[100:103], v0, s[28:31], s48 offen offset:1024
    s_waitcnt vmcnt(16)
    v_mfma_f32_16x16x32_bf16 v[16:19], a[232:235], v[104:107], v[16:19]
    v_mfma_f32_16x16x32_bf16 v[20:23], a[236:239], v[104:107], v[20:23]
    v_mfma_f32_16x16x32_bf16 v[24:27], v[244:247], v[104:107], v[24:27]
    buffer_load_dwordx4 v[104:107], v0, s[28:31], s48 offen offset:2048
    s_waitcnt vmcnt(16)
    v_mfma_f32_16x16x32_bf16 v[28:31], a[232:235], v[108:111], v[28:31]
    v_mfma_f32_16x16x32_bf16 v[32:35], a[236:239], v[108:111], v[32:35]
    v_mfma_f32_16x16x32_bf16 v[36:39], v[244:247], v[108:111], v[36:39]
    buffer_load_dwordx4 v[108:111], v0, s[28:31], s48 offen offset:3072
    s_waitcnt vmcnt(16)
    v_mfma_f32_16x16x32_bf16 v[16:19], a[240:243], v[112:115], v[16:19]
    v_mfma_f32_16x16x32_bf16 v[20:23], a[244:247], v[112:115], v[20:23]
    v_mfma_f32_16x16x32_bf16 v[24:27], v[248:251], v[112:115], v[24:27]
    s_add_u32 s48, s46, 12288
    buffer_load_dwordx4 v[112:115], v0, s[28:31], s48 offen offset:0
    s_waitcnt vmcnt(16)
    v_mfma_f32_16x16x32_bf16 v[28:31], a[240:243], v[116:119], v[28:31]
    v_mfma_f32_16x16x32_bf16 v[32:35], a[244:247], v[116:119], v[32:35]
    v_mfma_f32_16x16x32_bf16 v[36:39], v[248:251], v[116:119], v[36:39]
    buffer_load_dwordx4 v[116:119], v0, s[28:31], s48 offen offset:1024
    s_waitcnt vmcnt(16)
    v_mfma_f32_16x16x32_bf16 v[16:19], a[248:251], v[120:123], v[16:19]
    v_mfma_f32_16x16x32_bf16 v[20:23], a[252:255], v[120:123], v[20:23]
    v_mfma_f32_16x16x32_bf16 v[24:27], v[252:255], v[120:123], v[24:27]
    buffer_load_dwordx4 v[120:123], v0, s[28:31], s48 offen offset:2048
    s_waitcnt vmcnt(16)
    v_mfma_f32_16x16x32_bf16 v[28:31], a[248:251], v[124:127], v[28:31]
    v_mfma_f32_16x16x32_bf16 v[32:35], a[252:255], v[124:127], v[32:35]
    v_mfma_f32_16x16x32_bf16 v[36:39], v[252:255], v[124:127], v[36:39]
    s_nop 5
    ds_write_b128 v48, v[16:19] offset:0
    ds_write_b128 v48, v[20:23] offset:1024
    ds_write_b128 v48, v[24:27] offset:2048
    ds_write_b128 v48, v[28:31] offset:3072
    ds_write_b128 v48, v[32:35] offset:4096
    ds_write_b128 v48, v[36:39] offset:5120
    s_waitcnt lgkmcnt(0)
    s_barrier
    ds_read_b128 v[24:27], v50 offset:0
    ds_read_b128 v[28:31], v50 offset:1024
    ds_read_b128 v[32:35], v50 offset:6144
    ds_read_b128 v[36:39], v50 offset:7168
    ds_read_b128 v[56:59], v50 offset:12288
    ds_read_b128 v[60:63], v50 offset:13312
    ds_read_b128 v[124:127], v50 offset:18432
    ds_read_b128 v[52:55], v50 offset:19456
    v_xor_b32 v48, 0x8000, v48
    v_xor_b32 v50, 0x8000, v50
    v_lshlrev_b32 v16, 16, v40
    v_and_b32 v20, 0xffff0000, v40
    v_lshlrev_b32 v17, 16, v41
    v_and_b32 v21, 0xffff0000, v41
    v_lshlrev_b32 v18, 16, v42
    v_and_b32 v22, 0xffff0000, v42
    v_lshlrev_b32 v19, 16, v43
    v_and_b32 v23, 0xffff0000, v43
    buffer_load_dwordx4 v[40:43], v12, s[28:31], s41 offen
    s_waitcnt lgkmcnt(7)
    v_add_f32 v16, v16, v24
    v_add_f32 v17, v17, v25
    v_add_f32 v18, v18, v26
    v_add_f32 v19, v19, v27
    s_waitcnt lgkmcnt(6)
    v_add_f32 v20, v20, v28
    v_add_f32 v21, v21, v29
    v_add_f32 v22, v22, v30
    v_add_f32 v23, v23, v31
    s_waitcnt lgkmcnt(5)
    v_add_f32 v16, v16, v32
    v_add_f32 v17, v17, v33
    v_add_f32 v18, v18, v34
    v_add_f32 v19, v19, v35
    s_waitcnt lgkmcnt(4)
    v_add_f32 v20, v20, v36
    v_add_f32 v21, v21, v37
    v_add_f32 v22, v22, v38
    v_add_f32 v23, v23, v39
    s_waitcnt lgkmcnt(3)
    v_add_f32 v16, v16, v56
    v_add_f32 v17, v17, v57
    v_add_f32 v18, v18, v58
    v_add_f32 v19, v19, v59
    s_waitcnt lgkmcnt(2)
    v_add_f32 v20, v20, v60
    v_add_f32 v21, v21, v61
    v_add_f32 v22, v22, v62
    v_add_f32 v23, v23, v63
    s_waitcnt lgkmcnt(1)
    v_add_f32 v16, v16, v124
    v_add_f32 v17, v17, v125
    v_add_f32 v18, v18, v126
    v_add_f32 v19, v19, v127
    s_waitcnt lgkmcnt(0)
    v_add_f32 v20, v20, v52
    v_add_f32 v21, v21, v53
    v_add_f32 v22, v22, v54
    v_add_f32 v23, v23, v55
    v_cvt_pk_bf16_f32 v52, v16, v20
    v_cvt_pk_bf16_f32 v53, v17, v21
    v_cvt_pk_bf16_f32 v54, v18, v22
    v_cvt_pk_bf16_f32 v55, v19, v23
    s_cmp_eq_u32 s34, 0
    s_cbranch_scc1 LtwX_l0
    s_mul_i32 s17, s35, 36864
    buffer_store_dwordx4 v[52:55], v13, s[24:27], s17 offen sc1
    s_cmp_lg_u32 s62, 0
    s_cbranch_scc1 LtwX_item
LtwX_chk:
    s_min_u32 s17, s32, s33
    s_cmp_lt_u32 s17, 64
    s_cbranch_scc1 LtwX_idle
    s_branch L_role_tw_exit
LtwX_l0:
    s_add_u32 s47, s47, 2359296
    buffer_store_dwordx4 v[52:55], v12, s[8:11], s47 offen sc1
    v_add_f32 v44, v16, v17
    v_mul_f32 v45, v16, v16
    v_fmac_f32 v45, v17, v17
    v_add_f32 v44, v44, v18
    v_fmac_f32 v45, v18, v18
    v_add_f32 v44, v44, v19
    v_fmac_f32 v45, v19, v19
    v_add_f32 v44, v44, v20
    v_fmac_f32 v45, v20, v20
    v_add_f32 v44, v44, v21
    v_fmac_f32 v45, v21, v21
    v_add_f32 v44, v44, v22
    v_fmac_f32 v45, v22, v22
    v_add_f32 v44, v44, v23
    v_fmac_f32 v45, v23, v23
    v_mov_b32 v46, v44
    v_mov_b32 v47, v45
    s_nop 0
    v_permlane32_swap_b32 v44, v46
    v_permlane32_swap_b32 v45, v47
    v_add_f32 v44, v44, v46
    v_add_f32 v45, v45, v47
    v_mov_b32 v46, v44
    v_mov_b32 v47, v45
    s_nop 0
    v_permlane16_swap_b32 v44, v46
    v_permlane16_swap_b32 v45, v47
    v_add_f32 v44, v44, v46
    v_add_f32 v45, v45, v47
    s_mul_i32 s17, s35, 6144
    s_add_u32 s17, s17, 16515072
    s_mov_b64 exec, 0xffff
    buffer_store_dwordx2 v[44:45], v14, s[8:11], s17 offen sc1
    s_mov_b64 exec, -1
    s_mul_i32 s43, s35, 22528
    s_add_u32 s43, s43, s49
    s_cmp_lg_u32 s62, 0
    s_cbranch_scc1 LtwX_item
    s_waitcnt vmcnt(0)
    s_mov_b64 exec, 1
    buffer_store_dword v3, v4, s[8:11], s43 offen sc1
    s_mov_b64 exec, -1
    s_mov_b32 s43, 0
    s_branch LtwX_chk
Ltw_z:
    v_lshrrev_b32 v5, 1, v8
    v_lshl_add_u32 v12, v5, 9, v12
    v_and_b32 v5, 1, v8
    v_lshl_add_u32 v12, v5, 3, v12
    v_add_u32 v12, 2048, v12
    v_lshl_add_u32 v13, v8, 3, v13
    v_add_u32 v13, 64, v13
    v_add_u32 v14, 8, v14
    s_lshl_b32 s58, s14, 16
    s_add_u32 s58, s58, 144703488
    s_mov_b32 s43, 0
    s_mov_b32 s28, s8
    s_mov_b32 s29, s9
    s_mov_b32 s30, 0
    s_mov_b32 s31, 0x00020000
    s_mul_i32 s17, s51, 3072
    v_add_u32 v50, s17, v0
    ds_write2_b32 v49, v4, v4 offset0:0 offset1:1
    s_waitcnt lgkmcnt(0)
    s_cmp_lg_u32 s14, 0
    s_cbranch_scc1 LtwZ_inia_d
    v_mov_b32 v5, 40
    s_mov_b32 s16, 0
LtwZ_inia:
    global_load_dword v6, v5, s[12:13] sc1
    s_add_u32 s16, s16, 1
    s_cmp_gt_u32 s16, 100000
    s_cbranch_scc1 L_role_tw_abort
    s_waitcnt vmcnt(0)
    v_cmp_gt_u32 vcc, 72, v6
    s_nop 0
    s_cbranch_vccz LtwZ_inia_d
    s_sleep 8
    s_branch LtwZ_inia
LtwZ_inia_d:
    s_barrier
    s_cmp_lg_u32 s14, 0
    s_cbranch_scc1 LtwZ_inib_d
    v_mov_b32 v5, 160
    s_mov_b32 s16, 0
LtwZ_inib:
    global_load_dword v6, v5, s[12:13] sc1
    s_add_u32 s16, s16, 1
    s_cmp_gt_u32 s16, 100000
    s_cbranch_scc1 L_role_tw_abort
    s_waitcnt vmcnt(0)
    v_cmp_gt_u32 vcc, 64, v6
    s_nop 0
    s_cbranch_vccz LtwZ_inib_d
    s_sleep 8
    s_branch LtwZ_inib
LtwZ_inib_d:
    s_barrier
LtwZ_idle:
    s_barrier
    ds_read_b32 v6, v49
    v_xor_b32 v49, 4, v49
    s_waitcnt lgkmcnt(0)
    v_readfirstlane_b32 s62, v6
    s_nop 0
    s_cmp_eq_u32 s62, 0
    s_cbranch_scc1 L_role_tw_abort
    s_cmp_lt_u32 s33, 29
    s_cselect_b32 s38, 1, 3
    s_cmp_eq_u32 s62, 2
    s_cselect_b32 s36, 1, 0
    s_cselect_b32 s37, s33, s32
    s_cselect_b32 s17, s38, 0
    s_add_u32 s33, s33, s17
    s_cmp_eq_u32 s62, 1
    s_cselect_b32 s17, 2, 0
    s_add_u32 s32, s32, s17
    s_lshl_b32 s56, s36, 6
    s_add_u32 s56, s56, s37
    s_lshl_b32 s46, s56, 18
    s_add_u32 s46, s46, s58
    s_mul_i32 s41, s36, 4718592
    s_mul_i32 s17, s37, 36864
    s_add_u32 s41, s41, s17
    s_add_u32 s41, s41, 8650752
    s_cmp_ge_u32 s37, 64
    s_cbranch_scc1 L_role_tw_abort
    buffer_load_dword v9, v10, s[8:11], s46 offen
    s_add_u32 s48, s46, 0
    buffer_load_dwordx4 v[64:67], v0, s[8:11], s48 offen offset:0
    buffer_load_dwordx4 v[68:71], v0, s[8:11], s48 offen offset:1024
    buffer_load_dwordx4 v[72:75], v0, s[8:11], s48 offen offset:2048
    buffer_load_dwordx4 v[76:79], v0, s[8:11], s48 offen offset:3072
    s_add_u32 s48, s46, 4096
    buffer_load_dwordx4 v[80:83], v0, s[8:11], s48 offen offset:0
    buffer_load_dwordx4 v[84:87], v0, s[8:11], s48 offen offset:1024
    buffer_load_dwordx4 v[88:91], v0, s[8:11], s48 offen offset:2048
    buffer_load_dwordx4 v[92:95], v0, s[8:11], s48 offen offset:3072
    s_add_u32 s48, s46, 8192
    buffer_load_dwordx4 v[96:99], v0, s[8:11], s48 offen offset:0
    buffer_load_dwordx4 v[100:103], v0, s[8:11], s48 offen offset:1024
    buffer_load_dwordx4 v[104:107], v0, s[8:11], s48 offen offset:2048
    buffer_load_dwordx4 v[108:111], v0, s[8:11], s48 offen offset:3072
    s_add_u32 s48, s46, 12288
    buffer_load_dwordx4 v[112:115], v0, s[8:11], s48 offen offset:0
    buffer_load_dwordx4 v[116:119], v0, s[8:11], s48 offen offset:1024
    buffer_load_dwordx4 v[120:123], v0, s[8:11], s48 offen offset:2048
    buffer_load_dwordx2 v[40:41], v12, s[8:11], s41 offen
LtwZ_item:
    s_mov_b32 s34, s36
    s_mov_b32 s35, s37
    s_mov_b32 s47, s41
    buffer_load_dwordx4 v[124:127], v0, s[8:11], s48 offen offset:3072
    s_waitcnt vmcnt(15)
    v_mfma_f32_16x16x32_bf16 v[16:19], a[0:3], v[64:67], 0
    v_mfma_f32_16x16x32_bf16 v[20:23], a[4:7], v[64:67], 0
    v_mfma_f32_16x16x32_bf16 v[24:27], v[128:131], v[64:67], 0
    s_add_u32 s48, s46, 16384
    buffer_load_dwordx4 v[64:67], v0, s[8:11], s48 offen offset:0
    s_waitcnt vmcnt(15)
    v_mfma_f32_16x16x32_bf16 v[28:31], a[0:3], v[68:71], 0
    v_mfma_f32_16x16x32_bf16 v[32:35], a[4:7], v[68:71], 0
    v_mfma_f32_16x16x32_bf16 v[36:39], v[128:131], v[68:71], 0
    buffer_load_dwordx4 v[68:71], v0, s[8:11], s48 offen offset:1024
    s_waitcnt vmcnt(15)
    v_mfma_f32_16x16x32_bf16 v[16:19], a[8:11], v[72:75], v[16:19]
    v_mfma_f32_16x16x32_bf16 v[20:23], a[12:15], v[72:75], v[20:23]
    v_mfma_f32_16x16x32_bf16 v[24:27], v[132:135], v[72:75], v[24:27]
    buffer_load_dwordx4 v[72:75], v0, s[8:11], s48 offen offset:2048
    s_waitcnt vmcnt(15)
    v_mfma_f32_16x16x32_bf16 v[28:31], a[8:11], v[76:79], v[28:31]
    v_mfma_f32_16x16x32_bf16 v[32:35], a[12:15], v[76:79], v[32:35]
    v_mfma_f32_16x16x32_bf16 v[36:39], v[132:135], v[76:79], v[36:39]
    buffer_load_dwordx4 v[76:79], v0, s[8:11], s48 offen offset:3072
    s_waitcnt vmcnt(15)
    v_mfma_f32_16x16x32_bf16 v[16:19], a[16:19], v[80:83], v[16:19]
    v_mfma_f32_16x16x32_bf16 v[20:23], a[20:23], v[80:83], v[20:23]
    v_mfma_f32_16x16x32_bf16 v[24:27], v[136:139], v[80:83], v[24:27]
    s_add_u32 s48, s46, 20480
    buffer_load_dwordx4 v[80:83], v0, s[8:11], s48 offen offset:0
    s_waitcnt vmcnt(15)
    v_mfma_f32_16x16x32_bf16 v[28:31], a[16:19], v[84:87], v[28:31]
    v_mfma_f32_16x16x32_bf16 v[32:35], a[20:23], v[84:87], v[32:35]
    v_mfma_f32_16x16x32_bf16 v[36:39], v[136:139], v[84:87], v[36:39]
    buffer_load_dwordx4 v[84:87], v0, s[8:11], s48 offen offset:1024
    s_waitcnt vmcnt(15)
    v_mfma_f32_16x16x32_bf16 v[16:19], a[24:27], v[88:91], v[16:19]
    v_mfma_f32_16x16x32_bf16 v[20:23], a[28:31], v[88:91], v[20:23]
    v_mfma_f32_16x16x32_bf16 v[24:27], v[140:143], v[88:91], v[24:27]
    buffer_load_dwordx4 v[88:91], v0, s[8:11], s48 offen offset:2048
    s_waitcnt vmcnt(15)
    v_mfma_f32_16x16x32_bf16 v[28:31], a[24:27], v[92:95], v[28:31]
    v_mfma_f32_16x16x32_bf16 v[32:35], a[28:31], v[92:95], v[32:35]
    v_mfma_f32_16x16x32_bf16 v[36:39], v[140:143], v[92:95], v[36:39]
    buffer_load_dwordx4 v[92:95], v0, s[8:11], s48 offen offset:3072
    s_waitcnt vmcnt(15)
    v_mfma_f32_16x16x32_bf16 v[16:19], a[32:35], v[96:99], v[16:19]
    v_mfma_f32_16x16x32_bf16 v[20:23], a[36:39], v[96:99], v[20:23]
    v_mfma_f32_16x16x32_bf16 v[24:27], v[144:147], v[96:99], v[24:27]
    s_add_u32 s48, s46, 24576
    buffer_load_dwordx4 v[96:99], v0, s[8:11], s48 offen offset:0
    s_waitcnt vmcnt(15)
    v_mfma_f32_16x16x32_bf16 v[28:31], a[32:35], v[100:103], v[28:31]
    v_mfma_f32_16x16x32_bf16 v[32:35], a[36:39], v[100:103], v[32:35]
    v_mfma_f32_16x16x32_bf16 v[36:39], v[144:147], v[100:103], v[36:39]
    buffer_load_dwordx4 v[100:103], v0, s[8:11], s48 offen offset:1024
    s_waitcnt vmcnt(15)
    v_mfma_f32_16x16x32_bf16 v[16:19], a[40:43], v[104:107], v[16:19]
    v_mfma_f32_16x16x32_bf16 v[20:23], a[44:47], v[104:107], v[20:23]
    v_mfma_f32_16x16x32_bf16 v[24:27], v[148:151], v[104:107], v[24:27]
    buffer_load_dwordx4 v[104:107], v0, s[8:11], s48 offen offset:2048
    s_waitcnt vmcnt(15)
    v_mfma_f32_16x16x32_bf16 v[28:31], a[40:43], v[108:111], v[28:31]
    v_mfma_f32_16x16x32_bf16 v[32:35], a[44:47], v[108:111], v[32:35]
    v_mfma_f32_16x16x32_bf16 v[36:39], v[148:151], v[108:111], v[36:39]
    buffer_load_dwordx4 v[108:111], v0, s[8:11], s48 offen offset:3072
    s_waitcnt vmcnt(15)
    v_mfma_f32_16x16x32_bf16 v[16:19], a[48:51], v[112:115], v[16:19]
    v_mfma_f32_16x16x32_bf16 v[20:23], a[52:55], v[112:115], v[20:23]
    v_mfma_f32_16x16x32_bf16 v[24:27], v[152:155], v[112:115], v[24:27]
    s_add_u32 s48, s46, 28672
    buffer_load_dwordx4 v[112:115], v0, s[8:11], s48 offen offset:0
    s_waitcnt vmcnt(15)
    v_mfma_f32_16x16x32_bf16 v[28:31], a[48:51], v[116:119], v[28:31]
    v_mfma_f32_16x16x32_bf16 v[32:35], a[52:55], v[116:119], v[32:35]
    v_mfma_f32_16x16x32_bf16 v[36:39], v[152:155], v[116:119], v[36:39]
    buffer_load_dwordx4 v[116:119], v0, s[8:11], s48 offen offset:1024
    s_waitcnt vmcnt(15)
    v_mfma_f32_16x16x32_bf16 v[16:19], a[56:59], v[120:123], v[16:19]
    v_mfma_f32_16x16x32_bf16 v[20:23], a[60:63], v[120:123], v[20:23]
    v_mfma_f32_16x16x32_bf16 v[24:27], v[156:159], v[120:123], v[24:27]
    buffer_load_dwordx4 v[120:123], v0, s[8:11], s48 offen offset:2048
    s_waitcnt vmcnt(15)
    v_mfma_f32_16x16x32_bf16 v[28:31], a[56:59], v[124:127], v[28:31]
    v_mfma_f32_16x16x32_bf16 v[32:35], a[60:63], v[124:127], v[32:35]
    v_mfma_f32_16x16x32_bf16 v[36:39], v[156:159], v[124:127], v[36:39]
    buffer_load_dwordx4 v[124:127], v0, s[8:11], s48 offen offset:3072
    s_waitcnt vmcnt(15)
    v_mfma_f32_16x16x32_bf16 v[16:19], a[64:67], v[64:67], v[16:19]
    v_mfma_f32_16x16x32_bf16 v[20:23], a[68:71], v[64:67], v[20:23]
    v_mfma_f32_16x16x32_bf16 v[24:27], v[160:163], v[64:67], v[24:27]
    s_add_u32 s48, s46, 32768
    buffer_load_dwordx4 v[64:67], v0, s[8:11], s48 offen offset:0
    s_waitcnt vmcnt(15)
    v_mfma_f32_16x16x32_bf16 v[28:31], a[64:67], v[68:71], v[28:31]
    v_mfma_f32_16x16x32_bf16 v[32:35], a[68:71], v[68:71], v[32:35]
    v_mfma_f32_16x16x32_bf16 v[36:39], v[160:163], v[68:71], v[36:39]
    s_cmp_lg_u32 s43, 0
    s_cselect_b64 exec, 1, 0
    buffer_store_dword v3, v4, s[8:11], s43 offen sc1
    s_mov_b64 exec, -1
    s_mov_b32 s43, 0
    buffer_load_dwordx4 v[68:71], v0, s[8:11], s48 offen offset:1024
    s_waitcnt vmcnt(16)
    v_mfma_f32_16x16x32_bf16 v[16:19], a[72:75], v[72:75], v[16:19]
    v_mfma_f32_16x16x32_bf16 v[20:23], a[76:79], v[72:75], v[20:23]
    v_mfma_f32_16x16x32_bf16 v[24:27], v[164:167], v[72:75], v[24:27]
    buffer_load_dwordx4 v[72:75], v0, s[8:11], s48 offen offset:2048
    s_waitcnt vmcnt(16)
    v_mfma_f32_16x16x32_bf16 v[28:31], a[72:75], v[76:79], v[28:31]
    v_mfma_f32_16x16x32_bf16 v[32:35], a[76:79], v[76:79], v[32:35]
    v_mfma_f32_16x16x32_bf16 v[36:39], v[164:167], v[76:79], v[36:39]
    buffer_load_dwordx4 v[76:79], v0, s[8:11], s48 offen offset:3072
    s_waitcnt vmcnt(16)
    v_mfma_f32_16x16x32_bf16 v[16:19], a[80:83], v[80:83], v[16:19]
    v_mfma_f32_16x16x32_bf16 v[20:23], a[84:87], v[80:83], v[20:23]
    v_mfma_f32_16x16x32_bf16 v[24:27], v[168:171], v[80:83], v[24:27]
    s_add_u32 s48, s46, 36864
    buffer_load_dwordx4 v[80:83], v0, s[8:11], s48 offen offset:0
    s_waitcnt vmcnt(16)
    v_mfma_f32_16x16x32_bf16 v[28:31], a[80:83], v[84:87], v[28:31]
    v_mfma_f32_16x16x32_bf16 v[32:35], a[84:87], v[84:87], v[32:35]
    v_mfma_f32_16x16x32_bf16 v[36:39], v[168:171], v[84:87], v[36:39]
    buffer_load_dwordx4 v[84:87], v0, s[8:11], s48 offen offset:1024
    s_waitcnt vmcnt(16)
    v_mfma_f32_16x16x32_bf16 v[16:19], a[88:91], v[88:91], v[16:19]
    v_mfma_f32_16x16x32_bf16 v[20:23], a[92:95], v[88:91], v[20:23]
    v_mfma_f32_16x16x32_bf16 v[24:27], v[172:175], v[88:91], v[24:27]
    buffer_load_dwordx4 v[88:91], v0, s[8:11], s48 offen offset:2048
    s_waitcnt vmcnt(16)
    v_mfma_f32_16x16x32_bf16 v[28:31], a[88:91], v[92:95], v[28:31]
    v_mfma_f32_16x16x32_bf16 v[32:35], a[92:95], v[92:95], v[32:35]
    v_mfma_f32_16x16x32_bf16 v[36:39], v[172:175], v[92:95], v[36:39]
    buffer_load_dwordx4 v[92:95], v0, s[8:11], s48 offen offset:3072
    s_waitcnt vmcnt(16)
    v_mfma_f32_16x16x32_bf16 v[16:19], a[96:99], v[96:99], v[16:19]
    v_mfma_f32_16x16x32_bf16 v[20:23], a[100:103], v[96:99], v[20:23]
    v_mfma_f32_16x16x32_bf16 v[24:27], v[176:179], v[96:99], v[24:27]
    s_add_u32 s48, s46, 40960
    buffer_load_dwordx4 v[96:99], v0, s[8:11], s48 offen offset:0
    s_waitcnt vmcnt(16)
    v_mfma_f32_16x16x32_bf16 v[28:31], a[96:99], v[100:103], v[28:31]
    v_mfma_f32_16x16x32_bf16 v[32:35], a[100:103], v[100:103], v[32:35]
    v_mfma_f32_16x16x32_bf16 v[36:39], v[176:179], v[100:103], v[36:39]
    buffer_load_dwordx4 v[100:103], v0, s[8:11], s48 offen offset:1024
    s_waitcnt vmcnt(16)
    v_mfma_f32_16x16x32_bf16 v[16:19], a[104:107], v[104:107], v[16:19]
    v_mfma_f32_16x16x32_bf16 v[20:23], a[108:111], v[104:107], v[20:23]
    v_mfma_f32_16x16x32_bf16 v[24:27], v[180:183], v[104:107], v[24:27]
    buffer_load_dwordx4 v[104:107], v0, s[8:11], s48 offen offset:2048
    s_waitcnt vmcnt(16)
    v_mfma_f32_16x16x32_bf16 v[28:31], a[104:107], v[108:111], v[28:31]
    v_mfma_f32_16x16x32_bf16 v[32:35], a[108:111], v[108:111], v[32:35]
    v_mfma_f32_16x16x32_bf16 v[36:39], v[180:183], v[108:111], v[36:39]
    buffer_load_dwordx4 v[108:111], v0, s[8:11], s48 offen offset:3072
    s_waitcnt vmcnt(16)
    v_mfma_f32_16x16x32_bf16 v[16:19], a[112:115], v[112:115], v[16:19]
    v_mfma_f32_16x16x32_bf16 v[20:23], a[116:119], v[112:115], v[20:23]
    v_mfma_f32_16x16x32_bf16 v[24:27], v[184:187], v[112:115], v[24:27]
    s_add_u32 s48, s46, 45056
    buffer_load_dwordx4 v[112:115], v0, s[8:11], s48 offen offset:0
    s_waitcnt vmcnt(16)
    v_mfma_f32_16x16x32_bf16 v[28:31], a[112:115], v[116:119], v[28:31]
    v_mfma_f32_16x16x32_bf16 v[32:35], a[116:119], v[116:119], v[32:35]
    v_mfma_f32_16x16x32_bf16 v[36:39], v[184:187], v[116:119], v[36:39]
    buffer_load_dwordx4 v[116:119], v0, s[8:11], s48 offen offset:1024
    s_waitcnt vmcnt(16)
    v_mfma_f32_16x16x32_bf16 v[16:19], a[120:123], v[120:123], v[16:19]
    v_mfma_f32_16x16x32_bf16 v[20:23], a[124:127], v[120:123], v[20:23]
    v_mfma_f32_16x16x32_bf16 v[24:27], v[188:191], v[120:123], v[24:27]
    buffer_load_dwordx4 v[120:123], v0, s[8:11], s48 offen offset:2048
    s_waitcnt vmcnt(16)
    v_mfma_f32_16x16x32_bf16 v[28:31], a[120:123], v[124:127], v[28:31]
    v_mfma_f32_16x16x32_bf16 v[32:35], a[124:127], v[124:127], v[32:35]
    v_mfma_f32_16x16x32_bf16 v[36:39], v[188:191], v[124:127], v[36:39]
    buffer_load_dwordx4 v[124:127], v0, s[8:11], s48 offen offset:3072
    s_waitcnt vmcnt(16)
    v_mfma_f32_16x16x32_bf16 v[16:19], a[128:131], v[64:67], v[16:19]
    v_mfma_f32_16x16x32_bf16 v[20:23], a[132:135], v[64:67], v[20:23]
    v_mfma_f32_16x16x32_bf16 v[24:27], v[192:195], v[64:67], v[24:27]
    s_add_u32 s48, s46, 49152
    buffer_load_dwordx4 v[64:67], v0, s[8:11], s48 offen offset:0
    s_waitcnt vmcnt(15)
    v_mfma_f32_16x16x32_bf16 v[28:31], a[128:131], v[68:71], v[28:31]
    v_mfma_f32_16x16x32_bf16 v[32:35], a[132:135], v[68:71], v[32:35]
    v_mfma_f32_16x16x32_bf16 v[36:39], v[192:195], v[68:71], v[36:39]
    buffer_load_dwordx4 v[68:71], v0, s[8:11], s48 offen offset:1024
    s_waitcnt vmcnt(15)
    v_mfma_f32_16x16x32_bf16 v[16:19], a[136:139], v[72:75], v[16:19]
    v_mfma_f32_16x16x32_bf16 v[20:23], a[140:143], v[72:75], v[20:23]
    v_mfma_f32_16x16x32_bf16 v[24:27], v[196:199], v[72:75], v[24:27]
    buffer_load_dwordx4 v[72:75], v0, s[8:11], s48 offen offset:2048
    s_waitcnt vmcnt(15)
    v_mfma_f32_16x16x32_bf16 v[28:31], a[136:139], v[76:79], v[28:31]
    v_mfma_f32_16x16x32_bf16 v[32:35], a[140:143], v[76:79], v[32:35]
    v_mfma_f32_16x16x32_bf16 v[36:39], v[196:199], v[76:79], v[36:39]
    buffer_load_dwordx4 v[76:79], v0, s[8:11], s48 offen offset:3072
    s_waitcnt vmcnt(15)
    v_mfma_f32_16x16x32_bf16 v[16:19], a[144:147], v[80:83], v[16:19]
    v_mfma_f32_16x16x32_bf16 v[20:23], a[148:151], v[80:83], v[20:23]
    v_mfma_f32_16x16x32_bf16 v[24:27], v[200:203], v[80:83], v[24:27]
    s_add_u32 s48, s46, 53248
    buffer_load_dwordx4 v[80:83], v0, s[8:11], s48 offen offset:0
    s_waitcnt vmcnt(15)
    v_mfma_f32_16x16x32_bf16 v[28:31], a[144:147], v[84:87], v[28:31]
    v_mfma_f32_16x16x32_bf16 v[32:35], a[148:151], v[84:87], v[32:35]
    v_mfma_f32_16x16x32_bf16 v[36:39], v[200:203], v[84:87], v[36:39]
    buffer_load_dwordx4 v[84:87], v0, s[8:11], s48 offen offset:1024
    s_waitcnt vmcnt(15)
    v_mfma_f32_16x16x32_bf16 v[16:19], a[152:155], v[88:91], v[16:19]
    v_mfma_f32_16x16x32_bf16 v[20:23], a[156:159], v[88:91], v[20:23]
    v_mfma_f32_16x16x32_bf16 v[24:27], v[204:207], v[88:91], v[24:27]
    buffer_load_dwordx4 v[88:91], v0, s[8:11], s48 offen offset:2048
    s_waitcnt vmcnt(15)
    v_mfma_f32_16x16x32_bf16 v[28:31], a[152:155], v[92:95], v[28:31]
    v_mfma_f32_16x16x32_bf16 v[32:35], a[156:159], v[92:95], v[32:35]
    v_mfma_f32_16x16x32_bf16 v[36:39], v[204:207], v[92:95], v[36:39]
    buffer_load_dwordx4 v[92:95], v0, s[8:11], s48 offen offset:3072
    s_waitcnt vmcnt(15)
    v_mfma_f32_16x16x32_bf16 v[16:19], a[160:163], v[96:99], v[16:19]
    v_mfma_f32_16x16x32_bf16 v[20:23], a[164:167], v[96:99], v[20:23]
    v_mfma_f32_16x16x32_bf16 v[24:27], v[208:211], v[96:99], v[24:27]
    s_add_u32 s48, s46, 57344
    buffer_load_dwordx4 v[96:99], v0, s[8:11], s48 offen offset:0
    s_waitcnt vmcnt(15)
    v_mfma_f32_16x16x32_bf16 v[28:31], a[160:163], v[100:103], v[28:31]
    v_mfma_f32_16x16x32_bf16 v[32:35], a[164:167], v[100:103], v[32:35]
    v_mfma_f32_16x16x32_bf16 v[36:39], v[208:211], v[100:103], v[36:39]
    buffer_load_dwordx4 v[100:103], v0, s[8:11], s48 offen offset:1024
    s_waitcnt vmcnt(15)
    v_mfma_f32_16x16x32_bf16 v[16:19], a[168:171], v[104:107], v[16:19]
    v_mfma_f32_16x16x32_bf16 v[20:23], a[172:175], v[104:107], v[20:23]
    v_mfma_f32_16x16x32_bf16 v[24:27], v[212:215], v[104:107], v[24:27]
    buffer_load_dwordx4 v[104:107], v0, s[8:11], s48 offen offset:2048
    s_waitcnt vmcnt(15)
    v_mfma_f32_16x16x32_bf16 v[28:31], a[168:171], v[108:111], v[28:31]
    v_mfma_f32_16x16x32_bf16 v[32:35], a[172:175], v[108:111], v[32:35]
    v_mfma_f32_16x16x32_bf16 v[36:39], v[212:215], v[108:111], v[36:39]
    buffer_load_dwordx4 v[108:111], v0, s[8:11], s48 offen offset:3072
    s_waitcnt vmcnt(15)
    v_mfma_f32_16x16x32_bf16 v[16:19], a[176:179], v[112:115], v[16:19]
    v_mfma_f32_16x16x32_bf16 v[20:23], a[180:183], v[112:115], v[20:23]
    v_mfma_f32_16x16x32_bf16 v[24:27], v[216:219], v[112:115], v[24:27]
    s_barrier
    ds_read_b32 v6, v49
    v_xor_b32 v49, 4, v49
    s_add_u32 s48, s46, 61440
    buffer_load_dwordx4 v[112:115], v0, s[8:11], s48 offen offset:0
    s_waitcnt vmcnt(15)
    v_mfma_f32_16x16x32_bf16 v[28:31], a[176:179], v[116:119], v[28:31]
    v_mfma_f32_16x16x32_bf16 v[32:35], a[180:183], v[116:119], v[32:35]
    v_mfma_f32_16x16x32_bf16 v[36:39], v[216:219], v[116:119], v[36:39]
    buffer_load_dwordx4 v[116:119], v0, s[8:11], s48 offen offset:1024
    s_waitcnt vmcnt(15)
    v_mfma_f32_16x16x32_bf16 v[16:19], a[184:187], v[120:123], v[16:19]
    v_mfma_f32_16x16x32_bf16 v[20:23], a[188:191], v[120:123], v[20:23]
    v_mfma_f32_16x16x32_bf16 v[24:27], v[220:223], v[120:123], v[24:27]
    buffer_load_dwordx4 v[120:123], v0, s[8:11], s48 offen offset:2048
    s_waitcnt vmcnt(15)
    v_mfma_f32_16x16x32_bf16 v[28:31], a[184:187], v[124:127], v[28:31]
    v_mfma_f32_16x16x32_bf16 v[32:35], a[188:191], v[124:127], v[32:35]
    v_mfma_f32_16x16x32_bf16 v[36:39], v[220:223], v[124:127], v[36:39]
    s_waitcnt lgkmcnt(0)
    v_readfirstlane_b32 s62, v6
    s_cmp_lt_u32 s33, 29
    s_cselect_b32 s38, 1, 3
    s_cmp_eq_u32 s62, 2
    s_cselect_b32 s36, 1, 0
    s_cselect_b32 s37, s33, s32
    s_cselect_b32 s17, s38, 0
    s_add_u32 s33, s33, s17
    s_cmp_eq_u32 s62, 1
    s_cselect_b32 s17, 2, 0
    s_add_u32 s32, s32, s17
    s_lshl_b32 s56, s36, 6
    s_add_u32 s56, s56, s37
    buffer_load_dwordx4 v[124:127], v0, s[8:11], s48 offen offset:3072
    s_waitcnt vmcnt(15)
    v_mfma_f32_16x16x32_bf16 v[16:19], a[192:195], v[64:67], v[16:19]
    v_mfma_f32_16x16x32_bf16 v[20:23], a[196:199], v[64:67], v[20:23]
    v_mfma_f32_16x16x32_bf16 v[24:27], v[224:227], v[64:67], v[24:27]
    s_cmp_lt_u32 s37, 64
    s_cselect_b32 s62, s62, 0
    s_lshl_b32 s46, s56, 18
    s_add_u32 s46, s46, s58
    s_mul_i32 s41, s36, 4718592
    s_mul_i32 s17, s37, 36864
    s_add_u32 s41, s41, s17
    s_add_u32 s41, s41, 8650752
    s_cmp_lg_u32 s62, 0
    s_cselect_b32 s30, 268435456, 0
    buffer_load_dword v9, v10, s[28:31], s46 offen
    s_add_u32 s48, s46, 0
    buffer_load_dwordx4 v[64:67], v0, s[28:31], s48 offen offset:0
    s_waitcnt vmcnt(16)
    v_mfma_f32_16x16x32_bf16 v[28:31], a[192:195], v[68:71], v[28:31]
    v_mfma_f32_16x16x32_bf16 v[32:35], a[196:199], v[68:71], v[32:35]
    v_mfma_f32_16x16x32_bf16 v[36:39], v[224:227], v[68:71], v[36:39]
    buffer_load_dwordx4 v[68:71], v0, s[28:31], s48 offen offset:1024
    s_waitcnt vmcnt(16)
    v_mfma_f32_16x16x32_bf16 v[16:19], a[200:203], v[72:75], v[16:19]
    v_mfma_f32_16x16x32_bf16 v[20:23], a[204:207], v[72:75], v[20:23]
    v_mfma_f32_16x16x32_bf16 v[24:27], v[228:231], v[72:75], v[24:27]
    buffer_load_dwordx4 v[72:75], v0, s[28:31], s48 offen offset:2048
    s_waitcnt vmcnt(16)
    v_mfma_f32_16x16x32_bf16 v[28:31], a[200:203], v[76:79], v[28:31]
    v_mfma_f32_16x16x32_bf16 v[32:35], a[204:207], v[76:79], v[32:35]
    v_mfma_f32_16x16x32_bf16 v[36:39], v[228:231], v[76:79], v[36:39]
    buffer_load_dwordx4 v[76:79], v0, s[28:31], s48 offen offset:3072
    s_waitcnt vmcnt(16)
    v_mfma_f32_16x16x32_bf16 v[16:19], a[208:211], v[80:83], v[16:19]
    v_mfma_f32_16x16x32_bf16 v[20:23], a[212:215], v[80:83], v[20:23]
    v_mfma_f32_16x16x32_bf16 v[24:27], v[232:235], v[80:83], v[24:27]
    s_add_u32 s48, s46, 4096
    buffer_load_dwordx4 v[80:83], v0, s[28:31], s48 offen offset:0
    s_waitcnt vmcnt(16)
    v_mfma_f32_16x16x32_bf16 v[28:31], a[208:211], v[84:87], v[28:31]
    v_mfma_f32_16x16x32_bf16 v[32:35], a[212:215], v[84:87], v[32:35]
    v_mfma_f32_16x16x32_bf16 v[36:39], v[232:235], v[84:87], v[36:39]
    buffer_load_dwordx4 v[84:87], v0, s[28:31], s48 offen offset:1024
    s_waitcnt vmcnt(16)
    v_mfma_f32_16x16x32_bf16 v[16:19], a[216:219], v[88:91], v[16:19]
    v_mfma_f32_16x16x32_bf16 v[20:23], a[220:223], v[88:91], v[20:23]
    v_mfma_f32_16x16x32_bf16 v[24:27], v[236:239], v[88:91], v[24:27]
    buffer_load_dwordx4 v[88:91], v0, s[28:31], s48 offen offset:2048
    s_waitcnt vmcnt(16)
    v_mfma_f32_16x16x32_bf16 v[28:31], a[216:219], v[92:95], v[28:31]
    v_mfma_f32_16x16x32_bf16 v[32:35], a[220:223], v[92:95], v[32:35]
    v_mfma_f32_16x16x32_bf16 v[36:39], v[236:239], v[92:95], v[36:39]
    buffer_load_dwordx4 v[92:95], v0, s[28:31], s48 offen offset:3072
    s_waitcnt vmcnt(16)
    v_mfma_f32_16x16x32_bf16 v[16:19], a[224:227], v[96:99], v[16:19]
    v_mfma_f32_16x16x32_bf16 v[20:23], a[228:231], v[96:99], v[20:23]
    v_mfma_f32_16x16x32_bf16 v[24:27], v[240:243], v[96:99], v[24:27]
    s_add_u32 s48, s46, 8192
    buffer_load_dwordx4 v[96:99], v0, s[28:31], s48 offen offset:0
    s_waitcnt vmcnt(16)
    v_mfma_f32_16x16x32_bf16 v[28:31], a[224:227], v[100:103], v[28:31]
    v_mfma_f32_16x16x32_bf16 v[32:35], a[228:231], v[100:103], v[32:35]
    v_mfma_f32_16x16x32_bf16 v[36:39], v[240:243], v[100:103], v[36:39]
    buffer_load_dwordx4 v[100:103], v0, s[28:31], s48 offen offset:1024
    s_waitcnt vmcnt(16)
    v_mfma_f32_16x16x32_bf16 v[16:19], a[232:235], v[104:107], v[16:19]
    v_mfma_f32_16x16x32_bf16 v[20:23], a[236:239], v[104:107], v[20:23]
    v_mfma_f32_16x16x32_bf16 v[24:27], v[244:247], v[104:107], v[24:27]
    buffer_load_dwordx4 v[104:107], v0, s[28:31], s48 offen offset:2048
    s_waitcnt vmcnt(16)
    v_mfma_f32_16x16x32_bf16 v[28:31], a[232:235], v[108:111], v[28:31]
    v_mfma_f32_16x16x32_bf16 v[32:35], a[236:239], v[108:111], v[32:35]
    v_mfma_f32_16x16x32_bf16 v[36:39], v[244:247], v[108:111], v[36:39]
    buffer_load_dwordx4 v[108:111], v0, s[28:31], s48 offen offset:3072
    s_waitcnt vmcnt(16)
    v_mfma_f32_16x16x32_bf16 v[16:19], a[240:243], v[112:115], v[16:19]
    v_mfma_f32_16x16x32_bf16 v[20:23], a[244:247], v[112:115], v[20:23]
    v_mfma_f32_16x16x32_bf16 v[24:27], v[248:251], v[112:115], v[24:27]
    s_add_u32 s48, s46, 12288
    buffer_load_dwordx4 v[112:115], v0, s[28:31], s48 offen offset:0
    s_waitcnt vmcnt(16)
    v_mfma_f32_16x16x32_bf16 v[28:31], a[240:243], v[116:119], v[28:31]
    v_mfma_f32_16x16x32_bf16 v[32:35], a[244:247], v[116:119], v[32:35]
    v_mfma_f32_16x16x32_bf16 v[36:39], v[248:251], v[116:119], v[36:39]
    buffer_load_dwordx4 v[116:119], v0, s[28:31], s48 offen offset:1024
    s_waitcnt vmcnt(16)
    v_mfma_f32_16x16x32_bf16 v[16:19], a[248:251], v[120:123], v[16:19]
    v_mfma_f32_16x16x32_bf16 v[20:23], a[252:255], v[120:123], v[20:23]
    v_mfma_f32_16x16x32_bf16 v[24:27], v[252:255], v[120:123], v[24:27]
    buffer_load_dwordx4 v[120:123], v0, s[28:31], s48 offen offset:2048
    s_waitcnt vmcnt(16)
    v_mfma_f32_16x16x32_bf16 v[28:31], a[248:251], v[124:127], v[28:31]
    v_mfma_f32_16x16x32_bf16 v[32:35], a[252:255], v[124:127], v[32:35]
    v_mfma_f32_16x16x32_bf16 v[36:39], v[252:255], v[124:127], v[36:39]
    s_nop 5
    ds_write_b128 v48, v[16:19] offset:0
    ds_write_b128 v48, v[20:23] offset:1024
    ds_write_b128 v48, v[24:27] offset:2048
    ds_write_b128 v48, v[28:31] offset:3072
    ds_write_b128 v48, v[32:35] offset:4096
    ds_write_b128 v48, v[36:39] offset:5120
    s_waitcnt lgkmcnt(0)
    s_barrier
    ds_read_b128 v[24:27], v50 offset:2048
    ds_read_b128 v[28:31], v50 offset:8192
    ds_read_b128 v[32:35], v50 offset:14336
    ds_read_b128 v[36:39], v50 offset:20480
    v_xor_b32 v48, 0x8000, v48
    v_xor_b32 v50, 0x8000, v50
    v_lshlrev_b32 v16, 16, v40
    v_and_b32 v17, 0xffff0000, v40
    v_lshlrev_b32 v18, 16, v41
    v_and_b32 v19, 0xffff0000, v41
    buffer_load_dwordx2 v[40:41], v12, s[28:31], s41 offen
    s_waitcnt lgkmcnt(3)
    v_add_f32 v16, v16, v24
    v_add_f32 v17, v17, v25
    v_add_f32 v18, v18, v26
    v_add_f32 v19, v19, v27
    s_waitcnt lgkmcnt(2)
    v_add_f32 v16, v16, v28
    v_add_f32 v17, v17, v29
    v_add_f32 v18, v18, v30
    v_add_f32 v19, v19, v31
    s_waitcnt lgkmcnt(1)
    v_add_f32 v16, v16, v32
    v_add_f32 v17, v17, v33
    v_add_f32 v18, v18, v34
    v_add_f32 v19, v19, v35
    s_waitcnt lgkmcnt(0)
    v_add_f32 v16, v16, v36
    v_add_f32 v17, v17, v37
    v_add_f32 v18, v18, v38
    v_add_f32 v19, v19, v39
    v_cvt_pk_bf16_f32 v52, v16, v17
    v_cvt_pk_bf16_f32 v53, v18, v19
    s_cmp_eq_u32 s34, 0
    s_cbranch_scc1 LtwZ_l0
    s_mul_i32 s17, s35, 36864
    buffer_store_dwordx2 v[52:53], v13, s[24:27], s17 offen sc1
    s_cmp_lg_u32 s62, 0
    s_cbranch_scc1 LtwZ_item
LtwZ_chk:
    s_min_u32 s17, s32, s33
    s_cmp_lt_u32 s17, 64
    s_cbranch_scc1 LtwZ_idle
    s_branch L_role_tw_exit
LtwZ_l0:
    s_add_u32 s47, s47, 2359296
    buffer_store_dwordx2 v[52:53], v12, s[8:11], s47 offen sc1
    v_add_f32 v44, v16, v17
    v_mul_f32 v45, v16, v16
    v_fmac_f32 v45, v17, v17
    v_add_f32 v44, v44, v18
    v_fmac_f32 v45, v18, v18
    v_add_f32 v44, v44, v19
    v_fmac_f32 v45, v19, v19
    v_mov_b32 v46, v44
    v_mov_b32 v47, v45
    s_nop 0
    v_permlane32_swap_b32 v44, v46
    v_permlane32_swap_b32 v45, v47
    v_add_f32 v44, v44, v46
    v_add_f32 v45, v45, v47
    v_mov_b32 v46, v44
    v_mov_b32 v47, v45
    s_nop 0
    v_permlane16_swap_b32 v44, v46
    v_permlane16_swap_b32 v45, v47
    v_add_f32 v44, v44, v46
    v_add_f32 v45, v45, v47
    s_mul_i32 s17, s35, 6144
    s_add_u32 s17, s17, 16515072
    s_mov_b64 exec, 0xffff
    buffer_store_dwordx2 v[44:45], v14, s[8:11], s17 offen sc1
    s_mov_b64 exec, -1
    s_mul_i32 s43, s35, 22528
    s_add_u32 s43, s43, s49
    s_cmp_lg_u32 s62, 0
    s_cbranch_scc1 LtwZ_item
    s_waitcnt vmcnt(0)
    s_mov_b64 exec, 1
    buffer_store_dword v3, v4, s[8:11], s43 offen sc1
    s_mov_b64 exec, -1
    s_mov_b32 s43, 0
    s_branch LtwZ_chk
L_role_tw_abort:
    s_waitcnt lgkmcnt(0)
    s_mov_b64 exec, -1
    v_mov_b32 v0, 60
    s_lshl_b32 s5, s3, 8
    s_or_b32 s5, s5, s4
    s_or_b32 s5, s5, 0x10000
    v_mov_b32 v1, s5
    global_store_dword v0, v1, s[12:13]
    s_endpgm
L_role_tw_exit:
    s_endpgm
.p2align 6
L_role_r:
    s_mov_b32 s32, s3
    s_mov_b32 s15, s4
    v_and_b32 v60, 63, v0
    v_and_b32 v61, 15, v60
    v_lshrrev_b32 v62, 4, v60
    v_lshlrev_b32 v0, 4, v60
    s_mul_i32 s17, s14, 34816
    s_add_u32 s17, s17, 23296
    v_add_u32 v8, s17, v0
    s_mov_b32 s50, 0xfffffffe
    s_mov_b32 s44, 0x3e0293ee
    s_mov_b32 s45, 0x3e0293ee
    s_mov_b32 s52, 0x3f803f80
    s_mov_b32 s53, 0x3f803f80
    s_mov_b32 s40, 1
    s_mov_b32 s46, 0x00ff00ff
    s_cmp_eq_u32 s14, 2
    s_cselect_b32 s46, 0x00030003, s46
    s_mov_b32 s47, s46
    v_bfe_u32 v63, v61, 1, 1
    v_mov_b32 v1, 0x4444
    v_mov_b32 v64, 0xeeee
    v_cmp_eq_u32 vcc, 0, v63
    s_nop 1
    v_cndmask_b32 v1, v64, v1, vcc
    v_mul_u32_u24 v64, 1152, v62
    v_lshl_add_u32 v2, v61, 2, v64
    s_lshl_b32 s17, s14, 6
    s_add_u32 s18, s17, 0
    v_add_u32 v2, s18, v2
    v_mul_u32_u24 v64, 288, v61
    v_lshl_add_u32 v3, v62, 4, v64
    v_add_u32 v3, 0, v3
    v_lshrrev_b32 v64, 2, v61
    v_and_b32 v65, 1, v61
    v_lshl_add_u32 v64, v64, 1, v65
    v_mul_u32_u24 v65, 288, v64
    v_lshl_add_u32 v4, v62, 5, v65
    v_lshl_add_u32 v4, v63, 4, v4
    v_add_u32 v4, 4608, v4
    v_xor_b32 v63, 1, v63
    v_mul_u32_u24 v63, 2304, v63
    v_add_u32 v5, v65, v63
    v_lshl_add_u32 v5, v62, 4, v5
    s_add_u32 s18, s17, 4608
    v_add_u32 v5, s18, v5
    s_lshr_b32 s70, s15, 3
    s_bfe_u32 s71, s15, 0x20001
    s_and_b32 s72, s15, 1
    v_bfe_u32 v64, v61, 2, 1
    v_lshl_add_u32 v63, v64, 2, v62
    v_mul_u32_u24 v63, 9216, v63
    v_lshrrev_b32 v65, 3, v61
    v_lshlrev_b32 v65, 2, v65
    v_and_b32 v64, 3, v61
    v_add_u32 v65, v65, v64
    s_lshl_b32 s73, s71, 4
    s_lshl_b32 s17, s72, 3
    s_add_u32 s73, s73, s17
    v_add_u32 v65, s73, v65
    s_lshl_b32 s17, s70, 6
    v_add_u32 v65, s17, v65
    s_cmp_eq_u32 s14, 2
    s_cselect_b32 s17, 2, 4
    v_lshlrev_b32 v65, s17, v65
    v_add_u32 v6, v63, v65
    s_lshl_b32 s17, s14, 12
    v_add_u32 v6, s17, v6
    v_lshrrev_b32 v66, 1, v61
    s_lshl_b32 s17, s14, 2
    v_add_u32 v66, s17, v66
    v_and_b32 v64, 1, v61
    s_lshl_b32 s17, s70, 4
    s_lshl_b32 s18, s71, 2
    s_add_u32 s17, s17, s18
    s_lshl_b32 s18, s72, 1
    s_add_u32 s17, s17, s18
    v_add_u32 v65, s17, v64
    v_lshl_add_u32 v65, v66, 6, v65
    v_lshlrev_b32 v65, 4, v65
    v_lshl_add_u32 v7, v62, 2, v65
    s_lshl_b32 s17, s71, 1
    v_add_u32 v64, s17, v64
    v_mul_u32_u24 v64, 576, v64
    v_lshl_add_u32 v64, v66, 4, v64
    v_lshl_add_u32 v64, v62, 1, v64
    s_mul_i32 s17, s70, 144
    s_lshl_b32 s18, s72, 3
    s_add_u32 s17, s17, s18
    v_add_u32 v64, s17, v64
    v_lshlrev_b32 v67, 1, v64
    s_mul_i32 s48, s32, 1048576
    s_add_u32 s48, s48, 4194304
    s_mul_i32 s17, s15, 9216
    s_add_u32 s17, s17, s48
    s_lshl_b32 s18, s14, 10
    s_add_u32 s38, s17, s18
    s_lshl_b32 s19, s14, 8
    s_add_u32 s39, s17, s19
    s_add_u32 s39, s39, 8192
    s_add_u32 s37, s48, 983040
    s_xor_b32 s36, s37, 16384
    s_add_u32 s34, s37, s18
    s_add_u32 s35, s37, 8192
    s_mul_i32 s17, s32, 50331648
    s_lshl_b32 s19, s15, 13
    s_add_u32 s17, s17, s19
    s_add_u32 s68, s17, 77594624
    s_lshl_b32 s18, s14, 11
    s_add_u32 s17, s17, s18
    s_add_u32 s41, s17, 60817408
    s_add_u32 s42, s17, 77594624
    s_mul_i32 s17, s32, 8388608
    s_lshl_b32 s19, s15, 12
    s_add_u32 s17, s17, s19
    s_add_u32 s43, s17, 27262976
    s_mul_i32 s17, s32, 1441792
    s_lshl_b32 s19, s15, 9
    s_add_u32 s17, s17, s19
    s_add_u32 s66, s17, 5376
    s_mov_b32 s33, 0
    s_add_u32 s62, s48, 0
    s_add_u32 s63, s48, 73728
    s_add_u32 s64, s48, 147456
    s_add_u32 s65, s48, 221184
    s_load_dwordx2 s[20:21], s[0:1], 32
    s_mov_b32 s22, 9216
    s_mov_b32 s23, 0x00020000
    s_waitcnt lgkmcnt(0)
    s_and_b32 s21, s21, 0xffff
    s_cmp_gt_u32 s14, 2
    s_cbranch_scc1 Lr_mem0_done
    s_mov_b64 exec, s[46:47]
    buffer_load_dword v64, v67, s[20:23], 0 offen
    s_waitcnt vmcnt(0)
    v_min_u32 v64, s50, v64
    buffer_store_dword v64, v7, s[8:11], s37 offen sc1
    v_mov_b32 v64, -1
    buffer_store_dword v64, v7, s[8:11], s36 offen sc1
    s_mov_b64 exec, -1
Lr_mem0_done:
    v_mov_b32 v64, 0
    v_mov_b32 v65, 0
    v_mov_b32 v66, 0
    v_mov_b32 v67, 0
    v_lshrrev_b32 v63, 2, v0
    buffer_store_dwordx4 v[64:67], v0, s[8:11], s38 offen sc1
    s_add_u32 s17, s38, 4096
    buffer_store_dwordx4 v[64:67], v0, s[8:11], s17 offen sc1
    buffer_store_dword v64, v63, s[8:11], s39 offen sc1
    s_waitcnt vmcnt(0)
    s_barrier
    s_cmp_lg_u32 s14, 0
    s_cbranch_scc1 Lr_noadd
    s_lshl_b32 s17, s32, 2
    s_add_u32 s17, s17, 192
    v_mov_b32 v63, s17
    v_mov_b32 v64, 1
    s_mov_b64 exec, 1
    global_atomic_add v63, v64, s[12:13]
    s_mov_b64 exec, -1
Lr_noadd:
    s_cmp_lt_u32 s14, 3
    s_cbranch_scc1 Lr_not_w3
    v_lshlrev_b32 v6, 3, v0
    v_lshrrev_b32 v63, 2, v0
    v_and_b32 v7, 12, v63
    v_and_b32 v63, 16, v63
    v_lshl_add_u32 v7, v63, 3, v7
Lr_not_w3:
    s_cmp_eq_u32 s32, 0
    s_cbranch_scc1 Lr_gate_ng
    s_cmp_lg_u32 s14, 0
    s_cbranch_scc1 Lr_gate_d
    v_mov_b32 v63, 48
    s_mov_b32 s16, 0
Lr_gate:
    global_load_dword v64, v63, s[12:13] sc1
    s_add_u32 s16, s16, 1
    s_cmp_gt_u32 s16, 100000
    s_cbranch_scc1 Lr_abort
    s_waitcnt vmcnt(0)
    v_cmp_gt_u32 vcc, 32, v64
    s_nop 0
    s_cbranch_vccz Lr_gate_d
    s_sleep 100
    s_branch Lr_gate
Lr_gate_d:
    s_barrier
Lr_gate_ng:
    s_load_dwordx2 s[20:21], s[0:1], 40
    s_mov_b32 s22, 4718592
    s_mov_b32 s23, 0x00020000
    s_waitcnt lgkmcnt(0)
    s_and_b32 s21, s21, 0xffff
    s_load_dwordx2 s[24:25], s[0:1], 48
    s_mov_b32 s26, 4718592
    s_mov_b32 s27, 0x00020000
    s_waitcnt lgkmcnt(0)
    s_and_b32 s25, s25, 0xffff
    s_load_dwordx2 s[28:29], s[0:1], 56
    s_mov_b32 s30, 4718592
    s_mov_b32 s31, 0x00020000
    s_waitcnt lgkmcnt(0)
    s_and_b32 s29, s29, 0xffff
    s_load_dwordx2 s[76:77], s[0:1], 64
    s_mov_b32 s78, 4718592
    s_mov_b32 s79, 0x00020000
    s_waitcnt lgkmcnt(0)
    s_and_b32 s77, s77, 0xffff
    v_lshrrev_b32 v60, 4, v0
    v_and_b32 v61, 15, v60
    v_lshrrev_b32 v62, 4, v60
    s_mul_i32 s72, s14, 34816
    s_add_u32 s72, s72, 23296
    s_mul_i32 s70, s14, 1179648
    s_lshl_b32 s17, s15, 8
    s_add_u32 s70, s70, s17
    s_mul_i32 s71, s15, 147456
    s_mul_i32 s17, s14, 288
    s_add_u32 s71, s71, s17
    v_and_b32 v63, 1, v62
    v_lshrrev_b32 v64, 1, v61
    v_xor_b32 v64, v64, v63
    v_lshlrev_b32 v64, 5, v64
    v_and_b32 v65, 1, v61
    v_lshl_add_u32 v64, v65, 4, v64
    v_lshl_add_u32 v12, v62, 13, v64
    v_xor_b32 v13, 128, v12
    v_xor_b32 v14, 64, v12
    v_xor_b32 v15, 192, v12
    v_lshrrev_b32 v63, 2, v60
    v_mul_u32_u24 v63, 1152, v63
    v_and_b32 v64, 3, v60
    v_lshl_add_u32 v16, v64, 4, v63
    v_lshrrev_b32 v63, 1, v60
    v_mul_u32_u24 v63, 1152, v63
    v_and_b32 v64, 1, v60
    v_lshl_add_u32 v17, v64, 4, v63
    v_lshrrev_b32 v40, 2, v61
    v_and_b32 v41, 3, v61
    v_and_b32 v63, 1, v62
    v_lshl_add_u32 v42, v63, 2, v40
    v_and_b32 v64, 1, v40
    v_lshl_add_u32 v64, v63, 2, v64
    v_lshrrev_b32 v65, 1, v40
    v_lshl_add_u32 v64, v65, 3, v64
    v_lshlrev_b32 v64, 8, v64
    v_lshl_add_u32 v64, v41, 3, v64
    v_lshrrev_b32 v65, 1, v62
    v_mul_u32_u24 v65, 34816, v65
    v_add_u32 v64, v64, v65
    v_add_u32 v64, 23296, v64
    s_lshl_b32 s17, s14, 1
    s_add_u32 s18, s17, 0
    v_xor_b32 v65, s18, v42
    v_lshl_add_u32 v18, v65, 5, v64
    v_add_u32 v19, 69632, v18
    s_add_u32 s18, s17, 1
    v_xor_b32 v65, s18, v42
    v_lshl_add_u32 v20, v65, 5, v64
    v_add_u32 v21, 69632, v20
    v_lshrrev_b32 v63, 1, v62
    v_lshlrev_b32 v63, 3, v63
    v_and_b32 v64, 1, v62
    v_lshl_add_u32 v63, v64, 1, v63
    v_and_b32 v64, 1, v40
    v_lshl_add_u32 v63, v64, 4, v63
    v_lshrrev_b32 v64, 1, v40
    v_lshl_add_u32 v63, v64, 2, v63
    v_lshlrev_b32 v64, 3, v41
    v_lshl_add_u32 v22, v63, 6, v64
    v_add_u32 v22, s72, v22
    v_lshl_add_u32 v23, v63, 5, v64
    v_add_u32 v23, s72, v23
    s_add_u32 m0, s72, 0
    s_add_u32 s17, s70, 0
    buffer_load_dwordx4 v12, s[20:23], s17 offen lds
    s_add_u32 m0, m0, 1024
    s_add_u32 s17, s70, 32768
    buffer_load_dwordx4 v13, s[20:23], s17 offen lds
    s_add_u32 m0, m0, 1024
    s_add_u32 s17, s70, 65536
    buffer_load_dwordx4 v14, s[20:23], s17 offen lds
    s_add_u32 m0, m0, 1024
    s_add_u32 s17, s70, 98304
    buffer_load_dwordx4 v15, s[20:23], s17 offen lds
    s_add_u32 m0, s72, 4096
    s_add_u32 s17, s70, 0
    buffer_load_dwordx4 v12, s[24:27], s17 offen lds
    s_add_u32 m0, m0, 1024
    s_add_u32 s17, s70, 32768
    buffer_load_dwordx4 v13, s[24:27], s17 offen lds
    s_add_u32 m0, m0, 1024
    s_add_u32 s17, s70, 65536
    buffer_load_dwordx4 v14, s[24:27], s17 offen lds
    s_add_u32 m0, m0, 1024
    s_add_u32 s17, s70, 98304
    buffer_load_dwordx4 v15, s[24:27], s17 offen lds
    s_add_u32 m0, s72, 8192
    s_add_u32 s17, s70, 131072
    buffer_load_dwordx4 v12, s[20:23], s17 offen lds
    s_add_u32 m0, m0, 1024
    s_add_u32 s17, s70, 163840
    buffer_load_dwordx4 v13, s[20:23], s17 offen lds
    s_add_u32 m0, m0, 1024
    s_add_u32 s17, s70, 196608
    buffer_load_dwordx4 v14, s[20:23], s17 offen lds
    s_add_u32 m0, m0, 1024
    s_add_u32 s17, s70, 229376
    buffer_load_dwordx4 v15, s[20:23], s17 offen lds
    s_add_u32 m0, s72, 12288
    s_add_u32 s17, s70, 131072
    buffer_load_dwordx4 v12, s[24:27], s17 offen lds
    s_add_u32 m0, m0, 1024
    s_add_u32 s17, s70, 163840
    buffer_load_dwordx4 v13, s[24:27], s17 offen lds
    s_add_u32 m0, m0, 1024
    s_add_u32 s17, s70, 196608
    buffer_load_dwordx4 v14, s[24:27], s17 offen lds
    s_add_u32 m0, m0, 1024
    s_add_u32 s17, s70, 229376
    buffer_load_dwordx4 v15, s[24:27], s17 offen lds
    s_add_u32 m0, s72, 16384
    s_add_u32 s17, s70, 131072
    buffer_load_dwordx4 v12, s[28:31], s17 offen lds
    s_add_u32 m0, m0, 1024
    s_add_u32 s17, s70, 163840
    buffer_load_dwordx4 v13, s[28:31], s17 offen lds
    s_add_u32 m0, m0, 1024
    s_add_u32 s17, s70, 196608
    buffer_load_dwordx4 v14, s[28:31], s17 offen lds
    s_add_u32 m0, m0, 1024
    s_add_u32 s17, s70, 229376
    buffer_load_dwordx4 v15, s[28:31], s17 offen lds
    s_add_u32 m0, s72, 20480
    s_add_u32 s17, s70, 262144
    buffer_load_dwordx4 v12, s[20:23], s17 offen lds
    s_add_u32 m0, m0, 1024
    s_add_u32 s17, s70, 294912
    buffer_load_dwordx4 v13, s[20:23], s17 offen lds
    s_add_u32 m0, m0, 1024
    s_add_u32 s17, s70, 327680
    buffer_load_dwordx4 v14, s[20:23], s17 offen lds
    s_add_u32 m0, m0, 1024
    s_add_u32 s17, s70, 360448
    buffer_load_dwordx4 v15, s[20:23], s17 offen lds
    s_add_u32 m0, s72, 24576
    s_add_u32 s17, s70, 262144
    buffer_load_dwordx4 v12, s[24:27], s17 offen lds
    s_add_u32 m0, m0, 1024
    s_add_u32 s17, s70, 294912
    buffer_load_dwordx4 v13, s[24:27], s17 offen lds
    s_add_u32 m0, m0, 1024
    s_add_u32 s17, s70, 327680
    buffer_load_dwordx4 v14, s[24:27], s17 offen lds
    s_add_u32 m0, m0, 1024
    s_add_u32 s17, s70, 360448
    buffer_load_dwordx4 v15, s[24:27], s17 offen lds
    s_add_u32 m0, s72, 28672
    s_add_u32 s17, s70, 393216
    buffer_load_dwordx4 v12, s[20:23], s17 offen lds
    s_add_u32 m0, m0, 1024
    s_add_u32 s17, s70, 425984
    buffer_load_dwordx4 v13, s[20:23], s17 offen lds
    s_add_u32 m0, m0, 1024
    s_add_u32 s17, s70, 458752
    buffer_load_dwordx4 v14, s[20:23], s17 offen lds
    s_add_u32 m0, m0, 1024
    s_add_u32 s17, s70, 491520
    buffer_load_dwordx4 v15, s[20:23], s17 offen lds
    s_add_u32 m0, s72, 32768
    s_add_u32 s17, s71, 256
    buffer_load_dwordx4 v17, s[76:79], s17 offen lds
    s_add_u32 m0, m0, 1024
    s_add_u32 s17, s71, 37120
    buffer_load_dwordx4 v17, s[76:79], s17 offen lds
    s_waitcnt vmcnt(30)
    s_barrier
    ds_read_b64_tr_b16 v[72:73], v18 offset:0
    ds_read_b64_tr_b16 v[74:75], v18 offset:512
    ds_read_b64_tr_b16 v[76:77], v19 offset:0
    ds_read_b64_tr_b16 v[78:79], v19 offset:512
    ds_read_b64_tr_b16 v[80:81], v20 offset:0
    ds_read_b64_tr_b16 v[82:83], v20 offset:512
    ds_read_b64_tr_b16 v[84:85], v21 offset:0
    ds_read_b64_tr_b16 v[86:87], v21 offset:512
    s_waitcnt lgkmcnt(0)
    s_waitcnt vmcnt(26)
    s_barrier
    s_add_u32 m0, s72, 0
    s_add_u32 s17, s70, 393216
    buffer_load_dwordx4 v12, s[24:27], s17 offen lds
    s_add_u32 m0, m0, 1024
    s_add_u32 s17, s70, 425984
    buffer_load_dwordx4 v13, s[24:27], s17 offen lds
    s_add_u32 m0, m0, 1024
    s_add_u32 s17, s70, 458752
    buffer_load_dwordx4 v14, s[24:27], s17 offen lds
    s_add_u32 m0, m0, 1024
    s_add_u32 s17, s70, 491520
    buffer_load_dwordx4 v15, s[24:27], s17 offen lds
    ds_read_b64_tr_b16 v[184:185], v18 offset:4096
    ds_read_b64_tr_b16 v[186:187], v18 offset:4608
    ds_read_b64_tr_b16 v[188:189], v19 offset:4096
    ds_read_b64_tr_b16 v[190:191], v19 offset:4608
    ds_read_b64_tr_b16 v[192:193], v20 offset:4096
    ds_read_b64_tr_b16 v[194:195], v20 offset:4608
    ds_read_b64_tr_b16 v[196:197], v21 offset:4096
    ds_read_b64_tr_b16 v[198:199], v21 offset:4608
    s_waitcnt lgkmcnt(0)
    s_waitcnt vmcnt(26)
    s_barrier
    s_add_u32 m0, s72, 4096
    s_add_u32 s17, s70, 393216
    buffer_load_dwordx4 v12, s[28:31], s17 offen lds
    s_add_u32 m0, m0, 1024
    s_add_u32 s17, s70, 425984
    buffer_load_dwordx4 v13, s[28:31], s17 offen lds
    s_add_u32 m0, m0, 1024
    s_add_u32 s17, s70, 458752
    buffer_load_dwordx4 v14, s[28:31], s17 offen lds
    s_add_u32 m0, m0, 1024
    s_add_u32 s17, s70, 491520
    buffer_load_dwordx4 v15, s[28:31], s17 offen lds
    ds_read_b64_tr_b16 v[88:89], v18 offset:8192
    ds_read_b64_tr_b16 v[90:91], v18 offset:8704
    ds_read_b64_tr_b16 v[92:93], v19 offset:8192
    ds_read_b64_tr_b16 v[94:95], v19 offset:8704
    ds_read_b64_tr_b16 v[96:97], v20 offset:8192
    ds_read_b64_tr_b16 v[98:99], v20 offset:8704
    ds_read_b64_tr_b16 v[100:101], v21 offset:8192
    ds_read_b64_tr_b16 v[102:103], v21 offset:8704
    s_waitcnt lgkmcnt(0)
    s_waitcnt vmcnt(26)
    s_barrier
    s_add_u32 m0, s72, 8192
    s_add_u32 s17, s70, 524288
    buffer_load_dwordx4 v12, s[24:27], s17 offen lds
    s_add_u32 m0, m0, 1024
    s_add_u32 s17, s70, 557056
    buffer_load_dwordx4 v13, s[24:27], s17 offen lds
    s_add_u32 m0, m0, 1024
    s_add_u32 s17, s70, 589824
    buffer_load_dwordx4 v14, s[24:27], s17 offen lds
    s_add_u32 m0, m0, 1024
    s_add_u32 s17, s70, 622592
    buffer_load_dwordx4 v15, s[24:27], s17 offen lds
    ds_read_b64_tr_b16 v[200:201], v18 offset:12288
    ds_read_b64_tr_b16 v[202:203], v18 offset:12800
    ds_read_b64_tr_b16 v[204:205], v19 offset:12288
    ds_read_b64_tr_b16 v[206:207], v19 offset:12800
    ds_read_b64_tr_b16 v[208:209], v20 offset:12288
    ds_read_b64_tr_b16 v[210:211], v20 offset:12800
    ds_read_b64_tr_b16 v[212:213], v21 offset:12288
    ds_read_b64_tr_b16 v[214:215], v21 offset:12800
    s_waitcnt lgkmcnt(0)
    s_waitcnt vmcnt(26)
    s_barrier
    s_add_u32 m0, s72, 12288
    s_add_u32 s17, s70, 524288
    buffer_load_dwordx4 v12, s[28:31], s17 offen lds
    s_add_u32 m0, m0, 1024
    s_add_u32 s17, s70, 557056
    buffer_load_dwordx4 v13, s[28:31], s17 offen lds
    s_add_u32 m0, m0, 1024
    s_add_u32 s17, s70, 589824
    buffer_load_dwordx4 v14, s[28:31], s17 offen lds
    s_add_u32 m0, m0, 1024
    s_add_u32 s17, s70, 622592
    buffer_load_dwordx4 v15, s[28:31], s17 offen lds
    ds_read_b64_tr_b16 a[72:73], v18 offset:16384
    ds_read_b64_tr_b16 a[74:75], v18 offset:16896
    ds_read_b64_tr_b16 a[76:77], v19 offset:16384
    ds_read_b64_tr_b16 a[78:79], v19 offset:16896
    ds_read_b64_tr_b16 a[80:81], v20 offset:16384
    ds_read_b64_tr_b16 a[82:83], v20 offset:16896
    ds_read_b64_tr_b16 a[84:85], v21 offset:16384
    ds_read_b64_tr_b16 a[86:87], v21 offset:16896
    s_waitcnt lgkmcnt(0)
    s_waitcnt vmcnt(26)
    s_barrier
    s_add_u32 m0, s72, 16384
    s_add_u32 s17, s70, 655360
    buffer_load_dwordx4 v12, s[20:23], s17 offen lds
    s_add_u32 m0, m0, 1024
    s_add_u32 s17, s70, 688128
    buffer_load_dwordx4 v13, s[20:23], s17 offen lds
    s_add_u32 m0, m0, 1024
    s_add_u32 s17, s70, 720896
    buffer_load_dwordx4 v14, s[20:23], s17 offen lds
    s_add_u32 m0, m0, 1024
    s_add_u32 s17, s70, 753664
    buffer_load_dwordx4 v15, s[20:23], s17 offen lds
    ds_read_b64_tr_b16 v[104:105], v18 offset:20480
    ds_read_b64_tr_b16 v[106:107], v18 offset:20992
    ds_read_b64_tr_b16 v[108:109], v19 offset:20480
    ds_read_b64_tr_b16 v[110:111], v19 offset:20992
    ds_read_b64_tr_b16 v[112:113], v20 offset:20480
    ds_read_b64_tr_b16 v[114:115], v20 offset:20992
    ds_read_b64_tr_b16 v[116:117], v21 offset:20480
    ds_read_b64_tr_b16 v[118:119], v21 offset:20992
    s_waitcnt lgkmcnt(0)
    s_waitcnt vmcnt(26)
    s_barrier
    s_add_u32 m0, s72, 20480
    s_add_u32 s17, s70, 655360
    buffer_load_dwordx4 v12, s[24:27], s17 offen lds
    s_add_u32 m0, m0, 1024
    s_add_u32 s17, s70, 688128
    buffer_load_dwordx4 v13, s[24:27], s17 offen lds
    s_add_u32 m0, m0, 1024
    s_add_u32 s17, s70, 720896
    buffer_load_dwordx4 v14, s[24:27], s17 offen lds
    s_add_u32 m0, m0, 1024
    s_add_u32 s17, s70, 753664
    buffer_load_dwordx4 v15, s[24:27], s17 offen lds
    ds_read_b64_tr_b16 v[216:217], v18 offset:24576
    ds_read_b64_tr_b16 v[218:219], v18 offset:25088
    ds_read_b64_tr_b16 v[220:221], v19 offset:24576
    ds_read_b64_tr_b16 v[222:223], v19 offset:25088
    ds_read_b64_tr_b16 v[224:225], v20 offset:24576
    ds_read_b64_tr_b16 v[226:227], v20 offset:25088
    ds_read_b64_tr_b16 v[228:229], v21 offset:24576
    ds_read_b64_tr_b16 v[230:231], v21 offset:25088
    s_waitcnt lgkmcnt(0)
    s_waitcnt vmcnt(26)
    s_barrier
    s_add_u32 m0, s72, 24576
    s_add_u32 s17, s70, 655360
    buffer_load_dwordx4 v12, s[28:31], s17 offen lds
    s_add_u32 m0, m0, 1024
    s_add_u32 s17, s70, 688128
    buffer_load_dwordx4 v13, s[28:31], s17 offen lds
    s_add_u32 m0, m0, 1024
    s_add_u32 s17, s70, 720896
    buffer_load_dwordx4 v14, s[28:31], s17 offen lds
    s_add_u32 m0, m0, 1024
    s_add_u32 s17, s70, 753664
    buffer_load_dwordx4 v15, s[28:31], s17 offen lds
    ds_read_b64_tr_b16 v[120:121], v18 offset:28672
    ds_read_b64_tr_b16 v[122:123], v18 offset:29184
    ds_read_b64_tr_b16 v[124:125], v19 offset:28672
    ds_read_b64_tr_b16 v[126:127], v19 offset:29184
    ds_read_b64_tr_b16 v[128:129], v20 offset:28672
    ds_read_b64_tr_b16 v[130:131], v20 offset:29184
    ds_read_b64_tr_b16 v[132:133], v21 offset:28672
    ds_read_b64_tr_b16 v[134:135], v21 offset:29184
    s_waitcnt lgkmcnt(0)
    s_waitcnt vmcnt(24)
    s_barrier
    s_add_u32 m0, s72, 28672
    s_add_u32 s17, s70, 786432
    buffer_load_dwordx4 v12, s[24:27], s17 offen lds
    s_add_u32 m0, m0, 1024
    s_add_u32 s17, s70, 819200
    buffer_load_dwordx4 v13, s[24:27], s17 offen lds
    s_add_u32 m0, m0, 1024
    s_add_u32 s17, s70, 851968
    buffer_load_dwordx4 v14, s[24:27], s17 offen lds
    s_add_u32 m0, m0, 1024
    s_add_u32 s17, s70, 884736
    buffer_load_dwordx4 v15, s[24:27], s17 offen lds
    ds_read_b64_tr_b16 v[232:233], v18 offset:0
    ds_read_b64_tr_b16 v[234:235], v18 offset:512
    ds_read_b64_tr_b16 v[236:237], v19 offset:0
    ds_read_b64_tr_b16 v[238:239], v19 offset:512
    ds_read_b64_tr_b16 v[240:241], v20 offset:0
    ds_read_b64_tr_b16 v[242:243], v20 offset:512
    ds_read_b64_tr_b16 v[244:245], v21 offset:0
    ds_read_b64_tr_b16 v[246:247], v21 offset:512
    s_waitcnt lgkmcnt(0)
    s_waitcnt vmcnt(24)
    s_barrier
    s_add_u32 m0, s72, 0
    s_add_u32 s17, s70, 786432
    buffer_load_dwordx4 v12, s[28:31], s17 offen lds
    s_add_u32 m0, m0, 1024
    s_add_u32 s17, s70, 819200
    buffer_load_dwordx4 v13, s[28:31], s17 offen lds
    s_add_u32 m0, m0, 1024
    s_add_u32 s17, s70, 851968
    buffer_load_dwordx4 v14, s[28:31], s17 offen lds
    s_add_u32 m0, m0, 1024
    s_add_u32 s17, s70, 884736
    buffer_load_dwordx4 v15, s[28:31], s17 offen lds
    ds_read_b64_tr_b16 a[88:89], v18 offset:4096
    ds_read_b64_tr_b16 a[90:91], v18 offset:4608
    ds_read_b64_tr_b16 a[92:93], v19 offset:4096
    ds_read_b64_tr_b16 a[94:95], v19 offset:4608
    ds_read_b64_tr_b16 a[96:97], v20 offset:4096
    ds_read_b64_tr_b16 a[98:99], v20 offset:4608
    ds_read_b64_tr_b16 a[100:101], v21 offset:4096
    ds_read_b64_tr_b16 a[102:103], v21 offset:4608
    s_waitcnt lgkmcnt(0)
    s_waitcnt vmcnt(24)
    s_barrier
    s_add_u32 m0, s72, 4096
    s_add_u32 s17, s70, 917504
    buffer_load_dwordx4 v12, s[20:23], s17 offen lds
    s_add_u32 m0, m0, 1024
    s_add_u32 s17, s70, 950272
    buffer_load_dwordx4 v13, s[20:23], s17 offen lds
    s_add_u32 m0, m0, 1024
    s_add_u32 s17, s70, 983040
    buffer_load_dwordx4 v14, s[20:23], s17 offen lds
    s_add_u32 m0, m0, 1024
    s_add_u32 s17, s70, 1015808
    buffer_load_dwordx4 v15, s[20:23], s17 offen lds
    ds_read_b64_tr_b16 v[248:249], v18 offset:8192
    ds_read_b64_tr_b16 v[250:251], v18 offset:8704
    ds_read_b64_tr_b16 v[252:253], v19 offset:8192
    ds_read_b64_tr_b16 v[254:255], v19 offset:8704
    ds_read_b64_tr_b16 a[0:1], v20 offset:8192
    ds_read_b64_tr_b16 a[2:3], v20 offset:8704
    ds_read_b64_tr_b16 a[4:5], v21 offset:8192
    ds_read_b64_tr_b16 a[6:7], v21 offset:8704
    s_waitcnt lgkmcnt(0)
    s_waitcnt vmcnt(24)
    s_barrier
    s_add_u32 m0, s72, 8192
    s_add_u32 s17, s70, 917504
    buffer_load_dwordx4 v12, s[24:27], s17 offen lds
    s_add_u32 m0, m0, 1024
    s_add_u32 s17, s70, 950272
    buffer_load_dwordx4 v13, s[24:27], s17 offen lds
    s_add_u32 m0, m0, 1024
    s_add_u32 s17, s70, 983040
    buffer_load_dwordx4 v14, s[24:27], s17 offen lds
    s_add_u32 m0, m0, 1024
    s_add_u32 s17, s70, 1015808
    buffer_load_dwordx4 v15, s[24:27], s17 offen lds
    ds_read_b64_tr_b16 a[104:105], v18 offset:12288
    ds_read_b64_tr_b16 a[106:107], v18 offset:12800
    ds_read_b64_tr_b16 a[108:109], v19 offset:12288
    ds_read_b64_tr_b16 a[110:111], v19 offset:12800
    ds_read_b64_tr_b16 a[112:113], v20 offset:12288
    ds_read_b64_tr_b16 a[114:115], v20 offset:12800
    ds_read_b64_tr_b16 a[116:117], v21 offset:12288
    ds_read_b64_tr_b16 a[118:119], v21 offset:12800
    s_waitcnt lgkmcnt(0)
    s_waitcnt vmcnt(24)
    s_barrier
    s_add_u32 m0, s72, 12288
    s_add_u32 s17, s70, 917504
    buffer_load_dwordx4 v12, s[28:31], s17 offen lds
    s_add_u32 m0, m0, 1024
    s_add_u32 s17, s70, 950272
    buffer_load_dwordx4 v13, s[28:31], s17 offen lds
    s_add_u32 m0, m0, 1024
    s_add_u32 s17, s70, 983040
    buffer_load_dwordx4 v14, s[28:31], s17 offen lds
    s_add_u32 m0, m0, 1024
    s_add_u32 s17, s70, 1015808
    buffer_load_dwordx4 v15, s[28:31], s17 offen lds
    ds_read_b64_tr_b16 v[136:137], v18 offset:16384
    ds_read_b64_tr_b16 v[138:139], v18 offset:16896
    ds_read_b64_tr_b16 v[140:141], v19 offset:16384
    ds_read_b64_tr_b16 v[142:143], v19 offset:16896
    ds_read_b64_tr_b16 v[144:145], v20 offset:16384
    ds_read_b64_tr_b16 v[146:147], v20 offset:16896
    ds_read_b64_tr_b16 v[148:149], v21 offset:16384
    ds_read_b64_tr_b16 v[150:151], v21 offset:16896
    s_waitcnt lgkmcnt(0)
    s_add_u32 s17, s32, s14
    s_cmp_lg_u32 s17, 0
    s_cbranch_scc1 Lr_nold
    v_mov_b32 v63, 48
    v_mov_b32 v64, 1
    s_mov_b64 exec, 1
    global_atomic_add v63, v64, s[12:13]
    s_mov_b64 exec, -1
Lr_nold:
    s_waitcnt vmcnt(24)
    s_barrier
    s_add_u32 m0, s72, 16384
    s_add_u32 s17, s70, 1048576
    buffer_load_dwordx4 v12, s[20:23], s17 offen lds
    s_add_u32 m0, m0, 1024
    s_add_u32 s17, s70, 1081344
    buffer_load_dwordx4 v13, s[20:23], s17 offen lds
    s_add_u32 m0, m0, 1024
    s_add_u32 s17, s70, 1114112
    buffer_load_dwordx4 v14, s[20:23], s17 offen lds
    s_add_u32 m0, m0, 1024
    s_add_u32 s17, s70, 1146880
    buffer_load_dwordx4 v15, s[20:23], s17 offen lds
    ds_read_b64_tr_b16 a[8:9], v18 offset:20480
    ds_read_b64_tr_b16 a[10:11], v18 offset:20992
    ds_read_b64_tr_b16 a[12:13], v19 offset:20480
    ds_read_b64_tr_b16 a[14:15], v19 offset:20992
    ds_read_b64_tr_b16 a[16:17], v20 offset:20480
    ds_read_b64_tr_b16 a[18:19], v20 offset:20992
    ds_read_b64_tr_b16 a[20:21], v21 offset:20480
    ds_read_b64_tr_b16 a[22:23], v21 offset:20992
    s_waitcnt lgkmcnt(0)
    s_waitcnt vmcnt(24)
    s_barrier
    s_add_u32 m0, s72, 20480
    s_add_u32 s17, s70, 1048576
    buffer_load_dwordx4 v12, s[24:27], s17 offen lds
    s_add_u32 m0, m0, 1024
    s_add_u32 s17, s70, 1081344
    buffer_load_dwordx4 v13, s[24:27], s17 offen lds
    s_add_u32 m0, m0, 1024
    s_add_u32 s17, s70, 1114112
    buffer_load_dwordx4 v14, s[24:27], s17 offen lds
    s_add_u32 m0, m0, 1024
    s_add_u32 s17, s70, 1146880
    buffer_load_dwordx4 v15, s[24:27], s17 offen lds
    ds_read_b64_tr_b16 a[120:121], v18 offset:24576
    ds_read_b64_tr_b16 a[122:123], v18 offset:25088
    ds_read_b64_tr_b16 a[124:125], v19 offset:24576
    ds_read_b64_tr_b16 a[126:127], v19 offset:25088
    ds_read_b64_tr_b16 a[128:129], v20 offset:24576
    ds_read_b64_tr_b16 a[130:131], v20 offset:25088
    ds_read_b64_tr_b16 a[132:133], v21 offset:24576
    ds_read_b64_tr_b16 a[134:135], v21 offset:25088
    s_waitcnt lgkmcnt(0)
    s_waitcnt vmcnt(24)
    s_barrier
    s_add_u32 m0, s72, 24576
    s_add_u32 s17, s70, 1048576
    buffer_load_dwordx4 v12, s[28:31], s17 offen lds
    s_add_u32 m0, m0, 1024
    s_add_u32 s17, s70, 1081344
    buffer_load_dwordx4 v13, s[28:31], s17 offen lds
    s_add_u32 m0, m0, 1024
    s_add_u32 s17, s70, 1114112
    buffer_load_dwordx4 v14, s[28:31], s17 offen lds
    s_add_u32 m0, m0, 1024
    s_add_u32 s17, s70, 1146880
    buffer_load_dwordx4 v15, s[28:31], s17 offen lds
    ds_read_b64_tr_b16 a[24:25], v18 offset:28672
    ds_read_b64_tr_b16 a[26:27], v18 offset:29184
    ds_read_b64_tr_b16 a[28:29], v19 offset:28672
    ds_read_b64_tr_b16 a[30:31], v19 offset:29184
    ds_read_b64_tr_b16 a[32:33], v20 offset:28672
    ds_read_b64_tr_b16 a[34:35], v20 offset:29184
    ds_read_b64_tr_b16 a[36:37], v21 offset:28672
    ds_read_b64_tr_b16 a[38:39], v21 offset:29184
    s_waitcnt lgkmcnt(0)
    s_waitcnt vmcnt(24)
    s_barrier
    ds_read_b64_tr_b16 a[136:137], v18 offset:0
    ds_read_b64_tr_b16 a[138:139], v18 offset:512
    ds_read_b64_tr_b16 a[140:141], v19 offset:0
    ds_read_b64_tr_b16 a[142:143], v19 offset:512
    ds_read_b64_tr_b16 a[144:145], v20 offset:0
    ds_read_b64_tr_b16 a[146:147], v20 offset:512
    ds_read_b64_tr_b16 a[148:149], v21 offset:0
    ds_read_b64_tr_b16 a[150:151], v21 offset:512
    s_waitcnt lgkmcnt(0)
    s_waitcnt vmcnt(20)
    s_barrier
    s_add_u32 m0, s72, 0
    s_add_u32 s17, s70, 0
    buffer_load_dwordx4 v12, s[28:31], s17 offen lds
    s_add_u32 m0, m0, 1024
    s_add_u32 s17, s70, 32768
    buffer_load_dwordx4 v13, s[28:31], s17 offen lds
    s_add_u32 m0, m0, 1024
    s_add_u32 s17, s70, 65536
    buffer_load_dwordx4 v14, s[28:31], s17 offen lds
    s_add_u32 m0, m0, 1024
    s_add_u32 s17, s70, 98304
    buffer_load_dwordx4 v15, s[28:31], s17 offen lds
    ds_read_b64_tr_b16 v[152:153], v18 offset:4096
    ds_read_b64_tr_b16 v[154:155], v18 offset:4608
    ds_read_b64_tr_b16 v[156:157], v19 offset:4096
    ds_read_b64_tr_b16 v[158:159], v19 offset:4608
    ds_read_b64_tr_b16 v[160:161], v20 offset:4096
    ds_read_b64_tr_b16 v[162:163], v20 offset:4608
    ds_read_b64_tr_b16 v[164:165], v21 offset:4096
    ds_read_b64_tr_b16 v[166:167], v21 offset:4608
    s_waitcnt lgkmcnt(0)
    s_waitcnt vmcnt(20)
    s_barrier
    s_add_u32 m0, s72, 4096
    s_add_u32 s17, s70, 262144
    buffer_load_dwordx4 v12, s[28:31], s17 offen lds
    s_add_u32 m0, m0, 1024
    s_add_u32 s17, s70, 294912
    buffer_load_dwordx4 v13, s[28:31], s17 offen lds
    s_add_u32 m0, m0, 1024
    s_add_u32 s17, s70, 327680
    buffer_load_dwordx4 v14, s[28:31], s17 offen lds
    s_add_u32 m0, m0, 1024
    s_add_u32 s17, s70, 360448
    buffer_load_dwordx4 v15, s[28:31], s17 offen lds
    ds_read_b64_tr_b16 a[40:41], v18 offset:8192
    ds_read_b64_tr_b16 a[42:43], v18 offset:8704
    ds_read_b64_tr_b16 a[44:45], v19 offset:8192
    ds_read_b64_tr_b16 a[46:47], v19 offset:8704
    ds_read_b64_tr_b16 a[48:49], v20 offset:8192
    ds_read_b64_tr_b16 a[50:51], v20 offset:8704
    ds_read_b64_tr_b16 a[52:53], v21 offset:8192
    ds_read_b64_tr_b16 a[54:55], v21 offset:8704
    s_waitcnt lgkmcnt(0)
    s_waitcnt vmcnt(20)
    s_barrier
    s_add_u32 m0, s72, 8192
    s_add_u32 s17, s70, 524288
    buffer_load_dwordx4 v12, s[20:23], s17 offen lds
    s_add_u32 m0, m0, 1024
    s_add_u32 s17, s70, 557056
    buffer_load_dwordx4 v13, s[20:23], s17 offen lds
    s_add_u32 m0, m0, 1024
    s_add_u32 s17, s70, 589824
    buffer_load_dwordx4 v14, s[20:23], s17 offen lds
    s_add_u32 m0, m0, 1024
    s_add_u32 s17, s70, 622592
    buffer_load_dwordx4 v15, s[20:23], s17 offen lds
    ds_read_b64_tr_b16 a[152:153], v18 offset:12288
    ds_read_b64_tr_b16 a[154:155], v18 offset:12800
    ds_read_b64_tr_b16 a[156:157], v19 offset:12288
    ds_read_b64_tr_b16 a[158:159], v19 offset:12800
    ds_read_b64_tr_b16 a[160:161], v20 offset:12288
    ds_read_b64_tr_b16 a[162:163], v20 offset:12800
    ds_read_b64_tr_b16 a[164:165], v21 offset:12288
    ds_read_b64_tr_b16 a[166:167], v21 offset:12800
    s_waitcnt lgkmcnt(0)
    s_waitcnt vmcnt(20)
    s_barrier
    s_add_u32 m0, s72, 12288
    s_add_u32 s17, s70, 786432
    buffer_load_dwordx4 v12, s[20:23], s17 offen lds
    s_add_u32 m0, m0, 1024
    s_add_u32 s17, s70, 819200
    buffer_load_dwordx4 v13, s[20:23], s17 offen lds
    s_add_u32 m0, m0, 1024
    s_add_u32 s17, s70, 851968
    buffer_load_dwordx4 v14, s[20:23], s17 offen lds
    s_add_u32 m0, m0, 1024
    s_add_u32 s17, s70, 884736
    buffer_load_dwordx4 v15, s[20:23], s17 offen lds
    ds_read_b64_tr_b16 v[168:169], v18 offset:16384
    ds_read_b64_tr_b16 v[170:171], v18 offset:16896
    ds_read_b64_tr_b16 v[172:173], v19 offset:16384
    ds_read_b64_tr_b16 v[174:175], v19 offset:16896
    ds_read_b64_tr_b16 v[176:177], v20 offset:16384
    ds_read_b64_tr_b16 v[178:179], v20 offset:16896
    ds_read_b64_tr_b16 v[180:181], v21 offset:16384
    ds_read_b64_tr_b16 v[182:183], v21 offset:16896
    s_waitcnt lgkmcnt(0)
    s_waitcnt vmcnt(20)
    s_barrier
    s_add_u32 m0, s72, 16384
    s_add_u32 s17, s71, 0
    buffer_load_dwordx4 v16, s[76:79], s17 offen lds
    s_add_u32 m0, m0, 1024
    s_add_u32 s17, s71, 18432
    buffer_load_dwordx4 v16, s[76:79], s17 offen lds
    s_add_u32 m0, m0, 1024
    s_add_u32 s17, s71, 36864
    buffer_load_dwordx4 v16, s[76:79], s17 offen lds
    s_add_u32 m0, m0, 1024
    s_add_u32 s17, s71, 55296
    buffer_load_dwordx4 v16, s[76:79], s17 offen lds
    ds_read_b64_tr_b16 a[56:57], v18 offset:20480
    ds_read_b64_tr_b16 a[58:59], v18 offset:20992
    ds_read_b64_tr_b16 a[60:61], v19 offset:20480
    ds_read_b64_tr_b16 a[62:63], v19 offset:20992
    ds_read_b64_tr_b16 a[64:65], v20 offset:20480
    ds_read_b64_tr_b16 a[66:67], v20 offset:20992
    ds_read_b64_tr_b16 a[68:69], v21 offset:20480
    ds_read_b64_tr_b16 a[70:71], v21 offset:20992
    s_waitcnt lgkmcnt(0)
    s_waitcnt vmcnt(20)
    s_barrier
    s_add_u32 m0, s72, 20480
    s_add_u32 s17, s71, 73728
    buffer_load_dwordx4 v16, s[76:79], s17 offen lds
    s_add_u32 m0, m0, 1024
    s_add_u32 s17, s71, 92160
    buffer_load_dwordx4 v16, s[76:79], s17 offen lds
    s_add_u32 m0, m0, 1024
    s_add_u32 s17, s71, 110592
    buffer_load_dwordx4 v16, s[76:79], s17 offen lds
    s_add_u32 m0, m0, 1024
    s_add_u32 s17, s71, 129024
    buffer_load_dwordx4 v16, s[76:79], s17 offen lds
    ds_read_b64_tr_b16 a[168:169], v18 offset:24576
    ds_read_b64_tr_b16 a[170:171], v18 offset:25088
    ds_read_b64_tr_b16 a[172:173], v19 offset:24576
    ds_read_b64_tr_b16 a[174:175], v19 offset:25088
    ds_read_b64_tr_b16 a[176:177], v20 offset:24576
    ds_read_b64_tr_b16 a[178:179], v20 offset:25088
    ds_read_b64_tr_b16 a[180:181], v21 offset:24576
    ds_read_b64_tr_b16 a[182:183], v21 offset:25088
    s_waitcnt lgkmcnt(0)
    s_waitcnt vmcnt(20)
    s_barrier
    s_add_u32 m0, s72, 24576
    s_add_u32 s17, s71, 64
    buffer_load_dwordx4 v16, s[76:79], s17 offen lds
    s_add_u32 m0, m0, 1024
    s_add_u32 s17, s71, 18496
    buffer_load_dwordx4 v16, s[76:79], s17 offen lds
    s_add_u32 m0, m0, 1024
    s_add_u32 s17, s71, 36928
    buffer_load_dwordx4 v16, s[76:79], s17 offen lds
    s_add_u32 m0, m0, 1024
    s_add_u32 s17, s71, 55360
    buffer_load_dwordx4 v16, s[76:79], s17 offen lds
    s_add_u32 m0, s72, 28672
    s_add_u32 s17, s71, 73792
    buffer_load_dwordx4 v16, s[76:79], s17 offen lds
    s_add_u32 m0, m0, 1024
    s_add_u32 s17, s71, 92224
    buffer_load_dwordx4 v16, s[76:79], s17 offen lds
    s_add_u32 m0, m0, 1024
    s_add_u32 s17, s71, 110656
    buffer_load_dwordx4 v16, s[76:79], s17 offen lds
    s_add_u32 m0, m0, 1024
    s_add_u32 s17, s71, 129088
    buffer_load_dwordx4 v16, s[76:79], s17 offen lds
    ds_read_b64_tr_b16 v[24:25], v18 offset:0
    ds_read_b64_tr_b16 v[26:27], v18 offset:512
    ds_read_b64_tr_b16 v[28:29], v19 offset:0
    ds_read_b64_tr_b16 v[30:31], v19 offset:512
    ds_read_b64_tr_b16 v[32:33], v20 offset:0
    ds_read_b64_tr_b16 v[34:35], v20 offset:512
    ds_read_b64_tr_b16 v[36:37], v21 offset:0
    ds_read_b64_tr_b16 v[38:39], v21 offset:512
    s_waitcnt lgkmcnt(0)
    s_barrier
    ds_write_b128 v8, v[24:27] offset:0
    ds_write_b128 v8, v[28:31] offset:1024
    ds_write_b128 v8, v[32:35] offset:2048
    ds_write_b128 v8, v[36:39] offset:3072
    s_waitcnt lgkmcnt(0)
    s_waitcnt vmcnt(24)
    s_barrier
    ds_read_b64_tr_b16 v[24:25], v18 offset:4096
    ds_read_b64_tr_b16 v[26:27], v18 offset:4608
    ds_read_b64_tr_b16 v[28:29], v19 offset:4096
    ds_read_b64_tr_b16 v[30:31], v19 offset:4608
    ds_read_b64_tr_b16 v[32:33], v20 offset:4096
    ds_read_b64_tr_b16 v[34:35], v20 offset:4608
    ds_read_b64_tr_b16 v[36:37], v21 offset:4096
    ds_read_b64_tr_b16 v[38:39], v21 offset:4608
    s_waitcnt lgkmcnt(0)
    s_barrier
    ds_write_b128 v8, v[24:27] offset:4096
    ds_write_b128 v8, v[28:31] offset:5120
    ds_write_b128 v8, v[32:35] offset:6144
    ds_write_b128 v8, v[36:39] offset:7168
    s_waitcnt lgkmcnt(0)
    s_waitcnt vmcnt(20)
    s_barrier
    ds_read_b64_tr_b16 v[24:25], v18 offset:8192
    ds_read_b64_tr_b16 v[26:27], v18 offset:8704
    ds_read_b64_tr_b16 v[28:29], v19 offset:8192
    ds_read_b64_tr_b16 v[30:31], v19 offset:8704
    ds_read_b64_tr_b16 v[32:33], v20 offset:8192
    ds_read_b64_tr_b16 v[34:35], v20 offset:8704
    ds_read_b64_tr_b16 v[36:37], v21 offset:8192
    ds_read_b64_tr_b16 v[38:39], v21 offset:8704
    s_waitcnt lgkmcnt(0)
    s_barrier
    ds_write_b128 v8, v[24:27] offset:8192
    ds_write_b128 v8, v[28:31] offset:9216
    ds_write_b128 v8, v[32:35] offset:10240
    ds_write_b128 v8, v[36:39] offset:11264
    s_waitcnt lgkmcnt(0)
    s_waitcnt vmcnt(16)
    s_barrier
    ds_read_b64_tr_b16 v[24:25], v18 offset:12288
    ds_read_b64_tr_b16 v[26:27], v18 offset:12800
    ds_read_b64_tr_b16 v[28:29], v19 offset:12288
    ds_read_b64_tr_b16 v[30:31], v19 offset:12800
    ds_read_b64_tr_b16 v[32:33], v20 offset:12288
    ds_read_b64_tr_b16 v[34:35], v20 offset:12800
    ds_read_b64_tr_b16 v[36:37], v21 offset:12288
    ds_read_b64_tr_b16 v[38:39], v21 offset:12800
    s_waitcnt lgkmcnt(0)
    s_barrier
    ds_write_b128 v8, v[24:27] offset:12288
    ds_write_b128 v8, v[28:31] offset:13312
    ds_write_b128 v8, v[32:35] offset:14336
    ds_write_b128 v8, v[36:39] offset:15360
    s_waitcnt lgkmcnt(0)
    s_barrier
    s_waitcnt vmcnt(12)
    ds_read_b64_tr_b16 a[184:185], v22 offset:16384
    ds_read_b64_tr_b16 a[186:187], v22 offset:16448
    ds_read_b64_tr_b16 a[188:189], v22 offset:18432
    ds_read_b64_tr_b16 a[190:191], v22 offset:18496
    ds_read_b64_tr_b16 a[200:201], v22 offset:16416
    ds_read_b64_tr_b16 a[202:203], v22 offset:16480
    ds_read_b64_tr_b16 a[204:205], v22 offset:18464
    ds_read_b64_tr_b16 a[206:207], v22 offset:18528
    s_waitcnt lgkmcnt(0)
    s_add_u32 m0, s72, 16384
    s_add_u32 s17, s71, 128
    buffer_load_dwordx4 v16, s[76:79], s17 offen lds
    s_add_u32 m0, m0, 1024
    s_add_u32 s17, s71, 18560
    buffer_load_dwordx4 v16, s[76:79], s17 offen lds
    s_add_u32 m0, m0, 1024
    s_add_u32 s17, s71, 36992
    buffer_load_dwordx4 v16, s[76:79], s17 offen lds
    s_add_u32 m0, m0, 1024
    s_add_u32 s17, s71, 55424
    buffer_load_dwordx4 v16, s[76:79], s17 offen lds
    s_waitcnt vmcnt(12)
    ds_read_b64_tr_b16 a[192:193], v22 offset:20480
    ds_read_b64_tr_b16 a[194:195], v22 offset:20544
    ds_read_b64_tr_b16 a[196:197], v22 offset:22528
    ds_read_b64_tr_b16 a[198:199], v22 offset:22592
    ds_read_b64_tr_b16 a[208:209], v22 offset:20512
    ds_read_b64_tr_b16 a[210:211], v22 offset:20576
    ds_read_b64_tr_b16 a[212:213], v22 offset:22560
    ds_read_b64_tr_b16 a[214:215], v22 offset:22624
    s_waitcnt lgkmcnt(0)
    s_add_u32 m0, s72, 20480
    s_add_u32 s17, s71, 73856
    buffer_load_dwordx4 v16, s[76:79], s17 offen lds
    s_add_u32 m0, m0, 1024
    s_add_u32 s17, s71, 92288
    buffer_load_dwordx4 v16, s[76:79], s17 offen lds
    s_add_u32 m0, m0, 1024
    s_add_u32 s17, s71, 110720
    buffer_load_dwordx4 v16, s[76:79], s17 offen lds
    s_add_u32 m0, m0, 1024
    s_add_u32 s17, s71, 129152
    buffer_load_dwordx4 v16, s[76:79], s17 offen lds
    s_waitcnt vmcnt(12)
    ds_read_b64_tr_b16 a[216:217], v22 offset:24576
    ds_read_b64_tr_b16 a[218:219], v22 offset:24640
    ds_read_b64_tr_b16 a[220:221], v22 offset:26624
    ds_read_b64_tr_b16 a[222:223], v22 offset:26688
    ds_read_b64_tr_b16 a[232:233], v22 offset:24608
    ds_read_b64_tr_b16 a[234:235], v22 offset:24672
    ds_read_b64_tr_b16 a[236:237], v22 offset:26656
    ds_read_b64_tr_b16 a[238:239], v22 offset:26720
    s_waitcnt lgkmcnt(0)
    s_add_u32 m0, s72, 24576
    s_add_u32 s17, s71, 192
    buffer_load_dwordx4 v16, s[76:79], s17 offen lds
    s_add_u32 m0, m0, 1024
    s_add_u32 s17, s71, 18624
    buffer_load_dwordx4 v16, s[76:79], s17 offen lds
    s_add_u32 m0, m0, 1024
    s_add_u32 s17, s71, 37056
    buffer_load_dwordx4 v16, s[76:79], s17 offen lds
    s_add_u32 m0, m0, 1024
    s_add_u32 s17, s71, 55488
    buffer_load_dwordx4 v16, s[76:79], s17 offen lds
    s_waitcnt vmcnt(12)
    ds_read_b64_tr_b16 a[224:225], v22 offset:28672
    ds_read_b64_tr_b16 a[226:227], v22 offset:28736
    ds_read_b64_tr_b16 a[228:229], v22 offset:30720
    ds_read_b64_tr_b16 a[230:231], v22 offset:30784
    ds_read_b64_tr_b16 a[240:241], v22 offset:28704
    ds_read_b64_tr_b16 a[242:243], v22 offset:28768
    ds_read_b64_tr_b16 a[244:245], v22 offset:30752
    ds_read_b64_tr_b16 a[246:247], v22 offset:30816
    s_waitcnt lgkmcnt(0)
    s_add_u32 m0, s72, 28672
    s_add_u32 s17, s71, 73920
    buffer_load_dwordx4 v16, s[76:79], s17 offen lds
    s_add_u32 m0, m0, 1024
    s_add_u32 s17, s71, 92352
    buffer_load_dwordx4 v16, s[76:79], s17 offen lds
    s_add_u32 m0, m0, 1024
    s_add_u32 s17, s71, 110784
    buffer_load_dwordx4 v16, s[76:79], s17 offen lds
    s_add_u32 m0, m0, 1024
    s_add_u32 s17, s71, 129216
    buffer_load_dwordx4 v16, s[76:79], s17 offen lds
    s_waitcnt vmcnt(63)
    ds_read_b64_tr_b16 a[248:249], v23 offset:32768
    ds_read_b64_tr_b16 a[250:251], v23 offset:32800
    ds_read_b64_tr_b16 a[252:253], v23 offset:33792
    ds_read_b64_tr_b16 a[254:255], v23 offset:33824
    s_waitcnt lgkmcnt(0)
    s_add_u32 m0, s72, 32768
    s_add_u32 s17, s71, 73984
    buffer_load_dwordx4 v17, s[76:79], s17 offen lds
    s_add_u32 m0, m0, 1024
    s_add_u32 s17, s71, 110848
    buffer_load_dwordx4 v17, s[76:79], s17 offen lds
    s_waitcnt vmcnt(14)
    ds_read_b64_tr_b16 v[24:25], v22 offset:16384
    ds_read_b64_tr_b16 v[26:27], v22 offset:16448
    ds_read_b64_tr_b16 v[28:29], v22 offset:18432
    ds_read_b64_tr_b16 v[30:31], v22 offset:18496
    ds_read_b64_tr_b16 v[32:33], v22 offset:16416
    ds_read_b64_tr_b16 v[34:35], v22 offset:16480
    ds_read_b64_tr_b16 v[36:37], v22 offset:18464
    ds_read_b64_tr_b16 v[38:39], v22 offset:18528
    s_waitcnt lgkmcnt(0)
    ds_write_b128 v8, v[24:27] offset:16384
    ds_write_b128 v8, v[28:31] offset:17408
    ds_write_b128 v8, v[32:35] offset:18432
    ds_write_b128 v8, v[36:39] offset:19456
    s_waitcnt lgkmcnt(0)
    s_waitcnt vmcnt(10)
    ds_read_b64_tr_b16 v[24:25], v22 offset:20480
    ds_read_b64_tr_b16 v[26:27], v22 offset:20544
    ds_read_b64_tr_b16 v[28:29], v22 offset:22528
    ds_read_b64_tr_b16 v[30:31], v22 offset:22592
    ds_read_b64_tr_b16 v[32:33], v22 offset:20512
    ds_read_b64_tr_b16 v[34:35], v22 offset:20576
    ds_read_b64_tr_b16 v[36:37], v22 offset:22560
    ds_read_b64_tr_b16 v[38:39], v22 offset:22624
    s_waitcnt lgkmcnt(0)
    ds_write_b128 v8, v[24:27] offset:20480
    ds_write_b128 v8, v[28:31] offset:21504
    ds_write_b128 v8, v[32:35] offset:22528
    ds_write_b128 v8, v[36:39] offset:23552
    s_waitcnt lgkmcnt(0)
    s_waitcnt vmcnt(6)
    ds_read_b64_tr_b16 v[24:25], v22 offset:24576
    ds_read_b64_tr_b16 v[26:27], v22 offset:24640
    ds_read_b64_tr_b16 v[28:29], v22 offset:26624
    ds_read_b64_tr_b16 v[30:31], v22 offset:26688
    ds_read_b64_tr_b16 v[32:33], v22 offset:24608
    ds_read_b64_tr_b16 v[34:35], v22 offset:24672
    ds_read_b64_tr_b16 v[36:37], v22 offset:26656
    ds_read_b64_tr_b16 v[38:39], v22 offset:26720
    s_waitcnt lgkmcnt(0)
    ds_write_b128 v8, v[24:27] offset:24576
    ds_write_b128 v8, v[28:31] offset:25600
    ds_write_b128 v8, v[32:35] offset:26624
    ds_write_b128 v8, v[36:39] offset:27648
    s_waitcnt lgkmcnt(0)
    s_waitcnt vmcnt(2)
    ds_read_b64_tr_b16 v[24:25], v22 offset:28672
    ds_read_b64_tr_b16 v[26:27], v22 offset:28736
    ds_read_b64_tr_b16 v[28:29], v22 offset:30720
    ds_read_b64_tr_b16 v[30:31], v22 offset:30784
    ds_read_b64_tr_b16 v[32:33], v22 offset:28704
    ds_read_b64_tr_b16 v[34:35], v22 offset:28768
    ds_read_b64_tr_b16 v[36:37], v22 offset:30752
    ds_read_b64_tr_b16 v[38:39], v22 offset:30816
    s_waitcnt lgkmcnt(0)
    ds_write_b128 v8, v[24:27] offset:28672
    ds_write_b128 v8, v[28:31] offset:29696
    ds_write_b128 v8, v[32:35] offset:30720
    ds_write_b128 v8, v[36:39] offset:31744
    s_waitcnt lgkmcnt(0)
    s_waitcnt vmcnt(0)
    ds_read_b64_tr_b16 v[24:25], v23 offset:32768
    ds_read_b64_tr_b16 v[26:27], v23 offset:32800
    ds_read_b64_tr_b16 v[28:29], v23 offset:33792
    ds_read_b64_tr_b16 v[30:31], v23 offset:33824
    s_waitcnt lgkmcnt(0)
    ds_write_b128 v8, v[24:27] offset:32768
    ds_write_b128 v8, v[28:31] offset:33792
    s_waitcnt lgkmcnt(0)
    v_bfe_u32 v9, v0, 4, 4
    v_mov_b32 v10, 0x3f80
    v_mov_b32 v16, 0x3f800000
    v_cmp_eq_u32 vcc, 0, v9
    v_cmp_eq_u32 s[48:49], 1, v9
    s_nop 0
    v_cndmask_b32 v12, 0, v10, vcc
    v_cndmask_b32 v12, v12, v16, s[48:49]
    v_cmp_eq_u32 vcc, 2, v9
    v_cmp_eq_u32 s[48:49], 3, v9
    s_nop 0
    v_cndmask_b32 v13, 0, v10, vcc
    v_cndmask_b32 v13, v13, v16, s[48:49]
    v_cmp_eq_u32 vcc, 4, v9
    v_cmp_eq_u32 s[48:49], 5, v9
    s_nop 0
    v_cndmask_b32 v14, 0, v10, vcc
    v_cndmask_b32 v14, v14, v16, s[48:49]
    v_cmp_eq_u32 vcc, 6, v9
    v_cmp_eq_u32 s[48:49], 7, v9
    s_nop 0
    v_cndmask_b32 v15, 0, v10, vcc
    v_cndmask_b32 v15, v15, v16, s[48:49]
    v_add_u32 v9, 162560, v0
    ds_write_b128 v9, v[12:15]
    s_waitcnt lgkmcnt(0)
    s_mov_b64 exec, 0xff
    v_lshrrev_b32 v14, 2, v0
    v_lshlrev_b32 v12, 5, v14
    v_and_b32 v12, 128, v12
    v_lshrrev_b32 v13, 1, v14
    v_and_or_b32 v12, v13, 12, v12
    s_mov_b32 s16, 0
L_pure:
    global_load_dword v13, v12, s[12:13] sc1
    s_add_u32 s16, s16, 1
    s_cmp_gt_u32 s16, 100000
    s_cbranch_scc1 Lr_abort
    s_mov_b32 s6, 0
    s_waitcnt vmcnt(0)
    v_readlane_b32 s7, v13, 0
    s_nop 0
    s_add_u32 s6, s6, s7
    v_readlane_b32 s7, v13, 1
    s_nop 0
    s_add_u32 s6, s6, s7
    v_readlane_b32 s7, v13, 2
    s_nop 0
    s_add_u32 s6, s6, s7
    v_readlane_b32 s7, v13, 3
    s_nop 0
    s_add_u32 s6, s6, s7
    v_readlane_b32 s7, v13, 4
    s_nop 0
    s_add_u32 s6, s6, s7
    v_readlane_b32 s7, v13, 5
    s_nop 0
    s_add_u32 s6, s6, s7
    v_readlane_b32 s7, v13, 6
    s_nop 0
    s_add_u32 s6, s6, s7
    v_readlane_b32 s7, v13, 7
    s_nop 0
    s_add_u32 s6, s6, s7
    v_readlane_b32 s7, v13, s32
    s_nop 0
    s_cmp_ge_u32 s7, 32
    s_cselect_b32 s51, 1, 0
    s_cselect_b32 s6, 256, s6
    s_cmp_lt_u32 s6, 256
    s_cbranch_scc1 L_pure
    s_mov_b64 exec, -1
    s_lshl_b32 s6, s32, 2
    s_add_u32 s6, s6, 192
    s_cmp_lg_u32 s14, 0
    s_cbranch_scc1 L_team_d
    v_mov_b32 v12, s6
    s_mov_b32 s16, 0
L_team:
    global_load_dword v13, v12, s[12:13] sc1
    s_add_u32 s16, s16, 1
    s_cmp_gt_u32 s16, 100000
    s_cbranch_scc1 Lr_abort
    s_waitcnt vmcnt(0)
    v_cmp_gt_u32 vcc, 32, v13
    s_nop 0
    s_cbranch_vccz L_team_d
    s_sleep 8
    s_branch L_team
L_team_d:
    s_barrier
    s_cmp_lg_u32 s14, 0
    s_cbranch_scc1 L_rpoola_d
    v_mov_b32 v12, 40
    s_mov_b32 s16, 0
L_rpoola:
    global_load_dword v13, v12, s[12:13] sc1
    s_add_u32 s16, s16, 1
    s_cmp_gt_u32 s16, 100000
    s_cbranch_scc1 Lr_abort
    s_waitcnt vmcnt(0)
    v_cmp_gt_u32 vcc, 72, v13
    s_nop 0
    s_cbranch_vccz L_rpoola_d
    s_sleep 8
    s_branch L_rpoola
L_rpoola_d:
    s_barrier
    s_cmp_eq_u32 s32, 0
    s_cbranch_scc1 L_rpool_skip
    s_cmp_lg_u32 s14, 0
    s_cbranch_scc1 L_rpool_d
    v_mov_b32 v12, 160
    s_mov_b32 s16, 0
L_rpool:
    global_load_dword v13, v12, s[12:13] sc1
    s_add_u32 s16, s16, 1
    s_cmp_gt_u32 s16, 100000
    s_cbranch_scc1 Lr_abort
    s_waitcnt vmcnt(0)
    v_cmp_gt_u32 vcc, 64, v13
    s_nop 0
    s_cbranch_vccz L_rpool_d
    s_sleep 8
    s_branch L_rpool
L_rpool_d:
    s_barrier
L_rpool_skip:
    s_barrier
    s_cmp_eq_u32 s51, 0
    s_cbranch_scc1 L_slow
    s_cmp_lg_u32 s14, 0
    s_cbranch_scc1 L_w1_1
    s_mov_b32 s16, 0
    s_add_u32 s17, s66, 128
    v_lshrrev_b32 v10, 2, v0
    v_and_b32 v9, 16, v10
    v_lshlrev_b32 v9, 3, v9
    v_and_or_b32 v10, v10, 12, v9
Lr0f_fw_10:
    buffer_load_dword v9, v10, s[8:11], s17 offen sc1
    s_add_u32 s16, s16, 1
    s_cmp_gt_u32 s16, 100000
    s_cbranch_scc1 Lr_abort
    s_waitcnt vmcnt(0)
    v_cmp_eq_u32 vcc, 0, v9
    s_nop 0
    s_cbranch_vccnz Lr0f_fw_10
    s_mov_b32 m0, 15104
    s_nop 0
    buffer_load_dwordx4 v0, s[8:11], s41 offen offset:0 lds
    buffer_load_dwordx4 v0, s[8:11], s41 offen offset:1024 lds
    s_add_u32 s41, s41, 262144
    s_add_u32 s68, s68, 4278452224
    s_waitcnt vmcnt(0)
    ds_read_b128 v[56:59], v8 offset:0
    ds_read_b128 v[60:63], v8 offset:1024
    ds_read_b128 v[64:67], v8 offset:2048
    ds_read_b128 v[68:71], v8 offset:3072
    v_mov_b64 v[12:13], 0
    v_mov_b64 v[14:15], 0
    v_mov_b64 v[16:17], 0
    v_mov_b64 v[18:19], 0
    v_mov_b64 v[20:21], 0
    v_mov_b64 v[22:23], 0
    v_mov_b64 v[24:25], 0
    v_mov_b64 v[26:27], 0
    v_mov_b64 v[28:29], 0
    v_mov_b64 v[30:31], 0
    v_mov_b64 v[32:33], 0
    v_mov_b64 v[34:35], 0
    buffer_load_dwordx4 v[36:39], v0, s[8:11], s34 offen sc1
    s_waitcnt vmcnt(0) lgkmcnt(0)
Lr0f_step:
    s_mov_b32 s16, 0
Lr0f_alp:
    s_waitcnt vmcnt(2)
    v_max3_u32 v10, v36, v37, v38
    v_max_u32 v10, v10, v39
    v_cmp_eq_u32 vcc, -1, v10
    s_nop 0
    s_cbranch_vccz Lr0f_aok
    buffer_load_dwordx4 v[36:39], v0, s[8:11], s34 offen sc1
    s_add_u32 s16, s16, 1
    s_cmp_gt_u32 s16, 100000
    s_cbranch_scc1 Lr_abort
    s_branch Lr0f_alp
Lr0f_aok:
    ds_write_b128 v0, v[36:39] offset:6912
    v_smfmac_f32_16x16x64_bf16 v[12:15], v[36:39], v[72:79], v1
    v_smfmac_f32_16x16x64_bf16 v[16:19], v[36:39], v[80:87], v1
    v_smfmac_f32_16x16x64_bf16 v[20:23], v[36:39], v[184:191], v1
    s_waitcnt lgkmcnt(0)
    s_barrier
    ds_read_b128 v[48:51], v0 offset:7936
    ds_read_b128 v[52:55], v0 offset:8960
    v_smfmac_f32_16x16x64_bf16 v[28:31], v[36:39], v[56:63], v1
    ds_read_b128 v[56:59], v8 offset:4096
    ds_read_b128 v[60:63], v8 offset:5120
    s_add_u32 s17, s34, 4096
    buffer_load_dwordx4 v[40:43], v0, s[8:11], s17 offen sc1
    v_smfmac_f32_16x16x64_bf16 v[24:27], v[36:39], v[192:199], v1
    v_smfmac_f32_16x16x64_bf16 v[32:35], v[36:39], v[64:71], v1
    ds_read_b128 v[64:67], v8 offset:6144
    ds_read_b128 v[68:71], v8 offset:7168
    s_waitcnt vmcnt(1)
    ds_read_b128 v[36:39], v0 offset:9984
    s_waitcnt lgkmcnt(6)
    v_smfmac_f32_16x16x64_bf16 v[28:31], v[48:51], a[72:79], v1
    v_smfmac_f32_16x16x64_bf16 v[12:15], v[48:51], v[88:95], v1
    buffer_load_dwordx4 v[44:47], v0, s[8:11], s35 offen sc1
    v_smfmac_f32_16x16x64_bf16 v[16:19], v[48:51], v[96:103], v1
    v_smfmac_f32_16x16x64_bf16 v[32:35], v[48:51], a[80:87], v1
    v_smfmac_f32_16x16x64_bf16 v[20:23], v[48:51], v[200:207], v1
    v_smfmac_f32_16x16x64_bf16 v[24:27], v[48:51], v[208:215], v1
    s_waitcnt lgkmcnt(3)
    v_smfmac_f32_16x16x64_bf16 v[28:31], v[52:55], v[56:63], v1
    ds_read_b128 v[56:59], v8 offset:8192
    ds_read_b128 v[60:63], v8 offset:9216
    v_smfmac_f32_16x16x64_bf16 v[12:15], v[52:55], v[104:111], v1
    v_smfmac_f32_16x16x64_bf16 v[16:19], v[52:55], v[112:119], v1
    s_waitcnt lgkmcnt(3)
    v_smfmac_f32_16x16x64_bf16 v[32:35], v[52:55], v[64:71], v1
    ds_read_b128 v[64:67], v8 offset:10240
    ds_read_b128 v[68:71], v8 offset:11264
    v_smfmac_f32_16x16x64_bf16 v[20:23], v[52:55], v[216:223], v1
    v_smfmac_f32_16x16x64_bf16 v[24:27], v[52:55], v[224:231], v1
    s_waitcnt lgkmcnt(4)
    v_smfmac_f32_16x16x64_bf16 v[28:31], v[36:39], a[88:95], v1
    v_smfmac_f32_16x16x64_bf16 v[12:15], v[36:39], v[120:127], v1
    v_smfmac_f32_16x16x64_bf16 v[16:19], v[36:39], v[128:135], v1
    v_smfmac_f32_16x16x64_bf16 v[32:35], v[36:39], a[96:103], v1
    v_smfmac_f32_16x16x64_bf16 v[20:23], v[36:39], v[232:239], v1
    v_smfmac_f32_16x16x64_bf16 v[24:27], v[36:39], v[240:247], v1
    s_waitcnt vmcnt(1)
    v_max3_u32 v10, v40, v41, v42
    v_max_u32 v10, v10, v43
    v_cmp_eq_u32 vcc, -1, v10
    s_nop 0
    s_cbranch_vccnz Lr0f_pb_re
Lr0f_pb_ok:
    ds_write_b128 v0, v[40:43] offset:11008
    s_waitcnt lgkmcnt(3)
    v_smfmac_f32_16x16x64_bf16 v[12:15], v[40:43], v[56:63], v1
    ds_read_b128 v[56:59], v8 offset:12288
    ds_read_b128 v[60:63], v8 offset:13312
    v_smfmac_f32_16x16x64_bf16 v[20:23], v[40:43], v[248:255], v1
    s_waitcnt lgkmcnt(3)
    v_smfmac_f32_16x16x64_bf16 v[16:19], v[40:43], v[64:71], v1
    ds_read_b128 v[64:67], v8 offset:14336
    ds_read_b128 v[68:71], v8 offset:15360
    v_smfmac_f32_16x16x64_bf16 v[24:27], v[40:43], a[0:7], v1
    s_waitcnt lgkmcnt(4)
    s_barrier
    ds_read_b128 v[48:51], v0 offset:13056
    ds_read_b128 v[52:55], v0 offset:12032
    ds_read_b128 v[36:39], v0 offset:14080
    v_smfmac_f32_16x16x64_bf16 v[28:31], v[40:43], a[104:111], v1
    v_smfmac_f32_16x16x64_bf16 v[32:35], v[40:43], a[112:119], v1
    s_waitcnt lgkmcnt(2)
    v_smfmac_f32_16x16x64_bf16 v[12:15], v[48:51], v[56:63], v1
    v_smfmac_f32_16x16x64_bf16 v[16:19], v[48:51], v[64:71], v1
    s_waitcnt lgkmcnt(1)
    v_smfmac_f32_16x16x64_bf16 v[12:15], v[52:55], v[136:143], v1
    v_smfmac_f32_16x16x64_bf16 v[16:19], v[52:55], v[144:151], v1
    s_waitcnt lgkmcnt(0)
    v_smfmac_f32_16x16x64_bf16 v[12:15], v[36:39], v[152:159], v1
    v_smfmac_f32_16x16x64_bf16 v[16:19], v[36:39], v[160:167], v1
    s_waitcnt vmcnt(0)
    v_max3_u32 v10, v44, v45, v46
    v_max_u32 v10, v10, v47
    v_cmp_eq_u32 vcc, -1, v10
    s_nop 0
    s_cbranch_vccnz Lr0f_pc_re
Lr0f_pc_ok:
    v_smfmac_f32_16x16x64_bf16 v[12:15], v[44:47], v[168:175], v1
    v_smfmac_f32_16x16x64_bf16 v[16:19], v[44:47], v[176:183], v1
    v_smfmac_f32_16x16x64_bf16 v[20:23], v[48:51], a[24:31], v1
    buffer_load_dwordx4 v[64:67], v0, s[8:11], s42 offen
    v_smfmac_f32_16x16x64_bf16 v[24:27], v[48:51], a[32:39], v1
    v_smfmac_f32_16x16x64_bf16 v[20:23], v[52:55], a[8:15], v1
    v_add_f32 v12, v12, v14
    v_smfmac_f32_16x16x64_bf16 v[24:27], v[52:55], a[16:23], v1
    v_add_f32 v16, v16, v18
    v_smfmac_f32_16x16x64_bf16 v[20:23], v[36:39], a[40:47], v1
    v_add_f32 v13, v13, v15
    buffer_load_dwordx4 v[68:71], v0, s[8:11], s42 offen offset:1024
    v_smfmac_f32_16x16x64_bf16 v[24:27], v[36:39], a[48:55], v1
    v_add_f32 v17, v17, v19
    v_smfmac_f32_16x16x64_bf16 v[20:23], v[44:47], a[56:63], v1
    v_cvt_pk_bf16_f32 v14, v12, v16
    ds_read_b128 v[56:59], v0 offset:15104
    v_smfmac_f32_16x16x64_bf16 v[24:27], v[44:47], a[64:71], v1
    v_cvt_pk_bf16_f32 v15, v13, v17
    ds_read_b128 v[60:63], v0 offset:16128
    ds_write_b32 v2, v14 offset:576
    ds_write_b32 v2, v15 offset:864
    v_smfmac_f32_16x16x64_bf16 v[28:31], v[48:51], a[136:143], v1
    v_smfmac_f32_16x16x64_bf16 v[32:35], v[48:51], a[144:151], v1
    v_add_f32 v20, v20, v22
    v_add_f32 v24, v24, v26
    v_add_f32 v21, v21, v23
    v_add_f32 v25, v25, v27
    v_cvt_pk_bf16_f32 v22, v20, v24
    v_cvt_pk_bf16_f32 v23, v21, v25
    ds_write_b32 v2, v22 offset:0
    ds_write_b32 v2, v23 offset:288
    v_smfmac_f32_16x16x64_bf16 v[28:31], v[52:55], a[120:127], v1
    v_smfmac_f32_16x16x64_bf16 v[32:35], v[52:55], a[128:135], v1
    s_waitcnt lgkmcnt(0)
    s_barrier
    ds_read_b128 v[40:43], v3 offset:0
    ds_read_b128 v[48:51], v3 offset:64
    ds_read_b128 v[20:23], v3 offset:128
    ds_read_b128 v[52:55], v3 offset:192
    v_smfmac_f32_16x16x64_bf16 v[28:31], v[36:39], a[152:159], v1
    v_smfmac_f32_16x16x64_bf16 v[32:35], v[36:39], a[160:167], v1
    ds_read_b128 v[36:39], v0 offset:17152
    v_lshlrev_b32 v9, 3, v0
    buffer_load_dword v11, v9, s[8:11], s68 offen
    v_smfmac_f32_16x16x64_bf16 v[28:31], v[44:47], a[168:175], v1
    v_smfmac_f32_16x16x64_bf16 v[32:35], v[44:47], a[176:183], v1
    ds_read_b128 v[44:47], v0 offset:18176
    s_waitcnt lgkmcnt(5)
    v_mfma_f32_16x16x32_bf16 v[12:15], v[56:59], v[40:43], 0
    v_mfma_f32_16x16x32_bf16 v[16:19], v[60:63], v[40:43], 0
    v_mfma_f32_16x16x32_bf16 v[24:27], v[40:43], v[40:43], 0
    ds_read_b128 v[56:59], v0 offset:19200
    ds_read_b128 v[60:63], v0 offset:20224
    s_waitcnt lgkmcnt(3)
    v_mfma_f32_16x16x32_bf16 v[12:15], v[36:39], v[48:51], v[12:15]
    v_lshrrev_b32 v10, 1, v0
    v_lshrrev_b32 v9, 9, v0
    s_waitcnt lgkmcnt(2)
    v_mfma_f32_16x16x32_bf16 v[16:19], v[44:47], v[48:51], v[16:19]
    v_lshl_add_u32 v9, v9, 5, v10
    v_add_f32 v28, v28, v30
    v_mfma_f32_16x16x32_bf16 v[24:27], v[48:51], v[48:51], v[24:27]
    v_add_f32 v32, v32, v34
    v_add_f32 v29, v29, v31
    ds_read_b128 v[36:39], v0 offset:21248
    ds_read_b128 v[44:47], v0 offset:22272
    s_waitcnt lgkmcnt(3)
    v_mfma_f32_16x16x32_bf16 v[12:15], v[56:59], v[20:23], v[12:15]
    v_add_f32 v33, v33, v35
    v_cvt_pk_bf16_f32 v30, v28, v29
    s_waitcnt lgkmcnt(2)
    v_mfma_f32_16x16x32_bf16 v[16:19], v[60:63], v[20:23], v[16:19]
    v_cvt_pk_bf16_f32 v31, v32, v33
    ds_read_b64 v[34:35], v9 offset:0
    v_mfma_f32_16x16x32_bf16 v[24:27], v[20:23], v[20:23], v[24:27]
    s_add_u32 s17, s43, 2048
    buffer_store_dwordx2 v[30:31], v10, s[8:11], s17 offen sc1
    s_waitcnt lgkmcnt(2)
    v_mfma_f32_16x16x32_bf16 v[12:15], v[36:39], v[52:55], v[12:15]
    s_waitcnt lgkmcnt(1)
    v_mfma_f32_16x16x32_bf16 v[16:19], v[44:47], v[52:55], v[16:19]
    v_mfma_f32_16x16x32_bf16 v[24:27], v[52:55], v[52:55], v[24:27]
    s_add_u32 s17, s43, 0
    s_waitcnt lgkmcnt(0)
    buffer_store_dwordx2 v[34:35], v10, s[8:11], s17 offen sc1
    s_cmp_eq_u32 s33, 63
    s_cbranch_scc1 Lr0f_last
    ds_read_b128 v[56:59], v8 offset:16384
    ds_read_b128 v[60:63], v8 offset:17408
    v_mov_b64 v[20:21], s[52:53]
    v_mov_b64 v[22:23], s[52:53]
    v_mov_b32 v41, 0
    v_mov_b32 v42, 0
    v_max3_f32 v9, v12, v13, v14
    v_max3_f32 v9, v9, v15, v16
    v_max3_f32 v9, v9, v17, v18
    v_max3_f32 v9, v9, v19, v24
    v_max_f32 v9, v9, v25
    v_mov_b32 v10, v9
    v_mov_b64 v[32:33], 0
    v_mov_b64 v[34:35], 0
    v_permlane32_swap_b32 v9, v10
    v_max_f32 v9, v9, v10
    v_mov_b32 v10, v9
    s_nop 1
    v_permlane16_swap_b32 v9, v10
    v_max_f32 v9, v9, v10
    v_mul_f32 v28, s44, v9
    v_fma_f32 v12, v12, s44, -v28
    v_fma_f32 v13, v13, s44, -v28
    v_fma_f32 v14, v14, s44, -v28
    v_fma_f32 v15, v15, s44, -v28
    v_exp_f32 v12, v12
    v_exp_f32 v13, v13
    v_fma_f32 v16, v16, s44, -v28
    v_fma_f32 v17, v17, s44, -v28
    v_exp_f32 v14, v14
    v_exp_f32 v15, v15
    v_cvt_pk_bf16_f32 v36, v12, v13
    v_fma_f32 v18, v18, s44, -v28
    v_fma_f32 v19, v19, s44, -v28
    v_exp_f32 v16, v16
    v_exp_f32 v17, v17
    v_cvt_pk_bf16_f32 v37, v14, v15
    v_fma_f32 v24, v24, s44, -v28
    v_fma_f32 v25, v25, s44, -v28
    v_exp_f32 v18, v18
    v_exp_f32 v19, v19
    v_cvt_pk_bf16_f32 v38, v16, v17
    v_exp_f32 v24, v24
    v_exp_f32 v25, v25
    v_cvt_pk_bf16_f32 v39, v18, v19
    v_cvt_pk_bf16_f32 v40, v24, v25
    v_cvt_pk_bf16_f32 v43, v24, v25
    v_mfma_f32_16x16x32_bf16 v[52:55], v[20:23], v[36:39], 0
    v_mov_b64 v[12:13], 0
    v_mov_b64 v[14:15], 0
    s_waitcnt vmcnt(4)
    v_mfma_f32_16x16x32_bf16 v[44:47], v[64:67], v[36:39], 0
    v_mov_b64 v[24:25], 0
    v_mov_b64 v[26:27], 0
    s_waitcnt vmcnt(3)
    v_mfma_f32_16x16x32_bf16 v[48:51], v[68:71], v[36:39], 0
    ds_read_b128 v[64:67], v8 offset:20480
    ds_read_b128 v[68:71], v8 offset:21504
    v_mfma_f32_16x16x16_bf16 v[52:55], v[20:21], v[40:41], v[52:55]
    v_mfma_f32_16x16x16_bf16 v[44:47], v[30:31], v[40:41], v[44:47]
    v_mov_b64 v[20:21], 0
    v_mov_b64 v[22:23], 0
    v_mfma_f32_16x16x16_bf16 v[48:51], v[30:31], v[42:43], v[48:51]
    v_mov_b64 v[36:37], 0
    v_mov_b64 v[38:39], 0
    v_mov_b64 v[40:41], 0
    v_mov_b64 v[42:43], 0
    v_rcp_f32 v9, v52
    v_mov_b64 v[52:53], 0
    v_mov_b64 v[54:55], 0
    v_mul_f32 v44, v9, v44
    v_mul_f32 v48, v9, v48
    v_cvt_pk_bf16_f32 v16, v44, v48
    v_mul_f32 v45, v9, v45
    v_mul_f32 v49, v9, v49
    v_cvt_pk_bf16_f32 v17, v45, v49
    v_mul_f32 v46, v9, v46
    v_mul_f32 v50, v9, v50
    v_cvt_pk_bf16_f32 v18, v46, v50
    v_mul_f32 v47, v9, v47
    v_mul_f32 v51, v9, v51
    v_cvt_pk_bf16_f32 v19, v47, v51
    ds_write_b128 v5, v[16:19]
    v_mov_b64 v[28:29], 0
    v_mov_b64 v[30:31], 0
    s_waitcnt lgkmcnt(0)
    s_barrier
    ds_read_b128 v[44:47], v4 offset:0
    ds_read_b128 v[48:51], v4 offset:128
    v_mov_b64 v[16:17], 0
    v_mov_b64 v[18:19], 0
    buffer_load_dwordx4 v0, s[8:11], s41 offen offset:0 lds
    buffer_load_dwordx4 v0, s[8:11], s41 offen offset:1024 lds
    s_waitcnt lgkmcnt(1)
    v_smfmac_f32_16x16x64_bf16 v[12:15], v[44:47], a[184:191], v1
    s_waitcnt lgkmcnt(0)
    v_smfmac_f32_16x16x64_bf16 v[12:15], v[48:51], a[192:199], v1
    v_smfmac_f32_16x16x64_bf16 v[24:27], v[44:47], a[200:207], v1
    v_smfmac_f32_16x16x64_bf16 v[24:27], v[48:51], a[208:215], v1
    v_add_f32 v12, v12, v14
    v_smfmac_f32_16x16x64_bf16 v[20:23], v[44:47], a[216:223], v1
    v_add_f32 v13, v13, v15
    v_smfmac_f32_16x16x64_bf16 v[20:23], v[48:51], a[224:231], v1
    v_cvt_pk_bf16_f32 v12, v12, v13
    v_smfmac_f32_16x16x64_bf16 v[16:19], v[44:47], a[232:239], v1
    v_add_f32 v24, v24, v26
    v_smfmac_f32_16x16x64_bf16 v[16:19], v[48:51], a[240:247], v1
    v_add_f32 v25, v25, v27
    v_smfmac_f32_16x16x64_bf16 v[36:39], v[44:47], v[56:63], v1
    v_cvt_pk_bf16_f32 v13, v24, v25
    v_smfmac_f32_16x16x64_bf16 v[36:39], v[48:51], v[64:71], v1
    v_add_f32 v20, v20, v22
    v_add_f32 v21, v21, v23
    v_cvt_pk_bf16_f32 v14, v20, v21
    v_add_f32 v16, v16, v18
    v_add_f32 v17, v17, v19
    v_cvt_pk_bf16_f32 v15, v16, v17
    v_and_or_b32 v15, v15, -2, s40
    buffer_store_dwordx4 v[12:15], v0, s[8:11], s38 offen
    s_nop 0
    ds_read_b128 v[12:15], v8 offset:18432
    ds_read_b128 v[16:19], v8 offset:19456
    ds_read_b128 v[20:23], v8 offset:22528
    ds_read_b128 v[24:27], v8 offset:23552
    ds_read_b128 v[56:59], v8 offset:24576
    ds_read_b128 v[60:63], v8 offset:25600
    ds_read_b128 v[64:67], v8 offset:28672
    ds_read_b128 v[68:71], v8 offset:29696
    s_waitcnt lgkmcnt(6)
    v_smfmac_f32_16x16x64_bf16 v[40:43], v[44:47], v[12:19], v1
    ds_read_b128 v[12:15], v8 offset:26624
    ds_read_b128 v[16:19], v8 offset:27648
    s_waitcnt lgkmcnt(6)
    v_smfmac_f32_16x16x64_bf16 v[40:43], v[48:51], v[20:27], v1
    ds_read_b128 v[20:23], v8 offset:30720
    ds_read_b128 v[24:27], v8 offset:31744
    s_waitcnt lgkmcnt(6)
    v_smfmac_f32_16x16x64_bf16 v[52:55], v[44:47], v[56:63], v1
    ds_read_b128 v[56:59], v8 offset:32768
    ds_read_b128 v[60:63], v8 offset:33792
    s_waitcnt lgkmcnt(6)
    v_smfmac_f32_16x16x64_bf16 v[52:55], v[48:51], v[64:71], v1
    s_waitcnt lgkmcnt(4)
    v_smfmac_f32_16x16x64_bf16 v[32:35], v[44:47], v[12:19], v1
    s_waitcnt lgkmcnt(2)
    v_smfmac_f32_16x16x64_bf16 v[32:35], v[48:51], v[20:27], v1
    v_smfmac_f32_16x16x64_bf16 v[28:31], v[44:47], a[248:255], v1
    s_waitcnt lgkmcnt(0)
    v_smfmac_f32_16x16x64_bf16 v[28:31], v[48:51], v[56:63], v1
    buffer_load_dwordx4 v[12:15], v6, s[8:11], s62 offen sc1
    buffer_load_dwordx4 v[16:19], v6, s[8:11], s63 offen sc1
    buffer_load_dwordx4 v[20:23], v6, s[8:11], s64 offen sc1
    buffer_load_dwordx4 v[24:27], v6, s[8:11], s65 offen sc1
    v_add_f32 v36, v36, v38
    v_add_f32 v37, v37, v39
    v_cvt_pk_bf16_f32 v36, v36, v37
    v_add_f32 v40, v40, v42
    v_add_f32 v41, v41, v43
    v_cvt_pk_bf16_f32 v37, v40, v41
    v_add_f32 v52, v52, v54
    v_add_f32 v53, v53, v55
    v_cvt_pk_bf16_f32 v38, v52, v53
    v_add_f32 v32, v32, v34
    v_add_f32 v33, v33, v35
    v_cvt_pk_bf16_f32 v39, v32, v33
    v_and_or_b32 v39, v39, -2, s40
    s_add_u32 s17, s38, 4096
    buffer_store_dwordx4 v[36:39], v0, s[8:11], s17 offen
    v_add_f32 v28, v28, v30
    v_add_f32 v29, v29, v31
    v_cvt_pk_bf16_f32 v28, v28, v29
    v_and_or_b32 v28, v28, -2, s40
    v_lshrrev_b32 v9, 2, v0
    buffer_store_dword v28, v9, s[8:11], s39 offen
    v_add_u32 v10, 162560, v0
    ds_read_b128 v[64:67], v10
    s_nop 9
    buffer_load_dwordx4 v[40:43], v6, s[8:11], s62 offen sc1
    buffer_load_dwordx4 v[44:47], v6, s[8:11], s63 offen sc1
    buffer_load_dwordx4 v[48:51], v6, s[8:11], s64 offen sc1
    buffer_load_dwordx4 v[52:55], v6, s[8:11], s65 offen sc1
    s_add_u32 s33, s33, 1
    s_add_u32 s42, s42, 262144
    s_add_u32 s41, s41, 262144
    s_add_u32 s43, s43, 131072
    s_add_u32 s68, s68, 262144
    s_add_u32 s66, s66, 22528
    ds_read_b128 v[56:59], v8 offset:0
    ds_read_b128 v[60:63], v8 offset:1024
    s_waitcnt lgkmcnt(2)
    s_waitcnt vmcnt(9)
    v_mfma_f32_16x16x32_bf16 v[68:71], v[12:15], v[64:67], 0
    v_and_b32 v10, 1, v15
    v_cmp_ne_u32 s[54:55], s40, v10
    s_waitcnt vmcnt(8)
    v_mfma_f32_16x16x32_bf16 v[68:71], v[16:19], v[64:67], v[68:71]
    v_and_b32 v10, 1, v19
    v_cmp_ne_u32 s[56:57], s40, v10
    s_waitcnt vmcnt(7)
    v_mfma_f32_16x16x32_bf16 v[68:71], v[20:23], v[64:67], v[68:71]
    v_and_b32 v10, 1, v23
    v_cmp_ne_u32 s[58:59], s40, v10
    s_waitcnt vmcnt(6)
    v_mfma_f32_16x16x32_bf16 v[68:71], v[24:27], v[64:67], v[68:71]
    v_and_b32 v10, 1, v27
    v_cmp_ne_u32 s[60:61], s40, v10
    s_or_b64 vcc, s[54:55], s[56:57]
    s_or_b64 vcc, vcc, s[58:59]
    s_or_b64 vcc, vcc, s[60:61]
    s_cbranch_scc0 Lr0f_red
    s_mov_b32 s16, 0
Lr0f_p1:
    buffer_load_dwordx4 v[12:15], v6, s[8:11], s62 offen sc1
    buffer_load_dwordx4 v[16:19], v6, s[8:11], s63 offen sc1
    buffer_load_dwordx4 v[20:23], v6, s[8:11], s64 offen sc1
    buffer_load_dwordx4 v[24:27], v6, s[8:11], s65 offen sc1
    s_waitcnt vmcnt(7)
    v_mfma_f32_16x16x32_bf16 v[68:71], v[40:43], v[64:67], 0
    v_and_b32 v10, 1, v43
    v_cmp_ne_u32 s[54:55], s40, v10
    s_waitcnt vmcnt(6)
    v_mfma_f32_16x16x32_bf16 v[68:71], v[44:47], v[64:67], v[68:71]
    v_and_b32 v10, 1, v47
    v_cmp_ne_u32 s[56:57], s40, v10
    s_waitcnt vmcnt(5)
    v_mfma_f32_16x16x32_bf16 v[68:71], v[48:51], v[64:67], v[68:71]
    v_and_b32 v10, 1, v51
    v_cmp_ne_u32 s[58:59], s40, v10
    s_waitcnt vmcnt(4)
    v_mfma_f32_16x16x32_bf16 v[68:71], v[52:55], v[64:67], v[68:71]
    v_and_b32 v10, 1, v55
    v_cmp_ne_u32 s[60:61], s40, v10
    s_or_b64 vcc, s[54:55], s[56:57]
    s_or_b64 vcc, vcc, s[58:59]
    s_or_b64 vcc, vcc, s[60:61]
    s_cbranch_scc0 Lr0f_red
    buffer_load_dwordx4 v[40:43], v6, s[8:11], s62 offen sc1
    buffer_load_dwordx4 v[44:47], v6, s[8:11], s63 offen sc1
    buffer_load_dwordx4 v[48:51], v6, s[8:11], s64 offen sc1
    buffer_load_dwordx4 v[52:55], v6, s[8:11], s65 offen sc1
    s_add_u32 s16, s16, 1
    s_cmp_gt_u32 s16, 100000
    s_cbranch_scc1 Lr_abort
    s_waitcnt vmcnt(7)
    v_mfma_f32_16x16x32_bf16 v[68:71], v[12:15], v[64:67], 0
    v_and_b32 v10, 1, v15
    v_cmp_ne_u32 s[54:55], s40, v10
    s_waitcnt vmcnt(6)
    v_mfma_f32_16x16x32_bf16 v[68:71], v[16:19], v[64:67], v[68:71]
    v_and_b32 v10, 1, v19
    v_cmp_ne_u32 s[56:57], s40, v10
    s_waitcnt vmcnt(5)
    v_mfma_f32_16x16x32_bf16 v[68:71], v[20:23], v[64:67], v[68:71]
    v_and_b32 v10, 1, v23
    v_cmp_ne_u32 s[58:59], s40, v10
    s_waitcnt vmcnt(4)
    v_mfma_f32_16x16x32_bf16 v[68:71], v[24:27], v[64:67], v[68:71]
    v_and_b32 v10, 1, v27
    v_cmp_ne_u32 s[60:61], s40, v10
    s_or_b64 vcc, s[54:55], s[56:57]
    s_or_b64 vcc, vcc, s[58:59]
    s_or_b64 vcc, vcc, s[60:61]
    s_cbranch_scc1 Lr0f_p1
Lr0f_red:
    s_nop 1
    v_permlane16_swap_b32 v68, v70
    v_permlane16_swap_b32 v69, v71
    s_mov_b64 exec, s[46:47]
    v_add_f32 v68, v68, v70
    v_add_f32 v69, v69, v71
    v_cvt_pk_bf16_f32 v68, v68, v69
    v_min_u32 v68, s50, v68
    buffer_store_dword v68, v7, s[8:11], s36 offen
    v_mov_b32 v69, -1
    buffer_store_dword v69, v7, s[8:11], s37 offen
    s_mov_b64 exec, -1
    s_xor_b32 s34, s34, 16384
    s_xor_b32 s35, s35, 16384
    s_xor_b32 s40, s40, 1
    s_xor_b32 s36, s36, 16384
    s_xor_b32 s37, s37, 16384
    s_nop 15
    s_nop 3
    buffer_load_dwordx4 v[36:39], v0, s[8:11], s34 offen sc1
    s_waitcnt vmcnt(3)
    ds_read_b128 v[64:67], v8 offset:2048
    ds_read_b128 v[68:71], v8 offset:3072
    v_mov_b64 v[12:13], 0
    v_mov_b64 v[14:15], 0
    v_mov_b64 v[16:17], 0
    v_mov_b64 v[18:19], 0
    v_mov_b64 v[20:21], 0
    v_mov_b64 v[22:23], 0
    v_mov_b64 v[24:25], 0
    v_mov_b64 v[26:27], 0
    v_mov_b64 v[28:29], 0
    v_mov_b64 v[30:31], 0
    v_mov_b64 v[32:33], 0
    v_mov_b64 v[34:35], 0
    s_nop 9
    buffer_load_dwordx4 v[36:39], v0, s[8:11], s34 offen sc1
    s_nop 15
    s_nop 8
    buffer_load_dwordx4 v[36:39], v0, s[8:11], s34 offen sc1
    s_waitcnt lgkmcnt(0)
    s_branch Lr0f_step
Lr0f_pb_re:
    s_mov_b32 s16, 0
Lr0f_pb_lp:
    s_add_u32 s17, s34, 4096
    buffer_load_dwordx4 v[40:43], v0, s[8:11], s17 offen sc1
    s_add_u32 s16, s16, 1
    s_cmp_gt_u32 s16, 100000
    s_cbranch_scc1 Lr_abort
    s_waitcnt vmcnt(0)
    v_max3_u32 v10, v40, v41, v42
    v_max_u32 v10, v10, v43
    v_cmp_eq_u32 vcc, -1, v10
    s_nop 0
    s_cbranch_vccnz Lr0f_pb_lp
    s_branch Lr0f_pb_ok
Lr0f_pc_re:
    s_mov_b32 s16, 0
Lr0f_pc_lp:
    buffer_load_dwordx4 v[44:47], v0, s[8:11], s35 offen sc1
    s_add_u32 s16, s16, 1
    s_cmp_gt_u32 s16, 100000
    s_cbranch_scc1 Lr_abort
    s_waitcnt vmcnt(0)
    v_max3_u32 v10, v44, v45, v46
    v_max_u32 v10, v10, v47
    v_cmp_eq_u32 vcc, -1, v10
    s_nop 0
    s_cbranch_vccnz Lr0f_pc_lp
    s_branch Lr0f_pc_ok
Lr0f_last:
    s_waitcnt vmcnt(0) lgkmcnt(0)
    s_barrier
    s_branch Lr_exit
L_w1_1:
    s_cmp_lg_u32 s14, 1
    s_cbranch_scc1 L_w2_1
    s_mov_b32 s16, 0
    s_add_u32 s17, s66, 128
    v_lshrrev_b32 v10, 2, v0
    v_and_b32 v9, 16, v10
    v_lshlrev_b32 v9, 3, v9
    v_and_or_b32 v10, v10, 12, v9
Lr1f_fw_11:
    buffer_load_dword v9, v10, s[8:11], s17 offen sc1
    s_add_u32 s16, s16, 1
    s_cmp_gt_u32 s16, 100000
    s_cbranch_scc1 Lr_abort
    s_waitcnt vmcnt(0)
    v_cmp_eq_u32 vcc, 0, v9
    s_nop 0
    s_cbranch_vccnz Lr1f_fw_11
    s_lshl_b32 s67, s32, 5
    s_add_u32 s67, s67, s15
    s_lshl_b32 s67, s67, 12
    s_add_u32 s67, s67, 3145728
    s_mov_b32 m0, 17152
    s_nop 0
    buffer_load_dwordx4 v0, s[8:11], s41 offen offset:0 lds
    buffer_load_dwordx4 v0, s[8:11], s41 offen offset:1024 lds
    s_add_u32 s41, s41, 262144
    s_add_u32 s68, s68, 262144
    s_waitcnt vmcnt(0)
    ds_read_b128 v[56:59], v8 offset:4096
    ds_read_b128 v[60:63], v8 offset:5120
    ds_read_b128 v[64:67], v8 offset:6144
    ds_read_b128 v[68:71], v8 offset:7168
    v_mov_b64 v[12:13], 0
    v_mov_b64 v[14:15], 0
    v_mov_b64 v[16:17], 0
    v_mov_b64 v[18:19], 0
    v_mov_b64 v[20:21], 0
    v_mov_b64 v[22:23], 0
    v_mov_b64 v[24:25], 0
    v_mov_b64 v[26:27], 0
    v_mov_b64 v[28:29], 0
    v_mov_b64 v[30:31], 0
    v_mov_b64 v[32:33], 0
    v_mov_b64 v[34:35], 0
    buffer_load_dwordx4 v[36:39], v0, s[8:11], s34 offen sc1
    s_waitcnt vmcnt(0) lgkmcnt(0)
Lr1f_step:
    s_waitcnt vmcnt(3)
    v_max3_u32 v10, v36, v37, v38
    v_max_u32 v10, v10, v39
    v_cmp_eq_u32 vcc, -1, v10
    s_nop 0
    s_cbranch_vccz Lr1f_aok
    buffer_load_dwordx4 v[36:39], v0, s[8:11], s34 offen sc1
    s_nop 15
    s_nop 8
    buffer_load_dwordx4 v[36:39], v0, s[8:11], s34 offen sc1
    s_mov_b32 s16, 0
Lr1f_alp:
    s_waitcnt vmcnt(2)
    v_max3_u32 v10, v36, v37, v38
    v_max_u32 v10, v10, v39
    v_cmp_eq_u32 vcc, -1, v10
    s_nop 0
    s_cbranch_vccz Lr1f_aok
    buffer_load_dwordx4 v[36:39], v0, s[8:11], s34 offen sc1
    s_add_u32 s16, s16, 1
    s_cmp_gt_u32 s16, 100000
    s_cbranch_scc1 Lr_abort
    s_branch Lr1f_alp
Lr1f_aok:
    ds_write_b128 v0, v[36:39] offset:7936
    v_smfmac_f32_16x16x64_bf16 v[12:15], v[36:39], v[88:95], v1
    v_smfmac_f32_16x16x64_bf16 v[16:19], v[36:39], v[96:103], v1
    v_smfmac_f32_16x16x64_bf16 v[20:23], v[36:39], v[200:207], v1
    s_waitcnt lgkmcnt(0)
    s_barrier
    ds_read_b128 v[48:51], v0 offset:8960
    ds_read_b128 v[52:55], v0 offset:9984
    v_smfmac_f32_16x16x64_bf16 v[28:31], v[36:39], a[72:79], v1
    v_smfmac_f32_16x16x64_bf16 v[24:27], v[36:39], v[208:215], v1
    s_add_u32 s17, s34, 4096
    buffer_load_dwordx4 v[40:43], v0, s[8:11], s17 offen sc1
    v_smfmac_f32_16x16x64_bf16 v[32:35], v[36:39], a[80:87], v1
    s_waitcnt vmcnt(1)
    ds_read_b128 v[36:39], v0 offset:6912
    s_waitcnt lgkmcnt(2)
    v_smfmac_f32_16x16x64_bf16 v[28:31], v[48:51], v[56:63], v1
    ds_read_b128 v[56:59], v8 offset:0
    ds_read_b128 v[60:63], v8 offset:1024
    v_smfmac_f32_16x16x64_bf16 v[12:15], v[48:51], v[104:111], v1
    v_smfmac_f32_16x16x64_bf16 v[16:19], v[48:51], v[112:119], v1
    buffer_load_dwordx4 v[44:47], v0, s[8:11], s35 offen sc1
    v_smfmac_f32_16x16x64_bf16 v[32:35], v[48:51], v[64:71], v1
    ds_read_b128 v[64:67], v8 offset:2048
    ds_read_b128 v[68:71], v8 offset:3072
    v_smfmac_f32_16x16x64_bf16 v[20:23], v[48:51], v[216:223], v1
    v_smfmac_f32_16x16x64_bf16 v[24:27], v[48:51], v[224:231], v1
    s_waitcnt lgkmcnt(5)
    v_smfmac_f32_16x16x64_bf16 v[28:31], v[52:55], a[88:95], v1
    v_smfmac_f32_16x16x64_bf16 v[12:15], v[52:55], v[120:127], v1
    v_smfmac_f32_16x16x64_bf16 v[16:19], v[52:55], v[128:135], v1
    v_smfmac_f32_16x16x64_bf16 v[32:35], v[52:55], a[96:103], v1
    v_smfmac_f32_16x16x64_bf16 v[20:23], v[52:55], v[232:239], v1
    v_smfmac_f32_16x16x64_bf16 v[24:27], v[52:55], v[240:247], v1
    s_waitcnt lgkmcnt(2)
    v_smfmac_f32_16x16x64_bf16 v[28:31], v[36:39], v[56:63], v1
    ds_read_b128 v[56:59], v8 offset:12288
    ds_read_b128 v[60:63], v8 offset:13312
    v_smfmac_f32_16x16x64_bf16 v[12:15], v[36:39], v[72:79], v1
    v_smfmac_f32_16x16x64_bf16 v[16:19], v[36:39], v[80:87], v1
    s_waitcnt lgkmcnt(2)
    v_smfmac_f32_16x16x64_bf16 v[32:35], v[36:39], v[64:71], v1
    ds_read_b128 v[64:67], v8 offset:14336
    ds_read_b128 v[68:71], v8 offset:15360
    v_smfmac_f32_16x16x64_bf16 v[20:23], v[36:39], v[184:191], v1
    v_smfmac_f32_16x16x64_bf16 v[24:27], v[36:39], v[192:199], v1
    s_waitcnt vmcnt(1)
    v_max3_u32 v10, v40, v41, v42
    v_max_u32 v10, v10, v43
    v_cmp_eq_u32 vcc, -1, v10
    s_nop 0
    s_cbranch_vccnz Lr1f_pb_re
Lr1f_pb_ok:
    ds_write_b128 v0, v[40:43] offset:12032
    v_mov_b32 v9, 1
    v_mov_b32 v10, 0
    s_mov_b64 exec, 1
    buffer_store_dword v9, v10, s[8:11], s67 offen offset:384 sc1
    s_mov_b64 exec, -1
    v_smfmac_f32_16x16x64_bf16 v[12:15], v[40:43], v[136:143], v1
    v_smfmac_f32_16x16x64_bf16 v[20:23], v[40:43], a[8:15], v1
    v_smfmac_f32_16x16x64_bf16 v[16:19], v[40:43], v[144:151], v1
    v_smfmac_f32_16x16x64_bf16 v[24:27], v[40:43], a[16:23], v1
    s_waitcnt lgkmcnt(0)
    s_barrier
    ds_read_b128 v[48:51], v0 offset:13056
    ds_read_b128 v[52:55], v0 offset:14080
    ds_read_b128 v[36:39], v0 offset:11008
    v_smfmac_f32_16x16x64_bf16 v[28:31], v[40:43], a[120:127], v1
    v_smfmac_f32_16x16x64_bf16 v[32:35], v[40:43], a[128:135], v1
    s_waitcnt lgkmcnt(2)
    v_smfmac_f32_16x16x64_bf16 v[12:15], v[48:51], v[56:63], v1
    ds_read_b128 v[56:59], v8 offset:8192
    ds_read_b128 v[60:63], v8 offset:9216
    v_smfmac_f32_16x16x64_bf16 v[16:19], v[48:51], v[64:71], v1
    ds_read_b128 v[64:67], v8 offset:10240
    ds_read_b128 v[68:71], v8 offset:11264
    s_waitcnt lgkmcnt(5)
    v_smfmac_f32_16x16x64_bf16 v[12:15], v[52:55], v[152:159], v1
    v_smfmac_f32_16x16x64_bf16 v[16:19], v[52:55], v[160:167], v1
    s_waitcnt vmcnt(1)
    v_max3_u32 v10, v44, v45, v46
    v_max_u32 v10, v10, v47
    v_cmp_eq_u32 vcc, -1, v10
    s_nop 0
    s_cbranch_vccnz Lr1f_pc_re
Lr1f_pc_ok:
    v_smfmac_f32_16x16x64_bf16 v[12:15], v[44:47], v[168:175], v1
    v_smfmac_f32_16x16x64_bf16 v[16:19], v[44:47], v[176:183], v1
    s_waitcnt lgkmcnt(2)
    v_smfmac_f32_16x16x64_bf16 v[12:15], v[36:39], v[56:63], v1
    s_waitcnt lgkmcnt(0)
    v_smfmac_f32_16x16x64_bf16 v[16:19], v[36:39], v[64:71], v1
    v_smfmac_f32_16x16x64_bf16 v[20:23], v[48:51], a[24:31], v1
    v_smfmac_f32_16x16x64_bf16 v[24:27], v[48:51], a[32:39], v1
    buffer_load_dwordx4 v[64:67], v0, s[8:11], s42 offen
    v_smfmac_f32_16x16x64_bf16 v[20:23], v[52:55], a[40:47], v1
    v_add_f32 v12, v12, v14
    v_smfmac_f32_16x16x64_bf16 v[24:27], v[52:55], a[48:55], v1
    v_add_f32 v16, v16, v18
    v_smfmac_f32_16x16x64_bf16 v[20:23], v[36:39], v[248:255], v1
    v_add_f32 v13, v13, v15
    v_smfmac_f32_16x16x64_bf16 v[24:27], v[36:39], a[0:7], v1
    v_add_f32 v17, v17, v19
    buffer_load_dwordx4 v[68:71], v0, s[8:11], s42 offen offset:1024
    v_smfmac_f32_16x16x64_bf16 v[20:23], v[44:47], a[56:63], v1
    v_cvt_pk_bf16_f32 v14, v12, v16
    ds_read_b128 v[56:59], v0 offset:15104
    v_smfmac_f32_16x16x64_bf16 v[24:27], v[44:47], a[64:71], v1
    v_cvt_pk_bf16_f32 v15, v13, v17
    ds_read_b128 v[60:63], v0 offset:16128
    ds_write_b32 v2, v14 offset:576
    ds_write_b32 v2, v15 offset:864
    v_smfmac_f32_16x16x64_bf16 v[28:31], v[48:51], a[136:143], v1
    v_smfmac_f32_16x16x64_bf16 v[32:35], v[48:51], a[144:151], v1
    v_add_f32 v20, v20, v22
    v_add_f32 v24, v24, v26
    v_add_f32 v21, v21, v23
    v_add_f32 v25, v25, v27
    v_cvt_pk_bf16_f32 v22, v20, v24
    v_cvt_pk_bf16_f32 v23, v21, v25
    ds_write_b32 v2, v22 offset:0
    ds_write_b32 v2, v23 offset:288
    v_smfmac_f32_16x16x64_bf16 v[28:31], v[52:55], a[152:159], v1
    v_smfmac_f32_16x16x64_bf16 v[32:35], v[52:55], a[160:167], v1
    s_waitcnt lgkmcnt(0)
    s_barrier
    ds_read_b128 v[40:43], v3 offset:0
    ds_read_b128 v[48:51], v3 offset:64
    ds_read_b128 v[20:23], v3 offset:128
    ds_read_b128 v[52:55], v3 offset:192
    v_smfmac_f32_16x16x64_bf16 v[28:31], v[36:39], a[104:111], v1
    v_smfmac_f32_16x16x64_bf16 v[32:35], v[36:39], a[112:119], v1
    ds_read_b128 v[36:39], v0 offset:17152
    v_smfmac_f32_16x16x64_bf16 v[28:31], v[44:47], a[168:175], v1
    v_smfmac_f32_16x16x64_bf16 v[32:35], v[44:47], a[176:183], v1
    ds_read_b128 v[44:47], v0 offset:18176
    s_waitcnt lgkmcnt(5)
    v_mfma_f32_16x16x32_bf16 v[12:15], v[56:59], v[40:43], 0
    v_mfma_f32_16x16x32_bf16 v[16:19], v[60:63], v[40:43], 0
    v_mfma_f32_16x16x32_bf16 v[24:27], v[40:43], v[40:43], 0
    ds_read_b128 v[56:59], v0 offset:19200
    ds_read_b128 v[60:63], v0 offset:20224
    s_waitcnt lgkmcnt(3)
    v_mfma_f32_16x16x32_bf16 v[12:15], v[36:39], v[48:51], v[12:15]
    v_lshrrev_b32 v10, 1, v0
    v_lshrrev_b32 v9, 9, v0
    s_waitcnt lgkmcnt(2)
    v_mfma_f32_16x16x32_bf16 v[16:19], v[44:47], v[48:51], v[16:19]
    v_lshl_add_u32 v9, v9, 5, v10
    v_add_f32 v28, v28, v30
    v_mfma_f32_16x16x32_bf16 v[24:27], v[48:51], v[48:51], v[24:27]
    v_add_f32 v32, v32, v34
    v_add_f32 v29, v29, v31
    ds_read_b128 v[36:39], v0 offset:21248
    ds_read_b128 v[44:47], v0 offset:22272
    s_waitcnt lgkmcnt(3)
    v_mfma_f32_16x16x32_bf16 v[12:15], v[56:59], v[20:23], v[12:15]
    v_add_f32 v33, v33, v35
    v_cvt_pk_bf16_f32 v30, v28, v29
    s_waitcnt lgkmcnt(2)
    v_mfma_f32_16x16x32_bf16 v[16:19], v[60:63], v[20:23], v[16:19]
    v_cvt_pk_bf16_f32 v31, v32, v33
    ds_read_b64 v[34:35], v9 offset:1152
    v_mfma_f32_16x16x32_bf16 v[24:27], v[20:23], v[20:23], v[24:27]
    s_add_u32 s17, s43, 2560
    buffer_store_dwordx2 v[30:31], v10, s[8:11], s17 offen sc1
    s_waitcnt lgkmcnt(2)
    v_mfma_f32_16x16x32_bf16 v[12:15], v[36:39], v[52:55], v[12:15]
    s_waitcnt lgkmcnt(1)
    v_mfma_f32_16x16x32_bf16 v[16:19], v[44:47], v[52:55], v[16:19]
    v_mfma_f32_16x16x32_bf16 v[24:27], v[52:55], v[52:55], v[24:27]
    s_add_u32 s17, s43, 512
    s_waitcnt lgkmcnt(0)
    buffer_store_dwordx2 v[34:35], v10, s[8:11], s17 offen sc1
    s_cmp_eq_u32 s33, 63
    s_cbranch_scc1 Lr1f_last
    ds_read_b128 v[56:59], v8 offset:16384
    ds_read_b128 v[60:63], v8 offset:17408
    v_mov_b64 v[20:21], s[52:53]
    v_mov_b64 v[22:23], s[52:53]
    v_mov_b32 v41, 0
    v_mov_b32 v42, 0
    v_max3_f32 v9, v12, v13, v14
    v_max3_f32 v9, v9, v15, v16
    v_max3_f32 v9, v9, v17, v18
    v_max3_f32 v9, v9, v19, v24
    v_max_f32 v9, v9, v25
    v_mov_b32 v10, v9
    v_mov_b64 v[32:33], 0
    v_mov_b64 v[34:35], 0
    v_permlane32_swap_b32 v9, v10
    v_max_f32 v9, v9, v10
    v_mov_b32 v10, v9
    s_nop 1
    v_permlane16_swap_b32 v9, v10
    v_max_f32 v9, v9, v10
    v_mul_f32 v28, s44, v9
    v_fma_f32 v12, v12, s44, -v28
    v_fma_f32 v13, v13, s44, -v28
    v_fma_f32 v14, v14, s44, -v28
    v_fma_f32 v15, v15, s44, -v28
    v_exp_f32 v12, v12
    v_exp_f32 v13, v13
    v_fma_f32 v16, v16, s44, -v28
    v_fma_f32 v17, v17, s44, -v28
    v_exp_f32 v14, v14
    v_exp_f32 v15, v15
    v_cvt_pk_bf16_f32 v36, v12, v13
    v_fma_f32 v18, v18, s44, -v28
    v_fma_f32 v19, v19, s44, -v28
    v_exp_f32 v16, v16
    v_exp_f32 v17, v17
    v_cvt_pk_bf16_f32 v37, v14, v15
    v_fma_f32 v24, v24, s44, -v28
    v_fma_f32 v25, v25, s44, -v28
    v_exp_f32 v18, v18
    v_exp_f32 v19, v19
    v_cvt_pk_bf16_f32 v38, v16, v17
    v_exp_f32 v24, v24
    v_exp_f32 v25, v25
    v_cvt_pk_bf16_f32 v39, v18, v19
    v_cvt_pk_bf16_f32 v40, v24, v25
    v_cvt_pk_bf16_f32 v43, v24, v25
    v_mfma_f32_16x16x32_bf16 v[52:55], v[20:23], v[36:39], 0
    v_mov_b64 v[12:13], 0
    v_mov_b64 v[14:15], 0
    s_waitcnt vmcnt(3)
    v_mfma_f32_16x16x32_bf16 v[44:47], v[64:67], v[36:39], 0
    v_mov_b64 v[24:25], 0
    v_mov_b64 v[26:27], 0
    s_waitcnt vmcnt(2)
    v_mfma_f32_16x16x32_bf16 v[48:51], v[68:71], v[36:39], 0
    ds_read_b128 v[64:67], v8 offset:20480
    ds_read_b128 v[68:71], v8 offset:21504
    v_mfma_f32_16x16x16_bf16 v[52:55], v[20:21], v[40:41], v[52:55]
    v_mfma_f32_16x16x16_bf16 v[44:47], v[30:31], v[40:41], v[44:47]
    v_mov_b64 v[20:21], 0
    v_mov_b64 v[22:23], 0
    v_mfma_f32_16x16x16_bf16 v[48:51], v[30:31], v[42:43], v[48:51]
    v_mov_b64 v[36:37], 0
    v_mov_b64 v[38:39], 0
    v_mov_b64 v[40:41], 0
    v_mov_b64 v[42:43], 0
    v_rcp_f32 v9, v52
    v_mov_b64 v[52:53], 0
    v_mov_b64 v[54:55], 0
    v_mul_f32 v44, v9, v44
    v_mul_f32 v48, v9, v48
    v_cvt_pk_bf16_f32 v16, v44, v48
    v_mul_f32 v45, v9, v45
    v_mul_f32 v49, v9, v49
    v_cvt_pk_bf16_f32 v17, v45, v49
    v_mul_f32 v46, v9, v46
    v_mul_f32 v50, v9, v50
    v_cvt_pk_bf16_f32 v18, v46, v50
    v_mul_f32 v47, v9, v47
    v_mul_f32 v51, v9, v51
    v_cvt_pk_bf16_f32 v19, v47, v51
    ds_write_b128 v5, v[16:19]
    v_mov_b64 v[28:29], 0
    v_mov_b64 v[30:31], 0
    s_waitcnt lgkmcnt(0)
    s_barrier
    ds_read_b128 v[44:47], v4 offset:0
    ds_read_b128 v[48:51], v4 offset:128
    v_mov_b64 v[16:17], 0
    v_mov_b64 v[18:19], 0
    buffer_load_dwordx4 v0, s[8:11], s41 offen offset:0 lds
    buffer_load_dwordx4 v0, s[8:11], s41 offen offset:1024 lds
    s_waitcnt lgkmcnt(1)
    v_smfmac_f32_16x16x64_bf16 v[12:15], v[44:47], a[184:191], v1
    s_waitcnt lgkmcnt(0)
    v_smfmac_f32_16x16x64_bf16 v[12:15], v[48:51], a[192:199], v1
    v_smfmac_f32_16x16x64_bf16 v[24:27], v[44:47], a[200:207], v1
    v_smfmac_f32_16x16x64_bf16 v[24:27], v[48:51], a[208:215], v1
    v_add_f32 v12, v12, v14
    v_smfmac_f32_16x16x64_bf16 v[20:23], v[44:47], a[216:223], v1
    v_add_f32 v13, v13, v15
    v_smfmac_f32_16x16x64_bf16 v[20:23], v[48:51], a[224:231], v1
    v_cvt_pk_bf16_f32 v12, v12, v13
    v_smfmac_f32_16x16x64_bf16 v[16:19], v[44:47], a[232:239], v1
    v_add_f32 v24, v24, v26
    v_smfmac_f32_16x16x64_bf16 v[16:19], v[48:51], a[240:247], v1
    v_add_f32 v25, v25, v27
    v_smfmac_f32_16x16x64_bf16 v[36:39], v[44:47], v[56:63], v1
    v_cvt_pk_bf16_f32 v13, v24, v25
    v_smfmac_f32_16x16x64_bf16 v[36:39], v[48:51], v[64:71], v1
    v_add_f32 v20, v20, v22
    v_add_f32 v21, v21, v23
    v_cvt_pk_bf16_f32 v14, v20, v21
    v_add_f32 v16, v16, v18
    v_add_f32 v17, v17, v19
    v_cvt_pk_bf16_f32 v15, v16, v17
    v_and_or_b32 v15, v15, -2, s40
    buffer_store_dwordx4 v[12:15], v0, s[8:11], s38 offen
    s_nop 0
    ds_read_b128 v[12:15], v8 offset:18432
    ds_read_b128 v[16:19], v8 offset:19456
    ds_read_b128 v[20:23], v8 offset:22528
    ds_read_b128 v[24:27], v8 offset:23552
    ds_read_b128 v[56:59], v8 offset:24576
    ds_read_b128 v[60:63], v8 offset:25600
    ds_read_b128 v[64:67], v8 offset:28672
    ds_read_b128 v[68:71], v8 offset:29696
    s_waitcnt lgkmcnt(6)
    v_smfmac_f32_16x16x64_bf16 v[40:43], v[44:47], v[12:19], v1
    ds_read_b128 v[12:15], v8 offset:26624
    ds_read_b128 v[16:19], v8 offset:27648
    s_waitcnt lgkmcnt(6)
    v_smfmac_f32_16x16x64_bf16 v[40:43], v[48:51], v[20:27], v1
    ds_read_b128 v[20:23], v8 offset:30720
    ds_read_b128 v[24:27], v8 offset:31744
    s_waitcnt lgkmcnt(6)
    v_smfmac_f32_16x16x64_bf16 v[52:55], v[44:47], v[56:63], v1
    ds_read_b128 v[56:59], v8 offset:32768
    ds_read_b128 v[60:63], v8 offset:33792
    s_waitcnt lgkmcnt(6)
    v_smfmac_f32_16x16x64_bf16 v[52:55], v[48:51], v[64:71], v1
    s_waitcnt lgkmcnt(4)
    v_smfmac_f32_16x16x64_bf16 v[32:35], v[44:47], v[12:19], v1
    s_waitcnt lgkmcnt(2)
    v_smfmac_f32_16x16x64_bf16 v[32:35], v[48:51], v[20:27], v1
    v_smfmac_f32_16x16x64_bf16 v[28:31], v[44:47], a[248:255], v1
    s_waitcnt lgkmcnt(0)
    v_smfmac_f32_16x16x64_bf16 v[28:31], v[48:51], v[56:63], v1
    v_add_f32 v36, v36, v38
    v_add_f32 v37, v37, v39
    v_cvt_pk_bf16_f32 v36, v36, v37
    v_add_f32 v40, v40, v42
    v_add_f32 v41, v41, v43
    v_cvt_pk_bf16_f32 v37, v40, v41
    v_add_f32 v52, v52, v54
    v_add_f32 v53, v53, v55
    v_cvt_pk_bf16_f32 v38, v52, v53
    v_add_f32 v32, v32, v34
    v_add_f32 v33, v33, v35
    v_cvt_pk_bf16_f32 v39, v32, v33
    v_and_or_b32 v39, v39, -2, s40
    s_add_u32 s17, s38, 4096
    buffer_store_dwordx4 v[36:39], v0, s[8:11], s17 offen
    v_add_f32 v28, v28, v30
    v_add_f32 v29, v29, v31
    v_cvt_pk_bf16_f32 v28, v28, v29
    v_and_or_b32 v28, v28, -2, s40
    v_lshrrev_b32 v9, 2, v0
    buffer_store_dword v28, v9, s[8:11], s39 offen
    v_add_u32 v10, 162560, v0
    ds_read_b128 v[64:67], v10
    s_add_u32 s33, s33, 1
    s_add_u32 s42, s42, 262144
    s_add_u32 s41, s41, 262144
    s_add_u32 s43, s43, 131072
    s_mov_b32 s67, s66
    s_add_u32 s68, s68, 262144
    s_add_u32 s66, s66, 22528
    ds_read_b128 v[56:59], v8 offset:4096
    ds_read_b128 v[60:63], v8 offset:5120
    v_mov_b64 v[12:13], 0
    v_mov_b64 v[14:15], 0
    v_mov_b64 v[16:17], 0
    v_mov_b64 v[18:19], 0
    v_mov_b64 v[20:21], 0
    v_mov_b64 v[22:23], 0
    v_mov_b64 v[24:25], 0
    v_mov_b64 v[26:27], 0
    v_mov_b64 v[28:29], 0
    v_mov_b64 v[30:31], 0
    v_mov_b64 v[32:33], 0
    v_mov_b64 v[34:35], 0
    s_nop 15
    s_nop 15
    s_nop 15
    s_nop 11
    buffer_load_dwordx4 v[40:43], v6, s[8:11], s62 offen sc1
    buffer_load_dwordx4 v[44:47], v6, s[8:11], s63 offen sc1
    buffer_load_dwordx4 v[48:51], v6, s[8:11], s64 offen sc1
    buffer_load_dwordx4 v[52:55], v6, s[8:11], s65 offen sc1
    s_waitcnt lgkmcnt(0)
    s_waitcnt vmcnt(3)
    v_mfma_f32_16x16x32_bf16 v[68:71], v[40:43], v[64:67], 0
    v_and_b32 v10, 1, v43
    v_cmp_ne_u32 s[54:55], s40, v10
    s_waitcnt vmcnt(2)
    v_mfma_f32_16x16x32_bf16 v[68:71], v[44:47], v[64:67], v[68:71]
    v_and_b32 v10, 1, v47
    v_cmp_ne_u32 s[56:57], s40, v10
    s_waitcnt vmcnt(1)
    v_mfma_f32_16x16x32_bf16 v[68:71], v[48:51], v[64:67], v[68:71]
    v_and_b32 v10, 1, v51
    v_cmp_ne_u32 s[58:59], s40, v10
    s_waitcnt vmcnt(0)
    v_mfma_f32_16x16x32_bf16 v[68:71], v[52:55], v[64:67], v[68:71]
    v_and_b32 v10, 1, v55
    v_cmp_ne_u32 s[60:61], s40, v10
    s_or_b64 vcc, s[54:55], s[56:57]
    s_or_b64 vcc, vcc, s[58:59]
    s_or_b64 vcc, vcc, s[60:61]
    s_cbranch_scc0 Lr1f_red
    s_mov_b32 s16, 0
Lr1f_p1:
    s_mov_b64 exec, s[54:55]
    buffer_load_dwordx4 v[40:43], v6, s[8:11], s62 offen sc1
    s_mov_b64 exec, s[56:57]
    buffer_load_dwordx4 v[44:47], v6, s[8:11], s63 offen sc1
    s_mov_b64 exec, s[58:59]
    buffer_load_dwordx4 v[48:51], v6, s[8:11], s64 offen sc1
    s_mov_b64 exec, s[60:61]
    buffer_load_dwordx4 v[52:55], v6, s[8:11], s65 offen sc1
    s_mov_b64 exec, -1
    s_add_u32 s16, s16, 1
    s_cmp_gt_u32 s16, 100000
    s_cbranch_scc1 Lr_abort
    s_waitcnt vmcnt(3)
    v_mfma_f32_16x16x32_bf16 v[68:71], v[40:43], v[64:67], 0
    v_and_b32 v10, 1, v43
    v_cmp_ne_u32 s[54:55], s40, v10
    s_waitcnt vmcnt(2)
    v_mfma_f32_16x16x32_bf16 v[68:71], v[44:47], v[64:67], v[68:71]
    v_and_b32 v10, 1, v47
    v_cmp_ne_u32 s[56:57], s40, v10
    s_waitcnt vmcnt(1)
    v_mfma_f32_16x16x32_bf16 v[68:71], v[48:51], v[64:67], v[68:71]
    v_and_b32 v10, 1, v51
    v_cmp_ne_u32 s[58:59], s40, v10
    s_waitcnt vmcnt(0)
    v_mfma_f32_16x16x32_bf16 v[68:71], v[52:55], v[64:67], v[68:71]
    v_and_b32 v10, 1, v55
    v_cmp_ne_u32 s[60:61], s40, v10
    s_or_b64 vcc, s[54:55], s[56:57]
    s_or_b64 vcc, vcc, s[58:59]
    s_or_b64 vcc, vcc, s[60:61]
    s_cbranch_scc1 Lr1f_p1
Lr1f_red:
    s_xor_b32 s34, s34, 16384
    s_xor_b32 s35, s35, 16384
    buffer_load_dwordx4 v[36:39], v0, s[8:11], s34 offen sc1
    v_permlane16_swap_b32 v68, v70
    v_permlane16_swap_b32 v69, v71
    s_mov_b64 exec, s[46:47]
    v_add_f32 v68, v68, v70
    v_add_f32 v69, v69, v71
    v_cvt_pk_bf16_f32 v68, v68, v69
    v_min_u32 v68, s50, v68
    buffer_store_dword v68, v7, s[8:11], s36 offen
    v_mov_b32 v69, -1
    buffer_store_dword v69, v7, s[8:11], s37 offen
    s_mov_b64 exec, -1
    buffer_load_dwordx4 v[36:39], v0, s[8:11], s34 offen sc1
    s_xor_b32 s40, s40, 1
    s_xor_b32 s36, s36, 16384
    s_xor_b32 s37, s37, 16384
    ds_read_b128 v[64:67], v8 offset:6144
    ds_read_b128 v[68:71], v8 offset:7168
    s_waitcnt lgkmcnt(0)
    s_branch Lr1f_step
Lr1f_pb_re:
    s_mov_b32 s16, 0
Lr1f_pb_lp:
    s_add_u32 s17, s34, 4096
    buffer_load_dwordx4 v[40:43], v0, s[8:11], s17 offen sc1
    s_add_u32 s16, s16, 1
    s_cmp_gt_u32 s16, 100000
    s_cbranch_scc1 Lr_abort
    s_waitcnt vmcnt(0)
    v_max3_u32 v10, v40, v41, v42
    v_max_u32 v10, v10, v43
    v_cmp_eq_u32 vcc, -1, v10
    s_nop 0
    s_cbranch_vccnz Lr1f_pb_lp
    s_branch Lr1f_pb_ok
Lr1f_pc_re:
    s_mov_b32 s16, 0
Lr1f_pc_lp:
    buffer_load_dwordx4 v[44:47], v0, s[8:11], s35 offen sc1
    s_add_u32 s16, s16, 1
    s_cmp_gt_u32 s16, 100000
    s_cbranch_scc1 Lr_abort
    s_waitcnt vmcnt(0)
    v_max3_u32 v10, v44, v45, v46
    v_max_u32 v10, v10, v47
    v_cmp_eq_u32 vcc, -1, v10
    s_nop 0
    s_cbranch_vccnz Lr1f_pc_lp
    s_branch Lr1f_pc_ok
Lr1f_last:
    s_waitcnt vmcnt(0) lgkmcnt(0)
    s_barrier
    s_mov_b32 s67, s66
    v_mov_b32 v9, 1
    v_mov_b32 v10, 0
    s_mov_b64 exec, 1
    buffer_store_dword v9, v10, s[8:11], s67 offen offset:384 sc1
    s_mov_b64 exec, -1
    s_branch Lr_exit
L_w2_1:
    s_cmp_lg_u32 s14, 2
    s_cbranch_scc1 L_w3_1
    s_mov_b32 s16, 0
    s_add_u32 s17, s66, 128
    v_lshrrev_b32 v10, 2, v0
    v_and_b32 v9, 16, v10
    v_lshlrev_b32 v9, 3, v9
    v_and_or_b32 v10, v10, 12, v9
Lr2f_fw_12:
    buffer_load_dword v9, v10, s[8:11], s17 offen sc1
    s_add_u32 s16, s16, 1
    s_cmp_gt_u32 s16, 100000
    s_cbranch_scc1 Lr_abort
    s_waitcnt vmcnt(0)
    v_cmp_eq_u32 vcc, 0, v9
    s_nop 0
    s_cbranch_vccnz Lr2f_fw_12
    s_mov_b32 m0, 19200
    s_nop 0
    buffer_load_dwordx4 v0, s[8:11], s41 offen offset:0 lds
    buffer_load_dwordx4 v0, s[8:11], s41 offen offset:1024 lds
    s_add_u32 s41, s41, 262144
    s_add_u32 s68, s68, 262144
    s_waitcnt vmcnt(0)
    ds_read_b128 v[56:59], v8 offset:4096
    ds_read_b128 v[60:63], v8 offset:5120
    ds_read_b128 v[64:67], v8 offset:6144
    ds_read_b128 v[68:71], v8 offset:7168
    v_mov_b64 v[12:13], 0
    v_mov_b64 v[14:15], 0
    v_mov_b64 v[16:17], 0
    v_mov_b64 v[18:19], 0
    v_mov_b64 v[20:21], 0
    v_mov_b64 v[22:23], 0
    v_mov_b64 v[24:25], 0
    v_mov_b64 v[26:27], 0
    v_mov_b64 v[28:29], 0
    v_mov_b64 v[30:31], 0
    v_mov_b64 v[32:33], 0
    v_mov_b64 v[34:35], 0
    buffer_load_dwordx4 v[36:39], v0, s[8:11], s34 offen sc1
    s_waitcnt vmcnt(0) lgkmcnt(0)
Lr2f_step:
    s_waitcnt vmcnt(3)
    v_max3_u32 v10, v36, v37, v38
    v_max_u32 v10, v10, v39
    v_cmp_eq_u32 vcc, -1, v10
    s_nop 0
    s_cbranch_vccz Lr2f_aok
    buffer_load_dwordx4 v[36:39], v0, s[8:11], s34 offen sc1
    s_nop 15
    s_nop 8
    buffer_load_dwordx4 v[36:39], v0, s[8:11], s34 offen sc1
    s_mov_b32 s16, 0
Lr2f_alp:
    s_waitcnt vmcnt(2)
    v_max3_u32 v10, v36, v37, v38
    v_max_u32 v10, v10, v39
    v_cmp_eq_u32 vcc, -1, v10
    s_nop 0
    s_cbranch_vccz Lr2f_aok
    buffer_load_dwordx4 v[36:39], v0, s[8:11], s34 offen sc1
    s_add_u32 s16, s16, 1
    s_cmp_gt_u32 s16, 100000
    s_cbranch_scc1 Lr_abort
    s_branch Lr2f_alp
Lr2f_aok:
    ds_write_b128 v0, v[36:39] offset:8960
    v_smfmac_f32_16x16x64_bf16 v[12:15], v[36:39], v[104:111], v1
    v_smfmac_f32_16x16x64_bf16 v[16:19], v[36:39], v[112:119], v1
    v_smfmac_f32_16x16x64_bf16 v[20:23], v[36:39], v[216:223], v1
    s_waitcnt lgkmcnt(0)
    s_barrier
    ds_read_b128 v[48:51], v0 offset:9984
    ds_read_b128 v[52:55], v0 offset:6912
    v_smfmac_f32_16x16x64_bf16 v[28:31], v[36:39], v[56:63], v1
    ds_read_b128 v[56:59], v8 offset:0
    ds_read_b128 v[60:63], v8 offset:1024
    v_smfmac_f32_16x16x64_bf16 v[24:27], v[36:39], v[224:231], v1
    v_smfmac_f32_16x16x64_bf16 v[32:35], v[36:39], v[64:71], v1
    ds_read_b128 v[64:67], v8 offset:2048
    ds_read_b128 v[68:71], v8 offset:3072
    s_add_u32 s17, s34, 4096
    buffer_load_dwordx4 v[40:43], v0, s[8:11], s17 offen sc1
    s_waitcnt vmcnt(1)
    ds_read_b128 v[36:39], v0 offset:7936
    s_waitcnt lgkmcnt(6)
    v_smfmac_f32_16x16x64_bf16 v[28:31], v[48:51], a[88:95], v1
    v_smfmac_f32_16x16x64_bf16 v[12:15], v[48:51], v[120:127], v1
    v_smfmac_f32_16x16x64_bf16 v[16:19], v[48:51], v[128:135], v1
    v_smfmac_f32_16x16x64_bf16 v[32:35], v[48:51], a[96:103], v1
    buffer_load_dwordx4 v[44:47], v0, s[8:11], s35 offen sc1
    v_smfmac_f32_16x16x64_bf16 v[20:23], v[48:51], v[232:239], v1
    v_lshrrev_b32 v10, 2, v0
    v_and_b32 v9, 16, v10
    v_lshlrev_b32 v9, 3, v9
    v_and_or_b32 v10, v10, 12, v9
    s_add_u32 s17, s66, 22656
    v_mov_b32 v11, 2
    buffer_load_dword v11, v10, s[8:11], s17 offen sc1
    v_smfmac_f32_16x16x64_bf16 v[24:27], v[48:51], v[240:247], v1
    s_waitcnt lgkmcnt(3)
    v_smfmac_f32_16x16x64_bf16 v[28:31], v[52:55], v[56:63], v1
    ds_read_b128 v[56:59], v8 offset:12288
    ds_read_b128 v[60:63], v8 offset:13312
    v_smfmac_f32_16x16x64_bf16 v[12:15], v[52:55], v[72:79], v1
    v_smfmac_f32_16x16x64_bf16 v[16:19], v[52:55], v[80:87], v1
    s_waitcnt lgkmcnt(3)
    v_smfmac_f32_16x16x64_bf16 v[32:35], v[52:55], v[64:71], v1
    ds_read_b128 v[64:67], v8 offset:14336
    ds_read_b128 v[68:71], v8 offset:15360
    v_smfmac_f32_16x16x64_bf16 v[20:23], v[52:55], v[184:191], v1
    v_smfmac_f32_16x16x64_bf16 v[24:27], v[52:55], v[192:199], v1
    s_waitcnt lgkmcnt(4)
    v_smfmac_f32_16x16x64_bf16 v[28:31], v[36:39], a[72:79], v1
    v_smfmac_f32_16x16x64_bf16 v[12:15], v[36:39], v[88:95], v1
    v_smfmac_f32_16x16x64_bf16 v[16:19], v[36:39], v[96:103], v1
    v_smfmac_f32_16x16x64_bf16 v[32:35], v[36:39], a[80:87], v1
    v_smfmac_f32_16x16x64_bf16 v[20:23], v[36:39], v[200:207], v1
    v_smfmac_f32_16x16x64_bf16 v[24:27], v[36:39], v[208:215], v1
    s_waitcnt vmcnt(2)
    v_max3_u32 v10, v40, v41, v42
    v_max_u32 v10, v10, v43
    v_cmp_eq_u32 vcc, -1, v10
    s_nop 0
    s_cbranch_vccnz Lr2f_pb_re
Lr2f_pb_ok:
    ds_write_b128 v0, v[40:43] offset:13056
    s_waitcnt lgkmcnt(3)
    v_smfmac_f32_16x16x64_bf16 v[12:15], v[40:43], v[56:63], v1
    ds_read_b128 v[56:59], v8 offset:8192
    ds_read_b128 v[60:63], v8 offset:9216
    v_smfmac_f32_16x16x64_bf16 v[20:23], v[40:43], a[24:31], v1
    s_waitcnt lgkmcnt(3)
    v_smfmac_f32_16x16x64_bf16 v[16:19], v[40:43], v[64:71], v1
    ds_read_b128 v[64:67], v8 offset:10240
    ds_read_b128 v[68:71], v8 offset:11264
    v_smfmac_f32_16x16x64_bf16 v[24:27], v[40:43], a[32:39], v1
    s_waitcnt lgkmcnt(4)
    s_barrier
    ds_read_b128 v[48:51], v0 offset:11008
    ds_read_b128 v[52:55], v0 offset:14080
    ds_read_b128 v[36:39], v0 offset:12032
    v_smfmac_f32_16x16x64_bf16 v[28:31], v[40:43], a[136:143], v1
    v_smfmac_f32_16x16x64_bf16 v[32:35], v[40:43], a[144:151], v1
    s_waitcnt lgkmcnt(2)
    v_smfmac_f32_16x16x64_bf16 v[12:15], v[48:51], v[56:63], v1
    v_smfmac_f32_16x16x64_bf16 v[16:19], v[48:51], v[64:71], v1
    s_waitcnt lgkmcnt(1)
    v_smfmac_f32_16x16x64_bf16 v[12:15], v[52:55], v[152:159], v1
    v_smfmac_f32_16x16x64_bf16 v[16:19], v[52:55], v[160:167], v1
    s_waitcnt lgkmcnt(0)
    v_smfmac_f32_16x16x64_bf16 v[12:15], v[36:39], v[136:143], v1
    v_smfmac_f32_16x16x64_bf16 v[16:19], v[36:39], v[144:151], v1
    s_waitcnt vmcnt(1)
    v_max3_u32 v10, v44, v45, v46
    v_max_u32 v10, v10, v47
    v_cmp_eq_u32 vcc, -1, v10
    s_nop 0
    s_cbranch_vccnz Lr2f_pc_re
Lr2f_pc_ok:
    v_smfmac_f32_16x16x64_bf16 v[12:15], v[44:47], v[168:175], v1
    v_smfmac_f32_16x16x64_bf16 v[16:19], v[44:47], v[176:183], v1
    v_smfmac_f32_16x16x64_bf16 v[20:23], v[48:51], v[248:255], v1
    v_smfmac_f32_16x16x64_bf16 v[24:27], v[48:51], a[0:7], v1
    v_smfmac_f32_16x16x64_bf16 v[20:23], v[52:55], a[40:47], v1
    v_add_f32 v12, v12, v14
    buffer_load_dwordx4 v[64:67], v0, s[8:11], s42 offen
    v_smfmac_f32_16x16x64_bf16 v[24:27], v[52:55], a[48:55], v1
    v_add_f32 v16, v16, v18
    v_smfmac_f32_16x16x64_bf16 v[20:23], v[36:39], a[8:15], v1
    v_add_f32 v13, v13, v15
    v_smfmac_f32_16x16x64_bf16 v[24:27], v[36:39], a[16:23], v1
    v_add_f32 v17, v17, v19
    v_smfmac_f32_16x16x64_bf16 v[20:23], v[44:47], a[56:63], v1
    v_cvt_pk_bf16_f32 v14, v12, v16
    ds_read_b128 v[56:59], v0 offset:15104
    buffer_load_dwordx4 v[68:71], v0, s[8:11], s42 offen offset:1024
    v_smfmac_f32_16x16x64_bf16 v[24:27], v[44:47], a[64:71], v1
    v_cvt_pk_bf16_f32 v15, v13, v17
    ds_read_b128 v[60:63], v0 offset:16128
    ds_write_b32 v2, v14 offset:576
    ds_write_b32 v2, v15 offset:864
    v_smfmac_f32_16x16x64_bf16 v[28:31], v[48:51], a[104:111], v1
    v_smfmac_f32_16x16x64_bf16 v[32:35], v[48:51], a[112:119], v1
    v_add_f32 v20, v20, v22
    v_add_f32 v24, v24, v26
    v_add_f32 v21, v21, v23
    v_add_f32 v25, v25, v27
    v_cvt_pk_bf16_f32 v22, v20, v24
    v_cvt_pk_bf16_f32 v23, v21, v25
    ds_write_b32 v2, v22 offset:0
    ds_write_b32 v2, v23 offset:288
    v_smfmac_f32_16x16x64_bf16 v[28:31], v[52:55], a[152:159], v1
    v_smfmac_f32_16x16x64_bf16 v[32:35], v[52:55], a[160:167], v1
    s_waitcnt vmcnt(2)
    v_cmp_eq_u32 vcc, 0, v11
    s_nop 0
    s_cbranch_vccnz Lr2f_flbad
Lr2f_flok:
    s_waitcnt lgkmcnt(0)
    s_barrier
    ds_read_b128 v[40:43], v3 offset:0
    ds_read_b128 v[48:51], v3 offset:64
    ds_read_b128 v[20:23], v3 offset:128
    ds_read_b128 v[52:55], v3 offset:192
    v_smfmac_f32_16x16x64_bf16 v[28:31], v[36:39], a[120:127], v1
    v_smfmac_f32_16x16x64_bf16 v[32:35], v[36:39], a[128:135], v1
    ds_read_b128 v[36:39], v0 offset:17152
    v_smfmac_f32_16x16x64_bf16 v[28:31], v[44:47], a[168:175], v1
    v_smfmac_f32_16x16x64_bf16 v[32:35], v[44:47], a[176:183], v1
    ds_read_b128 v[44:47], v0 offset:18176
    s_waitcnt lgkmcnt(5)
    v_mfma_f32_16x16x32_bf16 v[12:15], v[56:59], v[40:43], 0
    v_mfma_f32_16x16x32_bf16 v[16:19], v[60:63], v[40:43], 0
    v_mfma_f32_16x16x32_bf16 v[24:27], v[40:43], v[40:43], 0
    ds_read_b128 v[56:59], v0 offset:19200
    ds_read_b128 v[60:63], v0 offset:20224
    s_waitcnt lgkmcnt(3)
    v_mfma_f32_16x16x32_bf16 v[12:15], v[36:39], v[48:51], v[12:15]
    v_lshrrev_b32 v10, 1, v0
    v_lshrrev_b32 v9, 9, v0
    s_waitcnt lgkmcnt(2)
    v_mfma_f32_16x16x32_bf16 v[16:19], v[44:47], v[48:51], v[16:19]
    v_lshl_add_u32 v9, v9, 5, v10
    v_add_f32 v28, v28, v30
    v_mfma_f32_16x16x32_bf16 v[24:27], v[48:51], v[48:51], v[24:27]
    v_add_f32 v32, v32, v34
    v_add_f32 v29, v29, v31
    ds_read_b128 v[36:39], v0 offset:21248
    ds_read_b128 v[44:47], v0 offset:22272
    s_waitcnt lgkmcnt(3)
    v_mfma_f32_16x16x32_bf16 v[12:15], v[56:59], v[20:23], v[12:15]
    v_add_f32 v33, v33, v35
    v_cvt_pk_bf16_f32 v30, v28, v29
    s_waitcnt lgkmcnt(2)
    v_mfma_f32_16x16x32_bf16 v[16:19], v[60:63], v[20:23], v[16:19]
    v_cvt_pk_bf16_f32 v31, v32, v33
    ds_read_b64 v[34:35], v9 offset:2304
    v_mfma_f32_16x16x32_bf16 v[24:27], v[20:23], v[20:23], v[24:27]
    s_add_u32 s17, s43, 3072
    buffer_store_dwordx2 v[30:31], v10, s[8:11], s17 offen sc1
    s_waitcnt lgkmcnt(2)
    v_mfma_f32_16x16x32_bf16 v[12:15], v[36:39], v[52:55], v[12:15]
    s_waitcnt lgkmcnt(1)
    v_mfma_f32_16x16x32_bf16 v[16:19], v[44:47], v[52:55], v[16:19]
    v_mfma_f32_16x16x32_bf16 v[24:27], v[52:55], v[52:55], v[24:27]
    s_add_u32 s17, s43, 1024
    s_waitcnt lgkmcnt(0)
    buffer_store_dwordx2 v[34:35], v10, s[8:11], s17 offen sc1
    s_cmp_eq_u32 s33, 63
    s_cbranch_scc1 Lr2f_last
    ds_read_b128 v[56:59], v8 offset:16384
    ds_read_b128 v[60:63], v8 offset:17408
    v_mov_b64 v[20:21], s[52:53]
    v_mov_b64 v[22:23], s[52:53]
    v_mov_b32 v41, 0
    v_mov_b32 v42, 0
    v_max3_f32 v9, v12, v13, v14
    v_max3_f32 v9, v9, v15, v16
    v_max3_f32 v9, v9, v17, v18
    v_max3_f32 v9, v9, v19, v24
    v_max_f32 v9, v9, v25
    v_mov_b32 v10, v9
    v_mov_b64 v[32:33], 0
    v_mov_b64 v[34:35], 0
    v_permlane32_swap_b32 v9, v10
    v_max_f32 v9, v9, v10
    v_mov_b32 v10, v9
    s_nop 1
    v_permlane16_swap_b32 v9, v10
    v_max_f32 v9, v9, v10
    v_mul_f32 v28, s44, v9
    v_fma_f32 v12, v12, s44, -v28
    v_fma_f32 v13, v13, s44, -v28
    v_fma_f32 v14, v14, s44, -v28
    v_fma_f32 v15, v15, s44, -v28
    v_exp_f32 v12, v12
    v_exp_f32 v13, v13
    v_fma_f32 v16, v16, s44, -v28
    v_fma_f32 v17, v17, s44, -v28
    v_exp_f32 v14, v14
    v_exp_f32 v15, v15
    v_cvt_pk_bf16_f32 v36, v12, v13
    v_fma_f32 v18, v18, s44, -v28
    v_fma_f32 v19, v19, s44, -v28
    v_exp_f32 v16, v16
    v_exp_f32 v17, v17
    v_cvt_pk_bf16_f32 v37, v14, v15
    v_fma_f32 v24, v24, s44, -v28
    v_fma_f32 v25, v25, s44, -v28
    v_exp_f32 v18, v18
    v_exp_f32 v19, v19
    v_cvt_pk_bf16_f32 v38, v16, v17
    v_exp_f32 v24, v24
    v_exp_f32 v25, v25
    v_cvt_pk_bf16_f32 v39, v18, v19
    v_cvt_pk_bf16_f32 v40, v24, v25
    v_cvt_pk_bf16_f32 v43, v24, v25
    v_mfma_f32_16x16x32_bf16 v[52:55], v[20:23], v[36:39], 0
    v_mov_b64 v[12:13], 0
    v_mov_b64 v[14:15], 0
    s_waitcnt vmcnt(3)
    v_mfma_f32_16x16x32_bf16 v[44:47], v[64:67], v[36:39], 0
    v_mov_b64 v[24:25], 0
    v_mov_b64 v[26:27], 0
    s_waitcnt vmcnt(2)
    v_mfma_f32_16x16x32_bf16 v[48:51], v[68:71], v[36:39], 0
    ds_read_b128 v[64:67], v8 offset:20480
    ds_read_b128 v[68:71], v8 offset:21504
    v_mfma_f32_16x16x16_bf16 v[52:55], v[20:21], v[40:41], v[52:55]
    v_mfma_f32_16x16x16_bf16 v[44:47], v[30:31], v[40:41], v[44:47]
    v_mov_b64 v[20:21], 0
    v_mov_b64 v[22:23], 0
    v_mfma_f32_16x16x16_bf16 v[48:51], v[30:31], v[42:43], v[48:51]
    v_mov_b64 v[36:37], 0
    v_mov_b64 v[38:39], 0
    v_mov_b64 v[40:41], 0
    v_mov_b64 v[42:43], 0
    v_rcp_f32 v9, v52
    v_mov_b64 v[52:53], 0
    v_mov_b64 v[54:55], 0
    v_mul_f32 v44, v9, v44
    v_mul_f32 v48, v9, v48
    v_cvt_pk_bf16_f32 v16, v44, v48
    v_mul_f32 v45, v9, v45
    v_mul_f32 v49, v9, v49
    v_cvt_pk_bf16_f32 v17, v45, v49
    v_mul_f32 v46, v9, v46
    v_mul_f32 v50, v9, v50
    v_cvt_pk_bf16_f32 v18, v46, v50
    v_mul_f32 v47, v9, v47
    v_mul_f32 v51, v9, v51
    v_cvt_pk_bf16_f32 v19, v47, v51
    ds_write_b128 v5, v[16:19]
    v_mov_b64 v[28:29], 0
    v_mov_b64 v[30:31], 0
    s_waitcnt lgkmcnt(0)
    s_barrier
    ds_read_b128 v[44:47], v4 offset:0
    ds_read_b128 v[48:51], v4 offset:128
    v_mov_b64 v[16:17], 0
    v_mov_b64 v[18:19], 0
    buffer_load_dwordx4 v0, s[8:11], s41 offen offset:0 lds
    buffer_load_dwordx4 v0, s[8:11], s41 offen offset:1024 lds
    s_waitcnt lgkmcnt(1)
    v_smfmac_f32_16x16x64_bf16 v[12:15], v[44:47], a[184:191], v1
    s_waitcnt lgkmcnt(0)
    v_smfmac_f32_16x16x64_bf16 v[12:15], v[48:51], a[192:199], v1
    v_smfmac_f32_16x16x64_bf16 v[24:27], v[44:47], a[200:207], v1
    v_smfmac_f32_16x16x64_bf16 v[24:27], v[48:51], a[208:215], v1
    v_add_f32 v12, v12, v14
    v_smfmac_f32_16x16x64_bf16 v[20:23], v[44:47], a[216:223], v1
    v_add_f32 v13, v13, v15
    v_smfmac_f32_16x16x64_bf16 v[20:23], v[48:51], a[224:231], v1
    v_cvt_pk_bf16_f32 v12, v12, v13
    v_smfmac_f32_16x16x64_bf16 v[16:19], v[44:47], a[232:239], v1
    v_add_f32 v24, v24, v26
    v_smfmac_f32_16x16x64_bf16 v[16:19], v[48:51], a[240:247], v1
    v_add_f32 v25, v25, v27
    v_smfmac_f32_16x16x64_bf16 v[36:39], v[44:47], v[56:63], v1
    v_cvt_pk_bf16_f32 v13, v24, v25
    v_smfmac_f32_16x16x64_bf16 v[36:39], v[48:51], v[64:71], v1
    v_add_f32 v20, v20, v22
    v_add_f32 v21, v21, v23
    v_cvt_pk_bf16_f32 v14, v20, v21
    v_add_f32 v16, v16, v18
    v_add_f32 v17, v17, v19
    v_cvt_pk_bf16_f32 v15, v16, v17
    v_and_or_b32 v15, v15, -2, s40
    buffer_store_dwordx4 v[12:15], v0, s[8:11], s38 offen
    s_nop 0
    ds_read_b128 v[12:15], v8 offset:18432
    ds_read_b128 v[16:19], v8 offset:19456
    ds_read_b128 v[20:23], v8 offset:22528
    ds_read_b128 v[24:27], v8 offset:23552
    ds_read_b128 v[56:59], v8 offset:24576
    ds_read_b128 v[60:63], v8 offset:25600
    ds_read_b128 v[64:67], v8 offset:28672
    ds_read_b128 v[68:71], v8 offset:29696
    s_waitcnt lgkmcnt(6)
    v_smfmac_f32_16x16x64_bf16 v[40:43], v[44:47], v[12:19], v1
    ds_read_b128 v[12:15], v8 offset:26624
    ds_read_b128 v[16:19], v8 offset:27648
    s_waitcnt lgkmcnt(6)
    v_smfmac_f32_16x16x64_bf16 v[40:43], v[48:51], v[20:27], v1
    ds_read_b128 v[20:23], v8 offset:30720
    ds_read_b128 v[24:27], v8 offset:31744
    s_waitcnt lgkmcnt(6)
    v_smfmac_f32_16x16x64_bf16 v[52:55], v[44:47], v[56:63], v1
    ds_read_b128 v[56:59], v8 offset:32768
    ds_read_b128 v[60:63], v8 offset:33792
    s_waitcnt lgkmcnt(6)
    v_smfmac_f32_16x16x64_bf16 v[52:55], v[48:51], v[64:71], v1
    s_waitcnt lgkmcnt(4)
    v_smfmac_f32_16x16x64_bf16 v[32:35], v[44:47], v[12:19], v1
    s_waitcnt lgkmcnt(2)
    v_smfmac_f32_16x16x64_bf16 v[32:35], v[48:51], v[20:27], v1
    v_smfmac_f32_16x16x64_bf16 v[28:31], v[44:47], a[248:255], v1
    s_waitcnt lgkmcnt(0)
    v_smfmac_f32_16x16x64_bf16 v[28:31], v[48:51], v[56:63], v1
    v_add_f32 v36, v36, v38
    v_add_f32 v37, v37, v39
    v_cvt_pk_bf16_f32 v36, v36, v37
    v_add_f32 v40, v40, v42
    v_add_f32 v41, v41, v43
    v_cvt_pk_bf16_f32 v37, v40, v41
    v_add_f32 v52, v52, v54
    v_add_f32 v53, v53, v55
    v_cvt_pk_bf16_f32 v38, v52, v53
    v_add_f32 v32, v32, v34
    v_add_f32 v33, v33, v35
    v_cvt_pk_bf16_f32 v39, v32, v33
    v_and_or_b32 v39, v39, -2, s40
    s_add_u32 s17, s38, 4096
    buffer_store_dwordx4 v[36:39], v0, s[8:11], s17 offen
    v_add_f32 v28, v28, v30
    v_add_f32 v29, v29, v31
    v_cvt_pk_bf16_f32 v28, v28, v29
    v_and_or_b32 v28, v28, -2, s40
    v_lshrrev_b32 v9, 2, v0
    buffer_store_dword v28, v9, s[8:11], s39 offen
    v_add_u32 v10, 162560, v0
    ds_read_b32 v64, v10
    v_mov_b32 v65, 0
    v_mov_b32 v41, 0
    v_mov_b32 v45, 0
    v_mov_b32 v49, 0
    v_mov_b32 v53, 0
    s_add_u32 s33, s33, 1
    s_add_u32 s42, s42, 262144
    s_add_u32 s41, s41, 262144
    s_add_u32 s43, s43, 131072
    s_add_u32 s68, s68, 262144
    s_add_u32 s66, s66, 22528
    ds_read_b128 v[56:59], v8 offset:4096
    ds_read_b128 v[60:63], v8 offset:5120
    v_mov_b64 v[12:13], 0
    v_mov_b64 v[14:15], 0
    v_mov_b64 v[16:17], 0
    v_mov_b64 v[18:19], 0
    v_mov_b64 v[20:21], 0
    v_mov_b64 v[22:23], 0
    v_mov_b64 v[24:25], 0
    v_mov_b64 v[26:27], 0
    v_mov_b64 v[28:29], 0
    v_mov_b64 v[30:31], 0
    v_mov_b64 v[32:33], 0
    v_mov_b64 v[34:35], 0
    s_nop 15
    s_nop 15
    s_nop 15
    s_nop 1
    buffer_load_dword v40, v6, s[8:11], s62 offen sc1
    buffer_load_dword v44, v6, s[8:11], s63 offen sc1
    buffer_load_dword v48, v6, s[8:11], s64 offen sc1
    buffer_load_dword v52, v6, s[8:11], s65 offen sc1
    s_waitcnt lgkmcnt(0)
    s_waitcnt vmcnt(3)
    v_mfma_f32_16x16x16_bf16 v[68:71], v[40:41], v[64:65], 0
    v_and_b32 v10, 1, v40
    v_cmp_ne_u32 s[54:55], s40, v10
    s_waitcnt vmcnt(2)
    v_mfma_f32_16x16x16_bf16 v[68:71], v[44:45], v[64:65], v[68:71]
    v_and_b32 v10, 1, v44
    v_cmp_ne_u32 s[56:57], s40, v10
    s_waitcnt vmcnt(1)
    v_mfma_f32_16x16x16_bf16 v[68:71], v[48:49], v[64:65], v[68:71]
    v_and_b32 v10, 1, v48
    v_cmp_ne_u32 s[58:59], s40, v10
    s_waitcnt vmcnt(0)
    v_mfma_f32_16x16x16_bf16 v[68:71], v[52:53], v[64:65], v[68:71]
    v_and_b32 v10, 1, v52
    v_cmp_ne_u32 s[60:61], s40, v10
    s_or_b64 vcc, s[54:55], s[56:57]
    s_or_b64 vcc, vcc, s[58:59]
    s_or_b64 vcc, vcc, s[60:61]
    s_cbranch_scc0 Lr2f_red
    s_mov_b32 s16, 0
Lr2f_p1:
    s_mov_b64 exec, s[54:55]
    buffer_load_dword v40, v6, s[8:11], s62 offen sc1
    s_mov_b64 exec, s[56:57]
    buffer_load_dword v44, v6, s[8:11], s63 offen sc1
    s_mov_b64 exec, s[58:59]
    buffer_load_dword v48, v6, s[8:11], s64 offen sc1
    s_mov_b64 exec, s[60:61]
    buffer_load_dword v52, v6, s[8:11], s65 offen sc1
    s_mov_b64 exec, -1
    s_add_u32 s16, s16, 1
    s_cmp_gt_u32 s16, 100000
    s_cbranch_scc1 Lr_abort
    s_waitcnt vmcnt(3)
    v_mfma_f32_16x16x16_bf16 v[68:71], v[40:41], v[64:65], 0
    v_and_b32 v10, 1, v40
    v_cmp_ne_u32 s[54:55], s40, v10
    s_waitcnt vmcnt(2)
    v_mfma_f32_16x16x16_bf16 v[68:71], v[44:45], v[64:65], v[68:71]
    v_and_b32 v10, 1, v44
    v_cmp_ne_u32 s[56:57], s40, v10
    s_waitcnt vmcnt(1)
    v_mfma_f32_16x16x16_bf16 v[68:71], v[48:49], v[64:65], v[68:71]
    v_and_b32 v10, 1, v48
    v_cmp_ne_u32 s[58:59], s40, v10
    s_waitcnt vmcnt(0)
    v_mfma_f32_16x16x16_bf16 v[68:71], v[52:53], v[64:65], v[68:71]
    v_and_b32 v10, 1, v52
    v_cmp_ne_u32 s[60:61], s40, v10
    s_or_b64 vcc, s[54:55], s[56:57]
    s_or_b64 vcc, vcc, s[58:59]
    s_or_b64 vcc, vcc, s[60:61]
    s_cbranch_scc1 Lr2f_p1
Lr2f_red:
    s_xor_b32 s34, s34, 16384
    s_xor_b32 s35, s35, 16384
    buffer_load_dwordx4 v[36:39], v0, s[8:11], s34 offen sc1
    v_permlane16_swap_b32 v68, v70
    v_permlane16_swap_b32 v69, v71
    s_mov_b64 exec, s[46:47]
    v_add_f32 v68, v68, v70
    v_add_f32 v69, v69, v71
    v_cvt_pk_bf16_f32 v68, v68, v69
    v_min_u32 v68, s50, v68
    buffer_store_dword v68, v7, s[8:11], s36 offen
    v_mov_b32 v69, -1
    buffer_store_dword v69, v7, s[8:11], s37 offen
    s_mov_b64 exec, -1
    buffer_load_dwordx4 v[36:39], v0, s[8:11], s34 offen sc1
    s_xor_b32 s40, s40, 1
    s_xor_b32 s36, s36, 16384
    s_xor_b32 s37, s37, 16384
    ds_read_b128 v[64:67], v8 offset:6144
    ds_read_b128 v[68:71], v8 offset:7168
    s_waitcnt lgkmcnt(0)
    s_branch Lr2f_step
Lr2f_pb_re:
    s_mov_b32 s16, 0
Lr2f_pb_lp:
    s_add_u32 s17, s34, 4096
    buffer_load_dwordx4 v[40:43], v0, s[8:11], s17 offen sc1
    s_add_u32 s16, s16, 1
    s_cmp_gt_u32 s16, 100000
    s_cbranch_scc1 Lr_abort
    s_waitcnt vmcnt(0)
    v_max3_u32 v10, v40, v41, v42
    v_max_u32 v10, v10, v43
    v_cmp_eq_u32 vcc, -1, v10
    s_nop 0
    s_cbranch_vccnz Lr2f_pb_lp
    s_branch Lr2f_pb_ok
Lr2f_pc_re:
    s_mov_b32 s16, 0
Lr2f_pc_lp:
    buffer_load_dwordx4 v[44:47], v0, s[8:11], s35 offen sc1
    s_add_u32 s16, s16, 1
    s_cmp_gt_u32 s16, 100000
    s_cbranch_scc1 Lr_abort
    s_waitcnt vmcnt(0)
    v_max3_u32 v10, v44, v45, v46
    v_max_u32 v10, v10, v47
    v_cmp_eq_u32 vcc, -1, v10
    s_nop 0
    s_cbranch_vccnz Lr2f_pc_lp
    s_branch Lr2f_pc_ok
Lr2f_flbad:
    s_cmp_eq_u32 s33, 63
    s_cbranch_scc1 Lr2f_flok
    s_mov_b32 s16, 0
    s_add_u32 s17, s66, 22656
    v_lshrrev_b32 v10, 2, v0
    v_and_b32 v9, 16, v10
    v_lshlrev_b32 v9, 3, v9
    v_and_or_b32 v10, v10, 12, v9
Lr2f_fw_13:
    buffer_load_dword v9, v10, s[8:11], s17 offen sc1
    s_add_u32 s16, s16, 1
    s_cmp_gt_u32 s16, 100000
    s_cbranch_scc1 Lr_abort
    s_waitcnt vmcnt(0)
    v_cmp_eq_u32 vcc, 0, v9
    s_nop 0
    s_cbranch_vccnz Lr2f_fw_13
    s_branch Lr2f_flok
Lr2f_last:
    s_waitcnt vmcnt(0) lgkmcnt(0)
    s_barrier
    s_branch Lr_exit
L_w3_1:
    s_mov_b32 s16, 0
    s_add_u32 s17, s66, 128
    v_lshrrev_b32 v10, 2, v0
    v_and_b32 v9, 16, v10
    v_lshlrev_b32 v9, 3, v9
    v_and_or_b32 v10, v10, 12, v9
Lr3f_fw_14:
    buffer_load_dword v9, v10, s[8:11], s17 offen sc1
    s_add_u32 s16, s16, 1
    s_cmp_gt_u32 s16, 100000
    s_cbranch_scc1 Lr_abort
    s_waitcnt vmcnt(0)
    v_cmp_eq_u32 vcc, 0, v9
    s_nop 0
    s_cbranch_vccnz Lr3f_fw_14
    s_mov_b32 m0, 21248
    s_nop 0
    buffer_load_dwordx4 v0, s[8:11], s41 offen offset:0 lds
    buffer_load_dwordx4 v0, s[8:11], s41 offen offset:1024 lds
    s_add_u32 s41, s41, 262144
    s_add_u32 s68, s68, 262144
    s_waitcnt vmcnt(0)
    ds_read_b128 v[56:59], v8 offset:0
    ds_read_b128 v[60:63], v8 offset:1024
    ds_read_b128 v[64:67], v8 offset:2048
    ds_read_b128 v[68:71], v8 offset:3072
    v_mov_b64 v[12:13], 0
    v_mov_b64 v[14:15], 0
    v_mov_b64 v[16:17], 0
    v_mov_b64 v[18:19], 0
    v_mov_b64 v[20:21], 0
    v_mov_b64 v[22:23], 0
    v_mov_b64 v[24:25], 0
    v_mov_b64 v[26:27], 0
    v_mov_b64 v[28:29], 0
    v_mov_b64 v[30:31], 0
    v_mov_b64 v[32:33], 0
    v_mov_b64 v[34:35], 0
    buffer_load_dwordx4 v[36:39], v0, s[8:11], s34 offen sc1
    s_waitcnt vmcnt(0) lgkmcnt(0)
Lr3f_step:
    s_mov_b32 s16, 0
Lr3f_alp:
    s_waitcnt vmcnt(2)
    v_max3_u32 v10, v36, v37, v38
    v_max_u32 v10, v10, v39
    v_cmp_eq_u32 vcc, -1, v10
    s_nop 0
    s_cbranch_vccz Lr3f_aok
    buffer_load_dwordx4 v[36:39], v0, s[8:11], s34 offen sc1
    s_add_u32 s16, s16, 1
    s_cmp_gt_u32 s16, 100000
    s_cbranch_scc1 Lr_abort
    s_branch Lr3f_alp
Lr3f_aok:
    ds_write_b128 v0, v[36:39] offset:9984
    v_smfmac_f32_16x16x64_bf16 v[12:15], v[36:39], v[120:127], v1
    v_smfmac_f32_16x16x64_bf16 v[16:19], v[36:39], v[128:135], v1
    v_smfmac_f32_16x16x64_bf16 v[20:23], v[36:39], v[232:239], v1
    s_waitcnt lgkmcnt(0)
    s_barrier
    ds_read_b128 v[48:51], v0 offset:6912
    ds_read_b128 v[52:55], v0 offset:7936
    v_smfmac_f32_16x16x64_bf16 v[28:31], v[36:39], a[88:95], v1
    v_smfmac_f32_16x16x64_bf16 v[24:27], v[36:39], v[240:247], v1
    v_smfmac_f32_16x16x64_bf16 v[32:35], v[36:39], a[96:103], v1
    s_waitcnt vmcnt(0)
    ds_read_b128 v[36:39], v0 offset:8960
    s_waitcnt lgkmcnt(2)
    v_smfmac_f32_16x16x64_bf16 v[28:31], v[48:51], v[56:63], v1
    ds_read_b128 v[56:59], v8 offset:4096
    ds_read_b128 v[60:63], v8 offset:5120
    s_add_u32 s17, s34, 4096
    buffer_load_dwordx4 v[40:43], v0, s[8:11], s17 offen sc1
    v_smfmac_f32_16x16x64_bf16 v[12:15], v[48:51], v[72:79], v1
    v_smfmac_f32_16x16x64_bf16 v[16:19], v[48:51], v[80:87], v1
    v_smfmac_f32_16x16x64_bf16 v[32:35], v[48:51], v[64:71], v1
    ds_read_b128 v[64:67], v8 offset:6144
    ds_read_b128 v[68:71], v8 offset:7168
    v_smfmac_f32_16x16x64_bf16 v[20:23], v[48:51], v[184:191], v1
    buffer_load_dwordx4 v[44:47], v0, s[8:11], s35 offen sc1
    v_smfmac_f32_16x16x64_bf16 v[24:27], v[48:51], v[192:199], v1
    s_waitcnt lgkmcnt(5)
    v_smfmac_f32_16x16x64_bf16 v[28:31], v[52:55], a[72:79], v1
    v_smfmac_f32_16x16x64_bf16 v[12:15], v[52:55], v[88:95], v1
    v_smfmac_f32_16x16x64_bf16 v[16:19], v[52:55], v[96:103], v1
    v_smfmac_f32_16x16x64_bf16 v[32:35], v[52:55], a[80:87], v1
    v_smfmac_f32_16x16x64_bf16 v[20:23], v[52:55], v[200:207], v1
    v_smfmac_f32_16x16x64_bf16 v[24:27], v[52:55], v[208:215], v1
    s_waitcnt lgkmcnt(2)
    v_smfmac_f32_16x16x64_bf16 v[28:31], v[36:39], v[56:63], v1
    ds_read_b128 v[56:59], v8 offset:8192
    ds_read_b128 v[60:63], v8 offset:9216
    v_smfmac_f32_16x16x64_bf16 v[12:15], v[36:39], v[104:111], v1
    v_smfmac_f32_16x16x64_bf16 v[16:19], v[36:39], v[112:119], v1
    s_waitcnt lgkmcnt(2)
    v_smfmac_f32_16x16x64_bf16 v[32:35], v[36:39], v[64:71], v1
    ds_read_b128 v[64:67], v8 offset:10240
    ds_read_b128 v[68:71], v8 offset:11264
    v_smfmac_f32_16x16x64_bf16 v[20:23], v[36:39], v[216:223], v1
    v_smfmac_f32_16x16x64_bf16 v[24:27], v[36:39], v[224:231], v1
    s_waitcnt vmcnt(1)
    v_max3_u32 v10, v40, v41, v42
    v_max_u32 v10, v10, v43
    v_cmp_eq_u32 vcc, -1, v10
    s_nop 0
    s_cbranch_vccnz Lr3f_pb_re
Lr3f_pb_ok:
    ds_write_b128 v0, v[40:43] offset:14080
    v_smfmac_f32_16x16x64_bf16 v[12:15], v[40:43], v[152:159], v1
    v_smfmac_f32_16x16x64_bf16 v[20:23], v[40:43], a[40:47], v1
    v_smfmac_f32_16x16x64_bf16 v[16:19], v[40:43], v[160:167], v1
    v_smfmac_f32_16x16x64_bf16 v[24:27], v[40:43], a[48:55], v1
    s_waitcnt lgkmcnt(0)
    s_barrier
    ds_read_b128 v[48:51], v0 offset:11008
    ds_read_b128 v[52:55], v0 offset:12032
    ds_read_b128 v[36:39], v0 offset:13056
    v_smfmac_f32_16x16x64_bf16 v[28:31], v[40:43], a[152:159], v1
    v_smfmac_f32_16x16x64_bf16 v[32:35], v[40:43], a[160:167], v1
    s_waitcnt lgkmcnt(2)
    v_smfmac_f32_16x16x64_bf16 v[12:15], v[48:51], v[56:63], v1
    ds_read_b128 v[56:59], v8 offset:12288
    ds_read_b128 v[60:63], v8 offset:13312
    v_smfmac_f32_16x16x64_bf16 v[16:19], v[48:51], v[64:71], v1
    ds_read_b128 v[64:67], v8 offset:14336
    ds_read_b128 v[68:71], v8 offset:15360
    s_waitcnt lgkmcnt(5)
    v_smfmac_f32_16x16x64_bf16 v[12:15], v[52:55], v[136:143], v1
    v_smfmac_f32_16x16x64_bf16 v[16:19], v[52:55], v[144:151], v1
    s_waitcnt vmcnt(0)
    v_max3_u32 v10, v44, v45, v46
    v_max_u32 v10, v10, v47
    v_cmp_eq_u32 vcc, -1, v10
    s_nop 0
    s_cbranch_vccnz Lr3f_pc_re
Lr3f_pc_ok:
    v_smfmac_f32_16x16x64_bf16 v[12:15], v[44:47], v[168:175], v1
    v_smfmac_f32_16x16x64_bf16 v[16:19], v[44:47], v[176:183], v1
    s_waitcnt lgkmcnt(2)
    v_smfmac_f32_16x16x64_bf16 v[12:15], v[36:39], v[56:63], v1
    s_waitcnt lgkmcnt(0)
    v_smfmac_f32_16x16x64_bf16 v[16:19], v[36:39], v[64:71], v1
    v_smfmac_f32_16x16x64_bf16 v[20:23], v[48:51], v[248:255], v1
    v_smfmac_f32_16x16x64_bf16 v[24:27], v[48:51], a[0:7], v1
    v_smfmac_f32_16x16x64_bf16 v[20:23], v[52:55], a[8:15], v1
    v_add_f32 v12, v12, v14
    v_smfmac_f32_16x16x64_bf16 v[24:27], v[52:55], a[16:23], v1
    v_add_f32 v16, v16, v18
    buffer_load_dwordx4 v[64:67], v0, s[8:11], s42 offen
    v_smfmac_f32_16x16x64_bf16 v[20:23], v[36:39], a[24:31], v1
    v_add_f32 v13, v13, v15
    v_smfmac_f32_16x16x64_bf16 v[24:27], v[36:39], a[32:39], v1
    v_add_f32 v17, v17, v19
    v_smfmac_f32_16x16x64_bf16 v[20:23], v[44:47], a[56:63], v1
    v_cvt_pk_bf16_f32 v14, v12, v16
    ds_read_b128 v[56:59], v0 offset:15104
    v_smfmac_f32_16x16x64_bf16 v[24:27], v[44:47], a[64:71], v1
    v_cvt_pk_bf16_f32 v15, v13, v17
    ds_read_b128 v[60:63], v0 offset:16128
    buffer_load_dwordx4 v[68:71], v0, s[8:11], s42 offen offset:1024
    ds_write_b32 v2, v14 offset:576
    ds_write_b32 v2, v15 offset:864
    v_smfmac_f32_16x16x64_bf16 v[28:31], v[48:51], a[104:111], v1
    v_smfmac_f32_16x16x64_bf16 v[32:35], v[48:51], a[112:119], v1
    v_add_f32 v20, v20, v22
    v_add_f32 v24, v24, v26
    v_add_f32 v21, v21, v23
    v_add_f32 v25, v25, v27
    v_cvt_pk_bf16_f32 v22, v20, v24
    v_cvt_pk_bf16_f32 v23, v21, v25
    ds_write_b32 v2, v22 offset:0
    ds_write_b32 v2, v23 offset:288
    v_smfmac_f32_16x16x64_bf16 v[28:31], v[52:55], a[120:127], v1
    v_smfmac_f32_16x16x64_bf16 v[32:35], v[52:55], a[128:135], v1
    s_waitcnt lgkmcnt(0)
    s_barrier
    ds_read_b128 v[40:43], v3 offset:0
    ds_read_b128 v[48:51], v3 offset:64
    ds_read_b128 v[20:23], v3 offset:128
    ds_read_b128 v[52:55], v3 offset:192
    v_smfmac_f32_16x16x64_bf16 v[28:31], v[36:39], a[136:143], v1
    v_smfmac_f32_16x16x64_bf16 v[32:35], v[36:39], a[144:151], v1
    ds_read_b128 v[36:39], v0 offset:17152
    v_lshlrev_b32 v9, 3, v0
    buffer_load_dword v11, v9, s[8:11], s68 offen
    v_smfmac_f32_16x16x64_bf16 v[28:31], v[44:47], a[168:175], v1
    v_smfmac_f32_16x16x64_bf16 v[32:35], v[44:47], a[176:183], v1
    ds_read_b128 v[44:47], v0 offset:18176
    s_waitcnt lgkmcnt(5)
    v_mfma_f32_16x16x32_bf16 v[12:15], v[56:59], v[40:43], 0
    v_mfma_f32_16x16x32_bf16 v[16:19], v[60:63], v[40:43], 0
    v_mfma_f32_16x16x32_bf16 v[24:27], v[40:43], v[40:43], 0
    ds_read_b128 v[56:59], v0 offset:19200
    ds_read_b128 v[60:63], v0 offset:20224
    s_waitcnt lgkmcnt(3)
    v_mfma_f32_16x16x32_bf16 v[12:15], v[36:39], v[48:51], v[12:15]
    v_lshrrev_b32 v10, 1, v0
    v_lshrrev_b32 v9, 9, v0
    s_waitcnt lgkmcnt(2)
    v_mfma_f32_16x16x32_bf16 v[16:19], v[44:47], v[48:51], v[16:19]
    v_lshl_add_u32 v9, v9, 5, v10
    v_add_f32 v28, v28, v30
    v_mfma_f32_16x16x32_bf16 v[24:27], v[48:51], v[48:51], v[24:27]
    v_add_f32 v32, v32, v34
    v_add_f32 v29, v29, v31
    ds_read_b128 v[36:39], v0 offset:21248
    ds_read_b128 v[44:47], v0 offset:22272
    s_waitcnt lgkmcnt(3)
    v_mfma_f32_16x16x32_bf16 v[12:15], v[56:59], v[20:23], v[12:15]
    v_add_f32 v33, v33, v35
    v_cvt_pk_bf16_f32 v30, v28, v29
    s_waitcnt lgkmcnt(2)
    v_mfma_f32_16x16x32_bf16 v[16:19], v[60:63], v[20:23], v[16:19]
    v_cvt_pk_bf16_f32 v31, v32, v33
    ds_read_b64 v[34:35], v9 offset:3456
    v_mfma_f32_16x16x32_bf16 v[24:27], v[20:23], v[20:23], v[24:27]
    s_add_u32 s17, s43, 3584
    buffer_store_dwordx2 v[30:31], v10, s[8:11], s17 offen sc1
    s_waitcnt lgkmcnt(2)
    v_mfma_f32_16x16x32_bf16 v[12:15], v[36:39], v[52:55], v[12:15]
    s_waitcnt lgkmcnt(1)
    v_mfma_f32_16x16x32_bf16 v[16:19], v[44:47], v[52:55], v[16:19]
    v_mfma_f32_16x16x32_bf16 v[24:27], v[52:55], v[52:55], v[24:27]
    s_add_u32 s17, s43, 1536
    s_waitcnt lgkmcnt(0)
    buffer_store_dwordx2 v[34:35], v10, s[8:11], s17 offen sc1
    s_cmp_eq_u32 s33, 63
    s_cbranch_scc1 Lr3f_last
    ds_read_b128 v[56:59], v8 offset:16384
    ds_read_b128 v[60:63], v8 offset:17408
    v_mov_b64 v[20:21], s[52:53]
    v_mov_b64 v[22:23], s[52:53]
    v_mov_b32 v41, 0
    v_mov_b32 v42, 0
    v_max3_f32 v9, v12, v13, v14
    v_max3_f32 v9, v9, v15, v16
    v_max3_f32 v9, v9, v17, v18
    v_max3_f32 v9, v9, v19, v24
    v_max_f32 v9, v9, v25
    v_mov_b32 v10, v9
    v_mov_b64 v[32:33], 0
    v_mov_b64 v[34:35], 0
    v_permlane32_swap_b32 v9, v10
    v_max_f32 v9, v9, v10
    v_mov_b32 v10, v9
    s_nop 1
    v_permlane16_swap_b32 v9, v10
    v_max_f32 v9, v9, v10
    v_mul_f32 v28, s44, v9
    v_fma_f32 v12, v12, s44, -v28
    v_fma_f32 v13, v13, s44, -v28
    v_fma_f32 v14, v14, s44, -v28
    v_fma_f32 v15, v15, s44, -v28
    v_exp_f32 v12, v12
    v_exp_f32 v13, v13
    v_fma_f32 v16, v16, s44, -v28
    v_fma_f32 v17, v17, s44, -v28
    v_exp_f32 v14, v14
    v_exp_f32 v15, v15
    v_cvt_pk_bf16_f32 v36, v12, v13
    v_fma_f32 v18, v18, s44, -v28
    v_fma_f32 v19, v19, s44, -v28
    v_exp_f32 v16, v16
    v_exp_f32 v17, v17
    v_cvt_pk_bf16_f32 v37, v14, v15
    v_fma_f32 v24, v24, s44, -v28
    v_fma_f32 v25, v25, s44, -v28
    v_exp_f32 v18, v18
    v_exp_f32 v19, v19
    v_cvt_pk_bf16_f32 v38, v16, v17
    v_exp_f32 v24, v24
    v_exp_f32 v25, v25
    v_cvt_pk_bf16_f32 v39, v18, v19
    v_cvt_pk_bf16_f32 v40, v24, v25
    v_cvt_pk_bf16_f32 v43, v24, v25
    v_mfma_f32_16x16x32_bf16 v[52:55], v[20:23], v[36:39], 0
    v_mov_b64 v[12:13], 0
    v_mov_b64 v[14:15], 0
    s_waitcnt vmcnt(4)
    v_mfma_f32_16x16x32_bf16 v[44:47], v[64:67], v[36:39], 0
    v_mov_b64 v[24:25], 0
    v_mov_b64 v[26:27], 0
    s_waitcnt vmcnt(3)
    v_mfma_f32_16x16x32_bf16 v[48:51], v[68:71], v[36:39], 0
    ds_read_b128 v[64:67], v8 offset:20480
    ds_read_b128 v[68:71], v8 offset:21504
    v_mfma_f32_16x16x16_bf16 v[52:55], v[20:21], v[40:41], v[52:55]
    v_mfma_f32_16x16x16_bf16 v[44:47], v[30:31], v[40:41], v[44:47]
    v_mov_b64 v[20:21], 0
    v_mov_b64 v[22:23], 0
    v_mfma_f32_16x16x16_bf16 v[48:51], v[30:31], v[42:43], v[48:51]
    v_mov_b64 v[36:37], 0
    v_mov_b64 v[38:39], 0
    v_mov_b64 v[40:41], 0
    v_mov_b64 v[42:43], 0
    v_rcp_f32 v9, v52
    v_mov_b64 v[52:53], 0
    v_mov_b64 v[54:55], 0
    v_mul_f32 v44, v9, v44
    v_mul_f32 v48, v9, v48
    v_cvt_pk_bf16_f32 v16, v44, v48
    v_mul_f32 v45, v9, v45
    v_mul_f32 v49, v9, v49
    v_cvt_pk_bf16_f32 v17, v45, v49
    v_mul_f32 v46, v9, v46
    v_mul_f32 v50, v9, v50
    v_cvt_pk_bf16_f32 v18, v46, v50
    v_mul_f32 v47, v9, v47
    v_mul_f32 v51, v9, v51
    v_cvt_pk_bf16_f32 v19, v47, v51
    ds_write_b128 v5, v[16:19]
    v_mov_b64 v[28:29], 0
    v_mov_b64 v[30:31], 0
    s_waitcnt lgkmcnt(0)
    s_barrier
    ds_read_b128 v[44:47], v4 offset:0
    ds_read_b128 v[48:51], v4 offset:128
    v_mov_b64 v[16:17], 0
    v_mov_b64 v[18:19], 0
    buffer_load_dwordx4 v0, s[8:11], s41 offen offset:0 lds
    buffer_load_dwordx4 v0, s[8:11], s41 offen offset:1024 lds
    s_waitcnt lgkmcnt(1)
    v_smfmac_f32_16x16x64_bf16 v[12:15], v[44:47], a[184:191], v1
    s_waitcnt lgkmcnt(0)
    v_smfmac_f32_16x16x64_bf16 v[12:15], v[48:51], a[192:199], v1
    v_smfmac_f32_16x16x64_bf16 v[24:27], v[44:47], a[200:207], v1
    v_smfmac_f32_16x16x64_bf16 v[24:27], v[48:51], a[208:215], v1
    v_add_f32 v12, v12, v14
    v_smfmac_f32_16x16x64_bf16 v[20:23], v[44:47], a[216:223], v1
    v_add_f32 v13, v13, v15
    v_smfmac_f32_16x16x64_bf16 v[20:23], v[48:51], a[224:231], v1
    v_cvt_pk_bf16_f32 v12, v12, v13
    v_smfmac_f32_16x16x64_bf16 v[16:19], v[44:47], a[232:239], v1
    v_add_f32 v24, v24, v26
    v_smfmac_f32_16x16x64_bf16 v[16:19], v[48:51], a[240:247], v1
    v_add_f32 v25, v25, v27
    v_smfmac_f32_16x16x64_bf16 v[36:39], v[44:47], v[56:63], v1
    v_cvt_pk_bf16_f32 v13, v24, v25
    v_smfmac_f32_16x16x64_bf16 v[36:39], v[48:51], v[64:71], v1
    v_add_f32 v20, v20, v22
    v_add_f32 v21, v21, v23
    v_cvt_pk_bf16_f32 v14, v20, v21
    v_add_f32 v16, v16, v18
    v_add_f32 v17, v17, v19
    v_cvt_pk_bf16_f32 v15, v16, v17
    v_and_or_b32 v15, v15, -2, s40
    buffer_store_dwordx4 v[12:15], v0, s[8:11], s38 offen
    s_nop 0
    ds_read_b128 v[12:15], v8 offset:18432
    ds_read_b128 v[16:19], v8 offset:19456
    ds_read_b128 v[20:23], v8 offset:22528
    ds_read_b128 v[24:27], v8 offset:23552
    ds_read_b128 v[56:59], v8 offset:24576
    ds_read_b128 v[60:63], v8 offset:25600
    ds_read_b128 v[64:67], v8 offset:28672
    ds_read_b128 v[68:71], v8 offset:29696
    s_waitcnt lgkmcnt(6)
    v_smfmac_f32_16x16x64_bf16 v[40:43], v[44:47], v[12:19], v1
    ds_read_b128 v[12:15], v8 offset:26624
    ds_read_b128 v[16:19], v8 offset:27648
    s_waitcnt lgkmcnt(6)
    v_smfmac_f32_16x16x64_bf16 v[40:43], v[48:51], v[20:27], v1
    ds_read_b128 v[20:23], v8 offset:30720
    ds_read_b128 v[24:27], v8 offset:31744
    s_waitcnt lgkmcnt(6)
    v_smfmac_f32_16x16x64_bf16 v[52:55], v[44:47], v[56:63], v1
    ds_read_b128 v[56:59], v8 offset:32768
    ds_read_b128 v[60:63], v8 offset:33792
    s_waitcnt lgkmcnt(6)
    v_smfmac_f32_16x16x64_bf16 v[52:55], v[48:51], v[64:71], v1
    s_waitcnt lgkmcnt(4)
    v_smfmac_f32_16x16x64_bf16 v[32:35], v[44:47], v[12:19], v1
    s_waitcnt lgkmcnt(2)
    v_smfmac_f32_16x16x64_bf16 v[32:35], v[48:51], v[20:27], v1
    v_smfmac_f32_16x16x64_bf16 v[28:31], v[44:47], a[248:255], v1
    s_waitcnt lgkmcnt(0)
    v_smfmac_f32_16x16x64_bf16 v[28:31], v[48:51], v[56:63], v1
    v_add_f32 v36, v36, v38
    v_add_f32 v37, v37, v39
    v_cvt_pk_bf16_f32 v36, v36, v37
    v_add_f32 v40, v40, v42
    v_add_f32 v41, v41, v43
    v_cvt_pk_bf16_f32 v37, v40, v41
    v_add_f32 v52, v52, v54
    v_add_f32 v53, v53, v55
    v_cvt_pk_bf16_f32 v38, v52, v53
    v_add_f32 v32, v32, v34
    v_add_f32 v33, v33, v35
    v_cvt_pk_bf16_f32 v39, v32, v33
    v_and_or_b32 v39, v39, -2, s40
    s_add_u32 s17, s38, 4096
    buffer_store_dwordx4 v[36:39], v0, s[8:11], s17 offen
    v_add_f32 v28, v28, v30
    v_add_f32 v29, v29, v31
    v_cvt_pk_bf16_f32 v28, v28, v29
    v_and_or_b32 v28, v28, -2, s40
    v_lshrrev_b32 v9, 2, v0
    buffer_store_dword v28, v9, s[8:11], s39 offen
    s_xor_b32 s34, s34, 16384
    s_xor_b32 s35, s35, 16384
    s_add_u32 s33, s33, 1
    s_add_u32 s42, s42, 262144
    s_add_u32 s41, s41, 262144
    s_add_u32 s43, s43, 131072
    s_add_u32 s68, s68, 262144
    s_add_u32 s66, s66, 22528
    s_xor_b32 s40, s40, 1
    ds_read_b128 v[56:59], v8 offset:0
    ds_read_b128 v[60:63], v8 offset:1024
    ds_read_b128 v[64:67], v8 offset:2048
    ds_read_b128 v[68:71], v8 offset:3072
    v_mov_b64 v[12:13], 0
    v_mov_b64 v[14:15], 0
    v_mov_b64 v[16:17], 0
    v_mov_b64 v[18:19], 0
    v_mov_b64 v[20:21], 0
    v_mov_b64 v[22:23], 0
    v_mov_b64 v[24:25], 0
    v_mov_b64 v[26:27], 0
    v_mov_b64 v[28:29], 0
    v_mov_b64 v[30:31], 0
    v_mov_b64 v[32:33], 0
    v_mov_b64 v[34:35], 0
    s_sleep 5
    s_nop 9
    buffer_load_dwordx4 v[36:39], v0, s[8:11], s34 offen sc1
    s_nop 15
    s_nop 8
    buffer_load_dwordx4 v[36:39], v0, s[8:11], s34 offen sc1
    s_nop 15
    s_nop 8
    buffer_load_dwordx4 v[36:39], v0, s[8:11], s34 offen sc1
    s_waitcnt lgkmcnt(0)
    s_branch Lr3f_step
Lr3f_pb_re:
    s_mov_b32 s16, 0
Lr3f_pb_lp:
    s_add_u32 s17, s34, 4096
    buffer_load_dwordx4 v[40:43], v0, s[8:11], s17 offen sc1
    s_add_u32 s16, s16, 1
    s_cmp_gt_u32 s16, 100000
    s_cbranch_scc1 Lr_abort
    s_waitcnt vmcnt(0)
    v_max3_u32 v10, v40, v41, v42
    v_max_u32 v10, v10, v43
    v_cmp_eq_u32 vcc, -1, v10
    s_nop 0
    s_cbranch_vccnz Lr3f_pb_lp
    s_branch Lr3f_pb_ok
Lr3f_pc_re:
    s_mov_b32 s16, 0
Lr3f_pc_lp:
    buffer_load_dwordx4 v[44:47], v0, s[8:11], s35 offen sc1
    s_add_u32 s16, s16, 1
    s_cmp_gt_u32 s16, 100000
    s_cbranch_scc1 Lr_abort
    s_waitcnt vmcnt(0)
    v_max3_u32 v10, v44, v45, v46
    v_max_u32 v10, v10, v47
    v_cmp_eq_u32 vcc, -1, v10
    s_nop 0
    s_cbranch_vccnz Lr3f_pc_lp
    s_branch Lr3f_pc_ok
Lr3f_last:
    s_waitcnt vmcnt(0) lgkmcnt(0)
    s_barrier
    s_branch Lr_exit
L_slow:
    s_cmp_lg_u32 s14, 0
    s_cbranch_scc1 L_w1_0
    s_mov_b32 s16, 0
    s_add_u32 s17, s66, 128
    v_lshrrev_b32 v10, 2, v0
    v_and_b32 v9, 16, v10
    v_lshlrev_b32 v9, 3, v9
    v_and_or_b32 v10, v10, 12, v9
Lr0s_fw_15:
    buffer_load_dword v9, v10, s[8:11], s17 offen sc1
    s_add_u32 s16, s16, 1
    s_cmp_gt_u32 s16, 100000
    s_cbranch_scc1 Lr_abort
    s_waitcnt vmcnt(0)
    v_cmp_eq_u32 vcc, 0, v9
    s_nop 0
    s_cbranch_vccnz Lr0s_fw_15
    s_mov_b32 m0, 15104
    s_nop 0
    buffer_load_dwordx4 v0, s[8:11], s41 offen offset:0 lds
    buffer_load_dwordx4 v0, s[8:11], s41 offen offset:1024 lds
    s_add_u32 s41, s41, 262144
    s_add_u32 s68, s68, 4278452224
    s_waitcnt vmcnt(0)
    ds_read_b128 v[56:59], v8 offset:0
    ds_read_b128 v[60:63], v8 offset:1024
    ds_read_b128 v[64:67], v8 offset:2048
    ds_read_b128 v[68:71], v8 offset:3072
    v_mov_b64 v[12:13], 0
    v_mov_b64 v[14:15], 0
    v_mov_b64 v[16:17], 0
    v_mov_b64 v[18:19], 0
    v_mov_b64 v[20:21], 0
    v_mov_b64 v[22:23], 0
    v_mov_b64 v[24:25], 0
    v_mov_b64 v[26:27], 0
    v_mov_b64 v[28:29], 0
    v_mov_b64 v[30:31], 0
    v_mov_b64 v[32:33], 0
    v_mov_b64 v[34:35], 0
    buffer_load_dwordx4 v[36:39], v0, s[8:11], s34 offen sc1
    s_waitcnt vmcnt(0) lgkmcnt(0)
Lr0s_step:
    s_mov_b32 s16, 0
Lr0s_alp:
    s_waitcnt vmcnt(2)
    v_max3_u32 v10, v36, v37, v38
    v_max_u32 v10, v10, v39
    v_cmp_eq_u32 vcc, -1, v10
    s_nop 0
    s_cbranch_vccz Lr0s_aok
    buffer_load_dwordx4 v[36:39], v0, s[8:11], s34 offen sc1
    s_add_u32 s16, s16, 1
    s_cmp_gt_u32 s16, 100000
    s_cbranch_scc1 Lr_abort
    s_branch Lr0s_alp
Lr0s_aok:
    ds_write_b128 v0, v[36:39] offset:6912
    v_smfmac_f32_16x16x64_bf16 v[12:15], v[36:39], v[72:79], v1
    v_smfmac_f32_16x16x64_bf16 v[16:19], v[36:39], v[80:87], v1
    v_smfmac_f32_16x16x64_bf16 v[20:23], v[36:39], v[184:191], v1
    s_waitcnt lgkmcnt(0)
    s_barrier
    ds_read_b128 v[48:51], v0 offset:7936
    ds_read_b128 v[52:55], v0 offset:8960
    v_smfmac_f32_16x16x64_bf16 v[28:31], v[36:39], v[56:63], v1
    ds_read_b128 v[56:59], v8 offset:4096
    ds_read_b128 v[60:63], v8 offset:5120
    s_add_u32 s17, s34, 4096
    buffer_load_dwordx4 v[40:43], v0, s[8:11], s17 offen sc1
    v_smfmac_f32_16x16x64_bf16 v[24:27], v[36:39], v[192:199], v1
    v_smfmac_f32_16x16x64_bf16 v[32:35], v[36:39], v[64:71], v1
    ds_read_b128 v[64:67], v8 offset:6144
    ds_read_b128 v[68:71], v8 offset:7168
    s_waitcnt vmcnt(1)
    ds_read_b128 v[36:39], v0 offset:9984
    s_waitcnt lgkmcnt(6)
    v_smfmac_f32_16x16x64_bf16 v[28:31], v[48:51], a[72:79], v1
    v_smfmac_f32_16x16x64_bf16 v[12:15], v[48:51], v[88:95], v1
    buffer_load_dwordx4 v[44:47], v0, s[8:11], s35 offen sc1
    v_smfmac_f32_16x16x64_bf16 v[16:19], v[48:51], v[96:103], v1
    v_smfmac_f32_16x16x64_bf16 v[32:35], v[48:51], a[80:87], v1
    v_smfmac_f32_16x16x64_bf16 v[20:23], v[48:51], v[200:207], v1
    v_smfmac_f32_16x16x64_bf16 v[24:27], v[48:51], v[208:215], v1
    s_waitcnt lgkmcnt(3)
    v_smfmac_f32_16x16x64_bf16 v[28:31], v[52:55], v[56:63], v1
    ds_read_b128 v[56:59], v8 offset:8192
    ds_read_b128 v[60:63], v8 offset:9216
    v_smfmac_f32_16x16x64_bf16 v[12:15], v[52:55], v[104:111], v1
    v_smfmac_f32_16x16x64_bf16 v[16:19], v[52:55], v[112:119], v1
    s_waitcnt lgkmcnt(3)
    v_smfmac_f32_16x16x64_bf16 v[32:35], v[52:55], v[64:71], v1
    ds_read_b128 v[64:67], v8 offset:10240
    ds_read_b128 v[68:71], v8 offset:11264
    v_smfmac_f32_16x16x64_bf16 v[20:23], v[52:55], v[216:223], v1
    v_smfmac_f32_16x16x64_bf16 v[24:27], v[52:55], v[224:231], v1
    s_waitcnt lgkmcnt(4)
    v_smfmac_f32_16x16x64_bf16 v[28:31], v[36:39], a[88:95], v1
    v_smfmac_f32_16x16x64_bf16 v[12:15], v[36:39], v[120:127], v1
    v_smfmac_f32_16x16x64_bf16 v[16:19], v[36:39], v[128:135], v1
    v_smfmac_f32_16x16x64_bf16 v[32:35], v[36:39], a[96:103], v1
    v_smfmac_f32_16x16x64_bf16 v[20:23], v[36:39], v[232:239], v1
    v_smfmac_f32_16x16x64_bf16 v[24:27], v[36:39], v[240:247], v1
    s_waitcnt vmcnt(1)
    v_max3_u32 v10, v40, v41, v42
    v_max_u32 v10, v10, v43
    v_cmp_eq_u32 vcc, -1, v10
    s_nop 0
    s_cbranch_vccnz Lr0s_pb_re
Lr0s_pb_ok:
    ds_write_b128 v0, v[40:43] offset:11008
    s_waitcnt lgkmcnt(3)
    v_smfmac_f32_16x16x64_bf16 v[12:15], v[40:43], v[56:63], v1
    ds_read_b128 v[56:59], v8 offset:12288
    ds_read_b128 v[60:63], v8 offset:13312
    v_smfmac_f32_16x16x64_bf16 v[20:23], v[40:43], v[248:255], v1
    s_waitcnt lgkmcnt(3)
    v_smfmac_f32_16x16x64_bf16 v[16:19], v[40:43], v[64:71], v1
    ds_read_b128 v[64:67], v8 offset:14336
    ds_read_b128 v[68:71], v8 offset:15360
    v_smfmac_f32_16x16x64_bf16 v[24:27], v[40:43], a[0:7], v1
    s_waitcnt lgkmcnt(4)
    s_barrier
    ds_read_b128 v[48:51], v0 offset:13056
    ds_read_b128 v[52:55], v0 offset:12032
    ds_read_b128 v[36:39], v0 offset:14080
    v_smfmac_f32_16x16x64_bf16 v[28:31], v[40:43], a[104:111], v1
    v_smfmac_f32_16x16x64_bf16 v[32:35], v[40:43], a[112:119], v1
    s_waitcnt lgkmcnt(2)
    v_smfmac_f32_16x16x64_bf16 v[12:15], v[48:51], v[56:63], v1
    v_smfmac_f32_16x16x64_bf16 v[16:19], v[48:51], v[64:71], v1
    s_waitcnt lgkmcnt(1)
    v_smfmac_f32_16x16x64_bf16 v[12:15], v[52:55], v[136:143], v1
    v_smfmac_f32_16x16x64_bf16 v[16:19], v[52:55], v[144:151], v1
    s_waitcnt lgkmcnt(0)
    v_smfmac_f32_16x16x64_bf16 v[12:15], v[36:39], v[152:159], v1
    v_smfmac_f32_16x16x64_bf16 v[16:19], v[36:39], v[160:167], v1
    s_waitcnt vmcnt(0)
    v_max3_u32 v10, v44, v45, v46
    v_max_u32 v10, v10, v47
    v_cmp_eq_u32 vcc, -1, v10
    s_nop 0
    s_cbranch_vccnz Lr0s_pc_re
Lr0s_pc_ok:
    v_smfmac_f32_16x16x64_bf16 v[12:15], v[44:47], v[168:175], v1
    v_smfmac_f32_16x16x64_bf16 v[16:19], v[44:47], v[176:183], v1
    v_smfmac_f32_16x16x64_bf16 v[20:23], v[48:51], a[24:31], v1
    buffer_load_dwordx4 v[64:67], v0, s[8:11], s42 offen
    v_smfmac_f32_16x16x64_bf16 v[24:27], v[48:51], a[32:39], v1
    v_smfmac_f32_16x16x64_bf16 v[20:23], v[52:55], a[8:15], v1
    v_add_f32 v12, v12, v14
    v_smfmac_f32_16x16x64_bf16 v[24:27], v[52:55], a[16:23], v1
    v_add_f32 v16, v16, v18
    v_smfmac_f32_16x16x64_bf16 v[20:23], v[36:39], a[40:47], v1
    v_add_f32 v13, v13, v15
    buffer_load_dwordx4 v[68:71], v0, s[8:11], s42 offen offset:1024
    v_smfmac_f32_16x16x64_bf16 v[24:27], v[36:39], a[48:55], v1
    v_add_f32 v17, v17, v19
    v_smfmac_f32_16x16x64_bf16 v[20:23], v[44:47], a[56:63], v1
    v_cvt_pk_bf16_f32 v14, v12, v16
    ds_read_b128 v[56:59], v0 offset:15104
    v_smfmac_f32_16x16x64_bf16 v[24:27], v[44:47], a[64:71], v1
    v_cvt_pk_bf16_f32 v15, v13, v17
    ds_read_b128 v[60:63], v0 offset:16128
    ds_write_b32 v2, v14 offset:576
    ds_write_b32 v2, v15 offset:864
    v_smfmac_f32_16x16x64_bf16 v[28:31], v[48:51], a[136:143], v1
    v_smfmac_f32_16x16x64_bf16 v[32:35], v[48:51], a[144:151], v1
    v_add_f32 v20, v20, v22
    v_add_f32 v24, v24, v26
    v_add_f32 v21, v21, v23
    v_add_f32 v25, v25, v27
    v_cvt_pk_bf16_f32 v22, v20, v24
    v_cvt_pk_bf16_f32 v23, v21, v25
    ds_write_b32 v2, v22 offset:0
    ds_write_b32 v2, v23 offset:288
    v_smfmac_f32_16x16x64_bf16 v[28:31], v[52:55], a[120:127], v1
    v_smfmac_f32_16x16x64_bf16 v[32:35], v[52:55], a[128:135], v1
    s_waitcnt lgkmcnt(0)
    s_barrier
    ds_read_b128 v[40:43], v3 offset:0
    ds_read_b128 v[48:51], v3 offset:64
    ds_read_b128 v[20:23], v3 offset:128
    ds_read_b128 v[52:55], v3 offset:192
    v_smfmac_f32_16x16x64_bf16 v[28:31], v[36:39], a[152:159], v1
    v_smfmac_f32_16x16x64_bf16 v[32:35], v[36:39], a[160:167], v1
    ds_read_b128 v[36:39], v0 offset:17152
    v_lshlrev_b32 v9, 3, v0
    buffer_load_dword v11, v9, s[8:11], s68 offen
    v_smfmac_f32_16x16x64_bf16 v[28:31], v[44:47], a[168:175], v1
    v_smfmac_f32_16x16x64_bf16 v[32:35], v[44:47], a[176:183], v1
    ds_read_b128 v[44:47], v0 offset:18176
    s_waitcnt lgkmcnt(5)
    v_mfma_f32_16x16x32_bf16 v[12:15], v[56:59], v[40:43], 0
    v_mfma_f32_16x16x32_bf16 v[16:19], v[60:63], v[40:43], 0
    v_mfma_f32_16x16x32_bf16 v[24:27], v[40:43], v[40:43], 0
    ds_read_b128 v[56:59], v0 offset:19200
    ds_read_b128 v[60:63], v0 offset:20224
    s_waitcnt lgkmcnt(3)
    v_mfma_f32_16x16x32_bf16 v[12:15], v[36:39], v[48:51], v[12:15]
    v_lshrrev_b32 v10, 1, v0
    v_lshrrev_b32 v9, 9, v0
    s_waitcnt lgkmcnt(2)
    v_mfma_f32_16x16x32_bf16 v[16:19], v[44:47], v[48:51], v[16:19]
    v_lshl_add_u32 v9, v9, 5, v10
    v_add_f32 v28, v28, v30
    v_mfma_f32_16x16x32_bf16 v[24:27], v[48:51], v[48:51], v[24:27]
    v_add_f32 v32, v32, v34
    v_add_f32 v29, v29, v31
    ds_read_b128 v[36:39], v0 offset:21248
    ds_read_b128 v[44:47], v0 offset:22272
    s_waitcnt lgkmcnt(3)
    v_mfma_f32_16x16x32_bf16 v[12:15], v[56:59], v[20:23], v[12:15]
    v_add_f32 v33, v33, v35
    v_cvt_pk_bf16_f32 v30, v28, v29
    s_waitcnt lgkmcnt(2)
    v_mfma_f32_16x16x32_bf16 v[16:19], v[60:63], v[20:23], v[16:19]
    v_cvt_pk_bf16_f32 v31, v32, v33
    ds_read_b64 v[34:35], v9 offset:0
    v_mfma_f32_16x16x32_bf16 v[24:27], v[20:23], v[20:23], v[24:27]
    s_add_u32 s17, s43, 2048
    buffer_store_dwordx2 v[30:31], v10, s[8:11], s17 offen sc1
    s_waitcnt lgkmcnt(2)
    v_mfma_f32_16x16x32_bf16 v[12:15], v[36:39], v[52:55], v[12:15]
    s_waitcnt lgkmcnt(1)
    v_mfma_f32_16x16x32_bf16 v[16:19], v[44:47], v[52:55], v[16:19]
    v_mfma_f32_16x16x32_bf16 v[24:27], v[52:55], v[52:55], v[24:27]
    s_add_u32 s17, s43, 0
    s_waitcnt lgkmcnt(0)
    buffer_store_dwordx2 v[34:35], v10, s[8:11], s17 offen sc1
    s_cmp_eq_u32 s33, 63
    s_cbranch_scc1 Lr0s_last
    ds_read_b128 v[56:59], v8 offset:16384
    ds_read_b128 v[60:63], v8 offset:17408
    v_mov_b64 v[20:21], s[52:53]
    v_mov_b64 v[22:23], s[52:53]
    v_mov_b32 v41, 0
    v_mov_b32 v42, 0
    v_max3_f32 v9, v12, v13, v14
    v_max3_f32 v9, v9, v15, v16
    v_max3_f32 v9, v9, v17, v18
    v_max3_f32 v9, v9, v19, v24
    v_max_f32 v9, v9, v25
    v_mov_b32 v10, v9
    v_mov_b64 v[32:33], 0
    v_mov_b64 v[34:35], 0
    v_permlane32_swap_b32 v9, v10
    v_max_f32 v9, v9, v10
    v_mov_b32 v10, v9
    s_nop 1
    v_permlane16_swap_b32 v9, v10
    v_max_f32 v9, v9, v10
    v_mul_f32 v28, s44, v9
    v_fma_f32 v12, v12, s44, -v28
    v_fma_f32 v13, v13, s44, -v28
    v_fma_f32 v14, v14, s44, -v28
    v_fma_f32 v15, v15, s44, -v28
    v_exp_f32 v12, v12
    v_exp_f32 v13, v13
    v_fma_f32 v16, v16, s44, -v28
    v_fma_f32 v17, v17, s44, -v28
    v_exp_f32 v14, v14
    v_exp_f32 v15, v15
    v_cvt_pk_bf16_f32 v36, v12, v13
    v_fma_f32 v18, v18, s44, -v28
    v_fma_f32 v19, v19, s44, -v28
    v_exp_f32 v16, v16
    v_exp_f32 v17, v17
    v_cvt_pk_bf16_f32 v37, v14, v15
    v_fma_f32 v24, v24, s44, -v28
    v_fma_f32 v25, v25, s44, -v28
    v_exp_f32 v18, v18
    v_exp_f32 v19, v19
    v_cvt_pk_bf16_f32 v38, v16, v17
    v_exp_f32 v24, v24
    v_exp_f32 v25, v25
    v_cvt_pk_bf16_f32 v39, v18, v19
    v_cvt_pk_bf16_f32 v40, v24, v25
    v_cvt_pk_bf16_f32 v43, v24, v25
    v_mfma_f32_16x16x32_bf16 v[52:55], v[20:23], v[36:39], 0
    v_mov_b64 v[12:13], 0
    v_mov_b64 v[14:15], 0
    s_waitcnt vmcnt(4)
    v_mfma_f32_16x16x32_bf16 v[44:47], v[64:67], v[36:39], 0
    v_mov_b64 v[24:25], 0
    v_mov_b64 v[26:27], 0
    s_waitcnt vmcnt(3)
    v_mfma_f32_16x16x32_bf16 v[48:51], v[68:71], v[36:39], 0
    ds_read_b128 v[64:67], v8 offset:20480
    ds_read_b128 v[68:71], v8 offset:21504
    v_mfma_f32_16x16x16_bf16 v[52:55], v[20:21], v[40:41], v[52:55]
    v_mfma_f32_16x16x16_bf16 v[44:47], v[30:31], v[40:41], v[44:47]
    v_mov_b64 v[20:21], 0
    v_mov_b64 v[22:23], 0
    v_mfma_f32_16x16x16_bf16 v[48:51], v[30:31], v[42:43], v[48:51]
    v_mov_b64 v[36:37], 0
    v_mov_b64 v[38:39], 0
    v_mov_b64 v[40:41], 0
    v_mov_b64 v[42:43], 0
    v_rcp_f32 v9, v52
    v_mov_b64 v[52:53], 0
    v_mov_b64 v[54:55], 0
    v_mul_f32 v44, v9, v44
    v_mul_f32 v48, v9, v48
    v_cvt_pk_bf16_f32 v16, v44, v48
    v_mul_f32 v45, v9, v45
    v_mul_f32 v49, v9, v49
    v_cvt_pk_bf16_f32 v17, v45, v49
    v_mul_f32 v46, v9, v46
    v_mul_f32 v50, v9, v50
    v_cvt_pk_bf16_f32 v18, v46, v50
    v_mul_f32 v47, v9, v47
    v_mul_f32 v51, v9, v51
    v_cvt_pk_bf16_f32 v19, v47, v51
    ds_write_b128 v5, v[16:19]
    v_mov_b64 v[28:29], 0
    v_mov_b64 v[30:31], 0
    s_waitcnt lgkmcnt(0)
    s_barrier
    ds_read_b128 v[44:47], v4 offset:0
    ds_read_b128 v[48:51], v4 offset:128
    v_mov_b64 v[16:17], 0
    v_mov_b64 v[18:19], 0
    buffer_load_dwordx4 v0, s[8:11], s41 offen offset:0 lds
    buffer_load_dwordx4 v0, s[8:11], s41 offen offset:1024 lds
    s_waitcnt lgkmcnt(1)
    v_smfmac_f32_16x16x64_bf16 v[12:15], v[44:47], a[184:191], v1
    s_waitcnt lgkmcnt(0)
    v_smfmac_f32_16x16x64_bf16 v[12:15], v[48:51], a[192:199], v1
    v_smfmac_f32_16x16x64_bf16 v[24:27], v[44:47], a[200:207], v1
    v_smfmac_f32_16x16x64_bf16 v[24:27], v[48:51], a[208:215], v1
    v_add_f32 v12, v12, v14
    v_smfmac_f32_16x16x64_bf16 v[20:23], v[44:47], a[216:223], v1
    v_add_f32 v13, v13, v15
    v_smfmac_f32_16x16x64_bf16 v[20:23], v[48:51], a[224:231], v1
    v_cvt_pk_bf16_f32 v12, v12, v13
    v_smfmac_f32_16x16x64_bf16 v[16:19], v[44:47], a[232:239], v1
    v_add_f32 v24, v24, v26
    v_smfmac_f32_16x16x64_bf16 v[16:19], v[48:51], a[240:247], v1
    v_add_f32 v25, v25, v27
    v_smfmac_f32_16x16x64_bf16 v[36:39], v[44:47], v[56:63], v1
    v_cvt_pk_bf16_f32 v13, v24, v25
    v_smfmac_f32_16x16x64_bf16 v[36:39], v[48:51], v[64:71], v1
    v_add_f32 v20, v20, v22
    v_add_f32 v21, v21, v23
    v_cvt_pk_bf16_f32 v14, v20, v21
    v_add_f32 v16, v16, v18
    v_add_f32 v17, v17, v19
    v_cvt_pk_bf16_f32 v15, v16, v17
    v_and_or_b32 v15, v15, -2, s40
    buffer_store_dwordx4 v[12:15], v0, s[8:11], s38 offen sc1
    s_nop 0
    ds_read_b128 v[12:15], v8 offset:18432
    ds_read_b128 v[16:19], v8 offset:19456
    ds_read_b128 v[20:23], v8 offset:22528
    ds_read_b128 v[24:27], v8 offset:23552
    ds_read_b128 v[56:59], v8 offset:24576
    ds_read_b128 v[60:63], v8 offset:25600
    ds_read_b128 v[64:67], v8 offset:28672
    ds_read_b128 v[68:71], v8 offset:29696
    s_waitcnt lgkmcnt(6)
    v_smfmac_f32_16x16x64_bf16 v[40:43], v[44:47], v[12:19], v1
    ds_read_b128 v[12:15], v8 offset:26624
    ds_read_b128 v[16:19], v8 offset:27648
    s_waitcnt lgkmcnt(6)
    v_smfmac_f32_16x16x64_bf16 v[40:43], v[48:51], v[20:27], v1
    ds_read_b128 v[20:23], v8 offset:30720
    ds_read_b128 v[24:27], v8 offset:31744
    s_waitcnt lgkmcnt(6)
    v_smfmac_f32_16x16x64_bf16 v[52:55], v[44:47], v[56:63], v1
    ds_read_b128 v[56:59], v8 offset:32768
    ds_read_b128 v[60:63], v8 offset:33792
    s_waitcnt lgkmcnt(6)
    v_smfmac_f32_16x16x64_bf16 v[52:55], v[48:51], v[64:71], v1
    s_waitcnt lgkmcnt(4)
    v_smfmac_f32_16x16x64_bf16 v[32:35], v[44:47], v[12:19], v1
    s_waitcnt lgkmcnt(2)
    v_smfmac_f32_16x16x64_bf16 v[32:35], v[48:51], v[20:27], v1
    v_smfmac_f32_16x16x64_bf16 v[28:31], v[44:47], a[248:255], v1
    s_waitcnt lgkmcnt(0)
    v_smfmac_f32_16x16x64_bf16 v[28:31], v[48:51], v[56:63], v1
    buffer_load_dwordx4 v[12:15], v6, s[8:11], s62 offen sc1
    buffer_load_dwordx4 v[16:19], v6, s[8:11], s63 offen sc1
    buffer_load_dwordx4 v[20:23], v6, s[8:11], s64 offen sc1
    buffer_load_dwordx4 v[24:27], v6, s[8:11], s65 offen sc1
    v_add_f32 v36, v36, v38
    v_add_f32 v37, v37, v39
    v_cvt_pk_bf16_f32 v36, v36, v37
    v_add_f32 v40, v40, v42
    v_add_f32 v41, v41, v43
    v_cvt_pk_bf16_f32 v37, v40, v41
    v_add_f32 v52, v52, v54
    v_add_f32 v53, v53, v55
    v_cvt_pk_bf16_f32 v38, v52, v53
    v_add_f32 v32, v32, v34
    v_add_f32 v33, v33, v35
    v_cvt_pk_bf16_f32 v39, v32, v33
    v_and_or_b32 v39, v39, -2, s40
    s_add_u32 s17, s38, 4096
    buffer_store_dwordx4 v[36:39], v0, s[8:11], s17 offen sc1
    v_add_f32 v28, v28, v30
    v_add_f32 v29, v29, v31
    v_cvt_pk_bf16_f32 v28, v28, v29
    v_and_or_b32 v28, v28, -2, s40
    v_lshrrev_b32 v9, 2, v0
    buffer_store_dword v28, v9, s[8:11], s39 offen sc1
    v_add_u32 v10, 162560, v0
    ds_read_b128 v[64:67], v10
    s_nop 9
    buffer_load_dwordx4 v[40:43], v6, s[8:11], s62 offen sc1
    buffer_load_dwordx4 v[44:47], v6, s[8:11], s63 offen sc1
    buffer_load_dwordx4 v[48:51], v6, s[8:11], s64 offen sc1
    buffer_load_dwordx4 v[52:55], v6, s[8:11], s65 offen sc1
    s_add_u32 s33, s33, 1
    s_add_u32 s42, s42, 262144
    s_add_u32 s41, s41, 262144
    s_add_u32 s43, s43, 131072
    s_add_u32 s68, s68, 262144
    s_add_u32 s66, s66, 22528
    ds_read_b128 v[56:59], v8 offset:0
    ds_read_b128 v[60:63], v8 offset:1024
    s_waitcnt lgkmcnt(2)
    s_waitcnt vmcnt(9)
    v_mfma_f32_16x16x32_bf16 v[68:71], v[12:15], v[64:67], 0
    v_and_b32 v10, 1, v15
    v_cmp_ne_u32 s[54:55], s40, v10
    s_waitcnt vmcnt(8)
    v_mfma_f32_16x16x32_bf16 v[68:71], v[16:19], v[64:67], v[68:71]
    v_and_b32 v10, 1, v19
    v_cmp_ne_u32 s[56:57], s40, v10
    s_waitcnt vmcnt(7)
    v_mfma_f32_16x16x32_bf16 v[68:71], v[20:23], v[64:67], v[68:71]
    v_and_b32 v10, 1, v23
    v_cmp_ne_u32 s[58:59], s40, v10
    s_waitcnt vmcnt(6)
    v_mfma_f32_16x16x32_bf16 v[68:71], v[24:27], v[64:67], v[68:71]
    v_and_b32 v10, 1, v27
    v_cmp_ne_u32 s[60:61], s40, v10
    s_or_b64 vcc, s[54:55], s[56:57]
    s_or_b64 vcc, vcc, s[58:59]
    s_or_b64 vcc, vcc, s[60:61]
    s_cbranch_scc0 Lr0s_red
    s_mov_b32 s16, 0
Lr0s_p1:
    buffer_load_dwordx4 v[12:15], v6, s[8:11], s62 offen sc1
    buffer_load_dwordx4 v[16:19], v6, s[8:11], s63 offen sc1
    buffer_load_dwordx4 v[20:23], v6, s[8:11], s64 offen sc1
    buffer_load_dwordx4 v[24:27], v6, s[8:11], s65 offen sc1
    s_waitcnt vmcnt(7)
    v_mfma_f32_16x16x32_bf16 v[68:71], v[40:43], v[64:67], 0
    v_and_b32 v10, 1, v43
    v_cmp_ne_u32 s[54:55], s40, v10
    s_waitcnt vmcnt(6)
    v_mfma_f32_16x16x32_bf16 v[68:71], v[44:47], v[64:67], v[68:71]
    v_and_b32 v10, 1, v47
    v_cmp_ne_u32 s[56:57], s40, v10
    s_waitcnt vmcnt(5)
    v_mfma_f32_16x16x32_bf16 v[68:71], v[48:51], v[64:67], v[68:71]
    v_and_b32 v10, 1, v51
    v_cmp_ne_u32 s[58:59], s40, v10
    s_waitcnt vmcnt(4)
    v_mfma_f32_16x16x32_bf16 v[68:71], v[52:55], v[64:67], v[68:71]
    v_and_b32 v10, 1, v55
    v_cmp_ne_u32 s[60:61], s40, v10
    s_or_b64 vcc, s[54:55], s[56:57]
    s_or_b64 vcc, vcc, s[58:59]
    s_or_b64 vcc, vcc, s[60:61]
    s_cbranch_scc0 Lr0s_red
    buffer_load_dwordx4 v[40:43], v6, s[8:11], s62 offen sc1
    buffer_load_dwordx4 v[44:47], v6, s[8:11], s63 offen sc1
    buffer_load_dwordx4 v[48:51], v6, s[8:11], s64 offen sc1
    buffer_load_dwordx4 v[52:55], v6, s[8:11], s65 offen sc1
    s_add_u32 s16, s16, 1
    s_cmp_gt_u32 s16, 100000
    s_cbranch_scc1 Lr_abort
    s_waitcnt vmcnt(7)
    v_mfma_f32_16x16x32_bf16 v[68:71], v[12:15], v[64:67], 0
    v_and_b32 v10, 1, v15
    v_cmp_ne_u32 s[54:55], s40, v10
    s_waitcnt vmcnt(6)
    v_mfma_f32_16x16x32_bf16 v[68:71], v[16:19], v[64:67], v[68:71]
    v_and_b32 v10, 1, v19
    v_cmp_ne_u32 s[56:57], s40, v10
    s_waitcnt vmcnt(5)
    v_mfma_f32_16x16x32_bf16 v[68:71], v[20:23], v[64:67], v[68:71]
    v_and_b32 v10, 1, v23
    v_cmp_ne_u32 s[58:59], s40, v10
    s_waitcnt vmcnt(4)
    v_mfma_f32_16x16x32_bf16 v[68:71], v[24:27], v[64:67], v[68:71]
    v_and_b32 v10, 1, v27
    v_cmp_ne_u32 s[60:61], s40, v10
    s_or_b64 vcc, s[54:55], s[56:57]
    s_or_b64 vcc, vcc, s[58:59]
    s_or_b64 vcc, vcc, s[60:61]
    s_cbranch_scc1 Lr0s_p1
Lr0s_red:
    s_nop 1
    v_permlane16_swap_b32 v68, v70
    v_permlane16_swap_b32 v69, v71
    s_mov_b64 exec, s[46:47]
    v_add_f32 v68, v68, v70
    v_add_f32 v69, v69, v71
    v_cvt_pk_bf16_f32 v68, v68, v69
    v_min_u32 v68, s50, v68
    buffer_store_dword v68, v7, s[8:11], s36 offen sc1
    v_mov_b32 v69, -1
    buffer_store_dword v69, v7, s[8:11], s37 offen sc1
    s_mov_b64 exec, -1
    s_xor_b32 s34, s34, 16384
    s_xor_b32 s35, s35, 16384
    s_xor_b32 s40, s40, 1
    s_xor_b32 s36, s36, 16384
    s_xor_b32 s37, s37, 16384
    s_nop 15
    s_nop 3
    buffer_load_dwordx4 v[36:39], v0, s[8:11], s34 offen sc1
    s_waitcnt vmcnt(3)
    ds_read_b128 v[64:67], v8 offset:2048
    ds_read_b128 v[68:71], v8 offset:3072
    v_mov_b64 v[12:13], 0
    v_mov_b64 v[14:15], 0
    v_mov_b64 v[16:17], 0
    v_mov_b64 v[18:19], 0
    v_mov_b64 v[20:21], 0
    v_mov_b64 v[22:23], 0
    v_mov_b64 v[24:25], 0
    v_mov_b64 v[26:27], 0
    v_mov_b64 v[28:29], 0
    v_mov_b64 v[30:31], 0
    v_mov_b64 v[32:33], 0
    v_mov_b64 v[34:35], 0
    s_nop 9
    buffer_load_dwordx4 v[36:39], v0, s[8:11], s34 offen sc1
    s_nop 15
    s_nop 8
    buffer_load_dwordx4 v[36:39], v0, s[8:11], s34 offen sc1
    s_waitcnt lgkmcnt(0)
    s_branch Lr0s_step
Lr0s_pb_re:
    s_mov_b32 s16, 0
Lr0s_pb_lp:
    s_add_u32 s17, s34, 4096
    buffer_load_dwordx4 v[40:43], v0, s[8:11], s17 offen sc1
    s_add_u32 s16, s16, 1
    s_cmp_gt_u32 s16, 100000
    s_cbranch_scc1 Lr_abort
    s_waitcnt vmcnt(0)
    v_max3_u32 v10, v40, v41, v42
    v_max_u32 v10, v10, v43
    v_cmp_eq_u32 vcc, -1, v10
    s_nop 0
    s_cbranch_vccnz Lr0s_pb_lp
    s_branch Lr0s_pb_ok
Lr0s_pc_re:
    s_mov_b32 s16, 0
Lr0s_pc_lp:
    buffer_load_dwordx4 v[44:47], v0, s[8:11], s35 offen sc1
    s_add_u32 s16, s16, 1
    s_cmp_gt_u32 s16, 100000
    s_cbranch_scc1 Lr_abort
    s_waitcnt vmcnt(0)
    v_max3_u32 v10, v44, v45, v46
    v_max_u32 v10, v10, v47
    v_cmp_eq_u32 vcc, -1, v10
    s_nop 0
    s_cbranch_vccnz Lr0s_pc_lp
    s_branch Lr0s_pc_ok
Lr0s_last:
    s_waitcnt vmcnt(0) lgkmcnt(0)
    s_barrier
    s_branch Lr_exit
L_w1_0:
    s_cmp_lg_u32 s14, 1
    s_cbranch_scc1 L_w2_0
    s_mov_b32 s16, 0
    s_add_u32 s17, s66, 128
    v_lshrrev_b32 v10, 2, v0
    v_and_b32 v9, 16, v10
    v_lshlrev_b32 v9, 3, v9
    v_and_or_b32 v10, v10, 12, v9
Lr1s_fw_16:
    buffer_load_dword v9, v10, s[8:11], s17 offen sc1
    s_add_u32 s16, s16, 1
    s_cmp_gt_u32 s16, 100000
    s_cbranch_scc1 Lr_abort
    s_waitcnt vmcnt(0)
    v_cmp_eq_u32 vcc, 0, v9
    s_nop 0
    s_cbranch_vccnz Lr1s_fw_16
    s_lshl_b32 s67, s32, 5
    s_add_u32 s67, s67, s15
    s_lshl_b32 s67, s67, 12
    s_add_u32 s67, s67, 3145728
    s_mov_b32 m0, 17152
    s_nop 0
    buffer_load_dwordx4 v0, s[8:11], s41 offen offset:0 lds
    buffer_load_dwordx4 v0, s[8:11], s41 offen offset:1024 lds
    s_add_u32 s41, s41, 262144
    s_add_u32 s68, s68, 262144
    s_waitcnt vmcnt(0)
    ds_read_b128 v[56:59], v8 offset:4096
    ds_read_b128 v[60:63], v8 offset:5120
    ds_read_b128 v[64:67], v8 offset:6144
    ds_read_b128 v[68:71], v8 offset:7168
    v_mov_b64 v[12:13], 0
    v_mov_b64 v[14:15], 0
    v_mov_b64 v[16:17], 0
    v_mov_b64 v[18:19], 0
    v_mov_b64 v[20:21], 0
    v_mov_b64 v[22:23], 0
    v_mov_b64 v[24:25], 0
    v_mov_b64 v[26:27], 0
    v_mov_b64 v[28:29], 0
    v_mov_b64 v[30:31], 0
    v_mov_b64 v[32:33], 0
    v_mov_b64 v[34:35], 0
    buffer_load_dwordx4 v[36:39], v0, s[8:11], s34 offen sc1
    s_waitcnt vmcnt(0) lgkmcnt(0)
Lr1s_step:
    s_waitcnt vmcnt(3)
    v_max3_u32 v10, v36, v37, v38
    v_max_u32 v10, v10, v39
    v_cmp_eq_u32 vcc, -1, v10
    s_nop 0
    s_cbranch_vccz Lr1s_aok
    buffer_load_dwordx4 v[36:39], v0, s[8:11], s34 offen sc1
    s_nop 15
    s_nop 8
    buffer_load_dwordx4 v[36:39], v0, s[8:11], s34 offen sc1
    s_mov_b32 s16, 0
Lr1s_alp:
    s_waitcnt vmcnt(2)
    v_max3_u32 v10, v36, v37, v38
    v_max_u32 v10, v10, v39
    v_cmp_eq_u32 vcc, -1, v10
    s_nop 0
    s_cbranch_vccz Lr1s_aok
    buffer_load_dwordx4 v[36:39], v0, s[8:11], s34 offen sc1
    s_add_u32 s16, s16, 1
    s_cmp_gt_u32 s16, 100000
    s_cbranch_scc1 Lr_abort
    s_branch Lr1s_alp
Lr1s_aok:
    ds_write_b128 v0, v[36:39] offset:7936
    v_smfmac_f32_16x16x64_bf16 v[12:15], v[36:39], v[88:95], v1
    v_smfmac_f32_16x16x64_bf16 v[16:19], v[36:39], v[96:103], v1
    v_smfmac_f32_16x16x64_bf16 v[20:23], v[36:39], v[200:207], v1
    s_waitcnt lgkmcnt(0)
    s_barrier
    ds_read_b128 v[48:51], v0 offset:8960
    ds_read_b128 v[52:55], v0 offset:9984
    v_smfmac_f32_16x16x64_bf16 v[28:31], v[36:39], a[72:79], v1
    v_smfmac_f32_16x16x64_bf16 v[24:27], v[36:39], v[208:215], v1
    s_add_u32 s17, s34, 4096
    buffer_load_dwordx4 v[40:43], v0, s[8:11], s17 offen sc1
    v_smfmac_f32_16x16x64_bf16 v[32:35], v[36:39], a[80:87], v1
    s_waitcnt vmcnt(1)
    ds_read_b128 v[36:39], v0 offset:6912
    s_waitcnt lgkmcnt(2)
    v_smfmac_f32_16x16x64_bf16 v[28:31], v[48:51], v[56:63], v1
    ds_read_b128 v[56:59], v8 offset:0
    ds_read_b128 v[60:63], v8 offset:1024
    v_smfmac_f32_16x16x64_bf16 v[12:15], v[48:51], v[104:111], v1
    v_smfmac_f32_16x16x64_bf16 v[16:19], v[48:51], v[112:119], v1
    buffer_load_dwordx4 v[44:47], v0, s[8:11], s35 offen sc1
    v_smfmac_f32_16x16x64_bf16 v[32:35], v[48:51], v[64:71], v1
    ds_read_b128 v[64:67], v8 offset:2048
    ds_read_b128 v[68:71], v8 offset:3072
    v_smfmac_f32_16x16x64_bf16 v[20:23], v[48:51], v[216:223], v1
    v_smfmac_f32_16x16x64_bf16 v[24:27], v[48:51], v[224:231], v1
    s_waitcnt lgkmcnt(5)
    v_smfmac_f32_16x16x64_bf16 v[28:31], v[52:55], a[88:95], v1
    v_smfmac_f32_16x16x64_bf16 v[12:15], v[52:55], v[120:127], v1
    v_smfmac_f32_16x16x64_bf16 v[16:19], v[52:55], v[128:135], v1
    v_smfmac_f32_16x16x64_bf16 v[32:35], v[52:55], a[96:103], v1
    v_smfmac_f32_16x16x64_bf16 v[20:23], v[52:55], v[232:239], v1
    v_smfmac_f32_16x16x64_bf16 v[24:27], v[52:55], v[240:247], v1
    s_waitcnt lgkmcnt(2)
    v_smfmac_f32_16x16x64_bf16 v[28:31], v[36:39], v[56:63], v1
    ds_read_b128 v[56:59], v8 offset:12288
    ds_read_b128 v[60:63], v8 offset:13312
    v_smfmac_f32_16x16x64_bf16 v[12:15], v[36:39], v[72:79], v1
    v_smfmac_f32_16x16x64_bf16 v[16:19], v[36:39], v[80:87], v1
    s_waitcnt lgkmcnt(2)
    v_smfmac_f32_16x16x64_bf16 v[32:35], v[36:39], v[64:71], v1
    ds_read_b128 v[64:67], v8 offset:14336
    ds_read_b128 v[68:71], v8 offset:15360
    v_smfmac_f32_16x16x64_bf16 v[20:23], v[36:39], v[184:191], v1
    v_smfmac_f32_16x16x64_bf16 v[24:27], v[36:39], v[192:199], v1
    s_waitcnt vmcnt(1)
    v_max3_u32 v10, v40, v41, v42
    v_max_u32 v10, v10, v43
    v_cmp_eq_u32 vcc, -1, v10
    s_nop 0
    s_cbranch_vccnz Lr1s_pb_re
Lr1s_pb_ok:
    ds_write_b128 v0, v[40:43] offset:12032
    v_mov_b32 v9, 1
    v_mov_b32 v10, 0
    s_mov_b64 exec, 1
    buffer_store_dword v9, v10, s[8:11], s67 offen offset:384 sc1
    s_mov_b64 exec, -1
    v_smfmac_f32_16x16x64_bf16 v[12:15], v[40:43], v[136:143], v1
    v_smfmac_f32_16x16x64_bf16 v[20:23], v[40:43], a[8:15], v1
    v_smfmac_f32_16x16x64_bf16 v[16:19], v[40:43], v[144:151], v1
    v_smfmac_f32_16x16x64_bf16 v[24:27], v[40:43], a[16:23], v1
    s_waitcnt lgkmcnt(0)
    s_barrier
    ds_read_b128 v[48:51], v0 offset:13056
    ds_read_b128 v[52:55], v0 offset:14080
    ds_read_b128 v[36:39], v0 offset:11008
    v_smfmac_f32_16x16x64_bf16 v[28:31], v[40:43], a[120:127], v1
    v_smfmac_f32_16x16x64_bf16 v[32:35], v[40:43], a[128:135], v1
    s_waitcnt lgkmcnt(2)
    v_smfmac_f32_16x16x64_bf16 v[12:15], v[48:51], v[56:63], v1
    ds_read_b128 v[56:59], v8 offset:8192
    ds_read_b128 v[60:63], v8 offset:9216
    v_smfmac_f32_16x16x64_bf16 v[16:19], v[48:51], v[64:71], v1
    ds_read_b128 v[64:67], v8 offset:10240
    ds_read_b128 v[68:71], v8 offset:11264
    s_waitcnt lgkmcnt(5)
    v_smfmac_f32_16x16x64_bf16 v[12:15], v[52:55], v[152:159], v1
    v_smfmac_f32_16x16x64_bf16 v[16:19], v[52:55], v[160:167], v1
    s_waitcnt vmcnt(1)
    v_max3_u32 v10, v44, v45, v46
    v_max_u32 v10, v10, v47
    v_cmp_eq_u32 vcc, -1, v10
    s_nop 0
    s_cbranch_vccnz Lr1s_pc_re
Lr1s_pc_ok:
    v_smfmac_f32_16x16x64_bf16 v[12:15], v[44:47], v[168:175], v1
    v_smfmac_f32_16x16x64_bf16 v[16:19], v[44:47], v[176:183], v1
    s_waitcnt lgkmcnt(2)
    v_smfmac_f32_16x16x64_bf16 v[12:15], v[36:39], v[56:63], v1
    s_waitcnt lgkmcnt(0)
    v_smfmac_f32_16x16x64_bf16 v[16:19], v[36:39], v[64:71], v1
    v_smfmac_f32_16x16x64_bf16 v[20:23], v[48:51], a[24:31], v1
    v_smfmac_f32_16x16x64_bf16 v[24:27], v[48:51], a[32:39], v1
    buffer_load_dwordx4 v[64:67], v0, s[8:11], s42 offen
    v_smfmac_f32_16x16x64_bf16 v[20:23], v[52:55], a[40:47], v1
    v_add_f32 v12, v12, v14
    v_smfmac_f32_16x16x64_bf16 v[24:27], v[52:55], a[48:55], v1
    v_add_f32 v16, v16, v18
    v_smfmac_f32_16x16x64_bf16 v[20:23], v[36:39], v[248:255], v1
    v_add_f32 v13, v13, v15
    v_smfmac_f32_16x16x64_bf16 v[24:27], v[36:39], a[0:7], v1
    v_add_f32 v17, v17, v19
    buffer_load_dwordx4 v[68:71], v0, s[8:11], s42 offen offset:1024
    v_smfmac_f32_16x16x64_bf16 v[20:23], v[44:47], a[56:63], v1
    v_cvt_pk_bf16_f32 v14, v12, v16
    ds_read_b128 v[56:59], v0 offset:15104
    v_smfmac_f32_16x16x64_bf16 v[24:27], v[44:47], a[64:71], v1
    v_cvt_pk_bf16_f32 v15, v13, v17
    ds_read_b128 v[60:63], v0 offset:16128
    ds_write_b32 v2, v14 offset:576
    ds_write_b32 v2, v15 offset:864
    v_smfmac_f32_16x16x64_bf16 v[28:31], v[48:51], a[136:143], v1
    v_smfmac_f32_16x16x64_bf16 v[32:35], v[48:51], a[144:151], v1
    v_add_f32 v20, v20, v22
    v_add_f32 v24, v24, v26
    v_add_f32 v21, v21, v23
    v_add_f32 v25, v25, v27
    v_cvt_pk_bf16_f32 v22, v20, v24
    v_cvt_pk_bf16_f32 v23, v21, v25
    ds_write_b32 v2, v22 offset:0
    ds_write_b32 v2, v23 offset:288
    v_smfmac_f32_16x16x64_bf16 v[28:31], v[52:55], a[152:159], v1
    v_smfmac_f32_16x16x64_bf16 v[32:35], v[52:55], a[160:167], v1
    s_waitcnt lgkmcnt(0)
    s_barrier
    ds_read_b128 v[40:43], v3 offset:0
    ds_read_b128 v[48:51], v3 offset:64
    ds_read_b128 v[20:23], v3 offset:128
    ds_read_b128 v[52:55], v3 offset:192
    v_smfmac_f32_16x16x64_bf16 v[28:31], v[36:39], a[104:111], v1
    v_smfmac_f32_16x16x64_bf16 v[32:35], v[36:39], a[112:119], v1
    ds_read_b128 v[36:39], v0 offset:17152
    v_smfmac_f32_16x16x64_bf16 v[28:31], v[44:47], a[168:175], v1
    v_smfmac_f32_16x16x64_bf16 v[32:35], v[44:47], a[176:183], v1
    ds_read_b128 v[44:47], v0 offset:18176
    s_waitcnt lgkmcnt(5)
    v_mfma_f32_16x16x32_bf16 v[12:15], v[56:59], v[40:43], 0
    v_mfma_f32_16x16x32_bf16 v[16:19], v[60:63], v[40:43], 0
    v_mfma_f32_16x16x32_bf16 v[24:27], v[40:43], v[40:43], 0
    ds_read_b128 v[56:59], v0 offset:19200
    ds_read_b128 v[60:63], v0 offset:20224
    s_waitcnt lgkmcnt(3)
    v_mfma_f32_16x16x32_bf16 v[12:15], v[36:39], v[48:51], v[12:15]
    v_lshrrev_b32 v10, 1, v0
    v_lshrrev_b32 v9, 9, v0
    s_waitcnt lgkmcnt(2)
    v_mfma_f32_16x16x32_bf16 v[16:19], v[44:47], v[48:51], v[16:19]
    v_lshl_add_u32 v9, v9, 5, v10
    v_add_f32 v28, v28, v30
    v_mfma_f32_16x16x32_bf16 v[24:27], v[48:51], v[48:51], v[24:27]
    v_add_f32 v32, v32, v34
    v_add_f32 v29, v29, v31
    ds_read_b128 v[36:39], v0 offset:21248
    ds_read_b128 v[44:47], v0 offset:22272
    s_waitcnt lgkmcnt(3)
    v_mfma_f32_16x16x32_bf16 v[12:15], v[56:59], v[20:23], v[12:15]
    v_add_f32 v33, v33, v35
    v_cvt_pk_bf16_f32 v30, v28, v29
    s_waitcnt lgkmcnt(2)
    v_mfma_f32_16x16x32_bf16 v[16:19], v[60:63], v[20:23], v[16:19]
    v_cvt_pk_bf16_f32 v31, v32, v33
    ds_read_b64 v[34:35], v9 offset:1152
    v_mfma_f32_16x16x32_bf16 v[24:27], v[20:23], v[20:23], v[24:27]
    s_add_u32 s17, s43, 2560
    buffer_store_dwordx2 v[30:31], v10, s[8:11], s17 offen sc1
    s_waitcnt lgkmcnt(2)
    v_mfma_f32_16x16x32_bf16 v[12:15], v[36:39], v[52:55], v[12:15]
    s_waitcnt lgkmcnt(1)
    v_mfma_f32_16x16x32_bf16 v[16:19], v[44:47], v[52:55], v[16:19]
    v_mfma_f32_16x16x32_bf16 v[24:27], v[52:55], v[52:55], v[24:27]
    s_add_u32 s17, s43, 512
    s_waitcnt lgkmcnt(0)
    buffer_store_dwordx2 v[34:35], v10, s[8:11], s17 offen sc1
    s_cmp_eq_u32 s33, 63
    s_cbranch_scc1 Lr1s_last
    ds_read_b128 v[56:59], v8 offset:16384
    ds_read_b128 v[60:63], v8 offset:17408
    v_mov_b64 v[20:21], s[52:53]
    v_mov_b64 v[22:23], s[52:53]
    v_mov_b32 v41, 0
    v_mov_b32 v42, 0
    v_max3_f32 v9, v12, v13, v14
    v_max3_f32 v9, v9, v15, v16
    v_max3_f32 v9, v9, v17, v18
    v_max3_f32 v9, v9, v19, v24
    v_max_f32 v9, v9, v25
    v_mov_b32 v10, v9
    v_mov_b64 v[32:33], 0
    v_mov_b64 v[34:35], 0
    v_permlane32_swap_b32 v9, v10
    v_max_f32 v9, v9, v10
    v_mov_b32 v10, v9
    s_nop 1
    v_permlane16_swap_b32 v9, v10
    v_max_f32 v9, v9, v10
    v_mul_f32 v28, s44, v9
    v_fma_f32 v12, v12, s44, -v28
    v_fma_f32 v13, v13, s44, -v28
    v_fma_f32 v14, v14, s44, -v28
    v_fma_f32 v15, v15, s44, -v28
    v_exp_f32 v12, v12
    v_exp_f32 v13, v13
    v_fma_f32 v16, v16, s44, -v28
    v_fma_f32 v17, v17, s44, -v28
    v_exp_f32 v14, v14
    v_exp_f32 v15, v15
    v_cvt_pk_bf16_f32 v36, v12, v13
    v_fma_f32 v18, v18, s44, -v28
    v_fma_f32 v19, v19, s44, -v28
    v_exp_f32 v16, v16
    v_exp_f32 v17, v17
    v_cvt_pk_bf16_f32 v37, v14, v15
    v_fma_f32 v24, v24, s44, -v28
    v_fma_f32 v25, v25, s44, -v28
    v_exp_f32 v18, v18
    v_exp_f32 v19, v19
    v_cvt_pk_bf16_f32 v38, v16, v17
    v_exp_f32 v24, v24
    v_exp_f32 v25, v25
    v_cvt_pk_bf16_f32 v39, v18, v19
    v_cvt_pk_bf16_f32 v40, v24, v25
    v_cvt_pk_bf16_f32 v43, v24, v25
    v_mfma_f32_16x16x32_bf16 v[52:55], v[20:23], v[36:39], 0
    v_mov_b64 v[12:13], 0
    v_mov_b64 v[14:15], 0
    s_waitcnt vmcnt(3)
    v_mfma_f32_16x16x32_bf16 v[44:47], v[64:67], v[36:39], 0
    v_mov_b64 v[24:25], 0
    v_mov_b64 v[26:27], 0
    s_waitcnt vmcnt(2)
    v_mfma_f32_16x16x32_bf16 v[48:51], v[68:71], v[36:39], 0
    ds_read_b128 v[64:67], v8 offset:20480
    ds_read_b128 v[68:71], v8 offset:21504
    v_mfma_f32_16x16x16_bf16 v[52:55], v[20:21], v[40:41], v[52:55]
    v_mfma_f32_16x16x16_bf16 v[44:47], v[30:31], v[40:41], v[44:47]
    v_mov_b64 v[20:21], 0
    v_mov_b64 v[22:23], 0
    v_mfma_f32_16x16x16_bf16 v[48:51], v[30:31], v[42:43], v[48:51]
    v_mov_b64 v[36:37], 0
    v_mov_b64 v[38:39], 0
    v_mov_b64 v[40:41], 0
    v_mov_b64 v[42:43], 0
    v_rcp_f32 v9, v52
    v_mov_b64 v[52:53], 0
    v_mov_b64 v[54:55], 0
    v_mul_f32 v44, v9, v44
    v_mul_f32 v48, v9, v48
    v_cvt_pk_bf16_f32 v16, v44, v48
    v_mul_f32 v45, v9, v45
    v_mul_f32 v49, v9, v49
    v_cvt_pk_bf16_f32 v17, v45, v49
    v_mul_f32 v46, v9, v46
    v_mul_f32 v50, v9, v50
    v_cvt_pk_bf16_f32 v18, v46, v50
    v_mul_f32 v47, v9, v47
    v_mul_f32 v51, v9, v51
    v_cvt_pk_bf16_f32 v19, v47, v51
    ds_write_b128 v5, v[16:19]
    v_mov_b64 v[28:29], 0
    v_mov_b64 v[30:31], 0
    s_waitcnt lgkmcnt(0)
    s_barrier
    ds_read_b128 v[44:47], v4 offset:0
    ds_read_b128 v[48:51], v4 offset:128
    v_mov_b64 v[16:17], 0
    v_mov_b64 v[18:19], 0
    buffer_load_dwordx4 v0, s[8:11], s41 offen offset:0 lds
    buffer_load_dwordx4 v0, s[8:11], s41 offen offset:1024 lds
    s_waitcnt lgkmcnt(1)
    v_smfmac_f32_16x16x64_bf16 v[12:15], v[44:47], a[184:191], v1
    s_waitcnt lgkmcnt(0)
    v_smfmac_f32_16x16x64_bf16 v[12:15], v[48:51], a[192:199], v1
    v_smfmac_f32_16x16x64_bf16 v[24:27], v[44:47], a[200:207], v1
    v_smfmac_f32_16x16x64_bf16 v[24:27], v[48:51], a[208:215], v1
    v_add_f32 v12, v12, v14
    v_smfmac_f32_16x16x64_bf16 v[20:23], v[44:47], a[216:223], v1
    v_add_f32 v13, v13, v15
    v_smfmac_f32_16x16x64_bf16 v[20:23], v[48:51], a[224:231], v1
    v_cvt_pk_bf16_f32 v12, v12, v13
    v_smfmac_f32_16x16x64_bf16 v[16:19], v[44:47], a[232:239], v1
    v_add_f32 v24, v24, v26
    v_smfmac_f32_16x16x64_bf16 v[16:19], v[48:51], a[240:247], v1
    v_add_f32 v25, v25, v27
    v_smfmac_f32_16x16x64_bf16 v[36:39], v[44:47], v[56:63], v1
    v_cvt_pk_bf16_f32 v13, v24, v25
    v_smfmac_f32_16x16x64_bf16 v[36:39], v[48:51], v[64:71], v1
    v_add_f32 v20, v20, v22
    v_add_f32 v21, v21, v23
    v_cvt_pk_bf16_f32 v14, v20, v21
    v_add_f32 v16, v16, v18
    v_add_f32 v17, v17, v19
    v_cvt_pk_bf16_f32 v15, v16, v17
    v_and_or_b32 v15, v15, -2, s40
    buffer_store_dwordx4 v[12:15], v0, s[8:11], s38 offen sc1
    s_nop 0
    ds_read_b128 v[12:15], v8 offset:18432
    ds_read_b128 v[16:19], v8 offset:19456
    ds_read_b128 v[20:23], v8 offset:22528
    ds_read_b128 v[24:27], v8 offset:23552
    ds_read_b128 v[56:59], v8 offset:24576
    ds_read_b128 v[60:63], v8 offset:25600
    ds_read_b128 v[64:67], v8 offset:28672
    ds_read_b128 v[68:71], v8 offset:29696
    s_waitcnt lgkmcnt(6)
    v_smfmac_f32_16x16x64_bf16 v[40:43], v[44:47], v[12:19], v1
    ds_read_b128 v[12:15], v8 offset:26624
    ds_read_b128 v[16:19], v8 offset:27648
    s_waitcnt lgkmcnt(6)
    v_smfmac_f32_16x16x64_bf16 v[40:43], v[48:51], v[20:27], v1
    ds_read_b128 v[20:23], v8 offset:30720
    ds_read_b128 v[24:27], v8 offset:31744
    s_waitcnt lgkmcnt(6)
    v_smfmac_f32_16x16x64_bf16 v[52:55], v[44:47], v[56:63], v1
    ds_read_b128 v[56:59], v8 offset:32768
    ds_read_b128 v[60:63], v8 offset:33792
    s_waitcnt lgkmcnt(6)
    v_smfmac_f32_16x16x64_bf16 v[52:55], v[48:51], v[64:71], v1
    s_waitcnt lgkmcnt(4)
    v_smfmac_f32_16x16x64_bf16 v[32:35], v[44:47], v[12:19], v1
    s_waitcnt lgkmcnt(2)
    v_smfmac_f32_16x16x64_bf16 v[32:35], v[48:51], v[20:27], v1
    v_smfmac_f32_16x16x64_bf16 v[28:31], v[44:47], a[248:255], v1
    s_waitcnt lgkmcnt(0)
    v_smfmac_f32_16x16x64_bf16 v[28:31], v[48:51], v[56:63], v1
    v_add_f32 v36, v36, v38
    v_add_f32 v37, v37, v39
    v_cvt_pk_bf16_f32 v36, v36, v37
    v_add_f32 v40, v40, v42
    v_add_f32 v41, v41, v43
    v_cvt_pk_bf16_f32 v37, v40, v41
    v_add_f32 v52, v52, v54
    v_add_f32 v53, v53, v55
    v_cvt_pk_bf16_f32 v38, v52, v53
    v_add_f32 v32, v32, v34
    v_add_f32 v33, v33, v35
    v_cvt_pk_bf16_f32 v39, v32, v33
    v_and_or_b32 v39, v39, -2, s40
    s_add_u32 s17, s38, 4096
    buffer_store_dwordx4 v[36:39], v0, s[8:11], s17 offen sc1
    v_add_f32 v28, v28, v30
    v_add_f32 v29, v29, v31
    v_cvt_pk_bf16_f32 v28, v28, v29
    v_and_or_b32 v28, v28, -2, s40
    v_lshrrev_b32 v9, 2, v0
    buffer_store_dword v28, v9, s[8:11], s39 offen sc1
    v_add_u32 v10, 162560, v0
    ds_read_b128 v[64:67], v10
    s_add_u32 s33, s33, 1
    s_add_u32 s42, s42, 262144
    s_add_u32 s41, s41, 262144
    s_add_u32 s43, s43, 131072
    s_mov_b32 s67, s66
    s_add_u32 s68, s68, 262144
    s_add_u32 s66, s66, 22528
    ds_read_b128 v[56:59], v8 offset:4096
    ds_read_b128 v[60:63], v8 offset:5120
    v_mov_b64 v[12:13], 0
    v_mov_b64 v[14:15], 0
    v_mov_b64 v[16:17], 0
    v_mov_b64 v[18:19], 0
    v_mov_b64 v[20:21], 0
    v_mov_b64 v[22:23], 0
    v_mov_b64 v[24:25], 0
    v_mov_b64 v[26:27], 0
    v_mov_b64 v[28:29], 0
    v_mov_b64 v[30:31], 0
    v_mov_b64 v[32:33], 0
    v_mov_b64 v[34:35], 0
    s_nop 15
    s_nop 15
    s_nop 15
    s_nop 11
    buffer_load_dwordx4 v[40:43], v6, s[8:11], s62 offen sc1
    buffer_load_dwordx4 v[44:47], v6, s[8:11], s63 offen sc1
    buffer_load_dwordx4 v[48:51], v6, s[8:11], s64 offen sc1
    buffer_load_dwordx4 v[52:55], v6, s[8:11], s65 offen sc1
    s_waitcnt lgkmcnt(0)
    s_waitcnt vmcnt(3)
    v_mfma_f32_16x16x32_bf16 v[68:71], v[40:43], v[64:67], 0
    v_and_b32 v10, 1, v43
    v_cmp_ne_u32 s[54:55], s40, v10
    s_waitcnt vmcnt(2)
    v_mfma_f32_16x16x32_bf16 v[68:71], v[44:47], v[64:67], v[68:71]
    v_and_b32 v10, 1, v47
    v_cmp_ne_u32 s[56:57], s40, v10
    s_waitcnt vmcnt(1)
    v_mfma_f32_16x16x32_bf16 v[68:71], v[48:51], v[64:67], v[68:71]
    v_and_b32 v10, 1, v51
    v_cmp_ne_u32 s[58:59], s40, v10
    s_waitcnt vmcnt(0)
    v_mfma_f32_16x16x32_bf16 v[68:71], v[52:55], v[64:67], v[68:71]
    v_and_b32 v10, 1, v55
    v_cmp_ne_u32 s[60:61], s40, v10
    s_or_b64 vcc, s[54:55], s[56:57]
    s_or_b64 vcc, vcc, s[58:59]
    s_or_b64 vcc, vcc, s[60:61]
    s_cbranch_scc0 Lr1s_red
    s_mov_b32 s16, 0
Lr1s_p1:
    s_mov_b64 exec, s[54:55]
    buffer_load_dwordx4 v[40:43], v6, s[8:11], s62 offen sc1
    s_mov_b64 exec, s[56:57]
    buffer_load_dwordx4 v[44:47], v6, s[8:11], s63 offen sc1
    s_mov_b64 exec, s[58:59]
    buffer_load_dwordx4 v[48:51], v6, s[8:11], s64 offen sc1
    s_mov_b64 exec, s[60:61]
    buffer_load_dwordx4 v[52:55], v6, s[8:11], s65 offen sc1
    s_mov_b64 exec, -1
    s_add_u32 s16, s16, 1
    s_cmp_gt_u32 s16, 100000
    s_cbranch_scc1 Lr_abort
    s_waitcnt vmcnt(3)
    v_mfma_f32_16x16x32_bf16 v[68:71], v[40:43], v[64:67], 0
    v_and_b32 v10, 1, v43
    v_cmp_ne_u32 s[54:55], s40, v10
    s_waitcnt vmcnt(2)
    v_mfma_f32_16x16x32_bf16 v[68:71], v[44:47], v[64:67], v[68:71]
    v_and_b32 v10, 1, v47
    v_cmp_ne_u32 s[56:57], s40, v10
    s_waitcnt vmcnt(1)
    v_mfma_f32_16x16x32_bf16 v[68:71], v[48:51], v[64:67], v[68:71]
    v_and_b32 v10, 1, v51
    v_cmp_ne_u32 s[58:59], s40, v10
    s_waitcnt vmcnt(0)
    v_mfma_f32_16x16x32_bf16 v[68:71], v[52:55], v[64:67], v[68:71]
    v_and_b32 v10, 1, v55
    v_cmp_ne_u32 s[60:61], s40, v10
    s_or_b64 vcc, s[54:55], s[56:57]
    s_or_b64 vcc, vcc, s[58:59]
    s_or_b64 vcc, vcc, s[60:61]
    s_cbranch_scc1 Lr1s_p1
Lr1s_red:
    s_xor_b32 s34, s34, 16384
    s_xor_b32 s35, s35, 16384
    buffer_load_dwordx4 v[36:39], v0, s[8:11], s34 offen sc1
    v_permlane16_swap_b32 v68, v70
    v_permlane16_swap_b32 v69, v71
    s_mov_b64 exec, s[46:47]
    v_add_f32 v68, v68, v70
    v_add_f32 v69, v69, v71
    v_cvt_pk_bf16_f32 v68, v68, v69
    v_min_u32 v68, s50, v68
    buffer_store_dword v68, v7, s[8:11], s36 offen sc1
    v_mov_b32 v69, -1
    buffer_store_dword v69, v7, s[8:11], s37 offen sc1
    s_mov_b64 exec, -1
    buffer_load_dwordx4 v[36:39], v0, s[8:11], s34 offen sc1
    s_xor_b32 s40, s40, 1
    s_xor_b32 s36, s36, 16384
    s_xor_b32 s37, s37, 16384
    ds_read_b128 v[64:67], v8 offset:6144
    ds_read_b128 v[68:71], v8 offset:7168
    s_waitcnt lgkmcnt(0)
    s_branch Lr1s_step
Lr1s_pb_re:
    s_mov_b32 s16, 0
Lr1s_pb_lp:
    s_add_u32 s17, s34, 4096
    buffer_load_dwordx4 v[40:43], v0, s[8:11], s17 offen sc1
    s_add_u32 s16, s16, 1
    s_cmp_gt_u32 s16, 100000
    s_cbranch_scc1 Lr_abort
    s_waitcnt vmcnt(0)
    v_max3_u32 v10, v40, v41, v42
    v_max_u32 v10, v10, v43
    v_cmp_eq_u32 vcc, -1, v10
    s_nop 0
    s_cbranch_vccnz Lr1s_pb_lp
    s_branch Lr1s_pb_ok
Lr1s_pc_re:
    s_mov_b32 s16, 0
Lr1s_pc_lp:
    buffer_load_dwordx4 v[44:47], v0, s[8:11], s35 offen sc1
    s_add_u32 s16, s16, 1
    s_cmp_gt_u32 s16, 100000
    s_cbranch_scc1 Lr_abort
    s_waitcnt vmcnt(0)
    v_max3_u32 v10, v44, v45, v46
    v_max_u32 v10, v10, v47
    v_cmp_eq_u32 vcc, -1, v10
    s_nop 0
    s_cbranch_vccnz Lr1s_pc_lp
    s_branch Lr1s_pc_ok
Lr1s_last:
    s_waitcnt vmcnt(0) lgkmcnt(0)
    s_barrier
    s_mov_b32 s67, s66
    v_mov_b32 v9, 1
    v_mov_b32 v10, 0
    s_mov_b64 exec, 1
    buffer_store_dword v9, v10, s[8:11], s67 offen offset:384 sc1
    s_mov_b64 exec, -1
    s_branch Lr_exit
L_w2_0:
    s_cmp_lg_u32 s14, 2
    s_cbranch_scc1 L_w3_0
    s_mov_b32 s16, 0
    s_add_u32 s17, s66, 128
    v_lshrrev_b32 v10, 2, v0
    v_and_b32 v9, 16, v10
    v_lshlrev_b32 v9, 3, v9
    v_and_or_b32 v10, v10, 12, v9
Lr2s_fw_17:
    buffer_load_dword v9, v10, s[8:11], s17 offen sc1
    s_add_u32 s16, s16, 1
    s_cmp_gt_u32 s16, 100000
    s_cbranch_scc1 Lr_abort
    s_waitcnt vmcnt(0)
    v_cmp_eq_u32 vcc, 0, v9
    s_nop 0
    s_cbranch_vccnz Lr2s_fw_17
    s_mov_b32 m0, 19200
    s_nop 0
    buffer_load_dwordx4 v0, s[8:11], s41 offen offset:0 lds
    buffer_load_dwordx4 v0, s[8:11], s41 offen offset:1024 lds
    s_add_u32 s41, s41, 262144
    s_add_u32 s68, s68, 262144
    s_waitcnt vmcnt(0)
    ds_read_b128 v[56:59], v8 offset:4096
    ds_read_b128 v[60:63], v8 offset:5120
    ds_read_b128 v[64:67], v8 offset:6144
    ds_read_b128 v[68:71], v8 offset:7168
    v_mov_b64 v[12:13], 0
    v_mov_b64 v[14:15], 0
    v_mov_b64 v[16:17], 0
    v_mov_b64 v[18:19], 0
    v_mov_b64 v[20:21], 0
    v_mov_b64 v[22:23], 0
    v_mov_b64 v[24:25], 0
    v_mov_b64 v[26:27], 0
    v_mov_b64 v[28:29], 0
    v_mov_b64 v[30:31], 0
    v_mov_b64 v[32:33], 0
    v_mov_b64 v[34:35], 0
    buffer_load_dwordx4 v[36:39], v0, s[8:11], s34 offen sc1
    s_waitcnt vmcnt(0) lgkmcnt(0)
Lr2s_step:
    s_waitcnt vmcnt(3)
    v_max3_u32 v10, v36, v37, v38
    v_max_u32 v10, v10, v39
    v_cmp_eq_u32 vcc, -1, v10
    s_nop 0
    s_cbranch_vccz Lr2s_aok
    buffer_load_dwordx4 v[36:39], v0, s[8:11], s34 offen sc1
    s_nop 15
    s_nop 8
    buffer_load_dwordx4 v[36:39], v0, s[8:11], s34 offen sc1
    s_mov_b32 s16, 0
Lr2s_alp:
    s_waitcnt vmcnt(2)
    v_max3_u32 v10, v36, v37, v38
    v_max_u32 v10, v10, v39
    v_cmp_eq_u32 vcc, -1, v10
    s_nop 0
    s_cbranch_vccz Lr2s_aok
    buffer_load_dwordx4 v[36:39], v0, s[8:11], s34 offen sc1
    s_add_u32 s16, s16, 1
    s_cmp_gt_u32 s16, 100000
    s_cbranch_scc1 Lr_abort
    s_branch Lr2s_alp
Lr2s_aok:
    ds_write_b128 v0, v[36:39] offset:8960
    v_smfmac_f32_16x16x64_bf16 v[12:15], v[36:39], v[104:111], v1
    v_smfmac_f32_16x16x64_bf16 v[16:19], v[36:39], v[112:119], v1
    v_smfmac_f32_16x16x64_bf16 v[20:23], v[36:39], v[216:223], v1
    s_waitcnt lgkmcnt(0)
    s_barrier
    ds_read_b128 v[48:51], v0 offset:9984
    ds_read_b128 v[52:55], v0 offset:6912
    v_smfmac_f32_16x16x64_bf16 v[28:31], v[36:39], v[56:63], v1
    ds_read_b128 v[56:59], v8 offset:0
    ds_read_b128 v[60:63], v8 offset:1024
    v_smfmac_f32_16x16x64_bf16 v[24:27], v[36:39], v[224:231], v1
    v_smfmac_f32_16x16x64_bf16 v[32:35], v[36:39], v[64:71], v1
    ds_read_b128 v[64:67], v8 offset:2048
    ds_read_b128 v[68:71], v8 offset:3072
    s_add_u32 s17, s34, 4096
    buffer_load_dwordx4 v[40:43], v0, s[8:11], s17 offen sc1
    s_waitcnt vmcnt(1)
    ds_read_b128 v[36:39], v0 offset:7936
    s_waitcnt lgkmcnt(6)
    v_smfmac_f32_16x16x64_bf16 v[28:31], v[48:51], a[88:95], v1
    v_smfmac_f32_16x16x64_bf16 v[12:15], v[48:51], v[120:127], v1
    v_smfmac_f32_16x16x64_bf16 v[16:19], v[48:51], v[128:135], v1
    v_smfmac_f32_16x16x64_bf16 v[32:35], v[48:51], a[96:103], v1
    buffer_load_dwordx4 v[44:47], v0, s[8:11], s35 offen sc1
    v_smfmac_f32_16x16x64_bf16 v[20:23], v[48:51], v[232:239], v1
    v_lshrrev_b32 v10, 2, v0
    v_and_b32 v9, 16, v10
    v_lshlrev_b32 v9, 3, v9
    v_and_or_b32 v10, v10, 12, v9
    s_add_u32 s17, s66, 22656
    v_mov_b32 v11, 2
    buffer_load_dword v11, v10, s[8:11], s17 offen sc1
    v_smfmac_f32_16x16x64_bf16 v[24:27], v[48:51], v[240:247], v1
    s_waitcnt lgkmcnt(3)
    v_smfmac_f32_16x16x64_bf16 v[28:31], v[52:55], v[56:63], v1
    ds_read_b128 v[56:59], v8 offset:12288
    ds_read_b128 v[60:63], v8 offset:13312
    v_smfmac_f32_16x16x64_bf16 v[12:15], v[52:55], v[72:79], v1
    v_smfmac_f32_16x16x64_bf16 v[16:19], v[52:55], v[80:87], v1
    s_waitcnt lgkmcnt(3)
    v_smfmac_f32_16x16x64_bf16 v[32:35], v[52:55], v[64:71], v1
    ds_read_b128 v[64:67], v8 offset:14336
    ds_read_b128 v[68:71], v8 offset:15360
    v_smfmac_f32_16x16x64_bf16 v[20:23], v[52:55], v[184:191], v1
    v_smfmac_f32_16x16x64_bf16 v[24:27], v[52:55], v[192:199], v1
    s_waitcnt lgkmcnt(4)
    v_smfmac_f32_16x16x64_bf16 v[28:31], v[36:39], a[72:79], v1
    v_smfmac_f32_16x16x64_bf16 v[12:15], v[36:39], v[88:95], v1
    v_smfmac_f32_16x16x64_bf16 v[16:19], v[36:39], v[96:103], v1
    v_smfmac_f32_16x16x64_bf16 v[32:35], v[36:39], a[80:87], v1
    v_smfmac_f32_16x16x64_bf16 v[20:23], v[36:39], v[200:207], v1
    v_smfmac_f32_16x16x64_bf16 v[24:27], v[36:39], v[208:215], v1
    s_waitcnt vmcnt(2)
    v_max3_u32 v10, v40, v41, v42
    v_max_u32 v10, v10, v43
    v_cmp_eq_u32 vcc, -1, v10
    s_nop 0
    s_cbranch_vccnz Lr2s_pb_re
Lr2s_pb_ok:
    ds_write_b128 v0, v[40:43] offset:13056
    s_waitcnt lgkmcnt(3)
    v_smfmac_f32_16x16x64_bf16 v[12:15], v[40:43], v[56:63], v1
    ds_read_b128 v[56:59], v8 offset:8192
    ds_read_b128 v[60:63], v8 offset:9216
    v_smfmac_f32_16x16x64_bf16 v[20:23], v[40:43], a[24:31], v1
    s_waitcnt lgkmcnt(3)
    v_smfmac_f32_16x16x64_bf16 v[16:19], v[40:43], v[64:71], v1
    ds_read_b128 v[64:67], v8 offset:10240
    ds_read_b128 v[68:71], v8 offset:11264
    v_smfmac_f32_16x16x64_bf16 v[24:27], v[40:43], a[32:39], v1
    s_waitcnt lgkmcnt(4)
    s_barrier
    ds_read_b128 v[48:51], v0 offset:11008
    ds_read_b128 v[52:55], v0 offset:14080
    ds_read_b128 v[36:39], v0 offset:12032
    v_smfmac_f32_16x16x64_bf16 v[28:31], v[40:43], a[136:143], v1
    v_smfmac_f32_16x16x64_bf16 v[32:35], v[40:43], a[144:151], v1
    s_waitcnt lgkmcnt(2)
    v_smfmac_f32_16x16x64_bf16 v[12:15], v[48:51], v[56:63], v1
    v_smfmac_f32_16x16x64_bf16 v[16:19], v[48:51], v[64:71], v1
    s_waitcnt lgkmcnt(1)
    v_smfmac_f32_16x16x64_bf16 v[12:15], v[52:55], v[152:159], v1
    v_smfmac_f32_16x16x64_bf16 v[16:19], v[52:55], v[160:167], v1
    s_waitcnt lgkmcnt(0)
    v_smfmac_f32_16x16x64_bf16 v[12:15], v[36:39], v[136:143], v1
    v_smfmac_f32_16x16x64_bf16 v[16:19], v[36:39], v[144:151], v1
    s_waitcnt vmcnt(1)
    v_max3_u32 v10, v44, v45, v46
    v_max_u32 v10, v10, v47
    v_cmp_eq_u32 vcc, -1, v10
    s_nop 0
    s_cbranch_vccnz Lr2s_pc_re
Lr2s_pc_ok:
    v_smfmac_f32_16x16x64_bf16 v[12:15], v[44:47], v[168:175], v1
    v_smfmac_f32_16x16x64_bf16 v[16:19], v[44:47], v[176:183], v1
    v_smfmac_f32_16x16x64_bf16 v[20:23], v[48:51], v[248:255], v1
    v_smfmac_f32_16x16x64_bf16 v[24:27], v[48:51], a[0:7], v1
    v_smfmac_f32_16x16x64_bf16 v[20:23], v[52:55], a[40:47], v1
    v_add_f32 v12, v12, v14
    buffer_load_dwordx4 v[64:67], v0, s[8:11], s42 offen
    v_smfmac_f32_16x16x64_bf16 v[24:27], v[52:55], a[48:55], v1
    v_add_f32 v16, v16, v18
    v_smfmac_f32_16x16x64_bf16 v[20:23], v[36:39], a[8:15], v1
    v_add_f32 v13, v13, v15
    v_smfmac_f32_16x16x64_bf16 v[24:27], v[36:39], a[16:23], v1
    v_add_f32 v17, v17, v19
    v_smfmac_f32_16x16x64_bf16 v[20:23], v[44:47], a[56:63], v1
    v_cvt_pk_bf16_f32 v14, v12, v16
    ds_read_b128 v[56:59], v0 offset:15104
    buffer_load_dwordx4 v[68:71], v0, s[8:11], s42 offen offset:1024
    v_smfmac_f32_16x16x64_bf16 v[24:27], v[44:47], a[64:71], v1
    v_cvt_pk_bf16_f32 v15, v13, v17
    ds_read_b128 v[60:63], v0 offset:16128
    ds_write_b32 v2, v14 offset:576
    ds_write_b32 v2, v15 offset:864
    v_smfmac_f32_16x16x64_bf16 v[28:31], v[48:51], a[104:111], v1
    v_smfmac_f32_16x16x64_bf16 v[32:35], v[48:51], a[112:119], v1
    v_add_f32 v20, v20, v22
    v_add_f32 v24, v24, v26
    v_add_f32 v21, v21, v23
    v_add_f32 v25, v25, v27
    v_cvt_pk_bf16_f32 v22, v20, v24
    v_cvt_pk_bf16_f32 v23, v21, v25
    ds_write_b32 v2, v22 offset:0
    ds_write_b32 v2, v23 offset:288
    v_smfmac_f32_16x16x64_bf16 v[28:31], v[52:55], a[152:159], v1
    v_smfmac_f32_16x16x64_bf16 v[32:35], v[52:55], a[160:167], v1
    s_waitcnt vmcnt(2)
    v_cmp_eq_u32 vcc, 0, v11
    s_nop 0
    s_cbranch_vccnz Lr2s_flbad
Lr2s_flok:
    s_waitcnt lgkmcnt(0)
    s_barrier
    ds_read_b128 v[40:43], v3 offset:0
    ds_read_b128 v[48:51], v3 offset:64
    ds_read_b128 v[20:23], v3 offset:128
    ds_read_b128 v[52:55], v3 offset:192
    v_smfmac_f32_16x16x64_bf16 v[28:31], v[36:39], a[120:127], v1
    v_smfmac_f32_16x16x64_bf16 v[32:35], v[36:39], a[128:135], v1
    ds_read_b128 v[36:39], v0 offset:17152
    v_smfmac_f32_16x16x64_bf16 v[28:31], v[44:47], a[168:175], v1
    v_smfmac_f32_16x16x64_bf16 v[32:35], v[44:47], a[176:183], v1
    ds_read_b128 v[44:47], v0 offset:18176
    s_waitcnt lgkmcnt(5)
    v_mfma_f32_16x16x32_bf16 v[12:15], v[56:59], v[40:43], 0
    v_mfma_f32_16x16x32_bf16 v[16:19], v[60:63], v[40:43], 0
    v_mfma_f32_16x16x32_bf16 v[24:27], v[40:43], v[40:43], 0
    ds_read_b128 v[56:59], v0 offset:19200
    ds_read_b128 v[60:63], v0 offset:20224
    s_waitcnt lgkmcnt(3)
    v_mfma_f32_16x16x32_bf16 v[12:15], v[36:39], v[48:51], v[12:15]
    v_lshrrev_b32 v10, 1, v0
    v_lshrrev_b32 v9, 9, v0
    s_waitcnt lgkmcnt(2)
    v_mfma_f32_16x16x32_bf16 v[16:19], v[44:47], v[48:51], v[16:19]
    v_lshl_add_u32 v9, v9, 5, v10
    v_add_f32 v28, v28, v30
    v_mfma_f32_16x16x32_bf16 v[24:27], v[48:51], v[48:51], v[24:27]
    v_add_f32 v32, v32, v34
    v_add_f32 v29, v29, v31
    ds_read_b128 v[36:39], v0 offset:21248
    ds_read_b128 v[44:47], v0 offset:22272
    s_waitcnt lgkmcnt(3)
    v_mfma_f32_16x16x32_bf16 v[12:15], v[56:59], v[20:23], v[12:15]
    v_add_f32 v33, v33, v35
    v_cvt_pk_bf16_f32 v30, v28, v29
    s_waitcnt lgkmcnt(2)
    v_mfma_f32_16x16x32_bf16 v[16:19], v[60:63], v[20:23], v[16:19]
    v_cvt_pk_bf16_f32 v31, v32, v33
    ds_read_b64 v[34:35], v9 offset:2304
    v_mfma_f32_16x16x32_bf16 v[24:27], v[20:23], v[20:23], v[24:27]
    s_add_u32 s17, s43, 3072
    buffer_store_dwordx2 v[30:31], v10, s[8:11], s17 offen sc1
    s_waitcnt lgkmcnt(2)
    v_mfma_f32_16x16x32_bf16 v[12:15], v[36:39], v[52:55], v[12:15]
    s_waitcnt lgkmcnt(1)
    v_mfma_f32_16x16x32_bf16 v[16:19], v[44:47], v[52:55], v[16:19]
    v_mfma_f32_16x16x32_bf16 v[24:27], v[52:55], v[52:55], v[24:27]
    s_add_u32 s17, s43, 1024
    s_waitcnt lgkmcnt(0)
    buffer_store_dwordx2 v[34:35], v10, s[8:11], s17 offen sc1
    s_cmp_eq_u32 s33, 63
    s_cbranch_scc1 Lr2s_last
    ds_read_b128 v[56:59], v8 offset:16384
    ds_read_b128 v[60:63], v8 offset:17408
    v_mov_b64 v[20:21], s[52:53]
    v_mov_b64 v[22:23], s[52:53]
    v_mov_b32 v41, 0
    v_mov_b32 v42, 0
    v_max3_f32 v9, v12, v13, v14
    v_max3_f32 v9, v9, v15, v16
    v_max3_f32 v9, v9, v17, v18
    v_max3_f32 v9, v9, v19, v24
    v_max_f32 v9, v9, v25
    v_mov_b32 v10, v9
    v_mov_b64 v[32:33], 0
    v_mov_b64 v[34:35], 0
    v_permlane32_swap_b32 v9, v10
    v_max_f32 v9, v9, v10
    v_mov_b32 v10, v9
    s_nop 1
    v_permlane16_swap_b32 v9, v10
    v_max_f32 v9, v9, v10
    v_mul_f32 v28, s44, v9
    v_fma_f32 v12, v12, s44, -v28
    v_fma_f32 v13, v13, s44, -v28
    v_fma_f32 v14, v14, s44, -v28
    v_fma_f32 v15, v15, s44, -v28
    v_exp_f32 v12, v12
    v_exp_f32 v13, v13
    v_fma_f32 v16, v16, s44, -v28
    v_fma_f32 v17, v17, s44, -v28
    v_exp_f32 v14, v14
    v_exp_f32 v15, v15
    v_cvt_pk_bf16_f32 v36, v12, v13
    v_fma_f32 v18, v18, s44, -v28
    v_fma_f32 v19, v19, s44, -v28
    v_exp_f32 v16, v16
    v_exp_f32 v17, v17
    v_cvt_pk_bf16_f32 v37, v14, v15
    v_fma_f32 v24, v24, s44, -v28
    v_fma_f32 v25, v25, s44, -v28
    v_exp_f32 v18, v18
    v_exp_f32 v19, v19
    v_cvt_pk_bf16_f32 v38, v16, v17
    v_exp_f32 v24, v24
    v_exp_f32 v25, v25
    v_cvt_pk_bf16_f32 v39, v18, v19
    v_cvt_pk_bf16_f32 v40, v24, v25
    v_cvt_pk_bf16_f32 v43, v24, v25
    v_mfma_f32_16x16x32_bf16 v[52:55], v[20:23], v[36:39], 0
    v_mov_b64 v[12:13], 0
    v_mov_b64 v[14:15], 0
    s_waitcnt vmcnt(3)
    v_mfma_f32_16x16x32_bf16 v[44:47], v[64:67], v[36:39], 0
    v_mov_b64 v[24:25], 0
    v_mov_b64 v[26:27], 0
    s_waitcnt vmcnt(2)
    v_mfma_f32_16x16x32_bf16 v[48:51], v[68:71], v[36:39], 0
    ds_read_b128 v[64:67], v8 offset:20480
    ds_read_b128 v[68:71], v8 offset:21504
    v_mfma_f32_16x16x16_bf16 v[52:55], v[20:21], v[40:41], v[52:55]
    v_mfma_f32_16x16x16_bf16 v[44:47], v[30:31], v[40:41], v[44:47]
    v_mov_b64 v[20:21], 0
    v_mov_b64 v[22:23], 0
    v_mfma_f32_16x16x16_bf16 v[48:51], v[30:31], v[42:43], v[48:51]
    v_mov_b64 v[36:37], 0
    v_mov_b64 v[38:39], 0
    v_mov_b64 v[40:41], 0
    v_mov_b64 v[42:43], 0
    v_rcp_f32 v9, v52
    v_mov_b64 v[52:53], 0
    v_mov_b64 v[54:55], 0
    v_mul_f32 v44, v9, v44
    v_mul_f32 v48, v9, v48
    v_cvt_pk_bf16_f32 v16, v44, v48
    v_mul_f32 v45, v9, v45
    v_mul_f32 v49, v9, v49
    v_cvt_pk_bf16_f32 v17, v45, v49
    v_mul_f32 v46, v9, v46
    v_mul_f32 v50, v9, v50
    v_cvt_pk_bf16_f32 v18, v46, v50
    v_mul_f32 v47, v9, v47
    v_mul_f32 v51, v9, v51
    v_cvt_pk_bf16_f32 v19, v47, v51
    ds_write_b128 v5, v[16:19]
    v_mov_b64 v[28:29], 0
    v_mov_b64 v[30:31], 0
    s_waitcnt lgkmcnt(0)
    s_barrier
    ds_read_b128 v[44:47], v4 offset:0
    ds_read_b128 v[48:51], v4 offset:128
    v_mov_b64 v[16:17], 0
    v_mov_b64 v[18:19], 0
    buffer_load_dwordx4 v0, s[8:11], s41 offen offset:0 lds
    buffer_load_dwordx4 v0, s[8:11], s41 offen offset:1024 lds
    s_waitcnt lgkmcnt(1)
    v_smfmac_f32_16x16x64_bf16 v[12:15], v[44:47], a[184:191], v1
    s_waitcnt lgkmcnt(0)
    v_smfmac_f32_16x16x64_bf16 v[12:15], v[48:51], a[192:199], v1
    v_smfmac_f32_16x16x64_bf16 v[24:27], v[44:47], a[200:207], v1
    v_smfmac_f32_16x16x64_bf16 v[24:27], v[48:51], a[208:215], v1
    v_add_f32 v12, v12, v14
    v_smfmac_f32_16x16x64_bf16 v[20:23], v[44:47], a[216:223], v1
    v_add_f32 v13, v13, v15
    v_smfmac_f32_16x16x64_bf16 v[20:23], v[48:51], a[224:231], v1
    v_cvt_pk_bf16_f32 v12, v12, v13
    v_smfmac_f32_16x16x64_bf16 v[16:19], v[44:47], a[232:239], v1
    v_add_f32 v24, v24, v26
    v_smfmac_f32_16x16x64_bf16 v[16:19], v[48:51], a[240:247], v1
    v_add_f32 v25, v25, v27
    v_smfmac_f32_16x16x64_bf16 v[36:39], v[44:47], v[56:63], v1
    v_cvt_pk_bf16_f32 v13, v24, v25
    v_smfmac_f32_16x16x64_bf16 v[36:39], v[48:51], v[64:71], v1
    v_add_f32 v20, v20, v22
    v_add_f32 v21, v21, v23
    v_cvt_pk_bf16_f32 v14, v20, v21
    v_add_f32 v16, v16, v18
    v_add_f32 v17, v17, v19
    v_cvt_pk_bf16_f32 v15, v16, v17
    v_and_or_b32 v15, v15, -2, s40
    buffer_store_dwordx4 v[12:15], v0, s[8:11], s38 offen sc1
    s_nop 0
    ds_read_b128 v[12:15], v8 offset:18432
    ds_read_b128 v[16:19], v8 offset:19456
    ds_read_b128 v[20:23], v8 offset:22528
    ds_read_b128 v[24:27], v8 offset:23552
    ds_read_b128 v[56:59], v8 offset:24576
    ds_read_b128 v[60:63], v8 offset:25600
    ds_read_b128 v[64:67], v8 offset:28672
    ds_read_b128 v[68:71], v8 offset:29696
    s_waitcnt lgkmcnt(6)
    v_smfmac_f32_16x16x64_bf16 v[40:43], v[44:47], v[12:19], v1
    ds_read_b128 v[12:15], v8 offset:26624
    ds_read_b128 v[16:19], v8 offset:27648
    s_waitcnt lgkmcnt(6)
    v_smfmac_f32_16x16x64_bf16 v[40:43], v[48:51], v[20:27], v1
    ds_read_b128 v[20:23], v8 offset:30720
    ds_read_b128 v[24:27], v8 offset:31744
    s_waitcnt lgkmcnt(6)
    v_smfmac_f32_16x16x64_bf16 v[52:55], v[44:47], v[56:63], v1
    ds_read_b128 v[56:59], v8 offset:32768
    ds_read_b128 v[60:63], v8 offset:33792
    s_waitcnt lgkmcnt(6)
    v_smfmac_f32_16x16x64_bf16 v[52:55], v[48:51], v[64:71], v1
    s_waitcnt lgkmcnt(4)
    v_smfmac_f32_16x16x64_bf16 v[32:35], v[44:47], v[12:19], v1
    s_waitcnt lgkmcnt(2)
    v_smfmac_f32_16x16x64_bf16 v[32:35], v[48:51], v[20:27], v1
    v_smfmac_f32_16x16x64_bf16 v[28:31], v[44:47], a[248:255], v1
    s_waitcnt lgkmcnt(0)
    v_smfmac_f32_16x16x64_bf16 v[28:31], v[48:51], v[56:63], v1
    v_add_f32 v36, v36, v38
    v_add_f32 v37, v37, v39
    v_cvt_pk_bf16_f32 v36, v36, v37
    v_add_f32 v40, v40, v42
    v_add_f32 v41, v41, v43
    v_cvt_pk_bf16_f32 v37, v40, v41
    v_add_f32 v52, v52, v54
    v_add_f32 v53, v53, v55
    v_cvt_pk_bf16_f32 v38, v52, v53
    v_add_f32 v32, v32, v34
    v_add_f32 v33, v33, v35
    v_cvt_pk_bf16_f32 v39, v32, v33
    v_and_or_b32 v39, v39, -2, s40
    s_add_u32 s17, s38, 4096
    buffer_store_dwordx4 v[36:39], v0, s[8:11], s17 offen sc1
    v_add_f32 v28, v28, v30
    v_add_f32 v29, v29, v31
    v_cvt_pk_bf16_f32 v28, v28, v29
    v_and_or_b32 v28, v28, -2, s40
    v_lshrrev_b32 v9, 2, v0
    buffer_store_dword v28, v9, s[8:11], s39 offen sc1
    v_add_u32 v10, 162560, v0
    ds_read_b32 v64, v10
    v_mov_b32 v65, 0
    v_mov_b32 v41, 0
    v_mov_b32 v45, 0
    v_mov_b32 v49, 0
    v_mov_b32 v53, 0
    s_add_u32 s33, s33, 1
    s_add_u32 s42, s42, 262144
    s_add_u32 s41, s41, 262144
    s_add_u32 s43, s43, 131072
    s_add_u32 s68, s68, 262144
    s_add_u32 s66, s66, 22528
    ds_read_b128 v[56:59], v8 offset:4096
    ds_read_b128 v[60:63], v8 offset:5120
    v_mov_b64 v[12:13], 0
    v_mov_b64 v[14:15], 0
    v_mov_b64 v[16:17], 0
    v_mov_b64 v[18:19], 0
    v_mov_b64 v[20:21], 0
    v_mov_b64 v[22:23], 0
    v_mov_b64 v[24:25], 0
    v_mov_b64 v[26:27], 0
    v_mov_b64 v[28:29], 0
    v_mov_b64 v[30:31], 0
    v_mov_b64 v[32:33], 0
    v_mov_b64 v[34:35], 0
    s_nop 15
    s_nop 15
    s_nop 15
    s_nop 1
    buffer_load_dword v40, v6, s[8:11], s62 offen sc1
    buffer_load_dword v44, v6, s[8:11], s63 offen sc1
    buffer_load_dword v48, v6, s[8:11], s64 offen sc1
    buffer_load_dword v52, v6, s[8:11], s65 offen sc1
    s_waitcnt lgkmcnt(0)
    s_waitcnt vmcnt(3)
    v_mfma_f32_16x16x16_bf16 v[68:71], v[40:41], v[64:65], 0
    v_and_b32 v10, 1, v40
    v_cmp_ne_u32 s[54:55], s40, v10
    s_waitcnt vmcnt(2)
    v_mfma_f32_16x16x16_bf16 v[68:71], v[44:45], v[64:65], v[68:71]
    v_and_b32 v10, 1, v44
    v_cmp_ne_u32 s[56:57], s40, v10
    s_waitcnt vmcnt(1)
    v_mfma_f32_16x16x16_bf16 v[68:71], v[48:49], v[64:65], v[68:71]
    v_and_b32 v10, 1, v48
    v_cmp_ne_u32 s[58:59], s40, v10
    s_waitcnt vmcnt(0)
    v_mfma_f32_16x16x16_bf16 v[68:71], v[52:53], v[64:65], v[68:71]
    v_and_b32 v10, 1, v52
    v_cmp_ne_u32 s[60:61], s40, v10
    s_or_b64 vcc, s[54:55], s[56:57]
    s_or_b64 vcc, vcc, s[58:59]
    s_or_b64 vcc, vcc, s[60:61]
    s_cbranch_scc0 Lr2s_red
    s_mov_b32 s16, 0
Lr2s_p1:
    s_mov_b64 exec, s[54:55]
    buffer_load_dword v40, v6, s[8:11], s62 offen sc1
    s_mov_b64 exec, s[56:57]
    buffer_load_dword v44, v6, s[8:11], s63 offen sc1
    s_mov_b64 exec, s[58:59]
    buffer_load_dword v48, v6, s[8:11], s64 offen sc1
    s_mov_b64 exec, s[60:61]
    buffer_load_dword v52, v6, s[8:11], s65 offen sc1
    s_mov_b64 exec, -1
    s_add_u32 s16, s16, 1
    s_cmp_gt_u32 s16, 100000
    s_cbranch_scc1 Lr_abort
    s_waitcnt vmcnt(3)
    v_mfma_f32_16x16x16_bf16 v[68:71], v[40:41], v[64:65], 0
    v_and_b32 v10, 1, v40
    v_cmp_ne_u32 s[54:55], s40, v10
    s_waitcnt vmcnt(2)
    v_mfma_f32_16x16x16_bf16 v[68:71], v[44:45], v[64:65], v[68:71]
    v_and_b32 v10, 1, v44
    v_cmp_ne_u32 s[56:57], s40, v10
    s_waitcnt vmcnt(1)
    v_mfma_f32_16x16x16_bf16 v[68:71], v[48:49], v[64:65], v[68:71]
    v_and_b32 v10, 1, v48
    v_cmp_ne_u32 s[58:59], s40, v10
    s_waitcnt vmcnt(0)
    v_mfma_f32_16x16x16_bf16 v[68:71], v[52:53], v[64:65], v[68:71]
    v_and_b32 v10, 1, v52
    v_cmp_ne_u32 s[60:61], s40, v10
    s_or_b64 vcc, s[54:55], s[56:57]
    s_or_b64 vcc, vcc, s[58:59]
    s_or_b64 vcc, vcc, s[60:61]
    s_cbranch_scc1 Lr2s_p1
Lr2s_red:
    s_xor_b32 s34, s34, 16384
    s_xor_b32 s35, s35, 16384
    buffer_load_dwordx4 v[36:39], v0, s[8:11], s34 offen sc1
    v_permlane16_swap_b32 v68, v70
    v_permlane16_swap_b32 v69, v71
    s_mov_b64 exec, s[46:47]
    v_add_f32 v68, v68, v70
    v_add_f32 v69, v69, v71
    v_cvt_pk_bf16_f32 v68, v68, v69
    v_min_u32 v68, s50, v68
    buffer_store_dword v68, v7, s[8:11], s36 offen sc1
    v_mov_b32 v69, -1
    buffer_store_dword v69, v7, s[8:11], s37 offen sc1
    s_mov_b64 exec, -1
    buffer_load_dwordx4 v[36:39], v0, s[8:11], s34 offen sc1
    s_xor_b32 s40, s40, 1
    s_xor_b32 s36, s36, 16384
    s_xor_b32 s37, s37, 16384
    ds_read_b128 v[64:67], v8 offset:6144
    ds_read_b128 v[68:71], v8 offset:7168
    s_waitcnt lgkmcnt(0)
    s_branch Lr2s_step
Lr2s_pb_re:
    s_mov_b32 s16, 0
Lr2s_pb_lp:
    s_add_u32 s17, s34, 4096
    buffer_load_dwordx4 v[40:43], v0, s[8:11], s17 offen sc1
    s_add_u32 s16, s16, 1
    s_cmp_gt_u32 s16, 100000
    s_cbranch_scc1 Lr_abort
    s_waitcnt vmcnt(0)
    v_max3_u32 v10, v40, v41, v42
    v_max_u32 v10, v10, v43
    v_cmp_eq_u32 vcc, -1, v10
    s_nop 0
    s_cbranch_vccnz Lr2s_pb_lp
    s_branch Lr2s_pb_ok
Lr2s_pc_re:
    s_mov_b32 s16, 0
Lr2s_pc_lp:
    buffer_load_dwordx4 v[44:47], v0, s[8:11], s35 offen sc1
    s_add_u32 s16, s16, 1
    s_cmp_gt_u32 s16, 100000
    s_cbranch_scc1 Lr_abort
    s_waitcnt vmcnt(0)
    v_max3_u32 v10, v44, v45, v46
    v_max_u32 v10, v10, v47
    v_cmp_eq_u32 vcc, -1, v10
    s_nop 0
    s_cbranch_vccnz Lr2s_pc_lp
    s_branch Lr2s_pc_ok
Lr2s_flbad:
    s_cmp_eq_u32 s33, 63
    s_cbranch_scc1 Lr2s_flok
    s_mov_b32 s16, 0
    s_add_u32 s17, s66, 22656
    v_lshrrev_b32 v10, 2, v0
    v_and_b32 v9, 16, v10
    v_lshlrev_b32 v9, 3, v9
    v_and_or_b32 v10, v10, 12, v9
Lr2s_fw_18:
    buffer_load_dword v9, v10, s[8:11], s17 offen sc1
    s_add_u32 s16, s16, 1
    s_cmp_gt_u32 s16, 100000
    s_cbranch_scc1 Lr_abort
    s_waitcnt vmcnt(0)
    v_cmp_eq_u32 vcc, 0, v9
    s_nop 0
    s_cbranch_vccnz Lr2s_fw_18
    s_branch Lr2s_flok
Lr2s_last:
    s_waitcnt vmcnt(0) lgkmcnt(0)
    s_barrier
    s_branch Lr_exit
L_w3_0:
    s_mov_b32 s16, 0
    s_add_u32 s17, s66, 128
    v_lshrrev_b32 v10, 2, v0
    v_and_b32 v9, 16, v10
    v_lshlrev_b32 v9, 3, v9
    v_and_or_b32 v10, v10, 12, v9
Lr3s_fw_19:
    buffer_load_dword v9, v10, s[8:11], s17 offen sc1
    s_add_u32 s16, s16, 1
    s_cmp_gt_u32 s16, 100000
    s_cbranch_scc1 Lr_abort
    s_waitcnt vmcnt(0)
    v_cmp_eq_u32 vcc, 0, v9
    s_nop 0
    s_cbranch_vccnz Lr3s_fw_19
    s_mov_b32 m0, 21248
    s_nop 0
    buffer_load_dwordx4 v0, s[8:11], s41 offen offset:0 lds
    buffer_load_dwordx4 v0, s[8:11], s41 offen offset:1024 lds
    s_add_u32 s41, s41, 262144
    s_add_u32 s68, s68, 262144
    s_waitcnt vmcnt(0)
    ds_read_b128 v[56:59], v8 offset:0
    ds_read_b128 v[60:63], v8 offset:1024
    ds_read_b128 v[64:67], v8 offset:2048
    ds_read_b128 v[68:71], v8 offset:3072
    v_mov_b64 v[12:13], 0
    v_mov_b64 v[14:15], 0
    v_mov_b64 v[16:17], 0
    v_mov_b64 v[18:19], 0
    v_mov_b64 v[20:21], 0
    v_mov_b64 v[22:23], 0
    v_mov_b64 v[24:25], 0
    v_mov_b64 v[26:27], 0
    v_mov_b64 v[28:29], 0
    v_mov_b64 v[30:31], 0
    v_mov_b64 v[32:33], 0
    v_mov_b64 v[34:35], 0
    buffer_load_dwordx4 v[36:39], v0, s[8:11], s34 offen sc1
    s_waitcnt vmcnt(0) lgkmcnt(0)
Lr3s_step:
    s_mov_b32 s16, 0
Lr3s_alp:
    s_waitcnt vmcnt(2)
    v_max3_u32 v10, v36, v37, v38
    v_max_u32 v10, v10, v39
    v_cmp_eq_u32 vcc, -1, v10
    s_nop 0
    s_cbranch_vccz Lr3s_aok
    buffer_load_dwordx4 v[36:39], v0, s[8:11], s34 offen sc1
    s_add_u32 s16, s16, 1
    s_cmp_gt_u32 s16, 100000
    s_cbranch_scc1 Lr_abort
    s_branch Lr3s_alp
Lr3s_aok:
    ds_write_b128 v0, v[36:39] offset:9984
    v_smfmac_f32_16x16x64_bf16 v[12:15], v[36:39], v[120:127], v1
    v_smfmac_f32_16x16x64_bf16 v[16:19], v[36:39], v[128:135], v1
    v_smfmac_f32_16x16x64_bf16 v[20:23], v[36:39], v[232:239], v1
    s_waitcnt lgkmcnt(0)
    s_barrier
    ds_read_b128 v[48:51], v0 offset:6912
    ds_read_b128 v[52:55], v0 offset:7936
    v_smfmac_f32_16x16x64_bf16 v[28:31], v[36:39], a[88:95], v1
    v_smfmac_f32_16x16x64_bf16 v[24:27], v[36:39], v[240:247], v1
    v_smfmac_f32_16x16x64_bf16 v[32:35], v[36:39], a[96:103], v1
    s_waitcnt vmcnt(0)
    ds_read_b128 v[36:39], v0 offset:8960
    s_waitcnt lgkmcnt(2)
    v_smfmac_f32_16x16x64_bf16 v[28:31], v[48:51], v[56:63], v1
    ds_read_b128 v[56:59], v8 offset:4096
    ds_read_b128 v[60:63], v8 offset:5120
    s_add_u32 s17, s34, 4096
    buffer_load_dwordx4 v[40:43], v0, s[8:11], s17 offen sc1
    v_smfmac_f32_16x16x64_bf16 v[12:15], v[48:51], v[72:79], v1
    v_smfmac_f32_16x16x64_bf16 v[16:19], v[48:51], v[80:87], v1
    v_smfmac_f32_16x16x64_bf16 v[32:35], v[48:51], v[64:71], v1
    ds_read_b128 v[64:67], v8 offset:6144
    ds_read_b128 v[68:71], v8 offset:7168
    v_smfmac_f32_16x16x64_bf16 v[20:23], v[48:51], v[184:191], v1
    buffer_load_dwordx4 v[44:47], v0, s[8:11], s35 offen sc1
    v_smfmac_f32_16x16x64_bf16 v[24:27], v[48:51], v[192:199], v1
    s_waitcnt lgkmcnt(5)
    v_smfmac_f32_16x16x64_bf16 v[28:31], v[52:55], a[72:79], v1
    v_smfmac_f32_16x16x64_bf16 v[12:15], v[52:55], v[88:95], v1
    v_smfmac_f32_16x16x64_bf16 v[16:19], v[52:55], v[96:103], v1
    v_smfmac_f32_16x16x64_bf16 v[32:35], v[52:55], a[80:87], v1
    v_smfmac_f32_16x16x64_bf16 v[20:23], v[52:55], v[200:207], v1
    v_smfmac_f32_16x16x64_bf16 v[24:27], v[52:55], v[208:215], v1
    s_waitcnt lgkmcnt(2)
    v_smfmac_f32_16x16x64_bf16 v[28:31], v[36:39], v[56:63], v1
    ds_read_b128 v[56:59], v8 offset:8192
    ds_read_b128 v[60:63], v8 offset:9216
    v_smfmac_f32_16x16x64_bf16 v[12:15], v[36:39], v[104:111], v1
    v_smfmac_f32_16x16x64_bf16 v[16:19], v[36:39], v[112:119], v1
    s_waitcnt lgkmcnt(2)
    v_smfmac_f32_16x16x64_bf16 v[32:35], v[36:39], v[64:71], v1
    ds_read_b128 v[64:67], v8 offset:10240
    ds_read_b128 v[68:71], v8 offset:11264
    v_smfmac_f32_16x16x64_bf16 v[20:23], v[36:39], v[216:223], v1
    v_smfmac_f32_16x16x64_bf16 v[24:27], v[36:39], v[224:231], v1
    s_waitcnt vmcnt(1)
    v_max3_u32 v10, v40, v41, v42
    v_max_u32 v10, v10, v43
    v_cmp_eq_u32 vcc, -1, v10
    s_nop 0
    s_cbranch_vccnz Lr3s_pb_re
Lr3s_pb_ok:
    ds_write_b128 v0, v[40:43] offset:14080
    v_smfmac_f32_16x16x64_bf16 v[12:15], v[40:43], v[152:159], v1
    v_smfmac_f32_16x16x64_bf16 v[20:23], v[40:43], a[40:47], v1
    v_smfmac_f32_16x16x64_bf16 v[16:19], v[40:43], v[160:167], v1
    v_smfmac_f32_16x16x64_bf16 v[24:27], v[40:43], a[48:55], v1
    s_waitcnt lgkmcnt(0)
    s_barrier
    ds_read_b128 v[48:51], v0 offset:11008
    ds_read_b128 v[52:55], v0 offset:12032
    ds_read_b128 v[36:39], v0 offset:13056
    v_smfmac_f32_16x16x64_bf16 v[28:31], v[40:43], a[152:159], v1
    v_smfmac_f32_16x16x64_bf16 v[32:35], v[40:43], a[160:167], v1
    s_waitcnt lgkmcnt(2)
    v_smfmac_f32_16x16x64_bf16 v[12:15], v[48:51], v[56:63], v1
    ds_read_b128 v[56:59], v8 offset:12288
    ds_read_b128 v[60:63], v8 offset:13312
    v_smfmac_f32_16x16x64_bf16 v[16:19], v[48:51], v[64:71], v1
    ds_read_b128 v[64:67], v8 offset:14336
    ds_read_b128 v[68:71], v8 offset:15360
    s_waitcnt lgkmcnt(5)
    v_smfmac_f32_16x16x64_bf16 v[12:15], v[52:55], v[136:143], v1
    v_smfmac_f32_16x16x64_bf16 v[16:19], v[52:55], v[144:151], v1
    s_waitcnt vmcnt(0)
    v_max3_u32 v10, v44, v45, v46
    v_max_u32 v10, v10, v47
    v_cmp_eq_u32 vcc, -1, v10
    s_nop 0
    s_cbranch_vccnz Lr3s_pc_re
Lr3s_pc_ok:
    v_smfmac_f32_16x16x64_bf16 v[12:15], v[44:47], v[168:175], v1
    v_smfmac_f32_16x16x64_bf16 v[16:19], v[44:47], v[176:183], v1
    s_waitcnt lgkmcnt(2)
    v_smfmac_f32_16x16x64_bf16 v[12:15], v[36:39], v[56:63], v1
    s_waitcnt lgkmcnt(0)
    v_smfmac_f32_16x16x64_bf16 v[16:19], v[36:39], v[64:71], v1
    v_smfmac_f32_16x16x64_bf16 v[20:23], v[48:51], v[248:255], v1
    v_smfmac_f32_16x16x64_bf16 v[24:27], v[48:51], a[0:7], v1
    v_smfmac_f32_16x16x64_bf16 v[20:23], v[52:55], a[8:15], v1
    v_add_f32 v12, v12, v14
    v_smfmac_f32_16x16x64_bf16 v[24:27], v[52:55], a[16:23], v1
    v_add_f32 v16, v16, v18
    buffer_load_dwordx4 v[64:67], v0, s[8:11], s42 offen
    v_smfmac_f32_16x16x64_bf16 v[20:23], v[36:39], a[24:31], v1
    v_add_f32 v13, v13, v15
    v_smfmac_f32_16x16x64_bf16 v[24:27], v[36:39], a[32:39], v1
    v_add_f32 v17, v17, v19
    v_smfmac_f32_16x16x64_bf16 v[20:23], v[44:47], a[56:63], v1
    v_cvt_pk_bf16_f32 v14, v12, v16
    ds_read_b128 v[56:59], v0 offset:15104
    v_smfmac_f32_16x16x64_bf16 v[24:27], v[44:47], a[64:71], v1
    v_cvt_pk_bf16_f32 v15, v13, v17
    ds_read_b128 v[60:63], v0 offset:16128
    buffer_load_dwordx4 v[68:71], v0, s[8:11], s42 offen offset:1024
    ds_write_b32 v2, v14 offset:576
    ds_write_b32 v2, v15 offset:864
    v_smfmac_f32_16x16x64_bf16 v[28:31], v[48:51], a[104:111], v1
    v_smfmac_f32_16x16x64_bf16 v[32:35], v[48:51], a[112:119], v1
    v_add_f32 v20, v20, v22
    v_add_f32 v24, v24, v26
    v_add_f32 v21, v21, v23
    v_add_f32 v25, v25, v27
    v_cvt_pk_bf16_f32 v22, v20, v24
    v_cvt_pk_bf16_f32 v23, v21, v25
    ds_write_b32 v2, v22 offset:0
    ds_write_b32 v2, v23 offset:288
    v_smfmac_f32_16x16x64_bf16 v[28:31], v[52:55], a[120:127], v1
    v_smfmac_f32_16x16x64_bf16 v[32:35], v[52:55], a[128:135], v1
    s_waitcnt lgkmcnt(0)
    s_barrier
    ds_read_b128 v[40:43], v3 offset:0
    ds_read_b128 v[48:51], v3 offset:64
    ds_read_b128 v[20:23], v3 offset:128
    ds_read_b128 v[52:55], v3 offset:192
    v_smfmac_f32_16x16x64_bf16 v[28:31], v[36:39], a[136:143], v1
    v_smfmac_f32_16x16x64_bf16 v[32:35], v[36:39], a[144:151], v1
    ds_read_b128 v[36:39], v0 offset:17152
    v_lshlrev_b32 v9, 3, v0
    buffer_load_dword v11, v9, s[8:11], s68 offen
    v_smfmac_f32_16x16x64_bf16 v[28:31], v[44:47], a[168:175], v1
    v_smfmac_f32_16x16x64_bf16 v[32:35], v[44:47], a[176:183], v1
    ds_read_b128 v[44:47], v0 offset:18176
    s_waitcnt lgkmcnt(5)
    v_mfma_f32_16x16x32_bf16 v[12:15], v[56:59], v[40:43], 0
    v_mfma_f32_16x16x32_bf16 v[16:19], v[60:63], v[40:43], 0
    v_mfma_f32_16x16x32_bf16 v[24:27], v[40:43], v[40:43], 0
    ds_read_b128 v[56:59], v0 offset:19200
    ds_read_b128 v[60:63], v0 offset:20224
    s_waitcnt lgkmcnt(3)
    v_mfma_f32_16x16x32_bf16 v[12:15], v[36:39], v[48:51], v[12:15]
    v_lshrrev_b32 v10, 1, v0
    v_lshrrev_b32 v9, 9, v0
    s_waitcnt lgkmcnt(2)
    v_mfma_f32_16x16x32_bf16 v[16:19], v[44:47], v[48:51], v[16:19]
    v_lshl_add_u32 v9, v9, 5, v10
    v_add_f32 v28, v28, v30
    v_mfma_f32_16x16x32_bf16 v[24:27], v[48:51], v[48:51], v[24:27]
    v_add_f32 v32, v32, v34
    v_add_f32 v29, v29, v31
    ds_read_b128 v[36:39], v0 offset:21248
    ds_read_b128 v[44:47], v0 offset:22272
    s_waitcnt lgkmcnt(3)
    v_mfma_f32_16x16x32_bf16 v[12:15], v[56:59], v[20:23], v[12:15]
    v_add_f32 v33, v33, v35
    v_cvt_pk_bf16_f32 v30, v28, v29
    s_waitcnt lgkmcnt(2)
    v_mfma_f32_16x16x32_bf16 v[16:19], v[60:63], v[20:23], v[16:19]
    v_cvt_pk_bf16_f32 v31, v32, v33
    ds_read_b64 v[34:35], v9 offset:3456
    v_mfma_f32_16x16x32_bf16 v[24:27], v[20:23], v[20:23], v[24:27]
    s_add_u32 s17, s43, 3584
    buffer_store_dwordx2 v[30:31], v10, s[8:11], s17 offen sc1
    s_waitcnt lgkmcnt(2)
    v_mfma_f32_16x16x32_bf16 v[12:15], v[36:39], v[52:55], v[12:15]
    s_waitcnt lgkmcnt(1)
    v_mfma_f32_16x16x32_bf16 v[16:19], v[44:47], v[52:55], v[16:19]
    v_mfma_f32_16x16x32_bf16 v[24:27], v[52:55], v[52:55], v[24:27]
    s_add_u32 s17, s43, 1536
    s_waitcnt lgkmcnt(0)
    buffer_store_dwordx2 v[34:35], v10, s[8:11], s17 offen sc1
    s_cmp_eq_u32 s33, 63
    s_cbranch_scc1 Lr3s_last
    ds_read_b128 v[56:59], v8 offset:16384
    ds_read_b128 v[60:63], v8 offset:17408
    v_mov_b64 v[20:21], s[52:53]
    v_mov_b64 v[22:23], s[52:53]
    v_mov_b32 v41, 0
    v_mov_b32 v42, 0
    v_max3_f32 v9, v12, v13, v14
    v_max3_f32 v9, v9, v15, v16
    v_max3_f32 v9, v9, v17, v18
    v_max3_f32 v9, v9, v19, v24
    v_max_f32 v9, v9, v25
    v_mov_b32 v10, v9
    v_mov_b64 v[32:33], 0
    v_mov_b64 v[34:35], 0
    v_permlane32_swap_b32 v9, v10
    v_max_f32 v9, v9, v10
    v_mov_b32 v10, v9
    s_nop 1
    v_permlane16_swap_b32 v9, v10
    v_max_f32 v9, v9, v10
    v_mul_f32 v28, s44, v9
    v_fma_f32 v12, v12, s44, -v28
    v_fma_f32 v13, v13, s44, -v28
    v_fma_f32 v14, v14, s44, -v28
    v_fma_f32 v15, v15, s44, -v28
    v_exp_f32 v12, v12
    v_exp_f32 v13, v13
    v_fma_f32 v16, v16, s44, -v28
    v_fma_f32 v17, v17, s44, -v28
    v_exp_f32 v14, v14
    v_exp_f32 v15, v15
    v_cvt_pk_bf16_f32 v36, v12, v13
    v_fma_f32 v18, v18, s44, -v28
    v_fma_f32 v19, v19, s44, -v28
    v_exp_f32 v16, v16
    v_exp_f32 v17, v17
    v_cvt_pk_bf16_f32 v37, v14, v15
    v_fma_f32 v24, v24, s44, -v28
    v_fma_f32 v25, v25, s44, -v28
    v_exp_f32 v18, v18
    v_exp_f32 v19, v19
    v_cvt_pk_bf16_f32 v38, v16, v17
    v_exp_f32 v24, v24
    v_exp_f32 v25, v25
    v_cvt_pk_bf16_f32 v39, v18, v19
    v_cvt_pk_bf16_f32 v40, v24, v25
    v_cvt_pk_bf16_f32 v43, v24, v25
    v_mfma_f32_16x16x32_bf16 v[52:55], v[20:23], v[36:39], 0
    v_mov_b64 v[12:13], 0
    v_mov_b64 v[14:15], 0
    s_waitcnt vmcnt(4)
    v_mfma_f32_16x16x32_bf16 v[44:47], v[64:67], v[36:39], 0
    v_mov_b64 v[24:25], 0
    v_mov_b64 v[26:27], 0
    s_waitcnt vmcnt(3)
    v_mfma_f32_16x16x32_bf16 v[48:51], v[68:71], v[36:39], 0
    ds_read_b128 v[64:67], v8 offset:20480
    ds_read_b128 v[68:71], v8 offset:21504
    v_mfma_f32_16x16x16_bf16 v[52:55], v[20:21], v[40:41], v[52:55]
    v_mfma_f32_16x16x16_bf16 v[44:47], v[30:31], v[40:41], v[44:47]
    v_mov_b64 v[20:21], 0
    v_mov_b64 v[22:23], 0
    v_mfma_f32_16x16x16_bf16 v[48:51], v[30:31], v[42:43], v[48:51]
    v_mov_b64 v[36:37], 0
    v_mov_b64 v[38:39], 0
    v_mov_b64 v[40:41], 0
    v_mov_b64 v[42:43], 0
    v_rcp_f32 v9, v52
    v_mov_b64 v[52:53], 0
    v_mov_b64 v[54:55], 0
    v_mul_f32 v44, v9, v44
    v_mul_f32 v48, v9, v48
    v_cvt_pk_bf16_f32 v16, v44, v48
    v_mul_f32 v45, v9, v45
    v_mul_f32 v49, v9, v49
    v_cvt_pk_bf16_f32 v17, v45, v49
    v_mul_f32 v46, v9, v46
    v_mul_f32 v50, v9, v50
    v_cvt_pk_bf16_f32 v18, v46, v50
    v_mul_f32 v47, v9, v47
    v_mul_f32 v51, v9, v51
    v_cvt_pk_bf16_f32 v19, v47, v51
    ds_write_b128 v5, v[16:19]
    v_mov_b64 v[28:29], 0
    v_mov_b64 v[30:31], 0
    s_waitcnt lgkmcnt(0)
    s_barrier
    ds_read_b128 v[44:47], v4 offset:0
    ds_read_b128 v[48:51], v4 offset:128
    v_mov_b64 v[16:17], 0
    v_mov_b64 v[18:19], 0
    buffer_load_dwordx4 v0, s[8:11], s41 offen offset:0 lds
    buffer_load_dwordx4 v0, s[8:11], s41 offen offset:1024 lds
    s_waitcnt lgkmcnt(1)
    v_smfmac_f32_16x16x64_bf16 v[12:15], v[44:47], a[184:191], v1
    s_waitcnt lgkmcnt(0)
    v_smfmac_f32_16x16x64_bf16 v[12:15], v[48:51], a[192:199], v1
    v_smfmac_f32_16x16x64_bf16 v[24:27], v[44:47], a[200:207], v1
    v_smfmac_f32_16x16x64_bf16 v[24:27], v[48:51], a[208:215], v1
    v_add_f32 v12, v12, v14
    v_smfmac_f32_16x16x64_bf16 v[20:23], v[44:47], a[216:223], v1
    v_add_f32 v13, v13, v15
    v_smfmac_f32_16x16x64_bf16 v[20:23], v[48:51], a[224:231], v1
    v_cvt_pk_bf16_f32 v12, v12, v13
    v_smfmac_f32_16x16x64_bf16 v[16:19], v[44:47], a[232:239], v1
    v_add_f32 v24, v24, v26
    v_smfmac_f32_16x16x64_bf16 v[16:19], v[48:51], a[240:247], v1
    v_add_f32 v25, v25, v27
    v_smfmac_f32_16x16x64_bf16 v[36:39], v[44:47], v[56:63], v1
    v_cvt_pk_bf16_f32 v13, v24, v25
    v_smfmac_f32_16x16x64_bf16 v[36:39], v[48:51], v[64:71], v1
    v_add_f32 v20, v20, v22
    v_add_f32 v21, v21, v23
    v_cvt_pk_bf16_f32 v14, v20, v21
    v_add_f32 v16, v16, v18
    v_add_f32 v17, v17, v19
    v_cvt_pk_bf16_f32 v15, v16, v17
    v_and_or_b32 v15, v15, -2, s40
    buffer_store_dwordx4 v[12:15], v0, s[8:11], s38 offen sc1
    s_nop 0
    ds_read_b128 v[12:15], v8 offset:18432
    ds_read_b128 v[16:19], v8 offset:19456
    ds_read_b128 v[20:23], v8 offset:22528
    ds_read_b128 v[24:27], v8 offset:23552
    ds_read_b128 v[56:59], v8 offset:24576
    ds_read_b128 v[60:63], v8 offset:25600
    ds_read_b128 v[64:67], v8 offset:28672
    ds_read_b128 v[68:71], v8 offset:29696
    s_waitcnt lgkmcnt(6)
    v_smfmac_f32_16x16x64_bf16 v[40:43], v[44:47], v[12:19], v1
    ds_read_b128 v[12:15], v8 offset:26624
    ds_read_b128 v[16:19], v8 offset:27648
    s_waitcnt lgkmcnt(6)
    v_smfmac_f32_16x16x64_bf16 v[40:43], v[48:51], v[20:27], v1
    ds_read_b128 v[20:23], v8 offset:30720
    ds_read_b128 v[24:27], v8 offset:31744
    s_waitcnt lgkmcnt(6)
    v_smfmac_f32_16x16x64_bf16 v[52:55], v[44:47], v[56:63], v1
    ds_read_b128 v[56:59], v8 offset:32768
    ds_read_b128 v[60:63], v8 offset:33792
    s_waitcnt lgkmcnt(6)
    v_smfmac_f32_16x16x64_bf16 v[52:55], v[48:51], v[64:71], v1
    s_waitcnt lgkmcnt(4)
    v_smfmac_f32_16x16x64_bf16 v[32:35], v[44:47], v[12:19], v1
    s_waitcnt lgkmcnt(2)
    v_smfmac_f32_16x16x64_bf16 v[32:35], v[48:51], v[20:27], v1
    v_smfmac_f32_16x16x64_bf16 v[28:31], v[44:47], a[248:255], v1
    s_waitcnt lgkmcnt(0)
    v_smfmac_f32_16x16x64_bf16 v[28:31], v[48:51], v[56:63], v1
    v_add_f32 v36, v36, v38
    v_add_f32 v37, v37, v39
    v_cvt_pk_bf16_f32 v36, v36, v37
    v_add_f32 v40, v40, v42
    v_add_f32 v41, v41, v43
    v_cvt_pk_bf16_f32 v37, v40, v41
    v_add_f32 v52, v52, v54
    v_add_f32 v53, v53, v55
    v_cvt_pk_bf16_f32 v38, v52, v53
    v_add_f32 v32, v32, v34
    v_add_f32 v33, v33, v35
    v_cvt_pk_bf16_f32 v39, v32, v33
    v_and_or_b32 v39, v39, -2, s40
    s_add_u32 s17, s38, 4096
    buffer_store_dwordx4 v[36:39], v0, s[8:11], s17 offen sc1
    v_add_f32 v28, v28, v30
    v_add_f32 v29, v29, v31
    v_cvt_pk_bf16_f32 v28, v28, v29
    v_and_or_b32 v28, v28, -2, s40
    v_lshrrev_b32 v9, 2, v0
    buffer_store_dword v28, v9, s[8:11], s39 offen sc1
    s_xor_b32 s34, s34, 16384
    s_xor_b32 s35, s35, 16384
    s_add_u32 s33, s33, 1
    s_add_u32 s42, s42, 262144
    s_add_u32 s41, s41, 262144
    s_add_u32 s43, s43, 131072
    s_add_u32 s68, s68, 262144
    s_add_u32 s66, s66, 22528
    s_xor_b32 s40, s40, 1
    ds_read_b128 v[56:59], v8 offset:0
    ds_read_b128 v[60:63], v8 offset:1024
    ds_read_b128 v[64:67], v8 offset:2048
    ds_read_b128 v[68:71], v8 offset:3072
    v_mov_b64 v[12:13], 0
    v_mov_b64 v[14:15], 0
    v_mov_b64 v[16:17], 0
    v_mov_b64 v[18:19], 0
    v_mov_b64 v[20:21], 0
    v_mov_b64 v[22:23], 0
    v_mov_b64 v[24:25], 0
    v_mov_b64 v[26:27], 0
    v_mov_b64 v[28:29], 0
    v_mov_b64 v[30:31], 0
    v_mov_b64 v[32:33], 0
    v_mov_b64 v[34:35], 0
    s_sleep 5
    s_nop 9
    buffer_load_dwordx4 v[36:39], v0, s[8:11], s34 offen sc1
    s_nop 15
    s_nop 8
    buffer_load_dwordx4 v[36:39], v0, s[8:11], s34 offen sc1
    s_nop 15
    s_nop 8
    buffer_load_dwordx4 v[36:39], v0, s[8:11], s34 offen sc1
    s_waitcnt lgkmcnt(0)
    s_branch Lr3s_step
Lr3s_pb_re:
    s_mov_b32 s16, 0
Lr3s_pb_lp:
    s_add_u32 s17, s34, 4096
    buffer_load_dwordx4 v[40:43], v0, s[8:11], s17 offen sc1
    s_add_u32 s16, s16, 1
    s_cmp_gt_u32 s16, 100000
    s_cbranch_scc1 Lr_abort
    s_waitcnt vmcnt(0)
    v_max3_u32 v10, v40, v41, v42
    v_max_u32 v10, v10, v43
    v_cmp_eq_u32 vcc, -1, v10
    s_nop 0
    s_cbranch_vccnz Lr3s_pb_lp
    s_branch Lr3s_pb_ok
Lr3s_pc_re:
    s_mov_b32 s16, 0
Lr3s_pc_lp:
    buffer_load_dwordx4 v[44:47], v0, s[8:11], s35 offen sc1
    s_add_u32 s16, s16, 1
    s_cmp_gt_u32 s16, 100000
    s_cbranch_scc1 Lr_abort
    s_waitcnt vmcnt(0)
    v_max3_u32 v10, v44, v45, v46
    v_max_u32 v10, v10, v47
    v_cmp_eq_u32 vcc, -1, v10
    s_nop 0
    s_cbranch_vccnz Lr3s_pc_lp
    s_branch Lr3s_pc_ok
Lr3s_last:
    s_waitcnt vmcnt(0) lgkmcnt(0)
    s_barrier
    s_branch Lr_exit
Lr_abort:
    s_waitcnt lgkmcnt(0)
    s_mov_b64 exec, -1
    v_mov_b32 v0, 60
    s_lshl_b32 s5, s3, 8
    s_or_b32 s5, s5, s4
    s_or_b32 s5, s5, 0x10000
    v_mov_b32 v1, s5
    global_store_dword v0, v1, s[12:13]
    s_endpgm
Lr_exit:
    s_endpgm
.section .rodata,"a"
.p2align 6
.amdhsa_kernel interleave_layers__sliding_local_dilated__memory_aug_recurrent_mem_tr__prompt_kernel
  .amdhsa_next_free_vgpr 512
  .amdhsa_next_free_sgpr 102
  .amdhsa_accum_offset 256
  .amdhsa_group_segment_fixed_size 0
  .amdhsa_kernarg_size 104
  .amdhsa_user_sgpr_count 2
  .amdhsa_user_sgpr_kernarg_segment_ptr 1
  .amdhsa_system_sgpr_workgroup_id_x 1
.end_amdhsa_kernel
```

```asm
; @launch grid=(256,1,1) block=(256,1,1) lds=163840
.amdgcn_target "amdgcn-amd-amdhsa--gfx950"
.text
.globl interleave_layers__sliding_local_dilated__memory_aug_recurrent_mem_tr__prompt_kernel
.p2align 8
.type interleave_layers__sliding_local_dilated__memory_aug_recurrent_mem_tr__prompt_kernel,@function
interleave_layers__sliding_local_dilated__memory_aug_recurrent_mem_tr__prompt_kernel:
    s_cmp_ge_u32 s2, 256
    s_cbranch_scc1 L_exit
    s_load_dwordx2 s[8:9], s[0:1], 96
    s_mov_b32 s10, 268435456
    s_mov_b32 s11, 0x00020000
    s_waitcnt lgkmcnt(0)
    s_and_b32 s9, s9, 0xffff
    s_load_dwordx2 s[12:13], s[0:1], 88
    v_lshrrev_b32 v1, 6, v0
    s_getreg_b32 s3, hwreg(HW_REG_XCC_ID)
    v_readfirstlane_b32 s14, v1
    s_and_b32 s3, s3, 7
    s_and_b32 s17, s3, 1
    s_lshl_b32 s17, s17, 7
    s_lshl_b32 s18, s3, 1
    s_and_b32 s18, s18, 12
    s_add_u32 s17, s17, s18
    v_mov_b32 v2, 0
    v_mov_b32 v3, 1
    v_mov_b32 v4, s17
    s_mov_b32 s33, 0
    s_waitcnt lgkmcnt(0)
    s_cmp_lg_u32 s14, 0
    s_cbranch_scc1 L_tk_wait
    s_mov_b64 exec, 1
    global_atomic_add v3, v4, v3, s[12:13] sc0
    s_waitcnt vmcnt(0)
    v_readfirstlane_b32 s4, v3
    s_nop 0
    s_cmp_lt_u32 s4, 32
    s_cbranch_scc1 L_tk_have
    v_mov_b32 v3, 1
    v_mov_b32 v4, 32
    global_atomic_add v3, v4, v3, s[12:13] sc0
    s_waitcnt vmcnt(0)
    v_readfirstlane_b32 s5, v3
    s_mov_b64 exec, 0xff
    v_and_b32 v4, 1, v0
    v_lshlrev_b32 v4, 7, v4
    v_lshlrev_b32 v5, 1, v0
    v_and_or_b32 v4, v5, 12, v4
    s_mov_b32 s16, 0
L_hl_poll:
    global_load_dword v5, v4, s[12:13] sc1
    s_add_u32 s16, s16, 1
    s_cmp_gt_u32 s16, 100000
    s_cbranch_scc1 L_abort
    s_mov_b32 s6, 0
    s_waitcnt vmcnt(0)
    v_readlane_b32 s40, v5, 0
    s_nop 0
    s_add_u32 s6, s6, s40
    v_readlane_b32 s41, v5, 1
    s_nop 0
    s_add_u32 s6, s6, s41
    v_readlane_b32 s42, v5, 2
    s_nop 0
    s_add_u32 s6, s6, s42
    v_readlane_b32 s43, v5, 3
    s_nop 0
    s_add_u32 s6, s6, s43
    v_readlane_b32 s44, v5, 4
    s_nop 0
    s_add_u32 s6, s6, s44
    v_readlane_b32 s45, v5, 5
    s_nop 0
    s_add_u32 s6, s6, s45
    v_readlane_b32 s46, v5, 6
    s_nop 0
    s_add_u32 s6, s6, s46
    v_readlane_b32 s47, v5, 7
    s_nop 0
    s_add_u32 s6, s6, s47
    s_cmp_lt_u32 s6, 256
    s_cbranch_scc1 L_hl_poll
    s_mov_b32 s3, 0
    s_mov_b32 s4, 0
    s_min_u32 s6, s47, 32
    s_sub_u32 s7, 32, s6
    s_cmp_lt_u32 s5, s7
    s_cselect_b32 s3, 7, s3
    s_add_u32 s6, s6, s5
    s_cmp_lt_u32 s5, s7
    s_cselect_b32 s4, s6, s4
    s_sub_u32 s5, s5, s7
    s_min_u32 s6, s46, 32
    s_sub_u32 s7, 32, s6
    s_cmp_lt_u32 s5, s7
    s_cselect_b32 s3, 6, s3
    s_add_u32 s6, s6, s5
    s_cmp_lt_u32 s5, s7
    s_cselect_b32 s4, s6, s4
    s_sub_u32 s5, s5, s7
    s_min_u32 s6, s45, 32
    s_sub_u32 s7, 32, s6
    s_cmp_lt_u32 s5, s7
    s_cselect_b32 s3, 5, s3
    s_add_u32 s6, s6, s5
    s_cmp_lt_u32 s5, s7
    s_cselect_b32 s4, s6, s4
    s_sub_u32 s5, s5, s7
    s_min_u32 s6, s44, 32
    s_sub_u32 s7, 32, s6
    s_cmp_lt_u32 s5, s7
    s_cselect_b32 s3, 4, s3
    s_add_u32 s6, s6, s5
    s_cmp_lt_u32 s5, s7
    s_cselect_b32 s4, s6, s4
    s_sub_u32 s5, s5, s7
    s_min_u32 s6, s43, 32
    s_sub_u32 s7, 32, s6
    s_cmp_lt_u32 s5, s7
    s_cselect_b32 s3, 3, s3
    s_add_u32 s6, s6, s5
    s_cmp_lt_u32 s5, s7
    s_cselect_b32 s4, s6, s4
    s_sub_u32 s5, s5, s7
    s_min_u32 s6, s42, 32
    s_sub_u32 s7, 32, s6
    s_cmp_lt_u32 s5, s7
    s_cselect_b32 s3, 2, s3
    s_add_u32 s6, s6, s5
    s_cmp_lt_u32 s5, s7
    s_cselect_b32 s4, s6, s4
    s_sub_u32 s5, s5, s7
    s_min_u32 s6, s41, 32
    s_sub_u32 s7, 32, s6
    s_cmp_lt_u32 s5, s7
    s_cselect_b32 s3, 1, s3
    s_add_u32 s6, s6, s5
    s_cmp_lt_u32 s5, s7
    s_cselect_b32 s4, s6, s4
    s_sub_u32 s5, s5, s7
    s_min_u32 s6, s40, 32
    s_sub_u32 s7, 32, s6
    s_cmp_lt_u32 s5, s7
    s_cselect_b32 s3, 0, s3
    s_add_u32 s6, s6, s5
    s_cmp_lt_u32 s5, s7
    s_cselect_b32 s4, s6, s4
    s_sub_u32 s5, s5, s7
L_tk_have:
    s_lshl_b32 s5, s3, 8
    s_or_b32 s5, s5, s4
    v_mov_b32 v3, s5
    s_mov_b64 exec, 1
    ds_write_b32 v2, v3
    s_mov_b64 exec, -1
L_tk_wait:
    s_waitcnt vmcnt(0) lgkmcnt(0)
    s_barrier
    ds_read_b32 v3, v2
    s_waitcnt lgkmcnt(0)
    v_readfirstlane_b32 s5, v3
    s_nop 0
    s_lshr_b32 s3, s5, 8
    s_and_b32 s4, s5, 255
    s_barrier
    s_cmp_lt_u32 s3, 2
    s_cbranch_scc1 L_role_r
    s_sub_u32 s6, s3, 2
    s_lshl_b32 s6, s6, 5
    s_add_u32 s6, s6, s4
    s_load_dwordx2 s[20:21], s[0:1], 8
    s_mov_b32 s22, 1990656
    s_mov_b32 s23, 0x00020000
    s_waitcnt lgkmcnt(0)
    s_and_b32 s21, s21, 0xffff
    s_load_dwordx2 s[24:25], s[0:1], 16
    s_mov_b32 s26, 663552
    s_mov_b32 s27, 0x00020000
    s_waitcnt lgkmcnt(0)
    s_and_b32 s25, s25, 0xffff
    s_sub_u32 s41, 191, s6
    s_lshl_b32 s41, s41, 15
    v_lshlrev_b32 v254, 7, v0
    buffer_load_dword v255, v254, s[20:23], s41 offen
    s_sub_u32 s41, s41, 1998848
    s_cmp_lt_u32 s41, 688128
    s_cselect_b32 s41, s41, 0x7f000000
    s_waitcnt vmcnt(0)
    buffer_load_dword v255, v254, s[24:27], s41 offen
    s_cmp_ge_u32 s6, 192
    s_cbranch_scc1 Li_end
    v_lshlrev_b32 v7, 4, v0
    v_mov_b32 v12, 0
    v_mov_b32 v13, 0
    v_mov_b32 v14, 0
    v_mov_b32 v15, 0
    s_cmp_ge_u32 s6, 64
    s_cbranch_scc1 Li_rest
    s_load_dwordx2 s[20:21], s[0:1], 0
    s_mov_b32 s22, 2359296
    s_mov_b32 s23, 0x00020000
    s_waitcnt lgkmcnt(0)
    s_and_b32 s21, s21, 0xffff
    v_and_b32 v1, 31, v0
    v_lshrrev_b32 v2, 5, v0
    v_mul_u32_u24 v3, 1152, v1
    v_mul_u32_u24 v5, 144, v2
    v_add_u32 v3, v3, v5
    s_mul_i32 s41, s6, 36864
    buffer_load_dwordx4 v[64:67], v3, s[20:23], s41 offen offset:0
    buffer_load_dwordx4 v[68:71], v3, s[20:23], s41 offen offset:16
    buffer_load_dwordx4 v[72:75], v3, s[20:23], s41 offen offset:32
    buffer_load_dwordx4 v[76:79], v3, s[20:23], s41 offen offset:48
    buffer_load_dwordx4 v[80:83], v3, s[20:23], s41 offen offset:64
    buffer_load_dwordx4 v[84:87], v3, s[20:23], s41 offen offset:80
    buffer_load_dwordx4 v[88:91], v3, s[20:23], s41 offen offset:96
    buffer_load_dwordx4 v[92:95], v3, s[20:23], s41 offen offset:112
    buffer_load_dwordx4 v[96:99], v3, s[20:23], s41 offen offset:128
    v_mul_u32_u24 v4, 4608, v2
    v_lshl_add_u32 v4, v1, 4, v4
    s_mul_i32 s41, s6, 36864
    s_add_u32 s41, s41, 6291456
    s_mul_i32 s42, s6, 6144
    s_add_u32 s42, s42, 15728640
    s_add_u32 s43, s42, 2048
    s_add_u32 s44, s42, 396288
    v_mov_b32 v60, 0
    v_mov_b32 v61, 0
    s_waitcnt vmcnt(8)
    buffer_store_dwordx4 v[64:67], v4, s[8:11], s41 offen offset:0 sc1
    s_waitcnt vmcnt(8)
    buffer_store_dwordx4 v[68:71], v4, s[8:11], s41 offen offset:512 sc1
    s_waitcnt vmcnt(8)
    buffer_store_dwordx4 v[72:75], v4, s[8:11], s41 offen offset:1024 sc1
    s_waitcnt vmcnt(8)
    buffer_store_dwordx4 v[76:79], v4, s[8:11], s41 offen offset:1536 sc1
    s_waitcnt vmcnt(8)
    buffer_store_dwordx4 v[80:83], v4, s[8:11], s41 offen offset:2048 sc1
    s_waitcnt vmcnt(8)
    buffer_store_dwordx4 v[84:87], v4, s[8:11], s41 offen offset:2560 sc1
    s_waitcnt vmcnt(8)
    buffer_store_dwordx4 v[88:91], v4, s[8:11], s41 offen offset:3072 sc1
    s_waitcnt vmcnt(8)
    buffer_store_dwordx4 v[92:95], v4, s[8:11], s41 offen offset:3584 sc1
    v_add_u32 v4, 4096, v4
    s_waitcnt vmcnt(8)
    buffer_store_dwordx4 v[96:99], v4, s[8:11], s41 offen offset:0 sc1
    buffer_store_dwordx4 v[12:15], v7, s[8:11], s43 offen sc1
    v_cmp_gt_u32 vcc, 192, v0
    s_nop 0
    s_and_saveexec_b64 s[46:47], vcc
    s_cbranch_execz Li_z1
    buffer_store_dwordx4 v[12:15], v7, s[8:11], s44 offen sc1
Li_z1:
    s_mov_b64 exec, s[46:47]
    v_mov_b32 v62, 0x3f803f80
    v_dot2c_f32_bf16 v60, v64, v62
    v_dot2c_f32_bf16 v61, v64, v64
    v_dot2c_f32_bf16 v60, v65, v62
    v_dot2c_f32_bf16 v61, v65, v65
    v_dot2c_f32_bf16 v60, v66, v62
    v_dot2c_f32_bf16 v61, v66, v66
    v_dot2c_f32_bf16 v60, v67, v62
    v_dot2c_f32_bf16 v61, v67, v67
    v_dot2c_f32_bf16 v60, v68, v62
    v_dot2c_f32_bf16 v61, v68, v68
    v_dot2c_f32_bf16 v60, v69, v62
    v_dot2c_f32_bf16 v61, v69, v69
    v_dot2c_f32_bf16 v60, v70, v62
    v_dot2c_f32_bf16 v61, v70, v70
    v_dot2c_f32_bf16 v60, v71, v62
    v_dot2c_f32_bf16 v61, v71, v71
    v_dot2c_f32_bf16 v60, v72, v62
    v_dot2c_f32_bf16 v61, v72, v72
    v_dot2c_f32_bf16 v60, v73, v62
    v_dot2c_f32_bf16 v61, v73, v73
    v_dot2c_f32_bf16 v60, v74, v62
    v_dot2c_f32_bf16 v61, v74, v74
    v_dot2c_f32_bf16 v60, v75, v62
    v_dot2c_f32_bf16 v61, v75, v75
    v_dot2c_f32_bf16 v60, v76, v62
    v_dot2c_f32_bf16 v61, v76, v76
    v_dot2c_f32_bf16 v60, v77, v62
    v_dot2c_f32_bf16 v61, v77, v77
    v_dot2c_f32_bf16 v60, v78, v62
    v_dot2c_f32_bf16 v61, v78, v78
    v_dot2c_f32_bf16 v60, v79, v62
    v_dot2c_f32_bf16 v61, v79, v79
    v_dot2c_f32_bf16 v60, v80, v62
    v_dot2c_f32_bf16 v61, v80, v80
    v_dot2c_f32_bf16 v60, v81, v62
    v_dot2c_f32_bf16 v61, v81, v81
    v_dot2c_f32_bf16 v60, v82, v62
    v_dot2c_f32_bf16 v61, v82, v82
    v_dot2c_f32_bf16 v60, v83, v62
    v_dot2c_f32_bf16 v61, v83, v83
    v_dot2c_f32_bf16 v60, v84, v62
    v_dot2c_f32_bf16 v61, v84, v84
    v_dot2c_f32_bf16 v60, v85, v62
    v_dot2c_f32_bf16 v61, v85, v85
    v_dot2c_f32_bf16 v60, v86, v62
    v_dot2c_f32_bf16 v61, v86, v86
    v_dot2c_f32_bf16 v60, v87, v62
    v_dot2c_f32_bf16 v61, v87, v87
    v_dot2c_f32_bf16 v60, v88, v62
    v_dot2c_f32_bf16 v61, v88, v88
    v_dot2c_f32_bf16 v60, v89, v62
    v_dot2c_f32_bf16 v61, v89, v89
    v_dot2c_f32_bf16 v60, v90, v62
    v_dot2c_f32_bf16 v61, v90, v90
    v_dot2c_f32_bf16 v60, v91, v62
    v_dot2c_f32_bf16 v61, v91, v91
    v_dot2c_f32_bf16 v60, v92, v62
    v_dot2c_f32_bf16 v61, v92, v92
    v_dot2c_f32_bf16 v60, v93, v62
    v_dot2c_f32_bf16 v61, v93, v93
    v_dot2c_f32_bf16 v60, v94, v62
    v_dot2c_f32_bf16 v61, v94, v94
    v_dot2c_f32_bf16 v60, v95, v62
    v_dot2c_f32_bf16 v61, v95, v95
    v_dot2c_f32_bf16 v60, v96, v62
    v_dot2c_f32_bf16 v61, v96, v96
    v_dot2c_f32_bf16 v60, v97, v62
    v_dot2c_f32_bf16 v61, v97, v97
    v_dot2c_f32_bf16 v60, v98, v62
    v_dot2c_f32_bf16 v61, v98, v98
    v_dot2c_f32_bf16 v60, v99, v62
    v_dot2c_f32_bf16 v61, v99, v99
    s_nop 3
    v_lshrrev_b32 v5, 1, v2
    v_lshlrev_b32 v5, 9, v5
    v_lshl_add_u32 v5, v1, 4, v5
    v_and_b32 v6, 1, v2
    v_lshl_add_u32 v5, v6, 3, v5
    buffer_store_dwordx2 v[60:61], v5, s[8:11], s42 offen sc1
    s_branch Li_flags
Li_rest:
    s_cmp_ge_u32 s6, 128
    s_cbranch_scc1 Li_pre
    s_sub_u32 s41, s6, 64
    s_mul_i32 s41, s41, 6144
    s_add_u32 s41, s41, 16911360
    v_cmp_gt_u32 vcc, 192, v0
    s_nop 0
    s_and_saveexec_b64 s[42:43], vcc
    s_cbranch_execz Li_rest2
    buffer_store_dwordx4 v[12:15], v7, s[8:11], s41 offen sc1
Li_rest2:
    s_mov_b64 exec, s[42:43]
    s_load_dwordx2 s[20:21], s[0:1], 80
    s_mov_b32 s22, 2359296
    s_mov_b32 s23, 0x00020000
    s_waitcnt lgkmcnt(0)
    s_and_b32 s21, s21, 0xffff
    s_sub_u32 s44, s6, 64
    s_mul_i32 s45, s44, 36864
    s_add_u32 s46, s45, 19660800
    buffer_store_dwordx4 v[12:15], v7, s[8:11], s46 offen sc1
    buffer_store_dwordx4 v[12:15], v7, s[20:23], s45 offen sc1
    s_add_u32 s46, s46, 4096
    s_add_u32 s45, s45, 4096
    buffer_store_dwordx4 v[12:15], v7, s[8:11], s46 offen sc1
    buffer_store_dwordx4 v[12:15], v7, s[20:23], s45 offen sc1
    s_add_u32 s46, s46, 4096
    s_add_u32 s45, s45, 4096
    buffer_store_dwordx4 v[12:15], v7, s[8:11], s46 offen sc1
    buffer_store_dwordx4 v[12:15], v7, s[20:23], s45 offen sc1
    s_add_u32 s46, s46, 4096
    s_add_u32 s45, s45, 4096
    buffer_store_dwordx4 v[12:15], v7, s[8:11], s46 offen sc1
    buffer_store_dwordx4 v[12:15], v7, s[20:23], s45 offen sc1
    s_add_u32 s46, s46, 4096
    s_add_u32 s45, s45, 4096
    buffer_store_dwordx4 v[12:15], v7, s[8:11], s46 offen sc1
    buffer_store_dwordx4 v[12:15], v7, s[20:23], s45 offen sc1
    s_add_u32 s46, s46, 4096
    s_add_u32 s45, s45, 4096
    buffer_store_dwordx4 v[12:15], v7, s[8:11], s46 offen sc1
    buffer_store_dwordx4 v[12:15], v7, s[20:23], s45 offen sc1
    s_add_u32 s46, s46, 4096
    s_add_u32 s45, s45, 4096
    buffer_store_dwordx4 v[12:15], v7, s[8:11], s46 offen sc1
    buffer_store_dwordx4 v[12:15], v7, s[20:23], s45 offen sc1
    s_add_u32 s46, s46, 4096
    s_add_u32 s45, s45, 4096
    buffer_store_dwordx4 v[12:15], v7, s[8:11], s46 offen sc1
    buffer_store_dwordx4 v[12:15], v7, s[20:23], s45 offen sc1
    s_add_u32 s46, s46, 4096
    s_add_u32 s45, s45, 4096
    buffer_store_dwordx4 v[12:15], v7, s[8:11], s46 offen sc1
    buffer_store_dwordx4 v[12:15], v7, s[20:23], s45 offen sc1
    s_mul_i32 s45, s44, 6144
    s_add_u32 s45, s45, 16515072
    buffer_store_dwordx4 v[12:15], v7, s[8:11], s45 offen sc1
    s_add_u32 s46, s45, 4096
    s_add_u32 s45, s45, 393216
    buffer_store_dwordx4 v[12:15], v7, s[8:11], s45 offen sc1
    v_cmp_gt_u32 vcc, 128, v0
    s_nop 0
    s_and_saveexec_b64 s[42:43], vcc
    s_cbranch_execz Li_rest3
    buffer_store_dwordx4 v[12:15], v7, s[8:11], s46 offen sc1
Li_rest3:
    s_mov_b64 exec, s[42:43]
    s_branch Li_flags
Li_pre:
    s_sub_u32 s44, s6, 128
    s_mul_i32 s45, s44, 36864
    s_add_u32 s45, s45, 17301504
    buffer_store_dwordx4 v[12:15], v7, s[8:11], s45 offen sc1
    s_add_u32 s45, s45, 4096
    buffer_store_dwordx4 v[12:15], v7, s[8:11], s45 offen sc1
    s_add_u32 s45, s45, 4096
    buffer_store_dwordx4 v[12:15], v7, s[8:11], s45 offen sc1
    s_add_u32 s45, s45, 4096
    buffer_store_dwordx4 v[12:15], v7, s[8:11], s45 offen sc1
    s_add_u32 s45, s45, 4096
    buffer_store_dwordx4 v[12:15], v7, s[8:11], s45 offen sc1
    s_add_u32 s45, s45, 4096
    buffer_store_dwordx4 v[12:15], v7, s[8:11], s45 offen sc1
    s_add_u32 s45, s45, 4096
    buffer_store_dwordx4 v[12:15], v7, s[8:11], s45 offen sc1
    s_add_u32 s45, s45, 4096
    buffer_store_dwordx4 v[12:15], v7, s[8:11], s45 offen sc1
    s_add_u32 s45, s45, 4096
    buffer_store_dwordx4 v[12:15], v7, s[8:11], s45 offen sc1
    s_mul_i32 s45, s44, 6144
    s_add_u32 s45, s45, 16121856
    v_cmp_gt_u32 vcc, 192, v0
    s_nop 0
    s_and_saveexec_b64 s[46:47], vcc
    s_cbranch_execz Li_z0
    buffer_store_dwordx4 v[12:15], v7, s[8:11], s45 offen sc1
Li_z0:
    s_mov_b64 exec, s[46:47]
    s_cmp_ge_u32 s6, 136
    s_cbranch_scc1 Li_nofl
Li_flags:
    v_cmp_gt_u32 vcc, 96, v0
    s_cmp_lt_u32 s6, 64
    s_cselect_b64 s[42:43], -1, 0
    s_and_b64 vcc, vcc, s[42:43]
    s_cmp_lt_u32 s6, 128
    s_cselect_b32 s44, 0, 0
    v_mov_b32 v12, s44
    v_mov_b32 v13, s44
    v_mov_b32 v14, s44
    v_mov_b32 v15, s44
    v_mov_b32 v9, 1
    v_cndmask_b32 v8, v12, v9, vcc
    v_mov_b32 v9, v8
    v_mov_b32 v10, v8
    v_mov_b32 v11, v8
    s_mul_i32 s41, s6, 22528
    s_sub_u32 s42, s6, 128
    s_lshl_b32 s42, s42, 12
    s_add_u32 s42, s42, 2883584
    s_cmp_ge_u32 s6, 128
    s_cselect_b32 s41, s42, s41
    buffer_store_dwordx4 v[8:11], v7, s[8:11], s41 offen sc1
    s_cbranch_scc1 Li_nofl
    s_add_u32 s41, s41, 4096
    buffer_store_dwordx4 v[12:15], v7, s[8:11], s41 offen sc1
    s_add_u32 s41, s41, 4096
    buffer_store_dwordx4 v[12:15], v7, s[8:11], s41 offen sc1
    s_add_u32 s41, s41, 4096
    buffer_store_dwordx4 v[12:15], v7, s[8:11], s41 offen sc1
    s_add_u32 s41, s41, 4096
    buffer_store_dwordx4 v[12:15], v7, s[8:11], s41 offen sc1
    s_add_u32 s41, s41, 4096
    v_cmp_gt_u32 vcc, 128, v0
    s_nop 0
    s_and_saveexec_b64 s[42:43], vcc
    s_cbranch_execz Li_fl5
    buffer_store_dwordx4 v[12:15], v7, s[8:11], s41 offen sc1
Li_fl5:
    s_mov_b64 exec, s[42:43]
Li_nofl:
    s_waitcnt vmcnt(0)
    s_barrier
    s_cmp_lg_u32 s14, 0
    s_cbranch_scc1 Li_end
    s_sub_u32 s41, s6, 64
    s_cmp_lt_u32 s41, 64
    s_cbranch_scc1 Li_l1
    v_mov_b32 v2, 40
    v_mov_b32 v3, 1
    s_mov_b64 exec, 1
    global_atomic_add v2, v3, s[12:13]
    s_mov_b64 exec, -1
    s_branch Li_end
Li_l1:
    v_mov_b32 v2, 160
    v_mov_b32 v3, 1
    s_mov_b64 exec, 1
    global_atomic_add v2, v3, s[12:13]
    s_mov_b64 exec, -1
Li_end:
    s_cmp_lg_u32 s3, 2
    s_cbranch_scc1 L_cls2_no
    s_add_u32 s15, s4, 0
    s_cmp_lt_u32 s4, 24
    s_cbranch_scc1 L_role_tw
    s_add_u32 s15, s4, 4294967272
    s_cmp_lt_u32 s4, 32
    s_cbranch_scc1 L_role_p
    s_endpgm
L_cls2_no:
    s_cmp_lg_u32 s3, 3
    s_cbranch_scc1 L_cls3_no
    s_add_u32 s15, s4, 24
    s_cmp_lt_u32 s4, 12
    s_cbranch_scc1 L_role_tw
    s_add_u32 s15, s4, 4294967292
    s_cmp_lt_u32 s4, 32
    s_cbranch_scc1 L_role_p
    s_endpgm
L_cls3_no:
    s_cmp_lg_u32 s3, 4
    s_cbranch_scc1 L_cls4_no
    s_add_u32 s15, s4, 0
    s_cmp_lt_u32 s4, 16
    s_cbranch_scc1 L_role_aq
    s_add_u32 s15, s4, 4294967280
    s_cmp_lt_u32 s4, 19
    s_cbranch_scc1 L_role_awo
    s_add_u32 s15, s4, 9
    s_cmp_lt_u32 s4, 32
    s_cbranch_scc1 L_role_p
    s_endpgm
L_cls4_no:
    s_cmp_lg_u32 s3, 5
    s_cbranch_scc1 L_cls5_no
    s_add_u32 s15, s4, 16
    s_cmp_lt_u32 s4, 16
    s_cbranch_scc1 L_role_aq
    s_add_u32 s15, s4, 4294967283
    s_cmp_lt_u32 s4, 19
    s_cbranch_scc1 L_role_awo
    s_add_u32 s15, s4, 22
    s_cmp_lt_u32 s4, 32
    s_cbranch_scc1 L_role_p
    s_endpgm
L_cls5_no:
    s_cmp_lg_u32 s3, 6
    s_cbranch_scc1 L_cls6_no
    s_add_u32 s15, s4, 0
    s_cmp_lt_u32 s4, 11
    s_cbranch_scc1 L_role_ta
    s_add_u32 s15, s4, 43
    s_cmp_lt_u32 s4, 32
    s_cbranch_scc1 L_role_p
    s_endpgm
L_cls6_no:
    s_cmp_lg_u32 s3, 7
    s_cbranch_scc1 L_cls7_no
    s_add_u32 s15, s4, 11
    s_cmp_lt_u32 s4, 11
    s_cbranch_scc1 L_role_ta
    s_add_u32 s15, s4, 64
    s_cmp_lt_u32 s4, 32
    s_cbranch_scc1 L_role_p
    s_endpgm
L_cls7_no:
L_exit:
    s_endpgm
L_abort:
    s_waitcnt lgkmcnt(0)
    s_mov_b64 exec, -1
    v_mov_b32 v0, 60
    s_lshl_b32 s5, s3, 8
    s_or_b32 s5, s5, s4
    s_or_b32 s5, s5, 0x10000
    v_mov_b32 v1, s5
    global_store_dword v0, v1, s[12:13]
    s_endpgm
.p2align 6
L_role_p:
    v_and_b32 v5, 63, v0
    v_lshlrev_b32 v0, 4, v5
    v_and_b32 v7, 15, v5
    v_lshrrev_b32 v8, 4, v5
    v_min_u32 v1, 11, v5
    v_lshrrev_b32 v6, 2, v1
    v_and_b32 v1, 3, v1
    v_lshlrev_b32 v1, 2, v1
    v_lshl_add_u32 v1, v6, 7, v1
    v_mov_b32 v3, 1
    v_mov_b32 v4, 0
    s_mov_b32 s44, 0x05040100
    s_mov_b32 s45, 0x07060302
    s_cmp_ge_u32 s15, 48
    s_cselect_b32 s63, 1, 0
    s_cselect_b32 s17, 48, 0
    s_sub_u32 s15, s15, s17
    s_cmp_lt_u32 s15, 32
    s_cselect_b32 s50, 1, 0
    s_sub_u32 s17, s15, 32
    s_lshl_b32 s17, s17, 1
    s_cmp_eq_u32 s50, 1
    s_cselect_b32 s51, s15, s17
    s_cselect_b32 s17, 48, 40
    s_cselect_b32 s18, 56, 40
    s_load_dwordx2 s[20:21], s[0:1], s17
    s_load_dwordx2 s[24:25], s[0:1], s18
    s_mov_b32 s22, 4718592
    s_mov_b32 s23, 0x00020000
    s_mov_b32 s26, 4718592
    s_mov_b32 s27, 0x00020000
    s_lshl_b32 s49, s51, 8
    s_mul_i32 s17, s14, 131072
    s_add_u32 s49, s49, s17
    s_cmp_eq_u32 s50, 1
    s_cselect_b32 s17, 0, 256
    s_add_u32 s52, s49, s17
    s_waitcnt lgkmcnt(0)
    s_and_b32 s21, s21, 0xffff
    s_and_b32 s25, s25, 0xffff
    s_cmp_eq_u32 s63, 0
    s_cbranch_scc1 Lp2_gate_ng
    s_cmp_lg_u32 s14, 0
    s_cbranch_scc1 Lp2_gate_d
    v_mov_b32 v5, 48
    s_mov_b32 s16, 0
Lp2_gate:
    global_load_dword v6, v5, s[12:13] sc1
    s_add_u32 s16, s16, 1
    s_cmp_gt_u32 s16, 100000
    s_cbranch_scc1 L_role_p_abort
    s_waitcnt vmcnt(0)
    v_cmp_gt_u32 vcc, 32, v6
    s_nop 0
    s_cbranch_vccz Lp2_gate_d
    s_sleep 100
    s_branch Lp2_gate
Lp2_gate_d:
    s_barrier
Lp2_gate_ng:
    v_lshrrev_b32 v5, 8, v0
    v_bfe_u32 v6, v0, 6, 2
    v_xor_b32 v6, v6, v5
    v_lshlrev_b32 v6, 6, v6
    v_and_b32 v16, 0x30, v0
    v_add_u32 v16, v16, v6
    v_lshl_add_u32 v16, v5, 13, v16
    v_lshrrev_b32 v5, 2, v7
    v_xor_b32 v6, s14, v5
    v_lshlrev_b32 v17, 6, v6
    v_lshrrev_b32 v6, 1, v8
    v_lshl_add_u32 v5, v6, 3, v5
    v_lshl_add_u32 v17, v5, 8, v17
    v_and_b32 v5, 1, v8
    v_lshl_add_u32 v17, v5, 5, v17
    v_and_b32 v5, 3, v7
    v_lshl_add_u32 v17, v5, 3, v17
    v_add_u32 v18, 65536, v17
    s_lshl_b32 s46, s14, 12
    s_add_u32 m0, s46, 0
    s_add_u32 s17, s49, 0
    buffer_load_dwordx4 v16, s[20:23], s17 offen lds
    s_add_u32 m0, m0, 1024
    s_add_u32 s17, s49, 32768
    buffer_load_dwordx4 v16, s[20:23], s17 offen lds
    s_add_u32 m0, m0, 1024
    s_add_u32 s17, s49, 65536
    buffer_load_dwordx4 v16, s[20:23], s17 offen lds
    s_add_u32 m0, m0, 1024
    s_add_u32 s17, s49, 98304
    buffer_load_dwordx4 v16, s[20:23], s17 offen lds
    s_add_u32 m0, s46, 16384
    s_add_u32 s17, s49, 524288
    buffer_load_dwordx4 v16, s[20:23], s17 offen lds
    s_add_u32 m0, m0, 1024
    s_add_u32 s17, s49, 557056
    buffer_load_dwordx4 v16, s[20:23], s17 offen lds
    s_add_u32 m0, m0, 1024
    s_add_u32 s17, s49, 589824
    buffer_load_dwordx4 v16, s[20:23], s17 offen lds
    s_add_u32 m0, m0, 1024
    s_add_u32 s17, s49, 622592
    buffer_load_dwordx4 v16, s[20:23], s17 offen lds
    s_add_u32 m0, s46, 32768
    s_add_u32 s17, s49, 1048576
    buffer_load_dwordx4 v16, s[20:23], s17 offen lds
    s_add_u32 m0, m0, 1024
    s_add_u32 s17, s49, 1081344
    buffer_load_dwordx4 v16, s[20:23], s17 offen lds
    s_add_u32 m0, m0, 1024
    s_add_u32 s17, s49, 1114112
    buffer_load_dwordx4 v16, s[20:23], s17 offen lds
    s_add_u32 m0, m0, 1024
    s_add_u32 s17, s49, 1146880
    buffer_load_dwordx4 v16, s[20:23], s17 offen lds
    s_add_u32 m0, s46, 49152
    s_add_u32 s17, s49, 1572864
    buffer_load_dwordx4 v16, s[20:23], s17 offen lds
    s_add_u32 m0, m0, 1024
    s_add_u32 s17, s49, 1605632
    buffer_load_dwordx4 v16, s[20:23], s17 offen lds
    s_add_u32 m0, m0, 1024
    s_add_u32 s17, s49, 1638400
    buffer_load_dwordx4 v16, s[20:23], s17 offen lds
    s_add_u32 m0, m0, 1024
    s_add_u32 s17, s49, 1671168
    buffer_load_dwordx4 v16, s[20:23], s17 offen lds
    s_add_u32 m0, s46, 65536
    s_add_u32 s17, s49, 2097152
    buffer_load_dwordx4 v16, s[20:23], s17 offen lds
    s_add_u32 m0, m0, 1024
    s_add_u32 s17, s49, 2129920
    buffer_load_dwordx4 v16, s[20:23], s17 offen lds
    s_add_u32 m0, m0, 1024
    s_add_u32 s17, s49, 2162688
    buffer_load_dwordx4 v16, s[20:23], s17 offen lds
    s_add_u32 m0, m0, 1024
    s_add_u32 s17, s49, 2195456
    buffer_load_dwordx4 v16, s[20:23], s17 offen lds
    s_add_u32 m0, s46, 81920
    s_add_u32 s17, s49, 2621440
    buffer_load_dwordx4 v16, s[20:23], s17 offen lds
    s_add_u32 m0, m0, 1024
    s_add_u32 s17, s49, 2654208
    buffer_load_dwordx4 v16, s[20:23], s17 offen lds
    s_add_u32 m0, m0, 1024
    s_add_u32 s17, s49, 2686976
    buffer_load_dwordx4 v16, s[20:23], s17 offen lds
    s_add_u32 m0, m0, 1024
    s_add_u32 s17, s49, 2719744
    buffer_load_dwordx4 v16, s[20:23], s17 offen lds
    s_add_u32 m0, s46, 98304
    s_add_u32 s17, s49, 3145728
    buffer_load_dwordx4 v16, s[20:23], s17 offen lds
    s_add_u32 m0, m0, 1024
    s_add_u32 s17, s49, 3178496
    buffer_load_dwordx4 v16, s[20:23], s17 offen lds
    s_add_u32 m0, m0, 1024
    s_add_u32 s17, s49, 3211264
    buffer_load_dwordx4 v16, s[20:23], s17 offen lds
    s_add_u32 m0, m0, 1024
    s_add_u32 s17, s49, 3244032
    buffer_load_dwordx4 v16, s[20:23], s17 offen lds
    s_waitcnt vmcnt(24)
    s_barrier
    s_add_u32 m0, s46, 114688
    s_add_u32 s17, s49, 3670016
    buffer_load_dwordx4 v16, s[20:23], s17 offen lds
    s_add_u32 m0, m0, 1024
    s_add_u32 s17, s49, 3702784
    buffer_load_dwordx4 v16, s[20:23], s17 offen lds
    s_add_u32 m0, m0, 1024
    s_add_u32 s17, s49, 3735552
    buffer_load_dwordx4 v16, s[20:23], s17 offen lds
    s_add_u32 m0, m0, 1024
    s_add_u32 s17, s49, 3768320
    buffer_load_dwordx4 v16, s[20:23], s17 offen lds
    ds_read_b64_tr_b16 a[0:1], v17 offset:0
    ds_read_b64_tr_b16 a[2:3], v17 offset:1024
    ds_read_b64_tr_b16 a[4:5], v17 offset:4096
    ds_read_b64_tr_b16 a[6:7], v17 offset:5120
    ds_read_b64_tr_b16 a[8:9], v17 offset:8192
    ds_read_b64_tr_b16 a[10:11], v17 offset:9216
    ds_read_b64_tr_b16 a[12:13], v17 offset:12288
    ds_read_b64_tr_b16 a[14:15], v17 offset:13312
    s_waitcnt lgkmcnt(0)
    s_waitcnt vmcnt(24)
    s_barrier
    s_add_u32 m0, s46, 0
    s_add_u32 s17, s49, 4194304
    buffer_load_dwordx4 v16, s[20:23], s17 offen lds
    s_add_u32 m0, m0, 1024
    s_add_u32 s17, s49, 4227072
    buffer_load_dwordx4 v16, s[20:23], s17 offen lds
    s_add_u32 m0, m0, 1024
    s_add_u32 s17, s49, 4259840
    buffer_load_dwordx4 v16, s[20:23], s17 offen lds
    s_add_u32 m0, m0, 1024
    s_add_u32 s17, s49, 4292608
    buffer_load_dwordx4 v16, s[20:23], s17 offen lds
    ds_read_b64_tr_b16 a[16:17], v17 offset:16384
    ds_read_b64_tr_b16 a[18:19], v17 offset:17408
    ds_read_b64_tr_b16 a[20:21], v17 offset:20480
    ds_read_b64_tr_b16 a[22:23], v17 offset:21504
    ds_read_b64_tr_b16 a[24:25], v17 offset:24576
    ds_read_b64_tr_b16 a[26:27], v17 offset:25600
    ds_read_b64_tr_b16 a[28:29], v17 offset:28672
    ds_read_b64_tr_b16 a[30:31], v17 offset:29696
    s_waitcnt lgkmcnt(0)
    s_waitcnt vmcnt(24)
    s_barrier
    s_add_u32 m0, s46, 16384
    s_add_u32 s17, s52, 0
    buffer_load_dwordx4 v16, s[24:27], s17 offen lds
    s_add_u32 m0, m0, 1024
    s_add_u32 s17, s52, 32768
    buffer_load_dwordx4 v16, s[24:27], s17 offen lds
    s_add_u32 m0, m0, 1024
    s_add_u32 s17, s52, 65536
    buffer_load_dwordx4 v16, s[24:27], s17 offen lds
    s_add_u32 m0, m0, 1024
    s_add_u32 s17, s52, 98304
    buffer_load_dwordx4 v16, s[24:27], s17 offen lds
    ds_read_b64_tr_b16 a[32:33], v17 offset:32768
    ds_read_b64_tr_b16 a[34:35], v17 offset:33792
    ds_read_b64_tr_b16 a[36:37], v17 offset:36864
    ds_read_b64_tr_b16 a[38:39], v17 offset:37888
    ds_read_b64_tr_b16 a[40:41], v17 offset:40960
    ds_read_b64_tr_b16 a[42:43], v17 offset:41984
    ds_read_b64_tr_b16 a[44:45], v17 offset:45056
    ds_read_b64_tr_b16 a[46:47], v17 offset:46080
    s_waitcnt lgkmcnt(0)
    s_waitcnt vmcnt(24)
    s_barrier
    s_add_u32 m0, s46, 32768
    s_add_u32 s17, s52, 524288
    buffer_load_dwordx4 v16, s[24:27], s17 offen lds
    s_add_u32 m0, m0, 1024
    s_add_u32 s17, s52, 557056
    buffer_load_dwordx4 v16, s[24:27], s17 offen lds
    s_add_u32 m0, m0, 1024
    s_add_u32 s17, s52, 589824
    buffer_load_dwordx4 v16, s[24:27], s17 offen lds
    s_add_u32 m0, m0, 1024
    s_add_u32 s17, s52, 622592
    buffer_load_dwordx4 v16, s[24:27], s17 offen lds
    ds_read_b64_tr_b16 a[48:49], v17 offset:49152
    ds_read_b64_tr_b16 a[50:51], v17 offset:50176
    ds_read_b64_tr_b16 a[52:53], v17 offset:53248
    ds_read_b64_tr_b16 a[54:55], v17 offset:54272
    ds_read_b64_tr_b16 a[56:57], v17 offset:57344
    ds_read_b64_tr_b16 a[58:59], v17 offset:58368
    ds_read_b64_tr_b16 a[60:61], v17 offset:61440
    ds_read_b64_tr_b16 a[62:63], v17 offset:62464
    s_waitcnt lgkmcnt(0)
    s_waitcnt vmcnt(24)
    s_barrier
    s_add_u32 m0, s46, 49152
    s_add_u32 s17, s52, 1048576
    buffer_load_dwordx4 v16, s[24:27], s17 offen lds
    s_add_u32 m0, m0, 1024
    s_add_u32 s17, s52, 1081344
    buffer_load_dwordx4 v16, s[24:27], s17 offen lds
    s_add_u32 m0, m0, 1024
    s_add_u32 s17, s52, 1114112
    buffer_load_dwordx4 v16, s[24:27], s17 offen lds
    s_add_u32 m0, m0, 1024
    s_add_u32 s17, s52, 1146880
    buffer_load_dwordx4 v16, s[24:27], s17 offen lds
    ds_read_b64_tr_b16 a[64:65], v18 offset:0
    ds_read_b64_tr_b16 a[66:67], v18 offset:1024
    ds_read_b64_tr_b16 a[68:69], v18 offset:4096
    ds_read_b64_tr_b16 a[70:71], v18 offset:5120
    ds_read_b64_tr_b16 a[72:73], v18 offset:8192
    ds_read_b64_tr_b16 a[74:75], v18 offset:9216
    ds_read_b64_tr_b16 a[76:77], v18 offset:12288
    ds_read_b64_tr_b16 a[78:79], v18 offset:13312
    s_waitcnt lgkmcnt(0)
    s_waitcnt vmcnt(24)
    s_barrier
    s_add_u32 m0, s46, 65536
    s_add_u32 s17, s52, 1572864
    buffer_load_dwordx4 v16, s[24:27], s17 offen lds
    s_add_u32 m0, m0, 1024
    s_add_u32 s17, s52, 1605632
    buffer_load_dwordx4 v16, s[24:27], s17 offen lds
    s_add_u32 m0, m0, 1024
    s_add_u32 s17, s52, 1638400
    buffer_load_dwordx4 v16, s[24:27], s17 offen lds
    s_add_u32 m0, m0, 1024
    s_add_u32 s17, s52, 1671168
    buffer_load_dwordx4 v16, s[24:27], s17 offen lds
    ds_read_b64_tr_b16 a[80:81], v18 offset:16384
    ds_read_b64_tr_b16 a[82:83], v18 offset:17408
    ds_read_b64_tr_b16 a[84:85], v18 offset:20480
    ds_read_b64_tr_b16 a[86:87], v18 offset:21504
    ds_read_b64_tr_b16 a[88:89], v18 offset:24576
    ds_read_b64_tr_b16 a[90:91], v18 offset:25600
    ds_read_b64_tr_b16 a[92:93], v18 offset:28672
    ds_read_b64_tr_b16 a[94:95], v18 offset:29696
    s_waitcnt lgkmcnt(0)
    s_waitcnt vmcnt(24)
    s_barrier
    s_add_u32 m0, s46, 81920
    s_add_u32 s17, s52, 2097152
    buffer_load_dwordx4 v16, s[24:27], s17 offen lds
    s_add_u32 m0, m0, 1024
    s_add_u32 s17, s52, 2129920
    buffer_load_dwordx4 v16, s[24:27], s17 offen lds
    s_add_u32 m0, m0, 1024
    s_add_u32 s17, s52, 2162688
    buffer_load_dwordx4 v16, s[24:27], s17 offen lds
    s_add_u32 m0, m0, 1024
    s_add_u32 s17, s52, 2195456
    buffer_load_dwordx4 v16, s[24:27], s17 offen lds
    ds_read_b64_tr_b16 a[96:97], v18 offset:32768
    ds_read_b64_tr_b16 a[98:99], v18 offset:33792
    ds_read_b64_tr_b16 a[100:101], v18 offset:36864
    ds_read_b64_tr_b16 a[102:103], v18 offset:37888
    ds_read_b64_tr_b16 a[104:105], v18 offset:40960
    ds_read_b64_tr_b16 a[106:107], v18 offset:41984
    ds_read_b64_tr_b16 a[108:109], v18 offset:45056
    ds_read_b64_tr_b16 a[110:111], v18 offset:46080
    s_waitcnt lgkmcnt(0)
    s_waitcnt vmcnt(24)
    s_barrier
    s_add_u32 m0, s46, 98304
    s_add_u32 s17, s52, 2621440
    buffer_load_dwordx4 v16, s[24:27], s17 offen lds
    s_add_u32 m0, m0, 1024
    s_add_u32 s17, s52, 2654208
    buffer_load_dwordx4 v16, s[24:27], s17 offen lds
    s_add_u32 m0, m0, 1024
    s_add_u32 s17, s52, 2686976
    buffer_load_dwordx4 v16, s[24:27], s17 offen lds
    s_add_u32 m0, m0, 1024
    s_add_u32 s17, s52, 2719744
    buffer_load_dwordx4 v16, s[24:27], s17 offen lds
    ds_read_b64_tr_b16 a[112:113], v18 offset:49152
    ds_read_b64_tr_b16 a[114:115], v18 offset:50176
    ds_read_b64_tr_b16 a[116:117], v18 offset:53248
    ds_read_b64_tr_b16 a[118:119], v18 offset:54272
    ds_read_b64_tr_b16 a[120:121], v18 offset:57344
    ds_read_b64_tr_b16 a[122:123], v18 offset:58368
    ds_read_b64_tr_b16 a[124:125], v18 offset:61440
    ds_read_b64_tr_b16 a[126:127], v18 offset:62464
    s_waitcnt lgkmcnt(0)
    s_waitcnt vmcnt(24)
    s_barrier
    s_add_u32 m0, s46, 114688
    s_add_u32 s17, s52, 3145728
    buffer_load_dwordx4 v16, s[24:27], s17 offen lds
    s_add_u32 m0, m0, 1024
    s_add_u32 s17, s52, 3178496
    buffer_load_dwordx4 v16, s[24:27], s17 offen lds
    s_add_u32 m0, m0, 1024
    s_add_u32 s17, s52, 3211264
    buffer_load_dwordx4 v16, s[24:27], s17 offen lds
    s_add_u32 m0, m0, 1024
    s_add_u32 s17, s52, 3244032
    buffer_load_dwordx4 v16, s[24:27], s17 offen lds
    ds_read_b64_tr_b16 a[128:129], v17 offset:0
    ds_read_b64_tr_b16 a[130:131], v17 offset:1024
    ds_read_b64_tr_b16 a[132:133], v17 offset:4096
    ds_read_b64_tr_b16 a[134:135], v17 offset:5120
    ds_read_b64_tr_b16 a[136:137], v17 offset:8192
    ds_read_b64_tr_b16 a[138:139], v17 offset:9216
    ds_read_b64_tr_b16 a[140:141], v17 offset:12288
    ds_read_b64_tr_b16 a[142:143], v17 offset:13312
    s_waitcnt lgkmcnt(0)
    s_waitcnt vmcnt(24)
    s_barrier
    s_add_u32 m0, s46, 0
    s_add_u32 s17, s52, 3670016
    buffer_load_dwordx4 v16, s[24:27], s17 offen lds
    s_add_u32 m0, m0, 1024
    s_add_u32 s17, s52, 3702784
    buffer_load_dwordx4 v16, s[24:27], s17 offen lds
    s_add_u32 m0, m0, 1024
    s_add_u32 s17, s52, 3735552
    buffer_load_dwordx4 v16, s[24:27], s17 offen lds
    s_add_u32 m0, m0, 1024
    s_add_u32 s17, s52, 3768320
    buffer_load_dwordx4 v16, s[24:27], s17 offen lds
    ds_read_b64_tr_b16 a[144:145], v17 offset:16384
    ds_read_b64_tr_b16 a[146:147], v17 offset:17408
    ds_read_b64_tr_b16 a[148:149], v17 offset:20480
    ds_read_b64_tr_b16 a[150:151], v17 offset:21504
    ds_read_b64_tr_b16 a[152:153], v17 offset:24576
    ds_read_b64_tr_b16 a[154:155], v17 offset:25600
    ds_read_b64_tr_b16 a[156:157], v17 offset:28672
    ds_read_b64_tr_b16 a[158:159], v17 offset:29696
    s_waitcnt lgkmcnt(0)
    s_waitcnt vmcnt(24)
    s_barrier
    s_add_u32 m0, s46, 16384
    s_add_u32 s17, s52, 4194304
    buffer_load_dwordx4 v16, s[24:27], s17 offen lds
    s_add_u32 m0, m0, 1024
    s_add_u32 s17, s52, 4227072
    buffer_load_dwordx4 v16, s[24:27], s17 offen lds
    s_add_u32 m0, m0, 1024
    s_add_u32 s17, s52, 4259840
    buffer_load_dwordx4 v16, s[24:27], s17 offen lds
    s_add_u32 m0, m0, 1024
    s_add_u32 s17, s52, 4292608
    buffer_load_dwordx4 v16, s[24:27], s17 offen lds
    ds_read_b64_tr_b16 a[160:161], v17 offset:32768
    ds_read_b64_tr_b16 a[162:163], v17 offset:33792
    ds_read_b64_tr_b16 a[164:165], v17 offset:36864
    ds_read_b64_tr_b16 a[166:167], v17 offset:37888
    ds_read_b64_tr_b16 a[168:169], v17 offset:40960
    ds_read_b64_tr_b16 a[170:171], v17 offset:41984
    ds_read_b64_tr_b16 a[172:173], v17 offset:45056
    ds_read_b64_tr_b16 a[174:175], v17 offset:46080
    s_waitcnt lgkmcnt(0)
    s_waitcnt vmcnt(24)
    s_barrier
    ds_read_b64_tr_b16 a[176:177], v17 offset:49152
    ds_read_b64_tr_b16 a[178:179], v17 offset:50176
    ds_read_b64_tr_b16 a[180:181], v17 offset:53248
    ds_read_b64_tr_b16 a[182:183], v17 offset:54272
    ds_read_b64_tr_b16 a[184:185], v17 offset:57344
    ds_read_b64_tr_b16 a[186:187], v17 offset:58368
    ds_read_b64_tr_b16 a[188:189], v17 offset:61440
    ds_read_b64_tr_b16 a[190:191], v17 offset:62464
    s_waitcnt lgkmcnt(0)
    s_waitcnt vmcnt(20)
    s_barrier
    ds_read_b64_tr_b16 a[192:193], v18 offset:0
    ds_read_b64_tr_b16 a[194:195], v18 offset:1024
    ds_read_b64_tr_b16 a[196:197], v18 offset:4096
    ds_read_b64_tr_b16 a[198:199], v18 offset:5120
    ds_read_b64_tr_b16 a[200:201], v18 offset:8192
    ds_read_b64_tr_b16 a[202:203], v18 offset:9216
    ds_read_b64_tr_b16 a[204:205], v18 offset:12288
    ds_read_b64_tr_b16 a[206:207], v18 offset:13312
    s_waitcnt lgkmcnt(0)
    s_waitcnt vmcnt(16)
    s_barrier
    ds_read_b64_tr_b16 a[208:209], v18 offset:16384
    ds_read_b64_tr_b16 a[210:211], v18 offset:17408
    ds_read_b64_tr_b16 a[212:213], v18 offset:20480
    ds_read_b64_tr_b16 a[214:215], v18 offset:21504
    ds_read_b64_tr_b16 a[216:217], v18 offset:24576
    ds_read_b64_tr_b16 a[218:219], v18 offset:25600
    ds_read_b64_tr_b16 a[220:221], v18 offset:28672
    ds_read_b64_tr_b16 a[222:223], v18 offset:29696
    s_waitcnt lgkmcnt(0)
    s_waitcnt vmcnt(12)
    s_barrier
    ds_read_b64_tr_b16 a[224:225], v18 offset:32768
    ds_read_b64_tr_b16 a[226:227], v18 offset:33792
    ds_read_b64_tr_b16 a[228:229], v18 offset:36864
    ds_read_b64_tr_b16 a[230:231], v18 offset:37888
    ds_read_b64_tr_b16 a[232:233], v18 offset:40960
    ds_read_b64_tr_b16 a[234:235], v18 offset:41984
    ds_read_b64_tr_b16 a[236:237], v18 offset:45056
    ds_read_b64_tr_b16 a[238:239], v18 offset:46080
    s_waitcnt lgkmcnt(0)
    s_waitcnt vmcnt(8)
    s_barrier
    ds_read_b64_tr_b16 a[240:241], v18 offset:49152
    ds_read_b64_tr_b16 a[242:243], v18 offset:50176
    ds_read_b64_tr_b16 a[244:245], v18 offset:53248
    ds_read_b64_tr_b16 a[246:247], v18 offset:54272
    ds_read_b64_tr_b16 a[248:249], v18 offset:57344
    ds_read_b64_tr_b16 a[250:251], v18 offset:58368
    ds_read_b64_tr_b16 a[252:253], v18 offset:61440
    ds_read_b64_tr_b16 a[254:255], v18 offset:62464
    s_waitcnt lgkmcnt(0)
    s_waitcnt vmcnt(4)
    s_barrier
    ds_read_b64_tr_b16 v[152:153], v17 offset:0
    ds_read_b64_tr_b16 v[154:155], v17 offset:1024
    ds_read_b64_tr_b16 v[156:157], v17 offset:4096
    ds_read_b64_tr_b16 v[158:159], v17 offset:5120
    ds_read_b64_tr_b16 v[160:161], v17 offset:8192
    ds_read_b64_tr_b16 v[162:163], v17 offset:9216
    ds_read_b64_tr_b16 v[164:165], v17 offset:12288
    ds_read_b64_tr_b16 v[166:167], v17 offset:13312
    s_waitcnt lgkmcnt(0)
    s_waitcnt vmcnt(0)
    s_barrier
    ds_read_b64_tr_b16 v[168:169], v17 offset:16384
    ds_read_b64_tr_b16 v[170:171], v17 offset:17408
    ds_read_b64_tr_b16 v[172:173], v17 offset:20480
    ds_read_b64_tr_b16 v[174:175], v17 offset:21504
    ds_read_b64_tr_b16 v[176:177], v17 offset:24576
    ds_read_b64_tr_b16 v[178:179], v17 offset:25600
    ds_read_b64_tr_b16 v[180:181], v17 offset:28672
    ds_read_b64_tr_b16 v[182:183], v17 offset:29696
    s_waitcnt lgkmcnt(0)
    s_barrier
    v_bfe_u32 v10, v0, 4, 5
    v_lshrrev_b32 v5, 9, v0
    v_lshlrev_b32 v10, 4, v10
    v_mul_u32_u24 v6, 2560, v5
    v_add_u32 v10, v10, v6
    v_add_u32 v10, 114688, v10
    s_lshl_b32 s67, s14, 10
    v_bfe_u32 v6, v0, 8, 1
    v_lshlrev_b32 v14, 10, v6
    v_lshl_add_u32 v14, v7, 4, v14
    v_lshl_add_u32 v14, v5, 8, v14
    s_lshl_b32 s17, s51, 13
    s_lshl_b32 s18, s14, 11
    s_add_u32 s52, s17, s18
    s_add_u32 s52, s52, 44040192
    s_lshl_b32 s49, s51, 9
    s_lshl_b32 s17, s14, 2
    s_add_u32 s49, s49, s17
    s_add_u32 s49, s49, 5376
    s_cmp_eq_u32 s50, 1
    s_cselect_b32 s17, 16777216, 0
    s_cselect_b32 s18, 128, 0
    s_add_u32 s52, s52, s17
    s_add_u32 s49, s49, s18
    s_cmp_eq_u32 s50, 1
    s_cselect_b32 s17, 0, 384
    s_add_u32 s17, s17, 128
    v_lshrrev_b32 v185, 4, v0
    v_mul_lo_u32 v185, v185, s17
    v_mov_b32 v48, 0x3f803f80
    v_mov_b32 v49, 0x3f803f80
    v_mov_b32 v50, 0x3f803f80
    v_mov_b32 v51, 0x3f803f80
    s_lshl_b32 s17, s14, 8
    s_add_u32 s17, s17, 110592
    v_bfe_u32 v5, v0, 4, 5
    v_lshl_add_u32 v12, v5, 2, s17
    v_lshrrev_b32 v5, 9, v0
    v_lshl_add_u32 v13, v5, 4, s17
    s_cmp_eq_u32 s50, 1
    s_cbranch_scc1 Lp2_kv
    v_mfma_f32_32x32x16_bf16 v[84:99], a[0:3], v[48:51], 0
    v_mfma_f32_32x32x16_bf16 v[116:131], a[144:147], v[48:51], 0
    v_mfma_f32_32x32x16_bf16 v[84:99], a[4:7], v[48:51], v[84:99]
    v_mfma_f32_32x32x16_bf16 v[116:131], a[148:151], v[48:51], v[116:131]
    v_mfma_f32_32x32x16_bf16 v[84:99], a[8:11], v[48:51], v[84:99]
    v_mfma_f32_32x32x16_bf16 v[116:131], a[152:155], v[48:51], v[116:131]
    v_mfma_f32_32x32x16_bf16 v[84:99], a[12:15], v[48:51], v[84:99]
    v_mfma_f32_32x32x16_bf16 v[116:131], a[156:159], v[48:51], v[116:131]
    v_mfma_f32_32x32x16_bf16 v[84:99], a[16:19], v[48:51], v[84:99]
    v_mfma_f32_32x32x16_bf16 v[116:131], a[160:163], v[48:51], v[116:131]
    v_mfma_f32_32x32x16_bf16 v[84:99], a[20:23], v[48:51], v[84:99]
    v_mfma_f32_32x32x16_bf16 v[116:131], a[164:167], v[48:51], v[116:131]
    v_mfma_f32_32x32x16_bf16 v[84:99], a[24:27], v[48:51], v[84:99]
    v_mfma_f32_32x32x16_bf16 v[116:131], a[168:171], v[48:51], v[116:131]
    v_mfma_f32_32x32x16_bf16 v[84:99], a[28:31], v[48:51], v[84:99]
    v_mfma_f32_32x32x16_bf16 v[116:131], a[172:175], v[48:51], v[116:131]
    v_mfma_f32_32x32x16_bf16 v[84:99], a[32:35], v[48:51], v[84:99]
    v_mfma_f32_32x32x16_bf16 v[116:131], a[176:179], v[48:51], v[116:131]
    v_mfma_f32_32x32x16_bf16 v[84:99], a[36:39], v[48:51], v[84:99]
    v_mfma_f32_32x32x16_bf16 v[116:131], a[180:183], v[48:51], v[116:131]
    v_mfma_f32_32x32x16_bf16 v[84:99], a[40:43], v[48:51], v[84:99]
    v_mfma_f32_32x32x16_bf16 v[116:131], a[184:187], v[48:51], v[116:131]
    v_mfma_f32_32x32x16_bf16 v[84:99], a[44:47], v[48:51], v[84:99]
    v_mfma_f32_32x32x16_bf16 v[116:131], a[188:191], v[48:51], v[116:131]
    v_mfma_f32_32x32x16_bf16 v[84:99], a[48:51], v[48:51], v[84:99]
    v_mfma_f32_32x32x16_bf16 v[116:131], a[192:195], v[48:51], v[116:131]
    v_mfma_f32_32x32x16_bf16 v[84:99], a[52:55], v[48:51], v[84:99]
    v_mfma_f32_32x32x16_bf16 v[116:131], a[196:199], v[48:51], v[116:131]
    v_mfma_f32_32x32x16_bf16 v[84:99], a[56:59], v[48:51], v[84:99]
    v_mfma_f32_32x32x16_bf16 v[116:131], a[200:203], v[48:51], v[116:131]
    v_mfma_f32_32x32x16_bf16 v[84:99], a[60:63], v[48:51], v[84:99]
    v_mfma_f32_32x32x16_bf16 v[116:131], a[204:207], v[48:51], v[116:131]
    v_mfma_f32_32x32x16_bf16 v[84:99], a[64:67], v[48:51], v[84:99]
    v_mfma_f32_32x32x16_bf16 v[116:131], a[208:211], v[48:51], v[116:131]
    v_mfma_f32_32x32x16_bf16 v[84:99], a[68:71], v[48:51], v[84:99]
    v_mfma_f32_32x32x16_bf16 v[116:131], a[212:215], v[48:51], v[116:131]
    v_mfma_f32_32x32x16_bf16 v[84:99], a[72:75], v[48:51], v[84:99]
    v_mfma_f32_32x32x16_bf16 v[116:131], a[216:219], v[48:51], v[116:131]
    v_mfma_f32_32x32x16_bf16 v[84:99], a[76:79], v[48:51], v[84:99]
    v_mfma_f32_32x32x16_bf16 v[116:131], a[220:223], v[48:51], v[116:131]
    v_mfma_f32_32x32x16_bf16 v[84:99], a[80:83], v[48:51], v[84:99]
    v_mfma_f32_32x32x16_bf16 v[116:131], a[224:227], v[48:51], v[116:131]
    v_mfma_f32_32x32x16_bf16 v[84:99], a[84:87], v[48:51], v[84:99]
    v_mfma_f32_32x32x16_bf16 v[116:131], a[228:231], v[48:51], v[116:131]
    v_mfma_f32_32x32x16_bf16 v[84:99], a[88:91], v[48:51], v[84:99]
    v_mfma_f32_32x32x16_bf16 v[116:131], a[232:235], v[48:51], v[116:131]
    v_mfma_f32_32x32x16_bf16 v[84:99], a[92:95], v[48:51], v[84:99]
    v_mfma_f32_32x32x16_bf16 v[116:131], a[236:239], v[48:51], v[116:131]
    v_mfma_f32_32x32x16_bf16 v[84:99], a[96:99], v[48:51], v[84:99]
    v_mfma_f32_32x32x16_bf16 v[116:131], a[240:243], v[48:51], v[116:131]
    v_mfma_f32_32x32x16_bf16 v[84:99], a[100:103], v[48:51], v[84:99]
    v_mfma_f32_32x32x16_bf16 v[116:131], a[244:247], v[48:51], v[116:131]
    v_mfma_f32_32x32x16_bf16 v[84:99], a[104:107], v[48:51], v[84:99]
    v_mfma_f32_32x32x16_bf16 v[116:131], a[248:251], v[48:51], v[116:131]
    v_mfma_f32_32x32x16_bf16 v[84:99], a[108:111], v[48:51], v[84:99]
    v_mfma_f32_32x32x16_bf16 v[116:131], a[252:255], v[48:51], v[116:131]
    v_mfma_f32_32x32x16_bf16 v[84:99], a[112:115], v[48:51], v[84:99]
    v_mfma_f32_32x32x16_bf16 v[116:131], v[152:155], v[48:51], v[116:131]
    v_mfma_f32_32x32x16_bf16 v[84:99], a[116:119], v[48:51], v[84:99]
    v_mfma_f32_32x32x16_bf16 v[116:131], v[156:159], v[48:51], v[116:131]
    v_mfma_f32_32x32x16_bf16 v[84:99], a[120:123], v[48:51], v[84:99]
    v_mfma_f32_32x32x16_bf16 v[116:131], v[160:163], v[48:51], v[116:131]
    v_mfma_f32_32x32x16_bf16 v[84:99], a[124:127], v[48:51], v[84:99]
    v_mfma_f32_32x32x16_bf16 v[116:131], v[164:167], v[48:51], v[116:131]
    v_mfma_f32_32x32x16_bf16 v[84:99], a[128:131], v[48:51], v[84:99]
    v_mfma_f32_32x32x16_bf16 v[116:131], v[168:171], v[48:51], v[116:131]
    v_mfma_f32_32x32x16_bf16 v[84:99], a[132:135], v[48:51], v[84:99]
    v_mfma_f32_32x32x16_bf16 v[116:131], v[172:175], v[48:51], v[116:131]
    v_mfma_f32_32x32x16_bf16 v[84:99], a[136:139], v[48:51], v[84:99]
    v_mfma_f32_32x32x16_bf16 v[116:131], v[176:179], v[48:51], v[116:131]
    v_mfma_f32_32x32x16_bf16 v[84:99], a[140:143], v[48:51], v[84:99]
    v_mfma_f32_32x32x16_bf16 v[116:131], v[180:183], v[48:51], v[116:131]
    s_mov_b32 s66, 114688
    s_mov_b32 s71, 0x2000
    s_mov_b32 s36, s63
    s_mov_b32 s34, s63
    s_mul_i32 s58, s14, 9216
    s_mul_i32 s64, s63, 4718592
    s_add_u32 s64, s64, s58
    s_add_u32 s64, s64, 8650752
    s_mul_i32 s61, s63, 1441792
    s_add_u32 s61, s61, 3584
    s_mov_b32 s37, 0
    s_mov_b32 s40, 36864
    s_mov_b32 s59, s58
    s_mov_b32 s43, 0
    s_mov_b32 s62, 1
    s_mov_b32 s28, s8
    s_mov_b32 s29, s9
    s_mov_b32 s30, 0
    s_mov_b32 s31, 0x00020000
    v_mov_b32 v184, 74752
    v_mov_b32 v5, -1
    ds_write_b32 v184, v5
    s_waitcnt lgkmcnt(0)
    s_cmp_lg_u32 s14, 0
    s_cbranch_scc1 LpQQ_inia_d
    v_mov_b32 v5, 40
    s_mov_b32 s16, 0
LpQQ_inia:
    global_load_dword v6, v5, s[12:13] sc1
    s_add_u32 s16, s16, 1
    s_cmp_gt_u32 s16, 100000
    s_cbranch_scc1 L_role_p_abort
    s_waitcnt vmcnt(0)
    v_cmp_gt_u32 vcc, 128, v6
    s_nop 0
    s_cbranch_vccz LpQQ_inia_d
    s_sleep 8
    s_branch LpQQ_inia
LpQQ_inia_d:
    s_barrier
    s_cmp_eq_u32 s63, 0
    s_cbranch_scc1 LpQQ_ini_sk
    s_cmp_lg_u32 s14, 0
    s_cbranch_scc1 LpQQ_inib_d
    v_mov_b32 v5, 160
    s_mov_b32 s16, 0
LpQQ_inib:
    global_load_dword v6, v5, s[12:13] sc1
    s_add_u32 s16, s16, 1
    s_cmp_gt_u32 s16, 100000
    s_cbranch_scc1 L_role_p_abort
    s_waitcnt vmcnt(0)
    v_cmp_gt_u32 vcc, 64, v6
    s_nop 0
    s_cbranch_vccz LpQQ_inib_d
    s_sleep 8
    s_branch LpQQ_inib
LpQQ_inib_d:
    s_barrier
LpQQ_ini_sk:
    s_mul_i32 s41, s37, 36864
    s_add_u32 s41, s41, s64
    s_mul_i32 s60, s37, 22528
    s_add_u32 s60, s60, s61
    s_cmp_lt_u32 s37, 64
    s_cselect_b32 s60, s60, 2883584
    s_branch LpQQ_wait
LpQQ_head:
    s_waitcnt vmcnt(4)
LpQQ_head2:
    s_barrier
    ds_read_b32 v15, v184
    s_xor_b32 s40, s40, 36864
    s_xor_b32 s59, s59, 36864
    s_mov_b32 s35, s37
    s_lshl_b32 s57, s34, 6
    s_add_u32 s57, s57, s35
    s_add_u32 s37, s37, 1
    s_mov_b32 s39, 0
    s_mov_b32 s54, 0
    s_xor_b32 s66, s66, 8192
    s_xor_b32 s71, s71, 8192
    s_mul_i32 s41, s37, 36864
    s_add_u32 s41, s41, s64
    s_mul_i32 s60, s37, 22528
    s_add_u32 s60, s60, s61
    s_cmp_lt_u32 s37, 64
    s_cselect_b32 s60, s60, 2883584
    v_add_u32 v9, s40, v0
    v_add_u32 v5, s71, v10
    ds_read_b128 v[48:51], v9 offset:0
    ds_read_b128 v[52:55], v9 offset:1024
    ds_read_b128 v[56:59], v9 offset:2048
    ds_read_b128 v[64:67], v5 offset:0
    ds_read_b128 v[68:71], v5 offset:512
    ds_read_b128 v[72:75], v5 offset:1024
    ds_read_b128 v[76:79], v5 offset:1536
    ds_read_b128 v[80:83], v5 offset:2048
    s_waitcnt lgkmcnt(7)
    v_mfma_f32_32x32x16_bf16 v[16:31], a[0:3], v[48:51], 0
    ds_read_b128 v[60:63], v9 offset:3072
    v_mfma_f32_32x32x16_bf16 v[32:47], a[144:147], v[48:51], 0
    s_waitcnt lgkmcnt(4)
    v_add_f32 v64, v64, v68
    v_add_f32 v65, v65, v69
    v_add_f32 v66, v66, v70
    v_add_f32 v67, v67, v71
    v_mfma_f32_32x32x16_bf16 v[16:31], a[4:7], v[52:55], v[16:31]
    ds_read_b128 v[48:51], v9 offset:4096
    s_waitcnt lgkmcnt(4)
    v_add_f32 v64, v64, v72
    v_add_f32 v65, v65, v73
    v_add_f32 v66, v66, v74
    v_mfma_f32_32x32x16_bf16 v[32:47], a[148:151], v[52:55], v[32:47]
    v_add_f32 v67, v67, v75
    s_waitcnt lgkmcnt(3)
    v_add_f32 v64, v64, v76
    v_add_f32 v65, v65, v77
    v_add_f32 v66, v66, v78
    v_readfirstlane_b32 s17, v15
    s_nop 0
    s_add_u32 s18, s17, 1
    s_max_i32 s32, s18, s37
    s_add_u32 s39, s37, 1
    s_min_u32 s39, s39, 63
    s_mul_i32 s33, s32, 22528
    s_add_u32 s33, s33, s61
    s_cmp_eq_u32 s14, 0
    s_cselect_b32 s18, s32, 0x7fff
    v_mov_b32 v2, 2
    s_cmp_le_u32 s18, s39
    s_cselect_b64 exec, -1, 0
    buffer_load_dword v2, v1, s[8:11], s33 offen sc1
    s_mov_b64 exec, -1
    s_cmp_ge_i32 s17, s37
    s_cbranch_scc1 LpQQ_f_1
    v_mfma_f32_32x32x16_bf16 v[16:31], a[8:11], v[56:59], v[16:31]
    ds_read_b128 v[52:55], v9 offset:5120
    v_add_f32 v67, v67, v79
    s_waitcnt lgkmcnt(3)
    v_add_f32 v64, v64, v80
    v_add_f32 v65, v65, v81
    v_mfma_f32_32x32x16_bf16 v[32:47], a[152:155], v[56:59], v[32:47]
    v_add_f32 v66, v66, v82
    v_add_f32 v67, v67, v83
    v_add_f32 v64, v64, v66
    v_add_f32 v65, v65, v67
    s_waitcnt lgkmcnt(2)
    v_mfma_f32_32x32x16_bf16 v[16:31], a[12:15], v[60:63], v[16:31]
    ds_read_b128 v[56:59], v9 offset:6144
    v_mov_b32 v66, v64
    v_mov_b32 v67, v65
    s_nop 0
    v_permlane32_swap_b32 v64, v66
    v_mfma_f32_32x32x16_bf16 v[32:47], a[156:159], v[60:63], v[32:47]
    v_permlane32_swap_b32 v65, v67
    v_add_f32 v64, v64, v66
    v_add_f32 v65, v65, v67
    v_mul_f32 v64, 0x3ae38e39, v64
    s_waitcnt lgkmcnt(2)
    v_mfma_f32_32x32x16_bf16 v[16:31], a[16:19], v[48:51], v[16:31]
    ds_read_b128 v[60:63], v9 offset:7168
    v_mul_f32 v65, 0x3ae38e39, v65
    v_fma_f32 v65, -v64, v64, v65
    v_max_f32 v65, 0, v65
    v_mfma_f32_32x32x16_bf16 v[32:47], a[160:163], v[48:51], v[32:47]
    v_add_f32 v65, 0x3727c5ac, v65
    v_rsq_f32 v148, v65
    s_nop 0
    v_mul_f32 v149, v64, v148
    v_mul_f32 v100, v149, v84
    s_waitcnt lgkmcnt(2)
    v_mfma_f32_32x32x16_bf16 v[16:31], a[20:23], v[52:55], v[16:31]
    ds_read_b128 v[48:51], v9 offset:8192
    v_mul_f32 v101, v149, v85
    v_mul_f32 v102, v149, v86
    v_mul_f32 v103, v149, v87
    v_mfma_f32_32x32x16_bf16 v[32:47], a[164:167], v[52:55], v[32:47]
    v_mul_f32 v104, v149, v88
    v_mul_f32 v105, v149, v89
    v_mul_f32 v106, v149, v90
    v_mul_f32 v107, v149, v91
    s_waitcnt lgkmcnt(2)
    v_mfma_f32_32x32x16_bf16 v[16:31], a[24:27], v[56:59], v[16:31]
    ds_read_b128 v[52:55], v9 offset:9216
    v_mul_f32 v108, v149, v92
    v_mul_f32 v109, v149, v93
    v_mul_f32 v110, v149, v94
    v_mfma_f32_32x32x16_bf16 v[32:47], a[168:171], v[56:59], v[32:47]
    v_mul_f32 v111, v149, v95
    v_mul_f32 v112, v149, v96
    v_mul_f32 v113, v149, v97
    v_mul_f32 v114, v149, v98
    s_waitcnt lgkmcnt(2)
    v_mfma_f32_32x32x16_bf16 v[16:31], a[28:31], v[60:63], v[16:31]
    ds_read_b128 v[56:59], v9 offset:10240
    v_mul_f32 v115, v149, v99
    v_mul_f32 v132, v149, v116
    v_mul_f32 v133, v149, v117
    v_mfma_f32_32x32x16_bf16 v[32:47], a[172:175], v[60:63], v[32:47]
    v_mul_f32 v134, v149, v118
    v_mul_f32 v135, v149, v119
    v_mul_f32 v136, v149, v120
    v_mul_f32 v137, v149, v121
    s_waitcnt lgkmcnt(2)
    v_mfma_f32_32x32x16_bf16 v[16:31], a[32:35], v[48:51], v[16:31]
    ds_read_b128 v[60:63], v9 offset:11264
    v_mul_f32 v138, v149, v122
    v_mul_f32 v139, v149, v123
    v_mul_f32 v140, v149, v124
    v_mfma_f32_32x32x16_bf16 v[32:47], a[176:179], v[48:51], v[32:47]
    v_mul_f32 v141, v149, v125
    v_mul_f32 v142, v149, v126
    v_mul_f32 v143, v149, v127
    v_mul_f32 v144, v149, v128
    s_waitcnt lgkmcnt(2)
    v_mfma_f32_32x32x16_bf16 v[16:31], a[36:39], v[52:55], v[16:31]
    ds_read_b128 v[48:51], v9 offset:12288
    v_mul_f32 v145, v149, v129
    v_mul_f32 v146, v149, v130
    v_mul_f32 v147, v149, v131
    v_mfma_f32_32x32x16_bf16 v[32:47], a[180:183], v[52:55], v[32:47]
    s_mul_i32 s46, s34, 50331648
    s_lshl_b32 s51, s35, 18
    s_add_u32 s46, s46, s51
    s_add_u32 s46, s46, s52
    s_waitcnt lgkmcnt(2)
    v_mfma_f32_32x32x16_bf16 v[16:31], a[40:43], v[56:59], v[16:31]
    ds_read_b128 v[52:55], v9 offset:13312
    v_mfma_f32_32x32x16_bf16 v[32:47], a[184:187], v[56:59], v[32:47]
    s_waitcnt lgkmcnt(2)
    v_mfma_f32_32x32x16_bf16 v[16:31], a[44:47], v[60:63], v[16:31]
    ds_read_b128 v[56:59], v9 offset:14336
    v_mfma_f32_32x32x16_bf16 v[32:47], a[188:191], v[60:63], v[32:47]
    s_waitcnt lgkmcnt(2)
    v_mfma_f32_32x32x16_bf16 v[16:31], a[48:51], v[48:51], v[16:31]
    ds_read_b128 v[60:63], v9 offset:15360
    v_mfma_f32_32x32x16_bf16 v[32:47], a[192:195], v[48:51], v[32:47]
    s_waitcnt vmcnt(1)
    s_cmp_lg_u32 s43, 0
    s_cselect_b64 exec, 3, 0
    buffer_store_dword v3, v185, s[8:11], s43 offen sc1
    s_mov_b64 exec, -1
    s_mov_b32 s43, 0
    s_waitcnt lgkmcnt(2)
    v_mfma_f32_32x32x16_bf16 v[16:31], a[52:55], v[52:55], v[16:31]
    ds_read_b128 v[48:51], v9 offset:16384
    v_mfma_f32_32x32x16_bf16 v[32:47], a[196:199], v[52:55], v[32:47]
    s_waitcnt lgkmcnt(2)
    v_mfma_f32_32x32x16_bf16 v[16:31], a[56:59], v[56:59], v[16:31]
    v_cmp_eq_u32 s[76:77], 1, v2
    v_cmp_eq_u32 vcc, 2, v2
    s_cmp_eq_u64 s[76:77], -1
    s_cselect_b32 s38, 1, 0
    ds_read_b128 v[52:55], v9 offset:17408
    v_mfma_f32_32x32x16_bf16 v[32:47], a[200:203], v[56:59], v[32:47]
    s_cmp_lg_u32 s38, 0
    s_cselect_b64 exec, 1, 0
    v_mov_b32 v15, s32
    ds_write_b32 v184, v15
    v_mov_b32 v2, 2
    s_mov_b64 exec, -1
    s_waitcnt lgkmcnt(3)
    v_mfma_f32_32x32x16_bf16 v[16:31], a[60:63], v[60:63], v[16:31]
    s_add_u32 s32, s32, s38
    s_mul_i32 s38, s38, 22528
    s_add_u32 s33, s33, s38
    ds_read_b128 v[56:59], v9 offset:18432
    v_mfma_f32_32x32x16_bf16 v[32:47], a[204:207], v[60:63], v[32:47]
    s_cmp_eq_u64 vcc, 0
    s_cselect_b32 s38, s32, 0x7fff
    s_waitcnt lgkmcnt(3)
    v_mfma_f32_32x32x16_bf16 v[16:31], a[64:67], v[48:51], v[16:31]
    ds_read_b128 v[60:63], v9 offset:19456
    v_mfma_f32_32x32x16_bf16 v[32:47], a[208:211], v[48:51], v[32:47]
    s_cmp_le_u32 s38, s39
    s_cselect_b64 exec, -1, 0
    v_mov_b32 v2, 2
    buffer_load_dword v2, v1, s[8:11], s33 offen sc1
    s_mov_b64 exec, -1
    ds_read_b32 v15, v184
    s_waitcnt lgkmcnt(4)
    v_mfma_f32_32x32x16_bf16 v[16:31], a[68:71], v[52:55], v[16:31]
    ds_read_b128 v[48:51], v9 offset:20480
    v_mfma_f32_32x32x16_bf16 v[32:47], a[212:215], v[52:55], v[32:47]
    s_waitcnt lgkmcnt(3)
    v_mfma_f32_32x32x16_bf16 v[16:31], a[72:75], v[56:59], v[16:31]
    ds_read_b128 v[52:55], v9 offset:21504
    v_mfma_f32_32x32x16_bf16 v[32:47], a[216:219], v[56:59], v[32:47]
    s_waitcnt lgkmcnt(2)
    v_readfirstlane_b32 s17, v15
    s_nop 0
    s_cmp_ge_i32 s17, s37
    s_cbranch_scc1 LpQQ_f_2
    v_mfma_f32_32x32x16_bf16 v[16:31], a[76:79], v[60:63], v[16:31]
    ds_read_b128 v[56:59], v9 offset:22528
    v_mfma_f32_32x32x16_bf16 v[32:47], a[220:223], v[60:63], v[32:47]
    s_waitcnt lgkmcnt(2)
    v_mfma_f32_32x32x16_bf16 v[16:31], a[80:83], v[48:51], v[16:31]
    ds_read_b128 v[60:63], v9 offset:23552
    v_mfma_f32_32x32x16_bf16 v[32:47], a[224:227], v[48:51], v[32:47]
    s_waitcnt lgkmcnt(2)
    v_mfma_f32_32x32x16_bf16 v[16:31], a[84:87], v[52:55], v[16:31]
    ds_read_b128 v[48:51], v9 offset:24576
    v_mfma_f32_32x32x16_bf16 v[32:47], a[228:231], v[52:55], v[32:47]
    s_waitcnt lgkmcnt(2)
    v_mfma_f32_32x32x16_bf16 v[16:31], a[88:91], v[56:59], v[16:31]
    ds_read_b128 v[52:55], v9 offset:25600
    v_mfma_f32_32x32x16_bf16 v[32:47], a[232:235], v[56:59], v[32:47]
    s_waitcnt lgkmcnt(2)
    v_mfma_f32_32x32x16_bf16 v[16:31], a[92:95], v[60:63], v[16:31]
    ds_read_b128 v[56:59], v9 offset:26624
    v_mfma_f32_32x32x16_bf16 v[32:47], a[236:239], v[60:63], v[32:47]
    s_waitcnt lgkmcnt(2)
    v_mfma_f32_32x32x16_bf16 v[16:31], a[96:99], v[48:51], v[16:31]
    ds_read_b128 v[60:63], v9 offset:27648
    v_mfma_f32_32x32x16_bf16 v[32:47], a[240:243], v[48:51], v[32:47]
    s_waitcnt lgkmcnt(2)
    v_mfma_f32_32x32x16_bf16 v[16:31], a[100:103], v[52:55], v[16:31]
    ds_read_b128 v[48:51], v9 offset:28672
    v_mfma_f32_32x32x16_bf16 v[32:47], a[244:247], v[52:55], v[32:47]
    s_waitcnt lgkmcnt(2)
    v_mfma_f32_32x32x16_bf16 v[16:31], a[104:107], v[56:59], v[16:31]
    ds_read_b128 v[52:55], v9 offset:29696
    v_mfma_f32_32x32x16_bf16 v[32:47], a[248:251], v[56:59], v[32:47]
    s_waitcnt lgkmcnt(2)
    v_mfma_f32_32x32x16_bf16 v[16:31], a[108:111], v[60:63], v[16:31]
    ds_read_b128 v[56:59], v9 offset:30720
    v_mfma_f32_32x32x16_bf16 v[32:47], a[252:255], v[60:63], v[32:47]
    s_waitcnt lgkmcnt(2)
    v_mfma_f32_32x32x16_bf16 v[16:31], a[112:115], v[48:51], v[16:31]
    ds_read_b128 v[60:63], v9 offset:31744
    v_mfma_f32_32x32x16_bf16 v[32:47], v[152:155], v[48:51], v[32:47]
    s_waitcnt lgkmcnt(2)
    v_mfma_f32_32x32x16_bf16 v[16:31], a[116:119], v[52:55], v[16:31]
    ds_read_b128 v[48:51], v9 offset:32768
    v_mfma_f32_32x32x16_bf16 v[32:47], v[156:159], v[52:55], v[32:47]
    s_waitcnt lgkmcnt(2)
    v_mfma_f32_32x32x16_bf16 v[16:31], a[120:123], v[56:59], v[16:31]
    ds_read_b128 v[52:55], v9 offset:33792
    v_mfma_f32_32x32x16_bf16 v[32:47], v[160:163], v[56:59], v[32:47]
    s_waitcnt lgkmcnt(2)
    v_mfma_f32_32x32x16_bf16 v[16:31], a[124:127], v[60:63], v[16:31]
    v_cmp_eq_u32 s[76:77], 1, v2
    v_cmp_eq_u32 vcc, 2, v2
    s_cmp_eq_u64 s[76:77], -1
    s_cselect_b32 s38, 1, 0
    ds_read_b128 v[56:59], v9 offset:34816
    v_mfma_f32_32x32x16_bf16 v[32:47], v[164:167], v[60:63], v[32:47]
    s_cmp_lg_u32 s38, 0
    s_cselect_b64 exec, 1, 0
    v_mov_b32 v15, s32
    ds_write_b32 v184, v15
    v_mov_b32 v2, 2
    s_mov_b64 exec, -1
    s_waitcnt lgkmcnt(3)
    v_mfma_f32_32x32x16_bf16 v[16:31], a[128:131], v[48:51], v[16:31]
    s_add_u32 s32, s32, s38
    s_mul_i32 s38, s38, 22528
    s_add_u32 s33, s33, s38
    ds_read_b128 v[60:63], v9 offset:35840
    v_mfma_f32_32x32x16_bf16 v[32:47], v[168:171], v[48:51], v[32:47]
    s_cmp_eq_u64 vcc, 0
    s_cselect_b32 s38, s32, 0x7fff
    s_waitcnt lgkmcnt(3)
    v_mfma_f32_32x32x16_bf16 v[16:31], a[132:135], v[52:55], v[16:31]
    s_cmp_le_u32 s38, s39
    s_cselect_b64 exec, -1, 0
    v_mov_b32 v2, 2
    buffer_load_dword v2, v1, s[8:11], s33 offen sc1
    s_mov_b64 exec, -1
    v_mfma_f32_32x32x16_bf16 v[32:47], v[172:175], v[52:55], v[32:47]
    s_waitcnt lgkmcnt(2)
    v_mfma_f32_32x32x16_bf16 v[16:31], a[136:139], v[56:59], v[16:31]
    v_mfma_f32_32x32x16_bf16 v[32:47], v[176:179], v[56:59], v[32:47]
    s_waitcnt lgkmcnt(0)
    v_mfma_f32_32x32x16_bf16 v[16:31], a[140:143], v[60:63], v[16:31]
    v_mfma_f32_32x32x16_bf16 v[32:47], v[180:183], v[60:63], v[32:47]
    s_add_u32 s51, s46, 8192
    s_nop 2
    v_pk_fma_f32 v[16:17], v[16:17], v[148:149], v[100:101] op_sel_hi:[1,0,1] neg_lo:[0,0,1] neg_hi:[0,0,1]
    v_pk_fma_f32 v[18:19], v[18:19], v[148:149], v[102:103] op_sel_hi:[1,0,1] neg_lo:[0,0,1] neg_hi:[0,0,1]
    v_pk_fma_f32 v[20:21], v[20:21], v[148:149], v[104:105] op_sel_hi:[1,0,1] neg_lo:[0,0,1] neg_hi:[0,0,1]
    v_pk_fma_f32 v[22:23], v[22:23], v[148:149], v[106:107] op_sel_hi:[1,0,1] neg_lo:[0,0,1] neg_hi:[0,0,1]
    v_pk_fma_f32 v[24:25], v[24:25], v[148:149], v[108:109] op_sel_hi:[1,0,1] neg_lo:[0,0,1] neg_hi:[0,0,1]
    v_pk_fma_f32 v[26:27], v[26:27], v[148:149], v[110:111] op_sel_hi:[1,0,1] neg_lo:[0,0,1] neg_hi:[0,0,1]
    v_pk_fma_f32 v[28:29], v[28:29], v[148:149], v[112:113] op_sel_hi:[1,0,1] neg_lo:[0,0,1] neg_hi:[0,0,1]
    v_pk_fma_f32 v[30:31], v[30:31], v[148:149], v[114:115] op_sel_hi:[1,0,1] neg_lo:[0,0,1] neg_hi:[0,0,1]
    v_cvt_pk_bf16_f32 v188, v16, v24
    v_cvt_pk_bf16_f32 v189, v17, v25
    v_cvt_pk_bf16_f32 v190, v18, v26
    v_cvt_pk_bf16_f32 v191, v19, v27
    buffer_store_dwordx4 v[188:191], v14, s[8:11], s46 offen offset:0 sc1
    v_cvt_pk_bf16_f32 v192, v20, v28
    v_cvt_pk_bf16_f32 v193, v21, v29
    v_cvt_pk_bf16_f32 v194, v22, v30
    v_cvt_pk_bf16_f32 v195, v23, v31
    buffer_store_dwordx4 v[192:195], v14, s[8:11], s46 offen offset:512 sc1
    v_pk_fma_f32 v[32:33], v[32:33], v[148:149], v[132:133] op_sel_hi:[1,0,1] neg_lo:[0,0,1] neg_hi:[0,0,1]
    v_pk_fma_f32 v[34:35], v[34:35], v[148:149], v[134:135] op_sel_hi:[1,0,1] neg_lo:[0,0,1] neg_hi:[0,0,1]
    v_pk_fma_f32 v[36:37], v[36:37], v[148:149], v[136:137] op_sel_hi:[1,0,1] neg_lo:[0,0,1] neg_hi:[0,0,1]
    v_pk_fma_f32 v[38:39], v[38:39], v[148:149], v[138:139] op_sel_hi:[1,0,1] neg_lo:[0,0,1] neg_hi:[0,0,1]
    v_pk_fma_f32 v[40:41], v[40:41], v[148:149], v[140:141] op_sel_hi:[1,0,1] neg_lo:[0,0,1] neg_hi:[0,0,1]
    v_pk_fma_f32 v[42:43], v[42:43], v[148:149], v[142:143] op_sel_hi:[1,0,1] neg_lo:[0,0,1] neg_hi:[0,0,1]
    v_pk_fma_f32 v[44:45], v[44:45], v[148:149], v[144:145] op_sel_hi:[1,0,1] neg_lo:[0,0,1] neg_hi:[0,0,1]
    v_pk_fma_f32 v[46:47], v[46:47], v[148:149], v[146:147] op_sel_hi:[1,0,1] neg_lo:[0,0,1] neg_hi:[0,0,1]
    v_cvt_pk_bf16_f32 v196, v32, v40
    v_cvt_pk_bf16_f32 v197, v33, v41
    v_cvt_pk_bf16_f32 v198, v34, v42
    v_cvt_pk_bf16_f32 v199, v35, v43
    buffer_store_dwordx4 v[196:199], v14, s[8:11], s51 offen offset:0 sc1
    v_cvt_pk_bf16_f32 v200, v36, v44
    v_cvt_pk_bf16_f32 v201, v37, v45
    v_cvt_pk_bf16_f32 v202, v38, v46
    v_cvt_pk_bf16_f32 v203, v39, v47
    buffer_store_dwordx4 v[200:203], v14, s[8:11], s51 offen offset:512 sc1
    s_mul_i32 s43, s57, 22528
    s_add_u32 s43, s43, s49
    s_branch LpQQ_none
LpQQ_f_1:
    v_mfma_f32_32x32x16_bf16 v[16:31], a[8:11], v[56:59], v[16:31]
    ds_read_b128 v[52:55], v9 offset:5120
    v_add_f32 v67, v67, v79
    s_waitcnt lgkmcnt(3)
    v_add_f32 v64, v64, v80
    v_add_f32 v65, v65, v81
    v_mfma_f32_32x32x16_bf16 v[32:47], a[152:155], v[56:59], v[32:47]
    v_add_f32 v66, v66, v82
    v_add_f32 v67, v67, v83
    v_add_f32 v64, v64, v66
    v_add_f32 v65, v65, v67
    s_waitcnt lgkmcnt(2)
    v_mfma_f32_32x32x16_bf16 v[16:31], a[12:15], v[60:63], v[16:31]
    ds_read_b128 v[56:59], v9 offset:6144
    v_mov_b32 v66, v64
    v_mov_b32 v67, v65
    s_nop 0
    v_permlane32_swap_b32 v64, v66
    v_mfma_f32_32x32x16_bf16 v[32:47], a[156:159], v[60:63], v[32:47]
    v_permlane32_swap_b32 v65, v67
    v_add_f32 v64, v64, v66
    v_add_f32 v65, v65, v67
    v_mul_f32 v64, 0x3ae38e39, v64
    s_waitcnt lgkmcnt(2)
    v_mfma_f32_32x32x16_bf16 v[16:31], a[16:19], v[48:51], v[16:31]
    ds_read_b128 v[60:63], v9 offset:7168
    v_mul_f32 v65, 0x3ae38e39, v65
    v_fma_f32 v65, -v64, v64, v65
    v_max_f32 v65, 0, v65
    v_mfma_f32_32x32x16_bf16 v[32:47], a[160:163], v[48:51], v[32:47]
    v_add_f32 v65, 0x3727c5ac, v65
    v_rsq_f32 v148, v65
    s_nop 0
    v_mul_f32 v149, v64, v148
    v_mul_f32 v100, v149, v84
    s_waitcnt lgkmcnt(2)
    v_mfma_f32_32x32x16_bf16 v[16:31], a[20:23], v[52:55], v[16:31]
    ds_read_b128 v[48:51], v9 offset:8192
    v_mul_f32 v101, v149, v85
    v_mul_f32 v102, v149, v86
    v_mul_f32 v103, v149, v87
    v_mfma_f32_32x32x16_bf16 v[32:47], a[164:167], v[52:55], v[32:47]
    v_mul_f32 v104, v149, v88
    v_mul_f32 v105, v149, v89
    v_mul_f32 v106, v149, v90
    v_mul_f32 v107, v149, v91
    s_waitcnt lgkmcnt(2)
    v_mfma_f32_32x32x16_bf16 v[16:31], a[24:27], v[56:59], v[16:31]
    ds_read_b128 v[52:55], v9 offset:9216
    v_mul_f32 v108, v149, v92
    v_mul_f32 v109, v149, v93
    v_mul_f32 v110, v149, v94
    v_mfma_f32_32x32x16_bf16 v[32:47], a[168:171], v[56:59], v[32:47]
    v_mul_f32 v111, v149, v95
    v_mul_f32 v112, v149, v96
    v_mul_f32 v113, v149, v97
    v_mul_f32 v114, v149, v98
    s_waitcnt lgkmcnt(2)
    v_mfma_f32_32x32x16_bf16 v[16:31], a[28:31], v[60:63], v[16:31]
    ds_read_b128 v[56:59], v9 offset:10240
    v_mul_f32 v115, v149, v99
    v_mul_f32 v132, v149, v116
    v_mul_f32 v133, v149, v117
    v_mfma_f32_32x32x16_bf16 v[32:47], a[172:175], v[60:63], v[32:47]
    v_mul_f32 v134, v149, v118
    v_mul_f32 v135, v149, v119
    v_mul_f32 v136, v149, v120
    v_mul_f32 v137, v149, v121
    s_waitcnt lgkmcnt(2)
    v_mfma_f32_32x32x16_bf16 v[16:31], a[32:35], v[48:51], v[16:31]
    ds_read_b128 v[60:63], v9 offset:11264
    v_mul_f32 v138, v149, v122
    v_mul_f32 v139, v149, v123
    v_mul_f32 v140, v149, v124
    v_mfma_f32_32x32x16_bf16 v[32:47], a[176:179], v[48:51], v[32:47]
    v_mul_f32 v141, v149, v125
    v_mul_f32 v142, v149, v126
    v_mul_f32 v143, v149, v127
    v_mul_f32 v144, v149, v128
    s_waitcnt lgkmcnt(2)
    v_mfma_f32_32x32x16_bf16 v[16:31], a[36:39], v[52:55], v[16:31]
    ds_read_b128 v[48:51], v9 offset:12288
    v_mul_f32 v145, v149, v129
    v_mul_f32 v146, v149, v130
    v_mul_f32 v147, v149, v131
    v_mfma_f32_32x32x16_bf16 v[32:47], a[180:183], v[52:55], v[32:47]
    s_mul_i32 s46, s34, 50331648
    s_lshl_b32 s51, s35, 18
    s_add_u32 s46, s46, s51
    s_add_u32 s46, s46, s52
    s_waitcnt lgkmcnt(2)
    v_mfma_f32_32x32x16_bf16 v[16:31], a[40:43], v[56:59], v[16:31]
    s_add_u32 m0, s59, 0
    s_add_u32 s47, s41, 0
    buffer_load_dwordx4 v0, s[8:11], s47 offen offset:0 lds
    buffer_load_dwordx4 v0, s[8:11], s47 offen offset:1024 lds
    ds_read_b128 v[52:55], v9 offset:13312
    v_mfma_f32_32x32x16_bf16 v[32:47], a[184:187], v[56:59], v[32:47]
    buffer_load_dwordx4 v0, s[8:11], s47 offen offset:2048 lds
    buffer_load_dwordx4 v0, s[8:11], s47 offen offset:3072 lds
    s_add_u32 m0, s59, 4096
    s_add_u32 s47, s41, 4096
    buffer_load_dwordx4 v0, s[8:11], s47 offen offset:0 lds
    s_waitcnt lgkmcnt(2)
    v_mfma_f32_32x32x16_bf16 v[16:31], a[44:47], v[60:63], v[16:31]
    buffer_load_dwordx4 v0, s[8:11], s47 offen offset:1024 lds
    buffer_load_dwordx4 v0, s[8:11], s47 offen offset:2048 lds
    buffer_load_dwordx4 v0, s[8:11], s47 offen offset:3072 lds
    ds_read_b128 v[56:59], v9 offset:14336
    v_mfma_f32_32x32x16_bf16 v[32:47], a[188:191], v[60:63], v[32:47]
    s_add_u32 m0, s59, 8192
    s_add_u32 s47, s41, 8192
    buffer_load_dwordx4 v0, s[8:11], s47 offen offset:0 lds
    s_waitcnt lgkmcnt(2)
    v_mfma_f32_32x32x16_bf16 v[16:31], a[48:51], v[48:51], v[16:31]
    s_mul_i32 s48, s36, 786432
    s_mul_i32 s18, s37, 6144
    s_add_u32 s48, s48, s18
    s_add_u32 s48, s48, 16125952
    s_add_u32 m0, s66, 4096
    s_nop 0
    buffer_load_dwordx4 v0, s[8:11], s48 offen lds
    ds_read_b128 v[60:63], v9 offset:15360
    v_mfma_f32_32x32x16_bf16 v[32:47], a[192:195], v[48:51], v[32:47]
    s_add_u32 m0, s66, s67
    s_sub_u32 s48, s48, 4096
    s_add_u32 s48, s48, s67
    buffer_load_dwordx4 v0, s[8:11], s48 offen lds
    s_waitcnt vmcnt(12)
    s_cmp_lg_u32 s43, 0
    s_cselect_b64 exec, 3, 0
    buffer_store_dword v3, v185, s[8:11], s43 offen sc1
    s_mov_b64 exec, -1
    s_mov_b32 s43, 0
    s_waitcnt lgkmcnt(2)
    v_mfma_f32_32x32x16_bf16 v[16:31], a[52:55], v[52:55], v[16:31]
    ds_read_b128 v[48:51], v9 offset:16384
    v_mfma_f32_32x32x16_bf16 v[32:47], a[196:199], v[52:55], v[32:47]
    s_waitcnt lgkmcnt(2)
    v_mfma_f32_32x32x16_bf16 v[16:31], a[56:59], v[56:59], v[16:31]
    v_cmp_eq_u32 s[76:77], 1, v2
    v_cmp_eq_u32 vcc, 2, v2
    s_cmp_eq_u64 s[76:77], -1
    s_cselect_b32 s38, 1, 0
    ds_read_b128 v[52:55], v9 offset:17408
    v_mfma_f32_32x32x16_bf16 v[32:47], a[200:203], v[56:59], v[32:47]
    s_cmp_lg_u32 s38, 0
    s_cselect_b64 exec, 1, 0
    v_mov_b32 v15, s32
    ds_write_b32 v184, v15
    v_mov_b32 v2, 2
    s_mov_b64 exec, -1
    s_waitcnt lgkmcnt(3)
    v_mfma_f32_32x32x16_bf16 v[16:31], a[60:63], v[60:63], v[16:31]
    s_add_u32 s32, s32, s38
    s_mul_i32 s38, s38, 22528
    s_add_u32 s33, s33, s38
    ds_read_b128 v[56:59], v9 offset:18432
    v_mfma_f32_32x32x16_bf16 v[32:47], a[204:207], v[60:63], v[32:47]
    s_cmp_eq_u64 vcc, 0
    s_cselect_b32 s38, s32, 0x7fff
    s_waitcnt lgkmcnt(3)
    v_mfma_f32_32x32x16_bf16 v[16:31], a[64:67], v[48:51], v[16:31]
    ds_read_b128 v[60:63], v9 offset:19456
    v_mfma_f32_32x32x16_bf16 v[32:47], a[208:211], v[48:51], v[32:47]
    s_cmp_le_u32 s38, s39
    s_cselect_b64 exec, -1, 0
    v_mov_b32 v2, 2
    buffer_load_dword v2, v1, s[8:11], s33 offen sc1
    s_mov_b64 exec, -1
    s_waitcnt lgkmcnt(3)
    v_mfma_f32_32x32x16_bf16 v[16:31], a[68:71], v[52:55], v[16:31]
    ds_read_b128 v[48:51], v9 offset:20480
    v_mfma_f32_32x32x16_bf16 v[32:47], a[212:215], v[52:55], v[32:47]
    s_waitcnt lgkmcnt(2)
    v_mfma_f32_32x32x16_bf16 v[16:31], a[72:75], v[56:59], v[16:31]
    ds_read_b128 v[52:55], v9 offset:21504
    v_mfma_f32_32x32x16_bf16 v[32:47], a[216:219], v[56:59], v[32:47]
    s_waitcnt lgkmcnt(2)
    v_mfma_f32_32x32x16_bf16 v[16:31], a[76:79], v[60:63], v[16:31]
    ds_read_b128 v[56:59], v9 offset:22528
    v_mfma_f32_32x32x16_bf16 v[32:47], a[220:223], v[60:63], v[32:47]
    s_waitcnt lgkmcnt(2)
    v_mfma_f32_32x32x16_bf16 v[16:31], a[80:83], v[48:51], v[16:31]
    ds_read_b128 v[60:63], v9 offset:23552
    v_mfma_f32_32x32x16_bf16 v[32:47], a[224:227], v[48:51], v[32:47]
    s_waitcnt lgkmcnt(2)
    v_mfma_f32_32x32x16_bf16 v[16:31], a[84:87], v[52:55], v[16:31]
    ds_read_b128 v[48:51], v9 offset:24576
    v_mfma_f32_32x32x16_bf16 v[32:47], a[228:231], v[52:55], v[32:47]
    s_waitcnt lgkmcnt(2)
    v_mfma_f32_32x32x16_bf16 v[16:31], a[88:91], v[56:59], v[16:31]
    ds_read_b128 v[52:55], v9 offset:25600
    v_mfma_f32_32x32x16_bf16 v[32:47], a[232:235], v[56:59], v[32:47]
    s_waitcnt lgkmcnt(2)
    v_mfma_f32_32x32x16_bf16 v[16:31], a[92:95], v[60:63], v[16:31]
    ds_read_b128 v[56:59], v9 offset:26624
    v_mfma_f32_32x32x16_bf16 v[32:47], a[236:239], v[60:63], v[32:47]
    s_waitcnt lgkmcnt(2)
    v_mfma_f32_32x32x16_bf16 v[16:31], a[96:99], v[48:51], v[16:31]
    ds_read_b128 v[60:63], v9 offset:27648
    v_mfma_f32_32x32x16_bf16 v[32:47], a[240:243], v[48:51], v[32:47]
    s_waitcnt lgkmcnt(2)
    v_mfma_f32_32x32x16_bf16 v[16:31], a[100:103], v[52:55], v[16:31]
    ds_read_b128 v[48:51], v9 offset:28672
    v_mfma_f32_32x32x16_bf16 v[32:47], a[244:247], v[52:55], v[32:47]
    s_waitcnt lgkmcnt(2)
    v_mfma_f32_32x32x16_bf16 v[16:31], a[104:107], v[56:59], v[16:31]
    ds_read_b128 v[52:55], v9 offset:29696
    v_mfma_f32_32x32x16_bf16 v[32:47], a[248:251], v[56:59], v[32:47]
    s_waitcnt lgkmcnt(2)
    v_mfma_f32_32x32x16_bf16 v[16:31], a[108:111], v[60:63], v[16:31]
    ds_read_b128 v[56:59], v9 offset:30720
    v_mfma_f32_32x32x16_bf16 v[32:47], a[252:255], v[60:63], v[32:47]
    s_waitcnt lgkmcnt(2)
    v_mfma_f32_32x32x16_bf16 v[16:31], a[112:115], v[48:51], v[16:31]
    ds_read_b128 v[60:63], v9 offset:31744
    v_mfma_f32_32x32x16_bf16 v[32:47], v[152:155], v[48:51], v[32:47]
    s_waitcnt lgkmcnt(2)
    v_mfma_f32_32x32x16_bf16 v[16:31], a[116:119], v[52:55], v[16:31]
    ds_read_b128 v[48:51], v9 offset:32768
    v_mfma_f32_32x32x16_bf16 v[32:47], v[156:159], v[52:55], v[32:47]
    s_waitcnt lgkmcnt(2)
    v_mfma_f32_32x32x16_bf16 v[16:31], a[120:123], v[56:59], v[16:31]
    ds_read_b128 v[52:55], v9 offset:33792
    v_mfma_f32_32x32x16_bf16 v[32:47], v[160:163], v[56:59], v[32:47]
    s_waitcnt lgkmcnt(2)
    v_mfma_f32_32x32x16_bf16 v[16:31], a[124:127], v[60:63], v[16:31]
    v_cmp_eq_u32 s[76:77], 1, v2
    v_cmp_eq_u32 vcc, 2, v2
    s_cmp_eq_u64 s[76:77], -1
    s_cselect_b32 s38, 1, 0
    ds_read_b128 v[56:59], v9 offset:34816
    v_mfma_f32_32x32x16_bf16 v[32:47], v[164:167], v[60:63], v[32:47]
    s_cmp_lg_u32 s38, 0
    s_cselect_b64 exec, 1, 0
    v_mov_b32 v15, s32
    ds_write_b32 v184, v15
    v_mov_b32 v2, 2
    s_mov_b64 exec, -1
    s_waitcnt lgkmcnt(3)
    v_mfma_f32_32x32x16_bf16 v[16:31], a[128:131], v[48:51], v[16:31]
    s_add_u32 s32, s32, s38
    s_mul_i32 s38, s38, 22528
    s_add_u32 s33, s33, s38
    ds_read_b128 v[60:63], v9 offset:35840
    v_mfma_f32_32x32x16_bf16 v[32:47], v[168:171], v[48:51], v[32:47]
    s_cmp_eq_u64 vcc, 0
    s_cselect_b32 s38, s32, 0x7fff
    s_waitcnt lgkmcnt(3)
    v_mfma_f32_32x32x16_bf16 v[16:31], a[132:135], v[52:55], v[16:31]
    s_cmp_le_u32 s38, s39
    s_cselect_b64 exec, -1, 0
    v_mov_b32 v2, 2
    buffer_load_dword v2, v1, s[8:11], s33 offen sc1
    s_mov_b64 exec, -1
    v_mfma_f32_32x32x16_bf16 v[32:47], v[172:175], v[52:55], v[32:47]
    s_waitcnt lgkmcnt(2)
    v_mfma_f32_32x32x16_bf16 v[16:31], a[136:139], v[56:59], v[16:31]
    v_mfma_f32_32x32x16_bf16 v[32:47], v[176:179], v[56:59], v[32:47]
    s_waitcnt lgkmcnt(0)
    v_mfma_f32_32x32x16_bf16 v[16:31], a[140:143], v[60:63], v[16:31]
    v_mfma_f32_32x32x16_bf16 v[32:47], v[180:183], v[60:63], v[32:47]
    s_add_u32 s51, s46, 8192
    s_nop 2
    v_pk_fma_f32 v[16:17], v[16:17], v[148:149], v[100:101] op_sel_hi:[1,0,1] neg_lo:[0,0,1] neg_hi:[0,0,1]
    v_pk_fma_f32 v[18:19], v[18:19], v[148:149], v[102:103] op_sel_hi:[1,0,1] neg_lo:[0,0,1] neg_hi:[0,0,1]
    v_pk_fma_f32 v[20:21], v[20:21], v[148:149], v[104:105] op_sel_hi:[1,0,1] neg_lo:[0,0,1] neg_hi:[0,0,1]
    v_pk_fma_f32 v[22:23], v[22:23], v[148:149], v[106:107] op_sel_hi:[1,0,1] neg_lo:[0,0,1] neg_hi:[0,0,1]
    v_pk_fma_f32 v[24:25], v[24:25], v[148:149], v[108:109] op_sel_hi:[1,0,1] neg_lo:[0,0,1] neg_hi:[0,0,1]
    v_pk_fma_f32 v[26:27], v[26:27], v[148:149], v[110:111] op_sel_hi:[1,0,1] neg_lo:[0,0,1] neg_hi:[0,0,1]
    v_pk_fma_f32 v[28:29], v[28:29], v[148:149], v[112:113] op_sel_hi:[1,0,1] neg_lo:[0,0,1] neg_hi:[0,0,1]
    v_pk_fma_f32 v[30:31], v[30:31], v[148:149], v[114:115] op_sel_hi:[1,0,1] neg_lo:[0,0,1] neg_hi:[0,0,1]
    v_cvt_pk_bf16_f32 v188, v16, v24
    v_cvt_pk_bf16_f32 v189, v17, v25
    v_cvt_pk_bf16_f32 v190, v18, v26
    v_cvt_pk_bf16_f32 v191, v19, v27
    buffer_store_dwordx4 v[188:191], v14, s[8:11], s46 offen offset:0 sc1
    v_cvt_pk_bf16_f32 v192, v20, v28
    v_cvt_pk_bf16_f32 v193, v21, v29
    v_cvt_pk_bf16_f32 v194, v22, v30
    v_cvt_pk_bf16_f32 v195, v23, v31
    buffer_store_dwordx4 v[192:195], v14, s[8:11], s46 offen offset:512 sc1
    v_pk_fma_f32 v[32:33], v[32:33], v[148:149], v[132:133] op_sel_hi:[1,0,1] neg_lo:[0,0,1] neg_hi:[0,0,1]
    v_pk_fma_f32 v[34:35], v[34:35], v[148:149], v[134:135] op_sel_hi:[1,0,1] neg_lo:[0,0,1] neg_hi:[0,0,1]
    v_pk_fma_f32 v[36:37], v[36:37], v[148:149], v[136:137] op_sel_hi:[1,0,1] neg_lo:[0,0,1] neg_hi:[0,0,1]
    v_pk_fma_f32 v[38:39], v[38:39], v[148:149], v[138:139] op_sel_hi:[1,0,1] neg_lo:[0,0,1] neg_hi:[0,0,1]
    v_pk_fma_f32 v[40:41], v[40:41], v[148:149], v[140:141] op_sel_hi:[1,0,1] neg_lo:[0,0,1] neg_hi:[0,0,1]
    v_pk_fma_f32 v[42:43], v[42:43], v[148:149], v[142:143] op_sel_hi:[1,0,1] neg_lo:[0,0,1] neg_hi:[0,0,1]
    v_pk_fma_f32 v[44:45], v[44:45], v[148:149], v[144:145] op_sel_hi:[1,0,1] neg_lo:[0,0,1] neg_hi:[0,0,1]
    v_pk_fma_f32 v[46:47], v[46:47], v[148:149], v[146:147] op_sel_hi:[1,0,1] neg_lo:[0,0,1] neg_hi:[0,0,1]
    v_cvt_pk_bf16_f32 v196, v32, v40
    v_cvt_pk_bf16_f32 v197, v33, v41
    v_cvt_pk_bf16_f32 v198, v34, v42
    v_cvt_pk_bf16_f32 v199, v35, v43
    buffer_store_dwordx4 v[196:199], v14, s[8:11], s51 offen offset:0 sc1
    v_cvt_pk_bf16_f32 v200, v36, v44
    v_cvt_pk_bf16_f32 v201, v37, v45
    v_cvt_pk_bf16_f32 v202, v38, v46
    v_cvt_pk_bf16_f32 v203, v39, v47
    buffer_store_dwordx4 v[200:203], v14, s[8:11], s51 offen offset:512 sc1
    s_mul_i32 s43, s57, 22528
    s_add_u32 s43, s43, s49
    s_branch LpQQ_head
LpQQ_f_2:
    v_mfma_f32_32x32x16_bf16 v[16:31], a[76:79], v[60:63], v[16:31]
    s_add_u32 m0, s59, 0
    s_add_u32 s47, s41, 0
    buffer_load_dwordx4 v0, s[8:11], s47 offen offset:0 lds
    ds_read_b128 v[56:59], v9 offset:22528
    v_mfma_f32_32x32x16_bf16 v[32:47], a[220:223], v[60:63], v[32:47]
    s_waitcnt lgkmcnt(2)
    v_mfma_f32_32x32x16_bf16 v[16:31], a[80:83], v[48:51], v[16:31]
    buffer_load_dwordx4 v0, s[8:11], s47 offen offset:1024 lds
    ds_read_b128 v[60:63], v9 offset:23552
    v_mfma_f32_32x32x16_bf16 v[32:47], a[224:227], v[48:51], v[32:47]
    s_waitcnt lgkmcnt(2)
    v_mfma_f32_32x32x16_bf16 v[16:31], a[84:87], v[52:55], v[16:31]
    buffer_load_dwordx4 v0, s[8:11], s47 offen offset:2048 lds
    ds_read_b128 v[48:51], v9 offset:24576
    v_mfma_f32_32x32x16_bf16 v[32:47], a[228:231], v[52:55], v[32:47]
    s_waitcnt lgkmcnt(2)
    v_mfma_f32_32x32x16_bf16 v[16:31], a[88:91], v[56:59], v[16:31]
    buffer_load_dwordx4 v0, s[8:11], s47 offen offset:3072 lds
    ds_read_b128 v[52:55], v9 offset:25600
    v_mfma_f32_32x32x16_bf16 v[32:47], a[232:235], v[56:59], v[32:47]
    s_waitcnt lgkmcnt(2)
    v_mfma_f32_32x32x16_bf16 v[16:31], a[92:95], v[60:63], v[16:31]
    s_add_u32 m0, s59, 4096
    s_add_u32 s47, s41, 4096
    buffer_load_dwordx4 v0, s[8:11], s47 offen offset:0 lds
    ds_read_b128 v[56:59], v9 offset:26624
    v_mfma_f32_32x32x16_bf16 v[32:47], a[236:239], v[60:63], v[32:47]
    s_waitcnt lgkmcnt(2)
    v_mfma_f32_32x32x16_bf16 v[16:31], a[96:99], v[48:51], v[16:31]
    buffer_load_dwordx4 v0, s[8:11], s47 offen offset:1024 lds
    ds_read_b128 v[60:63], v9 offset:27648
    v_mfma_f32_32x32x16_bf16 v[32:47], a[240:243], v[48:51], v[32:47]
    s_waitcnt lgkmcnt(2)
    v_mfma_f32_32x32x16_bf16 v[16:31], a[100:103], v[52:55], v[16:31]
    buffer_load_dwordx4 v0, s[8:11], s47 offen offset:2048 lds
    ds_read_b128 v[48:51], v9 offset:28672
    v_mfma_f32_32x32x16_bf16 v[32:47], a[244:247], v[52:55], v[32:47]
    s_waitcnt lgkmcnt(2)
    v_mfma_f32_32x32x16_bf16 v[16:31], a[104:107], v[56:59], v[16:31]
    buffer_load_dwordx4 v0, s[8:11], s47 offen offset:3072 lds
    ds_read_b128 v[52:55], v9 offset:29696
    v_mfma_f32_32x32x16_bf16 v[32:47], a[248:251], v[56:59], v[32:47]
    s_waitcnt lgkmcnt(2)
    v_mfma_f32_32x32x16_bf16 v[16:31], a[108:111], v[60:63], v[16:31]
    s_add_u32 m0, s59, 8192
    s_add_u32 s47, s41, 8192
    buffer_load_dwordx4 v0, s[8:11], s47 offen offset:0 lds
    ds_read_b128 v[56:59], v9 offset:30720
    v_mfma_f32_32x32x16_bf16 v[32:47], a[252:255], v[60:63], v[32:47]
    s_waitcnt lgkmcnt(2)
    v_mfma_f32_32x32x16_bf16 v[16:31], a[112:115], v[48:51], v[16:31]
    s_mul_i32 s48, s36, 786432
    s_mul_i32 s18, s37, 6144
    s_add_u32 s48, s48, s18
    s_add_u32 s48, s48, 16125952
    s_add_u32 m0, s66, 4096
    s_nop 0
    buffer_load_dwordx4 v0, s[8:11], s48 offen lds
    ds_read_b128 v[60:63], v9 offset:31744
    v_mfma_f32_32x32x16_bf16 v[32:47], v[152:155], v[48:51], v[32:47]
    s_waitcnt lgkmcnt(2)
    v_mfma_f32_32x32x16_bf16 v[16:31], a[116:119], v[52:55], v[16:31]
    s_add_u32 m0, s66, s67
    s_sub_u32 s48, s48, 4096
    s_add_u32 s48, s48, s67
    buffer_load_dwordx4 v0, s[8:11], s48 offen lds
    ds_read_b128 v[48:51], v9 offset:32768
    v_mfma_f32_32x32x16_bf16 v[32:47], v[156:159], v[52:55], v[32:47]
    s_waitcnt lgkmcnt(2)
    v_mfma_f32_32x32x16_bf16 v[16:31], a[120:123], v[56:59], v[16:31]
    ds_read_b128 v[52:55], v9 offset:33792
    v_mfma_f32_32x32x16_bf16 v[32:47], v[160:163], v[56:59], v[32:47]
    s_waitcnt lgkmcnt(2)
    v_mfma_f32_32x32x16_bf16 v[16:31], a[124:127], v[60:63], v[16:31]
    v_cmp_eq_u32 s[76:77], 1, v2
    v_cmp_eq_u32 vcc, 2, v2
    s_cmp_eq_u64 s[76:77], -1
    s_cselect_b32 s38, 1, 0
    ds_read_b128 v[56:59], v9 offset:34816
    v_mfma_f32_32x32x16_bf16 v[32:47], v[164:167], v[60:63], v[32:47]
    s_cmp_lg_u32 s38, 0
    s_cselect_b64 exec, 1, 0
    v_mov_b32 v15, s32
    ds_write_b32 v184, v15
    v_mov_b32 v2, 2
    s_mov_b64 exec, -1
    s_waitcnt lgkmcnt(3)
    v_mfma_f32_32x32x16_bf16 v[16:31], a[128:131], v[48:51], v[16:31]
    s_add_u32 s32, s32, s38
    s_mul_i32 s38, s38, 22528
    s_add_u32 s33, s33, s38
    ds_read_b128 v[60:63], v9 offset:35840
    v_mfma_f32_32x32x16_bf16 v[32:47], v[168:171], v[48:51], v[32:47]
    s_cmp_eq_u64 vcc, 0
    s_cselect_b32 s38, s32, 0x7fff
    s_waitcnt lgkmcnt(3)
    v_mfma_f32_32x32x16_bf16 v[16:31], a[132:135], v[52:55], v[16:31]
    s_cmp_le_u32 s38, s39
    s_cselect_b64 exec, -1, 0
    v_mov_b32 v2, 2
    buffer_load_dword v2, v1, s[8:11], s33 offen sc1
    s_mov_b64 exec, -1
    v_mfma_f32_32x32x16_bf16 v[32:47], v[172:175], v[52:55], v[32:47]
    s_waitcnt lgkmcnt(2)
    v_mfma_f32_32x32x16_bf16 v[16:31], a[136:139], v[56:59], v[16:31]
    v_mfma_f32_32x32x16_bf16 v[32:47], v[176:179], v[56:59], v[32:47]
    s_waitcnt lgkmcnt(0)
    v_mfma_f32_32x32x16_bf16 v[16:31], a[140:143], v[60:63], v[16:31]
    v_mfma_f32_32x32x16_bf16 v[32:47], v[180:183], v[60:63], v[32:47]
    s_add_u32 s51, s46, 8192
    s_nop 2
    v_pk_fma_f32 v[16:17], v[16:17], v[148:149], v[100:101] op_sel_hi:[1,0,1] neg_lo:[0,0,1] neg_hi:[0,0,1]
    v_pk_fma_f32 v[18:19], v[18:19], v[148:149], v[102:103] op_sel_hi:[1,0,1] neg_lo:[0,0,1] neg_hi:[0,0,1]
    v_pk_fma_f32 v[20:21], v[20:21], v[148:149], v[104:105] op_sel_hi:[1,0,1] neg_lo:[0,0,1] neg_hi:[0,0,1]
    v_pk_fma_f32 v[22:23], v[22:23], v[148:149], v[106:107] op_sel_hi:[1,0,1] neg_lo:[0,0,1] neg_hi:[0,0,1]
    v_pk_fma_f32 v[24:25], v[24:25], v[148:149], v[108:109] op_sel_hi:[1,0,1] neg_lo:[0,0,1] neg_hi:[0,0,1]
    v_pk_fma_f32 v[26:27], v[26:27], v[148:149], v[110:111] op_sel_hi:[1,0,1] neg_lo:[0,0,1] neg_hi:[0,0,1]
    v_pk_fma_f32 v[28:29], v[28:29], v[148:149], v[112:113] op_sel_hi:[1,0,1] neg_lo:[0,0,1] neg_hi:[0,0,1]
    v_pk_fma_f32 v[30:31], v[30:31], v[148:149], v[114:115] op_sel_hi:[1,0,1] neg_lo:[0,0,1] neg_hi:[0,0,1]
    v_cvt_pk_bf16_f32 v188, v16, v24
    v_cvt_pk_bf16_f32 v189, v17, v25
    v_cvt_pk_bf16_f32 v190, v18, v26
    v_cvt_pk_bf16_f32 v191, v19, v27
    buffer_store_dwordx4 v[188:191], v14, s[8:11], s46 offen offset:0 sc1
    v_cvt_pk_bf16_f32 v192, v20, v28
    v_cvt_pk_bf16_f32 v193, v21, v29
    v_cvt_pk_bf16_f32 v194, v22, v30
    v_cvt_pk_bf16_f32 v195, v23, v31
    buffer_store_dwordx4 v[192:195], v14, s[8:11], s46 offen offset:512 sc1
    v_pk_fma_f32 v[32:33], v[32:33], v[148:149], v[132:133] op_sel_hi:[1,0,1] neg_lo:[0,0,1] neg_hi:[0,0,1]
    v_pk_fma_f32 v[34:35], v[34:35], v[148:149], v[134:135] op_sel_hi:[1,0,1] neg_lo:[0,0,1] neg_hi:[0,0,1]
    v_pk_fma_f32 v[36:37], v[36:37], v[148:149], v[136:137] op_sel_hi:[1,0,1] neg_lo:[0,0,1] neg_hi:[0,0,1]
    v_pk_fma_f32 v[38:39], v[38:39], v[148:149], v[138:139] op_sel_hi:[1,0,1] neg_lo:[0,0,1] neg_hi:[0,0,1]
    v_pk_fma_f32 v[40:41], v[40:41], v[148:149], v[140:141] op_sel_hi:[1,0,1] neg_lo:[0,0,1] neg_hi:[0,0,1]
    v_pk_fma_f32 v[42:43], v[42:43], v[148:149], v[142:143] op_sel_hi:[1,0,1] neg_lo:[0,0,1] neg_hi:[0,0,1]
    v_pk_fma_f32 v[44:45], v[44:45], v[148:149], v[144:145] op_sel_hi:[1,0,1] neg_lo:[0,0,1] neg_hi:[0,0,1]
    v_pk_fma_f32 v[46:47], v[46:47], v[148:149], v[146:147] op_sel_hi:[1,0,1] neg_lo:[0,0,1] neg_hi:[0,0,1]
    v_cvt_pk_bf16_f32 v196, v32, v40
    v_cvt_pk_bf16_f32 v197, v33, v41
    v_cvt_pk_bf16_f32 v198, v34, v42
    v_cvt_pk_bf16_f32 v199, v35, v43
    buffer_store_dwordx4 v[196:199], v14, s[8:11], s51 offen offset:0 sc1
    v_cvt_pk_bf16_f32 v200, v36, v44
    v_cvt_pk_bf16_f32 v201, v37, v45
    v_cvt_pk_bf16_f32 v202, v38, v46
    v_cvt_pk_bf16_f32 v203, v39, v47
    buffer_store_dwordx4 v[200:203], v14, s[8:11], s51 offen offset:512 sc1
    s_mul_i32 s43, s57, 22528
    s_add_u32 s43, s43, s49
    s_branch LpQQ_head
LpQQ_none:
    ds_read_b32 v15, v184
    s_waitcnt lgkmcnt(0)
    v_readfirstlane_b32 s17, v15
    s_nop 0
    s_cmp_lt_i32 s17, s37
    s_cbranch_scc1 LpQQ_nopost
    s_add_u32 m0, s59, 0
    s_add_u32 s47, s41, 0
    buffer_load_dwordx4 v0, s[8:11], s47 offen offset:0 lds
    buffer_load_dwordx4 v0, s[8:11], s47 offen offset:1024 lds
    buffer_load_dwordx4 v0, s[8:11], s47 offen offset:2048 lds
    buffer_load_dwordx4 v0, s[8:11], s47 offen offset:3072 lds
    s_add_u32 m0, s59, 4096
    s_add_u32 s47, s41, 4096
    buffer_load_dwordx4 v0, s[8:11], s47 offen offset:0 lds
    buffer_load_dwordx4 v0, s[8:11], s47 offen offset:1024 lds
    buffer_load_dwordx4 v0, s[8:11], s47 offen offset:2048 lds
    buffer_load_dwordx4 v0, s[8:11], s47 offen offset:3072 lds
    s_add_u32 m0, s59, 8192
    s_add_u32 s47, s41, 8192
    buffer_load_dwordx4 v0, s[8:11], s47 offen offset:0 lds
    s_mul_i32 s48, s36, 786432
    s_mul_i32 s18, s37, 6144
    s_add_u32 s48, s48, s18
    s_add_u32 s48, s48, 16125952
    s_add_u32 m0, s66, 4096
    s_nop 0
    buffer_load_dwordx4 v0, s[8:11], s48 offen lds
    s_add_u32 m0, s66, s67
    s_sub_u32 s48, s48, 4096
    s_add_u32 s48, s48, s67
    buffer_load_dwordx4 v0, s[8:11], s48 offen lds
    s_waitcnt vmcnt(11)
    s_cmp_lg_u32 s43, 0
    s_cselect_b64 exec, 3, 0
    buffer_store_dword v3, v185, s[8:11], s43 offen sc1
    s_mov_b64 exec, -1
    s_mov_b32 s43, 0
    s_waitcnt vmcnt(1) lgkmcnt(0)
    s_branch LpQQ_head2
LpQQ_nopost:
    s_waitcnt vmcnt(0)
    s_cmp_lg_u32 s43, 0
    s_cselect_b64 exec, 3, 0
    buffer_store_dword v3, v185, s[8:11], s43 offen sc1
    s_mov_b64 exec, -1
    s_mov_b32 s43, 0
    s_cmp_ge_u32 s37, 64
    s_cbranch_scc1 LpQQ_end
LpQQ_wait:
    s_mov_b32 s16, 0
    s_cmp_lg_u32 s14, 0
    s_cbranch_scc1 LpQQ_wl
LpQQ_wp:
    buffer_load_dword v2, v1, s[8:11], s60 offen sc1
    s_add_u32 s16, s16, 1
    s_cmp_gt_u32 s16, 100000
    s_cbranch_scc1 LpQQ_giveup
    s_waitcnt vmcnt(0)
    v_cmp_eq_u32 vcc, 0, v2
    s_nop 0
    s_cbranch_vccz LpQQ_wok
    s_sleep 4
    s_branch LpQQ_wp
LpQQ_giveup:
    v_mov_b32 v5, -2
    ds_write_b32 v184, v5
    s_waitcnt lgkmcnt(0)
    s_branch L_role_p_abort
LpQQ_wok:
    v_mov_b32 v5, s37
    ds_write_b32 v184, v5
    s_branch LpQQ_go
LpQQ_wl:
    ds_read_b32 v15, v184
    s_add_u32 s16, s16, 1
    s_cmp_gt_u32 s16, 1600000
    s_cbranch_scc1 L_role_p_abort
    s_waitcnt lgkmcnt(0)
    v_readfirstlane_b32 s17, v15
    s_nop 0
    s_cmp_eq_u32 s17, -2
    s_cbranch_scc1 L_role_p_abort
    s_cmp_ge_i32 s17, s37
    s_cbranch_scc1 LpQQ_go
    s_sleep 1
    s_branch LpQQ_wl
LpQQ_go:
    s_add_u32 m0, s59, 0
    s_add_u32 s47, s41, 0
    buffer_load_dwordx4 v0, s[8:11], s47 offen offset:0 lds
    buffer_load_dwordx4 v0, s[8:11], s47 offen offset:1024 lds
    buffer_load_dwordx4 v0, s[8:11], s47 offen offset:2048 lds
    buffer_load_dwordx4 v0, s[8:11], s47 offen offset:3072 lds
    s_add_u32 m0, s59, 4096
    s_add_u32 s47, s41, 4096
    buffer_load_dwordx4 v0, s[8:11], s47 offen offset:0 lds
    buffer_load_dwordx4 v0, s[8:11], s47 offen offset:1024 lds
    buffer_load_dwordx4 v0, s[8:11], s47 offen offset:2048 lds
    buffer_load_dwordx4 v0, s[8:11], s47 offen offset:3072 lds
    s_add_u32 m0, s59, 8192
    s_add_u32 s47, s41, 8192
    buffer_load_dwordx4 v0, s[8:11], s47 offen offset:0 lds
    s_mul_i32 s48, s36, 786432
    s_mul_i32 s18, s37, 6144
    s_add_u32 s48, s48, s18
    s_add_u32 s48, s48, 16125952
    s_add_u32 m0, s66, 4096
    s_nop 0
    buffer_load_dwordx4 v0, s[8:11], s48 offen lds
    s_add_u32 m0, s66, s67
    s_sub_u32 s48, s48, 4096
    s_add_u32 s48, s48, s67
    buffer_load_dwordx4 v0, s[8:11], s48 offen lds
    s_waitcnt vmcnt(0) lgkmcnt(0)
    s_branch LpQQ_head2
LpQQ_end:
    s_branch L_role_p_exit
Lp2_kv:
    v_mfma_f32_32x32x16_bf16 v[84:99], a[0:3], v[48:51], 0
    v_mfma_f32_32x32x16_bf16 v[32:47], v[48:51], a[144:147], 0
    v_mfma_f32_32x32x16_bf16 v[84:99], a[4:7], v[48:51], v[84:99]
    v_mfma_f32_32x32x16_bf16 v[32:47], v[48:51], a[148:151], v[32:47]
    v_mfma_f32_32x32x16_bf16 v[84:99], a[8:11], v[48:51], v[84:99]
    v_mfma_f32_32x32x16_bf16 v[32:47], v[48:51], a[152:155], v[32:47]
    v_mfma_f32_32x32x16_bf16 v[84:99], a[12:15], v[48:51], v[84:99]
    v_mfma_f32_32x32x16_bf16 v[32:47], v[48:51], a[156:159], v[32:47]
    v_mfma_f32_32x32x16_bf16 v[84:99], a[16:19], v[48:51], v[84:99]
    v_mfma_f32_32x32x16_bf16 v[32:47], v[48:51], a[160:163], v[32:47]
    v_mfma_f32_32x32x16_bf16 v[84:99], a[20:23], v[48:51], v[84:99]
    v_mfma_f32_32x32x16_bf16 v[32:47], v[48:51], a[164:167], v[32:47]
    v_mfma_f32_32x32x16_bf16 v[84:99], a[24:27], v[48:51], v[84:99]
    v_mfma_f32_32x32x16_bf16 v[32:47], v[48:51], a[168:171], v[32:47]
    v_mfma_f32_32x32x16_bf16 v[84:99], a[28:31], v[48:51], v[84:99]
    v_mfma_f32_32x32x16_bf16 v[32:47], v[48:51], a[172:175], v[32:47]
    v_mfma_f32_32x32x16_bf16 v[84:99], a[32:35], v[48:51], v[84:99]
    v_mfma_f32_32x32x16_bf16 v[32:47], v[48:51], a[176:179], v[32:47]
    v_mfma_f32_32x32x16_bf16 v[84:99], a[36:39], v[48:51], v[84:99]
    v_mfma_f32_32x32x16_bf16 v[32:47], v[48:51], a[180:183], v[32:47]
    v_mfma_f32_32x32x16_bf16 v[84:99], a[40:43], v[48:51], v[84:99]
    v_mfma_f32_32x32x16_bf16 v[32:47], v[48:51], a[184:187], v[32:47]
    v_mfma_f32_32x32x16_bf16 v[84:99], a[44:47], v[48:51], v[84:99]
    v_mfma_f32_32x32x16_bf16 v[32:47], v[48:51], a[188:191], v[32:47]
    v_mfma_f32_32x32x16_bf16 v[84:99], a[48:51], v[48:51], v[84:99]
    v_mfma_f32_32x32x16_bf16 v[32:47], v[48:51], a[192:195], v[32:47]
    v_mfma_f32_32x32x16_bf16 v[84:99], a[52:55], v[48:51], v[84:99]
    v_mfma_f32_32x32x16_bf16 v[32:47], v[48:51], a[196:199], v[32:47]
    v_mfma_f32_32x32x16_bf16 v[84:99], a[56:59], v[48:51], v[84:99]
    v_mfma_f32_32x32x16_bf16 v[32:47], v[48:51], a[200:203], v[32:47]
    v_mfma_f32_32x32x16_bf16 v[84:99], a[60:63], v[48:51], v[84:99]
    v_mfma_f32_32x32x16_bf16 v[32:47], v[48:51], a[204:207], v[32:47]
    v_mfma_f32_32x32x16_bf16 v[84:99], a[64:67], v[48:51], v[84:99]
    v_mfma_f32_32x32x16_bf16 v[32:47], v[48:51], a[208:211], v[32:47]
    v_mfma_f32_32x32x16_bf16 v[84:99], a[68:71], v[48:51], v[84:99]
    v_mfma_f32_32x32x16_bf16 v[32:47], v[48:51], a[212:215], v[32:47]
    v_mfma_f32_32x32x16_bf16 v[84:99], a[72:75], v[48:51], v[84:99]
    v_mfma_f32_32x32x16_bf16 v[32:47], v[48:51], a[216:219], v[32:47]
    v_mfma_f32_32x32x16_bf16 v[84:99], a[76:79], v[48:51], v[84:99]
    v_mfma_f32_32x32x16_bf16 v[32:47], v[48:51], a[220:223], v[32:47]
    v_mfma_f32_32x32x16_bf16 v[84:99], a[80:83], v[48:51], v[84:99]
    v_mfma_f32_32x32x16_bf16 v[32:47], v[48:51], a[224:227], v[32:47]
    v_mfma_f32_32x32x16_bf16 v[84:99], a[84:87], v[48:51], v[84:99]
    v_mfma_f32_32x32x16_bf16 v[32:47], v[48:51], a[228:231], v[32:47]
    v_mfma_f32_32x32x16_bf16 v[84:99], a[88:91], v[48:51], v[84:99]
    v_mfma_f32_32x32x16_bf16 v[32:47], v[48:51], a[232:235], v[32:47]
    v_mfma_f32_32x32x16_bf16 v[84:99], a[92:95], v[48:51], v[84:99]
    v_mfma_f32_32x32x16_bf16 v[32:47], v[48:51], a[236:239], v[32:47]
    v_mfma_f32_32x32x16_bf16 v[84:99], a[96:99], v[48:51], v[84:99]
    v_mfma_f32_32x32x16_bf16 v[32:47], v[48:51], a[240:243], v[32:47]
    v_mfma_f32_32x32x16_bf16 v[84:99], a[100:103], v[48:51], v[84:99]
    v_mfma_f32_32x32x16_bf16 v[32:47], v[48:51], a[244:247], v[32:47]
    v_mfma_f32_32x32x16_bf16 v[84:99], a[104:107], v[48:51], v[84:99]
    v_mfma_f32_32x32x16_bf16 v[32:47], v[48:51], a[248:251], v[32:47]
    v_mfma_f32_32x32x16_bf16 v[84:99], a[108:111], v[48:51], v[84:99]
    v_mfma_f32_32x32x16_bf16 v[32:47], v[48:51], a[252:255], v[32:47]
    v_mfma_f32_32x32x16_bf16 v[84:99], a[112:115], v[48:51], v[84:99]
    v_mfma_f32_32x32x16_bf16 v[32:47], v[48:51], v[152:155], v[32:47]
    v_mfma_f32_32x32x16_bf16 v[84:99], a[116:119], v[48:51], v[84:99]
    v_mfma_f32_32x32x16_bf16 v[32:47], v[48:51], v[156:159], v[32:47]
    v_mfma_f32_32x32x16_bf16 v[84:99], a[120:123], v[48:51], v[84:99]
    v_mfma_f32_32x32x16_bf16 v[32:47], v[48:51], v[160:163], v[32:47]
    v_mfma_f32_32x32x16_bf16 v[84:99], a[124:127], v[48:51], v[84:99]
    v_mfma_f32_32x32x16_bf16 v[32:47], v[48:51], v[164:167], v[32:47]
    v_mfma_f32_32x32x16_bf16 v[84:99], a[128:131], v[48:51], v[84:99]
    v_mfma_f32_32x32x16_bf16 v[32:47], v[48:51], v[168:171], v[32:47]
    v_mfma_f32_32x32x16_bf16 v[84:99], a[132:135], v[48:51], v[84:99]
    v_mfma_f32_32x32x16_bf16 v[32:47], v[48:51], v[172:175], v[32:47]
    v_mfma_f32_32x32x16_bf16 v[84:99], a[136:139], v[48:51], v[84:99]
    v_mfma_f32_32x32x16_bf16 v[32:47], v[48:51], v[176:179], v[32:47]
    v_mfma_f32_32x32x16_bf16 v[84:99], a[140:143], v[48:51], v[84:99]
    v_mfma_f32_32x32x16_bf16 v[32:47], v[48:51], v[180:183], v[32:47]
    s_nop 11
    v_mov_b32 v11, v32
    s_mov_b32 s66, 114688
    s_mov_b32 s71, 0x2000
    s_mov_b32 s36, s63
    s_mov_b32 s34, s63
    s_mul_i32 s58, s14, 9216
    s_mul_i32 s64, s63, 4718592
    s_add_u32 s64, s64, s58
    s_add_u32 s64, s64, 8650752
    s_mul_i32 s61, s63, 1441792
    s_add_u32 s61, s61, 3584
    s_mov_b32 s37, 0
    s_mov_b32 s40, 36864
    s_mov_b32 s59, s58
    s_mov_b32 s43, 0
    s_mov_b32 s62, 1
    s_mov_b32 s28, s8
    s_mov_b32 s29, s9
    s_mov_b32 s30, 0
    s_mov_b32 s31, 0x00020000
    v_mov_b32 v184, 74752
    v_mov_b32 v5, -1
    ds_write_b32 v184, v5
    s_waitcnt lgkmcnt(0)
    s_cmp_lg_u32 s14, 0
    s_cbranch_scc1 LpKV_inia_d
    v_mov_b32 v5, 40
    s_mov_b32 s16, 0
LpKV_inia:
    global_load_dword v6, v5, s[12:13] sc1
    s_add_u32 s16, s16, 1
    s_cmp_gt_u32 s16, 100000
    s_cbranch_scc1 L_role_p_abort
    s_waitcnt vmcnt(0)
    v_cmp_gt_u32 vcc, 128, v6
    s_nop 0
    s_cbranch_vccz LpKV_inia_d
    s_sleep 8
    s_branch LpKV_inia
LpKV_inia_d:
    s_barrier
    s_cmp_eq_u32 s63, 0
    s_cbranch_scc1 LpKV_ini_sk
    s_cmp_lg_u32 s14, 0
    s_cbranch_scc1 LpKV_inib_d
    v_mov_b32 v5, 160
    s_mov_b32 s16, 0
LpKV_inib:
    global_load_dword v6, v5, s[12:13] sc1
    s_add_u32 s16, s16, 1
    s_cmp_gt_u32 s16, 100000
    s_cbranch_scc1 L_role_p_abort
    s_waitcnt vmcnt(0)
    v_cmp_gt_u32 vcc, 64, v6
    s_nop 0
    s_cbranch_vccz LpKV_inib_d
    s_sleep 8
    s_branch LpKV_inib
LpKV_inib_d:
    s_barrier
LpKV_ini_sk:
    s_mul_i32 s41, s37, 36864
    s_add_u32 s41, s41, s64
    s_mul_i32 s60, s37, 22528
    s_add_u32 s60, s60, s61
    s_cmp_lt_u32 s37, 64
    s_cselect_b32 s60, s60, 2883584
    s_branch LpKV_wait
LpKV_head:
    s_waitcnt vmcnt(4)
LpKV_head2:
    s_barrier
    ds_read_b32 v15, v184
    s_xor_b32 s40, s40, 36864
    s_xor_b32 s59, s59, 36864
    s_mov_b32 s35, s37
    s_lshl_b32 s57, s34, 6
    s_add_u32 s57, s57, s35
    s_add_u32 s37, s37, 1
    s_mov_b32 s39, 0
    s_mov_b32 s54, 0
    s_xor_b32 s66, s66, 8192
    s_xor_b32 s71, s71, 8192
    s_mul_i32 s41, s37, 36864
    s_add_u32 s41, s41, s64
    s_mul_i32 s60, s37, 22528
    s_add_u32 s60, s60, s61
    s_cmp_lt_u32 s37, 64
    s_cselect_b32 s60, s60, 2883584
    v_add_u32 v9, s40, v0
    v_add_u32 v5, s71, v10
    ds_read_b128 v[48:51], v9 offset:0
    ds_read_b128 v[52:55], v9 offset:1024
    ds_read_b128 v[56:59], v9 offset:2048
    ds_read_b128 v[64:67], v5 offset:0
    ds_read_b128 v[68:71], v5 offset:512
    ds_read_b128 v[72:75], v5 offset:1024
    ds_read_b128 v[76:79], v5 offset:1536
    ds_read_b128 v[80:83], v5 offset:2048
    s_waitcnt lgkmcnt(7)
    v_mfma_f32_32x32x16_bf16 v[16:31], a[0:3], v[48:51], 0
    ds_read_b128 v[60:63], v9 offset:3072
    v_mfma_f32_32x32x16_bf16 v[32:47], v[48:51], a[144:147], 0
    s_waitcnt lgkmcnt(4)
    v_add_f32 v64, v64, v68
    v_add_f32 v65, v65, v69
    v_add_f32 v66, v66, v70
    v_add_f32 v67, v67, v71
    v_mfma_f32_32x32x16_bf16 v[16:31], a[4:7], v[52:55], v[16:31]
    ds_read_b128 v[48:51], v9 offset:4096
    s_waitcnt lgkmcnt(4)
    v_add_f32 v64, v64, v72
    v_add_f32 v65, v65, v73
    v_add_f32 v66, v66, v74
    v_mfma_f32_32x32x16_bf16 v[32:47], v[52:55], a[148:151], v[32:47]
    v_add_f32 v67, v67, v75
    s_waitcnt lgkmcnt(3)
    v_add_f32 v64, v64, v76
    v_add_f32 v65, v65, v77
    v_add_f32 v66, v66, v78
    v_readfirstlane_b32 s17, v15
    s_nop 0
    s_add_u32 s18, s17, 1
    s_max_i32 s32, s18, s37
    s_add_u32 s39, s37, 1
    s_min_u32 s39, s39, 63
    s_mul_i32 s33, s32, 22528
    s_add_u32 s33, s33, s61
    s_cmp_eq_u32 s14, 0
    s_cselect_b32 s18, s32, 0x7fff
    v_mov_b32 v2, 2
    s_cmp_le_u32 s18, s39
    s_cselect_b64 exec, -1, 0
    buffer_load_dword v2, v1, s[8:11], s33 offen sc1
    s_mov_b64 exec, -1
    s_cmp_ge_i32 s17, s37
    s_cbranch_scc1 LpKV_f_3
    v_mfma_f32_32x32x16_bf16 v[16:31], a[8:11], v[56:59], v[16:31]
    ds_read_b128 v[52:55], v9 offset:5120
    v_add_f32 v67, v67, v79
    s_waitcnt lgkmcnt(3)
    v_add_f32 v64, v64, v80
    v_add_f32 v65, v65, v81
    v_mfma_f32_32x32x16_bf16 v[32:47], v[56:59], a[152:155], v[32:47]
    v_add_f32 v66, v66, v82
    v_add_f32 v67, v67, v83
    v_add_f32 v64, v64, v66
    v_add_f32 v65, v65, v67
    s_waitcnt lgkmcnt(2)
    v_mfma_f32_32x32x16_bf16 v[16:31], a[12:15], v[60:63], v[16:31]
    ds_read_b128 v[56:59], v9 offset:6144
    v_mov_b32 v66, v64
    v_mov_b32 v67, v65
    s_nop 0
    v_permlane32_swap_b32 v64, v66
    v_mfma_f32_32x32x16_bf16 v[32:47], v[60:63], a[156:159], v[32:47]
    v_permlane32_swap_b32 v65, v67
    v_add_f32 v64, v64, v66
    v_add_f32 v65, v65, v67
    v_mul_f32 v64, 0x3ae38e39, v64
    s_waitcnt lgkmcnt(2)
    v_mfma_f32_32x32x16_bf16 v[16:31], a[16:19], v[48:51], v[16:31]
    ds_read_b128 v[60:63], v9 offset:7168
    v_mul_f32 v65, 0x3ae38e39, v65
    v_fma_f32 v65, -v64, v64, v65
    v_max_f32 v65, 0, v65
    v_mfma_f32_32x32x16_bf16 v[32:47], v[48:51], a[160:163], v[32:47]
    v_add_f32 v65, 0x3727c5ac, v65
    v_rsq_f32 v148, v65
    s_nop 0
    v_mul_f32 v149, v64, v148
    v_mul_f32 v100, v149, v84
    s_waitcnt lgkmcnt(2)
    v_mfma_f32_32x32x16_bf16 v[16:31], a[20:23], v[52:55], v[16:31]
    ds_read_b128 v[48:51], v9 offset:8192
    v_mul_f32 v101, v149, v85
    v_mul_f32 v102, v149, v86
    v_mul_f32 v103, v149, v87
    v_mfma_f32_32x32x16_bf16 v[32:47], v[52:55], a[164:167], v[32:47]
    v_mul_f32 v104, v149, v88
    v_mul_f32 v105, v149, v89
    v_mul_f32 v106, v149, v90
    v_mul_f32 v107, v149, v91
    s_waitcnt lgkmcnt(2)
    v_mfma_f32_32x32x16_bf16 v[16:31], a[24:27], v[56:59], v[16:31]
    ds_read_b128 v[52:55], v9 offset:9216
    v_mul_f32 v108, v149, v92
    v_mul_f32 v109, v149, v93
    v_mul_f32 v110, v149, v94
    v_mfma_f32_32x32x16_bf16 v[32:47], v[56:59], a[168:171], v[32:47]
    v_mul_f32 v111, v149, v95
    v_mul_f32 v112, v149, v96
    v_mul_f32 v113, v149, v97
    v_mul_f32 v114, v149, v98
    s_waitcnt lgkmcnt(2)
    v_mfma_f32_32x32x16_bf16 v[16:31], a[28:31], v[60:63], v[16:31]
    ds_read_b128 v[56:59], v9 offset:10240
    v_mul_f32 v115, v149, v99
    ds_write2_b32 v12, v148, v149 offset0:0 offset1:32
    ds_read_b128 v[116:119], v13 offset:0
    v_mfma_f32_32x32x16_bf16 v[32:47], v[60:63], a[172:175], v[32:47]
    ds_read_b128 v[120:123], v13 offset:32
    ds_read_b128 v[124:127], v13 offset:64
    ds_read_b128 v[128:131], v13 offset:96
    ds_read_b128 v[132:135], v13 offset:128
    s_waitcnt lgkmcnt(8)
    v_mfma_f32_32x32x16_bf16 v[16:31], a[32:35], v[48:51], v[16:31]
    ds_read_b128 v[60:63], v9 offset:11264
    ds_read_b128 v[136:139], v13 offset:160
    ds_read_b128 v[140:143], v13 offset:192
    ds_read_b128 v[144:147], v13 offset:224
    v_mfma_f32_32x32x16_bf16 v[32:47], v[48:51], a[176:179], v[32:47]
    s_waitcnt lgkmcnt(11)
    v_mfma_f32_32x32x16_bf16 v[16:31], a[36:39], v[52:55], v[16:31]
    ds_read_b128 v[48:51], v9 offset:12288
    v_mfma_f32_32x32x16_bf16 v[32:47], v[52:55], a[180:183], v[32:47]
    s_waitcnt lgkmcnt(5)
    v_mul_f32 v132, v11, v132
    v_mul_f32 v133, v11, v133
    v_mfma_f32_32x32x16_bf16 v[16:31], a[40:43], v[56:59], v[16:31]
    ds_read_b128 v[52:55], v9 offset:13312
    v_mul_f32 v134, v11, v134
    v_mul_f32 v135, v11, v135
    s_waitcnt lgkmcnt(4)
    v_mul_f32 v136, v11, v136
    v_mfma_f32_32x32x16_bf16 v[32:47], v[56:59], a[184:187], v[32:47]
    v_mul_f32 v137, v11, v137
    v_mul_f32 v138, v11, v138
    v_mul_f32 v139, v11, v139
    s_waitcnt lgkmcnt(3)
    v_mul_f32 v140, v11, v140
    v_mfma_f32_32x32x16_bf16 v[16:31], a[44:47], v[60:63], v[16:31]
    ds_read_b128 v[56:59], v9 offset:14336
    v_mul_f32 v141, v11, v141
    v_mul_f32 v142, v11, v142
    v_mul_f32 v143, v11, v143
    v_mfma_f32_32x32x16_bf16 v[32:47], v[60:63], a[188:191], v[32:47]
    s_waitcnt lgkmcnt(3)
    v_mul_f32 v144, v11, v144
    v_mul_f32 v145, v11, v145
    v_mul_f32 v146, v11, v146
    v_mul_f32 v147, v11, v147
    s_waitcnt lgkmcnt(2)
    v_mfma_f32_32x32x16_bf16 v[16:31], a[48:51], v[48:51], v[16:31]
    ds_read_b128 v[60:63], v9 offset:15360
    s_mul_i32 s46, s34, 50331648
    s_lshl_b32 s51, s35, 18
    s_add_u32 s46, s46, s51
    v_mfma_f32_32x32x16_bf16 v[32:47], v[48:51], a[192:195], v[32:47]
    s_add_u32 s46, s46, s52
    s_waitcnt vmcnt(1)
    s_cmp_lg_u32 s43, 0
    s_cselect_b64 exec, 3, 0
    buffer_store_dword v3, v185, s[8:11], s43 offen sc1
    s_mov_b64 exec, -1
    s_mov_b32 s43, 0
    s_waitcnt lgkmcnt(2)
    v_mfma_f32_32x32x16_bf16 v[16:31], a[52:55], v[52:55], v[16:31]
    ds_read_b128 v[48:51], v9 offset:16384
    v_mfma_f32_32x32x16_bf16 v[32:47], v[52:55], a[196:199], v[32:47]
    s_waitcnt lgkmcnt(2)
    v_mfma_f32_32x32x16_bf16 v[16:31], a[56:59], v[56:59], v[16:31]
    v_cmp_eq_u32 s[76:77], 1, v2
    v_cmp_eq_u32 vcc, 2, v2
    s_cmp_eq_u64 s[76:77], -1
    s_cselect_b32 s38, 1, 0
    ds_read_b128 v[52:55], v9 offset:17408
    v_mfma_f32_32x32x16_bf16 v[32:47], v[56:59], a[200:203], v[32:47]
    s_cmp_lg_u32 s38, 0
    s_cselect_b64 exec, 1, 0
    v_mov_b32 v15, s32
    ds_write_b32 v184, v15
    v_mov_b32 v2, 2
    s_mov_b64 exec, -1
    s_waitcnt lgkmcnt(3)
    v_mfma_f32_32x32x16_bf16 v[16:31], a[60:63], v[60:63], v[16:31]
    s_add_u32 s32, s32, s38
    s_mul_i32 s38, s38, 22528
    s_add_u32 s33, s33, s38
    ds_read_b128 v[56:59], v9 offset:18432
    v_mfma_f32_32x32x16_bf16 v[32:47], v[60:63], a[204:207], v[32:47]
    s_cmp_eq_u64 vcc, 0
    s_cselect_b32 s38, s32, 0x7fff
    s_waitcnt lgkmcnt(3)
    v_mfma_f32_32x32x16_bf16 v[16:31], a[64:67], v[48:51], v[16:31]
    ds_read_b128 v[60:63], v9 offset:19456
    v_mfma_f32_32x32x16_bf16 v[32:47], v[48:51], a[208:211], v[32:47]
    s_cmp_le_u32 s38, s39
    s_cselect_b64 exec, -1, 0
    v_mov_b32 v2, 2
    buffer_load_dword v2, v1, s[8:11], s33 offen sc1
    s_mov_b64 exec, -1
    ds_read_b32 v15, v184
    s_waitcnt lgkmcnt(4)
    v_mfma_f32_32x32x16_bf16 v[16:31], a[68:71], v[52:55], v[16:31]
    ds_read_b128 v[48:51], v9 offset:20480
    v_mfma_f32_32x32x16_bf16 v[32:47], v[52:55], a[212:215], v[32:47]
    s_waitcnt lgkmcnt(3)
    v_mfma_f32_32x32x16_bf16 v[16:31], a[72:75], v[56:59], v[16:31]
    ds_read_b128 v[52:55], v9 offset:21504
    v_mfma_f32_32x32x16_bf16 v[32:47], v[56:59], a[216:219], v[32:47]
    s_waitcnt lgkmcnt(2)
    v_readfirstlane_b32 s17, v15
    s_nop 0
    s_cmp_ge_i32 s17, s37
    s_cbranch_scc1 LpKV_f_4
    v_mfma_f32_32x32x16_bf16 v[16:31], a[76:79], v[60:63], v[16:31]
    ds_read_b128 v[56:59], v9 offset:22528
    v_mfma_f32_32x32x16_bf16 v[32:47], v[60:63], a[220:223], v[32:47]
    s_waitcnt lgkmcnt(2)
    v_mfma_f32_32x32x16_bf16 v[16:31], a[80:83], v[48:51], v[16:31]
    ds_read_b128 v[60:63], v9 offset:23552
    v_mfma_f32_32x32x16_bf16 v[32:47], v[48:51], a[224:227], v[32:47]
    s_waitcnt lgkmcnt(2)
    v_mfma_f32_32x32x16_bf16 v[16:31], a[84:87], v[52:55], v[16:31]
    ds_read_b128 v[48:51], v9 offset:24576
    v_mfma_f32_32x32x16_bf16 v[32:47], v[52:55], a[228:231], v[32:47]
    s_waitcnt lgkmcnt(2)
    v_mfma_f32_32x32x16_bf16 v[16:31], a[88:91], v[56:59], v[16:31]
    ds_read_b128 v[52:55], v9 offset:25600
    v_mfma_f32_32x32x16_bf16 v[32:47], v[56:59], a[232:235], v[32:47]
    s_waitcnt lgkmcnt(2)
    v_mfma_f32_32x32x16_bf16 v[16:31], a[92:95], v[60:63], v[16:31]
    ds_read_b128 v[56:59], v9 offset:26624
    v_mfma_f32_32x32x16_bf16 v[32:47], v[60:63], a[236:239], v[32:47]
    s_waitcnt lgkmcnt(2)
    v_mfma_f32_32x32x16_bf16 v[16:31], a[96:99], v[48:51], v[16:31]
    ds_read_b128 v[60:63], v9 offset:27648
    v_mfma_f32_32x32x16_bf16 v[32:47], v[48:51], a[240:243], v[32:47]
    s_waitcnt lgkmcnt(2)
    v_mfma_f32_32x32x16_bf16 v[16:31], a[100:103], v[52:55], v[16:31]
    ds_read_b128 v[48:51], v9 offset:28672
    v_mfma_f32_32x32x16_bf16 v[32:47], v[52:55], a[244:247], v[32:47]
    s_waitcnt lgkmcnt(2)
    v_mfma_f32_32x32x16_bf16 v[16:31], a[104:107], v[56:59], v[16:31]
    ds_read_b128 v[52:55], v9 offset:29696
    v_mfma_f32_32x32x16_bf16 v[32:47], v[56:59], a[248:251], v[32:47]
    s_waitcnt lgkmcnt(2)
    v_mfma_f32_32x32x16_bf16 v[16:31], a[108:111], v[60:63], v[16:31]
    ds_read_b128 v[56:59], v9 offset:30720
    v_mfma_f32_32x32x16_bf16 v[32:47], v[60:63], a[252:255], v[32:47]
    s_waitcnt lgkmcnt(2)
    v_mfma_f32_32x32x16_bf16 v[16:31], a[112:115], v[48:51], v[16:31]
    ds_read_b128 v[60:63], v9 offset:31744
    v_mfma_f32_32x32x16_bf16 v[32:47], v[48:51], v[152:155], v[32:47]
    s_waitcnt lgkmcnt(2)
    v_mfma_f32_32x32x16_bf16 v[16:31], a[116:119], v[52:55], v[16:31]
    ds_read_b128 v[48:51], v9 offset:32768
    v_mfma_f32_32x32x16_bf16 v[32:47], v[52:55], v[156:159], v[32:47]
    s_waitcnt lgkmcnt(2)
    v_mfma_f32_32x32x16_bf16 v[16:31], a[120:123], v[56:59], v[16:31]
    ds_read_b128 v[52:55], v9 offset:33792
    v_mfma_f32_32x32x16_bf16 v[32:47], v[56:59], v[160:163], v[32:47]
    s_waitcnt lgkmcnt(2)
    v_mfma_f32_32x32x16_bf16 v[16:31], a[124:127], v[60:63], v[16:31]
    v_cmp_eq_u32 s[76:77], 1, v2
    v_cmp_eq_u32 vcc, 2, v2
    s_cmp_eq_u64 s[76:77], -1
    s_cselect_b32 s38, 1, 0
    ds_read_b128 v[56:59], v9 offset:34816
    v_mfma_f32_32x32x16_bf16 v[32:47], v[60:63], v[164:167], v[32:47]
    s_cmp_lg_u32 s38, 0
    s_cselect_b64 exec, 1, 0
    v_mov_b32 v15, s32
    ds_write_b32 v184, v15
    v_mov_b32 v2, 2
    s_mov_b64 exec, -1
    s_waitcnt lgkmcnt(3)
    v_mfma_f32_32x32x16_bf16 v[16:31], a[128:131], v[48:51], v[16:31]
    s_add_u32 s32, s32, s38
    s_mul_i32 s38, s38, 22528
    s_add_u32 s33, s33, s38
    ds_read_b128 v[60:63], v9 offset:35840
    v_mfma_f32_32x32x16_bf16 v[32:47], v[48:51], v[168:171], v[32:47]
    s_cmp_eq_u64 vcc, 0
    s_cselect_b32 s38, s32, 0x7fff
    s_waitcnt lgkmcnt(3)
    v_mfma_f32_32x32x16_bf16 v[16:31], a[132:135], v[52:55], v[16:31]
    s_cmp_le_u32 s38, s39
    s_cselect_b64 exec, -1, 0
    v_mov_b32 v2, 2
    buffer_load_dword v2, v1, s[8:11], s33 offen sc1
    s_mov_b64 exec, -1
    v_mfma_f32_32x32x16_bf16 v[32:47], v[52:55], v[172:175], v[32:47]
    s_waitcnt lgkmcnt(2)
    v_mfma_f32_32x32x16_bf16 v[16:31], a[136:139], v[56:59], v[16:31]
    v_mfma_f32_32x32x16_bf16 v[32:47], v[56:59], v[176:179], v[32:47]
    s_waitcnt lgkmcnt(0)
    v_mfma_f32_32x32x16_bf16 v[16:31], a[140:143], v[60:63], v[16:31]
    v_mfma_f32_32x32x16_bf16 v[32:47], v[60:63], v[180:183], v[32:47]
    s_add_u32 s51, s46, 16777216
    s_nop 2
    v_pk_fma_f32 v[16:17], v[16:17], v[148:149], v[100:101] op_sel_hi:[1,0,1] neg_lo:[0,0,1] neg_hi:[0,0,1]
    v_pk_fma_f32 v[18:19], v[18:19], v[148:149], v[102:103] op_sel_hi:[1,0,1] neg_lo:[0,0,1] neg_hi:[0,0,1]
    v_pk_fma_f32 v[20:21], v[20:21], v[148:149], v[104:105] op_sel_hi:[1,0,1] neg_lo:[0,0,1] neg_hi:[0,0,1]
    v_pk_fma_f32 v[22:23], v[22:23], v[148:149], v[106:107] op_sel_hi:[1,0,1] neg_lo:[0,0,1] neg_hi:[0,0,1]
    v_pk_fma_f32 v[24:25], v[24:25], v[148:149], v[108:109] op_sel_hi:[1,0,1] neg_lo:[0,0,1] neg_hi:[0,0,1]
    v_pk_fma_f32 v[26:27], v[26:27], v[148:149], v[110:111] op_sel_hi:[1,0,1] neg_lo:[0,0,1] neg_hi:[0,0,1]
    v_pk_fma_f32 v[28:29], v[28:29], v[148:149], v[112:113] op_sel_hi:[1,0,1] neg_lo:[0,0,1] neg_hi:[0,0,1]
    v_pk_fma_f32 v[30:31], v[30:31], v[148:149], v[114:115] op_sel_hi:[1,0,1] neg_lo:[0,0,1] neg_hi:[0,0,1]
    v_cvt_pk_bf16_f32 v188, v16, v24
    v_cvt_pk_bf16_f32 v189, v17, v25
    v_cvt_pk_bf16_f32 v190, v18, v26
    v_cvt_pk_bf16_f32 v191, v19, v27
    buffer_store_dwordx4 v[188:191], v14, s[8:11], s46 offen offset:0 sc1
    v_cvt_pk_bf16_f32 v192, v20, v28
    v_cvt_pk_bf16_f32 v193, v21, v29
    v_cvt_pk_bf16_f32 v194, v22, v30
    v_cvt_pk_bf16_f32 v195, v23, v31
    buffer_store_dwordx4 v[192:195], v14, s[8:11], s46 offen offset:512 sc1
    v_pk_fma_f32 v[32:33], v[32:33], v[116:117], v[132:133] neg_lo:[0,0,1] neg_hi:[0,0,1]
    v_pk_fma_f32 v[34:35], v[34:35], v[118:119], v[134:135] neg_lo:[0,0,1] neg_hi:[0,0,1]
    v_pk_fma_f32 v[36:37], v[36:37], v[120:121], v[136:137] neg_lo:[0,0,1] neg_hi:[0,0,1]
    v_pk_fma_f32 v[38:39], v[38:39], v[122:123], v[138:139] neg_lo:[0,0,1] neg_hi:[0,0,1]
    v_pk_fma_f32 v[40:41], v[40:41], v[124:125], v[140:141] neg_lo:[0,0,1] neg_hi:[0,0,1]
    v_pk_fma_f32 v[42:43], v[42:43], v[126:127], v[142:143] neg_lo:[0,0,1] neg_hi:[0,0,1]
    v_pk_fma_f32 v[44:45], v[44:45], v[128:129], v[144:145] neg_lo:[0,0,1] neg_hi:[0,0,1]
    v_pk_fma_f32 v[46:47], v[46:47], v[130:131], v[146:147] neg_lo:[0,0,1] neg_hi:[0,0,1]
    v_cvt_pk_bf16_f32 v196, v32, v33
    v_cvt_pk_bf16_f32 v197, v34, v35
    v_cvt_pk_bf16_f32 v198, v40, v41
    v_cvt_pk_bf16_f32 v199, v42, v43
    buffer_store_dwordx4 v[196:199], v14, s[8:11], s51 offen offset:0 sc1
    v_cvt_pk_bf16_f32 v200, v36, v37
    v_cvt_pk_bf16_f32 v201, v38, v39
    v_cvt_pk_bf16_f32 v202, v44, v45
    v_cvt_pk_bf16_f32 v203, v46, v47
    buffer_store_dwordx4 v[200:203], v14, s[8:11], s51 offen offset:512 sc1
    s_mul_i32 s43, s57, 22528
    s_add_u32 s43, s43, s49
    s_branch LpKV_none
LpKV_f_3:
    v_mfma_f32_32x32x16_bf16 v[16:31], a[8:11], v[56:59], v[16:31]
    ds_read_b128 v[52:55], v9 offset:5120
    v_add_f32 v67, v67, v79
    s_waitcnt lgkmcnt(3)
    v_add_f32 v64, v64, v80
    v_add_f32 v65, v65, v81
    v_mfma_f32_32x32x16_bf16 v[32:47], v[56:59], a[152:155], v[32:47]
    v_add_f32 v66, v66, v82
    v_add_f32 v67, v67, v83
    v_add_f32 v64, v64, v66
    v_add_f32 v65, v65, v67
    s_waitcnt lgkmcnt(2)
    v_mfma_f32_32x32x16_bf16 v[16:31], a[12:15], v[60:63], v[16:31]
    ds_read_b128 v[56:59], v9 offset:6144
    v_mov_b32 v66, v64
    v_mov_b32 v67, v65
    s_nop 0
    v_permlane32_swap_b32 v64, v66
    v_mfma_f32_32x32x16_bf16 v[32:47], v[60:63], a[156:159], v[32:47]
    v_permlane32_swap_b32 v65, v67
    v_add_f32 v64, v64, v66
    v_add_f32 v65, v65, v67
    v_mul_f32 v64, 0x3ae38e39, v64
    s_waitcnt lgkmcnt(2)
    v_mfma_f32_32x32x16_bf16 v[16:31], a[16:19], v[48:51], v[16:31]
    ds_read_b128 v[60:63], v9 offset:7168
    v_mul_f32 v65, 0x3ae38e39, v65
    v_fma_f32 v65, -v64, v64, v65
    v_max_f32 v65, 0, v65
    v_mfma_f32_32x32x16_bf16 v[32:47], v[48:51], a[160:163], v[32:47]
    v_add_f32 v65, 0x3727c5ac, v65
    v_rsq_f32 v148, v65
    s_nop 0
    v_mul_f32 v149, v64, v148
    v_mul_f32 v100, v149, v84
    s_waitcnt lgkmcnt(2)
    v_mfma_f32_32x32x16_bf16 v[16:31], a[20:23], v[52:55], v[16:31]
    ds_read_b128 v[48:51], v9 offset:8192
    v_mul_f32 v101, v149, v85
    v_mul_f32 v102, v149, v86
    v_mul_f32 v103, v149, v87
    v_mfma_f32_32x32x16_bf16 v[32:47], v[52:55], a[164:167], v[32:47]
    v_mul_f32 v104, v149, v88
    v_mul_f32 v105, v149, v89
    v_mul_f32 v106, v149, v90
    v_mul_f32 v107, v149, v91
    s_waitcnt lgkmcnt(2)
    v_mfma_f32_32x32x16_bf16 v[16:31], a[24:27], v[56:59], v[16:31]
    ds_read_b128 v[52:55], v9 offset:9216
    v_mul_f32 v108, v149, v92
    v_mul_f32 v109, v149, v93
    v_mul_f32 v110, v149, v94
    v_mfma_f32_32x32x16_bf16 v[32:47], v[56:59], a[168:171], v[32:47]
    v_mul_f32 v111, v149, v95
    v_mul_f32 v112, v149, v96
    v_mul_f32 v113, v149, v97
    v_mul_f32 v114, v149, v98
    s_waitcnt lgkmcnt(2)
    v_mfma_f32_32x32x16_bf16 v[16:31], a[28:31], v[60:63], v[16:31]
    ds_read_b128 v[56:59], v9 offset:10240
    v_mul_f32 v115, v149, v99
    ds_write2_b32 v12, v148, v149 offset0:0 offset1:32
    ds_read_b128 v[116:119], v13 offset:0
    v_mfma_f32_32x32x16_bf16 v[32:47], v[60:63], a[172:175], v[32:47]
    ds_read_b128 v[120:123], v13 offset:32
    ds_read_b128 v[124:127], v13 offset:64
    ds_read_b128 v[128:131], v13 offset:96
    ds_read_b128 v[132:135], v13 offset:128
    s_waitcnt lgkmcnt(8)
    v_mfma_f32_32x32x16_bf16 v[16:31], a[32:35], v[48:51], v[16:31]
    ds_read_b128 v[60:63], v9 offset:11264
    ds_read_b128 v[136:139], v13 offset:160
    ds_read_b128 v[140:143], v13 offset:192
    ds_read_b128 v[144:147], v13 offset:224
    v_mfma_f32_32x32x16_bf16 v[32:47], v[48:51], a[176:179], v[32:47]
    s_add_u32 m0, s59, 0
    s_add_u32 s47, s41, 0
    buffer_load_dwordx4 v0, s[8:11], s47 offen offset:0 lds
    buffer_load_dwordx4 v0, s[8:11], s47 offen offset:1024 lds
    buffer_load_dwordx4 v0, s[8:11], s47 offen offset:2048 lds
    s_waitcnt lgkmcnt(11)
    v_mfma_f32_32x32x16_bf16 v[16:31], a[36:39], v[52:55], v[16:31]
    buffer_load_dwordx4 v0, s[8:11], s47 offen offset:3072 lds
    s_add_u32 m0, s59, 4096
    s_add_u32 s47, s41, 4096
    buffer_load_dwordx4 v0, s[8:11], s47 offen offset:0 lds
    ds_read_b128 v[48:51], v9 offset:12288
    v_mfma_f32_32x32x16_bf16 v[32:47], v[52:55], a[180:183], v[32:47]
    buffer_load_dwordx4 v0, s[8:11], s47 offen offset:1024 lds
    buffer_load_dwordx4 v0, s[8:11], s47 offen offset:2048 lds
    buffer_load_dwordx4 v0, s[8:11], s47 offen offset:3072 lds
    s_waitcnt lgkmcnt(5)
    v_mul_f32 v132, v11, v132
    v_mul_f32 v133, v11, v133
    v_mfma_f32_32x32x16_bf16 v[16:31], a[40:43], v[56:59], v[16:31]
    ds_read_b128 v[52:55], v9 offset:13312
    v_mul_f32 v134, v11, v134
    v_mul_f32 v135, v11, v135
    s_waitcnt lgkmcnt(4)
    v_mul_f32 v136, v11, v136
    v_mfma_f32_32x32x16_bf16 v[32:47], v[56:59], a[184:187], v[32:47]
    v_mul_f32 v137, v11, v137
    v_mul_f32 v138, v11, v138
    v_mul_f32 v139, v11, v139
    s_waitcnt lgkmcnt(3)
    v_mul_f32 v140, v11, v140
    v_mfma_f32_32x32x16_bf16 v[16:31], a[44:47], v[60:63], v[16:31]
    ds_read_b128 v[56:59], v9 offset:14336
    v_mul_f32 v141, v11, v141
    v_mul_f32 v142, v11, v142
    v_mul_f32 v143, v11, v143
    v_mfma_f32_32x32x16_bf16 v[32:47], v[60:63], a[188:191], v[32:47]
    s_waitcnt lgkmcnt(3)
    v_mul_f32 v144, v11, v144
    v_mul_f32 v145, v11, v145
    v_mul_f32 v146, v11, v146
    v_mul_f32 v147, v11, v147
    s_waitcnt lgkmcnt(2)
    v_mfma_f32_32x32x16_bf16 v[16:31], a[48:51], v[48:51], v[16:31]
    ds_read_b128 v[60:63], v9 offset:15360
    s_mul_i32 s46, s34, 50331648
    s_lshl_b32 s51, s35, 18
    s_add_u32 s46, s46, s51
    v_mfma_f32_32x32x16_bf16 v[32:47], v[48:51], a[192:195], v[32:47]
    s_add_u32 m0, s59, 8192
    s_add_u32 s47, s41, 8192
    buffer_load_dwordx4 v0, s[8:11], s47 offen offset:0 lds
    s_add_u32 s46, s46, s52
    s_waitcnt vmcnt(10)
    s_cmp_lg_u32 s43, 0
    s_cselect_b64 exec, 3, 0
    buffer_store_dword v3, v185, s[8:11], s43 offen sc1
    s_mov_b64 exec, -1
    s_mov_b32 s43, 0
    s_waitcnt lgkmcnt(2)
    v_mfma_f32_32x32x16_bf16 v[16:31], a[52:55], v[52:55], v[16:31]
    s_mul_i32 s48, s36, 786432
    s_mul_i32 s18, s37, 6144
    s_add_u32 s48, s48, s18
    s_add_u32 s48, s48, 16125952
    s_add_u32 m0, s66, 4096
    s_nop 0
    buffer_load_dwordx4 v0, s[8:11], s48 offen lds
    ds_read_b128 v[48:51], v9 offset:16384
    v_mfma_f32_32x32x16_bf16 v[32:47], v[52:55], a[196:199], v[32:47]
    s_add_u32 m0, s66, s67
    s_sub_u32 s48, s48, 4096
    s_add_u32 s48, s48, s67
    buffer_load_dwordx4 v0, s[8:11], s48 offen lds
    s_waitcnt lgkmcnt(2)
    v_mfma_f32_32x32x16_bf16 v[16:31], a[56:59], v[56:59], v[16:31]
    v_cmp_eq_u32 s[76:77], 1, v2
    v_cmp_eq_u32 vcc, 2, v2
    s_cmp_eq_u64 s[76:77], -1
    s_cselect_b32 s38, 1, 0
    ds_read_b128 v[52:55], v9 offset:17408
    v_mfma_f32_32x32x16_bf16 v[32:47], v[56:59], a[200:203], v[32:47]
    s_cmp_lg_u32 s38, 0
    s_cselect_b64 exec, 1, 0
    v_mov_b32 v15, s32
    ds_write_b32 v184, v15
    v_mov_b32 v2, 2
    s_mov_b64 exec, -1
    s_waitcnt lgkmcnt(3)
    v_mfma_f32_32x32x16_bf16 v[16:31], a[60:63], v[60:63], v[16:31]
    s_add_u32 s32, s32, s38
    s_mul_i32 s38, s38, 22528
    s_add_u32 s33, s33, s38
    ds_read_b128 v[56:59], v9 offset:18432
    v_mfma_f32_32x32x16_bf16 v[32:47], v[60:63], a[204:207], v[32:47]
    s_cmp_eq_u64 vcc, 0
    s_cselect_b32 s38, s32, 0x7fff
    s_waitcnt lgkmcnt(3)
    v_mfma_f32_32x32x16_bf16 v[16:31], a[64:67], v[48:51], v[16:31]
    ds_read_b128 v[60:63], v9 offset:19456
    v_mfma_f32_32x32x16_bf16 v[32:47], v[48:51], a[208:211], v[32:47]
    s_cmp_le_u32 s38, s39
    s_cselect_b64 exec, -1, 0
    v_mov_b32 v2, 2
    buffer_load_dword v2, v1, s[8:11], s33 offen sc1
    s_mov_b64 exec, -1
    s_waitcnt lgkmcnt(3)
    v_mfma_f32_32x32x16_bf16 v[16:31], a[68:71], v[52:55], v[16:31]
    ds_read_b128 v[48:51], v9 offset:20480
    v_mfma_f32_32x32x16_bf16 v[32:47], v[52:55], a[212:215], v[32:47]
    s_waitcnt lgkmcnt(2)
    v_mfma_f32_32x32x16_bf16 v[16:31], a[72:75], v[56:59], v[16:31]
    ds_read_b128 v[52:55], v9 offset:21504
    v_mfma_f32_32x32x16_bf16 v[32:47], v[56:59], a[216:219], v[32:47]
    s_waitcnt lgkmcnt(2)
    v_mfma_f32_32x32x16_bf16 v[16:31], a[76:79], v[60:63], v[16:31]
    ds_read_b128 v[56:59], v9 offset:22528
    v_mfma_f32_32x32x16_bf16 v[32:47], v[60:63], a[220:223], v[32:47]
    s_waitcnt lgkmcnt(2)
    v_mfma_f32_32x32x16_bf16 v[16:31], a[80:83], v[48:51], v[16:31]
    ds_read_b128 v[60:63], v9 offset:23552
    v_mfma_f32_32x32x16_bf16 v[32:47], v[48:51], a[224:227], v[32:47]
    s_waitcnt lgkmcnt(2)
    v_mfma_f32_32x32x16_bf16 v[16:31], a[84:87], v[52:55], v[16:31]
    ds_read_b128 v[48:51], v9 offset:24576
    v_mfma_f32_32x32x16_bf16 v[32:47], v[52:55], a[228:231], v[32:47]
    s_waitcnt lgkmcnt(2)
    v_mfma_f32_32x32x16_bf16 v[16:31], a[88:91], v[56:59], v[16:31]
    ds_read_b128 v[52:55], v9 offset:25600
    v_mfma_f32_32x32x16_bf16 v[32:47], v[56:59], a[232:235], v[32:47]
    s_waitcnt lgkmcnt(2)
    v_mfma_f32_32x32x16_bf16 v[16:31], a[92:95], v[60:63], v[16:31]
    ds_read_b128 v[56:59], v9 offset:26624
    v_mfma_f32_32x32x16_bf16 v[32:47], v[60:63], a[236:239], v[32:47]
    s_waitcnt lgkmcnt(2)
    v_mfma_f32_32x32x16_bf16 v[16:31], a[96:99], v[48:51], v[16:31]
    ds_read_b128 v[60:63], v9 offset:27648
    v_mfma_f32_32x32x16_bf16 v[32:47], v[48:51], a[240:243], v[32:47]
    s_waitcnt lgkmcnt(2)
    v_mfma_f32_32x32x16_bf16 v[16:31], a[100:103], v[52:55], v[16:31]
    ds_read_b128 v[48:51], v9 offset:28672
    v_mfma_f32_32x32x16_bf16 v[32:47], v[52:55], a[244:247], v[32:47]
    s_waitcnt lgkmcnt(2)
    v_mfma_f32_32x32x16_bf16 v[16:31], a[104:107], v[56:59], v[16:31]
    ds_read_b128 v[52:55], v9 offset:29696
    v_mfma_f32_32x32x16_bf16 v[32:47], v[56:59], a[248:251], v[32:47]
    s_waitcnt lgkmcnt(2)
    v_mfma_f32_32x32x16_bf16 v[16:31], a[108:111], v[60:63], v[16:31]
    ds_read_b128 v[56:59], v9 offset:30720
    v_mfma_f32_32x32x16_bf16 v[32:47], v[60:63], a[252:255], v[32:47]
    s_waitcnt lgkmcnt(2)
    v_mfma_f32_32x32x16_bf16 v[16:31], a[112:115], v[48:51], v[16:31]
    ds_read_b128 v[60:63], v9 offset:31744
    v_mfma_f32_32x32x16_bf16 v[32:47], v[48:51], v[152:155], v[32:47]
    s_waitcnt lgkmcnt(2)
    v_mfma_f32_32x32x16_bf16 v[16:31], a[116:119], v[52:55], v[16:31]
    ds_read_b128 v[48:51], v9 offset:32768
    v_mfma_f32_32x32x16_bf16 v[32:47], v[52:55], v[156:159], v[32:47]
    s_waitcnt lgkmcnt(2)
    v_mfma_f32_32x32x16_bf16 v[16:31], a[120:123], v[56:59], v[16:31]
    ds_read_b128 v[52:55], v9 offset:33792
    v_mfma_f32_32x32x16_bf16 v[32:47], v[56:59], v[160:163], v[32:47]
    s_waitcnt lgkmcnt(2)
    v_mfma_f32_32x32x16_bf16 v[16:31], a[124:127], v[60:63], v[16:31]
    v_cmp_eq_u32 s[76:77], 1, v2
    v_cmp_eq_u32 vcc, 2, v2
    s_cmp_eq_u64 s[76:77], -1
    s_cselect_b32 s38, 1, 0
    ds_read_b128 v[56:59], v9 offset:34816
    v_mfma_f32_32x32x16_bf16 v[32:47], v[60:63], v[164:167], v[32:47]
    s_cmp_lg_u32 s38, 0
    s_cselect_b64 exec, 1, 0
    v_mov_b32 v15, s32
    ds_write_b32 v184, v15
    v_mov_b32 v2, 2
    s_mov_b64 exec, -1
    s_waitcnt lgkmcnt(3)
    v_mfma_f32_32x32x16_bf16 v[16:31], a[128:131], v[48:51], v[16:31]
    s_add_u32 s32, s32, s38
    s_mul_i32 s38, s38, 22528
    s_add_u32 s33, s33, s38
    ds_read_b128 v[60:63], v9 offset:35840
    v_mfma_f32_32x32x16_bf16 v[32:47], v[48:51], v[168:171], v[32:47]
    s_cmp_eq_u64 vcc, 0
    s_cselect_b32 s38, s32, 0x7fff
    s_waitcnt lgkmcnt(3)
    v_mfma_f32_32x32x16_bf16 v[16:31], a[132:135], v[52:55], v[16:31]
    s_cmp_le_u32 s38, s39
    s_cselect_b64 exec, -1, 0
    v_mov_b32 v2, 2
    buffer_load_dword v2, v1, s[8:11], s33 offen sc1
    s_mov_b64 exec, -1
    v_mfma_f32_32x32x16_bf16 v[32:47], v[52:55], v[172:175], v[32:47]
    s_waitcnt lgkmcnt(2)
    v_mfma_f32_32x32x16_bf16 v[16:31], a[136:139], v[56:59], v[16:31]
    v_mfma_f32_32x32x16_bf16 v[32:47], v[56:59], v[176:179], v[32:47]
    s_waitcnt lgkmcnt(0)
    v_mfma_f32_32x32x16_bf16 v[16:31], a[140:143], v[60:63], v[16:31]
    v_mfma_f32_32x32x16_bf16 v[32:47], v[60:63], v[180:183], v[32:47]
    s_add_u32 s51, s46, 16777216
    s_nop 2
    v_pk_fma_f32 v[16:17], v[16:17], v[148:149], v[100:101] op_sel_hi:[1,0,1] neg_lo:[0,0,1] neg_hi:[0,0,1]
    v_pk_fma_f32 v[18:19], v[18:19], v[148:149], v[102:103] op_sel_hi:[1,0,1] neg_lo:[0,0,1] neg_hi:[0,0,1]
    v_pk_fma_f32 v[20:21], v[20:21], v[148:149], v[104:105] op_sel_hi:[1,0,1] neg_lo:[0,0,1] neg_hi:[0,0,1]
    v_pk_fma_f32 v[22:23], v[22:23], v[148:149], v[106:107] op_sel_hi:[1,0,1] neg_lo:[0,0,1] neg_hi:[0,0,1]
    v_pk_fma_f32 v[24:25], v[24:25], v[148:149], v[108:109] op_sel_hi:[1,0,1] neg_lo:[0,0,1] neg_hi:[0,0,1]
    v_pk_fma_f32 v[26:27], v[26:27], v[148:149], v[110:111] op_sel_hi:[1,0,1] neg_lo:[0,0,1] neg_hi:[0,0,1]
    v_pk_fma_f32 v[28:29], v[28:29], v[148:149], v[112:113] op_sel_hi:[1,0,1] neg_lo:[0,0,1] neg_hi:[0,0,1]
    v_pk_fma_f32 v[30:31], v[30:31], v[148:149], v[114:115] op_sel_hi:[1,0,1] neg_lo:[0,0,1] neg_hi:[0,0,1]
    v_cvt_pk_bf16_f32 v188, v16, v24
    v_cvt_pk_bf16_f32 v189, v17, v25
    v_cvt_pk_bf16_f32 v190, v18, v26
    v_cvt_pk_bf16_f32 v191, v19, v27
    buffer_store_dwordx4 v[188:191], v14, s[8:11], s46 offen offset:0 sc1
    v_cvt_pk_bf16_f32 v192, v20, v28
    v_cvt_pk_bf16_f32 v193, v21, v29
    v_cvt_pk_bf16_f32 v194, v22, v30
    v_cvt_pk_bf16_f32 v195, v23, v31
    buffer_store_dwordx4 v[192:195], v14, s[8:11], s46 offen offset:512 sc1
    v_pk_fma_f32 v[32:33], v[32:33], v[116:117], v[132:133] neg_lo:[0,0,1] neg_hi:[0,0,1]
    v_pk_fma_f32 v[34:35], v[34:35], v[118:119], v[134:135] neg_lo:[0,0,1] neg_hi:[0,0,1]
    v_pk_fma_f32 v[36:37], v[36:37], v[120:121], v[136:137] neg_lo:[0,0,1] neg_hi:[0,0,1]
    v_pk_fma_f32 v[38:39], v[38:39], v[122:123], v[138:139] neg_lo:[0,0,1] neg_hi:[0,0,1]
    v_pk_fma_f32 v[40:41], v[40:41], v[124:125], v[140:141] neg_lo:[0,0,1] neg_hi:[0,0,1]
    v_pk_fma_f32 v[42:43], v[42:43], v[126:127], v[142:143] neg_lo:[0,0,1] neg_hi:[0,0,1]
    v_pk_fma_f32 v[44:45], v[44:45], v[128:129], v[144:145] neg_lo:[0,0,1] neg_hi:[0,0,1]
    v_pk_fma_f32 v[46:47], v[46:47], v[130:131], v[146:147] neg_lo:[0,0,1] neg_hi:[0,0,1]
    v_cvt_pk_bf16_f32 v196, v32, v33
    v_cvt_pk_bf16_f32 v197, v34, v35
    v_cvt_pk_bf16_f32 v198, v40, v41
    v_cvt_pk_bf16_f32 v199, v42, v43
    buffer_store_dwordx4 v[196:199], v14, s[8:11], s51 offen offset:0 sc1
    v_cvt_pk_bf16_f32 v200, v36, v37
    v_cvt_pk_bf16_f32 v201, v38, v39
    v_cvt_pk_bf16_f32 v202, v44, v45
    v_cvt_pk_bf16_f32 v203, v46, v47
    buffer_store_dwordx4 v[200:203], v14, s[8:11], s51 offen offset:512 sc1
    s_mul_i32 s43, s57, 22528
    s_add_u32 s43, s43, s49
    s_branch LpKV_head
LpKV_f_4:
    v_mfma_f32_32x32x16_bf16 v[16:31], a[76:79], v[60:63], v[16:31]
    s_add_u32 m0, s59, 0
    s_add_u32 s47, s41, 0
    buffer_load_dwordx4 v0, s[8:11], s47 offen offset:0 lds
    ds_read_b128 v[56:59], v9 offset:22528
    v_mfma_f32_32x32x16_bf16 v[32:47], v[60:63], a[220:223], v[32:47]
    s_waitcnt lgkmcnt(2)
    v_mfma_f32_32x32x16_bf16 v[16:31], a[80:83], v[48:51], v[16:31]
    buffer_load_dwordx4 v0, s[8:11], s47 offen offset:1024 lds
    ds_read_b128 v[60:63], v9 offset:23552
    v_mfma_f32_32x32x16_bf16 v[32:47], v[48:51], a[224:227], v[32:47]
    s_waitcnt lgkmcnt(2)
    v_mfma_f32_32x32x16_bf16 v[16:31], a[84:87], v[52:55], v[16:31]
    buffer_load_dwordx4 v0, s[8:11], s47 offen offset:2048 lds
    ds_read_b128 v[48:51], v9 offset:24576
    v_mfma_f32_32x32x16_bf16 v[32:47], v[52:55], a[228:231], v[32:47]
    s_waitcnt lgkmcnt(2)
    v_mfma_f32_32x32x16_bf16 v[16:31], a[88:91], v[56:59], v[16:31]
    buffer_load_dwordx4 v0, s[8:11], s47 offen offset:3072 lds
    ds_read_b128 v[52:55], v9 offset:25600
    v_mfma_f32_32x32x16_bf16 v[32:47], v[56:59], a[232:235], v[32:47]
    s_waitcnt lgkmcnt(2)
    v_mfma_f32_32x32x16_bf16 v[16:31], a[92:95], v[60:63], v[16:31]
    s_add_u32 m0, s59, 4096
    s_add_u32 s47, s41, 4096
    buffer_load_dwordx4 v0, s[8:11], s47 offen offset:0 lds
    ds_read_b128 v[56:59], v9 offset:26624
    v_mfma_f32_32x32x16_bf16 v[32:47], v[60:63], a[236:239], v[32:47]
    s_waitcnt lgkmcnt(2)
    v_mfma_f32_32x32x16_bf16 v[16:31], a[96:99], v[48:51], v[16:31]
    buffer_load_dwordx4 v0, s[8:11], s47 offen offset:1024 lds
    ds_read_b128 v[60:63], v9 offset:27648
    v_mfma_f32_32x32x16_bf16 v[32:47], v[48:51], a[240:243], v[32:47]
    s_waitcnt lgkmcnt(2)
    v_mfma_f32_32x32x16_bf16 v[16:31], a[100:103], v[52:55], v[16:31]
    buffer_load_dwordx4 v0, s[8:11], s47 offen offset:2048 lds
    ds_read_b128 v[48:51], v9 offset:28672
    v_mfma_f32_32x32x16_bf16 v[32:47], v[52:55], a[244:247], v[32:47]
    s_waitcnt lgkmcnt(2)
    v_mfma_f32_32x32x16_bf16 v[16:31], a[104:107], v[56:59], v[16:31]
    buffer_load_dwordx4 v0, s[8:11], s47 offen offset:3072 lds
    ds_read_b128 v[52:55], v9 offset:29696
    v_mfma_f32_32x32x16_bf16 v[32:47], v[56:59], a[248:251], v[32:47]
    s_waitcnt lgkmcnt(2)
    v_mfma_f32_32x32x16_bf16 v[16:31], a[108:111], v[60:63], v[16:31]
    s_add_u32 m0, s59, 8192
    s_add_u32 s47, s41, 8192
    buffer_load_dwordx4 v0, s[8:11], s47 offen offset:0 lds
    ds_read_b128 v[56:59], v9 offset:30720
    v_mfma_f32_32x32x16_bf16 v[32:47], v[60:63], a[252:255], v[32:47]
    s_waitcnt lgkmcnt(2)
    v_mfma_f32_32x32x16_bf16 v[16:31], a[112:115], v[48:51], v[16:31]
    s_mul_i32 s48, s36, 786432
    s_mul_i32 s18, s37, 6144
    s_add_u32 s48, s48, s18
    s_add_u32 s48, s48, 16125952
    s_add_u32 m0, s66, 4096
    s_nop 0
    buffer_load_dwordx4 v0, s[8:11], s48 offen lds
    ds_read_b128 v[60:63], v9 offset:31744
    v_mfma_f32_32x32x16_bf16 v[32:47], v[48:51], v[152:155], v[32:47]
    s_waitcnt lgkmcnt(2)
    v_mfma_f32_32x32x16_bf16 v[16:31], a[116:119], v[52:55], v[16:31]
    s_add_u32 m0, s66, s67
    s_sub_u32 s48, s48, 4096
    s_add_u32 s48, s48, s67
    buffer_load_dwordx4 v0, s[8:11], s48 offen lds
    ds_read_b128 v[48:51], v9 offset:32768
    v_mfma_f32_32x32x16_bf16 v[32:47], v[52:55], v[156:159], v[32:47]
    s_waitcnt lgkmcnt(2)
    v_mfma_f32_32x32x16_bf16 v[16:31], a[120:123], v[56:59], v[16:31]
    ds_read_b128 v[52:55], v9 offset:33792
    v_mfma_f32_32x32x16_bf16 v[32:47], v[56:59], v[160:163], v[32:47]
    s_waitcnt lgkmcnt(2)
    v_mfma_f32_32x32x16_bf16 v[16:31], a[124:127], v[60:63], v[16:31]
    v_cmp_eq_u32 s[76:77], 1, v2
    v_cmp_eq_u32 vcc, 2, v2
    s_cmp_eq_u64 s[76:77], -1
    s_cselect_b32 s38, 1, 0
    ds_read_b128 v[56:59], v9 offset:34816
    v_mfma_f32_32x32x16_bf16 v[32:47], v[60:63], v[164:167], v[32:47]
    s_cmp_lg_u32 s38, 0
    s_cselect_b64 exec, 1, 0
    v_mov_b32 v15, s32
    ds_write_b32 v184, v15
    v_mov_b32 v2, 2
    s_mov_b64 exec, -1
    s_waitcnt lgkmcnt(3)
    v_mfma_f32_32x32x16_bf16 v[16:31], a[128:131], v[48:51], v[16:31]
    s_add_u32 s32, s32, s38
    s_mul_i32 s38, s38, 22528
    s_add_u32 s33, s33, s38
    ds_read_b128 v[60:63], v9 offset:35840
    v_mfma_f32_32x32x16_bf16 v[32:47], v[48:51], v[168:171], v[32:47]
    s_cmp_eq_u64 vcc, 0
    s_cselect_b32 s38, s32, 0x7fff
    s_waitcnt lgkmcnt(3)
    v_mfma_f32_32x32x16_bf16 v[16:31], a[132:135], v[52:55], v[16:31]
    s_cmp_le_u32 s38, s39
    s_cselect_b64 exec, -1, 0
    v_mov_b32 v2, 2
    buffer_load_dword v2, v1, s[8:11], s33 offen sc1
    s_mov_b64 exec, -1
    v_mfma_f32_32x32x16_bf16 v[32:47], v[52:55], v[172:175], v[32:47]
    s_waitcnt lgkmcnt(2)
    v_mfma_f32_32x32x16_bf16 v[16:31], a[136:139], v[56:59], v[16:31]
    v_mfma_f32_32x32x16_bf16 v[32:47], v[56:59], v[176:179], v[32:47]
    s_waitcnt lgkmcnt(0)
    v_mfma_f32_32x32x16_bf16 v[16:31], a[140:143], v[60:63], v[16:31]
    v_mfma_f32_32x32x16_bf16 v[32:47], v[60:63], v[180:183], v[32:47]
    s_add_u32 s51, s46, 16777216
    s_nop 2
    v_pk_fma_f32 v[16:17], v[16:17], v[148:149], v[100:101] op_sel_hi:[1,0,1] neg_lo:[0,0,1] neg_hi:[0,0,1]
    v_pk_fma_f32 v[18:19], v[18:19], v[148:149], v[102:103] op_sel_hi:[1,0,1] neg_lo:[0,0,1] neg_hi:[0,0,1]
    v_pk_fma_f32 v[20:21], v[20:21], v[148:149], v[104:105] op_sel_hi:[1,0,1] neg_lo:[0,0,1] neg_hi:[0,0,1]
    v_pk_fma_f32 v[22:23], v[22:23], v[148:149], v[106:107] op_sel_hi:[1,0,1] neg_lo:[0,0,1] neg_hi:[0,0,1]
    v_pk_fma_f32 v[24:25], v[24:25], v[148:149], v[108:109] op_sel_hi:[1,0,1] neg_lo:[0,0,1] neg_hi:[0,0,1]
    v_pk_fma_f32 v[26:27], v[26:27], v[148:149], v[110:111] op_sel_hi:[1,0,1] neg_lo:[0,0,1] neg_hi:[0,0,1]
    v_pk_fma_f32 v[28:29], v[28:29], v[148:149], v[112:113] op_sel_hi:[1,0,1] neg_lo:[0,0,1] neg_hi:[0,0,1]
    v_pk_fma_f32 v[30:31], v[30:31], v[148:149], v[114:115] op_sel_hi:[1,0,1] neg_lo:[0,0,1] neg_hi:[0,0,1]
    v_cvt_pk_bf16_f32 v188, v16, v24
    v_cvt_pk_bf16_f32 v189, v17, v25
    v_cvt_pk_bf16_f32 v190, v18, v26
    v_cvt_pk_bf16_f32 v191, v19, v27
    buffer_store_dwordx4 v[188:191], v14, s[8:11], s46 offen offset:0 sc1
    v_cvt_pk_bf16_f32 v192, v20, v28
    v_cvt_pk_bf16_f32 v193, v21, v29
    v_cvt_pk_bf16_f32 v194, v22, v30
    v_cvt_pk_bf16_f32 v195, v23, v31
    buffer_store_dwordx4 v[192:195], v14, s[8:11], s46 offen offset:512 sc1
    v_pk_fma_f32 v[32:33], v[32:33], v[116:117], v[132:133] neg_lo:[0,0,1] neg_hi:[0,0,1]
    v_pk_fma_f32 v[34:35], v[34:35], v[118:119], v[134:135] neg_lo:[0,0,1] neg_hi:[0,0,1]
    v_pk_fma_f32 v[36:37], v[36:37], v[120:121], v[136:137] neg_lo:[0,0,1] neg_hi:[0,0,1]
    v_pk_fma_f32 v[38:39], v[38:39], v[122:123], v[138:139] neg_lo:[0,0,1] neg_hi:[0,0,1]
    v_pk_fma_f32 v[40:41], v[40:41], v[124:125], v[140:141] neg_lo:[0,0,1] neg_hi:[0,0,1]
    v_pk_fma_f32 v[42:43], v[42:43], v[126:127], v[142:143] neg_lo:[0,0,1] neg_hi:[0,0,1]
    v_pk_fma_f32 v[44:45], v[44:45], v[128:129], v[144:145] neg_lo:[0,0,1] neg_hi:[0,0,1]
    v_pk_fma_f32 v[46:47], v[46:47], v[130:131], v[146:147] neg_lo:[0,0,1] neg_hi:[0,0,1]
    v_cvt_pk_bf16_f32 v196, v32, v33
    v_cvt_pk_bf16_f32 v197, v34, v35
    v_cvt_pk_bf16_f32 v198, v40, v41
    v_cvt_pk_bf16_f32 v199, v42, v43
    buffer_store_dwordx4 v[196:199], v14, s[8:11], s51 offen offset:0 sc1
    v_cvt_pk_bf16_f32 v200, v36, v37
    v_cvt_pk_bf16_f32 v201, v38, v39
    v_cvt_pk_bf16_f32 v202, v44, v45
    v_cvt_pk_bf16_f32 v203, v46, v47
    buffer_store_dwordx4 v[200:203], v14, s[8:11], s51 offen offset:512 sc1
    s_mul_i32 s43, s57, 22528
    s_add_u32 s43, s43, s49
    s_branch LpKV_head
LpKV_none:
    ds_read_b32 v15, v184
    s_waitcnt lgkmcnt(0)
    v_readfirstlane_b32 s17, v15
    s_nop 0
    s_cmp_lt_i32 s17, s37
    s_cbranch_scc1 LpKV_nopost
    s_add_u32 m0, s59, 0
    s_add_u32 s47, s41, 0
    buffer_load_dwordx4 v0, s[8:11], s47 offen offset:0 lds
    buffer_load_dwordx4 v0, s[8:11], s47 offen offset:1024 lds
    buffer_load_dwordx4 v0, s[8:11], s47 offen offset:2048 lds
    buffer_load_dwordx4 v0, s[8:11], s47 offen offset:3072 lds
    s_add_u32 m0, s59, 4096
    s_add_u32 s47, s41, 4096
    buffer_load_dwordx4 v0, s[8:11], s47 offen offset:0 lds
    buffer_load_dwordx4 v0, s[8:11], s47 offen offset:1024 lds
    buffer_load_dwordx4 v0, s[8:11], s47 offen offset:2048 lds
    buffer_load_dwordx4 v0, s[8:11], s47 offen offset:3072 lds
    s_add_u32 m0, s59, 8192
    s_add_u32 s47, s41, 8192
    buffer_load_dwordx4 v0, s[8:11], s47 offen offset:0 lds
    s_mul_i32 s48, s36, 786432
    s_mul_i32 s18, s37, 6144
    s_add_u32 s48, s48, s18
    s_add_u32 s48, s48, 16125952
    s_add_u32 m0, s66, 4096
    s_nop 0
    buffer_load_dwordx4 v0, s[8:11], s48 offen lds
    s_add_u32 m0, s66, s67
    s_sub_u32 s48, s48, 4096
    s_add_u32 s48, s48, s67
    buffer_load_dwordx4 v0, s[8:11], s48 offen lds
    s_waitcnt vmcnt(11)
    s_cmp_lg_u32 s43, 0
    s_cselect_b64 exec, 3, 0
    buffer_store_dword v3, v185, s[8:11], s43 offen sc1
    s_mov_b64 exec, -1
    s_mov_b32 s43, 0
    s_waitcnt vmcnt(1) lgkmcnt(0)
    s_branch LpKV_head2
LpKV_nopost:
    s_waitcnt vmcnt(0)
    s_cmp_lg_u32 s43, 0
    s_cselect_b64 exec, 3, 0
    buffer_store_dword v3, v185, s[8:11], s43 offen sc1
    s_mov_b64 exec, -1
    s_mov_b32 s43, 0
    s_cmp_ge_u32 s37, 64
    s_cbranch_scc1 LpKV_end
LpKV_wait:
    s_mov_b32 s16, 0
    s_cmp_lg_u32 s14, 0
    s_cbranch_scc1 LpKV_wl
LpKV_wp:
    buffer_load_dword v2, v1, s[8:11], s60 offen sc1
    s_add_u32 s16, s16, 1
    s_cmp_gt_u32 s16, 100000
    s_cbranch_scc1 LpKV_giveup
    s_waitcnt vmcnt(0)
    v_cmp_eq_u32 vcc, 0, v2
    s_nop 0
    s_cbranch_vccz LpKV_wok
    s_sleep 4
    s_branch LpKV_wp
LpKV_giveup:
    v_mov_b32 v5, -2
    ds_write_b32 v184, v5
    s_waitcnt lgkmcnt(0)
    s_branch L_role_p_abort
LpKV_wok:
    v_mov_b32 v5, s37
    ds_write_b32 v184, v5
    s_branch LpKV_go
LpKV_wl:
    ds_read_b32 v15, v184
    s_add_u32 s16, s16, 1
    s_cmp_gt_u32 s16, 1600000
    s_cbranch_scc1 L_role_p_abort
    s_waitcnt lgkmcnt(0)
    v_readfirstlane_b32 s17, v15
    s_nop 0
    s_cmp_eq_u32 s17, -2
    s_cbranch_scc1 L_role_p_abort
    s_cmp_ge_i32 s17, s37
    s_cbranch_scc1 LpKV_go
    s_sleep 1
    s_branch LpKV_wl
LpKV_go:
    s_add_u32 m0, s59, 0
    s_add_u32 s47, s41, 0
    buffer_load_dwordx4 v0, s[8:11], s47 offen offset:0 lds
    buffer_load_dwordx4 v0, s[8:11], s47 offen offset:1024 lds
    buffer_load_dwordx4 v0, s[8:11], s47 offen offset:2048 lds
    buffer_load_dwordx4 v0, s[8:11], s47 offen offset:3072 lds
    s_add_u32 m0, s59, 4096
    s_add_u32 s47, s41, 4096
    buffer_load_dwordx4 v0, s[8:11], s47 offen offset:0 lds
    buffer_load_dwordx4 v0, s[8:11], s47 offen offset:1024 lds
    buffer_load_dwordx4 v0, s[8:11], s47 offen offset:2048 lds
    buffer_load_dwordx4 v0, s[8:11], s47 offen offset:3072 lds
    s_add_u32 m0, s59, 8192
    s_add_u32 s47, s41, 8192
    buffer_load_dwordx4 v0, s[8:11], s47 offen offset:0 lds
    s_mul_i32 s48, s36, 786432
    s_mul_i32 s18, s37, 6144
    s_add_u32 s48, s48, s18
    s_add_u32 s48, s48, 16125952
    s_add_u32 m0, s66, 4096
    s_nop 0
    buffer_load_dwordx4 v0, s[8:11], s48 offen lds
    s_add_u32 m0, s66, s67
    s_sub_u32 s48, s48, 4096
    s_add_u32 s48, s48, s67
    buffer_load_dwordx4 v0, s[8:11], s48 offen lds
    s_waitcnt vmcnt(0) lgkmcnt(0)
    s_branch LpKV_head2
LpKV_end:
    s_branch L_role_p_exit
L_role_p_abort:
    s_waitcnt lgkmcnt(0)
    s_mov_b64 exec, -1
    v_mov_b32 v0, 60
    s_lshl_b32 s5, s3, 8
    s_or_b32 s5, s5, s4
    s_or_b32 s5, s5, 0x10000
    v_mov_b32 v1, s5
    global_store_dword v0, v1, s[12:13]
    s_endpgm
L_role_p_exit:
    s_endpgm
.p2align 6
L_role_awo:
    v_and_b32 v5, 63, v0
    v_lshlrev_b32 v0, 4, v5
    v_and_b32 v7, 15, v5
    v_lshrrev_b32 v8, 4, v5
    v_min_u32 v1, 63, v5
    v_lshrrev_b32 v6, 2, v1
    v_and_b32 v1, 3, v1
    v_lshlrev_b32 v1, 2, v1
    v_lshl_add_u32 v1, v6, 7, v1
    v_mov_b32 v3, 1
    v_mov_b32 v4, 0
    s_mov_b32 s44, 0x05040100
    s_mov_b32 s45, 0x07060302
    s_load_dwordx2 s[20:21], s[0:1], 16
    s_mov_b32 s22, 663552
    s_mov_b32 s23, 0x00020000
    s_waitcnt lgkmcnt(0)
    s_and_b32 s21, s21, 0xffff
    s_cmp_ge_u32 s15, 3
    s_cselect_b32 s63, 1, 0
    s_cselect_b32 s17, 3, 0
    s_sub_u32 s15, s15, s17
    s_lshl_b32 s50, s15, 2
    s_add_u32 s50, s50, s14
    s_cmp_eq_u32 s63, 0
    s_cbranch_scc1 Lao_gate_ng
    s_cmp_lg_u32 s14, 0
    s_cbranch_scc1 Lao_gate_d
    v_mov_b32 v5, 48
    s_mov_b32 s16, 0
Lao_gate:
    global_load_dword v6, v5, s[12:13] sc1
    s_add_u32 s16, s16, 1
    s_cmp_gt_u32 s16, 100000
    s_cbranch_scc1 L_role_awo_abort
    s_waitcnt vmcnt(0)
    v_cmp_gt_u32 vcc, 32, v6
    s_nop 0
    s_cbranch_vccz Lao_gate_d
    s_sleep 100
    s_branch Lao_gate
Lao_gate_d:
    s_barrier
Lao_gate_ng:
    v_lshrrev_b32 v5, 7, v0
    v_and_b32 v6, 0x70, v0
    v_mul_u32_u24 v16, 1152, v5
    v_add_u32 v16, v16, v6
    v_lshrrev_b32 v17, 1, v5
    v_mul_u32_u24 v17, 18, v17
    v_and_b32 v5, 1, v5
    v_add_u32 v17, v17, v5
    v_add_u32 v17, 16, v17
    v_mul_u32_u24 v17, 1152, v17
    v_add_u32 v17, v17, v6
    v_lshrrev_b32 v5, 2, v7
    v_lshl_add_u32 v5, v8, 3, v5
    v_lshlrev_b32 v18, 7, v5
    v_and_b32 v5, 3, v7
    v_lshl_add_u32 v19, v5, 3, v18
    v_lshl_add_u32 v18, v5, 4, v18
    s_lshl_b32 s46, s14, 15
    v_add_u32 v18, s46, v18
    v_add_u32 v19, s46, v19
    s_mul_i32 s49, s50, 96
    s_add_u32 m0, s46, 0
    s_add_u32 s17, s49, 0
    buffer_load_dwordx4 v16, s[20:23], s17 offen lds
    s_add_u32 m0, s46, 1024
    s_add_u32 s17, s49, 9216
    buffer_load_dwordx4 v16, s[20:23], s17 offen lds
    s_add_u32 m0, s46, 2048
    s_add_u32 s17, s49, 20736
    buffer_load_dwordx4 v16, s[20:23], s17 offen lds
    s_add_u32 m0, s46, 3072
    s_add_u32 s17, s49, 29952
    buffer_load_dwordx4 v16, s[20:23], s17 offen lds
    s_add_u32 m0, s46, 4096
    s_add_u32 s17, s49, 41472
    buffer_load_dwordx4 v16, s[20:23], s17 offen lds
    s_add_u32 m0, s46, 5120
    s_add_u32 s17, s49, 50688
    buffer_load_dwordx4 v16, s[20:23], s17 offen lds
    s_add_u32 m0, s46, 6144
    s_add_u32 s17, s49, 62208
    buffer_load_dwordx4 v16, s[20:23], s17 offen lds
    s_add_u32 m0, s46, 7168
    s_add_u32 s17, s49, 71424
    buffer_load_dwordx4 v16, s[20:23], s17 offen lds
    s_add_u32 m0, s46, 8192
    s_add_u32 s17, s49, 82944
    buffer_load_dwordx4 v16, s[20:23], s17 offen lds
    s_add_u32 m0, s46, 9216
    s_add_u32 s17, s49, 92160
    buffer_load_dwordx4 v16, s[20:23], s17 offen lds
    s_add_u32 m0, s46, 10240
    s_add_u32 s17, s49, 103680
    buffer_load_dwordx4 v16, s[20:23], s17 offen lds
    s_add_u32 m0, s46, 11264
    s_add_u32 s17, s49, 112896
    buffer_load_dwordx4 v16, s[20:23], s17 offen lds
    s_add_u32 m0, s46, 12288
    s_add_u32 s17, s49, 124416
    buffer_load_dwordx4 v16, s[20:23], s17 offen lds
    s_add_u32 m0, s46, 13312
    s_add_u32 s17, s49, 133632
    buffer_load_dwordx4 v16, s[20:23], s17 offen lds
    s_add_u32 m0, s46, 14336
    s_add_u32 s17, s49, 145152
    buffer_load_dwordx4 v16, s[20:23], s17 offen lds
    s_add_u32 m0, s46, 15360
    s_add_u32 s17, s49, 154368
    buffer_load_dwordx4 v16, s[20:23], s17 offen lds
    s_add_u32 m0, s46, 16384
    s_add_u32 s17, s49, 165888
    buffer_load_dwordx4 v16, s[20:23], s17 offen lds
    s_add_u32 m0, s46, 17408
    s_add_u32 s17, s49, 175104
    buffer_load_dwordx4 v16, s[20:23], s17 offen lds
    s_add_u32 m0, s46, 18432
    s_add_u32 s17, s49, 186624
    buffer_load_dwordx4 v16, s[20:23], s17 offen lds
    s_add_u32 m0, s46, 19456
    s_add_u32 s17, s49, 195840
    buffer_load_dwordx4 v16, s[20:23], s17 offen lds
    s_add_u32 m0, s46, 20480
    s_add_u32 s17, s49, 207360
    buffer_load_dwordx4 v16, s[20:23], s17 offen lds
    s_add_u32 m0, s46, 21504
    s_add_u32 s17, s49, 216576
    buffer_load_dwordx4 v16, s[20:23], s17 offen lds
    s_add_u32 m0, s46, 22528
    s_add_u32 s17, s49, 228096
    buffer_load_dwordx4 v16, s[20:23], s17 offen lds
    s_add_u32 m0, s46, 23552
    s_add_u32 s17, s49, 237312
    buffer_load_dwordx4 v16, s[20:23], s17 offen lds
    s_add_u32 m0, s46, 24576
    s_add_u32 s17, s49, 248832
    buffer_load_dwordx4 v16, s[20:23], s17 offen lds
    s_add_u32 m0, s46, 25600
    s_add_u32 s17, s49, 258048
    buffer_load_dwordx4 v16, s[20:23], s17 offen lds
    s_add_u32 m0, s46, 26624
    s_add_u32 s17, s49, 269568
    buffer_load_dwordx4 v16, s[20:23], s17 offen lds
    s_add_u32 m0, s46, 27648
    s_add_u32 s17, s49, 278784
    buffer_load_dwordx4 v16, s[20:23], s17 offen lds
    s_add_u32 m0, s46, 28672
    s_add_u32 s17, s49, 290304
    buffer_load_dwordx4 v16, s[20:23], s17 offen lds
    s_add_u32 m0, s46, 29696
    s_add_u32 s17, s49, 299520
    buffer_load_dwordx4 v16, s[20:23], s17 offen lds
    s_add_u32 m0, s46, 30720
    s_add_u32 s17, s49, 311040
    buffer_load_dwordx4 v16, s[20:23], s17 offen lds
    s_add_u32 m0, s46, 31744
    s_add_u32 s17, s49, 320256
    buffer_load_dwordx4 v16, s[20:23], s17 offen lds
    s_waitcnt vmcnt(28)
    ds_read_b64_tr_b16 a[0:1], v18 offset:0
    ds_read_b64_tr_b16 a[2:3], v18 offset:512
    ds_read_b64_tr_b16 a[4:5], v18 offset:8
    ds_read_b64_tr_b16 a[6:7], v18 offset:520
    ds_read_b64_tr_b16 a[8:9], v19 offset:64
    ds_read_b64_tr_b16 a[10:11], v19 offset:576
    s_waitcnt lgkmcnt(0)
    s_add_u32 m0, s46, 0
    s_add_u32 s17, s49, 331776
    buffer_load_dwordx4 v16, s[20:23], s17 offen lds
    s_add_u32 m0, s46, 1024
    s_add_u32 s17, s49, 340992
    buffer_load_dwordx4 v16, s[20:23], s17 offen lds
    s_add_u32 m0, s46, 2048
    s_add_u32 s17, s49, 352512
    buffer_load_dwordx4 v16, s[20:23], s17 offen lds
    s_add_u32 m0, s46, 3072
    s_add_u32 s17, s49, 361728
    buffer_load_dwordx4 v16, s[20:23], s17 offen lds
    s_waitcnt vmcnt(28)
    ds_read_b64_tr_b16 a[12:13], v18 offset:4096
    ds_read_b64_tr_b16 a[14:15], v18 offset:4608
    ds_read_b64_tr_b16 a[16:17], v18 offset:4104
    ds_read_b64_tr_b16 a[18:19], v18 offset:4616
    ds_read_b64_tr_b16 a[20:21], v19 offset:4160
    ds_read_b64_tr_b16 a[22:23], v19 offset:4672
    s_waitcnt lgkmcnt(0)
    s_add_u32 m0, s46, 4096
    s_add_u32 s17, s49, 373248
    buffer_load_dwordx4 v16, s[20:23], s17 offen lds
    s_add_u32 m0, s46, 5120
    s_add_u32 s17, s49, 382464
    buffer_load_dwordx4 v16, s[20:23], s17 offen lds
    s_add_u32 m0, s46, 6144
    s_add_u32 s17, s49, 393984
    buffer_load_dwordx4 v16, s[20:23], s17 offen lds
    s_add_u32 m0, s46, 7168
    s_add_u32 s17, s49, 403200
    buffer_load_dwordx4 v16, s[20:23], s17 offen lds
    s_waitcnt vmcnt(28)
    ds_read_b64_tr_b16 a[24:25], v18 offset:8192
    ds_read_b64_tr_b16 a[26:27], v18 offset:8704
    ds_read_b64_tr_b16 a[28:29], v18 offset:8200
    ds_read_b64_tr_b16 a[30:31], v18 offset:8712
    ds_read_b64_tr_b16 a[32:33], v19 offset:8256
    ds_read_b64_tr_b16 a[34:35], v19 offset:8768
    s_waitcnt lgkmcnt(0)
    s_add_u32 m0, s46, 8192
    s_add_u32 s17, s49, 414720
    buffer_load_dwordx4 v16, s[20:23], s17 offen lds
    s_add_u32 m0, s46, 9216
    s_add_u32 s17, s49, 423936
    buffer_load_dwordx4 v16, s[20:23], s17 offen lds
    s_add_u32 m0, s46, 10240
    s_add_u32 s17, s49, 435456
    buffer_load_dwordx4 v16, s[20:23], s17 offen lds
    s_add_u32 m0, s46, 11264
    s_add_u32 s17, s49, 444672
    buffer_load_dwordx4 v16, s[20:23], s17 offen lds
    s_waitcnt vmcnt(28)
    ds_read_b64_tr_b16 a[36:37], v18 offset:12288
    ds_read_b64_tr_b16 a[38:39], v18 offset:12800
    ds_read_b64_tr_b16 a[40:41], v18 offset:12296
    ds_read_b64_tr_b16 a[42:43], v18 offset:12808
    ds_read_b64_tr_b16 a[44:45], v19 offset:12352
    ds_read_b64_tr_b16 a[46:47], v19 offset:12864
    s_waitcnt lgkmcnt(0)
    s_add_u32 m0, s46, 12288
    s_add_u32 s17, s49, 456192
    buffer_load_dwordx4 v16, s[20:23], s17 offen lds
    s_add_u32 m0, s46, 13312
    s_add_u32 s17, s49, 465408
    buffer_load_dwordx4 v16, s[20:23], s17 offen lds
    s_add_u32 m0, s46, 14336
    s_add_u32 s17, s49, 476928
    buffer_load_dwordx4 v16, s[20:23], s17 offen lds
    s_add_u32 m0, s46, 15360
    s_add_u32 s17, s49, 486144
    buffer_load_dwordx4 v16, s[20:23], s17 offen lds
    s_waitcnt vmcnt(28)
    ds_read_b64_tr_b16 a[48:49], v18 offset:16384
    ds_read_b64_tr_b16 a[50:51], v18 offset:16896
    ds_read_b64_tr_b16 a[52:53], v18 offset:16392
    ds_read_b64_tr_b16 a[54:55], v18 offset:16904
    ds_read_b64_tr_b16 a[56:57], v19 offset:16448
    ds_read_b64_tr_b16 a[58:59], v19 offset:16960
    s_waitcnt lgkmcnt(0)
    s_add_u32 m0, s46, 16384
    s_add_u32 s17, s49, 497664
    buffer_load_dwordx4 v16, s[20:23], s17 offen lds
    s_add_u32 m0, s46, 17408
    s_add_u32 s17, s49, 506880
    buffer_load_dwordx4 v16, s[20:23], s17 offen lds
    s_add_u32 m0, s46, 18432
    s_add_u32 s17, s49, 518400
    buffer_load_dwordx4 v16, s[20:23], s17 offen lds
    s_add_u32 m0, s46, 19456
    s_add_u32 s17, s49, 527616
    buffer_load_dwordx4 v16, s[20:23], s17 offen lds
    s_waitcnt vmcnt(28)
    ds_read_b64_tr_b16 a[60:61], v18 offset:20480
    ds_read_b64_tr_b16 a[62:63], v18 offset:20992
    ds_read_b64_tr_b16 a[64:65], v18 offset:20488
    ds_read_b64_tr_b16 a[66:67], v18 offset:21000
    ds_read_b64_tr_b16 a[68:69], v19 offset:20544
    ds_read_b64_tr_b16 a[70:71], v19 offset:21056
    s_waitcnt lgkmcnt(0)
    s_add_u32 m0, s46, 20480
    s_add_u32 s17, s49, 539136
    buffer_load_dwordx4 v16, s[20:23], s17 offen lds
    s_add_u32 m0, s46, 21504
    s_add_u32 s17, s49, 548352
    buffer_load_dwordx4 v16, s[20:23], s17 offen lds
    s_add_u32 m0, s46, 22528
    s_add_u32 s17, s49, 559872
    buffer_load_dwordx4 v16, s[20:23], s17 offen lds
    s_add_u32 m0, s46, 23552
    s_add_u32 s17, s49, 569088
    buffer_load_dwordx4 v16, s[20:23], s17 offen lds
    s_waitcnt vmcnt(28)
    ds_read_b64_tr_b16 a[72:73], v18 offset:24576
    ds_read_b64_tr_b16 a[74:75], v18 offset:25088
    ds_read_b64_tr_b16 a[76:77], v18 offset:24584
    ds_read_b64_tr_b16 a[78:79], v18 offset:25096
    ds_read_b64_tr_b16 a[80:81], v19 offset:24640
    ds_read_b64_tr_b16 a[82:83], v19 offset:25152
    s_waitcnt lgkmcnt(0)
    s_add_u32 m0, s46, 24576
    s_add_u32 s17, s49, 580608
    buffer_load_dwordx4 v16, s[20:23], s17 offen lds
    s_add_u32 m0, s46, 25600
    s_add_u32 s17, s49, 589824
    buffer_load_dwordx4 v16, s[20:23], s17 offen lds
    s_add_u32 m0, s46, 26624
    s_add_u32 s17, s49, 601344
    buffer_load_dwordx4 v16, s[20:23], s17 offen lds
    s_add_u32 m0, s46, 27648
    s_add_u32 s17, s49, 610560
    buffer_load_dwordx4 v16, s[20:23], s17 offen lds
    s_waitcnt vmcnt(28)
    ds_read_b64_tr_b16 a[84:85], v18 offset:28672
    ds_read_b64_tr_b16 a[86:87], v18 offset:29184
    ds_read_b64_tr_b16 a[88:89], v18 offset:28680
    ds_read_b64_tr_b16 a[90:91], v18 offset:29192
    ds_read_b64_tr_b16 a[92:93], v19 offset:28736
    ds_read_b64_tr_b16 a[94:95], v19 offset:29248
    s_waitcnt lgkmcnt(0)
    s_add_u32 m0, s46, 28672
    s_add_u32 s17, s49, 622080
    buffer_load_dwordx4 v16, s[20:23], s17 offen lds
    s_add_u32 m0, s46, 29696
    s_add_u32 s17, s49, 631296
    buffer_load_dwordx4 v16, s[20:23], s17 offen lds
    s_add_u32 m0, s46, 30720
    s_add_u32 s17, s49, 642816
    buffer_load_dwordx4 v16, s[20:23], s17 offen lds
    s_add_u32 m0, s46, 31744
    s_add_u32 s17, s49, 652032
    buffer_load_dwordx4 v16, s[20:23], s17 offen lds
    s_waitcnt vmcnt(28)
    ds_read_b64_tr_b16 a[96:97], v18 offset:0
    ds_read_b64_tr_b16 a[98:99], v18 offset:512
    ds_read_b64_tr_b16 a[100:101], v18 offset:8
    ds_read_b64_tr_b16 a[102:103], v18 offset:520
    ds_read_b64_tr_b16 a[104:105], v19 offset:64
    ds_read_b64_tr_b16 a[106:107], v19 offset:576
    s_waitcnt lgkmcnt(0)
    s_add_u32 m0, s46, 0
    s_add_u32 s17, s49, 0
    buffer_load_dwordx4 v17, s[20:23], s17 offen lds
    s_add_u32 m0, s46, 1024
    s_add_u32 s17, s49, 82944
    buffer_load_dwordx4 v17, s[20:23], s17 offen lds
    s_add_u32 m0, s46, 2048
    s_add_u32 s17, s49, 165888
    buffer_load_dwordx4 v17, s[20:23], s17 offen lds
    s_add_u32 m0, s46, 3072
    s_add_u32 s17, s49, 248832
    buffer_load_dwordx4 v17, s[20:23], s17 offen lds
    s_waitcnt vmcnt(28)
    ds_read_b64_tr_b16 a[108:109], v18 offset:4096
    ds_read_b64_tr_b16 a[110:111], v18 offset:4608
    ds_read_b64_tr_b16 a[112:113], v18 offset:4104
    ds_read_b64_tr_b16 a[114:115], v18 offset:4616
    ds_read_b64_tr_b16 a[116:117], v19 offset:4160
    ds_read_b64_tr_b16 a[118:119], v19 offset:4672
    s_waitcnt lgkmcnt(0)
    s_add_u32 m0, s46, 4096
    s_add_u32 s17, s49, 331776
    buffer_load_dwordx4 v17, s[20:23], s17 offen lds
    s_add_u32 m0, s46, 5120
    s_add_u32 s17, s49, 414720
    buffer_load_dwordx4 v17, s[20:23], s17 offen lds
    s_add_u32 m0, s46, 6144
    s_add_u32 s17, s49, 497664
    buffer_load_dwordx4 v17, s[20:23], s17 offen lds
    s_add_u32 m0, s46, 7168
    s_add_u32 s17, s49, 580608
    buffer_load_dwordx4 v17, s[20:23], s17 offen lds
    s_waitcnt vmcnt(28)
    ds_read_b64_tr_b16 a[120:121], v18 offset:8192
    ds_read_b64_tr_b16 a[122:123], v18 offset:8704
    ds_read_b64_tr_b16 a[124:125], v18 offset:8200
    ds_read_b64_tr_b16 a[126:127], v18 offset:8712
    ds_read_b64_tr_b16 a[128:129], v19 offset:8256
    ds_read_b64_tr_b16 a[130:131], v19 offset:8768
    s_waitcnt lgkmcnt(0)
    s_waitcnt vmcnt(24)
    ds_read_b64_tr_b16 a[132:133], v18 offset:12288
    ds_read_b64_tr_b16 a[134:135], v18 offset:12800
    ds_read_b64_tr_b16 a[136:137], v18 offset:12296
    ds_read_b64_tr_b16 a[138:139], v18 offset:12808
    ds_read_b64_tr_b16 a[140:141], v19 offset:12352
    ds_read_b64_tr_b16 a[142:143], v19 offset:12864
    s_waitcnt lgkmcnt(0)
    s_waitcnt vmcnt(20)
    ds_read_b64_tr_b16 a[144:145], v18 offset:16384
    ds_read_b64_tr_b16 a[146:147], v18 offset:16896
    ds_read_b64_tr_b16 a[148:149], v18 offset:16392
    ds_read_b64_tr_b16 a[150:151], v18 offset:16904
    ds_read_b64_tr_b16 a[152:153], v19 offset:16448
    ds_read_b64_tr_b16 a[154:155], v19 offset:16960
    s_waitcnt lgkmcnt(0)
    s_waitcnt vmcnt(16)
    ds_read_b64_tr_b16 a[156:157], v18 offset:20480
    ds_read_b64_tr_b16 a[158:159], v18 offset:20992
    ds_read_b64_tr_b16 a[160:161], v18 offset:20488
    ds_read_b64_tr_b16 a[162:163], v18 offset:21000
    ds_read_b64_tr_b16 a[164:165], v19 offset:20544
    ds_read_b64_tr_b16 a[166:167], v19 offset:21056
    s_waitcnt lgkmcnt(0)
    s_waitcnt vmcnt(12)
    ds_read_b64_tr_b16 a[168:169], v18 offset:24576
    ds_read_b64_tr_b16 a[170:171], v18 offset:25088
    ds_read_b64_tr_b16 a[172:173], v18 offset:24584
    ds_read_b64_tr_b16 a[174:175], v18 offset:25096
    ds_read_b64_tr_b16 a[176:177], v19 offset:24640
    ds_read_b64_tr_b16 a[178:179], v19 offset:25152
    s_waitcnt lgkmcnt(0)
    s_waitcnt vmcnt(8)
    ds_read_b64_tr_b16 a[180:181], v18 offset:28672
    ds_read_b64_tr_b16 a[182:183], v18 offset:29184
    ds_read_b64_tr_b16 a[184:185], v18 offset:28680
    ds_read_b64_tr_b16 a[186:187], v18 offset:29192
    ds_read_b64_tr_b16 a[188:189], v19 offset:28736
    ds_read_b64_tr_b16 a[190:191], v19 offset:29248
    s_waitcnt lgkmcnt(0)
    s_waitcnt vmcnt(4)
    ds_read_b64_tr_b16 a[192:193], v18 offset:0
    ds_read_b64_tr_b16 a[194:195], v18 offset:512
    ds_read_b64_tr_b16 a[196:197], v18 offset:8
    ds_read_b64_tr_b16 a[198:199], v18 offset:520
    ds_read_b64_tr_b16 a[200:201], v19 offset:64
    ds_read_b64_tr_b16 a[202:203], v19 offset:576
    s_waitcnt lgkmcnt(0)
    s_waitcnt vmcnt(0)
    ds_read_b64_tr_b16 a[204:205], v18 offset:4096
    ds_read_b64_tr_b16 a[206:207], v18 offset:4608
    ds_read_b64_tr_b16 a[208:209], v18 offset:4104
    ds_read_b64_tr_b16 a[210:211], v18 offset:4616
    ds_read_b64_tr_b16 a[212:213], v19 offset:4160
    ds_read_b64_tr_b16 a[214:215], v19 offset:4672
    s_waitcnt lgkmcnt(0)
    s_barrier
    v_lshlrev_b32 v5, 4, v7
    v_lshl_add_u32 v10, v8, 9, v5
    s_mul_i32 s17, s50, 3072
    v_add_u32 v10, s17, v10
    v_lshrrev_b32 v6, 1, v8
    v_lshl_add_u32 v12, v6, 9, v5
    v_and_b32 v6, 1, v8
    v_lshl_add_u32 v12, v6, 3, v12
    s_add_u32 s17, s17, 2048
    v_add_u32 v12, s17, v12
    s_lshr_b32 s17, s50, 1
    s_lshl_b32 s17, s17, 9
    s_and_b32 s18, s50, 1
    s_lshl_b32 s18, s18, 3
    s_add_u32 s17, s17, s18
    v_add_u32 v11, s17, v5
    s_lshl_b32 s49, s15, 7
    s_lshl_b32 s17, s14, 2
    s_add_u32 s49, s49, s17
    s_add_u32 s49, s49, 3584
    s_mov_b32 s36, s63
    s_mov_b32 s34, s63
    s_mul_i32 s58, s14, 9216
    s_mul_i32 s64, s63, 2359296
    s_add_u32 s64, s64, s58
    s_add_u32 s64, s64, 17301504
    s_mul_i32 s61, s63, 1441792
    s_add_u32 s61, s61, 1536
    s_mov_b32 s37, 0
    s_mov_b32 s40, 36864
    s_mov_b32 s59, s58
    s_mov_b32 s43, 0
    s_mov_b32 s62, 1
    s_mov_b32 s28, s8
    s_mov_b32 s29, s9
    s_mov_b32 s30, 0
    s_mov_b32 s31, 0x00020000
    v_mov_b32 v184, 74752
    v_mov_b32 v5, -1
    ds_write_b32 v184, v5
    s_waitcnt lgkmcnt(0)
    s_cmp_lg_u32 s14, 0
    s_cbranch_scc1 Lawo_inia_d
    v_mov_b32 v5, 40
    s_mov_b32 s16, 0
Lawo_inia:
    global_load_dword v6, v5, s[12:13] sc1
    s_add_u32 s16, s16, 1
    s_cmp_gt_u32 s16, 100000
    s_cbranch_scc1 L_role_awo_abort
    s_waitcnt vmcnt(0)
    v_cmp_gt_u32 vcc, 128, v6
    s_nop 0
    s_cbranch_vccz Lawo_inia_d
    s_sleep 8
    s_branch Lawo_inia
Lawo_inia_d:
    s_barrier
    s_cmp_eq_u32 s63, 0
    s_cbranch_scc1 Lawo_ini_sk
    s_cmp_lg_u32 s14, 0
    s_cbranch_scc1 Lawo_inib_d
    v_mov_b32 v5, 160
    s_mov_b32 s16, 0
Lawo_inib:
    global_load_dword v6, v5, s[12:13] sc1
    s_add_u32 s16, s16, 1
    s_cmp_gt_u32 s16, 100000
    s_cbranch_scc1 L_role_awo_abort
    s_waitcnt vmcnt(0)
    v_cmp_gt_u32 vcc, 64, v6
    s_nop 0
    s_cbranch_vccz Lawo_inib_d
    s_sleep 8
    s_branch Lawo_inib
Lawo_inib_d:
    s_barrier
Lawo_ini_sk:
    s_mul_i32 s41, s37, 36864
    s_add_u32 s41, s41, s64
    s_mul_i32 s60, s37, 22528
    s_add_u32 s60, s60, s61
    s_cmp_lt_u32 s37, 64
    s_cselect_b32 s60, s60, 2883584
    s_branch Lawo_wait
Lawo_head:
    s_waitcnt vmcnt(6)
Lawo_head2:
    s_barrier
    ds_read_b32 v15, v184
    s_xor_b32 s40, s40, 36864
    s_xor_b32 s59, s59, 36864
    s_mov_b32 s35, s37
    s_lshl_b32 s57, s34, 6
    s_add_u32 s57, s57, s35
    s_add_u32 s37, s37, 1
    s_mov_b32 s39, 0
    s_mov_b32 s54, 0
    s_mul_i32 s41, s37, 36864
    s_add_u32 s41, s41, s64
    s_mul_i32 s60, s37, 22528
    s_add_u32 s60, s60, s61
    s_cmp_lt_u32 s37, 64
    s_cselect_b32 s60, s60, 2883584
    v_lshlrev_b32 v9, 9, v8
    v_lshl_add_u32 v9, v7, 4, v9
    v_add_u32 v9, s40, v9
    ds_read_b128 v[40:43], v9 offset:0
    ds_read_b128 v[44:47], v9 offset:256
    ds_read_b128 v[48:51], v9 offset:2048
    ds_read_b128 v[52:55], v9 offset:2304
    ds_read_b128 v[56:59], v9 offset:4096
    v_lshlrev_b32 v16, 16, v64
    v_and_b32 v17, 0xffff0000, v64
    v_lshlrev_b32 v18, 16, v65
    v_and_b32 v19, 0xffff0000, v65
    v_lshlrev_b32 v20, 16, v66
    v_and_b32 v21, 0xffff0000, v66
    v_lshlrev_b32 v22, 16, v67
    v_and_b32 v23, 0xffff0000, v67
    v_lshlrev_b32 v24, 16, v68
    v_and_b32 v25, 0xffff0000, v68
    v_lshlrev_b32 v26, 16, v69
    v_and_b32 v27, 0xffff0000, v69
    v_lshlrev_b32 v28, 16, v72
    v_and_b32 v29, 0xffff0000, v72
    v_lshlrev_b32 v30, 16, v73
    v_and_b32 v31, 0xffff0000, v73
    v_lshlrev_b32 v32, 16, v74
    v_and_b32 v33, 0xffff0000, v74
    v_lshlrev_b32 v34, 16, v75
    v_and_b32 v35, 0xffff0000, v75
    v_lshlrev_b32 v36, 16, v76
    v_and_b32 v37, 0xffff0000, v76
    v_lshlrev_b32 v38, 16, v77
    v_and_b32 v39, 0xffff0000, v77
    s_waitcnt lgkmcnt(4)
    v_mfma_f32_16x16x32_bf16 v[16:19], a[0:3], v[40:43], v[16:19]
    ds_read_b128 v[60:63], v9 offset:4352
    v_mfma_f32_16x16x32_bf16 v[20:23], a[4:7], v[40:43], v[20:23]
    s_mul_i32 s46, s34, 4718592
    v_mfma_f32_16x16x32_bf16 v[24:27], a[8:11], v[40:43], v[24:27]
    s_waitcnt lgkmcnt(4)
    v_mfma_f32_16x16x32_bf16 v[28:31], a[0:3], v[44:47], v[28:31]
    ds_read_b128 v[40:43], v9 offset:6144
    v_mfma_f32_16x16x32_bf16 v[32:35], a[4:7], v[44:47], v[32:35]
    s_mul_i32 s51, s35, 36864
    v_mfma_f32_16x16x32_bf16 v[36:39], a[8:11], v[44:47], v[36:39]
    v_readfirstlane_b32 s17, v15
    s_nop 0
    s_add_u32 s18, s17, 1
    s_max_i32 s32, s18, s37
    s_add_u32 s39, s37, 1
    s_min_u32 s39, s39, 63
    s_mul_i32 s33, s32, 22528
    s_add_u32 s33, s33, s61
    s_cmp_eq_u32 s14, 0
    s_cselect_b32 s18, s32, 0x7fff
    v_mov_b32 v2, 2
    s_cmp_le_u32 s18, s39
    s_cselect_b64 exec, -1, 0
    buffer_load_dword v2, v1, s[8:11], s33 offen sc1
    s_mov_b64 exec, -1
    s_cmp_ge_i32 s17, s37
    s_cbranch_scc1 Lawo_f_5
    s_waitcnt lgkmcnt(4)
    v_mfma_f32_16x16x32_bf16 v[16:19], a[12:15], v[48:51], v[16:19]
    ds_read_b128 v[44:47], v9 offset:6400
    v_mfma_f32_16x16x32_bf16 v[20:23], a[16:19], v[48:51], v[20:23]
    s_add_u32 s46, s46, s51
    v_mfma_f32_16x16x32_bf16 v[24:27], a[20:23], v[48:51], v[24:27]
    s_waitcnt lgkmcnt(4)
    v_mfma_f32_16x16x32_bf16 v[28:31], a[12:15], v[52:55], v[28:31]
    ds_read_b128 v[48:51], v9 offset:8192
    v_mfma_f32_16x16x32_bf16 v[32:35], a[16:19], v[52:55], v[32:35]
    s_add_u32 s46, s46, 8650752
    v_mfma_f32_16x16x32_bf16 v[36:39], a[20:23], v[52:55], v[36:39]
    s_waitcnt lgkmcnt(4)
    v_mfma_f32_16x16x32_bf16 v[16:19], a[24:27], v[56:59], v[16:19]
    ds_read_b128 v[52:55], v9 offset:8448
    v_mfma_f32_16x16x32_bf16 v[20:23], a[28:31], v[56:59], v[20:23]
    s_mul_i32 s52, s34, 786432
    v_mfma_f32_16x16x32_bf16 v[24:27], a[32:35], v[56:59], v[24:27]
    s_waitcnt lgkmcnt(4)
    v_mfma_f32_16x16x32_bf16 v[28:31], a[24:27], v[60:63], v[28:31]
    ds_read_b128 v[56:59], v9 offset:10240
    v_mfma_f32_16x16x32_bf16 v[32:35], a[28:31], v[60:63], v[32:35]
    s_mul_i32 s51, s35, 6144
    v_mfma_f32_16x16x32_bf16 v[36:39], a[32:35], v[60:63], v[36:39]
    s_waitcnt lgkmcnt(4)
    v_mfma_f32_16x16x32_bf16 v[16:19], a[36:39], v[40:43], v[16:19]
    ds_read_b128 v[60:63], v9 offset:10496
    v_mfma_f32_16x16x32_bf16 v[20:23], a[40:43], v[40:43], v[20:23]
    s_add_u32 s52, s52, s51
    v_mfma_f32_16x16x32_bf16 v[24:27], a[44:47], v[40:43], v[24:27]
    s_waitcnt lgkmcnt(4)
    v_mfma_f32_16x16x32_bf16 v[28:31], a[36:39], v[44:47], v[28:31]
    ds_read_b128 v[40:43], v9 offset:12288
    v_mfma_f32_16x16x32_bf16 v[32:35], a[40:43], v[44:47], v[32:35]
    s_add_u32 s52, s52, 16121856
    v_mfma_f32_16x16x32_bf16 v[36:39], a[44:47], v[44:47], v[36:39]
    s_waitcnt lgkmcnt(4)
    v_mfma_f32_16x16x32_bf16 v[16:19], a[48:51], v[48:51], v[16:19]
    ds_read_b128 v[44:47], v9 offset:12544
    v_mfma_f32_16x16x32_bf16 v[20:23], a[52:55], v[48:51], v[20:23]
    v_mfma_f32_16x16x32_bf16 v[24:27], a[56:59], v[48:51], v[24:27]
    s_waitcnt lgkmcnt(4)
    v_mfma_f32_16x16x32_bf16 v[28:31], a[48:51], v[52:55], v[28:31]
    ds_read_b128 v[48:51], v9 offset:14336
    v_mfma_f32_16x16x32_bf16 v[32:35], a[52:55], v[52:55], v[32:35]
    v_mfma_f32_16x16x32_bf16 v[36:39], a[56:59], v[52:55], v[36:39]
    s_waitcnt lgkmcnt(4)
    v_mfma_f32_16x16x32_bf16 v[16:19], a[60:63], v[56:59], v[16:19]
    ds_read_b128 v[52:55], v9 offset:14592
    v_mfma_f32_16x16x32_bf16 v[20:23], a[64:67], v[56:59], v[20:23]
    v_mfma_f32_16x16x32_bf16 v[24:27], a[68:71], v[56:59], v[24:27]
    s_waitcnt lgkmcnt(4)
    v_mfma_f32_16x16x32_bf16 v[28:31], a[60:63], v[60:63], v[28:31]
    v_cmp_eq_u32 s[76:77], 1, v2
    v_cmp_eq_u32 vcc, 2, v2
    ds_read_b128 v[56:59], v9 offset:16384
    v_mfma_f32_16x16x32_bf16 v[32:35], a[64:67], v[60:63], v[32:35]
    s_cmp_eq_u64 s[76:77], -1
    s_cselect_b32 s38, 1, 0
    v_mfma_f32_16x16x32_bf16 v[36:39], a[68:71], v[60:63], v[36:39]
    s_cmp_lg_u32 s38, 0
    s_cselect_b64 exec, 1, 0
    v_mov_b32 v15, s32
    ds_write_b32 v184, v15
    v_mov_b32 v2, 2
    s_mov_b64 exec, -1
    s_waitcnt lgkmcnt(5)
    v_mfma_f32_16x16x32_bf16 v[16:19], a[72:75], v[40:43], v[16:19]
    ds_read_b128 v[60:63], v9 offset:16640
    v_mfma_f32_16x16x32_bf16 v[20:23], a[76:79], v[40:43], v[20:23]
    s_add_u32 s32, s32, s38
    s_mul_i32 s38, s38, 22528
    s_add_u32 s33, s33, s38
    v_mfma_f32_16x16x32_bf16 v[24:27], a[80:83], v[40:43], v[24:27]
    s_cmp_eq_u64 vcc, 0
    s_cselect_b32 s38, s32, 0x7fff
    s_waitcnt lgkmcnt(5)
    v_mfma_f32_16x16x32_bf16 v[28:31], a[72:75], v[44:47], v[28:31]
    s_cmp_le_u32 s38, s39
    s_cselect_b64 exec, -1, 0
    v_mov_b32 v2, 2
    buffer_load_dword v2, v1, s[8:11], s33 offen sc1
    s_mov_b64 exec, -1
    ds_read_b128 v[40:43], v9 offset:18432
    v_mfma_f32_16x16x32_bf16 v[32:35], a[76:79], v[44:47], v[32:35]
    v_mfma_f32_16x16x32_bf16 v[36:39], a[80:83], v[44:47], v[36:39]
    ds_read_b32 v15, v184
    s_waitcnt lgkmcnt(6)
    v_mfma_f32_16x16x32_bf16 v[16:19], a[84:87], v[48:51], v[16:19]
    ds_read_b128 v[44:47], v9 offset:18688
    v_mfma_f32_16x16x32_bf16 v[20:23], a[88:91], v[48:51], v[20:23]
    v_mfma_f32_16x16x32_bf16 v[24:27], a[92:95], v[48:51], v[24:27]
    s_waitcnt lgkmcnt(6)
    v_mfma_f32_16x16x32_bf16 v[28:31], a[84:87], v[52:55], v[28:31]
    ds_read_b128 v[48:51], v9 offset:20480
    v_mfma_f32_16x16x32_bf16 v[32:35], a[88:91], v[52:55], v[32:35]
    v_mfma_f32_16x16x32_bf16 v[36:39], a[92:95], v[52:55], v[36:39]
    s_waitcnt lgkmcnt(2)
    v_readfirstlane_b32 s17, v15
    s_nop 0
    s_cmp_ge_i32 s17, s37
    s_cbranch_scc1 Lawo_f_6
    v_mfma_f32_16x16x32_bf16 v[16:19], a[96:99], v[56:59], v[16:19]
    ds_read_b128 v[52:55], v9 offset:20736
    v_mfma_f32_16x16x32_bf16 v[20:23], a[100:103], v[56:59], v[20:23]
    v_mfma_f32_16x16x32_bf16 v[24:27], a[104:107], v[56:59], v[24:27]
    v_mfma_f32_16x16x32_bf16 v[28:31], a[96:99], v[60:63], v[28:31]
    ds_read_b128 v[56:59], v9 offset:22528
    v_mfma_f32_16x16x32_bf16 v[32:35], a[100:103], v[60:63], v[32:35]
    v_mfma_f32_16x16x32_bf16 v[36:39], a[104:107], v[60:63], v[36:39]
    s_waitcnt vmcnt(2)
    s_cmp_lg_u32 s43, 0
    s_cselect_b64 exec, 1, 0
    buffer_store_dword v3, v4, s[8:11], s43 offen sc1
    s_mov_b64 exec, -1
    s_mov_b32 s43, 0
    v_mfma_f32_16x16x32_bf16 v[16:19], a[108:111], v[40:43], v[16:19]
    ds_read_b128 v[60:63], v9 offset:22784
    v_mfma_f32_16x16x32_bf16 v[20:23], a[112:115], v[40:43], v[20:23]
    v_mfma_f32_16x16x32_bf16 v[24:27], a[116:119], v[40:43], v[24:27]
    s_waitcnt lgkmcnt(4)
    v_mfma_f32_16x16x32_bf16 v[28:31], a[108:111], v[44:47], v[28:31]
    ds_read_b128 v[40:43], v9 offset:24576
    v_mfma_f32_16x16x32_bf16 v[32:35], a[112:115], v[44:47], v[32:35]
    v_mfma_f32_16x16x32_bf16 v[36:39], a[116:119], v[44:47], v[36:39]
    s_waitcnt lgkmcnt(4)
    v_mfma_f32_16x16x32_bf16 v[16:19], a[120:123], v[48:51], v[16:19]
    ds_read_b128 v[44:47], v9 offset:24832
    v_mfma_f32_16x16x32_bf16 v[20:23], a[124:127], v[48:51], v[20:23]
    v_mfma_f32_16x16x32_bf16 v[24:27], a[128:131], v[48:51], v[24:27]
    s_waitcnt lgkmcnt(4)
    v_mfma_f32_16x16x32_bf16 v[28:31], a[120:123], v[52:55], v[28:31]
    ds_read_b128 v[48:51], v9 offset:26624
    v_mfma_f32_16x16x32_bf16 v[32:35], a[124:127], v[52:55], v[32:35]
    v_mfma_f32_16x16x32_bf16 v[36:39], a[128:131], v[52:55], v[36:39]
    s_waitcnt lgkmcnt(4)
    v_mfma_f32_16x16x32_bf16 v[16:19], a[132:135], v[56:59], v[16:19]
    ds_read_b128 v[52:55], v9 offset:26880
    v_mfma_f32_16x16x32_bf16 v[20:23], a[136:139], v[56:59], v[20:23]
    v_mfma_f32_16x16x32_bf16 v[24:27], a[140:143], v[56:59], v[24:27]
    s_waitcnt lgkmcnt(4)
    v_mfma_f32_16x16x32_bf16 v[28:31], a[132:135], v[60:63], v[28:31]
    ds_read_b128 v[56:59], v9 offset:28672
    v_mfma_f32_16x16x32_bf16 v[32:35], a[136:139], v[60:63], v[32:35]
    v_mfma_f32_16x16x32_bf16 v[36:39], a[140:143], v[60:63], v[36:39]
    s_waitcnt lgkmcnt(4)
    v_mfma_f32_16x16x32_bf16 v[16:19], a[144:147], v[40:43], v[16:19]
    ds_read_b128 v[60:63], v9 offset:28928
    v_mfma_f32_16x16x32_bf16 v[20:23], a[148:151], v[40:43], v[20:23]
    v_mfma_f32_16x16x32_bf16 v[24:27], a[152:155], v[40:43], v[24:27]
    s_waitcnt lgkmcnt(4)
    v_mfma_f32_16x16x32_bf16 v[28:31], a[144:147], v[44:47], v[28:31]
    ds_read_b128 v[40:43], v9 offset:30720
    v_mfma_f32_16x16x32_bf16 v[32:35], a[148:151], v[44:47], v[32:35]
    v_mfma_f32_16x16x32_bf16 v[36:39], a[152:155], v[44:47], v[36:39]
    s_waitcnt lgkmcnt(4)
    v_mfma_f32_16x16x32_bf16 v[16:19], a[156:159], v[48:51], v[16:19]
    ds_read_b128 v[44:47], v9 offset:30976
    v_mfma_f32_16x16x32_bf16 v[20:23], a[160:163], v[48:51], v[20:23]
    v_mfma_f32_16x16x32_bf16 v[24:27], a[164:167], v[48:51], v[24:27]
    s_waitcnt lgkmcnt(4)
    v_mfma_f32_16x16x32_bf16 v[28:31], a[156:159], v[52:55], v[28:31]
    ds_read_b128 v[48:51], v9 offset:32768
    v_mfma_f32_16x16x32_bf16 v[32:35], a[160:163], v[52:55], v[32:35]
    v_mfma_f32_16x16x32_bf16 v[36:39], a[164:167], v[52:55], v[36:39]
    s_waitcnt lgkmcnt(4)
    v_mfma_f32_16x16x32_bf16 v[16:19], a[168:171], v[56:59], v[16:19]
    ds_read_b128 v[52:55], v9 offset:33024
    v_mfma_f32_16x16x32_bf16 v[20:23], a[172:175], v[56:59], v[20:23]
    v_mfma_f32_16x16x32_bf16 v[24:27], a[176:179], v[56:59], v[24:27]
    s_waitcnt lgkmcnt(4)
    v_mfma_f32_16x16x32_bf16 v[28:31], a[168:171], v[60:63], v[28:31]
    v_cmp_eq_u32 s[76:77], 1, v2
    v_cmp_eq_u32 vcc, 2, v2
    ds_read_b128 v[56:59], v9 offset:34816
    v_mfma_f32_16x16x32_bf16 v[32:35], a[172:175], v[60:63], v[32:35]
    s_cmp_eq_u64 s[76:77], -1
    s_cselect_b32 s38, 1, 0
    v_mfma_f32_16x16x32_bf16 v[36:39], a[176:179], v[60:63], v[36:39]
    s_cmp_lg_u32 s38, 0
    s_cselect_b64 exec, 1, 0
    v_mov_b32 v15, s32
    ds_write_b32 v184, v15
    v_mov_b32 v2, 2
    s_mov_b64 exec, -1
    s_waitcnt lgkmcnt(5)
    v_mfma_f32_16x16x32_bf16 v[16:19], a[180:183], v[40:43], v[16:19]
    ds_read_b128 v[60:63], v9 offset:35072
    v_mfma_f32_16x16x32_bf16 v[20:23], a[184:187], v[40:43], v[20:23]
    s_add_u32 s32, s32, s38
    s_mul_i32 s38, s38, 22528
    s_add_u32 s33, s33, s38
    v_mfma_f32_16x16x32_bf16 v[24:27], a[188:191], v[40:43], v[24:27]
    s_cmp_eq_u64 vcc, 0
    s_cselect_b32 s38, s32, 0x7fff
    s_waitcnt lgkmcnt(5)
    v_mfma_f32_16x16x32_bf16 v[28:31], a[180:183], v[44:47], v[28:31]
    s_cmp_le_u32 s38, s39
    s_cselect_b64 exec, -1, 0
    v_mov_b32 v2, 2
    buffer_load_dword v2, v1, s[8:11], s33 offen sc1
    s_mov_b64 exec, -1
    v_mfma_f32_16x16x32_bf16 v[32:35], a[184:187], v[44:47], v[32:35]
    v_mfma_f32_16x16x32_bf16 v[36:39], a[188:191], v[44:47], v[36:39]
    s_waitcnt lgkmcnt(4)
    v_mfma_f32_16x16x32_bf16 v[16:19], a[192:195], v[48:51], v[16:19]
    v_mfma_f32_16x16x32_bf16 v[20:23], a[196:199], v[48:51], v[20:23]
    v_mfma_f32_16x16x32_bf16 v[24:27], a[200:203], v[48:51], v[24:27]
    s_waitcnt lgkmcnt(3)
    v_mfma_f32_16x16x32_bf16 v[28:31], a[192:195], v[52:55], v[28:31]
    v_mfma_f32_16x16x32_bf16 v[32:35], a[196:199], v[52:55], v[32:35]
    v_mfma_f32_16x16x32_bf16 v[36:39], a[200:203], v[52:55], v[36:39]
    s_waitcnt lgkmcnt(2)
    v_mfma_f32_16x16x32_bf16 v[16:19], a[204:207], v[56:59], v[16:19]
    v_mfma_f32_16x16x32_bf16 v[20:23], a[208:211], v[56:59], v[20:23]
    v_mfma_f32_16x16x32_bf16 v[24:27], a[212:215], v[56:59], v[24:27]
    s_waitcnt lgkmcnt(0)
    v_mfma_f32_16x16x32_bf16 v[28:31], a[204:207], v[60:63], v[28:31]
    v_mfma_f32_16x16x32_bf16 v[32:35], a[208:211], v[60:63], v[32:35]
    v_mfma_f32_16x16x32_bf16 v[36:39], a[212:215], v[60:63], v[36:39]
    v_mov_b32 v88, 0x3f803f80
    v_cvt_pk_bf16_f32 v96, v16, v17
    v_cvt_pk_bf16_f32 v97, v18, v19
    v_cvt_pk_bf16_f32 v98, v20, v21
    v_cvt_pk_bf16_f32 v99, v22, v23
    v_cvt_pk_bf16_f32 v100, v24, v25
    v_cvt_pk_bf16_f32 v101, v26, v27
    buffer_store_dwordx4 v[96:99], v10, s[8:11], s46 offen offset:0 sc1
    buffer_store_dwordx2 v[100:101], v12, s[8:11], s46 offen offset:0 sc1
    v_cvt_pk_bf16_f32 v104, v28, v29
    v_cvt_pk_bf16_f32 v105, v30, v31
    v_cvt_pk_bf16_f32 v106, v32, v33
    v_cvt_pk_bf16_f32 v107, v34, v35
    v_cvt_pk_bf16_f32 v108, v36, v37
    v_cvt_pk_bf16_f32 v109, v38, v39
    buffer_store_dwordx4 v[104:107], v10, s[8:11], s46 offen offset:256 sc1
    buffer_store_dwordx2 v[108:109], v12, s[8:11], s46 offen offset:256 sc1
    v_mov_b32 v80, 0
    v_mov_b32 v81, 0
    v_mov_b32 v84, 0
    v_mov_b32 v85, 0
    v_dot2c_f32_bf16 v80, v96, v88
    v_dot2c_f32_bf16 v81, v96, v96
    v_dot2c_f32_bf16 v84, v104, v88
    v_dot2c_f32_bf16 v85, v104, v104
    v_dot2c_f32_bf16 v80, v97, v88
    v_dot2c_f32_bf16 v81, v97, v97
    v_dot2c_f32_bf16 v84, v105, v88
    v_dot2c_f32_bf16 v85, v105, v105
    v_dot2c_f32_bf16 v80, v98, v88
    v_dot2c_f32_bf16 v81, v98, v98
    v_dot2c_f32_bf16 v84, v106, v88
    v_dot2c_f32_bf16 v85, v106, v106
    v_dot2c_f32_bf16 v80, v99, v88
    v_dot2c_f32_bf16 v81, v99, v99
    v_dot2c_f32_bf16 v84, v107, v88
    v_dot2c_f32_bf16 v85, v107, v107
    v_dot2c_f32_bf16 v80, v100, v88
    v_dot2c_f32_bf16 v81, v100, v100
    v_dot2c_f32_bf16 v84, v108, v88
    v_dot2c_f32_bf16 v85, v108, v108
    v_dot2c_f32_bf16 v80, v101, v88
    v_dot2c_f32_bf16 v81, v101, v101
    v_dot2c_f32_bf16 v84, v109, v88
    v_dot2c_f32_bf16 v85, v109, v109
    s_nop 2
    v_mov_b32 v82, v80
    v_mov_b32 v83, v81
    v_mov_b32 v86, v84
    v_mov_b32 v87, v85
    v_permlane32_swap_b32 v80, v82
    v_permlane32_swap_b32 v81, v83
    v_permlane32_swap_b32 v84, v86
    v_permlane32_swap_b32 v85, v87
    v_add_f32 v80, v80, v82
    v_add_f32 v81, v81, v83
    v_add_f32 v84, v84, v86
    v_add_f32 v85, v85, v87
    v_mov_b32 v82, v80
    v_mov_b32 v83, v81
    v_mov_b32 v86, v84
    v_mov_b32 v87, v85
    v_permlane16_swap_b32 v80, v82
    v_permlane16_swap_b32 v81, v83
    v_permlane16_swap_b32 v84, v86
    v_permlane16_swap_b32 v85, v87
    v_add_f32 v80, v80, v82
    v_add_f32 v81, v81, v83
    v_add_f32 v84, v84, v86
    v_add_f32 v85, v85, v87
    s_mov_b64 exec, 0xffff
    buffer_store_dwordx2 v[80:81], v11, s[8:11], s52 offen offset:0 sc1
    buffer_store_dwordx2 v[84:85], v11, s[8:11], s52 offen offset:256 sc1
    s_mov_b64 exec, -1
    s_mul_i32 s43, s57, 22528
    s_add_u32 s43, s43, s49
    s_branch Lawo_none
Lawo_f_5:
    s_waitcnt lgkmcnt(4)
    v_mfma_f32_16x16x32_bf16 v[16:19], a[12:15], v[48:51], v[16:19]
    ds_read_b128 v[44:47], v9 offset:6400
    v_mfma_f32_16x16x32_bf16 v[20:23], a[16:19], v[48:51], v[20:23]
    s_add_u32 s46, s46, s51
    v_mfma_f32_16x16x32_bf16 v[24:27], a[20:23], v[48:51], v[24:27]
    s_add_u32 m0, s59, 0
    s_add_u32 s47, s41, 0
    buffer_load_dwordx4 v0, s[8:11], s47 offen offset:0 lds
    s_waitcnt lgkmcnt(4)
    v_mfma_f32_16x16x32_bf16 v[28:31], a[12:15], v[52:55], v[28:31]
    buffer_load_dwordx4 v0, s[8:11], s47 offen offset:1024 lds
    ds_read_b128 v[48:51], v9 offset:8192
    v_mfma_f32_16x16x32_bf16 v[32:35], a[16:19], v[52:55], v[32:35]
    s_add_u32 s46, s46, 8650752
    v_mfma_f32_16x16x32_bf16 v[36:39], a[20:23], v[52:55], v[36:39]
    s_waitcnt lgkmcnt(4)
    v_mfma_f32_16x16x32_bf16 v[16:19], a[24:27], v[56:59], v[16:19]
    buffer_load_dwordx4 v0, s[8:11], s47 offen offset:2048 lds
    ds_read_b128 v[52:55], v9 offset:8448
    v_mfma_f32_16x16x32_bf16 v[20:23], a[28:31], v[56:59], v[20:23]
    s_mul_i32 s52, s34, 786432
    v_mfma_f32_16x16x32_bf16 v[24:27], a[32:35], v[56:59], v[24:27]
    s_waitcnt lgkmcnt(4)
    v_mfma_f32_16x16x32_bf16 v[28:31], a[24:27], v[60:63], v[28:31]
    buffer_load_dwordx4 v0, s[8:11], s47 offen offset:3072 lds
    ds_read_b128 v[56:59], v9 offset:10240
    v_mfma_f32_16x16x32_bf16 v[32:35], a[28:31], v[60:63], v[32:35]
    s_mul_i32 s51, s35, 6144
    v_mfma_f32_16x16x32_bf16 v[36:39], a[32:35], v[60:63], v[36:39]
    s_waitcnt lgkmcnt(4)
    v_mfma_f32_16x16x32_bf16 v[16:19], a[36:39], v[40:43], v[16:19]
    ds_read_b128 v[60:63], v9 offset:10496
    v_mfma_f32_16x16x32_bf16 v[20:23], a[40:43], v[40:43], v[20:23]
    s_add_u32 s52, s52, s51
    v_mfma_f32_16x16x32_bf16 v[24:27], a[44:47], v[40:43], v[24:27]
    s_add_u32 m0, s59, 4096
    s_add_u32 s47, s41, 4096
    buffer_load_dwordx4 v0, s[8:11], s47 offen offset:0 lds
    s_waitcnt lgkmcnt(4)
    v_mfma_f32_16x16x32_bf16 v[28:31], a[36:39], v[44:47], v[28:31]
    buffer_load_dwordx4 v0, s[8:11], s47 offen offset:1024 lds
    ds_read_b128 v[40:43], v9 offset:12288
    v_mfma_f32_16x16x32_bf16 v[32:35], a[40:43], v[44:47], v[32:35]
    s_add_u32 s52, s52, 16121856
    v_mfma_f32_16x16x32_bf16 v[36:39], a[44:47], v[44:47], v[36:39]
    s_waitcnt lgkmcnt(4)
    v_mfma_f32_16x16x32_bf16 v[16:19], a[48:51], v[48:51], v[16:19]
    buffer_load_dwordx4 v0, s[8:11], s47 offen offset:2048 lds
    ds_read_b128 v[44:47], v9 offset:12544
    v_mfma_f32_16x16x32_bf16 v[20:23], a[52:55], v[48:51], v[20:23]
    v_mfma_f32_16x16x32_bf16 v[24:27], a[56:59], v[48:51], v[24:27]
    s_waitcnt lgkmcnt(4)
    v_mfma_f32_16x16x32_bf16 v[28:31], a[48:51], v[52:55], v[28:31]
    buffer_load_dwordx4 v0, s[8:11], s47 offen offset:3072 lds
    ds_read_b128 v[48:51], v9 offset:14336
    v_mfma_f32_16x16x32_bf16 v[32:35], a[52:55], v[52:55], v[32:35]
    v_mfma_f32_16x16x32_bf16 v[36:39], a[56:59], v[52:55], v[36:39]
    s_waitcnt lgkmcnt(4)
    v_mfma_f32_16x16x32_bf16 v[16:19], a[60:63], v[56:59], v[16:19]
    ds_read_b128 v[52:55], v9 offset:14592
    v_mfma_f32_16x16x32_bf16 v[20:23], a[64:67], v[56:59], v[20:23]
    s_add_u32 m0, s59, 8192
    s_add_u32 s47, s41, 8192
    buffer_load_dwordx4 v0, s[8:11], s47 offen offset:0 lds
    v_mfma_f32_16x16x32_bf16 v[24:27], a[68:71], v[56:59], v[24:27]
    s_waitcnt lgkmcnt(4)
    v_mfma_f32_16x16x32_bf16 v[28:31], a[60:63], v[60:63], v[28:31]
    s_mul_i32 s48, s36, 4718592
    s_mul_i32 s18, s37, 36864
    s_add_u32 s48, s48, s18
    s_add_u32 s48, s48, 6291456
    buffer_load_dwordx4 v[64:67], v10, s[8:11], s48 offen offset:0
    ds_read_b128 v[56:59], v9 offset:16384
    v_mfma_f32_16x16x32_bf16 v[32:35], a[64:67], v[60:63], v[32:35]
    v_cmp_eq_u32 s[76:77], 1, v2
    v_cmp_eq_u32 vcc, 2, v2
    v_mfma_f32_16x16x32_bf16 v[36:39], a[68:71], v[60:63], v[36:39]
    s_cmp_eq_u64 s[76:77], -1
    s_cselect_b32 s38, 1, 0
    s_waitcnt lgkmcnt(4)
    v_mfma_f32_16x16x32_bf16 v[16:19], a[72:75], v[40:43], v[16:19]
    s_cmp_lg_u32 s38, 0
    s_cselect_b64 exec, 1, 0
    v_mov_b32 v15, s32
    ds_write_b32 v184, v15
    v_mov_b32 v2, 2
    s_mov_b64 exec, -1
    ds_read_b128 v[60:63], v9 offset:16640
    v_mfma_f32_16x16x32_bf16 v[20:23], a[76:79], v[40:43], v[20:23]
    s_add_u32 s32, s32, s38
    s_mul_i32 s38, s38, 22528
    s_add_u32 s33, s33, s38
    v_mfma_f32_16x16x32_bf16 v[24:27], a[80:83], v[40:43], v[24:27]
    s_cmp_eq_u64 vcc, 0
    s_cselect_b32 s38, s32, 0x7fff
    s_waitcnt lgkmcnt(5)
    v_mfma_f32_16x16x32_bf16 v[28:31], a[72:75], v[44:47], v[28:31]
    s_cmp_le_u32 s38, s39
    s_cselect_b64 exec, -1, 0
    v_mov_b32 v2, 2
    buffer_load_dword v2, v1, s[8:11], s33 offen sc1
    s_mov_b64 exec, -1
    ds_read_b128 v[40:43], v9 offset:18432
    v_mfma_f32_16x16x32_bf16 v[32:35], a[76:79], v[44:47], v[32:35]
    buffer_load_dwordx2 v[68:69], v12, s[8:11], s48 offen offset:0
    buffer_load_dwordx4 v[72:75], v10, s[8:11], s48 offen offset:256
    v_mfma_f32_16x16x32_bf16 v[36:39], a[80:83], v[44:47], v[36:39]
    s_waitcnt lgkmcnt(5)
    v_mfma_f32_16x16x32_bf16 v[16:19], a[84:87], v[48:51], v[16:19]
    buffer_load_dwordx2 v[76:77], v12, s[8:11], s48 offen offset:256
    ds_read_b128 v[44:47], v9 offset:18688
    v_mfma_f32_16x16x32_bf16 v[20:23], a[88:91], v[48:51], v[20:23]
    v_mfma_f32_16x16x32_bf16 v[24:27], a[92:95], v[48:51], v[24:27]
    s_waitcnt lgkmcnt(5)
    v_mfma_f32_16x16x32_bf16 v[28:31], a[84:87], v[52:55], v[28:31]
    ds_read_b128 v[48:51], v9 offset:20480
    v_mfma_f32_16x16x32_bf16 v[32:35], a[88:91], v[52:55], v[32:35]
    v_mfma_f32_16x16x32_bf16 v[36:39], a[92:95], v[52:55], v[36:39]
    s_waitcnt lgkmcnt(5)
    v_mfma_f32_16x16x32_bf16 v[16:19], a[96:99], v[56:59], v[16:19]
    ds_read_b128 v[52:55], v9 offset:20736
    v_mfma_f32_16x16x32_bf16 v[20:23], a[100:103], v[56:59], v[20:23]
    v_mfma_f32_16x16x32_bf16 v[24:27], a[104:107], v[56:59], v[24:27]
    s_waitcnt lgkmcnt(4)
    v_mfma_f32_16x16x32_bf16 v[28:31], a[96:99], v[60:63], v[28:31]
    ds_read_b128 v[56:59], v9 offset:22528
    v_mfma_f32_16x16x32_bf16 v[32:35], a[100:103], v[60:63], v[32:35]
    v_mfma_f32_16x16x32_bf16 v[36:39], a[104:107], v[60:63], v[36:39]
    s_waitcnt vmcnt(15)
    s_cmp_lg_u32 s43, 0
    s_cselect_b64 exec, 1, 0
    buffer_store_dword v3, v4, s[8:11], s43 offen sc1
    s_mov_b64 exec, -1
    s_mov_b32 s43, 0
    s_waitcnt lgkmcnt(4)
    v_mfma_f32_16x16x32_bf16 v[16:19], a[108:111], v[40:43], v[16:19]
    ds_read_b128 v[60:63], v9 offset:22784
    v_mfma_f32_16x16x32_bf16 v[20:23], a[112:115], v[40:43], v[20:23]
    v_mfma_f32_16x16x32_bf16 v[24:27], a[116:119], v[40:43], v[24:27]
    s_waitcnt lgkmcnt(4)
    v_mfma_f32_16x16x32_bf16 v[28:31], a[108:111], v[44:47], v[28:31]
    ds_read_b128 v[40:43], v9 offset:24576
    v_mfma_f32_16x16x32_bf16 v[32:35], a[112:115], v[44:47], v[32:35]
    v_mfma_f32_16x16x32_bf16 v[36:39], a[116:119], v[44:47], v[36:39]
    s_waitcnt lgkmcnt(4)
    v_mfma_f32_16x16x32_bf16 v[16:19], a[120:123], v[48:51], v[16:19]
    ds_read_b128 v[44:47], v9 offset:24832
    v_mfma_f32_16x16x32_bf16 v[20:23], a[124:127], v[48:51], v[20:23]
    v_mfma_f32_16x16x32_bf16 v[24:27], a[128:131], v[48:51], v[24:27]
    s_waitcnt lgkmcnt(4)
    v_mfma_f32_16x16x32_bf16 v[28:31], a[120:123], v[52:55], v[28:31]
    ds_read_b128 v[48:51], v9 offset:26624
    v_mfma_f32_16x16x32_bf16 v[32:35], a[124:127], v[52:55], v[32:35]
    v_mfma_f32_16x16x32_bf16 v[36:39], a[128:131], v[52:55], v[36:39]
    s_waitcnt lgkmcnt(4)
    v_mfma_f32_16x16x32_bf16 v[16:19], a[132:135], v[56:59], v[16:19]
    ds_read_b128 v[52:55], v9 offset:26880
    v_mfma_f32_16x16x32_bf16 v[20:23], a[136:139], v[56:59], v[20:23]
    v_mfma_f32_16x16x32_bf16 v[24:27], a[140:143], v[56:59], v[24:27]
    s_waitcnt lgkmcnt(4)
    v_mfma_f32_16x16x32_bf16 v[28:31], a[132:135], v[60:63], v[28:31]
    ds_read_b128 v[56:59], v9 offset:28672
    v_mfma_f32_16x16x32_bf16 v[32:35], a[136:139], v[60:63], v[32:35]
    v_mfma_f32_16x16x32_bf16 v[36:39], a[140:143], v[60:63], v[36:39]
    s_waitcnt lgkmcnt(4)
    v_mfma_f32_16x16x32_bf16 v[16:19], a[144:147], v[40:43], v[16:19]
    ds_read_b128 v[60:63], v9 offset:28928
    v_mfma_f32_16x16x32_bf16 v[20:23], a[148:151], v[40:43], v[20:23]
    v_mfma_f32_16x16x32_bf16 v[24:27], a[152:155], v[40:43], v[24:27]
    s_waitcnt lgkmcnt(4)
    v_mfma_f32_16x16x32_bf16 v[28:31], a[144:147], v[44:47], v[28:31]
    ds_read_b128 v[40:43], v9 offset:30720
    v_mfma_f32_16x16x32_bf16 v[32:35], a[148:151], v[44:47], v[32:35]
    v_mfma_f32_16x16x32_bf16 v[36:39], a[152:155], v[44:47], v[36:39]
    s_waitcnt lgkmcnt(4)
    v_mfma_f32_16x16x32_bf16 v[16:19], a[156:159], v[48:51], v[16:19]
    ds_read_b128 v[44:47], v9 offset:30976
    v_mfma_f32_16x16x32_bf16 v[20:23], a[160:163], v[48:51], v[20:23]
    v_mfma_f32_16x16x32_bf16 v[24:27], a[164:167], v[48:51], v[24:27]
    s_waitcnt lgkmcnt(4)
    v_mfma_f32_16x16x32_bf16 v[28:31], a[156:159], v[52:55], v[28:31]
    ds_read_b128 v[48:51], v9 offset:32768
    v_mfma_f32_16x16x32_bf16 v[32:35], a[160:163], v[52:55], v[32:35]
    v_mfma_f32_16x16x32_bf16 v[36:39], a[164:167], v[52:55], v[36:39]
    s_waitcnt lgkmcnt(4)
    v_mfma_f32_16x16x32_bf16 v[16:19], a[168:171], v[56:59], v[16:19]
    ds_read_b128 v[52:55], v9 offset:33024
    v_mfma_f32_16x16x32_bf16 v[20:23], a[172:175], v[56:59], v[20:23]
    v_mfma_f32_16x16x32_bf16 v[24:27], a[176:179], v[56:59], v[24:27]
    s_waitcnt lgkmcnt(4)
    v_mfma_f32_16x16x32_bf16 v[28:31], a[168:171], v[60:63], v[28:31]
    v_cmp_eq_u32 s[76:77], 1, v2
    v_cmp_eq_u32 vcc, 2, v2
    ds_read_b128 v[56:59], v9 offset:34816
    v_mfma_f32_16x16x32_bf16 v[32:35], a[172:175], v[60:63], v[32:35]
    s_cmp_eq_u64 s[76:77], -1
    s_cselect_b32 s38, 1, 0
    v_mfma_f32_16x16x32_bf16 v[36:39], a[176:179], v[60:63], v[36:39]
    s_cmp_lg_u32 s38, 0
    s_cselect_b64 exec, 1, 0
    v_mov_b32 v15, s32
    ds_write_b32 v184, v15
    v_mov_b32 v2, 2
    s_mov_b64 exec, -1
    s_waitcnt lgkmcnt(5)
    v_mfma_f32_16x16x32_bf16 v[16:19], a[180:183], v[40:43], v[16:19]
    ds_read_b128 v[60:63], v9 offset:35072
    v_mfma_f32_16x16x32_bf16 v[20:23], a[184:187], v[40:43], v[20:23]
    s_add_u32 s32, s32, s38
    s_mul_i32 s38, s38, 22528
    s_add_u32 s33, s33, s38
    v_mfma_f32_16x16x32_bf16 v[24:27], a[188:191], v[40:43], v[24:27]
    s_cmp_eq_u64 vcc, 0
    s_cselect_b32 s38, s32, 0x7fff
    s_waitcnt lgkmcnt(5)
    v_mfma_f32_16x16x32_bf16 v[28:31], a[180:183], v[44:47], v[28:31]
    s_cmp_le_u32 s38, s39
    s_cselect_b64 exec, -1, 0
    v_mov_b32 v2, 2
    buffer_load_dword v2, v1, s[8:11], s33 offen sc1
    s_mov_b64 exec, -1
    v_mfma_f32_16x16x32_bf16 v[32:35], a[184:187], v[44:47], v[32:35]
    v_mfma_f32_16x16x32_bf16 v[36:39], a[188:191], v[44:47], v[36:39]
    s_waitcnt lgkmcnt(4)
    v_mfma_f32_16x16x32_bf16 v[16:19], a[192:195], v[48:51], v[16:19]
    v_mfma_f32_16x16x32_bf16 v[20:23], a[196:199], v[48:51], v[20:23]
    v_mfma_f32_16x16x32_bf16 v[24:27], a[200:203], v[48:51], v[24:27]
    s_waitcnt lgkmcnt(3)
    v_mfma_f32_16x16x32_bf16 v[28:31], a[192:195], v[52:55], v[28:31]
    v_mfma_f32_16x16x32_bf16 v[32:35], a[196:199], v[52:55], v[32:35]
    v_mfma_f32_16x16x32_bf16 v[36:39], a[200:203], v[52:55], v[36:39]
    s_waitcnt lgkmcnt(2)
    v_mfma_f32_16x16x32_bf16 v[16:19], a[204:207], v[56:59], v[16:19]
    v_mfma_f32_16x16x32_bf16 v[20:23], a[208:211], v[56:59], v[20:23]
    v_mfma_f32_16x16x32_bf16 v[24:27], a[212:215], v[56:59], v[24:27]
    s_waitcnt lgkmcnt(0)
    v_mfma_f32_16x16x32_bf16 v[28:31], a[204:207], v[60:63], v[28:31]
    v_mfma_f32_16x16x32_bf16 v[32:35], a[208:211], v[60:63], v[32:35]
    v_mfma_f32_16x16x32_bf16 v[36:39], a[212:215], v[60:63], v[36:39]
    v_mov_b32 v88, 0x3f803f80
    v_cvt_pk_bf16_f32 v96, v16, v17
    v_cvt_pk_bf16_f32 v97, v18, v19
    v_cvt_pk_bf16_f32 v98, v20, v21
    v_cvt_pk_bf16_f32 v99, v22, v23
    v_cvt_pk_bf16_f32 v100, v24, v25
    v_cvt_pk_bf16_f32 v101, v26, v27
    buffer_store_dwordx4 v[96:99], v10, s[8:11], s46 offen offset:0 sc1
    buffer_store_dwordx2 v[100:101], v12, s[8:11], s46 offen offset:0 sc1
    v_cvt_pk_bf16_f32 v104, v28, v29
    v_cvt_pk_bf16_f32 v105, v30, v31
    v_cvt_pk_bf16_f32 v106, v32, v33
    v_cvt_pk_bf16_f32 v107, v34, v35
    v_cvt_pk_bf16_f32 v108, v36, v37
    v_cvt_pk_bf16_f32 v109, v38, v39
    buffer_store_dwordx4 v[104:107], v10, s[8:11], s46 offen offset:256 sc1
    buffer_store_dwordx2 v[108:109], v12, s[8:11], s46 offen offset:256 sc1
    v_mov_b32 v80, 0
    v_mov_b32 v81, 0
    v_mov_b32 v84, 0
    v_mov_b32 v85, 0
    v_dot2c_f32_bf16 v80, v96, v88
    v_dot2c_f32_bf16 v81, v96, v96
    v_dot2c_f32_bf16 v84, v104, v88
    v_dot2c_f32_bf16 v85, v104, v104
    v_dot2c_f32_bf16 v80, v97, v88
    v_dot2c_f32_bf16 v81, v97, v97
    v_dot2c_f32_bf16 v84, v105, v88
    v_dot2c_f32_bf16 v85, v105, v105
    v_dot2c_f32_bf16 v80, v98, v88
    v_dot2c_f32_bf16 v81, v98, v98
    v_dot2c_f32_bf16 v84, v106, v88
    v_dot2c_f32_bf16 v85, v106, v106
    v_dot2c_f32_bf16 v80, v99, v88
    v_dot2c_f32_bf16 v81, v99, v99
    v_dot2c_f32_bf16 v84, v107, v88
    v_dot2c_f32_bf16 v85, v107, v107
    v_dot2c_f32_bf16 v80, v100, v88
    v_dot2c_f32_bf16 v81, v100, v100
    v_dot2c_f32_bf16 v84, v108, v88
    v_dot2c_f32_bf16 v85, v108, v108
    v_dot2c_f32_bf16 v80, v101, v88
    v_dot2c_f32_bf16 v81, v101, v101
    v_dot2c_f32_bf16 v84, v109, v88
    v_dot2c_f32_bf16 v85, v109, v109
    s_nop 2
    v_mov_b32 v82, v80
    v_mov_b32 v83, v81
    v_mov_b32 v86, v84
    v_mov_b32 v87, v85
    v_permlane32_swap_b32 v80, v82
    v_permlane32_swap_b32 v81, v83
    v_permlane32_swap_b32 v84, v86
    v_permlane32_swap_b32 v85, v87
    v_add_f32 v80, v80, v82
    v_add_f32 v81, v81, v83
    v_add_f32 v84, v84, v86
    v_add_f32 v85, v85, v87
    v_mov_b32 v82, v80
    v_mov_b32 v83, v81
    v_mov_b32 v86, v84
    v_mov_b32 v87, v85
    v_permlane16_swap_b32 v80, v82
    v_permlane16_swap_b32 v81, v83
    v_permlane16_swap_b32 v84, v86
    v_permlane16_swap_b32 v85, v87
    v_add_f32 v80, v80, v82
    v_add_f32 v81, v81, v83
    v_add_f32 v84, v84, v86
    v_add_f32 v85, v85, v87
    s_mov_b64 exec, 0xffff
    buffer_store_dwordx2 v[80:81], v11, s[8:11], s52 offen offset:0 sc1
    buffer_store_dwordx2 v[84:85], v11, s[8:11], s52 offen offset:256 sc1
    s_mov_b64 exec, -1
    s_mul_i32 s43, s57, 22528
    s_add_u32 s43, s43, s49
    s_branch Lawo_head
Lawo_f_6:
    v_mfma_f32_16x16x32_bf16 v[16:19], a[96:99], v[56:59], v[16:19]
    ds_read_b128 v[52:55], v9 offset:20736
    v_mfma_f32_16x16x32_bf16 v[20:23], a[100:103], v[56:59], v[20:23]
    s_add_u32 m0, s59, 0
    s_add_u32 s47, s41, 0
    buffer_load_dwordx4 v0, s[8:11], s47 offen offset:0 lds
    v_mfma_f32_16x16x32_bf16 v[24:27], a[104:107], v[56:59], v[24:27]
    v_mfma_f32_16x16x32_bf16 v[28:31], a[96:99], v[60:63], v[28:31]
    buffer_load_dwordx4 v0, s[8:11], s47 offen offset:1024 lds
    ds_read_b128 v[56:59], v9 offset:22528
    v_mfma_f32_16x16x32_bf16 v[32:35], a[100:103], v[60:63], v[32:35]
    v_mfma_f32_16x16x32_bf16 v[36:39], a[104:107], v[60:63], v[36:39]
    s_waitcnt vmcnt(4)
    s_cmp_lg_u32 s43, 0
    s_cselect_b64 exec, 1, 0
    buffer_store_dword v3, v4, s[8:11], s43 offen sc1
    s_mov_b64 exec, -1
    s_mov_b32 s43, 0
    v_mfma_f32_16x16x32_bf16 v[16:19], a[108:111], v[40:43], v[16:19]
    buffer_load_dwordx4 v0, s[8:11], s47 offen offset:2048 lds
    ds_read_b128 v[60:63], v9 offset:22784
    v_mfma_f32_16x16x32_bf16 v[20:23], a[112:115], v[40:43], v[20:23]
    v_mfma_f32_16x16x32_bf16 v[24:27], a[116:119], v[40:43], v[24:27]
    s_waitcnt lgkmcnt(4)
    v_mfma_f32_16x16x32_bf16 v[28:31], a[108:111], v[44:47], v[28:31]
    buffer_load_dwordx4 v0, s[8:11], s47 offen offset:3072 lds
    ds_read_b128 v[40:43], v9 offset:24576
    v_mfma_f32_16x16x32_bf16 v[32:35], a[112:115], v[44:47], v[32:35]
    v_mfma_f32_16x16x32_bf16 v[36:39], a[116:119], v[44:47], v[36:39]
    s_waitcnt lgkmcnt(4)
    v_mfma_f32_16x16x32_bf16 v[16:19], a[120:123], v[48:51], v[16:19]
    ds_read_b128 v[44:47], v9 offset:24832
    v_mfma_f32_16x16x32_bf16 v[20:23], a[124:127], v[48:51], v[20:23]
    s_add_u32 m0, s59, 4096
    s_add_u32 s47, s41, 4096
    buffer_load_dwordx4 v0, s[8:11], s47 offen offset:0 lds
    v_mfma_f32_16x16x32_bf16 v[24:27], a[128:131], v[48:51], v[24:27]
    s_waitcnt lgkmcnt(4)
    v_mfma_f32_16x16x32_bf16 v[28:31], a[120:123], v[52:55], v[28:31]
    buffer_load_dwordx4 v0, s[8:11], s47 offen offset:1024 lds
    ds_read_b128 v[48:51], v9 offset:26624
    v_mfma_f32_16x16x32_bf16 v[32:35], a[124:127], v[52:55], v[32:35]
    v_mfma_f32_16x16x32_bf16 v[36:39], a[128:131], v[52:55], v[36:39]
    s_waitcnt lgkmcnt(4)
    v_mfma_f32_16x16x32_bf16 v[16:19], a[132:135], v[56:59], v[16:19]
    buffer_load_dwordx4 v0, s[8:11], s47 offen offset:2048 lds
    ds_read_b128 v[52:55], v9 offset:26880
    v_mfma_f32_16x16x32_bf16 v[20:23], a[136:139], v[56:59], v[20:23]
    v_mfma_f32_16x16x32_bf16 v[24:27], a[140:143], v[56:59], v[24:27]
    s_waitcnt lgkmcnt(4)
    v_mfma_f32_16x16x32_bf16 v[28:31], a[132:135], v[60:63], v[28:31]
    buffer_load_dwordx4 v0, s[8:11], s47 offen offset:3072 lds
    ds_read_b128 v[56:59], v9 offset:28672
    v_mfma_f32_16x16x32_bf16 v[32:35], a[136:139], v[60:63], v[32:35]
    v_mfma_f32_16x16x32_bf16 v[36:39], a[140:143], v[60:63], v[36:39]
    s_waitcnt lgkmcnt(4)
    v_mfma_f32_16x16x32_bf16 v[16:19], a[144:147], v[40:43], v[16:19]
    ds_read_b128 v[60:63], v9 offset:28928
    v_mfma_f32_16x16x32_bf16 v[20:23], a[148:151], v[40:43], v[20:23]
    s_add_u32 m0, s59, 8192
    s_add_u32 s47, s41, 8192
    buffer_load_dwordx4 v0, s[8:11], s47 offen offset:0 lds
    v_mfma_f32_16x16x32_bf16 v[24:27], a[152:155], v[40:43], v[24:27]
    s_waitcnt lgkmcnt(4)
    v_mfma_f32_16x16x32_bf16 v[28:31], a[144:147], v[44:47], v[28:31]
    s_mul_i32 s48, s36, 4718592
    s_mul_i32 s18, s37, 36864
    s_add_u32 s48, s48, s18
    s_add_u32 s48, s48, 6291456
    buffer_load_dwordx4 v[64:67], v10, s[8:11], s48 offen offset:0
    ds_read_b128 v[40:43], v9 offset:30720
    v_mfma_f32_16x16x32_bf16 v[32:35], a[148:151], v[44:47], v[32:35]
    v_mfma_f32_16x16x32_bf16 v[36:39], a[152:155], v[44:47], v[36:39]
    s_waitcnt lgkmcnt(4)
    v_mfma_f32_16x16x32_bf16 v[16:19], a[156:159], v[48:51], v[16:19]
    buffer_load_dwordx2 v[68:69], v12, s[8:11], s48 offen offset:0
    ds_read_b128 v[44:47], v9 offset:30976
    v_mfma_f32_16x16x32_bf16 v[20:23], a[160:163], v[48:51], v[20:23]
    v_mfma_f32_16x16x32_bf16 v[24:27], a[164:167], v[48:51], v[24:27]
    s_waitcnt lgkmcnt(4)
    v_mfma_f32_16x16x32_bf16 v[28:31], a[156:159], v[52:55], v[28:31]
    buffer_load_dwordx4 v[72:75], v10, s[8:11], s48 offen offset:256
    ds_read_b128 v[48:51], v9 offset:32768
    v_mfma_f32_16x16x32_bf16 v[32:35], a[160:163], v[52:55], v[32:35]
    v_mfma_f32_16x16x32_bf16 v[36:39], a[164:167], v[52:55], v[36:39]
    s_waitcnt lgkmcnt(4)
    v_mfma_f32_16x16x32_bf16 v[16:19], a[168:171], v[56:59], v[16:19]
    buffer_load_dwordx2 v[76:77], v12, s[8:11], s48 offen offset:256
    ds_read_b128 v[52:55], v9 offset:33024
    v_mfma_f32_16x16x32_bf16 v[20:23], a[172:175], v[56:59], v[20:23]
    v_mfma_f32_16x16x32_bf16 v[24:27], a[176:179], v[56:59], v[24:27]
    s_waitcnt lgkmcnt(4)
    v_mfma_f32_16x16x32_bf16 v[28:31], a[168:171], v[60:63], v[28:31]
    v_cmp_eq_u32 s[76:77], 1, v2
    v_cmp_eq_u32 vcc, 2, v2
    ds_read_b128 v[56:59], v9 offset:34816
    v_mfma_f32_16x16x32_bf16 v[32:35], a[172:175], v[60:63], v[32:35]
    s_cmp_eq_u64 s[76:77], -1
    s_cselect_b32 s38, 1, 0
    v_mfma_f32_16x16x32_bf16 v[36:39], a[176:179], v[60:63], v[36:39]
    s_cmp_lg_u32 s38, 0
    s_cselect_b64 exec, 1, 0
    v_mov_b32 v15, s32
    ds_write_b32 v184, v15
    v_mov_b32 v2, 2
    s_mov_b64 exec, -1
    s_waitcnt lgkmcnt(5)
    v_mfma_f32_16x16x32_bf16 v[16:19], a[180:183], v[40:43], v[16:19]
    ds_read_b128 v[60:63], v9 offset:35072
    v_mfma_f32_16x16x32_bf16 v[20:23], a[184:187], v[40:43], v[20:23]
    s_add_u32 s32, s32, s38
    s_mul_i32 s38, s38, 22528
    s_add_u32 s33, s33, s38
    v_mfma_f32_16x16x32_bf16 v[24:27], a[188:191], v[40:43], v[24:27]
    s_cmp_eq_u64 vcc, 0
    s_cselect_b32 s38, s32, 0x7fff
    s_waitcnt lgkmcnt(5)
    v_mfma_f32_16x16x32_bf16 v[28:31], a[180:183], v[44:47], v[28:31]
    s_cmp_le_u32 s38, s39
    s_cselect_b64 exec, -1, 0
    v_mov_b32 v2, 2
    buffer_load_dword v2, v1, s[8:11], s33 offen sc1
    s_mov_b64 exec, -1
    v_mfma_f32_16x16x32_bf16 v[32:35], a[184:187], v[44:47], v[32:35]
    v_mfma_f32_16x16x32_bf16 v[36:39], a[188:191], v[44:47], v[36:39]
    s_waitcnt lgkmcnt(4)
    v_mfma_f32_16x16x32_bf16 v[16:19], a[192:195], v[48:51], v[16:19]
    v_mfma_f32_16x16x32_bf16 v[20:23], a[196:199], v[48:51], v[20:23]
    v_mfma_f32_16x16x32_bf16 v[24:27], a[200:203], v[48:51], v[24:27]
    s_waitcnt lgkmcnt(3)
    v_mfma_f32_16x16x32_bf16 v[28:31], a[192:195], v[52:55], v[28:31]
    v_mfma_f32_16x16x32_bf16 v[32:35], a[196:199], v[52:55], v[32:35]
    v_mfma_f32_16x16x32_bf16 v[36:39], a[200:203], v[52:55], v[36:39]
    s_waitcnt lgkmcnt(2)
    v_mfma_f32_16x16x32_bf16 v[16:19], a[204:207], v[56:59], v[16:19]
    v_mfma_f32_16x16x32_bf16 v[20:23], a[208:211], v[56:59], v[20:23]
    v_mfma_f32_16x16x32_bf16 v[24:27], a[212:215], v[56:59], v[24:27]
    s_waitcnt lgkmcnt(0)
    v_mfma_f32_16x16x32_bf16 v[28:31], a[204:207], v[60:63], v[28:31]
    v_mfma_f32_16x16x32_bf16 v[32:35], a[208:211], v[60:63], v[32:35]
    v_mfma_f32_16x16x32_bf16 v[36:39], a[212:215], v[60:63], v[36:39]
    v_mov_b32 v88, 0x3f803f80
    v_cvt_pk_bf16_f32 v96, v16, v17
    v_cvt_pk_bf16_f32 v97, v18, v19
    v_cvt_pk_bf16_f32 v98, v20, v21
    v_cvt_pk_bf16_f32 v99, v22, v23
    v_cvt_pk_bf16_f32 v100, v24, v25
    v_cvt_pk_bf16_f32 v101, v26, v27
    buffer_store_dwordx4 v[96:99], v10, s[8:11], s46 offen offset:0 sc1
    buffer_store_dwordx2 v[100:101], v12, s[8:11], s46 offen offset:0 sc1
    v_cvt_pk_bf16_f32 v104, v28, v29
    v_cvt_pk_bf16_f32 v105, v30, v31
    v_cvt_pk_bf16_f32 v106, v32, v33
    v_cvt_pk_bf16_f32 v107, v34, v35
    v_cvt_pk_bf16_f32 v108, v36, v37
    v_cvt_pk_bf16_f32 v109, v38, v39
    buffer_store_dwordx4 v[104:107], v10, s[8:11], s46 offen offset:256 sc1
    buffer_store_dwordx2 v[108:109], v12, s[8:11], s46 offen offset:256 sc1
    v_mov_b32 v80, 0
    v_mov_b32 v81, 0
    v_mov_b32 v84, 0
    v_mov_b32 v85, 0
    v_dot2c_f32_bf16 v80, v96, v88
    v_dot2c_f32_bf16 v81, v96, v96
    v_dot2c_f32_bf16 v84, v104, v88
    v_dot2c_f32_bf16 v85, v104, v104
    v_dot2c_f32_bf16 v80, v97, v88
    v_dot2c_f32_bf16 v81, v97, v97
    v_dot2c_f32_bf16 v84, v105, v88
    v_dot2c_f32_bf16 v85, v105, v105
    v_dot2c_f32_bf16 v80, v98, v88
    v_dot2c_f32_bf16 v81, v98, v98
    v_dot2c_f32_bf16 v84, v106, v88
    v_dot2c_f32_bf16 v85, v106, v106
    v_dot2c_f32_bf16 v80, v99, v88
    v_dot2c_f32_bf16 v81, v99, v99
    v_dot2c_f32_bf16 v84, v107, v88
    v_dot2c_f32_bf16 v85, v107, v107
    v_dot2c_f32_bf16 v80, v100, v88
    v_dot2c_f32_bf16 v81, v100, v100
    v_dot2c_f32_bf16 v84, v108, v88
    v_dot2c_f32_bf16 v85, v108, v108
    v_dot2c_f32_bf16 v80, v101, v88
    v_dot2c_f32_bf16 v81, v101, v101
    v_dot2c_f32_bf16 v84, v109, v88
    v_dot2c_f32_bf16 v85, v109, v109
    s_nop 2
    v_mov_b32 v82, v80
    v_mov_b32 v83, v81
    v_mov_b32 v86, v84
    v_mov_b32 v87, v85
    v_permlane32_swap_b32 v80, v82
    v_permlane32_swap_b32 v81, v83
    v_permlane32_swap_b32 v84, v86
    v_permlane32_swap_b32 v85, v87
    v_add_f32 v80, v80, v82
    v_add_f32 v81, v81, v83
    v_add_f32 v84, v84, v86
    v_add_f32 v85, v85, v87
    v_mov_b32 v82, v80
    v_mov_b32 v83, v81
    v_mov_b32 v86, v84
    v_mov_b32 v87, v85
    v_permlane16_swap_b32 v80, v82
    v_permlane16_swap_b32 v81, v83
    v_permlane16_swap_b32 v84, v86
    v_permlane16_swap_b32 v85, v87
    v_add_f32 v80, v80, v82
    v_add_f32 v81, v81, v83
    v_add_f32 v84, v84, v86
    v_add_f32 v85, v85, v87
    s_mov_b64 exec, 0xffff
    buffer_store_dwordx2 v[80:81], v11, s[8:11], s52 offen offset:0 sc1
    buffer_store_dwordx2 v[84:85], v11, s[8:11], s52 offen offset:256 sc1
    s_mov_b64 exec, -1
    s_mul_i32 s43, s57, 22528
    s_add_u32 s43, s43, s49
    s_branch Lawo_head
Lawo_none:
    ds_read_b32 v15, v184
    s_waitcnt lgkmcnt(0)
    v_readfirstlane_b32 s17, v15
    s_nop 0
    s_cmp_lt_i32 s17, s37
    s_cbranch_scc1 Lawo_nopost
    s_add_u32 m0, s59, 0
    s_add_u32 s47, s41, 0
    buffer_load_dwordx4 v0, s[8:11], s47 offen offset:0 lds
    buffer_load_dwordx4 v0, s[8:11], s47 offen offset:1024 lds
    buffer_load_dwordx4 v0, s[8:11], s47 offen offset:2048 lds
    buffer_load_dwordx4 v0, s[8:11], s47 offen offset:3072 lds
    s_add_u32 m0, s59, 4096
    s_add_u32 s47, s41, 4096
    buffer_load_dwordx4 v0, s[8:11], s47 offen offset:0 lds
    buffer_load_dwordx4 v0, s[8:11], s47 offen offset:1024 lds
    buffer_load_dwordx4 v0, s[8:11], s47 offen offset:2048 lds
    buffer_load_dwordx4 v0, s[8:11], s47 offen offset:3072 lds
    s_add_u32 m0, s59, 8192
    s_add_u32 s47, s41, 8192
    buffer_load_dwordx4 v0, s[8:11], s47 offen offset:0 lds
    s_mul_i32 s48, s36, 4718592
    s_mul_i32 s18, s37, 36864
    s_add_u32 s48, s48, s18
    s_add_u32 s48, s48, 6291456
    buffer_load_dwordx4 v[64:67], v10, s[8:11], s48 offen offset:0
    buffer_load_dwordx2 v[68:69], v12, s[8:11], s48 offen offset:0
    buffer_load_dwordx4 v[72:75], v10, s[8:11], s48 offen offset:256
    buffer_load_dwordx2 v[76:77], v12, s[8:11], s48 offen offset:256
    s_waitcnt vmcnt(13)
    s_cmp_lg_u32 s43, 0
    s_cselect_b64 exec, 1, 0
    buffer_store_dword v3, v4, s[8:11], s43 offen sc1
    s_mov_b64 exec, -1
    s_mov_b32 s43, 0
    s_waitcnt vmcnt(1) lgkmcnt(0)
    s_branch Lawo_head2
Lawo_nopost:
    s_waitcnt vmcnt(0)
    s_cmp_lg_u32 s43, 0
    s_cselect_b64 exec, 1, 0
    buffer_store_dword v3, v4, s[8:11], s43 offen sc1
    s_mov_b64 exec, -1
    s_mov_b32 s43, 0
    s_cmp_ge_u32 s37, 64
    s_cbranch_scc1 Lawo_end
Lawo_wait:
    s_mov_b32 s16, 0
    s_cmp_lg_u32 s14, 0
    s_cbranch_scc1 Lawo_wl
Lawo_wp:
    buffer_load_dword v2, v1, s[8:11], s60 offen sc1
    s_add_u32 s16, s16, 1
    s_cmp_gt_u32 s16, 100000
    s_cbranch_scc1 Lawo_giveup
    s_waitcnt vmcnt(0)
    v_cmp_eq_u32 vcc, 0, v2
    s_nop 0
    s_cbranch_vccz Lawo_wok
    s_sleep 4
    s_branch Lawo_wp
Lawo_giveup:
    v_mov_b32 v5, -2
    ds_write_b32 v184, v5
    s_waitcnt lgkmcnt(0)
    s_branch L_role_awo_abort
Lawo_wok:
    v_mov_b32 v5, s37
    ds_write_b32 v184, v5
    s_branch Lawo_go
Lawo_wl:
    ds_read_b32 v15, v184
    s_add_u32 s16, s16, 1
    s_cmp_gt_u32 s16, 1600000
    s_cbranch_scc1 L_role_awo_abort
    s_waitcnt lgkmcnt(0)
    v_readfirstlane_b32 s17, v15
    s_nop 0
    s_cmp_eq_u32 s17, -2
    s_cbranch_scc1 L_role_awo_abort
    s_cmp_ge_i32 s17, s37
    s_cbranch_scc1 Lawo_go
    s_sleep 1
    s_branch Lawo_wl
Lawo_go:
    s_add_u32 m0, s59, 0
    s_add_u32 s47, s41, 0
    buffer_load_dwordx4 v0, s[8:11], s47 offen offset:0 lds
    buffer_load_dwordx4 v0, s[8:11], s47 offen offset:1024 lds
    buffer_load_dwordx4 v0, s[8:11], s47 offen offset:2048 lds
    buffer_load_dwordx4 v0, s[8:11], s47 offen offset:3072 lds
    s_add_u32 m0, s59, 4096
    s_add_u32 s47, s41, 4096
    buffer_load_dwordx4 v0, s[8:11], s47 offen offset:0 lds
    buffer_load_dwordx4 v0, s[8:11], s47 offen offset:1024 lds
    buffer_load_dwordx4 v0, s[8:11], s47 offen offset:2048 lds
    buffer_load_dwordx4 v0, s[8:11], s47 offen offset:3072 lds
    s_add_u32 m0, s59, 8192
    s_add_u32 s47, s41, 8192
    buffer_load_dwordx4 v0, s[8:11], s47 offen offset:0 lds
    s_mul_i32 s48, s36, 4718592
    s_mul_i32 s18, s37, 36864
    s_add_u32 s48, s48, s18
    s_add_u32 s48, s48, 6291456
    buffer_load_dwordx4 v[64:67], v10, s[8:11], s48 offen offset:0
    buffer_load_dwordx2 v[68:69], v12, s[8:11], s48 offen offset:0
    buffer_load_dwordx4 v[72:75], v10, s[8:11], s48 offen offset:256
    buffer_load_dwordx2 v[76:77], v12, s[8:11], s48 offen offset:256
    s_waitcnt vmcnt(0) lgkmcnt(0)
    s_branch Lawo_head2
Lawo_end:
    s_branch L_role_awo_exit
L_role_awo_abort:
    s_waitcnt lgkmcnt(0)
    s_mov_b64 exec, -1
    v_mov_b32 v0, 60
    s_lshl_b32 s5, s3, 8
    s_or_b32 s5, s5, s4
    s_or_b32 s5, s5, 0x10000
    v_mov_b32 v1, s5
    global_store_dword v0, v1, s[12:13]
    s_endpgm
L_role_awo_exit:
    s_endpgm
.p2align 6
L_role_aq:
    v_and_b32 v5, 63, v0
    v_lshlrev_b32 v0, 4, v5
    v_and_b32 v7, 15, v5
    v_lshrrev_b32 v8, 4, v5
    v_min_u32 v1, 47, v5
    v_lshrrev_b32 v6, 2, v1
    v_and_b32 v1, 3, v1
    v_lshlrev_b32 v1, 2, v1
    v_lshl_add_u32 v1, v6, 7, v1
    v_mov_b32 v3, 1
    v_mov_b32 v4, 0
    s_mov_b32 s44, 0x05040100
    s_mov_b32 s45, 0x07060302
    s_lshr_b32 s63, s15, 4
    s_and_b32 s15, s15, 15
    s_lshr_b32 s50, s15, 1
    s_lshl_b32 s50, s50, 2
    s_and_b32 s17, s15, 1
    s_add_u32 s50, s50, s17
    s_and_b32 s17, s14, 2
    s_add_u32 s50, s50, s17
    s_and_b32 s51, s14, 1
    s_cmp_eq_u32 s63, 0
    s_cbranch_scc1 Laq_gate_ng
    s_cmp_lg_u32 s14, 0
    s_cbranch_scc1 Laq_gate_d
    v_mov_b32 v5, 48
    s_mov_b32 s16, 0
Laq_gate:
    global_load_dword v6, v5, s[12:13] sc1
    s_add_u32 s16, s16, 1
    s_cmp_gt_u32 s16, 100000
    s_cbranch_scc1 L_role_aq_abort
    s_waitcnt vmcnt(0)
    v_cmp_gt_u32 vcc, 32, v6
    s_nop 0
    s_cbranch_vccz Laq_gate_d
    s_sleep 100
    s_branch Laq_gate
Laq_gate_d:
    s_barrier
Laq_gate_ng:
    s_load_dwordx2 s[20:21], s[0:1], 8
    s_mov_b32 s22, 1990656
    s_mov_b32 s23, 0x00020000
    s_waitcnt lgkmcnt(0)
    s_and_b32 s21, s21, 0xffff
    v_lshrrev_b32 v5, 7, v0
    v_mul_u32_u24 v16, 3456, v5
    v_and_b32 v5, 0x70, v0
    v_add_u32 v16, v16, v5
    s_lshr_b32 s17, s14, 1
    s_mul_i32 s46, s17, 72
    v_lshrrev_b32 v5, 2, v7
    v_lshl_add_u32 v5, v8, 3, v5
    v_and_b32 v6, 3, v7
    v_lshlrev_b32 v17, 7, v5
    v_lshl_add_u32 v17, v6, 3, v17
    v_add_u32 v17, s46, v17
    v_lshlrev_b32 v18, 5, v5
    v_min_u32 v6, 1, v6
    v_lshl_add_u32 v18, v6, 4, v18
    s_mul_i32 s17, s17, 3072
    s_add_u32 s17, s17, 36864
    v_add_u32 v18, s17, v18
    s_sub_u32 s17, s50, s14
    s_lshr_b32 s17, s14, 1
    s_lshl_b32 s17, s17, 1
    s_sub_u32 s17, s50, s17
    s_mul_i32 s49, s17, 36
    s_mul_i32 s17, s14, 82944
    s_add_u32 s49, s49, s17
    s_mul_i32 s47, s14, 3072
    v_lshrrev_b32 v21, 4, v0
    s_lshl_b32 s17, s14, 6
    v_add_u32 v21, s17, v21
    v_cmp_le_u32 vcc, 96, v21
    s_nop 1
    v_cndmask_b32 v5, 0, 1, vcc
    v_mul_u32_u24 v6, 96, v5
    v_sub_u32 v6, v21, v6
    v_lshlrev_b32 v19, 7, v6
    v_mul_u32_u24 v20, 72, v5
    v_add_u32 v19, v19, v20
    v_add_u32 v19, 32, v19
    v_lshlrev_b32 v20, 5, v21
    v_add_u32 v20, 36864, v20
    v_mov_b32 v24, 0
    v_mov_b32 v25, 0
    v_mov_b32 v26, 0
    v_mov_b32 v27, 0
    v_mov_b32 v31, 0
    s_cmp_eq_u32 s14, 3
    s_cselect_b64 s[76:77], 0, -1
    s_mov_b64 exec, s[76:77]
    v_add_u32 v22, 0, v20
    ds_write_b128 v22, v[24:27] offset:16
    v_add_u32 v22, 43008, v20
    ds_write_b128 v22, v[24:27] offset:16
    v_add_u32 v22, 86016, v20
    ds_write_b128 v22, v[24:27] offset:16
    s_mov_b64 exec, -1
    s_add_u32 m0, s47, 0
    s_add_u32 s17, s49, 0
    buffer_load_dwordx4 v16, s[20:23], s17 offen lds
    s_add_u32 m0, s47, 1024
    s_add_u32 s17, s49, 27648
    buffer_load_dwordx4 v16, s[20:23], s17 offen lds
    s_add_u32 m0, s47, 2048
    s_add_u32 s17, s49, 55296
    buffer_load_dwordx4 v16, s[20:23], s17 offen lds
    s_add_u32 m0, s47, 12288
    s_add_u32 s17, s49, 1152
    buffer_load_dwordx4 v16, s[20:23], s17 offen lds
    s_add_u32 m0, s47, 13312
    s_add_u32 s17, s49, 28800
    buffer_load_dwordx4 v16, s[20:23], s17 offen lds
    s_add_u32 m0, s47, 14336
    s_add_u32 s17, s49, 56448
    buffer_load_dwordx4 v16, s[20:23], s17 offen lds
    s_add_u32 m0, s47, 24576
    s_add_u32 s17, s49, 2304
    buffer_load_dwordx4 v16, s[20:23], s17 offen lds
    s_add_u32 m0, s47, 25600
    s_add_u32 s17, s49, 29952
    buffer_load_dwordx4 v16, s[20:23], s17 offen lds
    s_add_u32 m0, s47, 26624
    s_add_u32 s17, s49, 57600
    buffer_load_dwordx4 v16, s[20:23], s17 offen lds
    s_add_u32 m0, s47, 43008
    s_add_u32 s17, s49, 331776
    buffer_load_dwordx4 v16, s[20:23], s17 offen lds
    s_add_u32 m0, s47, 44032
    s_add_u32 s17, s49, 359424
    buffer_load_dwordx4 v16, s[20:23], s17 offen lds
    s_add_u32 m0, s47, 45056
    s_add_u32 s17, s49, 387072
    buffer_load_dwordx4 v16, s[20:23], s17 offen lds
    s_add_u32 m0, s47, 55296
    s_add_u32 s17, s49, 332928
    buffer_load_dwordx4 v16, s[20:23], s17 offen lds
    s_add_u32 m0, s47, 56320
    s_add_u32 s17, s49, 360576
    buffer_load_dwordx4 v16, s[20:23], s17 offen lds
    s_add_u32 m0, s47, 57344
    s_add_u32 s17, s49, 388224
    buffer_load_dwordx4 v16, s[20:23], s17 offen lds
    s_add_u32 m0, s47, 67584
    s_add_u32 s17, s49, 334080
    buffer_load_dwordx4 v16, s[20:23], s17 offen lds
    s_add_u32 m0, s47, 68608
    s_add_u32 s17, s49, 361728
    buffer_load_dwordx4 v16, s[20:23], s17 offen lds
    s_add_u32 m0, s47, 69632
    s_add_u32 s17, s49, 389376
    buffer_load_dwordx4 v16, s[20:23], s17 offen lds
    s_add_u32 m0, s47, 86016
    s_add_u32 s17, s49, 663552
    buffer_load_dwordx4 v16, s[20:23], s17 offen lds
    s_add_u32 m0, s47, 87040
    s_add_u32 s17, s49, 691200
    buffer_load_dwordx4 v16, s[20:23], s17 offen lds
    s_add_u32 m0, s47, 88064
    s_add_u32 s17, s49, 718848
    buffer_load_dwordx4 v16, s[20:23], s17 offen lds
    s_add_u32 m0, s47, 98304
    s_add_u32 s17, s49, 664704
    buffer_load_dwordx4 v16, s[20:23], s17 offen lds
    s_add_u32 m0, s47, 99328
    s_add_u32 s17, s49, 692352
    buffer_load_dwordx4 v16, s[20:23], s17 offen lds
    s_add_u32 m0, s47, 100352
    s_add_u32 s17, s49, 720000
    buffer_load_dwordx4 v16, s[20:23], s17 offen lds
    s_add_u32 m0, s47, 110592
    s_add_u32 s17, s49, 665856
    buffer_load_dwordx4 v16, s[20:23], s17 offen lds
    s_add_u32 m0, s47, 111616
    s_add_u32 s17, s49, 693504
    buffer_load_dwordx4 v16, s[20:23], s17 offen lds
    s_add_u32 m0, s47, 112640
    s_add_u32 s17, s49, 721152
    buffer_load_dwordx4 v16, s[20:23], s17 offen lds
    s_waitcnt vmcnt(18) lgkmcnt(0)
    s_barrier
    s_mov_b64 exec, s[76:77]
    v_add_u32 v22, 0, v19
    ds_read_b32 v28, v22 offset:0
    ds_read_b32 v29, v22 offset:12288
    ds_read_b32 v30, v22 offset:24576
    s_waitcnt lgkmcnt(0)
    v_add_u32 v22, 0, v20
    ds_write_b128 v22, v[28:31]
    s_mov_b64 exec, -1
    v_add_u32 v22, 0, v17
    v_add_u32 v23, 0, v18
    ds_read_b64_tr_b16 v[152:153], v22 offset:0
    ds_read_b64_tr_b16 v[154:155], v22 offset:512
    ds_read_b64_tr_b16 v[224:225], v22 offset:12288
    ds_read_b64_tr_b16 v[226:227], v22 offset:12800
    ds_read_b64_tr_b16 a[112:113], v22 offset:24576
    ds_read_b64_tr_b16 a[114:115], v22 offset:25088
    ds_read_b64_tr_b16 v[156:157], v22 offset:4096
    ds_read_b64_tr_b16 v[158:159], v22 offset:4608
    ds_read_b64_tr_b16 v[228:229], v22 offset:16384
    ds_read_b64_tr_b16 v[230:231], v22 offset:16896
    ds_read_b64_tr_b16 a[116:117], v22 offset:28672
    ds_read_b64_tr_b16 a[118:119], v22 offset:29184
    ds_read_b64_tr_b16 v[160:161], v22 offset:8192
    ds_read_b64_tr_b16 v[162:163], v22 offset:8704
    ds_read_b64_tr_b16 v[232:233], v22 offset:20480
    ds_read_b64_tr_b16 v[234:235], v22 offset:20992
    ds_read_b64_tr_b16 a[120:121], v22 offset:32768
    ds_read_b64_tr_b16 a[122:123], v22 offset:33280
    s_waitcnt lgkmcnt(0)
    s_barrier
    ds_read_b64_tr_b16 a[40:41], v23 offset:0
    ds_read_b64_tr_b16 a[42:43], v23 offset:128
    ds_read_b64_tr_b16 a[184:185], v23 offset:8
    ds_read_b64_tr_b16 a[186:187], v23 offset:136
    ds_read_b64_tr_b16 a[44:45], v23 offset:1024
    ds_read_b64_tr_b16 a[46:47], v23 offset:1152
    ds_read_b64_tr_b16 a[188:189], v23 offset:1032
    ds_read_b64_tr_b16 a[190:191], v23 offset:1160
    ds_read_b64_tr_b16 a[48:49], v23 offset:2048
    ds_read_b64_tr_b16 a[50:51], v23 offset:2176
    ds_read_b64_tr_b16 a[192:193], v23 offset:2056
    ds_read_b64_tr_b16 a[194:195], v23 offset:2184
    s_waitcnt vmcnt(9) lgkmcnt(0)
    s_barrier
    s_add_u32 m0, s47, 0
    s_add_u32 s17, s49, 995328
    buffer_load_dwordx4 v16, s[20:23], s17 offen lds
    s_add_u32 m0, s47, 1024
    s_add_u32 s17, s49, 1022976
    buffer_load_dwordx4 v16, s[20:23], s17 offen lds
    s_add_u32 m0, s47, 2048
    s_add_u32 s17, s49, 1050624
    buffer_load_dwordx4 v16, s[20:23], s17 offen lds
    s_add_u32 m0, s47, 12288
    s_add_u32 s17, s49, 996480
    buffer_load_dwordx4 v16, s[20:23], s17 offen lds
    s_add_u32 m0, s47, 13312
    s_add_u32 s17, s49, 1024128
    buffer_load_dwordx4 v16, s[20:23], s17 offen lds
    s_add_u32 m0, s47, 14336
    s_add_u32 s17, s49, 1051776
    buffer_load_dwordx4 v16, s[20:23], s17 offen lds
    s_add_u32 m0, s47, 24576
    s_add_u32 s17, s49, 997632
    buffer_load_dwordx4 v16, s[20:23], s17 offen lds
    s_add_u32 m0, s47, 25600
    s_add_u32 s17, s49, 1025280
    buffer_load_dwordx4 v16, s[20:23], s17 offen lds
    s_add_u32 m0, s47, 26624
    s_add_u32 s17, s49, 1052928
    buffer_load_dwordx4 v16, s[20:23], s17 offen lds
    s_mov_b64 exec, s[76:77]
    v_add_u32 v22, 43008, v19
    ds_read_b32 v28, v22 offset:0
    ds_read_b32 v29, v22 offset:12288
    ds_read_b32 v30, v22 offset:24576
    s_waitcnt lgkmcnt(0)
    v_add_u32 v22, 43008, v20
    ds_write_b128 v22, v[28:31]
    s_mov_b64 exec, -1
    v_add_u32 v22, 43008, v17
    v_add_u32 v23, 43008, v18
    ds_read_b64_tr_b16 v[164:165], v22 offset:0
    ds_read_b64_tr_b16 v[166:167], v22 offset:512
    ds_read_b64_tr_b16 v[236:237], v22 offset:12288
    ds_read_b64_tr_b16 v[238:239], v22 offset:12800
    ds_read_b64_tr_b16 a[124:125], v22 offset:24576
    ds_read_b64_tr_b16 a[126:127], v22 offset:25088
    ds_read_b64_tr_b16 v[168:169], v22 offset:4096
    ds_read_b64_tr_b16 v[170:171], v22 offset:4608
    ds_read_b64_tr_b16 v[240:241], v22 offset:16384
    ds_read_b64_tr_b16 v[242:243], v22 offset:16896
    ds_read_b64_tr_b16 a[128:129], v22 offset:28672
    ds_read_b64_tr_b16 a[130:131], v22 offset:29184
    ds_read_b64_tr_b16 v[172:173], v22 offset:8192
    ds_read_b64_tr_b16 v[174:175], v22 offset:8704
    ds_read_b64_tr_b16 v[244:245], v22 offset:20480
    ds_read_b64_tr_b16 v[246:247], v22 offset:20992
    ds_read_b64_tr_b16 a[132:133], v22 offset:32768
    ds_read_b64_tr_b16 a[134:135], v22 offset:33280
    s_waitcnt lgkmcnt(0)
    s_barrier
    ds_read_b64_tr_b16 a[52:53], v23 offset:0
    ds_read_b64_tr_b16 a[54:55], v23 offset:128
    ds_read_b64_tr_b16 a[196:197], v23 offset:8
    ds_read_b64_tr_b16 a[198:199], v23 offset:136
    ds_read_b64_tr_b16 a[56:57], v23 offset:1024
    ds_read_b64_tr_b16 a[58:59], v23 offset:1152
    ds_read_b64_tr_b16 a[200:201], v23 offset:1032
    ds_read_b64_tr_b16 a[202:203], v23 offset:1160
    ds_read_b64_tr_b16 a[60:61], v23 offset:2048
    ds_read_b64_tr_b16 a[62:63], v23 offset:2176
    ds_read_b64_tr_b16 a[204:205], v23 offset:2056
    ds_read_b64_tr_b16 a[206:207], v23 offset:2184
    s_waitcnt vmcnt(9) lgkmcnt(0)
    s_barrier
    s_add_u32 m0, s47, 43008
    s_add_u32 s17, s49, 1327104
    buffer_load_dwordx4 v16, s[20:23], s17 offen lds
    s_add_u32 m0, s47, 44032
    s_add_u32 s17, s49, 1354752
    buffer_load_dwordx4 v16, s[20:23], s17 offen lds
    s_add_u32 m0, s47, 45056
    s_add_u32 s17, s49, 1382400
    buffer_load_dwordx4 v16, s[20:23], s17 offen lds
    s_add_u32 m0, s47, 55296
    s_add_u32 s17, s49, 1328256
    buffer_load_dwordx4 v16, s[20:23], s17 offen lds
    s_add_u32 m0, s47, 56320
    s_add_u32 s17, s49, 1355904
    buffer_load_dwordx4 v16, s[20:23], s17 offen lds
    s_add_u32 m0, s47, 57344
    s_add_u32 s17, s49, 1383552
    buffer_load_dwordx4 v16, s[20:23], s17 offen lds
    s_add_u32 m0, s47, 67584
    s_add_u32 s17, s49, 1329408
    buffer_load_dwordx4 v16, s[20:23], s17 offen lds
    s_add_u32 m0, s47, 68608
    s_add_u32 s17, s49, 1357056
    buffer_load_dwordx4 v16, s[20:23], s17 offen lds
    s_add_u32 m0, s47, 69632
    s_add_u32 s17, s49, 1384704
    buffer_load_dwordx4 v16, s[20:23], s17 offen lds
    s_mov_b64 exec, s[76:77]
    v_add_u32 v22, 86016, v19
    ds_read_b32 v28, v22 offset:0
    ds_read_b32 v29, v22 offset:12288
    ds_read_b32 v30, v22 offset:24576
    s_waitcnt lgkmcnt(0)
    v_add_u32 v22, 86016, v20
    ds_write_b128 v22, v[28:31]
    s_mov_b64 exec, -1
    v_add_u32 v22, 86016, v17
    v_add_u32 v23, 86016, v18
    ds_read_b64_tr_b16 v[176:177], v22 offset:0
    ds_read_b64_tr_b16 v[178:179], v22 offset:512
    ds_read_b64_tr_b16 v[248:249], v22 offset:12288
    ds_read_b64_tr_b16 v[250:251], v22 offset:12800
    ds_read_b64_tr_b16 a[136:137], v22 offset:24576
    ds_read_b64_tr_b16 a[138:139], v22 offset:25088
    ds_read_b64_tr_b16 v[180:181], v22 offset:4096
    ds_read_b64_tr_b16 v[182:183], v22 offset:4608
    ds_read_b64_tr_b16 v[252:253], v22 offset:16384
    ds_read_b64_tr_b16 v[254:255], v22 offset:16896
    ds_read_b64_tr_b16 a[140:141], v22 offset:28672
    ds_read_b64_tr_b16 a[142:143], v22 offset:29184
    ds_read_b64_tr_b16 v[184:185], v22 offset:8192
    ds_read_b64_tr_b16 v[186:187], v22 offset:8704
    ds_read_b64_tr_b16 a[0:1], v22 offset:20480
    ds_read_b64_tr_b16 a[2:3], v22 offset:20992
    ds_read_b64_tr_b16 a[144:145], v22 offset:32768
    ds_read_b64_tr_b16 a[146:147], v22 offset:33280
    s_waitcnt lgkmcnt(0)
    s_barrier
    ds_read_b64_tr_b16 a[64:65], v23 offset:0
    ds_read_b64_tr_b16 a[66:67], v23 offset:128
    ds_read_b64_tr_b16 a[208:209], v23 offset:8
    ds_read_b64_tr_b16 a[210:211], v23 offset:136
    ds_read_b64_tr_b16 a[68:69], v23 offset:1024
    ds_read_b64_tr_b16 a[70:71], v23 offset:1152
    ds_read_b64_tr_b16 a[212:213], v23 offset:1032
    ds_read_b64_tr_b16 a[214:215], v23 offset:1160
    ds_read_b64_tr_b16 a[72:73], v23 offset:2048
    ds_read_b64_tr_b16 a[74:75], v23 offset:2176
    ds_read_b64_tr_b16 a[216:217], v23 offset:2056
    ds_read_b64_tr_b16 a[218:219], v23 offset:2184
    s_waitcnt vmcnt(9) lgkmcnt(0)
    s_barrier
    s_add_u32 m0, s47, 86016
    s_add_u32 s17, s49, 1658880
    buffer_load_dwordx4 v16, s[20:23], s17 offen lds
    s_add_u32 m0, s47, 87040
    s_add_u32 s17, s49, 1686528
    buffer_load_dwordx4 v16, s[20:23], s17 offen lds
    s_add_u32 m0, s47, 88064
    s_add_u32 s17, s49, 1714176
    buffer_load_dwordx4 v16, s[20:23], s17 offen lds
    s_add_u32 m0, s47, 98304
    s_add_u32 s17, s49, 1660032
    buffer_load_dwordx4 v16, s[20:23], s17 offen lds
    s_add_u32 m0, s47, 99328
    s_add_u32 s17, s49, 1687680
    buffer_load_dwordx4 v16, s[20:23], s17 offen lds
    s_add_u32 m0, s47, 100352
    s_add_u32 s17, s49, 1715328
    buffer_load_dwordx4 v16, s[20:23], s17 offen lds
    s_add_u32 m0, s47, 110592
    s_add_u32 s17, s49, 1661184
    buffer_load_dwordx4 v16, s[20:23], s17 offen lds
    s_add_u32 m0, s47, 111616
    s_add_u32 s17, s49, 1688832
    buffer_load_dwordx4 v16, s[20:23], s17 offen lds
    s_add_u32 m0, s47, 112640
    s_add_u32 s17, s49, 1716480
    buffer_load_dwordx4 v16, s[20:23], s17 offen lds
    s_mov_b64 exec, s[76:77]
    v_add_u32 v22, 0, v19
    ds_read_b32 v28, v22 offset:0
    ds_read_b32 v29, v22 offset:12288
    ds_read_b32 v30, v22 offset:24576
    s_waitcnt lgkmcnt(0)
    v_add_u32 v22, 0, v20
    ds_write_b128 v22, v[28:31]
    s_mov_b64 exec, -1
    v_add_u32 v22, 0, v17
    v_add_u32 v23, 0, v18
    ds_read_b64_tr_b16 v[188:189], v22 offset:0
    ds_read_b64_tr_b16 v[190:191], v22 offset:512
    ds_read_b64_tr_b16 a[4:5], v22 offset:12288
    ds_read_b64_tr_b16 a[6:7], v22 offset:12800
    ds_read_b64_tr_b16 a[148:149], v22 offset:24576
    ds_read_b64_tr_b16 a[150:151], v22 offset:25088
    ds_read_b64_tr_b16 v[192:193], v22 offset:4096
    ds_read_b64_tr_b16 v[194:195], v22 offset:4608
    ds_read_b64_tr_b16 a[8:9], v22 offset:16384
    ds_read_b64_tr_b16 a[10:11], v22 offset:16896
    ds_read_b64_tr_b16 a[152:153], v22 offset:28672
    ds_read_b64_tr_b16 a[154:155], v22 offset:29184
    ds_read_b64_tr_b16 v[196:197], v22 offset:8192
    ds_read_b64_tr_b16 v[198:199], v22 offset:8704
    ds_read_b64_tr_b16 a[12:13], v22 offset:20480
    ds_read_b64_tr_b16 a[14:15], v22 offset:20992
    ds_read_b64_tr_b16 a[156:157], v22 offset:32768
    ds_read_b64_tr_b16 a[158:159], v22 offset:33280
    s_waitcnt lgkmcnt(0)
    s_barrier
    ds_read_b64_tr_b16 a[76:77], v23 offset:0
    ds_read_b64_tr_b16 a[78:79], v23 offset:128
    ds_read_b64_tr_b16 a[220:221], v23 offset:8
    ds_read_b64_tr_b16 a[222:223], v23 offset:136
    ds_read_b64_tr_b16 a[80:81], v23 offset:1024
    ds_read_b64_tr_b16 a[82:83], v23 offset:1152
    ds_read_b64_tr_b16 a[224:225], v23 offset:1032
    ds_read_b64_tr_b16 a[226:227], v23 offset:1160
    ds_read_b64_tr_b16 a[84:85], v23 offset:2048
    ds_read_b64_tr_b16 a[86:87], v23 offset:2176
    ds_read_b64_tr_b16 a[228:229], v23 offset:2056
    ds_read_b64_tr_b16 a[230:231], v23 offset:2184
    s_waitcnt vmcnt(9) lgkmcnt(0)
    s_barrier
    s_mov_b64 exec, s[76:77]
    v_add_u32 v22, 43008, v19
    ds_read_b32 v28, v22 offset:0
    ds_read_b32 v29, v22 offset:12288
    ds_read_b32 v30, v22 offset:24576
    s_waitcnt lgkmcnt(0)
    v_add_u32 v22, 43008, v20
    ds_write_b128 v22, v[28:31]
    s_mov_b64 exec, -1
    v_add_u32 v22, 43008, v17
    v_add_u32 v23, 43008, v18
    ds_read_b64_tr_b16 v[200:201], v22 offset:0
    ds_read_b64_tr_b16 v[202:203], v22 offset:512
    ds_read_b64_tr_b16 a[16:17], v22 offset:12288
    ds_read_b64_tr_b16 a[18:19], v22 offset:12800
    ds_read_b64_tr_b16 a[160:161], v22 offset:24576
    ds_read_b64_tr_b16 a[162:163], v22 offset:25088
    ds_read_b64_tr_b16 v[204:205], v22 offset:4096
    ds_read_b64_tr_b16 v[206:207], v22 offset:4608
    ds_read_b64_tr_b16 a[20:21], v22 offset:16384
    ds_read_b64_tr_b16 a[22:23], v22 offset:16896
    ds_read_b64_tr_b16 a[164:165], v22 offset:28672
    ds_read_b64_tr_b16 a[166:167], v22 offset:29184
    ds_read_b64_tr_b16 v[208:209], v22 offset:8192
    ds_read_b64_tr_b16 v[210:211], v22 offset:8704
    ds_read_b64_tr_b16 a[24:25], v22 offset:20480
    ds_read_b64_tr_b16 a[26:27], v22 offset:20992
    ds_read_b64_tr_b16 a[168:169], v22 offset:32768
    ds_read_b64_tr_b16 a[170:171], v22 offset:33280
    s_waitcnt lgkmcnt(0)
    s_barrier
    ds_read_b64_tr_b16 a[88:89], v23 offset:0
    ds_read_b64_tr_b16 a[90:91], v23 offset:128
    ds_read_b64_tr_b16 a[232:233], v23 offset:8
    ds_read_b64_tr_b16 a[234:235], v23 offset:136
    ds_read_b64_tr_b16 a[92:93], v23 offset:1024
    ds_read_b64_tr_b16 a[94:95], v23 offset:1152
    ds_read_b64_tr_b16 a[236:237], v23 offset:1032
    ds_read_b64_tr_b16 a[238:239], v23 offset:1160
    ds_read_b64_tr_b16 a[96:97], v23 offset:2048
    ds_read_b64_tr_b16 a[98:99], v23 offset:2176
    ds_read_b64_tr_b16 a[240:241], v23 offset:2056
    ds_read_b64_tr_b16 a[242:243], v23 offset:2184
    s_waitcnt vmcnt(0) lgkmcnt(0)
    s_barrier
    s_mov_b64 exec, s[76:77]
    v_add_u32 v22, 86016, v19
    ds_read_b32 v28, v22 offset:0
    ds_read_b32 v29, v22 offset:12288
    ds_read_b32 v30, v22 offset:24576
    s_waitcnt lgkmcnt(0)
    v_add_u32 v22, 86016, v20
    ds_write_b128 v22, v[28:31]
    s_mov_b64 exec, -1
    v_add_u32 v22, 86016, v17
    v_add_u32 v23, 86016, v18
    ds_read_b64_tr_b16 v[212:213], v22 offset:0
    ds_read_b64_tr_b16 v[214:215], v22 offset:512
    ds_read_b64_tr_b16 a[28:29], v22 offset:12288
    ds_read_b64_tr_b16 a[30:31], v22 offset:12800
    ds_read_b64_tr_b16 a[172:173], v22 offset:24576
    ds_read_b64_tr_b16 a[174:175], v22 offset:25088
    ds_read_b64_tr_b16 v[216:217], v22 offset:4096
    ds_read_b64_tr_b16 v[218:219], v22 offset:4608
    ds_read_b64_tr_b16 a[32:33], v22 offset:16384
    ds_read_b64_tr_b16 a[34:35], v22 offset:16896
    ds_read_b64_tr_b16 a[176:177], v22 offset:28672
    ds_read_b64_tr_b16 a[178:179], v22 offset:29184
    ds_read_b64_tr_b16 v[220:221], v22 offset:8192
    ds_read_b64_tr_b16 v[222:223], v22 offset:8704
    ds_read_b64_tr_b16 a[36:37], v22 offset:20480
    ds_read_b64_tr_b16 a[38:39], v22 offset:20992
    ds_read_b64_tr_b16 a[180:181], v22 offset:32768
    ds_read_b64_tr_b16 a[182:183], v22 offset:33280
    s_waitcnt lgkmcnt(0)
    s_barrier
    ds_read_b64_tr_b16 a[100:101], v23 offset:0
    ds_read_b64_tr_b16 a[102:103], v23 offset:128
    ds_read_b64_tr_b16 a[244:245], v23 offset:8
    ds_read_b64_tr_b16 a[246:247], v23 offset:136
    ds_read_b64_tr_b16 a[104:105], v23 offset:1024
    ds_read_b64_tr_b16 a[106:107], v23 offset:1152
    ds_read_b64_tr_b16 a[248:249], v23 offset:1032
    ds_read_b64_tr_b16 a[250:251], v23 offset:1160
    ds_read_b64_tr_b16 a[108:109], v23 offset:2048
    ds_read_b64_tr_b16 a[110:111], v23 offset:2176
    ds_read_b64_tr_b16 a[252:253], v23 offset:2056
    ds_read_b64_tr_b16 a[254:255], v23 offset:2184
    s_waitcnt lgkmcnt(0)
    s_barrier
    v_mov_b32 v56, 0x3f803f80
    v_mov_b32 v57, 0x3f803f80
    v_mov_b32 v58, 0x3f803f80
    v_mov_b32 v59, 0x3f803f80
    s_nop 1
    v_mfma_f32_16x16x32_bf16 v[36:39], v[152:155], v[56:59], 0
    v_mfma_f32_16x16x32_bf16 v[40:43], v[224:227], v[56:59], 0
    v_mfma_f32_16x16x32_bf16 v[44:47], a[40:43], v[56:59], 0
    v_mfma_f32_16x16x32_bf16 v[48:51], v[56:59], a[112:115], 0
    v_mfma_f32_16x16x32_bf16 v[52:55], v[56:59], a[184:187], 0
    v_mfma_f32_16x16x32_bf16 v[36:39], v[156:159], v[56:59], v[36:39]
    v_mfma_f32_16x16x32_bf16 v[40:43], v[228:231], v[56:59], v[40:43]
    v_mfma_f32_16x16x32_bf16 v[44:47], a[44:47], v[56:59], v[44:47]
    v_mfma_f32_16x16x32_bf16 v[48:51], v[56:59], a[116:119], v[48:51]
    v_mfma_f32_16x16x32_bf16 v[52:55], v[56:59], a[188:191], v[52:55]
    v_mfma_f32_16x16x32_bf16 v[36:39], v[160:163], v[56:59], v[36:39]
    v_mfma_f32_16x16x32_bf16 v[40:43], v[232:235], v[56:59], v[40:43]
    v_mfma_f32_16x16x32_bf16 v[44:47], a[48:51], v[56:59], v[44:47]
    v_mfma_f32_16x16x32_bf16 v[48:51], v[56:59], a[120:123], v[48:51]
    v_mfma_f32_16x16x32_bf16 v[52:55], v[56:59], a[192:195], v[52:55]
    v_mfma_f32_16x16x32_bf16 v[36:39], v[164:167], v[56:59], v[36:39]
    v_mfma_f32_16x16x32_bf16 v[40:43], v[236:239], v[56:59], v[40:43]
    v_mfma_f32_16x16x32_bf16 v[44:47], a[52:55], v[56:59], v[44:47]
    v_mfma_f32_16x16x32_bf16 v[48:51], v[56:59], a[124:127], v[48:51]
    v_mfma_f32_16x16x32_bf16 v[52:55], v[56:59], a[196:199], v[52:55]
    v_mfma_f32_16x16x32_bf16 v[36:39], v[168:171], v[56:59], v[36:39]
    v_mfma_f32_16x16x32_bf16 v[40:43], v[240:243], v[56:59], v[40:43]
    v_mfma_f32_16x16x32_bf16 v[44:47], a[56:59], v[56:59], v[44:47]
    v_mfma_f32_16x16x32_bf16 v[48:51], v[56:59], a[128:131], v[48:51]
    v_mfma_f32_16x16x32_bf16 v[52:55], v[56:59], a[200:203], v[52:55]
    v_mfma_f32_16x16x32_bf16 v[36:39], v[172:175], v[56:59], v[36:39]
    v_mfma_f32_16x16x32_bf16 v[40:43], v[244:247], v[56:59], v[40:43]
    v_mfma_f32_16x16x32_bf16 v[44:47], a[60:63], v[56:59], v[44:47]
    v_mfma_f32_16x16x32_bf16 v[48:51], v[56:59], a[132:135], v[48:51]
    v_mfma_f32_16x16x32_bf16 v[52:55], v[56:59], a[204:207], v[52:55]
    v_mfma_f32_16x16x32_bf16 v[36:39], v[176:179], v[56:59], v[36:39]
    v_mfma_f32_16x16x32_bf16 v[40:43], v[248:251], v[56:59], v[40:43]
    v_mfma_f32_16x16x32_bf16 v[44:47], a[64:67], v[56:59], v[44:47]
    v_mfma_f32_16x16x32_bf16 v[48:51], v[56:59], a[136:139], v[48:51]
    v_mfma_f32_16x16x32_bf16 v[52:55], v[56:59], a[208:211], v[52:55]
    v_mfma_f32_16x16x32_bf16 v[36:39], v[180:183], v[56:59], v[36:39]
    v_mfma_f32_16x16x32_bf16 v[40:43], v[252:255], v[56:59], v[40:43]
    v_mfma_f32_16x16x32_bf16 v[44:47], a[68:71], v[56:59], v[44:47]
    v_mfma_f32_16x16x32_bf16 v[48:51], v[56:59], a[140:143], v[48:51]
    v_mfma_f32_16x16x32_bf16 v[52:55], v[56:59], a[212:215], v[52:55]
    v_mfma_f32_16x16x32_bf16 v[36:39], v[184:187], v[56:59], v[36:39]
    v_mfma_f32_16x16x32_bf16 v[40:43], a[0:3], v[56:59], v[40:43]
    v_mfma_f32_16x16x32_bf16 v[44:47], a[72:75], v[56:59], v[44:47]
    v_mfma_f32_16x16x32_bf16 v[48:51], v[56:59], a[144:147], v[48:51]
    v_mfma_f32_16x16x32_bf16 v[52:55], v[56:59], a[216:219], v[52:55]
    v_mfma_f32_16x16x32_bf16 v[36:39], v[188:191], v[56:59], v[36:39]
    v_mfma_f32_16x16x32_bf16 v[40:43], a[4:7], v[56:59], v[40:43]
    v_mfma_f32_16x16x32_bf16 v[44:47], a[76:79], v[56:59], v[44:47]
    v_mfma_f32_16x16x32_bf16 v[48:51], v[56:59], a[148:151], v[48:51]
    v_mfma_f32_16x16x32_bf16 v[52:55], v[56:59], a[220:223], v[52:55]
    v_mfma_f32_16x16x32_bf16 v[36:39], v[192:195], v[56:59], v[36:39]
    v_mfma_f32_16x16x32_bf16 v[40:43], a[8:11], v[56:59], v[40:43]
    v_mfma_f32_16x16x32_bf16 v[44:47], a[80:83], v[56:59], v[44:47]
    v_mfma_f32_16x16x32_bf16 v[48:51], v[56:59], a[152:155], v[48:51]
    v_mfma_f32_16x16x32_bf16 v[52:55], v[56:59], a[224:227], v[52:55]
    v_mfma_f32_16x16x32_bf16 v[36:39], v[196:199], v[56:59], v[36:39]
    v_mfma_f32_16x16x32_bf16 v[40:43], a[12:15], v[56:59], v[40:43]
    v_mfma_f32_16x16x32_bf16 v[44:47], a[84:87], v[56:59], v[44:47]
    v_mfma_f32_16x16x32_bf16 v[48:51], v[56:59], a[156:159], v[48:51]
    v_mfma_f32_16x16x32_bf16 v[52:55], v[56:59], a[228:231], v[52:55]
    v_mfma_f32_16x16x32_bf16 v[36:39], v[200:203], v[56:59], v[36:39]
    v_mfma_f32_16x16x32_bf16 v[40:43], a[16:19], v[56:59], v[40:43]
    v_mfma_f32_16x16x32_bf16 v[44:47], a[88:91], v[56:59], v[44:47]
    v_mfma_f32_16x16x32_bf16 v[48:51], v[56:59], a[160:163], v[48:51]
    v_mfma_f32_16x16x32_bf16 v[52:55], v[56:59], a[232:235], v[52:55]
    v_mfma_f32_16x16x32_bf16 v[36:39], v[204:207], v[56:59], v[36:39]
    v_mfma_f32_16x16x32_bf16 v[40:43], a[20:23], v[56:59], v[40:43]
    v_mfma_f32_16x16x32_bf16 v[44:47], a[92:95], v[56:59], v[44:47]
    v_mfma_f32_16x16x32_bf16 v[48:51], v[56:59], a[164:167], v[48:51]
    v_mfma_f32_16x16x32_bf16 v[52:55], v[56:59], a[236:239], v[52:55]
    v_mfma_f32_16x16x32_bf16 v[36:39], v[208:211], v[56:59], v[36:39]
    v_mfma_f32_16x16x32_bf16 v[40:43], a[24:27], v[56:59], v[40:43]
    v_mfma_f32_16x16x32_bf16 v[44:47], a[96:99], v[56:59], v[44:47]
    v_mfma_f32_16x16x32_bf16 v[48:51], v[56:59], a[168:171], v[48:51]
    v_mfma_f32_16x16x32_bf16 v[52:55], v[56:59], a[240:243], v[52:55]
    v_mfma_f32_16x16x32_bf16 v[36:39], v[212:215], v[56:59], v[36:39]
    v_mfma_f32_16x16x32_bf16 v[40:43], a[28:31], v[56:59], v[40:43]
    v_mfma_f32_16x16x32_bf16 v[44:47], a[100:103], v[56:59], v[44:47]
    v_mfma_f32_16x16x32_bf16 v[48:51], v[56:59], a[172:175], v[48:51]
    v_mfma_f32_16x16x32_bf16 v[52:55], v[56:59], a[244:247], v[52:55]
    v_mfma_f32_16x16x32_bf16 v[36:39], v[216:219], v[56:59], v[36:39]
    v_mfma_f32_16x16x32_bf16 v[40:43], a[32:35], v[56:59], v[40:43]
    v_mfma_f32_16x16x32_bf16 v[44:47], a[104:107], v[56:59], v[44:47]
    v_mfma_f32_16x16x32_bf16 v[48:51], v[56:59], a[176:179], v[48:51]
    v_mfma_f32_16x16x32_bf16 v[52:55], v[56:59], a[248:251], v[52:55]
    v_mfma_f32_16x16x32_bf16 v[36:39], v[220:223], v[56:59], v[36:39]
    v_mfma_f32_16x16x32_bf16 v[40:43], a[36:39], v[56:59], v[40:43]
    v_mfma_f32_16x16x32_bf16 v[44:47], a[108:111], v[56:59], v[44:47]
    v_mfma_f32_16x16x32_bf16 v[48:51], v[56:59], a[180:183], v[48:51]
    v_mfma_f32_16x16x32_bf16 v[52:55], v[56:59], a[252:255], v[52:55]
    v_lshlrev_b32 v10, 5, v7
    s_lshl_b32 s17, s51, 4
    v_add_u32 v10, s17, v10
    v_mul_u32_u24 v6, 1536, v8
    v_add_u32 v10, v10, v6
    s_lshl_b32 s17, s14, 7
    s_add_u32 s17, s17, 73728
    v_lshl_add_u32 v11, v7, 3, s17
    v_lshl_add_u32 v12, v8, 5, s17
    v_lshlrev_b32 v13, 5, v7
    s_lshl_b32 s17, s51, 4
    v_add_u32 v13, s17, v13
    s_lshr_b32 s17, s50, 2
    s_add_u32 s17, s17, 64
    s_lshl_b32 s17, s17, 9
    s_and_b32 s18, s50, 3
    s_lshl_b32 s18, s18, 2
    s_add_u32 s17, s17, s18
    v_add_u32 v14, s17, v13
    v_lshrrev_b32 v5, 1, v8
    v_lshl_add_u32 v13, v5, 9, v13
    v_and_b32 v5, 1, v8
    v_lshl_add_u32 v13, v5, 3, v13
    s_lshl_b32 s17, s50, 10
    v_add_u32 v13, s17, v13
    s_lshl_b32 s49, s15, 7
    s_lshl_b32 s17, s14, 2
    s_add_u32 s49, s49, s17
    s_add_u32 s49, s49, 1536
    s_mov_b32 s52, 0x3eae1a93
    v_mov_b32 v6, 0xf149f2ca
    v_lshl_add_u32 v5, v8, 2, 0
    v_sub_u32 v5, v5, v7
    v_cmp_le_i32 vcc, 9, v5
    s_nop 1
    v_cndmask_b32 v72, v6, v4, vcc
    v_add_u32 v5, 7, v5
    v_cmp_ge_u32 vcc, 7, v5
    s_nop 1
    v_cndmask_b32 v76, v6, v4, vcc
    v_lshl_add_u32 v5, v8, 2, 1
    v_sub_u32 v5, v5, v7
    v_cmp_le_i32 vcc, 9, v5
    s_nop 1
    v_cndmask_b32 v73, v6, v4, vcc
    v_add_u32 v5, 7, v5
    v_cmp_ge_u32 vcc, 7, v5
    s_nop 1
    v_cndmask_b32 v77, v6, v4, vcc
    v_lshl_add_u32 v5, v8, 2, 2
    v_sub_u32 v5, v5, v7
    v_cmp_le_i32 vcc, 9, v5
    s_nop 1
    v_cndmask_b32 v74, v6, v4, vcc
    v_add_u32 v5, 7, v5
    v_cmp_ge_u32 vcc, 7, v5
    s_nop 1
    v_cndmask_b32 v78, v6, v4, vcc
    v_lshl_add_u32 v5, v8, 2, 3
    v_sub_u32 v5, v5, v7
    v_cmp_le_i32 vcc, 9, v5
    s_nop 1
    v_cndmask_b32 v75, v6, v4, vcc
    v_add_u32 v5, 7, v5
    v_cmp_ge_u32 vcc, 7, v5
    s_nop 1
    v_cndmask_b32 v79, v6, v4, vcc
    v_mov_b32 v112, 0
    v_mov_b32 v113, 0
    v_mov_b32 v114, 0
    v_mov_b32 v115, 0
    v_mov_b32 v136, 0
    v_mov_b32 v137, 0
    v_mov_b32 v138, 0
    v_mov_b32 v139, 0
    v_mov_b32 v140, 0
    v_mov_b32 v141, 0
    v_mov_b32 v142, 0
    v_mov_b32 v143, 0
    v_mov_b32 v116, 0x3f803f80
    v_mov_b32 v117, 0x3f803f80
    v_mov_b32 v118, 0x3f803f80
    v_mov_b32 v119, 0x3f803f80
    v_mov_b32 v131, 0
    v_mov_b32 v135, 0
    s_mov_b64 exec, 0xff
    v_lshrrev_b32 v6, 2, v0
    v_lshlrev_b32 v5, 5, v6
    v_and_b32 v5, 128, v5
    v_lshrrev_b32 v6, 1, v6
    v_and_or_b32 v5, v6, 12, v5
    s_mov_b32 s16, 0
Laq_pure:
    global_load_dword v6, v5, s[12:13] sc1
    s_add_u32 s16, s16, 1
    s_cmp_gt_u32 s16, 100000
    s_cbranch_scc1 L_role_aq_abort
    s_mov_b32 s6, 0
    s_waitcnt vmcnt(0)
    v_readlane_b32 s7, v6, 0
    s_nop 0
    s_add_u32 s6, s6, s7
    v_readlane_b32 s7, v6, 1
    s_nop 0
    s_add_u32 s6, s6, s7
    v_readlane_b32 s7, v6, 2
    s_nop 0
    s_add_u32 s6, s6, s7
    v_readlane_b32 s7, v6, 3
    s_nop 0
    s_add_u32 s6, s6, s7
    v_readlane_b32 s7, v6, 4
    s_nop 0
    s_add_u32 s6, s6, s7
    v_readlane_b32 s7, v6, 5
    s_nop 0
    s_add_u32 s6, s6, s7
    v_readlane_b32 s7, v6, 6
    s_nop 0
    s_add_u32 s6, s6, s7
    v_readlane_b32 s7, v6, 7
    s_nop 0
    s_add_u32 s6, s6, s7
    v_readlane_b32 s7, v6, s3
    s_nop 0
    s_cmp_ge_u32 s7, 32
    s_cselect_b32 s78, 0, -1
    s_cselect_b32 s6, 256, s6
    s_cmp_lt_u32 s6, 256
    s_cbranch_scc1 Laq_pure
    s_mov_b32 s79, s78
    s_mov_b64 exec, -1
    s_mov_b32 s36, s63
    s_mov_b32 s34, s63
    s_mul_i32 s58, s14, 9216
    s_mul_i32 s64, s63, 4718592
    s_add_u32 s64, s64, s58
    s_add_u32 s64, s64, 6291456
    s_mul_i32 s61, s63, 1441792
    s_add_u32 s61, s61, 0
    s_mov_b32 s37, 0
    s_mov_b32 s40, 36864
    s_mov_b32 s59, s58
    s_mov_b32 s43, 0
    s_mov_b32 s62, 1
    s_mov_b32 s28, s8
    s_mov_b32 s29, s9
    s_mov_b32 s30, 0
    s_mov_b32 s31, 0x00020000
    v_mov_b32 v110, 74752
    v_mov_b32 v5, -1
    ds_write_b32 v110, v5
    s_waitcnt lgkmcnt(0)
    s_cmp_lg_u32 s14, 0
    s_cbranch_scc1 Laq_inia_d
    v_mov_b32 v5, 40
    s_mov_b32 s16, 0
Laq_inia:
    global_load_dword v6, v5, s[12:13] sc1
    s_add_u32 s16, s16, 1
    s_cmp_gt_u32 s16, 100000
    s_cbranch_scc1 L_role_aq_abort
    s_waitcnt vmcnt(0)
    v_cmp_gt_u32 vcc, 128, v6
    s_nop 0
    s_cbranch_vccz Laq_inia_d
    s_sleep 8
    s_branch Laq_inia
Laq_inia_d:
    s_barrier
    s_cmp_eq_u32 s63, 0
    s_cbranch_scc1 Laq_ini_sk
    s_cmp_lg_u32 s14, 0
    s_cbranch_scc1 Laq_inib_d
    v_mov_b32 v5, 160
    s_mov_b32 s16, 0
Laq_inib:
    global_load_dword v6, v5, s[12:13] sc1
    s_add_u32 s16, s16, 1
    s_cmp_gt_u32 s16, 100000
    s_cbranch_scc1 L_role_aq_abort
    s_waitcnt vmcnt(0)
    v_cmp_gt_u32 vcc, 64, v6
    s_nop 0
    s_cbranch_vccz Laq_inib_d
    s_sleep 8
    s_branch Laq_inib
Laq_inib_d:
    s_barrier
Laq_ini_sk:
    s_mul_i32 s41, s37, 36864
    s_add_u32 s41, s41, s64
    s_mul_i32 s60, s37, 22528
    s_add_u32 s60, s60, s61
    s_cmp_lt_u32 s37, 64
    s_cselect_b32 s60, s60, 2883584
    s_branch Laq_wait
Laq_head:
    s_waitcnt vmcnt(4)
Laq_head2:
    s_barrier
    ds_read_b32 v15, v110
    s_xor_b32 s40, s40, 36864
    s_xor_b32 s59, s59, 36864
    s_mov_b32 s35, s37
    s_lshl_b32 s57, s34, 6
    s_add_u32 s57, s57, s35
    s_add_u32 s37, s37, 1
    s_mov_b32 s39, 0
    s_mov_b32 s54, 0
    s_mul_i32 s41, s37, 36864
    s_add_u32 s41, s41, s64
    s_mul_i32 s60, s37, 22528
    s_add_u32 s60, s60, s61
    s_cmp_lt_u32 s37, 64
    s_cselect_b32 s60, s60, 2883584
    v_lshlrev_b32 v9, 9, v8
    v_lshl_add_u32 v9, v7, 5, v9
    s_lshl_b32 s17, s51, 4
    s_add_u32 s17, s17, s40
    v_add_u32 v9, s17, v9
    ds_read_b128 v[56:59], v9 offset:0
    ds_read_b128 v[60:63], v9 offset:2048
    ds_read_b128 v[64:67], v9 offset:4096
    s_waitcnt lgkmcnt(2)
    v_mfma_f32_16x16x32_bf16 v[16:19], v[152:155], v[56:59], 0
    v_add_f32 v80, v80, v84
    v_mfma_f32_16x16x32_bf16 v[20:23], v[224:227], v[56:59], 0
    v_add_f32 v81, v81, v85
    v_mfma_f32_16x16x32_bf16 v[24:27], a[40:43], v[56:59], 0
    v_add_f32 v82, v82, v86
    ds_read_b128 v[56:59], v9 offset:6144
    s_waitcnt lgkmcnt(2)
    v_mfma_f32_16x16x32_bf16 v[16:19], v[156:159], v[60:63], v[16:19]
    v_add_f32 v83, v83, v87
    v_mfma_f32_16x16x32_bf16 v[20:23], v[228:231], v[60:63], v[20:23]
    v_add_f32 v80, v80, v88
    v_mfma_f32_16x16x32_bf16 v[24:27], a[44:47], v[60:63], v[24:27]
    v_add_f32 v81, v81, v89
    v_readfirstlane_b32 s17, v15
    s_nop 0
    s_add_u32 s18, s17, 1
    s_max_i32 s32, s18, s37
    s_add_u32 s39, s37, 1
    s_min_u32 s39, s39, 63
    s_mul_i32 s33, s32, 22528
    s_add_u32 s33, s33, s61
    s_cmp_eq_u32 s14, 0
    s_cselect_b32 s18, s32, 0x7fff
    v_mov_b32 v2, 2
    s_cmp_le_u32 s18, s39
    s_cselect_b64 exec, -1, 0
    buffer_load_dword v2, v1, s[8:11], s33 offen sc1
    s_mov_b64 exec, -1
    s_cmp_ge_i32 s17, s37
    s_cbranch_scc1 Laq_f_7
    ds_read_b128 v[60:63], v9 offset:8192
    s_waitcnt lgkmcnt(2)
    v_mfma_f32_16x16x32_bf16 v[16:19], v[160:163], v[64:67], v[16:19]
    v_add_f32 v82, v82, v90
    v_mfma_f32_16x16x32_bf16 v[20:23], v[232:235], v[64:67], v[20:23]
    v_add_f32 v83, v83, v91
    v_mfma_f32_16x16x32_bf16 v[24:27], a[48:51], v[64:67], v[24:27]
    v_add_f32 v80, v80, v82
    ds_read_b128 v[64:67], v9 offset:10240
    s_waitcnt lgkmcnt(2)
    v_mfma_f32_16x16x32_bf16 v[16:19], v[164:167], v[56:59], v[16:19]
    v_add_f32 v81, v81, v83
    v_mfma_f32_16x16x32_bf16 v[20:23], v[236:239], v[56:59], v[20:23]
    v_mov_b32 v82, v80
    v_mfma_f32_16x16x32_bf16 v[24:27], a[52:55], v[56:59], v[24:27]
    v_mov_b32 v83, v81
    ds_read_b128 v[56:59], v9 offset:12288
    s_waitcnt lgkmcnt(2)
    v_mfma_f32_16x16x32_bf16 v[16:19], v[168:171], v[60:63], v[16:19]
    v_permlane32_swap_b32 v80, v82
    v_mfma_f32_16x16x32_bf16 v[20:23], v[240:243], v[60:63], v[20:23]
    v_permlane32_swap_b32 v81, v83
    v_mfma_f32_16x16x32_bf16 v[24:27], a[56:59], v[60:63], v[24:27]
    v_add_f32 v80, v80, v82
    ds_read_b128 v[60:63], v9 offset:14336
    s_waitcnt lgkmcnt(2)
    v_mfma_f32_16x16x32_bf16 v[16:19], v[172:175], v[64:67], v[16:19]
    v_add_f32 v81, v81, v83
    v_mfma_f32_16x16x32_bf16 v[20:23], v[244:247], v[64:67], v[20:23]
    v_mov_b32 v82, v80
    v_mfma_f32_16x16x32_bf16 v[24:27], a[60:63], v[64:67], v[24:27]
    v_mov_b32 v83, v81
    s_waitcnt vmcnt(1)
    s_cmp_lg_u32 s43, 0
    s_cselect_b64 exec, 1, 0
    buffer_store_dword v3, v4, s[8:11], s43 offen
    s_and_b64 exec, exec, s[78:79]
    buffer_store_dword v3, v4, s[8:11], s43 offen sc1
    s_mov_b64 exec, -1
    s_mov_b32 s43, 0
    ds_read_b128 v[64:67], v9 offset:16384
    s_waitcnt lgkmcnt(2)
    v_mfma_f32_16x16x32_bf16 v[16:19], v[176:179], v[56:59], v[16:19]
    v_permlane16_swap_b32 v80, v82
    v_mfma_f32_16x16x32_bf16 v[20:23], v[248:251], v[56:59], v[20:23]
    v_permlane16_swap_b32 v81, v83
    v_mfma_f32_16x16x32_bf16 v[24:27], a[64:67], v[56:59], v[24:27]
    v_add_f32 v80, v80, v82
    ds_read_b128 v[56:59], v9 offset:18432
    s_waitcnt lgkmcnt(2)
    v_mfma_f32_16x16x32_bf16 v[16:19], v[180:183], v[60:63], v[16:19]
    v_add_f32 v81, v81, v83
    v_mfma_f32_16x16x32_bf16 v[20:23], v[252:255], v[60:63], v[20:23]
    v_mul_f32 v80, 0x3ae38e39, v80
    v_mfma_f32_16x16x32_bf16 v[24:27], a[68:71], v[60:63], v[24:27]
    v_mul_f32 v81, 0x3ae38e39, v81
    ds_read_b128 v[60:63], v9 offset:20480
    s_waitcnt lgkmcnt(2)
    v_mfma_f32_16x16x32_bf16 v[16:19], v[184:187], v[64:67], v[16:19]
    v_fma_f32 v81, -v80, v80, v81
    v_mfma_f32_16x16x32_bf16 v[20:23], a[0:3], v[64:67], v[20:23]
    v_max_f32 v81, 0, v81
    v_mfma_f32_16x16x32_bf16 v[24:27], a[72:75], v[64:67], v[24:27]
    v_add_f32 v81, 0x3727c5ac, v81
    ds_read_b128 v[64:67], v9 offset:22528
    s_waitcnt lgkmcnt(2)
    v_mfma_f32_16x16x32_bf16 v[16:19], v[188:191], v[56:59], v[16:19]
    v_rsq_f32 v92, v81
    v_mfma_f32_16x16x32_bf16 v[20:23], a[4:7], v[56:59], v[20:23]
    v_mul_f32 v93, v80, v92
    v_mfma_f32_16x16x32_bf16 v[24:27], a[76:79], v[56:59], v[24:27]
    ds_write_b64 v11, v[92:93]
    ds_read_b128 v[56:59], v9 offset:24576
    s_waitcnt lgkmcnt(3)
    v_mfma_f32_16x16x32_bf16 v[16:19], v[192:195], v[60:63], v[16:19]
    ds_read_b128 v[96:99], v12
    v_mfma_f32_16x16x32_bf16 v[20:23], a[8:11], v[60:63], v[20:23]
    ds_read_b128 v[100:103], v12 offset:16
    v_mfma_f32_16x16x32_bf16 v[24:27], a[80:83], v[60:63], v[24:27]
    ds_read_b128 v[60:63], v9 offset:26624
    s_waitcnt lgkmcnt(5)
    v_mfma_f32_16x16x32_bf16 v[16:19], v[196:199], v[64:67], v[16:19]
    v_mfma_f32_16x16x32_bf16 v[20:23], a[12:15], v[64:67], v[20:23]
    v_mfma_f32_16x16x32_bf16 v[24:27], a[84:87], v[64:67], v[24:27]
    ds_read_b128 v[64:67], v9 offset:28672
    s_waitcnt lgkmcnt(4)
    v_mfma_f32_16x16x32_bf16 v[16:19], v[200:203], v[56:59], v[16:19]
    v_mfma_f32_16x16x32_bf16 v[20:23], a[16:19], v[56:59], v[20:23]
    v_mfma_f32_16x16x32_bf16 v[24:27], a[88:91], v[56:59], v[24:27]
    ds_read_b128 v[56:59], v9 offset:30720
    s_waitcnt lgkmcnt(2)
    v_mfma_f32_16x16x32_bf16 v[16:19], v[204:207], v[60:63], v[16:19]
    v_mfma_f32_16x16x32_bf16 v[20:23], a[20:23], v[60:63], v[20:23]
    v_mfma_f32_16x16x32_bf16 v[24:27], a[92:95], v[60:63], v[24:27]
    ds_read_b128 v[60:63], v9 offset:32768
    s_waitcnt lgkmcnt(2)
    v_mfma_f32_16x16x32_bf16 v[16:19], v[208:211], v[64:67], v[16:19]
    v_mfma_f32_16x16x32_bf16 v[20:23], a[24:27], v[64:67], v[20:23]
    v_mfma_f32_16x16x32_bf16 v[24:27], a[96:99], v[64:67], v[24:27]
    ds_read_b128 v[64:67], v9 offset:34816
    s_waitcnt lgkmcnt(2)
    v_mfma_f32_16x16x32_bf16 v[16:19], v[212:215], v[56:59], v[16:19]
    v_cmp_eq_u32 s[76:77], 1, v2
    v_cmp_eq_u32 vcc, 2, v2
    v_mfma_f32_16x16x32_bf16 v[20:23], a[28:31], v[56:59], v[20:23]
    s_cmp_eq_u64 s[76:77], -1
    s_cselect_b32 s38, 1, 0
    v_mfma_f32_16x16x32_bf16 v[24:27], a[100:103], v[56:59], v[24:27]
    s_cmp_lg_u32 s38, 0
    s_cselect_b64 exec, 1, 0
    v_mov_b32 v15, s32
    ds_write_b32 v110, v15
    v_mov_b32 v2, 2
    s_mov_b64 exec, -1
    ds_read_b128 v[56:59], v9 offset:0
    s_waitcnt lgkmcnt(3)
    v_mfma_f32_16x16x32_bf16 v[16:19], v[216:219], v[60:63], v[16:19]
    s_add_u32 s32, s32, s38
    s_mul_i32 s38, s38, 22528
    s_add_u32 s33, s33, s38
    v_mfma_f32_16x16x32_bf16 v[20:23], a[32:35], v[60:63], v[20:23]
    s_cmp_eq_u64 vcc, 0
    s_cselect_b32 s38, s32, 0x7fff
    v_mfma_f32_16x16x32_bf16 v[24:27], a[104:107], v[60:63], v[24:27]
    s_cmp_le_u32 s38, s39
    s_cselect_b64 exec, -1, 0
    v_mov_b32 v2, 2
    buffer_load_dword v2, v1, s[8:11], s33 offen sc1
    s_mov_b64 exec, -1
    ds_read_b128 v[60:63], v9 offset:2048
    s_waitcnt lgkmcnt(3)
    v_mfma_f32_16x16x32_bf16 v[16:19], v[220:223], v[64:67], v[16:19]
    v_mfma_f32_16x16x32_bf16 v[20:23], a[36:39], v[64:67], v[20:23]
    v_mfma_f32_16x16x32_bf16 v[24:27], a[108:111], v[64:67], v[24:27]
    ds_read_b32 v15, v110
    ds_read_b128 v[64:67], v9 offset:4096
    s_waitcnt lgkmcnt(3)
    v_mfma_f32_16x16x32_bf16 v[28:31], v[56:59], a[112:115], 0
    v_mfma_f32_16x16x32_bf16 v[32:35], v[56:59], a[184:187], 0
    ds_read_b128 v[56:59], v9 offset:6144
    s_waitcnt lgkmcnt(3)
    v_mfma_f32_16x16x32_bf16 v[28:31], v[60:63], a[116:119], v[28:31]
    v_mul_f32 v94, v93, v36
    v_fma_f32 v16, v16, v92, -v94
    v_mfma_f32_16x16x32_bf16 v[32:35], v[60:63], a[188:191], v[32:35]
    v_mul_f32 v94, v93, v37
    v_fma_f32 v17, v17, v92, -v94
    s_waitcnt lgkmcnt(2)
    v_readfirstlane_b32 s17, v15
    s_nop 0
    s_cmp_ge_i32 s17, s37
    s_cbranch_scc1 Laq_f_8
    ds_read_b128 v[60:63], v9 offset:8192
    s_waitcnt lgkmcnt(2)
    v_mfma_f32_16x16x32_bf16 v[28:31], v[64:67], a[120:123], v[28:31]
    v_mul_f32 v94, v93, v38
    v_fma_f32 v18, v18, v92, -v94
    v_mfma_f32_16x16x32_bf16 v[32:35], v[64:67], a[192:195], v[32:35]
    v_mul_f32 v94, v93, v39
    v_fma_f32 v19, v19, v92, -v94
    ds_read_b128 v[64:67], v9 offset:10240
    s_waitcnt lgkmcnt(2)
    v_mfma_f32_16x16x32_bf16 v[28:31], v[56:59], a[124:127], v[28:31]
    v_mul_f32 v94, v93, v44
    v_fma_f32 v24, v24, v92, -v94
    v_mfma_f32_16x16x32_bf16 v[32:35], v[56:59], a[196:199], v[32:35]
    v_mul_f32 v94, v93, v45
    v_fma_f32 v25, v25, v92, -v94
    ds_read_b128 v[56:59], v9 offset:12288
    s_waitcnt lgkmcnt(2)
    v_mfma_f32_16x16x32_bf16 v[28:31], v[60:63], a[128:131], v[28:31]
    v_mul_f32 v94, v93, v46
    v_fma_f32 v26, v26, v92, -v94
    v_mfma_f32_16x16x32_bf16 v[32:35], v[60:63], a[200:203], v[32:35]
    v_mul_f32 v94, v93, v47
    v_fma_f32 v27, v27, v92, -v94
    ds_read_b128 v[60:63], v9 offset:14336
    s_waitcnt lgkmcnt(2)
    v_mfma_f32_16x16x32_bf16 v[28:31], v[64:67], a[132:135], v[28:31]
    v_mul_f32 v94, v93, v40
    v_fma_f32 v20, v20, v92, -v94
    v_mfma_f32_16x16x32_bf16 v[32:35], v[64:67], a[204:207], v[32:35]
    v_mul_f32 v94, v93, v41
    v_fma_f32 v21, v21, v92, -v94
    ds_read_b128 v[64:67], v9 offset:16384
    s_waitcnt lgkmcnt(2)
    v_mfma_f32_16x16x32_bf16 v[28:31], v[56:59], a[136:139], v[28:31]
    v_mul_f32 v94, v93, v42
    v_fma_f32 v22, v22, v92, -v94
    v_mfma_f32_16x16x32_bf16 v[32:35], v[56:59], a[208:211], v[32:35]
    v_mul_f32 v94, v93, v43
    v_fma_f32 v23, v23, v92, -v94
    ds_read_b128 v[56:59], v9 offset:18432
    s_waitcnt lgkmcnt(2)
    v_mfma_f32_16x16x32_bf16 v[28:31], v[60:63], a[140:143], v[28:31]
    v_cvt_pk_bf16_f32 v128, v16, v17
    v_cvt_pk_bf16_f32 v129, v18, v19
    v_mfma_f32_16x16x32_bf16 v[32:35], v[60:63], a[212:215], v[32:35]
    v_cvt_pk_bf16_f32 v130, v24, v25
    v_cvt_pk_bf16_f32 v132, v20, v21
    ds_read_b128 v[60:63], v9 offset:20480
    s_waitcnt lgkmcnt(2)
    v_mfma_f32_16x16x32_bf16 v[28:31], v[64:67], a[144:147], v[28:31]
    v_cvt_pk_bf16_f32 v133, v22, v23
    v_cvt_pk_bf16_f32 v134, v26, v27
    v_mfma_f32_16x16x32_bf16 v[32:35], v[64:67], a[216:219], v[32:35]
    s_cmp_eq_u32 s35, 0
    s_cselect_b32 s46, 0xf149f2ca, 0
    ds_read_b128 v[64:67], v9 offset:22528
    s_waitcnt lgkmcnt(2)
    v_mfma_f32_16x16x32_bf16 v[28:31], v[56:59], a[148:151], v[28:31]
    v_mfma_f32_16x16x32_bf16 v[144:147], v[112:115], v[128:131], 0
    v_mfma_f32_16x16x32_bf16 v[32:35], v[56:59], a[220:223], v[32:35]
    v_mfma_f32_16x16x32_bf16 v[148:151], v[132:135], v[128:131], 0
    ds_read_b128 v[56:59], v9 offset:24576
    s_waitcnt lgkmcnt(2)
    v_mfma_f32_16x16x32_bf16 v[28:31], v[60:63], a[152:155], v[28:31]
    v_mov_b32 v112, v132
    v_mfma_f32_16x16x32_bf16 v[32:35], v[60:63], a[224:227], v[32:35]
    v_mov_b32 v113, v133
    v_mov_b32 v114, v134
    ds_read_b128 v[60:63], v9 offset:26624
    s_waitcnt lgkmcnt(2)
    v_mfma_f32_16x16x32_bf16 v[28:31], v[64:67], a[156:159], v[28:31]
    v_mfma_f32_16x16x32_bf16 v[32:35], v[64:67], a[228:231], v[32:35]
    v_fma_f32 v144, v144, s52, v72
    ds_read_b128 v[64:67], v9 offset:28672
    s_waitcnt lgkmcnt(2)
    v_mfma_f32_16x16x32_bf16 v[28:31], v[56:59], a[160:163], v[28:31]
    v_fma_f32 v145, v145, s52, v73
    v_fma_f32 v146, v146, s52, v74
    v_fma_f32 v147, v147, s52, v75
    v_mfma_f32_16x16x32_bf16 v[32:35], v[56:59], a[232:235], v[32:35]
    v_fma_f32 v148, v148, s52, v76
    v_fma_f32 v149, v149, s52, v77
    v_fma_f32 v150, v150, s52, v78
    ds_read_b128 v[56:59], v9 offset:30720
    s_waitcnt lgkmcnt(2)
    v_mfma_f32_16x16x32_bf16 v[28:31], v[60:63], a[164:167], v[28:31]
    v_fma_f32 v151, v151, s52, v79
    v_add_f32 v144, s46, v144
    v_add_f32 v145, s46, v145
    v_mfma_f32_16x16x32_bf16 v[32:35], v[60:63], a[236:239], v[32:35]
    v_add_f32 v146, s46, v146
    v_add_f32 v147, s46, v147
    v_max3_f32 v5, v144, v145, v146
    ds_read_b128 v[60:63], v9 offset:32768
    s_waitcnt lgkmcnt(2)
    v_mfma_f32_16x16x32_bf16 v[28:31], v[64:67], a[168:171], v[28:31]
    v_max3_f32 v5, v5, v147, v148
    v_max3_f32 v5, v5, v149, v150
    v_max_f32 v5, v5, v151
    v_mfma_f32_16x16x32_bf16 v[32:35], v[64:67], a[240:243], v[32:35]
    v_mov_b32 v6, v5
    s_nop 1
    v_permlane32_swap_b32 v5, v6
    ds_read_b128 v[64:67], v9 offset:34816
    s_waitcnt lgkmcnt(2)
    v_mfma_f32_16x16x32_bf16 v[28:31], v[56:59], a[172:175], v[28:31]
    v_max_f32 v5, v5, v6
    v_mov_b32 v6, v5
    v_mfma_f32_16x16x32_bf16 v[32:35], v[56:59], a[244:247], v[32:35]
    s_nop 0
    v_permlane16_swap_b32 v5, v6
    v_max_f32 v5, v5, v6
    v_sub_f32 v144, v144, v5
    s_waitcnt lgkmcnt(1)
    v_mfma_f32_16x16x32_bf16 v[28:31], v[60:63], a[176:179], v[28:31]
    v_sub_f32 v145, v145, v5
    v_sub_f32 v146, v146, v5
    v_sub_f32 v147, v147, v5
    v_mfma_f32_16x16x32_bf16 v[32:35], v[60:63], a[248:251], v[32:35]
    v_sub_f32 v148, v148, v5
    v_sub_f32 v149, v149, v5
    v_sub_f32 v150, v150, v5
    s_waitcnt lgkmcnt(0)
    v_mfma_f32_16x16x32_bf16 v[28:31], v[64:67], a[180:183], v[28:31]
    v_sub_f32 v151, v151, v5
    v_exp_f32 v144, v144
    v_exp_f32 v145, v145
    v_mfma_f32_16x16x32_bf16 v[32:35], v[64:67], a[252:255], v[32:35]
    v_exp_f32 v146, v146
    v_exp_f32 v147, v147
    v_exp_f32 v148, v148
    v_cmp_eq_u32 s[76:77], 1, v2
    v_cmp_eq_u32 vcc, 2, v2
    s_cmp_eq_u64 s[76:77], -1
    s_cselect_b32 s38, 1, 0
    s_cmp_lg_u32 s38, 0
    s_cselect_b64 exec, 1, 0
    v_mov_b32 v15, s32
    ds_write_b32 v110, v15
    v_mov_b32 v2, 2
    s_mov_b64 exec, -1
    s_add_u32 s32, s32, s38
    s_mul_i32 s38, s38, 22528
    s_add_u32 s33, s33, s38
    s_cmp_eq_u64 vcc, 0
    s_cselect_b32 s38, s32, 0x7fff
    s_cmp_le_u32 s38, s39
    s_cselect_b64 exec, -1, 0
    v_mov_b32 v2, 2
    buffer_load_dword v2, v1, s[8:11], s33 offen sc1
    s_mov_b64 exec, -1
    v_exp_f32 v149, v149
    v_exp_f32 v150, v150
    v_exp_f32 v151, v151
    v_cvt_pk_bf16_f32 v68, v144, v145
    v_cvt_pk_bf16_f32 v69, v146, v147
    v_cvt_pk_bf16_f32 v70, v148, v149
    v_cvt_pk_bf16_f32 v71, v150, v151
    s_nop 1
    v_mfma_f32_16x16x32_bf16 v[16:19], v[116:119], v[68:71], 0
    s_mul_i32 s46, s57, 36864
    s_add_u32 s46, s46, 17301504
    s_nop 5
    v_rcp_f32 v6, v16
    v_mul_f32 v94, v97, v48
    v_fma_f32 v28, v28, v96, -v94
    v_mul_f32 v94, v99, v49
    v_fma_f32 v29, v29, v98, -v94
    v_mul_f32 v94, v101, v50
    v_fma_f32 v30, v30, v100, -v94
    v_mul_f32 v94, v103, v51
    v_fma_f32 v31, v31, v102, -v94
    v_cvt_pk_bf16_f32 v138, v28, v29
    v_cvt_pk_bf16_f32 v139, v30, v31
    v_mul_f32 v94, v97, v52
    v_fma_f32 v32, v32, v96, -v94
    v_mfma_f32_16x16x32_bf16 v[20:23], v[136:139], v[68:71], 0
    v_mul_f32 v94, v99, v53
    v_fma_f32 v33, v33, v98, -v94
    v_mul_f32 v94, v101, v54
    v_fma_f32 v34, v34, v100, -v94
    v_mul_f32 v94, v103, v55
    v_fma_f32 v35, v35, v102, -v94
    v_cvt_pk_bf16_f32 v142, v32, v33
    v_cvt_pk_bf16_f32 v143, v34, v35
    v_mov_b32 v136, v138
    v_mov_b32 v137, v139
    v_mfma_f32_16x16x32_bf16 v[24:27], v[140:143], v[68:71], 0
    v_mul_f32 v20, v6, v20
    v_mul_f32 v21, v6, v21
    v_mul_f32 v22, v6, v22
    v_mul_f32 v23, v6, v23
    v_cvt_pk_bf16_f32 v20, v20, v21
    v_cvt_pk_bf16_f32 v21, v22, v23
    s_mov_b64 exec, -1
    buffer_store_dwordx2 v[20:21], v13, s[8:11], s46 offen
    s_and_b64 exec, exec, s[78:79]
    buffer_store_dwordx2 v[20:21], v13, s[8:11], s46 offen sc1
    s_mov_b64 exec, -1
    v_mov_b32 v140, v142
    v_mov_b32 v141, v143
    v_mul_f32 v24, v6, v24
    v_mul_f32 v25, v6, v25
    v_cvt_pk_bf16_f32 v24, v24, v25
    s_mov_b64 exec, 0xffff
    buffer_store_dword v24, v14, s[8:11], s46 offen
    s_and_b64 exec, exec, s[78:79]
    buffer_store_dword v24, v14, s[8:11], s46 offen sc1
    s_mov_b64 exec, -1
    s_mul_i32 s43, s57, 22528
    s_add_u32 s43, s43, s49
    s_branch Laq_none
Laq_f_7:
    ds_read_b128 v[60:63], v9 offset:8192
    s_waitcnt lgkmcnt(2)
    v_mfma_f32_16x16x32_bf16 v[16:19], v[160:163], v[64:67], v[16:19]
    v_add_f32 v82, v82, v90
    v_mfma_f32_16x16x32_bf16 v[20:23], v[232:235], v[64:67], v[20:23]
    v_add_f32 v83, v83, v91
    v_mfma_f32_16x16x32_bf16 v[24:27], a[48:51], v[64:67], v[24:27]
    v_add_f32 v80, v80, v82
    ds_read_b128 v[64:67], v9 offset:10240
    s_waitcnt lgkmcnt(2)
    v_mfma_f32_16x16x32_bf16 v[16:19], v[164:167], v[56:59], v[16:19]
    v_add_f32 v81, v81, v83
    v_mfma_f32_16x16x32_bf16 v[20:23], v[236:239], v[56:59], v[20:23]
    v_mov_b32 v82, v80
    v_mfma_f32_16x16x32_bf16 v[24:27], a[52:55], v[56:59], v[24:27]
    v_mov_b32 v83, v81
    ds_read_b128 v[56:59], v9 offset:12288
    s_waitcnt lgkmcnt(2)
    v_mfma_f32_16x16x32_bf16 v[16:19], v[168:171], v[60:63], v[16:19]
    v_permlane32_swap_b32 v80, v82
    v_mfma_f32_16x16x32_bf16 v[20:23], v[240:243], v[60:63], v[20:23]
    v_permlane32_swap_b32 v81, v83
    v_mfma_f32_16x16x32_bf16 v[24:27], a[56:59], v[60:63], v[24:27]
    v_add_f32 v80, v80, v82
    ds_read_b128 v[60:63], v9 offset:14336
    s_waitcnt lgkmcnt(2)
    v_mfma_f32_16x16x32_bf16 v[16:19], v[172:175], v[64:67], v[16:19]
    v_add_f32 v81, v81, v83
    v_mfma_f32_16x16x32_bf16 v[20:23], v[244:247], v[64:67], v[20:23]
    v_mov_b32 v82, v80
    v_mfma_f32_16x16x32_bf16 v[24:27], a[60:63], v[64:67], v[24:27]
    v_mov_b32 v83, v81
    s_waitcnt vmcnt(1)
    s_cmp_lg_u32 s43, 0
    s_cselect_b64 exec, 1, 0
    buffer_store_dword v3, v4, s[8:11], s43 offen
    s_and_b64 exec, exec, s[78:79]
    buffer_store_dword v3, v4, s[8:11], s43 offen sc1
    s_mov_b64 exec, -1
    s_mov_b32 s43, 0
    ds_read_b128 v[64:67], v9 offset:16384
    s_waitcnt lgkmcnt(2)
    v_mfma_f32_16x16x32_bf16 v[16:19], v[176:179], v[56:59], v[16:19]
    v_permlane16_swap_b32 v80, v82
    v_mfma_f32_16x16x32_bf16 v[20:23], v[248:251], v[56:59], v[20:23]
    v_permlane16_swap_b32 v81, v83
    v_mfma_f32_16x16x32_bf16 v[24:27], a[64:67], v[56:59], v[24:27]
    v_add_f32 v80, v80, v82
    ds_read_b128 v[56:59], v9 offset:18432
    s_waitcnt lgkmcnt(2)
    v_mfma_f32_16x16x32_bf16 v[16:19], v[180:183], v[60:63], v[16:19]
    v_add_f32 v81, v81, v83
    v_mfma_f32_16x16x32_bf16 v[20:23], v[252:255], v[60:63], v[20:23]
    v_mul_f32 v80, 0x3ae38e39, v80
    v_mfma_f32_16x16x32_bf16 v[24:27], a[68:71], v[60:63], v[24:27]
    v_mul_f32 v81, 0x3ae38e39, v81
    ds_read_b128 v[60:63], v9 offset:20480
    s_waitcnt lgkmcnt(2)
    v_mfma_f32_16x16x32_bf16 v[16:19], v[184:187], v[64:67], v[16:19]
    v_fma_f32 v81, -v80, v80, v81
    v_mfma_f32_16x16x32_bf16 v[20:23], a[0:3], v[64:67], v[20:23]
    v_max_f32 v81, 0, v81
    v_mfma_f32_16x16x32_bf16 v[24:27], a[72:75], v[64:67], v[24:27]
    v_add_f32 v81, 0x3727c5ac, v81
    ds_read_b128 v[64:67], v9 offset:22528
    s_waitcnt lgkmcnt(2)
    v_mfma_f32_16x16x32_bf16 v[16:19], v[188:191], v[56:59], v[16:19]
    v_rsq_f32 v92, v81
    v_mfma_f32_16x16x32_bf16 v[20:23], a[4:7], v[56:59], v[20:23]
    v_mul_f32 v93, v80, v92
    v_mfma_f32_16x16x32_bf16 v[24:27], a[76:79], v[56:59], v[24:27]
    ds_write_b64 v11, v[92:93]
    ds_read_b128 v[56:59], v9 offset:24576
    s_waitcnt lgkmcnt(3)
    v_mfma_f32_16x16x32_bf16 v[16:19], v[192:195], v[60:63], v[16:19]
    ds_read_b128 v[96:99], v12
    v_mfma_f32_16x16x32_bf16 v[20:23], a[8:11], v[60:63], v[20:23]
    ds_read_b128 v[100:103], v12 offset:16
    v_mfma_f32_16x16x32_bf16 v[24:27], a[80:83], v[60:63], v[24:27]
    s_add_u32 m0, s59, 0
    s_add_u32 s47, s41, 0
    buffer_load_dwordx4 v0, s[8:11], s47 offen offset:0 lds
    ds_read_b128 v[60:63], v9 offset:26624
    s_waitcnt lgkmcnt(5)
    v_mfma_f32_16x16x32_bf16 v[16:19], v[196:199], v[64:67], v[16:19]
    buffer_load_dwordx4 v0, s[8:11], s47 offen offset:1024 lds
    buffer_load_dwordx4 v0, s[8:11], s47 offen offset:2048 lds
    buffer_load_dwordx4 v0, s[8:11], s47 offen offset:3072 lds
    v_mfma_f32_16x16x32_bf16 v[20:23], a[12:15], v[64:67], v[20:23]
    s_add_u32 m0, s59, 4096
    s_add_u32 s47, s41, 4096
    buffer_load_dwordx4 v0, s[8:11], s47 offen offset:0 lds
    v_mfma_f32_16x16x32_bf16 v[24:27], a[84:87], v[64:67], v[24:27]
    buffer_load_dwordx4 v0, s[8:11], s47 offen offset:1024 lds
    buffer_load_dwordx4 v0, s[8:11], s47 offen offset:2048 lds
    buffer_load_dwordx4 v0, s[8:11], s47 offen offset:3072 lds
    ds_read_b128 v[64:67], v9 offset:28672
    s_waitcnt lgkmcnt(4)
    v_mfma_f32_16x16x32_bf16 v[16:19], v[200:203], v[56:59], v[16:19]
    s_add_u32 m0, s59, 8192
    s_add_u32 s47, s41, 8192
    buffer_load_dwordx4 v0, s[8:11], s47 offen offset:0 lds
    v_mfma_f32_16x16x32_bf16 v[20:23], a[16:19], v[56:59], v[20:23]
    v_mfma_f32_16x16x32_bf16 v[24:27], a[88:91], v[56:59], v[24:27]
    ds_read_b128 v[56:59], v9 offset:30720
    s_waitcnt lgkmcnt(2)
    v_mfma_f32_16x16x32_bf16 v[16:19], v[204:207], v[60:63], v[16:19]
    v_mfma_f32_16x16x32_bf16 v[20:23], a[20:23], v[60:63], v[20:23]
    v_mfma_f32_16x16x32_bf16 v[24:27], a[92:95], v[60:63], v[24:27]
    ds_read_b128 v[60:63], v9 offset:32768
    s_waitcnt lgkmcnt(2)
    v_mfma_f32_16x16x32_bf16 v[16:19], v[208:211], v[64:67], v[16:19]
    v_mfma_f32_16x16x32_bf16 v[20:23], a[24:27], v[64:67], v[20:23]
    v_mfma_f32_16x16x32_bf16 v[24:27], a[96:99], v[64:67], v[24:27]
    ds_read_b128 v[64:67], v9 offset:34816
    s_waitcnt lgkmcnt(2)
    v_mfma_f32_16x16x32_bf16 v[16:19], v[212:215], v[56:59], v[16:19]
    v_cmp_eq_u32 s[76:77], 1, v2
    v_cmp_eq_u32 vcc, 2, v2
    v_mfma_f32_16x16x32_bf16 v[20:23], a[28:31], v[56:59], v[20:23]
    s_cmp_eq_u64 s[76:77], -1
    s_cselect_b32 s38, 1, 0
    v_mfma_f32_16x16x32_bf16 v[24:27], a[100:103], v[56:59], v[24:27]
    s_cmp_lg_u32 s38, 0
    s_cselect_b64 exec, 1, 0
    v_mov_b32 v15, s32
    ds_write_b32 v110, v15
    v_mov_b32 v2, 2
    s_mov_b64 exec, -1
    ds_read_b128 v[56:59], v9 offset:0
    s_waitcnt lgkmcnt(3)
    v_mfma_f32_16x16x32_bf16 v[16:19], v[216:219], v[60:63], v[16:19]
    s_add_u32 s32, s32, s38
    s_mul_i32 s38, s38, 22528
    s_add_u32 s33, s33, s38
    v_mfma_f32_16x16x32_bf16 v[20:23], a[32:35], v[60:63], v[20:23]
    s_cmp_eq_u64 vcc, 0
    s_cselect_b32 s38, s32, 0x7fff
    v_mfma_f32_16x16x32_bf16 v[24:27], a[104:107], v[60:63], v[24:27]
    s_cmp_le_u32 s38, s39
    s_cselect_b64 exec, -1, 0
    v_mov_b32 v2, 2
    buffer_load_dword v2, v1, s[8:11], s33 offen sc1
    s_mov_b64 exec, -1
    ds_read_b128 v[60:63], v9 offset:2048
    s_waitcnt lgkmcnt(3)
    v_mfma_f32_16x16x32_bf16 v[16:19], v[220:223], v[64:67], v[16:19]
    s_mul_i32 s48, s36, 786432
    s_mul_i32 s18, s37, 6144
    s_add_u32 s48, s48, s18
    s_add_u32 s48, s48, 15728640
    buffer_load_dwordx4 v[80:83], v10, s[8:11], s48 offen offset:0
    v_mfma_f32_16x16x32_bf16 v[20:23], a[36:39], v[64:67], v[20:23]
    v_mfma_f32_16x16x32_bf16 v[24:27], a[108:111], v[64:67], v[24:27]
    ds_read_b128 v[64:67], v9 offset:4096
    s_waitcnt lgkmcnt(2)
    v_mfma_f32_16x16x32_bf16 v[28:31], v[56:59], a[112:115], 0
    buffer_load_dwordx4 v[84:87], v10, s[8:11], s48 offen offset:512
    v_mfma_f32_16x16x32_bf16 v[32:35], v[56:59], a[184:187], 0
    ds_read_b128 v[56:59], v9 offset:6144
    s_waitcnt lgkmcnt(2)
    v_mfma_f32_16x16x32_bf16 v[28:31], v[60:63], a[116:119], v[28:31]
    buffer_load_dwordx4 v[88:91], v10, s[8:11], s48 offen offset:1024
    v_mul_f32 v94, v93, v36
    v_fma_f32 v16, v16, v92, -v94
    v_mfma_f32_16x16x32_bf16 v[32:35], v[60:63], a[188:191], v[32:35]
    v_mul_f32 v94, v93, v37
    v_fma_f32 v17, v17, v92, -v94
    ds_read_b128 v[60:63], v9 offset:8192
    s_waitcnt lgkmcnt(2)
    v_mfma_f32_16x16x32_bf16 v[28:31], v[64:67], a[120:123], v[28:31]
    v_mul_f32 v94, v93, v38
    v_fma_f32 v18, v18, v92, -v94
    v_mfma_f32_16x16x32_bf16 v[32:35], v[64:67], a[192:195], v[32:35]
    v_mul_f32 v94, v93, v39
    v_fma_f32 v19, v19, v92, -v94
    ds_read_b128 v[64:67], v9 offset:10240
    s_waitcnt lgkmcnt(2)
    v_mfma_f32_16x16x32_bf16 v[28:31], v[56:59], a[124:127], v[28:31]
    v_mul_f32 v94, v93, v44
    v_fma_f32 v24, v24, v92, -v94
    v_mfma_f32_16x16x32_bf16 v[32:35], v[56:59], a[196:199], v[32:35]
    v_mul_f32 v94, v93, v45
    v_fma_f32 v25, v25, v92, -v94
    ds_read_b128 v[56:59], v9 offset:12288
    s_waitcnt lgkmcnt(2)
    v_mfma_f32_16x16x32_bf16 v[28:31], v[60:63], a[128:131], v[28:31]
    v_mul_f32 v94, v93, v46
    v_fma_f32 v26, v26, v92, -v94
    v_mfma_f32_16x16x32_bf16 v[32:35], v[60:63], a[200:203], v[32:35]
    v_mul_f32 v94, v93, v47
    v_fma_f32 v27, v27, v92, -v94
    ds_read_b128 v[60:63], v9 offset:14336
    s_waitcnt lgkmcnt(2)
    v_mfma_f32_16x16x32_bf16 v[28:31], v[64:67], a[132:135], v[28:31]
    v_mul_f32 v94, v93, v40
    v_fma_f32 v20, v20, v92, -v94
    v_mfma_f32_16x16x32_bf16 v[32:35], v[64:67], a[204:207], v[32:35]
    v_mul_f32 v94, v93, v41
    v_fma_f32 v21, v21, v92, -v94
    ds_read_b128 v[64:67], v9 offset:16384
    s_waitcnt lgkmcnt(2)
    v_mfma_f32_16x16x32_bf16 v[28:31], v[56:59], a[136:139], v[28:31]
    v_mul_f32 v94, v93, v42
    v_fma_f32 v22, v22, v92, -v94
    v_mfma_f32_16x16x32_bf16 v[32:35], v[56:59], a[208:211], v[32:35]
    v_mul_f32 v94, v93, v43
    v_fma_f32 v23, v23, v92, -v94
    ds_read_b128 v[56:59], v9 offset:18432
    s_waitcnt lgkmcnt(2)
    v_mfma_f32_16x16x32_bf16 v[28:31], v[60:63], a[140:143], v[28:31]
    v_cvt_pk_bf16_f32 v128, v16, v17
    v_cvt_pk_bf16_f32 v129, v18, v19
    v_mfma_f32_16x16x32_bf16 v[32:35], v[60:63], a[212:215], v[32:35]
    v_cvt_pk_bf16_f32 v130, v24, v25
    v_cvt_pk_bf16_f32 v132, v20, v21
    ds_read_b128 v[60:63], v9 offset:20480
    s_waitcnt lgkmcnt(2)
    v_mfma_f32_16x16x32_bf16 v[28:31], v[64:67], a[144:147], v[28:31]
    v_cvt_pk_bf16_f32 v133, v22, v23
    v_cvt_pk_bf16_f32 v134, v26, v27
    v_mfma_f32_16x16x32_bf16 v[32:35], v[64:67], a[216:219], v[32:35]
    s_cmp_eq_u32 s35, 0
    s_cselect_b32 s46, 0xf149f2ca, 0
    ds_read_b128 v[64:67], v9 offset:22528
    s_waitcnt lgkmcnt(2)
    v_mfma_f32_16x16x32_bf16 v[28:31], v[56:59], a[148:151], v[28:31]
    v_mfma_f32_16x16x32_bf16 v[144:147], v[112:115], v[128:131], 0
    v_mfma_f32_16x16x32_bf16 v[32:35], v[56:59], a[220:223], v[32:35]
    v_mfma_f32_16x16x32_bf16 v[148:151], v[132:135], v[128:131], 0
    ds_read_b128 v[56:59], v9 offset:24576
    s_waitcnt lgkmcnt(2)
    v_mfma_f32_16x16x32_bf16 v[28:31], v[60:63], a[152:155], v[28:31]
    v_mov_b32 v112, v132
    v_mfma_f32_16x16x32_bf16 v[32:35], v[60:63], a[224:227], v[32:35]
    v_mov_b32 v113, v133
    v_mov_b32 v114, v134
    ds_read_b128 v[60:63], v9 offset:26624
    s_waitcnt lgkmcnt(2)
    v_mfma_f32_16x16x32_bf16 v[28:31], v[64:67], a[156:159], v[28:31]
    v_mfma_f32_16x16x32_bf16 v[32:35], v[64:67], a[228:231], v[32:35]
    v_fma_f32 v144, v144, s52, v72
    ds_read_b128 v[64:67], v9 offset:28672
    s_waitcnt lgkmcnt(2)
    v_mfma_f32_16x16x32_bf16 v[28:31], v[56:59], a[160:163], v[28:31]
    v_fma_f32 v145, v145, s52, v73
    v_fma_f32 v146, v146, s52, v74
    v_fma_f32 v147, v147, s52, v75
    v_mfma_f32_16x16x32_bf16 v[32:35], v[56:59], a[232:235], v[32:35]
    v_fma_f32 v148, v148, s52, v76
    v_fma_f32 v149, v149, s52, v77
    v_fma_f32 v150, v150, s52, v78
    ds_read_b128 v[56:59], v9 offset:30720
    s_waitcnt lgkmcnt(2)
    v_mfma_f32_16x16x32_bf16 v[28:31], v[60:63], a[164:167], v[28:31]
    v_fma_f32 v151, v151, s52, v79
    v_add_f32 v144, s46, v144
    v_add_f32 v145, s46, v145
    v_mfma_f32_16x16x32_bf16 v[32:35], v[60:63], a[236:239], v[32:35]
    v_add_f32 v146, s46, v146
    v_add_f32 v147, s46, v147
    v_max3_f32 v5, v144, v145, v146
    ds_read_b128 v[60:63], v9 offset:32768
    s_waitcnt lgkmcnt(2)
    v_mfma_f32_16x16x32_bf16 v[28:31], v[64:67], a[168:171], v[28:31]
    v_max3_f32 v5, v5, v147, v148
    v_max3_f32 v5, v5, v149, v150
    v_max_f32 v5, v5, v151
    v_mfma_f32_16x16x32_bf16 v[32:35], v[64:67], a[240:243], v[32:35]
    v_mov_b32 v6, v5
    s_nop 1
    v_permlane32_swap_b32 v5, v6
    ds_read_b128 v[64:67], v9 offset:34816
    s_waitcnt lgkmcnt(2)
    v_mfma_f32_16x16x32_bf16 v[28:31], v[56:59], a[172:175], v[28:31]
    v_max_f32 v5, v5, v6
    v_mov_b32 v6, v5
    v_mfma_f32_16x16x32_bf16 v[32:35], v[56:59], a[244:247], v[32:35]
    s_nop 0
    v_permlane16_swap_b32 v5, v6
    v_max_f32 v5, v5, v6
    v_sub_f32 v144, v144, v5
    s_waitcnt lgkmcnt(1)
    v_mfma_f32_16x16x32_bf16 v[28:31], v[60:63], a[176:179], v[28:31]
    v_sub_f32 v145, v145, v5
    v_sub_f32 v146, v146, v5
    v_sub_f32 v147, v147, v5
    v_mfma_f32_16x16x32_bf16 v[32:35], v[60:63], a[248:251], v[32:35]
    v_sub_f32 v148, v148, v5
    v_sub_f32 v149, v149, v5
    v_sub_f32 v150, v150, v5
    s_waitcnt lgkmcnt(0)
    v_mfma_f32_16x16x32_bf16 v[28:31], v[64:67], a[180:183], v[28:31]
    v_sub_f32 v151, v151, v5
    v_exp_f32 v144, v144
    v_exp_f32 v145, v145
    v_mfma_f32_16x16x32_bf16 v[32:35], v[64:67], a[252:255], v[32:35]
    v_exp_f32 v146, v146
    v_exp_f32 v147, v147
    v_exp_f32 v148, v148
    v_cmp_eq_u32 s[76:77], 1, v2
    v_cmp_eq_u32 vcc, 2, v2
    s_cmp_eq_u64 s[76:77], -1
    s_cselect_b32 s38, 1, 0
    s_cmp_lg_u32 s38, 0
    s_cselect_b64 exec, 1, 0
    v_mov_b32 v15, s32
    ds_write_b32 v110, v15
    v_mov_b32 v2, 2
    s_mov_b64 exec, -1
    s_add_u32 s32, s32, s38
    s_mul_i32 s38, s38, 22528
    s_add_u32 s33, s33, s38
    s_cmp_eq_u64 vcc, 0
    s_cselect_b32 s38, s32, 0x7fff
    s_cmp_le_u32 s38, s39
    s_cselect_b64 exec, -1, 0
    v_mov_b32 v2, 2
    buffer_load_dword v2, v1, s[8:11], s33 offen sc1
    s_mov_b64 exec, -1
    v_exp_f32 v149, v149
    v_exp_f32 v150, v150
    v_exp_f32 v151, v151
    v_cvt_pk_bf16_f32 v68, v144, v145
    v_cvt_pk_bf16_f32 v69, v146, v147
    v_cvt_pk_bf16_f32 v70, v148, v149
    v_cvt_pk_bf16_f32 v71, v150, v151
    s_nop 1
    v_mfma_f32_16x16x32_bf16 v[16:19], v[116:119], v[68:71], 0
    s_mul_i32 s46, s57, 36864
    s_add_u32 s46, s46, 17301504
    s_nop 5
    v_rcp_f32 v6, v16
    v_mul_f32 v94, v97, v48
    v_fma_f32 v28, v28, v96, -v94
    v_mul_f32 v94, v99, v49
    v_fma_f32 v29, v29, v98, -v94
    v_mul_f32 v94, v101, v50
    v_fma_f32 v30, v30, v100, -v94
    v_mul_f32 v94, v103, v51
    v_fma_f32 v31, v31, v102, -v94
    v_cvt_pk_bf16_f32 v138, v28, v29
    v_cvt_pk_bf16_f32 v139, v30, v31
    v_mul_f32 v94, v97, v52
    v_fma_f32 v32, v32, v96, -v94
    v_mfma_f32_16x16x32_bf16 v[20:23], v[136:139], v[68:71], 0
    v_mul_f32 v94, v99, v53
    v_fma_f32 v33, v33, v98, -v94
    v_mul_f32 v94, v101, v54
    v_fma_f32 v34, v34, v100, -v94
    v_mul_f32 v94, v103, v55
    v_fma_f32 v35, v35, v102, -v94
    v_cvt_pk_bf16_f32 v142, v32, v33
    v_cvt_pk_bf16_f32 v143, v34, v35
    v_mov_b32 v136, v138
    v_mov_b32 v137, v139
    v_mfma_f32_16x16x32_bf16 v[24:27], v[140:143], v[68:71], 0
    v_mul_f32 v20, v6, v20
    v_mul_f32 v21, v6, v21
    v_mul_f32 v22, v6, v22
    v_mul_f32 v23, v6, v23
    v_cvt_pk_bf16_f32 v20, v20, v21
    v_cvt_pk_bf16_f32 v21, v22, v23
    s_mov_b64 exec, -1
    buffer_store_dwordx2 v[20:21], v13, s[8:11], s46 offen
    s_and_b64 exec, exec, s[78:79]
    buffer_store_dwordx2 v[20:21], v13, s[8:11], s46 offen sc1
    s_mov_b64 exec, -1
    v_mov_b32 v140, v142
    v_mov_b32 v141, v143
    v_mul_f32 v24, v6, v24
    v_mul_f32 v25, v6, v25
    v_cvt_pk_bf16_f32 v24, v24, v25
    s_mov_b64 exec, 0xffff
    buffer_store_dword v24, v14, s[8:11], s46 offen
    s_and_b64 exec, exec, s[78:79]
    buffer_store_dword v24, v14, s[8:11], s46 offen sc1
    s_mov_b64 exec, -1
    s_mul_i32 s43, s57, 22528
    s_add_u32 s43, s43, s49
    s_branch Laq_head
Laq_f_8:
    ds_read_b128 v[60:63], v9 offset:8192
    s_waitcnt lgkmcnt(2)
    v_mfma_f32_16x16x32_bf16 v[28:31], v[64:67], a[120:123], v[28:31]
    v_mul_f32 v94, v93, v38
    v_fma_f32 v18, v18, v92, -v94
    v_mfma_f32_16x16x32_bf16 v[32:35], v[64:67], a[192:195], v[32:35]
    v_mul_f32 v94, v93, v39
    v_fma_f32 v19, v19, v92, -v94
    ds_read_b128 v[64:67], v9 offset:10240
    s_waitcnt lgkmcnt(2)
    v_mfma_f32_16x16x32_bf16 v[28:31], v[56:59], a[124:127], v[28:31]
    v_mul_f32 v94, v93, v44
    v_fma_f32 v24, v24, v92, -v94
    v_mfma_f32_16x16x32_bf16 v[32:35], v[56:59], a[196:199], v[32:35]
    v_mul_f32 v94, v93, v45
    v_fma_f32 v25, v25, v92, -v94
    ds_read_b128 v[56:59], v9 offset:12288
    s_waitcnt lgkmcnt(2)
    v_mfma_f32_16x16x32_bf16 v[28:31], v[60:63], a[128:131], v[28:31]
    v_mul_f32 v94, v93, v46
    v_fma_f32 v26, v26, v92, -v94
    v_mfma_f32_16x16x32_bf16 v[32:35], v[60:63], a[200:203], v[32:35]
    v_mul_f32 v94, v93, v47
    v_fma_f32 v27, v27, v92, -v94
    ds_read_b128 v[60:63], v9 offset:14336
    s_waitcnt lgkmcnt(2)
    v_mfma_f32_16x16x32_bf16 v[28:31], v[64:67], a[132:135], v[28:31]
    v_mul_f32 v94, v93, v40
    v_fma_f32 v20, v20, v92, -v94
    v_mfma_f32_16x16x32_bf16 v[32:35], v[64:67], a[204:207], v[32:35]
    v_mul_f32 v94, v93, v41
    v_fma_f32 v21, v21, v92, -v94
    ds_read_b128 v[64:67], v9 offset:16384
    s_waitcnt lgkmcnt(2)
    v_mfma_f32_16x16x32_bf16 v[28:31], v[56:59], a[136:139], v[28:31]
    v_mul_f32 v94, v93, v42
    v_fma_f32 v22, v22, v92, -v94
    v_mfma_f32_16x16x32_bf16 v[32:35], v[56:59], a[208:211], v[32:35]
    v_mul_f32 v94, v93, v43
    v_fma_f32 v23, v23, v92, -v94
    ds_read_b128 v[56:59], v9 offset:18432
    s_waitcnt lgkmcnt(2)
    v_mfma_f32_16x16x32_bf16 v[28:31], v[60:63], a[140:143], v[28:31]
    v_cvt_pk_bf16_f32 v128, v16, v17
    v_cvt_pk_bf16_f32 v129, v18, v19
    v_mfma_f32_16x16x32_bf16 v[32:35], v[60:63], a[212:215], v[32:35]
    v_cvt_pk_bf16_f32 v130, v24, v25
    v_cvt_pk_bf16_f32 v132, v20, v21
    ds_read_b128 v[60:63], v9 offset:20480
    s_waitcnt lgkmcnt(2)
    v_mfma_f32_16x16x32_bf16 v[28:31], v[64:67], a[144:147], v[28:31]
    v_cvt_pk_bf16_f32 v133, v22, v23
    v_cvt_pk_bf16_f32 v134, v26, v27
    v_mfma_f32_16x16x32_bf16 v[32:35], v[64:67], a[216:219], v[32:35]
    s_cmp_eq_u32 s35, 0
    s_cselect_b32 s46, 0xf149f2ca, 0
    ds_read_b128 v[64:67], v9 offset:22528
    s_waitcnt lgkmcnt(2)
    v_mfma_f32_16x16x32_bf16 v[28:31], v[56:59], a[148:151], v[28:31]
    s_add_u32 m0, s59, 0
    s_add_u32 s47, s41, 0
    buffer_load_dwordx4 v0, s[8:11], s47 offen offset:0 lds
    v_mfma_f32_16x16x32_bf16 v[144:147], v[112:115], v[128:131], 0
    buffer_load_dwordx4 v0, s[8:11], s47 offen offset:1024 lds
    buffer_load_dwordx4 v0, s[8:11], s47 offen offset:2048 lds
    buffer_load_dwordx4 v0, s[8:11], s47 offen offset:3072 lds
    v_mfma_f32_16x16x32_bf16 v[32:35], v[56:59], a[220:223], v[32:35]
    s_add_u32 m0, s59, 4096
    s_add_u32 s47, s41, 4096
    buffer_load_dwordx4 v0, s[8:11], s47 offen offset:0 lds
    v_mfma_f32_16x16x32_bf16 v[148:151], v[132:135], v[128:131], 0
    buffer_load_dwordx4 v0, s[8:11], s47 offen offset:1024 lds
    buffer_load_dwordx4 v0, s[8:11], s47 offen offset:2048 lds
    buffer_load_dwordx4 v0, s[8:11], s47 offen offset:3072 lds
    ds_read_b128 v[56:59], v9 offset:24576
    s_waitcnt lgkmcnt(2)
    v_mfma_f32_16x16x32_bf16 v[28:31], v[60:63], a[152:155], v[28:31]
    v_mov_b32 v112, v132
    v_mfma_f32_16x16x32_bf16 v[32:35], v[60:63], a[224:227], v[32:35]
    v_mov_b32 v113, v133
    v_mov_b32 v114, v134
    ds_read_b128 v[60:63], v9 offset:26624
    s_waitcnt lgkmcnt(2)
    v_mfma_f32_16x16x32_bf16 v[28:31], v[64:67], a[156:159], v[28:31]
    s_add_u32 m0, s59, 8192
    s_add_u32 s47, s41, 8192
    buffer_load_dwordx4 v0, s[8:11], s47 offen offset:0 lds
    v_mfma_f32_16x16x32_bf16 v[32:35], v[64:67], a[228:231], v[32:35]
    s_mul_i32 s48, s36, 786432
    s_mul_i32 s18, s37, 6144
    s_add_u32 s48, s48, s18
    s_add_u32 s48, s48, 15728640
    buffer_load_dwordx4 v[80:83], v10, s[8:11], s48 offen offset:0
    v_fma_f32 v144, v144, s52, v72
    ds_read_b128 v[64:67], v9 offset:28672
    s_waitcnt lgkmcnt(2)
    v_mfma_f32_16x16x32_bf16 v[28:31], v[56:59], a[160:163], v[28:31]
    v_fma_f32 v145, v145, s52, v73
    v_fma_f32 v146, v146, s52, v74
    v_fma_f32 v147, v147, s52, v75
    v_mfma_f32_16x16x32_bf16 v[32:35], v[56:59], a[232:235], v[32:35]
    v_fma_f32 v148, v148, s52, v76
    v_fma_f32 v149, v149, s52, v77
    v_fma_f32 v150, v150, s52, v78
    ds_read_b128 v[56:59], v9 offset:30720
    s_waitcnt lgkmcnt(2)
    v_mfma_f32_16x16x32_bf16 v[28:31], v[60:63], a[164:167], v[28:31]
    v_fma_f32 v151, v151, s52, v79
    v_add_f32 v144, s46, v144
    v_add_f32 v145, s46, v145
    v_mfma_f32_16x16x32_bf16 v[32:35], v[60:63], a[236:239], v[32:35]
    v_add_f32 v146, s46, v146
    v_add_f32 v147, s46, v147
    v_max3_f32 v5, v144, v145, v146
    ds_read_b128 v[60:63], v9 offset:32768
    s_waitcnt lgkmcnt(2)
    v_mfma_f32_16x16x32_bf16 v[28:31], v[64:67], a[168:171], v[28:31]
    v_max3_f32 v5, v5, v147, v148
    v_max3_f32 v5, v5, v149, v150
    v_max_f32 v5, v5, v151
    v_mfma_f32_16x16x32_bf16 v[32:35], v[64:67], a[240:243], v[32:35]
    buffer_load_dwordx4 v[84:87], v10, s[8:11], s48 offen offset:512
    v_mov_b32 v6, v5
    s_nop 1
    v_permlane32_swap_b32 v5, v6
    ds_read_b128 v[64:67], v9 offset:34816
    s_waitcnt lgkmcnt(2)
    v_mfma_f32_16x16x32_bf16 v[28:31], v[56:59], a[172:175], v[28:31]
    buffer_load_dwordx4 v[88:91], v10, s[8:11], s48 offen offset:1024
    v_max_f32 v5, v5, v6
    v_mov_b32 v6, v5
    v_mfma_f32_16x16x32_bf16 v[32:35], v[56:59], a[244:247], v[32:35]
    s_nop 0
    v_permlane16_swap_b32 v5, v6
    v_max_f32 v5, v5, v6
    v_sub_f32 v144, v144, v5
    s_waitcnt lgkmcnt(1)
    v_mfma_f32_16x16x32_bf16 v[28:31], v[60:63], a[176:179], v[28:31]
    v_sub_f32 v145, v145, v5
    v_sub_f32 v146, v146, v5
    v_sub_f32 v147, v147, v5
    v_mfma_f32_16x16x32_bf16 v[32:35], v[60:63], a[248:251], v[32:35]
    v_sub_f32 v148, v148, v5
    v_sub_f32 v149, v149, v5
    v_sub_f32 v150, v150, v5
    s_waitcnt lgkmcnt(0)
    v_mfma_f32_16x16x32_bf16 v[28:31], v[64:67], a[180:183], v[28:31]
    v_sub_f32 v151, v151, v5
    v_exp_f32 v144, v144
    v_exp_f32 v145, v145
    v_mfma_f32_16x16x32_bf16 v[32:35], v[64:67], a[252:255], v[32:35]
    v_exp_f32 v146, v146
    v_exp_f32 v147, v147
    v_exp_f32 v148, v148
    v_cmp_eq_u32 s[76:77], 1, v2
    v_cmp_eq_u32 vcc, 2, v2
    s_cmp_eq_u64 s[76:77], -1
    s_cselect_b32 s38, 1, 0
    s_cmp_lg_u32 s38, 0
    s_cselect_b64 exec, 1, 0
    v_mov_b32 v15, s32
    ds_write_b32 v110, v15
    v_mov_b32 v2, 2
    s_mov_b64 exec, -1
    s_add_u32 s32, s32, s38
    s_mul_i32 s38, s38, 22528
    s_add_u32 s33, s33, s38
    s_cmp_eq_u64 vcc, 0
    s_cselect_b32 s38, s32, 0x7fff
    s_cmp_le_u32 s38, s39
    s_cselect_b64 exec, -1, 0
    v_mov_b32 v2, 2
    buffer_load_dword v2, v1, s[8:11], s33 offen sc1
    s_mov_b64 exec, -1
    v_exp_f32 v149, v149
    v_exp_f32 v150, v150
    v_exp_f32 v151, v151
    v_cvt_pk_bf16_f32 v68, v144, v145
    v_cvt_pk_bf16_f32 v69, v146, v147
    v_cvt_pk_bf16_f32 v70, v148, v149
    v_cvt_pk_bf16_f32 v71, v150, v151
    s_nop 1
    v_mfma_f32_16x16x32_bf16 v[16:19], v[116:119], v[68:71], 0
    s_mul_i32 s46, s57, 36864
    s_add_u32 s46, s46, 17301504
    s_nop 5
    v_rcp_f32 v6, v16
    v_mul_f32 v94, v97, v48
    v_fma_f32 v28, v28, v96, -v94
    v_mul_f32 v94, v99, v49
    v_fma_f32 v29, v29, v98, -v94
    v_mul_f32 v94, v101, v50
    v_fma_f32 v30, v30, v100, -v94
    v_mul_f32 v94, v103, v51
    v_fma_f32 v31, v31, v102, -v94
    v_cvt_pk_bf16_f32 v138, v28, v29
    v_cvt_pk_bf16_f32 v139, v30, v31
    v_mul_f32 v94, v97, v52
    v_fma_f32 v32, v32, v96, -v94
    v_mfma_f32_16x16x32_bf16 v[20:23], v[136:139], v[68:71], 0
    v_mul_f32 v94, v99, v53
    v_fma_f32 v33, v33, v98, -v94
    v_mul_f32 v94, v101, v54
    v_fma_f32 v34, v34, v100, -v94
    v_mul_f32 v94, v103, v55
    v_fma_f32 v35, v35, v102, -v94
    v_cvt_pk_bf16_f32 v142, v32, v33
    v_cvt_pk_bf16_f32 v143, v34, v35
    v_mov_b32 v136, v138
    v_mov_b32 v137, v139
    v_mfma_f32_16x16x32_bf16 v[24:27], v[140:143], v[68:71], 0
    v_mul_f32 v20, v6, v20
    v_mul_f32 v21, v6, v21
    v_mul_f32 v22, v6, v22
    v_mul_f32 v23, v6, v23
    v_cvt_pk_bf16_f32 v20, v20, v21
    v_cvt_pk_bf16_f32 v21, v22, v23
    s_mov_b64 exec, -1
    buffer_store_dwordx2 v[20:21], v13, s[8:11], s46 offen
    s_and_b64 exec, exec, s[78:79]
    buffer_store_dwordx2 v[20:21], v13, s[8:11], s46 offen sc1
    s_mov_b64 exec, -1
    v_mov_b32 v140, v142
    v_mov_b32 v141, v143
    v_mul_f32 v24, v6, v24
    v_mul_f32 v25, v6, v25
    v_cvt_pk_bf16_f32 v24, v24, v25
    s_mov_b64 exec, 0xffff
    buffer_store_dword v24, v14, s[8:11], s46 offen
    s_and_b64 exec, exec, s[78:79]
    buffer_store_dword v24, v14, s[8:11], s46 offen sc1
    s_mov_b64 exec, -1
    s_mul_i32 s43, s57, 22528
    s_add_u32 s43, s43, s49
    s_branch Laq_head
Laq_none:
    ds_read_b32 v15, v110
    s_waitcnt lgkmcnt(0)
    v_readfirstlane_b32 s17, v15
    s_nop 0
    s_cmp_lt_i32 s17, s37
    s_cbranch_scc1 Laq_nopost
    s_add_u32 m0, s59, 0
    s_add_u32 s47, s41, 0
    buffer_load_dwordx4 v0, s[8:11], s47 offen offset:0 lds
    buffer_load_dwordx4 v0, s[8:11], s47 offen offset:1024 lds
    buffer_load_dwordx4 v0, s[8:11], s47 offen offset:2048 lds
    buffer_load_dwordx4 v0, s[8:11], s47 offen offset:3072 lds
    s_add_u32 m0, s59, 4096
    s_add_u32 s47, s41, 4096
    buffer_load_dwordx4 v0, s[8:11], s47 offen offset:0 lds
    buffer_load_dwordx4 v0, s[8:11], s47 offen offset:1024 lds
    buffer_load_dwordx4 v0, s[8:11], s47 offen offset:2048 lds
    buffer_load_dwordx4 v0, s[8:11], s47 offen offset:3072 lds
    s_add_u32 m0, s59, 8192
    s_add_u32 s47, s41, 8192
    buffer_load_dwordx4 v0, s[8:11], s47 offen offset:0 lds
    s_mul_i32 s48, s36, 786432
    s_mul_i32 s18, s37, 6144
    s_add_u32 s48, s48, s18
    s_add_u32 s48, s48, 15728640
    buffer_load_dwordx4 v[80:83], v10, s[8:11], s48 offen offset:0
    buffer_load_dwordx4 v[84:87], v10, s[8:11], s48 offen offset:512
    buffer_load_dwordx4 v[88:91], v10, s[8:11], s48 offen offset:1024
    s_waitcnt vmcnt(12)
    s_cmp_lg_u32 s43, 0
    s_cselect_b64 exec, 1, 0
    buffer_store_dword v3, v4, s[8:11], s43 offen
    s_and_b64 exec, exec, s[78:79]
    buffer_store_dword v3, v4, s[8:11], s43 offen sc1
    s_mov_b64 exec, -1
    s_mov_b32 s43, 0
    s_waitcnt vmcnt(2) lgkmcnt(0)
    s_branch Laq_head2
Laq_nopost:
    s_waitcnt vmcnt(0)
    s_cmp_lg_u32 s43, 0
    s_cselect_b64 exec, 1, 0
    buffer_store_dword v3, v4, s[8:11], s43 offen
    s_and_b64 exec, exec, s[78:79]
    buffer_store_dword v3, v4, s[8:11], s43 offen sc1
    s_mov_b64 exec, -1
    s_mov_b32 s43, 0
    s_cmp_ge_u32 s37, 64
    s_cbranch_scc1 Laq_end
Laq_wait:
    s_mov_b32 s16, 0
    s_cmp_lg_u32 s14, 0
    s_cbranch_scc1 Laq_wl
Laq_wp:
    buffer_load_dword v2, v1, s[8:11], s60 offen sc1
    s_add_u32 s16, s16, 1
    s_cmp_gt_u32 s16, 100000
    s_cbranch_scc1 Laq_giveup
    s_waitcnt vmcnt(0)
    v_cmp_eq_u32 vcc, 0, v2
    s_nop 0
    s_cbranch_vccz Laq_wok
    s_sleep 4
    s_branch Laq_wp
Laq_giveup:
    v_mov_b32 v5, -2
    ds_write_b32 v110, v5
    s_waitcnt lgkmcnt(0)
    s_branch L_role_aq_abort
Laq_wok:
    v_mov_b32 v5, s37
    ds_write_b32 v110, v5
    s_branch Laq_go
Laq_wl:
    ds_read_b32 v15, v110
    s_add_u32 s16, s16, 1
    s_cmp_gt_u32 s16, 1600000
    s_cbranch_scc1 L_role_aq_abort
    s_waitcnt lgkmcnt(0)
    v_readfirstlane_b32 s17, v15
    s_nop 0
    s_cmp_eq_u32 s17, -2
    s_cbranch_scc1 L_role_aq_abort
    s_cmp_ge_i32 s17, s37
    s_cbranch_scc1 Laq_go
    s_sleep 1
    s_branch Laq_wl
Laq_go:
    s_add_u32 m0, s59, 0
    s_add_u32 s47, s41, 0
    buffer_load_dwordx4 v0, s[8:11], s47 offen offset:0 lds
    buffer_load_dwordx4 v0, s[8:11], s47 offen offset:1024 lds
    buffer_load_dwordx4 v0, s[8:11], s47 offen offset:2048 lds
    buffer_load_dwordx4 v0, s[8:11], s47 offen offset:3072 lds
    s_add_u32 m0, s59, 4096
    s_add_u32 s47, s41, 4096
    buffer_load_dwordx4 v0, s[8:11], s47 offen offset:0 lds
    buffer_load_dwordx4 v0, s[8:11], s47 offen offset:1024 lds
    buffer_load_dwordx4 v0, s[8:11], s47 offen offset:2048 lds
    buffer_load_dwordx4 v0, s[8:11], s47 offen offset:3072 lds
    s_add_u32 m0, s59, 8192
    s_add_u32 s47, s41, 8192
    buffer_load_dwordx4 v0, s[8:11], s47 offen offset:0 lds
    s_mul_i32 s48, s36, 786432
    s_mul_i32 s18, s37, 6144
    s_add_u32 s48, s48, s18
    s_add_u32 s48, s48, 15728640
    buffer_load_dwordx4 v[80:83], v10, s[8:11], s48 offen offset:0
    buffer_load_dwordx4 v[84:87], v10, s[8:11], s48 offen offset:512
    buffer_load_dwordx4 v[88:91], v10, s[8:11], s48 offen offset:1024
    s_waitcnt vmcnt(0) lgkmcnt(0)
    s_branch Laq_head2
Laq_end:
    s_branch L_role_aq_exit
L_role_aq_abort:
    s_waitcnt lgkmcnt(0)
    s_mov_b64 exec, -1
    v_mov_b32 v0, 60
    s_lshl_b32 s5, s3, 8
    s_or_b32 s5, s5, s4
    s_or_b32 s5, s5, 0x10000
    v_mov_b32 v1, s5
    global_store_dword v0, v1, s[12:13]
    s_endpgm
L_role_aq_exit:
    s_endpgm
.p2align 6
L_role_ta:
    v_and_b32 v5, 63, v0
    v_lshlrev_b32 v0, 4, v5
    v_and_b32 v7, 15, v5
    v_lshrrev_b32 v8, 4, v5
    v_min_u32 v1, 12, v5
    v_lshrrev_b32 v6, 2, v1
    v_and_b32 v1, 3, v1
    v_lshlrev_b32 v1, 2, v1
    v_lshl_add_u32 v1, v6, 7, v1
    v_mov_b32 v3, 1
    v_mov_b32 v4, 0
    s_mov_b32 s44, 0x05040100
    s_mov_b32 s45, 0x07060302
    s_cmp_ge_u32 s15, 11
    s_cselect_b32 s36, 1, 0
    s_cselect_b32 s17, 11, 0
    s_sub_u32 s17, s15, s17
    s_mul_i32 s50, s17, 3
    s_add_u32 s50, s50, s14
    s_cmp_eq_u32 s14, 3
    s_cselect_b32 s50, 32, s50
    s_mov_b32 s40, s50
    s_mov_b32 s37, 0
    s_mov_b32 s52, 0x3e0293ee
    v_lshrrev_b32 v5, 2, v7
    v_and_b32 v6, 1, v7
    v_lshl_add_u32 v5, v5, 1, v6
    v_lshlrev_b32 v9, 8, v5
    v_lshl_add_u32 v9, v8, 4, v9
    v_lshrrev_b32 v10, 1, v0
    v_mov_b32 v11, 384
    v_mov_b32 v6, 0xf149f2ca
    v_mov_b32 v21, 0
    v_mov_b32 v22, 0
    s_mul_i32 s42, s36, 1441792
    s_lshl_b32 s17, s50, 9
    s_add_u32 s42, s42, s17
    s_add_u32 s42, s42, 5376
    s_mul_i32 s51, s36, 50331648
    s_lshl_b32 s17, s50, 13
    s_add_u32 s51, s51, s17
    s_add_u32 s51, s51, 44040192
    s_lshl_b32 s47, s36, 11
    s_add_u32 s47, s47, s50
    s_lshl_b32 s48, s47, 13
    s_add_u32 s48, s48, 144703488
    s_lshl_b32 s47, s47, 12
    s_add_u32 s47, s47, 27262976
    s_mul_i32 s43, s36, 1441792
    s_lshr_b32 s17, s50, 2
    s_lshl_b32 s17, s17, 7
    s_add_u32 s43, s43, s17
    s_and_b32 s17, s50, 3
    s_lshl_b32 s17, s17, 2
    s_add_u32 s43, s43, s17
    s_add_u32 s43, s43, 4224
    s_mov_b32 s28, s8
    s_mov_b32 s29, s9
    s_mov_b32 s30, 0
    s_mov_b32 s31, 0x00020000
    s_mov_b32 s39, 0
    s_mov_b32 s38, 0
    s_mov_b32 s49, 0
    s_mov_b32 s20, s8
    s_mov_b32 s21, s9
    s_mov_b32 s22, 0
    s_mov_b32 s23, 0x00020000
    v_mov_b32 v16, 0x3f803f80
    v_lshl_add_u32 v5, v8, 2, 0
    v_cmp_le_u32 vcc, v5, v7
    s_nop 1
    v_cndmask_b32 v236, v6, v4, vcc
    v_mov_b32 v17, 0x3f803f80
    v_lshl_add_u32 v5, v8, 2, 1
    v_cmp_le_u32 vcc, v5, v7
    s_nop 1
    v_cndmask_b32 v237, v6, v4, vcc
    v_mov_b32 v18, 0x3f803f80
    v_lshl_add_u32 v5, v8, 2, 2
    v_cmp_le_u32 vcc, v5, v7
    s_nop 1
    v_cndmask_b32 v238, v6, v4, vcc
    v_mov_b32 v19, 0x3f803f80
    v_lshl_add_u32 v5, v8, 2, 3
    v_cmp_le_u32 vcc, v5, v7
    s_nop 1
    v_cndmask_b32 v239, v6, v4, vcc
    v_mov_b32 v15, 0
    s_cmp_lg_u32 s14, 0
    s_cbranch_scc1 Lta_inia_d
    v_mov_b32 v5, 40
    s_mov_b32 s16, 0
Lta_inia:
    global_load_dword v6, v5, s[12:13] sc1
    s_add_u32 s16, s16, 1
    s_cmp_gt_u32 s16, 100000
    s_cbranch_scc1 L_role_ta_abort
    s_waitcnt vmcnt(0)
    v_cmp_gt_u32 vcc, 128, v6
    s_nop 0
    s_cbranch_vccz Lta_inia_d
    s_sleep 8
    s_branch Lta_inia
Lta_inia_d:
    s_barrier
    s_cmp_eq_u32 s36, 0
    s_cbranch_scc1 Lta_ini_sk
    s_cmp_lg_u32 s14, 0
    s_cbranch_scc1 Lta_inib_d
    v_mov_b32 v5, 160
    s_mov_b32 s16, 0
Lta_inib:
    global_load_dword v6, v5, s[12:13] sc1
    s_add_u32 s16, s16, 1
    s_cmp_gt_u32 s16, 100000
    s_cbranch_scc1 L_role_ta_abort
    s_waitcnt vmcnt(0)
    v_cmp_gt_u32 vcc, 64, v6
    s_nop 0
    s_cbranch_vccz Lta_inib_d
    s_sleep 8
    s_branch Lta_inib
Lta_inib_d:
    s_barrier
Lta_ini_sk:
    s_cmp_ge_u32 s40, 32
    s_cbranch_scc1 L_role_ta_exit
Lta0:
    s_cmp_eq_u32 s39, 1
    s_cbranch_scc1 Lta0_have
    s_waitcnt vmcnt(0)
    s_cmp_lg_u32 s49, 0
    s_cselect_b64 exec, 1, 0
    buffer_store_dword v3, v4, s[8:11], s43 offen sc1
    s_mov_b64 exec, -1
    s_add_u32 s43, s43, s49
    s_mov_b32 s49, 0
    s_mov_b32 s16, 0
Lta0_f:
    buffer_load_dword v2, v1, s[8:11], s42 offen sc1
    s_add_u32 s16, s16, 1
    s_cmp_gt_u32 s16, 100000
    s_cbranch_scc1 L_role_ta_abort
    s_waitcnt vmcnt(0)
    v_cmp_eq_u32 vcc, 0, v2
    s_nop 0
    s_and_b32 s17, vcc_lo, 0xfff
    s_cbranch_scc0 Lta0_fd
    s_sleep 4
    s_branch Lta0_f
Lta0_fd:
    s_add_u32 s46, s51, 0
    buffer_load_dwordx4 v[140:143], v0, s[8:11], s46 offen offset:0
    buffer_load_dwordx4 v[144:147], v0, s[8:11], s46 offen offset:1024
    buffer_load_dwordx4 v[148:151], v0, s[8:11], s46 offen offset:2048
    buffer_load_dwordx4 v[152:155], v0, s[8:11], s46 offen offset:3072
    s_add_u32 s46, s51, 4096
    buffer_load_dwordx4 v[156:159], v0, s[8:11], s46 offen offset:0
    buffer_load_dwordx4 v[160:163], v0, s[8:11], s46 offen offset:1024
    buffer_load_dwordx4 v[164:167], v0, s[8:11], s46 offen offset:2048
    buffer_load_dwordx4 v[168:171], v0, s[8:11], s46 offen offset:3072
    s_add_u32 s46, s51, 16777216
    buffer_load_dwordx4 v[172:175], v0, s[8:11], s46 offen offset:0
    buffer_load_dwordx4 v[176:179], v0, s[8:11], s46 offen offset:1024
    buffer_load_dwordx4 v[180:183], v0, s[8:11], s46 offen offset:2048
    buffer_load_dwordx4 v[184:187], v0, s[8:11], s46 offen offset:3072
    s_add_u32 s46, s51, 16781312
    buffer_load_dwordx4 v[188:191], v0, s[8:11], s46 offen offset:0
    buffer_load_dwordx4 v[192:195], v0, s[8:11], s46 offen offset:1024
    buffer_load_dwordx4 v[196:199], v0, s[8:11], s46 offen offset:2048
    buffer_load_dwordx4 v[200:203], v0, s[8:11], s46 offen offset:3072
    s_add_u32 s46, s51, 33554432
    buffer_load_dwordx4 v[204:207], v0, s[8:11], s46 offen offset:0
    buffer_load_dwordx4 v[208:211], v0, s[8:11], s46 offen offset:1024
    buffer_load_dwordx4 v[212:215], v0, s[8:11], s46 offen offset:2048
    buffer_load_dwordx4 v[216:219], v0, s[8:11], s46 offen offset:3072
    s_add_u32 s46, s51, 33558528
    buffer_load_dwordx4 v[220:223], v0, s[8:11], s46 offen offset:0
    buffer_load_dwordx4 v[224:227], v0, s[8:11], s46 offen offset:1024
    buffer_load_dwordx4 v[228:231], v0, s[8:11], s46 offen offset:2048
    buffer_load_dwordx4 v[232:235], v0, s[8:11], s46 offen offset:3072
    s_waitcnt vmcnt(0)
Lta0_have:
    buffer_load_dword v2, v11, s[8:11], s42 offen sc1
    s_waitcnt vmcnt(5)
    v_cmp_eq_u32 vcc, 0, v15
    s_add_u32 s51, s51, 262144
    s_add_u32 s37, s37, 1
    s_mov_b32 s62, s38
    s_and_b32 s17, vcc_lo, 0xfff
    s_cselect_b32 s39, 0, 1
    s_cmp_eq_u64 vcc, 0
    s_cselect_b32 s38, 1, 0
    s_cmp_lt_u32 s37, 64
    s_cselect_b32 s39, s39, 0
    s_cselect_b32 s38, s38, 0
    s_cmp_eq_u32 s39, 1
    s_cselect_b32 s30, 268435456, 0
    s_cmp_eq_u32 s38, 1
    s_cselect_b32 s22, 268435456, 0
    v_mfma_f32_16x16x32_bf16 v[32:35], v[172:175], v[140:143], 0
    s_add_u32 s46, s51, 0
    buffer_load_dwordx4 a[0:3], v0, s[28:31], s46 offen offset:0
    v_mfma_f32_16x16x32_bf16 v[36:39], v[172:175], v[144:147], 0
    buffer_load_dwordx4 a[4:7], v0, s[28:31], s46 offen offset:1024
    v_mfma_f32_16x16x32_bf16 v[40:43], v[176:179], v[144:147], 0
    buffer_load_dwordx4 a[8:11], v0, s[28:31], s46 offen offset:2048
    v_mfma_f32_16x16x32_bf16 v[32:35], v[180:183], v[148:151], v[32:35]
    buffer_load_dwordx4 a[12:15], v0, s[28:31], s46 offen offset:3072
    v_mfma_f32_16x16x32_bf16 v[36:39], v[180:183], v[152:155], v[36:39]
    s_add_u32 s46, s51, 4096
    buffer_load_dwordx4 a[16:19], v0, s[28:31], s46 offen offset:0
    v_mfma_f32_16x16x32_bf16 v[40:43], v[184:187], v[152:155], v[40:43]
    buffer_load_dwordx4 a[20:23], v0, s[28:31], s46 offen offset:1024
    v_mfma_f32_16x16x32_bf16 v[32:35], v[188:191], v[156:159], v[32:35]
    v_mfma_f32_16x16x32_bf16 v[36:39], v[188:191], v[160:163], v[36:39]
    v_mfma_f32_16x16x32_bf16 v[40:43], v[192:195], v[160:163], v[40:43]
    v_mfma_f32_16x16x32_bf16 v[32:35], v[196:199], v[164:167], v[32:35]
    v_mfma_f32_16x16x32_bf16 v[36:39], v[196:199], v[168:171], v[36:39]
    v_mfma_f32_16x16x32_bf16 v[40:43], v[200:203], v[168:171], v[40:43]
    s_waitcnt vmcnt(7)
    s_cmp_lg_u32 s49, 0
    s_cselect_b64 exec, 1, 0
    buffer_store_dword v3, v4, s[8:11], s43 offen sc1
    s_mov_b64 exec, -1
    s_add_u32 s43, s43, s49
    s_mov_b32 s49, 0
    s_cmp_eq_u32 s62, 1
    s_cbranch_scc1 Lta0_km
    s_waitcnt vmcnt(6)
    v_cmp_eq_u32 vcc, 0, v2
    s_nop 0
    s_cbranch_vccz Lta0_r
    s_mov_b32 s16, 0
Lta0_rp:
    buffer_load_dword v2, v11, s[8:11], s42 offen sc1
    s_add_u32 s16, s16, 1
    s_cmp_gt_u32 s16, 100000
    s_cbranch_scc1 L_role_ta_abort
    s_waitcnt vmcnt(0)
    v_cmp_eq_u32 vcc, 0, v2
    s_nop 0
    s_cbranch_vccnz Lta0_rp
Lta0_r:
    buffer_load_dwordx4 a[96:99], v9, s[8:11], s47 offen offset:0
    buffer_load_dwordx4 a[100:103], v9, s[8:11], s47 offen offset:64
    buffer_load_dwordx4 a[104:107], v9, s[8:11], s47 offen offset:128
    buffer_load_dwordx4 a[108:111], v9, s[8:11], s47 offen offset:192
    buffer_load_dwordx2 a[112:113], v10, s[8:11], s47 offen offset:2048
    buffer_load_dwordx2 a[114:115], v10, s[8:11], s47 offen offset:2560
    buffer_load_dwordx2 a[116:117], v10, s[8:11], s47 offen offset:3072
    buffer_load_dwordx2 a[118:119], v10, s[8:11], s47 offen offset:3584
Lta0_km:
    s_add_u32 s42, s42, 22528
    s_add_u32 s47, s47, 131072
    v_fma_f32 v32, v32, s52, v236
    v_fma_f32 v33, v33, s52, v237
    v_fma_f32 v34, v34, s52, v238
    v_fma_f32 v35, v35, s52, v239
    buffer_load_dwordx4 a[24:27], v0, s[28:31], s46 offen offset:2048
    buffer_load_dwordx4 a[28:31], v0, s[28:31], s46 offen offset:3072
    v_mul_f32 v36, s52, v36
    v_mul_f32 v37, s52, v37
    v_mul_f32 v38, s52, v38
    v_mul_f32 v39, s52, v39
    s_add_u32 s46, s51, 16777216
    buffer_load_dwordx4 a[32:35], v0, s[28:31], s46 offen offset:0
    buffer_load_dwordx4 a[36:39], v0, s[28:31], s46 offen offset:1024
    v_fma_f32 v40, v40, s52, v236
    v_fma_f32 v41, v41, s52, v237
    v_fma_f32 v42, v42, s52, v238
    v_fma_f32 v43, v43, s52, v239
    buffer_load_dwordx4 a[40:43], v0, s[28:31], s46 offen offset:2048
    buffer_load_dwordx4 a[44:47], v0, s[28:31], s46 offen offset:3072
    s_waitcnt vmcnt(13)
    v_mfma_f32_16x16x32_bf16 v[44:47], a[96:99], v[140:143], 0
    v_mfma_f32_16x16x32_bf16 v[48:51], a[96:99], v[144:147], 0
    s_add_u32 s46, s51, 16781312
    buffer_load_dwordx4 a[48:51], v0, s[28:31], s46 offen offset:0
    s_waitcnt vmcnt(13)
    v_mfma_f32_16x16x32_bf16 v[44:47], a[100:103], v[148:151], v[44:47]
    v_mfma_f32_16x16x32_bf16 v[48:51], a[100:103], v[152:155], v[48:51]
    buffer_load_dwordx4 a[52:55], v0, s[28:31], s46 offen offset:1024
    s_waitcnt vmcnt(13)
    v_mfma_f32_16x16x32_bf16 v[44:47], a[104:107], v[156:159], v[44:47]
    v_mfma_f32_16x16x32_bf16 v[48:51], a[104:107], v[160:163], v[48:51]
    buffer_load_dwordx4 a[56:59], v0, s[28:31], s46 offen offset:2048
    s_waitcnt vmcnt(13)
    v_mfma_f32_16x16x32_bf16 v[44:47], a[108:111], v[164:167], v[44:47]
    v_mfma_f32_16x16x32_bf16 v[48:51], a[108:111], v[168:171], v[48:51]
    buffer_load_dwordx4 a[60:63], v0, s[28:31], s46 offen offset:3072
    v_max3_f32 v5, v32, v33, v34
    v_max_f32 v5, v5, v35
    s_nop 0
    v_mul_f32 v44, s52, v44
    v_mul_f32 v45, s52, v45
    v_max3_f32 v5, v5, v44, v45
    v_mov_b32 v6, v5
    s_add_u32 s46, s51, 33554432
    buffer_load_dwordx4 a[64:67], v0, s[28:31], s46 offen offset:0
    v_permlane32_swap_b32 v5, v6
    v_max_f32 v5, v5, v6
    v_mov_b32 v6, v5
    buffer_load_dwordx4 a[68:71], v0, s[28:31], s46 offen offset:1024
    s_nop 0
    v_permlane16_swap_b32 v5, v6
    v_max_f32 v5, v5, v6
    v_sub_f32 v32, v32, v5
    v_sub_f32 v33, v33, v5
    v_sub_f32 v34, v34, v5
    v_sub_f32 v35, v35, v5
    v_sub_f32 v44, v44, v5
    v_sub_f32 v45, v45, v5
    v_exp_f32 v32, v32
    v_exp_f32 v33, v33
    v_exp_f32 v34, v34
    v_exp_f32 v35, v35
    v_exp_f32 v44, v44
    v_exp_f32 v45, v45
    v_cvt_pk_bf16_f32 v24, v32, v33
    v_cvt_pk_bf16_f32 v25, v34, v35
    v_mov_b32 v26, 0
    v_mov_b32 v27, 0
    v_cvt_pk_bf16_f32 v20, v44, v45
    v_cvt_pk_bf16_f32 v23, v44, v45
    v_mfma_f32_16x16x32_bf16 v[28:31], v[16:19], v[24:27], 0
    v_mfma_f32_16x16x32_bf16 v[76:79], v[204:207], v[24:27], 0
    v_mfma_f32_16x16x32_bf16 v[80:83], v[208:211], v[24:27], 0
    s_add_u32 s17, s42, 22528
    buffer_load_dword v15, v1, s[8:11], s17 offen sc1
    v_mfma_f32_16x16x32_bf16 v[84:87], v[212:215], v[24:27], 0
    v_mfma_f32_16x16x32_bf16 v[88:91], v[216:219], v[24:27], 0
    buffer_load_dwordx4 a[72:75], v0, s[28:31], s46 offen offset:2048
    v_mfma_f32_16x16x32_bf16 v[92:95], v[220:223], v[24:27], 0
    v_mfma_f32_16x16x32_bf16 v[96:99], v[224:227], v[24:27], 0
    buffer_load_dwordx4 a[76:79], v0, s[28:31], s46 offen offset:3072
    v_mfma_f32_16x16x16_bf16 v[28:31], v[16:17], v[20:21], v[28:31]
    v_mfma_f32_16x16x32_bf16 v[100:103], v[228:231], v[24:27], 0
    v_mfma_f32_16x16x32_bf16 v[104:107], v[232:235], v[24:27], 0
    s_add_u32 s46, s51, 33558528
    buffer_load_dwordx4 a[80:83], v0, s[28:31], s46 offen offset:0
    s_waitcnt vmcnt(19)
    v_mfma_f32_16x16x16_bf16 v[76:79], a[112:113], v[20:21], v[76:79]
    v_mfma_f32_16x16x16_bf16 v[80:83], a[112:113], v[22:23], v[80:83]
    v_rcp_f32 v6, v28
    s_waitcnt vmcnt(18)
    v_mfma_f32_16x16x16_bf16 v[84:87], a[114:115], v[20:21], v[84:87]
    v_mfma_f32_16x16x16_bf16 v[88:91], a[114:115], v[22:23], v[88:91]
    v_mul_f32 v76, v6, v76
    v_mul_f32 v80, v6, v80
    v_cvt_pk_bf16_f32 v108, v76, v80
    v_mul_f32 v77, v6, v77
    v_mul_f32 v81, v6, v81
    v_cvt_pk_bf16_f32 v109, v77, v81
    v_mul_f32 v78, v6, v78
    v_mul_f32 v82, v6, v82
    v_cvt_pk_bf16_f32 v110, v78, v82
    v_mul_f32 v79, v6, v79
    v_mul_f32 v83, v6, v83
    v_cvt_pk_bf16_f32 v111, v79, v83
    s_add_u32 s17, s48, 0
    buffer_store_dwordx4 v[108:111], v0, s[8:11], s17 offen offset:0 sc1
    buffer_load_dwordx4 a[84:87], v0, s[28:31], s46 offen offset:1024
    s_waitcnt vmcnt(19)
    v_mfma_f32_16x16x16_bf16 v[92:95], a[116:117], v[20:21], v[92:95]
    v_mfma_f32_16x16x16_bf16 v[96:99], a[116:117], v[22:23], v[96:99]
    v_mul_f32 v84, v6, v84
    v_mul_f32 v88, v6, v88
    v_cvt_pk_bf16_f32 v112, v84, v88
    v_mul_f32 v85, v6, v85
    v_mul_f32 v89, v6, v89
    v_cvt_pk_bf16_f32 v113, v85, v89
    v_mul_f32 v86, v6, v86
    v_mul_f32 v90, v6, v90
    v_cvt_pk_bf16_f32 v114, v86, v90
    v_mul_f32 v87, v6, v87
    v_mul_f32 v91, v6, v91
    v_cvt_pk_bf16_f32 v115, v87, v91
    buffer_store_dwordx4 v[112:115], v0, s[8:11], s17 offen offset:2048 sc1
    buffer_load_dwordx4 a[88:91], v0, s[28:31], s46 offen offset:2048
    s_waitcnt vmcnt(20)
    v_mfma_f32_16x16x16_bf16 v[100:103], a[118:119], v[20:21], v[100:103]
    v_mfma_f32_16x16x16_bf16 v[104:107], a[118:119], v[22:23], v[104:107]
    v_mul_f32 v92, v6, v92
    v_mul_f32 v96, v6, v96
    v_cvt_pk_bf16_f32 v116, v92, v96
    v_mul_f32 v93, v6, v93
    v_mul_f32 v97, v6, v97
    v_cvt_pk_bf16_f32 v117, v93, v97
    v_mul_f32 v94, v6, v94
    v_mul_f32 v98, v6, v98
    v_cvt_pk_bf16_f32 v118, v94, v98
    v_mul_f32 v95, v6, v95
    v_mul_f32 v99, v6, v99
    v_cvt_pk_bf16_f32 v119, v95, v99
    s_add_u32 s17, s48, 4096
    buffer_store_dwordx4 v[116:119], v0, s[8:11], s17 offen offset:0 sc1
    buffer_load_dwordx4 a[92:95], v0, s[28:31], s46 offen offset:3072
    v_mul_f32 v100, v6, v100
    v_mul_f32 v104, v6, v104
    v_cvt_pk_bf16_f32 v120, v100, v104
    v_mul_f32 v101, v6, v101
    v_mul_f32 v105, v6, v105
    v_cvt_pk_bf16_f32 v121, v101, v105
    v_mul_f32 v102, v6, v102
    v_mul_f32 v106, v6, v106
    v_cvt_pk_bf16_f32 v122, v102, v106
    v_mul_f32 v103, v6, v103
    v_mul_f32 v107, v6, v107
    v_cvt_pk_bf16_f32 v123, v103, v107
    buffer_store_dwordx4 v[120:123], v0, s[8:11], s17 offen offset:2048 sc1
    buffer_load_dwordx4 a[120:123], v9, s[20:23], s47 offen offset:0
    v_max3_f32 v5, v36, v37, v38
    v_max_f32 v5, v5, v39
    v_max3_f32 v5, v5, v40, v41
    v_max3_f32 v5, v5, v42, v43
    v_mul_f32 v48, s52, v48
    v_mul_f32 v49, s52, v49
    v_max3_f32 v5, v5, v48, v49
    v_mov_b32 v6, v5
    buffer_load_dwordx4 a[124:127], v9, s[20:23], s47 offen offset:64
    s_nop 0
    v_permlane32_swap_b32 v5, v6
    v_max_f32 v5, v5, v6
    v_mov_b32 v6, v5
    buffer_load_dwordx4 a[128:131], v9, s[20:23], s47 offen offset:128
    s_nop 0
    v_permlane16_swap_b32 v5, v6
    v_max_f32 v5, v5, v6
    v_sub_f32 v36, v36, v5
    v_sub_f32 v37, v37, v5
    v_sub_f32 v38, v38, v5
    v_sub_f32 v39, v39, v5
    v_sub_f32 v40, v40, v5
    v_sub_f32 v41, v41, v5
    v_sub_f32 v42, v42, v5
    v_sub_f32 v43, v43, v5
    v_sub_f32 v48, v48, v5
    v_sub_f32 v49, v49, v5
    v_exp_f32 v36, v36
    v_exp_f32 v37, v37
    v_exp_f32 v38, v38
    v_exp_f32 v39, v39
    v_exp_f32 v40, v40
    v_exp_f32 v41, v41
    v_exp_f32 v42, v42
    v_exp_f32 v43, v43
    v_exp_f32 v48, v48
    v_exp_f32 v49, v49
    v_cvt_pk_bf16_f32 v24, v36, v37
    v_cvt_pk_bf16_f32 v25, v38, v39
    v_cvt_pk_bf16_f32 v26, v40, v41
    v_cvt_pk_bf16_f32 v27, v42, v43
    v_cvt_pk_bf16_f32 v20, v48, v49
    v_cvt_pk_bf16_f32 v23, v48, v49
    v_mfma_f32_16x16x32_bf16 v[28:31], v[16:19], v[24:27], 0
    v_mfma_f32_16x16x32_bf16 v[76:79], v[204:207], v[24:27], 0
    v_mfma_f32_16x16x32_bf16 v[80:83], v[208:211], v[24:27], 0
    buffer_load_dwordx4 a[132:135], v9, s[20:23], s47 offen offset:192
    v_mfma_f32_16x16x32_bf16 v[84:87], v[212:215], v[24:27], 0
    v_mfma_f32_16x16x32_bf16 v[88:91], v[216:219], v[24:27], 0
    buffer_load_dwordx2 a[136:137], v10, s[20:23], s47 offen offset:2048
    v_mfma_f32_16x16x32_bf16 v[92:95], v[220:223], v[24:27], 0
    v_mfma_f32_16x16x32_bf16 v[96:99], v[224:227], v[24:27], 0
    buffer_load_dwordx2 a[138:139], v10, s[20:23], s47 offen offset:2560
    v_mfma_f32_16x16x16_bf16 v[28:31], v[16:17], v[20:21], v[28:31]
    v_mfma_f32_16x16x32_bf16 v[100:103], v[228:231], v[24:27], 0
    v_mfma_f32_16x16x32_bf16 v[104:107], v[232:235], v[24:27], 0
    buffer_load_dwordx2 a[140:141], v10, s[20:23], s47 offen offset:3072
    buffer_load_dwordx2 a[142:143], v10, s[20:23], s47 offen offset:3584
    v_mfma_f32_16x16x16_bf16 v[76:79], a[112:113], v[20:21], v[76:79]
    v_mfma_f32_16x16x16_bf16 v[80:83], a[112:113], v[22:23], v[80:83]
    v_rcp_f32 v6, v28
    v_mfma_f32_16x16x16_bf16 v[84:87], a[114:115], v[20:21], v[84:87]
    v_mfma_f32_16x16x16_bf16 v[88:91], a[114:115], v[22:23], v[88:91]
    v_mul_f32 v76, v6, v76
    v_mul_f32 v80, v6, v80
    v_cvt_pk_bf16_f32 v124, v76, v80
    v_mul_f32 v77, v6, v77
    v_mul_f32 v81, v6, v81
    v_cvt_pk_bf16_f32 v125, v77, v81
    v_mul_f32 v78, v6, v78
    v_mul_f32 v82, v6, v82
    v_cvt_pk_bf16_f32 v126, v78, v82
    v_mul_f32 v79, v6, v79
    v_mul_f32 v83, v6, v83
    v_cvt_pk_bf16_f32 v127, v79, v83
    s_add_u32 s17, s48, 0
    buffer_store_dwordx4 v[124:127], v0, s[8:11], s17 offen offset:1024 sc1
    v_mfma_f32_16x16x16_bf16 v[92:95], a[116:117], v[20:21], v[92:95]
    v_mfma_f32_16x16x16_bf16 v[96:99], a[116:117], v[22:23], v[96:99]
    v_mul_f32 v84, v6, v84
    v_mul_f32 v88, v6, v88
    v_cvt_pk_bf16_f32 v128, v84, v88
    v_mul_f32 v85, v6, v85
    v_mul_f32 v89, v6, v89
    v_cvt_pk_bf16_f32 v129, v85, v89
    v_mul_f32 v86, v6, v86
    v_mul_f32 v90, v6, v90
    v_cvt_pk_bf16_f32 v130, v86, v90
    v_mul_f32 v87, v6, v87
    v_mul_f32 v91, v6, v91
    v_cvt_pk_bf16_f32 v131, v87, v91
    buffer_store_dwordx4 v[128:131], v0, s[8:11], s17 offen offset:3072 sc1
    v_mfma_f32_16x16x16_bf16 v[100:103], a[118:119], v[20:21], v[100:103]
    v_mfma_f32_16x16x16_bf16 v[104:107], a[118:119], v[22:23], v[104:107]
    v_mul_f32 v92, v6, v92
    v_mul_f32 v96, v6, v96
    v_cvt_pk_bf16_f32 v132, v92, v96
    v_mul_f32 v93, v6, v93
    v_mul_f32 v97, v6, v97
    v_cvt_pk_bf16_f32 v133, v93, v97
    v_mul_f32 v94, v6, v94
    v_mul_f32 v98, v6, v98
    v_cvt_pk_bf16_f32 v134, v94, v98
    v_mul_f32 v95, v6, v95
    v_mul_f32 v99, v6, v99
    v_cvt_pk_bf16_f32 v135, v95, v99
    s_add_u32 s17, s48, 4096
    buffer_store_dwordx4 v[132:135], v0, s[8:11], s17 offen offset:1024 sc1
    v_mul_f32 v100, v6, v100
    v_mul_f32 v104, v6, v104
    v_cvt_pk_bf16_f32 v136, v100, v104
    v_mul_f32 v101, v6, v101
    v_mul_f32 v105, v6, v105
    v_cvt_pk_bf16_f32 v137, v101, v105
    v_mul_f32 v102, v6, v102
    v_mul_f32 v106, v6, v106
    v_cvt_pk_bf16_f32 v138, v102, v106
    v_mul_f32 v103, v6, v103
    v_mul_f32 v107, v6, v107
    v_cvt_pk_bf16_f32 v139, v103, v107
    buffer_store_dwordx4 v[136:139], v0, s[8:11], s17 offen offset:3072 sc1
    s_add_u32 s48, s48, 262144
    s_mov_b32 s49, 22528
    s_cmp_ge_u32 s37, 64
    s_cbranch_scc1 Lta_end
Lta1:
    s_cmp_eq_u32 s39, 1
    s_cbranch_scc1 Lta1_have
    s_waitcnt vmcnt(0)
    s_cmp_lg_u32 s49, 0
    s_cselect_b64 exec, 1, 0
    buffer_store_dword v3, v4, s[8:11], s43 offen sc1
    s_mov_b64 exec, -1
    s_add_u32 s43, s43, s49
    s_mov_b32 s49, 0
    s_mov_b32 s16, 0
Lta1_f:
    buffer_load_dword v2, v1, s[8:11], s42 offen sc1
    s_add_u32 s16, s16, 1
    s_cmp_gt_u32 s16, 100000
    s_cbranch_scc1 L_role_ta_abort
    s_waitcnt vmcnt(0)
    v_cmp_eq_u32 vcc, 0, v2
    s_nop 0
    s_and_b32 s17, vcc_lo, 0xfff
    s_cbranch_scc0 Lta1_fd
    s_sleep 4
    s_branch Lta1_f
Lta1_fd:
    s_add_u32 s46, s51, 0
    buffer_load_dwordx4 a[0:3], v0, s[8:11], s46 offen offset:0
    buffer_load_dwordx4 a[4:7], v0, s[8:11], s46 offen offset:1024
    buffer_load_dwordx4 a[8:11], v0, s[8:11], s46 offen offset:2048
    buffer_load_dwordx4 a[12:15], v0, s[8:11], s46 offen offset:3072
    s_add_u32 s46, s51, 4096
    buffer_load_dwordx4 a[16:19], v0, s[8:11], s46 offen offset:0
    buffer_load_dwordx4 a[20:23], v0, s[8:11], s46 offen offset:1024
    buffer_load_dwordx4 a[24:27], v0, s[8:11], s46 offen offset:2048
    buffer_load_dwordx4 a[28:31], v0, s[8:11], s46 offen offset:3072
    s_add_u32 s46, s51, 16777216
    buffer_load_dwordx4 a[32:35], v0, s[8:11], s46 offen offset:0
    buffer_load_dwordx4 a[36:39], v0, s[8:11], s46 offen offset:1024
    buffer_load_dwordx4 a[40:43], v0, s[8:11], s46 offen offset:2048
    buffer_load_dwordx4 a[44:47], v0, s[8:11], s46 offen offset:3072
    s_add_u32 s46, s51, 16781312
    buffer_load_dwordx4 a[48:51], v0, s[8:11], s46 offen offset:0
    buffer_load_dwordx4 a[52:55], v0, s[8:11], s46 offen offset:1024
    buffer_load_dwordx4 a[56:59], v0, s[8:11], s46 offen offset:2048
    buffer_load_dwordx4 a[60:63], v0, s[8:11], s46 offen offset:3072
    s_add_u32 s46, s51, 33554432
    buffer_load_dwordx4 a[64:67], v0, s[8:11], s46 offen offset:0
    buffer_load_dwordx4 a[68:71], v0, s[8:11], s46 offen offset:1024
    buffer_load_dwordx4 a[72:75], v0, s[8:11], s46 offen offset:2048
    buffer_load_dwordx4 a[76:79], v0, s[8:11], s46 offen offset:3072
    s_add_u32 s46, s51, 33558528
    buffer_load_dwordx4 a[80:83], v0, s[8:11], s46 offen offset:0
    buffer_load_dwordx4 a[84:87], v0, s[8:11], s46 offen offset:1024
    buffer_load_dwordx4 a[88:91], v0, s[8:11], s46 offen offset:2048
    buffer_load_dwordx4 a[92:95], v0, s[8:11], s46 offen offset:3072
    s_waitcnt vmcnt(0)
Lta1_have:
    buffer_load_dword v2, v11, s[8:11], s42 offen sc1
    s_waitcnt vmcnt(5)
    v_cmp_eq_u32 vcc, 0, v15
    s_add_u32 s51, s51, 262144
    s_add_u32 s37, s37, 1
    s_mov_b32 s62, s38
    s_and_b32 s17, vcc_lo, 0xfff
    s_cselect_b32 s39, 0, 1
    s_cmp_eq_u64 vcc, 0
    s_cselect_b32 s38, 1, 0
    s_cmp_lt_u32 s37, 64
    s_cselect_b32 s39, s39, 0
    s_cselect_b32 s38, s38, 0
    s_cmp_eq_u32 s39, 1
    s_cselect_b32 s30, 268435456, 0
    s_cmp_eq_u32 s38, 1
    s_cselect_b32 s22, 268435456, 0
    v_mfma_f32_16x16x32_bf16 v[32:35], a[32:35], a[0:3], 0
    s_add_u32 s46, s51, 0
    buffer_load_dwordx4 v[140:143], v0, s[28:31], s46 offen offset:0
    v_mfma_f32_16x16x32_bf16 v[36:39], a[32:35], a[4:7], 0
    buffer_load_dwordx4 v[144:147], v0, s[28:31], s46 offen offset:1024
    v_mfma_f32_16x16x32_bf16 v[40:43], a[36:39], a[4:7], 0
    buffer_load_dwordx4 v[148:151], v0, s[28:31], s46 offen offset:2048
    v_mfma_f32_16x16x32_bf16 v[32:35], a[40:43], a[8:11], v[32:35]
    buffer_load_dwordx4 v[152:155], v0, s[28:31], s46 offen offset:3072
    v_mfma_f32_16x16x32_bf16 v[36:39], a[40:43], a[12:15], v[36:39]
    s_add_u32 s46, s51, 4096
    buffer_load_dwordx4 v[156:159], v0, s[28:31], s46 offen offset:0
    v_mfma_f32_16x16x32_bf16 v[40:43], a[44:47], a[12:15], v[40:43]
    buffer_load_dwordx4 v[160:163], v0, s[28:31], s46 offen offset:1024
    v_mfma_f32_16x16x32_bf16 v[32:35], a[48:51], a[16:19], v[32:35]
    v_mfma_f32_16x16x32_bf16 v[36:39], a[48:51], a[20:23], v[36:39]
    v_mfma_f32_16x16x32_bf16 v[40:43], a[52:55], a[20:23], v[40:43]
    v_mfma_f32_16x16x32_bf16 v[32:35], a[56:59], a[24:27], v[32:35]
    v_mfma_f32_16x16x32_bf16 v[36:39], a[56:59], a[28:31], v[36:39]
    v_mfma_f32_16x16x32_bf16 v[40:43], a[60:63], a[28:31], v[40:43]
    s_waitcnt vmcnt(7)
    s_cmp_lg_u32 s49, 0
    s_cselect_b64 exec, 1, 0
    buffer_store_dword v3, v4, s[8:11], s43 offen sc1
    s_mov_b64 exec, -1
    s_add_u32 s43, s43, s49
    s_mov_b32 s49, 0
    s_cmp_eq_u32 s62, 1
    s_cbranch_scc1 Lta1_km
    s_waitcnt vmcnt(6)
    v_cmp_eq_u32 vcc, 0, v2
    s_nop 0
    s_cbranch_vccz Lta1_r
    s_mov_b32 s16, 0
Lta1_rp:
    buffer_load_dword v2, v11, s[8:11], s42 offen sc1
    s_add_u32 s16, s16, 1
    s_cmp_gt_u32 s16, 100000
    s_cbranch_scc1 L_role_ta_abort
    s_waitcnt vmcnt(0)
    v_cmp_eq_u32 vcc, 0, v2
    s_nop 0
    s_cbranch_vccnz Lta1_rp
Lta1_r:
    buffer_load_dwordx4 a[120:123], v9, s[8:11], s47 offen offset:0
    buffer_load_dwordx4 a[124:127], v9, s[8:11], s47 offen offset:64
    buffer_load_dwordx4 a[128:131], v9, s[8:11], s47 offen offset:128
    buffer_load_dwordx4 a[132:135], v9, s[8:11], s47 offen offset:192
    buffer_load_dwordx2 a[136:137], v10, s[8:11], s47 offen offset:2048
    buffer_load_dwordx2 a[138:139], v10, s[8:11], s47 offen offset:2560
    buffer_load_dwordx2 a[140:141], v10, s[8:11], s47 offen offset:3072
    buffer_load_dwordx2 a[142:143], v10, s[8:11], s47 offen offset:3584
Lta1_km:
    s_add_u32 s42, s42, 22528
    s_add_u32 s47, s47, 131072
    v_fma_f32 v32, v32, s52, v236
    v_fma_f32 v33, v33, s52, v237
    v_fma_f32 v34, v34, s52, v238
    v_fma_f32 v35, v35, s52, v239
    buffer_load_dwordx4 v[164:167], v0, s[28:31], s46 offen offset:2048
    buffer_load_dwordx4 v[168:171], v0, s[28:31], s46 offen offset:3072
    v_mul_f32 v36, s52, v36
    v_mul_f32 v37, s52, v37
    v_mul_f32 v38, s52, v38
    v_mul_f32 v39, s52, v39
    s_add_u32 s46, s51, 16777216
    buffer_load_dwordx4 v[172:175], v0, s[28:31], s46 offen offset:0
    buffer_load_dwordx4 v[176:179], v0, s[28:31], s46 offen offset:1024
    v_fma_f32 v40, v40, s52, v236
    v_fma_f32 v41, v41, s52, v237
    v_fma_f32 v42, v42, s52, v238
    v_fma_f32 v43, v43, s52, v239
    buffer_load_dwordx4 v[180:183], v0, s[28:31], s46 offen offset:2048
    buffer_load_dwordx4 v[184:187], v0, s[28:31], s46 offen offset:3072
    s_waitcnt vmcnt(13)
    v_mfma_f32_16x16x32_bf16 v[44:47], a[120:123], a[0:3], 0
    v_mfma_f32_16x16x32_bf16 v[48:51], a[120:123], a[4:7], 0
    s_add_u32 s46, s51, 16781312
    buffer_load_dwordx4 v[188:191], v0, s[28:31], s46 offen offset:0
    s_waitcnt vmcnt(13)
    v_mfma_f32_16x16x32_bf16 v[44:47], a[124:127], a[8:11], v[44:47]
    v_mfma_f32_16x16x32_bf16 v[48:51], a[124:127], a[12:15], v[48:51]
    buffer_load_dwordx4 v[192:195], v0, s[28:31], s46 offen offset:1024
    s_waitcnt vmcnt(13)
    v_mfma_f32_16x16x32_bf16 v[44:47], a[128:131], a[16:19], v[44:47]
    v_mfma_f32_16x16x32_bf16 v[48:51], a[128:131], a[20:23], v[48:51]
    buffer_load_dwordx4 v[196:199], v0, s[28:31], s46 offen offset:2048
    s_waitcnt vmcnt(13)
    v_mfma_f32_16x16x32_bf16 v[44:47], a[132:135], a[24:27], v[44:47]
    v_mfma_f32_16x16x32_bf16 v[48:51], a[132:135], a[28:31], v[48:51]
    buffer_load_dwordx4 v[200:203], v0, s[28:31], s46 offen offset:3072
    v_max3_f32 v5, v32, v33, v34
    v_max_f32 v5, v5, v35
    s_nop 0
    v_mul_f32 v44, s52, v44
    v_mul_f32 v45, s52, v45
    v_max3_f32 v5, v5, v44, v45
    v_mov_b32 v6, v5
    s_add_u32 s46, s51, 33554432
    buffer_load_dwordx4 v[204:207], v0, s[28:31], s46 offen offset:0
    v_permlane32_swap_b32 v5, v6
    v_max_f32 v5, v5, v6
    v_mov_b32 v6, v5
    buffer_load_dwordx4 v[208:211], v0, s[28:31], s46 offen offset:1024
    s_nop 0
    v_permlane16_swap_b32 v5, v6
    v_max_f32 v5, v5, v6
    v_sub_f32 v32, v32, v5
    v_sub_f32 v33, v33, v5
    v_sub_f32 v34, v34, v5
    v_sub_f32 v35, v35, v5
    v_sub_f32 v44, v44, v5
    v_sub_f32 v45, v45, v5
    v_exp_f32 v32, v32
    v_exp_f32 v33, v33
    v_exp_f32 v34, v34
    v_exp_f32 v35, v35
    v_exp_f32 v44, v44
    v_exp_f32 v45, v45
    v_cvt_pk_bf16_f32 v24, v32, v33
    v_cvt_pk_bf16_f32 v25, v34, v35
    v_mov_b32 v26, 0
    v_mov_b32 v27, 0
    v_cvt_pk_bf16_f32 v20, v44, v45
    v_cvt_pk_bf16_f32 v23, v44, v45
    v_mfma_f32_16x16x32_bf16 v[28:31], v[16:19], v[24:27], 0
    v_mfma_f32_16x16x32_bf16 v[76:79], a[64:67], v[24:27], 0
    v_mfma_f32_16x16x32_bf16 v[80:83], a[68:71], v[24:27], 0
    s_add_u32 s17, s42, 22528
    buffer_load_dword v15, v1, s[8:11], s17 offen sc1
    v_mfma_f32_16x16x32_bf16 v[84:87], a[72:75], v[24:27], 0
    v_mfma_f32_16x16x32_bf16 v[88:91], a[76:79], v[24:27], 0
    buffer_load_dwordx4 v[212:215], v0, s[28:31], s46 offen offset:2048
    v_mfma_f32_16x16x32_bf16 v[92:95], a[80:83], v[24:27], 0
    v_mfma_f32_16x16x32_bf16 v[96:99], a[84:87], v[24:27], 0
    buffer_load_dwordx4 v[216:219], v0, s[28:31], s46 offen offset:3072
    v_mfma_f32_16x16x16_bf16 v[28:31], v[16:17], v[20:21], v[28:31]
    v_mfma_f32_16x16x32_bf16 v[100:103], a[88:91], v[24:27], 0
    v_mfma_f32_16x16x32_bf16 v[104:107], a[92:95], v[24:27], 0
    s_add_u32 s46, s51, 33558528
    buffer_load_dwordx4 v[220:223], v0, s[28:31], s46 offen offset:0
    s_waitcnt vmcnt(19)
    v_mfma_f32_16x16x16_bf16 v[76:79], a[136:137], v[20:21], v[76:79]
    v_mfma_f32_16x16x16_bf16 v[80:83], a[136:137], v[22:23], v[80:83]
    v_rcp_f32 v6, v28
    s_waitcnt vmcnt(18)
    v_mfma_f32_16x16x16_bf16 v[84:87], a[138:139], v[20:21], v[84:87]
    v_mfma_f32_16x16x16_bf16 v[88:91], a[138:139], v[22:23], v[88:91]
    v_mul_f32 v76, v6, v76
    v_mul_f32 v80, v6, v80
    v_cvt_pk_bf16_f32 v108, v76, v80
    v_mul_f32 v77, v6, v77
    v_mul_f32 v81, v6, v81
    v_cvt_pk_bf16_f32 v109, v77, v81
    v_mul_f32 v78, v6, v78
    v_mul_f32 v82, v6, v82
    v_cvt_pk_bf16_f32 v110, v78, v82
    v_mul_f32 v79, v6, v79
    v_mul_f32 v83, v6, v83
    v_cvt_pk_bf16_f32 v111, v79, v83
    s_add_u32 s17, s48, 0
    buffer_store_dwordx4 v[108:111], v0, s[8:11], s17 offen offset:0 sc1
    buffer_load_dwordx4 v[224:227], v0, s[28:31], s46 offen offset:1024
    s_waitcnt vmcnt(19)
    v_mfma_f32_16x16x16_bf16 v[92:95], a[140:141], v[20:21], v[92:95]
    v_mfma_f32_16x16x16_bf16 v[96:99], a[140:141], v[22:23], v[96:99]
    v_mul_f32 v84, v6, v84
    v_mul_f32 v88, v6, v88
    v_cvt_pk_bf16_f32 v112, v84, v88
    v_mul_f32 v85, v6, v85
    v_mul_f32 v89, v6, v89
    v_cvt_pk_bf16_f32 v113, v85, v89
    v_mul_f32 v86, v6, v86
    v_mul_f32 v90, v6, v90
    v_cvt_pk_bf16_f32 v114, v86, v90
    v_mul_f32 v87, v6, v87
    v_mul_f32 v91, v6, v91
    v_cvt_pk_bf16_f32 v115, v87, v91
    buffer_store_dwordx4 v[112:115], v0, s[8:11], s17 offen offset:2048 sc1
    buffer_load_dwordx4 v[228:231], v0, s[28:31], s46 offen offset:2048
    s_waitcnt vmcnt(20)
    v_mfma_f32_16x16x16_bf16 v[100:103], a[142:143], v[20:21], v[100:103]
    v_mfma_f32_16x16x16_bf16 v[104:107], a[142:143], v[22:23], v[104:107]
    v_mul_f32 v92, v6, v92
    v_mul_f32 v96, v6, v96
    v_cvt_pk_bf16_f32 v116, v92, v96
    v_mul_f32 v93, v6, v93
    v_mul_f32 v97, v6, v97
    v_cvt_pk_bf16_f32 v117, v93, v97
    v_mul_f32 v94, v6, v94
    v_mul_f32 v98, v6, v98
    v_cvt_pk_bf16_f32 v118, v94, v98
    v_mul_f32 v95, v6, v95
    v_mul_f32 v99, v6, v99
    v_cvt_pk_bf16_f32 v119, v95, v99
    s_add_u32 s17, s48, 4096
    buffer_store_dwordx4 v[116:119], v0, s[8:11], s17 offen offset:0 sc1
    buffer_load_dwordx4 v[232:235], v0, s[28:31], s46 offen offset:3072
    v_mul_f32 v100, v6, v100
    v_mul_f32 v104, v6, v104
    v_cvt_pk_bf16_f32 v120, v100, v104
    v_mul_f32 v101, v6, v101
    v_mul_f32 v105, v6, v105
    v_cvt_pk_bf16_f32 v121, v101, v105
    v_mul_f32 v102, v6, v102
    v_mul_f32 v106, v6, v106
    v_cvt_pk_bf16_f32 v122, v102, v106
    v_mul_f32 v103, v6, v103
    v_mul_f32 v107, v6, v107
    v_cvt_pk_bf16_f32 v123, v103, v107
    buffer_store_dwordx4 v[120:123], v0, s[8:11], s17 offen offset:2048 sc1
    buffer_load_dwordx4 a[96:99], v9, s[20:23], s47 offen offset:0
    v_max3_f32 v5, v36, v37, v38
    v_max_f32 v5, v5, v39
    v_max3_f32 v5, v5, v40, v41
    v_max3_f32 v5, v5, v42, v43
    v_mul_f32 v48, s52, v48
    v_mul_f32 v49, s52, v49
    v_max3_f32 v5, v5, v48, v49
    v_mov_b32 v6, v5
    buffer_load_dwordx4 a[100:103], v9, s[20:23], s47 offen offset:64
    s_nop 0
    v_permlane32_swap_b32 v5, v6
    v_max_f32 v5, v5, v6
    v_mov_b32 v6, v5
    buffer_load_dwordx4 a[104:107], v9, s[20:23], s47 offen offset:128
    s_nop 0
    v_permlane16_swap_b32 v5, v6
    v_max_f32 v5, v5, v6
    v_sub_f32 v36, v36, v5
    v_sub_f32 v37, v37, v5
    v_sub_f32 v38, v38, v5
    v_sub_f32 v39, v39, v5
    v_sub_f32 v40, v40, v5
    v_sub_f32 v41, v41, v5
    v_sub_f32 v42, v42, v5
    v_sub_f32 v43, v43, v5
    v_sub_f32 v48, v48, v5
    v_sub_f32 v49, v49, v5
    v_exp_f32 v36, v36
    v_exp_f32 v37, v37
    v_exp_f32 v38, v38
    v_exp_f32 v39, v39
    v_exp_f32 v40, v40
    v_exp_f32 v41, v41
    v_exp_f32 v42, v42
    v_exp_f32 v43, v43
    v_exp_f32 v48, v48
    v_exp_f32 v49, v49
    v_cvt_pk_bf16_f32 v24, v36, v37
    v_cvt_pk_bf16_f32 v25, v38, v39
    v_cvt_pk_bf16_f32 v26, v40, v41
    v_cvt_pk_bf16_f32 v27, v42, v43
    v_cvt_pk_bf16_f32 v20, v48, v49
    v_cvt_pk_bf16_f32 v23, v48, v49
    v_mfma_f32_16x16x32_bf16 v[28:31], v[16:19], v[24:27], 0
    v_mfma_f32_16x16x32_bf16 v[76:79], a[64:67], v[24:27], 0
    v_mfma_f32_16x16x32_bf16 v[80:83], a[68:71], v[24:27], 0
    buffer_load_dwordx4 a[108:111], v9, s[20:23], s47 offen offset:192
    v_mfma_f32_16x16x32_bf16 v[84:87], a[72:75], v[24:27], 0
    v_mfma_f32_16x16x32_bf16 v[88:91], a[76:79], v[24:27], 0
    buffer_load_dwordx2 a[112:113], v10, s[20:23], s47 offen offset:2048
    v_mfma_f32_16x16x32_bf16 v[92:95], a[80:83], v[24:27], 0
    v_mfma_f32_16x16x32_bf16 v[96:99], a[84:87], v[24:27], 0
    buffer_load_dwordx2 a[114:115], v10, s[20:23], s47 offen offset:2560
    v_mfma_f32_16x16x16_bf16 v[28:31], v[16:17], v[20:21], v[28:31]
    v_mfma_f32_16x16x32_bf16 v[100:103], a[88:91], v[24:27], 0
    v_mfma_f32_16x16x32_bf16 v[104:107], a[92:95], v[24:27], 0
    buffer_load_dwordx2 a[116:117], v10, s[20:23], s47 offen offset:3072
    buffer_load_dwordx2 a[118:119], v10, s[20:23], s47 offen offset:3584
    v_mfma_f32_16x16x16_bf16 v[76:79], a[136:137], v[20:21], v[76:79]
    v_mfma_f32_16x16x16_bf16 v[80:83], a[136:137], v[22:23], v[80:83]
    v_rcp_f32 v6, v28
    v_mfma_f32_16x16x16_bf16 v[84:87], a[138:139], v[20:21], v[84:87]
    v_mfma_f32_16x16x16_bf16 v[88:91], a[138:139], v[22:23], v[88:91]
    v_mul_f32 v76, v6, v76
    v_mul_f32 v80, v6, v80
    v_cvt_pk_bf16_f32 v124, v76, v80
    v_mul_f32 v77, v6, v77
    v_mul_f32 v81, v6, v81
    v_cvt_pk_bf16_f32 v125, v77, v81
    v_mul_f32 v78, v6, v78
    v_mul_f32 v82, v6, v82
    v_cvt_pk_bf16_f32 v126, v78, v82
    v_mul_f32 v79, v6, v79
    v_mul_f32 v83, v6, v83
    v_cvt_pk_bf16_f32 v127, v79, v83
    s_add_u32 s17, s48, 0
    buffer_store_dwordx4 v[124:127], v0, s[8:11], s17 offen offset:1024 sc1
    v_mfma_f32_16x16x16_bf16 v[92:95], a[140:141], v[20:21], v[92:95]
    v_mfma_f32_16x16x16_bf16 v[96:99], a[140:141], v[22:23], v[96:99]
    v_mul_f32 v84, v6, v84
    v_mul_f32 v88, v6, v88
    v_cvt_pk_bf16_f32 v128, v84, v88
    v_mul_f32 v85, v6, v85
    v_mul_f32 v89, v6, v89
    v_cvt_pk_bf16_f32 v129, v85, v89
    v_mul_f32 v86, v6, v86
    v_mul_f32 v90, v6, v90
    v_cvt_pk_bf16_f32 v130, v86, v90
    v_mul_f32 v87, v6, v87
    v_mul_f32 v91, v6, v91
    v_cvt_pk_bf16_f32 v131, v87, v91
    buffer_store_dwordx4 v[128:131], v0, s[8:11], s17 offen offset:3072 sc1
    v_mfma_f32_16x16x16_bf16 v[100:103], a[142:143], v[20:21], v[100:103]
    v_mfma_f32_16x16x16_bf16 v[104:107], a[142:143], v[22:23], v[104:107]
    v_mul_f32 v92, v6, v92
    v_mul_f32 v96, v6, v96
    v_cvt_pk_bf16_f32 v132, v92, v96
    v_mul_f32 v93, v6, v93
    v_mul_f32 v97, v6, v97
    v_cvt_pk_bf16_f32 v133, v93, v97
    v_mul_f32 v94, v6, v94
    v_mul_f32 v98, v6, v98
    v_cvt_pk_bf16_f32 v134, v94, v98
    v_mul_f32 v95, v6, v95
    v_mul_f32 v99, v6, v99
    v_cvt_pk_bf16_f32 v135, v95, v99
    s_add_u32 s17, s48, 4096
    buffer_store_dwordx4 v[132:135], v0, s[8:11], s17 offen offset:1024 sc1
    v_mul_f32 v100, v6, v100
    v_mul_f32 v104, v6, v104
    v_cvt_pk_bf16_f32 v136, v100, v104
    v_mul_f32 v101, v6, v101
    v_mul_f32 v105, v6, v105
    v_cvt_pk_bf16_f32 v137, v101, v105
    v_mul_f32 v102, v6, v102
    v_mul_f32 v106, v6, v106
    v_cvt_pk_bf16_f32 v138, v102, v106
    v_mul_f32 v103, v6, v103
    v_mul_f32 v107, v6, v107
    v_cvt_pk_bf16_f32 v139, v103, v107
    buffer_store_dwordx4 v[136:139], v0, s[8:11], s17 offen offset:3072 sc1
    s_add_u32 s48, s48, 262144
    s_mov_b32 s49, 22528
    s_cmp_ge_u32 s37, 64
    s_cbranch_scc1 Lta_end
    s_branch Lta0
Lta_end:
    s_waitcnt vmcnt(0)
    s_mov_b64 exec, 1
    buffer_store_dword v3, v4, s[8:11], s43 offen sc1
    s_mov_b64 exec, -1
    s_branch L_role_ta_exit
L_role_ta_abort:
    s_waitcnt lgkmcnt(0)
    s_mov_b64 exec, -1
    v_mov_b32 v0, 60
    s_lshl_b32 s5, s3, 8
    s_or_b32 s5, s5, s4
    s_or_b32 s5, s5, 0x10000
    v_mov_b32 v1, s5
    global_store_dword v0, v1, s[12:13]
    s_endpgm
L_role_ta_exit:
    s_endpgm
.p2align 6
L_role_tw:
    v_and_b32 v5, 63, v0
    v_lshlrev_b32 v0, 4, v5
    v_and_b32 v7, 15, v5
    v_lshrrev_b32 v8, 4, v5
    v_min_u32 v1, 31, v5
    v_lshrrev_b32 v6, 2, v1
    v_and_b32 v1, 3, v1
    v_lshlrev_b32 v1, 2, v1
    v_lshl_add_u32 v1, v6, 7, v1
    v_mov_b32 v3, 1
    v_mov_b32 v4, 0
    s_mov_b32 s44, 0x05040100
    s_mov_b32 s45, 0x07060302
    s_cmp_lg_u32 s14, 0
    s_cbranch_scc1 Ltw_gate_d
    v_mov_b32 v5, 48
    s_mov_b32 s16, 0
Ltw_gate:
    global_load_dword v6, v5, s[12:13] sc1
    s_add_u32 s16, s16, 1
    s_cmp_gt_u32 s16, 100000
    s_cbranch_scc1 L_role_tw_abort
    s_waitcnt vmcnt(0)
    v_cmp_gt_u32 vcc, 32, v6
    s_nop 0
    s_cbranch_vccz Ltw_gate_d
    s_sleep 100
    s_branch Ltw_gate
Ltw_gate_d:
    s_barrier
    s_load_dwordx2 s[20:21], s[0:1], 64
    s_mov_b32 s22, 4718592
    s_mov_b32 s23, 0x00020000
    s_waitcnt lgkmcnt(0)
    s_and_b32 s21, s21, 0xffff
    s_load_dwordx2 s[24:25], s[0:1], 80
    s_mov_b32 s26, 2359296
    s_mov_b32 s27, 0x00020000
    s_waitcnt lgkmcnt(0)
    s_and_b32 s25, s25, 0xffff
    s_mul_i32 s17, s15, 43
    s_lshr_b32 s32, s17, 9
    s_mul_i32 s17, s32, 12
    s_sub_u32 s50, s15, s17
    s_add_u32 s33, s32, 30
    s_cmp_eq_u32 s32, 2
    s_cselect_b32 s33, 0, s33
    s_cselect_b32 s32, 64, s32
    s_mul_i32 s49, s50, 96
    s_mul_i32 s17, s14, 1179648
    s_add_u32 s49, s49, s17
    v_mul_u32_u24 v5, 4608, v8
    v_lshl_add_u32 v9, v7, 2, v5
    v_add_u32 v10, 18432, v9
    v_and_b32 v6, 14, v7
    v_lshl_add_u32 v12, v6, 1, v5
    v_add_u32 v12, 64, v12
    v_add_u32 v13, 18432, v12
    v_and_b32 v5, 1, v7
    v_mov_b32 v11, s44
    v_mov_b32 v6, s45
    v_cmp_eq_u32 vcc, 1, v5
    s_nop 1
    v_cndmask_b32 v11, v11, v6, vcc
    s_add_u32 s17, s49, 0
    buffer_load_dword v16, v9, s[20:23], s17 offen
    buffer_load_dword v17, v10, s[20:23], s17 offen
    buffer_load_dword v18, v12, s[20:23], s17 offen
    buffer_load_dword v19, v13, s[20:23], s17 offen
    s_add_u32 s17, s49, 1152
    buffer_load_dword v20, v9, s[20:23], s17 offen
    buffer_load_dword v21, v10, s[20:23], s17 offen
    buffer_load_dword v22, v12, s[20:23], s17 offen
    buffer_load_dword v23, v13, s[20:23], s17 offen
    s_add_u32 s17, s49, 2304
    buffer_load_dword v24, v9, s[20:23], s17 offen
    buffer_load_dword v25, v10, s[20:23], s17 offen
    buffer_load_dword v26, v12, s[20:23], s17 offen
    buffer_load_dword v27, v13, s[20:23], s17 offen
    s_add_u32 s17, s49, 3456
    buffer_load_dword v28, v9, s[20:23], s17 offen
    buffer_load_dword v29, v10, s[20:23], s17 offen
    buffer_load_dword v30, v12, s[20:23], s17 offen
    buffer_load_dword v31, v13, s[20:23], s17 offen
    s_add_u32 s17, s49, 36864
    buffer_load_dword v32, v9, s[20:23], s17 offen
    buffer_load_dword v33, v10, s[20:23], s17 offen
    buffer_load_dword v34, v12, s[20:23], s17 offen
    buffer_load_dword v35, v13, s[20:23], s17 offen
    s_add_u32 s17, s49, 38016
    buffer_load_dword v36, v9, s[20:23], s17 offen
    buffer_load_dword v37, v10, s[20:23], s17 offen
    buffer_load_dword v38, v12, s[20:23], s17 offen
    buffer_load_dword v39, v13, s[20:23], s17 offen
    s_add_u32 s17, s49, 39168
    buffer_load_dword v40, v9, s[20:23], s17 offen
    buffer_load_dword v41, v10, s[20:23], s17 offen
    buffer_load_dword v42, v12, s[20:23], s17 offen
    buffer_load_dword v43, v13, s[20:23], s17 offen
    s_add_u32 s17, s49, 40320
    buffer_load_dword v44, v9, s[20:23], s17 offen
    buffer_load_dword v45, v10, s[20:23], s17 offen
    buffer_load_dword v46, v12, s[20:23], s17 offen
    buffer_load_dword v47, v13, s[20:23], s17 offen
    s_add_u32 s17, s49, 73728
    buffer_load_dword v48, v9, s[20:23], s17 offen
    buffer_load_dword v49, v10, s[20:23], s17 offen
    buffer_load_dword v50, v12, s[20:23], s17 offen
    buffer_load_dword v51, v13, s[20:23], s17 offen
    s_add_u32 s17, s49, 74880
    buffer_load_dword v52, v9, s[20:23], s17 offen
    buffer_load_dword v53, v10, s[20:23], s17 offen
    buffer_load_dword v54, v12, s[20:23], s17 offen
    buffer_load_dword v55, v13, s[20:23], s17 offen
    s_add_u32 s17, s49, 76032
    buffer_load_dword v56, v9, s[20:23], s17 offen
    buffer_load_dword v57, v10, s[20:23], s17 offen
    buffer_load_dword v58, v12, s[20:23], s17 offen
    buffer_load_dword v59, v13, s[20:23], s17 offen
    s_add_u32 s17, s49, 77184
    buffer_load_dword v60, v9, s[20:23], s17 offen
    buffer_load_dword v61, v10, s[20:23], s17 offen
    buffer_load_dword v62, v12, s[20:23], s17 offen
    buffer_load_dword v63, v13, s[20:23], s17 offen
    s_add_u32 s17, s49, 110592
    buffer_load_dword v64, v9, s[20:23], s17 offen
    buffer_load_dword v65, v10, s[20:23], s17 offen
    buffer_load_dword v66, v12, s[20:23], s17 offen
    buffer_load_dword v67, v13, s[20:23], s17 offen
    s_add_u32 s17, s49, 111744
    buffer_load_dword v68, v9, s[20:23], s17 offen
    buffer_load_dword v69, v10, s[20:23], s17 offen
    buffer_load_dword v70, v12, s[20:23], s17 offen
    buffer_load_dword v71, v13, s[20:23], s17 offen
    s_add_u32 s17, s49, 112896
    buffer_load_dword v72, v9, s[20:23], s17 offen
    buffer_load_dword v73, v10, s[20:23], s17 offen
    buffer_load_dword v74, v12, s[20:23], s17 offen
    buffer_load_dword v75, v13, s[20:23], s17 offen
    s_waitcnt vmcnt(58)
    v_perm_b32 v5, v17, v16, s44
    v_perm_b32 v6, v17, v16, s45
    s_waitcnt vmcnt(56)
    v_perm_b32 v128, v19, v18, v11
    v_accvgpr_write_b32 a0, v5
    v_accvgpr_write_b32 a4, v6
    s_add_u32 s17, s49, 114048
    buffer_load_dword v76, v9, s[20:23], s17 offen
    buffer_load_dword v77, v10, s[20:23], s17 offen
    buffer_load_dword v78, v12, s[20:23], s17 offen
    buffer_load_dword v79, v13, s[20:23], s17 offen
    s_waitcnt vmcnt(58)
    v_perm_b32 v5, v21, v20, s44
    v_perm_b32 v6, v21, v20, s45
    s_waitcnt vmcnt(56)
    v_perm_b32 v129, v23, v22, v11
    v_accvgpr_write_b32 a1, v5
    v_accvgpr_write_b32 a5, v6
    s_add_u32 s17, s49, 147456
    buffer_load_dword v80, v9, s[20:23], s17 offen
    buffer_load_dword v81, v10, s[20:23], s17 offen
    buffer_load_dword v82, v12, s[20:23], s17 offen
    buffer_load_dword v83, v13, s[20:23], s17 offen
    s_waitcnt vmcnt(58)
    v_perm_b32 v5, v25, v24, s44
    v_perm_b32 v6, v25, v24, s45
    s_waitcnt vmcnt(56)
    v_perm_b32 v130, v27, v26, v11
    v_accvgpr_write_b32 a2, v5
    v_accvgpr_write_b32 a6, v6
    s_add_u32 s17, s49, 148608
    buffer_load_dword v84, v9, s[20:23], s17 offen
    buffer_load_dword v85, v10, s[20:23], s17 offen
    buffer_load_dword v86, v12, s[20:23], s17 offen
    buffer_load_dword v87, v13, s[20:23], s17 offen
    s_waitcnt vmcnt(58)
    v_perm_b32 v5, v29, v28, s44
    v_perm_b32 v6, v29, v28, s45
    s_waitcnt vmcnt(56)
    v_perm_b32 v131, v31, v30, v11
    v_accvgpr_write_b32 a3, v5
    v_accvgpr_write_b32 a7, v6
    s_add_u32 s17, s49, 149760
    buffer_load_dword v88, v9, s[20:23], s17 offen
    buffer_load_dword v89, v10, s[20:23], s17 offen
    buffer_load_dword v90, v12, s[20:23], s17 offen
    buffer_load_dword v91, v13, s[20:23], s17 offen
    s_waitcnt vmcnt(58)
    v_perm_b32 v5, v33, v32, s44
    v_perm_b32 v6, v33, v32, s45
    s_waitcnt vmcnt(56)
    v_perm_b32 v132, v35, v34, v11
    v_accvgpr_write_b32 a8, v5
    v_accvgpr_write_b32 a12, v6
    s_add_u32 s17, s49, 150912
    buffer_load_dword v92, v9, s[20:23], s17 offen
    buffer_load_dword v93, v10, s[20:23], s17 offen
    buffer_load_dword v94, v12, s[20:23], s17 offen
    buffer_load_dword v95, v13, s[20:23], s17 offen
    s_waitcnt vmcnt(58)
    v_perm_b32 v5, v37, v36, s44
    v_perm_b32 v6, v37, v36, s45
    s_waitcnt vmcnt(56)
    v_perm_b32 v133, v39, v38, v11
    v_accvgpr_write_b32 a9, v5
    v_accvgpr_write_b32 a13, v6
    s_add_u32 s17, s49, 184320
    buffer_load_dword v96, v9, s[20:23], s17 offen
    buffer_load_dword v97, v10, s[20:23], s17 offen
    buffer_load_dword v98, v12, s[20:23], s17 offen
    buffer_load_dword v99, v13, s[20:23], s17 offen
    s_waitcnt vmcnt(58)
    v_perm_b32 v5, v41, v40, s44
    v_perm_b32 v6, v41, v40, s45
    s_waitcnt vmcnt(56)
    v_perm_b32 v134, v43, v42, v11
    v_accvgpr_write_b32 a10, v5
    v_accvgpr_write_b32 a14, v6
    s_add_u32 s17, s49, 185472
    buffer_load_dword v100, v9, s[20:23], s17 offen
    buffer_load_dword v101, v10, s[20:23], s17 offen
    buffer_load_dword v102, v12, s[20:23], s17 offen
    buffer_load_dword v103, v13, s[20:23], s17 offen
    s_waitcnt vmcnt(58)
    v_perm_b32 v5, v45, v44, s44
    v_perm_b32 v6, v45, v44, s45
    s_waitcnt vmcnt(56)
    v_perm_b32 v135, v47, v46, v11
    v_accvgpr_write_b32 a11, v5
    v_accvgpr_write_b32 a15, v6
    s_add_u32 s17, s49, 186624
    buffer_load_dword v104, v9, s[20:23], s17 offen
    buffer_load_dword v105, v10, s[20:23], s17 offen
    buffer_load_dword v106, v12, s[20:23], s17 offen
    buffer_load_dword v107, v13, s[20:23], s17 offen
    s_waitcnt vmcnt(58)
    v_perm_b32 v5, v49, v48, s44
    v_perm_b32 v6, v49, v48, s45
    s_waitcnt vmcnt(56)
    v_perm_b32 v136, v51, v50, v11
    v_accvgpr_write_b32 a16, v5
    v_accvgpr_write_b32 a20, v6
    s_add_u32 s17, s49, 187776
    buffer_load_dword v108, v9, s[20:23], s17 offen
    buffer_load_dword v109, v10, s[20:23], s17 offen
    buffer_load_dword v110, v12, s[20:23], s17 offen
    buffer_load_dword v111, v13, s[20:23], s17 offen
    s_waitcnt vmcnt(58)
    v_perm_b32 v5, v53, v52, s44
    v_perm_b32 v6, v53, v52, s45
    s_waitcnt vmcnt(56)
    v_perm_b32 v137, v55, v54, v11
    v_accvgpr_write_b32 a17, v5
    v_accvgpr_write_b32 a21, v6
    s_add_u32 s17, s49, 221184
    buffer_load_dword v112, v9, s[20:23], s17 offen
    buffer_load_dword v113, v10, s[20:23], s17 offen
    buffer_load_dword v114, v12, s[20:23], s17 offen
    buffer_load_dword v115, v13, s[20:23], s17 offen
    s_waitcnt vmcnt(58)
    v_perm_b32 v5, v57, v56, s44
    v_perm_b32 v6, v57, v56, s45
    s_waitcnt vmcnt(56)
    v_perm_b32 v138, v59, v58, v11
    v_accvgpr_write_b32 a18, v5
    v_accvgpr_write_b32 a22, v6
    s_add_u32 s17, s49, 222336
    buffer_load_dword v116, v9, s[20:23], s17 offen
    buffer_load_dword v117, v10, s[20:23], s17 offen
    buffer_load_dword v118, v12, s[20:23], s17 offen
    buffer_load_dword v119, v13, s[20:23], s17 offen
    s_waitcnt vmcnt(58)
    v_perm_b32 v5, v61, v60, s44
    v_perm_b32 v6, v61, v60, s45
    s_waitcnt vmcnt(56)
    v_perm_b32 v139, v63, v62, v11
    v_accvgpr_write_b32 a19, v5
    v_accvgpr_write_b32 a23, v6
    s_add_u32 s17, s49, 223488
    buffer_load_dword v120, v9, s[20:23], s17 offen
    buffer_load_dword v121, v10, s[20:23], s17 offen
    buffer_load_dword v122, v12, s[20:23], s17 offen
    buffer_load_dword v123, v13, s[20:23], s17 offen
    s_waitcnt vmcnt(58)
    v_perm_b32 v5, v65, v64, s44
    v_perm_b32 v6, v65, v64, s45
    s_waitcnt vmcnt(56)
    v_perm_b32 v140, v67, v66, v11
    v_accvgpr_write_b32 a24, v5
    v_accvgpr_write_b32 a28, v6
    s_add_u32 s17, s49, 224640
    buffer_load_dword v124, v9, s[20:23], s17 offen
    buffer_load_dword v125, v10, s[20:23], s17 offen
    buffer_load_dword v126, v12, s[20:23], s17 offen
    buffer_load_dword v127, v13, s[20:23], s17 offen
    s_waitcnt vmcnt(58)
    v_perm_b32 v5, v69, v68, s44
    v_perm_b32 v6, v69, v68, s45
    s_waitcnt vmcnt(56)
    v_perm_b32 v141, v71, v70, v11
    v_accvgpr_write_b32 a25, v5
    v_accvgpr_write_b32 a29, v6
    s_add_u32 s17, s49, 258048
    buffer_load_dword v16, v9, s[20:23], s17 offen
    buffer_load_dword v17, v10, s[20:23], s17 offen
    buffer_load_dword v18, v12, s[20:23], s17 offen
    buffer_load_dword v19, v13, s[20:23], s17 offen
    s_waitcnt vmcnt(58)
    v_perm_b32 v5, v73, v72, s44
    v_perm_b32 v6, v73, v72, s45
    s_waitcnt vmcnt(56)
    v_perm_b32 v142, v75, v74, v11
    v_accvgpr_write_b32 a26, v5
    v_accvgpr_write_b32 a30, v6
    s_add_u32 s17, s49, 259200
    buffer_load_dword v20, v9, s[20:23], s17 offen
    buffer_load_dword v21, v10, s[20:23], s17 offen
    buffer_load_dword v22, v12, s[20:23], s17 offen
    buffer_load_dword v23, v13, s[20:23], s17 offen
    s_waitcnt vmcnt(58)
    v_perm_b32 v5, v77, v76, s44
    v_perm_b32 v6, v77, v76, s45
    s_waitcnt vmcnt(56)
    v_perm_b32 v143, v79, v78, v11
    v_accvgpr_write_b32 a27, v5
    v_accvgpr_write_b32 a31, v6
    s_add_u32 s17, s49, 260352
    buffer_load_dword v24, v9, s[20:23], s17 offen
    buffer_load_dword v25, v10, s[20:23], s17 offen
    buffer_load_dword v26, v12, s[20:23], s17 offen
    buffer_load_dword v27, v13, s[20:23], s17 offen
    s_waitcnt vmcnt(58)
    v_perm_b32 v5, v81, v80, s44
    v_perm_b32 v6, v81, v80, s45
    s_waitcnt vmcnt(56)
    v_perm_b32 v144, v83, v82, v11
    v_accvgpr_write_b32 a32, v5
    v_accvgpr_write_b32 a36, v6
    s_add_u32 s17, s49, 261504
    buffer_load_dword v28, v9, s[20:23], s17 offen
    buffer_load_dword v29, v10, s[20:23], s17 offen
    buffer_load_dword v30, v12, s[20:23], s17 offen
    buffer_load_dword v31, v13, s[20:23], s17 offen
    s_waitcnt vmcnt(58)
    v_perm_b32 v5, v85, v84, s44
    v_perm_b32 v6, v85, v84, s45
    s_waitcnt vmcnt(56)
    v_perm_b32 v145, v87, v86, v11
    v_accvgpr_write_b32 a33, v5
    v_accvgpr_write_b32 a37, v6
    s_add_u32 s17, s49, 294912
    buffer_load_dword v32, v9, s[20:23], s17 offen
    buffer_load_dword v33, v10, s[20:23], s17 offen
    buffer_load_dword v34, v12, s[20:23], s17 offen
    buffer_load_dword v35, v13, s[20:23], s17 offen
    s_waitcnt vmcnt(58)
    v_perm_b32 v5, v89, v88, s44
    v_perm_b32 v6, v89, v88, s45
    s_waitcnt vmcnt(56)
    v_perm_b32 v146, v91, v90, v11
    v_accvgpr_write_b32 a34, v5
    v_accvgpr_write_b32 a38, v6
    s_add_u32 s17, s49, 296064
    buffer_load_dword v36, v9, s[20:23], s17 offen
    buffer_load_dword v37, v10, s[20:23], s17 offen
    buffer_load_dword v38, v12, s[20:23], s17 offen
    buffer_load_dword v39, v13, s[20:23], s17 offen
    s_waitcnt vmcnt(58)
    v_perm_b32 v5, v93, v92, s44
    v_perm_b32 v6, v93, v92, s45
    s_waitcnt vmcnt(56)
    v_perm_b32 v147, v95, v94, v11
    v_accvgpr_write_b32 a35, v5
    v_accvgpr_write_b32 a39, v6
    s_add_u32 s17, s49, 297216
    buffer_load_dword v40, v9, s[20:23], s17 offen
    buffer_load_dword v41, v10, s[20:23], s17 offen
    buffer_load_dword v42, v12, s[20:23], s17 offen
    buffer_load_dword v43, v13, s[20:23], s17 offen
    s_waitcnt vmcnt(58)
    v_perm_b32 v5, v97, v96, s44
    v_perm_b32 v6, v97, v96, s45
    s_waitcnt vmcnt(56)
    v_perm_b32 v148, v99, v98, v11
    v_accvgpr_write_b32 a40, v5
    v_accvgpr_write_b32 a44, v6
    s_add_u32 s17, s49, 298368
    buffer_load_dword v44, v9, s[20:23], s17 offen
    buffer_load_dword v45, v10, s[20:23], s17 offen
    buffer_load_dword v46, v12, s[20:23], s17 offen
    buffer_load_dword v47, v13, s[20:23], s17 offen
    s_waitcnt vmcnt(58)
    v_perm_b32 v5, v101, v100, s44
    v_perm_b32 v6, v101, v100, s45
    s_waitcnt vmcnt(56)
    v_perm_b32 v149, v103, v102, v11
    v_accvgpr_write_b32 a41, v5
    v_accvgpr_write_b32 a45, v6
    s_add_u32 s17, s49, 331776
    buffer_load_dword v48, v9, s[20:23], s17 offen
    buffer_load_dword v49, v10, s[20:23], s17 offen
    buffer_load_dword v50, v12, s[20:23], s17 offen
    buffer_load_dword v51, v13, s[20:23], s17 offen
    s_waitcnt vmcnt(58)
    v_perm_b32 v5, v105, v104, s44
    v_perm_b32 v6, v105, v104, s45
    s_waitcnt vmcnt(56)
    v_perm_b32 v150, v107, v106, v11
    v_accvgpr_write_b32 a42, v5
    v_accvgpr_write_b32 a46, v6
    s_add_u32 s17, s49, 332928
    buffer_load_dword v52, v9, s[20:23], s17 offen
    buffer_load_dword v53, v10, s[20:23], s17 offen
    buffer_load_dword v54, v12, s[20:23], s17 offen
    buffer_load_dword v55, v13, s[20:23], s17 offen
    s_waitcnt vmcnt(58)
    v_perm_b32 v5, v109, v108, s44
    v_perm_b32 v6, v109, v108, s45
    s_waitcnt vmcnt(56)
    v_perm_b32 v151, v111, v110, v11
    v_accvgpr_write_b32 a43, v5
    v_accvgpr_write_b32 a47, v6
    s_add_u32 s17, s49, 334080
    buffer_load_dword v56, v9, s[20:23], s17 offen
    buffer_load_dword v57, v10, s[20:23], s17 offen
    buffer_load_dword v58, v12, s[20:23], s17 offen
    buffer_load_dword v59, v13, s[20:23], s17 offen
    s_waitcnt vmcnt(58)
    v_perm_b32 v5, v113, v112, s44
    v_perm_b32 v6, v113, v112, s45
    s_waitcnt vmcnt(56)
    v_perm_b32 v152, v115, v114, v11
    v_accvgpr_write_b32 a48, v5
    v_accvgpr_write_b32 a52, v6
    s_add_u32 s17, s49, 335232
    buffer_load_dword v60, v9, s[20:23], s17 offen
    buffer_load_dword v61, v10, s[20:23], s17 offen
    buffer_load_dword v62, v12, s[20:23], s17 offen
    buffer_load_dword v63, v13, s[20:23], s17 offen
    s_waitcnt vmcnt(58)
    v_perm_b32 v5, v117, v116, s44
    v_perm_b32 v6, v117, v116, s45
    s_waitcnt vmcnt(56)
    v_perm_b32 v153, v119, v118, v11
    v_accvgpr_write_b32 a49, v5
    v_accvgpr_write_b32 a53, v6
    s_add_u32 s17, s49, 368640
    buffer_load_dword v64, v9, s[20:23], s17 offen
    buffer_load_dword v65, v10, s[20:23], s17 offen
    buffer_load_dword v66, v12, s[20:23], s17 offen
    buffer_load_dword v67, v13, s[20:23], s17 offen
    s_waitcnt vmcnt(58)
    v_perm_b32 v5, v121, v120, s44
    v_perm_b32 v6, v121, v120, s45
    s_waitcnt vmcnt(56)
    v_perm_b32 v154, v123, v122, v11
    v_accvgpr_write_b32 a50, v5
    v_accvgpr_write_b32 a54, v6
    s_add_u32 s17, s49, 369792
    buffer_load_dword v68, v9, s[20:23], s17 offen
    buffer_load_dword v69, v10, s[20:23], s17 offen
    buffer_load_dword v70, v12, s[20:23], s17 offen
    buffer_load_dword v71, v13, s[20:23], s17 offen
    s_waitcnt vmcnt(58)
    v_perm_b32 v5, v125, v124, s44
    v_perm_b32 v6, v125, v124, s45
    s_waitcnt vmcnt(56)
    v_perm_b32 v155, v127, v126, v11
    v_accvgpr_write_b32 a51, v5
    v_accvgpr_write_b32 a55, v6
    s_add_u32 s17, s49, 370944
    buffer_load_dword v72, v9, s[20:23], s17 offen
    buffer_load_dword v73, v10, s[20:23], s17 offen
    buffer_load_dword v74, v12, s[20:23], s17 offen
    buffer_load_dword v75, v13, s[20:23], s17 offen
    s_waitcnt vmcnt(58)
    v_perm_b32 v5, v17, v16, s44
    v_perm_b32 v6, v17, v16, s45
    s_waitcnt vmcnt(56)
    v_perm_b32 v156, v19, v18, v11
    v_accvgpr_write_b32 a56, v5
    v_accvgpr_write_b32 a60, v6
    s_add_u32 s17, s49, 372096
    buffer_load_dword v76, v9, s[20:23], s17 offen
    buffer_load_dword v77, v10, s[20:23], s17 offen
    buffer_load_dword v78, v12, s[20:23], s17 offen
    buffer_load_dword v79, v13, s[20:23], s17 offen
    s_waitcnt vmcnt(58)
    v_perm_b32 v5, v21, v20, s44
    v_perm_b32 v6, v21, v20, s45
    s_waitcnt vmcnt(56)
    v_perm_b32 v157, v23, v22, v11
    v_accvgpr_write_b32 a57, v5
    v_accvgpr_write_b32 a61, v6
    s_add_u32 s17, s49, 405504
    buffer_load_dword v80, v9, s[20:23], s17 offen
    buffer_load_dword v81, v10, s[20:23], s17 offen
    buffer_load_dword v82, v12, s[20:23], s17 offen
    buffer_load_dword v83, v13, s[20:23], s17 offen
    s_waitcnt vmcnt(58)
    v_perm_b32 v5, v25, v24, s44
    v_perm_b32 v6, v25, v24, s45
    s_waitcnt vmcnt(56)
    v_perm_b32 v158, v27, v26, v11
    v_accvgpr_write_b32 a58, v5
    v_accvgpr_write_b32 a62, v6
    s_add_u32 s17, s49, 406656
    buffer_load_dword v84, v9, s[20:23], s17 offen
    buffer_load_dword v85, v10, s[20:23], s17 offen
    buffer_load_dword v86, v12, s[20:23], s17 offen
    buffer_load_dword v87, v13, s[20:23], s17 offen
    s_waitcnt vmcnt(58)
    v_perm_b32 v5, v29, v28, s44
    v_perm_b32 v6, v29, v28, s45
    s_waitcnt vmcnt(56)
    v_perm_b32 v159, v31, v30, v11
    v_accvgpr_write_b32 a59, v5
    v_accvgpr_write_b32 a63, v6
    s_add_u32 s17, s49, 407808
    buffer_load_dword v88, v9, s[20:23], s17 offen
    buffer_load_dword v89, v10, s[20:23], s17 offen
    buffer_load_dword v90, v12, s[20:23], s17 offen
    buffer_load_dword v91, v13, s[20:23], s17 offen
    s_waitcnt vmcnt(58)
    v_perm_b32 v5, v33, v32, s44
    v_perm_b32 v6, v33, v32, s45
    s_waitcnt vmcnt(56)
    v_perm_b32 v160, v35, v34, v11
    v_accvgpr_write_b32 a64, v5
    v_accvgpr_write_b32 a68, v6
    s_add_u32 s17, s49, 408960
    buffer_load_dword v92, v9, s[20:23], s17 offen
    buffer_load_dword v93, v10, s[20:23], s17 offen
    buffer_load_dword v94, v12, s[20:23], s17 offen
    buffer_load_dword v95, v13, s[20:23], s17 offen
    s_waitcnt vmcnt(58)
    v_perm_b32 v5, v37, v36, s44
    v_perm_b32 v6, v37, v36, s45
    s_waitcnt vmcnt(56)
    v_perm_b32 v161, v39, v38, v11
    v_accvgpr_write_b32 a65, v5
    v_accvgpr_write_b32 a69, v6
    s_add_u32 s17, s49, 442368
    buffer_load_dword v96, v9, s[20:23], s17 offen
    buffer_load_dword v97, v10, s[20:23], s17 offen
    buffer_load_dword v98, v12, s[20:23], s17 offen
    buffer_load_dword v99, v13, s[20:23], s17 offen
    s_waitcnt vmcnt(58)
    v_perm_b32 v5, v41, v40, s44
    v_perm_b32 v6, v41, v40, s45
    s_waitcnt vmcnt(56)
    v_perm_b32 v162, v43, v42, v11
    v_accvgpr_write_b32 a66, v5
    v_accvgpr_write_b32 a70, v6
    s_add_u32 s17, s49, 443520
    buffer_load_dword v100, v9, s[20:23], s17 offen
    buffer_load_dword v101, v10, s[20:23], s17 offen
    buffer_load_dword v102, v12, s[20:23], s17 offen
    buffer_load_dword v103, v13, s[20:23], s17 offen
    s_waitcnt vmcnt(58)
    v_perm_b32 v5, v45, v44, s44
    v_perm_b32 v6, v45, v44, s45
    s_waitcnt vmcnt(56)
    v_perm_b32 v163, v47, v46, v11
    v_accvgpr_write_b32 a67, v5
    v_accvgpr_write_b32 a71, v6
    s_add_u32 s17, s49, 444672
    buffer_load_dword v104, v9, s[20:23], s17 offen
    buffer_load_dword v105, v10, s[20:23], s17 offen
    buffer_load_dword v106, v12, s[20:23], s17 offen
    buffer_load_dword v107, v13, s[20:23], s17 offen
    s_waitcnt vmcnt(58)
    v_perm_b32 v5, v49, v48, s44
    v_perm_b32 v6, v49, v48, s45
    s_waitcnt vmcnt(56)
    v_perm_b32 v164, v51, v50, v11
    v_accvgpr_write_b32 a72, v5
    v_accvgpr_write_b32 a76, v6
    s_add_u32 s17, s49, 445824
    buffer_load_dword v108, v9, s[20:23], s17 offen
    buffer_load_dword v109, v10, s[20:23], s17 offen
    buffer_load_dword v110, v12, s[20:23], s17 offen
    buffer_load_dword v111, v13, s[20:23], s17 offen
    s_waitcnt vmcnt(58)
    v_perm_b32 v5, v53, v52, s44
    v_perm_b32 v6, v53, v52, s45
    s_waitcnt vmcnt(56)
    v_perm_b32 v165, v55, v54, v11
    v_accvgpr_write_b32 a73, v5
    v_accvgpr_write_b32 a77, v6
    s_add_u32 s17, s49, 479232
    buffer_load_dword v112, v9, s[20:23], s17 offen
    buffer_load_dword v113, v10, s[20:23], s17 offen
    buffer_load_dword v114, v12, s[20:23], s17 offen
    buffer_load_dword v115, v13, s[20:23], s17 offen
    s_waitcnt vmcnt(58)
    v_perm_b32 v5, v57, v56, s44
    v_perm_b32 v6, v57, v56, s45
    s_waitcnt vmcnt(56)
    v_perm_b32 v166, v59, v58, v11
    v_accvgpr_write_b32 a74, v5
    v_accvgpr_write_b32 a78, v6
    s_add_u32 s17, s49, 480384
    buffer_load_dword v116, v9, s[20:23], s17 offen
    buffer_load_dword v117, v10, s[20:23], s17 offen
    buffer_load_dword v118, v12, s[20:23], s17 offen
    buffer_load_dword v119, v13, s[20:23], s17 offen
    s_waitcnt vmcnt(58)
    v_perm_b32 v5, v61, v60, s44
    v_perm_b32 v6, v61, v60, s45
    s_waitcnt vmcnt(56)
    v_perm_b32 v167, v63, v62, v11
    v_accvgpr_write_b32 a75, v5
    v_accvgpr_write_b32 a79, v6
    s_add_u32 s17, s49, 481536
    buffer_load_dword v120, v9, s[20:23], s17 offen
    buffer_load_dword v121, v10, s[20:23], s17 offen
    buffer_load_dword v122, v12, s[20:23], s17 offen
    buffer_load_dword v123, v13, s[20:23], s17 offen
    s_waitcnt vmcnt(58)
    v_perm_b32 v5, v65, v64, s44
    v_perm_b32 v6, v65, v64, s45
    s_waitcnt vmcnt(56)
    v_perm_b32 v168, v67, v66, v11
    v_accvgpr_write_b32 a80, v5
    v_accvgpr_write_b32 a84, v6
    s_add_u32 s17, s49, 482688
    buffer_load_dword v124, v9, s[20:23], s17 offen
    buffer_load_dword v125, v10, s[20:23], s17 offen
    buffer_load_dword v126, v12, s[20:23], s17 offen
    buffer_load_dword v127, v13, s[20:23], s17 offen
    s_waitcnt vmcnt(58)
    v_perm_b32 v5, v69, v68, s44
    v_perm_b32 v6, v69, v68, s45
    s_waitcnt vmcnt(56)
    v_perm_b32 v169, v71, v70, v11
    v_accvgpr_write_b32 a81, v5
    v_accvgpr_write_b32 a85, v6
    s_add_u32 s17, s49, 516096
    buffer_load_dword v16, v9, s[20:23], s17 offen
    buffer_load_dword v17, v10, s[20:23], s17 offen
    buffer_load_dword v18, v12, s[20:23], s17 offen
    buffer_load_dword v19, v13, s[20:23], s17 offen
    s_waitcnt vmcnt(58)
    v_perm_b32 v5, v73, v72, s44
    v_perm_b32 v6, v73, v72, s45
    s_waitcnt vmcnt(56)
    v_perm_b32 v170, v75, v74, v11
    v_accvgpr_write_b32 a82, v5
    v_accvgpr_write_b32 a86, v6
    s_add_u32 s17, s49, 517248
    buffer_load_dword v20, v9, s[20:23], s17 offen
    buffer_load_dword v21, v10, s[20:23], s17 offen
    buffer_load_dword v22, v12, s[20:23], s17 offen
    buffer_load_dword v23, v13, s[20:23], s17 offen
    s_waitcnt vmcnt(58)
    v_perm_b32 v5, v77, v76, s44
    v_perm_b32 v6, v77, v76, s45
    s_waitcnt vmcnt(56)
    v_perm_b32 v171, v79, v78, v11
    v_accvgpr_write_b32 a83, v5
    v_accvgpr_write_b32 a87, v6
    s_add_u32 s17, s49, 518400
    buffer_load_dword v24, v9, s[20:23], s17 offen
    buffer_load_dword v25, v10, s[20:23], s17 offen
    buffer_load_dword v26, v12, s[20:23], s17 offen
    buffer_load_dword v27, v13, s[20:23], s17 offen
    s_waitcnt vmcnt(58)
    v_perm_b32 v5, v81, v80, s44
    v_perm_b32 v6, v81, v80, s45
    s_waitcnt vmcnt(56)
    v_perm_b32 v172, v83, v82, v11
    v_accvgpr_write_b32 a88, v5
    v_accvgpr_write_b32 a92, v6
    s_add_u32 s17, s49, 519552
    buffer_load_dword v28, v9, s[20:23], s17 offen
    buffer_load_dword v29, v10, s[20:23], s17 offen
    buffer_load_dword v30, v12, s[20:23], s17 offen
    buffer_load_dword v31, v13, s[20:23], s17 offen
    s_waitcnt vmcnt(58)
    v_perm_b32 v5, v85, v84, s44
    v_perm_b32 v6, v85, v84, s45
    s_waitcnt vmcnt(56)
    v_perm_b32 v173, v87, v86, v11
    v_accvgpr_write_b32 a89, v5
    v_accvgpr_write_b32 a93, v6
    s_add_u32 s17, s49, 552960
    buffer_load_dword v32, v9, s[20:23], s17 offen
    buffer_load_dword v33, v10, s[20:23], s17 offen
    buffer_load_dword v34, v12, s[20:23], s17 offen
    buffer_load_dword v35, v13, s[20:23], s17 offen
    s_waitcnt vmcnt(58)
    v_perm_b32 v5, v89, v88, s44
    v_perm_b32 v6, v89, v88, s45
    s_waitcnt vmcnt(56)
    v_perm_b32 v174, v91, v90, v11
    v_accvgpr_write_b32 a90, v5
    v_accvgpr_write_b32 a94, v6
    s_add_u32 s17, s49, 554112
    buffer_load_dword v36, v9, s[20:23], s17 offen
    buffer_load_dword v37, v10, s[20:23], s17 offen
    buffer_load_dword v38, v12, s[20:23], s17 offen
    buffer_load_dword v39, v13, s[20:23], s17 offen
    s_waitcnt vmcnt(58)
    v_perm_b32 v5, v93, v92, s44
    v_perm_b32 v6, v93, v92, s45
    s_waitcnt vmcnt(56)
    v_perm_b32 v175, v95, v94, v11
    v_accvgpr_write_b32 a91, v5
    v_accvgpr_write_b32 a95, v6
    s_add_u32 s17, s49, 555264
    buffer_load_dword v40, v9, s[20:23], s17 offen
    buffer_load_dword v41, v10, s[20:23], s17 offen
    buffer_load_dword v42, v12, s[20:23], s17 offen
    buffer_load_dword v43, v13, s[20:23], s17 offen
    s_waitcnt vmcnt(58)
    v_perm_b32 v5, v97, v96, s44
    v_perm_b32 v6, v97, v96, s45
    s_waitcnt vmcnt(56)
    v_perm_b32 v176, v99, v98, v11
    v_accvgpr_write_b32 a96, v5
    v_accvgpr_write_b32 a100, v6
    s_add_u32 s17, s49, 556416
    buffer_load_dword v44, v9, s[20:23], s17 offen
    buffer_load_dword v45, v10, s[20:23], s17 offen
    buffer_load_dword v46, v12, s[20:23], s17 offen
    buffer_load_dword v47, v13, s[20:23], s17 offen
    s_waitcnt vmcnt(58)
    v_perm_b32 v5, v101, v100, s44
    v_perm_b32 v6, v101, v100, s45
    s_waitcnt vmcnt(56)
    v_perm_b32 v177, v103, v102, v11
    v_accvgpr_write_b32 a97, v5
    v_accvgpr_write_b32 a101, v6
    s_add_u32 s17, s49, 589824
    buffer_load_dword v48, v9, s[20:23], s17 offen
    buffer_load_dword v49, v10, s[20:23], s17 offen
    buffer_load_dword v50, v12, s[20:23], s17 offen
    buffer_load_dword v51, v13, s[20:23], s17 offen
    s_waitcnt vmcnt(58)
    v_perm_b32 v5, v105, v104, s44
    v_perm_b32 v6, v105, v104, s45
    s_waitcnt vmcnt(56)
    v_perm_b32 v178, v107, v106, v11
    v_accvgpr_write_b32 a98, v5
    v_accvgpr_write_b32 a102, v6
    s_add_u32 s17, s49, 590976
    buffer_load_dword v52, v9, s[20:23], s17 offen
    buffer_load_dword v53, v10, s[20:23], s17 offen
    buffer_load_dword v54, v12, s[20:23], s17 offen
    buffer_load_dword v55, v13, s[20:23], s17 offen
    s_waitcnt vmcnt(58)
    v_perm_b32 v5, v109, v108, s44
    v_perm_b32 v6, v109, v108, s45
    s_waitcnt vmcnt(56)
    v_perm_b32 v179, v111, v110, v11
    v_accvgpr_write_b32 a99, v5
    v_accvgpr_write_b32 a103, v6
    s_add_u32 s17, s49, 592128
    buffer_load_dword v56, v9, s[20:23], s17 offen
    buffer_load_dword v57, v10, s[20:23], s17 offen
    buffer_load_dword v58, v12, s[20:23], s17 offen
    buffer_load_dword v59, v13, s[20:23], s17 offen
    s_waitcnt vmcnt(58)
    v_perm_b32 v5, v113, v112, s44
    v_perm_b32 v6, v113, v112, s45
    s_waitcnt vmcnt(56)
    v_perm_b32 v180, v115, v114, v11
    v_accvgpr_write_b32 a104, v5
    v_accvgpr_write_b32 a108, v6
    s_add_u32 s17, s49, 593280
    buffer_load_dword v60, v9, s[20:23], s17 offen
    buffer_load_dword v61, v10, s[20:23], s17 offen
    buffer_load_dword v62, v12, s[20:23], s17 offen
    buffer_load_dword v63, v13, s[20:23], s17 offen
    s_waitcnt vmcnt(58)
    v_perm_b32 v5, v117, v116, s44
    v_perm_b32 v6, v117, v116, s45
    s_waitcnt vmcnt(56)
    v_perm_b32 v181, v119, v118, v11
    v_accvgpr_write_b32 a105, v5
    v_accvgpr_write_b32 a109, v6
    s_add_u32 s17, s49, 626688
    buffer_load_dword v64, v9, s[20:23], s17 offen
    buffer_load_dword v65, v10, s[20:23], s17 offen
    buffer_load_dword v66, v12, s[20:23], s17 offen
    buffer_load_dword v67, v13, s[20:23], s17 offen
    s_waitcnt vmcnt(58)
    v_perm_b32 v5, v121, v120, s44
    v_perm_b32 v6, v121, v120, s45
    s_waitcnt vmcnt(56)
    v_perm_b32 v182, v123, v122, v11
    v_accvgpr_write_b32 a106, v5
    v_accvgpr_write_b32 a110, v6
    s_add_u32 s17, s49, 627840
    buffer_load_dword v68, v9, s[20:23], s17 offen
    buffer_load_dword v69, v10, s[20:23], s17 offen
    buffer_load_dword v70, v12, s[20:23], s17 offen
    buffer_load_dword v71, v13, s[20:23], s17 offen
    s_waitcnt vmcnt(58)
    v_perm_b32 v5, v125, v124, s44
    v_perm_b32 v6, v125, v124, s45
    s_waitcnt vmcnt(56)
    v_perm_b32 v183, v127, v126, v11
    v_accvgpr_write_b32 a107, v5
    v_accvgpr_write_b32 a111, v6
    s_add_u32 s17, s49, 628992
    buffer_load_dword v72, v9, s[20:23], s17 offen
    buffer_load_dword v73, v10, s[20:23], s17 offen
    buffer_load_dword v74, v12, s[20:23], s17 offen
    buffer_load_dword v75, v13, s[20:23], s17 offen
    s_waitcnt vmcnt(58)
    v_perm_b32 v5, v17, v16, s44
    v_perm_b32 v6, v17, v16, s45
    s_waitcnt vmcnt(56)
    v_perm_b32 v184, v19, v18, v11
    v_accvgpr_write_b32 a112, v5
    v_accvgpr_write_b32 a116, v6
    s_add_u32 s17, s49, 630144
    buffer_load_dword v76, v9, s[20:23], s17 offen
    buffer_load_dword v77, v10, s[20:23], s17 offen
    buffer_load_dword v78, v12, s[20:23], s17 offen
    buffer_load_dword v79, v13, s[20:23], s17 offen
    s_waitcnt vmcnt(58)
    v_perm_b32 v5, v21, v20, s44
    v_perm_b32 v6, v21, v20, s45
    s_waitcnt vmcnt(56)
    v_perm_b32 v185, v23, v22, v11
    v_accvgpr_write_b32 a113, v5
    v_accvgpr_write_b32 a117, v6
    s_add_u32 s17, s49, 663552
    buffer_load_dword v80, v9, s[20:23], s17 offen
    buffer_load_dword v81, v10, s[20:23], s17 offen
    buffer_load_dword v82, v12, s[20:23], s17 offen
    buffer_load_dword v83, v13, s[20:23], s17 offen
    s_waitcnt vmcnt(58)
    v_perm_b32 v5, v25, v24, s44
    v_perm_b32 v6, v25, v24, s45
    s_waitcnt vmcnt(56)
    v_perm_b32 v186, v27, v26, v11
    v_accvgpr_write_b32 a114, v5
    v_accvgpr_write_b32 a118, v6
    s_add_u32 s17, s49, 664704
    buffer_load_dword v84, v9, s[20:23], s17 offen
    buffer_load_dword v85, v10, s[20:23], s17 offen
    buffer_load_dword v86, v12, s[20:23], s17 offen
    buffer_load_dword v87, v13, s[20:23], s17 offen
    s_waitcnt vmcnt(58)
    v_perm_b32 v5, v29, v28, s44
    v_perm_b32 v6, v29, v28, s45
    s_waitcnt vmcnt(56)
    v_perm_b32 v187, v31, v30, v11
    v_accvgpr_write_b32 a115, v5
    v_accvgpr_write_b32 a119, v6
    s_add_u32 s17, s49, 665856
    buffer_load_dword v88, v9, s[20:23], s17 offen
    buffer_load_dword v89, v10, s[20:23], s17 offen
    buffer_load_dword v90, v12, s[20:23], s17 offen
    buffer_load_dword v91, v13, s[20:23], s17 offen
    s_waitcnt vmcnt(58)
    v_perm_b32 v5, v33, v32, s44
    v_perm_b32 v6, v33, v32, s45
    s_waitcnt vmcnt(56)
    v_perm_b32 v188, v35, v34, v11
    v_accvgpr_write_b32 a120, v5
    v_accvgpr_write_b32 a124, v6
    s_add_u32 s17, s49, 667008
    buffer_load_dword v92, v9, s[20:23], s17 offen
    buffer_load_dword v93, v10, s[20:23], s17 offen
    buffer_load_dword v94, v12, s[20:23], s17 offen
    buffer_load_dword v95, v13, s[20:23], s17 offen
    s_waitcnt vmcnt(58)
    v_perm_b32 v5, v37, v36, s44
    v_perm_b32 v6, v37, v36, s45
    s_waitcnt vmcnt(56)
    v_perm_b32 v189, v39, v38, v11
    v_accvgpr_write_b32 a121, v5
    v_accvgpr_write_b32 a125, v6
    s_add_u32 s17, s49, 700416
    buffer_load_dword v96, v9, s[20:23], s17 offen
    buffer_load_dword v97, v10, s[20:23], s17 offen
    buffer_load_dword v98, v12, s[20:23], s17 offen
    buffer_load_dword v99, v13, s[20:23], s17 offen
    s_waitcnt vmcnt(58)
    v_perm_b32 v5, v41, v40, s44
    v_perm_b32 v6, v41, v40, s45
    s_waitcnt vmcnt(56)
    v_perm_b32 v190, v43, v42, v11
    v_accvgpr_write_b32 a122, v5
    v_accvgpr_write_b32 a126, v6
    s_add_u32 s17, s49, 701568
    buffer_load_dword v100, v9, s[20:23], s17 offen
    buffer_load_dword v101, v10, s[20:23], s17 offen
    buffer_load_dword v102, v12, s[20:23], s17 offen
    buffer_load_dword v103, v13, s[20:23], s17 offen
    s_waitcnt vmcnt(58)
    v_perm_b32 v5, v45, v44, s44
    v_perm_b32 v6, v45, v44, s45
    s_waitcnt vmcnt(56)
    v_perm_b32 v191, v47, v46, v11
    v_accvgpr_write_b32 a123, v5
    v_accvgpr_write_b32 a127, v6
    s_add_u32 s17, s49, 702720
    buffer_load_dword v104, v9, s[20:23], s17 offen
    buffer_load_dword v105, v10, s[20:23], s17 offen
    buffer_load_dword v106, v12, s[20:23], s17 offen
    buffer_load_dword v107, v13, s[20:23], s17 offen
    s_waitcnt vmcnt(58)
    v_perm_b32 v5, v49, v48, s44
    v_perm_b32 v6, v49, v48, s45
    s_waitcnt vmcnt(56)
    v_perm_b32 v192, v51, v50, v11
    v_accvgpr_write_b32 a128, v5
    v_accvgpr_write_b32 a132, v6
    s_add_u32 s17, s49, 703872
    buffer_load_dword v108, v9, s[20:23], s17 offen
    buffer_load_dword v109, v10, s[20:23], s17 offen
    buffer_load_dword v110, v12, s[20:23], s17 offen
    buffer_load_dword v111, v13, s[20:23], s17 offen
    s_waitcnt vmcnt(58)
    v_perm_b32 v5, v53, v52, s44
    v_perm_b32 v6, v53, v52, s45
    s_waitcnt vmcnt(56)
    v_perm_b32 v193, v55, v54, v11
    v_accvgpr_write_b32 a129, v5
    v_accvgpr_write_b32 a133, v6
    s_add_u32 s17, s49, 737280
    buffer_load_dword v112, v9, s[20:23], s17 offen
    buffer_load_dword v113, v10, s[20:23], s17 offen
    buffer_load_dword v114, v12, s[20:23], s17 offen
    buffer_load_dword v115, v13, s[20:23], s17 offen
    s_waitcnt vmcnt(58)
    v_perm_b32 v5, v57, v56, s44
    v_perm_b32 v6, v57, v56, s45
    s_waitcnt vmcnt(56)
    v_perm_b32 v194, v59, v58, v11
    v_accvgpr_write_b32 a130, v5
    v_accvgpr_write_b32 a134, v6
    s_add_u32 s17, s49, 738432
    buffer_load_dword v116, v9, s[20:23], s17 offen
    buffer_load_dword v117, v10, s[20:23], s17 offen
    buffer_load_dword v118, v12, s[20:23], s17 offen
    buffer_load_dword v119, v13, s[20:23], s17 offen
    s_waitcnt vmcnt(58)
    v_perm_b32 v5, v61, v60, s44
    v_perm_b32 v6, v61, v60, s45
    s_waitcnt vmcnt(56)
    v_perm_b32 v195, v63, v62, v11
    v_accvgpr_write_b32 a131, v5
    v_accvgpr_write_b32 a135, v6
    s_add_u32 s17, s49, 739584
    buffer_load_dword v120, v9, s[20:23], s17 offen
    buffer_load_dword v121, v10, s[20:23], s17 offen
    buffer_load_dword v122, v12, s[20:23], s17 offen
    buffer_load_dword v123, v13, s[20:23], s17 offen
    s_waitcnt vmcnt(58)
    v_perm_b32 v5, v65, v64, s44
    v_perm_b32 v6, v65, v64, s45
    s_waitcnt vmcnt(56)
    v_perm_b32 v196, v67, v66, v11
    v_accvgpr_write_b32 a136, v5
    v_accvgpr_write_b32 a140, v6
    s_add_u32 s17, s49, 740736
    buffer_load_dword v124, v9, s[20:23], s17 offen
    buffer_load_dword v125, v10, s[20:23], s17 offen
    buffer_load_dword v126, v12, s[20:23], s17 offen
    buffer_load_dword v127, v13, s[20:23], s17 offen
    s_waitcnt vmcnt(58)
    v_perm_b32 v5, v69, v68, s44
    v_perm_b32 v6, v69, v68, s45
    s_waitcnt vmcnt(56)
    v_perm_b32 v197, v71, v70, v11
    v_accvgpr_write_b32 a137, v5
    v_accvgpr_write_b32 a141, v6
    s_add_u32 s17, s49, 774144
    buffer_load_dword v16, v9, s[20:23], s17 offen
    buffer_load_dword v17, v10, s[20:23], s17 offen
    buffer_load_dword v18, v12, s[20:23], s17 offen
    buffer_load_dword v19, v13, s[20:23], s17 offen
    s_waitcnt vmcnt(58)
    v_perm_b32 v5, v73, v72, s44
    v_perm_b32 v6, v73, v72, s45
    s_waitcnt vmcnt(56)
    v_perm_b32 v198, v75, v74, v11
    v_accvgpr_write_b32 a138, v5
    v_accvgpr_write_b32 a142, v6
    s_add_u32 s17, s49, 775296
    buffer_load_dword v20, v9, s[20:23], s17 offen
    buffer_load_dword v21, v10, s[20:23], s17 offen
    buffer_load_dword v22, v12, s[20:23], s17 offen
    buffer_load_dword v23, v13, s[20:23], s17 offen
    s_waitcnt vmcnt(58)
    v_perm_b32 v5, v77, v76, s44
    v_perm_b32 v6, v77, v76, s45
    s_waitcnt vmcnt(56)
    v_perm_b32 v199, v79, v78, v11
    v_accvgpr_write_b32 a139, v5
    v_accvgpr_write_b32 a143, v6
    s_add_u32 s17, s49, 776448
    buffer_load_dword v24, v9, s[20:23], s17 offen
    buffer_load_dword v25, v10, s[20:23], s17 offen
    buffer_load_dword v26, v12, s[20:23], s17 offen
    buffer_load_dword v27, v13, s[20:23], s17 offen
    s_waitcnt vmcnt(58)
    v_perm_b32 v5, v81, v80, s44
    v_perm_b32 v6, v81, v80, s45
    s_waitcnt vmcnt(56)
    v_perm_b32 v200, v83, v82, v11
    v_accvgpr_write_b32 a144, v5
    v_accvgpr_write_b32 a148, v6
    s_add_u32 s17, s49, 777600
    buffer_load_dword v28, v9, s[20:23], s17 offen
    buffer_load_dword v29, v10, s[20:23], s17 offen
    buffer_load_dword v30, v12, s[20:23], s17 offen
    buffer_load_dword v31, v13, s[20:23], s17 offen
    s_waitcnt vmcnt(58)
    v_perm_b32 v5, v85, v84, s44
    v_perm_b32 v6, v85, v84, s45
    s_waitcnt vmcnt(56)
    v_perm_b32 v201, v87, v86, v11
    v_accvgpr_write_b32 a145, v5
    v_accvgpr_write_b32 a149, v6
    s_add_u32 s17, s49, 811008
    buffer_load_dword v32, v9, s[20:23], s17 offen
    buffer_load_dword v33, v10, s[20:23], s17 offen
    buffer_load_dword v34, v12, s[20:23], s17 offen
    buffer_load_dword v35, v13, s[20:23], s17 offen
    s_waitcnt vmcnt(58)
    v_perm_b32 v5, v89, v88, s44
    v_perm_b32 v6, v89, v88, s45
    s_waitcnt vmcnt(56)
    v_perm_b32 v202, v91, v90, v11
    v_accvgpr_write_b32 a146, v5
    v_accvgpr_write_b32 a150, v6
    s_add_u32 s17, s49, 812160
    buffer_load_dword v36, v9, s[20:23], s17 offen
    buffer_load_dword v37, v10, s[20:23], s17 offen
    buffer_load_dword v38, v12, s[20:23], s17 offen
    buffer_load_dword v39, v13, s[20:23], s17 offen
    s_waitcnt vmcnt(58)
    v_perm_b32 v5, v93, v92, s44
    v_perm_b32 v6, v93, v92, s45
    s_waitcnt vmcnt(56)
    v_perm_b32 v203, v95, v94, v11
    v_accvgpr_write_b32 a147, v5
    v_accvgpr_write_b32 a151, v6
    s_add_u32 s17, s49, 813312
    buffer_load_dword v40, v9, s[20:23], s17 offen
    buffer_load_dword v41, v10, s[20:23], s17 offen
    buffer_load_dword v42, v12, s[20:23], s17 offen
    buffer_load_dword v43, v13, s[20:23], s17 offen
    s_waitcnt vmcnt(58)
    v_perm_b32 v5, v97, v96, s44
    v_perm_b32 v6, v97, v96, s45
    s_waitcnt vmcnt(56)
    v_perm_b32 v204, v99, v98, v11
    v_accvgpr_write_b32 a152, v5
    v_accvgpr_write_b32 a156, v6
    s_add_u32 s17, s49, 814464
    buffer_load_dword v44, v9, s[20:23], s17 offen
    buffer_load_dword v45, v10, s[20:23], s17 offen
    buffer_load_dword v46, v12, s[20:23], s17 offen
    buffer_load_dword v47, v13, s[20:23], s17 offen
    s_waitcnt vmcnt(58)
    v_perm_b32 v5, v101, v100, s44
    v_perm_b32 v6, v101, v100, s45
    s_waitcnt vmcnt(56)
    v_perm_b32 v205, v103, v102, v11
    v_accvgpr_write_b32 a153, v5
    v_accvgpr_write_b32 a157, v6
    s_add_u32 s17, s49, 847872
    buffer_load_dword v48, v9, s[20:23], s17 offen
    buffer_load_dword v49, v10, s[20:23], s17 offen
    buffer_load_dword v50, v12, s[20:23], s17 offen
    buffer_load_dword v51, v13, s[20:23], s17 offen
    s_waitcnt vmcnt(58)
    v_perm_b32 v5, v105, v104, s44
    v_perm_b32 v6, v105, v104, s45
    s_waitcnt vmcnt(56)
    v_perm_b32 v206, v107, v106, v11
    v_accvgpr_write_b32 a154, v5
    v_accvgpr_write_b32 a158, v6
    s_add_u32 s17, s49, 849024
    buffer_load_dword v52, v9, s[20:23], s17 offen
    buffer_load_dword v53, v10, s[20:23], s17 offen
    buffer_load_dword v54, v12, s[20:23], s17 offen
    buffer_load_dword v55, v13, s[20:23], s17 offen
    s_waitcnt vmcnt(58)
    v_perm_b32 v5, v109, v108, s44
    v_perm_b32 v6, v109, v108, s45
    s_waitcnt vmcnt(56)
    v_perm_b32 v207, v111, v110, v11
    v_accvgpr_write_b32 a155, v5
    v_accvgpr_write_b32 a159, v6
    s_add_u32 s17, s49, 850176
    buffer_load_dword v56, v9, s[20:23], s17 offen
    buffer_load_dword v57, v10, s[20:23], s17 offen
    buffer_load_dword v58, v12, s[20:23], s17 offen
    buffer_load_dword v59, v13, s[20:23], s17 offen
    s_waitcnt vmcnt(58)
    v_perm_b32 v5, v113, v112, s44
    v_perm_b32 v6, v113, v112, s45
    s_waitcnt vmcnt(56)
    v_perm_b32 v208, v115, v114, v11
    v_accvgpr_write_b32 a160, v5
    v_accvgpr_write_b32 a164, v6
    s_add_u32 s17, s49, 851328
    buffer_load_dword v60, v9, s[20:23], s17 offen
    buffer_load_dword v61, v10, s[20:23], s17 offen
    buffer_load_dword v62, v12, s[20:23], s17 offen
    buffer_load_dword v63, v13, s[20:23], s17 offen
    s_waitcnt vmcnt(58)
    v_perm_b32 v5, v117, v116, s44
    v_perm_b32 v6, v117, v116, s45
    s_waitcnt vmcnt(56)
    v_perm_b32 v209, v119, v118, v11
    v_accvgpr_write_b32 a161, v5
    v_accvgpr_write_b32 a165, v6
    s_add_u32 s17, s49, 884736
    buffer_load_dword v64, v9, s[20:23], s17 offen
    buffer_load_dword v65, v10, s[20:23], s17 offen
    buffer_load_dword v66, v12, s[20:23], s17 offen
    buffer_load_dword v67, v13, s[20:23], s17 offen
    s_waitcnt vmcnt(58)
    v_perm_b32 v5, v121, v120, s44
    v_perm_b32 v6, v121, v120, s45
    s_waitcnt vmcnt(56)
    v_perm_b32 v210, v123, v122, v11
    v_accvgpr_write_b32 a162, v5
    v_accvgpr_write_b32 a166, v6
    s_add_u32 s17, s49, 885888
    buffer_load_dword v68, v9, s[20:23], s17 offen
    buffer_load_dword v69, v10, s[20:23], s17 offen
    buffer_load_dword v70, v12, s[20:23], s17 offen
    buffer_load_dword v71, v13, s[20:23], s17 offen
    s_waitcnt vmcnt(58)
    v_perm_b32 v5, v125, v124, s44
    v_perm_b32 v6, v125, v124, s45
    s_waitcnt vmcnt(56)
    v_perm_b32 v211, v127, v126, v11
    v_accvgpr_write_b32 a163, v5
    v_accvgpr_write_b32 a167, v6
    s_add_u32 s17, s49, 887040
    buffer_load_dword v72, v9, s[20:23], s17 offen
    buffer_load_dword v73, v10, s[20:23], s17 offen
    buffer_load_dword v74, v12, s[20:23], s17 offen
    buffer_load_dword v75, v13, s[20:23], s17 offen
    s_waitcnt vmcnt(58)
    v_perm_b32 v5, v17, v16, s44
    v_perm_b32 v6, v17, v16, s45
    s_waitcnt vmcnt(56)
    v_perm_b32 v212, v19, v18, v11
    v_accvgpr_write_b32 a168, v5
    v_accvgpr_write_b32 a172, v6
    s_add_u32 s17, s49, 888192
    buffer_load_dword v76, v9, s[20:23], s17 offen
    buffer_load_dword v77, v10, s[20:23], s17 offen
    buffer_load_dword v78, v12, s[20:23], s17 offen
    buffer_load_dword v79, v13, s[20:23], s17 offen
    s_waitcnt vmcnt(58)
    v_perm_b32 v5, v21, v20, s44
    v_perm_b32 v6, v21, v20, s45
    s_waitcnt vmcnt(56)
    v_perm_b32 v213, v23, v22, v11
    v_accvgpr_write_b32 a169, v5
    v_accvgpr_write_b32 a173, v6
    s_add_u32 s17, s49, 921600
    buffer_load_dword v80, v9, s[20:23], s17 offen
    buffer_load_dword v81, v10, s[20:23], s17 offen
    buffer_load_dword v82, v12, s[20:23], s17 offen
    buffer_load_dword v83, v13, s[20:23], s17 offen
    s_waitcnt vmcnt(58)
    v_perm_b32 v5, v25, v24, s44
    v_perm_b32 v6, v25, v24, s45
    s_waitcnt vmcnt(56)
    v_perm_b32 v214, v27, v26, v11
    v_accvgpr_write_b32 a170, v5
    v_accvgpr_write_b32 a174, v6
    s_add_u32 s17, s49, 922752
    buffer_load_dword v84, v9, s[20:23], s17 offen
    buffer_load_dword v85, v10, s[20:23], s17 offen
    buffer_load_dword v86, v12, s[20:23], s17 offen
    buffer_load_dword v87, v13, s[20:23], s17 offen
    s_waitcnt vmcnt(58)
    v_perm_b32 v5, v29, v28, s44
    v_perm_b32 v6, v29, v28, s45
    s_waitcnt vmcnt(56)
    v_perm_b32 v215, v31, v30, v11
    v_accvgpr_write_b32 a171, v5
    v_accvgpr_write_b32 a175, v6
    s_add_u32 s17, s49, 923904
    buffer_load_dword v88, v9, s[20:23], s17 offen
    buffer_load_dword v89, v10, s[20:23], s17 offen
    buffer_load_dword v90, v12, s[20:23], s17 offen
    buffer_load_dword v91, v13, s[20:23], s17 offen
    s_waitcnt vmcnt(58)
    v_perm_b32 v5, v33, v32, s44
    v_perm_b32 v6, v33, v32, s45
    s_waitcnt vmcnt(56)
    v_perm_b32 v216, v35, v34, v11
    v_accvgpr_write_b32 a176, v5
    v_accvgpr_write_b32 a180, v6
    s_add_u32 s17, s49, 925056
    buffer_load_dword v92, v9, s[20:23], s17 offen
    buffer_load_dword v93, v10, s[20:23], s17 offen
    buffer_load_dword v94, v12, s[20:23], s17 offen
    buffer_load_dword v95, v13, s[20:23], s17 offen
    s_waitcnt vmcnt(58)
    v_perm_b32 v5, v37, v36, s44
    v_perm_b32 v6, v37, v36, s45
    s_waitcnt vmcnt(56)
    v_perm_b32 v217, v39, v38, v11
    v_accvgpr_write_b32 a177, v5
    v_accvgpr_write_b32 a181, v6
    s_add_u32 s17, s49, 958464
    buffer_load_dword v96, v9, s[20:23], s17 offen
    buffer_load_dword v97, v10, s[20:23], s17 offen
    buffer_load_dword v98, v12, s[20:23], s17 offen
    buffer_load_dword v99, v13, s[20:23], s17 offen
    s_waitcnt vmcnt(58)
    v_perm_b32 v5, v41, v40, s44
    v_perm_b32 v6, v41, v40, s45
    s_waitcnt vmcnt(56)
    v_perm_b32 v218, v43, v42, v11
    v_accvgpr_write_b32 a178, v5
    v_accvgpr_write_b32 a182, v6
    s_add_u32 s17, s49, 959616
    buffer_load_dword v100, v9, s[20:23], s17 offen
    buffer_load_dword v101, v10, s[20:23], s17 offen
    buffer_load_dword v102, v12, s[20:23], s17 offen
    buffer_load_dword v103, v13, s[20:23], s17 offen
    s_waitcnt vmcnt(58)
    v_perm_b32 v5, v45, v44, s44
    v_perm_b32 v6, v45, v44, s45
    s_waitcnt vmcnt(56)
    v_perm_b32 v219, v47, v46, v11
    v_accvgpr_write_b32 a179, v5
    v_accvgpr_write_b32 a183, v6
    s_add_u32 s17, s49, 960768
    buffer_load_dword v104, v9, s[20:23], s17 offen
    buffer_load_dword v105, v10, s[20:23], s17 offen
    buffer_load_dword v106, v12, s[20:23], s17 offen
    buffer_load_dword v107, v13, s[20:23], s17 offen
    s_waitcnt vmcnt(58)
    v_perm_b32 v5, v49, v48, s44
    v_perm_b32 v6, v49, v48, s45
    s_waitcnt vmcnt(56)
    v_perm_b32 v220, v51, v50, v11
    v_accvgpr_write_b32 a184, v5
    v_accvgpr_write_b32 a188, v6
    s_add_u32 s17, s49, 961920
    buffer_load_dword v108, v9, s[20:23], s17 offen
    buffer_load_dword v109, v10, s[20:23], s17 offen
    buffer_load_dword v110, v12, s[20:23], s17 offen
    buffer_load_dword v111, v13, s[20:23], s17 offen
    s_waitcnt vmcnt(58)
    v_perm_b32 v5, v53, v52, s44
    v_perm_b32 v6, v53, v52, s45
    s_waitcnt vmcnt(56)
    v_perm_b32 v221, v55, v54, v11
    v_accvgpr_write_b32 a185, v5
    v_accvgpr_write_b32 a189, v6
    s_add_u32 s17, s49, 995328
    buffer_load_dword v112, v9, s[20:23], s17 offen
    buffer_load_dword v113, v10, s[20:23], s17 offen
    buffer_load_dword v114, v12, s[20:23], s17 offen
    buffer_load_dword v115, v13, s[20:23], s17 offen
    s_waitcnt vmcnt(58)
    v_perm_b32 v5, v57, v56, s44
    v_perm_b32 v6, v57, v56, s45
    s_waitcnt vmcnt(56)
    v_perm_b32 v222, v59, v58, v11
    v_accvgpr_write_b32 a186, v5
    v_accvgpr_write_b32 a190, v6
    s_add_u32 s17, s49, 996480
    buffer_load_dword v116, v9, s[20:23], s17 offen
    buffer_load_dword v117, v10, s[20:23], s17 offen
    buffer_load_dword v118, v12, s[20:23], s17 offen
    buffer_load_dword v119, v13, s[20:23], s17 offen
    s_waitcnt vmcnt(58)
    v_perm_b32 v5, v61, v60, s44
    v_perm_b32 v6, v61, v60, s45
    s_waitcnt vmcnt(56)
    v_perm_b32 v223, v63, v62, v11
    v_accvgpr_write_b32 a187, v5
    v_accvgpr_write_b32 a191, v6
    s_add_u32 s17, s49, 997632
    buffer_load_dword v120, v9, s[20:23], s17 offen
    buffer_load_dword v121, v10, s[20:23], s17 offen
    buffer_load_dword v122, v12, s[20:23], s17 offen
    buffer_load_dword v123, v13, s[20:23], s17 offen
    s_waitcnt vmcnt(58)
    v_perm_b32 v5, v65, v64, s44
    v_perm_b32 v6, v65, v64, s45
    s_waitcnt vmcnt(56)
    v_perm_b32 v224, v67, v66, v11
    v_accvgpr_write_b32 a192, v5
    v_accvgpr_write_b32 a196, v6
    s_add_u32 s17, s49, 998784
    buffer_load_dword v124, v9, s[20:23], s17 offen
    buffer_load_dword v125, v10, s[20:23], s17 offen
    buffer_load_dword v126, v12, s[20:23], s17 offen
    buffer_load_dword v127, v13, s[20:23], s17 offen
    s_waitcnt vmcnt(58)
    v_perm_b32 v5, v69, v68, s44
    v_perm_b32 v6, v69, v68, s45
    s_waitcnt vmcnt(56)
    v_perm_b32 v225, v71, v70, v11
    v_accvgpr_write_b32 a193, v5
    v_accvgpr_write_b32 a197, v6
    s_add_u32 s17, s49, 1032192
    buffer_load_dword v16, v9, s[20:23], s17 offen
    buffer_load_dword v17, v10, s[20:23], s17 offen
    buffer_load_dword v18, v12, s[20:23], s17 offen
    buffer_load_dword v19, v13, s[20:23], s17 offen
    s_waitcnt vmcnt(58)
    v_perm_b32 v5, v73, v72, s44
    v_perm_b32 v6, v73, v72, s45
    s_waitcnt vmcnt(56)
    v_perm_b32 v226, v75, v74, v11
    v_accvgpr_write_b32 a194, v5
    v_accvgpr_write_b32 a198, v6
    s_add_u32 s17, s49, 1033344
    buffer_load_dword v20, v9, s[20:23], s17 offen
    buffer_load_dword v21, v10, s[20:23], s17 offen
    buffer_load_dword v22, v12, s[20:23], s17 offen
    buffer_load_dword v23, v13, s[20:23], s17 offen
    s_waitcnt vmcnt(58)
    v_perm_b32 v5, v77, v76, s44
    v_perm_b32 v6, v77, v76, s45
    s_waitcnt vmcnt(56)
    v_perm_b32 v227, v79, v78, v11
    v_accvgpr_write_b32 a195, v5
    v_accvgpr_write_b32 a199, v6
    s_add_u32 s17, s49, 1034496
    buffer_load_dword v24, v9, s[20:23], s17 offen
    buffer_load_dword v25, v10, s[20:23], s17 offen
    buffer_load_dword v26, v12, s[20:23], s17 offen
    buffer_load_dword v27, v13, s[20:23], s17 offen
    s_waitcnt vmcnt(58)
    v_perm_b32 v5, v81, v80, s44
    v_perm_b32 v6, v81, v80, s45
    s_waitcnt vmcnt(56)
    v_perm_b32 v228, v83, v82, v11
    v_accvgpr_write_b32 a200, v5
    v_accvgpr_write_b32 a204, v6
    s_add_u32 s17, s49, 1035648
    buffer_load_dword v28, v9, s[20:23], s17 offen
    buffer_load_dword v29, v10, s[20:23], s17 offen
    buffer_load_dword v30, v12, s[20:23], s17 offen
    buffer_load_dword v31, v13, s[20:23], s17 offen
    s_waitcnt vmcnt(58)
    v_perm_b32 v5, v85, v84, s44
    v_perm_b32 v6, v85, v84, s45
    s_waitcnt vmcnt(56)
    v_perm_b32 v229, v87, v86, v11
    v_accvgpr_write_b32 a201, v5
    v_accvgpr_write_b32 a205, v6
    s_add_u32 s17, s49, 1069056
    buffer_load_dword v32, v9, s[20:23], s17 offen
    buffer_load_dword v33, v10, s[20:23], s17 offen
    buffer_load_dword v34, v12, s[20:23], s17 offen
    buffer_load_dword v35, v13, s[20:23], s17 offen
    s_waitcnt vmcnt(58)
    v_perm_b32 v5, v89, v88, s44
    v_perm_b32 v6, v89, v88, s45
    s_waitcnt vmcnt(56)
    v_perm_b32 v230, v91, v90, v11
    v_accvgpr_write_b32 a202, v5
    v_accvgpr_write_b32 a206, v6
    s_add_u32 s17, s49, 1070208
    buffer_load_dword v36, v9, s[20:23], s17 offen
    buffer_load_dword v37, v10, s[20:23], s17 offen
    buffer_load_dword v38, v12, s[20:23], s17 offen
    buffer_load_dword v39, v13, s[20:23], s17 offen
    s_waitcnt vmcnt(58)
    v_perm_b32 v5, v93, v92, s44
    v_perm_b32 v6, v93, v92, s45
    s_waitcnt vmcnt(56)
    v_perm_b32 v231, v95, v94, v11
    v_accvgpr_write_b32 a203, v5
    v_accvgpr_write_b32 a207, v6
    s_add_u32 s17, s49, 1071360
    buffer_load_dword v40, v9, s[20:23], s17 offen
    buffer_load_dword v41, v10, s[20:23], s17 offen
    buffer_load_dword v42, v12, s[20:23], s17 offen
    buffer_load_dword v43, v13, s[20:23], s17 offen
    s_waitcnt vmcnt(58)
    v_perm_b32 v5, v97, v96, s44
    v_perm_b32 v6, v97, v96, s45
    s_waitcnt vmcnt(56)
    v_perm_b32 v232, v99, v98, v11
    v_accvgpr_write_b32 a208, v5
    v_accvgpr_write_b32 a212, v6
    s_add_u32 s17, s49, 1072512
    buffer_load_dword v44, v9, s[20:23], s17 offen
    buffer_load_dword v45, v10, s[20:23], s17 offen
    buffer_load_dword v46, v12, s[20:23], s17 offen
    buffer_load_dword v47, v13, s[20:23], s17 offen
    s_waitcnt vmcnt(58)
    v_perm_b32 v5, v101, v100, s44
    v_perm_b32 v6, v101, v100, s45
    s_waitcnt vmcnt(56)
    v_perm_b32 v233, v103, v102, v11
    v_accvgpr_write_b32 a209, v5
    v_accvgpr_write_b32 a213, v6
    s_add_u32 s17, s49, 1105920
    buffer_load_dword v48, v9, s[20:23], s17 offen
    buffer_load_dword v49, v10, s[20:23], s17 offen
    buffer_load_dword v50, v12, s[20:23], s17 offen
    buffer_load_dword v51, v13, s[20:23], s17 offen
    s_waitcnt vmcnt(58)
    v_perm_b32 v5, v105, v104, s44
    v_perm_b32 v6, v105, v104, s45
    s_waitcnt vmcnt(56)
    v_perm_b32 v234, v107, v106, v11
    v_accvgpr_write_b32 a210, v5
    v_accvgpr_write_b32 a214, v6
    s_add_u32 s17, s49, 1107072
    buffer_load_dword v52, v9, s[20:23], s17 offen
    buffer_load_dword v53, v10, s[20:23], s17 offen
    buffer_load_dword v54, v12, s[20:23], s17 offen
    buffer_load_dword v55, v13, s[20:23], s17 offen
    s_waitcnt vmcnt(58)
    v_perm_b32 v5, v109, v108, s44
    v_perm_b32 v6, v109, v108, s45
    s_waitcnt vmcnt(56)
    v_perm_b32 v235, v111, v110, v11
    v_accvgpr_write_b32 a211, v5
    v_accvgpr_write_b32 a215, v6
    s_add_u32 s17, s49, 1108224
    buffer_load_dword v56, v9, s[20:23], s17 offen
    buffer_load_dword v57, v10, s[20:23], s17 offen
    buffer_load_dword v58, v12, s[20:23], s17 offen
    buffer_load_dword v59, v13, s[20:23], s17 offen
    s_waitcnt vmcnt(58)
    v_perm_b32 v5, v113, v112, s44
    v_perm_b32 v6, v113, v112, s45
    s_waitcnt vmcnt(56)
    v_perm_b32 v236, v115, v114, v11
    v_accvgpr_write_b32 a216, v5
    v_accvgpr_write_b32 a220, v6
    s_add_u32 s17, s49, 1109376
    buffer_load_dword v60, v9, s[20:23], s17 offen
    buffer_load_dword v61, v10, s[20:23], s17 offen
    buffer_load_dword v62, v12, s[20:23], s17 offen
    buffer_load_dword v63, v13, s[20:23], s17 offen
    s_waitcnt vmcnt(58)
    v_perm_b32 v5, v117, v116, s44
    v_perm_b32 v6, v117, v116, s45
    s_waitcnt vmcnt(56)
    v_perm_b32 v237, v119, v118, v11
    v_accvgpr_write_b32 a217, v5
    v_accvgpr_write_b32 a221, v6
    s_add_u32 s17, s49, 1142784
    buffer_load_dword v64, v9, s[20:23], s17 offen
    buffer_load_dword v65, v10, s[20:23], s17 offen
    buffer_load_dword v66, v12, s[20:23], s17 offen
    buffer_load_dword v67, v13, s[20:23], s17 offen
    s_waitcnt vmcnt(58)
    v_perm_b32 v5, v121, v120, s44
    v_perm_b32 v6, v121, v120, s45
    s_waitcnt vmcnt(56)
    v_perm_b32 v238, v123, v122, v11
    v_accvgpr_write_b32 a218, v5
    v_accvgpr_write_b32 a222, v6
    s_add_u32 s17, s49, 1143936
    buffer_load_dword v68, v9, s[20:23], s17 offen
    buffer_load_dword v69, v10, s[20:23], s17 offen
    buffer_load_dword v70, v12, s[20:23], s17 offen
    buffer_load_dword v71, v13, s[20:23], s17 offen
    s_waitcnt vmcnt(58)
    v_perm_b32 v5, v125, v124, s44
    v_perm_b32 v6, v125, v124, s45
    s_waitcnt vmcnt(56)
    v_perm_b32 v239, v127, v126, v11
    v_accvgpr_write_b32 a219, v5
    v_accvgpr_write_b32 a223, v6
    s_add_u32 s17, s49, 1145088
    buffer_load_dword v72, v9, s[20:23], s17 offen
    buffer_load_dword v73, v10, s[20:23], s17 offen
    buffer_load_dword v74, v12, s[20:23], s17 offen
    buffer_load_dword v75, v13, s[20:23], s17 offen
    s_waitcnt vmcnt(58)
    v_perm_b32 v5, v17, v16, s44
    v_perm_b32 v6, v17, v16, s45
    s_waitcnt vmcnt(56)
    v_perm_b32 v240, v19, v18, v11
    v_accvgpr_write_b32 a224, v5
    v_accvgpr_write_b32 a228, v6
    s_add_u32 s17, s49, 1146240
    buffer_load_dword v76, v9, s[20:23], s17 offen
    buffer_load_dword v77, v10, s[20:23], s17 offen
    buffer_load_dword v78, v12, s[20:23], s17 offen
    buffer_load_dword v79, v13, s[20:23], s17 offen
    s_waitcnt vmcnt(58)
    v_perm_b32 v5, v21, v20, s44
    v_perm_b32 v6, v21, v20, s45
    s_waitcnt vmcnt(56)
    v_perm_b32 v241, v23, v22, v11
    v_accvgpr_write_b32 a225, v5
    v_accvgpr_write_b32 a229, v6
    s_waitcnt vmcnt(54)
    v_perm_b32 v5, v25, v24, s44
    v_perm_b32 v6, v25, v24, s45
    s_waitcnt vmcnt(52)
    v_perm_b32 v242, v27, v26, v11
    v_accvgpr_write_b32 a226, v5
    v_accvgpr_write_b32 a230, v6
    s_waitcnt vmcnt(50)
    v_perm_b32 v5, v29, v28, s44
    v_perm_b32 v6, v29, v28, s45
    s_waitcnt vmcnt(48)
    v_perm_b32 v243, v31, v30, v11
    v_accvgpr_write_b32 a227, v5
    v_accvgpr_write_b32 a231, v6
    s_waitcnt vmcnt(46)
    v_perm_b32 v5, v33, v32, s44
    v_perm_b32 v6, v33, v32, s45
    s_waitcnt vmcnt(44)
    v_perm_b32 v244, v35, v34, v11
    v_accvgpr_write_b32 a232, v5
    v_accvgpr_write_b32 a236, v6
    s_waitcnt vmcnt(42)
    v_perm_b32 v5, v37, v36, s44
    v_perm_b32 v6, v37, v36, s45
    s_waitcnt vmcnt(40)
    v_perm_b32 v245, v39, v38, v11
    v_accvgpr_write_b32 a233, v5
    v_accvgpr_write_b32 a237, v6
    s_waitcnt vmcnt(38)
    v_perm_b32 v5, v41, v40, s44
    v_perm_b32 v6, v41, v40, s45
    s_waitcnt vmcnt(36)
    v_perm_b32 v246, v43, v42, v11
    v_accvgpr_write_b32 a234, v5
    v_accvgpr_write_b32 a238, v6
    s_waitcnt vmcnt(34)
    v_perm_b32 v5, v45, v44, s44
    v_perm_b32 v6, v45, v44, s45
    s_waitcnt vmcnt(32)
    v_perm_b32 v247, v47, v46, v11
    v_accvgpr_write_b32 a235, v5
    v_accvgpr_write_b32 a239, v6
    s_waitcnt vmcnt(30)
    v_perm_b32 v5, v49, v48, s44
    v_perm_b32 v6, v49, v48, s45
    s_waitcnt vmcnt(28)
    v_perm_b32 v248, v51, v50, v11
    v_accvgpr_write_b32 a240, v5
    v_accvgpr_write_b32 a244, v6
    s_waitcnt vmcnt(26)
    v_perm_b32 v5, v53, v52, s44
    v_perm_b32 v6, v53, v52, s45
    s_waitcnt vmcnt(24)
    v_perm_b32 v249, v55, v54, v11
    v_accvgpr_write_b32 a241, v5
    v_accvgpr_write_b32 a245, v6
    s_waitcnt vmcnt(22)
    v_perm_b32 v5, v57, v56, s44
    v_perm_b32 v6, v57, v56, s45
    s_waitcnt vmcnt(20)
    v_perm_b32 v250, v59, v58, v11
    v_accvgpr_write_b32 a242, v5
    v_accvgpr_write_b32 a246, v6
    s_waitcnt vmcnt(18)
    v_perm_b32 v5, v61, v60, s44
    v_perm_b32 v6, v61, v60, s45
    s_waitcnt vmcnt(16)
    v_perm_b32 v251, v63, v62, v11
    v_accvgpr_write_b32 a243, v5
    v_accvgpr_write_b32 a247, v6
    s_waitcnt vmcnt(14)
    v_perm_b32 v5, v65, v64, s44
    v_perm_b32 v6, v65, v64, s45
    s_waitcnt vmcnt(12)
    v_perm_b32 v252, v67, v66, v11
    v_accvgpr_write_b32 a248, v5
    v_accvgpr_write_b32 a252, v6
    s_waitcnt vmcnt(10)
    v_perm_b32 v5, v69, v68, s44
    v_perm_b32 v6, v69, v68, s45
    s_waitcnt vmcnt(8)
    v_perm_b32 v253, v71, v70, v11
    v_accvgpr_write_b32 a249, v5
    v_accvgpr_write_b32 a253, v6
    s_waitcnt vmcnt(6)
    v_perm_b32 v5, v73, v72, s44
    v_perm_b32 v6, v73, v72, s45
    s_waitcnt vmcnt(4)
    v_perm_b32 v254, v75, v74, v11
    v_accvgpr_write_b32 a250, v5
    v_accvgpr_write_b32 a254, v6
    s_waitcnt vmcnt(2)
    v_perm_b32 v5, v77, v76, s44
    v_perm_b32 v6, v77, v76, s45
    s_waitcnt vmcnt(0)
    v_perm_b32 v255, v79, v78, v11
    v_accvgpr_write_b32 a251, v5
    v_accvgpr_write_b32 a255, v6
    s_and_b32 s51, s14, 1
    s_lshl_b32 s17, s51, 4
    v_add_u32 v5, s17, v7
    v_lshlrev_b32 v14, 4, v5
    v_mul_u32_u24 v13, 1152, v5
    s_mul_i32 s17, s50, 96
    v_add_u32 v13, s17, v13
    s_mul_i32 s17, s50, 3072
    v_add_u32 v12, s17, v14
    s_lshl_b32 s17, s50, 9
    v_add_u32 v14, s17, v14
    s_lshl_b32 s49, s50, 7
    s_lshl_b32 s17, s14, 2
    s_add_u32 s49, s49, s17
    s_add_u32 s49, s49, 1441792
    s_mul_i32 s17, s14, 6144
    v_add_u32 v48, s17, v0
    v_mov_b32 v49, 0x10000
    s_mul_i32 s17, s50, 43
    v_lshrrev_b32 v10, 4, v0
    v_add_u32 v10, s17, v10
    v_min_u32 v10, 511, v10
    v_lshlrev_b32 v10, 7, v10
    s_cmp_gt_u32 s14, 1
    s_cbranch_scc1 Ltw_z
    v_lshl_add_u32 v12, v8, 9, v12
    v_lshl_add_u32 v13, v8, 4, v13
    s_lshl_b32 s58, s14, 16
    s_add_u32 s58, s58, 144703488
    s_mov_b32 s43, 0
    s_mov_b32 s28, s8
    s_mov_b32 s29, s9
    s_mov_b32 s30, 0
    s_mov_b32 s31, 0x00020000
    s_mul_i32 s17, s51, 3072
    v_add_u32 v50, s17, v0
    ds_write2_b32 v49, v4, v4 offset0:0 offset1:1
    s_waitcnt lgkmcnt(0)
    s_cmp_lg_u32 s14, 0
    s_cbranch_scc1 LtwX_inia_d
    v_mov_b32 v5, 40
    s_mov_b32 s16, 0
LtwX_inia:
    global_load_dword v6, v5, s[12:13] sc1
    s_add_u32 s16, s16, 1
    s_cmp_gt_u32 s16, 100000
    s_cbranch_scc1 L_role_tw_abort
    s_waitcnt vmcnt(0)
    v_cmp_gt_u32 vcc, 128, v6
    s_nop 0
    s_cbranch_vccz LtwX_inia_d
    s_sleep 8
    s_branch LtwX_inia
LtwX_inia_d:
    s_barrier
    s_cmp_lg_u32 s14, 0
    s_cbranch_scc1 LtwX_inib_d
    v_mov_b32 v5, 160
    s_mov_b32 s16, 0
LtwX_inib:
    global_load_dword v6, v5, s[12:13] sc1
    s_add_u32 s16, s16, 1
    s_cmp_gt_u32 s16, 100000
    s_cbranch_scc1 L_role_tw_abort
    s_waitcnt vmcnt(0)
    v_cmp_gt_u32 vcc, 64, v6
    s_nop 0
    s_cbranch_vccz LtwX_inib_d
    s_sleep 8
    s_branch LtwX_inib
LtwX_inib_d:
    s_barrier
LtwX_idle:
    s_cmp_lg_u32 s14, 0
    s_cbranch_scc1 LtwX_nw0
    s_mul_i32 s60, s32, 22528
    s_add_u32 s60, s60, 4224
    s_cmp_lt_u32 s32, 64
    s_cselect_b32 s60, s60, 2883584
    s_mul_i32 s61, s33, 22528
    s_add_u32 s61, s61, 1446016
    s_cmp_lt_u32 s33, 64
    s_cselect_b32 s61, s61, 2883584
    s_mov_b32 s16, 0
LtwX_p_9:
    buffer_load_dword v2, v1, s[8:11], s60 offen sc1
    buffer_load_dword v15, v1, s[8:11], s61 offen sc1
    s_add_u32 s16, s16, 1
    s_cmp_gt_u32 s16, 100000
    s_cbranch_scc1 L_role_tw_abort
    s_waitcnt vmcnt(1)
    v_cmp_eq_u32 vcc, 0, v2
    s_waitcnt vmcnt(0)
    v_cmp_eq_u32 s[54:55], 0, v15
    s_nop 0
    s_cmp_eq_u64 s[54:55], 0
    s_cselect_b32 s62, 2, 0
    s_cmp_eq_u64 vcc, 0
    s_cselect_b32 s62, 1, s62
    s_cmp_lg_u32 s62, 0
    s_cbranch_scc1 LtwX_p_9d
    s_sleep 4
    s_branch LtwX_p_9
LtwX_p_9d:
    v_mov_b32 v5, s62
    ds_write_b32 v49, v5
    s_waitcnt lgkmcnt(0)
LtwX_nw0:
    s_barrier
    ds_read_b32 v6, v49
    v_xor_b32 v49, 4, v49
    s_waitcnt lgkmcnt(0)
    v_readfirstlane_b32 s62, v6
    s_nop 0
    s_cmp_eq_u32 s62, 0
    s_cbranch_scc1 L_role_tw_abort
    s_cmp_lt_u32 s33, 29
    s_cselect_b32 s38, 1, 3
    s_cmp_eq_u32 s62, 2
    s_cselect_b32 s36, 1, 0
    s_cselect_b32 s37, s33, s32
    s_cselect_b32 s17, s38, 0
    s_add_u32 s33, s33, s17
    s_cmp_eq_u32 s62, 1
    s_cselect_b32 s17, 2, 0
    s_add_u32 s32, s32, s17
    s_lshl_b32 s56, s36, 6
    s_add_u32 s56, s56, s37
    s_lshl_b32 s46, s56, 18
    s_add_u32 s46, s46, s58
    s_mul_i32 s41, s36, 4718592
    s_mul_i32 s17, s37, 36864
    s_add_u32 s41, s41, s17
    s_add_u32 s41, s41, 8650752
    s_cmp_ge_u32 s37, 64
    s_cbranch_scc1 L_role_tw_abort
    buffer_load_dword v9, v10, s[8:11], s46 offen
    s_add_u32 s48, s46, 0
    buffer_load_dwordx4 v[64:67], v0, s[8:11], s48 offen offset:0
    buffer_load_dwordx4 v[68:71], v0, s[8:11], s48 offen offset:1024
    buffer_load_dwordx4 v[72:75], v0, s[8:11], s48 offen offset:2048
    buffer_load_dwordx4 v[76:79], v0, s[8:11], s48 offen offset:3072
    s_add_u32 s48, s46, 4096
    buffer_load_dwordx4 v[80:83], v0, s[8:11], s48 offen offset:0
    buffer_load_dwordx4 v[84:87], v0, s[8:11], s48 offen offset:1024
    buffer_load_dwordx4 v[88:91], v0, s[8:11], s48 offen offset:2048
    buffer_load_dwordx4 v[92:95], v0, s[8:11], s48 offen offset:3072
    s_add_u32 s48, s46, 8192
    buffer_load_dwordx4 v[96:99], v0, s[8:11], s48 offen offset:0
    buffer_load_dwordx4 v[100:103], v0, s[8:11], s48 offen offset:1024
    buffer_load_dwordx4 v[104:107], v0, s[8:11], s48 offen offset:2048
    buffer_load_dwordx4 v[108:111], v0, s[8:11], s48 offen offset:3072
    s_add_u32 s48, s46, 12288
    buffer_load_dwordx4 v[112:115], v0, s[8:11], s48 offen offset:0
    buffer_load_dwordx4 v[116:119], v0, s[8:11], s48 offen offset:1024
    buffer_load_dwordx4 v[120:123], v0, s[8:11], s48 offen offset:2048
    buffer_load_dwordx4 v[40:43], v12, s[8:11], s41 offen
LtwX_item:
    s_mov_b32 s34, s36
    s_mov_b32 s35, s37
    s_mov_b32 s47, s41
    buffer_load_dwordx4 v[124:127], v0, s[8:11], s48 offen offset:3072
    s_waitcnt vmcnt(15)
    v_mfma_f32_16x16x32_bf16 v[16:19], a[0:3], v[64:67], 0
    v_mfma_f32_16x16x32_bf16 v[20:23], a[4:7], v[64:67], 0
    v_mfma_f32_16x16x32_bf16 v[24:27], v[128:131], v[64:67], 0
    s_add_u32 s48, s46, 16384
    buffer_load_dwordx4 v[64:67], v0, s[8:11], s48 offen offset:0
    s_waitcnt vmcnt(15)
    v_mfma_f32_16x16x32_bf16 v[28:31], a[0:3], v[68:71], 0
    v_mfma_f32_16x16x32_bf16 v[32:35], a[4:7], v[68:71], 0
    v_mfma_f32_16x16x32_bf16 v[36:39], v[128:131], v[68:71], 0
    buffer_load_dwordx4 v[68:71], v0, s[8:11], s48 offen offset:1024
    s_waitcnt vmcnt(15)
    v_mfma_f32_16x16x32_bf16 v[16:19], a[8:11], v[72:75], v[16:19]
    v_mfma_f32_16x16x32_bf16 v[20:23], a[12:15], v[72:75], v[20:23]
    v_mfma_f32_16x16x32_bf16 v[24:27], v[132:135], v[72:75], v[24:27]
    buffer_load_dwordx4 v[72:75], v0, s[8:11], s48 offen offset:2048
    s_waitcnt vmcnt(15)
    v_mfma_f32_16x16x32_bf16 v[28:31], a[8:11], v[76:79], v[28:31]
    v_mfma_f32_16x16x32_bf16 v[32:35], a[12:15], v[76:79], v[32:35]
    v_mfma_f32_16x16x32_bf16 v[36:39], v[132:135], v[76:79], v[36:39]
    buffer_load_dwordx4 v[76:79], v0, s[8:11], s48 offen offset:3072
    s_waitcnt vmcnt(15)
    v_mfma_f32_16x16x32_bf16 v[16:19], a[16:19], v[80:83], v[16:19]
    v_mfma_f32_16x16x32_bf16 v[20:23], a[20:23], v[80:83], v[20:23]
    v_mfma_f32_16x16x32_bf16 v[24:27], v[136:139], v[80:83], v[24:27]
    s_add_u32 s48, s46, 20480
    buffer_load_dwordx4 v[80:83], v0, s[8:11], s48 offen offset:0
    s_waitcnt vmcnt(15)
    v_mfma_f32_16x16x32_bf16 v[28:31], a[16:19], v[84:87], v[28:31]
    v_mfma_f32_16x16x32_bf16 v[32:35], a[20:23], v[84:87], v[32:35]
    v_mfma_f32_16x16x32_bf16 v[36:39], v[136:139], v[84:87], v[36:39]
    buffer_load_dwordx4 v[84:87], v0, s[8:11], s48 offen offset:1024
    s_waitcnt vmcnt(15)
    v_mfma_f32_16x16x32_bf16 v[16:19], a[24:27], v[88:91], v[16:19]
    v_mfma_f32_16x16x32_bf16 v[20:23], a[28:31], v[88:91], v[20:23]
    v_mfma_f32_16x16x32_bf16 v[24:27], v[140:143], v[88:91], v[24:27]
    buffer_load_dwordx4 v[88:91], v0, s[8:11], s48 offen offset:2048
    s_waitcnt vmcnt(15)
    v_mfma_f32_16x16x32_bf16 v[28:31], a[24:27], v[92:95], v[28:31]
    v_mfma_f32_16x16x32_bf16 v[32:35], a[28:31], v[92:95], v[32:35]
    v_mfma_f32_16x16x32_bf16 v[36:39], v[140:143], v[92:95], v[36:39]
    buffer_load_dwordx4 v[92:95], v0, s[8:11], s48 offen offset:3072
    s_waitcnt vmcnt(15)
    v_mfma_f32_16x16x32_bf16 v[16:19], a[32:35], v[96:99], v[16:19]
    v_mfma_f32_16x16x32_bf16 v[20:23], a[36:39], v[96:99], v[20:23]
    v_mfma_f32_16x16x32_bf16 v[24:27], v[144:147], v[96:99], v[24:27]
    s_add_u32 s48, s46, 24576
    buffer_load_dwordx4 v[96:99], v0, s[8:11], s48 offen offset:0
    s_waitcnt vmcnt(15)
    v_mfma_f32_16x16x32_bf16 v[28:31], a[32:35], v[100:103], v[28:31]
    v_mfma_f32_16x16x32_bf16 v[32:35], a[36:39], v[100:103], v[32:35]
    v_mfma_f32_16x16x32_bf16 v[36:39], v[144:147], v[100:103], v[36:39]
    buffer_load_dwordx4 v[100:103], v0, s[8:11], s48 offen offset:1024
    s_waitcnt vmcnt(15)
    v_mfma_f32_16x16x32_bf16 v[16:19], a[40:43], v[104:107], v[16:19]
    v_mfma_f32_16x16x32_bf16 v[20:23], a[44:47], v[104:107], v[20:23]
    v_mfma_f32_16x16x32_bf16 v[24:27], v[148:151], v[104:107], v[24:27]
    buffer_load_dwordx4 v[104:107], v0, s[8:11], s48 offen offset:2048
    s_waitcnt vmcnt(15)
    v_mfma_f32_16x16x32_bf16 v[28:31], a[40:43], v[108:111], v[28:31]
    v_mfma_f32_16x16x32_bf16 v[32:35], a[44:47], v[108:111], v[32:35]
    v_mfma_f32_16x16x32_bf16 v[36:39], v[148:151], v[108:111], v[36:39]
    buffer_load_dwordx4 v[108:111], v0, s[8:11], s48 offen offset:3072
    s_waitcnt vmcnt(15)
    v_mfma_f32_16x16x32_bf16 v[16:19], a[48:51], v[112:115], v[16:19]
    v_mfma_f32_16x16x32_bf16 v[20:23], a[52:55], v[112:115], v[20:23]
    v_mfma_f32_16x16x32_bf16 v[24:27], v[152:155], v[112:115], v[24:27]
    s_add_u32 s48, s46, 28672
    buffer_load_dwordx4 v[112:115], v0, s[8:11], s48 offen offset:0
    s_waitcnt vmcnt(15)
    v_mfma_f32_16x16x32_bf16 v[28:31], a[48:51], v[116:119], v[28:31]
    v_mfma_f32_16x16x32_bf16 v[32:35], a[52:55], v[116:119], v[32:35]
    v_mfma_f32_16x16x32_bf16 v[36:39], v[152:155], v[116:119], v[36:39]
    buffer_load_dwordx4 v[116:119], v0, s[8:11], s48 offen offset:1024
    s_waitcnt vmcnt(15)
    v_mfma_f32_16x16x32_bf16 v[16:19], a[56:59], v[120:123], v[16:19]
    v_mfma_f32_16x16x32_bf16 v[20:23], a[60:63], v[120:123], v[20:23]
    v_mfma_f32_16x16x32_bf16 v[24:27], v[156:159], v[120:123], v[24:27]
    buffer_load_dwordx4 v[120:123], v0, s[8:11], s48 offen offset:2048
    s_waitcnt vmcnt(15)
    v_mfma_f32_16x16x32_bf16 v[28:31], a[56:59], v[124:127], v[28:31]
    v_mfma_f32_16x16x32_bf16 v[32:35], a[60:63], v[124:127], v[32:35]
    v_mfma_f32_16x16x32_bf16 v[36:39], v[156:159], v[124:127], v[36:39]
    buffer_load_dwordx4 v[124:127], v0, s[8:11], s48 offen offset:3072
    s_waitcnt vmcnt(15)
    v_mfma_f32_16x16x32_bf16 v[16:19], a[64:67], v[64:67], v[16:19]
    v_mfma_f32_16x16x32_bf16 v[20:23], a[68:71], v[64:67], v[20:23]
    v_mfma_f32_16x16x32_bf16 v[24:27], v[160:163], v[64:67], v[24:27]
    s_add_u32 s48, s46, 32768
    buffer_load_dwordx4 v[64:67], v0, s[8:11], s48 offen offset:0
    s_waitcnt vmcnt(15)
    v_mfma_f32_16x16x32_bf16 v[28:31], a[64:67], v[68:71], v[28:31]
    v_mfma_f32_16x16x32_bf16 v[32:35], a[68:71], v[68:71], v[32:35]
    v_mfma_f32_16x16x32_bf16 v[36:39], v[160:163], v[68:71], v[36:39]
    s_cmp_lg_u32 s43, 0
    s_cselect_b64 exec, 1, 0
    buffer_store_dword v3, v4, s[8:11], s43 offen sc1
    s_mov_b64 exec, -1
    s_mov_b32 s43, 0
    buffer_load_dwordx4 v[68:71], v0, s[8:11], s48 offen offset:1024
    s_waitcnt vmcnt(16)
    v_mfma_f32_16x16x32_bf16 v[16:19], a[72:75], v[72:75], v[16:19]
    v_mfma_f32_16x16x32_bf16 v[20:23], a[76:79], v[72:75], v[20:23]
    v_mfma_f32_16x16x32_bf16 v[24:27], v[164:167], v[72:75], v[24:27]
    buffer_load_dwordx4 v[72:75], v0, s[8:11], s48 offen offset:2048
    s_waitcnt vmcnt(16)
    v_mfma_f32_16x16x32_bf16 v[28:31], a[72:75], v[76:79], v[28:31]
    v_mfma_f32_16x16x32_bf16 v[32:35], a[76:79], v[76:79], v[32:35]
    v_mfma_f32_16x16x32_bf16 v[36:39], v[164:167], v[76:79], v[36:39]
    buffer_load_dwordx4 v[76:79], v0, s[8:11], s48 offen offset:3072
    s_waitcnt vmcnt(16)
    v_mfma_f32_16x16x32_bf16 v[16:19], a[80:83], v[80:83], v[16:19]
    v_mfma_f32_16x16x32_bf16 v[20:23], a[84:87], v[80:83], v[20:23]
    v_mfma_f32_16x16x32_bf16 v[24:27], v[168:171], v[80:83], v[24:27]
    s_add_u32 s48, s46, 36864
    buffer_load_dwordx4 v[80:83], v0, s[8:11], s48 offen offset:0
    s_waitcnt vmcnt(16)
    v_mfma_f32_16x16x32_bf16 v[28:31], a[80:83], v[84:87], v[28:31]
    v_mfma_f32_16x16x32_bf16 v[32:35], a[84:87], v[84:87], v[32:35]
    v_mfma_f32_16x16x32_bf16 v[36:39], v[168:171], v[84:87], v[36:39]
    buffer_load_dwordx4 v[84:87], v0, s[8:11], s48 offen offset:1024
    s_waitcnt vmcnt(16)
    v_mfma_f32_16x16x32_bf16 v[16:19], a[88:91], v[88:91], v[16:19]
    v_mfma_f32_16x16x32_bf16 v[20:23], a[92:95], v[88:91], v[20:23]
    v_mfma_f32_16x16x32_bf16 v[24:27], v[172:175], v[88:91], v[24:27]
    buffer_load_dwordx4 v[88:91], v0, s[8:11], s48 offen offset:2048
    s_waitcnt vmcnt(16)
    v_mfma_f32_16x16x32_bf16 v[28:31], a[88:91], v[92:95], v[28:31]
    v_mfma_f32_16x16x32_bf16 v[32:35], a[92:95], v[92:95], v[32:35]
    v_mfma_f32_16x16x32_bf16 v[36:39], v[172:175], v[92:95], v[36:39]
    buffer_load_dwordx4 v[92:95], v0, s[8:11], s48 offen offset:3072
    s_waitcnt vmcnt(16)
    v_mfma_f32_16x16x32_bf16 v[16:19], a[96:99], v[96:99], v[16:19]
    v_mfma_f32_16x16x32_bf16 v[20:23], a[100:103], v[96:99], v[20:23]
    v_mfma_f32_16x16x32_bf16 v[24:27], v[176:179], v[96:99], v[24:27]
    s_add_u32 s48, s46, 40960
    buffer_load_dwordx4 v[96:99], v0, s[8:11], s48 offen offset:0
    s_waitcnt vmcnt(16)
    v_mfma_f32_16x16x32_bf16 v[28:31], a[96:99], v[100:103], v[28:31]
    v_mfma_f32_16x16x32_bf16 v[32:35], a[100:103], v[100:103], v[32:35]
    v_mfma_f32_16x16x32_bf16 v[36:39], v[176:179], v[100:103], v[36:39]
    buffer_load_dwordx4 v[100:103], v0, s[8:11], s48 offen offset:1024
    s_waitcnt vmcnt(16)
    v_mfma_f32_16x16x32_bf16 v[16:19], a[104:107], v[104:107], v[16:19]
    v_mfma_f32_16x16x32_bf16 v[20:23], a[108:111], v[104:107], v[20:23]
    v_mfma_f32_16x16x32_bf16 v[24:27], v[180:183], v[104:107], v[24:27]
    s_cmp_lg_u32 s14, 0
    s_cbranch_scc1 LtwX_nw1
    s_mul_i32 s60, s32, 22528
    s_add_u32 s60, s60, 4224
    s_cmp_lt_u32 s32, 64
    s_cselect_b32 s60, s60, 2883584
    s_mul_i32 s61, s33, 22528
    s_add_u32 s61, s61, 1446016
    s_cmp_lt_u32 s33, 64
    s_cselect_b32 s61, s61, 2883584
    buffer_load_dword v2, v1, s[8:11], s60 offen sc1
    buffer_load_dword v15, v1, s[8:11], s61 offen sc1
LtwX_nw1:
    buffer_load_dwordx4 v[104:107], v0, s[8:11], s48 offen offset:2048
    s_waitcnt vmcnt(16)
    v_mfma_f32_16x16x32_bf16 v[28:31], a[104:107], v[108:111], v[28:31]
    v_mfma_f32_16x16x32_bf16 v[32:35], a[108:111], v[108:111], v[32:35]
    v_mfma_f32_16x16x32_bf16 v[36:39], v[180:183], v[108:111], v[36:39]
    buffer_load_dwordx4 v[108:111], v0, s[8:11], s48 offen offset:3072
    s_waitcnt vmcnt(16)
    v_mfma_f32_16x16x32_bf16 v[16:19], a[112:115], v[112:115], v[16:19]
    v_mfma_f32_16x16x32_bf16 v[20:23], a[116:119], v[112:115], v[20:23]
    v_mfma_f32_16x16x32_bf16 v[24:27], v[184:187], v[112:115], v[24:27]
    s_add_u32 s48, s46, 45056
    buffer_load_dwordx4 v[112:115], v0, s[8:11], s48 offen offset:0
    s_waitcnt vmcnt(16)
    v_mfma_f32_16x16x32_bf16 v[28:31], a[112:115], v[116:119], v[28:31]
    v_mfma_f32_16x16x32_bf16 v[32:35], a[116:119], v[116:119], v[32:35]
    v_mfma_f32_16x16x32_bf16 v[36:39], v[184:187], v[116:119], v[36:39]
    buffer_load_dwordx4 v[116:119], v0, s[8:11], s48 offen offset:1024
    s_waitcnt vmcnt(16)
    v_mfma_f32_16x16x32_bf16 v[16:19], a[120:123], v[120:123], v[16:19]
    v_mfma_f32_16x16x32_bf16 v[20:23], a[124:127], v[120:123], v[20:23]
    v_mfma_f32_16x16x32_bf16 v[24:27], v[188:191], v[120:123], v[24:27]
    buffer_load_dwordx4 v[120:123], v0, s[8:11], s48 offen offset:2048
    s_waitcnt vmcnt(16)
    v_mfma_f32_16x16x32_bf16 v[28:31], a[120:123], v[124:127], v[28:31]
    v_mfma_f32_16x16x32_bf16 v[32:35], a[124:127], v[124:127], v[32:35]
    v_mfma_f32_16x16x32_bf16 v[36:39], v[188:191], v[124:127], v[36:39]
    buffer_load_dwordx4 v[124:127], v0, s[8:11], s48 offen offset:3072
    s_waitcnt vmcnt(16)
    v_mfma_f32_16x16x32_bf16 v[16:19], a[128:131], v[64:67], v[16:19]
    v_mfma_f32_16x16x32_bf16 v[20:23], a[132:135], v[64:67], v[20:23]
    v_mfma_f32_16x16x32_bf16 v[24:27], v[192:195], v[64:67], v[24:27]
    s_add_u32 s48, s46, 49152
    buffer_load_dwordx4 v[64:67], v0, s[8:11], s48 offen offset:0
    s_waitcnt vmcnt(15)
    v_mfma_f32_16x16x32_bf16 v[28:31], a[128:131], v[68:71], v[28:31]
    v_mfma_f32_16x16x32_bf16 v[32:35], a[132:135], v[68:71], v[32:35]
    v_mfma_f32_16x16x32_bf16 v[36:39], v[192:195], v[68:71], v[36:39]
    buffer_load_dwordx4 v[68:71], v0, s[8:11], s48 offen offset:1024
    s_waitcnt vmcnt(15)
    v_mfma_f32_16x16x32_bf16 v[16:19], a[136:139], v[72:75], v[16:19]
    v_mfma_f32_16x16x32_bf16 v[20:23], a[140:143], v[72:75], v[20:23]
    v_mfma_f32_16x16x32_bf16 v[24:27], v[196:199], v[72:75], v[24:27]
    buffer_load_dwordx4 v[72:75], v0, s[8:11], s48 offen offset:2048
    s_waitcnt vmcnt(15)
    v_mfma_f32_16x16x32_bf16 v[28:31], a[136:139], v[76:79], v[28:31]
    v_mfma_f32_16x16x32_bf16 v[32:35], a[140:143], v[76:79], v[32:35]
    v_mfma_f32_16x16x32_bf16 v[36:39], v[196:199], v[76:79], v[36:39]
    buffer_load_dwordx4 v[76:79], v0, s[8:11], s48 offen offset:3072
    s_waitcnt vmcnt(15)
    v_mfma_f32_16x16x32_bf16 v[16:19], a[144:147], v[80:83], v[16:19]
    v_mfma_f32_16x16x32_bf16 v[20:23], a[148:151], v[80:83], v[20:23]
    v_mfma_f32_16x16x32_bf16 v[24:27], v[200:203], v[80:83], v[24:27]
    s_add_u32 s48, s46, 53248
    buffer_load_dwordx4 v[80:83], v0, s[8:11], s48 offen offset:0
    s_waitcnt vmcnt(15)
    v_mfma_f32_16x16x32_bf16 v[28:31], a[144:147], v[84:87], v[28:31]
    v_mfma_f32_16x16x32_bf16 v[32:35], a[148:151], v[84:87], v[32:35]
    v_mfma_f32_16x16x32_bf16 v[36:39], v[200:203], v[84:87], v[36:39]
    buffer_load_dwordx4 v[84:87], v0, s[8:11], s48 offen offset:1024
    s_waitcnt vmcnt(15)
    v_mfma_f32_16x16x32_bf16 v[16:19], a[152:155], v[88:91], v[16:19]
    v_mfma_f32_16x16x32_bf16 v[20:23], a[156:159], v[88:91], v[20:23]
    v_mfma_f32_16x16x32_bf16 v[24:27], v[204:207], v[88:91], v[24:27]
    buffer_load_dwordx4 v[88:91], v0, s[8:11], s48 offen offset:2048
    s_waitcnt vmcnt(15)
    v_mfma_f32_16x16x32_bf16 v[28:31], a[152:155], v[92:95], v[28:31]
    v_mfma_f32_16x16x32_bf16 v[32:35], a[156:159], v[92:95], v[32:35]
    v_mfma_f32_16x16x32_bf16 v[36:39], v[204:207], v[92:95], v[36:39]
    buffer_load_dwordx4 v[92:95], v0, s[8:11], s48 offen offset:3072
    s_waitcnt vmcnt(15)
    v_mfma_f32_16x16x32_bf16 v[16:19], a[160:163], v[96:99], v[16:19]
    v_mfma_f32_16x16x32_bf16 v[20:23], a[164:167], v[96:99], v[20:23]
    v_mfma_f32_16x16x32_bf16 v[24:27], v[208:211], v[96:99], v[24:27]
    s_add_u32 s48, s46, 57344
    buffer_load_dwordx4 v[96:99], v0, s[8:11], s48 offen offset:0
    s_waitcnt vmcnt(15)
    v_mfma_f32_16x16x32_bf16 v[28:31], a[160:163], v[100:103], v[28:31]
    v_mfma_f32_16x16x32_bf16 v[32:35], a[164:167], v[100:103], v[32:35]
    v_mfma_f32_16x16x32_bf16 v[36:39], v[208:211], v[100:103], v[36:39]
    buffer_load_dwordx4 v[100:103], v0, s[8:11], s48 offen offset:1024
    s_waitcnt vmcnt(15)
    v_mfma_f32_16x16x32_bf16 v[16:19], a[168:171], v[104:107], v[16:19]
    v_mfma_f32_16x16x32_bf16 v[20:23], a[172:175], v[104:107], v[20:23]
    v_mfma_f32_16x16x32_bf16 v[24:27], v[212:215], v[104:107], v[24:27]
    buffer_load_dwordx4 v[104:107], v0, s[8:11], s48 offen offset:2048
    s_waitcnt vmcnt(15)
    v_mfma_f32_16x16x32_bf16 v[28:31], a[168:171], v[108:111], v[28:31]
    v_mfma_f32_16x16x32_bf16 v[32:35], a[172:175], v[108:111], v[32:35]
    v_mfma_f32_16x16x32_bf16 v[36:39], v[212:215], v[108:111], v[36:39]
    buffer_load_dwordx4 v[108:111], v0, s[8:11], s48 offen offset:3072
    s_waitcnt vmcnt(15)
    v_mfma_f32_16x16x32_bf16 v[16:19], a[176:179], v[112:115], v[16:19]
    v_mfma_f32_16x16x32_bf16 v[20:23], a[180:183], v[112:115], v[20:23]
    v_mfma_f32_16x16x32_bf16 v[24:27], v[216:219], v[112:115], v[24:27]
    s_cmp_lg_u32 s14, 0
    s_cbranch_scc1 LtwX_nw2
    v_cmp_eq_u32 vcc, 0, v2
    v_cmp_eq_u32 s[54:55], 0, v15
    s_nop 0
    s_cmp_eq_u64 s[54:55], 0
    s_cselect_b32 s62, 2, 0
    s_cmp_eq_u64 vcc, 0
    s_cselect_b32 s62, 1, s62
    v_mov_b32 v5, s62
    ds_write_b32 v49, v5
    s_waitcnt lgkmcnt(0)
LtwX_nw2:
    s_barrier
    ds_read_b32 v6, v49
    v_xor_b32 v49, 4, v49
    s_add_u32 s48, s46, 61440
    buffer_load_dwordx4 v[112:115], v0, s[8:11], s48 offen offset:0
    s_waitcnt vmcnt(15)
    v_mfma_f32_16x16x32_bf16 v[28:31], a[176:179], v[116:119], v[28:31]
    v_mfma_f32_16x16x32_bf16 v[32:35], a[180:183], v[116:119], v[32:35]
    v_mfma_f32_16x16x32_bf16 v[36:39], v[216:219], v[116:119], v[36:39]
    buffer_load_dwordx4 v[116:119], v0, s[8:11], s48 offen offset:1024
    s_waitcnt vmcnt(15)
    v_mfma_f32_16x16x32_bf16 v[16:19], a[184:187], v[120:123], v[16:19]
    v_mfma_f32_16x16x32_bf16 v[20:23], a[188:191], v[120:123], v[20:23]
    v_mfma_f32_16x16x32_bf16 v[24:27], v[220:223], v[120:123], v[24:27]
    buffer_load_dwordx4 v[120:123], v0, s[8:11], s48 offen offset:2048
    s_waitcnt vmcnt(15)
    v_mfma_f32_16x16x32_bf16 v[28:31], a[184:187], v[124:127], v[28:31]
    v_mfma_f32_16x16x32_bf16 v[32:35], a[188:191], v[124:127], v[32:35]
    v_mfma_f32_16x16x32_bf16 v[36:39], v[220:223], v[124:127], v[36:39]
    s_waitcnt lgkmcnt(0)
    v_readfirstlane_b32 s62, v6
    s_cmp_lt_u32 s33, 29
    s_cselect_b32 s38, 1, 3
    s_cmp_eq_u32 s62, 2
    s_cselect_b32 s36, 1, 0
    s_cselect_b32 s37, s33, s32
    s_cselect_b32 s17, s38, 0
    s_add_u32 s33, s33, s17
    s_cmp_eq_u32 s62, 1
    s_cselect_b32 s17, 2, 0
    s_add_u32 s32, s32, s17
    s_lshl_b32 s56, s36, 6
    s_add_u32 s56, s56, s37
    buffer_load_dwordx4 v[124:127], v0, s[8:11], s48 offen offset:3072
    s_waitcnt vmcnt(15)
    v_mfma_f32_16x16x32_bf16 v[16:19], a[192:195], v[64:67], v[16:19]
    v_mfma_f32_16x16x32_bf16 v[20:23], a[196:199], v[64:67], v[20:23]
    v_mfma_f32_16x16x32_bf16 v[24:27], v[224:227], v[64:67], v[24:27]
    s_cmp_lt_u32 s37, 64
    s_cselect_b32 s62, s62, 0
    s_lshl_b32 s46, s56, 18
    s_add_u32 s46, s46, s58
    s_mul_i32 s41, s36, 4718592
    s_mul_i32 s17, s37, 36864
    s_add_u32 s41, s41, s17
    s_add_u32 s41, s41, 8650752
    s_cmp_lg_u32 s62, 0
    s_cselect_b32 s30, 268435456, 0
    buffer_load_dword v9, v10, s[28:31], s46 offen
    s_add_u32 s48, s46, 0
    buffer_load_dwordx4 v[64:67], v0, s[28:31], s48 offen offset:0
    s_waitcnt vmcnt(16)
    v_mfma_f32_16x16x32_bf16 v[28:31], a[192:195], v[68:71], v[28:31]
    v_mfma_f32_16x16x32_bf16 v[32:35], a[196:199], v[68:71], v[32:35]
    v_mfma_f32_16x16x32_bf16 v[36:39], v[224:227], v[68:71], v[36:39]
    buffer_load_dwordx4 v[68:71], v0, s[28:31], s48 offen offset:1024
    s_waitcnt vmcnt(16)
    v_mfma_f32_16x16x32_bf16 v[16:19], a[200:203], v[72:75], v[16:19]
    v_mfma_f32_16x16x32_bf16 v[20:23], a[204:207], v[72:75], v[20:23]
    v_mfma_f32_16x16x32_bf16 v[24:27], v[228:231], v[72:75], v[24:27]
    buffer_load_dwordx4 v[72:75], v0, s[28:31], s48 offen offset:2048
    s_waitcnt vmcnt(16)
    v_mfma_f32_16x16x32_bf16 v[28:31], a[200:203], v[76:79], v[28:31]
    v_mfma_f32_16x16x32_bf16 v[32:35], a[204:207], v[76:79], v[32:35]
    v_mfma_f32_16x16x32_bf16 v[36:39], v[228:231], v[76:79], v[36:39]
    buffer_load_dwordx4 v[76:79], v0, s[28:31], s48 offen offset:3072
    s_waitcnt vmcnt(16)
    v_mfma_f32_16x16x32_bf16 v[16:19], a[208:211], v[80:83], v[16:19]
    v_mfma_f32_16x16x32_bf16 v[20:23], a[212:215], v[80:83], v[20:23]
    v_mfma_f32_16x16x32_bf16 v[24:27], v[232:235], v[80:83], v[24:27]
    s_add_u32 s48, s46, 4096
    buffer_load_dwordx4 v[80:83], v0, s[28:31], s48 offen offset:0
    s_waitcnt vmcnt(16)
    v_mfma_f32_16x16x32_bf16 v[28:31], a[208:211], v[84:87], v[28:31]
    v_mfma_f32_16x16x32_bf16 v[32:35], a[212:215], v[84:87], v[32:35]
    v_mfma_f32_16x16x32_bf16 v[36:39], v[232:235], v[84:87], v[36:39]
    buffer_load_dwordx4 v[84:87], v0, s[28:31], s48 offen offset:1024
    s_waitcnt vmcnt(16)
    v_mfma_f32_16x16x32_bf16 v[16:19], a[216:219], v[88:91], v[16:19]
    v_mfma_f32_16x16x32_bf16 v[20:23], a[220:223], v[88:91], v[20:23]
    v_mfma_f32_16x16x32_bf16 v[24:27], v[236:239], v[88:91], v[24:27]
    buffer_load_dwordx4 v[88:91], v0, s[28:31], s48 offen offset:2048
    s_waitcnt vmcnt(16)
    v_mfma_f32_16x16x32_bf16 v[28:31], a[216:219], v[92:95], v[28:31]
    v_mfma_f32_16x16x32_bf16 v[32:35], a[220:223], v[92:95], v[32:35]
    v_mfma_f32_16x16x32_bf16 v[36:39], v[236:239], v[92:95], v[36:39]
    buffer_load_dwordx4 v[92:95], v0, s[28:31], s48 offen offset:3072
    s_waitcnt vmcnt(16)
    v_mfma_f32_16x16x32_bf16 v[16:19], a[224:227], v[96:99], v[16:19]
    v_mfma_f32_16x16x32_bf16 v[20:23], a[228:231], v[96:99], v[20:23]
    v_mfma_f32_16x16x32_bf16 v[24:27], v[240:243], v[96:99], v[24:27]
    s_add_u32 s48, s46, 8192
    buffer_load_dwordx4 v[96:99], v0, s[28:31], s48 offen offset:0
    s_waitcnt vmcnt(16)
    v_mfma_f32_16x16x32_bf16 v[28:31], a[224:227], v[100:103], v[28:31]
    v_mfma_f32_16x16x32_bf16 v[32:35], a[228:231], v[100:103], v[32:35]
    v_mfma_f32_16x16x32_bf16 v[36:39], v[240:243], v[100:103], v[36:39]
    buffer_load_dwordx4 v[100:103], v0, s[28:31], s48 offen offset:1024
    s_waitcnt vmcnt(16)
    v_mfma_f32_16x16x32_bf16 v[16:19], a[232:235], v[104:107], v[16:19]
    v_mfma_f32_16x16x32_bf16 v[20:23], a[236:239], v[104:107], v[20:23]
    v_mfma_f32_16x16x32_bf16 v[24:27], v[244:247], v[104:107], v[24:27]
    buffer_load_dwordx4 v[104:107], v0, s[28:31], s48 offen offset:2048
    s_waitcnt vmcnt(16)
    v_mfma_f32_16x16x32_bf16 v[28:31], a[232:235], v[108:111], v[28:31]
    v_mfma_f32_16x16x32_bf16 v[32:35], a[236:239], v[108:111], v[32:35]
    v_mfma_f32_16x16x32_bf16 v[36:39], v[244:247], v[108:111], v[36:39]
    buffer_load_dwordx4 v[108:111], v0, s[28:31], s48 offen offset:3072
    s_waitcnt vmcnt(16)
    v_mfma_f32_16x16x32_bf16 v[16:19], a[240:243], v[112:115], v[16:19]
    v_mfma_f32_16x16x32_bf16 v[20:23], a[244:247], v[112:115], v[20:23]
    v_mfma_f32_16x16x32_bf16 v[24:27], v[248:251], v[112:115], v[24:27]
    s_add_u32 s48, s46, 12288
    buffer_load_dwordx4 v[112:115], v0, s[28:31], s48 offen offset:0
    s_waitcnt vmcnt(16)
    v_mfma_f32_16x16x32_bf16 v[28:31], a[240:243], v[116:119], v[28:31]
    v_mfma_f32_16x16x32_bf16 v[32:35], a[244:247], v[116:119], v[32:35]
    v_mfma_f32_16x16x32_bf16 v[36:39], v[248:251], v[116:119], v[36:39]
    buffer_load_dwordx4 v[116:119], v0, s[28:31], s48 offen offset:1024
    s_waitcnt vmcnt(16)
    v_mfma_f32_16x16x32_bf16 v[16:19], a[248:251], v[120:123], v[16:19]
    v_mfma_f32_16x16x32_bf16 v[20:23], a[252:255], v[120:123], v[20:23]
    v_mfma_f32_16x16x32_bf16 v[24:27], v[252:255], v[120:123], v[24:27]
    buffer_load_dwordx4 v[120:123], v0, s[28:31], s48 offen offset:2048
    s_waitcnt vmcnt(16)
    v_mfma_f32_16x16x32_bf16 v[28:31], a[248:251], v[124:127], v[28:31]
    v_mfma_f32_16x16x32_bf16 v[32:35], a[252:255], v[124:127], v[32:35]
    v_mfma_f32_16x16x32_bf16 v[36:39], v[252:255], v[124:127], v[36:39]
    s_nop 5
    ds_write_b128 v48, v[16:19] offset:0
    ds_write_b128 v48, v[20:23] offset:1024
    ds_write_b128 v48, v[24:27] offset:2048
    ds_write_b128 v48, v[28:31] offset:3072
    ds_write_b128 v48, v[32:35] offset:4096
    ds_write_b128 v48, v[36:39] offset:5120
    s_waitcnt lgkmcnt(0)
    s_barrier
    ds_read_b128 v[24:27], v50 offset:0
    ds_read_b128 v[28:31], v50 offset:1024
    ds_read_b128 v[32:35], v50 offset:6144
    ds_read_b128 v[36:39], v50 offset:7168
    ds_read_b128 v[56:59], v50 offset:12288
    ds_read_b128 v[60:63], v50 offset:13312
    ds_read_b128 v[124:127], v50 offset:18432
    ds_read_b128 v[52:55], v50 offset:19456
    v_xor_b32 v48, 0x8000, v48
    v_xor_b32 v50, 0x8000, v50
    v_lshlrev_b32 v16, 16, v40
    v_and_b32 v20, 0xffff0000, v40
    v_lshlrev_b32 v17, 16, v41
    v_and_b32 v21, 0xffff0000, v41
    v_lshlrev_b32 v18, 16, v42
    v_and_b32 v22, 0xffff0000, v42
    v_lshlrev_b32 v19, 16, v43
    v_and_b32 v23, 0xffff0000, v43
    buffer_load_dwordx4 v[40:43], v12, s[28:31], s41 offen
    s_waitcnt lgkmcnt(7)
    v_add_f32 v16, v16, v24
    v_add_f32 v17, v17, v25
    v_add_f32 v18, v18, v26
    v_add_f32 v19, v19, v27
    s_waitcnt lgkmcnt(6)
    v_add_f32 v20, v20, v28
    v_add_f32 v21, v21, v29
    v_add_f32 v22, v22, v30
    v_add_f32 v23, v23, v31
    s_waitcnt lgkmcnt(5)
    v_add_f32 v16, v16, v32
    v_add_f32 v17, v17, v33
    v_add_f32 v18, v18, v34
    v_add_f32 v19, v19, v35
    s_waitcnt lgkmcnt(4)
    v_add_f32 v20, v20, v36
    v_add_f32 v21, v21, v37
    v_add_f32 v22, v22, v38
    v_add_f32 v23, v23, v39
    s_waitcnt lgkmcnt(3)
    v_add_f32 v16, v16, v56
    v_add_f32 v17, v17, v57
    v_add_f32 v18, v18, v58
    v_add_f32 v19, v19, v59
    s_waitcnt lgkmcnt(2)
    v_add_f32 v20, v20, v60
    v_add_f32 v21, v21, v61
    v_add_f32 v22, v22, v62
    v_add_f32 v23, v23, v63
    s_waitcnt lgkmcnt(1)
    v_add_f32 v16, v16, v124
    v_add_f32 v17, v17, v125
    v_add_f32 v18, v18, v126
    v_add_f32 v19, v19, v127
    s_waitcnt lgkmcnt(0)
    v_add_f32 v20, v20, v52
    v_add_f32 v21, v21, v53
    v_add_f32 v22, v22, v54
    v_add_f32 v23, v23, v55
    v_cvt_pk_bf16_f32 v52, v16, v20
    v_cvt_pk_bf16_f32 v53, v17, v21
    v_cvt_pk_bf16_f32 v54, v18, v22
    v_cvt_pk_bf16_f32 v55, v19, v23
    s_cmp_eq_u32 s34, 0
    s_cbranch_scc1 LtwX_l0
    s_mul_i32 s17, s35, 36864
    buffer_store_dwordx4 v[52:55], v13, s[24:27], s17 offen sc1
    s_cmp_lg_u32 s62, 0
    s_cbranch_scc1 LtwX_item
LtwX_chk:
    s_min_u32 s17, s32, s33
    s_cmp_lt_u32 s17, 64
    s_cbranch_scc1 LtwX_idle
    s_branch L_role_tw_exit
LtwX_l0:
    s_add_u32 s47, s47, 2359296
    buffer_store_dwordx4 v[52:55], v12, s[8:11], s47 offen sc1
    v_add_f32 v44, v16, v17
    v_mul_f32 v45, v16, v16
    v_fmac_f32 v45, v17, v17
    v_add_f32 v44, v44, v18
    v_fmac_f32 v45, v18, v18
    v_add_f32 v44, v44, v19
    v_fmac_f32 v45, v19, v19
    v_add_f32 v44, v44, v20
    v_fmac_f32 v45, v20, v20
    v_add_f32 v44, v44, v21
    v_fmac_f32 v45, v21, v21
    v_add_f32 v44, v44, v22
    v_fmac_f32 v45, v22, v22
    v_add_f32 v44, v44, v23
    v_fmac_f32 v45, v23, v23
    v_mov_b32 v46, v44
    v_mov_b32 v47, v45
    s_nop 0
    v_permlane32_swap_b32 v44, v46
    v_permlane32_swap_b32 v45, v47
    v_add_f32 v44, v44, v46
    v_add_f32 v45, v45, v47
    v_mov_b32 v46, v44
    v_mov_b32 v47, v45
    s_nop 0
    v_permlane16_swap_b32 v44, v46
    v_permlane16_swap_b32 v45, v47
    v_add_f32 v44, v44, v46
    v_add_f32 v45, v45, v47
    s_mul_i32 s17, s35, 6144
    s_add_u32 s17, s17, 16515072
    s_mov_b64 exec, 0xffff
    buffer_store_dwordx2 v[44:45], v14, s[8:11], s17 offen sc1
    s_mov_b64 exec, -1
    s_mul_i32 s43, s35, 22528
    s_add_u32 s43, s43, s49
    s_cmp_lg_u32 s62, 0
    s_cbranch_scc1 LtwX_item
    s_waitcnt vmcnt(0)
    s_mov_b64 exec, 1
    buffer_store_dword v3, v4, s[8:11], s43 offen sc1
    s_mov_b64 exec, -1
    s_mov_b32 s43, 0
    s_branch LtwX_chk
Ltw_z:
    v_lshrrev_b32 v5, 1, v8
    v_lshl_add_u32 v12, v5, 9, v12
    v_and_b32 v5, 1, v8
    v_lshl_add_u32 v12, v5, 3, v12
    v_add_u32 v12, 2048, v12
    v_lshl_add_u32 v13, v8, 3, v13
    v_add_u32 v13, 64, v13
    v_add_u32 v14, 8, v14
    s_lshl_b32 s58, s14, 16
    s_add_u32 s58, s58, 144703488
    s_mov_b32 s43, 0
    s_mov_b32 s28, s8
    s_mov_b32 s29, s9
    s_mov_b32 s30, 0
    s_mov_b32 s31, 0x00020000
    s_mul_i32 s17, s51, 3072
    v_add_u32 v50, s17, v0
    ds_write2_b32 v49, v4, v4 offset0:0 offset1:1
    s_waitcnt lgkmcnt(0)
    s_cmp_lg_u32 s14, 0
    s_cbranch_scc1 LtwZ_inia_d
    v_mov_b32 v5, 40
    s_mov_b32 s16, 0
LtwZ_inia:
    global_load_dword v6, v5, s[12:13] sc1
    s_add_u32 s16, s16, 1
    s_cmp_gt_u32 s16, 100000
    s_cbranch_scc1 L_role_tw_abort
    s_waitcnt vmcnt(0)
    v_cmp_gt_u32 vcc, 128, v6
    s_nop 0
    s_cbranch_vccz LtwZ_inia_d
    s_sleep 8
    s_branch LtwZ_inia
LtwZ_inia_d:
    s_barrier
    s_cmp_lg_u32 s14, 0
    s_cbranch_scc1 LtwZ_inib_d
    v_mov_b32 v5, 160
    s_mov_b32 s16, 0
LtwZ_inib:
    global_load_dword v6, v5, s[12:13] sc1
    s_add_u32 s16, s16, 1
    s_cmp_gt_u32 s16, 100000
    s_cbranch_scc1 L_role_tw_abort
    s_waitcnt vmcnt(0)
    v_cmp_gt_u32 vcc, 64, v6
    s_nop 0
    s_cbranch_vccz LtwZ_inib_d
    s_sleep 8
    s_branch LtwZ_inib
LtwZ_inib_d:
    s_barrier
LtwZ_idle:
    s_barrier
    ds_read_b32 v6, v49
    v_xor_b32 v49, 4, v49
    s_waitcnt lgkmcnt(0)
    v_readfirstlane_b32 s62, v6
    s_nop 0
    s_cmp_eq_u32 s62, 0
    s_cbranch_scc1 L_role_tw_abort
    s_cmp_lt_u32 s33, 29
    s_cselect_b32 s38, 1, 3
    s_cmp_eq_u32 s62, 2
    s_cselect_b32 s36, 1, 0
    s_cselect_b32 s37, s33, s32
    s_cselect_b32 s17, s38, 0
    s_add_u32 s33, s33, s17
    s_cmp_eq_u32 s62, 1
    s_cselect_b32 s17, 2, 0
    s_add_u32 s32, s32, s17
    s_lshl_b32 s56, s36, 6
    s_add_u32 s56, s56, s37
    s_lshl_b32 s46, s56, 18
    s_add_u32 s46, s46, s58
    s_mul_i32 s41, s36, 4718592
    s_mul_i32 s17, s37, 36864
    s_add_u32 s41, s41, s17
    s_add_u32 s41, s41, 8650752
    s_cmp_ge_u32 s37, 64
    s_cbranch_scc1 L_role_tw_abort
    buffer_load_dword v9, v10, s[8:11], s46 offen
    s_add_u32 s48, s46, 0
    buffer_load_dwordx4 v[64:67], v0, s[8:11], s48 offen offset:0
    buffer_load_dwordx4 v[68:71], v0, s[8:11], s48 offen offset:1024
    buffer_load_dwordx4 v[72:75], v0, s[8:11], s48 offen offset:2048
    buffer_load_dwordx4 v[76:79], v0, s[8:11], s48 offen offset:3072
    s_add_u32 s48, s46, 4096
    buffer_load_dwordx4 v[80:83], v0, s[8:11], s48 offen offset:0
    buffer_load_dwordx4 v[84:87], v0, s[8:11], s48 offen offset:1024
    buffer_load_dwordx4 v[88:91], v0, s[8:11], s48 offen offset:2048
    buffer_load_dwordx4 v[92:95], v0, s[8:11], s48 offen offset:3072
    s_add_u32 s48, s46, 8192
    buffer_load_dwordx4 v[96:99], v0, s[8:11], s48 offen offset:0
    buffer_load_dwordx4 v[100:103], v0, s[8:11], s48 offen offset:1024
    buffer_load_dwordx4 v[104:107], v0, s[8:11], s48 offen offset:2048
    buffer_load_dwordx4 v[108:111], v0, s[8:11], s48 offen offset:3072
    s_add_u32 s48, s46, 12288
    buffer_load_dwordx4 v[112:115], v0, s[8:11], s48 offen offset:0
    buffer_load_dwordx4 v[116:119], v0, s[8:11], s48 offen offset:1024
    buffer_load_dwordx4 v[120:123], v0, s[8:11], s48 offen offset:2048
    buffer_load_dwordx2 v[40:41], v12, s[8:11], s41 offen
LtwZ_item:
    s_mov_b32 s34, s36
    s_mov_b32 s35, s37
    s_mov_b32 s47, s41
    buffer_load_dwordx4 v[124:127], v0, s[8:11], s48 offen offset:3072
    s_waitcnt vmcnt(15)
    v_mfma_f32_16x16x32_bf16 v[16:19], a[0:3], v[64:67], 0
    v_mfma_f32_16x16x32_bf16 v[20:23], a[4:7], v[64:67], 0
    v_mfma_f32_16x16x32_bf16 v[24:27], v[128:131], v[64:67], 0
    s_add_u32 s48, s46, 16384
    buffer_load_dwordx4 v[64:67], v0, s[8:11], s48 offen offset:0
    s_waitcnt vmcnt(15)
    v_mfma_f32_16x16x32_bf16 v[28:31], a[0:3], v[68:71], 0
    v_mfma_f32_16x16x32_bf16 v[32:35], a[4:7], v[68:71], 0
    v_mfma_f32_16x16x32_bf16 v[36:39], v[128:131], v[68:71], 0
    buffer_load_dwordx4 v[68:71], v0, s[8:11], s48 offen offset:1024
    s_waitcnt vmcnt(15)
    v_mfma_f32_16x16x32_bf16 v[16:19], a[8:11], v[72:75], v[16:19]
    v_mfma_f32_16x16x32_bf16 v[20:23], a[12:15], v[72:75], v[20:23]
    v_mfma_f32_16x16x32_bf16 v[24:27], v[132:135], v[72:75], v[24:27]
    buffer_load_dwordx4 v[72:75], v0, s[8:11], s48 offen offset:2048
    s_waitcnt vmcnt(15)
    v_mfma_f32_16x16x32_bf16 v[28:31], a[8:11], v[76:79], v[28:31]
    v_mfma_f32_16x16x32_bf16 v[32:35], a[12:15], v[76:79], v[32:35]
    v_mfma_f32_16x16x32_bf16 v[36:39], v[132:135], v[76:79], v[36:39]
    buffer_load_dwordx4 v[76:79], v0, s[8:11], s48 offen offset:3072
    s_waitcnt vmcnt(15)
    v_mfma_f32_16x16x32_bf16 v[16:19], a[16:19], v[80:83], v[16:19]
    v_mfma_f32_16x16x32_bf16 v[20:23], a[20:23], v[80:83], v[20:23]
    v_mfma_f32_16x16x32_bf16 v[24:27], v[136:139], v[80:83], v[24:27]
    s_add_u32 s48, s46, 20480
    buffer_load_dwordx4 v[80:83], v0, s[8:11], s48 offen offset:0
    s_waitcnt vmcnt(15)
    v_mfma_f32_16x16x32_bf16 v[28:31], a[16:19], v[84:87], v[28:31]
    v_mfma_f32_16x16x32_bf16 v[32:35], a[20:23], v[84:87], v[32:35]
    v_mfma_f32_16x16x32_bf16 v[36:39], v[136:139], v[84:87], v[36:39]
    buffer_load_dwordx4 v[84:87], v0, s[8:11], s48 offen offset:1024
    s_waitcnt vmcnt(15)
    v_mfma_f32_16x16x32_bf16 v[16:19], a[24:27], v[88:91], v[16:19]
    v_mfma_f32_16x16x32_bf16 v[20:23], a[28:31], v[88:91], v[20:23]
    v_mfma_f32_16x16x32_bf16 v[24:27], v[140:143], v[88:91], v[24:27]
    buffer_load_dwordx4 v[88:91], v0, s[8:11], s48 offen offset:2048
    s_waitcnt vmcnt(15)
    v_mfma_f32_16x16x32_bf16 v[28:31], a[24:27], v[92:95], v[28:31]
    v_mfma_f32_16x16x32_bf16 v[32:35], a[28:31], v[92:95], v[32:35]
    v_mfma_f32_16x16x32_bf16 v[36:39], v[140:143], v[92:95], v[36:39]
    buffer_load_dwordx4 v[92:95], v0, s[8:11], s48 offen offset:3072
    s_waitcnt vmcnt(15)
    v_mfma_f32_16x16x32_bf16 v[16:19], a[32:35], v[96:99], v[16:19]
    v_mfma_f32_16x16x32_bf16 v[20:23], a[36:39], v[96:99], v[20:23]
    v_mfma_f32_16x16x32_bf16 v[24:27], v[144:147], v[96:99], v[24:27]
    s_add_u32 s48, s46, 24576
    buffer_load_dwordx4 v[96:99], v0, s[8:11], s48 offen offset:0
    s_waitcnt vmcnt(15)
    v_mfma_f32_16x16x32_bf16 v[28:31], a[32:35], v[100:103], v[28:31]
    v_mfma_f32_16x16x32_bf16 v[32:35], a[36:39], v[100:103], v[32:35]
    v_mfma_f32_16x16x32_bf16 v[36:39], v[144:147], v[100:103], v[36:39]
    buffer_load_dwordx4 v[100:103], v0, s[8:11], s48 offen offset:1024
    s_waitcnt vmcnt(15)
    v_mfma_f32_16x16x32_bf16 v[16:19], a[40:43], v[104:107], v[16:19]
    v_mfma_f32_16x16x32_bf16 v[20:23], a[44:47], v[104:107], v[20:23]
    v_mfma_f32_16x16x32_bf16 v[24:27], v[148:151], v[104:107], v[24:27]
    buffer_load_dwordx4 v[104:107], v0, s[8:11], s48 offen offset:2048
    s_waitcnt vmcnt(15)
    v_mfma_f32_16x16x32_bf16 v[28:31], a[40:43], v[108:111], v[28:31]
    v_mfma_f32_16x16x32_bf16 v[32:35], a[44:47], v[108:111], v[32:35]
    v_mfma_f32_16x16x32_bf16 v[36:39], v[148:151], v[108:111], v[36:39]
    buffer_load_dwordx4 v[108:111], v0, s[8:11], s48 offen offset:3072
    s_waitcnt vmcnt(15)
    v_mfma_f32_16x16x32_bf16 v[16:19], a[48:51], v[112:115], v[16:19]
    v_mfma_f32_16x16x32_bf16 v[20:23], a[52:55], v[112:115], v[20:23]
    v_mfma_f32_16x16x32_bf16 v[24:27], v[152:155], v[112:115], v[24:27]
    s_add_u32 s48, s46, 28672
    buffer_load_dwordx4 v[112:115], v0, s[8:11], s48 offen offset:0
    s_waitcnt vmcnt(15)
    v_mfma_f32_16x16x32_bf16 v[28:31], a[48:51], v[116:119], v[28:31]
    v_mfma_f32_16x16x32_bf16 v[32:35], a[52:55], v[116:119], v[32:35]
    v_mfma_f32_16x16x32_bf16 v[36:39], v[152:155], v[116:119], v[36:39]
    buffer_load_dwordx4 v[116:119], v0, s[8:11], s48 offen offset:1024
    s_waitcnt vmcnt(15)
    v_mfma_f32_16x16x32_bf16 v[16:19], a[56:59], v[120:123], v[16:19]
    v_mfma_f32_16x16x32_bf16 v[20:23], a[60:63], v[120:123], v[20:23]
    v_mfma_f32_16x16x32_bf16 v[24:27], v[156:159], v[120:123], v[24:27]
    buffer_load_dwordx4 v[120:123], v0, s[8:11], s48 offen offset:2048
    s_waitcnt vmcnt(15)
    v_mfma_f32_16x16x32_bf16 v[28:31], a[56:59], v[124:127], v[28:31]
    v_mfma_f32_16x16x32_bf16 v[32:35], a[60:63], v[124:127], v[32:35]
    v_mfma_f32_16x16x32_bf16 v[36:39], v[156:159], v[124:127], v[36:39]
    buffer_load_dwordx4 v[124:127], v0, s[8:11], s48 offen offset:3072
    s_waitcnt vmcnt(15)
    v_mfma_f32_16x16x32_bf16 v[16:19], a[64:67], v[64:67], v[16:19]
    v_mfma_f32_16x16x32_bf16 v[20:23], a[68:71], v[64:67], v[20:23]
    v_mfma_f32_16x16x32_bf16 v[24:27], v[160:163], v[64:67], v[24:27]
    s_add_u32 s48, s46, 32768
    buffer_load_dwordx4 v[64:67], v0, s[8:11], s48 offen offset:0
    s_waitcnt vmcnt(15)
    v_mfma_f32_16x16x32_bf16 v[28:31], a[64:67], v[68:71], v[28:31]
    v_mfma_f32_16x16x32_bf16 v[32:35], a[68:71], v[68:71], v[32:35]
    v_mfma_f32_16x16x32_bf16 v[36:39], v[160:163], v[68:71], v[36:39]
    s_cmp_lg_u32 s43, 0
    s_cselect_b64 exec, 1, 0
    buffer_store_dword v3, v4, s[8:11], s43 offen sc1
    s_mov_b64 exec, -1
    s_mov_b32 s43, 0
    buffer_load_dwordx4 v[68:71], v0, s[8:11], s48 offen offset:1024
    s_waitcnt vmcnt(16)
    v_mfma_f32_16x16x32_bf16 v[16:19], a[72:75], v[72:75], v[16:19]
    v_mfma_f32_16x16x32_bf16 v[20:23], a[76:79], v[72:75], v[20:23]
    v_mfma_f32_16x16x32_bf16 v[24:27], v[164:167], v[72:75], v[24:27]
    buffer_load_dwordx4 v[72:75], v0, s[8:11], s48 offen offset:2048
    s_waitcnt vmcnt(16)
    v_mfma_f32_16x16x32_bf16 v[28:31], a[72:75], v[76:79], v[28:31]
    v_mfma_f32_16x16x32_bf16 v[32:35], a[76:79], v[76:79], v[32:35]
    v_mfma_f32_16x16x32_bf16 v[36:39], v[164:167], v[76:79], v[36:39]
    buffer_load_dwordx4 v[76:79], v0, s[8:11], s48 offen offset:3072
    s_waitcnt vmcnt(16)
    v_mfma_f32_16x16x32_bf16 v[16:19], a[80:83], v[80:83], v[16:19]
    v_mfma_f32_16x16x32_bf16 v[20:23], a[84:87], v[80:83], v[20:23]
    v_mfma_f32_16x16x32_bf16 v[24:27], v[168:171], v[80:83], v[24:27]
    s_add_u32 s48, s46, 36864
    buffer_load_dwordx4 v[80:83], v0, s[8:11], s48 offen offset:0
    s_waitcnt vmcnt(16)
    v_mfma_f32_16x16x32_bf16 v[28:31], a[80:83], v[84:87], v[28:31]
    v_mfma_f32_16x16x32_bf16 v[32:35], a[84:87], v[84:87], v[32:35]
    v_mfma_f32_16x16x32_bf16 v[36:39], v[168:171], v[84:87], v[36:39]
    buffer_load_dwordx4 v[84:87], v0, s[8:11], s48 offen offset:1024
    s_waitcnt vmcnt(16)
    v_mfma_f32_16x16x32_bf16 v[16:19], a[88:91], v[88:91], v[16:19]
    v_mfma_f32_16x16x32_bf16 v[20:23], a[92:95], v[88:91], v[20:23]
    v_mfma_f32_16x16x32_bf16 v[24:27], v[172:175], v[88:91], v[24:27]
    buffer_load_dwordx4 v[88:91], v0, s[8:11], s48 offen offset:2048
    s_waitcnt vmcnt(16)
    v_mfma_f32_16x16x32_bf16 v[28:31], a[88:91], v[92:95], v[28:31]
    v_mfma_f32_16x16x32_bf16 v[32:35], a[92:95], v[92:95], v[32:35]
    v_mfma_f32_16x16x32_bf16 v[36:39], v[172:175], v[92:95], v[36:39]
    buffer_load_dwordx4 v[92:95], v0, s[8:11], s48 offen offset:3072
    s_waitcnt vmcnt(16)
    v_mfma_f32_16x16x32_bf16 v[16:19], a[96:99], v[96:99], v[16:19]
    v_mfma_f32_16x16x32_bf16 v[20:23], a[100:103], v[96:99], v[20:23]
    v_mfma_f32_16x16x32_bf16 v[24:27], v[176:179], v[96:99], v[24:27]
    s_add_u32 s48, s46, 40960
    buffer_load_dwordx4 v[96:99], v0, s[8:11], s48 offen offset:0
    s_waitcnt vmcnt(16)
    v_mfma_f32_16x16x32_bf16 v[28:31], a[96:99], v[100:103], v[28:31]
    v_mfma_f32_16x16x32_bf16 v[32:35], a[100:103], v[100:103], v[32:35]
    v_mfma_f32_16x16x32_bf16 v[36:39], v[176:179], v[100:103], v[36:39]
    buffer_load_dwordx4 v[100:103], v0, s[8:11], s48 offen offset:1024
    s_waitcnt vmcnt(16)
    v_mfma_f32_16x16x32_bf16 v[16:19], a[104:107], v[104:107], v[16:19]
    v_mfma_f32_16x16x32_bf16 v[20:23], a[108:111], v[104:107], v[20:23]
    v_mfma_f32_16x16x32_bf16 v[24:27], v[180:183], v[104:107], v[24:27]
    buffer_load_dwordx4 v[104:107], v0, s[8:11], s48 offen offset:2048
    s_waitcnt vmcnt(16)
    v_mfma_f32_16x16x32_bf16 v[28:31], a[104:107], v[108:111], v[28:31]
    v_mfma_f32_16x16x32_bf16 v[32:35], a[108:111], v[108:111], v[32:35]
    v_mfma_f32_16x16x32_bf16 v[36:39], v[180:183], v[108:111], v[36:39]
    buffer_load_dwordx4 v[108:111], v0, s[8:11], s48 offen offset:3072
    s_waitcnt vmcnt(16)
    v_mfma_f32_16x16x32_bf16 v[16:19], a[112:115], v[112:115], v[16:19]
    v_mfma_f32_16x16x32_bf16 v[20:23], a[116:119], v[112:115], v[20:23]
    v_mfma_f32_16x16x32_bf16 v[24:27], v[184:187], v[112:115], v[24:27]
    s_add_u32 s48, s46, 45056
    buffer_load_dwordx4 v[112:115], v0, s[8:11], s48 offen offset:0
    s_waitcnt vmcnt(16)
    v_mfma_f32_16x16x32_bf16 v[28:31], a[112:115], v[116:119], v[28:31]
    v_mfma_f32_16x16x32_bf16 v[32:35], a[116:119], v[116:119], v[32:35]
    v_mfma_f32_16x16x32_bf16 v[36:39], v[184:187], v[116:119], v[36:39]
    buffer_load_dwordx4 v[116:119], v0, s[8:11], s48 offen offset:1024
    s_waitcnt vmcnt(16)
    v_mfma_f32_16x16x32_bf16 v[16:19], a[120:123], v[120:123], v[16:19]
    v_mfma_f32_16x16x32_bf16 v[20:23], a[124:127], v[120:123], v[20:23]
    v_mfma_f32_16x16x32_bf16 v[24:27], v[188:191], v[120:123], v[24:27]
    buffer_load_dwordx4 v[120:123], v0, s[8:11], s48 offen offset:2048
    s_waitcnt vmcnt(16)
    v_mfma_f32_16x16x32_bf16 v[28:31], a[120:123], v[124:127], v[28:31]
    v_mfma_f32_16x16x32_bf16 v[32:35], a[124:127], v[124:127], v[32:35]
    v_mfma_f32_16x16x32_bf16 v[36:39], v[188:191], v[124:127], v[36:39]
    buffer_load_dwordx4 v[124:127], v0, s[8:11], s48 offen offset:3072
    s_waitcnt vmcnt(16)
    v_mfma_f32_16x16x32_bf16 v[16:19], a[128:131], v[64:67], v[16:19]
    v_mfma_f32_16x16x32_bf16 v[20:23], a[132:135], v[64:67], v[20:23]
    v_mfma_f32_16x16x32_bf16 v[24:27], v[192:195], v[64:67], v[24:27]
    s_add_u32 s48, s46, 49152
    buffer_load_dwordx4 v[64:67], v0, s[8:11], s48 offen offset:0
    s_waitcnt vmcnt(15)
    v_mfma_f32_16x16x32_bf16 v[28:31], a[128:131], v[68:71], v[28:31]
    v_mfma_f32_16x16x32_bf16 v[32:35], a[132:135], v[68:71], v[32:35]
    v_mfma_f32_16x16x32_bf16 v[36:39], v[192:195], v[68:71], v[36:39]
    buffer_load_dwordx4 v[68:71], v0, s[8:11], s48 offen offset:1024
    s_waitcnt vmcnt(15)
    v_mfma_f32_16x16x32_bf16 v[16:19], a[136:139], v[72:75], v[16:19]
    v_mfma_f32_16x16x32_bf16 v[20:23], a[140:143], v[72:75], v[20:23]
    v_mfma_f32_16x16x32_bf16 v[24:27], v[196:199], v[72:75], v[24:27]
    buffer_load_dwordx4 v[72:75], v0, s[8:11], s48 offen offset:2048
    s_waitcnt vmcnt(15)
    v_mfma_f32_16x16x32_bf16 v[28:31], a[136:139], v[76:79], v[28:31]
    v_mfma_f32_16x16x32_bf16 v[32:35], a[140:143], v[76:79], v[32:35]
    v_mfma_f32_16x16x32_bf16 v[36:39], v[196:199], v[76:79], v[36:39]
    buffer_load_dwordx4 v[76:79], v0, s[8:11], s48 offen offset:3072
    s_waitcnt vmcnt(15)
    v_mfma_f32_16x16x32_bf16 v[16:19], a[144:147], v[80:83], v[16:19]
    v_mfma_f32_16x16x32_bf16 v[20:23], a[148:151], v[80:83], v[20:23]
    v_mfma_f32_16x16x32_bf16 v[24:27], v[200:203], v[80:83], v[24:27]
    s_add_u32 s48, s46, 53248
    buffer_load_dwordx4 v[80:83], v0, s[8:11], s48 offen offset:0
    s_waitcnt vmcnt(15)
    v_mfma_f32_16x16x32_bf16 v[28:31], a[144:147], v[84:87], v[28:31]
    v_mfma_f32_16x16x32_bf16 v[32:35], a[148:151], v[84:87], v[32:35]
    v_mfma_f32_16x16x32_bf16 v[36:39], v[200:203], v[84:87], v[36:39]
    buffer_load_dwordx4 v[84:87], v0, s[8:11], s48 offen offset:1024
    s_waitcnt vmcnt(15)
    v_mfma_f32_16x16x32_bf16 v[16:19], a[152:155], v[88:91], v[16:19]
    v_mfma_f32_16x16x32_bf16 v[20:23], a[156:159], v[88:91], v[20:23]
    v_mfma_f32_16x16x32_bf16 v[24:27], v[204:207], v[88:91], v[24:27]
    buffer_load_dwordx4 v[88:91], v0, s[8:11], s48 offen offset:2048
    s_waitcnt vmcnt(15)
    v_mfma_f32_16x16x32_bf16 v[28:31], a[152:155], v[92:95], v[28:31]
    v_mfma_f32_16x16x32_bf16 v[32:35], a[156:159], v[92:95], v[32:35]
    v_mfma_f32_16x16x32_bf16 v[36:39], v[204:207], v[92:95], v[36:39]
    buffer_load_dwordx4 v[92:95], v0, s[8:11], s48 offen offset:3072
    s_waitcnt vmcnt(15)
    v_mfma_f32_16x16x32_bf16 v[16:19], a[160:163], v[96:99], v[16:19]
    v_mfma_f32_16x16x32_bf16 v[20:23], a[164:167], v[96:99], v[20:23]
    v_mfma_f32_16x16x32_bf16 v[24:27], v[208:211], v[96:99], v[24:27]
    s_add_u32 s48, s46, 57344
    buffer_load_dwordx4 v[96:99], v0, s[8:11], s48 offen offset:0
    s_waitcnt vmcnt(15)
    v_mfma_f32_16x16x32_bf16 v[28:31], a[160:163], v[100:103], v[28:31]
    v_mfma_f32_16x16x32_bf16 v[32:35], a[164:167], v[100:103], v[32:35]
    v_mfma_f32_16x16x32_bf16 v[36:39], v[208:211], v[100:103], v[36:39]
    buffer_load_dwordx4 v[100:103], v0, s[8:11], s48 offen offset:1024
    s_waitcnt vmcnt(15)
    v_mfma_f32_16x16x32_bf16 v[16:19], a[168:171], v[104:107], v[16:19]
    v_mfma_f32_16x16x32_bf16 v[20:23], a[172:175], v[104:107], v[20:23]
    v_mfma_f32_16x16x32_bf16 v[24:27], v[212:215], v[104:107], v[24:27]
    buffer_load_dwordx4 v[104:107], v0, s[8:11], s48 offen offset:2048
    s_waitcnt vmcnt(15)
    v_mfma_f32_16x16x32_bf16 v[28:31], a[168:171], v[108:111], v[28:31]
    v_mfma_f32_16x16x32_bf16 v[32:35], a[172:175], v[108:111], v[32:35]
    v_mfma_f32_16x16x32_bf16 v[36:39], v[212:215], v[108:111], v[36:39]
    buffer_load_dwordx4 v[108:111], v0, s[8:11], s48 offen offset:3072
    s_waitcnt vmcnt(15)
    v_mfma_f32_16x16x32_bf16 v[16:19], a[176:179], v[112:115], v[16:19]
    v_mfma_f32_16x16x32_bf16 v[20:23], a[180:183], v[112:115], v[20:23]
    v_mfma_f32_16x16x32_bf16 v[24:27], v[216:219], v[112:115], v[24:27]
    s_barrier
    ds_read_b32 v6, v49
    v_xor_b32 v49, 4, v49
    s_add_u32 s48, s46, 61440
    buffer_load_dwordx4 v[112:115], v0, s[8:11], s48 offen offset:0
    s_waitcnt vmcnt(15)
    v_mfma_f32_16x16x32_bf16 v[28:31], a[176:179], v[116:119], v[28:31]
    v_mfma_f32_16x16x32_bf16 v[32:35], a[180:183], v[116:119], v[32:35]
    v_mfma_f32_16x16x32_bf16 v[36:39], v[216:219], v[116:119], v[36:39]
    buffer_load_dwordx4 v[116:119], v0, s[8:11], s48 offen offset:1024
    s_waitcnt vmcnt(15)
    v_mfma_f32_16x16x32_bf16 v[16:19], a[184:187], v[120:123], v[16:19]
    v_mfma_f32_16x16x32_bf16 v[20:23], a[188:191], v[120:123], v[20:23]
    v_mfma_f32_16x16x32_bf16 v[24:27], v[220:223], v[120:123], v[24:27]
    buffer_load_dwordx4 v[120:123], v0, s[8:11], s48 offen offset:2048
    s_waitcnt vmcnt(15)
    v_mfma_f32_16x16x32_bf16 v[28:31], a[184:187], v[124:127], v[28:31]
    v_mfma_f32_16x16x32_bf16 v[32:35], a[188:191], v[124:127], v[32:35]
    v_mfma_f32_16x16x32_bf16 v[36:39], v[220:223], v[124:127], v[36:39]
    s_waitcnt lgkmcnt(0)
    v_readfirstlane_b32 s62, v6
    s_cmp_lt_u32 s33, 29
    s_cselect_b32 s38, 1, 3
    s_cmp_eq_u32 s62, 2
    s_cselect_b32 s36, 1, 0
    s_cselect_b32 s37, s33, s32
    s_cselect_b32 s17, s38, 0
    s_add_u32 s33, s33, s17
    s_cmp_eq_u32 s62, 1
    s_cselect_b32 s17, 2, 0
    s_add_u32 s32, s32, s17
    s_lshl_b32 s56, s36, 6
    s_add_u32 s56, s56, s37
    buffer_load_dwordx4 v[124:127], v0, s[8:11], s48 offen offset:3072
    s_waitcnt vmcnt(15)
    v_mfma_f32_16x16x32_bf16 v[16:19], a[192:195], v[64:67], v[16:19]
    v_mfma_f32_16x16x32_bf16 v[20:23], a[196:199], v[64:67], v[20:23]
    v_mfma_f32_16x16x32_bf16 v[24:27], v[224:227], v[64:67], v[24:27]
    s_cmp_lt_u32 s37, 64
    s_cselect_b32 s62, s62, 0
    s_lshl_b32 s46, s56, 18
    s_add_u32 s46, s46, s58
    s_mul_i32 s41, s36, 4718592
    s_mul_i32 s17, s37, 36864
    s_add_u32 s41, s41, s17
    s_add_u32 s41, s41, 8650752
    s_cmp_lg_u32 s62, 0
    s_cselect_b32 s30, 268435456, 0
    buffer_load_dword v9, v10, s[28:31], s46 offen
    s_add_u32 s48, s46, 0
    buffer_load_dwordx4 v[64:67], v0, s[28:31], s48 offen offset:0
    s_waitcnt vmcnt(16)
    v_mfma_f32_16x16x32_bf16 v[28:31], a[192:195], v[68:71], v[28:31]
    v_mfma_f32_16x16x32_bf16 v[32:35], a[196:199], v[68:71], v[32:35]
    v_mfma_f32_16x16x32_bf16 v[36:39], v[224:227], v[68:71], v[36:39]
    buffer_load_dwordx4 v[68:71], v0, s[28:31], s48 offen offset:1024
    s_waitcnt vmcnt(16)
    v_mfma_f32_16x16x32_bf16 v[16:19], a[200:203], v[72:75], v[16:19]
    v_mfma_f32_16x16x32_bf16 v[20:23], a[204:207], v[72:75], v[20:23]
    v_mfma_f32_16x16x32_bf16 v[24:27], v[228:231], v[72:75], v[24:27]
    buffer_load_dwordx4 v[72:75], v0, s[28:31], s48 offen offset:2048
    s_waitcnt vmcnt(16)
    v_mfma_f32_16x16x32_bf16 v[28:31], a[200:203], v[76:79], v[28:31]
    v_mfma_f32_16x16x32_bf16 v[32:35], a[204:207], v[76:79], v[32:35]
    v_mfma_f32_16x16x32_bf16 v[36:39], v[228:231], v[76:79], v[36:39]
    buffer_load_dwordx4 v[76:79], v0, s[28:31], s48 offen offset:3072
    s_waitcnt vmcnt(16)
    v_mfma_f32_16x16x32_bf16 v[16:19], a[208:211], v[80:83], v[16:19]
    v_mfma_f32_16x16x32_bf16 v[20:23], a[212:215], v[80:83], v[20:23]
    v_mfma_f32_16x16x32_bf16 v[24:27], v[232:235], v[80:83], v[24:27]
    s_add_u32 s48, s46, 4096
    buffer_load_dwordx4 v[80:83], v0, s[28:31], s48 offen offset:0
    s_waitcnt vmcnt(16)
    v_mfma_f32_16x16x32_bf16 v[28:31], a[208:211], v[84:87], v[28:31]
    v_mfma_f32_16x16x32_bf16 v[32:35], a[212:215], v[84:87], v[32:35]
    v_mfma_f32_16x16x32_bf16 v[36:39], v[232:235], v[84:87], v[36:39]
    buffer_load_dwordx4 v[84:87], v0, s[28:31], s48 offen offset:1024
    s_waitcnt vmcnt(16)
    v_mfma_f32_16x16x32_bf16 v[16:19], a[216:219], v[88:91], v[16:19]
    v_mfma_f32_16x16x32_bf16 v[20:23], a[220:223], v[88:91], v[20:23]
    v_mfma_f32_16x16x32_bf16 v[24:27], v[236:239], v[88:91], v[24:27]
    buffer_load_dwordx4 v[88:91], v0, s[28:31], s48 offen offset:2048
    s_waitcnt vmcnt(16)
    v_mfma_f32_16x16x32_bf16 v[28:31], a[216:219], v[92:95], v[28:31]
    v_mfma_f32_16x16x32_bf16 v[32:35], a[220:223], v[92:95], v[32:35]
    v_mfma_f32_16x16x32_bf16 v[36:39], v[236:239], v[92:95], v[36:39]
    buffer_load_dwordx4 v[92:95], v0, s[28:31], s48 offen offset:3072
    s_waitcnt vmcnt(16)
    v_mfma_f32_16x16x32_bf16 v[16:19], a[224:227], v[96:99], v[16:19]
    v_mfma_f32_16x16x32_bf16 v[20:23], a[228:231], v[96:99], v[20:23]
    v_mfma_f32_16x16x32_bf16 v[24:27], v[240:243], v[96:99], v[24:27]
    s_add_u32 s48, s46, 8192
    buffer_load_dwordx4 v[96:99], v0, s[28:31], s48 offen offset:0
    s_waitcnt vmcnt(16)
    v_mfma_f32_16x16x32_bf16 v[28:31], a[224:227], v[100:103], v[28:31]
    v_mfma_f32_16x16x32_bf16 v[32:35], a[228:231], v[100:103], v[32:35]
    v_mfma_f32_16x16x32_bf16 v[36:39], v[240:243], v[100:103], v[36:39]
    buffer_load_dwordx4 v[100:103], v0, s[28:31], s48 offen offset:1024
    s_waitcnt vmcnt(16)
    v_mfma_f32_16x16x32_bf16 v[16:19], a[232:235], v[104:107], v[16:19]
    v_mfma_f32_16x16x32_bf16 v[20:23], a[236:239], v[104:107], v[20:23]
    v_mfma_f32_16x16x32_bf16 v[24:27], v[244:247], v[104:107], v[24:27]
    buffer_load_dwordx4 v[104:107], v0, s[28:31], s48 offen offset:2048
    s_waitcnt vmcnt(16)
    v_mfma_f32_16x16x32_bf16 v[28:31], a[232:235], v[108:111], v[28:31]
    v_mfma_f32_16x16x32_bf16 v[32:35], a[236:239], v[108:111], v[32:35]
    v_mfma_f32_16x16x32_bf16 v[36:39], v[244:247], v[108:111], v[36:39]
    buffer_load_dwordx4 v[108:111], v0, s[28:31], s48 offen offset:3072
    s_waitcnt vmcnt(16)
    v_mfma_f32_16x16x32_bf16 v[16:19], a[240:243], v[112:115], v[16:19]
    v_mfma_f32_16x16x32_bf16 v[20:23], a[244:247], v[112:115], v[20:23]
    v_mfma_f32_16x16x32_bf16 v[24:27], v[248:251], v[112:115], v[24:27]
    s_add_u32 s48, s46, 12288
    buffer_load_dwordx4 v[112:115], v0, s[28:31], s48 offen offset:0
    s_waitcnt vmcnt(16)
    v_mfma_f32_16x16x32_bf16 v[28:31], a[240:243], v[116:119], v[28:31]
    v_mfma_f32_16x16x32_bf16 v[32:35], a[244:247], v[116:119], v[32:35]
    v_mfma_f32_16x16x32_bf16 v[36:39], v[248:251], v[116:119], v[36:39]
    buffer_load_dwordx4 v[116:119], v0, s[28:31], s48 offen offset:1024
    s_waitcnt vmcnt(16)
    v_mfma_f32_16x16x32_bf16 v[16:19], a[248:251], v[120:123], v[16:19]
    v_mfma_f32_16x16x32_bf16 v[20:23], a[252:255], v[120:123], v[20:23]
    v_mfma_f32_16x16x32_bf16 v[24:27], v[252:255], v[120:123], v[24:27]
    buffer_load_dwordx4 v[120:123], v0, s[28:31], s48 offen offset:2048
    s_waitcnt vmcnt(16)
    v_mfma_f32_16x16x32_bf16 v[28:31], a[248:251], v[124:127], v[28:31]
    v_mfma_f32_16x16x32_bf16 v[32:35], a[252:255], v[124:127], v[32:35]
    v_mfma_f32_16x16x32_bf16 v[36:39], v[252:255], v[124:127], v[36:39]
    s_nop 5
    ds_write_b128 v48, v[16:19] offset:0
    ds_write_b128 v48, v[20:23] offset:1024
    ds_write_b128 v48, v[24:27] offset:2048
    ds_write_b128 v48, v[28:31] offset:3072
    ds_write_b128 v48, v[32:35] offset:4096
    ds_write_b128 v48, v[36:39] offset:5120
    s_waitcnt lgkmcnt(0)
    s_barrier
    ds_read_b128 v[24:27], v50 offset:2048
    ds_read_b128 v[28:31], v50 offset:8192
    ds_read_b128 v[32:35], v50 offset:14336
    ds_read_b128 v[36:39], v50 offset:20480
    v_xor_b32 v48, 0x8000, v48
    v_xor_b32 v50, 0x8000, v50
    v_lshlrev_b32 v16, 16, v40
    v_and_b32 v17, 0xffff0000, v40
    v_lshlrev_b32 v18, 16, v41
    v_and_b32 v19, 0xffff0000, v41
    buffer_load_dwordx2 v[40:41], v12, s[28:31], s41 offen
    s_waitcnt lgkmcnt(3)
    v_add_f32 v16, v16, v24
    v_add_f32 v17, v17, v25
    v_add_f32 v18, v18, v26
    v_add_f32 v19, v19, v27
    s_waitcnt lgkmcnt(2)
    v_add_f32 v16, v16, v28
    v_add_f32 v17, v17, v29
    v_add_f32 v18, v18, v30
    v_add_f32 v19, v19, v31
    s_waitcnt lgkmcnt(1)
    v_add_f32 v16, v16, v32
    v_add_f32 v17, v17, v33
    v_add_f32 v18, v18, v34
    v_add_f32 v19, v19, v35
    s_waitcnt lgkmcnt(0)
    v_add_f32 v16, v16, v36
    v_add_f32 v17, v17, v37
    v_add_f32 v18, v18, v38
    v_add_f32 v19, v19, v39
    v_cvt_pk_bf16_f32 v52, v16, v17
    v_cvt_pk_bf16_f32 v53, v18, v19
    s_cmp_eq_u32 s34, 0
    s_cbranch_scc1 LtwZ_l0
    s_mul_i32 s17, s35, 36864
    buffer_store_dwordx2 v[52:53], v13, s[24:27], s17 offen sc1
    s_cmp_lg_u32 s62, 0
    s_cbranch_scc1 LtwZ_item
LtwZ_chk:
    s_min_u32 s17, s32, s33
    s_cmp_lt_u32 s17, 64
    s_cbranch_scc1 LtwZ_idle
    s_branch L_role_tw_exit
LtwZ_l0:
    s_add_u32 s47, s47, 2359296
    buffer_store_dwordx2 v[52:53], v12, s[8:11], s47 offen sc1
    v_add_f32 v44, v16, v17
    v_mul_f32 v45, v16, v16
    v_fmac_f32 v45, v17, v17
    v_add_f32 v44, v44, v18
    v_fmac_f32 v45, v18, v18
    v_add_f32 v44, v44, v19
    v_fmac_f32 v45, v19, v19
    v_mov_b32 v46, v44
    v_mov_b32 v47, v45
    s_nop 0
    v_permlane32_swap_b32 v44, v46
    v_permlane32_swap_b32 v45, v47
    v_add_f32 v44, v44, v46
    v_add_f32 v45, v45, v47
    v_mov_b32 v46, v44
    v_mov_b32 v47, v45
    s_nop 0
    v_permlane16_swap_b32 v44, v46
    v_permlane16_swap_b32 v45, v47
    v_add_f32 v44, v44, v46
    v_add_f32 v45, v45, v47
    s_mul_i32 s17, s35, 6144
    s_add_u32 s17, s17, 16515072
    s_mov_b64 exec, 0xffff
    buffer_store_dwordx2 v[44:45], v14, s[8:11], s17 offen sc1
    s_mov_b64 exec, -1
    s_mul_i32 s43, s35, 22528
    s_add_u32 s43, s43, s49
    s_cmp_lg_u32 s62, 0
    s_cbranch_scc1 LtwZ_item
    s_waitcnt vmcnt(0)
    s_mov_b64 exec, 1
    buffer_store_dword v3, v4, s[8:11], s43 offen sc1
    s_mov_b64 exec, -1
    s_mov_b32 s43, 0
    s_branch LtwZ_chk
L_role_tw_abort:
    s_waitcnt lgkmcnt(0)
    s_mov_b64 exec, -1
    v_mov_b32 v0, 60
    s_lshl_b32 s5, s3, 8
    s_or_b32 s5, s5, s4
    s_or_b32 s5, s5, 0x10000
    v_mov_b32 v1, s5
    global_store_dword v0, v1, s[12:13]
    s_endpgm
L_role_tw_exit:
    s_endpgm
.p2align 6
L_role_r:
    s_mov_b32 s32, s3
    s_mov_b32 s15, s4
    v_and_b32 v60, 63, v0
    v_and_b32 v61, 15, v60
    v_lshrrev_b32 v62, 4, v60
    v_lshlrev_b32 v0, 4, v60
    s_mul_i32 s17, s14, 34816
    s_add_u32 s17, s17, 23296
    v_add_u32 v8, s17, v0
    s_mov_b32 s50, 0xfffffffe
    s_mov_b32 s44, 0x3e0293ee
    s_mov_b32 s45, 0x3e0293ee
    s_mov_b32 s52, 0x3f803f80
    s_mov_b32 s53, 0x3f803f80
    s_mov_b32 s40, 1
    s_mov_b32 s46, 0x00ff00ff
    s_cmp_eq_u32 s14, 2
    s_cselect_b32 s46, 0x00030003, s46
    s_mov_b32 s47, s46
    v_bfe_u32 v63, v61, 1, 1
    v_mov_b32 v1, 0x4444
    v_mov_b32 v64, 0xeeee
    v_cmp_eq_u32 vcc, 0, v63
    s_nop 1
    v_cndmask_b32 v1, v64, v1, vcc
    v_mul_u32_u24 v64, 1152, v62
    v_lshl_add_u32 v2, v61, 2, v64
    s_lshl_b32 s17, s14, 6
    s_add_u32 s18, s17, 0
    v_add_u32 v2, s18, v2
    v_mul_u32_u24 v64, 288, v61
    v_lshl_add_u32 v3, v62, 4, v64
    v_add_u32 v3, 0, v3
    v_lshrrev_b32 v64, 2, v61
    v_and_b32 v65, 1, v61
    v_lshl_add_u32 v64, v64, 1, v65
    v_mul_u32_u24 v65, 288, v64
    v_lshl_add_u32 v4, v62, 5, v65
    v_lshl_add_u32 v4, v63, 4, v4
    v_add_u32 v4, 4608, v4
    v_xor_b32 v63, 1, v63
    v_mul_u32_u24 v63, 2304, v63
    v_add_u32 v5, v65, v63
    v_lshl_add_u32 v5, v62, 4, v5
    s_add_u32 s18, s17, 4608
    v_add_u32 v5, s18, v5
    s_lshr_b32 s70, s15, 3
    s_bfe_u32 s71, s15, 0x20001
    s_and_b32 s72, s15, 1
    v_bfe_u32 v64, v61, 2, 1
    v_lshl_add_u32 v63, v64, 2, v62
    v_mul_u32_u24 v63, 9216, v63
    v_lshrrev_b32 v65, 3, v61
    v_lshlrev_b32 v65, 2, v65
    v_and_b32 v64, 3, v61
    v_add_u32 v65, v65, v64
    s_lshl_b32 s73, s71, 4
    s_lshl_b32 s17, s72, 3
    s_add_u32 s73, s73, s17
    v_add_u32 v65, s73, v65
    s_lshl_b32 s17, s70, 6
    v_add_u32 v65, s17, v65
    s_cmp_eq_u32 s14, 2
    s_cselect_b32 s17, 2, 4
    v_lshlrev_b32 v65, s17, v65
    v_add_u32 v6, v63, v65
    s_lshl_b32 s17, s14, 12
    v_add_u32 v6, s17, v6
    v_lshrrev_b32 v66, 1, v61
    s_lshl_b32 s17, s14, 2
    v_add_u32 v66, s17, v66
    v_and_b32 v64, 1, v61
    s_lshl_b32 s17, s70, 4
    s_lshl_b32 s18, s71, 2
    s_add_u32 s17, s17, s18
    s_lshl_b32 s18, s72, 1
    s_add_u32 s17, s17, s18
    v_add_u32 v65, s17, v64
    v_lshl_add_u32 v65, v66, 6, v65
    v_lshlrev_b32 v65, 4, v65
    v_lshl_add_u32 v7, v62, 2, v65
    s_lshl_b32 s17, s71, 1
    v_add_u32 v64, s17, v64
    v_mul_u32_u24 v64, 576, v64
    v_lshl_add_u32 v64, v66, 4, v64
    v_lshl_add_u32 v64, v62, 1, v64
    s_mul_i32 s17, s70, 144
    s_lshl_b32 s18, s72, 3
    s_add_u32 s17, s17, s18
    v_add_u32 v64, s17, v64
    v_lshlrev_b32 v67, 1, v64
    s_mul_i32 s48, s32, 1048576
    s_add_u32 s48, s48, 4194304
    s_mul_i32 s17, s15, 9216
    s_add_u32 s17, s17, s48
    s_lshl_b32 s18, s14, 10
    s_add_u32 s38, s17, s18
    s_lshl_b32 s19, s14, 8
    s_add_u32 s39, s17, s19
    s_add_u32 s39, s39, 8192
    s_add_u32 s37, s48, 983040
    s_xor_b32 s36, s37, 16384
    s_add_u32 s34, s37, s18
    s_add_u32 s35, s37, 8192
    s_mul_i32 s17, s32, 50331648
    s_lshl_b32 s19, s15, 13
    s_add_u32 s17, s17, s19
    s_add_u32 s68, s17, 77594624
    s_lshl_b32 s18, s14, 11
    s_add_u32 s17, s17, s18
    s_add_u32 s41, s17, 60817408
    s_add_u32 s42, s17, 77594624
    s_mul_i32 s17, s32, 8388608
    s_lshl_b32 s19, s15, 12
    s_add_u32 s17, s17, s19
    s_add_u32 s43, s17, 27262976
    s_mul_i32 s17, s32, 1441792
    s_lshl_b32 s19, s15, 9
    s_add_u32 s17, s17, s19
    s_add_u32 s66, s17, 5376
    s_mov_b32 s33, 0
    s_add_u32 s62, s48, 0
    s_add_u32 s63, s48, 73728
    s_add_u32 s64, s48, 147456
    s_add_u32 s65, s48, 221184
    s_load_dwordx2 s[20:21], s[0:1], 32
    s_mov_b32 s22, 9216
    s_mov_b32 s23, 0x00020000
    s_waitcnt lgkmcnt(0)
    s_and_b32 s21, s21, 0xffff
    s_cmp_gt_u32 s14, 2
    s_cbranch_scc1 Lr_mem0_done
    s_mov_b64 exec, s[46:47]
    buffer_load_dword v64, v67, s[20:23], 0 offen
    s_waitcnt vmcnt(0)
    v_min_u32 v64, s50, v64
    buffer_store_dword v64, v7, s[8:11], s37 offen sc1
    v_mov_b32 v64, -1
    buffer_store_dword v64, v7, s[8:11], s36 offen sc1
    s_mov_b64 exec, -1
Lr_mem0_done:
    v_mov_b32 v64, 0
    v_mov_b32 v65, 0
    v_mov_b32 v66, 0
    v_mov_b32 v67, 0
    v_lshrrev_b32 v63, 2, v0
    buffer_store_dwordx4 v[64:67], v0, s[8:11], s38 offen sc1
    s_add_u32 s17, s38, 4096
    buffer_store_dwordx4 v[64:67], v0, s[8:11], s17 offen sc1
    buffer_store_dword v64, v63, s[8:11], s39 offen sc1
    s_waitcnt vmcnt(0)
    s_barrier
    s_cmp_lg_u32 s14, 0
    s_cbranch_scc1 Lr_noadd
    s_lshl_b32 s17, s32, 2
    s_add_u32 s17, s17, 192
    v_mov_b32 v63, s17
    v_mov_b32 v64, 1
    s_mov_b64 exec, 1
    global_atomic_add v63, v64, s[12:13]
    s_mov_b64 exec, -1
Lr_noadd:
    s_cmp_lt_u32 s14, 3
    s_cbranch_scc1 Lr_not_w3
    v_lshlrev_b32 v6, 3, v0
    v_lshrrev_b32 v63, 2, v0
    v_and_b32 v7, 12, v63
    v_and_b32 v63, 16, v63
    v_lshl_add_u32 v7, v63, 3, v7
Lr_not_w3:
    s_cmp_eq_u32 s32, 0
    s_cbranch_scc1 Lr_gate_ng
    s_cmp_lg_u32 s14, 0
    s_cbranch_scc1 Lr_gate_d
    v_mov_b32 v63, 48
    s_mov_b32 s16, 0
Lr_gate:
    global_load_dword v64, v63, s[12:13] sc1
    s_add_u32 s16, s16, 1
    s_cmp_gt_u32 s16, 100000
    s_cbranch_scc1 Lr_abort
    s_waitcnt vmcnt(0)
    v_cmp_gt_u32 vcc, 32, v64
    s_nop 0
    s_cbranch_vccz Lr_gate_d
    s_sleep 100
    s_branch Lr_gate
Lr_gate_d:
    s_barrier
Lr_gate_ng:
    s_load_dwordx2 s[20:21], s[0:1], 40
    s_mov_b32 s22, 4718592
    s_mov_b32 s23, 0x00020000
    s_waitcnt lgkmcnt(0)
    s_and_b32 s21, s21, 0xffff
    s_load_dwordx2 s[24:25], s[0:1], 48
    s_mov_b32 s26, 4718592
    s_mov_b32 s27, 0x00020000
    s_waitcnt lgkmcnt(0)
    s_and_b32 s25, s25, 0xffff
    s_load_dwordx2 s[28:29], s[0:1], 56
    s_mov_b32 s30, 4718592
    s_mov_b32 s31, 0x00020000
    s_waitcnt lgkmcnt(0)
    s_and_b32 s29, s29, 0xffff
    s_load_dwordx2 s[76:77], s[0:1], 64
    s_mov_b32 s78, 4718592
    s_mov_b32 s79, 0x00020000
    s_waitcnt lgkmcnt(0)
    s_and_b32 s77, s77, 0xffff
    v_lshrrev_b32 v60, 4, v0
    v_and_b32 v61, 15, v60
    v_lshrrev_b32 v62, 4, v60
    s_mul_i32 s72, s14, 34816
    s_add_u32 s72, s72, 23296
    s_mul_i32 s70, s14, 1179648
    s_lshl_b32 s17, s15, 8
    s_add_u32 s70, s70, s17
    s_mul_i32 s71, s15, 147456
    s_mul_i32 s17, s14, 288
    s_add_u32 s71, s71, s17
    v_and_b32 v63, 1, v62
    v_lshrrev_b32 v64, 1, v61
    v_xor_b32 v64, v64, v63
    v_lshlrev_b32 v64, 5, v64
    v_and_b32 v65, 1, v61
    v_lshl_add_u32 v64, v65, 4, v64
    v_lshl_add_u32 v12, v62, 13, v64
    v_xor_b32 v13, 128, v12
    v_xor_b32 v14, 64, v12
    v_xor_b32 v15, 192, v12
    v_lshrrev_b32 v63, 2, v60
    v_mul_u32_u24 v63, 1152, v63
    v_and_b32 v64, 3, v60
    v_lshl_add_u32 v16, v64, 4, v63
    v_lshrrev_b32 v63, 1, v60
    v_mul_u32_u24 v63, 1152, v63
    v_and_b32 v64, 1, v60
    v_lshl_add_u32 v17, v64, 4, v63
    v_lshrrev_b32 v40, 2, v61
    v_and_b32 v41, 3, v61
    v_and_b32 v63, 1, v62
    v_lshl_add_u32 v42, v63, 2, v40
    v_and_b32 v64, 1, v40
    v_lshl_add_u32 v64, v63, 2, v64
    v_lshrrev_b32 v65, 1, v40
    v_lshl_add_u32 v64, v65, 3, v64
    v_lshlrev_b32 v64, 8, v64
    v_lshl_add_u32 v64, v41, 3, v64
    v_lshrrev_b32 v65, 1, v62
    v_mul_u32_u24 v65, 34816, v65
    v_add_u32 v64, v64, v65
    v_add_u32 v64, 23296, v64
    s_lshl_b32 s17, s14, 1
    s_add_u32 s18, s17, 0
    v_xor_b32 v65, s18, v42
    v_lshl_add_u32 v18, v65, 5, v64
    v_add_u32 v19, 69632, v18
    s_add_u32 s18, s17, 1
    v_xor_b32 v65, s18, v42
    v_lshl_add_u32 v20, v65, 5, v64
    v_add_u32 v21, 69632, v20
    v_lshrrev_b32 v63, 1, v62
    v_lshlrev_b32 v63, 3, v63
    v_and_b32 v64, 1, v62
    v_lshl_add_u32 v63, v64, 1, v63
    v_and_b32 v64, 1, v40
    v_lshl_add_u32 v63, v64, 4, v63
    v_lshrrev_b32 v64, 1, v40
    v_lshl_add_u32 v63, v64, 2, v63
    v_lshlrev_b32 v64, 3, v41
    v_lshl_add_u32 v22, v63, 6, v64
    v_add_u32 v22, s72, v22
    v_lshl_add_u32 v23, v63, 5, v64
    v_add_u32 v23, s72, v23
    s_add_u32 m0, s72, 0
    s_add_u32 s17, s70, 0
    buffer_load_dwordx4 v12, s[20:23], s17 offen lds
    s_add_u32 m0, m0, 1024
    s_add_u32 s17, s70, 32768
    buffer_load_dwordx4 v13, s[20:23], s17 offen lds
    s_add_u32 m0, m0, 1024
    s_add_u32 s17, s70, 65536
    buffer_load_dwordx4 v14, s[20:23], s17 offen lds
    s_add_u32 m0, m0, 1024
    s_add_u32 s17, s70, 98304
    buffer_load_dwordx4 v15, s[20:23], s17 offen lds
    s_add_u32 m0, s72, 4096
    s_add_u32 s17, s70, 0
    buffer_load_dwordx4 v12, s[24:27], s17 offen lds
    s_add_u32 m0, m0, 1024
    s_add_u32 s17, s70, 32768
    buffer_load_dwordx4 v13, s[24:27], s17 offen lds
    s_add_u32 m0, m0, 1024
    s_add_u32 s17, s70, 65536
    buffer_load_dwordx4 v14, s[24:27], s17 offen lds
    s_add_u32 m0, m0, 1024
    s_add_u32 s17, s70, 98304
    buffer_load_dwordx4 v15, s[24:27], s17 offen lds
    s_add_u32 m0, s72, 8192
    s_add_u32 s17, s70, 131072
    buffer_load_dwordx4 v12, s[20:23], s17 offen lds
    s_add_u32 m0, m0, 1024
    s_add_u32 s17, s70, 163840
    buffer_load_dwordx4 v13, s[20:23], s17 offen lds
    s_add_u32 m0, m0, 1024
    s_add_u32 s17, s70, 196608
    buffer_load_dwordx4 v14, s[20:23], s17 offen lds
    s_add_u32 m0, m0, 1024
    s_add_u32 s17, s70, 229376
    buffer_load_dwordx4 v15, s[20:23], s17 offen lds
    s_add_u32 m0, s72, 12288
    s_add_u32 s17, s70, 131072
    buffer_load_dwordx4 v12, s[24:27], s17 offen lds
    s_add_u32 m0, m0, 1024
    s_add_u32 s17, s70, 163840
    buffer_load_dwordx4 v13, s[24:27], s17 offen lds
    s_add_u32 m0, m0, 1024
    s_add_u32 s17, s70, 196608
    buffer_load_dwordx4 v14, s[24:27], s17 offen lds
    s_add_u32 m0, m0, 1024
    s_add_u32 s17, s70, 229376
    buffer_load_dwordx4 v15, s[24:27], s17 offen lds
    s_add_u32 m0, s72, 16384
    s_add_u32 s17, s70, 131072
    buffer_load_dwordx4 v12, s[28:31], s17 offen lds
    s_add_u32 m0, m0, 1024
    s_add_u32 s17, s70, 163840
    buffer_load_dwordx4 v13, s[28:31], s17 offen lds
    s_add_u32 m0, m0, 1024
    s_add_u32 s17, s70, 196608
    buffer_load_dwordx4 v14, s[28:31], s17 offen lds
    s_add_u32 m0, m0, 1024
    s_add_u32 s17, s70, 229376
    buffer_load_dwordx4 v15, s[28:31], s17 offen lds
    s_add_u32 m0, s72, 20480
    s_add_u32 s17, s70, 262144
    buffer_load_dwordx4 v12, s[20:23], s17 offen lds
    s_add_u32 m0, m0, 1024
    s_add_u32 s17, s70, 294912
    buffer_load_dwordx4 v13, s[20:23], s17 offen lds
    s_add_u32 m0, m0, 1024
    s_add_u32 s17, s70, 327680
    buffer_load_dwordx4 v14, s[20:23], s17 offen lds
    s_add_u32 m0, m0, 1024
    s_add_u32 s17, s70, 360448
    buffer_load_dwordx4 v15, s[20:23], s17 offen lds
    s_add_u32 m0, s72, 24576
    s_add_u32 s17, s70, 262144
    buffer_load_dwordx4 v12, s[24:27], s17 offen lds
    s_add_u32 m0, m0, 1024
    s_add_u32 s17, s70, 294912
    buffer_load_dwordx4 v13, s[24:27], s17 offen lds
    s_add_u32 m0, m0, 1024
    s_add_u32 s17, s70, 327680
    buffer_load_dwordx4 v14, s[24:27], s17 offen lds
    s_add_u32 m0, m0, 1024
    s_add_u32 s17, s70, 360448
    buffer_load_dwordx4 v15, s[24:27], s17 offen lds
    s_add_u32 m0, s72, 28672
    s_add_u32 s17, s70, 393216
    buffer_load_dwordx4 v12, s[20:23], s17 offen lds
    s_add_u32 m0, m0, 1024
    s_add_u32 s17, s70, 425984
    buffer_load_dwordx4 v13, s[20:23], s17 offen lds
    s_add_u32 m0, m0, 1024
    s_add_u32 s17, s70, 458752
    buffer_load_dwordx4 v14, s[20:23], s17 offen lds
    s_add_u32 m0, m0, 1024
    s_add_u32 s17, s70, 491520
    buffer_load_dwordx4 v15, s[20:23], s17 offen lds
    s_add_u32 m0, s72, 32768
    s_add_u32 s17, s71, 256
    buffer_load_dwordx4 v17, s[76:79], s17 offen lds
    s_add_u32 m0, m0, 1024
    s_add_u32 s17, s71, 37120
    buffer_load_dwordx4 v17, s[76:79], s17 offen lds
    s_waitcnt vmcnt(30)
    s_barrier
    ds_read_b64_tr_b16 v[72:73], v18 offset:0
    ds_read_b64_tr_b16 v[74:75], v18 offset:512
    ds_read_b64_tr_b16 v[76:77], v19 offset:0
    ds_read_b64_tr_b16 v[78:79], v19 offset:512
    ds_read_b64_tr_b16 v[80:81], v20 offset:0
    ds_read_b64_tr_b16 v[82:83], v20 offset:512
    ds_read_b64_tr_b16 v[84:85], v21 offset:0
    ds_read_b64_tr_b16 v[86:87], v21 offset:512
    s_waitcnt lgkmcnt(0)
    s_waitcnt vmcnt(26)
    s_barrier
    s_add_u32 m0, s72, 0
    s_add_u32 s17, s70, 393216
    buffer_load_dwordx4 v12, s[24:27], s17 offen lds
    s_add_u32 m0, m0, 1024
    s_add_u32 s17, s70, 425984
    buffer_load_dwordx4 v13, s[24:27], s17 offen lds
    s_add_u32 m0, m0, 1024
    s_add_u32 s17, s70, 458752
    buffer_load_dwordx4 v14, s[24:27], s17 offen lds
    s_add_u32 m0, m0, 1024
    s_add_u32 s17, s70, 491520
    buffer_load_dwordx4 v15, s[24:27], s17 offen lds
    ds_read_b64_tr_b16 v[184:185], v18 offset:4096
    ds_read_b64_tr_b16 v[186:187], v18 offset:4608
    ds_read_b64_tr_b16 v[188:189], v19 offset:4096
    ds_read_b64_tr_b16 v[190:191], v19 offset:4608
    ds_read_b64_tr_b16 v[192:193], v20 offset:4096
    ds_read_b64_tr_b16 v[194:195], v20 offset:4608
    ds_read_b64_tr_b16 v[196:197], v21 offset:4096
    ds_read_b64_tr_b16 v[198:199], v21 offset:4608
    s_waitcnt lgkmcnt(0)
    s_waitcnt vmcnt(26)
    s_barrier
    s_add_u32 m0, s72, 4096
    s_add_u32 s17, s70, 393216
    buffer_load_dwordx4 v12, s[28:31], s17 offen lds
    s_add_u32 m0, m0, 1024
    s_add_u32 s17, s70, 425984
    buffer_load_dwordx4 v13, s[28:31], s17 offen lds
    s_add_u32 m0, m0, 1024
    s_add_u32 s17, s70, 458752
    buffer_load_dwordx4 v14, s[28:31], s17 offen lds
    s_add_u32 m0, m0, 1024
    s_add_u32 s17, s70, 491520
    buffer_load_dwordx4 v15, s[28:31], s17 offen lds
    ds_read_b64_tr_b16 v[88:89], v18 offset:8192
    ds_read_b64_tr_b16 v[90:91], v18 offset:8704
    ds_read_b64_tr_b16 v[92:93], v19 offset:8192
    ds_read_b64_tr_b16 v[94:95], v19 offset:8704
    ds_read_b64_tr_b16 v[96:97], v20 offset:8192
    ds_read_b64_tr_b16 v[98:99], v20 offset:8704
    ds_read_b64_tr_b16 v[100:101], v21 offset:8192
    ds_read_b64_tr_b16 v[102:103], v21 offset:8704
    s_waitcnt lgkmcnt(0)
    s_waitcnt vmcnt(26)
    s_barrier
    s_add_u32 m0, s72, 8192
    s_add_u32 s17, s70, 524288
    buffer_load_dwordx4 v12, s[24:27], s17 offen lds
    s_add_u32 m0, m0, 1024
    s_add_u32 s17, s70, 557056
    buffer_load_dwordx4 v13, s[24:27], s17 offen lds
    s_add_u32 m0, m0, 1024
    s_add_u32 s17, s70, 589824
    buffer_load_dwordx4 v14, s[24:27], s17 offen lds
    s_add_u32 m0, m0, 1024
    s_add_u32 s17, s70, 622592
    buffer_load_dwordx4 v15, s[24:27], s17 offen lds
    ds_read_b64_tr_b16 v[200:201], v18 offset:12288
    ds_read_b64_tr_b16 v[202:203], v18 offset:12800
    ds_read_b64_tr_b16 v[204:205], v19 offset:12288
    ds_read_b64_tr_b16 v[206:207], v19 offset:12800
    ds_read_b64_tr_b16 v[208:209], v20 offset:12288
    ds_read_b64_tr_b16 v[210:211], v20 offset:12800
    ds_read_b64_tr_b16 v[212:213], v21 offset:12288
    ds_read_b64_tr_b16 v[214:215], v21 offset:12800
    s_waitcnt lgkmcnt(0)
    s_waitcnt vmcnt(26)
    s_barrier
    s_add_u32 m0, s72, 12288
    s_add_u32 s17, s70, 524288
    buffer_load_dwordx4 v12, s[28:31], s17 offen lds
    s_add_u32 m0, m0, 1024
    s_add_u32 s17, s70, 557056
    buffer_load_dwordx4 v13, s[28:31], s17 offen lds
    s_add_u32 m0, m0, 1024
    s_add_u32 s17, s70, 589824
    buffer_load_dwordx4 v14, s[28:31], s17 offen lds
    s_add_u32 m0, m0, 1024
    s_add_u32 s17, s70, 622592
    buffer_load_dwordx4 v15, s[28:31], s17 offen lds
    ds_read_b64_tr_b16 a[72:73], v18 offset:16384
    ds_read_b64_tr_b16 a[74:75], v18 offset:16896
    ds_read_b64_tr_b16 a[76:77], v19 offset:16384
    ds_read_b64_tr_b16 a[78:79], v19 offset:16896
    ds_read_b64_tr_b16 a[80:81], v20 offset:16384
    ds_read_b64_tr_b16 a[82:83], v20 offset:16896
    ds_read_b64_tr_b16 a[84:85], v21 offset:16384
    ds_read_b64_tr_b16 a[86:87], v21 offset:16896
    s_waitcnt lgkmcnt(0)
    s_waitcnt vmcnt(26)
    s_barrier
    s_add_u32 m0, s72, 16384
    s_add_u32 s17, s70, 655360
    buffer_load_dwordx4 v12, s[20:23], s17 offen lds
    s_add_u32 m0, m0, 1024
    s_add_u32 s17, s70, 688128
    buffer_load_dwordx4 v13, s[20:23], s17 offen lds
    s_add_u32 m0, m0, 1024
    s_add_u32 s17, s70, 720896
    buffer_load_dwordx4 v14, s[20:23], s17 offen lds
    s_add_u32 m0, m0, 1024
    s_add_u32 s17, s70, 753664
    buffer_load_dwordx4 v15, s[20:23], s17 offen lds
    ds_read_b64_tr_b16 v[104:105], v18 offset:20480
    ds_read_b64_tr_b16 v[106:107], v18 offset:20992
    ds_read_b64_tr_b16 v[108:109], v19 offset:20480
    ds_read_b64_tr_b16 v[110:111], v19 offset:20992
    ds_read_b64_tr_b16 v[112:113], v20 offset:20480
    ds_read_b64_tr_b16 v[114:115], v20 offset:20992
    ds_read_b64_tr_b16 v[116:117], v21 offset:20480
    ds_read_b64_tr_b16 v[118:119], v21 offset:20992
    s_waitcnt lgkmcnt(0)
    s_waitcnt vmcnt(26)
    s_barrier
    s_add_u32 m0, s72, 20480
    s_add_u32 s17, s70, 655360
    buffer_load_dwordx4 v12, s[24:27], s17 offen lds
    s_add_u32 m0, m0, 1024
    s_add_u32 s17, s70, 688128
    buffer_load_dwordx4 v13, s[24:27], s17 offen lds
    s_add_u32 m0, m0, 1024
    s_add_u32 s17, s70, 720896
    buffer_load_dwordx4 v14, s[24:27], s17 offen lds
    s_add_u32 m0, m0, 1024
    s_add_u32 s17, s70, 753664
    buffer_load_dwordx4 v15, s[24:27], s17 offen lds
    ds_read_b64_tr_b16 v[216:217], v18 offset:24576
    ds_read_b64_tr_b16 v[218:219], v18 offset:25088
    ds_read_b64_tr_b16 v[220:221], v19 offset:24576
    ds_read_b64_tr_b16 v[222:223], v19 offset:25088
    ds_read_b64_tr_b16 v[224:225], v20 offset:24576
    ds_read_b64_tr_b16 v[226:227], v20 offset:25088
    ds_read_b64_tr_b16 v[228:229], v21 offset:24576
    ds_read_b64_tr_b16 v[230:231], v21 offset:25088
    s_waitcnt lgkmcnt(0)
    s_waitcnt vmcnt(26)
    s_barrier
    s_add_u32 m0, s72, 24576
    s_add_u32 s17, s70, 655360
    buffer_load_dwordx4 v12, s[28:31], s17 offen lds
    s_add_u32 m0, m0, 1024
    s_add_u32 s17, s70, 688128
    buffer_load_dwordx4 v13, s[28:31], s17 offen lds
    s_add_u32 m0, m0, 1024
    s_add_u32 s17, s70, 720896
    buffer_load_dwordx4 v14, s[28:31], s17 offen lds
    s_add_u32 m0, m0, 1024
    s_add_u32 s17, s70, 753664
    buffer_load_dwordx4 v15, s[28:31], s17 offen lds
    ds_read_b64_tr_b16 v[120:121], v18 offset:28672
    ds_read_b64_tr_b16 v[122:123], v18 offset:29184
    ds_read_b64_tr_b16 v[124:125], v19 offset:28672
    ds_read_b64_tr_b16 v[126:127], v19 offset:29184
    ds_read_b64_tr_b16 v[128:129], v20 offset:28672
    ds_read_b64_tr_b16 v[130:131], v20 offset:29184
    ds_read_b64_tr_b16 v[132:133], v21 offset:28672
    ds_read_b64_tr_b16 v[134:135], v21 offset:29184
    s_waitcnt lgkmcnt(0)
    s_waitcnt vmcnt(24)
    s_barrier
    s_add_u32 m0, s72, 28672
    s_add_u32 s17, s70, 786432
    buffer_load_dwordx4 v12, s[24:27], s17 offen lds
    s_add_u32 m0, m0, 1024
    s_add_u32 s17, s70, 819200
    buffer_load_dwordx4 v13, s[24:27], s17 offen lds
    s_add_u32 m0, m0, 1024
    s_add_u32 s17, s70, 851968
    buffer_load_dwordx4 v14, s[24:27], s17 offen lds
    s_add_u32 m0, m0, 1024
    s_add_u32 s17, s70, 884736
    buffer_load_dwordx4 v15, s[24:27], s17 offen lds
    ds_read_b64_tr_b16 v[232:233], v18 offset:0
    ds_read_b64_tr_b16 v[234:235], v18 offset:512
    ds_read_b64_tr_b16 v[236:237], v19 offset:0
    ds_read_b64_tr_b16 v[238:239], v19 offset:512
    ds_read_b64_tr_b16 v[240:241], v20 offset:0
    ds_read_b64_tr_b16 v[242:243], v20 offset:512
    ds_read_b64_tr_b16 v[244:245], v21 offset:0
    ds_read_b64_tr_b16 v[246:247], v21 offset:512
    s_waitcnt lgkmcnt(0)
    s_waitcnt vmcnt(24)
    s_barrier
    s_add_u32 m0, s72, 0
    s_add_u32 s17, s70, 786432
    buffer_load_dwordx4 v12, s[28:31], s17 offen lds
    s_add_u32 m0, m0, 1024
    s_add_u32 s17, s70, 819200
    buffer_load_dwordx4 v13, s[28:31], s17 offen lds
    s_add_u32 m0, m0, 1024
    s_add_u32 s17, s70, 851968
    buffer_load_dwordx4 v14, s[28:31], s17 offen lds
    s_add_u32 m0, m0, 1024
    s_add_u32 s17, s70, 884736
    buffer_load_dwordx4 v15, s[28:31], s17 offen lds
    ds_read_b64_tr_b16 a[88:89], v18 offset:4096
    ds_read_b64_tr_b16 a[90:91], v18 offset:4608
    ds_read_b64_tr_b16 a[92:93], v19 offset:4096
    ds_read_b64_tr_b16 a[94:95], v19 offset:4608
    ds_read_b64_tr_b16 a[96:97], v20 offset:4096
    ds_read_b64_tr_b16 a[98:99], v20 offset:4608
    ds_read_b64_tr_b16 a[100:101], v21 offset:4096
    ds_read_b64_tr_b16 a[102:103], v21 offset:4608
    s_waitcnt lgkmcnt(0)
    s_waitcnt vmcnt(24)
    s_barrier
    s_add_u32 m0, s72, 4096
    s_add_u32 s17, s70, 917504
    buffer_load_dwordx4 v12, s[20:23], s17 offen lds
    s_add_u32 m0, m0, 1024
    s_add_u32 s17, s70, 950272
    buffer_load_dwordx4 v13, s[20:23], s17 offen lds
    s_add_u32 m0, m0, 1024
    s_add_u32 s17, s70, 983040
    buffer_load_dwordx4 v14, s[20:23], s17 offen lds
    s_add_u32 m0, m0, 1024
    s_add_u32 s17, s70, 1015808
    buffer_load_dwordx4 v15, s[20:23], s17 offen lds
    ds_read_b64_tr_b16 v[248:249], v18 offset:8192
    ds_read_b64_tr_b16 v[250:251], v18 offset:8704
    ds_read_b64_tr_b16 v[252:253], v19 offset:8192
    ds_read_b64_tr_b16 v[254:255], v19 offset:8704
    ds_read_b64_tr_b16 a[0:1], v20 offset:8192
    ds_read_b64_tr_b16 a[2:3], v20 offset:8704
    ds_read_b64_tr_b16 a[4:5], v21 offset:8192
    ds_read_b64_tr_b16 a[6:7], v21 offset:8704
    s_waitcnt lgkmcnt(0)
    s_waitcnt vmcnt(24)
    s_barrier
    s_add_u32 m0, s72, 8192
    s_add_u32 s17, s70, 917504
    buffer_load_dwordx4 v12, s[24:27], s17 offen lds
    s_add_u32 m0, m0, 1024
    s_add_u32 s17, s70, 950272
    buffer_load_dwordx4 v13, s[24:27], s17 offen lds
    s_add_u32 m0, m0, 1024
    s_add_u32 s17, s70, 983040
    buffer_load_dwordx4 v14, s[24:27], s17 offen lds
    s_add_u32 m0, m0, 1024
    s_add_u32 s17, s70, 1015808
    buffer_load_dwordx4 v15, s[24:27], s17 offen lds
    ds_read_b64_tr_b16 a[104:105], v18 offset:12288
    ds_read_b64_tr_b16 a[106:107], v18 offset:12800
    ds_read_b64_tr_b16 a[108:109], v19 offset:12288
    ds_read_b64_tr_b16 a[110:111], v19 offset:12800
    ds_read_b64_tr_b16 a[112:113], v20 offset:12288
    ds_read_b64_tr_b16 a[114:115], v20 offset:12800
    ds_read_b64_tr_b16 a[116:117], v21 offset:12288
    ds_read_b64_tr_b16 a[118:119], v21 offset:12800
    s_waitcnt lgkmcnt(0)
    s_waitcnt vmcnt(24)
    s_barrier
    s_add_u32 m0, s72, 12288
    s_add_u32 s17, s70, 917504
    buffer_load_dwordx4 v12, s[28:31], s17 offen lds
    s_add_u32 m0, m0, 1024
    s_add_u32 s17, s70, 950272
    buffer_load_dwordx4 v13, s[28:31], s17 offen lds
    s_add_u32 m0, m0, 1024
    s_add_u32 s17, s70, 983040
    buffer_load_dwordx4 v14, s[28:31], s17 offen lds
    s_add_u32 m0, m0, 1024
    s_add_u32 s17, s70, 1015808
    buffer_load_dwordx4 v15, s[28:31], s17 offen lds
    ds_read_b64_tr_b16 v[136:137], v18 offset:16384
    ds_read_b64_tr_b16 v[138:139], v18 offset:16896
    ds_read_b64_tr_b16 v[140:141], v19 offset:16384
    ds_read_b64_tr_b16 v[142:143], v19 offset:16896
    ds_read_b64_tr_b16 v[144:145], v20 offset:16384
    ds_read_b64_tr_b16 v[146:147], v20 offset:16896
    ds_read_b64_tr_b16 v[148:149], v21 offset:16384
    ds_read_b64_tr_b16 v[150:151], v21 offset:16896
    s_waitcnt lgkmcnt(0)
    s_add_u32 s17, s32, s14
    s_cmp_lg_u32 s17, 0
    s_cbranch_scc1 Lr_nold
    v_mov_b32 v63, 48
    v_mov_b32 v64, 1
    s_mov_b64 exec, 1
    global_atomic_add v63, v64, s[12:13]
    s_mov_b64 exec, -1
Lr_nold:
    s_waitcnt vmcnt(24)
    s_barrier
    s_add_u32 m0, s72, 16384
    s_add_u32 s17, s70, 1048576
    buffer_load_dwordx4 v12, s[20:23], s17 offen lds
    s_add_u32 m0, m0, 1024
    s_add_u32 s17, s70, 1081344
    buffer_load_dwordx4 v13, s[20:23], s17 offen lds
    s_add_u32 m0, m0, 1024
    s_add_u32 s17, s70, 1114112
    buffer_load_dwordx4 v14, s[20:23], s17 offen lds
    s_add_u32 m0, m0, 1024
    s_add_u32 s17, s70, 1146880
    buffer_load_dwordx4 v15, s[20:23], s17 offen lds
    ds_read_b64_tr_b16 a[8:9], v18 offset:20480
    ds_read_b64_tr_b16 a[10:11], v18 offset:20992
    ds_read_b64_tr_b16 a[12:13], v19 offset:20480
    ds_read_b64_tr_b16 a[14:15], v19 offset:20992
    ds_read_b64_tr_b16 a[16:17], v20 offset:20480
    ds_read_b64_tr_b16 a[18:19], v20 offset:20992
    ds_read_b64_tr_b16 a[20:21], v21 offset:20480
    ds_read_b64_tr_b16 a[22:23], v21 offset:20992
    s_waitcnt lgkmcnt(0)
    s_waitcnt vmcnt(24)
    s_barrier
    s_add_u32 m0, s72, 20480
    s_add_u32 s17, s70, 1048576
    buffer_load_dwordx4 v12, s[24:27], s17 offen lds
    s_add_u32 m0, m0, 1024
    s_add_u32 s17, s70, 1081344
    buffer_load_dwordx4 v13, s[24:27], s17 offen lds
    s_add_u32 m0, m0, 1024
    s_add_u32 s17, s70, 1114112
    buffer_load_dwordx4 v14, s[24:27], s17 offen lds
    s_add_u32 m0, m0, 1024
    s_add_u32 s17, s70, 1146880
    buffer_load_dwordx4 v15, s[24:27], s17 offen lds
    ds_read_b64_tr_b16 a[120:121], v18 offset:24576
    ds_read_b64_tr_b16 a[122:123], v18 offset:25088
    ds_read_b64_tr_b16 a[124:125], v19 offset:24576
    ds_read_b64_tr_b16 a[126:127], v19 offset:25088
    ds_read_b64_tr_b16 a[128:129], v20 offset:24576
    ds_read_b64_tr_b16 a[130:131], v20 offset:25088
    ds_read_b64_tr_b16 a[132:133], v21 offset:24576
    ds_read_b64_tr_b16 a[134:135], v21 offset:25088
    s_waitcnt lgkmcnt(0)
    s_waitcnt vmcnt(24)
    s_barrier
    s_add_u32 m0, s72, 24576
    s_add_u32 s17, s70, 1048576
    buffer_load_dwordx4 v12, s[28:31], s17 offen lds
    s_add_u32 m0, m0, 1024
    s_add_u32 s17, s70, 1081344
    buffer_load_dwordx4 v13, s[28:31], s17 offen lds
    s_add_u32 m0, m0, 1024
    s_add_u32 s17, s70, 1114112
    buffer_load_dwordx4 v14, s[28:31], s17 offen lds
    s_add_u32 m0, m0, 1024
    s_add_u32 s17, s70, 1146880
    buffer_load_dwordx4 v15, s[28:31], s17 offen lds
    ds_read_b64_tr_b16 a[24:25], v18 offset:28672
    ds_read_b64_tr_b16 a[26:27], v18 offset:29184
    ds_read_b64_tr_b16 a[28:29], v19 offset:28672
    ds_read_b64_tr_b16 a[30:31], v19 offset:29184
    ds_read_b64_tr_b16 a[32:33], v20 offset:28672
    ds_read_b64_tr_b16 a[34:35], v20 offset:29184
    ds_read_b64_tr_b16 a[36:37], v21 offset:28672
    ds_read_b64_tr_b16 a[38:39], v21 offset:29184
    s_waitcnt lgkmcnt(0)
    s_waitcnt vmcnt(24)
    s_barrier
    ds_read_b64_tr_b16 a[136:137], v18 offset:0
    ds_read_b64_tr_b16 a[138:139], v18 offset:512
    ds_read_b64_tr_b16 a[140:141], v19 offset:0
    ds_read_b64_tr_b16 a[142:143], v19 offset:512
    ds_read_b64_tr_b16 a[144:145], v20 offset:0
    ds_read_b64_tr_b16 a[146:147], v20 offset:512
    ds_read_b64_tr_b16 a[148:149], v21 offset:0
    ds_read_b64_tr_b16 a[150:151], v21 offset:512
    s_waitcnt lgkmcnt(0)
    s_waitcnt vmcnt(20)
    s_barrier
    s_add_u32 m0, s72, 0
    s_add_u32 s17, s70, 0
    buffer_load_dwordx4 v12, s[28:31], s17 offen lds
    s_add_u32 m0, m0, 1024
    s_add_u32 s17, s70, 32768
    buffer_load_dwordx4 v13, s[28:31], s17 offen lds
    s_add_u32 m0, m0, 1024
    s_add_u32 s17, s70, 65536
    buffer_load_dwordx4 v14, s[28:31], s17 offen lds
    s_add_u32 m0, m0, 1024
    s_add_u32 s17, s70, 98304
    buffer_load_dwordx4 v15, s[28:31], s17 offen lds
    ds_read_b64_tr_b16 v[152:153], v18 offset:4096
    ds_read_b64_tr_b16 v[154:155], v18 offset:4608
    ds_read_b64_tr_b16 v[156:157], v19 offset:4096
    ds_read_b64_tr_b16 v[158:159], v19 offset:4608
    ds_read_b64_tr_b16 v[160:161], v20 offset:4096
    ds_read_b64_tr_b16 v[162:163], v20 offset:4608
    ds_read_b64_tr_b16 v[164:165], v21 offset:4096
    ds_read_b64_tr_b16 v[166:167], v21 offset:4608
    s_waitcnt lgkmcnt(0)
    s_waitcnt vmcnt(20)
    s_barrier
    s_add_u32 m0, s72, 4096
    s_add_u32 s17, s70, 262144
    buffer_load_dwordx4 v12, s[28:31], s17 offen lds
    s_add_u32 m0, m0, 1024
    s_add_u32 s17, s70, 294912
    buffer_load_dwordx4 v13, s[28:31], s17 offen lds
    s_add_u32 m0, m0, 1024
    s_add_u32 s17, s70, 327680
    buffer_load_dwordx4 v14, s[28:31], s17 offen lds
    s_add_u32 m0, m0, 1024
    s_add_u32 s17, s70, 360448
    buffer_load_dwordx4 v15, s[28:31], s17 offen lds
    ds_read_b64_tr_b16 a[40:41], v18 offset:8192
    ds_read_b64_tr_b16 a[42:43], v18 offset:8704
    ds_read_b64_tr_b16 a[44:45], v19 offset:8192
    ds_read_b64_tr_b16 a[46:47], v19 offset:8704
    ds_read_b64_tr_b16 a[48:49], v20 offset:8192
    ds_read_b64_tr_b16 a[50:51], v20 offset:8704
    ds_read_b64_tr_b16 a[52:53], v21 offset:8192
    ds_read_b64_tr_b16 a[54:55], v21 offset:8704
    s_waitcnt lgkmcnt(0)
    s_waitcnt vmcnt(20)
    s_barrier
    s_add_u32 m0, s72, 8192
    s_add_u32 s17, s70, 524288
    buffer_load_dwordx4 v12, s[20:23], s17 offen lds
    s_add_u32 m0, m0, 1024
    s_add_u32 s17, s70, 557056
    buffer_load_dwordx4 v13, s[20:23], s17 offen lds
    s_add_u32 m0, m0, 1024
    s_add_u32 s17, s70, 589824
    buffer_load_dwordx4 v14, s[20:23], s17 offen lds
    s_add_u32 m0, m0, 1024
    s_add_u32 s17, s70, 622592
    buffer_load_dwordx4 v15, s[20:23], s17 offen lds
    ds_read_b64_tr_b16 a[152:153], v18 offset:12288
    ds_read_b64_tr_b16 a[154:155], v18 offset:12800
    ds_read_b64_tr_b16 a[156:157], v19 offset:12288
    ds_read_b64_tr_b16 a[158:159], v19 offset:12800
    ds_read_b64_tr_b16 a[160:161], v20 offset:12288
    ds_read_b64_tr_b16 a[162:163], v20 offset:12800
    ds_read_b64_tr_b16 a[164:165], v21 offset:12288
    ds_read_b64_tr_b16 a[166:167], v21 offset:12800
    s_waitcnt lgkmcnt(0)
    s_waitcnt vmcnt(20)
    s_barrier
    s_add_u32 m0, s72, 12288
    s_add_u32 s17, s70, 786432
    buffer_load_dwordx4 v12, s[20:23], s17 offen lds
    s_add_u32 m0, m0, 1024
    s_add_u32 s17, s70, 819200
    buffer_load_dwordx4 v13, s[20:23], s17 offen lds
    s_add_u32 m0, m0, 1024
    s_add_u32 s17, s70, 851968
    buffer_load_dwordx4 v14, s[20:23], s17 offen lds
    s_add_u32 m0, m0, 1024
    s_add_u32 s17, s70, 884736
    buffer_load_dwordx4 v15, s[20:23], s17 offen lds
    ds_read_b64_tr_b16 v[168:169], v18 offset:16384
    ds_read_b64_tr_b16 v[170:171], v18 offset:16896
    ds_read_b64_tr_b16 v[172:173], v19 offset:16384
    ds_read_b64_tr_b16 v[174:175], v19 offset:16896
    ds_read_b64_tr_b16 v[176:177], v20 offset:16384
    ds_read_b64_tr_b16 v[178:179], v20 offset:16896
    ds_read_b64_tr_b16 v[180:181], v21 offset:16384
    ds_read_b64_tr_b16 v[182:183], v21 offset:16896
    s_waitcnt lgkmcnt(0)
    s_waitcnt vmcnt(20)
    s_barrier
    s_add_u32 m0, s72, 16384
    s_add_u32 s17, s71, 0
    buffer_load_dwordx4 v16, s[76:79], s17 offen lds
    s_add_u32 m0, m0, 1024
    s_add_u32 s17, s71, 18432
    buffer_load_dwordx4 v16, s[76:79], s17 offen lds
    s_add_u32 m0, m0, 1024
    s_add_u32 s17, s71, 36864
    buffer_load_dwordx4 v16, s[76:79], s17 offen lds
    s_add_u32 m0, m0, 1024
    s_add_u32 s17, s71, 55296
    buffer_load_dwordx4 v16, s[76:79], s17 offen lds
    ds_read_b64_tr_b16 a[56:57], v18 offset:20480
    ds_read_b64_tr_b16 a[58:59], v18 offset:20992
    ds_read_b64_tr_b16 a[60:61], v19 offset:20480
    ds_read_b64_tr_b16 a[62:63], v19 offset:20992
    ds_read_b64_tr_b16 a[64:65], v20 offset:20480
    ds_read_b64_tr_b16 a[66:67], v20 offset:20992
    ds_read_b64_tr_b16 a[68:69], v21 offset:20480
    ds_read_b64_tr_b16 a[70:71], v21 offset:20992
    s_waitcnt lgkmcnt(0)
    s_waitcnt vmcnt(20)
    s_barrier
    s_add_u32 m0, s72, 20480
    s_add_u32 s17, s71, 73728
    buffer_load_dwordx4 v16, s[76:79], s17 offen lds
    s_add_u32 m0, m0, 1024
    s_add_u32 s17, s71, 92160
    buffer_load_dwordx4 v16, s[76:79], s17 offen lds
    s_add_u32 m0, m0, 1024
    s_add_u32 s17, s71, 110592
    buffer_load_dwordx4 v16, s[76:79], s17 offen lds
    s_add_u32 m0, m0, 1024
    s_add_u32 s17, s71, 129024
    buffer_load_dwordx4 v16, s[76:79], s17 offen lds
    ds_read_b64_tr_b16 a[168:169], v18 offset:24576
    ds_read_b64_tr_b16 a[170:171], v18 offset:25088
    ds_read_b64_tr_b16 a[172:173], v19 offset:24576
    ds_read_b64_tr_b16 a[174:175], v19 offset:25088
    ds_read_b64_tr_b16 a[176:177], v20 offset:24576
    ds_read_b64_tr_b16 a[178:179], v20 offset:25088
    ds_read_b64_tr_b16 a[180:181], v21 offset:24576
    ds_read_b64_tr_b16 a[182:183], v21 offset:25088
    s_waitcnt lgkmcnt(0)
    s_waitcnt vmcnt(20)
    s_barrier
    s_add_u32 m0, s72, 24576
    s_add_u32 s17, s71, 64
    buffer_load_dwordx4 v16, s[76:79], s17 offen lds
    s_add_u32 m0, m0, 1024
    s_add_u32 s17, s71, 18496
    buffer_load_dwordx4 v16, s[76:79], s17 offen lds
    s_add_u32 m0, m0, 1024
    s_add_u32 s17, s71, 36928
    buffer_load_dwordx4 v16, s[76:79], s17 offen lds
    s_add_u32 m0, m0, 1024
    s_add_u32 s17, s71, 55360
    buffer_load_dwordx4 v16, s[76:79], s17 offen lds
    s_add_u32 m0, s72, 28672
    s_add_u32 s17, s71, 73792
    buffer_load_dwordx4 v16, s[76:79], s17 offen lds
    s_add_u32 m0, m0, 1024
    s_add_u32 s17, s71, 92224
    buffer_load_dwordx4 v16, s[76:79], s17 offen lds
    s_add_u32 m0, m0, 1024
    s_add_u32 s17, s71, 110656
    buffer_load_dwordx4 v16, s[76:79], s17 offen lds
    s_add_u32 m0, m0, 1024
    s_add_u32 s17, s71, 129088
    buffer_load_dwordx4 v16, s[76:79], s17 offen lds
    ds_read_b64_tr_b16 v[24:25], v18 offset:0
    ds_read_b64_tr_b16 v[26:27], v18 offset:512
    ds_read_b64_tr_b16 v[28:29], v19 offset:0
    ds_read_b64_tr_b16 v[30:31], v19 offset:512
    ds_read_b64_tr_b16 v[32:33], v20 offset:0
    ds_read_b64_tr_b16 v[34:35], v20 offset:512
    ds_read_b64_tr_b16 v[36:37], v21 offset:0
    ds_read_b64_tr_b16 v[38:39], v21 offset:512
    s_waitcnt lgkmcnt(0)
    s_barrier
    ds_write_b128 v8, v[24:27] offset:0
    ds_write_b128 v8, v[28:31] offset:1024
    ds_write_b128 v8, v[32:35] offset:2048
    ds_write_b128 v8, v[36:39] offset:3072
    s_waitcnt lgkmcnt(0)
    s_waitcnt vmcnt(24)
    s_barrier
    ds_read_b64_tr_b16 v[24:25], v18 offset:4096
    ds_read_b64_tr_b16 v[26:27], v18 offset:4608
    ds_read_b64_tr_b16 v[28:29], v19 offset:4096
    ds_read_b64_tr_b16 v[30:31], v19 offset:4608
    ds_read_b64_tr_b16 v[32:33], v20 offset:4096
    ds_read_b64_tr_b16 v[34:35], v20 offset:4608
    ds_read_b64_tr_b16 v[36:37], v21 offset:4096
    ds_read_b64_tr_b16 v[38:39], v21 offset:4608
    s_waitcnt lgkmcnt(0)
    s_barrier
    ds_write_b128 v8, v[24:27] offset:4096
    ds_write_b128 v8, v[28:31] offset:5120
    ds_write_b128 v8, v[32:35] offset:6144
    ds_write_b128 v8, v[36:39] offset:7168
    s_waitcnt lgkmcnt(0)
    s_waitcnt vmcnt(20)
    s_barrier
    ds_read_b64_tr_b16 v[24:25], v18 offset:8192
    ds_read_b64_tr_b16 v[26:27], v18 offset:8704
    ds_read_b64_tr_b16 v[28:29], v19 offset:8192
    ds_read_b64_tr_b16 v[30:31], v19 offset:8704
    ds_read_b64_tr_b16 v[32:33], v20 offset:8192
    ds_read_b64_tr_b16 v[34:35], v20 offset:8704
    ds_read_b64_tr_b16 v[36:37], v21 offset:8192
    ds_read_b64_tr_b16 v[38:39], v21 offset:8704
    s_waitcnt lgkmcnt(0)
    s_barrier
    ds_write_b128 v8, v[24:27] offset:8192
    ds_write_b128 v8, v[28:31] offset:9216
    ds_write_b128 v8, v[32:35] offset:10240
    ds_write_b128 v8, v[36:39] offset:11264
    s_waitcnt lgkmcnt(0)
    s_waitcnt vmcnt(16)
    s_barrier
    ds_read_b64_tr_b16 v[24:25], v18 offset:12288
    ds_read_b64_tr_b16 v[26:27], v18 offset:12800
    ds_read_b64_tr_b16 v[28:29], v19 offset:12288
    ds_read_b64_tr_b16 v[30:31], v19 offset:12800
    ds_read_b64_tr_b16 v[32:33], v20 offset:12288
    ds_read_b64_tr_b16 v[34:35], v20 offset:12800
    ds_read_b64_tr_b16 v[36:37], v21 offset:12288
    ds_read_b64_tr_b16 v[38:39], v21 offset:12800
    s_waitcnt lgkmcnt(0)
    s_barrier
    ds_write_b128 v8, v[24:27] offset:12288
    ds_write_b128 v8, v[28:31] offset:13312
    ds_write_b128 v8, v[32:35] offset:14336
    ds_write_b128 v8, v[36:39] offset:15360
    s_waitcnt lgkmcnt(0)
    s_barrier
    s_waitcnt vmcnt(12)
    ds_read_b64_tr_b16 a[184:185], v22 offset:16384
    ds_read_b64_tr_b16 a[186:187], v22 offset:16448
    ds_read_b64_tr_b16 a[188:189], v22 offset:18432
    ds_read_b64_tr_b16 a[190:191], v22 offset:18496
    ds_read_b64_tr_b16 a[200:201], v22 offset:16416
    ds_read_b64_tr_b16 a[202:203], v22 offset:16480
    ds_read_b64_tr_b16 a[204:205], v22 offset:18464
    ds_read_b64_tr_b16 a[206:207], v22 offset:18528
    s_waitcnt lgkmcnt(0)
    s_add_u32 m0, s72, 16384
    s_add_u32 s17, s71, 128
    buffer_load_dwordx4 v16, s[76:79], s17 offen lds
    s_add_u32 m0, m0, 1024
    s_add_u32 s17, s71, 18560
    buffer_load_dwordx4 v16, s[76:79], s17 offen lds
    s_add_u32 m0, m0, 1024
    s_add_u32 s17, s71, 36992
    buffer_load_dwordx4 v16, s[76:79], s17 offen lds
    s_add_u32 m0, m0, 1024
    s_add_u32 s17, s71, 55424
    buffer_load_dwordx4 v16, s[76:79], s17 offen lds
    s_waitcnt vmcnt(12)
    ds_read_b64_tr_b16 a[192:193], v22 offset:20480
    ds_read_b64_tr_b16 a[194:195], v22 offset:20544
    ds_read_b64_tr_b16 a[196:197], v22 offset:22528
    ds_read_b64_tr_b16 a[198:199], v22 offset:22592
    ds_read_b64_tr_b16 a[208:209], v22 offset:20512
    ds_read_b64_tr_b16 a[210:211], v22 offset:20576
    ds_read_b64_tr_b16 a[212:213], v22 offset:22560
    ds_read_b64_tr_b16 a[214:215], v22 offset:22624
    s_waitcnt lgkmcnt(0)
    s_add_u32 m0, s72, 20480
    s_add_u32 s17, s71, 73856
    buffer_load_dwordx4 v16, s[76:79], s17 offen lds
    s_add_u32 m0, m0, 1024
    s_add_u32 s17, s71, 92288
    buffer_load_dwordx4 v16, s[76:79], s17 offen lds
    s_add_u32 m0, m0, 1024
    s_add_u32 s17, s71, 110720
    buffer_load_dwordx4 v16, s[76:79], s17 offen lds
    s_add_u32 m0, m0, 1024
    s_add_u32 s17, s71, 129152
    buffer_load_dwordx4 v16, s[76:79], s17 offen lds
    s_waitcnt vmcnt(12)
    ds_read_b64_tr_b16 a[216:217], v22 offset:24576
    ds_read_b64_tr_b16 a[218:219], v22 offset:24640
    ds_read_b64_tr_b16 a[220:221], v22 offset:26624
    ds_read_b64_tr_b16 a[222:223], v22 offset:26688
    ds_read_b64_tr_b16 a[232:233], v22 offset:24608
    ds_read_b64_tr_b16 a[234:235], v22 offset:24672
    ds_read_b64_tr_b16 a[236:237], v22 offset:26656
    ds_read_b64_tr_b16 a[238:239], v22 offset:26720
    s_waitcnt lgkmcnt(0)
    s_add_u32 m0, s72, 24576
    s_add_u32 s17, s71, 192
    buffer_load_dwordx4 v16, s[76:79], s17 offen lds
    s_add_u32 m0, m0, 1024
    s_add_u32 s17, s71, 18624
    buffer_load_dwordx4 v16, s[76:79], s17 offen lds
    s_add_u32 m0, m0, 1024
    s_add_u32 s17, s71, 37056
    buffer_load_dwordx4 v16, s[76:79], s17 offen lds
    s_add_u32 m0, m0, 1024
    s_add_u32 s17, s71, 55488
    buffer_load_dwordx4 v16, s[76:79], s17 offen lds
    s_waitcnt vmcnt(12)
    ds_read_b64_tr_b16 a[224:225], v22 offset:28672
    ds_read_b64_tr_b16 a[226:227], v22 offset:28736
    ds_read_b64_tr_b16 a[228:229], v22 offset:30720
    ds_read_b64_tr_b16 a[230:231], v22 offset:30784
    ds_read_b64_tr_b16 a[240:241], v22 offset:28704
    ds_read_b64_tr_b16 a[242:243], v22 offset:28768
    ds_read_b64_tr_b16 a[244:245], v22 offset:30752
    ds_read_b64_tr_b16 a[246:247], v22 offset:30816
    s_waitcnt lgkmcnt(0)
    s_add_u32 m0, s72, 28672
    s_add_u32 s17, s71, 73920
    buffer_load_dwordx4 v16, s[76:79], s17 offen lds
    s_add_u32 m0, m0, 1024
    s_add_u32 s17, s71, 92352
    buffer_load_dwordx4 v16, s[76:79], s17 offen lds
    s_add_u32 m0, m0, 1024
    s_add_u32 s17, s71, 110784
    buffer_load_dwordx4 v16, s[76:79], s17 offen lds
    s_add_u32 m0, m0, 1024
    s_add_u32 s17, s71, 129216
    buffer_load_dwordx4 v16, s[76:79], s17 offen lds
    s_waitcnt vmcnt(63)
    ds_read_b64_tr_b16 a[248:249], v23 offset:32768
    ds_read_b64_tr_b16 a[250:251], v23 offset:32800
    ds_read_b64_tr_b16 a[252:253], v23 offset:33792
    ds_read_b64_tr_b16 a[254:255], v23 offset:33824
    s_waitcnt lgkmcnt(0)
    s_add_u32 m0, s72, 32768
    s_add_u32 s17, s71, 73984
    buffer_load_dwordx4 v17, s[76:79], s17 offen lds
    s_add_u32 m0, m0, 1024
    s_add_u32 s17, s71, 110848
    buffer_load_dwordx4 v17, s[76:79], s17 offen lds
    s_waitcnt vmcnt(14)
    ds_read_b64_tr_b16 v[24:25], v22 offset:16384
    ds_read_b64_tr_b16 v[26:27], v22 offset:16448
    ds_read_b64_tr_b16 v[28:29], v22 offset:18432
    ds_read_b64_tr_b16 v[30:31], v22 offset:18496
    ds_read_b64_tr_b16 v[32:33], v22 offset:16416
    ds_read_b64_tr_b16 v[34:35], v22 offset:16480
    ds_read_b64_tr_b16 v[36:37], v22 offset:18464
    ds_read_b64_tr_b16 v[38:39], v22 offset:18528
    s_waitcnt lgkmcnt(0)
    ds_write_b128 v8, v[24:27] offset:16384
    ds_write_b128 v8, v[28:31] offset:17408
    ds_write_b128 v8, v[32:35] offset:18432
    ds_write_b128 v8, v[36:39] offset:19456
    s_waitcnt lgkmcnt(0)
    s_waitcnt vmcnt(10)
    ds_read_b64_tr_b16 v[24:25], v22 offset:20480
    ds_read_b64_tr_b16 v[26:27], v22 offset:20544
    ds_read_b64_tr_b16 v[28:29], v22 offset:22528
    ds_read_b64_tr_b16 v[30:31], v22 offset:22592
    ds_read_b64_tr_b16 v[32:33], v22 offset:20512
    ds_read_b64_tr_b16 v[34:35], v22 offset:20576
    ds_read_b64_tr_b16 v[36:37], v22 offset:22560
    ds_read_b64_tr_b16 v[38:39], v22 offset:22624
    s_waitcnt lgkmcnt(0)
    ds_write_b128 v8, v[24:27] offset:20480
    ds_write_b128 v8, v[28:31] offset:21504
    ds_write_b128 v8, v[32:35] offset:22528
    ds_write_b128 v8, v[36:39] offset:23552
    s_waitcnt lgkmcnt(0)
    s_waitcnt vmcnt(6)
    ds_read_b64_tr_b16 v[24:25], v22 offset:24576
    ds_read_b64_tr_b16 v[26:27], v22 offset:24640
    ds_read_b64_tr_b16 v[28:29], v22 offset:26624
    ds_read_b64_tr_b16 v[30:31], v22 offset:26688
    ds_read_b64_tr_b16 v[32:33], v22 offset:24608
    ds_read_b64_tr_b16 v[34:35], v22 offset:24672
    ds_read_b64_tr_b16 v[36:37], v22 offset:26656
    ds_read_b64_tr_b16 v[38:39], v22 offset:26720
    s_waitcnt lgkmcnt(0)
    ds_write_b128 v8, v[24:27] offset:24576
    ds_write_b128 v8, v[28:31] offset:25600
    ds_write_b128 v8, v[32:35] offset:26624
    ds_write_b128 v8, v[36:39] offset:27648
    s_waitcnt lgkmcnt(0)
    s_waitcnt vmcnt(2)
    ds_read_b64_tr_b16 v[24:25], v22 offset:28672
    ds_read_b64_tr_b16 v[26:27], v22 offset:28736
    ds_read_b64_tr_b16 v[28:29], v22 offset:30720
    ds_read_b64_tr_b16 v[30:31], v22 offset:30784
    ds_read_b64_tr_b16 v[32:33], v22 offset:28704
    ds_read_b64_tr_b16 v[34:35], v22 offset:28768
    ds_read_b64_tr_b16 v[36:37], v22 offset:30752
    ds_read_b64_tr_b16 v[38:39], v22 offset:30816
    s_waitcnt lgkmcnt(0)
    ds_write_b128 v8, v[24:27] offset:28672
    ds_write_b128 v8, v[28:31] offset:29696
    ds_write_b128 v8, v[32:35] offset:30720
    ds_write_b128 v8, v[36:39] offset:31744
    s_waitcnt lgkmcnt(0)
    s_waitcnt vmcnt(0)
    ds_read_b64_tr_b16 v[24:25], v23 offset:32768
    ds_read_b64_tr_b16 v[26:27], v23 offset:32800
    ds_read_b64_tr_b16 v[28:29], v23 offset:33792
    ds_read_b64_tr_b16 v[30:31], v23 offset:33824
    s_waitcnt lgkmcnt(0)
    ds_write_b128 v8, v[24:27] offset:32768
    ds_write_b128 v8, v[28:31] offset:33792
    s_waitcnt lgkmcnt(0)
    v_bfe_u32 v9, v0, 4, 4
    v_mov_b32 v10, 0x3f80
    v_mov_b32 v16, 0x3f800000
    v_cmp_eq_u32 vcc, 0, v9
    v_cmp_eq_u32 s[48:49], 1, v9
    s_nop 0
    v_cndmask_b32 v12, 0, v10, vcc
    v_cndmask_b32 v12, v12, v16, s[48:49]
    v_cmp_eq_u32 vcc, 2, v9
    v_cmp_eq_u32 s[48:49], 3, v9
    s_nop 0
    v_cndmask_b32 v13, 0, v10, vcc
    v_cndmask_b32 v13, v13, v16, s[48:49]
    v_cmp_eq_u32 vcc, 4, v9
    v_cmp_eq_u32 s[48:49], 5, v9
    s_nop 0
    v_cndmask_b32 v14, 0, v10, vcc
    v_cndmask_b32 v14, v14, v16, s[48:49]
    v_cmp_eq_u32 vcc, 6, v9
    v_cmp_eq_u32 s[48:49], 7, v9
    s_nop 0
    v_cndmask_b32 v15, 0, v10, vcc
    v_cndmask_b32 v15, v15, v16, s[48:49]
    v_add_u32 v9, 162560, v0
    ds_write_b128 v9, v[12:15]
    s_waitcnt lgkmcnt(0)
    s_mov_b64 exec, 0xff
    v_lshrrev_b32 v14, 2, v0
    v_lshlrev_b32 v12, 5, v14
    v_and_b32 v12, 128, v12
    v_lshrrev_b32 v13, 1, v14
    v_and_or_b32 v12, v13, 12, v12
    s_mov_b32 s16, 0
L_pure:
    global_load_dword v13, v12, s[12:13] sc1
    s_add_u32 s16, s16, 1
    s_cmp_gt_u32 s16, 100000
    s_cbranch_scc1 Lr_abort
    s_mov_b32 s6, 0
    s_waitcnt vmcnt(0)
    v_readlane_b32 s7, v13, 0
    s_nop 0
    s_add_u32 s6, s6, s7
    v_readlane_b32 s7, v13, 1
    s_nop 0
    s_add_u32 s6, s6, s7
    v_readlane_b32 s7, v13, 2
    s_nop 0
    s_add_u32 s6, s6, s7
    v_readlane_b32 s7, v13, 3
    s_nop 0
    s_add_u32 s6, s6, s7
    v_readlane_b32 s7, v13, 4
    s_nop 0
    s_add_u32 s6, s6, s7
    v_readlane_b32 s7, v13, 5
    s_nop 0
    s_add_u32 s6, s6, s7
    v_readlane_b32 s7, v13, 6
    s_nop 0
    s_add_u32 s6, s6, s7
    v_readlane_b32 s7, v13, 7
    s_nop 0
    s_add_u32 s6, s6, s7
    v_readlane_b32 s7, v13, s32
    s_nop 0
    s_cmp_ge_u32 s7, 32
    s_cselect_b32 s51, 1, 0
    s_cselect_b32 s6, 256, s6
    s_cmp_lt_u32 s6, 256
    s_cbranch_scc1 L_pure
    s_mov_b64 exec, -1
    s_lshl_b32 s6, s32, 2
    s_add_u32 s6, s6, 192
    s_cmp_lg_u32 s14, 0
    s_cbranch_scc1 L_team_d
    v_mov_b32 v12, s6
    s_mov_b32 s16, 0
L_team:
    global_load_dword v13, v12, s[12:13] sc1
    s_add_u32 s16, s16, 1
    s_cmp_gt_u32 s16, 100000
    s_cbranch_scc1 Lr_abort
    s_waitcnt vmcnt(0)
    v_cmp_gt_u32 vcc, 32, v13
    s_nop 0
    s_cbranch_vccz L_team_d
    s_sleep 8
    s_branch L_team
L_team_d:
    s_barrier
    s_cmp_lg_u32 s14, 0
    s_cbranch_scc1 L_rpoola_d
    v_mov_b32 v12, 40
    s_mov_b32 s16, 0
L_rpoola:
    global_load_dword v13, v12, s[12:13] sc1
    s_add_u32 s16, s16, 1
    s_cmp_gt_u32 s16, 100000
    s_cbranch_scc1 Lr_abort
    s_waitcnt vmcnt(0)
    v_cmp_gt_u32 vcc, 128, v13
    s_nop 0
    s_cbranch_vccz L_rpoola_d
    s_sleep 8
    s_branch L_rpoola
L_rpoola_d:
    s_barrier
    s_cmp_eq_u32 s32, 0
    s_cbranch_scc1 L_rpool_skip
    s_cmp_lg_u32 s14, 0
    s_cbranch_scc1 L_rpool_d
    v_mov_b32 v12, 160
    s_mov_b32 s16, 0
L_rpool:
    global_load_dword v13, v12, s[12:13] sc1
    s_add_u32 s16, s16, 1
    s_cmp_gt_u32 s16, 100000
    s_cbranch_scc1 Lr_abort
    s_waitcnt vmcnt(0)
    v_cmp_gt_u32 vcc, 64, v13
    s_nop 0
    s_cbranch_vccz L_rpool_d
    s_sleep 8
    s_branch L_rpool
L_rpool_d:
    s_barrier
L_rpool_skip:
    s_barrier
    s_cmp_eq_u32 s51, 0
    s_cbranch_scc1 L_slow
    s_cmp_lg_u32 s14, 0
    s_cbranch_scc1 L_w1_1
    s_mov_b32 s16, 0
    s_add_u32 s17, s66, 128
    v_lshrrev_b32 v10, 2, v0
    v_and_b32 v9, 16, v10
    v_lshlrev_b32 v9, 3, v9
    v_and_or_b32 v10, v10, 12, v9
Lr0f_fw_10:
    buffer_load_dword v9, v10, s[8:11], s17 offen sc1
    s_add_u32 s16, s16, 1
    s_cmp_gt_u32 s16, 100000
    s_cbranch_scc1 Lr_abort
    s_waitcnt vmcnt(0)
    v_cmp_eq_u32 vcc, 0, v9
    s_nop 0
    s_cbranch_vccnz Lr0f_fw_10
    s_mov_b32 m0, 15104
    s_nop 0
    buffer_load_dwordx4 v0, s[8:11], s41 offen offset:0 lds
    buffer_load_dwordx4 v0, s[8:11], s41 offen offset:1024 lds
    s_add_u32 s41, s41, 262144
    s_add_u32 s68, s68, 4278452224
    s_waitcnt vmcnt(0)
    ds_read_b128 v[56:59], v8 offset:0
    ds_read_b128 v[60:63], v8 offset:1024
    ds_read_b128 v[64:67], v8 offset:2048
    ds_read_b128 v[68:71], v8 offset:3072
    v_mov_b64 v[12:13], 0
    v_mov_b64 v[14:15], 0
    v_mov_b64 v[16:17], 0
    v_mov_b64 v[18:19], 0
    v_mov_b64 v[20:21], 0
    v_mov_b64 v[22:23], 0
    v_mov_b64 v[24:25], 0
    v_mov_b64 v[26:27], 0
    v_mov_b64 v[28:29], 0
    v_mov_b64 v[30:31], 0
    v_mov_b64 v[32:33], 0
    v_mov_b64 v[34:35], 0
    buffer_load_dwordx4 v[36:39], v0, s[8:11], s34 offen sc1
    s_waitcnt vmcnt(0) lgkmcnt(0)
Lr0f_step:
    s_mov_b32 s16, 0
Lr0f_alp:
    s_waitcnt vmcnt(2)
    v_max3_u32 v10, v36, v37, v38
    v_max_u32 v10, v10, v39
    v_cmp_eq_u32 vcc, -1, v10
    s_nop 0
    s_cbranch_vccz Lr0f_aok
    buffer_load_dwordx4 v[36:39], v0, s[8:11], s34 offen sc1
    s_add_u32 s16, s16, 1
    s_cmp_gt_u32 s16, 100000
    s_cbranch_scc1 Lr_abort
    s_branch Lr0f_alp
Lr0f_aok:
    ds_write_b128 v0, v[36:39] offset:6912
    v_smfmac_f32_16x16x64_bf16 v[12:15], v[36:39], v[72:79], v1
    v_smfmac_f32_16x16x64_bf16 v[16:19], v[36:39], v[80:87], v1
    v_smfmac_f32_16x16x64_bf16 v[20:23], v[36:39], v[184:191], v1
    s_waitcnt lgkmcnt(0)
    s_barrier
    ds_read_b128 v[48:51], v0 offset:7936
    ds_read_b128 v[52:55], v0 offset:8960
    v_smfmac_f32_16x16x64_bf16 v[28:31], v[36:39], v[56:63], v1
    ds_read_b128 v[56:59], v8 offset:4096
    ds_read_b128 v[60:63], v8 offset:5120
    s_add_u32 s17, s34, 4096
    buffer_load_dwordx4 v[40:43], v0, s[8:11], s17 offen sc1
    v_smfmac_f32_16x16x64_bf16 v[24:27], v[36:39], v[192:199], v1
    v_smfmac_f32_16x16x64_bf16 v[32:35], v[36:39], v[64:71], v1
    ds_read_b128 v[64:67], v8 offset:6144
    ds_read_b128 v[68:71], v8 offset:7168
    s_waitcnt vmcnt(1)
    ds_read_b128 v[36:39], v0 offset:9984
    s_waitcnt lgkmcnt(6)
    v_smfmac_f32_16x16x64_bf16 v[28:31], v[48:51], a[72:79], v1
    v_smfmac_f32_16x16x64_bf16 v[12:15], v[48:51], v[88:95], v1
    buffer_load_dwordx4 v[44:47], v0, s[8:11], s35 offen sc1
    v_smfmac_f32_16x16x64_bf16 v[16:19], v[48:51], v[96:103], v1
    v_smfmac_f32_16x16x64_bf16 v[32:35], v[48:51], a[80:87], v1
    v_smfmac_f32_16x16x64_bf16 v[20:23], v[48:51], v[200:207], v1
    v_smfmac_f32_16x16x64_bf16 v[24:27], v[48:51], v[208:215], v1
    s_waitcnt lgkmcnt(3)
    v_smfmac_f32_16x16x64_bf16 v[28:31], v[52:55], v[56:63], v1
    ds_read_b128 v[56:59], v8 offset:8192
    ds_read_b128 v[60:63], v8 offset:9216
    v_smfmac_f32_16x16x64_bf16 v[12:15], v[52:55], v[104:111], v1
    v_smfmac_f32_16x16x64_bf16 v[16:19], v[52:55], v[112:119], v1
    s_waitcnt lgkmcnt(3)
    v_smfmac_f32_16x16x64_bf16 v[32:35], v[52:55], v[64:71], v1
    ds_read_b128 v[64:67], v8 offset:10240
    ds_read_b128 v[68:71], v8 offset:11264
    v_smfmac_f32_16x16x64_bf16 v[20:23], v[52:55], v[216:223], v1
    v_smfmac_f32_16x16x64_bf16 v[24:27], v[52:55], v[224:231], v1
    s_waitcnt lgkmcnt(4)
    v_smfmac_f32_16x16x64_bf16 v[28:31], v[36:39], a[88:95], v1
    v_smfmac_f32_16x16x64_bf16 v[12:15], v[36:39], v[120:127], v1
    v_smfmac_f32_16x16x64_bf16 v[16:19], v[36:39], v[128:135], v1
    v_smfmac_f32_16x16x64_bf16 v[32:35], v[36:39], a[96:103], v1
    v_smfmac_f32_16x16x64_bf16 v[20:23], v[36:39], v[232:239], v1
    v_smfmac_f32_16x16x64_bf16 v[24:27], v[36:39], v[240:247], v1
    s_waitcnt vmcnt(1)
    v_max3_u32 v10, v40, v41, v42
    v_max_u32 v10, v10, v43
    v_cmp_eq_u32 vcc, -1, v10
    s_nop 0
    s_cbranch_vccnz Lr0f_pb_re
Lr0f_pb_ok:
    ds_write_b128 v0, v[40:43] offset:11008
    s_waitcnt lgkmcnt(3)
    v_smfmac_f32_16x16x64_bf16 v[12:15], v[40:43], v[56:63], v1
    ds_read_b128 v[56:59], v8 offset:12288
    ds_read_b128 v[60:63], v8 offset:13312
    v_smfmac_f32_16x16x64_bf16 v[20:23], v[40:43], v[248:255], v1
    s_waitcnt lgkmcnt(3)
    v_smfmac_f32_16x16x64_bf16 v[16:19], v[40:43], v[64:71], v1
    ds_read_b128 v[64:67], v8 offset:14336
    ds_read_b128 v[68:71], v8 offset:15360
    v_smfmac_f32_16x16x64_bf16 v[24:27], v[40:43], a[0:7], v1
    s_waitcnt lgkmcnt(4)
    s_barrier
    ds_read_b128 v[48:51], v0 offset:13056
    ds_read_b128 v[52:55], v0 offset:12032
    ds_read_b128 v[36:39], v0 offset:14080
    v_smfmac_f32_16x16x64_bf16 v[28:31], v[40:43], a[104:111], v1
    v_smfmac_f32_16x16x64_bf16 v[32:35], v[40:43], a[112:119], v1
    s_waitcnt lgkmcnt(2)
    v_smfmac_f32_16x16x64_bf16 v[12:15], v[48:51], v[56:63], v1
    v_smfmac_f32_16x16x64_bf16 v[16:19], v[48:51], v[64:71], v1
    s_waitcnt lgkmcnt(1)
    v_smfmac_f32_16x16x64_bf16 v[12:15], v[52:55], v[136:143], v1
    v_smfmac_f32_16x16x64_bf16 v[16:19], v[52:55], v[144:151], v1
    s_waitcnt lgkmcnt(0)
    v_smfmac_f32_16x16x64_bf16 v[12:15], v[36:39], v[152:159], v1
    v_smfmac_f32_16x16x64_bf16 v[16:19], v[36:39], v[160:167], v1
    s_waitcnt vmcnt(0)
    v_max3_u32 v10, v44, v45, v46
    v_max_u32 v10, v10, v47
    v_cmp_eq_u32 vcc, -1, v10
    s_nop 0
    s_cbranch_vccnz Lr0f_pc_re
Lr0f_pc_ok:
    v_smfmac_f32_16x16x64_bf16 v[12:15], v[44:47], v[168:175], v1
    v_smfmac_f32_16x16x64_bf16 v[16:19], v[44:47], v[176:183], v1
    v_smfmac_f32_16x16x64_bf16 v[20:23], v[48:51], a[24:31], v1
    buffer_load_dwordx4 v[64:67], v0, s[8:11], s42 offen
    v_smfmac_f32_16x16x64_bf16 v[24:27], v[48:51], a[32:39], v1
    v_smfmac_f32_16x16x64_bf16 v[20:23], v[52:55], a[8:15], v1
    v_add_f32 v12, v12, v14
    v_smfmac_f32_16x16x64_bf16 v[24:27], v[52:55], a[16:23], v1
    v_add_f32 v16, v16, v18
    v_smfmac_f32_16x16x64_bf16 v[20:23], v[36:39], a[40:47], v1
    v_add_f32 v13, v13, v15
    buffer_load_dwordx4 v[68:71], v0, s[8:11], s42 offen offset:1024
    v_smfmac_f32_16x16x64_bf16 v[24:27], v[36:39], a[48:55], v1
    v_add_f32 v17, v17, v19
    v_smfmac_f32_16x16x64_bf16 v[20:23], v[44:47], a[56:63], v1
    v_cvt_pk_bf16_f32 v14, v12, v16
    ds_read_b128 v[56:59], v0 offset:15104
    v_smfmac_f32_16x16x64_bf16 v[24:27], v[44:47], a[64:71], v1
    v_cvt_pk_bf16_f32 v15, v13, v17
    ds_read_b128 v[60:63], v0 offset:16128
    ds_write_b32 v2, v14 offset:576
    ds_write_b32 v2, v15 offset:864
    v_smfmac_f32_16x16x64_bf16 v[28:31], v[48:51], a[136:143], v1
    v_smfmac_f32_16x16x64_bf16 v[32:35], v[48:51], a[144:151], v1
    v_add_f32 v20, v20, v22
    v_add_f32 v24, v24, v26
    v_add_f32 v21, v21, v23
    v_add_f32 v25, v25, v27
    v_cvt_pk_bf16_f32 v22, v20, v24
    v_cvt_pk_bf16_f32 v23, v21, v25
    ds_write_b32 v2, v22 offset:0
    ds_write_b32 v2, v23 offset:288
    v_smfmac_f32_16x16x64_bf16 v[28:31], v[52:55], a[120:127], v1
    v_smfmac_f32_16x16x64_bf16 v[32:35], v[52:55], a[128:135], v1
    s_waitcnt lgkmcnt(0)
    s_barrier
    ds_read_b128 v[40:43], v3 offset:0
    ds_read_b128 v[48:51], v3 offset:64
    ds_read_b128 v[20:23], v3 offset:128
    ds_read_b128 v[52:55], v3 offset:192
    v_smfmac_f32_16x16x64_bf16 v[28:31], v[36:39], a[152:159], v1
    v_smfmac_f32_16x16x64_bf16 v[32:35], v[36:39], a[160:167], v1
    ds_read_b128 v[36:39], v0 offset:17152
    v_lshlrev_b32 v9, 3, v0
    buffer_load_dword v11, v9, s[8:11], s68 offen
    v_smfmac_f32_16x16x64_bf16 v[28:31], v[44:47], a[168:175], v1
    v_smfmac_f32_16x16x64_bf16 v[32:35], v[44:47], a[176:183], v1
    ds_read_b128 v[44:47], v0 offset:18176
    s_waitcnt lgkmcnt(5)
    v_mfma_f32_16x16x32_bf16 v[12:15], v[56:59], v[40:43], 0
    v_mfma_f32_16x16x32_bf16 v[16:19], v[60:63], v[40:43], 0
    v_mfma_f32_16x16x32_bf16 v[24:27], v[40:43], v[40:43], 0
    ds_read_b128 v[56:59], v0 offset:19200
    ds_read_b128 v[60:63], v0 offset:20224
    s_waitcnt lgkmcnt(3)
    v_mfma_f32_16x16x32_bf16 v[12:15], v[36:39], v[48:51], v[12:15]
    v_lshrrev_b32 v10, 1, v0
    v_lshrrev_b32 v9, 9, v0
    s_waitcnt lgkmcnt(2)
    v_mfma_f32_16x16x32_bf16 v[16:19], v[44:47], v[48:51], v[16:19]
    v_lshl_add_u32 v9, v9, 5, v10
    v_add_f32 v28, v28, v30
    v_mfma_f32_16x16x32_bf16 v[24:27], v[48:51], v[48:51], v[24:27]
    v_add_f32 v32, v32, v34
    v_add_f32 v29, v29, v31
    ds_read_b128 v[36:39], v0 offset:21248
    ds_read_b128 v[44:47], v0 offset:22272
    s_waitcnt lgkmcnt(3)
    v_mfma_f32_16x16x32_bf16 v[12:15], v[56:59], v[20:23], v[12:15]
    v_add_f32 v33, v33, v35
    v_cvt_pk_bf16_f32 v30, v28, v29
    s_waitcnt lgkmcnt(2)
    v_mfma_f32_16x16x32_bf16 v[16:19], v[60:63], v[20:23], v[16:19]
    v_cvt_pk_bf16_f32 v31, v32, v33
    ds_read_b64 v[34:35], v9 offset:0
    v_mfma_f32_16x16x32_bf16 v[24:27], v[20:23], v[20:23], v[24:27]
    s_add_u32 s17, s43, 2048
    buffer_store_dwordx2 v[30:31], v10, s[8:11], s17 offen sc1
    s_waitcnt lgkmcnt(2)
    v_mfma_f32_16x16x32_bf16 v[12:15], v[36:39], v[52:55], v[12:15]
    s_waitcnt lgkmcnt(1)
    v_mfma_f32_16x16x32_bf16 v[16:19], v[44:47], v[52:55], v[16:19]
    v_mfma_f32_16x16x32_bf16 v[24:27], v[52:55], v[52:55], v[24:27]
    s_add_u32 s17, s43, 0
    s_waitcnt lgkmcnt(0)
    buffer_store_dwordx2 v[34:35], v10, s[8:11], s17 offen sc1
    s_cmp_eq_u32 s33, 63
    s_cbranch_scc1 Lr0f_last
    ds_read_b128 v[56:59], v8 offset:16384
    ds_read_b128 v[60:63], v8 offset:17408
    v_mov_b64 v[20:21], s[52:53]
    v_mov_b64 v[22:23], s[52:53]
    v_mov_b32 v41, 0
    v_mov_b32 v42, 0
    v_max3_f32 v9, v12, v13, v14
    v_max3_f32 v9, v9, v15, v16
    v_max3_f32 v9, v9, v17, v18
    v_max3_f32 v9, v9, v19, v24
    v_max_f32 v9, v9, v25
    v_mov_b32 v10, v9
    v_mov_b64 v[32:33], 0
    v_mov_b64 v[34:35], 0
    v_permlane32_swap_b32 v9, v10
    v_max_f32 v9, v9, v10
    v_mov_b32 v10, v9
    s_nop 1
    v_permlane16_swap_b32 v9, v10
    v_max_f32 v9, v9, v10
    v_mul_f32 v28, s44, v9
    v_fma_f32 v12, v12, s44, -v28
    v_fma_f32 v13, v13, s44, -v28
    v_fma_f32 v14, v14, s44, -v28
    v_fma_f32 v15, v15, s44, -v28
    v_exp_f32 v12, v12
    v_exp_f32 v13, v13
    v_fma_f32 v16, v16, s44, -v28
    v_fma_f32 v17, v17, s44, -v28
    v_exp_f32 v14, v14
    v_exp_f32 v15, v15
    v_cvt_pk_bf16_f32 v36, v12, v13
    v_fma_f32 v18, v18, s44, -v28
    v_fma_f32 v19, v19, s44, -v28
    v_exp_f32 v16, v16
    v_exp_f32 v17, v17
    v_cvt_pk_bf16_f32 v37, v14, v15
    v_fma_f32 v24, v24, s44, -v28
    v_fma_f32 v25, v25, s44, -v28
    v_exp_f32 v18, v18
    v_exp_f32 v19, v19
    v_cvt_pk_bf16_f32 v38, v16, v17
    v_exp_f32 v24, v24
    v_exp_f32 v25, v25
    v_cvt_pk_bf16_f32 v39, v18, v19
    v_cvt_pk_bf16_f32 v40, v24, v25
    v_cvt_pk_bf16_f32 v43, v24, v25
    v_mfma_f32_16x16x32_bf16 v[52:55], v[20:23], v[36:39], 0
    v_mov_b64 v[12:13], 0
    v_mov_b64 v[14:15], 0
    s_waitcnt vmcnt(4)
    v_mfma_f32_16x16x32_bf16 v[44:47], v[64:67], v[36:39], 0
    v_mov_b64 v[24:25], 0
    v_mov_b64 v[26:27], 0
    s_waitcnt vmcnt(3)
    v_mfma_f32_16x16x32_bf16 v[48:51], v[68:71], v[36:39], 0
    ds_read_b128 v[64:67], v8 offset:20480
    ds_read_b128 v[68:71], v8 offset:21504
    v_mfma_f32_16x16x16_bf16 v[52:55], v[20:21], v[40:41], v[52:55]
    v_mfma_f32_16x16x16_bf16 v[44:47], v[30:31], v[40:41], v[44:47]
    v_mov_b64 v[20:21], 0
    v_mov_b64 v[22:23], 0
    v_mfma_f32_16x16x16_bf16 v[48:51], v[30:31], v[42:43], v[48:51]
    v_mov_b64 v[36:37], 0
    v_mov_b64 v[38:39], 0
    v_mov_b64 v[40:41], 0
    v_mov_b64 v[42:43], 0
    v_rcp_f32 v9, v52
    v_mov_b64 v[52:53], 0
    v_mov_b64 v[54:55], 0
    v_mul_f32 v44, v9, v44
    v_mul_f32 v48, v9, v48
    v_cvt_pk_bf16_f32 v16, v44, v48
    v_mul_f32 v45, v9, v45
    v_mul_f32 v49, v9, v49
    v_cvt_pk_bf16_f32 v17, v45, v49
    v_mul_f32 v46, v9, v46
    v_mul_f32 v50, v9, v50
    v_cvt_pk_bf16_f32 v18, v46, v50
    v_mul_f32 v47, v9, v47
    v_mul_f32 v51, v9, v51
    v_cvt_pk_bf16_f32 v19, v47, v51
    ds_write_b128 v5, v[16:19]
    v_mov_b64 v[28:29], 0
    v_mov_b64 v[30:31], 0
    s_waitcnt lgkmcnt(0)
    s_barrier
    ds_read_b128 v[44:47], v4 offset:0
    ds_read_b128 v[48:51], v4 offset:128
    v_mov_b64 v[16:17], 0
    v_mov_b64 v[18:19], 0
    buffer_load_dwordx4 v0, s[8:11], s41 offen offset:0 lds
    buffer_load_dwordx4 v0, s[8:11], s41 offen offset:1024 lds
    s_waitcnt lgkmcnt(1)
    v_smfmac_f32_16x16x64_bf16 v[12:15], v[44:47], a[184:191], v1
    s_waitcnt lgkmcnt(0)
    v_smfmac_f32_16x16x64_bf16 v[12:15], v[48:51], a[192:199], v1
    v_smfmac_f32_16x16x64_bf16 v[24:27], v[44:47], a[200:207], v1
    v_smfmac_f32_16x16x64_bf16 v[24:27], v[48:51], a[208:215], v1
    v_add_f32 v12, v12, v14
    v_smfmac_f32_16x16x64_bf16 v[20:23], v[44:47], a[216:223], v1
    v_add_f32 v13, v13, v15
    v_smfmac_f32_16x16x64_bf16 v[20:23], v[48:51], a[224:231], v1
    v_cvt_pk_bf16_f32 v12, v12, v13
    v_smfmac_f32_16x16x64_bf16 v[16:19], v[44:47], a[232:239], v1
    v_add_f32 v24, v24, v26
    v_smfmac_f32_16x16x64_bf16 v[16:19], v[48:51], a[240:247], v1
    v_add_f32 v25, v25, v27
    v_smfmac_f32_16x16x64_bf16 v[36:39], v[44:47], v[56:63], v1
    v_cvt_pk_bf16_f32 v13, v24, v25
    v_smfmac_f32_16x16x64_bf16 v[36:39], v[48:51], v[64:71], v1
    v_add_f32 v20, v20, v22
    v_add_f32 v21, v21, v23
    v_cvt_pk_bf16_f32 v14, v20, v21
    v_add_f32 v16, v16, v18
    v_add_f32 v17, v17, v19
    v_cvt_pk_bf16_f32 v15, v16, v17
    v_and_or_b32 v15, v15, -2, s40
    buffer_store_dwordx4 v[12:15], v0, s[8:11], s38 offen
    s_nop 0
    ds_read_b128 v[12:15], v8 offset:18432
    ds_read_b128 v[16:19], v8 offset:19456
    ds_read_b128 v[20:23], v8 offset:22528
    ds_read_b128 v[24:27], v8 offset:23552
    ds_read_b128 v[56:59], v8 offset:24576
    ds_read_b128 v[60:63], v8 offset:25600
    ds_read_b128 v[64:67], v8 offset:28672
    ds_read_b128 v[68:71], v8 offset:29696
    s_waitcnt lgkmcnt(6)
    v_smfmac_f32_16x16x64_bf16 v[40:43], v[44:47], v[12:19], v1
    ds_read_b128 v[12:15], v8 offset:26624
    ds_read_b128 v[16:19], v8 offset:27648
    s_waitcnt lgkmcnt(6)
    v_smfmac_f32_16x16x64_bf16 v[40:43], v[48:51], v[20:27], v1
    ds_read_b128 v[20:23], v8 offset:30720
    ds_read_b128 v[24:27], v8 offset:31744
    s_waitcnt lgkmcnt(6)
    v_smfmac_f32_16x16x64_bf16 v[52:55], v[44:47], v[56:63], v1
    ds_read_b128 v[56:59], v8 offset:32768
    ds_read_b128 v[60:63], v8 offset:33792
    s_waitcnt lgkmcnt(6)
    v_smfmac_f32_16x16x64_bf16 v[52:55], v[48:51], v[64:71], v1
    s_waitcnt lgkmcnt(4)
    v_smfmac_f32_16x16x64_bf16 v[32:35], v[44:47], v[12:19], v1
    s_waitcnt lgkmcnt(2)
    v_smfmac_f32_16x16x64_bf16 v[32:35], v[48:51], v[20:27], v1
    v_smfmac_f32_16x16x64_bf16 v[28:31], v[44:47], a[248:255], v1
    s_waitcnt lgkmcnt(0)
    v_smfmac_f32_16x16x64_bf16 v[28:31], v[48:51], v[56:63], v1
    buffer_load_dwordx4 v[12:15], v6, s[8:11], s62 offen sc1
    buffer_load_dwordx4 v[16:19], v6, s[8:11], s63 offen sc1
    buffer_load_dwordx4 v[20:23], v6, s[8:11], s64 offen sc1
    buffer_load_dwordx4 v[24:27], v6, s[8:11], s65 offen sc1
    v_add_f32 v36, v36, v38
    v_add_f32 v37, v37, v39
    v_cvt_pk_bf16_f32 v36, v36, v37
    v_add_f32 v40, v40, v42
    v_add_f32 v41, v41, v43
    v_cvt_pk_bf16_f32 v37, v40, v41
    v_add_f32 v52, v52, v54
    v_add_f32 v53, v53, v55
    v_cvt_pk_bf16_f32 v38, v52, v53
    v_add_f32 v32, v32, v34
    v_add_f32 v33, v33, v35
    v_cvt_pk_bf16_f32 v39, v32, v33
    v_and_or_b32 v39, v39, -2, s40
    s_add_u32 s17, s38, 4096
    buffer_store_dwordx4 v[36:39], v0, s[8:11], s17 offen
    v_add_f32 v28, v28, v30
    v_add_f32 v29, v29, v31
    v_cvt_pk_bf16_f32 v28, v28, v29
    v_and_or_b32 v28, v28, -2, s40
    v_lshrrev_b32 v9, 2, v0
    buffer_store_dword v28, v9, s[8:11], s39 offen
    v_add_u32 v10, 162560, v0
    ds_read_b128 v[64:67], v10
    s_nop 9
    buffer_load_dwordx4 v[40:43], v6, s[8:11], s62 offen sc1
    buffer_load_dwordx4 v[44:47], v6, s[8:11], s63 offen sc1
    buffer_load_dwordx4 v[48:51], v6, s[8:11], s64 offen sc1
    buffer_load_dwordx4 v[52:55], v6, s[8:11], s65 offen sc1
    s_add_u32 s33, s33, 1
    s_add_u32 s42, s42, 262144
    s_add_u32 s41, s41, 262144
    s_add_u32 s43, s43, 131072
    s_add_u32 s68, s68, 262144
    s_add_u32 s66, s66, 22528
    ds_read_b128 v[56:59], v8 offset:0
    ds_read_b128 v[60:63], v8 offset:1024
    s_waitcnt lgkmcnt(2)
    s_waitcnt vmcnt(9)
    v_mfma_f32_16x16x32_bf16 v[68:71], v[12:15], v[64:67], 0
    v_and_b32 v10, 1, v15
    v_cmp_ne_u32 s[54:55], s40, v10
    s_waitcnt vmcnt(8)
    v_mfma_f32_16x16x32_bf16 v[68:71], v[16:19], v[64:67], v[68:71]
    v_and_b32 v10, 1, v19
    v_cmp_ne_u32 s[56:57], s40, v10
    s_waitcnt vmcnt(7)
    v_mfma_f32_16x16x32_bf16 v[68:71], v[20:23], v[64:67], v[68:71]
    v_and_b32 v10, 1, v23
    v_cmp_ne_u32 s[58:59], s40, v10
    s_waitcnt vmcnt(6)
    v_mfma_f32_16x16x32_bf16 v[68:71], v[24:27], v[64:67], v[68:71]
    v_and_b32 v10, 1, v27
    v_cmp_ne_u32 s[60:61], s40, v10
    s_or_b64 vcc, s[54:55], s[56:57]
    s_or_b64 vcc, vcc, s[58:59]
    s_or_b64 vcc, vcc, s[60:61]
    s_cbranch_scc0 Lr0f_red
    s_mov_b32 s16, 0
Lr0f_p1:
    buffer_load_dwordx4 v[12:15], v6, s[8:11], s62 offen sc1
    buffer_load_dwordx4 v[16:19], v6, s[8:11], s63 offen sc1
    buffer_load_dwordx4 v[20:23], v6, s[8:11], s64 offen sc1
    buffer_load_dwordx4 v[24:27], v6, s[8:11], s65 offen sc1
    s_waitcnt vmcnt(7)
    v_mfma_f32_16x16x32_bf16 v[68:71], v[40:43], v[64:67], 0
    v_and_b32 v10, 1, v43
    v_cmp_ne_u32 s[54:55], s40, v10
    s_waitcnt vmcnt(6)
    v_mfma_f32_16x16x32_bf16 v[68:71], v[44:47], v[64:67], v[68:71]
    v_and_b32 v10, 1, v47
    v_cmp_ne_u32 s[56:57], s40, v10
    s_waitcnt vmcnt(5)
    v_mfma_f32_16x16x32_bf16 v[68:71], v[48:51], v[64:67], v[68:71]
    v_and_b32 v10, 1, v51
    v_cmp_ne_u32 s[58:59], s40, v10
    s_waitcnt vmcnt(4)
    v_mfma_f32_16x16x32_bf16 v[68:71], v[52:55], v[64:67], v[68:71]
    v_and_b32 v10, 1, v55
    v_cmp_ne_u32 s[60:61], s40, v10
    s_or_b64 vcc, s[54:55], s[56:57]
    s_or_b64 vcc, vcc, s[58:59]
    s_or_b64 vcc, vcc, s[60:61]
    s_cbranch_scc0 Lr0f_red
    buffer_load_dwordx4 v[40:43], v6, s[8:11], s62 offen sc1
    buffer_load_dwordx4 v[44:47], v6, s[8:11], s63 offen sc1
    buffer_load_dwordx4 v[48:51], v6, s[8:11], s64 offen sc1
    buffer_load_dwordx4 v[52:55], v6, s[8:11], s65 offen sc1
    s_add_u32 s16, s16, 1
    s_cmp_gt_u32 s16, 100000
    s_cbranch_scc1 Lr_abort
    s_waitcnt vmcnt(7)
    v_mfma_f32_16x16x32_bf16 v[68:71], v[12:15], v[64:67], 0
    v_and_b32 v10, 1, v15
    v_cmp_ne_u32 s[54:55], s40, v10
    s_waitcnt vmcnt(6)
    v_mfma_f32_16x16x32_bf16 v[68:71], v[16:19], v[64:67], v[68:71]
    v_and_b32 v10, 1, v19
    v_cmp_ne_u32 s[56:57], s40, v10
    s_waitcnt vmcnt(5)
    v_mfma_f32_16x16x32_bf16 v[68:71], v[20:23], v[64:67], v[68:71]
    v_and_b32 v10, 1, v23
    v_cmp_ne_u32 s[58:59], s40, v10
    s_waitcnt vmcnt(4)
    v_mfma_f32_16x16x32_bf16 v[68:71], v[24:27], v[64:67], v[68:71]
    v_and_b32 v10, 1, v27
    v_cmp_ne_u32 s[60:61], s40, v10
    s_or_b64 vcc, s[54:55], s[56:57]
    s_or_b64 vcc, vcc, s[58:59]
    s_or_b64 vcc, vcc, s[60:61]
    s_cbranch_scc1 Lr0f_p1
Lr0f_red:
    s_nop 1
    v_permlane16_swap_b32 v68, v70
    v_permlane16_swap_b32 v69, v71
    s_mov_b64 exec, s[46:47]
    v_add_f32 v68, v68, v70
    v_add_f32 v69, v69, v71
    v_cvt_pk_bf16_f32 v68, v68, v69
    v_min_u32 v68, s50, v68
    buffer_store_dword v68, v7, s[8:11], s36 offen
    v_mov_b32 v69, -1
    buffer_store_dword v69, v7, s[8:11], s37 offen
    s_mov_b64 exec, -1
    s_xor_b32 s34, s34, 16384
    s_xor_b32 s35, s35, 16384
    s_xor_b32 s40, s40, 1
    s_xor_b32 s36, s36, 16384
    s_xor_b32 s37, s37, 16384
    s_nop 15
    s_nop 3
    buffer_load_dwordx4 v[36:39], v0, s[8:11], s34 offen sc1
    s_waitcnt vmcnt(3)
    ds_read_b128 v[64:67], v8 offset:2048
    ds_read_b128 v[68:71], v8 offset:3072
    v_mov_b64 v[12:13], 0
    v_mov_b64 v[14:15], 0
    v_mov_b64 v[16:17], 0
    v_mov_b64 v[18:19], 0
    v_mov_b64 v[20:21], 0
    v_mov_b64 v[22:23], 0
    v_mov_b64 v[24:25], 0
    v_mov_b64 v[26:27], 0
    v_mov_b64 v[28:29], 0
    v_mov_b64 v[30:31], 0
    v_mov_b64 v[32:33], 0
    v_mov_b64 v[34:35], 0
    s_nop 9
    buffer_load_dwordx4 v[36:39], v0, s[8:11], s34 offen sc1
    s_nop 15
    s_nop 8
    buffer_load_dwordx4 v[36:39], v0, s[8:11], s34 offen sc1
    s_waitcnt lgkmcnt(0)
    s_branch Lr0f_step
Lr0f_pb_re:
    s_mov_b32 s16, 0
Lr0f_pb_lp:
    s_add_u32 s17, s34, 4096
    buffer_load_dwordx4 v[40:43], v0, s[8:11], s17 offen sc1
    s_add_u32 s16, s16, 1
    s_cmp_gt_u32 s16, 100000
    s_cbranch_scc1 Lr_abort
    s_waitcnt vmcnt(0)
    v_max3_u32 v10, v40, v41, v42
    v_max_u32 v10, v10, v43
    v_cmp_eq_u32 vcc, -1, v10
    s_nop 0
    s_cbranch_vccnz Lr0f_pb_lp
    s_branch Lr0f_pb_ok
Lr0f_pc_re:
    s_mov_b32 s16, 0
Lr0f_pc_lp:
    buffer_load_dwordx4 v[44:47], v0, s[8:11], s35 offen sc1
    s_add_u32 s16, s16, 1
    s_cmp_gt_u32 s16, 100000
    s_cbranch_scc1 Lr_abort
    s_waitcnt vmcnt(0)
    v_max3_u32 v10, v44, v45, v46
    v_max_u32 v10, v10, v47
    v_cmp_eq_u32 vcc, -1, v10
    s_nop 0
    s_cbranch_vccnz Lr0f_pc_lp
    s_branch Lr0f_pc_ok
Lr0f_last:
    s_waitcnt vmcnt(0) lgkmcnt(0)
    s_barrier
    s_branch Lr_exit
L_w1_1:
    s_cmp_lg_u32 s14, 1
    s_cbranch_scc1 L_w2_1
    s_mov_b32 s16, 0
    s_add_u32 s17, s66, 128
    v_lshrrev_b32 v10, 2, v0
    v_and_b32 v9, 16, v10
    v_lshlrev_b32 v9, 3, v9
    v_and_or_b32 v10, v10, 12, v9
Lr1f_fw_11:
    buffer_load_dword v9, v10, s[8:11], s17 offen sc1
    s_add_u32 s16, s16, 1
    s_cmp_gt_u32 s16, 100000
    s_cbranch_scc1 Lr_abort
    s_waitcnt vmcnt(0)
    v_cmp_eq_u32 vcc, 0, v9
    s_nop 0
    s_cbranch_vccnz Lr1f_fw_11
    s_lshl_b32 s67, s32, 5
    s_add_u32 s67, s67, s15
    s_lshl_b32 s67, s67, 12
    s_add_u32 s67, s67, 3145728
    s_mov_b32 m0, 17152
    s_nop 0
    buffer_load_dwordx4 v0, s[8:11], s41 offen offset:0 lds
    buffer_load_dwordx4 v0, s[8:11], s41 offen offset:1024 lds
    s_add_u32 s41, s41, 262144
    s_add_u32 s68, s68, 262144
    s_waitcnt vmcnt(0)
    ds_read_b128 v[56:59], v8 offset:4096
    ds_read_b128 v[60:63], v8 offset:5120
    ds_read_b128 v[64:67], v8 offset:6144
    ds_read_b128 v[68:71], v8 offset:7168
    v_mov_b64 v[12:13], 0
    v_mov_b64 v[14:15], 0
    v_mov_b64 v[16:17], 0
    v_mov_b64 v[18:19], 0
    v_mov_b64 v[20:21], 0
    v_mov_b64 v[22:23], 0
    v_mov_b64 v[24:25], 0
    v_mov_b64 v[26:27], 0
    v_mov_b64 v[28:29], 0
    v_mov_b64 v[30:31], 0
    v_mov_b64 v[32:33], 0
    v_mov_b64 v[34:35], 0
    buffer_load_dwordx4 v[36:39], v0, s[8:11], s34 offen sc1
    s_waitcnt vmcnt(0) lgkmcnt(0)
Lr1f_step:
    s_waitcnt vmcnt(3)
    v_max3_u32 v10, v36, v37, v38
    v_max_u32 v10, v10, v39
    v_cmp_eq_u32 vcc, -1, v10
    s_nop 0
    s_cbranch_vccz Lr1f_aok
    buffer_load_dwordx4 v[36:39], v0, s[8:11], s34 offen sc1
    s_nop 15
    s_nop 8
    buffer_load_dwordx4 v[36:39], v0, s[8:11], s34 offen sc1
    s_mov_b32 s16, 0
Lr1f_alp:
    s_waitcnt vmcnt(2)
    v_max3_u32 v10, v36, v37, v38
    v_max_u32 v10, v10, v39
    v_cmp_eq_u32 vcc, -1, v10
    s_nop 0
    s_cbranch_vccz Lr1f_aok
    buffer_load_dwordx4 v[36:39], v0, s[8:11], s34 offen sc1
    s_add_u32 s16, s16, 1
    s_cmp_gt_u32 s16, 100000
    s_cbranch_scc1 Lr_abort
    s_branch Lr1f_alp
Lr1f_aok:
    ds_write_b128 v0, v[36:39] offset:7936
    v_smfmac_f32_16x16x64_bf16 v[12:15], v[36:39], v[88:95], v1
    v_smfmac_f32_16x16x64_bf16 v[16:19], v[36:39], v[96:103], v1
    v_smfmac_f32_16x16x64_bf16 v[20:23], v[36:39], v[200:207], v1
    s_waitcnt lgkmcnt(0)
    s_barrier
    ds_read_b128 v[48:51], v0 offset:8960
    ds_read_b128 v[52:55], v0 offset:9984
    v_smfmac_f32_16x16x64_bf16 v[28:31], v[36:39], a[72:79], v1
    v_smfmac_f32_16x16x64_bf16 v[24:27], v[36:39], v[208:215], v1
    s_add_u32 s17, s34, 4096
    buffer_load_dwordx4 v[40:43], v0, s[8:11], s17 offen sc1
    v_smfmac_f32_16x16x64_bf16 v[32:35], v[36:39], a[80:87], v1
    s_waitcnt vmcnt(1)
    ds_read_b128 v[36:39], v0 offset:6912
    s_waitcnt lgkmcnt(2)
    v_smfmac_f32_16x16x64_bf16 v[28:31], v[48:51], v[56:63], v1
    ds_read_b128 v[56:59], v8 offset:0
    ds_read_b128 v[60:63], v8 offset:1024
    v_smfmac_f32_16x16x64_bf16 v[12:15], v[48:51], v[104:111], v1
    v_smfmac_f32_16x16x64_bf16 v[16:19], v[48:51], v[112:119], v1
    buffer_load_dwordx4 v[44:47], v0, s[8:11], s35 offen sc1
    v_smfmac_f32_16x16x64_bf16 v[32:35], v[48:51], v[64:71], v1
    ds_read_b128 v[64:67], v8 offset:2048
    ds_read_b128 v[68:71], v8 offset:3072
    v_smfmac_f32_16x16x64_bf16 v[20:23], v[48:51], v[216:223], v1
    v_smfmac_f32_16x16x64_bf16 v[24:27], v[48:51], v[224:231], v1
    s_waitcnt lgkmcnt(5)
    v_smfmac_f32_16x16x64_bf16 v[28:31], v[52:55], a[88:95], v1
    v_smfmac_f32_16x16x64_bf16 v[12:15], v[52:55], v[120:127], v1
    v_smfmac_f32_16x16x64_bf16 v[16:19], v[52:55], v[128:135], v1
    v_smfmac_f32_16x16x64_bf16 v[32:35], v[52:55], a[96:103], v1
    v_smfmac_f32_16x16x64_bf16 v[20:23], v[52:55], v[232:239], v1
    v_smfmac_f32_16x16x64_bf16 v[24:27], v[52:55], v[240:247], v1
    s_waitcnt lgkmcnt(2)
    v_smfmac_f32_16x16x64_bf16 v[28:31], v[36:39], v[56:63], v1
    ds_read_b128 v[56:59], v8 offset:12288
    ds_read_b128 v[60:63], v8 offset:13312
    v_smfmac_f32_16x16x64_bf16 v[12:15], v[36:39], v[72:79], v1
    v_smfmac_f32_16x16x64_bf16 v[16:19], v[36:39], v[80:87], v1
    s_waitcnt lgkmcnt(2)
    v_smfmac_f32_16x16x64_bf16 v[32:35], v[36:39], v[64:71], v1
    ds_read_b128 v[64:67], v8 offset:14336
    ds_read_b128 v[68:71], v8 offset:15360
    v_smfmac_f32_16x16x64_bf16 v[20:23], v[36:39], v[184:191], v1
    v_smfmac_f32_16x16x64_bf16 v[24:27], v[36:39], v[192:199], v1
    s_waitcnt vmcnt(1)
    v_max3_u32 v10, v40, v41, v42
    v_max_u32 v10, v10, v43
    v_cmp_eq_u32 vcc, -1, v10
    s_nop 0
    s_cbranch_vccnz Lr1f_pb_re
Lr1f_pb_ok:
    ds_write_b128 v0, v[40:43] offset:12032
    v_mov_b32 v9, 1
    v_mov_b32 v10, 0
    s_mov_b64 exec, 1
    buffer_store_dword v9, v10, s[8:11], s67 offen offset:384 sc1
    s_mov_b64 exec, -1
    v_smfmac_f32_16x16x64_bf16 v[12:15], v[40:43], v[136:143], v1
    v_smfmac_f32_16x16x64_bf16 v[20:23], v[40:43], a[8:15], v1
    v_smfmac_f32_16x16x64_bf16 v[16:19], v[40:43], v[144:151], v1
    v_smfmac_f32_16x16x64_bf16 v[24:27], v[40:43], a[16:23], v1
    s_waitcnt lgkmcnt(0)
    s_barrier
    ds_read_b128 v[48:51], v0 offset:13056
    ds_read_b128 v[52:55], v0 offset:14080
    ds_read_b128 v[36:39], v0 offset:11008
    v_smfmac_f32_16x16x64_bf16 v[28:31], v[40:43], a[120:127], v1
    v_smfmac_f32_16x16x64_bf16 v[32:35], v[40:43], a[128:135], v1
    s_waitcnt lgkmcnt(2)
    v_smfmac_f32_16x16x64_bf16 v[12:15], v[48:51], v[56:63], v1
    ds_read_b128 v[56:59], v8 offset:8192
    ds_read_b128 v[60:63], v8 offset:9216
    v_smfmac_f32_16x16x64_bf16 v[16:19], v[48:51], v[64:71], v1
    ds_read_b128 v[64:67], v8 offset:10240
    ds_read_b128 v[68:71], v8 offset:11264
    s_waitcnt lgkmcnt(5)
    v_smfmac_f32_16x16x64_bf16 v[12:15], v[52:55], v[152:159], v1
    v_smfmac_f32_16x16x64_bf16 v[16:19], v[52:55], v[160:167], v1
    s_waitcnt vmcnt(1)
    v_max3_u32 v10, v44, v45, v46
    v_max_u32 v10, v10, v47
    v_cmp_eq_u32 vcc, -1, v10
    s_nop 0
    s_cbranch_vccnz Lr1f_pc_re
Lr1f_pc_ok:
    v_smfmac_f32_16x16x64_bf16 v[12:15], v[44:47], v[168:175], v1
    v_smfmac_f32_16x16x64_bf16 v[16:19], v[44:47], v[176:183], v1
    s_waitcnt lgkmcnt(2)
    v_smfmac_f32_16x16x64_bf16 v[12:15], v[36:39], v[56:63], v1
    s_waitcnt lgkmcnt(0)
    v_smfmac_f32_16x16x64_bf16 v[16:19], v[36:39], v[64:71], v1
    v_smfmac_f32_16x16x64_bf16 v[20:23], v[48:51], a[24:31], v1
    v_smfmac_f32_16x16x64_bf16 v[24:27], v[48:51], a[32:39], v1
    buffer_load_dwordx4 v[64:67], v0, s[8:11], s42 offen
    v_smfmac_f32_16x16x64_bf16 v[20:23], v[52:55], a[40:47], v1
    v_add_f32 v12, v12, v14
    v_smfmac_f32_16x16x64_bf16 v[24:27], v[52:55], a[48:55], v1
    v_add_f32 v16, v16, v18
    v_smfmac_f32_16x16x64_bf16 v[20:23], v[36:39], v[248:255], v1
    v_add_f32 v13, v13, v15
    v_smfmac_f32_16x16x64_bf16 v[24:27], v[36:39], a[0:7], v1
    v_add_f32 v17, v17, v19
    buffer_load_dwordx4 v[68:71], v0, s[8:11], s42 offen offset:1024
    v_smfmac_f32_16x16x64_bf16 v[20:23], v[44:47], a[56:63], v1
    v_cvt_pk_bf16_f32 v14, v12, v16
    ds_read_b128 v[56:59], v0 offset:15104
    v_smfmac_f32_16x16x64_bf16 v[24:27], v[44:47], a[64:71], v1
    v_cvt_pk_bf16_f32 v15, v13, v17
    ds_read_b128 v[60:63], v0 offset:16128
    ds_write_b32 v2, v14 offset:576
    ds_write_b32 v2, v15 offset:864
    v_smfmac_f32_16x16x64_bf16 v[28:31], v[48:51], a[136:143], v1
    v_smfmac_f32_16x16x64_bf16 v[32:35], v[48:51], a[144:151], v1
    v_add_f32 v20, v20, v22
    v_add_f32 v24, v24, v26
    v_add_f32 v21, v21, v23
    v_add_f32 v25, v25, v27
    v_cvt_pk_bf16_f32 v22, v20, v24
    v_cvt_pk_bf16_f32 v23, v21, v25
    ds_write_b32 v2, v22 offset:0
    ds_write_b32 v2, v23 offset:288
    v_smfmac_f32_16x16x64_bf16 v[28:31], v[52:55], a[152:159], v1
    v_smfmac_f32_16x16x64_bf16 v[32:35], v[52:55], a[160:167], v1
    s_waitcnt lgkmcnt(0)
    s_barrier
    ds_read_b128 v[40:43], v3 offset:0
    ds_read_b128 v[48:51], v3 offset:64
    ds_read_b128 v[20:23], v3 offset:128
    ds_read_b128 v[52:55], v3 offset:192
    v_smfmac_f32_16x16x64_bf16 v[28:31], v[36:39], a[104:111], v1
    v_smfmac_f32_16x16x64_bf16 v[32:35], v[36:39], a[112:119], v1
    ds_read_b128 v[36:39], v0 offset:17152
    v_smfmac_f32_16x16x64_bf16 v[28:31], v[44:47], a[168:175], v1
    v_smfmac_f32_16x16x64_bf16 v[32:35], v[44:47], a[176:183], v1
    ds_read_b128 v[44:47], v0 offset:18176
    s_waitcnt lgkmcnt(5)
    v_mfma_f32_16x16x32_bf16 v[12:15], v[56:59], v[40:43], 0
    v_mfma_f32_16x16x32_bf16 v[16:19], v[60:63], v[40:43], 0
    v_mfma_f32_16x16x32_bf16 v[24:27], v[40:43], v[40:43], 0
    ds_read_b128 v[56:59], v0 offset:19200
    ds_read_b128 v[60:63], v0 offset:20224
    s_waitcnt lgkmcnt(3)
    v_mfma_f32_16x16x32_bf16 v[12:15], v[36:39], v[48:51], v[12:15]
    v_lshrrev_b32 v10, 1, v0
    v_lshrrev_b32 v9, 9, v0
    s_waitcnt lgkmcnt(2)
    v_mfma_f32_16x16x32_bf16 v[16:19], v[44:47], v[48:51], v[16:19]
    v_lshl_add_u32 v9, v9, 5, v10
    v_add_f32 v28, v28, v30
    v_mfma_f32_16x16x32_bf16 v[24:27], v[48:51], v[48:51], v[24:27]
    v_add_f32 v32, v32, v34
    v_add_f32 v29, v29, v31
    ds_read_b128 v[36:39], v0 offset:21248
    ds_read_b128 v[44:47], v0 offset:22272
    s_waitcnt lgkmcnt(3)
    v_mfma_f32_16x16x32_bf16 v[12:15], v[56:59], v[20:23], v[12:15]
    v_add_f32 v33, v33, v35
    v_cvt_pk_bf16_f32 v30, v28, v29
    s_waitcnt lgkmcnt(2)
    v_mfma_f32_16x16x32_bf16 v[16:19], v[60:63], v[20:23], v[16:19]
    v_cvt_pk_bf16_f32 v31, v32, v33
    ds_read_b64 v[34:35], v9 offset:1152
    v_mfma_f32_16x16x32_bf16 v[24:27], v[20:23], v[20:23], v[24:27]
    s_add_u32 s17, s43, 2560
    buffer_store_dwordx2 v[30:31], v10, s[8:11], s17 offen sc1
    s_waitcnt lgkmcnt(2)
    v_mfma_f32_16x16x32_bf16 v[12:15], v[36:39], v[52:55], v[12:15]
    s_waitcnt lgkmcnt(1)
    v_mfma_f32_16x16x32_bf16 v[16:19], v[44:47], v[52:55], v[16:19]
    v_mfma_f32_16x16x32_bf16 v[24:27], v[52:55], v[52:55], v[24:27]
    s_add_u32 s17, s43, 512
    s_waitcnt lgkmcnt(0)
    buffer_store_dwordx2 v[34:35], v10, s[8:11], s17 offen sc1
    s_cmp_eq_u32 s33, 63
    s_cbranch_scc1 Lr1f_last
    ds_read_b128 v[56:59], v8 offset:16384
    ds_read_b128 v[60:63], v8 offset:17408
    v_mov_b64 v[20:21], s[52:53]
    v_mov_b64 v[22:23], s[52:53]
    v_mov_b32 v41, 0
    v_mov_b32 v42, 0
    v_max3_f32 v9, v12, v13, v14
    v_max3_f32 v9, v9, v15, v16
    v_max3_f32 v9, v9, v17, v18
    v_max3_f32 v9, v9, v19, v24
    v_max_f32 v9, v9, v25
    v_mov_b32 v10, v9
    v_mov_b64 v[32:33], 0
    v_mov_b64 v[34:35], 0
    v_permlane32_swap_b32 v9, v10
    v_max_f32 v9, v9, v10
    v_mov_b32 v10, v9
    s_nop 1
    v_permlane16_swap_b32 v9, v10
    v_max_f32 v9, v9, v10
    v_mul_f32 v28, s44, v9
    v_fma_f32 v12, v12, s44, -v28
    v_fma_f32 v13, v13, s44, -v28
    v_fma_f32 v14, v14, s44, -v28
    v_fma_f32 v15, v15, s44, -v28
    v_exp_f32 v12, v12
    v_exp_f32 v13, v13
    v_fma_f32 v16, v16, s44, -v28
    v_fma_f32 v17, v17, s44, -v28
    v_exp_f32 v14, v14
    v_exp_f32 v15, v15
    v_cvt_pk_bf16_f32 v36, v12, v13
    v_fma_f32 v18, v18, s44, -v28
    v_fma_f32 v19, v19, s44, -v28
    v_exp_f32 v16, v16
    v_exp_f32 v17, v17
    v_cvt_pk_bf16_f32 v37, v14, v15
    v_fma_f32 v24, v24, s44, -v28
    v_fma_f32 v25, v25, s44, -v28
    v_exp_f32 v18, v18
    v_exp_f32 v19, v19
    v_cvt_pk_bf16_f32 v38, v16, v17
    v_exp_f32 v24, v24
    v_exp_f32 v25, v25
    v_cvt_pk_bf16_f32 v39, v18, v19
    v_cvt_pk_bf16_f32 v40, v24, v25
    v_cvt_pk_bf16_f32 v43, v24, v25
    v_mfma_f32_16x16x32_bf16 v[52:55], v[20:23], v[36:39], 0
    v_mov_b64 v[12:13], 0
    v_mov_b64 v[14:15], 0
    s_waitcnt vmcnt(3)
    v_mfma_f32_16x16x32_bf16 v[44:47], v[64:67], v[36:39], 0
    v_mov_b64 v[24:25], 0
    v_mov_b64 v[26:27], 0
    s_waitcnt vmcnt(2)
    v_mfma_f32_16x16x32_bf16 v[48:51], v[68:71], v[36:39], 0
    ds_read_b128 v[64:67], v8 offset:20480
    ds_read_b128 v[68:71], v8 offset:21504
    v_mfma_f32_16x16x16_bf16 v[52:55], v[20:21], v[40:41], v[52:55]
    v_mfma_f32_16x16x16_bf16 v[44:47], v[30:31], v[40:41], v[44:47]
    v_mov_b64 v[20:21], 0
    v_mov_b64 v[22:23], 0
    v_mfma_f32_16x16x16_bf16 v[48:51], v[30:31], v[42:43], v[48:51]
    v_mov_b64 v[36:37], 0
    v_mov_b64 v[38:39], 0
    v_mov_b64 v[40:41], 0
    v_mov_b64 v[42:43], 0
    v_rcp_f32 v9, v52
    v_mov_b64 v[52:53], 0
    v_mov_b64 v[54:55], 0
    v_mul_f32 v44, v9, v44
    v_mul_f32 v48, v9, v48
    v_cvt_pk_bf16_f32 v16, v44, v48
    v_mul_f32 v45, v9, v45
    v_mul_f32 v49, v9, v49
    v_cvt_pk_bf16_f32 v17, v45, v49
    v_mul_f32 v46, v9, v46
    v_mul_f32 v50, v9, v50
    v_cvt_pk_bf16_f32 v18, v46, v50
    v_mul_f32 v47, v9, v47
    v_mul_f32 v51, v9, v51
    v_cvt_pk_bf16_f32 v19, v47, v51
    ds_write_b128 v5, v[16:19]
    v_mov_b64 v[28:29], 0
    v_mov_b64 v[30:31], 0
    s_waitcnt lgkmcnt(0)
    s_barrier
    ds_read_b128 v[44:47], v4 offset:0
    ds_read_b128 v[48:51], v4 offset:128
    v_mov_b64 v[16:17], 0
    v_mov_b64 v[18:19], 0
    buffer_load_dwordx4 v0, s[8:11], s41 offen offset:0 lds
    buffer_load_dwordx4 v0, s[8:11], s41 offen offset:1024 lds
    s_waitcnt lgkmcnt(1)
    v_smfmac_f32_16x16x64_bf16 v[12:15], v[44:47], a[184:191], v1
    s_waitcnt lgkmcnt(0)
    v_smfmac_f32_16x16x64_bf16 v[12:15], v[48:51], a[192:199], v1
    v_smfmac_f32_16x16x64_bf16 v[24:27], v[44:47], a[200:207], v1
    v_smfmac_f32_16x16x64_bf16 v[24:27], v[48:51], a[208:215], v1
    v_add_f32 v12, v12, v14
    v_smfmac_f32_16x16x64_bf16 v[20:23], v[44:47], a[216:223], v1
    v_add_f32 v13, v13, v15
    v_smfmac_f32_16x16x64_bf16 v[20:23], v[48:51], a[224:231], v1
    v_cvt_pk_bf16_f32 v12, v12, v13
    v_smfmac_f32_16x16x64_bf16 v[16:19], v[44:47], a[232:239], v1
    v_add_f32 v24, v24, v26
    v_smfmac_f32_16x16x64_bf16 v[16:19], v[48:51], a[240:247], v1
    v_add_f32 v25, v25, v27
    v_smfmac_f32_16x16x64_bf16 v[36:39], v[44:47], v[56:63], v1
    v_cvt_pk_bf16_f32 v13, v24, v25
    v_smfmac_f32_16x16x64_bf16 v[36:39], v[48:51], v[64:71], v1
    v_add_f32 v20, v20, v22
    v_add_f32 v21, v21, v23
    v_cvt_pk_bf16_f32 v14, v20, v21
    v_add_f32 v16, v16, v18
    v_add_f32 v17, v17, v19
    v_cvt_pk_bf16_f32 v15, v16, v17
    v_and_or_b32 v15, v15, -2, s40
    buffer_store_dwordx4 v[12:15], v0, s[8:11], s38 offen
    s_nop 0
    ds_read_b128 v[12:15], v8 offset:18432
    ds_read_b128 v[16:19], v8 offset:19456
    ds_read_b128 v[20:23], v8 offset:22528
    ds_read_b128 v[24:27], v8 offset:23552
    ds_read_b128 v[56:59], v8 offset:24576
    ds_read_b128 v[60:63], v8 offset:25600
    ds_read_b128 v[64:67], v8 offset:28672
    ds_read_b128 v[68:71], v8 offset:29696
    s_waitcnt lgkmcnt(6)
    v_smfmac_f32_16x16x64_bf16 v[40:43], v[44:47], v[12:19], v1
    ds_read_b128 v[12:15], v8 offset:26624
    ds_read_b128 v[16:19], v8 offset:27648
    s_waitcnt lgkmcnt(6)
    v_smfmac_f32_16x16x64_bf16 v[40:43], v[48:51], v[20:27], v1
    ds_read_b128 v[20:23], v8 offset:30720
    ds_read_b128 v[24:27], v8 offset:31744
    s_waitcnt lgkmcnt(6)
    v_smfmac_f32_16x16x64_bf16 v[52:55], v[44:47], v[56:63], v1
    ds_read_b128 v[56:59], v8 offset:32768
    ds_read_b128 v[60:63], v8 offset:33792
    s_waitcnt lgkmcnt(6)
    v_smfmac_f32_16x16x64_bf16 v[52:55], v[48:51], v[64:71], v1
    s_waitcnt lgkmcnt(4)
    v_smfmac_f32_16x16x64_bf16 v[32:35], v[44:47], v[12:19], v1
    s_waitcnt lgkmcnt(2)
    v_smfmac_f32_16x16x64_bf16 v[32:35], v[48:51], v[20:27], v1
    v_smfmac_f32_16x16x64_bf16 v[28:31], v[44:47], a[248:255], v1
    s_waitcnt lgkmcnt(0)
    v_smfmac_f32_16x16x64_bf16 v[28:31], v[48:51], v[56:63], v1
    v_add_f32 v36, v36, v38
    v_add_f32 v37, v37, v39
    v_cvt_pk_bf16_f32 v36, v36, v37
    v_add_f32 v40, v40, v42
    v_add_f32 v41, v41, v43
    v_cvt_pk_bf16_f32 v37, v40, v41
    v_add_f32 v52, v52, v54
    v_add_f32 v53, v53, v55
    v_cvt_pk_bf16_f32 v38, v52, v53
    v_add_f32 v32, v32, v34
    v_add_f32 v33, v33, v35
    v_cvt_pk_bf16_f32 v39, v32, v33
    v_and_or_b32 v39, v39, -2, s40
    s_add_u32 s17, s38, 4096
    buffer_store_dwordx4 v[36:39], v0, s[8:11], s17 offen
    v_add_f32 v28, v28, v30
    v_add_f32 v29, v29, v31
    v_cvt_pk_bf16_f32 v28, v28, v29
    v_and_or_b32 v28, v28, -2, s40
    v_lshrrev_b32 v9, 2, v0
    buffer_store_dword v28, v9, s[8:11], s39 offen
    v_add_u32 v10, 162560, v0
    ds_read_b128 v[64:67], v10
    s_add_u32 s33, s33, 1
    s_add_u32 s42, s42, 262144
    s_add_u32 s41, s41, 262144
    s_add_u32 s43, s43, 131072
    s_mov_b32 s67, s66
    s_add_u32 s68, s68, 262144
    s_add_u32 s66, s66, 22528
    ds_read_b128 v[56:59], v8 offset:4096
    ds_read_b128 v[60:63], v8 offset:5120
    v_mov_b64 v[12:13], 0
    v_mov_b64 v[14:15], 0
    v_mov_b64 v[16:17], 0
    v_mov_b64 v[18:19], 0
    v_mov_b64 v[20:21], 0
    v_mov_b64 v[22:23], 0
    v_mov_b64 v[24:25], 0
    v_mov_b64 v[26:27], 0
    v_mov_b64 v[28:29], 0
    v_mov_b64 v[30:31], 0
    v_mov_b64 v[32:33], 0
    v_mov_b64 v[34:35], 0
    s_nop 15
    s_nop 15
    s_nop 15
    s_nop 11
    buffer_load_dwordx4 v[40:43], v6, s[8:11], s62 offen sc1
    buffer_load_dwordx4 v[44:47], v6, s[8:11], s63 offen sc1
    buffer_load_dwordx4 v[48:51], v6, s[8:11], s64 offen sc1
    buffer_load_dwordx4 v[52:55], v6, s[8:11], s65 offen sc1
    s_waitcnt lgkmcnt(0)
    s_waitcnt vmcnt(3)
    v_mfma_f32_16x16x32_bf16 v[68:71], v[40:43], v[64:67], 0
    v_and_b32 v10, 1, v43
    v_cmp_ne_u32 s[54:55], s40, v10
    s_waitcnt vmcnt(2)
    v_mfma_f32_16x16x32_bf16 v[68:71], v[44:47], v[64:67], v[68:71]
    v_and_b32 v10, 1, v47
    v_cmp_ne_u32 s[56:57], s40, v10
    s_waitcnt vmcnt(1)
    v_mfma_f32_16x16x32_bf16 v[68:71], v[48:51], v[64:67], v[68:71]
    v_and_b32 v10, 1, v51
    v_cmp_ne_u32 s[58:59], s40, v10
    s_waitcnt vmcnt(0)
    v_mfma_f32_16x16x32_bf16 v[68:71], v[52:55], v[64:67], v[68:71]
    v_and_b32 v10, 1, v55
    v_cmp_ne_u32 s[60:61], s40, v10
    s_or_b64 vcc, s[54:55], s[56:57]
    s_or_b64 vcc, vcc, s[58:59]
    s_or_b64 vcc, vcc, s[60:61]
    s_cbranch_scc0 Lr1f_red
    s_mov_b32 s16, 0
Lr1f_p1:
    s_mov_b64 exec, s[54:55]
    buffer_load_dwordx4 v[40:43], v6, s[8:11], s62 offen sc1
    s_mov_b64 exec, s[56:57]
    buffer_load_dwordx4 v[44:47], v6, s[8:11], s63 offen sc1
    s_mov_b64 exec, s[58:59]
    buffer_load_dwordx4 v[48:51], v6, s[8:11], s64 offen sc1
    s_mov_b64 exec, s[60:61]
    buffer_load_dwordx4 v[52:55], v6, s[8:11], s65 offen sc1
    s_mov_b64 exec, -1
    s_add_u32 s16, s16, 1
    s_cmp_gt_u32 s16, 100000
    s_cbranch_scc1 Lr_abort
    s_waitcnt vmcnt(3)
    v_mfma_f32_16x16x32_bf16 v[68:71], v[40:43], v[64:67], 0
    v_and_b32 v10, 1, v43
    v_cmp_ne_u32 s[54:55], s40, v10
    s_waitcnt vmcnt(2)
    v_mfma_f32_16x16x32_bf16 v[68:71], v[44:47], v[64:67], v[68:71]
    v_and_b32 v10, 1, v47
    v_cmp_ne_u32 s[56:57], s40, v10
    s_waitcnt vmcnt(1)
    v_mfma_f32_16x16x32_bf16 v[68:71], v[48:51], v[64:67], v[68:71]
    v_and_b32 v10, 1, v51
    v_cmp_ne_u32 s[58:59], s40, v10
    s_waitcnt vmcnt(0)
    v_mfma_f32_16x16x32_bf16 v[68:71], v[52:55], v[64:67], v[68:71]
    v_and_b32 v10, 1, v55
    v_cmp_ne_u32 s[60:61], s40, v10
    s_or_b64 vcc, s[54:55], s[56:57]
    s_or_b64 vcc, vcc, s[58:59]
    s_or_b64 vcc, vcc, s[60:61]
    s_cbranch_scc1 Lr1f_p1
Lr1f_red:
    s_xor_b32 s34, s34, 16384
    s_xor_b32 s35, s35, 16384
    buffer_load_dwordx4 v[36:39], v0, s[8:11], s34 offen sc1
    v_permlane16_swap_b32 v68, v70
    v_permlane16_swap_b32 v69, v71
    s_mov_b64 exec, s[46:47]
    v_add_f32 v68, v68, v70
    v_add_f32 v69, v69, v71
    v_cvt_pk_bf16_f32 v68, v68, v69
    v_min_u32 v68, s50, v68
    buffer_store_dword v68, v7, s[8:11], s36 offen
    v_mov_b32 v69, -1
    buffer_store_dword v69, v7, s[8:11], s37 offen
    s_mov_b64 exec, -1
    buffer_load_dwordx4 v[36:39], v0, s[8:11], s34 offen sc1
    s_xor_b32 s40, s40, 1
    s_xor_b32 s36, s36, 16384
    s_xor_b32 s37, s37, 16384
    ds_read_b128 v[64:67], v8 offset:6144
    ds_read_b128 v[68:71], v8 offset:7168
    s_waitcnt lgkmcnt(0)
    s_branch Lr1f_step
Lr1f_pb_re:
    s_mov_b32 s16, 0
Lr1f_pb_lp:
    s_add_u32 s17, s34, 4096
    buffer_load_dwordx4 v[40:43], v0, s[8:11], s17 offen sc1
    s_add_u32 s16, s16, 1
    s_cmp_gt_u32 s16, 100000
    s_cbranch_scc1 Lr_abort
    s_waitcnt vmcnt(0)
    v_max3_u32 v10, v40, v41, v42
    v_max_u32 v10, v10, v43
    v_cmp_eq_u32 vcc, -1, v10
    s_nop 0
    s_cbranch_vccnz Lr1f_pb_lp
    s_branch Lr1f_pb_ok
Lr1f_pc_re:
    s_mov_b32 s16, 0
Lr1f_pc_lp:
    buffer_load_dwordx4 v[44:47], v0, s[8:11], s35 offen sc1
    s_add_u32 s16, s16, 1
    s_cmp_gt_u32 s16, 100000
    s_cbranch_scc1 Lr_abort
    s_waitcnt vmcnt(0)
    v_max3_u32 v10, v44, v45, v46
    v_max_u32 v10, v10, v47
    v_cmp_eq_u32 vcc, -1, v10
    s_nop 0
    s_cbranch_vccnz Lr1f_pc_lp
    s_branch Lr1f_pc_ok
Lr1f_last:
    s_waitcnt vmcnt(0) lgkmcnt(0)
    s_barrier
    s_mov_b32 s67, s66
    v_mov_b32 v9, 1
    v_mov_b32 v10, 0
    s_mov_b64 exec, 1
    buffer_store_dword v9, v10, s[8:11], s67 offen offset:384 sc1
    s_mov_b64 exec, -1
    s_branch Lr_exit
L_w2_1:
    s_cmp_lg_u32 s14, 2
    s_cbranch_scc1 L_w3_1
    s_mov_b32 s16, 0
    s_add_u32 s17, s66, 128
    v_lshrrev_b32 v10, 2, v0
    v_and_b32 v9, 16, v10
    v_lshlrev_b32 v9, 3, v9
    v_and_or_b32 v10, v10, 12, v9
Lr2f_fw_12:
    buffer_load_dword v9, v10, s[8:11], s17 offen sc1
    s_add_u32 s16, s16, 1
    s_cmp_gt_u32 s16, 100000
    s_cbranch_scc1 Lr_abort
    s_waitcnt vmcnt(0)
    v_cmp_eq_u32 vcc, 0, v9
    s_nop 0
    s_cbranch_vccnz Lr2f_fw_12
    s_mov_b32 m0, 19200
    s_nop 0
    buffer_load_dwordx4 v0, s[8:11], s41 offen offset:0 lds
    buffer_load_dwordx4 v0, s[8:11], s41 offen offset:1024 lds
    s_add_u32 s41, s41, 262144
    s_add_u32 s68, s68, 262144
    s_waitcnt vmcnt(0)
    ds_read_b128 v[56:59], v8 offset:4096
    ds_read_b128 v[60:63], v8 offset:5120
    ds_read_b128 v[64:67], v8 offset:6144
    ds_read_b128 v[68:71], v8 offset:7168
    v_mov_b64 v[12:13], 0
    v_mov_b64 v[14:15], 0
    v_mov_b64 v[16:17], 0
    v_mov_b64 v[18:19], 0
    v_mov_b64 v[20:21], 0
    v_mov_b64 v[22:23], 0
    v_mov_b64 v[24:25], 0
    v_mov_b64 v[26:27], 0
    v_mov_b64 v[28:29], 0
    v_mov_b64 v[30:31], 0
    v_mov_b64 v[32:33], 0
    v_mov_b64 v[34:35], 0
    buffer_load_dwordx4 v[36:39], v0, s[8:11], s34 offen sc1
    s_waitcnt vmcnt(0) lgkmcnt(0)
Lr2f_step:
    s_waitcnt vmcnt(3)
    v_max3_u32 v10, v36, v37, v38
    v_max_u32 v10, v10, v39
    v_cmp_eq_u32 vcc, -1, v10
    s_nop 0
    s_cbranch_vccz Lr2f_aok
    buffer_load_dwordx4 v[36:39], v0, s[8:11], s34 offen sc1
    s_nop 15
    s_nop 8
    buffer_load_dwordx4 v[36:39], v0, s[8:11], s34 offen sc1
    s_mov_b32 s16, 0
Lr2f_alp:
    s_waitcnt vmcnt(2)
    v_max3_u32 v10, v36, v37, v38
    v_max_u32 v10, v10, v39
    v_cmp_eq_u32 vcc, -1, v10
    s_nop 0
    s_cbranch_vccz Lr2f_aok
    buffer_load_dwordx4 v[36:39], v0, s[8:11], s34 offen sc1
    s_add_u32 s16, s16, 1
    s_cmp_gt_u32 s16, 100000
    s_cbranch_scc1 Lr_abort
    s_branch Lr2f_alp
Lr2f_aok:
    ds_write_b128 v0, v[36:39] offset:8960
    v_smfmac_f32_16x16x64_bf16 v[12:15], v[36:39], v[104:111], v1
    v_smfmac_f32_16x16x64_bf16 v[16:19], v[36:39], v[112:119], v1
    v_smfmac_f32_16x16x64_bf16 v[20:23], v[36:39], v[216:223], v1
    s_waitcnt lgkmcnt(0)
    s_barrier
    ds_read_b128 v[48:51], v0 offset:9984
    ds_read_b128 v[52:55], v0 offset:6912
    v_smfmac_f32_16x16x64_bf16 v[28:31], v[36:39], v[56:63], v1
    ds_read_b128 v[56:59], v8 offset:0
    ds_read_b128 v[60:63], v8 offset:1024
    v_smfmac_f32_16x16x64_bf16 v[24:27], v[36:39], v[224:231], v1
    v_smfmac_f32_16x16x64_bf16 v[32:35], v[36:39], v[64:71], v1
    ds_read_b128 v[64:67], v8 offset:2048
    ds_read_b128 v[68:71], v8 offset:3072
    s_add_u32 s17, s34, 4096
    buffer_load_dwordx4 v[40:43], v0, s[8:11], s17 offen sc1
    s_waitcnt vmcnt(1)
    ds_read_b128 v[36:39], v0 offset:7936
    s_waitcnt lgkmcnt(6)
    v_smfmac_f32_16x16x64_bf16 v[28:31], v[48:51], a[88:95], v1
    v_smfmac_f32_16x16x64_bf16 v[12:15], v[48:51], v[120:127], v1
    v_smfmac_f32_16x16x64_bf16 v[16:19], v[48:51], v[128:135], v1
    v_smfmac_f32_16x16x64_bf16 v[32:35], v[48:51], a[96:103], v1
    buffer_load_dwordx4 v[44:47], v0, s[8:11], s35 offen sc1
    v_smfmac_f32_16x16x64_bf16 v[20:23], v[48:51], v[232:239], v1
    v_lshrrev_b32 v10, 2, v0
    v_and_b32 v9, 16, v10
    v_lshlrev_b32 v9, 3, v9
    v_and_or_b32 v10, v10, 12, v9
    s_add_u32 s17, s66, 22656
    v_mov_b32 v11, 2
    buffer_load_dword v11, v10, s[8:11], s17 offen sc1
    v_smfmac_f32_16x16x64_bf16 v[24:27], v[48:51], v[240:247], v1
    s_waitcnt lgkmcnt(3)
    v_smfmac_f32_16x16x64_bf16 v[28:31], v[52:55], v[56:63], v1
    ds_read_b128 v[56:59], v8 offset:12288
    ds_read_b128 v[60:63], v8 offset:13312
    v_smfmac_f32_16x16x64_bf16 v[12:15], v[52:55], v[72:79], v1
    v_smfmac_f32_16x16x64_bf16 v[16:19], v[52:55], v[80:87], v1
    s_waitcnt lgkmcnt(3)
    v_smfmac_f32_16x16x64_bf16 v[32:35], v[52:55], v[64:71], v1
    ds_read_b128 v[64:67], v8 offset:14336
    ds_read_b128 v[68:71], v8 offset:15360
    v_smfmac_f32_16x16x64_bf16 v[20:23], v[52:55], v[184:191], v1
    v_smfmac_f32_16x16x64_bf16 v[24:27], v[52:55], v[192:199], v1
    s_waitcnt lgkmcnt(4)
    v_smfmac_f32_16x16x64_bf16 v[28:31], v[36:39], a[72:79], v1
    v_smfmac_f32_16x16x64_bf16 v[12:15], v[36:39], v[88:95], v1
    v_smfmac_f32_16x16x64_bf16 v[16:19], v[36:39], v[96:103], v1
    v_smfmac_f32_16x16x64_bf16 v[32:35], v[36:39], a[80:87], v1
    v_smfmac_f32_16x16x64_bf16 v[20:23], v[36:39], v[200:207], v1
    v_smfmac_f32_16x16x64_bf16 v[24:27], v[36:39], v[208:215], v1
    s_waitcnt vmcnt(2)
    v_max3_u32 v10, v40, v41, v42
    v_max_u32 v10, v10, v43
    v_cmp_eq_u32 vcc, -1, v10
    s_nop 0
    s_cbranch_vccnz Lr2f_pb_re
Lr2f_pb_ok:
    ds_write_b128 v0, v[40:43] offset:13056
    s_waitcnt lgkmcnt(3)
    v_smfmac_f32_16x16x64_bf16 v[12:15], v[40:43], v[56:63], v1
    ds_read_b128 v[56:59], v8 offset:8192
    ds_read_b128 v[60:63], v8 offset:9216
    v_smfmac_f32_16x16x64_bf16 v[20:23], v[40:43], a[24:31], v1
    s_waitcnt lgkmcnt(3)
    v_smfmac_f32_16x16x64_bf16 v[16:19], v[40:43], v[64:71], v1
    ds_read_b128 v[64:67], v8 offset:10240
    ds_read_b128 v[68:71], v8 offset:11264
    v_smfmac_f32_16x16x64_bf16 v[24:27], v[40:43], a[32:39], v1
    s_waitcnt lgkmcnt(4)
    s_barrier
    ds_read_b128 v[48:51], v0 offset:11008
    ds_read_b128 v[52:55], v0 offset:14080
    ds_read_b128 v[36:39], v0 offset:12032
    v_smfmac_f32_16x16x64_bf16 v[28:31], v[40:43], a[136:143], v1
    v_smfmac_f32_16x16x64_bf16 v[32:35], v[40:43], a[144:151], v1
    s_waitcnt lgkmcnt(2)
    v_smfmac_f32_16x16x64_bf16 v[12:15], v[48:51], v[56:63], v1
    v_smfmac_f32_16x16x64_bf16 v[16:19], v[48:51], v[64:71], v1
    s_waitcnt lgkmcnt(1)
    v_smfmac_f32_16x16x64_bf16 v[12:15], v[52:55], v[152:159], v1
    v_smfmac_f32_16x16x64_bf16 v[16:19], v[52:55], v[160:167], v1
    s_waitcnt lgkmcnt(0)
    v_smfmac_f32_16x16x64_bf16 v[12:15], v[36:39], v[136:143], v1
    v_smfmac_f32_16x16x64_bf16 v[16:19], v[36:39], v[144:151], v1
    s_waitcnt vmcnt(1)
    v_max3_u32 v10, v44, v45, v46
    v_max_u32 v10, v10, v47
    v_cmp_eq_u32 vcc, -1, v10
    s_nop 0
    s_cbranch_vccnz Lr2f_pc_re
Lr2f_pc_ok:
    v_smfmac_f32_16x16x64_bf16 v[12:15], v[44:47], v[168:175], v1
    v_smfmac_f32_16x16x64_bf16 v[16:19], v[44:47], v[176:183], v1
    v_smfmac_f32_16x16x64_bf16 v[20:23], v[48:51], v[248:255], v1
    v_smfmac_f32_16x16x64_bf16 v[24:27], v[48:51], a[0:7], v1
    v_smfmac_f32_16x16x64_bf16 v[20:23], v[52:55], a[40:47], v1
    v_add_f32 v12, v12, v14
    buffer_load_dwordx4 v[64:67], v0, s[8:11], s42 offen
    v_smfmac_f32_16x16x64_bf16 v[24:27], v[52:55], a[48:55], v1
    v_add_f32 v16, v16, v18
    v_smfmac_f32_16x16x64_bf16 v[20:23], v[36:39], a[8:15], v1
    v_add_f32 v13, v13, v15
    v_smfmac_f32_16x16x64_bf16 v[24:27], v[36:39], a[16:23], v1
    v_add_f32 v17, v17, v19
    v_smfmac_f32_16x16x64_bf16 v[20:23], v[44:47], a[56:63], v1
    v_cvt_pk_bf16_f32 v14, v12, v16
    ds_read_b128 v[56:59], v0 offset:15104
    buffer_load_dwordx4 v[68:71], v0, s[8:11], s42 offen offset:1024
    v_smfmac_f32_16x16x64_bf16 v[24:27], v[44:47], a[64:71], v1
    v_cvt_pk_bf16_f32 v15, v13, v17
    ds_read_b128 v[60:63], v0 offset:16128
    ds_write_b32 v2, v14 offset:576
    ds_write_b32 v2, v15 offset:864
    v_smfmac_f32_16x16x64_bf16 v[28:31], v[48:51], a[104:111], v1
    v_smfmac_f32_16x16x64_bf16 v[32:35], v[48:51], a[112:119], v1
    v_add_f32 v20, v20, v22
    v_add_f32 v24, v24, v26
    v_add_f32 v21, v21, v23
    v_add_f32 v25, v25, v27
    v_cvt_pk_bf16_f32 v22, v20, v24
    v_cvt_pk_bf16_f32 v23, v21, v25
    ds_write_b32 v2, v22 offset:0
    ds_write_b32 v2, v23 offset:288
    v_smfmac_f32_16x16x64_bf16 v[28:31], v[52:55], a[152:159], v1
    v_smfmac_f32_16x16x64_bf16 v[32:35], v[52:55], a[160:167], v1
    s_waitcnt vmcnt(2)
    v_cmp_eq_u32 vcc, 0, v11
    s_nop 0
    s_cbranch_vccnz Lr2f_flbad
Lr2f_flok:
    s_waitcnt lgkmcnt(0)
    s_barrier
    ds_read_b128 v[40:43], v3 offset:0
    ds_read_b128 v[48:51], v3 offset:64
    ds_read_b128 v[20:23], v3 offset:128
    ds_read_b128 v[52:55], v3 offset:192
    v_smfmac_f32_16x16x64_bf16 v[28:31], v[36:39], a[120:127], v1
    v_smfmac_f32_16x16x64_bf16 v[32:35], v[36:39], a[128:135], v1
    ds_read_b128 v[36:39], v0 offset:17152
    v_smfmac_f32_16x16x64_bf16 v[28:31], v[44:47], a[168:175], v1
    v_smfmac_f32_16x16x64_bf16 v[32:35], v[44:47], a[176:183], v1
    ds_read_b128 v[44:47], v0 offset:18176
    s_waitcnt lgkmcnt(5)
    v_mfma_f32_16x16x32_bf16 v[12:15], v[56:59], v[40:43], 0
    v_mfma_f32_16x16x32_bf16 v[16:19], v[60:63], v[40:43], 0
    v_mfma_f32_16x16x32_bf16 v[24:27], v[40:43], v[40:43], 0
    ds_read_b128 v[56:59], v0 offset:19200
    ds_read_b128 v[60:63], v0 offset:20224
    s_waitcnt lgkmcnt(3)
    v_mfma_f32_16x16x32_bf16 v[12:15], v[36:39], v[48:51], v[12:15]
    v_lshrrev_b32 v10, 1, v0
    v_lshrrev_b32 v9, 9, v0
    s_waitcnt lgkmcnt(2)
    v_mfma_f32_16x16x32_bf16 v[16:19], v[44:47], v[48:51], v[16:19]
    v_lshl_add_u32 v9, v9, 5, v10
    v_add_f32 v28, v28, v30
    v_mfma_f32_16x16x32_bf16 v[24:27], v[48:51], v[48:51], v[24:27]
    v_add_f32 v32, v32, v34
    v_add_f32 v29, v29, v31
    ds_read_b128 v[36:39], v0 offset:21248
    ds_read_b128 v[44:47], v0 offset:22272
    s_waitcnt lgkmcnt(3)
    v_mfma_f32_16x16x32_bf16 v[12:15], v[56:59], v[20:23], v[12:15]
    v_add_f32 v33, v33, v35
    v_cvt_pk_bf16_f32 v30, v28, v29
    s_waitcnt lgkmcnt(2)
    v_mfma_f32_16x16x32_bf16 v[16:19], v[60:63], v[20:23], v[16:19]
    v_cvt_pk_bf16_f32 v31, v32, v33
    ds_read_b64 v[34:35], v9 offset:2304
    v_mfma_f32_16x16x32_bf16 v[24:27], v[20:23], v[20:23], v[24:27]
    s_add_u32 s17, s43, 3072
    buffer_store_dwordx2 v[30:31], v10, s[8:11], s17 offen sc1
    s_waitcnt lgkmcnt(2)
    v_mfma_f32_16x16x32_bf16 v[12:15], v[36:39], v[52:55], v[12:15]
    s_waitcnt lgkmcnt(1)
    v_mfma_f32_16x16x32_bf16 v[16:19], v[44:47], v[52:55], v[16:19]
    v_mfma_f32_16x16x32_bf16 v[24:27], v[52:55], v[52:55], v[24:27]
    s_add_u32 s17, s43, 1024
    s_waitcnt lgkmcnt(0)
    buffer_store_dwordx2 v[34:35], v10, s[8:11], s17 offen sc1
    s_cmp_eq_u32 s33, 63
    s_cbranch_scc1 Lr2f_last
    ds_read_b128 v[56:59], v8 offset:16384
    ds_read_b128 v[60:63], v8 offset:17408
    v_mov_b64 v[20:21], s[52:53]
    v_mov_b64 v[22:23], s[52:53]
    v_mov_b32 v41, 0
    v_mov_b32 v42, 0
    v_max3_f32 v9, v12, v13, v14
    v_max3_f32 v9, v9, v15, v16
    v_max3_f32 v9, v9, v17, v18
    v_max3_f32 v9, v9, v19, v24
    v_max_f32 v9, v9, v25
    v_mov_b32 v10, v9
    v_mov_b64 v[32:33], 0
    v_mov_b64 v[34:35], 0
    v_permlane32_swap_b32 v9, v10
    v_max_f32 v9, v9, v10
    v_mov_b32 v10, v9
    s_nop 1
    v_permlane16_swap_b32 v9, v10
    v_max_f32 v9, v9, v10
    v_mul_f32 v28, s44, v9
    v_fma_f32 v12, v12, s44, -v28
    v_fma_f32 v13, v13, s44, -v28
    v_fma_f32 v14, v14, s44, -v28
    v_fma_f32 v15, v15, s44, -v28
    v_exp_f32 v12, v12
    v_exp_f32 v13, v13
    v_fma_f32 v16, v16, s44, -v28
    v_fma_f32 v17, v17, s44, -v28
    v_exp_f32 v14, v14
    v_exp_f32 v15, v15
    v_cvt_pk_bf16_f32 v36, v12, v13
    v_fma_f32 v18, v18, s44, -v28
    v_fma_f32 v19, v19, s44, -v28
    v_exp_f32 v16, v16
    v_exp_f32 v17, v17
    v_cvt_pk_bf16_f32 v37, v14, v15
    v_fma_f32 v24, v24, s44, -v28
    v_fma_f32 v25, v25, s44, -v28
    v_exp_f32 v18, v18
    v_exp_f32 v19, v19
    v_cvt_pk_bf16_f32 v38, v16, v17
    v_exp_f32 v24, v24
    v_exp_f32 v25, v25
    v_cvt_pk_bf16_f32 v39, v18, v19
    v_cvt_pk_bf16_f32 v40, v24, v25
    v_cvt_pk_bf16_f32 v43, v24, v25
    v_mfma_f32_16x16x32_bf16 v[52:55], v[20:23], v[36:39], 0
    v_mov_b64 v[12:13], 0
    v_mov_b64 v[14:15], 0
    s_waitcnt vmcnt(3)
    v_mfma_f32_16x16x32_bf16 v[44:47], v[64:67], v[36:39], 0
    v_mov_b64 v[24:25], 0
    v_mov_b64 v[26:27], 0
    s_waitcnt vmcnt(2)
    v_mfma_f32_16x16x32_bf16 v[48:51], v[68:71], v[36:39], 0
    ds_read_b128 v[64:67], v8 offset:20480
    ds_read_b128 v[68:71], v8 offset:21504
    v_mfma_f32_16x16x16_bf16 v[52:55], v[20:21], v[40:41], v[52:55]
    v_mfma_f32_16x16x16_bf16 v[44:47], v[30:31], v[40:41], v[44:47]
    v_mov_b64 v[20:21], 0
    v_mov_b64 v[22:23], 0
    v_mfma_f32_16x16x16_bf16 v[48:51], v[30:31], v[42:43], v[48:51]
    v_mov_b64 v[36:37], 0
    v_mov_b64 v[38:39], 0
    v_mov_b64 v[40:41], 0
    v_mov_b64 v[42:43], 0
    v_rcp_f32 v9, v52
    v_mov_b64 v[52:53], 0
    v_mov_b64 v[54:55], 0
    v_mul_f32 v44, v9, v44
    v_mul_f32 v48, v9, v48
    v_cvt_pk_bf16_f32 v16, v44, v48
    v_mul_f32 v45, v9, v45
    v_mul_f32 v49, v9, v49
    v_cvt_pk_bf16_f32 v17, v45, v49
    v_mul_f32 v46, v9, v46
    v_mul_f32 v50, v9, v50
    v_cvt_pk_bf16_f32 v18, v46, v50
    v_mul_f32 v47, v9, v47
    v_mul_f32 v51, v9, v51
    v_cvt_pk_bf16_f32 v19, v47, v51
    ds_write_b128 v5, v[16:19]
    v_mov_b64 v[28:29], 0
    v_mov_b64 v[30:31], 0
    s_waitcnt lgkmcnt(0)
    s_barrier
    ds_read_b128 v[44:47], v4 offset:0
    ds_read_b128 v[48:51], v4 offset:128
    v_mov_b64 v[16:17], 0
    v_mov_b64 v[18:19], 0
    buffer_load_dwordx4 v0, s[8:11], s41 offen offset:0 lds
    buffer_load_dwordx4 v0, s[8:11], s41 offen offset:1024 lds
    s_waitcnt lgkmcnt(1)
    v_smfmac_f32_16x16x64_bf16 v[12:15], v[44:47], a[184:191], v1
    s_waitcnt lgkmcnt(0)
    v_smfmac_f32_16x16x64_bf16 v[12:15], v[48:51], a[192:199], v1
    v_smfmac_f32_16x16x64_bf16 v[24:27], v[44:47], a[200:207], v1
    v_smfmac_f32_16x16x64_bf16 v[24:27], v[48:51], a[208:215], v1
    v_add_f32 v12, v12, v14
    v_smfmac_f32_16x16x64_bf16 v[20:23], v[44:47], a[216:223], v1
    v_add_f32 v13, v13, v15
    v_smfmac_f32_16x16x64_bf16 v[20:23], v[48:51], a[224:231], v1
    v_cvt_pk_bf16_f32 v12, v12, v13
    v_smfmac_f32_16x16x64_bf16 v[16:19], v[44:47], a[232:239], v1
    v_add_f32 v24, v24, v26
    v_smfmac_f32_16x16x64_bf16 v[16:19], v[48:51], a[240:247], v1
    v_add_f32 v25, v25, v27
    v_smfmac_f32_16x16x64_bf16 v[36:39], v[44:47], v[56:63], v1
    v_cvt_pk_bf16_f32 v13, v24, v25
    v_smfmac_f32_16x16x64_bf16 v[36:39], v[48:51], v[64:71], v1
    v_add_f32 v20, v20, v22
    v_add_f32 v21, v21, v23
    v_cvt_pk_bf16_f32 v14, v20, v21
    v_add_f32 v16, v16, v18
    v_add_f32 v17, v17, v19
    v_cvt_pk_bf16_f32 v15, v16, v17
    v_and_or_b32 v15, v15, -2, s40
    buffer_store_dwordx4 v[12:15], v0, s[8:11], s38 offen
    s_nop 0
    ds_read_b128 v[12:15], v8 offset:18432
    ds_read_b128 v[16:19], v8 offset:19456
    ds_read_b128 v[20:23], v8 offset:22528
    ds_read_b128 v[24:27], v8 offset:23552
    ds_read_b128 v[56:59], v8 offset:24576
    ds_read_b128 v[60:63], v8 offset:25600
    ds_read_b128 v[64:67], v8 offset:28672
    ds_read_b128 v[68:71], v8 offset:29696
    s_waitcnt lgkmcnt(6)
    v_smfmac_f32_16x16x64_bf16 v[40:43], v[44:47], v[12:19], v1
    ds_read_b128 v[12:15], v8 offset:26624
    ds_read_b128 v[16:19], v8 offset:27648
    s_waitcnt lgkmcnt(6)
    v_smfmac_f32_16x16x64_bf16 v[40:43], v[48:51], v[20:27], v1
    ds_read_b128 v[20:23], v8 offset:30720
    ds_read_b128 v[24:27], v8 offset:31744
    s_waitcnt lgkmcnt(6)
    v_smfmac_f32_16x16x64_bf16 v[52:55], v[44:47], v[56:63], v1
    ds_read_b128 v[56:59], v8 offset:32768
    ds_read_b128 v[60:63], v8 offset:33792
    s_waitcnt lgkmcnt(6)
    v_smfmac_f32_16x16x64_bf16 v[52:55], v[48:51], v[64:71], v1
    s_waitcnt lgkmcnt(4)
    v_smfmac_f32_16x16x64_bf16 v[32:35], v[44:47], v[12:19], v1
    s_waitcnt lgkmcnt(2)
    v_smfmac_f32_16x16x64_bf16 v[32:35], v[48:51], v[20:27], v1
    v_smfmac_f32_16x16x64_bf16 v[28:31], v[44:47], a[248:255], v1
    s_waitcnt lgkmcnt(0)
    v_smfmac_f32_16x16x64_bf16 v[28:31], v[48:51], v[56:63], v1
    v_add_f32 v36, v36, v38
    v_add_f32 v37, v37, v39
    v_cvt_pk_bf16_f32 v36, v36, v37
    v_add_f32 v40, v40, v42
    v_add_f32 v41, v41, v43
    v_cvt_pk_bf16_f32 v37, v40, v41
    v_add_f32 v52, v52, v54
    v_add_f32 v53, v53, v55
    v_cvt_pk_bf16_f32 v38, v52, v53
    v_add_f32 v32, v32, v34
    v_add_f32 v33, v33, v35
    v_cvt_pk_bf16_f32 v39, v32, v33
    v_and_or_b32 v39, v39, -2, s40
    s_add_u32 s17, s38, 4096
    buffer_store_dwordx4 v[36:39], v0, s[8:11], s17 offen
    v_add_f32 v28, v28, v30
    v_add_f32 v29, v29, v31
    v_cvt_pk_bf16_f32 v28, v28, v29
    v_and_or_b32 v28, v28, -2, s40
    v_lshrrev_b32 v9, 2, v0
    buffer_store_dword v28, v9, s[8:11], s39 offen
    v_add_u32 v10, 162560, v0
    ds_read_b32 v64, v10
    v_mov_b32 v65, 0
    v_mov_b32 v41, 0
    v_mov_b32 v45, 0
    v_mov_b32 v49, 0
    v_mov_b32 v53, 0
    s_add_u32 s33, s33, 1
    s_add_u32 s42, s42, 262144
    s_add_u32 s41, s41, 262144
    s_add_u32 s43, s43, 131072
    s_add_u32 s68, s68, 262144
    s_add_u32 s66, s66, 22528
    ds_read_b128 v[56:59], v8 offset:4096
    ds_read_b128 v[60:63], v8 offset:5120
    v_mov_b64 v[12:13], 0
    v_mov_b64 v[14:15], 0
    v_mov_b64 v[16:17], 0
    v_mov_b64 v[18:19], 0
    v_mov_b64 v[20:21], 0
    v_mov_b64 v[22:23], 0
    v_mov_b64 v[24:25], 0
    v_mov_b64 v[26:27], 0
    v_mov_b64 v[28:29], 0
    v_mov_b64 v[30:31], 0
    v_mov_b64 v[32:33], 0
    v_mov_b64 v[34:35], 0
    s_nop 15
    s_nop 15
    s_nop 15
    s_nop 1
    buffer_load_dword v40, v6, s[8:11], s62 offen sc1
    buffer_load_dword v44, v6, s[8:11], s63 offen sc1
    buffer_load_dword v48, v6, s[8:11], s64 offen sc1
    buffer_load_dword v52, v6, s[8:11], s65 offen sc1
    s_waitcnt lgkmcnt(0)
    s_waitcnt vmcnt(3)
    v_mfma_f32_16x16x16_bf16 v[68:71], v[40:41], v[64:65], 0
    v_and_b32 v10, 1, v40
    v_cmp_ne_u32 s[54:55], s40, v10
    s_waitcnt vmcnt(2)
    v_mfma_f32_16x16x16_bf16 v[68:71], v[44:45], v[64:65], v[68:71]
    v_and_b32 v10, 1, v44
    v_cmp_ne_u32 s[56:57], s40, v10
    s_waitcnt vmcnt(1)
    v_mfma_f32_16x16x16_bf16 v[68:71], v[48:49], v[64:65], v[68:71]
    v_and_b32 v10, 1, v48
    v_cmp_ne_u32 s[58:59], s40, v10
    s_waitcnt vmcnt(0)
    v_mfma_f32_16x16x16_bf16 v[68:71], v[52:53], v[64:65], v[68:71]
    v_and_b32 v10, 1, v52
    v_cmp_ne_u32 s[60:61], s40, v10
    s_or_b64 vcc, s[54:55], s[56:57]
    s_or_b64 vcc, vcc, s[58:59]
    s_or_b64 vcc, vcc, s[60:61]
    s_cbranch_scc0 Lr2f_red
    s_mov_b32 s16, 0
Lr2f_p1:
    s_mov_b64 exec, s[54:55]
    buffer_load_dword v40, v6, s[8:11], s62 offen sc1
    s_mov_b64 exec, s[56:57]
    buffer_load_dword v44, v6, s[8:11], s63 offen sc1
    s_mov_b64 exec, s[58:59]
    buffer_load_dword v48, v6, s[8:11], s64 offen sc1
    s_mov_b64 exec, s[60:61]
    buffer_load_dword v52, v6, s[8:11], s65 offen sc1
    s_mov_b64 exec, -1
    s_add_u32 s16, s16, 1
    s_cmp_gt_u32 s16, 100000
    s_cbranch_scc1 Lr_abort
    s_waitcnt vmcnt(3)
    v_mfma_f32_16x16x16_bf16 v[68:71], v[40:41], v[64:65], 0
    v_and_b32 v10, 1, v40
    v_cmp_ne_u32 s[54:55], s40, v10
    s_waitcnt vmcnt(2)
    v_mfma_f32_16x16x16_bf16 v[68:71], v[44:45], v[64:65], v[68:71]
    v_and_b32 v10, 1, v44
    v_cmp_ne_u32 s[56:57], s40, v10
    s_waitcnt vmcnt(1)
    v_mfma_f32_16x16x16_bf16 v[68:71], v[48:49], v[64:65], v[68:71]
    v_and_b32 v10, 1, v48
    v_cmp_ne_u32 s[58:59], s40, v10
    s_waitcnt vmcnt(0)
    v_mfma_f32_16x16x16_bf16 v[68:71], v[52:53], v[64:65], v[68:71]
    v_and_b32 v10, 1, v52
    v_cmp_ne_u32 s[60:61], s40, v10
    s_or_b64 vcc, s[54:55], s[56:57]
    s_or_b64 vcc, vcc, s[58:59]
    s_or_b64 vcc, vcc, s[60:61]
    s_cbranch_scc1 Lr2f_p1
Lr2f_red:
    s_xor_b32 s34, s34, 16384
    s_xor_b32 s35, s35, 16384
    buffer_load_dwordx4 v[36:39], v0, s[8:11], s34 offen sc1
    v_permlane16_swap_b32 v68, v70
    v_permlane16_swap_b32 v69, v71
    s_mov_b64 exec, s[46:47]
    v_add_f32 v68, v68, v70
    v_add_f32 v69, v69, v71
    v_cvt_pk_bf16_f32 v68, v68, v69
    v_min_u32 v68, s50, v68
    buffer_store_dword v68, v7, s[8:11], s36 offen
    v_mov_b32 v69, -1
    buffer_store_dword v69, v7, s[8:11], s37 offen
    s_mov_b64 exec, -1
    buffer_load_dwordx4 v[36:39], v0, s[8:11], s34 offen sc1
    s_xor_b32 s40, s40, 1
    s_xor_b32 s36, s36, 16384
    s_xor_b32 s37, s37, 16384
    ds_read_b128 v[64:67], v8 offset:6144
    ds_read_b128 v[68:71], v8 offset:7168
    s_waitcnt lgkmcnt(0)
    s_branch Lr2f_step
Lr2f_pb_re:
    s_mov_b32 s16, 0
Lr2f_pb_lp:
    s_add_u32 s17, s34, 4096
    buffer_load_dwordx4 v[40:43], v0, s[8:11], s17 offen sc1
    s_add_u32 s16, s16, 1
    s_cmp_gt_u32 s16, 100000
    s_cbranch_scc1 Lr_abort
    s_waitcnt vmcnt(0)
    v_max3_u32 v10, v40, v41, v42
    v_max_u32 v10, v10, v43
    v_cmp_eq_u32 vcc, -1, v10
    s_nop 0
    s_cbranch_vccnz Lr2f_pb_lp
    s_branch Lr2f_pb_ok
Lr2f_pc_re:
    s_mov_b32 s16, 0
Lr2f_pc_lp:
    buffer_load_dwordx4 v[44:47], v0, s[8:11], s35 offen sc1
    s_add_u32 s16, s16, 1
    s_cmp_gt_u32 s16, 100000
    s_cbranch_scc1 Lr_abort
    s_waitcnt vmcnt(0)
    v_max3_u32 v10, v44, v45, v46
    v_max_u32 v10, v10, v47
    v_cmp_eq_u32 vcc, -1, v10
    s_nop 0
    s_cbranch_vccnz Lr2f_pc_lp
    s_branch Lr2f_pc_ok
Lr2f_flbad:
    s_cmp_eq_u32 s33, 63
    s_cbranch_scc1 Lr2f_flok
    s_mov_b32 s16, 0
    s_add_u32 s17, s66, 22656
    v_lshrrev_b32 v10, 2, v0
    v_and_b32 v9, 16, v10
    v_lshlrev_b32 v9, 3, v9
    v_and_or_b32 v10, v10, 12, v9
Lr2f_fw_13:
    buffer_load_dword v9, v10, s[8:11], s17 offen sc1
    s_add_u32 s16, s16, 1
    s_cmp_gt_u32 s16, 100000
    s_cbranch_scc1 Lr_abort
    s_waitcnt vmcnt(0)
    v_cmp_eq_u32 vcc, 0, v9
    s_nop 0
    s_cbranch_vccnz Lr2f_fw_13
    s_branch Lr2f_flok
Lr2f_last:
    s_waitcnt vmcnt(0) lgkmcnt(0)
    s_barrier
    s_branch Lr_exit
L_w3_1:
    s_mov_b32 s16, 0
    s_add_u32 s17, s66, 128
    v_lshrrev_b32 v10, 2, v0
    v_and_b32 v9, 16, v10
    v_lshlrev_b32 v9, 3, v9
    v_and_or_b32 v10, v10, 12, v9
Lr3f_fw_14:
    buffer_load_dword v9, v10, s[8:11], s17 offen sc1
    s_add_u32 s16, s16, 1
    s_cmp_gt_u32 s16, 100000
    s_cbranch_scc1 Lr_abort
    s_waitcnt vmcnt(0)
    v_cmp_eq_u32 vcc, 0, v9
    s_nop 0
    s_cbranch_vccnz Lr3f_fw_14
    s_mov_b32 m0, 21248
    s_nop 0
    buffer_load_dwordx4 v0, s[8:11], s41 offen offset:0 lds
    buffer_load_dwordx4 v0, s[8:11], s41 offen offset:1024 lds
    s_add_u32 s41, s41, 262144
    s_add_u32 s68, s68, 262144
    s_waitcnt vmcnt(0)
    ds_read_b128 v[56:59], v8 offset:0
    ds_read_b128 v[60:63], v8 offset:1024
    ds_read_b128 v[64:67], v8 offset:2048
    ds_read_b128 v[68:71], v8 offset:3072
    v_mov_b64 v[12:13], 0
    v_mov_b64 v[14:15], 0
    v_mov_b64 v[16:17], 0
    v_mov_b64 v[18:19], 0
    v_mov_b64 v[20:21], 0
    v_mov_b64 v[22:23], 0
    v_mov_b64 v[24:25], 0
    v_mov_b64 v[26:27], 0
    v_mov_b64 v[28:29], 0
    v_mov_b64 v[30:31], 0
    v_mov_b64 v[32:33], 0
    v_mov_b64 v[34:35], 0
    buffer_load_dwordx4 v[36:39], v0, s[8:11], s34 offen sc1
    s_waitcnt vmcnt(0) lgkmcnt(0)
Lr3f_step:
    s_mov_b32 s16, 0
Lr3f_alp:
    s_waitcnt vmcnt(2)
    v_max3_u32 v10, v36, v37, v38
    v_max_u32 v10, v10, v39
    v_cmp_eq_u32 vcc, -1, v10
    s_nop 0
    s_cbranch_vccz Lr3f_aok
    buffer_load_dwordx4 v[36:39], v0, s[8:11], s34 offen sc1
    s_add_u32 s16, s16, 1
    s_cmp_gt_u32 s16, 100000
    s_cbranch_scc1 Lr_abort
    s_branch Lr3f_alp
Lr3f_aok:
    ds_write_b128 v0, v[36:39] offset:9984
    v_smfmac_f32_16x16x64_bf16 v[12:15], v[36:39], v[120:127], v1
    v_smfmac_f32_16x16x64_bf16 v[16:19], v[36:39], v[128:135], v1
    v_smfmac_f32_16x16x64_bf16 v[20:23], v[36:39], v[232:239], v1
    s_waitcnt lgkmcnt(0)
    s_barrier
    ds_read_b128 v[48:51], v0 offset:6912
    ds_read_b128 v[52:55], v0 offset:7936
    v_smfmac_f32_16x16x64_bf16 v[28:31], v[36:39], a[88:95], v1
    v_smfmac_f32_16x16x64_bf16 v[24:27], v[36:39], v[240:247], v1
    v_smfmac_f32_16x16x64_bf16 v[32:35], v[36:39], a[96:103], v1
    s_waitcnt vmcnt(0)
    ds_read_b128 v[36:39], v0 offset:8960
    s_waitcnt lgkmcnt(2)
    v_smfmac_f32_16x16x64_bf16 v[28:31], v[48:51], v[56:63], v1
    ds_read_b128 v[56:59], v8 offset:4096
    ds_read_b128 v[60:63], v8 offset:5120
    s_add_u32 s17, s34, 4096
    buffer_load_dwordx4 v[40:43], v0, s[8:11], s17 offen sc1
    v_smfmac_f32_16x16x64_bf16 v[12:15], v[48:51], v[72:79], v1
    v_smfmac_f32_16x16x64_bf16 v[16:19], v[48:51], v[80:87], v1
    v_smfmac_f32_16x16x64_bf16 v[32:35], v[48:51], v[64:71], v1
    ds_read_b128 v[64:67], v8 offset:6144
    ds_read_b128 v[68:71], v8 offset:7168
    v_smfmac_f32_16x16x64_bf16 v[20:23], v[48:51], v[184:191], v1
    buffer_load_dwordx4 v[44:47], v0, s[8:11], s35 offen sc1
    v_smfmac_f32_16x16x64_bf16 v[24:27], v[48:51], v[192:199], v1
    s_waitcnt lgkmcnt(5)
    v_smfmac_f32_16x16x64_bf16 v[28:31], v[52:55], a[72:79], v1
    v_smfmac_f32_16x16x64_bf16 v[12:15], v[52:55], v[88:95], v1
    v_smfmac_f32_16x16x64_bf16 v[16:19], v[52:55], v[96:103], v1
    v_smfmac_f32_16x16x64_bf16 v[32:35], v[52:55], a[80:87], v1
    v_smfmac_f32_16x16x64_bf16 v[20:23], v[52:55], v[200:207], v1
    v_smfmac_f32_16x16x64_bf16 v[24:27], v[52:55], v[208:215], v1
    s_waitcnt lgkmcnt(2)
    v_smfmac_f32_16x16x64_bf16 v[28:31], v[36:39], v[56:63], v1
    ds_read_b128 v[56:59], v8 offset:8192
    ds_read_b128 v[60:63], v8 offset:9216
    v_smfmac_f32_16x16x64_bf16 v[12:15], v[36:39], v[104:111], v1
    v_smfmac_f32_16x16x64_bf16 v[16:19], v[36:39], v[112:119], v1
    s_waitcnt lgkmcnt(2)
    v_smfmac_f32_16x16x64_bf16 v[32:35], v[36:39], v[64:71], v1
    ds_read_b128 v[64:67], v8 offset:10240
    ds_read_b128 v[68:71], v8 offset:11264
    v_smfmac_f32_16x16x64_bf16 v[20:23], v[36:39], v[216:223], v1
    v_smfmac_f32_16x16x64_bf16 v[24:27], v[36:39], v[224:231], v1
    s_waitcnt vmcnt(1)
    v_max3_u32 v10, v40, v41, v42
    v_max_u32 v10, v10, v43
    v_cmp_eq_u32 vcc, -1, v10
    s_nop 0
    s_cbranch_vccnz Lr3f_pb_re
Lr3f_pb_ok:
    ds_write_b128 v0, v[40:43] offset:14080
    v_smfmac_f32_16x16x64_bf16 v[12:15], v[40:43], v[152:159], v1
    v_smfmac_f32_16x16x64_bf16 v[20:23], v[40:43], a[40:47], v1
    v_smfmac_f32_16x16x64_bf16 v[16:19], v[40:43], v[160:167], v1
    v_smfmac_f32_16x16x64_bf16 v[24:27], v[40:43], a[48:55], v1
    s_waitcnt lgkmcnt(0)
    s_barrier
    ds_read_b128 v[48:51], v0 offset:11008
    ds_read_b128 v[52:55], v0 offset:12032
    ds_read_b128 v[36:39], v0 offset:13056
    v_smfmac_f32_16x16x64_bf16 v[28:31], v[40:43], a[152:159], v1
    v_smfmac_f32_16x16x64_bf16 v[32:35], v[40:43], a[160:167], v1
    s_waitcnt lgkmcnt(2)
    v_smfmac_f32_16x16x64_bf16 v[12:15], v[48:51], v[56:63], v1
    ds_read_b128 v[56:59], v8 offset:12288
    ds_read_b128 v[60:63], v8 offset:13312
    v_smfmac_f32_16x16x64_bf16 v[16:19], v[48:51], v[64:71], v1
    ds_read_b128 v[64:67], v8 offset:14336
    ds_read_b128 v[68:71], v8 offset:15360
    s_waitcnt lgkmcnt(5)
    v_smfmac_f32_16x16x64_bf16 v[12:15], v[52:55], v[136:143], v1
    v_smfmac_f32_16x16x64_bf16 v[16:19], v[52:55], v[144:151], v1
    s_waitcnt vmcnt(0)
    v_max3_u32 v10, v44, v45, v46
    v_max_u32 v10, v10, v47
    v_cmp_eq_u32 vcc, -1, v10
    s_nop 0
    s_cbranch_vccnz Lr3f_pc_re
Lr3f_pc_ok:
    v_smfmac_f32_16x16x64_bf16 v[12:15], v[44:47], v[168:175], v1
    v_smfmac_f32_16x16x64_bf16 v[16:19], v[44:47], v[176:183], v1
    s_waitcnt lgkmcnt(2)
    v_smfmac_f32_16x16x64_bf16 v[12:15], v[36:39], v[56:63], v1
    s_waitcnt lgkmcnt(0)
    v_smfmac_f32_16x16x64_bf16 v[16:19], v[36:39], v[64:71], v1
    v_smfmac_f32_16x16x64_bf16 v[20:23], v[48:51], v[248:255], v1
    v_smfmac_f32_16x16x64_bf16 v[24:27], v[48:51], a[0:7], v1
    v_smfmac_f32_16x16x64_bf16 v[20:23], v[52:55], a[8:15], v1
    v_add_f32 v12, v12, v14
    v_smfmac_f32_16x16x64_bf16 v[24:27], v[52:55], a[16:23], v1
    v_add_f32 v16, v16, v18
    buffer_load_dwordx4 v[64:67], v0, s[8:11], s42 offen
    v_smfmac_f32_16x16x64_bf16 v[20:23], v[36:39], a[24:31], v1
    v_add_f32 v13, v13, v15
    v_smfmac_f32_16x16x64_bf16 v[24:27], v[36:39], a[32:39], v1
    v_add_f32 v17, v17, v19
    v_smfmac_f32_16x16x64_bf16 v[20:23], v[44:47], a[56:63], v1
    v_cvt_pk_bf16_f32 v14, v12, v16
    ds_read_b128 v[56:59], v0 offset:15104
    v_smfmac_f32_16x16x64_bf16 v[24:27], v[44:47], a[64:71], v1
    v_cvt_pk_bf16_f32 v15, v13, v17
    ds_read_b128 v[60:63], v0 offset:16128
    buffer_load_dwordx4 v[68:71], v0, s[8:11], s42 offen offset:1024
    ds_write_b32 v2, v14 offset:576
    ds_write_b32 v2, v15 offset:864
    v_smfmac_f32_16x16x64_bf16 v[28:31], v[48:51], a[104:111], v1
    v_smfmac_f32_16x16x64_bf16 v[32:35], v[48:51], a[112:119], v1
    v_add_f32 v20, v20, v22
    v_add_f32 v24, v24, v26
    v_add_f32 v21, v21, v23
    v_add_f32 v25, v25, v27
    v_cvt_pk_bf16_f32 v22, v20, v24
    v_cvt_pk_bf16_f32 v23, v21, v25
    ds_write_b32 v2, v22 offset:0
    ds_write_b32 v2, v23 offset:288
    v_smfmac_f32_16x16x64_bf16 v[28:31], v[52:55], a[120:127], v1
    v_smfmac_f32_16x16x64_bf16 v[32:35], v[52:55], a[128:135], v1
    s_waitcnt lgkmcnt(0)
    s_barrier
    ds_read_b128 v[40:43], v3 offset:0
    ds_read_b128 v[48:51], v3 offset:64
    ds_read_b128 v[20:23], v3 offset:128
    ds_read_b128 v[52:55], v3 offset:192
    v_smfmac_f32_16x16x64_bf16 v[28:31], v[36:39], a[136:143], v1
    v_smfmac_f32_16x16x64_bf16 v[32:35], v[36:39], a[144:151], v1
    ds_read_b128 v[36:39], v0 offset:17152
    v_lshlrev_b32 v9, 3, v0
    buffer_load_dword v11, v9, s[8:11], s68 offen
    v_smfmac_f32_16x16x64_bf16 v[28:31], v[44:47], a[168:175], v1
    v_smfmac_f32_16x16x64_bf16 v[32:35], v[44:47], a[176:183], v1
    ds_read_b128 v[44:47], v0 offset:18176
    s_waitcnt lgkmcnt(5)
    v_mfma_f32_16x16x32_bf16 v[12:15], v[56:59], v[40:43], 0
    v_mfma_f32_16x16x32_bf16 v[16:19], v[60:63], v[40:43], 0
    v_mfma_f32_16x16x32_bf16 v[24:27], v[40:43], v[40:43], 0
    ds_read_b128 v[56:59], v0 offset:19200
    ds_read_b128 v[60:63], v0 offset:20224
    s_waitcnt lgkmcnt(3)
    v_mfma_f32_16x16x32_bf16 v[12:15], v[36:39], v[48:51], v[12:15]
    v_lshrrev_b32 v10, 1, v0
    v_lshrrev_b32 v9, 9, v0
    s_waitcnt lgkmcnt(2)
    v_mfma_f32_16x16x32_bf16 v[16:19], v[44:47], v[48:51], v[16:19]
    v_lshl_add_u32 v9, v9, 5, v10
    v_add_f32 v28, v28, v30
    v_mfma_f32_16x16x32_bf16 v[24:27], v[48:51], v[48:51], v[24:27]
    v_add_f32 v32, v32, v34
    v_add_f32 v29, v29, v31
    ds_read_b128 v[36:39], v0 offset:21248
    ds_read_b128 v[44:47], v0 offset:22272
    s_waitcnt lgkmcnt(3)
    v_mfma_f32_16x16x32_bf16 v[12:15], v[56:59], v[20:23], v[12:15]
    v_add_f32 v33, v33, v35
    v_cvt_pk_bf16_f32 v30, v28, v29
    s_waitcnt lgkmcnt(2)
    v_mfma_f32_16x16x32_bf16 v[16:19], v[60:63], v[20:23], v[16:19]
    v_cvt_pk_bf16_f32 v31, v32, v33
    ds_read_b64 v[34:35], v9 offset:3456
    v_mfma_f32_16x16x32_bf16 v[24:27], v[20:23], v[20:23], v[24:27]
    s_add_u32 s17, s43, 3584
    buffer_store_dwordx2 v[30:31], v10, s[8:11], s17 offen sc1
    s_waitcnt lgkmcnt(2)
    v_mfma_f32_16x16x32_bf16 v[12:15], v[36:39], v[52:55], v[12:15]
    s_waitcnt lgkmcnt(1)
    v_mfma_f32_16x16x32_bf16 v[16:19], v[44:47], v[52:55], v[16:19]
    v_mfma_f32_16x16x32_bf16 v[24:27], v[52:55], v[52:55], v[24:27]
    s_add_u32 s17, s43, 1536
    s_waitcnt lgkmcnt(0)
    buffer_store_dwordx2 v[34:35], v10, s[8:11], s17 offen sc1
    s_cmp_eq_u32 s33, 63
    s_cbranch_scc1 Lr3f_last
    ds_read_b128 v[56:59], v8 offset:16384
    ds_read_b128 v[60:63], v8 offset:17408
    v_mov_b64 v[20:21], s[52:53]
    v_mov_b64 v[22:23], s[52:53]
    v_mov_b32 v41, 0
    v_mov_b32 v42, 0
    v_max3_f32 v9, v12, v13, v14
    v_max3_f32 v9, v9, v15, v16
    v_max3_f32 v9, v9, v17, v18
    v_max3_f32 v9, v9, v19, v24
    v_max_f32 v9, v9, v25
    v_mov_b32 v10, v9
    v_mov_b64 v[32:33], 0
    v_mov_b64 v[34:35], 0
    v_permlane32_swap_b32 v9, v10
    v_max_f32 v9, v9, v10
    v_mov_b32 v10, v9
    s_nop 1
    v_permlane16_swap_b32 v9, v10
    v_max_f32 v9, v9, v10
    v_mul_f32 v28, s44, v9
    v_fma_f32 v12, v12, s44, -v28
    v_fma_f32 v13, v13, s44, -v28
    v_fma_f32 v14, v14, s44, -v28
    v_fma_f32 v15, v15, s44, -v28
    v_exp_f32 v12, v12
    v_exp_f32 v13, v13
    v_fma_f32 v16, v16, s44, -v28
    v_fma_f32 v17, v17, s44, -v28
    v_exp_f32 v14, v14
    v_exp_f32 v15, v15
    v_cvt_pk_bf16_f32 v36, v12, v13
    v_fma_f32 v18, v18, s44, -v28
    v_fma_f32 v19, v19, s44, -v28
    v_exp_f32 v16, v16
    v_exp_f32 v17, v17
    v_cvt_pk_bf16_f32 v37, v14, v15
    v_fma_f32 v24, v24, s44, -v28
    v_fma_f32 v25, v25, s44, -v28
    v_exp_f32 v18, v18
    v_exp_f32 v19, v19
    v_cvt_pk_bf16_f32 v38, v16, v17
    v_exp_f32 v24, v24
    v_exp_f32 v25, v25
    v_cvt_pk_bf16_f32 v39, v18, v19
    v_cvt_pk_bf16_f32 v40, v24, v25
    v_cvt_pk_bf16_f32 v43, v24, v25
    v_mfma_f32_16x16x32_bf16 v[52:55], v[20:23], v[36:39], 0
    v_mov_b64 v[12:13], 0
    v_mov_b64 v[14:15], 0
    s_waitcnt vmcnt(4)
    v_mfma_f32_16x16x32_bf16 v[44:47], v[64:67], v[36:39], 0
    v_mov_b64 v[24:25], 0
    v_mov_b64 v[26:27], 0
    s_waitcnt vmcnt(3)
    v_mfma_f32_16x16x32_bf16 v[48:51], v[68:71], v[36:39], 0
    ds_read_b128 v[64:67], v8 offset:20480
    ds_read_b128 v[68:71], v8 offset:21504
    v_mfma_f32_16x16x16_bf16 v[52:55], v[20:21], v[40:41], v[52:55]
    v_mfma_f32_16x16x16_bf16 v[44:47], v[30:31], v[40:41], v[44:47]
    v_mov_b64 v[20:21], 0
    v_mov_b64 v[22:23], 0
    v_mfma_f32_16x16x16_bf16 v[48:51], v[30:31], v[42:43], v[48:51]
    v_mov_b64 v[36:37], 0
    v_mov_b64 v[38:39], 0
    v_mov_b64 v[40:41], 0
    v_mov_b64 v[42:43], 0
    v_rcp_f32 v9, v52
    v_mov_b64 v[52:53], 0
    v_mov_b64 v[54:55], 0
    v_mul_f32 v44, v9, v44
    v_mul_f32 v48, v9, v48
    v_cvt_pk_bf16_f32 v16, v44, v48
    v_mul_f32 v45, v9, v45
    v_mul_f32 v49, v9, v49
    v_cvt_pk_bf16_f32 v17, v45, v49
    v_mul_f32 v46, v9, v46
    v_mul_f32 v50, v9, v50
    v_cvt_pk_bf16_f32 v18, v46, v50
    v_mul_f32 v47, v9, v47
    v_mul_f32 v51, v9, v51
    v_cvt_pk_bf16_f32 v19, v47, v51
    ds_write_b128 v5, v[16:19]
    v_mov_b64 v[28:29], 0
    v_mov_b64 v[30:31], 0
    s_waitcnt lgkmcnt(0)
    s_barrier
    ds_read_b128 v[44:47], v4 offset:0
    ds_read_b128 v[48:51], v4 offset:128
    v_mov_b64 v[16:17], 0
    v_mov_b64 v[18:19], 0
    buffer_load_dwordx4 v0, s[8:11], s41 offen offset:0 lds
    buffer_load_dwordx4 v0, s[8:11], s41 offen offset:1024 lds
    s_waitcnt lgkmcnt(1)
    v_smfmac_f32_16x16x64_bf16 v[12:15], v[44:47], a[184:191], v1
    s_waitcnt lgkmcnt(0)
    v_smfmac_f32_16x16x64_bf16 v[12:15], v[48:51], a[192:199], v1
    v_smfmac_f32_16x16x64_bf16 v[24:27], v[44:47], a[200:207], v1
    v_smfmac_f32_16x16x64_bf16 v[24:27], v[48:51], a[208:215], v1
    v_add_f32 v12, v12, v14
    v_smfmac_f32_16x16x64_bf16 v[20:23], v[44:47], a[216:223], v1
    v_add_f32 v13, v13, v15
    v_smfmac_f32_16x16x64_bf16 v[20:23], v[48:51], a[224:231], v1
    v_cvt_pk_bf16_f32 v12, v12, v13
    v_smfmac_f32_16x16x64_bf16 v[16:19], v[44:47], a[232:239], v1
    v_add_f32 v24, v24, v26
    v_smfmac_f32_16x16x64_bf16 v[16:19], v[48:51], a[240:247], v1
    v_add_f32 v25, v25, v27
    v_smfmac_f32_16x16x64_bf16 v[36:39], v[44:47], v[56:63], v1
    v_cvt_pk_bf16_f32 v13, v24, v25
    v_smfmac_f32_16x16x64_bf16 v[36:39], v[48:51], v[64:71], v1
    v_add_f32 v20, v20, v22
    v_add_f32 v21, v21, v23
    v_cvt_pk_bf16_f32 v14, v20, v21
    v_add_f32 v16, v16, v18
    v_add_f32 v17, v17, v19
    v_cvt_pk_bf16_f32 v15, v16, v17
    v_and_or_b32 v15, v15, -2, s40
    buffer_store_dwordx4 v[12:15], v0, s[8:11], s38 offen
    s_nop 0
    ds_read_b128 v[12:15], v8 offset:18432
    ds_read_b128 v[16:19], v8 offset:19456
    ds_read_b128 v[20:23], v8 offset:22528
    ds_read_b128 v[24:27], v8 offset:23552
    ds_read_b128 v[56:59], v8 offset:24576
    ds_read_b128 v[60:63], v8 offset:25600
    ds_read_b128 v[64:67], v8 offset:28672
    ds_read_b128 v[68:71], v8 offset:29696
    s_waitcnt lgkmcnt(6)
    v_smfmac_f32_16x16x64_bf16 v[40:43], v[44:47], v[12:19], v1
    ds_read_b128 v[12:15], v8 offset:26624
    ds_read_b128 v[16:19], v8 offset:27648
    s_waitcnt lgkmcnt(6)
    v_smfmac_f32_16x16x64_bf16 v[40:43], v[48:51], v[20:27], v1
    ds_read_b128 v[20:23], v8 offset:30720
    ds_read_b128 v[24:27], v8 offset:31744
    s_waitcnt lgkmcnt(6)
    v_smfmac_f32_16x16x64_bf16 v[52:55], v[44:47], v[56:63], v1
    ds_read_b128 v[56:59], v8 offset:32768
    ds_read_b128 v[60:63], v8 offset:33792
    s_waitcnt lgkmcnt(6)
    v_smfmac_f32_16x16x64_bf16 v[52:55], v[48:51], v[64:71], v1
    s_waitcnt lgkmcnt(4)
    v_smfmac_f32_16x16x64_bf16 v[32:35], v[44:47], v[12:19], v1
    s_waitcnt lgkmcnt(2)
    v_smfmac_f32_16x16x64_bf16 v[32:35], v[48:51], v[20:27], v1
    v_smfmac_f32_16x16x64_bf16 v[28:31], v[44:47], a[248:255], v1
    s_waitcnt lgkmcnt(0)
    v_smfmac_f32_16x16x64_bf16 v[28:31], v[48:51], v[56:63], v1
    v_add_f32 v36, v36, v38
    v_add_f32 v37, v37, v39
    v_cvt_pk_bf16_f32 v36, v36, v37
    v_add_f32 v40, v40, v42
    v_add_f32 v41, v41, v43
    v_cvt_pk_bf16_f32 v37, v40, v41
    v_add_f32 v52, v52, v54
    v_add_f32 v53, v53, v55
    v_cvt_pk_bf16_f32 v38, v52, v53
    v_add_f32 v32, v32, v34
    v_add_f32 v33, v33, v35
    v_cvt_pk_bf16_f32 v39, v32, v33
    v_and_or_b32 v39, v39, -2, s40
    s_add_u32 s17, s38, 4096
    buffer_store_dwordx4 v[36:39], v0, s[8:11], s17 offen
    v_add_f32 v28, v28, v30
    v_add_f32 v29, v29, v31
    v_cvt_pk_bf16_f32 v28, v28, v29
    v_and_or_b32 v28, v28, -2, s40
    v_lshrrev_b32 v9, 2, v0
    buffer_store_dword v28, v9, s[8:11], s39 offen
    s_xor_b32 s34, s34, 16384
    s_xor_b32 s35, s35, 16384
    s_add_u32 s33, s33, 1
    s_add_u32 s42, s42, 262144
    s_add_u32 s41, s41, 262144
    s_add_u32 s43, s43, 131072
    s_add_u32 s68, s68, 262144
    s_add_u32 s66, s66, 22528
    s_xor_b32 s40, s40, 1
    ds_read_b128 v[56:59], v8 offset:0
    ds_read_b128 v[60:63], v8 offset:1024
    ds_read_b128 v[64:67], v8 offset:2048
    ds_read_b128 v[68:71], v8 offset:3072
    v_mov_b64 v[12:13], 0
    v_mov_b64 v[14:15], 0
    v_mov_b64 v[16:17], 0
    v_mov_b64 v[18:19], 0
    v_mov_b64 v[20:21], 0
    v_mov_b64 v[22:23], 0
    v_mov_b64 v[24:25], 0
    v_mov_b64 v[26:27], 0
    v_mov_b64 v[28:29], 0
    v_mov_b64 v[30:31], 0
    v_mov_b64 v[32:33], 0
    v_mov_b64 v[34:35], 0
    s_sleep 5
    s_nop 9
    buffer_load_dwordx4 v[36:39], v0, s[8:11], s34 offen sc1
    s_nop 15
    s_nop 8
    buffer_load_dwordx4 v[36:39], v0, s[8:11], s34 offen sc1
    s_nop 15
    s_nop 8
    buffer_load_dwordx4 v[36:39], v0, s[8:11], s34 offen sc1
    s_waitcnt lgkmcnt(0)
    s_branch Lr3f_step
Lr3f_pb_re:
    s_mov_b32 s16, 0
Lr3f_pb_lp:
    s_add_u32 s17, s34, 4096
    buffer_load_dwordx4 v[40:43], v0, s[8:11], s17 offen sc1
    s_add_u32 s16, s16, 1
    s_cmp_gt_u32 s16, 100000
    s_cbranch_scc1 Lr_abort
    s_waitcnt vmcnt(0)
    v_max3_u32 v10, v40, v41, v42
    v_max_u32 v10, v10, v43
    v_cmp_eq_u32 vcc, -1, v10
    s_nop 0
    s_cbranch_vccnz Lr3f_pb_lp
    s_branch Lr3f_pb_ok
Lr3f_pc_re:
    s_mov_b32 s16, 0
Lr3f_pc_lp:
    buffer_load_dwordx4 v[44:47], v0, s[8:11], s35 offen sc1
    s_add_u32 s16, s16, 1
    s_cmp_gt_u32 s16, 100000
    s_cbranch_scc1 Lr_abort
    s_waitcnt vmcnt(0)
    v_max3_u32 v10, v44, v45, v46
    v_max_u32 v10, v10, v47
    v_cmp_eq_u32 vcc, -1, v10
    s_nop 0
    s_cbranch_vccnz Lr3f_pc_lp
    s_branch Lr3f_pc_ok
Lr3f_last:
    s_waitcnt vmcnt(0) lgkmcnt(0)
    s_barrier
    s_branch Lr_exit
L_slow:
    s_cmp_lg_u32 s14, 0
    s_cbranch_scc1 L_w1_0
    s_mov_b32 s16, 0
    s_add_u32 s17, s66, 128
    v_lshrrev_b32 v10, 2, v0
    v_and_b32 v9, 16, v10
    v_lshlrev_b32 v9, 3, v9
    v_and_or_b32 v10, v10, 12, v9
Lr0s_fw_15:
    buffer_load_dword v9, v10, s[8:11], s17 offen sc1
    s_add_u32 s16, s16, 1
    s_cmp_gt_u32 s16, 100000
    s_cbranch_scc1 Lr_abort
    s_waitcnt vmcnt(0)
    v_cmp_eq_u32 vcc, 0, v9
    s_nop 0
    s_cbranch_vccnz Lr0s_fw_15
    s_mov_b32 m0, 15104
    s_nop 0
    buffer_load_dwordx4 v0, s[8:11], s41 offen offset:0 lds
    buffer_load_dwordx4 v0, s[8:11], s41 offen offset:1024 lds
    s_add_u32 s41, s41, 262144
    s_add_u32 s68, s68, 4278452224
    s_waitcnt vmcnt(0)
    ds_read_b128 v[56:59], v8 offset:0
    ds_read_b128 v[60:63], v8 offset:1024
    ds_read_b128 v[64:67], v8 offset:2048
    ds_read_b128 v[68:71], v8 offset:3072
    v_mov_b64 v[12:13], 0
    v_mov_b64 v[14:15], 0
    v_mov_b64 v[16:17], 0
    v_mov_b64 v[18:19], 0
    v_mov_b64 v[20:21], 0
    v_mov_b64 v[22:23], 0
    v_mov_b64 v[24:25], 0
    v_mov_b64 v[26:27], 0
    v_mov_b64 v[28:29], 0
    v_mov_b64 v[30:31], 0
    v_mov_b64 v[32:33], 0
    v_mov_b64 v[34:35], 0
    buffer_load_dwordx4 v[36:39], v0, s[8:11], s34 offen sc1
    s_waitcnt vmcnt(0) lgkmcnt(0)
Lr0s_step:
    s_mov_b32 s16, 0
Lr0s_alp:
    s_waitcnt vmcnt(2)
    v_max3_u32 v10, v36, v37, v38
    v_max_u32 v10, v10, v39
    v_cmp_eq_u32 vcc, -1, v10
    s_nop 0
    s_cbranch_vccz Lr0s_aok
    buffer_load_dwordx4 v[36:39], v0, s[8:11], s34 offen sc1
    s_add_u32 s16, s16, 1
    s_cmp_gt_u32 s16, 100000
    s_cbranch_scc1 Lr_abort
    s_branch Lr0s_alp
Lr0s_aok:
    ds_write_b128 v0, v[36:39] offset:6912
    v_smfmac_f32_16x16x64_bf16 v[12:15], v[36:39], v[72:79], v1
    v_smfmac_f32_16x16x64_bf16 v[16:19], v[36:39], v[80:87], v1
    v_smfmac_f32_16x16x64_bf16 v[20:23], v[36:39], v[184:191], v1
    s_waitcnt lgkmcnt(0)
    s_barrier
    ds_read_b128 v[48:51], v0 offset:7936
    ds_read_b128 v[52:55], v0 offset:8960
    v_smfmac_f32_16x16x64_bf16 v[28:31], v[36:39], v[56:63], v1
    ds_read_b128 v[56:59], v8 offset:4096
    ds_read_b128 v[60:63], v8 offset:5120
    s_add_u32 s17, s34, 4096
    buffer_load_dwordx4 v[40:43], v0, s[8:11], s17 offen sc1
    v_smfmac_f32_16x16x64_bf16 v[24:27], v[36:39], v[192:199], v1
    v_smfmac_f32_16x16x64_bf16 v[32:35], v[36:39], v[64:71], v1
    ds_read_b128 v[64:67], v8 offset:6144
    ds_read_b128 v[68:71], v8 offset:7168
    s_waitcnt vmcnt(1)
    ds_read_b128 v[36:39], v0 offset:9984
    s_waitcnt lgkmcnt(6)
    v_smfmac_f32_16x16x64_bf16 v[28:31], v[48:51], a[72:79], v1
    v_smfmac_f32_16x16x64_bf16 v[12:15], v[48:51], v[88:95], v1
    buffer_load_dwordx4 v[44:47], v0, s[8:11], s35 offen sc1
    v_smfmac_f32_16x16x64_bf16 v[16:19], v[48:51], v[96:103], v1
    v_smfmac_f32_16x16x64_bf16 v[32:35], v[48:51], a[80:87], v1
    v_smfmac_f32_16x16x64_bf16 v[20:23], v[48:51], v[200:207], v1
    v_smfmac_f32_16x16x64_bf16 v[24:27], v[48:51], v[208:215], v1
    s_waitcnt lgkmcnt(3)
    v_smfmac_f32_16x16x64_bf16 v[28:31], v[52:55], v[56:63], v1
    ds_read_b128 v[56:59], v8 offset:8192
    ds_read_b128 v[60:63], v8 offset:9216
    v_smfmac_f32_16x16x64_bf16 v[12:15], v[52:55], v[104:111], v1
    v_smfmac_f32_16x16x64_bf16 v[16:19], v[52:55], v[112:119], v1
    s_waitcnt lgkmcnt(3)
    v_smfmac_f32_16x16x64_bf16 v[32:35], v[52:55], v[64:71], v1
    ds_read_b128 v[64:67], v8 offset:10240
    ds_read_b128 v[68:71], v8 offset:11264
    v_smfmac_f32_16x16x64_bf16 v[20:23], v[52:55], v[216:223], v1
    v_smfmac_f32_16x16x64_bf16 v[24:27], v[52:55], v[224:231], v1
    s_waitcnt lgkmcnt(4)
    v_smfmac_f32_16x16x64_bf16 v[28:31], v[36:39], a[88:95], v1
    v_smfmac_f32_16x16x64_bf16 v[12:15], v[36:39], v[120:127], v1
    v_smfmac_f32_16x16x64_bf16 v[16:19], v[36:39], v[128:135], v1
    v_smfmac_f32_16x16x64_bf16 v[32:35], v[36:39], a[96:103], v1
    v_smfmac_f32_16x16x64_bf16 v[20:23], v[36:39], v[232:239], v1
    v_smfmac_f32_16x16x64_bf16 v[24:27], v[36:39], v[240:247], v1
    s_waitcnt vmcnt(1)
    v_max3_u32 v10, v40, v41, v42
    v_max_u32 v10, v10, v43
    v_cmp_eq_u32 vcc, -1, v10
    s_nop 0
    s_cbranch_vccnz Lr0s_pb_re
Lr0s_pb_ok:
    ds_write_b128 v0, v[40:43] offset:11008
    s_waitcnt lgkmcnt(3)
    v_smfmac_f32_16x16x64_bf16 v[12:15], v[40:43], v[56:63], v1
    ds_read_b128 v[56:59], v8 offset:12288
    ds_read_b128 v[60:63], v8 offset:13312
    v_smfmac_f32_16x16x64_bf16 v[20:23], v[40:43], v[248:255], v1
    s_waitcnt lgkmcnt(3)
    v_smfmac_f32_16x16x64_bf16 v[16:19], v[40:43], v[64:71], v1
    ds_read_b128 v[64:67], v8 offset:14336
    ds_read_b128 v[68:71], v8 offset:15360
    v_smfmac_f32_16x16x64_bf16 v[24:27], v[40:43], a[0:7], v1
    s_waitcnt lgkmcnt(4)
    s_barrier
    ds_read_b128 v[48:51], v0 offset:13056
    ds_read_b128 v[52:55], v0 offset:12032
    ds_read_b128 v[36:39], v0 offset:14080
    v_smfmac_f32_16x16x64_bf16 v[28:31], v[40:43], a[104:111], v1
    v_smfmac_f32_16x16x64_bf16 v[32:35], v[40:43], a[112:119], v1
    s_waitcnt lgkmcnt(2)
    v_smfmac_f32_16x16x64_bf16 v[12:15], v[48:51], v[56:63], v1
    v_smfmac_f32_16x16x64_bf16 v[16:19], v[48:51], v[64:71], v1
    s_waitcnt lgkmcnt(1)
    v_smfmac_f32_16x16x64_bf16 v[12:15], v[52:55], v[136:143], v1
    v_smfmac_f32_16x16x64_bf16 v[16:19], v[52:55], v[144:151], v1
    s_waitcnt lgkmcnt(0)
    v_smfmac_f32_16x16x64_bf16 v[12:15], v[36:39], v[152:159], v1
    v_smfmac_f32_16x16x64_bf16 v[16:19], v[36:39], v[160:167], v1
    s_waitcnt vmcnt(0)
    v_max3_u32 v10, v44, v45, v46
    v_max_u32 v10, v10, v47
    v_cmp_eq_u32 vcc, -1, v10
    s_nop 0
    s_cbranch_vccnz Lr0s_pc_re
Lr0s_pc_ok:
    v_smfmac_f32_16x16x64_bf16 v[12:15], v[44:47], v[168:175], v1
    v_smfmac_f32_16x16x64_bf16 v[16:19], v[44:47], v[176:183], v1
    v_smfmac_f32_16x16x64_bf16 v[20:23], v[48:51], a[24:31], v1
    buffer_load_dwordx4 v[64:67], v0, s[8:11], s42 offen
    v_smfmac_f32_16x16x64_bf16 v[24:27], v[48:51], a[32:39], v1
    v_smfmac_f32_16x16x64_bf16 v[20:23], v[52:55], a[8:15], v1
    v_add_f32 v12, v12, v14
    v_smfmac_f32_16x16x64_bf16 v[24:27], v[52:55], a[16:23], v1
    v_add_f32 v16, v16, v18
    v_smfmac_f32_16x16x64_bf16 v[20:23], v[36:39], a[40:47], v1
    v_add_f32 v13, v13, v15
    buffer_load_dwordx4 v[68:71], v0, s[8:11], s42 offen offset:1024
    v_smfmac_f32_16x16x64_bf16 v[24:27], v[36:39], a[48:55], v1
    v_add_f32 v17, v17, v19
    v_smfmac_f32_16x16x64_bf16 v[20:23], v[44:47], a[56:63], v1
    v_cvt_pk_bf16_f32 v14, v12, v16
    ds_read_b128 v[56:59], v0 offset:15104
    v_smfmac_f32_16x16x64_bf16 v[24:27], v[44:47], a[64:71], v1
    v_cvt_pk_bf16_f32 v15, v13, v17
    ds_read_b128 v[60:63], v0 offset:16128
    ds_write_b32 v2, v14 offset:576
    ds_write_b32 v2, v15 offset:864
    v_smfmac_f32_16x16x64_bf16 v[28:31], v[48:51], a[136:143], v1
    v_smfmac_f32_16x16x64_bf16 v[32:35], v[48:51], a[144:151], v1
    v_add_f32 v20, v20, v22
    v_add_f32 v24, v24, v26
    v_add_f32 v21, v21, v23
    v_add_f32 v25, v25, v27
    v_cvt_pk_bf16_f32 v22, v20, v24
    v_cvt_pk_bf16_f32 v23, v21, v25
    ds_write_b32 v2, v22 offset:0
    ds_write_b32 v2, v23 offset:288
    v_smfmac_f32_16x16x64_bf16 v[28:31], v[52:55], a[120:127], v1
    v_smfmac_f32_16x16x64_bf16 v[32:35], v[52:55], a[128:135], v1
    s_waitcnt lgkmcnt(0)
    s_barrier
    ds_read_b128 v[40:43], v3 offset:0
    ds_read_b128 v[48:51], v3 offset:64
    ds_read_b128 v[20:23], v3 offset:128
    ds_read_b128 v[52:55], v3 offset:192
    v_smfmac_f32_16x16x64_bf16 v[28:31], v[36:39], a[152:159], v1
    v_smfmac_f32_16x16x64_bf16 v[32:35], v[36:39], a[160:167], v1
    ds_read_b128 v[36:39], v0 offset:17152
    v_lshlrev_b32 v9, 3, v0
    buffer_load_dword v11, v9, s[8:11], s68 offen
    v_smfmac_f32_16x16x64_bf16 v[28:31], v[44:47], a[168:175], v1
    v_smfmac_f32_16x16x64_bf16 v[32:35], v[44:47], a[176:183], v1
    ds_read_b128 v[44:47], v0 offset:18176
    s_waitcnt lgkmcnt(5)
    v_mfma_f32_16x16x32_bf16 v[12:15], v[56:59], v[40:43], 0
    v_mfma_f32_16x16x32_bf16 v[16:19], v[60:63], v[40:43], 0
    v_mfma_f32_16x16x32_bf16 v[24:27], v[40:43], v[40:43], 0
    ds_read_b128 v[56:59], v0 offset:19200
    ds_read_b128 v[60:63], v0 offset:20224
    s_waitcnt lgkmcnt(3)
    v_mfma_f32_16x16x32_bf16 v[12:15], v[36:39], v[48:51], v[12:15]
    v_lshrrev_b32 v10, 1, v0
    v_lshrrev_b32 v9, 9, v0
    s_waitcnt lgkmcnt(2)
    v_mfma_f32_16x16x32_bf16 v[16:19], v[44:47], v[48:51], v[16:19]
    v_lshl_add_u32 v9, v9, 5, v10
    v_add_f32 v28, v28, v30
    v_mfma_f32_16x16x32_bf16 v[24:27], v[48:51], v[48:51], v[24:27]
    v_add_f32 v32, v32, v34
    v_add_f32 v29, v29, v31
    ds_read_b128 v[36:39], v0 offset:21248
    ds_read_b128 v[44:47], v0 offset:22272
    s_waitcnt lgkmcnt(3)
    v_mfma_f32_16x16x32_bf16 v[12:15], v[56:59], v[20:23], v[12:15]
    v_add_f32 v33, v33, v35
    v_cvt_pk_bf16_f32 v30, v28, v29
    s_waitcnt lgkmcnt(2)
    v_mfma_f32_16x16x32_bf16 v[16:19], v[60:63], v[20:23], v[16:19]
    v_cvt_pk_bf16_f32 v31, v32, v33
    ds_read_b64 v[34:35], v9 offset:0
    v_mfma_f32_16x16x32_bf16 v[24:27], v[20:23], v[20:23], v[24:27]
    s_add_u32 s17, s43, 2048
    buffer_store_dwordx2 v[30:31], v10, s[8:11], s17 offen sc1
    s_waitcnt lgkmcnt(2)
    v_mfma_f32_16x16x32_bf16 v[12:15], v[36:39], v[52:55], v[12:15]
    s_waitcnt lgkmcnt(1)
    v_mfma_f32_16x16x32_bf16 v[16:19], v[44:47], v[52:55], v[16:19]
    v_mfma_f32_16x16x32_bf16 v[24:27], v[52:55], v[52:55], v[24:27]
    s_add_u32 s17, s43, 0
    s_waitcnt lgkmcnt(0)
    buffer_store_dwordx2 v[34:35], v10, s[8:11], s17 offen sc1
    s_cmp_eq_u32 s33, 63
    s_cbranch_scc1 Lr0s_last
    ds_read_b128 v[56:59], v8 offset:16384
    ds_read_b128 v[60:63], v8 offset:17408
    v_mov_b64 v[20:21], s[52:53]
    v_mov_b64 v[22:23], s[52:53]
    v_mov_b32 v41, 0
    v_mov_b32 v42, 0
    v_max3_f32 v9, v12, v13, v14
    v_max3_f32 v9, v9, v15, v16
    v_max3_f32 v9, v9, v17, v18
    v_max3_f32 v9, v9, v19, v24
    v_max_f32 v9, v9, v25
    v_mov_b32 v10, v9
    v_mov_b64 v[32:33], 0
    v_mov_b64 v[34:35], 0
    v_permlane32_swap_b32 v9, v10
    v_max_f32 v9, v9, v10
    v_mov_b32 v10, v9
    s_nop 1
    v_permlane16_swap_b32 v9, v10
    v_max_f32 v9, v9, v10
    v_mul_f32 v28, s44, v9
    v_fma_f32 v12, v12, s44, -v28
    v_fma_f32 v13, v13, s44, -v28
    v_fma_f32 v14, v14, s44, -v28
    v_fma_f32 v15, v15, s44, -v28
    v_exp_f32 v12, v12
    v_exp_f32 v13, v13
    v_fma_f32 v16, v16, s44, -v28
    v_fma_f32 v17, v17, s44, -v28
    v_exp_f32 v14, v14
    v_exp_f32 v15, v15
    v_cvt_pk_bf16_f32 v36, v12, v13
    v_fma_f32 v18, v18, s44, -v28
    v_fma_f32 v19, v19, s44, -v28
    v_exp_f32 v16, v16
    v_exp_f32 v17, v17
    v_cvt_pk_bf16_f32 v37, v14, v15
    v_fma_f32 v24, v24, s44, -v28
    v_fma_f32 v25, v25, s44, -v28
    v_exp_f32 v18, v18
    v_exp_f32 v19, v19
    v_cvt_pk_bf16_f32 v38, v16, v17
    v_exp_f32 v24, v24
    v_exp_f32 v25, v25
    v_cvt_pk_bf16_f32 v39, v18, v19
    v_cvt_pk_bf16_f32 v40, v24, v25
    v_cvt_pk_bf16_f32 v43, v24, v25
    v_mfma_f32_16x16x32_bf16 v[52:55], v[20:23], v[36:39], 0
    v_mov_b64 v[12:13], 0
    v_mov_b64 v[14:15], 0
    s_waitcnt vmcnt(4)
    v_mfma_f32_16x16x32_bf16 v[44:47], v[64:67], v[36:39], 0
    v_mov_b64 v[24:25], 0
    v_mov_b64 v[26:27], 0
    s_waitcnt vmcnt(3)
    v_mfma_f32_16x16x32_bf16 v[48:51], v[68:71], v[36:39], 0
    ds_read_b128 v[64:67], v8 offset:20480
    ds_read_b128 v[68:71], v8 offset:21504
    v_mfma_f32_16x16x16_bf16 v[52:55], v[20:21], v[40:41], v[52:55]
    v_mfma_f32_16x16x16_bf16 v[44:47], v[30:31], v[40:41], v[44:47]
    v_mov_b64 v[20:21], 0
    v_mov_b64 v[22:23], 0
    v_mfma_f32_16x16x16_bf16 v[48:51], v[30:31], v[42:43], v[48:51]
    v_mov_b64 v[36:37], 0
    v_mov_b64 v[38:39], 0
    v_mov_b64 v[40:41], 0
    v_mov_b64 v[42:43], 0
    v_rcp_f32 v9, v52
    v_mov_b64 v[52:53], 0
    v_mov_b64 v[54:55], 0
    v_mul_f32 v44, v9, v44
    v_mul_f32 v48, v9, v48
    v_cvt_pk_bf16_f32 v16, v44, v48
    v_mul_f32 v45, v9, v45
    v_mul_f32 v49, v9, v49
    v_cvt_pk_bf16_f32 v17, v45, v49
    v_mul_f32 v46, v9, v46
    v_mul_f32 v50, v9, v50
    v_cvt_pk_bf16_f32 v18, v46, v50
    v_mul_f32 v47, v9, v47
    v_mul_f32 v51, v9, v51
    v_cvt_pk_bf16_f32 v19, v47, v51
    ds_write_b128 v5, v[16:19]
    v_mov_b64 v[28:29], 0
    v_mov_b64 v[30:31], 0
    s_waitcnt lgkmcnt(0)
    s_barrier
    ds_read_b128 v[44:47], v4 offset:0
    ds_read_b128 v[48:51], v4 offset:128
    v_mov_b64 v[16:17], 0
    v_mov_b64 v[18:19], 0
    buffer_load_dwordx4 v0, s[8:11], s41 offen offset:0 lds
    buffer_load_dwordx4 v0, s[8:11], s41 offen offset:1024 lds
    s_waitcnt lgkmcnt(1)
    v_smfmac_f32_16x16x64_bf16 v[12:15], v[44:47], a[184:191], v1
    s_waitcnt lgkmcnt(0)
    v_smfmac_f32_16x16x64_bf16 v[12:15], v[48:51], a[192:199], v1
    v_smfmac_f32_16x16x64_bf16 v[24:27], v[44:47], a[200:207], v1
    v_smfmac_f32_16x16x64_bf16 v[24:27], v[48:51], a[208:215], v1
    v_add_f32 v12, v12, v14
    v_smfmac_f32_16x16x64_bf16 v[20:23], v[44:47], a[216:223], v1
    v_add_f32 v13, v13, v15
    v_smfmac_f32_16x16x64_bf16 v[20:23], v[48:51], a[224:231], v1
    v_cvt_pk_bf16_f32 v12, v12, v13
    v_smfmac_f32_16x16x64_bf16 v[16:19], v[44:47], a[232:239], v1
    v_add_f32 v24, v24, v26
    v_smfmac_f32_16x16x64_bf16 v[16:19], v[48:51], a[240:247], v1
    v_add_f32 v25, v25, v27
    v_smfmac_f32_16x16x64_bf16 v[36:39], v[44:47], v[56:63], v1
    v_cvt_pk_bf16_f32 v13, v24, v25
    v_smfmac_f32_16x16x64_bf16 v[36:39], v[48:51], v[64:71], v1
    v_add_f32 v20, v20, v22
    v_add_f32 v21, v21, v23
    v_cvt_pk_bf16_f32 v14, v20, v21
    v_add_f32 v16, v16, v18
    v_add_f32 v17, v17, v19
    v_cvt_pk_bf16_f32 v15, v16, v17
    v_and_or_b32 v15, v15, -2, s40
    buffer_store_dwordx4 v[12:15], v0, s[8:11], s38 offen sc1
    s_nop 0
    ds_read_b128 v[12:15], v8 offset:18432
    ds_read_b128 v[16:19], v8 offset:19456
    ds_read_b128 v[20:23], v8 offset:22528
    ds_read_b128 v[24:27], v8 offset:23552
    ds_read_b128 v[56:59], v8 offset:24576
    ds_read_b128 v[60:63], v8 offset:25600
    ds_read_b128 v[64:67], v8 offset:28672
    ds_read_b128 v[68:71], v8 offset:29696
    s_waitcnt lgkmcnt(6)
    v_smfmac_f32_16x16x64_bf16 v[40:43], v[44:47], v[12:19], v1
    ds_read_b128 v[12:15], v8 offset:26624
    ds_read_b128 v[16:19], v8 offset:27648
    s_waitcnt lgkmcnt(6)
    v_smfmac_f32_16x16x64_bf16 v[40:43], v[48:51], v[20:27], v1
    ds_read_b128 v[20:23], v8 offset:30720
    ds_read_b128 v[24:27], v8 offset:31744
    s_waitcnt lgkmcnt(6)
    v_smfmac_f32_16x16x64_bf16 v[52:55], v[44:47], v[56:63], v1
    ds_read_b128 v[56:59], v8 offset:32768
    ds_read_b128 v[60:63], v8 offset:33792
    s_waitcnt lgkmcnt(6)
    v_smfmac_f32_16x16x64_bf16 v[52:55], v[48:51], v[64:71], v1
    s_waitcnt lgkmcnt(4)
    v_smfmac_f32_16x16x64_bf16 v[32:35], v[44:47], v[12:19], v1
    s_waitcnt lgkmcnt(2)
    v_smfmac_f32_16x16x64_bf16 v[32:35], v[48:51], v[20:27], v1
    v_smfmac_f32_16x16x64_bf16 v[28:31], v[44:47], a[248:255], v1
    s_waitcnt lgkmcnt(0)
    v_smfmac_f32_16x16x64_bf16 v[28:31], v[48:51], v[56:63], v1
    buffer_load_dwordx4 v[12:15], v6, s[8:11], s62 offen sc1
    buffer_load_dwordx4 v[16:19], v6, s[8:11], s63 offen sc1
    buffer_load_dwordx4 v[20:23], v6, s[8:11], s64 offen sc1
    buffer_load_dwordx4 v[24:27], v6, s[8:11], s65 offen sc1
    v_add_f32 v36, v36, v38
    v_add_f32 v37, v37, v39
    v_cvt_pk_bf16_f32 v36, v36, v37
    v_add_f32 v40, v40, v42
    v_add_f32 v41, v41, v43
    v_cvt_pk_bf16_f32 v37, v40, v41
    v_add_f32 v52, v52, v54
    v_add_f32 v53, v53, v55
    v_cvt_pk_bf16_f32 v38, v52, v53
    v_add_f32 v32, v32, v34
    v_add_f32 v33, v33, v35
    v_cvt_pk_bf16_f32 v39, v32, v33
    v_and_or_b32 v39, v39, -2, s40
    s_add_u32 s17, s38, 4096
    buffer_store_dwordx4 v[36:39], v0, s[8:11], s17 offen sc1
    v_add_f32 v28, v28, v30
    v_add_f32 v29, v29, v31
    v_cvt_pk_bf16_f32 v28, v28, v29
    v_and_or_b32 v28, v28, -2, s40
    v_lshrrev_b32 v9, 2, v0
    buffer_store_dword v28, v9, s[8:11], s39 offen sc1
    v_add_u32 v10, 162560, v0
    ds_read_b128 v[64:67], v10
    s_nop 9
    buffer_load_dwordx4 v[40:43], v6, s[8:11], s62 offen sc1
    buffer_load_dwordx4 v[44:47], v6, s[8:11], s63 offen sc1
    buffer_load_dwordx4 v[48:51], v6, s[8:11], s64 offen sc1
    buffer_load_dwordx4 v[52:55], v6, s[8:11], s65 offen sc1
    s_add_u32 s33, s33, 1
    s_add_u32 s42, s42, 262144
    s_add_u32 s41, s41, 262144
    s_add_u32 s43, s43, 131072
    s_add_u32 s68, s68, 262144
    s_add_u32 s66, s66, 22528
    ds_read_b128 v[56:59], v8 offset:0
    ds_read_b128 v[60:63], v8 offset:1024
    s_waitcnt lgkmcnt(2)
    s_waitcnt vmcnt(9)
    v_mfma_f32_16x16x32_bf16 v[68:71], v[12:15], v[64:67], 0
    v_and_b32 v10, 1, v15
    v_cmp_ne_u32 s[54:55], s40, v10
    s_waitcnt vmcnt(8)
    v_mfma_f32_16x16x32_bf16 v[68:71], v[16:19], v[64:67], v[68:71]
    v_and_b32 v10, 1, v19
    v_cmp_ne_u32 s[56:57], s40, v10
    s_waitcnt vmcnt(7)
    v_mfma_f32_16x16x32_bf16 v[68:71], v[20:23], v[64:67], v[68:71]
    v_and_b32 v10, 1, v23
    v_cmp_ne_u32 s[58:59], s40, v10
    s_waitcnt vmcnt(6)
    v_mfma_f32_16x16x32_bf16 v[68:71], v[24:27], v[64:67], v[68:71]
    v_and_b32 v10, 1, v27
    v_cmp_ne_u32 s[60:61], s40, v10
    s_or_b64 vcc, s[54:55], s[56:57]
    s_or_b64 vcc, vcc, s[58:59]
    s_or_b64 vcc, vcc, s[60:61]
    s_cbranch_scc0 Lr0s_red
    s_mov_b32 s16, 0
Lr0s_p1:
    buffer_load_dwordx4 v[12:15], v6, s[8:11], s62 offen sc1
    buffer_load_dwordx4 v[16:19], v6, s[8:11], s63 offen sc1
    buffer_load_dwordx4 v[20:23], v6, s[8:11], s64 offen sc1
    buffer_load_dwordx4 v[24:27], v6, s[8:11], s65 offen sc1
    s_waitcnt vmcnt(7)
    v_mfma_f32_16x16x32_bf16 v[68:71], v[40:43], v[64:67], 0
    v_and_b32 v10, 1, v43
    v_cmp_ne_u32 s[54:55], s40, v10
    s_waitcnt vmcnt(6)
    v_mfma_f32_16x16x32_bf16 v[68:71], v[44:47], v[64:67], v[68:71]
    v_and_b32 v10, 1, v47
    v_cmp_ne_u32 s[56:57], s40, v10
    s_waitcnt vmcnt(5)
    v_mfma_f32_16x16x32_bf16 v[68:71], v[48:51], v[64:67], v[68:71]
    v_and_b32 v10, 1, v51
    v_cmp_ne_u32 s[58:59], s40, v10
    s_waitcnt vmcnt(4)
    v_mfma_f32_16x16x32_bf16 v[68:71], v[52:55], v[64:67], v[68:71]
    v_and_b32 v10, 1, v55
    v_cmp_ne_u32 s[60:61], s40, v10
    s_or_b64 vcc, s[54:55], s[56:57]
    s_or_b64 vcc, vcc, s[58:59]
    s_or_b64 vcc, vcc, s[60:61]
    s_cbranch_scc0 Lr0s_red
    buffer_load_dwordx4 v[40:43], v6, s[8:11], s62 offen sc1
    buffer_load_dwordx4 v[44:47], v6, s[8:11], s63 offen sc1
    buffer_load_dwordx4 v[48:51], v6, s[8:11], s64 offen sc1
    buffer_load_dwordx4 v[52:55], v6, s[8:11], s65 offen sc1
    s_add_u32 s16, s16, 1
    s_cmp_gt_u32 s16, 100000
    s_cbranch_scc1 Lr_abort
    s_waitcnt vmcnt(7)
    v_mfma_f32_16x16x32_bf16 v[68:71], v[12:15], v[64:67], 0
    v_and_b32 v10, 1, v15
    v_cmp_ne_u32 s[54:55], s40, v10
    s_waitcnt vmcnt(6)
    v_mfma_f32_16x16x32_bf16 v[68:71], v[16:19], v[64:67], v[68:71]
    v_and_b32 v10, 1, v19
    v_cmp_ne_u32 s[56:57], s40, v10
    s_waitcnt vmcnt(5)
    v_mfma_f32_16x16x32_bf16 v[68:71], v[20:23], v[64:67], v[68:71]
    v_and_b32 v10, 1, v23
    v_cmp_ne_u32 s[58:59], s40, v10
    s_waitcnt vmcnt(4)
    v_mfma_f32_16x16x32_bf16 v[68:71], v[24:27], v[64:67], v[68:71]
    v_and_b32 v10, 1, v27
    v_cmp_ne_u32 s[60:61], s40, v10
    s_or_b64 vcc, s[54:55], s[56:57]
    s_or_b64 vcc, vcc, s[58:59]
    s_or_b64 vcc, vcc, s[60:61]
    s_cbranch_scc1 Lr0s_p1
Lr0s_red:
    s_nop 1
    v_permlane16_swap_b32 v68, v70
    v_permlane16_swap_b32 v69, v71
    s_mov_b64 exec, s[46:47]
    v_add_f32 v68, v68, v70
    v_add_f32 v69, v69, v71
    v_cvt_pk_bf16_f32 v68, v68, v69
    v_min_u32 v68, s50, v68
    buffer_store_dword v68, v7, s[8:11], s36 offen sc1
    v_mov_b32 v69, -1
    buffer_store_dword v69, v7, s[8:11], s37 offen sc1
    s_mov_b64 exec, -1
    s_xor_b32 s34, s34, 16384
    s_xor_b32 s35, s35, 16384
    s_xor_b32 s40, s40, 1
    s_xor_b32 s36, s36, 16384
    s_xor_b32 s37, s37, 16384
    s_nop 15
    s_nop 3
    buffer_load_dwordx4 v[36:39], v0, s[8:11], s34 offen sc1
    s_waitcnt vmcnt(3)
    ds_read_b128 v[64:67], v8 offset:2048
    ds_read_b128 v[68:71], v8 offset:3072
    v_mov_b64 v[12:13], 0
    v_mov_b64 v[14:15], 0
    v_mov_b64 v[16:17], 0
    v_mov_b64 v[18:19], 0
    v_mov_b64 v[20:21], 0
    v_mov_b64 v[22:23], 0
    v_mov_b64 v[24:25], 0
    v_mov_b64 v[26:27], 0
    v_mov_b64 v[28:29], 0
    v_mov_b64 v[30:31], 0
    v_mov_b64 v[32:33], 0
    v_mov_b64 v[34:35], 0
    s_nop 9
    buffer_load_dwordx4 v[36:39], v0, s[8:11], s34 offen sc1
    s_nop 15
    s_nop 8
    buffer_load_dwordx4 v[36:39], v0, s[8:11], s34 offen sc1
    s_waitcnt lgkmcnt(0)
    s_branch Lr0s_step
Lr0s_pb_re:
    s_mov_b32 s16, 0
Lr0s_pb_lp:
    s_add_u32 s17, s34, 4096
    buffer_load_dwordx4 v[40:43], v0, s[8:11], s17 offen sc1
    s_add_u32 s16, s16, 1
    s_cmp_gt_u32 s16, 100000
    s_cbranch_scc1 Lr_abort
    s_waitcnt vmcnt(0)
    v_max3_u32 v10, v40, v41, v42
    v_max_u32 v10, v10, v43
    v_cmp_eq_u32 vcc, -1, v10
    s_nop 0
    s_cbranch_vccnz Lr0s_pb_lp
    s_branch Lr0s_pb_ok
Lr0s_pc_re:
    s_mov_b32 s16, 0
Lr0s_pc_lp:
    buffer_load_dwordx4 v[44:47], v0, s[8:11], s35 offen sc1
    s_add_u32 s16, s16, 1
    s_cmp_gt_u32 s16, 100000
    s_cbranch_scc1 Lr_abort
    s_waitcnt vmcnt(0)
    v_max3_u32 v10, v44, v45, v46
    v_max_u32 v10, v10, v47
    v_cmp_eq_u32 vcc, -1, v10
    s_nop 0
    s_cbranch_vccnz Lr0s_pc_lp
    s_branch Lr0s_pc_ok
Lr0s_last:
    s_waitcnt vmcnt(0) lgkmcnt(0)
    s_barrier
    s_branch Lr_exit
L_w1_0:
    s_cmp_lg_u32 s14, 1
    s_cbranch_scc1 L_w2_0
    s_mov_b32 s16, 0
    s_add_u32 s17, s66, 128
    v_lshrrev_b32 v10, 2, v0
    v_and_b32 v9, 16, v10
    v_lshlrev_b32 v9, 3, v9
    v_and_or_b32 v10, v10, 12, v9
Lr1s_fw_16:
    buffer_load_dword v9, v10, s[8:11], s17 offen sc1
    s_add_u32 s16, s16, 1
    s_cmp_gt_u32 s16, 100000
    s_cbranch_scc1 Lr_abort
    s_waitcnt vmcnt(0)
    v_cmp_eq_u32 vcc, 0, v9
    s_nop 0
    s_cbranch_vccnz Lr1s_fw_16
    s_lshl_b32 s67, s32, 5
    s_add_u32 s67, s67, s15
    s_lshl_b32 s67, s67, 12
    s_add_u32 s67, s67, 3145728
    s_mov_b32 m0, 17152
    s_nop 0
    buffer_load_dwordx4 v0, s[8:11], s41 offen offset:0 lds
    buffer_load_dwordx4 v0, s[8:11], s41 offen offset:1024 lds
    s_add_u32 s41, s41, 262144
    s_add_u32 s68, s68, 262144
    s_waitcnt vmcnt(0)
    ds_read_b128 v[56:59], v8 offset:4096
    ds_read_b128 v[60:63], v8 offset:5120
    ds_read_b128 v[64:67], v8 offset:6144
    ds_read_b128 v[68:71], v8 offset:7168
    v_mov_b64 v[12:13], 0
    v_mov_b64 v[14:15], 0
    v_mov_b64 v[16:17], 0
    v_mov_b64 v[18:19], 0
    v_mov_b64 v[20:21], 0
    v_mov_b64 v[22:23], 0
    v_mov_b64 v[24:25], 0
    v_mov_b64 v[26:27], 0
    v_mov_b64 v[28:29], 0
    v_mov_b64 v[30:31], 0
    v_mov_b64 v[32:33], 0
    v_mov_b64 v[34:35], 0
    buffer_load_dwordx4 v[36:39], v0, s[8:11], s34 offen sc1
    s_waitcnt vmcnt(0) lgkmcnt(0)
Lr1s_step:
    s_waitcnt vmcnt(3)
    v_max3_u32 v10, v36, v37, v38
    v_max_u32 v10, v10, v39
    v_cmp_eq_u32 vcc, -1, v10
    s_nop 0
    s_cbranch_vccz Lr1s_aok
    buffer_load_dwordx4 v[36:39], v0, s[8:11], s34 offen sc1
    s_nop 15
    s_nop 8
    buffer_load_dwordx4 v[36:39], v0, s[8:11], s34 offen sc1
    s_mov_b32 s16, 0
Lr1s_alp:
    s_waitcnt vmcnt(2)
    v_max3_u32 v10, v36, v37, v38
    v_max_u32 v10, v10, v39
    v_cmp_eq_u32 vcc, -1, v10
    s_nop 0
    s_cbranch_vccz Lr1s_aok
    buffer_load_dwordx4 v[36:39], v0, s[8:11], s34 offen sc1
    s_add_u32 s16, s16, 1
    s_cmp_gt_u32 s16, 100000
    s_cbranch_scc1 Lr_abort
    s_branch Lr1s_alp
Lr1s_aok:
    ds_write_b128 v0, v[36:39] offset:7936
    v_smfmac_f32_16x16x64_bf16 v[12:15], v[36:39], v[88:95], v1
    v_smfmac_f32_16x16x64_bf16 v[16:19], v[36:39], v[96:103], v1
    v_smfmac_f32_16x16x64_bf16 v[20:23], v[36:39], v[200:207], v1
    s_waitcnt lgkmcnt(0)
    s_barrier
    ds_read_b128 v[48:51], v0 offset:8960
    ds_read_b128 v[52:55], v0 offset:9984
    v_smfmac_f32_16x16x64_bf16 v[28:31], v[36:39], a[72:79], v1
    v_smfmac_f32_16x16x64_bf16 v[24:27], v[36:39], v[208:215], v1
    s_add_u32 s17, s34, 4096
    buffer_load_dwordx4 v[40:43], v0, s[8:11], s17 offen sc1
    v_smfmac_f32_16x16x64_bf16 v[32:35], v[36:39], a[80:87], v1
    s_waitcnt vmcnt(1)
    ds_read_b128 v[36:39], v0 offset:6912
    s_waitcnt lgkmcnt(2)
    v_smfmac_f32_16x16x64_bf16 v[28:31], v[48:51], v[56:63], v1
    ds_read_b128 v[56:59], v8 offset:0
    ds_read_b128 v[60:63], v8 offset:1024
    v_smfmac_f32_16x16x64_bf16 v[12:15], v[48:51], v[104:111], v1
    v_smfmac_f32_16x16x64_bf16 v[16:19], v[48:51], v[112:119], v1
    buffer_load_dwordx4 v[44:47], v0, s[8:11], s35 offen sc1
    v_smfmac_f32_16x16x64_bf16 v[32:35], v[48:51], v[64:71], v1
    ds_read_b128 v[64:67], v8 offset:2048
    ds_read_b128 v[68:71], v8 offset:3072
    v_smfmac_f32_16x16x64_bf16 v[20:23], v[48:51], v[216:223], v1
    v_smfmac_f32_16x16x64_bf16 v[24:27], v[48:51], v[224:231], v1
    s_waitcnt lgkmcnt(5)
    v_smfmac_f32_16x16x64_bf16 v[28:31], v[52:55], a[88:95], v1
    v_smfmac_f32_16x16x64_bf16 v[12:15], v[52:55], v[120:127], v1
    v_smfmac_f32_16x16x64_bf16 v[16:19], v[52:55], v[128:135], v1
    v_smfmac_f32_16x16x64_bf16 v[32:35], v[52:55], a[96:103], v1
    v_smfmac_f32_16x16x64_bf16 v[20:23], v[52:55], v[232:239], v1
    v_smfmac_f32_16x16x64_bf16 v[24:27], v[52:55], v[240:247], v1
    s_waitcnt lgkmcnt(2)
    v_smfmac_f32_16x16x64_bf16 v[28:31], v[36:39], v[56:63], v1
    ds_read_b128 v[56:59], v8 offset:12288
    ds_read_b128 v[60:63], v8 offset:13312
    v_smfmac_f32_16x16x64_bf16 v[12:15], v[36:39], v[72:79], v1
    v_smfmac_f32_16x16x64_bf16 v[16:19], v[36:39], v[80:87], v1
    s_waitcnt lgkmcnt(2)
    v_smfmac_f32_16x16x64_bf16 v[32:35], v[36:39], v[64:71], v1
    ds_read_b128 v[64:67], v8 offset:14336
    ds_read_b128 v[68:71], v8 offset:15360
    v_smfmac_f32_16x16x64_bf16 v[20:23], v[36:39], v[184:191], v1
    v_smfmac_f32_16x16x64_bf16 v[24:27], v[36:39], v[192:199], v1
    s_waitcnt vmcnt(1)
    v_max3_u32 v10, v40, v41, v42
    v_max_u32 v10, v10, v43
    v_cmp_eq_u32 vcc, -1, v10
    s_nop 0
    s_cbranch_vccnz Lr1s_pb_re
Lr1s_pb_ok:
    ds_write_b128 v0, v[40:43] offset:12032
    v_mov_b32 v9, 1
    v_mov_b32 v10, 0
    s_mov_b64 exec, 1
    buffer_store_dword v9, v10, s[8:11], s67 offen offset:384 sc1
    s_mov_b64 exec, -1
    v_smfmac_f32_16x16x64_bf16 v[12:15], v[40:43], v[136:143], v1
    v_smfmac_f32_16x16x64_bf16 v[20:23], v[40:43], a[8:15], v1
    v_smfmac_f32_16x16x64_bf16 v[16:19], v[40:43], v[144:151], v1
    v_smfmac_f32_16x16x64_bf16 v[24:27], v[40:43], a[16:23], v1
    s_waitcnt lgkmcnt(0)
    s_barrier
    ds_read_b128 v[48:51], v0 offset:13056
    ds_read_b128 v[52:55], v0 offset:14080
    ds_read_b128 v[36:39], v0 offset:11008
    v_smfmac_f32_16x16x64_bf16 v[28:31], v[40:43], a[120:127], v1
    v_smfmac_f32_16x16x64_bf16 v[32:35], v[40:43], a[128:135], v1
    s_waitcnt lgkmcnt(2)
    v_smfmac_f32_16x16x64_bf16 v[12:15], v[48:51], v[56:63], v1
    ds_read_b128 v[56:59], v8 offset:8192
    ds_read_b128 v[60:63], v8 offset:9216
    v_smfmac_f32_16x16x64_bf16 v[16:19], v[48:51], v[64:71], v1
    ds_read_b128 v[64:67], v8 offset:10240
    ds_read_b128 v[68:71], v8 offset:11264
    s_waitcnt lgkmcnt(5)
    v_smfmac_f32_16x16x64_bf16 v[12:15], v[52:55], v[152:159], v1
    v_smfmac_f32_16x16x64_bf16 v[16:19], v[52:55], v[160:167], v1
    s_waitcnt vmcnt(1)
    v_max3_u32 v10, v44, v45, v46
    v_max_u32 v10, v10, v47
    v_cmp_eq_u32 vcc, -1, v10
    s_nop 0
    s_cbranch_vccnz Lr1s_pc_re
Lr1s_pc_ok:
    v_smfmac_f32_16x16x64_bf16 v[12:15], v[44:47], v[168:175], v1
    v_smfmac_f32_16x16x64_bf16 v[16:19], v[44:47], v[176:183], v1
    s_waitcnt lgkmcnt(2)
    v_smfmac_f32_16x16x64_bf16 v[12:15], v[36:39], v[56:63], v1
    s_waitcnt lgkmcnt(0)
    v_smfmac_f32_16x16x64_bf16 v[16:19], v[36:39], v[64:71], v1
    v_smfmac_f32_16x16x64_bf16 v[20:23], v[48:51], a[24:31], v1
    v_smfmac_f32_16x16x64_bf16 v[24:27], v[48:51], a[32:39], v1
    buffer_load_dwordx4 v[64:67], v0, s[8:11], s42 offen
    v_smfmac_f32_16x16x64_bf16 v[20:23], v[52:55], a[40:47], v1
    v_add_f32 v12, v12, v14
    v_smfmac_f32_16x16x64_bf16 v[24:27], v[52:55], a[48:55], v1
    v_add_f32 v16, v16, v18
    v_smfmac_f32_16x16x64_bf16 v[20:23], v[36:39], v[248:255], v1
    v_add_f32 v13, v13, v15
    v_smfmac_f32_16x16x64_bf16 v[24:27], v[36:39], a[0:7], v1
    v_add_f32 v17, v17, v19
    buffer_load_dwordx4 v[68:71], v0, s[8:11], s42 offen offset:1024
    v_smfmac_f32_16x16x64_bf16 v[20:23], v[44:47], a[56:63], v1
    v_cvt_pk_bf16_f32 v14, v12, v16
    ds_read_b128 v[56:59], v0 offset:15104
    v_smfmac_f32_16x16x64_bf16 v[24:27], v[44:47], a[64:71], v1
    v_cvt_pk_bf16_f32 v15, v13, v17
    ds_read_b128 v[60:63], v0 offset:16128
    ds_write_b32 v2, v14 offset:576
    ds_write_b32 v2, v15 offset:864
    v_smfmac_f32_16x16x64_bf16 v[28:31], v[48:51], a[136:143], v1
    v_smfmac_f32_16x16x64_bf16 v[32:35], v[48:51], a[144:151], v1
    v_add_f32 v20, v20, v22
    v_add_f32 v24, v24, v26
    v_add_f32 v21, v21, v23
    v_add_f32 v25, v25, v27
    v_cvt_pk_bf16_f32 v22, v20, v24
    v_cvt_pk_bf16_f32 v23, v21, v25
    ds_write_b32 v2, v22 offset:0
    ds_write_b32 v2, v23 offset:288
    v_smfmac_f32_16x16x64_bf16 v[28:31], v[52:55], a[152:159], v1
    v_smfmac_f32_16x16x64_bf16 v[32:35], v[52:55], a[160:167], v1
    s_waitcnt lgkmcnt(0)
    s_barrier
    ds_read_b128 v[40:43], v3 offset:0
    ds_read_b128 v[48:51], v3 offset:64
    ds_read_b128 v[20:23], v3 offset:128
    ds_read_b128 v[52:55], v3 offset:192
    v_smfmac_f32_16x16x64_bf16 v[28:31], v[36:39], a[104:111], v1
    v_smfmac_f32_16x16x64_bf16 v[32:35], v[36:39], a[112:119], v1
    ds_read_b128 v[36:39], v0 offset:17152
    v_smfmac_f32_16x16x64_bf16 v[28:31], v[44:47], a[168:175], v1
    v_smfmac_f32_16x16x64_bf16 v[32:35], v[44:47], a[176:183], v1
    ds_read_b128 v[44:47], v0 offset:18176
    s_waitcnt lgkmcnt(5)
    v_mfma_f32_16x16x32_bf16 v[12:15], v[56:59], v[40:43], 0
    v_mfma_f32_16x16x32_bf16 v[16:19], v[60:63], v[40:43], 0
    v_mfma_f32_16x16x32_bf16 v[24:27], v[40:43], v[40:43], 0
    ds_read_b128 v[56:59], v0 offset:19200
    ds_read_b128 v[60:63], v0 offset:20224
    s_waitcnt lgkmcnt(3)
    v_mfma_f32_16x16x32_bf16 v[12:15], v[36:39], v[48:51], v[12:15]
    v_lshrrev_b32 v10, 1, v0
    v_lshrrev_b32 v9, 9, v0
    s_waitcnt lgkmcnt(2)
    v_mfma_f32_16x16x32_bf16 v[16:19], v[44:47], v[48:51], v[16:19]
    v_lshl_add_u32 v9, v9, 5, v10
    v_add_f32 v28, v28, v30
    v_mfma_f32_16x16x32_bf16 v[24:27], v[48:51], v[48:51], v[24:27]
    v_add_f32 v32, v32, v34
    v_add_f32 v29, v29, v31
    ds_read_b128 v[36:39], v0 offset:21248
    ds_read_b128 v[44:47], v0 offset:22272
    s_waitcnt lgkmcnt(3)
    v_mfma_f32_16x16x32_bf16 v[12:15], v[56:59], v[20:23], v[12:15]
    v_add_f32 v33, v33, v35
    v_cvt_pk_bf16_f32 v30, v28, v29
    s_waitcnt lgkmcnt(2)
    v_mfma_f32_16x16x32_bf16 v[16:19], v[60:63], v[20:23], v[16:19]
    v_cvt_pk_bf16_f32 v31, v32, v33
    ds_read_b64 v[34:35], v9 offset:1152
    v_mfma_f32_16x16x32_bf16 v[24:27], v[20:23], v[20:23], v[24:27]
    s_add_u32 s17, s43, 2560
    buffer_store_dwordx2 v[30:31], v10, s[8:11], s17 offen sc1
    s_waitcnt lgkmcnt(2)
    v_mfma_f32_16x16x32_bf16 v[12:15], v[36:39], v[52:55], v[12:15]
    s_waitcnt lgkmcnt(1)
    v_mfma_f32_16x16x32_bf16 v[16:19], v[44:47], v[52:55], v[16:19]
    v_mfma_f32_16x16x32_bf16 v[24:27], v[52:55], v[52:55], v[24:27]
    s_add_u32 s17, s43, 512
    s_waitcnt lgkmcnt(0)
    buffer_store_dwordx2 v[34:35], v10, s[8:11], s17 offen sc1
    s_cmp_eq_u32 s33, 63
    s_cbranch_scc1 Lr1s_last
    ds_read_b128 v[56:59], v8 offset:16384
    ds_read_b128 v[60:63], v8 offset:17408
    v_mov_b64 v[20:21], s[52:53]
    v_mov_b64 v[22:23], s[52:53]
    v_mov_b32 v41, 0
    v_mov_b32 v42, 0
    v_max3_f32 v9, v12, v13, v14
    v_max3_f32 v9, v9, v15, v16
    v_max3_f32 v9, v9, v17, v18
    v_max3_f32 v9, v9, v19, v24
    v_max_f32 v9, v9, v25
    v_mov_b32 v10, v9
    v_mov_b64 v[32:33], 0
    v_mov_b64 v[34:35], 0
    v_permlane32_swap_b32 v9, v10
    v_max_f32 v9, v9, v10
    v_mov_b32 v10, v9
    s_nop 1
    v_permlane16_swap_b32 v9, v10
    v_max_f32 v9, v9, v10
    v_mul_f32 v28, s44, v9
    v_fma_f32 v12, v12, s44, -v28
    v_fma_f32 v13, v13, s44, -v28
    v_fma_f32 v14, v14, s44, -v28
    v_fma_f32 v15, v15, s44, -v28
    v_exp_f32 v12, v12
    v_exp_f32 v13, v13
    v_fma_f32 v16, v16, s44, -v28
    v_fma_f32 v17, v17, s44, -v28
    v_exp_f32 v14, v14
    v_exp_f32 v15, v15
    v_cvt_pk_bf16_f32 v36, v12, v13
    v_fma_f32 v18, v18, s44, -v28
    v_fma_f32 v19, v19, s44, -v28
    v_exp_f32 v16, v16
    v_exp_f32 v17, v17
    v_cvt_pk_bf16_f32 v37, v14, v15
    v_fma_f32 v24, v24, s44, -v28
    v_fma_f32 v25, v25, s44, -v28
    v_exp_f32 v18, v18
    v_exp_f32 v19, v19
    v_cvt_pk_bf16_f32 v38, v16, v17
    v_exp_f32 v24, v24
    v_exp_f32 v25, v25
    v_cvt_pk_bf16_f32 v39, v18, v19
    v_cvt_pk_bf16_f32 v40, v24, v25
    v_cvt_pk_bf16_f32 v43, v24, v25
    v_mfma_f32_16x16x32_bf16 v[52:55], v[20:23], v[36:39], 0
    v_mov_b64 v[12:13], 0
    v_mov_b64 v[14:15], 0
    s_waitcnt vmcnt(3)
    v_mfma_f32_16x16x32_bf16 v[44:47], v[64:67], v[36:39], 0
    v_mov_b64 v[24:25], 0
    v_mov_b64 v[26:27], 0
    s_waitcnt vmcnt(2)
    v_mfma_f32_16x16x32_bf16 v[48:51], v[68:71], v[36:39], 0
    ds_read_b128 v[64:67], v8 offset:20480
    ds_read_b128 v[68:71], v8 offset:21504
    v_mfma_f32_16x16x16_bf16 v[52:55], v[20:21], v[40:41], v[52:55]
    v_mfma_f32_16x16x16_bf16 v[44:47], v[30:31], v[40:41], v[44:47]
    v_mov_b64 v[20:21], 0
    v_mov_b64 v[22:23], 0
    v_mfma_f32_16x16x16_bf16 v[48:51], v[30:31], v[42:43], v[48:51]
    v_mov_b64 v[36:37], 0
    v_mov_b64 v[38:39], 0
    v_mov_b64 v[40:41], 0
    v_mov_b64 v[42:43], 0
    v_rcp_f32 v9, v52
    v_mov_b64 v[52:53], 0
    v_mov_b64 v[54:55], 0
    v_mul_f32 v44, v9, v44
    v_mul_f32 v48, v9, v48
    v_cvt_pk_bf16_f32 v16, v44, v48
    v_mul_f32 v45, v9, v45
    v_mul_f32 v49, v9, v49
    v_cvt_pk_bf16_f32 v17, v45, v49
    v_mul_f32 v46, v9, v46
    v_mul_f32 v50, v9, v50
    v_cvt_pk_bf16_f32 v18, v46, v50
    v_mul_f32 v47, v9, v47
    v_mul_f32 v51, v9, v51
    v_cvt_pk_bf16_f32 v19, v47, v51
    ds_write_b128 v5, v[16:19]
    v_mov_b64 v[28:29], 0
    v_mov_b64 v[30:31], 0
    s_waitcnt lgkmcnt(0)
    s_barrier
    ds_read_b128 v[44:47], v4 offset:0
    ds_read_b128 v[48:51], v4 offset:128
    v_mov_b64 v[16:17], 0
    v_mov_b64 v[18:19], 0
    buffer_load_dwordx4 v0, s[8:11], s41 offen offset:0 lds
    buffer_load_dwordx4 v0, s[8:11], s41 offen offset:1024 lds
    s_waitcnt lgkmcnt(1)
    v_smfmac_f32_16x16x64_bf16 v[12:15], v[44:47], a[184:191], v1
    s_waitcnt lgkmcnt(0)
    v_smfmac_f32_16x16x64_bf16 v[12:15], v[48:51], a[192:199], v1
    v_smfmac_f32_16x16x64_bf16 v[24:27], v[44:47], a[200:207], v1
    v_smfmac_f32_16x16x64_bf16 v[24:27], v[48:51], a[208:215], v1
    v_add_f32 v12, v12, v14
    v_smfmac_f32_16x16x64_bf16 v[20:23], v[44:47], a[216:223], v1
    v_add_f32 v13, v13, v15
    v_smfmac_f32_16x16x64_bf16 v[20:23], v[48:51], a[224:231], v1
    v_cvt_pk_bf16_f32 v12, v12, v13
    v_smfmac_f32_16x16x64_bf16 v[16:19], v[44:47], a[232:239], v1
    v_add_f32 v24, v24, v26
    v_smfmac_f32_16x16x64_bf16 v[16:19], v[48:51], a[240:247], v1
    v_add_f32 v25, v25, v27
    v_smfmac_f32_16x16x64_bf16 v[36:39], v[44:47], v[56:63], v1
    v_cvt_pk_bf16_f32 v13, v24, v25
    v_smfmac_f32_16x16x64_bf16 v[36:39], v[48:51], v[64:71], v1
    v_add_f32 v20, v20, v22
    v_add_f32 v21, v21, v23
    v_cvt_pk_bf16_f32 v14, v20, v21
    v_add_f32 v16, v16, v18
    v_add_f32 v17, v17, v19
    v_cvt_pk_bf16_f32 v15, v16, v17
    v_and_or_b32 v15, v15, -2, s40
    buffer_store_dwordx4 v[12:15], v0, s[8:11], s38 offen sc1
    s_nop 0
    ds_read_b128 v[12:15], v8 offset:18432
    ds_read_b128 v[16:19], v8 offset:19456
    ds_read_b128 v[20:23], v8 offset:22528
    ds_read_b128 v[24:27], v8 offset:23552
    ds_read_b128 v[56:59], v8 offset:24576
    ds_read_b128 v[60:63], v8 offset:25600
    ds_read_b128 v[64:67], v8 offset:28672
    ds_read_b128 v[68:71], v8 offset:29696
    s_waitcnt lgkmcnt(6)
    v_smfmac_f32_16x16x64_bf16 v[40:43], v[44:47], v[12:19], v1
    ds_read_b128 v[12:15], v8 offset:26624
    ds_read_b128 v[16:19], v8 offset:27648
    s_waitcnt lgkmcnt(6)
    v_smfmac_f32_16x16x64_bf16 v[40:43], v[48:51], v[20:27], v1
    ds_read_b128 v[20:23], v8 offset:30720
    ds_read_b128 v[24:27], v8 offset:31744
    s_waitcnt lgkmcnt(6)
    v_smfmac_f32_16x16x64_bf16 v[52:55], v[44:47], v[56:63], v1
    ds_read_b128 v[56:59], v8 offset:32768
    ds_read_b128 v[60:63], v8 offset:33792
    s_waitcnt lgkmcnt(6)
    v_smfmac_f32_16x16x64_bf16 v[52:55], v[48:51], v[64:71], v1
    s_waitcnt lgkmcnt(4)
    v_smfmac_f32_16x16x64_bf16 v[32:35], v[44:47], v[12:19], v1
    s_waitcnt lgkmcnt(2)
    v_smfmac_f32_16x16x64_bf16 v[32:35], v[48:51], v[20:27], v1
    v_smfmac_f32_16x16x64_bf16 v[28:31], v[44:47], a[248:255], v1
    s_waitcnt lgkmcnt(0)
    v_smfmac_f32_16x16x64_bf16 v[28:31], v[48:51], v[56:63], v1
    v_add_f32 v36, v36, v38
    v_add_f32 v37, v37, v39
    v_cvt_pk_bf16_f32 v36, v36, v37
    v_add_f32 v40, v40, v42
    v_add_f32 v41, v41, v43
    v_cvt_pk_bf16_f32 v37, v40, v41
    v_add_f32 v52, v52, v54
    v_add_f32 v53, v53, v55
    v_cvt_pk_bf16_f32 v38, v52, v53
    v_add_f32 v32, v32, v34
    v_add_f32 v33, v33, v35
    v_cvt_pk_bf16_f32 v39, v32, v33
    v_and_or_b32 v39, v39, -2, s40
    s_add_u32 s17, s38, 4096
    buffer_store_dwordx4 v[36:39], v0, s[8:11], s17 offen sc1
    v_add_f32 v28, v28, v30
    v_add_f32 v29, v29, v31
    v_cvt_pk_bf16_f32 v28, v28, v29
    v_and_or_b32 v28, v28, -2, s40
    v_lshrrev_b32 v9, 2, v0
    buffer_store_dword v28, v9, s[8:11], s39 offen sc1
    v_add_u32 v10, 162560, v0
    ds_read_b128 v[64:67], v10
    s_add_u32 s33, s33, 1
    s_add_u32 s42, s42, 262144
    s_add_u32 s41, s41, 262144
    s_add_u32 s43, s43, 131072
    s_mov_b32 s67, s66
    s_add_u32 s68, s68, 262144
    s_add_u32 s66, s66, 22528
    ds_read_b128 v[56:59], v8 offset:4096
    ds_read_b128 v[60:63], v8 offset:5120
    v_mov_b64 v[12:13], 0
    v_mov_b64 v[14:15], 0
    v_mov_b64 v[16:17], 0
    v_mov_b64 v[18:19], 0
    v_mov_b64 v[20:21], 0
    v_mov_b64 v[22:23], 0
    v_mov_b64 v[24:25], 0
    v_mov_b64 v[26:27], 0
    v_mov_b64 v[28:29], 0
    v_mov_b64 v[30:31], 0
    v_mov_b64 v[32:33], 0
    v_mov_b64 v[34:35], 0
    s_nop 15
    s_nop 15
    s_nop 15
    s_nop 11
    buffer_load_dwordx4 v[40:43], v6, s[8:11], s62 offen sc1
    buffer_load_dwordx4 v[44:47], v6, s[8:11], s63 offen sc1
    buffer_load_dwordx4 v[48:51], v6, s[8:11], s64 offen sc1
    buffer_load_dwordx4 v[52:55], v6, s[8:11], s65 offen sc1
    s_waitcnt lgkmcnt(0)
    s_waitcnt vmcnt(3)
    v_mfma_f32_16x16x32_bf16 v[68:71], v[40:43], v[64:67], 0
    v_and_b32 v10, 1, v43
    v_cmp_ne_u32 s[54:55], s40, v10
    s_waitcnt vmcnt(2)
    v_mfma_f32_16x16x32_bf16 v[68:71], v[44:47], v[64:67], v[68:71]
    v_and_b32 v10, 1, v47
    v_cmp_ne_u32 s[56:57], s40, v10
    s_waitcnt vmcnt(1)
    v_mfma_f32_16x16x32_bf16 v[68:71], v[48:51], v[64:67], v[68:71]
    v_and_b32 v10, 1, v51
    v_cmp_ne_u32 s[58:59], s40, v10
    s_waitcnt vmcnt(0)
    v_mfma_f32_16x16x32_bf16 v[68:71], v[52:55], v[64:67], v[68:71]
    v_and_b32 v10, 1, v55
    v_cmp_ne_u32 s[60:61], s40, v10
    s_or_b64 vcc, s[54:55], s[56:57]
    s_or_b64 vcc, vcc, s[58:59]
    s_or_b64 vcc, vcc, s[60:61]
    s_cbranch_scc0 Lr1s_red
    s_mov_b32 s16, 0
Lr1s_p1:
    s_mov_b64 exec, s[54:55]
    buffer_load_dwordx4 v[40:43], v6, s[8:11], s62 offen sc1
    s_mov_b64 exec, s[56:57]
    buffer_load_dwordx4 v[44:47], v6, s[8:11], s63 offen sc1
    s_mov_b64 exec, s[58:59]
    buffer_load_dwordx4 v[48:51], v6, s[8:11], s64 offen sc1
    s_mov_b64 exec, s[60:61]
    buffer_load_dwordx4 v[52:55], v6, s[8:11], s65 offen sc1
    s_mov_b64 exec, -1
    s_add_u32 s16, s16, 1
    s_cmp_gt_u32 s16, 100000
    s_cbranch_scc1 Lr_abort
    s_waitcnt vmcnt(3)
    v_mfma_f32_16x16x32_bf16 v[68:71], v[40:43], v[64:67], 0
    v_and_b32 v10, 1, v43
    v_cmp_ne_u32 s[54:55], s40, v10
    s_waitcnt vmcnt(2)
    v_mfma_f32_16x16x32_bf16 v[68:71], v[44:47], v[64:67], v[68:71]
    v_and_b32 v10, 1, v47
    v_cmp_ne_u32 s[56:57], s40, v10
    s_waitcnt vmcnt(1)
    v_mfma_f32_16x16x32_bf16 v[68:71], v[48:51], v[64:67], v[68:71]
    v_and_b32 v10, 1, v51
    v_cmp_ne_u32 s[58:59], s40, v10
    s_waitcnt vmcnt(0)
    v_mfma_f32_16x16x32_bf16 v[68:71], v[52:55], v[64:67], v[68:71]
    v_and_b32 v10, 1, v55
    v_cmp_ne_u32 s[60:61], s40, v10
    s_or_b64 vcc, s[54:55], s[56:57]
    s_or_b64 vcc, vcc, s[58:59]
    s_or_b64 vcc, vcc, s[60:61]
    s_cbranch_scc1 Lr1s_p1
Lr1s_red:
    s_xor_b32 s34, s34, 16384
    s_xor_b32 s35, s35, 16384
    buffer_load_dwordx4 v[36:39], v0, s[8:11], s34 offen sc1
    v_permlane16_swap_b32 v68, v70
    v_permlane16_swap_b32 v69, v71
    s_mov_b64 exec, s[46:47]
    v_add_f32 v68, v68, v70
    v_add_f32 v69, v69, v71
    v_cvt_pk_bf16_f32 v68, v68, v69
    v_min_u32 v68, s50, v68
    buffer_store_dword v68, v7, s[8:11], s36 offen sc1
    v_mov_b32 v69, -1
    buffer_store_dword v69, v7, s[8:11], s37 offen sc1
    s_mov_b64 exec, -1
    buffer_load_dwordx4 v[36:39], v0, s[8:11], s34 offen sc1
    s_xor_b32 s40, s40, 1
    s_xor_b32 s36, s36, 16384
    s_xor_b32 s37, s37, 16384
    ds_read_b128 v[64:67], v8 offset:6144
    ds_read_b128 v[68:71], v8 offset:7168
    s_waitcnt lgkmcnt(0)
    s_branch Lr1s_step
Lr1s_pb_re:
    s_mov_b32 s16, 0
Lr1s_pb_lp:
    s_add_u32 s17, s34, 4096
    buffer_load_dwordx4 v[40:43], v0, s[8:11], s17 offen sc1
    s_add_u32 s16, s16, 1
    s_cmp_gt_u32 s16, 100000
    s_cbranch_scc1 Lr_abort
    s_waitcnt vmcnt(0)
    v_max3_u32 v10, v40, v41, v42
    v_max_u32 v10, v10, v43
    v_cmp_eq_u32 vcc, -1, v10
    s_nop 0
    s_cbranch_vccnz Lr1s_pb_lp
    s_branch Lr1s_pb_ok
Lr1s_pc_re:
    s_mov_b32 s16, 0
Lr1s_pc_lp:
    buffer_load_dwordx4 v[44:47], v0, s[8:11], s35 offen sc1
    s_add_u32 s16, s16, 1
    s_cmp_gt_u32 s16, 100000
    s_cbranch_scc1 Lr_abort
    s_waitcnt vmcnt(0)
    v_max3_u32 v10, v44, v45, v46
    v_max_u32 v10, v10, v47
    v_cmp_eq_u32 vcc, -1, v10
    s_nop 0
    s_cbranch_vccnz Lr1s_pc_lp
    s_branch Lr1s_pc_ok
Lr1s_last:
    s_waitcnt vmcnt(0) lgkmcnt(0)
    s_barrier
    s_mov_b32 s67, s66
    v_mov_b32 v9, 1
    v_mov_b32 v10, 0
    s_mov_b64 exec, 1
    buffer_store_dword v9, v10, s[8:11], s67 offen offset:384 sc1
    s_mov_b64 exec, -1
    s_branch Lr_exit
L_w2_0:
    s_cmp_lg_u32 s14, 2
    s_cbranch_scc1 L_w3_0
    s_mov_b32 s16, 0
    s_add_u32 s17, s66, 128
    v_lshrrev_b32 v10, 2, v0
    v_and_b32 v9, 16, v10
    v_lshlrev_b32 v9, 3, v9
    v_and_or_b32 v10, v10, 12, v9
Lr2s_fw_17:
    buffer_load_dword v9, v10, s[8:11], s17 offen sc1
    s_add_u32 s16, s16, 1
    s_cmp_gt_u32 s16, 100000
    s_cbranch_scc1 Lr_abort
    s_waitcnt vmcnt(0)
    v_cmp_eq_u32 vcc, 0, v9
    s_nop 0
    s_cbranch_vccnz Lr2s_fw_17
    s_mov_b32 m0, 19200
    s_nop 0
    buffer_load_dwordx4 v0, s[8:11], s41 offen offset:0 lds
    buffer_load_dwordx4 v0, s[8:11], s41 offen offset:1024 lds
    s_add_u32 s41, s41, 262144
    s_add_u32 s68, s68, 262144
    s_waitcnt vmcnt(0)
    ds_read_b128 v[56:59], v8 offset:4096
    ds_read_b128 v[60:63], v8 offset:5120
    ds_read_b128 v[64:67], v8 offset:6144
    ds_read_b128 v[68:71], v8 offset:7168
    v_mov_b64 v[12:13], 0
    v_mov_b64 v[14:15], 0
    v_mov_b64 v[16:17], 0
    v_mov_b64 v[18:19], 0
    v_mov_b64 v[20:21], 0
    v_mov_b64 v[22:23], 0
    v_mov_b64 v[24:25], 0
    v_mov_b64 v[26:27], 0
    v_mov_b64 v[28:29], 0
    v_mov_b64 v[30:31], 0
    v_mov_b64 v[32:33], 0
    v_mov_b64 v[34:35], 0
    buffer_load_dwordx4 v[36:39], v0, s[8:11], s34 offen sc1
    s_waitcnt vmcnt(0) lgkmcnt(0)
Lr2s_step:
    s_waitcnt vmcnt(3)
    v_max3_u32 v10, v36, v37, v38
    v_max_u32 v10, v10, v39
    v_cmp_eq_u32 vcc, -1, v10
    s_nop 0
    s_cbranch_vccz Lr2s_aok
    buffer_load_dwordx4 v[36:39], v0, s[8:11], s34 offen sc1
    s_nop 15
    s_nop 8
    buffer_load_dwordx4 v[36:39], v0, s[8:11], s34 offen sc1
    s_mov_b32 s16, 0
Lr2s_alp:
    s_waitcnt vmcnt(2)
    v_max3_u32 v10, v36, v37, v38
    v_max_u32 v10, v10, v39
    v_cmp_eq_u32 vcc, -1, v10
    s_nop 0
    s_cbranch_vccz Lr2s_aok
    buffer_load_dwordx4 v[36:39], v0, s[8:11], s34 offen sc1
    s_add_u32 s16, s16, 1
    s_cmp_gt_u32 s16, 100000
    s_cbranch_scc1 Lr_abort
    s_branch Lr2s_alp
Lr2s_aok:
    ds_write_b128 v0, v[36:39] offset:8960
    v_smfmac_f32_16x16x64_bf16 v[12:15], v[36:39], v[104:111], v1
    v_smfmac_f32_16x16x64_bf16 v[16:19], v[36:39], v[112:119], v1
    v_smfmac_f32_16x16x64_bf16 v[20:23], v[36:39], v[216:223], v1
    s_waitcnt lgkmcnt(0)
    s_barrier
    ds_read_b128 v[48:51], v0 offset:9984
    ds_read_b128 v[52:55], v0 offset:6912
    v_smfmac_f32_16x16x64_bf16 v[28:31], v[36:39], v[56:63], v1
    ds_read_b128 v[56:59], v8 offset:0
    ds_read_b128 v[60:63], v8 offset:1024
    v_smfmac_f32_16x16x64_bf16 v[24:27], v[36:39], v[224:231], v1
    v_smfmac_f32_16x16x64_bf16 v[32:35], v[36:39], v[64:71], v1
    ds_read_b128 v[64:67], v8 offset:2048
    ds_read_b128 v[68:71], v8 offset:3072
    s_add_u32 s17, s34, 4096
    buffer_load_dwordx4 v[40:43], v0, s[8:11], s17 offen sc1
    s_waitcnt vmcnt(1)
    ds_read_b128 v[36:39], v0 offset:7936
    s_waitcnt lgkmcnt(6)
    v_smfmac_f32_16x16x64_bf16 v[28:31], v[48:51], a[88:95], v1
    v_smfmac_f32_16x16x64_bf16 v[12:15], v[48:51], v[120:127], v1
    v_smfmac_f32_16x16x64_bf16 v[16:19], v[48:51], v[128:135], v1
    v_smfmac_f32_16x16x64_bf16 v[32:35], v[48:51], a[96:103], v1
    buffer_load_dwordx4 v[44:47], v0, s[8:11], s35 offen sc1
    v_smfmac_f32_16x16x64_bf16 v[20:23], v[48:51], v[232:239], v1
    v_lshrrev_b32 v10, 2, v0
    v_and_b32 v9, 16, v10
    v_lshlrev_b32 v9, 3, v9
    v_and_or_b32 v10, v10, 12, v9
    s_add_u32 s17, s66, 22656
    v_mov_b32 v11, 2
    buffer_load_dword v11, v10, s[8:11], s17 offen sc1
    v_smfmac_f32_16x16x64_bf16 v[24:27], v[48:51], v[240:247], v1
    s_waitcnt lgkmcnt(3)
    v_smfmac_f32_16x16x64_bf16 v[28:31], v[52:55], v[56:63], v1
    ds_read_b128 v[56:59], v8 offset:12288
    ds_read_b128 v[60:63], v8 offset:13312
    v_smfmac_f32_16x16x64_bf16 v[12:15], v[52:55], v[72:79], v1
    v_smfmac_f32_16x16x64_bf16 v[16:19], v[52:55], v[80:87], v1
    s_waitcnt lgkmcnt(3)
    v_smfmac_f32_16x16x64_bf16 v[32:35], v[52:55], v[64:71], v1
    ds_read_b128 v[64:67], v8 offset:14336
    ds_read_b128 v[68:71], v8 offset:15360
    v_smfmac_f32_16x16x64_bf16 v[20:23], v[52:55], v[184:191], v1
    v_smfmac_f32_16x16x64_bf16 v[24:27], v[52:55], v[192:199], v1
    s_waitcnt lgkmcnt(4)
    v_smfmac_f32_16x16x64_bf16 v[28:31], v[36:39], a[72:79], v1
    v_smfmac_f32_16x16x64_bf16 v[12:15], v[36:39], v[88:95], v1
    v_smfmac_f32_16x16x64_bf16 v[16:19], v[36:39], v[96:103], v1
    v_smfmac_f32_16x16x64_bf16 v[32:35], v[36:39], a[80:87], v1
    v_smfmac_f32_16x16x64_bf16 v[20:23], v[36:39], v[200:207], v1
    v_smfmac_f32_16x16x64_bf16 v[24:27], v[36:39], v[208:215], v1
    s_waitcnt vmcnt(2)
    v_max3_u32 v10, v40, v41, v42
    v_max_u32 v10, v10, v43
    v_cmp_eq_u32 vcc, -1, v10
    s_nop 0
    s_cbranch_vccnz Lr2s_pb_re
Lr2s_pb_ok:
    ds_write_b128 v0, v[40:43] offset:13056
    s_waitcnt lgkmcnt(3)
    v_smfmac_f32_16x16x64_bf16 v[12:15], v[40:43], v[56:63], v1
    ds_read_b128 v[56:59], v8 offset:8192
    ds_read_b128 v[60:63], v8 offset:9216
    v_smfmac_f32_16x16x64_bf16 v[20:23], v[40:43], a[24:31], v1
    s_waitcnt lgkmcnt(3)
    v_smfmac_f32_16x16x64_bf16 v[16:19], v[40:43], v[64:71], v1
    ds_read_b128 v[64:67], v8 offset:10240
    ds_read_b128 v[68:71], v8 offset:11264
    v_smfmac_f32_16x16x64_bf16 v[24:27], v[40:43], a[32:39], v1
    s_waitcnt lgkmcnt(4)
    s_barrier
    ds_read_b128 v[48:51], v0 offset:11008
    ds_read_b128 v[52:55], v0 offset:14080
    ds_read_b128 v[36:39], v0 offset:12032
    v_smfmac_f32_16x16x64_bf16 v[28:31], v[40:43], a[136:143], v1
    v_smfmac_f32_16x16x64_bf16 v[32:35], v[40:43], a[144:151], v1
    s_waitcnt lgkmcnt(2)
    v_smfmac_f32_16x16x64_bf16 v[12:15], v[48:51], v[56:63], v1
    v_smfmac_f32_16x16x64_bf16 v[16:19], v[48:51], v[64:71], v1
    s_waitcnt lgkmcnt(1)
    v_smfmac_f32_16x16x64_bf16 v[12:15], v[52:55], v[152:159], v1
    v_smfmac_f32_16x16x64_bf16 v[16:19], v[52:55], v[160:167], v1
    s_waitcnt lgkmcnt(0)
    v_smfmac_f32_16x16x64_bf16 v[12:15], v[36:39], v[136:143], v1
    v_smfmac_f32_16x16x64_bf16 v[16:19], v[36:39], v[144:151], v1
    s_waitcnt vmcnt(1)
    v_max3_u32 v10, v44, v45, v46
    v_max_u32 v10, v10, v47
    v_cmp_eq_u32 vcc, -1, v10
    s_nop 0
    s_cbranch_vccnz Lr2s_pc_re
Lr2s_pc_ok:
    v_smfmac_f32_16x16x64_bf16 v[12:15], v[44:47], v[168:175], v1
    v_smfmac_f32_16x16x64_bf16 v[16:19], v[44:47], v[176:183], v1
    v_smfmac_f32_16x16x64_bf16 v[20:23], v[48:51], v[248:255], v1
    v_smfmac_f32_16x16x64_bf16 v[24:27], v[48:51], a[0:7], v1
    v_smfmac_f32_16x16x64_bf16 v[20:23], v[52:55], a[40:47], v1
    v_add_f32 v12, v12, v14
    buffer_load_dwordx4 v[64:67], v0, s[8:11], s42 offen
    v_smfmac_f32_16x16x64_bf16 v[24:27], v[52:55], a[48:55], v1
    v_add_f32 v16, v16, v18
    v_smfmac_f32_16x16x64_bf16 v[20:23], v[36:39], a[8:15], v1
    v_add_f32 v13, v13, v15
    v_smfmac_f32_16x16x64_bf16 v[24:27], v[36:39], a[16:23], v1
    v_add_f32 v17, v17, v19
    v_smfmac_f32_16x16x64_bf16 v[20:23], v[44:47], a[56:63], v1
    v_cvt_pk_bf16_f32 v14, v12, v16
    ds_read_b128 v[56:59], v0 offset:15104
    buffer_load_dwordx4 v[68:71], v0, s[8:11], s42 offen offset:1024
    v_smfmac_f32_16x16x64_bf16 v[24:27], v[44:47], a[64:71], v1
    v_cvt_pk_bf16_f32 v15, v13, v17
    ds_read_b128 v[60:63], v0 offset:16128
    ds_write_b32 v2, v14 offset:576
    ds_write_b32 v2, v15 offset:864
    v_smfmac_f32_16x16x64_bf16 v[28:31], v[48:51], a[104:111], v1
    v_smfmac_f32_16x16x64_bf16 v[32:35], v[48:51], a[112:119], v1
    v_add_f32 v20, v20, v22
    v_add_f32 v24, v24, v26
    v_add_f32 v21, v21, v23
    v_add_f32 v25, v25, v27
    v_cvt_pk_bf16_f32 v22, v20, v24
    v_cvt_pk_bf16_f32 v23, v21, v25
    ds_write_b32 v2, v22 offset:0
    ds_write_b32 v2, v23 offset:288
    v_smfmac_f32_16x16x64_bf16 v[28:31], v[52:55], a[152:159], v1
    v_smfmac_f32_16x16x64_bf16 v[32:35], v[52:55], a[160:167], v1
    s_waitcnt vmcnt(2)
    v_cmp_eq_u32 vcc, 0, v11
    s_nop 0
    s_cbranch_vccnz Lr2s_flbad
Lr2s_flok:
    s_waitcnt lgkmcnt(0)
    s_barrier
    ds_read_b128 v[40:43], v3 offset:0
    ds_read_b128 v[48:51], v3 offset:64
    ds_read_b128 v[20:23], v3 offset:128
    ds_read_b128 v[52:55], v3 offset:192
    v_smfmac_f32_16x16x64_bf16 v[28:31], v[36:39], a[120:127], v1
    v_smfmac_f32_16x16x64_bf16 v[32:35], v[36:39], a[128:135], v1
    ds_read_b128 v[36:39], v0 offset:17152
    v_smfmac_f32_16x16x64_bf16 v[28:31], v[44:47], a[168:175], v1
    v_smfmac_f32_16x16x64_bf16 v[32:35], v[44:47], a[176:183], v1
    ds_read_b128 v[44:47], v0 offset:18176
    s_waitcnt lgkmcnt(5)
    v_mfma_f32_16x16x32_bf16 v[12:15], v[56:59], v[40:43], 0
    v_mfma_f32_16x16x32_bf16 v[16:19], v[60:63], v[40:43], 0
    v_mfma_f32_16x16x32_bf16 v[24:27], v[40:43], v[40:43], 0
    ds_read_b128 v[56:59], v0 offset:19200
    ds_read_b128 v[60:63], v0 offset:20224
    s_waitcnt lgkmcnt(3)
    v_mfma_f32_16x16x32_bf16 v[12:15], v[36:39], v[48:51], v[12:15]
    v_lshrrev_b32 v10, 1, v0
    v_lshrrev_b32 v9, 9, v0
    s_waitcnt lgkmcnt(2)
    v_mfma_f32_16x16x32_bf16 v[16:19], v[44:47], v[48:51], v[16:19]
    v_lshl_add_u32 v9, v9, 5, v10
    v_add_f32 v28, v28, v30
    v_mfma_f32_16x16x32_bf16 v[24:27], v[48:51], v[48:51], v[24:27]
    v_add_f32 v32, v32, v34
    v_add_f32 v29, v29, v31
    ds_read_b128 v[36:39], v0 offset:21248
    ds_read_b128 v[44:47], v0 offset:22272
    s_waitcnt lgkmcnt(3)
    v_mfma_f32_16x16x32_bf16 v[12:15], v[56:59], v[20:23], v[12:15]
    v_add_f32 v33, v33, v35
    v_cvt_pk_bf16_f32 v30, v28, v29
    s_waitcnt lgkmcnt(2)
    v_mfma_f32_16x16x32_bf16 v[16:19], v[60:63], v[20:23], v[16:19]
    v_cvt_pk_bf16_f32 v31, v32, v33
    ds_read_b64 v[34:35], v9 offset:2304
    v_mfma_f32_16x16x32_bf16 v[24:27], v[20:23], v[20:23], v[24:27]
    s_add_u32 s17, s43, 3072
    buffer_store_dwordx2 v[30:31], v10, s[8:11], s17 offen sc1
    s_waitcnt lgkmcnt(2)
    v_mfma_f32_16x16x32_bf16 v[12:15], v[36:39], v[52:55], v[12:15]
    s_waitcnt lgkmcnt(1)
    v_mfma_f32_16x16x32_bf16 v[16:19], v[44:47], v[52:55], v[16:19]
    v_mfma_f32_16x16x32_bf16 v[24:27], v[52:55], v[52:55], v[24:27]
    s_add_u32 s17, s43, 1024
    s_waitcnt lgkmcnt(0)
    buffer_store_dwordx2 v[34:35], v10, s[8:11], s17 offen sc1
    s_cmp_eq_u32 s33, 63
    s_cbranch_scc1 Lr2s_last
    ds_read_b128 v[56:59], v8 offset:16384
    ds_read_b128 v[60:63], v8 offset:17408
    v_mov_b64 v[20:21], s[52:53]
    v_mov_b64 v[22:23], s[52:53]
    v_mov_b32 v41, 0
    v_mov_b32 v42, 0
    v_max3_f32 v9, v12, v13, v14
    v_max3_f32 v9, v9, v15, v16
    v_max3_f32 v9, v9, v17, v18
    v_max3_f32 v9, v9, v19, v24
    v_max_f32 v9, v9, v25
    v_mov_b32 v10, v9
    v_mov_b64 v[32:33], 0
    v_mov_b64 v[34:35], 0
    v_permlane32_swap_b32 v9, v10
    v_max_f32 v9, v9, v10
    v_mov_b32 v10, v9
    s_nop 1
    v_permlane16_swap_b32 v9, v10
    v_max_f32 v9, v9, v10
    v_mul_f32 v28, s44, v9
    v_fma_f32 v12, v12, s44, -v28
    v_fma_f32 v13, v13, s44, -v28
    v_fma_f32 v14, v14, s44, -v28
    v_fma_f32 v15, v15, s44, -v28
    v_exp_f32 v12, v12
    v_exp_f32 v13, v13
    v_fma_f32 v16, v16, s44, -v28
    v_fma_f32 v17, v17, s44, -v28
    v_exp_f32 v14, v14
    v_exp_f32 v15, v15
    v_cvt_pk_bf16_f32 v36, v12, v13
    v_fma_f32 v18, v18, s44, -v28
    v_fma_f32 v19, v19, s44, -v28
    v_exp_f32 v16, v16
    v_exp_f32 v17, v17
    v_cvt_pk_bf16_f32 v37, v14, v15
    v_fma_f32 v24, v24, s44, -v28
    v_fma_f32 v25, v25, s44, -v28
    v_exp_f32 v18, v18
    v_exp_f32 v19, v19
    v_cvt_pk_bf16_f32 v38, v16, v17
    v_exp_f32 v24, v24
    v_exp_f32 v25, v25
    v_cvt_pk_bf16_f32 v39, v18, v19
    v_cvt_pk_bf16_f32 v40, v24, v25
    v_cvt_pk_bf16_f32 v43, v24, v25
    v_mfma_f32_16x16x32_bf16 v[52:55], v[20:23], v[36:39], 0
    v_mov_b64 v[12:13], 0
    v_mov_b64 v[14:15], 0
    s_waitcnt vmcnt(3)
    v_mfma_f32_16x16x32_bf16 v[44:47], v[64:67], v[36:39], 0
    v_mov_b64 v[24:25], 0
    v_mov_b64 v[26:27], 0
    s_waitcnt vmcnt(2)
    v_mfma_f32_16x16x32_bf16 v[48:51], v[68:71], v[36:39], 0
    ds_read_b128 v[64:67], v8 offset:20480
    ds_read_b128 v[68:71], v8 offset:21504
    v_mfma_f32_16x16x16_bf16 v[52:55], v[20:21], v[40:41], v[52:55]
    v_mfma_f32_16x16x16_bf16 v[44:47], v[30:31], v[40:41], v[44:47]
    v_mov_b64 v[20:21], 0
    v_mov_b64 v[22:23], 0
    v_mfma_f32_16x16x16_bf16 v[48:51], v[30:31], v[42:43], v[48:51]
    v_mov_b64 v[36:37], 0
    v_mov_b64 v[38:39], 0
    v_mov_b64 v[40:41], 0
    v_mov_b64 v[42:43], 0
    v_rcp_f32 v9, v52
    v_mov_b64 v[52:53], 0
    v_mov_b64 v[54:55], 0
    v_mul_f32 v44, v9, v44
    v_mul_f32 v48, v9, v48
    v_cvt_pk_bf16_f32 v16, v44, v48
    v_mul_f32 v45, v9, v45
    v_mul_f32 v49, v9, v49
    v_cvt_pk_bf16_f32 v17, v45, v49
    v_mul_f32 v46, v9, v46
    v_mul_f32 v50, v9, v50
    v_cvt_pk_bf16_f32 v18, v46, v50
    v_mul_f32 v47, v9, v47
    v_mul_f32 v51, v9, v51
    v_cvt_pk_bf16_f32 v19, v47, v51
    ds_write_b128 v5, v[16:19]
    v_mov_b64 v[28:29], 0
    v_mov_b64 v[30:31], 0
    s_waitcnt lgkmcnt(0)
    s_barrier
    ds_read_b128 v[44:47], v4 offset:0
    ds_read_b128 v[48:51], v4 offset:128
    v_mov_b64 v[16:17], 0
    v_mov_b64 v[18:19], 0
    buffer_load_dwordx4 v0, s[8:11], s41 offen offset:0 lds
    buffer_load_dwordx4 v0, s[8:11], s41 offen offset:1024 lds
    s_waitcnt lgkmcnt(1)
    v_smfmac_f32_16x16x64_bf16 v[12:15], v[44:47], a[184:191], v1
    s_waitcnt lgkmcnt(0)
    v_smfmac_f32_16x16x64_bf16 v[12:15], v[48:51], a[192:199], v1
    v_smfmac_f32_16x16x64_bf16 v[24:27], v[44:47], a[200:207], v1
    v_smfmac_f32_16x16x64_bf16 v[24:27], v[48:51], a[208:215], v1
    v_add_f32 v12, v12, v14
    v_smfmac_f32_16x16x64_bf16 v[20:23], v[44:47], a[216:223], v1
    v_add_f32 v13, v13, v15
    v_smfmac_f32_16x16x64_bf16 v[20:23], v[48:51], a[224:231], v1
    v_cvt_pk_bf16_f32 v12, v12, v13
    v_smfmac_f32_16x16x64_bf16 v[16:19], v[44:47], a[232:239], v1
    v_add_f32 v24, v24, v26
    v_smfmac_f32_16x16x64_bf16 v[16:19], v[48:51], a[240:247], v1
    v_add_f32 v25, v25, v27
    v_smfmac_f32_16x16x64_bf16 v[36:39], v[44:47], v[56:63], v1
    v_cvt_pk_bf16_f32 v13, v24, v25
    v_smfmac_f32_16x16x64_bf16 v[36:39], v[48:51], v[64:71], v1
    v_add_f32 v20, v20, v22
    v_add_f32 v21, v21, v23
    v_cvt_pk_bf16_f32 v14, v20, v21
    v_add_f32 v16, v16, v18
    v_add_f32 v17, v17, v19
    v_cvt_pk_bf16_f32 v15, v16, v17
    v_and_or_b32 v15, v15, -2, s40
    buffer_store_dwordx4 v[12:15], v0, s[8:11], s38 offen sc1
    s_nop 0
    ds_read_b128 v[12:15], v8 offset:18432
    ds_read_b128 v[16:19], v8 offset:19456
    ds_read_b128 v[20:23], v8 offset:22528
    ds_read_b128 v[24:27], v8 offset:23552
    ds_read_b128 v[56:59], v8 offset:24576
    ds_read_b128 v[60:63], v8 offset:25600
    ds_read_b128 v[64:67], v8 offset:28672
    ds_read_b128 v[68:71], v8 offset:29696
    s_waitcnt lgkmcnt(6)
    v_smfmac_f32_16x16x64_bf16 v[40:43], v[44:47], v[12:19], v1
    ds_read_b128 v[12:15], v8 offset:26624
    ds_read_b128 v[16:19], v8 offset:27648
    s_waitcnt lgkmcnt(6)
    v_smfmac_f32_16x16x64_bf16 v[40:43], v[48:51], v[20:27], v1
    ds_read_b128 v[20:23], v8 offset:30720
    ds_read_b128 v[24:27], v8 offset:31744
    s_waitcnt lgkmcnt(6)
    v_smfmac_f32_16x16x64_bf16 v[52:55], v[44:47], v[56:63], v1
    ds_read_b128 v[56:59], v8 offset:32768
    ds_read_b128 v[60:63], v8 offset:33792
    s_waitcnt lgkmcnt(6)
    v_smfmac_f32_16x16x64_bf16 v[52:55], v[48:51], v[64:71], v1
    s_waitcnt lgkmcnt(4)
    v_smfmac_f32_16x16x64_bf16 v[32:35], v[44:47], v[12:19], v1
    s_waitcnt lgkmcnt(2)
    v_smfmac_f32_16x16x64_bf16 v[32:35], v[48:51], v[20:27], v1
    v_smfmac_f32_16x16x64_bf16 v[28:31], v[44:47], a[248:255], v1
    s_waitcnt lgkmcnt(0)
    v_smfmac_f32_16x16x64_bf16 v[28:31], v[48:51], v[56:63], v1
    v_add_f32 v36, v36, v38
    v_add_f32 v37, v37, v39
    v_cvt_pk_bf16_f32 v36, v36, v37
    v_add_f32 v40, v40, v42
    v_add_f32 v41, v41, v43
    v_cvt_pk_bf16_f32 v37, v40, v41
    v_add_f32 v52, v52, v54
    v_add_f32 v53, v53, v55
    v_cvt_pk_bf16_f32 v38, v52, v53
    v_add_f32 v32, v32, v34
    v_add_f32 v33, v33, v35
    v_cvt_pk_bf16_f32 v39, v32, v33
    v_and_or_b32 v39, v39, -2, s40
    s_add_u32 s17, s38, 4096
    buffer_store_dwordx4 v[36:39], v0, s[8:11], s17 offen sc1
    v_add_f32 v28, v28, v30
    v_add_f32 v29, v29, v31
    v_cvt_pk_bf16_f32 v28, v28, v29
    v_and_or_b32 v28, v28, -2, s40
    v_lshrrev_b32 v9, 2, v0
    buffer_store_dword v28, v9, s[8:11], s39 offen sc1
    v_add_u32 v10, 162560, v0
    ds_read_b32 v64, v10
    v_mov_b32 v65, 0
    v_mov_b32 v41, 0
    v_mov_b32 v45, 0
    v_mov_b32 v49, 0
    v_mov_b32 v53, 0
    s_add_u32 s33, s33, 1
    s_add_u32 s42, s42, 262144
    s_add_u32 s41, s41, 262144
    s_add_u32 s43, s43, 131072
    s_add_u32 s68, s68, 262144
    s_add_u32 s66, s66, 22528
    ds_read_b128 v[56:59], v8 offset:4096
    ds_read_b128 v[60:63], v8 offset:5120
    v_mov_b64 v[12:13], 0
    v_mov_b64 v[14:15], 0
    v_mov_b64 v[16:17], 0
    v_mov_b64 v[18:19], 0
    v_mov_b64 v[20:21], 0
    v_mov_b64 v[22:23], 0
    v_mov_b64 v[24:25], 0
    v_mov_b64 v[26:27], 0
    v_mov_b64 v[28:29], 0
    v_mov_b64 v[30:31], 0
    v_mov_b64 v[32:33], 0
    v_mov_b64 v[34:35], 0
    s_nop 15
    s_nop 15
    s_nop 15
    s_nop 1
    buffer_load_dword v40, v6, s[8:11], s62 offen sc1
    buffer_load_dword v44, v6, s[8:11], s63 offen sc1
    buffer_load_dword v48, v6, s[8:11], s64 offen sc1
    buffer_load_dword v52, v6, s[8:11], s65 offen sc1
    s_waitcnt lgkmcnt(0)
    s_waitcnt vmcnt(3)
    v_mfma_f32_16x16x16_bf16 v[68:71], v[40:41], v[64:65], 0
    v_and_b32 v10, 1, v40
    v_cmp_ne_u32 s[54:55], s40, v10
    s_waitcnt vmcnt(2)
    v_mfma_f32_16x16x16_bf16 v[68:71], v[44:45], v[64:65], v[68:71]
    v_and_b32 v10, 1, v44
    v_cmp_ne_u32 s[56:57], s40, v10
    s_waitcnt vmcnt(1)
    v_mfma_f32_16x16x16_bf16 v[68:71], v[48:49], v[64:65], v[68:71]
    v_and_b32 v10, 1, v48
    v_cmp_ne_u32 s[58:59], s40, v10
    s_waitcnt vmcnt(0)
    v_mfma_f32_16x16x16_bf16 v[68:71], v[52:53], v[64:65], v[68:71]
    v_and_b32 v10, 1, v52
    v_cmp_ne_u32 s[60:61], s40, v10
    s_or_b64 vcc, s[54:55], s[56:57]
    s_or_b64 vcc, vcc, s[58:59]
    s_or_b64 vcc, vcc, s[60:61]
    s_cbranch_scc0 Lr2s_red
    s_mov_b32 s16, 0
Lr2s_p1:
    s_mov_b64 exec, s[54:55]
    buffer_load_dword v40, v6, s[8:11], s62 offen sc1
    s_mov_b64 exec, s[56:57]
    buffer_load_dword v44, v6, s[8:11], s63 offen sc1
    s_mov_b64 exec, s[58:59]
    buffer_load_dword v48, v6, s[8:11], s64 offen sc1
    s_mov_b64 exec, s[60:61]
    buffer_load_dword v52, v6, s[8:11], s65 offen sc1
    s_mov_b64 exec, -1
    s_add_u32 s16, s16, 1
    s_cmp_gt_u32 s16, 100000
    s_cbranch_scc1 Lr_abort
    s_waitcnt vmcnt(3)
    v_mfma_f32_16x16x16_bf16 v[68:71], v[40:41], v[64:65], 0
    v_and_b32 v10, 1, v40
    v_cmp_ne_u32 s[54:55], s40, v10
    s_waitcnt vmcnt(2)
    v_mfma_f32_16x16x16_bf16 v[68:71], v[44:45], v[64:65], v[68:71]
    v_and_b32 v10, 1, v44
    v_cmp_ne_u32 s[56:57], s40, v10
    s_waitcnt vmcnt(1)
    v_mfma_f32_16x16x16_bf16 v[68:71], v[48:49], v[64:65], v[68:71]
    v_and_b32 v10, 1, v48
    v_cmp_ne_u32 s[58:59], s40, v10
    s_waitcnt vmcnt(0)
    v_mfma_f32_16x16x16_bf16 v[68:71], v[52:53], v[64:65], v[68:71]
    v_and_b32 v10, 1, v52
    v_cmp_ne_u32 s[60:61], s40, v10
    s_or_b64 vcc, s[54:55], s[56:57]
    s_or_b64 vcc, vcc, s[58:59]
    s_or_b64 vcc, vcc, s[60:61]
    s_cbranch_scc1 Lr2s_p1
Lr2s_red:
    s_xor_b32 s34, s34, 16384
    s_xor_b32 s35, s35, 16384
    buffer_load_dwordx4 v[36:39], v0, s[8:11], s34 offen sc1
    v_permlane16_swap_b32 v68, v70
    v_permlane16_swap_b32 v69, v71
    s_mov_b64 exec, s[46:47]
    v_add_f32 v68, v68, v70
    v_add_f32 v69, v69, v71
    v_cvt_pk_bf16_f32 v68, v68, v69
    v_min_u32 v68, s50, v68
    buffer_store_dword v68, v7, s[8:11], s36 offen sc1
    v_mov_b32 v69, -1
    buffer_store_dword v69, v7, s[8:11], s37 offen sc1
    s_mov_b64 exec, -1
    buffer_load_dwordx4 v[36:39], v0, s[8:11], s34 offen sc1
    s_xor_b32 s40, s40, 1
    s_xor_b32 s36, s36, 16384
    s_xor_b32 s37, s37, 16384
    ds_read_b128 v[64:67], v8 offset:6144
    ds_read_b128 v[68:71], v8 offset:7168
    s_waitcnt lgkmcnt(0)
    s_branch Lr2s_step
Lr2s_pb_re:
    s_mov_b32 s16, 0
Lr2s_pb_lp:
    s_add_u32 s17, s34, 4096
    buffer_load_dwordx4 v[40:43], v0, s[8:11], s17 offen sc1
    s_add_u32 s16, s16, 1
    s_cmp_gt_u32 s16, 100000
    s_cbranch_scc1 Lr_abort
    s_waitcnt vmcnt(0)
    v_max3_u32 v10, v40, v41, v42
    v_max_u32 v10, v10, v43
    v_cmp_eq_u32 vcc, -1, v10
    s_nop 0
    s_cbranch_vccnz Lr2s_pb_lp
    s_branch Lr2s_pb_ok
Lr2s_pc_re:
    s_mov_b32 s16, 0
Lr2s_pc_lp:
    buffer_load_dwordx4 v[44:47], v0, s[8:11], s35 offen sc1
    s_add_u32 s16, s16, 1
    s_cmp_gt_u32 s16, 100000
    s_cbranch_scc1 Lr_abort
    s_waitcnt vmcnt(0)
    v_max3_u32 v10, v44, v45, v46
    v_max_u32 v10, v10, v47
    v_cmp_eq_u32 vcc, -1, v10
    s_nop 0
    s_cbranch_vccnz Lr2s_pc_lp
    s_branch Lr2s_pc_ok
Lr2s_flbad:
    s_cmp_eq_u32 s33, 63
    s_cbranch_scc1 Lr2s_flok
    s_mov_b32 s16, 0
    s_add_u32 s17, s66, 22656
    v_lshrrev_b32 v10, 2, v0
    v_and_b32 v9, 16, v10
    v_lshlrev_b32 v9, 3, v9
    v_and_or_b32 v10, v10, 12, v9
Lr2s_fw_18:
    buffer_load_dword v9, v10, s[8:11], s17 offen sc1
    s_add_u32 s16, s16, 1
    s_cmp_gt_u32 s16, 100000
    s_cbranch_scc1 Lr_abort
    s_waitcnt vmcnt(0)
    v_cmp_eq_u32 vcc, 0, v9
    s_nop 0
    s_cbranch_vccnz Lr2s_fw_18
    s_branch Lr2s_flok
Lr2s_last:
    s_waitcnt vmcnt(0) lgkmcnt(0)
    s_barrier
    s_branch Lr_exit
L_w3_0:
    s_mov_b32 s16, 0
    s_add_u32 s17, s66, 128
    v_lshrrev_b32 v10, 2, v0
    v_and_b32 v9, 16, v10
    v_lshlrev_b32 v9, 3, v9
    v_and_or_b32 v10, v10, 12, v9
Lr3s_fw_19:
    buffer_load_dword v9, v10, s[8:11], s17 offen sc1
    s_add_u32 s16, s16, 1
    s_cmp_gt_u32 s16, 100000
    s_cbranch_scc1 Lr_abort
    s_waitcnt vmcnt(0)
    v_cmp_eq_u32 vcc, 0, v9
    s_nop 0
    s_cbranch_vccnz Lr3s_fw_19
    s_mov_b32 m0, 21248
    s_nop 0
    buffer_load_dwordx4 v0, s[8:11], s41 offen offset:0 lds
    buffer_load_dwordx4 v0, s[8:11], s41 offen offset:1024 lds
    s_add_u32 s41, s41, 262144
    s_add_u32 s68, s68, 262144
    s_waitcnt vmcnt(0)
    ds_read_b128 v[56:59], v8 offset:0
    ds_read_b128 v[60:63], v8 offset:1024
    ds_read_b128 v[64:67], v8 offset:2048
    ds_read_b128 v[68:71], v8 offset:3072
    v_mov_b64 v[12:13], 0
    v_mov_b64 v[14:15], 0
    v_mov_b64 v[16:17], 0
    v_mov_b64 v[18:19], 0
    v_mov_b64 v[20:21], 0
    v_mov_b64 v[22:23], 0
    v_mov_b64 v[24:25], 0
    v_mov_b64 v[26:27], 0
    v_mov_b64 v[28:29], 0
    v_mov_b64 v[30:31], 0
    v_mov_b64 v[32:33], 0
    v_mov_b64 v[34:35], 0
    buffer_load_dwordx4 v[36:39], v0, s[8:11], s34 offen sc1
    s_waitcnt vmcnt(0) lgkmcnt(0)
Lr3s_step:
    s_mov_b32 s16, 0
Lr3s_alp:
    s_waitcnt vmcnt(2)
    v_max3_u32 v10, v36, v37, v38
    v_max_u32 v10, v10, v39
    v_cmp_eq_u32 vcc, -1, v10
    s_nop 0
    s_cbranch_vccz Lr3s_aok
    buffer_load_dwordx4 v[36:39], v0, s[8:11], s34 offen sc1
    s_add_u32 s16, s16, 1
    s_cmp_gt_u32 s16, 100000
    s_cbranch_scc1 Lr_abort
    s_branch Lr3s_alp
Lr3s_aok:
    ds_write_b128 v0, v[36:39] offset:9984
    v_smfmac_f32_16x16x64_bf16 v[12:15], v[36:39], v[120:127], v1
    v_smfmac_f32_16x16x64_bf16 v[16:19], v[36:39], v[128:135], v1
    v_smfmac_f32_16x16x64_bf16 v[20:23], v[36:39], v[232:239], v1
    s_waitcnt lgkmcnt(0)
    s_barrier
    ds_read_b128 v[48:51], v0 offset:6912
    ds_read_b128 v[52:55], v0 offset:7936
    v_smfmac_f32_16x16x64_bf16 v[28:31], v[36:39], a[88:95], v1
    v_smfmac_f32_16x16x64_bf16 v[24:27], v[36:39], v[240:247], v1
    v_smfmac_f32_16x16x64_bf16 v[32:35], v[36:39], a[96:103], v1
    s_waitcnt vmcnt(0)
    ds_read_b128 v[36:39], v0 offset:8960
    s_waitcnt lgkmcnt(2)
    v_smfmac_f32_16x16x64_bf16 v[28:31], v[48:51], v[56:63], v1
    ds_read_b128 v[56:59], v8 offset:4096
    ds_read_b128 v[60:63], v8 offset:5120
    s_add_u32 s17, s34, 4096
    buffer_load_dwordx4 v[40:43], v0, s[8:11], s17 offen sc1
    v_smfmac_f32_16x16x64_bf16 v[12:15], v[48:51], v[72:79], v1
    v_smfmac_f32_16x16x64_bf16 v[16:19], v[48:51], v[80:87], v1
    v_smfmac_f32_16x16x64_bf16 v[32:35], v[48:51], v[64:71], v1
    ds_read_b128 v[64:67], v8 offset:6144
    ds_read_b128 v[68:71], v8 offset:7168
    v_smfmac_f32_16x16x64_bf16 v[20:23], v[48:51], v[184:191], v1
    buffer_load_dwordx4 v[44:47], v0, s[8:11], s35 offen sc1
    v_smfmac_f32_16x16x64_bf16 v[24:27], v[48:51], v[192:199], v1
    s_waitcnt lgkmcnt(5)
    v_smfmac_f32_16x16x64_bf16 v[28:31], v[52:55], a[72:79], v1
    v_smfmac_f32_16x16x64_bf16 v[12:15], v[52:55], v[88:95], v1
    v_smfmac_f32_16x16x64_bf16 v[16:19], v[52:55], v[96:103], v1
    v_smfmac_f32_16x16x64_bf16 v[32:35], v[52:55], a[80:87], v1
    v_smfmac_f32_16x16x64_bf16 v[20:23], v[52:55], v[200:207], v1
    v_smfmac_f32_16x16x64_bf16 v[24:27], v[52:55], v[208:215], v1
    s_waitcnt lgkmcnt(2)
    v_smfmac_f32_16x16x64_bf16 v[28:31], v[36:39], v[56:63], v1
    ds_read_b128 v[56:59], v8 offset:8192
    ds_read_b128 v[60:63], v8 offset:9216
    v_smfmac_f32_16x16x64_bf16 v[12:15], v[36:39], v[104:111], v1
    v_smfmac_f32_16x16x64_bf16 v[16:19], v[36:39], v[112:119], v1
    s_waitcnt lgkmcnt(2)
    v_smfmac_f32_16x16x64_bf16 v[32:35], v[36:39], v[64:71], v1
    ds_read_b128 v[64:67], v8 offset:10240
    ds_read_b128 v[68:71], v8 offset:11264
    v_smfmac_f32_16x16x64_bf16 v[20:23], v[36:39], v[216:223], v1
    v_smfmac_f32_16x16x64_bf16 v[24:27], v[36:39], v[224:231], v1
    s_waitcnt vmcnt(1)
    v_max3_u32 v10, v40, v41, v42
    v_max_u32 v10, v10, v43
    v_cmp_eq_u32 vcc, -1, v10
    s_nop 0
    s_cbranch_vccnz Lr3s_pb_re
Lr3s_pb_ok:
    ds_write_b128 v0, v[40:43] offset:14080
    v_smfmac_f32_16x16x64_bf16 v[12:15], v[40:43], v[152:159], v1
    v_smfmac_f32_16x16x64_bf16 v[20:23], v[40:43], a[40:47], v1
    v_smfmac_f32_16x16x64_bf16 v[16:19], v[40:43], v[160:167], v1
    v_smfmac_f32_16x16x64_bf16 v[24:27], v[40:43], a[48:55], v1
    s_waitcnt lgkmcnt(0)
    s_barrier
    ds_read_b128 v[48:51], v0 offset:11008
    ds_read_b128 v[52:55], v0 offset:12032
    ds_read_b128 v[36:39], v0 offset:13056
    v_smfmac_f32_16x16x64_bf16 v[28:31], v[40:43], a[152:159], v1
    v_smfmac_f32_16x16x64_bf16 v[32:35], v[40:43], a[160:167], v1
    s_waitcnt lgkmcnt(2)
    v_smfmac_f32_16x16x64_bf16 v[12:15], v[48:51], v[56:63], v1
    ds_read_b128 v[56:59], v8 offset:12288
    ds_read_b128 v[60:63], v8 offset:13312
    v_smfmac_f32_16x16x64_bf16 v[16:19], v[48:51], v[64:71], v1
    ds_read_b128 v[64:67], v8 offset:14336
    ds_read_b128 v[68:71], v8 offset:15360
    s_waitcnt lgkmcnt(5)
    v_smfmac_f32_16x16x64_bf16 v[12:15], v[52:55], v[136:143], v1
    v_smfmac_f32_16x16x64_bf16 v[16:19], v[52:55], v[144:151], v1
    s_waitcnt vmcnt(0)
    v_max3_u32 v10, v44, v45, v46
    v_max_u32 v10, v10, v47
    v_cmp_eq_u32 vcc, -1, v10
    s_nop 0
    s_cbranch_vccnz Lr3s_pc_re
Lr3s_pc_ok:
    v_smfmac_f32_16x16x64_bf16 v[12:15], v[44:47], v[168:175], v1
    v_smfmac_f32_16x16x64_bf16 v[16:19], v[44:47], v[176:183], v1
    s_waitcnt lgkmcnt(2)
    v_smfmac_f32_16x16x64_bf16 v[12:15], v[36:39], v[56:63], v1
    s_waitcnt lgkmcnt(0)
    v_smfmac_f32_16x16x64_bf16 v[16:19], v[36:39], v[64:71], v1
    v_smfmac_f32_16x16x64_bf16 v[20:23], v[48:51], v[248:255], v1
    v_smfmac_f32_16x16x64_bf16 v[24:27], v[48:51], a[0:7], v1
    v_smfmac_f32_16x16x64_bf16 v[20:23], v[52:55], a[8:15], v1
    v_add_f32 v12, v12, v14
    v_smfmac_f32_16x16x64_bf16 v[24:27], v[52:55], a[16:23], v1
    v_add_f32 v16, v16, v18
    buffer_load_dwordx4 v[64:67], v0, s[8:11], s42 offen
    v_smfmac_f32_16x16x64_bf16 v[20:23], v[36:39], a[24:31], v1
    v_add_f32 v13, v13, v15
    v_smfmac_f32_16x16x64_bf16 v[24:27], v[36:39], a[32:39], v1
    v_add_f32 v17, v17, v19
    v_smfmac_f32_16x16x64_bf16 v[20:23], v[44:47], a[56:63], v1
    v_cvt_pk_bf16_f32 v14, v12, v16
    ds_read_b128 v[56:59], v0 offset:15104
    v_smfmac_f32_16x16x64_bf16 v[24:27], v[44:47], a[64:71], v1
    v_cvt_pk_bf16_f32 v15, v13, v17
    ds_read_b128 v[60:63], v0 offset:16128
    buffer_load_dwordx4 v[68:71], v0, s[8:11], s42 offen offset:1024
    ds_write_b32 v2, v14 offset:576
    ds_write_b32 v2, v15 offset:864
    v_smfmac_f32_16x16x64_bf16 v[28:31], v[48:51], a[104:111], v1
    v_smfmac_f32_16x16x64_bf16 v[32:35], v[48:51], a[112:119], v1
    v_add_f32 v20, v20, v22
    v_add_f32 v24, v24, v26
    v_add_f32 v21, v21, v23
    v_add_f32 v25, v25, v27
    v_cvt_pk_bf16_f32 v22, v20, v24
    v_cvt_pk_bf16_f32 v23, v21, v25
    ds_write_b32 v2, v22 offset:0
    ds_write_b32 v2, v23 offset:288
    v_smfmac_f32_16x16x64_bf16 v[28:31], v[52:55], a[120:127], v1
    v_smfmac_f32_16x16x64_bf16 v[32:35], v[52:55], a[128:135], v1
    s_waitcnt lgkmcnt(0)
    s_barrier
    ds_read_b128 v[40:43], v3 offset:0
    ds_read_b128 v[48:51], v3 offset:64
    ds_read_b128 v[20:23], v3 offset:128
    ds_read_b128 v[52:55], v3 offset:192
    v_smfmac_f32_16x16x64_bf16 v[28:31], v[36:39], a[136:143], v1
    v_smfmac_f32_16x16x64_bf16 v[32:35], v[36:39], a[144:151], v1
    ds_read_b128 v[36:39], v0 offset:17152
    v_lshlrev_b32 v9, 3, v0
    buffer_load_dword v11, v9, s[8:11], s68 offen
    v_smfmac_f32_16x16x64_bf16 v[28:31], v[44:47], a[168:175], v1
    v_smfmac_f32_16x16x64_bf16 v[32:35], v[44:47], a[176:183], v1
    ds_read_b128 v[44:47], v0 offset:18176
    s_waitcnt lgkmcnt(5)
    v_mfma_f32_16x16x32_bf16 v[12:15], v[56:59], v[40:43], 0
    v_mfma_f32_16x16x32_bf16 v[16:19], v[60:63], v[40:43], 0
    v_mfma_f32_16x16x32_bf16 v[24:27], v[40:43], v[40:43], 0
    ds_read_b128 v[56:59], v0 offset:19200
    ds_read_b128 v[60:63], v0 offset:20224
    s_waitcnt lgkmcnt(3)
    v_mfma_f32_16x16x32_bf16 v[12:15], v[36:39], v[48:51], v[12:15]
    v_lshrrev_b32 v10, 1, v0
    v_lshrrev_b32 v9, 9, v0
    s_waitcnt lgkmcnt(2)
    v_mfma_f32_16x16x32_bf16 v[16:19], v[44:47], v[48:51], v[16:19]
    v_lshl_add_u32 v9, v9, 5, v10
    v_add_f32 v28, v28, v30
    v_mfma_f32_16x16x32_bf16 v[24:27], v[48:51], v[48:51], v[24:27]
    v_add_f32 v32, v32, v34
    v_add_f32 v29, v29, v31
    ds_read_b128 v[36:39], v0 offset:21248
    ds_read_b128 v[44:47], v0 offset:22272
    s_waitcnt lgkmcnt(3)
    v_mfma_f32_16x16x32_bf16 v[12:15], v[56:59], v[20:23], v[12:15]
    v_add_f32 v33, v33, v35
    v_cvt_pk_bf16_f32 v30, v28, v29
    s_waitcnt lgkmcnt(2)
    v_mfma_f32_16x16x32_bf16 v[16:19], v[60:63], v[20:23], v[16:19]
    v_cvt_pk_bf16_f32 v31, v32, v33
    ds_read_b64 v[34:35], v9 offset:3456
    v_mfma_f32_16x16x32_bf16 v[24:27], v[20:23], v[20:23], v[24:27]
    s_add_u32 s17, s43, 3584
    buffer_store_dwordx2 v[30:31], v10, s[8:11], s17 offen sc1
    s_waitcnt lgkmcnt(2)
    v_mfma_f32_16x16x32_bf16 v[12:15], v[36:39], v[52:55], v[12:15]
    s_waitcnt lgkmcnt(1)
    v_mfma_f32_16x16x32_bf16 v[16:19], v[44:47], v[52:55], v[16:19]
    v_mfma_f32_16x16x32_bf16 v[24:27], v[52:55], v[52:55], v[24:27]
    s_add_u32 s17, s43, 1536
    s_waitcnt lgkmcnt(0)
    buffer_store_dwordx2 v[34:35], v10, s[8:11], s17 offen sc1
    s_cmp_eq_u32 s33, 63
    s_cbranch_scc1 Lr3s_last
    ds_read_b128 v[56:59], v8 offset:16384
    ds_read_b128 v[60:63], v8 offset:17408
    v_mov_b64 v[20:21], s[52:53]
    v_mov_b64 v[22:23], s[52:53]
    v_mov_b32 v41, 0
    v_mov_b32 v42, 0
    v_max3_f32 v9, v12, v13, v14
    v_max3_f32 v9, v9, v15, v16
    v_max3_f32 v9, v9, v17, v18
    v_max3_f32 v9, v9, v19, v24
    v_max_f32 v9, v9, v25
    v_mov_b32 v10, v9
    v_mov_b64 v[32:33], 0
    v_mov_b64 v[34:35], 0
    v_permlane32_swap_b32 v9, v10
    v_max_f32 v9, v9, v10
    v_mov_b32 v10, v9
    s_nop 1
    v_permlane16_swap_b32 v9, v10
    v_max_f32 v9, v9, v10
    v_mul_f32 v28, s44, v9
    v_fma_f32 v12, v12, s44, -v28
    v_fma_f32 v13, v13, s44, -v28
    v_fma_f32 v14, v14, s44, -v28
    v_fma_f32 v15, v15, s44, -v28
    v_exp_f32 v12, v12
    v_exp_f32 v13, v13
    v_fma_f32 v16, v16, s44, -v28
    v_fma_f32 v17, v17, s44, -v28
    v_exp_f32 v14, v14
    v_exp_f32 v15, v15
    v_cvt_pk_bf16_f32 v36, v12, v13
    v_fma_f32 v18, v18, s44, -v28
    v_fma_f32 v19, v19, s44, -v28
    v_exp_f32 v16, v16
    v_exp_f32 v17, v17
    v_cvt_pk_bf16_f32 v37, v14, v15
    v_fma_f32 v24, v24, s44, -v28
    v_fma_f32 v25, v25, s44, -v28
    v_exp_f32 v18, v18
    v_exp_f32 v19, v19
    v_cvt_pk_bf16_f32 v38, v16, v17
    v_exp_f32 v24, v24
    v_exp_f32 v25, v25
    v_cvt_pk_bf16_f32 v39, v18, v19
    v_cvt_pk_bf16_f32 v40, v24, v25
    v_cvt_pk_bf16_f32 v43, v24, v25
    v_mfma_f32_16x16x32_bf16 v[52:55], v[20:23], v[36:39], 0
    v_mov_b64 v[12:13], 0
    v_mov_b64 v[14:15], 0
    s_waitcnt vmcnt(4)
    v_mfma_f32_16x16x32_bf16 v[44:47], v[64:67], v[36:39], 0
    v_mov_b64 v[24:25], 0
    v_mov_b64 v[26:27], 0
    s_waitcnt vmcnt(3)
    v_mfma_f32_16x16x32_bf16 v[48:51], v[68:71], v[36:39], 0
    ds_read_b128 v[64:67], v8 offset:20480
    ds_read_b128 v[68:71], v8 offset:21504
    v_mfma_f32_16x16x16_bf16 v[52:55], v[20:21], v[40:41], v[52:55]
    v_mfma_f32_16x16x16_bf16 v[44:47], v[30:31], v[40:41], v[44:47]
    v_mov_b64 v[20:21], 0
    v_mov_b64 v[22:23], 0
    v_mfma_f32_16x16x16_bf16 v[48:51], v[30:31], v[42:43], v[48:51]
    v_mov_b64 v[36:37], 0
    v_mov_b64 v[38:39], 0
    v_mov_b64 v[40:41], 0
    v_mov_b64 v[42:43], 0
    v_rcp_f32 v9, v52
    v_mov_b64 v[52:53], 0
    v_mov_b64 v[54:55], 0
    v_mul_f32 v44, v9, v44
    v_mul_f32 v48, v9, v48
    v_cvt_pk_bf16_f32 v16, v44, v48
    v_mul_f32 v45, v9, v45
    v_mul_f32 v49, v9, v49
    v_cvt_pk_bf16_f32 v17, v45, v49
    v_mul_f32 v46, v9, v46
    v_mul_f32 v50, v9, v50
    v_cvt_pk_bf16_f32 v18, v46, v50
    v_mul_f32 v47, v9, v47
    v_mul_f32 v51, v9, v51
    v_cvt_pk_bf16_f32 v19, v47, v51
    ds_write_b128 v5, v[16:19]
    v_mov_b64 v[28:29], 0
    v_mov_b64 v[30:31], 0
    s_waitcnt lgkmcnt(0)
    s_barrier
    ds_read_b128 v[44:47], v4 offset:0
    ds_read_b128 v[48:51], v4 offset:128
    v_mov_b64 v[16:17], 0
    v_mov_b64 v[18:19], 0
    buffer_load_dwordx4 v0, s[8:11], s41 offen offset:0 lds
    buffer_load_dwordx4 v0, s[8:11], s41 offen offset:1024 lds
    s_waitcnt lgkmcnt(1)
    v_smfmac_f32_16x16x64_bf16 v[12:15], v[44:47], a[184:191], v1
    s_waitcnt lgkmcnt(0)
    v_smfmac_f32_16x16x64_bf16 v[12:15], v[48:51], a[192:199], v1
    v_smfmac_f32_16x16x64_bf16 v[24:27], v[44:47], a[200:207], v1
    v_smfmac_f32_16x16x64_bf16 v[24:27], v[48:51], a[208:215], v1
    v_add_f32 v12, v12, v14
    v_smfmac_f32_16x16x64_bf16 v[20:23], v[44:47], a[216:223], v1
    v_add_f32 v13, v13, v15
    v_smfmac_f32_16x16x64_bf16 v[20:23], v[48:51], a[224:231], v1
    v_cvt_pk_bf16_f32 v12, v12, v13
    v_smfmac_f32_16x16x64_bf16 v[16:19], v[44:47], a[232:239], v1
    v_add_f32 v24, v24, v26
    v_smfmac_f32_16x16x64_bf16 v[16:19], v[48:51], a[240:247], v1
    v_add_f32 v25, v25, v27
    v_smfmac_f32_16x16x64_bf16 v[36:39], v[44:47], v[56:63], v1
    v_cvt_pk_bf16_f32 v13, v24, v25
    v_smfmac_f32_16x16x64_bf16 v[36:39], v[48:51], v[64:71], v1
    v_add_f32 v20, v20, v22
    v_add_f32 v21, v21, v23
    v_cvt_pk_bf16_f32 v14, v20, v21
    v_add_f32 v16, v16, v18
    v_add_f32 v17, v17, v19
    v_cvt_pk_bf16_f32 v15, v16, v17
    v_and_or_b32 v15, v15, -2, s40
    buffer_store_dwordx4 v[12:15], v0, s[8:11], s38 offen sc1
    s_nop 0
    ds_read_b128 v[12:15], v8 offset:18432
    ds_read_b128 v[16:19], v8 offset:19456
    ds_read_b128 v[20:23], v8 offset:22528
    ds_read_b128 v[24:27], v8 offset:23552
    ds_read_b128 v[56:59], v8 offset:24576
    ds_read_b128 v[60:63], v8 offset:25600
    ds_read_b128 v[64:67], v8 offset:28672
    ds_read_b128 v[68:71], v8 offset:29696
    s_waitcnt lgkmcnt(6)
    v_smfmac_f32_16x16x64_bf16 v[40:43], v[44:47], v[12:19], v1
    ds_read_b128 v[12:15], v8 offset:26624
    ds_read_b128 v[16:19], v8 offset:27648
    s_waitcnt lgkmcnt(6)
    v_smfmac_f32_16x16x64_bf16 v[40:43], v[48:51], v[20:27], v1
    ds_read_b128 v[20:23], v8 offset:30720
    ds_read_b128 v[24:27], v8 offset:31744
    s_waitcnt lgkmcnt(6)
    v_smfmac_f32_16x16x64_bf16 v[52:55], v[44:47], v[56:63], v1
    ds_read_b128 v[56:59], v8 offset:32768
    ds_read_b128 v[60:63], v8 offset:33792
    s_waitcnt lgkmcnt(6)
    v_smfmac_f32_16x16x64_bf16 v[52:55], v[48:51], v[64:71], v1
    s_waitcnt lgkmcnt(4)
    v_smfmac_f32_16x16x64_bf16 v[32:35], v[44:47], v[12:19], v1
    s_waitcnt lgkmcnt(2)
    v_smfmac_f32_16x16x64_bf16 v[32:35], v[48:51], v[20:27], v1
    v_smfmac_f32_16x16x64_bf16 v[28:31], v[44:47], a[248:255], v1
    s_waitcnt lgkmcnt(0)
    v_smfmac_f32_16x16x64_bf16 v[28:31], v[48:51], v[56:63], v1
    v_add_f32 v36, v36, v38
    v_add_f32 v37, v37, v39
    v_cvt_pk_bf16_f32 v36, v36, v37
    v_add_f32 v40, v40, v42
    v_add_f32 v41, v41, v43
    v_cvt_pk_bf16_f32 v37, v40, v41
    v_add_f32 v52, v52, v54
    v_add_f32 v53, v53, v55
    v_cvt_pk_bf16_f32 v38, v52, v53
    v_add_f32 v32, v32, v34
    v_add_f32 v33, v33, v35
    v_cvt_pk_bf16_f32 v39, v32, v33
    v_and_or_b32 v39, v39, -2, s40
    s_add_u32 s17, s38, 4096
    buffer_store_dwordx4 v[36:39], v0, s[8:11], s17 offen sc1
    v_add_f32 v28, v28, v30
    v_add_f32 v29, v29, v31
    v_cvt_pk_bf16_f32 v28, v28, v29
    v_and_or_b32 v28, v28, -2, s40
    v_lshrrev_b32 v9, 2, v0
    buffer_store_dword v28, v9, s[8:11], s39 offen sc1
    s_xor_b32 s34, s34, 16384
    s_xor_b32 s35, s35, 16384
    s_add_u32 s33, s33, 1
    s_add_u32 s42, s42, 262144
    s_add_u32 s41, s41, 262144
    s_add_u32 s43, s43, 131072
    s_add_u32 s68, s68, 262144
    s_add_u32 s66, s66, 22528
    s_xor_b32 s40, s40, 1
    ds_read_b128 v[56:59], v8 offset:0
    ds_read_b128 v[60:63], v8 offset:1024
    ds_read_b128 v[64:67], v8 offset:2048
    ds_read_b128 v[68:71], v8 offset:3072
    v_mov_b64 v[12:13], 0
    v_mov_b64 v[14:15], 0
    v_mov_b64 v[16:17], 0
    v_mov_b64 v[18:19], 0
    v_mov_b64 v[20:21], 0
    v_mov_b64 v[22:23], 0
    v_mov_b64 v[24:25], 0
    v_mov_b64 v[26:27], 0
    v_mov_b64 v[28:29], 0
    v_mov_b64 v[30:31], 0
    v_mov_b64 v[32:33], 0
    v_mov_b64 v[34:35], 0
    s_sleep 5
    s_nop 9
    buffer_load_dwordx4 v[36:39], v0, s[8:11], s34 offen sc1
    s_nop 15
    s_nop 8
    buffer_load_dwordx4 v[36:39], v0, s[8:11], s34 offen sc1
    s_nop 15
    s_nop 8
    buffer_load_dwordx4 v[36:39], v0, s[8:11], s34 offen sc1
    s_waitcnt lgkmcnt(0)
    s_branch Lr3s_step
Lr3s_pb_re:
    s_mov_b32 s16, 0
Lr3s_pb_lp:
    s_add_u32 s17, s34, 4096
    buffer_load_dwordx4 v[40:43], v0, s[8:11], s17 offen sc1
    s_add_u32 s16, s16, 1
    s_cmp_gt_u32 s16, 100000
    s_cbranch_scc1 Lr_abort
    s_waitcnt vmcnt(0)
    v_max3_u32 v10, v40, v41, v42
    v_max_u32 v10, v10, v43
    v_cmp_eq_u32 vcc, -1, v10
    s_nop 0
    s_cbranch_vccnz Lr3s_pb_lp
    s_branch Lr3s_pb_ok
Lr3s_pc_re:
    s_mov_b32 s16, 0
Lr3s_pc_lp:
    buffer_load_dwordx4 v[44:47], v0, s[8:11], s35 offen sc1
    s_add_u32 s16, s16, 1
    s_cmp_gt_u32 s16, 100000
    s_cbranch_scc1 Lr_abort
    s_waitcnt vmcnt(0)
    v_max3_u32 v10, v44, v45, v46
    v_max_u32 v10, v10, v47
    v_cmp_eq_u32 vcc, -1, v10
    s_nop 0
    s_cbranch_vccnz Lr3s_pc_lp
    s_branch Lr3s_pc_ok
Lr3s_last:
    s_waitcnt vmcnt(0) lgkmcnt(0)
    s_barrier
    s_branch Lr_exit
Lr_abort:
    s_waitcnt lgkmcnt(0)
    s_mov_b64 exec, -1
    v_mov_b32 v0, 60
    s_lshl_b32 s5, s3, 8
    s_or_b32 s5, s5, s4
    s_or_b32 s5, s5, 0x10000
    v_mov_b32 v1, s5
    global_store_dword v0, v1, s[12:13]
    s_endpgm
Lr_exit:
    s_endpgm
.section .rodata,"a"
.p2align 6
.amdhsa_kernel interleave_layers__sliding_local_dilated__memory_aug_recurrent_mem_tr__prompt_kernel
  .amdhsa_next_free_vgpr 512
  .amdhsa_next_free_sgpr 102
  .amdhsa_accum_offset 256
  .amdhsa_group_segment_fixed_size 0
  .amdhsa_kernarg_size 104
  .amdhsa_user_sgpr_count 2
  .amdhsa_user_sgpr_kernarg_segment_ptr 1
  .amdhsa_system_sgpr_workgroup_id_x 1
.end_amdhsa_kernel
```

```asm
; @launch grid=(256,1,1) block=(256,1,1) lds=163840
.amdgcn_target "amdgcn-amd-amdhsa--gfx950"
.text
.globl interleave_layers__sliding_local_dilated__memory_aug_recurrent_mem_tr__prompt_kernel
.p2align 8
.type interleave_layers__sliding_local_dilated__memory_aug_recurrent_mem_tr__prompt_kernel,@function
interleave_layers__sliding_local_dilated__memory_aug_recurrent_mem_tr__prompt_kernel:
    s_cmp_ge_u32 s2, 256
    s_cbranch_scc1 L_exit
    s_load_dwordx2 s[8:9], s[0:1], 96
    s_mov_b32 s10, 268435456
    s_mov_b32 s11, 0x00020000
    s_waitcnt lgkmcnt(0)
    s_and_b32 s9, s9, 0xffff
    s_load_dwordx2 s[12:13], s[0:1], 88
    v_lshrrev_b32 v1, 6, v0
    s_getreg_b32 s3, hwreg(HW_REG_XCC_ID)
    v_readfirstlane_b32 s14, v1
    s_and_b32 s3, s3, 7
    s_and_b32 s17, s3, 1
    s_lshl_b32 s17, s17, 7
    s_lshl_b32 s18, s3, 1
    s_and_b32 s18, s18, 12
    s_add_u32 s17, s17, s18
    v_mov_b32 v2, 0
    v_mov_b32 v3, 1
    v_mov_b32 v4, s17
    s_mov_b32 s33, 0
    s_waitcnt lgkmcnt(0)
    s_cmp_lg_u32 s14, 0
    s_cbranch_scc1 L_tk_wait
    s_mov_b64 exec, 1
    global_atomic_add v3, v4, v3, s[12:13] sc0
    s_waitcnt vmcnt(0)
    v_readfirstlane_b32 s4, v3
    s_nop 0
    s_cmp_lt_u32 s4, 32
    s_cbranch_scc1 L_tk_have
    v_mov_b32 v3, 1
    v_mov_b32 v4, 32
    global_atomic_add v3, v4, v3, s[12:13] sc0
    s_waitcnt vmcnt(0)
    v_readfirstlane_b32 s5, v3
    s_mov_b64 exec, 0xff
    v_and_b32 v4, 1, v0
    v_lshlrev_b32 v4, 7, v4
    v_lshlrev_b32 v5, 1, v0
    v_and_or_b32 v4, v5, 12, v4
    s_mov_b32 s16, 0
L_hl_poll:
    global_load_dword v5, v4, s[12:13] sc1
    s_add_u32 s16, s16, 1
    s_cmp_gt_u32 s16, 100000
    s_cbranch_scc1 L_abort
    s_mov_b32 s6, 0
    s_waitcnt vmcnt(0)
    v_readlane_b32 s40, v5, 0
    s_nop 0
    s_add_u32 s6, s6, s40
    v_readlane_b32 s41, v5, 1
    s_nop 0
    s_add_u32 s6, s6, s41
    v_readlane_b32 s42, v5, 2
    s_nop 0
    s_add_u32 s6, s6, s42
    v_readlane_b32 s43, v5, 3
    s_nop 0
    s_add_u32 s6, s6, s43
    v_readlane_b32 s44, v5, 4
    s_nop 0
    s_add_u32 s6, s6, s44
    v_readlane_b32 s45, v5, 5
    s_nop 0
    s_add_u32 s6, s6, s45
    v_readlane_b32 s46, v5, 6
    s_nop 0
    s_add_u32 s6, s6, s46
    v_readlane_b32 s47, v5, 7
    s_nop 0
    s_add_u32 s6, s6, s47
    s_cmp_lt_u32 s6, 256
    s_cbranch_scc1 L_hl_poll
    s_mov_b32 s3, 0
    s_mov_b32 s4, 0
    s_min_u32 s6, s47, 32
    s_sub_u32 s7, 32, s6
    s_cmp_lt_u32 s5, s7
    s_cselect_b32 s3, 7, s3
    s_add_u32 s6, s6, s5
    s_cmp_lt_u32 s5, s7
    s_cselect_b32 s4, s6, s4
    s_sub_u32 s5, s5, s7
    s_min_u32 s6, s46, 32
    s_sub_u32 s7, 32, s6
    s_cmp_lt_u32 s5, s7
    s_cselect_b32 s3, 6, s3
    s_add_u32 s6, s6, s5
    s_cmp_lt_u32 s5, s7
    s_cselect_b32 s4, s6, s4
    s_sub_u32 s5, s5, s7
    s_min_u32 s6, s45, 32
    s_sub_u32 s7, 32, s6
    s_cmp_lt_u32 s5, s7
    s_cselect_b32 s3, 5, s3
    s_add_u32 s6, s6, s5
    s_cmp_lt_u32 s5, s7
    s_cselect_b32 s4, s6, s4
    s_sub_u32 s5, s5, s7
    s_min_u32 s6, s44, 32
    s_sub_u32 s7, 32, s6
    s_cmp_lt_u32 s5, s7
    s_cselect_b32 s3, 4, s3
    s_add_u32 s6, s6, s5
    s_cmp_lt_u32 s5, s7
    s_cselect_b32 s4, s6, s4
    s_sub_u32 s5, s5, s7
    s_min_u32 s6, s43, 32
    s_sub_u32 s7, 32, s6
    s_cmp_lt_u32 s5, s7
    s_cselect_b32 s3, 3, s3
    s_add_u32 s6, s6, s5
    s_cmp_lt_u32 s5, s7
    s_cselect_b32 s4, s6, s4
    s_sub_u32 s5, s5, s7
    s_min_u32 s6, s42, 32
    s_sub_u32 s7, 32, s6
    s_cmp_lt_u32 s5, s7
    s_cselect_b32 s3, 2, s3
    s_add_u32 s6, s6, s5
    s_cmp_lt_u32 s5, s7
    s_cselect_b32 s4, s6, s4
    s_sub_u32 s5, s5, s7
    s_min_u32 s6, s41, 32
    s_sub_u32 s7, 32, s6
    s_cmp_lt_u32 s5, s7
    s_cselect_b32 s3, 1, s3
    s_add_u32 s6, s6, s5
    s_cmp_lt_u32 s5, s7
    s_cselect_b32 s4, s6, s4
    s_sub_u32 s5, s5, s7
    s_min_u32 s6, s40, 32
    s_sub_u32 s7, 32, s6
    s_cmp_lt_u32 s5, s7
    s_cselect_b32 s3, 0, s3
    s_add_u32 s6, s6, s5
    s_cmp_lt_u32 s5, s7
    s_cselect_b32 s4, s6, s4
    s_sub_u32 s5, s5, s7
L_tk_have:
    s_lshl_b32 s5, s3, 8
    s_or_b32 s5, s5, s4
    v_mov_b32 v3, s5
    s_mov_b64 exec, 1
    ds_write_b32 v2, v3
    s_mov_b64 exec, -1
L_tk_wait:
    s_waitcnt vmcnt(0) lgkmcnt(0)
    s_barrier
    ds_read_b32 v3, v2
    s_waitcnt lgkmcnt(0)
    v_readfirstlane_b32 s5, v3
    s_nop 0
    s_lshr_b32 s3, s5, 8
    s_and_b32 s4, s5, 255
    s_barrier
    s_cmp_lt_u32 s3, 2
    s_cbranch_scc1 L_role_r
    s_sub_u32 s6, s3, 2
    s_lshl_b32 s6, s6, 5
    s_add_u32 s6, s6, s4
    s_load_dwordx2 s[20:21], s[0:1], 8
    s_mov_b32 s22, 1990656
    s_mov_b32 s23, 0x00020000
    s_waitcnt lgkmcnt(0)
    s_and_b32 s21, s21, 0xffff
    s_load_dwordx2 s[24:25], s[0:1], 16
    s_mov_b32 s26, 663552
    s_mov_b32 s27, 0x00020000
    s_waitcnt lgkmcnt(0)
    s_and_b32 s25, s25, 0xffff
    s_sub_u32 s41, 191, s6
    s_lshl_b32 s41, s41, 15
    v_lshlrev_b32 v254, 7, v0
    buffer_load_dword v255, v254, s[20:23], s41 offen
    s_sub_u32 s41, s41, 1998848
    s_cmp_lt_u32 s41, 688128
    s_cselect_b32 s41, s41, 0x7f000000
    s_waitcnt vmcnt(0)
    buffer_load_dword v255, v254, s[24:27], s41 offen
    s_cmp_ge_u32 s6, 192
    s_cbranch_scc1 Li_end
    s_sub_u32 s41, s6, 64
    s_cmp_lt_u32 s41, 64
    s_cbranch_scc1 Li_end
Li_body:
    v_lshlrev_b32 v7, 4, v0
    v_mov_b32 v12, 0
    v_mov_b32 v13, 0
    v_mov_b32 v14, 0
    v_mov_b32 v15, 0
    s_cmp_ge_u32 s6, 64
    s_cbranch_scc1 Li_rest
    s_load_dwordx2 s[20:21], s[0:1], 0
    s_mov_b32 s22, 2359296
    s_mov_b32 s23, 0x00020000
    s_waitcnt lgkmcnt(0)
    s_and_b32 s21, s21, 0xffff
    v_and_b32 v1, 31, v0
    v_lshrrev_b32 v2, 5, v0
    v_mul_u32_u24 v3, 1152, v1
    v_mul_u32_u24 v5, 144, v2
    v_add_u32 v3, v3, v5
    s_mul_i32 s41, s6, 36864
    buffer_load_dwordx4 v[64:67], v3, s[20:23], s41 offen offset:0
    buffer_load_dwordx4 v[68:71], v3, s[20:23], s41 offen offset:16
    buffer_load_dwordx4 v[72:75], v3, s[20:23], s41 offen offset:32
    buffer_load_dwordx4 v[76:79], v3, s[20:23], s41 offen offset:48
    buffer_load_dwordx4 v[80:83], v3, s[20:23], s41 offen offset:64
    buffer_load_dwordx4 v[84:87], v3, s[20:23], s41 offen offset:80
    buffer_load_dwordx4 v[88:91], v3, s[20:23], s41 offen offset:96
    buffer_load_dwordx4 v[92:95], v3, s[20:23], s41 offen offset:112
    buffer_load_dwordx4 v[96:99], v3, s[20:23], s41 offen offset:128
    v_mul_u32_u24 v4, 4608, v2
    v_lshl_add_u32 v4, v1, 4, v4
    s_mul_i32 s41, s6, 36864
    s_add_u32 s41, s41, 6291456
    s_mul_i32 s42, s6, 6144
    s_add_u32 s42, s42, 15728640
    s_add_u32 s43, s42, 2048
    s_add_u32 s44, s42, 396288
    v_mov_b32 v60, 0
    v_mov_b32 v61, 0
    s_waitcnt vmcnt(8)
    buffer_store_dwordx4 v[64:67], v4, s[8:11], s41 offen offset:0 sc1
    s_waitcnt vmcnt(8)
    buffer_store_dwordx4 v[68:71], v4, s[8:11], s41 offen offset:512 sc1
    s_waitcnt vmcnt(8)
    buffer_store_dwordx4 v[72:75], v4, s[8:11], s41 offen offset:1024 sc1
    s_waitcnt vmcnt(8)
    buffer_store_dwordx4 v[76:79], v4, s[8:11], s41 offen offset:1536 sc1
    s_waitcnt vmcnt(8)
    buffer_store_dwordx4 v[80:83], v4, s[8:11], s41 offen offset:2048 sc1
    s_waitcnt vmcnt(8)
    buffer_store_dwordx4 v[84:87], v4, s[8:11], s41 offen offset:2560 sc1
    s_waitcnt vmcnt(8)
    buffer_store_dwordx4 v[88:91], v4, s[8:11], s41 offen offset:3072 sc1
    s_waitcnt vmcnt(8)
    buffer_store_dwordx4 v[92:95], v4, s[8:11], s41 offen offset:3584 sc1
    v_add_u32 v4, 4096, v4
    s_waitcnt vmcnt(8)
    buffer_store_dwordx4 v[96:99], v4, s[8:11], s41 offen offset:0 sc1
    buffer_store_dwordx4 v[12:15], v7, s[8:11], s43 offen sc1
    v_cmp_gt_u32 vcc, 192, v0
    s_nop 0
    s_and_saveexec_b64 s[46:47], vcc
    s_cbranch_execz Li_z1
    buffer_store_dwordx4 v[12:15], v7, s[8:11], s44 offen sc1
Li_z1:
    s_mov_b64 exec, s[46:47]
    v_mov_b32 v62, 0x3f803f80
    v_dot2c_f32_bf16 v60, v64, v62
    v_dot2c_f32_bf16 v61, v64, v64
    v_dot2c_f32_bf16 v60, v65, v62
    v_dot2c_f32_bf16 v61, v65, v65
    v_dot2c_f32_bf16 v60, v66, v62
    v_dot2c_f32_bf16 v61, v66, v66
    v_dot2c_f32_bf16 v60, v67, v62
    v_dot2c_f32_bf16 v61, v67, v67
    v_dot2c_f32_bf16 v60, v68, v62
    v_dot2c_f32_bf16 v61, v68, v68
    v_dot2c_f32_bf16 v60, v69, v62
    v_dot2c_f32_bf16 v61, v69, v69
    v_dot2c_f32_bf16 v60, v70, v62
    v_dot2c_f32_bf16 v61, v70, v70
    v_dot2c_f32_bf16 v60, v71, v62
    v_dot2c_f32_bf16 v61, v71, v71
    v_dot2c_f32_bf16 v60, v72, v62
    v_dot2c_f32_bf16 v61, v72, v72
    v_dot2c_f32_bf16 v60, v73, v62
    v_dot2c_f32_bf16 v61, v73, v73
    v_dot2c_f32_bf16 v60, v74, v62
    v_dot2c_f32_bf16 v61, v74, v74
    v_dot2c_f32_bf16 v60, v75, v62
    v_dot2c_f32_bf16 v61, v75, v75
    v_dot2c_f32_bf16 v60, v76, v62
    v_dot2c_f32_bf16 v61, v76, v76
    v_dot2c_f32_bf16 v60, v77, v62
    v_dot2c_f32_bf16 v61, v77, v77
    v_dot2c_f32_bf16 v60, v78, v62
    v_dot2c_f32_bf16 v61, v78, v78
    v_dot2c_f32_bf16 v60, v79, v62
    v_dot2c_f32_bf16 v61, v79, v79
    v_dot2c_f32_bf16 v60, v80, v62
    v_dot2c_f32_bf16 v61, v80, v80
    v_dot2c_f32_bf16 v60, v81, v62
    v_dot2c_f32_bf16 v61, v81, v81
    v_dot2c_f32_bf16 v60, v82, v62
    v_dot2c_f32_bf16 v61, v82, v82
    v_dot2c_f32_bf16 v60, v83, v62
    v_dot2c_f32_bf16 v61, v83, v83
    v_dot2c_f32_bf16 v60, v84, v62
    v_dot2c_f32_bf16 v61, v84, v84
    v_dot2c_f32_bf16 v60, v85, v62
    v_dot2c_f32_bf16 v61, v85, v85
    v_dot2c_f32_bf16 v60, v86, v62
    v_dot2c_f32_bf16 v61, v86, v86
    v_dot2c_f32_bf16 v60, v87, v62
    v_dot2c_f32_bf16 v61, v87, v87
    v_dot2c_f32_bf16 v60, v88, v62
    v_dot2c_f32_bf16 v61, v88, v88
    v_dot2c_f32_bf16 v60, v89, v62
    v_dot2c_f32_bf16 v61, v89, v89
    v_dot2c_f32_bf16 v60, v90, v62
    v_dot2c_f32_bf16 v61, v90, v90
    v_dot2c_f32_bf16 v60, v91, v62
    v_dot2c_f32_bf16 v61, v91, v91
    v_dot2c_f32_bf16 v60, v92, v62
    v_dot2c_f32_bf16 v61, v92, v92
    v_dot2c_f32_bf16 v60, v93, v62
    v_dot2c_f32_bf16 v61, v93, v93
    v_dot2c_f32_bf16 v60, v94, v62
    v_dot2c_f32_bf16 v61, v94, v94
    v_dot2c_f32_bf16 v60, v95, v62
    v_dot2c_f32_bf16 v61, v95, v95
    v_dot2c_f32_bf16 v60, v96, v62
    v_dot2c_f32_bf16 v61, v96, v96
    v_dot2c_f32_bf16 v60, v97, v62
    v_dot2c_f32_bf16 v61, v97, v97
    v_dot2c_f32_bf16 v60, v98, v62
    v_dot2c_f32_bf16 v61, v98, v98
    v_dot2c_f32_bf16 v60, v99, v62
    v_dot2c_f32_bf16 v61, v99, v99
    s_nop 3
    v_lshrrev_b32 v5, 1, v2
    v_lshlrev_b32 v5, 9, v5
    v_lshl_add_u32 v5, v1, 4, v5
    v_and_b32 v6, 1, v2
    v_lshl_add_u32 v5, v6, 3, v5
    buffer_store_dwordx2 v[60:61], v5, s[8:11], s42 offen sc1
    s_branch Li_flags
Li_rest:
    s_cmp_ge_u32 s6, 128
    s_cbranch_scc1 Li_pre
    s_sub_u32 s41, s6, 64
    s_mul_i32 s41, s41, 6144
    s_add_u32 s41, s41, 16911360
    v_cmp_gt_u32 vcc, 192, v0
    s_nop 0
    s_and_saveexec_b64 s[42:43], vcc
    s_cbranch_execz Li_rest2
    buffer_store_dwordx4 v[12:15], v7, s[8:11], s41 offen sc1
Li_rest2:
    s_mov_b64 exec, s[42:43]
    s_load_dwordx2 s[20:21], s[0:1], 80
    s_mov_b32 s22, 2359296
    s_mov_b32 s23, 0x00020000
    s_waitcnt lgkmcnt(0)
    s_and_b32 s21, s21, 0xffff
    s_sub_u32 s44, s6, 64
    s_mul_i32 s45, s44, 36864
    s_add_u32 s46, s45, 19660800
    buffer_store_dwordx4 v[12:15], v7, s[8:11], s46 offen sc1
    buffer_store_dwordx4 v[12:15], v7, s[20:23], s45 offen sc1
    s_add_u32 s46, s46, 4096
    s_add_u32 s45, s45, 4096
    buffer_store_dwordx4 v[12:15], v7, s[8:11], s46 offen sc1
    buffer_store_dwordx4 v[12:15], v7, s[20:23], s45 offen sc1
    s_add_u32 s46, s46, 4096
    s_add_u32 s45, s45, 4096
    buffer_store_dwordx4 v[12:15], v7, s[8:11], s46 offen sc1
    buffer_store_dwordx4 v[12:15], v7, s[20:23], s45 offen sc1
    s_add_u32 s46, s46, 4096
    s_add_u32 s45, s45, 4096
    buffer_store_dwordx4 v[12:15], v7, s[8:11], s46 offen sc1
    buffer_store_dwordx4 v[12:15], v7, s[20:23], s45 offen sc1
    s_add_u32 s46, s46, 4096
    s_add_u32 s45, s45, 4096
    buffer_store_dwordx4 v[12:15], v7, s[8:11], s46 offen sc1
    buffer_store_dwordx4 v[12:15], v7, s[20:23], s45 offen sc1
    s_add_u32 s46, s46, 4096
    s_add_u32 s45, s45, 4096
    buffer_store_dwordx4 v[12:15], v7, s[8:11], s46 offen sc1
    buffer_store_dwordx4 v[12:15], v7, s[20:23], s45 offen sc1
    s_add_u32 s46, s46, 4096
    s_add_u32 s45, s45, 4096
    buffer_store_dwordx4 v[12:15], v7, s[8:11], s46 offen sc1
    buffer_store_dwordx4 v[12:15], v7, s[20:23], s45 offen sc1
    s_add_u32 s46, s46, 4096
    s_add_u32 s45, s45, 4096
    buffer_store_dwordx4 v[12:15], v7, s[8:11], s46 offen sc1
    buffer_store_dwordx4 v[12:15], v7, s[20:23], s45 offen sc1
    s_add_u32 s46, s46, 4096
    s_add_u32 s45, s45, 4096
    buffer_store_dwordx4 v[12:15], v7, s[8:11], s46 offen sc1
    buffer_store_dwordx4 v[12:15], v7, s[20:23], s45 offen sc1
    s_mul_i32 s45, s44, 6144
    s_add_u32 s45, s45, 16515072
    buffer_store_dwordx4 v[12:15], v7, s[8:11], s45 offen sc1
    s_add_u32 s46, s45, 4096
    s_add_u32 s45, s45, 393216
    buffer_store_dwordx4 v[12:15], v7, s[8:11], s45 offen sc1
    v_cmp_gt_u32 vcc, 128, v0
    s_nop 0
    s_and_saveexec_b64 s[42:43], vcc
    s_cbranch_execz Li_rest3
    buffer_store_dwordx4 v[12:15], v7, s[8:11], s46 offen sc1
Li_rest3:
    s_mov_b64 exec, s[42:43]
    s_branch Li_flags
Li_pre:
    s_sub_u32 s44, s6, 128
    s_mul_i32 s45, s44, 36864
    s_add_u32 s45, s45, 17301504
    buffer_store_dwordx4 v[12:15], v7, s[8:11], s45 offen sc1
    s_add_u32 s45, s45, 4096
    buffer_store_dwordx4 v[12:15], v7, s[8:11], s45 offen sc1
    s_add_u32 s45, s45, 4096
    buffer_store_dwordx4 v[12:15], v7, s[8:11], s45 offen sc1
    s_add_u32 s45, s45, 4096
    buffer_store_dwordx4 v[12:15], v7, s[8:11], s45 offen sc1
    s_add_u32 s45, s45, 4096
    buffer_store_dwordx4 v[12:15], v7, s[8:11], s45 offen sc1
    s_add_u32 s45, s45, 4096
    buffer_store_dwordx4 v[12:15], v7, s[8:11], s45 offen sc1
    s_add_u32 s45, s45, 4096
    buffer_store_dwordx4 v[12:15], v7, s[8:11], s45 offen sc1
    s_add_u32 s45, s45, 4096
    buffer_store_dwordx4 v[12:15], v7, s[8:11], s45 offen sc1
    s_add_u32 s45, s45, 4096
    buffer_store_dwordx4 v[12:15], v7, s[8:11], s45 offen sc1
    s_mul_i32 s45, s44, 6144
    s_add_u32 s45, s45, 16121856
    v_cmp_gt_u32 vcc, 192, v0
    s_nop 0
    s_and_saveexec_b64 s[46:47], vcc
    s_cbranch_execz Li_z0
    buffer_store_dwordx4 v[12:15], v7, s[8:11], s45 offen sc1
Li_z0:
    s_mov_b64 exec, s[46:47]
    s_cmp_ge_u32 s6, 136
    s_cbranch_scc1 Li_nofl
Li_flags:
    v_cmp_gt_u32 vcc, 96, v0
    s_cmp_lt_u32 s6, 64
    s_cselect_b64 s[42:43], -1, 0
    s_and_b64 vcc, vcc, s[42:43]
    s_cmp_lt_u32 s6, 128
    s_cselect_b32 s44, 0, 0
    v_mov_b32 v12, s44
    v_mov_b32 v13, s44
    v_mov_b32 v14, s44
    v_mov_b32 v15, s44
    v_mov_b32 v9, 1
    v_cndmask_b32 v8, v12, v9, vcc
    v_mov_b32 v9, v8
    v_mov_b32 v10, v8
    v_mov_b32 v11, v8
    s_mul_i32 s41, s6, 22528
    s_sub_u32 s42, s6, 128
    s_lshl_b32 s42, s42, 12
    s_add_u32 s42, s42, 2883584
    s_cmp_ge_u32 s6, 128
    s_cselect_b32 s41, s42, s41
    buffer_store_dwordx4 v[8:11], v7, s[8:11], s41 offen sc1
    s_cbranch_scc1 Li_nofl
    s_add_u32 s41, s41, 4096
    buffer_store_dwordx4 v[12:15], v7, s[8:11], s41 offen sc1
    s_add_u32 s41, s41, 4096
    buffer_store_dwordx4 v[12:15], v7, s[8:11], s41 offen sc1
    s_add_u32 s41, s41, 4096
    buffer_store_dwordx4 v[12:15], v7, s[8:11], s41 offen sc1
    s_add_u32 s41, s41, 4096
    buffer_store_dwordx4 v[12:15], v7, s[8:11], s41 offen sc1
    s_add_u32 s41, s41, 4096
    v_cmp_gt_u32 vcc, 128, v0
    s_nop 0
    s_and_saveexec_b64 s[42:43], vcc
    s_cbranch_execz Li_fl5
    buffer_store_dwordx4 v[12:15], v7, s[8:11], s41 offen sc1
Li_fl5:
    s_mov_b64 exec, s[42:43]
Li_nofl:
    s_waitcnt vmcnt(0)
    s_barrier
    s_cmp_lg_u32 s14, 0
    s_cbranch_scc1 Li_cnt
    s_sub_u32 s41, s6, 64
    s_cmp_lt_u32 s41, 64
    s_cbranch_scc1 Li_l1
    v_mov_b32 v2, 40
    v_mov_b32 v3, 1
    s_mov_b64 exec, 1
    global_atomic_add v2, v3, s[12:13]
    s_mov_b64 exec, -1
    s_branch Li_cnt
Li_l1:
    v_mov_b32 v2, 160
    v_mov_b32 v3, 1
    s_mov_b64 exec, 1
    global_atomic_add v2, v3, s[12:13]
    s_mov_b64 exec, -1
Li_cnt:
    s_cmp_lt_u32 s6, 128
    s_cbranch_scc1 Li_end
    s_sub_u32 s6, s6, 64
    s_branch Li_body
Li_end:
    s_cmp_lg_u32 s3, 2
    s_cbranch_scc1 L_cls2_no
    s_add_u32 s15, s4, 0
    s_cmp_lt_u32 s4, 24
    s_cbranch_scc1 L_role_tw
    s_add_u32 s15, s4, 4294967272
    s_cmp_lt_u32 s4, 32
    s_cbranch_scc1 L_role_p
    s_endpgm
L_cls2_no:
    s_cmp_lg_u32 s3, 3
    s_cbranch_scc1 L_cls3_no
    s_add_u32 s15, s4, 24
    s_cmp_lt_u32 s4, 12
    s_cbranch_scc1 L_role_tw
    s_add_u32 s15, s4, 4294967292
    s_cmp_lt_u32 s4, 32
    s_cbranch_scc1 L_role_p
    s_endpgm
L_cls3_no:
    s_cmp_lg_u32 s3, 4
    s_cbranch_scc1 L_cls4_no
    s_add_u32 s15, s4, 0
    s_cmp_lt_u32 s4, 16
    s_cbranch_scc1 L_role_aq
    s_add_u32 s15, s4, 4294967280
    s_cmp_lt_u32 s4, 19
    s_cbranch_scc1 L_role_awo
    s_add_u32 s15, s4, 9
    s_cmp_lt_u32 s4, 32
    s_cbranch_scc1 L_role_p
    s_endpgm
L_cls4_no:
    s_cmp_lg_u32 s3, 5
    s_cbranch_scc1 L_cls5_no
    s_add_u32 s15, s4, 16
    s_cmp_lt_u32 s4, 16
    s_cbranch_scc1 L_role_aq
    s_add_u32 s15, s4, 4294967283
    s_cmp_lt_u32 s4, 19
    s_cbranch_scc1 L_role_awo
    s_add_u32 s15, s4, 22
    s_cmp_lt_u32 s4, 32
    s_cbranch_scc1 L_role_p
    s_endpgm
L_cls5_no:
    s_cmp_lg_u32 s3, 6
    s_cbranch_scc1 L_cls6_no
    s_add_u32 s15, s4, 0
    s_cmp_lt_u32 s4, 11
    s_cbranch_scc1 L_role_ta
    s_add_u32 s15, s4, 43
    s_cmp_lt_u32 s4, 32
    s_cbranch_scc1 L_role_p
    s_endpgm
L_cls6_no:
    s_cmp_lg_u32 s3, 7
    s_cbranch_scc1 L_cls7_no
    s_add_u32 s15, s4, 11
    s_cmp_lt_u32 s4, 11
    s_cbranch_scc1 L_role_ta
    s_add_u32 s15, s4, 64
    s_cmp_lt_u32 s4, 32
    s_cbranch_scc1 L_role_p
    s_endpgm
L_cls7_no:
L_exit:
    s_endpgm
L_abort:
    s_waitcnt lgkmcnt(0)
    s_mov_b64 exec, -1
    v_mov_b32 v0, 60
    s_lshl_b32 s5, s3, 8
    s_or_b32 s5, s5, s4
    s_or_b32 s5, s5, 0x10000
    v_mov_b32 v1, s5
    global_store_dword v0, v1, s[12:13]
    s_endpgm
.p2align 6
L_role_p:
    v_and_b32 v5, 63, v0
    v_lshlrev_b32 v0, 4, v5
    v_and_b32 v7, 15, v5
    v_lshrrev_b32 v8, 4, v5
    v_min_u32 v1, 11, v5
    v_lshrrev_b32 v6, 2, v1
    v_and_b32 v1, 3, v1
    v_lshlrev_b32 v1, 2, v1
    v_lshl_add_u32 v1, v6, 7, v1
    v_mov_b32 v3, 1
    v_mov_b32 v4, 0
    s_mov_b32 s44, 0x05040100
    s_mov_b32 s45, 0x07060302
    s_cmp_ge_u32 s15, 48
    s_cselect_b32 s63, 1, 0
    s_cselect_b32 s17, 48, 0
    s_sub_u32 s15, s15, s17
    s_cmp_lt_u32 s15, 32
    s_cselect_b32 s50, 1, 0
    s_sub_u32 s17, s15, 32
    s_lshl_b32 s17, s17, 1
    s_cmp_eq_u32 s50, 1
    s_cselect_b32 s51, s15, s17
    s_cselect_b32 s17, 48, 40
    s_cselect_b32 s18, 56, 40
    s_load_dwordx2 s[20:21], s[0:1], s17
    s_load_dwordx2 s[24:25], s[0:1], s18
    s_mov_b32 s22, 4718592
    s_mov_b32 s23, 0x00020000
    s_mov_b32 s26, 4718592
    s_mov_b32 s27, 0x00020000
    s_lshl_b32 s49, s51, 8
    s_mul_i32 s17, s14, 131072
    s_add_u32 s49, s49, s17
    s_cmp_eq_u32 s50, 1
    s_cselect_b32 s17, 0, 256
    s_add_u32 s52, s49, s17
    s_waitcnt lgkmcnt(0)
    s_and_b32 s21, s21, 0xffff
    s_and_b32 s25, s25, 0xffff
    s_cmp_eq_u32 s63, 0
    s_cbranch_scc1 Lp2_gate_ng
    s_cmp_lg_u32 s14, 0
    s_cbranch_scc1 Lp2_gate_d
    v_mov_b32 v5, 48
    s_mov_b32 s16, 0
Lp2_gate:
    global_load_dword v6, v5, s[12:13] sc1
    s_add_u32 s16, s16, 1
    s_cmp_gt_u32 s16, 100000
    s_cbranch_scc1 L_role_p_abort
    s_waitcnt vmcnt(0)
    v_cmp_gt_u32 vcc, 32, v6
    s_nop 0
    s_cbranch_vccz Lp2_gate_d
    s_sleep 100
    s_branch Lp2_gate
Lp2_gate_d:
    s_barrier
Lp2_gate_ng:
    v_lshrrev_b32 v5, 8, v0
    v_bfe_u32 v6, v0, 6, 2
    v_xor_b32 v6, v6, v5
    v_lshlrev_b32 v6, 6, v6
    v_and_b32 v16, 0x30, v0
    v_add_u32 v16, v16, v6
    v_lshl_add_u32 v16, v5, 13, v16
    v_lshrrev_b32 v5, 2, v7
    v_xor_b32 v6, s14, v5
    v_lshlrev_b32 v17, 6, v6
    v_lshrrev_b32 v6, 1, v8
    v_lshl_add_u32 v5, v6, 3, v5
    v_lshl_add_u32 v17, v5, 8, v17
    v_and_b32 v5, 1, v8
    v_lshl_add_u32 v17, v5, 5, v17
    v_and_b32 v5, 3, v7
    v_lshl_add_u32 v17, v5, 3, v17
    v_add_u32 v18, 65536, v17
    s_lshl_b32 s46, s14, 12
    s_add_u32 m0, s46, 0
    s_add_u32 s17, s49, 0
    buffer_load_dwordx4 v16, s[20:23], s17 offen lds
    s_add_u32 m0, m0, 1024
    s_add_u32 s17, s49, 32768
    buffer_load_dwordx4 v16, s[20:23], s17 offen lds
    s_add_u32 m0, m0, 1024
    s_add_u32 s17, s49, 65536
    buffer_load_dwordx4 v16, s[20:23], s17 offen lds
    s_add_u32 m0, m0, 1024
    s_add_u32 s17, s49, 98304
    buffer_load_dwordx4 v16, s[20:23], s17 offen lds
    s_add_u32 m0, s46, 16384
    s_add_u32 s17, s49, 524288
    buffer_load_dwordx4 v16, s[20:23], s17 offen lds
    s_add_u32 m0, m0, 1024
    s_add_u32 s17, s49, 557056
    buffer_load_dwordx4 v16, s[20:23], s17 offen lds
    s_add_u32 m0, m0, 1024
    s_add_u32 s17, s49, 589824
    buffer_load_dwordx4 v16, s[20:23], s17 offen lds
    s_add_u32 m0, m0, 1024
    s_add_u32 s17, s49, 622592
    buffer_load_dwordx4 v16, s[20:23], s17 offen lds
    s_add_u32 m0, s46, 32768
    s_add_u32 s17, s49, 1048576
    buffer_load_dwordx4 v16, s[20:23], s17 offen lds
    s_add_u32 m0, m0, 1024
    s_add_u32 s17, s49, 1081344
    buffer_load_dwordx4 v16, s[20:23], s17 offen lds
    s_add_u32 m0, m0, 1024
    s_add_u32 s17, s49, 1114112
    buffer_load_dwordx4 v16, s[20:23], s17 offen lds
    s_add_u32 m0, m0, 1024
    s_add_u32 s17, s49, 1146880
    buffer_load_dwordx4 v16, s[20:23], s17 offen lds
    s_add_u32 m0, s46, 49152
    s_add_u32 s17, s49, 1572864
    buffer_load_dwordx4 v16, s[20:23], s17 offen lds
    s_add_u32 m0, m0, 1024
    s_add_u32 s17, s49, 1605632
    buffer_load_dwordx4 v16, s[20:23], s17 offen lds
    s_add_u32 m0, m0, 1024
    s_add_u32 s17, s49, 1638400
    buffer_load_dwordx4 v16, s[20:23], s17 offen lds
    s_add_u32 m0, m0, 1024
    s_add_u32 s17, s49, 1671168
    buffer_load_dwordx4 v16, s[20:23], s17 offen lds
    s_add_u32 m0, s46, 65536
    s_add_u32 s17, s49, 2097152
    buffer_load_dwordx4 v16, s[20:23], s17 offen lds
    s_add_u32 m0, m0, 1024
    s_add_u32 s17, s49, 2129920
    buffer_load_dwordx4 v16, s[20:23], s17 offen lds
    s_add_u32 m0, m0, 1024
    s_add_u32 s17, s49, 2162688
    buffer_load_dwordx4 v16, s[20:23], s17 offen lds
    s_add_u32 m0, m0, 1024
    s_add_u32 s17, s49, 2195456
    buffer_load_dwordx4 v16, s[20:23], s17 offen lds
    s_add_u32 m0, s46, 81920
    s_add_u32 s17, s49, 2621440
    buffer_load_dwordx4 v16, s[20:23], s17 offen lds
    s_add_u32 m0, m0, 1024
    s_add_u32 s17, s49, 2654208
    buffer_load_dwordx4 v16, s[20:23], s17 offen lds
    s_add_u32 m0, m0, 1024
    s_add_u32 s17, s49, 2686976
    buffer_load_dwordx4 v16, s[20:23], s17 offen lds
    s_add_u32 m0, m0, 1024
    s_add_u32 s17, s49, 2719744
    buffer_load_dwordx4 v16, s[20:23], s17 offen lds
    s_add_u32 m0, s46, 98304
    s_add_u32 s17, s49, 3145728
    buffer_load_dwordx4 v16, s[20:23], s17 offen lds
    s_add_u32 m0, m0, 1024
    s_add_u32 s17, s49, 3178496
    buffer_load_dwordx4 v16, s[20:23], s17 offen lds
    s_add_u32 m0, m0, 1024
    s_add_u32 s17, s49, 3211264
    buffer_load_dwordx4 v16, s[20:23], s17 offen lds
    s_add_u32 m0, m0, 1024
    s_add_u32 s17, s49, 3244032
    buffer_load_dwordx4 v16, s[20:23], s17 offen lds
    s_waitcnt vmcnt(24)
    s_barrier
    s_add_u32 m0, s46, 114688
    s_add_u32 s17, s49, 3670016
    buffer_load_dwordx4 v16, s[20:23], s17 offen lds
    s_add_u32 m0, m0, 1024
    s_add_u32 s17, s49, 3702784
    buffer_load_dwordx4 v16, s[20:23], s17 offen lds
    s_add_u32 m0, m0, 1024
    s_add_u32 s17, s49, 3735552
    buffer_load_dwordx4 v16, s[20:23], s17 offen lds
    s_add_u32 m0, m0, 1024
    s_add_u32 s17, s49, 3768320
    buffer_load_dwordx4 v16, s[20:23], s17 offen lds
    ds_read_b64_tr_b16 a[0:1], v17 offset:0
    ds_read_b64_tr_b16 a[2:3], v17 offset:1024
    ds_read_b64_tr_b16 a[4:5], v17 offset:4096
    ds_read_b64_tr_b16 a[6:7], v17 offset:5120
    ds_read_b64_tr_b16 a[8:9], v17 offset:8192
    ds_read_b64_tr_b16 a[10:11], v17 offset:9216
    ds_read_b64_tr_b16 a[12:13], v17 offset:12288
    ds_read_b64_tr_b16 a[14:15], v17 offset:13312
    s_waitcnt lgkmcnt(0)
    s_waitcnt vmcnt(24)
    s_barrier
    s_add_u32 m0, s46, 0
    s_add_u32 s17, s49, 4194304
    buffer_load_dwordx4 v16, s[20:23], s17 offen lds
    s_add_u32 m0, m0, 1024
    s_add_u32 s17, s49, 4227072
    buffer_load_dwordx4 v16, s[20:23], s17 offen lds
    s_add_u32 m0, m0, 1024
    s_add_u32 s17, s49, 4259840
    buffer_load_dwordx4 v16, s[20:23], s17 offen lds
    s_add_u32 m0, m0, 1024
    s_add_u32 s17, s49, 4292608
    buffer_load_dwordx4 v16, s[20:23], s17 offen lds
    ds_read_b64_tr_b16 a[16:17], v17 offset:16384
    ds_read_b64_tr_b16 a[18:19], v17 offset:17408
    ds_read_b64_tr_b16 a[20:21], v17 offset:20480
    ds_read_b64_tr_b16 a[22:23], v17 offset:21504
    ds_read_b64_tr_b16 a[24:25], v17 offset:24576
    ds_read_b64_tr_b16 a[26:27], v17 offset:25600
    ds_read_b64_tr_b16 a[28:29], v17 offset:28672
    ds_read_b64_tr_b16 a[30:31], v17 offset:29696
    s_waitcnt lgkmcnt(0)
    s_waitcnt vmcnt(24)
    s_barrier
    s_add_u32 m0, s46, 16384
    s_add_u32 s17, s52, 0
    buffer_load_dwordx4 v16, s[24:27], s17 offen lds
    s_add_u32 m0, m0, 1024
    s_add_u32 s17, s52, 32768
    buffer_load_dwordx4 v16, s[24:27], s17 offen lds
    s_add_u32 m0, m0, 1024
    s_add_u32 s17, s52, 65536
    buffer_load_dwordx4 v16, s[24:27], s17 offen lds
    s_add_u32 m0, m0, 1024
    s_add_u32 s17, s52, 98304
    buffer_load_dwordx4 v16, s[24:27], s17 offen lds
    ds_read_b64_tr_b16 a[32:33], v17 offset:32768
    ds_read_b64_tr_b16 a[34:35], v17 offset:33792
    ds_read_b64_tr_b16 a[36:37], v17 offset:36864
    ds_read_b64_tr_b16 a[38:39], v17 offset:37888
    ds_read_b64_tr_b16 a[40:41], v17 offset:40960
    ds_read_b64_tr_b16 a[42:43], v17 offset:41984
    ds_read_b64_tr_b16 a[44:45], v17 offset:45056
    ds_read_b64_tr_b16 a[46:47], v17 offset:46080
    s_waitcnt lgkmcnt(0)
    s_waitcnt vmcnt(24)
    s_barrier
    s_add_u32 m0, s46, 32768
    s_add_u32 s17, s52, 524288
    buffer_load_dwordx4 v16, s[24:27], s17 offen lds
    s_add_u32 m0, m0, 1024
    s_add_u32 s17, s52, 557056
    buffer_load_dwordx4 v16, s[24:27], s17 offen lds
    s_add_u32 m0, m0, 1024
    s_add_u32 s17, s52, 589824
    buffer_load_dwordx4 v16, s[24:27], s17 offen lds
    s_add_u32 m0, m0, 1024
    s_add_u32 s17, s52, 622592
    buffer_load_dwordx4 v16, s[24:27], s17 offen lds
    ds_read_b64_tr_b16 a[48:49], v17 offset:49152
    ds_read_b64_tr_b16 a[50:51], v17 offset:50176
    ds_read_b64_tr_b16 a[52:53], v17 offset:53248
    ds_read_b64_tr_b16 a[54:55], v17 offset:54272
    ds_read_b64_tr_b16 a[56:57], v17 offset:57344
    ds_read_b64_tr_b16 a[58:59], v17 offset:58368
    ds_read_b64_tr_b16 a[60:61], v17 offset:61440
    ds_read_b64_tr_b16 a[62:63], v17 offset:62464
    s_waitcnt lgkmcnt(0)
    s_waitcnt vmcnt(24)
    s_barrier
    s_add_u32 m0, s46, 49152
    s_add_u32 s17, s52, 1048576
    buffer_load_dwordx4 v16, s[24:27], s17 offen lds
    s_add_u32 m0, m0, 1024
    s_add_u32 s17, s52, 1081344
    buffer_load_dwordx4 v16, s[24:27], s17 offen lds
    s_add_u32 m0, m0, 1024
    s_add_u32 s17, s52, 1114112
    buffer_load_dwordx4 v16, s[24:27], s17 offen lds
    s_add_u32 m0, m0, 1024
    s_add_u32 s17, s52, 1146880
    buffer_load_dwordx4 v16, s[24:27], s17 offen lds
    ds_read_b64_tr_b16 a[64:65], v18 offset:0
    ds_read_b64_tr_b16 a[66:67], v18 offset:1024
    ds_read_b64_tr_b16 a[68:69], v18 offset:4096
    ds_read_b64_tr_b16 a[70:71], v18 offset:5120
    ds_read_b64_tr_b16 a[72:73], v18 offset:8192
    ds_read_b64_tr_b16 a[74:75], v18 offset:9216
    ds_read_b64_tr_b16 a[76:77], v18 offset:12288
    ds_read_b64_tr_b16 a[78:79], v18 offset:13312
    s_waitcnt lgkmcnt(0)
    s_waitcnt vmcnt(24)
    s_barrier
    s_add_u32 m0, s46, 65536
    s_add_u32 s17, s52, 1572864
    buffer_load_dwordx4 v16, s[24:27], s17 offen lds
    s_add_u32 m0, m0, 1024
    s_add_u32 s17, s52, 1605632
    buffer_load_dwordx4 v16, s[24:27], s17 offen lds
    s_add_u32 m0, m0, 1024
    s_add_u32 s17, s52, 1638400
    buffer_load_dwordx4 v16, s[24:27], s17 offen lds
    s_add_u32 m0, m0, 1024
    s_add_u32 s17, s52, 1671168
    buffer_load_dwordx4 v16, s[24:27], s17 offen lds
    ds_read_b64_tr_b16 a[80:81], v18 offset:16384
    ds_read_b64_tr_b16 a[82:83], v18 offset:17408
    ds_read_b64_tr_b16 a[84:85], v18 offset:20480
    ds_read_b64_tr_b16 a[86:87], v18 offset:21504
    ds_read_b64_tr_b16 a[88:89], v18 offset:24576
    ds_read_b64_tr_b16 a[90:91], v18 offset:25600
    ds_read_b64_tr_b16 a[92:93], v18 offset:28672
    ds_read_b64_tr_b16 a[94:95], v18 offset:29696
    s_waitcnt lgkmcnt(0)
    s_waitcnt vmcnt(24)
    s_barrier
    s_add_u32 m0, s46, 81920
    s_add_u32 s17, s52, 2097152
    buffer_load_dwordx4 v16, s[24:27], s17 offen lds
    s_add_u32 m0, m0, 1024
    s_add_u32 s17, s52, 2129920
    buffer_load_dwordx4 v16, s[24:27], s17 offen lds
    s_add_u32 m0, m0, 1024
    s_add_u32 s17, s52, 2162688
    buffer_load_dwordx4 v16, s[24:27], s17 offen lds
    s_add_u32 m0, m0, 1024
    s_add_u32 s17, s52, 2195456
    buffer_load_dwordx4 v16, s[24:27], s17 offen lds
    ds_read_b64_tr_b16 a[96:97], v18 offset:32768
    ds_read_b64_tr_b16 a[98:99], v18 offset:33792
    ds_read_b64_tr_b16 a[100:101], v18 offset:36864
    ds_read_b64_tr_b16 a[102:103], v18 offset:37888
    ds_read_b64_tr_b16 a[104:105], v18 offset:40960
    ds_read_b64_tr_b16 a[106:107], v18 offset:41984
    ds_read_b64_tr_b16 a[108:109], v18 offset:45056
    ds_read_b64_tr_b16 a[110:111], v18 offset:46080
    s_waitcnt lgkmcnt(0)
    s_waitcnt vmcnt(24)
    s_barrier
    s_add_u32 m0, s46, 98304
    s_add_u32 s17, s52, 2621440
    buffer_load_dwordx4 v16, s[24:27], s17 offen lds
    s_add_u32 m0, m0, 1024
    s_add_u32 s17, s52, 2654208
    buffer_load_dwordx4 v16, s[24:27], s17 offen lds
    s_add_u32 m0, m0, 1024
    s_add_u32 s17, s52, 2686976
    buffer_load_dwordx4 v16, s[24:27], s17 offen lds
    s_add_u32 m0, m0, 1024
    s_add_u32 s17, s52, 2719744
    buffer_load_dwordx4 v16, s[24:27], s17 offen lds
    ds_read_b64_tr_b16 a[112:113], v18 offset:49152
    ds_read_b64_tr_b16 a[114:115], v18 offset:50176
    ds_read_b64_tr_b16 a[116:117], v18 offset:53248
    ds_read_b64_tr_b16 a[118:119], v18 offset:54272
    ds_read_b64_tr_b16 a[120:121], v18 offset:57344
    ds_read_b64_tr_b16 a[122:123], v18 offset:58368
    ds_read_b64_tr_b16 a[124:125], v18 offset:61440
    ds_read_b64_tr_b16 a[126:127], v18 offset:62464
    s_waitcnt lgkmcnt(0)
    s_waitcnt vmcnt(24)
    s_barrier
    s_add_u32 m0, s46, 114688
    s_add_u32 s17, s52, 3145728
    buffer_load_dwordx4 v16, s[24:27], s17 offen lds
    s_add_u32 m0, m0, 1024
    s_add_u32 s17, s52, 3178496
    buffer_load_dwordx4 v16, s[24:27], s17 offen lds
    s_add_u32 m0, m0, 1024
    s_add_u32 s17, s52, 3211264
    buffer_load_dwordx4 v16, s[24:27], s17 offen lds
    s_add_u32 m0, m0, 1024
    s_add_u32 s17, s52, 3244032
    buffer_load_dwordx4 v16, s[24:27], s17 offen lds
    ds_read_b64_tr_b16 a[128:129], v17 offset:0
    ds_read_b64_tr_b16 a[130:131], v17 offset:1024
    ds_read_b64_tr_b16 a[132:133], v17 offset:4096
    ds_read_b64_tr_b16 a[134:135], v17 offset:5120
    ds_read_b64_tr_b16 a[136:137], v17 offset:8192
    ds_read_b64_tr_b16 a[138:139], v17 offset:9216
    ds_read_b64_tr_b16 a[140:141], v17 offset:12288
    ds_read_b64_tr_b16 a[142:143], v17 offset:13312
    s_waitcnt lgkmcnt(0)
    s_waitcnt vmcnt(24)
    s_barrier
    s_add_u32 m0, s46, 0
    s_add_u32 s17, s52, 3670016
    buffer_load_dwordx4 v16, s[24:27], s17 offen lds
    s_add_u32 m0, m0, 1024
    s_add_u32 s17, s52, 3702784
    buffer_load_dwordx4 v16, s[24:27], s17 offen lds
    s_add_u32 m0, m0, 1024
    s_add_u32 s17, s52, 3735552
    buffer_load_dwordx4 v16, s[24:27], s17 offen lds
    s_add_u32 m0, m0, 1024
    s_add_u32 s17, s52, 3768320
    buffer_load_dwordx4 v16, s[24:27], s17 offen lds
    ds_read_b64_tr_b16 a[144:145], v17 offset:16384
    ds_read_b64_tr_b16 a[146:147], v17 offset:17408
    ds_read_b64_tr_b16 a[148:149], v17 offset:20480
    ds_read_b64_tr_b16 a[150:151], v17 offset:21504
    ds_read_b64_tr_b16 a[152:153], v17 offset:24576
    ds_read_b64_tr_b16 a[154:155], v17 offset:25600
    ds_read_b64_tr_b16 a[156:157], v17 offset:28672
    ds_read_b64_tr_b16 a[158:159], v17 offset:29696
    s_waitcnt lgkmcnt(0)
    s_waitcnt vmcnt(24)
    s_barrier
    s_add_u32 m0, s46, 16384
    s_add_u32 s17, s52, 4194304
    buffer_load_dwordx4 v16, s[24:27], s17 offen lds
    s_add_u32 m0, m0, 1024
    s_add_u32 s17, s52, 4227072
    buffer_load_dwordx4 v16, s[24:27], s17 offen lds
    s_add_u32 m0, m0, 1024
    s_add_u32 s17, s52, 4259840
    buffer_load_dwordx4 v16, s[24:27], s17 offen lds
    s_add_u32 m0, m0, 1024
    s_add_u32 s17, s52, 4292608
    buffer_load_dwordx4 v16, s[24:27], s17 offen lds
    ds_read_b64_tr_b16 a[160:161], v17 offset:32768
    ds_read_b64_tr_b16 a[162:163], v17 offset:33792
    ds_read_b64_tr_b16 a[164:165], v17 offset:36864
    ds_read_b64_tr_b16 a[166:167], v17 offset:37888
    ds_read_b64_tr_b16 a[168:169], v17 offset:40960
    ds_read_b64_tr_b16 a[170:171], v17 offset:41984
    ds_read_b64_tr_b16 a[172:173], v17 offset:45056
    ds_read_b64_tr_b16 a[174:175], v17 offset:46080
    s_waitcnt lgkmcnt(0)
    s_waitcnt vmcnt(24)
    s_barrier
    ds_read_b64_tr_b16 a[176:177], v17 offset:49152
    ds_read_b64_tr_b16 a[178:179], v17 offset:50176
    ds_read_b64_tr_b16 a[180:181], v17 offset:53248
    ds_read_b64_tr_b16 a[182:183], v17 offset:54272
    ds_read_b64_tr_b16 a[184:185], v17 offset:57344
    ds_read_b64_tr_b16 a[186:187], v17 offset:58368
    ds_read_b64_tr_b16 a[188:189], v17 offset:61440
    ds_read_b64_tr_b16 a[190:191], v17 offset:62464
    s_waitcnt lgkmcnt(0)
    s_waitcnt vmcnt(20)
    s_barrier
    ds_read_b64_tr_b16 a[192:193], v18 offset:0
    ds_read_b64_tr_b16 a[194:195], v18 offset:1024
    ds_read_b64_tr_b16 a[196:197], v18 offset:4096
    ds_read_b64_tr_b16 a[198:199], v18 offset:5120
    ds_read_b64_tr_b16 a[200:201], v18 offset:8192
    ds_read_b64_tr_b16 a[202:203], v18 offset:9216
    ds_read_b64_tr_b16 a[204:205], v18 offset:12288
    ds_read_b64_tr_b16 a[206:207], v18 offset:13312
    s_waitcnt lgkmcnt(0)
    s_waitcnt vmcnt(16)
    s_barrier
    ds_read_b64_tr_b16 a[208:209], v18 offset:16384
    ds_read_b64_tr_b16 a[210:211], v18 offset:17408
    ds_read_b64_tr_b16 a[212:213], v18 offset:20480
    ds_read_b64_tr_b16 a[214:215], v18 offset:21504
    ds_read_b64_tr_b16 a[216:217], v18 offset:24576
    ds_read_b64_tr_b16 a[218:219], v18 offset:25600
    ds_read_b64_tr_b16 a[220:221], v18 offset:28672
    ds_read_b64_tr_b16 a[222:223], v18 offset:29696
    s_waitcnt lgkmcnt(0)
    s_waitcnt vmcnt(12)
    s_barrier
    ds_read_b64_tr_b16 a[224:225], v18 offset:32768
    ds_read_b64_tr_b16 a[226:227], v18 offset:33792
    ds_read_b64_tr_b16 a[228:229], v18 offset:36864
    ds_read_b64_tr_b16 a[230:231], v18 offset:37888
    ds_read_b64_tr_b16 a[232:233], v18 offset:40960
    ds_read_b64_tr_b16 a[234:235], v18 offset:41984
    ds_read_b64_tr_b16 a[236:237], v18 offset:45056
    ds_read_b64_tr_b16 a[238:239], v18 offset:46080
    s_waitcnt lgkmcnt(0)
    s_waitcnt vmcnt(8)
    s_barrier
    ds_read_b64_tr_b16 a[240:241], v18 offset:49152
    ds_read_b64_tr_b16 a[242:243], v18 offset:50176
    ds_read_b64_tr_b16 a[244:245], v18 offset:53248
    ds_read_b64_tr_b16 a[246:247], v18 offset:54272
    ds_read_b64_tr_b16 a[248:249], v18 offset:57344
    ds_read_b64_tr_b16 a[250:251], v18 offset:58368
    ds_read_b64_tr_b16 a[252:253], v18 offset:61440
    ds_read_b64_tr_b16 a[254:255], v18 offset:62464
    s_waitcnt lgkmcnt(0)
    s_waitcnt vmcnt(4)
    s_barrier
    ds_read_b64_tr_b16 v[152:153], v17 offset:0
    ds_read_b64_tr_b16 v[154:155], v17 offset:1024
    ds_read_b64_tr_b16 v[156:157], v17 offset:4096
    ds_read_b64_tr_b16 v[158:159], v17 offset:5120
    ds_read_b64_tr_b16 v[160:161], v17 offset:8192
    ds_read_b64_tr_b16 v[162:163], v17 offset:9216
    ds_read_b64_tr_b16 v[164:165], v17 offset:12288
    ds_read_b64_tr_b16 v[166:167], v17 offset:13312
    s_waitcnt lgkmcnt(0)
    s_waitcnt vmcnt(0)
    s_barrier
    ds_read_b64_tr_b16 v[168:169], v17 offset:16384
    ds_read_b64_tr_b16 v[170:171], v17 offset:17408
    ds_read_b64_tr_b16 v[172:173], v17 offset:20480
    ds_read_b64_tr_b16 v[174:175], v17 offset:21504
    ds_read_b64_tr_b16 v[176:177], v17 offset:24576
    ds_read_b64_tr_b16 v[178:179], v17 offset:25600
    ds_read_b64_tr_b16 v[180:181], v17 offset:28672
    ds_read_b64_tr_b16 v[182:183], v17 offset:29696
    s_waitcnt lgkmcnt(0)
    s_barrier
    v_bfe_u32 v10, v0, 4, 5
    v_lshrrev_b32 v5, 9, v0
    v_lshlrev_b32 v10, 4, v10
    v_mul_u32_u24 v6, 2560, v5
    v_add_u32 v10, v10, v6
    v_add_u32 v10, 114688, v10
    s_lshl_b32 s67, s14, 10
    v_bfe_u32 v6, v0, 8, 1
    v_lshlrev_b32 v14, 10, v6
    v_lshl_add_u32 v14, v7, 4, v14
    v_lshl_add_u32 v14, v5, 8, v14
    s_lshl_b32 s17, s51, 13
    s_lshl_b32 s18, s14, 11
    s_add_u32 s52, s17, s18
    s_add_u32 s52, s52, 44040192
    s_lshl_b32 s49, s51, 9
    s_lshl_b32 s17, s14, 2
    s_add_u32 s49, s49, s17
    s_add_u32 s49, s49, 5376
    s_cmp_eq_u32 s50, 1
    s_cselect_b32 s17, 16777216, 0
    s_cselect_b32 s18, 128, 0
    s_add_u32 s52, s52, s17
    s_add_u32 s49, s49, s18
    s_cmp_eq_u32 s50, 1
    s_cselect_b32 s17, 0, 384
    s_add_u32 s17, s17, 128
    v_lshrrev_b32 v185, 4, v0
    v_mul_lo_u32 v185, v185, s17
    v_mov_b32 v48, 0x3f803f80
    v_mov_b32 v49, 0x3f803f80
    v_mov_b32 v50, 0x3f803f80
    v_mov_b32 v51, 0x3f803f80
    s_lshl_b32 s17, s14, 8
    s_add_u32 s17, s17, 110592
    v_bfe_u32 v5, v0, 4, 5
    v_lshl_add_u32 v12, v5, 2, s17
    v_lshrrev_b32 v5, 9, v0
    v_lshl_add_u32 v13, v5, 4, s17
    s_cmp_eq_u32 s50, 1
    s_cbranch_scc1 Lp2_kv
    v_mfma_f32_32x32x16_bf16 v[84:99], a[0:3], v[48:51], 0
    v_mfma_f32_32x32x16_bf16 v[116:131], a[144:147], v[48:51], 0
    v_mfma_f32_32x32x16_bf16 v[84:99], a[4:7], v[48:51], v[84:99]
    v_mfma_f32_32x32x16_bf16 v[116:131], a[148:151], v[48:51], v[116:131]
    v_mfma_f32_32x32x16_bf16 v[84:99], a[8:11], v[48:51], v[84:99]
    v_mfma_f32_32x32x16_bf16 v[116:131], a[152:155], v[48:51], v[116:131]
    v_mfma_f32_32x32x16_bf16 v[84:99], a[12:15], v[48:51], v[84:99]
    v_mfma_f32_32x32x16_bf16 v[116:131], a[156:159], v[48:51], v[116:131]
    v_mfma_f32_32x32x16_bf16 v[84:99], a[16:19], v[48:51], v[84:99]
    v_mfma_f32_32x32x16_bf16 v[116:131], a[160:163], v[48:51], v[116:131]
    v_mfma_f32_32x32x16_bf16 v[84:99], a[20:23], v[48:51], v[84:99]
    v_mfma_f32_32x32x16_bf16 v[116:131], a[164:167], v[48:51], v[116:131]
    v_mfma_f32_32x32x16_bf16 v[84:99], a[24:27], v[48:51], v[84:99]
    v_mfma_f32_32x32x16_bf16 v[116:131], a[168:171], v[48:51], v[116:131]
    v_mfma_f32_32x32x16_bf16 v[84:99], a[28:31], v[48:51], v[84:99]
    v_mfma_f32_32x32x16_bf16 v[116:131], a[172:175], v[48:51], v[116:131]
    v_mfma_f32_32x32x16_bf16 v[84:99], a[32:35], v[48:51], v[84:99]
    v_mfma_f32_32x32x16_bf16 v[116:131], a[176:179], v[48:51], v[116:131]
    v_mfma_f32_32x32x16_bf16 v[84:99], a[36:39], v[48:51], v[84:99]
    v_mfma_f32_32x32x16_bf16 v[116:131], a[180:183], v[48:51], v[116:131]
    v_mfma_f32_32x32x16_bf16 v[84:99], a[40:43], v[48:51], v[84:99]
    v_mfma_f32_32x32x16_bf16 v[116:131], a[184:187], v[48:51], v[116:131]
    v_mfma_f32_32x32x16_bf16 v[84:99], a[44:47], v[48:51], v[84:99]
    v_mfma_f32_32x32x16_bf16 v[116:131], a[188:191], v[48:51], v[116:131]
    v_mfma_f32_32x32x16_bf16 v[84:99], a[48:51], v[48:51], v[84:99]
    v_mfma_f32_32x32x16_bf16 v[116:131], a[192:195], v[48:51], v[116:131]
    v_mfma_f32_32x32x16_bf16 v[84:99], a[52:55], v[48:51], v[84:99]
    v_mfma_f32_32x32x16_bf16 v[116:131], a[196:199], v[48:51], v[116:131]
    v_mfma_f32_32x32x16_bf16 v[84:99], a[56:59], v[48:51], v[84:99]
    v_mfma_f32_32x32x16_bf16 v[116:131], a[200:203], v[48:51], v[116:131]
    v_mfma_f32_32x32x16_bf16 v[84:99], a[60:63], v[48:51], v[84:99]
    v_mfma_f32_32x32x16_bf16 v[116:131], a[204:207], v[48:51], v[116:131]
    v_mfma_f32_32x32x16_bf16 v[84:99], a[64:67], v[48:51], v[84:99]
    v_mfma_f32_32x32x16_bf16 v[116:131], a[208:211], v[48:51], v[116:131]
    v_mfma_f32_32x32x16_bf16 v[84:99], a[68:71], v[48:51], v[84:99]
    v_mfma_f32_32x32x16_bf16 v[116:131], a[212:215], v[48:51], v[116:131]
    v_mfma_f32_32x32x16_bf16 v[84:99], a[72:75], v[48:51], v[84:99]
    v_mfma_f32_32x32x16_bf16 v[116:131], a[216:219], v[48:51], v[116:131]
    v_mfma_f32_32x32x16_bf16 v[84:99], a[76:79], v[48:51], v[84:99]
    v_mfma_f32_32x32x16_bf16 v[116:131], a[220:223], v[48:51], v[116:131]
    v_mfma_f32_32x32x16_bf16 v[84:99], a[80:83], v[48:51], v[84:99]
    v_mfma_f32_32x32x16_bf16 v[116:131], a[224:227], v[48:51], v[116:131]
    v_mfma_f32_32x32x16_bf16 v[84:99], a[84:87], v[48:51], v[84:99]
    v_mfma_f32_32x32x16_bf16 v[116:131], a[228:231], v[48:51], v[116:131]
    v_mfma_f32_32x32x16_bf16 v[84:99], a[88:91], v[48:51], v[84:99]
    v_mfma_f32_32x32x16_bf16 v[116:131], a[232:235], v[48:51], v[116:131]
    v_mfma_f32_32x32x16_bf16 v[84:99], a[92:95], v[48:51], v[84:99]
    v_mfma_f32_32x32x16_bf16 v[116:131], a[236:239], v[48:51], v[116:131]
    v_mfma_f32_32x32x16_bf16 v[84:99], a[96:99], v[48:51], v[84:99]
    v_mfma_f32_32x32x16_bf16 v[116:131], a[240:243], v[48:51], v[116:131]
    v_mfma_f32_32x32x16_bf16 v[84:99], a[100:103], v[48:51], v[84:99]
    v_mfma_f32_32x32x16_bf16 v[116:131], a[244:247], v[48:51], v[116:131]
    v_mfma_f32_32x32x16_bf16 v[84:99], a[104:107], v[48:51], v[84:99]
    v_mfma_f32_32x32x16_bf16 v[116:131], a[248:251], v[48:51], v[116:131]
    v_mfma_f32_32x32x16_bf16 v[84:99], a[108:111], v[48:51], v[84:99]
    v_mfma_f32_32x32x16_bf16 v[116:131], a[252:255], v[48:51], v[116:131]
    v_mfma_f32_32x32x16_bf16 v[84:99], a[112:115], v[48:51], v[84:99]
    v_mfma_f32_32x32x16_bf16 v[116:131], v[152:155], v[48:51], v[116:131]
    v_mfma_f32_32x32x16_bf16 v[84:99], a[116:119], v[48:51], v[84:99]
    v_mfma_f32_32x32x16_bf16 v[116:131], v[156:159], v[48:51], v[116:131]
    v_mfma_f32_32x32x16_bf16 v[84:99], a[120:123], v[48:51], v[84:99]
    v_mfma_f32_32x32x16_bf16 v[116:131], v[160:163], v[48:51], v[116:131]
    v_mfma_f32_32x32x16_bf16 v[84:99], a[124:127], v[48:51], v[84:99]
    v_mfma_f32_32x32x16_bf16 v[116:131], v[164:167], v[48:51], v[116:131]
    v_mfma_f32_32x32x16_bf16 v[84:99], a[128:131], v[48:51], v[84:99]
    v_mfma_f32_32x32x16_bf16 v[116:131], v[168:171], v[48:51], v[116:131]
    v_mfma_f32_32x32x16_bf16 v[84:99], a[132:135], v[48:51], v[84:99]
    v_mfma_f32_32x32x16_bf16 v[116:131], v[172:175], v[48:51], v[116:131]
    v_mfma_f32_32x32x16_bf16 v[84:99], a[136:139], v[48:51], v[84:99]
    v_mfma_f32_32x32x16_bf16 v[116:131], v[176:179], v[48:51], v[116:131]
    v_mfma_f32_32x32x16_bf16 v[84:99], a[140:143], v[48:51], v[84:99]
    v_mfma_f32_32x32x16_bf16 v[116:131], v[180:183], v[48:51], v[116:131]
    s_mov_b32 s66, 114688
    s_mov_b32 s71, 0x2000
    s_mov_b32 s36, s63
    s_mov_b32 s34, s63
    s_mul_i32 s58, s14, 9216
    s_mul_i32 s64, s63, 4718592
    s_add_u32 s64, s64, s58
    s_add_u32 s64, s64, 8650752
    s_mul_i32 s61, s63, 1441792
    s_add_u32 s61, s61, 3584
    s_mov_b32 s37, 0
    s_mov_b32 s40, 36864
    s_mov_b32 s59, s58
    s_mov_b32 s43, 0
    s_mov_b32 s62, 1
    s_mov_b32 s28, s8
    s_mov_b32 s29, s9
    s_mov_b32 s30, 0
    s_mov_b32 s31, 0x00020000
    v_mov_b32 v184, 74752
    v_mov_b32 v5, -1
    ds_write_b32 v184, v5
    s_waitcnt lgkmcnt(0)
    s_cmp_lg_u32 s14, 0
    s_cbranch_scc1 LpQQ_inia_d
    v_mov_b32 v5, 40
    s_mov_b32 s16, 0
LpQQ_inia:
    global_load_dword v6, v5, s[12:13] sc1
    s_add_u32 s16, s16, 1
    s_cmp_gt_u32 s16, 100000
    s_cbranch_scc1 L_role_p_abort
    s_waitcnt vmcnt(0)
    v_cmp_gt_u32 vcc, 128, v6
    s_nop 0
    s_cbranch_vccz LpQQ_inia_d
    s_sleep 8
    s_branch LpQQ_inia
LpQQ_inia_d:
    s_barrier
    s_cmp_eq_u32 s63, 0
    s_cbranch_scc1 LpQQ_ini_sk
    s_cmp_lg_u32 s14, 0
    s_cbranch_scc1 LpQQ_inib_d
    v_mov_b32 v5, 160
    s_mov_b32 s16, 0
LpQQ_inib:
    global_load_dword v6, v5, s[12:13] sc1
    s_add_u32 s16, s16, 1
    s_cmp_gt_u32 s16, 100000
    s_cbranch_scc1 L_role_p_abort
    s_waitcnt vmcnt(0)
    v_cmp_gt_u32 vcc, 64, v6
    s_nop 0
    s_cbranch_vccz LpQQ_inib_d
    s_sleep 8
    s_branch LpQQ_inib
LpQQ_inib_d:
    s_barrier
LpQQ_ini_sk:
    s_mul_i32 s41, s37, 36864
    s_add_u32 s41, s41, s64
    s_mul_i32 s60, s37, 22528
    s_add_u32 s60, s60, s61
    s_cmp_lt_u32 s37, 64
    s_cselect_b32 s60, s60, 2883584
    s_branch LpQQ_wait
LpQQ_head:
    s_waitcnt vmcnt(4)
LpQQ_head2:
    s_barrier
    ds_read_b32 v15, v184
    s_xor_b32 s40, s40, 36864
    s_xor_b32 s59, s59, 36864
    s_mov_b32 s35, s37
    s_lshl_b32 s57, s34, 6
    s_add_u32 s57, s57, s35
    s_add_u32 s37, s37, 1
    s_mov_b32 s39, 0
    s_mov_b32 s54, 0
    s_xor_b32 s66, s66, 8192
    s_xor_b32 s71, s71, 8192
    s_mul_i32 s41, s37, 36864
    s_add_u32 s41, s41, s64
    s_mul_i32 s60, s37, 22528
    s_add_u32 s60, s60, s61
    s_cmp_lt_u32 s37, 64
    s_cselect_b32 s60, s60, 2883584
    v_add_u32 v9, s40, v0
    v_add_u32 v5, s71, v10
    ds_read_b128 v[48:51], v9 offset:0
    ds_read_b128 v[52:55], v9 offset:1024
    ds_read_b128 v[56:59], v9 offset:2048
    ds_read_b128 v[64:67], v5 offset:0
    ds_read_b128 v[68:71], v5 offset:512
    ds_read_b128 v[72:75], v5 offset:1024
    ds_read_b128 v[76:79], v5 offset:1536
    ds_read_b128 v[80:83], v5 offset:2048
    s_waitcnt lgkmcnt(7)
    v_mfma_f32_32x32x16_bf16 v[16:31], a[0:3], v[48:51], 0
    ds_read_b128 v[60:63], v9 offset:3072
    v_mfma_f32_32x32x16_bf16 v[32:47], a[144:147], v[48:51], 0
    s_waitcnt lgkmcnt(4)
    v_add_f32 v64, v64, v68
    v_add_f32 v65, v65, v69
    v_add_f32 v66, v66, v70
    v_add_f32 v67, v67, v71
    v_mfma_f32_32x32x16_bf16 v[16:31], a[4:7], v[52:55], v[16:31]
    ds_read_b128 v[48:51], v9 offset:4096
    s_waitcnt lgkmcnt(4)
    v_add_f32 v64, v64, v72
    v_add_f32 v65, v65, v73
    v_add_f32 v66, v66, v74
    v_mfma_f32_32x32x16_bf16 v[32:47], a[148:151], v[52:55], v[32:47]
    v_add_f32 v67, v67, v75
    s_waitcnt lgkmcnt(3)
    v_add_f32 v64, v64, v76
    v_add_f32 v65, v65, v77
    v_add_f32 v66, v66, v78
    v_readfirstlane_b32 s17, v15
    s_nop 0
    s_add_u32 s18, s17, 1
    s_max_i32 s32, s18, s37
    s_add_u32 s39, s37, 1
    s_min_u32 s39, s39, 63
    s_mul_i32 s33, s32, 22528
    s_add_u32 s33, s33, s61
    s_cmp_eq_u32 s14, 0
    s_cselect_b32 s18, s32, 0x7fff
    v_mov_b32 v2, 2
    s_cmp_le_u32 s18, s39
    s_cselect_b64 exec, -1, 0
    buffer_load_dword v2, v1, s[8:11], s33 offen sc1
    s_mov_b64 exec, -1
    s_cmp_ge_i32 s17, s37
    s_cbranch_scc1 LpQQ_f_1
    v_mfma_f32_32x32x16_bf16 v[16:31], a[8:11], v[56:59], v[16:31]
    ds_read_b128 v[52:55], v9 offset:5120
    v_add_f32 v67, v67, v79
    s_waitcnt lgkmcnt(3)
    v_add_f32 v64, v64, v80
    v_add_f32 v65, v65, v81
    v_mfma_f32_32x32x16_bf16 v[32:47], a[152:155], v[56:59], v[32:47]
    v_add_f32 v66, v66, v82
    v_add_f32 v67, v67, v83
    v_add_f32 v64, v64, v66
    v_add_f32 v65, v65, v67
    s_waitcnt lgkmcnt(2)
    v_mfma_f32_32x32x16_bf16 v[16:31], a[12:15], v[60:63], v[16:31]
    ds_read_b128 v[56:59], v9 offset:6144
    v_mov_b32 v66, v64
    v_mov_b32 v67, v65
    s_nop 0
    v_permlane32_swap_b32 v64, v66
    v_mfma_f32_32x32x16_bf16 v[32:47], a[156:159], v[60:63], v[32:47]
    v_permlane32_swap_b32 v65, v67
    v_add_f32 v64, v64, v66
    v_add_f32 v65, v65, v67
    v_mul_f32 v64, 0x3ae38e39, v64
    s_waitcnt lgkmcnt(2)
    v_mfma_f32_32x32x16_bf16 v[16:31], a[16:19], v[48:51], v[16:31]
    ds_read_b128 v[60:63], v9 offset:7168
    v_mul_f32 v65, 0x3ae38e39, v65
    v_fma_f32 v65, -v64, v64, v65
    v_max_f32 v65, 0, v65
    v_mfma_f32_32x32x16_bf16 v[32:47], a[160:163], v[48:51], v[32:47]
    v_add_f32 v65, 0x3727c5ac, v65
    v_rsq_f32 v148, v65
    s_nop 0
    v_mul_f32 v149, v64, v148
    v_mul_f32 v100, v149, v84
    s_waitcnt lgkmcnt(2)
    v_mfma_f32_32x32x16_bf16 v[16:31], a[20:23], v[52:55], v[16:31]
    ds_read_b128 v[48:51], v9 offset:8192
    v_mul_f32 v101, v149, v85
    v_mul_f32 v102, v149, v86
    v_mul_f32 v103, v149, v87
    v_mfma_f32_32x32x16_bf16 v[32:47], a[164:167], v[52:55], v[32:47]
    v_mul_f32 v104, v149, v88
    v_mul_f32 v105, v149, v89
    v_mul_f32 v106, v149, v90
    v_mul_f32 v107, v149, v91
    s_waitcnt lgkmcnt(2)
    v_mfma_f32_32x32x16_bf16 v[16:31], a[24:27], v[56:59], v[16:31]
    ds_read_b128 v[52:55], v9 offset:9216
    v_mul_f32 v108, v149, v92
    v_mul_f32 v109, v149, v93
    v_mul_f32 v110, v149, v94
    v_mfma_f32_32x32x16_bf16 v[32:47], a[168:171], v[56:59], v[32:47]
    v_mul_f32 v111, v149, v95
    v_mul_f32 v112, v149, v96
    v_mul_f32 v113, v149, v97
    v_mul_f32 v114, v149, v98
    s_waitcnt lgkmcnt(2)
    v_mfma_f32_32x32x16_bf16 v[16:31], a[28:31], v[60:63], v[16:31]
    ds_read_b128 v[56:59], v9 offset:10240
    v_mul_f32 v115, v149, v99
    v_mul_f32 v132, v149, v116
    v_mul_f32 v133, v149, v117
    v_mfma_f32_32x32x16_bf16 v[32:47], a[172:175], v[60:63], v[32:47]
    v_mul_f32 v134, v149, v118
    v_mul_f32 v135, v149, v119
    v_mul_f32 v136, v149, v120
    v_mul_f32 v137, v149, v121
    s_waitcnt lgkmcnt(2)
    v_mfma_f32_32x32x16_bf16 v[16:31], a[32:35], v[48:51], v[16:31]
    ds_read_b128 v[60:63], v9 offset:11264
    v_mul_f32 v138, v149, v122
    v_mul_f32 v139, v149, v123
    v_mul_f32 v140, v149, v124
    v_mfma_f32_32x32x16_bf16 v[32:47], a[176:179], v[48:51], v[32:47]
    v_mul_f32 v141, v149, v125
    v_mul_f32 v142, v149, v126
    v_mul_f32 v143, v149, v127
    v_mul_f32 v144, v149, v128
    s_waitcnt lgkmcnt(2)
    v_mfma_f32_32x32x16_bf16 v[16:31], a[36:39], v[52:55], v[16:31]
    ds_read_b128 v[48:51], v9 offset:12288
    v_mul_f32 v145, v149, v129
    v_mul_f32 v146, v149, v130
    v_mul_f32 v147, v149, v131
    v_mfma_f32_32x32x16_bf16 v[32:47], a[180:183], v[52:55], v[32:47]
    s_mul_i32 s46, s34, 50331648
    s_lshl_b32 s51, s35, 18
    s_add_u32 s46, s46, s51
    s_add_u32 s46, s46, s52
    s_waitcnt lgkmcnt(2)
    v_mfma_f32_32x32x16_bf16 v[16:31], a[40:43], v[56:59], v[16:31]
    ds_read_b128 v[52:55], v9 offset:13312
    v_mfma_f32_32x32x16_bf16 v[32:47], a[184:187], v[56:59], v[32:47]
    s_waitcnt lgkmcnt(2)
    v_mfma_f32_32x32x16_bf16 v[16:31], a[44:47], v[60:63], v[16:31]
    ds_read_b128 v[56:59], v9 offset:14336
    v_mfma_f32_32x32x16_bf16 v[32:47], a[188:191], v[60:63], v[32:47]
    s_waitcnt lgkmcnt(2)
    v_mfma_f32_32x32x16_bf16 v[16:31], a[48:51], v[48:51], v[16:31]
    ds_read_b128 v[60:63], v9 offset:15360
    v_mfma_f32_32x32x16_bf16 v[32:47], a[192:195], v[48:51], v[32:47]
    s_waitcnt vmcnt(1)
    s_cmp_lg_u32 s43, 0
    s_cselect_b64 exec, 3, 0
    buffer_store_dword v3, v185, s[8:11], s43 offen sc1
    s_mov_b64 exec, -1
    s_mov_b32 s43, 0
    s_waitcnt lgkmcnt(2)
    v_mfma_f32_32x32x16_bf16 v[16:31], a[52:55], v[52:55], v[16:31]
    ds_read_b128 v[48:51], v9 offset:16384
    v_mfma_f32_32x32x16_bf16 v[32:47], a[196:199], v[52:55], v[32:47]
    s_waitcnt lgkmcnt(2)
    v_mfma_f32_32x32x16_bf16 v[16:31], a[56:59], v[56:59], v[16:31]
    v_cmp_eq_u32 s[76:77], 1, v2
    v_cmp_eq_u32 vcc, 2, v2
    s_cmp_eq_u64 s[76:77], -1
    s_cselect_b32 s38, 1, 0
    ds_read_b128 v[52:55], v9 offset:17408
    v_mfma_f32_32x32x16_bf16 v[32:47], a[200:203], v[56:59], v[32:47]
    s_cmp_lg_u32 s38, 0
    s_cselect_b64 exec, 1, 0
    v_mov_b32 v15, s32
    ds_write_b32 v184, v15
    v_mov_b32 v2, 2
    s_mov_b64 exec, -1
    s_waitcnt lgkmcnt(3)
    v_mfma_f32_32x32x16_bf16 v[16:31], a[60:63], v[60:63], v[16:31]
    s_add_u32 s32, s32, s38
    s_mul_i32 s38, s38, 22528
    s_add_u32 s33, s33, s38
    ds_read_b128 v[56:59], v9 offset:18432
    v_mfma_f32_32x32x16_bf16 v[32:47], a[204:207], v[60:63], v[32:47]
    s_cmp_eq_u64 vcc, 0
    s_cselect_b32 s38, s32, 0x7fff
    s_waitcnt lgkmcnt(3)
    v_mfma_f32_32x32x16_bf16 v[16:31], a[64:67], v[48:51], v[16:31]
    ds_read_b128 v[60:63], v9 offset:19456
    v_mfma_f32_32x32x16_bf16 v[32:47], a[208:211], v[48:51], v[32:47]
    s_cmp_le_u32 s38, s39
    s_cselect_b64 exec, -1, 0
    v_mov_b32 v2, 2
    buffer_load_dword v2, v1, s[8:11], s33 offen sc1
    s_mov_b64 exec, -1
    ds_read_b32 v15, v184
    s_waitcnt lgkmcnt(4)
    v_mfma_f32_32x32x16_bf16 v[16:31], a[68:71], v[52:55], v[16:31]
    ds_read_b128 v[48:51], v9 offset:20480
    v_mfma_f32_32x32x16_bf16 v[32:47], a[212:215], v[52:55], v[32:47]
    s_waitcnt lgkmcnt(3)
    v_mfma_f32_32x32x16_bf16 v[16:31], a[72:75], v[56:59], v[16:31]
    ds_read_b128 v[52:55], v9 offset:21504
    v_mfma_f32_32x32x16_bf16 v[32:47], a[216:219], v[56:59], v[32:47]
    s_waitcnt lgkmcnt(2)
    v_readfirstlane_b32 s17, v15
    s_nop 0
    s_cmp_ge_i32 s17, s37
    s_cbranch_scc1 LpQQ_f_2
    v_mfma_f32_32x32x16_bf16 v[16:31], a[76:79], v[60:63], v[16:31]
    ds_read_b128 v[56:59], v9 offset:22528
    v_mfma_f32_32x32x16_bf16 v[32:47], a[220:223], v[60:63], v[32:47]
    s_waitcnt lgkmcnt(2)
    v_mfma_f32_32x32x16_bf16 v[16:31], a[80:83], v[48:51], v[16:31]
    ds_read_b128 v[60:63], v9 offset:23552
    v_mfma_f32_32x32x16_bf16 v[32:47], a[224:227], v[48:51], v[32:47]
    s_waitcnt lgkmcnt(2)
    v_mfma_f32_32x32x16_bf16 v[16:31], a[84:87], v[52:55], v[16:31]
    ds_read_b128 v[48:51], v9 offset:24576
    v_mfma_f32_32x32x16_bf16 v[32:47], a[228:231], v[52:55], v[32:47]
    s_waitcnt lgkmcnt(2)
    v_mfma_f32_32x32x16_bf16 v[16:31], a[88:91], v[56:59], v[16:31]
    ds_read_b128 v[52:55], v9 offset:25600
    v_mfma_f32_32x32x16_bf16 v[32:47], a[232:235], v[56:59], v[32:47]
    s_waitcnt lgkmcnt(2)
    v_mfma_f32_32x32x16_bf16 v[16:31], a[92:95], v[60:63], v[16:31]
    ds_read_b128 v[56:59], v9 offset:26624
    v_mfma_f32_32x32x16_bf16 v[32:47], a[236:239], v[60:63], v[32:47]
    s_waitcnt lgkmcnt(2)
    v_mfma_f32_32x32x16_bf16 v[16:31], a[96:99], v[48:51], v[16:31]
    ds_read_b128 v[60:63], v9 offset:27648
    v_mfma_f32_32x32x16_bf16 v[32:47], a[240:243], v[48:51], v[32:47]
    s_waitcnt lgkmcnt(2)
    v_mfma_f32_32x32x16_bf16 v[16:31], a[100:103], v[52:55], v[16:31]
    ds_read_b128 v[48:51], v9 offset:28672
    v_mfma_f32_32x32x16_bf16 v[32:47], a[244:247], v[52:55], v[32:47]
    s_waitcnt lgkmcnt(2)
    v_mfma_f32_32x32x16_bf16 v[16:31], a[104:107], v[56:59], v[16:31]
    ds_read_b128 v[52:55], v9 offset:29696
    v_mfma_f32_32x32x16_bf16 v[32:47], a[248:251], v[56:59], v[32:47]
    s_waitcnt lgkmcnt(2)
    v_mfma_f32_32x32x16_bf16 v[16:31], a[108:111], v[60:63], v[16:31]
    ds_read_b128 v[56:59], v9 offset:30720
    v_mfma_f32_32x32x16_bf16 v[32:47], a[252:255], v[60:63], v[32:47]
    s_waitcnt lgkmcnt(2)
    v_mfma_f32_32x32x16_bf16 v[16:31], a[112:115], v[48:51], v[16:31]
    ds_read_b128 v[60:63], v9 offset:31744
    v_mfma_f32_32x32x16_bf16 v[32:47], v[152:155], v[48:51], v[32:47]
    s_waitcnt lgkmcnt(2)
    v_mfma_f32_32x32x16_bf16 v[16:31], a[116:119], v[52:55], v[16:31]
    ds_read_b128 v[48:51], v9 offset:32768
    v_mfma_f32_32x32x16_bf16 v[32:47], v[156:159], v[52:55], v[32:47]
    s_waitcnt lgkmcnt(2)
    v_mfma_f32_32x32x16_bf16 v[16:31], a[120:123], v[56:59], v[16:31]
    ds_read_b128 v[52:55], v9 offset:33792
    v_mfma_f32_32x32x16_bf16 v[32:47], v[160:163], v[56:59], v[32:47]
    s_waitcnt lgkmcnt(2)
    v_mfma_f32_32x32x16_bf16 v[16:31], a[124:127], v[60:63], v[16:31]
    v_cmp_eq_u32 s[76:77], 1, v2
    v_cmp_eq_u32 vcc, 2, v2
    s_cmp_eq_u64 s[76:77], -1
    s_cselect_b32 s38, 1, 0
    ds_read_b128 v[56:59], v9 offset:34816
    v_mfma_f32_32x32x16_bf16 v[32:47], v[164:167], v[60:63], v[32:47]
    s_cmp_lg_u32 s38, 0
    s_cselect_b64 exec, 1, 0
    v_mov_b32 v15, s32
    ds_write_b32 v184, v15
    v_mov_b32 v2, 2
    s_mov_b64 exec, -1
    s_waitcnt lgkmcnt(3)
    v_mfma_f32_32x32x16_bf16 v[16:31], a[128:131], v[48:51], v[16:31]
    s_add_u32 s32, s32, s38
    s_mul_i32 s38, s38, 22528
    s_add_u32 s33, s33, s38
    ds_read_b128 v[60:63], v9 offset:35840
    v_mfma_f32_32x32x16_bf16 v[32:47], v[168:171], v[48:51], v[32:47]
    s_cmp_eq_u64 vcc, 0
    s_cselect_b32 s38, s32, 0x7fff
    s_waitcnt lgkmcnt(3)
    v_mfma_f32_32x32x16_bf16 v[16:31], a[132:135], v[52:55], v[16:31]
    s_cmp_le_u32 s38, s39
    s_cselect_b64 exec, -1, 0
    v_mov_b32 v2, 2
    buffer_load_dword v2, v1, s[8:11], s33 offen sc1
    s_mov_b64 exec, -1
    v_mfma_f32_32x32x16_bf16 v[32:47], v[172:175], v[52:55], v[32:47]
    s_waitcnt lgkmcnt(2)
    v_mfma_f32_32x32x16_bf16 v[16:31], a[136:139], v[56:59], v[16:31]
    v_mfma_f32_32x32x16_bf16 v[32:47], v[176:179], v[56:59], v[32:47]
    s_waitcnt lgkmcnt(0)
    v_mfma_f32_32x32x16_bf16 v[16:31], a[140:143], v[60:63], v[16:31]
    v_mfma_f32_32x32x16_bf16 v[32:47], v[180:183], v[60:63], v[32:47]
    s_add_u32 s51, s46, 8192
    s_nop 2
    v_pk_fma_f32 v[16:17], v[16:17], v[148:149], v[100:101] op_sel_hi:[1,0,1] neg_lo:[0,0,1] neg_hi:[0,0,1]
    v_pk_fma_f32 v[18:19], v[18:19], v[148:149], v[102:103] op_sel_hi:[1,0,1] neg_lo:[0,0,1] neg_hi:[0,0,1]
    v_pk_fma_f32 v[20:21], v[20:21], v[148:149], v[104:105] op_sel_hi:[1,0,1] neg_lo:[0,0,1] neg_hi:[0,0,1]
    v_pk_fma_f32 v[22:23], v[22:23], v[148:149], v[106:107] op_sel_hi:[1,0,1] neg_lo:[0,0,1] neg_hi:[0,0,1]
    v_pk_fma_f32 v[24:25], v[24:25], v[148:149], v[108:109] op_sel_hi:[1,0,1] neg_lo:[0,0,1] neg_hi:[0,0,1]
    v_pk_fma_f32 v[26:27], v[26:27], v[148:149], v[110:111] op_sel_hi:[1,0,1] neg_lo:[0,0,1] neg_hi:[0,0,1]
    v_pk_fma_f32 v[28:29], v[28:29], v[148:149], v[112:113] op_sel_hi:[1,0,1] neg_lo:[0,0,1] neg_hi:[0,0,1]
    v_pk_fma_f32 v[30:31], v[30:31], v[148:149], v[114:115] op_sel_hi:[1,0,1] neg_lo:[0,0,1] neg_hi:[0,0,1]
    v_cvt_pk_bf16_f32 v188, v16, v24
    v_cvt_pk_bf16_f32 v189, v17, v25
    v_cvt_pk_bf16_f32 v190, v18, v26
    v_cvt_pk_bf16_f32 v191, v19, v27
    buffer_store_dwordx4 v[188:191], v14, s[8:11], s46 offen offset:0 sc1
    v_cvt_pk_bf16_f32 v192, v20, v28
    v_cvt_pk_bf16_f32 v193, v21, v29
    v_cvt_pk_bf16_f32 v194, v22, v30
    v_cvt_pk_bf16_f32 v195, v23, v31
    buffer_store_dwordx4 v[192:195], v14, s[8:11], s46 offen offset:512 sc1
    v_pk_fma_f32 v[32:33], v[32:33], v[148:149], v[132:133] op_sel_hi:[1,0,1] neg_lo:[0,0,1] neg_hi:[0,0,1]
    v_pk_fma_f32 v[34:35], v[34:35], v[148:149], v[134:135] op_sel_hi:[1,0,1] neg_lo:[0,0,1] neg_hi:[0,0,1]
    v_pk_fma_f32 v[36:37], v[36:37], v[148:149], v[136:137] op_sel_hi:[1,0,1] neg_lo:[0,0,1] neg_hi:[0,0,1]
    v_pk_fma_f32 v[38:39], v[38:39], v[148:149], v[138:139] op_sel_hi:[1,0,1] neg_lo:[0,0,1] neg_hi:[0,0,1]
    v_pk_fma_f32 v[40:41], v[40:41], v[148:149], v[140:141] op_sel_hi:[1,0,1] neg_lo:[0,0,1] neg_hi:[0,0,1]
    v_pk_fma_f32 v[42:43], v[42:43], v[148:149], v[142:143] op_sel_hi:[1,0,1] neg_lo:[0,0,1] neg_hi:[0,0,1]
    v_pk_fma_f32 v[44:45], v[44:45], v[148:149], v[144:145] op_sel_hi:[1,0,1] neg_lo:[0,0,1] neg_hi:[0,0,1]
    v_pk_fma_f32 v[46:47], v[46:47], v[148:149], v[146:147] op_sel_hi:[1,0,1] neg_lo:[0,0,1] neg_hi:[0,0,1]
    v_cvt_pk_bf16_f32 v196, v32, v40
    v_cvt_pk_bf16_f32 v197, v33, v41
    v_cvt_pk_bf16_f32 v198, v34, v42
    v_cvt_pk_bf16_f32 v199, v35, v43
    buffer_store_dwordx4 v[196:199], v14, s[8:11], s51 offen offset:0 sc1
    v_cvt_pk_bf16_f32 v200, v36, v44
    v_cvt_pk_bf16_f32 v201, v37, v45
    v_cvt_pk_bf16_f32 v202, v38, v46
    v_cvt_pk_bf16_f32 v203, v39, v47
    buffer_store_dwordx4 v[200:203], v14, s[8:11], s51 offen offset:512 sc1
    s_mul_i32 s43, s57, 22528
    s_add_u32 s43, s43, s49
    s_branch LpQQ_none
LpQQ_f_1:
    v_mfma_f32_32x32x16_bf16 v[16:31], a[8:11], v[56:59], v[16:31]
    ds_read_b128 v[52:55], v9 offset:5120
    v_add_f32 v67, v67, v79
    s_waitcnt lgkmcnt(3)
    v_add_f32 v64, v64, v80
    v_add_f32 v65, v65, v81
    v_mfma_f32_32x32x16_bf16 v[32:47], a[152:155], v[56:59], v[32:47]
    v_add_f32 v66, v66, v82
    v_add_f32 v67, v67, v83
    v_add_f32 v64, v64, v66
    v_add_f32 v65, v65, v67
    s_waitcnt lgkmcnt(2)
    v_mfma_f32_32x32x16_bf16 v[16:31], a[12:15], v[60:63], v[16:31]
    ds_read_b128 v[56:59], v9 offset:6144
    v_mov_b32 v66, v64
    v_mov_b32 v67, v65
    s_nop 0
    v_permlane32_swap_b32 v64, v66
    v_mfma_f32_32x32x16_bf16 v[32:47], a[156:159], v[60:63], v[32:47]
    v_permlane32_swap_b32 v65, v67
    v_add_f32 v64, v64, v66
    v_add_f32 v65, v65, v67
    v_mul_f32 v64, 0x3ae38e39, v64
    s_waitcnt lgkmcnt(2)
    v_mfma_f32_32x32x16_bf16 v[16:31], a[16:19], v[48:51], v[16:31]
    ds_read_b128 v[60:63], v9 offset:7168
    v_mul_f32 v65, 0x3ae38e39, v65
    v_fma_f32 v65, -v64, v64, v65
    v_max_f32 v65, 0, v65
    v_mfma_f32_32x32x16_bf16 v[32:47], a[160:163], v[48:51], v[32:47]
    v_add_f32 v65, 0x3727c5ac, v65
    v_rsq_f32 v148, v65
    s_nop 0
    v_mul_f32 v149, v64, v148
    v_mul_f32 v100, v149, v84
    s_waitcnt lgkmcnt(2)
    v_mfma_f32_32x32x16_bf16 v[16:31], a[20:23], v[52:55], v[16:31]
    ds_read_b128 v[48:51], v9 offset:8192
    v_mul_f32 v101, v149, v85
    v_mul_f32 v102, v149, v86
    v_mul_f32 v103, v149, v87
    v_mfma_f32_32x32x16_bf16 v[32:47], a[164:167], v[52:55], v[32:47]
    v_mul_f32 v104, v149, v88
    v_mul_f32 v105, v149, v89
    v_mul_f32 v106, v149, v90
    v_mul_f32 v107, v149, v91
    s_waitcnt lgkmcnt(2)
    v_mfma_f32_32x32x16_bf16 v[16:31], a[24:27], v[56:59], v[16:31]
    ds_read_b128 v[52:55], v9 offset:9216
    v_mul_f32 v108, v149, v92
    v_mul_f32 v109, v149, v93
    v_mul_f32 v110, v149, v94
    v_mfma_f32_32x32x16_bf16 v[32:47], a[168:171], v[56:59], v[32:47]
    v_mul_f32 v111, v149, v95
    v_mul_f32 v112, v149, v96
    v_mul_f32 v113, v149, v97
    v_mul_f32 v114, v149, v98
    s_waitcnt lgkmcnt(2)
    v_mfma_f32_32x32x16_bf16 v[16:31], a[28:31], v[60:63], v[16:31]
    ds_read_b128 v[56:59], v9 offset:10240
    v_mul_f32 v115, v149, v99
    v_mul_f32 v132, v149, v116
    v_mul_f32 v133, v149, v117
    v_mfma_f32_32x32x16_bf16 v[32:47], a[172:175], v[60:63], v[32:47]
    v_mul_f32 v134, v149, v118
    v_mul_f32 v135, v149, v119
    v_mul_f32 v136, v149, v120
    v_mul_f32 v137, v149, v121
    s_waitcnt lgkmcnt(2)
    v_mfma_f32_32x32x16_bf16 v[16:31], a[32:35], v[48:51], v[16:31]
    ds_read_b128 v[60:63], v9 offset:11264
    v_mul_f32 v138, v149, v122
    v_mul_f32 v139, v149, v123
    v_mul_f32 v140, v149, v124
    v_mfma_f32_32x32x16_bf16 v[32:47], a[176:179], v[48:51], v[32:47]
    v_mul_f32 v141, v149, v125
    v_mul_f32 v142, v149, v126
    v_mul_f32 v143, v149, v127
    v_mul_f32 v144, v149, v128
    s_waitcnt lgkmcnt(2)
    v_mfma_f32_32x32x16_bf16 v[16:31], a[36:39], v[52:55], v[16:31]
    ds_read_b128 v[48:51], v9 offset:12288
    v_mul_f32 v145, v149, v129
    v_mul_f32 v146, v149, v130
    v_mul_f32 v147, v149, v131
    v_mfma_f32_32x32x16_bf16 v[32:47], a[180:183], v[52:55], v[32:47]
    s_mul_i32 s46, s34, 50331648
    s_lshl_b32 s51, s35, 18
    s_add_u32 s46, s46, s51
    s_add_u32 s46, s46, s52
    s_waitcnt lgkmcnt(2)
    v_mfma_f32_32x32x16_bf16 v[16:31], a[40:43], v[56:59], v[16:31]
    s_add_u32 m0, s59, 0
    s_add_u32 s47, s41, 0
    buffer_load_dwordx4 v0, s[8:11], s47 offen offset:0 lds
    buffer_load_dwordx4 v0, s[8:11], s47 offen offset:1024 lds
    ds_read_b128 v[52:55], v9 offset:13312
    v_mfma_f32_32x32x16_bf16 v[32:47], a[184:187], v[56:59], v[32:47]
    buffer_load_dwordx4 v0, s[8:11], s47 offen offset:2048 lds
    buffer_load_dwordx4 v0, s[8:11], s47 offen offset:3072 lds
    s_add_u32 m0, s59, 4096
    s_add_u32 s47, s41, 4096
    buffer_load_dwordx4 v0, s[8:11], s47 offen offset:0 lds
    s_waitcnt lgkmcnt(2)
    v_mfma_f32_32x32x16_bf16 v[16:31], a[44:47], v[60:63], v[16:31]
    buffer_load_dwordx4 v0, s[8:11], s47 offen offset:1024 lds
    buffer_load_dwordx4 v0, s[8:11], s47 offen offset:2048 lds
    buffer_load_dwordx4 v0, s[8:11], s47 offen offset:3072 lds
    ds_read_b128 v[56:59], v9 offset:14336
    v_mfma_f32_32x32x16_bf16 v[32:47], a[188:191], v[60:63], v[32:47]
    s_add_u32 m0, s59, 8192
    s_add_u32 s47, s41, 8192
    buffer_load_dwordx4 v0, s[8:11], s47 offen offset:0 lds
    s_waitcnt lgkmcnt(2)
    v_mfma_f32_32x32x16_bf16 v[16:31], a[48:51], v[48:51], v[16:31]
    s_mul_i32 s48, s36, 786432
    s_mul_i32 s18, s37, 6144
    s_add_u32 s48, s48, s18
    s_add_u32 s48, s48, 16125952
    s_add_u32 m0, s66, 4096
    s_nop 0
    buffer_load_dwordx4 v0, s[8:11], s48 offen lds
    ds_read_b128 v[60:63], v9 offset:15360
    v_mfma_f32_32x32x16_bf16 v[32:47], a[192:195], v[48:51], v[32:47]
    s_add_u32 m0, s66, s67
    s_sub_u32 s48, s48, 4096
    s_add_u32 s48, s48, s67
    buffer_load_dwordx4 v0, s[8:11], s48 offen lds
    s_waitcnt vmcnt(12)
    s_cmp_lg_u32 s43, 0
    s_cselect_b64 exec, 3, 0
    buffer_store_dword v3, v185, s[8:11], s43 offen sc1
    s_mov_b64 exec, -1
    s_mov_b32 s43, 0
    s_waitcnt lgkmcnt(2)
    v_mfma_f32_32x32x16_bf16 v[16:31], a[52:55], v[52:55], v[16:31]
    ds_read_b128 v[48:51], v9 offset:16384
    v_mfma_f32_32x32x16_bf16 v[32:47], a[196:199], v[52:55], v[32:47]
    s_waitcnt lgkmcnt(2)
    v_mfma_f32_32x32x16_bf16 v[16:31], a[56:59], v[56:59], v[16:31]
    v_cmp_eq_u32 s[76:77], 1, v2
    v_cmp_eq_u32 vcc, 2, v2
    s_cmp_eq_u64 s[76:77], -1
    s_cselect_b32 s38, 1, 0
    ds_read_b128 v[52:55], v9 offset:17408
    v_mfma_f32_32x32x16_bf16 v[32:47], a[200:203], v[56:59], v[32:47]
    s_cmp_lg_u32 s38, 0
    s_cselect_b64 exec, 1, 0
    v_mov_b32 v15, s32
    ds_write_b32 v184, v15
    v_mov_b32 v2, 2
    s_mov_b64 exec, -1
    s_waitcnt lgkmcnt(3)
    v_mfma_f32_32x32x16_bf16 v[16:31], a[60:63], v[60:63], v[16:31]
    s_add_u32 s32, s32, s38
    s_mul_i32 s38, s38, 22528
    s_add_u32 s33, s33, s38
    ds_read_b128 v[56:59], v9 offset:18432
    v_mfma_f32_32x32x16_bf16 v[32:47], a[204:207], v[60:63], v[32:47]
    s_cmp_eq_u64 vcc, 0
    s_cselect_b32 s38, s32, 0x7fff
    s_waitcnt lgkmcnt(3)
    v_mfma_f32_32x32x16_bf16 v[16:31], a[64:67], v[48:51], v[16:31]
    ds_read_b128 v[60:63], v9 offset:19456
    v_mfma_f32_32x32x16_bf16 v[32:47], a[208:211], v[48:51], v[32:47]
    s_cmp_le_u32 s38, s39
    s_cselect_b64 exec, -1, 0
    v_mov_b32 v2, 2
    buffer_load_dword v2, v1, s[8:11], s33 offen sc1
    s_mov_b64 exec, -1
    s_waitcnt lgkmcnt(3)
    v_mfma_f32_32x32x16_bf16 v[16:31], a[68:71], v[52:55], v[16:31]
    ds_read_b128 v[48:51], v9 offset:20480
    v_mfma_f32_32x32x16_bf16 v[32:47], a[212:215], v[52:55], v[32:47]
    s_waitcnt lgkmcnt(2)
    v_mfma_f32_32x32x16_bf16 v[16:31], a[72:75], v[56:59], v[16:31]
    ds_read_b128 v[52:55], v9 offset:21504
    v_mfma_f32_32x32x16_bf16 v[32:47], a[216:219], v[56:59], v[32:47]
    s_waitcnt lgkmcnt(2)
    v_mfma_f32_32x32x16_bf16 v[16:31], a[76:79], v[60:63], v[16:31]
    ds_read_b128 v[56:59], v9 offset:22528
    v_mfma_f32_32x32x16_bf16 v[32:47], a[220:223], v[60:63], v[32:47]
    s_waitcnt lgkmcnt(2)
    v_mfma_f32_32x32x16_bf16 v[16:31], a[80:83], v[48:51], v[16:31]
    ds_read_b128 v[60:63], v9 offset:23552
    v_mfma_f32_32x32x16_bf16 v[32:47], a[224:227], v[48:51], v[32:47]
    s_waitcnt lgkmcnt(2)
    v_mfma_f32_32x32x16_bf16 v[16:31], a[84:87], v[52:55], v[16:31]
    ds_read_b128 v[48:51], v9 offset:24576
    v_mfma_f32_32x32x16_bf16 v[32:47], a[228:231], v[52:55], v[32:47]
    s_waitcnt lgkmcnt(2)
    v_mfma_f32_32x32x16_bf16 v[16:31], a[88:91], v[56:59], v[16:31]
    ds_read_b128 v[52:55], v9 offset:25600
    v_mfma_f32_32x32x16_bf16 v[32:47], a[232:235], v[56:59], v[32:47]
    s_waitcnt lgkmcnt(2)
    v_mfma_f32_32x32x16_bf16 v[16:31], a[92:95], v[60:63], v[16:31]
    ds_read_b128 v[56:59], v9 offset:26624
    v_mfma_f32_32x32x16_bf16 v[32:47], a[236:239], v[60:63], v[32:47]
    s_waitcnt lgkmcnt(2)
    v_mfma_f32_32x32x16_bf16 v[16:31], a[96:99], v[48:51], v[16:31]
    ds_read_b128 v[60:63], v9 offset:27648
    v_mfma_f32_32x32x16_bf16 v[32:47], a[240:243], v[48:51], v[32:47]
    s_waitcnt lgkmcnt(2)
    v_mfma_f32_32x32x16_bf16 v[16:31], a[100:103], v[52:55], v[16:31]
    ds_read_b128 v[48:51], v9 offset:28672
    v_mfma_f32_32x32x16_bf16 v[32:47], a[244:247], v[52:55], v[32:47]
    s_waitcnt lgkmcnt(2)
    v_mfma_f32_32x32x16_bf16 v[16:31], a[104:107], v[56:59], v[16:31]
    ds_read_b128 v[52:55], v9 offset:29696
    v_mfma_f32_32x32x16_bf16 v[32:47], a[248:251], v[56:59], v[32:47]
    s_waitcnt lgkmcnt(2)
    v_mfma_f32_32x32x16_bf16 v[16:31], a[108:111], v[60:63], v[16:31]
    ds_read_b128 v[56:59], v9 offset:30720
    v_mfma_f32_32x32x16_bf16 v[32:47], a[252:255], v[60:63], v[32:47]
    s_waitcnt lgkmcnt(2)
    v_mfma_f32_32x32x16_bf16 v[16:31], a[112:115], v[48:51], v[16:31]
    ds_read_b128 v[60:63], v9 offset:31744
    v_mfma_f32_32x32x16_bf16 v[32:47], v[152:155], v[48:51], v[32:47]
    s_waitcnt lgkmcnt(2)
    v_mfma_f32_32x32x16_bf16 v[16:31], a[116:119], v[52:55], v[16:31]
    ds_read_b128 v[48:51], v9 offset:32768
    v_mfma_f32_32x32x16_bf16 v[32:47], v[156:159], v[52:55], v[32:47]
    s_waitcnt lgkmcnt(2)
    v_mfma_f32_32x32x16_bf16 v[16:31], a[120:123], v[56:59], v[16:31]
    ds_read_b128 v[52:55], v9 offset:33792
    v_mfma_f32_32x32x16_bf16 v[32:47], v[160:163], v[56:59], v[32:47]
    s_waitcnt lgkmcnt(2)
    v_mfma_f32_32x32x16_bf16 v[16:31], a[124:127], v[60:63], v[16:31]
    v_cmp_eq_u32 s[76:77], 1, v2
    v_cmp_eq_u32 vcc, 2, v2
    s_cmp_eq_u64 s[76:77], -1
    s_cselect_b32 s38, 1, 0
    ds_read_b128 v[56:59], v9 offset:34816
    v_mfma_f32_32x32x16_bf16 v[32:47], v[164:167], v[60:63], v[32:47]
    s_cmp_lg_u32 s38, 0
    s_cselect_b64 exec, 1, 0
    v_mov_b32 v15, s32
    ds_write_b32 v184, v15
    v_mov_b32 v2, 2
    s_mov_b64 exec, -1
    s_waitcnt lgkmcnt(3)
    v_mfma_f32_32x32x16_bf16 v[16:31], a[128:131], v[48:51], v[16:31]
    s_add_u32 s32, s32, s38
    s_mul_i32 s38, s38, 22528
    s_add_u32 s33, s33, s38
    ds_read_b128 v[60:63], v9 offset:35840
    v_mfma_f32_32x32x16_bf16 v[32:47], v[168:171], v[48:51], v[32:47]
    s_cmp_eq_u64 vcc, 0
    s_cselect_b32 s38, s32, 0x7fff
    s_waitcnt lgkmcnt(3)
    v_mfma_f32_32x32x16_bf16 v[16:31], a[132:135], v[52:55], v[16:31]
    s_cmp_le_u32 s38, s39
    s_cselect_b64 exec, -1, 0
    v_mov_b32 v2, 2
    buffer_load_dword v2, v1, s[8:11], s33 offen sc1
    s_mov_b64 exec, -1
    v_mfma_f32_32x32x16_bf16 v[32:47], v[172:175], v[52:55], v[32:47]
    s_waitcnt lgkmcnt(2)
    v_mfma_f32_32x32x16_bf16 v[16:31], a[136:139], v[56:59], v[16:31]
    v_mfma_f32_32x32x16_bf16 v[32:47], v[176:179], v[56:59], v[32:47]
    s_waitcnt lgkmcnt(0)
    v_mfma_f32_32x32x16_bf16 v[16:31], a[140:143], v[60:63], v[16:31]
    v_mfma_f32_32x32x16_bf16 v[32:47], v[180:183], v[60:63], v[32:47]
    s_add_u32 s51, s46, 8192
    s_nop 2
    v_pk_fma_f32 v[16:17], v[16:17], v[148:149], v[100:101] op_sel_hi:[1,0,1] neg_lo:[0,0,1] neg_hi:[0,0,1]
    v_pk_fma_f32 v[18:19], v[18:19], v[148:149], v[102:103] op_sel_hi:[1,0,1] neg_lo:[0,0,1] neg_hi:[0,0,1]
    v_pk_fma_f32 v[20:21], v[20:21], v[148:149], v[104:105] op_sel_hi:[1,0,1] neg_lo:[0,0,1] neg_hi:[0,0,1]
    v_pk_fma_f32 v[22:23], v[22:23], v[148:149], v[106:107] op_sel_hi:[1,0,1] neg_lo:[0,0,1] neg_hi:[0,0,1]
    v_pk_fma_f32 v[24:25], v[24:25], v[148:149], v[108:109] op_sel_hi:[1,0,1] neg_lo:[0,0,1] neg_hi:[0,0,1]
    v_pk_fma_f32 v[26:27], v[26:27], v[148:149], v[110:111] op_sel_hi:[1,0,1] neg_lo:[0,0,1] neg_hi:[0,0,1]
    v_pk_fma_f32 v[28:29], v[28:29], v[148:149], v[112:113] op_sel_hi:[1,0,1] neg_lo:[0,0,1] neg_hi:[0,0,1]
    v_pk_fma_f32 v[30:31], v[30:31], v[148:149], v[114:115] op_sel_hi:[1,0,1] neg_lo:[0,0,1] neg_hi:[0,0,1]
    v_cvt_pk_bf16_f32 v188, v16, v24
    v_cvt_pk_bf16_f32 v189, v17, v25
    v_cvt_pk_bf16_f32 v190, v18, v26
    v_cvt_pk_bf16_f32 v191, v19, v27
    buffer_store_dwordx4 v[188:191], v14, s[8:11], s46 offen offset:0 sc1
    v_cvt_pk_bf16_f32 v192, v20, v28
    v_cvt_pk_bf16_f32 v193, v21, v29
    v_cvt_pk_bf16_f32 v194, v22, v30
    v_cvt_pk_bf16_f32 v195, v23, v31
    buffer_store_dwordx4 v[192:195], v14, s[8:11], s46 offen offset:512 sc1
    v_pk_fma_f32 v[32:33], v[32:33], v[148:149], v[132:133] op_sel_hi:[1,0,1] neg_lo:[0,0,1] neg_hi:[0,0,1]
    v_pk_fma_f32 v[34:35], v[34:35], v[148:149], v[134:135] op_sel_hi:[1,0,1] neg_lo:[0,0,1] neg_hi:[0,0,1]
    v_pk_fma_f32 v[36:37], v[36:37], v[148:149], v[136:137] op_sel_hi:[1,0,1] neg_lo:[0,0,1] neg_hi:[0,0,1]
    v_pk_fma_f32 v[38:39], v[38:39], v[148:149], v[138:139] op_sel_hi:[1,0,1] neg_lo:[0,0,1] neg_hi:[0,0,1]
    v_pk_fma_f32 v[40:41], v[40:41], v[148:149], v[140:141] op_sel_hi:[1,0,1] neg_lo:[0,0,1] neg_hi:[0,0,1]
    v_pk_fma_f32 v[42:43], v[42:43], v[148:149], v[142:143] op_sel_hi:[1,0,1] neg_lo:[0,0,1] neg_hi:[0,0,1]
    v_pk_fma_f32 v[44:45], v[44:45], v[148:149], v[144:145] op_sel_hi:[1,0,1] neg_lo:[0,0,1] neg_hi:[0,0,1]
    v_pk_fma_f32 v[46:47], v[46:47], v[148:149], v[146:147] op_sel_hi:[1,0,1] neg_lo:[0,0,1] neg_hi:[0,0,1]
    v_cvt_pk_bf16_f32 v196, v32, v40
    v_cvt_pk_bf16_f32 v197, v33, v41
    v_cvt_pk_bf16_f32 v198, v34, v42
    v_cvt_pk_bf16_f32 v199, v35, v43
    buffer_store_dwordx4 v[196:199], v14, s[8:11], s51 offen offset:0 sc1
    v_cvt_pk_bf16_f32 v200, v36, v44
    v_cvt_pk_bf16_f32 v201, v37, v45
    v_cvt_pk_bf16_f32 v202, v38, v46
    v_cvt_pk_bf16_f32 v203, v39, v47
    buffer_store_dwordx4 v[200:203], v14, s[8:11], s51 offen offset:512 sc1
    s_mul_i32 s43, s57, 22528
    s_add_u32 s43, s43, s49
    s_branch LpQQ_head
LpQQ_f_2:
    v_mfma_f32_32x32x16_bf16 v[16:31], a[76:79], v[60:63], v[16:31]
    s_add_u32 m0, s59, 0
    s_add_u32 s47, s41, 0
    buffer_load_dwordx4 v0, s[8:11], s47 offen offset:0 lds
    ds_read_b128 v[56:59], v9 offset:22528
    v_mfma_f32_32x32x16_bf16 v[32:47], a[220:223], v[60:63], v[32:47]
    s_waitcnt lgkmcnt(2)
    v_mfma_f32_32x32x16_bf16 v[16:31], a[80:83], v[48:51], v[16:31]
    buffer_load_dwordx4 v0, s[8:11], s47 offen offset:1024 lds
    ds_read_b128 v[60:63], v9 offset:23552
    v_mfma_f32_32x32x16_bf16 v[32:47], a[224:227], v[48:51], v[32:47]
    s_waitcnt lgkmcnt(2)
    v_mfma_f32_32x32x16_bf16 v[16:31], a[84:87], v[52:55], v[16:31]
    buffer_load_dwordx4 v0, s[8:11], s47 offen offset:2048 lds
    ds_read_b128 v[48:51], v9 offset:24576
    v_mfma_f32_32x32x16_bf16 v[32:47], a[228:231], v[52:55], v[32:47]
    s_waitcnt lgkmcnt(2)
    v_mfma_f32_32x32x16_bf16 v[16:31], a[88:91], v[56:59], v[16:31]
    buffer_load_dwordx4 v0, s[8:11], s47 offen offset:3072 lds
    ds_read_b128 v[52:55], v9 offset:25600
    v_mfma_f32_32x32x16_bf16 v[32:47], a[232:235], v[56:59], v[32:47]
    s_waitcnt lgkmcnt(2)
    v_mfma_f32_32x32x16_bf16 v[16:31], a[92:95], v[60:63], v[16:31]
    s_add_u32 m0, s59, 4096
    s_add_u32 s47, s41, 4096
    buffer_load_dwordx4 v0, s[8:11], s47 offen offset:0 lds
    ds_read_b128 v[56:59], v9 offset:26624
    v_mfma_f32_32x32x16_bf16 v[32:47], a[236:239], v[60:63], v[32:47]
    s_waitcnt lgkmcnt(2)
    v_mfma_f32_32x32x16_bf16 v[16:31], a[96:99], v[48:51], v[16:31]
    buffer_load_dwordx4 v0, s[8:11], s47 offen offset:1024 lds
    ds_read_b128 v[60:63], v9 offset:27648
    v_mfma_f32_32x32x16_bf16 v[32:47], a[240:243], v[48:51], v[32:47]
    s_waitcnt lgkmcnt(2)
    v_mfma_f32_32x32x16_bf16 v[16:31], a[100:103], v[52:55], v[16:31]
    buffer_load_dwordx4 v0, s[8:11], s47 offen offset:2048 lds
    ds_read_b128 v[48:51], v9 offset:28672
    v_mfma_f32_32x32x16_bf16 v[32:47], a[244:247], v[52:55], v[32:47]
    s_waitcnt lgkmcnt(2)
    v_mfma_f32_32x32x16_bf16 v[16:31], a[104:107], v[56:59], v[16:31]
    buffer_load_dwordx4 v0, s[8:11], s47 offen offset:3072 lds
    ds_read_b128 v[52:55], v9 offset:29696
    v_mfma_f32_32x32x16_bf16 v[32:47], a[248:251], v[56:59], v[32:47]
    s_waitcnt lgkmcnt(2)
    v_mfma_f32_32x32x16_bf16 v[16:31], a[108:111], v[60:63], v[16:31]
    s_add_u32 m0, s59, 8192
    s_add_u32 s47, s41, 8192
    buffer_load_dwordx4 v0, s[8:11], s47 offen offset:0 lds
    ds_read_b128 v[56:59], v9 offset:30720
    v_mfma_f32_32x32x16_bf16 v[32:47], a[252:255], v[60:63], v[32:47]
    s_waitcnt lgkmcnt(2)
    v_mfma_f32_32x32x16_bf16 v[16:31], a[112:115], v[48:51], v[16:31]
    s_mul_i32 s48, s36, 786432
    s_mul_i32 s18, s37, 6144
    s_add_u32 s48, s48, s18
    s_add_u32 s48, s48, 16125952
    s_add_u32 m0, s66, 4096
    s_nop 0
    buffer_load_dwordx4 v0, s[8:11], s48 offen lds
    ds_read_b128 v[60:63], v9 offset:31744
    v_mfma_f32_32x32x16_bf16 v[32:47], v[152:155], v[48:51], v[32:47]
    s_waitcnt lgkmcnt(2)
    v_mfma_f32_32x32x16_bf16 v[16:31], a[116:119], v[52:55], v[16:31]
    s_add_u32 m0, s66, s67
    s_sub_u32 s48, s48, 4096
    s_add_u32 s48, s48, s67
    buffer_load_dwordx4 v0, s[8:11], s48 offen lds
    ds_read_b128 v[48:51], v9 offset:32768
    v_mfma_f32_32x32x16_bf16 v[32:47], v[156:159], v[52:55], v[32:47]
    s_waitcnt lgkmcnt(2)
    v_mfma_f32_32x32x16_bf16 v[16:31], a[120:123], v[56:59], v[16:31]
    ds_read_b128 v[52:55], v9 offset:33792
    v_mfma_f32_32x32x16_bf16 v[32:47], v[160:163], v[56:59], v[32:47]
    s_waitcnt lgkmcnt(2)
    v_mfma_f32_32x32x16_bf16 v[16:31], a[124:127], v[60:63], v[16:31]
    v_cmp_eq_u32 s[76:77], 1, v2
    v_cmp_eq_u32 vcc, 2, v2
    s_cmp_eq_u64 s[76:77], -1
    s_cselect_b32 s38, 1, 0
    ds_read_b128 v[56:59], v9 offset:34816
    v_mfma_f32_32x32x16_bf16 v[32:47], v[164:167], v[60:63], v[32:47]
    s_cmp_lg_u32 s38, 0
    s_cselect_b64 exec, 1, 0
    v_mov_b32 v15, s32
    ds_write_b32 v184, v15
    v_mov_b32 v2, 2
    s_mov_b64 exec, -1
    s_waitcnt lgkmcnt(3)
    v_mfma_f32_32x32x16_bf16 v[16:31], a[128:131], v[48:51], v[16:31]
    s_add_u32 s32, s32, s38
    s_mul_i32 s38, s38, 22528
    s_add_u32 s33, s33, s38
    ds_read_b128 v[60:63], v9 offset:35840
    v_mfma_f32_32x32x16_bf16 v[32:47], v[168:171], v[48:51], v[32:47]
    s_cmp_eq_u64 vcc, 0
    s_cselect_b32 s38, s32, 0x7fff
    s_waitcnt lgkmcnt(3)
    v_mfma_f32_32x32x16_bf16 v[16:31], a[132:135], v[52:55], v[16:31]
    s_cmp_le_u32 s38, s39
    s_cselect_b64 exec, -1, 0
    v_mov_b32 v2, 2
    buffer_load_dword v2, v1, s[8:11], s33 offen sc1
    s_mov_b64 exec, -1
    v_mfma_f32_32x32x16_bf16 v[32:47], v[172:175], v[52:55], v[32:47]
    s_waitcnt lgkmcnt(2)
    v_mfma_f32_32x32x16_bf16 v[16:31], a[136:139], v[56:59], v[16:31]
    v_mfma_f32_32x32x16_bf16 v[32:47], v[176:179], v[56:59], v[32:47]
    s_waitcnt lgkmcnt(0)
    v_mfma_f32_32x32x16_bf16 v[16:31], a[140:143], v[60:63], v[16:31]
    v_mfma_f32_32x32x16_bf16 v[32:47], v[180:183], v[60:63], v[32:47]
    s_add_u32 s51, s46, 8192
    s_nop 2
    v_pk_fma_f32 v[16:17], v[16:17], v[148:149], v[100:101] op_sel_hi:[1,0,1] neg_lo:[0,0,1] neg_hi:[0,0,1]
    v_pk_fma_f32 v[18:19], v[18:19], v[148:149], v[102:103] op_sel_hi:[1,0,1] neg_lo:[0,0,1] neg_hi:[0,0,1]
    v_pk_fma_f32 v[20:21], v[20:21], v[148:149], v[104:105] op_sel_hi:[1,0,1] neg_lo:[0,0,1] neg_hi:[0,0,1]
    v_pk_fma_f32 v[22:23], v[22:23], v[148:149], v[106:107] op_sel_hi:[1,0,1] neg_lo:[0,0,1] neg_hi:[0,0,1]
    v_pk_fma_f32 v[24:25], v[24:25], v[148:149], v[108:109] op_sel_hi:[1,0,1] neg_lo:[0,0,1] neg_hi:[0,0,1]
    v_pk_fma_f32 v[26:27], v[26:27], v[148:149], v[110:111] op_sel_hi:[1,0,1] neg_lo:[0,0,1] neg_hi:[0,0,1]
    v_pk_fma_f32 v[28:29], v[28:29], v[148:149], v[112:113] op_sel_hi:[1,0,1] neg_lo:[0,0,1] neg_hi:[0,0,1]
    v_pk_fma_f32 v[30:31], v[30:31], v[148:149], v[114:115] op_sel_hi:[1,0,1] neg_lo:[0,0,1] neg_hi:[0,0,1]
    v_cvt_pk_bf16_f32 v188, v16, v24
    v_cvt_pk_bf16_f32 v189, v17, v25
    v_cvt_pk_bf16_f32 v190, v18, v26
    v_cvt_pk_bf16_f32 v191, v19, v27
    buffer_store_dwordx4 v[188:191], v14, s[8:11], s46 offen offset:0 sc1
    v_cvt_pk_bf16_f32 v192, v20, v28
    v_cvt_pk_bf16_f32 v193, v21, v29
    v_cvt_pk_bf16_f32 v194, v22, v30
    v_cvt_pk_bf16_f32 v195, v23, v31
    buffer_store_dwordx4 v[192:195], v14, s[8:11], s46 offen offset:512 sc1
    v_pk_fma_f32 v[32:33], v[32:33], v[148:149], v[132:133] op_sel_hi:[1,0,1] neg_lo:[0,0,1] neg_hi:[0,0,1]
    v_pk_fma_f32 v[34:35], v[34:35], v[148:149], v[134:135] op_sel_hi:[1,0,1] neg_lo:[0,0,1] neg_hi:[0,0,1]
    v_pk_fma_f32 v[36:37], v[36:37], v[148:149], v[136:137] op_sel_hi:[1,0,1] neg_lo:[0,0,1] neg_hi:[0,0,1]
    v_pk_fma_f32 v[38:39], v[38:39], v[148:149], v[138:139] op_sel_hi:[1,0,1] neg_lo:[0,0,1] neg_hi:[0,0,1]
    v_pk_fma_f32 v[40:41], v[40:41], v[148:149], v[140:141] op_sel_hi:[1,0,1] neg_lo:[0,0,1] neg_hi:[0,0,1]
    v_pk_fma_f32 v[42:43], v[42:43], v[148:149], v[142:143] op_sel_hi:[1,0,1] neg_lo:[0,0,1] neg_hi:[0,0,1]
    v_pk_fma_f32 v[44:45], v[44:45], v[148:149], v[144:145] op_sel_hi:[1,0,1] neg_lo:[0,0,1] neg_hi:[0,0,1]
    v_pk_fma_f32 v[46:47], v[46:47], v[148:149], v[146:147] op_sel_hi:[1,0,1] neg_lo:[0,0,1] neg_hi:[0,0,1]
    v_cvt_pk_bf16_f32 v196, v32, v40
    v_cvt_pk_bf16_f32 v197, v33, v41
    v_cvt_pk_bf16_f32 v198, v34, v42
    v_cvt_pk_bf16_f32 v199, v35, v43
    buffer_store_dwordx4 v[196:199], v14, s[8:11], s51 offen offset:0 sc1
    v_cvt_pk_bf16_f32 v200, v36, v44
    v_cvt_pk_bf16_f32 v201, v37, v45
    v_cvt_pk_bf16_f32 v202, v38, v46
    v_cvt_pk_bf16_f32 v203, v39, v47
    buffer_store_dwordx4 v[200:203], v14, s[8:11], s51 offen offset:512 sc1
    s_mul_i32 s43, s57, 22528
    s_add_u32 s43, s43, s49
    s_branch LpQQ_head
LpQQ_none:
    ds_read_b32 v15, v184
    s_waitcnt lgkmcnt(0)
    v_readfirstlane_b32 s17, v15
    s_nop 0
    s_cmp_lt_i32 s17, s37
    s_cbranch_scc1 LpQQ_nopost
    s_add_u32 m0, s59, 0
    s_add_u32 s47, s41, 0
    buffer_load_dwordx4 v0, s[8:11], s47 offen offset:0 lds
    buffer_load_dwordx4 v0, s[8:11], s47 offen offset:1024 lds
    buffer_load_dwordx4 v0, s[8:11], s47 offen offset:2048 lds
    buffer_load_dwordx4 v0, s[8:11], s47 offen offset:3072 lds
    s_add_u32 m0, s59, 4096
    s_add_u32 s47, s41, 4096
    buffer_load_dwordx4 v0, s[8:11], s47 offen offset:0 lds
    buffer_load_dwordx4 v0, s[8:11], s47 offen offset:1024 lds
    buffer_load_dwordx4 v0, s[8:11], s47 offen offset:2048 lds
    buffer_load_dwordx4 v0, s[8:11], s47 offen offset:3072 lds
    s_add_u32 m0, s59, 8192
    s_add_u32 s47, s41, 8192
    buffer_load_dwordx4 v0, s[8:11], s47 offen offset:0 lds
    s_mul_i32 s48, s36, 786432
    s_mul_i32 s18, s37, 6144
    s_add_u32 s48, s48, s18
    s_add_u32 s48, s48, 16125952
    s_add_u32 m0, s66, 4096
    s_nop 0
    buffer_load_dwordx4 v0, s[8:11], s48 offen lds
    s_add_u32 m0, s66, s67
    s_sub_u32 s48, s48, 4096
    s_add_u32 s48, s48, s67
    buffer_load_dwordx4 v0, s[8:11], s48 offen lds
    s_waitcnt vmcnt(11)
    s_cmp_lg_u32 s43, 0
    s_cselect_b64 exec, 3, 0
    buffer_store_dword v3, v185, s[8:11], s43 offen sc1
    s_mov_b64 exec, -1
    s_mov_b32 s43, 0
    s_waitcnt vmcnt(1) lgkmcnt(0)
    s_branch LpQQ_head2
LpQQ_nopost:
    s_waitcnt vmcnt(0)
    s_cmp_lg_u32 s43, 0
    s_cselect_b64 exec, 3, 0
    buffer_store_dword v3, v185, s[8:11], s43 offen sc1
    s_mov_b64 exec, -1
    s_mov_b32 s43, 0
    s_cmp_ge_u32 s37, 64
    s_cbranch_scc1 LpQQ_end
LpQQ_wait:
    s_mov_b32 s16, 0
    s_cmp_lg_u32 s14, 0
    s_cbranch_scc1 LpQQ_wl
LpQQ_wp:
    buffer_load_dword v2, v1, s[8:11], s60 offen sc1
    s_add_u32 s16, s16, 1
    s_cmp_gt_u32 s16, 100000
    s_cbranch_scc1 LpQQ_giveup
    s_waitcnt vmcnt(0)
    v_cmp_eq_u32 vcc, 0, v2
    s_nop 0
    s_cbranch_vccz LpQQ_wok
    s_sleep 4
    s_branch LpQQ_wp
LpQQ_giveup:
    v_mov_b32 v5, -2
    ds_write_b32 v184, v5
    s_waitcnt lgkmcnt(0)
    s_branch L_role_p_abort
LpQQ_wok:
    v_mov_b32 v5, s37
    ds_write_b32 v184, v5
    s_branch LpQQ_go
LpQQ_wl:
    ds_read_b32 v15, v184
    s_add_u32 s16, s16, 1
    s_cmp_gt_u32 s16, 1600000
    s_cbranch_scc1 L_role_p_abort
    s_waitcnt lgkmcnt(0)
    v_readfirstlane_b32 s17, v15
    s_nop 0
    s_cmp_eq_u32 s17, -2
    s_cbranch_scc1 L_role_p_abort
    s_cmp_ge_i32 s17, s37
    s_cbranch_scc1 LpQQ_go
    s_sleep 1
    s_branch LpQQ_wl
LpQQ_go:
    s_add_u32 m0, s59, 0
    s_add_u32 s47, s41, 0
    buffer_load_dwordx4 v0, s[8:11], s47 offen offset:0 lds
    buffer_load_dwordx4 v0, s[8:11], s47 offen offset:1024 lds
    buffer_load_dwordx4 v0, s[8:11], s47 offen offset:2048 lds
    buffer_load_dwordx4 v0, s[8:11], s47 offen offset:3072 lds
    s_add_u32 m0, s59, 4096
    s_add_u32 s47, s41, 4096
    buffer_load_dwordx4 v0, s[8:11], s47 offen offset:0 lds
    buffer_load_dwordx4 v0, s[8:11], s47 offen offset:1024 lds
    buffer_load_dwordx4 v0, s[8:11], s47 offen offset:2048 lds
    buffer_load_dwordx4 v0, s[8:11], s47 offen offset:3072 lds
    s_add_u32 m0, s59, 8192
    s_add_u32 s47, s41, 8192
    buffer_load_dwordx4 v0, s[8:11], s47 offen offset:0 lds
    s_mul_i32 s48, s36, 786432
    s_mul_i32 s18, s37, 6144
    s_add_u32 s48, s48, s18
    s_add_u32 s48, s48, 16125952
    s_add_u32 m0, s66, 4096
    s_nop 0
    buffer_load_dwordx4 v0, s[8:11], s48 offen lds
    s_add_u32 m0, s66, s67
    s_sub_u32 s48, s48, 4096
    s_add_u32 s48, s48, s67
    buffer_load_dwordx4 v0, s[8:11], s48 offen lds
    s_waitcnt vmcnt(0) lgkmcnt(0)
    s_branch LpQQ_head2
LpQQ_end:
    s_branch L_role_p_exit
Lp2_kv:
    v_mfma_f32_32x32x16_bf16 v[84:99], a[0:3], v[48:51], 0
    v_mfma_f32_32x32x16_bf16 v[32:47], v[48:51], a[144:147], 0
    v_mfma_f32_32x32x16_bf16 v[84:99], a[4:7], v[48:51], v[84:99]
    v_mfma_f32_32x32x16_bf16 v[32:47], v[48:51], a[148:151], v[32:47]
    v_mfma_f32_32x32x16_bf16 v[84:99], a[8:11], v[48:51], v[84:99]
    v_mfma_f32_32x32x16_bf16 v[32:47], v[48:51], a[152:155], v[32:47]
    v_mfma_f32_32x32x16_bf16 v[84:99], a[12:15], v[48:51], v[84:99]
    v_mfma_f32_32x32x16_bf16 v[32:47], v[48:51], a[156:159], v[32:47]
    v_mfma_f32_32x32x16_bf16 v[84:99], a[16:19], v[48:51], v[84:99]
    v_mfma_f32_32x32x16_bf16 v[32:47], v[48:51], a[160:163], v[32:47]
    v_mfma_f32_32x32x16_bf16 v[84:99], a[20:23], v[48:51], v[84:99]
    v_mfma_f32_32x32x16_bf16 v[32:47], v[48:51], a[164:167], v[32:47]
    v_mfma_f32_32x32x16_bf16 v[84:99], a[24:27], v[48:51], v[84:99]
    v_mfma_f32_32x32x16_bf16 v[32:47], v[48:51], a[168:171], v[32:47]
    v_mfma_f32_32x32x16_bf16 v[84:99], a[28:31], v[48:51], v[84:99]
    v_mfma_f32_32x32x16_bf16 v[32:47], v[48:51], a[172:175], v[32:47]
    v_mfma_f32_32x32x16_bf16 v[84:99], a[32:35], v[48:51], v[84:99]
    v_mfma_f32_32x32x16_bf16 v[32:47], v[48:51], a[176:179], v[32:47]
    v_mfma_f32_32x32x16_bf16 v[84:99], a[36:39], v[48:51], v[84:99]
    v_mfma_f32_32x32x16_bf16 v[32:47], v[48:51], a[180:183], v[32:47]
    v_mfma_f32_32x32x16_bf16 v[84:99], a[40:43], v[48:51], v[84:99]
    v_mfma_f32_32x32x16_bf16 v[32:47], v[48:51], a[184:187], v[32:47]
    v_mfma_f32_32x32x16_bf16 v[84:99], a[44:47], v[48:51], v[84:99]
    v_mfma_f32_32x32x16_bf16 v[32:47], v[48:51], a[188:191], v[32:47]
    v_mfma_f32_32x32x16_bf16 v[84:99], a[48:51], v[48:51], v[84:99]
    v_mfma_f32_32x32x16_bf16 v[32:47], v[48:51], a[192:195], v[32:47]
    v_mfma_f32_32x32x16_bf16 v[84:99], a[52:55], v[48:51], v[84:99]
    v_mfma_f32_32x32x16_bf16 v[32:47], v[48:51], a[196:199], v[32:47]
    v_mfma_f32_32x32x16_bf16 v[84:99], a[56:59], v[48:51], v[84:99]
    v_mfma_f32_32x32x16_bf16 v[32:47], v[48:51], a[200:203], v[32:47]
    v_mfma_f32_32x32x16_bf16 v[84:99], a[60:63], v[48:51], v[84:99]
    v_mfma_f32_32x32x16_bf16 v[32:47], v[48:51], a[204:207], v[32:47]
    v_mfma_f32_32x32x16_bf16 v[84:99], a[64:67], v[48:51], v[84:99]
    v_mfma_f32_32x32x16_bf16 v[32:47], v[48:51], a[208:211], v[32:47]
    v_mfma_f32_32x32x16_bf16 v[84:99], a[68:71], v[48:51], v[84:99]
    v_mfma_f32_32x32x16_bf16 v[32:47], v[48:51], a[212:215], v[32:47]
    v_mfma_f32_32x32x16_bf16 v[84:99], a[72:75], v[48:51], v[84:99]
    v_mfma_f32_32x32x16_bf16 v[32:47], v[48:51], a[216:219], v[32:47]
    v_mfma_f32_32x32x16_bf16 v[84:99], a[76:79], v[48:51], v[84:99]
    v_mfma_f32_32x32x16_bf16 v[32:47], v[48:51], a[220:223], v[32:47]
    v_mfma_f32_32x32x16_bf16 v[84:99], a[80:83], v[48:51], v[84:99]
    v_mfma_f32_32x32x16_bf16 v[32:47], v[48:51], a[224:227], v[32:47]
    v_mfma_f32_32x32x16_bf16 v[84:99], a[84:87], v[48:51], v[84:99]
    v_mfma_f32_32x32x16_bf16 v[32:47], v[48:51], a[228:231], v[32:47]
    v_mfma_f32_32x32x16_bf16 v[84:99], a[88:91], v[48:51], v[84:99]
    v_mfma_f32_32x32x16_bf16 v[32:47], v[48:51], a[232:235], v[32:47]
    v_mfma_f32_32x32x16_bf16 v[84:99], a[92:95], v[48:51], v[84:99]
    v_mfma_f32_32x32x16_bf16 v[32:47], v[48:51], a[236:239], v[32:47]
    v_mfma_f32_32x32x16_bf16 v[84:99], a[96:99], v[48:51], v[84:99]
    v_mfma_f32_32x32x16_bf16 v[32:47], v[48:51], a[240:243], v[32:47]
    v_mfma_f32_32x32x16_bf16 v[84:99], a[100:103], v[48:51], v[84:99]
    v_mfma_f32_32x32x16_bf16 v[32:47], v[48:51], a[244:247], v[32:47]
    v_mfma_f32_32x32x16_bf16 v[84:99], a[104:107], v[48:51], v[84:99]
    v_mfma_f32_32x32x16_bf16 v[32:47], v[48:51], a[248:251], v[32:47]
    v_mfma_f32_32x32x16_bf16 v[84:99], a[108:111], v[48:51], v[84:99]
    v_mfma_f32_32x32x16_bf16 v[32:47], v[48:51], a[252:255], v[32:47]
    v_mfma_f32_32x32x16_bf16 v[84:99], a[112:115], v[48:51], v[84:99]
    v_mfma_f32_32x32x16_bf16 v[32:47], v[48:51], v[152:155], v[32:47]
    v_mfma_f32_32x32x16_bf16 v[84:99], a[116:119], v[48:51], v[84:99]
    v_mfma_f32_32x32x16_bf16 v[32:47], v[48:51], v[156:159], v[32:47]
    v_mfma_f32_32x32x16_bf16 v[84:99], a[120:123], v[48:51], v[84:99]
    v_mfma_f32_32x32x16_bf16 v[32:47], v[48:51], v[160:163], v[32:47]
    v_mfma_f32_32x32x16_bf16 v[84:99], a[124:127], v[48:51], v[84:99]
    v_mfma_f32_32x32x16_bf16 v[32:47], v[48:51], v[164:167], v[32:47]
    v_mfma_f32_32x32x16_bf16 v[84:99], a[128:131], v[48:51], v[84:99]
    v_mfma_f32_32x32x16_bf16 v[32:47], v[48:51], v[168:171], v[32:47]
    v_mfma_f32_32x32x16_bf16 v[84:99], a[132:135], v[48:51], v[84:99]
    v_mfma_f32_32x32x16_bf16 v[32:47], v[48:51], v[172:175], v[32:47]
    v_mfma_f32_32x32x16_bf16 v[84:99], a[136:139], v[48:51], v[84:99]
    v_mfma_f32_32x32x16_bf16 v[32:47], v[48:51], v[176:179], v[32:47]
    v_mfma_f32_32x32x16_bf16 v[84:99], a[140:143], v[48:51], v[84:99]
    v_mfma_f32_32x32x16_bf16 v[32:47], v[48:51], v[180:183], v[32:47]
    s_nop 11
    v_mov_b32 v11, v32
    s_mov_b32 s66, 114688
    s_mov_b32 s71, 0x2000
    s_mov_b32 s36, s63
    s_mov_b32 s34, s63
    s_mul_i32 s58, s14, 9216
    s_mul_i32 s64, s63, 4718592
    s_add_u32 s64, s64, s58
    s_add_u32 s64, s64, 8650752
    s_mul_i32 s61, s63, 1441792
    s_add_u32 s61, s61, 3584
    s_mov_b32 s37, 0
    s_mov_b32 s40, 36864
    s_mov_b32 s59, s58
    s_mov_b32 s43, 0
    s_mov_b32 s62, 1
    s_mov_b32 s28, s8
    s_mov_b32 s29, s9
    s_mov_b32 s30, 0
    s_mov_b32 s31, 0x00020000
    v_mov_b32 v184, 74752
    v_mov_b32 v5, -1
    ds_write_b32 v184, v5
    s_waitcnt lgkmcnt(0)
    s_cmp_lg_u32 s14, 0
    s_cbranch_scc1 LpKV_inia_d
    v_mov_b32 v5, 40
    s_mov_b32 s16, 0
LpKV_inia:
    global_load_dword v6, v5, s[12:13] sc1
    s_add_u32 s16, s16, 1
    s_cmp_gt_u32 s16, 100000
    s_cbranch_scc1 L_role_p_abort
    s_waitcnt vmcnt(0)
    v_cmp_gt_u32 vcc, 128, v6
    s_nop 0
    s_cbranch_vccz LpKV_inia_d
    s_sleep 8
    s_branch LpKV_inia
LpKV_inia_d:
    s_barrier
    s_cmp_eq_u32 s63, 0
    s_cbranch_scc1 LpKV_ini_sk
    s_cmp_lg_u32 s14, 0
    s_cbranch_scc1 LpKV_inib_d
    v_mov_b32 v5, 160
    s_mov_b32 s16, 0
LpKV_inib:
    global_load_dword v6, v5, s[12:13] sc1
    s_add_u32 s16, s16, 1
    s_cmp_gt_u32 s16, 100000
    s_cbranch_scc1 L_role_p_abort
    s_waitcnt vmcnt(0)
    v_cmp_gt_u32 vcc, 64, v6
    s_nop 0
    s_cbranch_vccz LpKV_inib_d
    s_sleep 8
    s_branch LpKV_inib
LpKV_inib_d:
    s_barrier
LpKV_ini_sk:
    s_mul_i32 s41, s37, 36864
    s_add_u32 s41, s41, s64
    s_mul_i32 s60, s37, 22528
    s_add_u32 s60, s60, s61
    s_cmp_lt_u32 s37, 64
    s_cselect_b32 s60, s60, 2883584
    s_branch LpKV_wait
LpKV_head:
    s_waitcnt vmcnt(4)
LpKV_head2:
    s_barrier
    ds_read_b32 v15, v184
    s_xor_b32 s40, s40, 36864
    s_xor_b32 s59, s59, 36864
    s_mov_b32 s35, s37
    s_lshl_b32 s57, s34, 6
    s_add_u32 s57, s57, s35
    s_add_u32 s37, s37, 1
    s_mov_b32 s39, 0
    s_mov_b32 s54, 0
    s_xor_b32 s66, s66, 8192
    s_xor_b32 s71, s71, 8192
    s_mul_i32 s41, s37, 36864
    s_add_u32 s41, s41, s64
    s_mul_i32 s60, s37, 22528
    s_add_u32 s60, s60, s61
    s_cmp_lt_u32 s37, 64
    s_cselect_b32 s60, s60, 2883584
    v_add_u32 v9, s40, v0
    v_add_u32 v5, s71, v10
    ds_read_b128 v[48:51], v9 offset:0
    ds_read_b128 v[52:55], v9 offset:1024
    ds_read_b128 v[56:59], v9 offset:2048
    ds_read_b128 v[64:67], v5 offset:0
    ds_read_b128 v[68:71], v5 offset:512
    ds_read_b128 v[72:75], v5 offset:1024
    ds_read_b128 v[76:79], v5 offset:1536
    ds_read_b128 v[80:83], v5 offset:2048
    s_waitcnt lgkmcnt(7)
    v_mfma_f32_32x32x16_bf16 v[16:31], a[0:3], v[48:51], 0
    ds_read_b128 v[60:63], v9 offset:3072
    v_mfma_f32_32x32x16_bf16 v[32:47], v[48:51], a[144:147], 0
    s_waitcnt lgkmcnt(4)
    v_add_f32 v64, v64, v68
    v_add_f32 v65, v65, v69
    v_add_f32 v66, v66, v70
    v_add_f32 v67, v67, v71
    v_mfma_f32_32x32x16_bf16 v[16:31], a[4:7], v[52:55], v[16:31]
    ds_read_b128 v[48:51], v9 offset:4096
    s_waitcnt lgkmcnt(4)
    v_add_f32 v64, v64, v72
    v_add_f32 v65, v65, v73
    v_add_f32 v66, v66, v74
    v_mfma_f32_32x32x16_bf16 v[32:47], v[52:55], a[148:151], v[32:47]
    v_add_f32 v67, v67, v75
    s_waitcnt lgkmcnt(3)
    v_add_f32 v64, v64, v76
    v_add_f32 v65, v65, v77
    v_add_f32 v66, v66, v78
    v_readfirstlane_b32 s17, v15
    s_nop 0
    s_add_u32 s18, s17, 1
    s_max_i32 s32, s18, s37
    s_add_u32 s39, s37, 1
    s_min_u32 s39, s39, 63
    s_mul_i32 s33, s32, 22528
    s_add_u32 s33, s33, s61
    s_cmp_eq_u32 s14, 0
    s_cselect_b32 s18, s32, 0x7fff
    v_mov_b32 v2, 2
    s_cmp_le_u32 s18, s39
    s_cselect_b64 exec, -1, 0
    buffer_load_dword v2, v1, s[8:11], s33 offen sc1
    s_mov_b64 exec, -1
    s_cmp_ge_i32 s17, s37
    s_cbranch_scc1 LpKV_f_3
    v_mfma_f32_32x32x16_bf16 v[16:31], a[8:11], v[56:59], v[16:31]
    ds_read_b128 v[52:55], v9 offset:5120
    v_add_f32 v67, v67, v79
    s_waitcnt lgkmcnt(3)
    v_add_f32 v64, v64, v80
    v_add_f32 v65, v65, v81
    v_mfma_f32_32x32x16_bf16 v[32:47], v[56:59], a[152:155], v[32:47]
    v_add_f32 v66, v66, v82
    v_add_f32 v67, v67, v83
    v_add_f32 v64, v64, v66
    v_add_f32 v65, v65, v67
    s_waitcnt lgkmcnt(2)
    v_mfma_f32_32x32x16_bf16 v[16:31], a[12:15], v[60:63], v[16:31]
    ds_read_b128 v[56:59], v9 offset:6144
    v_mov_b32 v66, v64
    v_mov_b32 v67, v65
    s_nop 0
    v_permlane32_swap_b32 v64, v66
    v_mfma_f32_32x32x16_bf16 v[32:47], v[60:63], a[156:159], v[32:47]
    v_permlane32_swap_b32 v65, v67
    v_add_f32 v64, v64, v66
    v_add_f32 v65, v65, v67
    v_mul_f32 v64, 0x3ae38e39, v64
    s_waitcnt lgkmcnt(2)
    v_mfma_f32_32x32x16_bf16 v[16:31], a[16:19], v[48:51], v[16:31]
    ds_read_b128 v[60:63], v9 offset:7168
    v_mul_f32 v65, 0x3ae38e39, v65
    v_fma_f32 v65, -v64, v64, v65
    v_max_f32 v65, 0, v65
    v_mfma_f32_32x32x16_bf16 v[32:47], v[48:51], a[160:163], v[32:47]
    v_add_f32 v65, 0x3727c5ac, v65
    v_rsq_f32 v148, v65
    s_nop 0
    v_mul_f32 v149, v64, v148
    v_mul_f32 v100, v149, v84
    s_waitcnt lgkmcnt(2)
    v_mfma_f32_32x32x16_bf16 v[16:31], a[20:23], v[52:55], v[16:31]
    ds_read_b128 v[48:51], v9 offset:8192
    v_mul_f32 v101, v149, v85
    v_mul_f32 v102, v149, v86
    v_mul_f32 v103, v149, v87
    v_mfma_f32_32x32x16_bf16 v[32:47], v[52:55], a[164:167], v[32:47]
    v_mul_f32 v104, v149, v88
    v_mul_f32 v105, v149, v89
    v_mul_f32 v106, v149, v90
    v_mul_f32 v107, v149, v91
    s_waitcnt lgkmcnt(2)
    v_mfma_f32_32x32x16_bf16 v[16:31], a[24:27], v[56:59], v[16:31]
    ds_read_b128 v[52:55], v9 offset:9216
    v_mul_f32 v108, v149, v92
    v_mul_f32 v109, v149, v93
    v_mul_f32 v110, v149, v94
    v_mfma_f32_32x32x16_bf16 v[32:47], v[56:59], a[168:171], v[32:47]
    v_mul_f32 v111, v149, v95
    v_mul_f32 v112, v149, v96
    v_mul_f32 v113, v149, v97
    v_mul_f32 v114, v149, v98
    s_waitcnt lgkmcnt(2)
    v_mfma_f32_32x32x16_bf16 v[16:31], a[28:31], v[60:63], v[16:31]
    ds_read_b128 v[56:59], v9 offset:10240
    v_mul_f32 v115, v149, v99
    ds_write2_b32 v12, v148, v149 offset0:0 offset1:32
    ds_read_b128 v[116:119], v13 offset:0
    v_mfma_f32_32x32x16_bf16 v[32:47], v[60:63], a[172:175], v[32:47]
    ds_read_b128 v[120:123], v13 offset:32
    ds_read_b128 v[124:127], v13 offset:64
    ds_read_b128 v[128:131], v13 offset:96
    ds_read_b128 v[132:135], v13 offset:128
    s_waitcnt lgkmcnt(8)
    v_mfma_f32_32x32x16_bf16 v[16:31], a[32:35], v[48:51], v[16:31]
    ds_read_b128 v[60:63], v9 offset:11264
    ds_read_b128 v[136:139], v13 offset:160
    ds_read_b128 v[140:143], v13 offset:192
    ds_read_b128 v[144:147], v13 offset:224
    v_mfma_f32_32x32x16_bf16 v[32:47], v[48:51], a[176:179], v[32:47]
    s_waitcnt lgkmcnt(11)
    v_mfma_f32_32x32x16_bf16 v[16:31], a[36:39], v[52:55], v[16:31]
    ds_read_b128 v[48:51], v9 offset:12288
    v_mfma_f32_32x32x16_bf16 v[32:47], v[52:55], a[180:183], v[32:47]
    s_waitcnt lgkmcnt(5)
    v_mul_f32 v132, v11, v132
    v_mul_f32 v133, v11, v133
    v_mfma_f32_32x32x16_bf16 v[16:31], a[40:43], v[56:59], v[16:31]
    ds_read_b128 v[52:55], v9 offset:13312
    v_mul_f32 v134, v11, v134
    v_mul_f32 v135, v11, v135
    s_waitcnt lgkmcnt(4)
    v_mul_f32 v136, v11, v136
    v_mfma_f32_32x32x16_bf16 v[32:47], v[56:59], a[184:187], v[32:47]
    v_mul_f32 v137, v11, v137
    v_mul_f32 v138, v11, v138
    v_mul_f32 v139, v11, v139
    s_waitcnt lgkmcnt(3)
    v_mul_f32 v140, v11, v140
    v_mfma_f32_32x32x16_bf16 v[16:31], a[44:47], v[60:63], v[16:31]
    ds_read_b128 v[56:59], v9 offset:14336
    v_mul_f32 v141, v11, v141
    v_mul_f32 v142, v11, v142
    v_mul_f32 v143, v11, v143
    v_mfma_f32_32x32x16_bf16 v[32:47], v[60:63], a[188:191], v[32:47]
    s_waitcnt lgkmcnt(3)
    v_mul_f32 v144, v11, v144
    v_mul_f32 v145, v11, v145
    v_mul_f32 v146, v11, v146
    v_mul_f32 v147, v11, v147
    s_waitcnt lgkmcnt(2)
    v_mfma_f32_32x32x16_bf16 v[16:31], a[48:51], v[48:51], v[16:31]
    ds_read_b128 v[60:63], v9 offset:15360
    s_mul_i32 s46, s34, 50331648
    s_lshl_b32 s51, s35, 18
    s_add_u32 s46, s46, s51
    v_mfma_f32_32x32x16_bf16 v[32:47], v[48:51], a[192:195], v[32:47]
    s_add_u32 s46, s46, s52
    s_waitcnt vmcnt(1)
    s_cmp_lg_u32 s43, 0
    s_cselect_b64 exec, 3, 0
    buffer_store_dword v3, v185, s[8:11], s43 offen sc1
    s_mov_b64 exec, -1
    s_mov_b32 s43, 0
    s_waitcnt lgkmcnt(2)
    v_mfma_f32_32x32x16_bf16 v[16:31], a[52:55], v[52:55], v[16:31]
    ds_read_b128 v[48:51], v9 offset:16384
    v_mfma_f32_32x32x16_bf16 v[32:47], v[52:55], a[196:199], v[32:47]
    s_waitcnt lgkmcnt(2)
    v_mfma_f32_32x32x16_bf16 v[16:31], a[56:59], v[56:59], v[16:31]
    v_cmp_eq_u32 s[76:77], 1, v2
    v_cmp_eq_u32 vcc, 2, v2
    s_cmp_eq_u64 s[76:77], -1
    s_cselect_b32 s38, 1, 0
    ds_read_b128 v[52:55], v9 offset:17408
    v_mfma_f32_32x32x16_bf16 v[32:47], v[56:59], a[200:203], v[32:47]
    s_cmp_lg_u32 s38, 0
    s_cselect_b64 exec, 1, 0
    v_mov_b32 v15, s32
    ds_write_b32 v184, v15
    v_mov_b32 v2, 2
    s_mov_b64 exec, -1
    s_waitcnt lgkmcnt(3)
    v_mfma_f32_32x32x16_bf16 v[16:31], a[60:63], v[60:63], v[16:31]
    s_add_u32 s32, s32, s38
    s_mul_i32 s38, s38, 22528
    s_add_u32 s33, s33, s38
    ds_read_b128 v[56:59], v9 offset:18432
    v_mfma_f32_32x32x16_bf16 v[32:47], v[60:63], a[204:207], v[32:47]
    s_cmp_eq_u64 vcc, 0
    s_cselect_b32 s38, s32, 0x7fff
    s_waitcnt lgkmcnt(3)
    v_mfma_f32_32x32x16_bf16 v[16:31], a[64:67], v[48:51], v[16:31]
    ds_read_b128 v[60:63], v9 offset:19456
    v_mfma_f32_32x32x16_bf16 v[32:47], v[48:51], a[208:211], v[32:47]
    s_cmp_le_u32 s38, s39
    s_cselect_b64 exec, -1, 0
    v_mov_b32 v2, 2
    buffer_load_dword v2, v1, s[8:11], s33 offen sc1
    s_mov_b64 exec, -1
    ds_read_b32 v15, v184
    s_waitcnt lgkmcnt(4)
    v_mfma_f32_32x32x16_bf16 v[16:31], a[68:71], v[52:55], v[16:31]
    ds_read_b128 v[48:51], v9 offset:20480
    v_mfma_f32_32x32x16_bf16 v[32:47], v[52:55], a[212:215], v[32:47]
    s_waitcnt lgkmcnt(3)
    v_mfma_f32_32x32x16_bf16 v[16:31], a[72:75], v[56:59], v[16:31]
    ds_read_b128 v[52:55], v9 offset:21504
    v_mfma_f32_32x32x16_bf16 v[32:47], v[56:59], a[216:219], v[32:47]
    s_waitcnt lgkmcnt(2)
    v_readfirstlane_b32 s17, v15
    s_nop 0
    s_cmp_ge_i32 s17, s37
    s_cbranch_scc1 LpKV_f_4
    v_mfma_f32_32x32x16_bf16 v[16:31], a[76:79], v[60:63], v[16:31]
    ds_read_b128 v[56:59], v9 offset:22528
    v_mfma_f32_32x32x16_bf16 v[32:47], v[60:63], a[220:223], v[32:47]
    s_waitcnt lgkmcnt(2)
    v_mfma_f32_32x32x16_bf16 v[16:31], a[80:83], v[48:51], v[16:31]
    ds_read_b128 v[60:63], v9 offset:23552
    v_mfma_f32_32x32x16_bf16 v[32:47], v[48:51], a[224:227], v[32:47]
    s_waitcnt lgkmcnt(2)
    v_mfma_f32_32x32x16_bf16 v[16:31], a[84:87], v[52:55], v[16:31]
    ds_read_b128 v[48:51], v9 offset:24576
    v_mfma_f32_32x32x16_bf16 v[32:47], v[52:55], a[228:231], v[32:47]
    s_waitcnt lgkmcnt(2)
    v_mfma_f32_32x32x16_bf16 v[16:31], a[88:91], v[56:59], v[16:31]
    ds_read_b128 v[52:55], v9 offset:25600
    v_mfma_f32_32x32x16_bf16 v[32:47], v[56:59], a[232:235], v[32:47]
    s_waitcnt lgkmcnt(2)
    v_mfma_f32_32x32x16_bf16 v[16:31], a[92:95], v[60:63], v[16:31]
    ds_read_b128 v[56:59], v9 offset:26624
    v_mfma_f32_32x32x16_bf16 v[32:47], v[60:63], a[236:239], v[32:47]
    s_waitcnt lgkmcnt(2)
    v_mfma_f32_32x32x16_bf16 v[16:31], a[96:99], v[48:51], v[16:31]
    ds_read_b128 v[60:63], v9 offset:27648
    v_mfma_f32_32x32x16_bf16 v[32:47], v[48:51], a[240:243], v[32:47]
    s_waitcnt lgkmcnt(2)
    v_mfma_f32_32x32x16_bf16 v[16:31], a[100:103], v[52:55], v[16:31]
    ds_read_b128 v[48:51], v9 offset:28672
    v_mfma_f32_32x32x16_bf16 v[32:47], v[52:55], a[244:247], v[32:47]
    s_waitcnt lgkmcnt(2)
    v_mfma_f32_32x32x16_bf16 v[16:31], a[104:107], v[56:59], v[16:31]
    ds_read_b128 v[52:55], v9 offset:29696
    v_mfma_f32_32x32x16_bf16 v[32:47], v[56:59], a[248:251], v[32:47]
    s_waitcnt lgkmcnt(2)
    v_mfma_f32_32x32x16_bf16 v[16:31], a[108:111], v[60:63], v[16:31]
    ds_read_b128 v[56:59], v9 offset:30720
    v_mfma_f32_32x32x16_bf16 v[32:47], v[60:63], a[252:255], v[32:47]
    s_waitcnt lgkmcnt(2)
    v_mfma_f32_32x32x16_bf16 v[16:31], a[112:115], v[48:51], v[16:31]
    ds_read_b128 v[60:63], v9 offset:31744
    v_mfma_f32_32x32x16_bf16 v[32:47], v[48:51], v[152:155], v[32:47]
    s_waitcnt lgkmcnt(2)
    v_mfma_f32_32x32x16_bf16 v[16:31], a[116:119], v[52:55], v[16:31]
    ds_read_b128 v[48:51], v9 offset:32768
    v_mfma_f32_32x32x16_bf16 v[32:47], v[52:55], v[156:159], v[32:47]
    s_waitcnt lgkmcnt(2)
    v_mfma_f32_32x32x16_bf16 v[16:31], a[120:123], v[56:59], v[16:31]
    ds_read_b128 v[52:55], v9 offset:33792
    v_mfma_f32_32x32x16_bf16 v[32:47], v[56:59], v[160:163], v[32:47]
    s_waitcnt lgkmcnt(2)
    v_mfma_f32_32x32x16_bf16 v[16:31], a[124:127], v[60:63], v[16:31]
    v_cmp_eq_u32 s[76:77], 1, v2
    v_cmp_eq_u32 vcc, 2, v2
    s_cmp_eq_u64 s[76:77], -1
    s_cselect_b32 s38, 1, 0
    ds_read_b128 v[56:59], v9 offset:34816
    v_mfma_f32_32x32x16_bf16 v[32:47], v[60:63], v[164:167], v[32:47]
    s_cmp_lg_u32 s38, 0
    s_cselect_b64 exec, 1, 0
    v_mov_b32 v15, s32
    ds_write_b32 v184, v15
    v_mov_b32 v2, 2
    s_mov_b64 exec, -1
    s_waitcnt lgkmcnt(3)
    v_mfma_f32_32x32x16_bf16 v[16:31], a[128:131], v[48:51], v[16:31]
    s_add_u32 s32, s32, s38
    s_mul_i32 s38, s38, 22528
    s_add_u32 s33, s33, s38
    ds_read_b128 v[60:63], v9 offset:35840
    v_mfma_f32_32x32x16_bf16 v[32:47], v[48:51], v[168:171], v[32:47]
    s_cmp_eq_u64 vcc, 0
    s_cselect_b32 s38, s32, 0x7fff
    s_waitcnt lgkmcnt(3)
    v_mfma_f32_32x32x16_bf16 v[16:31], a[132:135], v[52:55], v[16:31]
    s_cmp_le_u32 s38, s39
    s_cselect_b64 exec, -1, 0
    v_mov_b32 v2, 2
    buffer_load_dword v2, v1, s[8:11], s33 offen sc1
    s_mov_b64 exec, -1
    v_mfma_f32_32x32x16_bf16 v[32:47], v[52:55], v[172:175], v[32:47]
    s_waitcnt lgkmcnt(2)
    v_mfma_f32_32x32x16_bf16 v[16:31], a[136:139], v[56:59], v[16:31]
    v_mfma_f32_32x32x16_bf16 v[32:47], v[56:59], v[176:179], v[32:47]
    s_waitcnt lgkmcnt(0)
    v_mfma_f32_32x32x16_bf16 v[16:31], a[140:143], v[60:63], v[16:31]
    v_mfma_f32_32x32x16_bf16 v[32:47], v[60:63], v[180:183], v[32:47]
    s_add_u32 s51, s46, 16777216
    s_nop 2
    v_pk_fma_f32 v[16:17], v[16:17], v[148:149], v[100:101] op_sel_hi:[1,0,1] neg_lo:[0,0,1] neg_hi:[0,0,1]
    v_pk_fma_f32 v[18:19], v[18:19], v[148:149], v[102:103] op_sel_hi:[1,0,1] neg_lo:[0,0,1] neg_hi:[0,0,1]
    v_pk_fma_f32 v[20:21], v[20:21], v[148:149], v[104:105] op_sel_hi:[1,0,1] neg_lo:[0,0,1] neg_hi:[0,0,1]
    v_pk_fma_f32 v[22:23], v[22:23], v[148:149], v[106:107] op_sel_hi:[1,0,1] neg_lo:[0,0,1] neg_hi:[0,0,1]
    v_pk_fma_f32 v[24:25], v[24:25], v[148:149], v[108:109] op_sel_hi:[1,0,1] neg_lo:[0,0,1] neg_hi:[0,0,1]
    v_pk_fma_f32 v[26:27], v[26:27], v[148:149], v[110:111] op_sel_hi:[1,0,1] neg_lo:[0,0,1] neg_hi:[0,0,1]
    v_pk_fma_f32 v[28:29], v[28:29], v[148:149], v[112:113] op_sel_hi:[1,0,1] neg_lo:[0,0,1] neg_hi:[0,0,1]
    v_pk_fma_f32 v[30:31], v[30:31], v[148:149], v[114:115] op_sel_hi:[1,0,1] neg_lo:[0,0,1] neg_hi:[0,0,1]
    v_cvt_pk_bf16_f32 v188, v16, v24
    v_cvt_pk_bf16_f32 v189, v17, v25
    v_cvt_pk_bf16_f32 v190, v18, v26
    v_cvt_pk_bf16_f32 v191, v19, v27
    buffer_store_dwordx4 v[188:191], v14, s[8:11], s46 offen offset:0 sc1
    v_cvt_pk_bf16_f32 v192, v20, v28
    v_cvt_pk_bf16_f32 v193, v21, v29
    v_cvt_pk_bf16_f32 v194, v22, v30
    v_cvt_pk_bf16_f32 v195, v23, v31
    buffer_store_dwordx4 v[192:195], v14, s[8:11], s46 offen offset:512 sc1
    v_pk_fma_f32 v[32:33], v[32:33], v[116:117], v[132:133] neg_lo:[0,0,1] neg_hi:[0,0,1]
    v_pk_fma_f32 v[34:35], v[34:35], v[118:119], v[134:135] neg_lo:[0,0,1] neg_hi:[0,0,1]
    v_pk_fma_f32 v[36:37], v[36:37], v[120:121], v[136:137] neg_lo:[0,0,1] neg_hi:[0,0,1]
    v_pk_fma_f32 v[38:39], v[38:39], v[122:123], v[138:139] neg_lo:[0,0,1] neg_hi:[0,0,1]
    v_pk_fma_f32 v[40:41], v[40:41], v[124:125], v[140:141] neg_lo:[0,0,1] neg_hi:[0,0,1]
    v_pk_fma_f32 v[42:43], v[42:43], v[126:127], v[142:143] neg_lo:[0,0,1] neg_hi:[0,0,1]
    v_pk_fma_f32 v[44:45], v[44:45], v[128:129], v[144:145] neg_lo:[0,0,1] neg_hi:[0,0,1]
    v_pk_fma_f32 v[46:47], v[46:47], v[130:131], v[146:147] neg_lo:[0,0,1] neg_hi:[0,0,1]
    v_cvt_pk_bf16_f32 v196, v32, v33
    v_cvt_pk_bf16_f32 v197, v34, v35
    v_cvt_pk_bf16_f32 v198, v40, v41
    v_cvt_pk_bf16_f32 v199, v42, v43
    buffer_store_dwordx4 v[196:199], v14, s[8:11], s51 offen offset:0 sc1
    v_cvt_pk_bf16_f32 v200, v36, v37
    v_cvt_pk_bf16_f32 v201, v38, v39
    v_cvt_pk_bf16_f32 v202, v44, v45
    v_cvt_pk_bf16_f32 v203, v46, v47
    buffer_store_dwordx4 v[200:203], v14, s[8:11], s51 offen offset:512 sc1
    s_mul_i32 s43, s57, 22528
    s_add_u32 s43, s43, s49
    s_branch LpKV_none
LpKV_f_3:
    v_mfma_f32_32x32x16_bf16 v[16:31], a[8:11], v[56:59], v[16:31]
    ds_read_b128 v[52:55], v9 offset:5120
    v_add_f32 v67, v67, v79
    s_waitcnt lgkmcnt(3)
    v_add_f32 v64, v64, v80
    v_add_f32 v65, v65, v81
    v_mfma_f32_32x32x16_bf16 v[32:47], v[56:59], a[152:155], v[32:47]
    v_add_f32 v66, v66, v82
    v_add_f32 v67, v67, v83
    v_add_f32 v64, v64, v66
    v_add_f32 v65, v65, v67
    s_waitcnt lgkmcnt(2)
    v_mfma_f32_32x32x16_bf16 v[16:31], a[12:15], v[60:63], v[16:31]
    ds_read_b128 v[56:59], v9 offset:6144
    v_mov_b32 v66, v64
    v_mov_b32 v67, v65
    s_nop 0
    v_permlane32_swap_b32 v64, v66
    v_mfma_f32_32x32x16_bf16 v[32:47], v[60:63], a[156:159], v[32:47]
    v_permlane32_swap_b32 v65, v67
    v_add_f32 v64, v64, v66
    v_add_f32 v65, v65, v67
    v_mul_f32 v64, 0x3ae38e39, v64
    s_waitcnt lgkmcnt(2)
    v_mfma_f32_32x32x16_bf16 v[16:31], a[16:19], v[48:51], v[16:31]
    ds_read_b128 v[60:63], v9 offset:7168
    v_mul_f32 v65, 0x3ae38e39, v65
    v_fma_f32 v65, -v64, v64, v65
    v_max_f32 v65, 0, v65
    v_mfma_f32_32x32x16_bf16 v[32:47], v[48:51], a[160:163], v[32:47]
    v_add_f32 v65, 0x3727c5ac, v65
    v_rsq_f32 v148, v65
    s_nop 0
    v_mul_f32 v149, v64, v148
    v_mul_f32 v100, v149, v84
    s_waitcnt lgkmcnt(2)
    v_mfma_f32_32x32x16_bf16 v[16:31], a[20:23], v[52:55], v[16:31]
    ds_read_b128 v[48:51], v9 offset:8192
    v_mul_f32 v101, v149, v85
    v_mul_f32 v102, v149, v86
    v_mul_f32 v103, v149, v87
    v_mfma_f32_32x32x16_bf16 v[32:47], v[52:55], a[164:167], v[32:47]
    v_mul_f32 v104, v149, v88
    v_mul_f32 v105, v149, v89
    v_mul_f32 v106, v149, v90
    v_mul_f32 v107, v149, v91
    s_waitcnt lgkmcnt(2)
    v_mfma_f32_32x32x16_bf16 v[16:31], a[24:27], v[56:59], v[16:31]
    ds_read_b128 v[52:55], v9 offset:9216
    v_mul_f32 v108, v149, v92
    v_mul_f32 v109, v149, v93
    v_mul_f32 v110, v149, v94
    v_mfma_f32_32x32x16_bf16 v[32:47], v[56:59], a[168:171], v[32:47]
    v_mul_f32 v111, v149, v95
    v_mul_f32 v112, v149, v96
    v_mul_f32 v113, v149, v97
    v_mul_f32 v114, v149, v98
    s_waitcnt lgkmcnt(2)
    v_mfma_f32_32x32x16_bf16 v[16:31], a[28:31], v[60:63], v[16:31]
    ds_read_b128 v[56:59], v9 offset:10240
    v_mul_f32 v115, v149, v99
    ds_write2_b32 v12, v148, v149 offset0:0 offset1:32
    ds_read_b128 v[116:119], v13 offset:0
    v_mfma_f32_32x32x16_bf16 v[32:47], v[60:63], a[172:175], v[32:47]
    ds_read_b128 v[120:123], v13 offset:32
    ds_read_b128 v[124:127], v13 offset:64
    ds_read_b128 v[128:131], v13 offset:96
    ds_read_b128 v[132:135], v13 offset:128
    s_waitcnt lgkmcnt(8)
    v_mfma_f32_32x32x16_bf16 v[16:31], a[32:35], v[48:51], v[16:31]
    ds_read_b128 v[60:63], v9 offset:11264
    ds_read_b128 v[136:139], v13 offset:160
    ds_read_b128 v[140:143], v13 offset:192
    ds_read_b128 v[144:147], v13 offset:224
    v_mfma_f32_32x32x16_bf16 v[32:47], v[48:51], a[176:179], v[32:47]
    s_add_u32 m0, s59, 0
    s_add_u32 s47, s41, 0
    buffer_load_dwordx4 v0, s[8:11], s47 offen offset:0 lds
    buffer_load_dwordx4 v0, s[8:11], s47 offen offset:1024 lds
    buffer_load_dwordx4 v0, s[8:11], s47 offen offset:2048 lds
    s_waitcnt lgkmcnt(11)
    v_mfma_f32_32x32x16_bf16 v[16:31], a[36:39], v[52:55], v[16:31]
    buffer_load_dwordx4 v0, s[8:11], s47 offen offset:3072 lds
    s_add_u32 m0, s59, 4096
    s_add_u32 s47, s41, 4096
    buffer_load_dwordx4 v0, s[8:11], s47 offen offset:0 lds
    ds_read_b128 v[48:51], v9 offset:12288
    v_mfma_f32_32x32x16_bf16 v[32:47], v[52:55], a[180:183], v[32:47]
    buffer_load_dwordx4 v0, s[8:11], s47 offen offset:1024 lds
    buffer_load_dwordx4 v0, s[8:11], s47 offen offset:2048 lds
    buffer_load_dwordx4 v0, s[8:11], s47 offen offset:3072 lds
    s_waitcnt lgkmcnt(5)
    v_mul_f32 v132, v11, v132
    v_mul_f32 v133, v11, v133
    v_mfma_f32_32x32x16_bf16 v[16:31], a[40:43], v[56:59], v[16:31]
    ds_read_b128 v[52:55], v9 offset:13312
    v_mul_f32 v134, v11, v134
    v_mul_f32 v135, v11, v135
    s_waitcnt lgkmcnt(4)
    v_mul_f32 v136, v11, v136
    v_mfma_f32_32x32x16_bf16 v[32:47], v[56:59], a[184:187], v[32:47]
    v_mul_f32 v137, v11, v137
    v_mul_f32 v138, v11, v138
    v_mul_f32 v139, v11, v139
    s_waitcnt lgkmcnt(3)
    v_mul_f32 v140, v11, v140
    v_mfma_f32_32x32x16_bf16 v[16:31], a[44:47], v[60:63], v[16:31]
    ds_read_b128 v[56:59], v9 offset:14336
    v_mul_f32 v141, v11, v141
    v_mul_f32 v142, v11, v142
    v_mul_f32 v143, v11, v143
    v_mfma_f32_32x32x16_bf16 v[32:47], v[60:63], a[188:191], v[32:47]
    s_waitcnt lgkmcnt(3)
    v_mul_f32 v144, v11, v144
    v_mul_f32 v145, v11, v145
    v_mul_f32 v146, v11, v146
    v_mul_f32 v147, v11, v147
    s_waitcnt lgkmcnt(2)
    v_mfma_f32_32x32x16_bf16 v[16:31], a[48:51], v[48:51], v[16:31]
    ds_read_b128 v[60:63], v9 offset:15360
    s_mul_i32 s46, s34, 50331648
    s_lshl_b32 s51, s35, 18
    s_add_u32 s46, s46, s51
    v_mfma_f32_32x32x16_bf16 v[32:47], v[48:51], a[192:195], v[32:47]
    s_add_u32 m0, s59, 8192
    s_add_u32 s47, s41, 8192
    buffer_load_dwordx4 v0, s[8:11], s47 offen offset:0 lds
    s_add_u32 s46, s46, s52
    s_waitcnt vmcnt(10)
    s_cmp_lg_u32 s43, 0
    s_cselect_b64 exec, 3, 0
    buffer_store_dword v3, v185, s[8:11], s43 offen sc1
    s_mov_b64 exec, -1
    s_mov_b32 s43, 0
    s_waitcnt lgkmcnt(2)
    v_mfma_f32_32x32x16_bf16 v[16:31], a[52:55], v[52:55], v[16:31]
    s_mul_i32 s48, s36, 786432
    s_mul_i32 s18, s37, 6144
    s_add_u32 s48, s48, s18
    s_add_u32 s48, s48, 16125952
    s_add_u32 m0, s66, 4096
    s_nop 0
    buffer_load_dwordx4 v0, s[8:11], s48 offen lds
    ds_read_b128 v[48:51], v9 offset:16384
    v_mfma_f32_32x32x16_bf16 v[32:47], v[52:55], a[196:199], v[32:47]
    s_add_u32 m0, s66, s67
    s_sub_u32 s48, s48, 4096
    s_add_u32 s48, s48, s67
    buffer_load_dwordx4 v0, s[8:11], s48 offen lds
    s_waitcnt lgkmcnt(2)
    v_mfma_f32_32x32x16_bf16 v[16:31], a[56:59], v[56:59], v[16:31]
    v_cmp_eq_u32 s[76:77], 1, v2
    v_cmp_eq_u32 vcc, 2, v2
    s_cmp_eq_u64 s[76:77], -1
    s_cselect_b32 s38, 1, 0
    ds_read_b128 v[52:55], v9 offset:17408
    v_mfma_f32_32x32x16_bf16 v[32:47], v[56:59], a[200:203], v[32:47]
    s_cmp_lg_u32 s38, 0
    s_cselect_b64 exec, 1, 0
    v_mov_b32 v15, s32
    ds_write_b32 v184, v15
    v_mov_b32 v2, 2
    s_mov_b64 exec, -1
    s_waitcnt lgkmcnt(3)
    v_mfma_f32_32x32x16_bf16 v[16:31], a[60:63], v[60:63], v[16:31]
    s_add_u32 s32, s32, s38
    s_mul_i32 s38, s38, 22528
    s_add_u32 s33, s33, s38
    ds_read_b128 v[56:59], v9 offset:18432
    v_mfma_f32_32x32x16_bf16 v[32:47], v[60:63], a[204:207], v[32:47]
    s_cmp_eq_u64 vcc, 0
    s_cselect_b32 s38, s32, 0x7fff
    s_waitcnt lgkmcnt(3)
    v_mfma_f32_32x32x16_bf16 v[16:31], a[64:67], v[48:51], v[16:31]
    ds_read_b128 v[60:63], v9 offset:19456
    v_mfma_f32_32x32x16_bf16 v[32:47], v[48:51], a[208:211], v[32:47]
    s_cmp_le_u32 s38, s39
    s_cselect_b64 exec, -1, 0
    v_mov_b32 v2, 2
    buffer_load_dword v2, v1, s[8:11], s33 offen sc1
    s_mov_b64 exec, -1
    s_waitcnt lgkmcnt(3)
    v_mfma_f32_32x32x16_bf16 v[16:31], a[68:71], v[52:55], v[16:31]
    ds_read_b128 v[48:51], v9 offset:20480
    v_mfma_f32_32x32x16_bf16 v[32:47], v[52:55], a[212:215], v[32:47]
    s_waitcnt lgkmcnt(2)
    v_mfma_f32_32x32x16_bf16 v[16:31], a[72:75], v[56:59], v[16:31]
    ds_read_b128 v[52:55], v9 offset:21504
    v_mfma_f32_32x32x16_bf16 v[32:47], v[56:59], a[216:219], v[32:47]
    s_waitcnt lgkmcnt(2)
    v_mfma_f32_32x32x16_bf16 v[16:31], a[76:79], v[60:63], v[16:31]
    ds_read_b128 v[56:59], v9 offset:22528
    v_mfma_f32_32x32x16_bf16 v[32:47], v[60:63], a[220:223], v[32:47]
    s_waitcnt lgkmcnt(2)
    v_mfma_f32_32x32x16_bf16 v[16:31], a[80:83], v[48:51], v[16:31]
    ds_read_b128 v[60:63], v9 offset:23552
    v_mfma_f32_32x32x16_bf16 v[32:47], v[48:51], a[224:227], v[32:47]
    s_waitcnt lgkmcnt(2)
    v_mfma_f32_32x32x16_bf16 v[16:31], a[84:87], v[52:55], v[16:31]
    ds_read_b128 v[48:51], v9 offset:24576
    v_mfma_f32_32x32x16_bf16 v[32:47], v[52:55], a[228:231], v[32:47]
    s_waitcnt lgkmcnt(2)
    v_mfma_f32_32x32x16_bf16 v[16:31], a[88:91], v[56:59], v[16:31]
    ds_read_b128 v[52:55], v9 offset:25600
    v_mfma_f32_32x32x16_bf16 v[32:47], v[56:59], a[232:235], v[32:47]
    s_waitcnt lgkmcnt(2)
    v_mfma_f32_32x32x16_bf16 v[16:31], a[92:95], v[60:63], v[16:31]
    ds_read_b128 v[56:59], v9 offset:26624
    v_mfma_f32_32x32x16_bf16 v[32:47], v[60:63], a[236:239], v[32:47]
    s_waitcnt lgkmcnt(2)
    v_mfma_f32_32x32x16_bf16 v[16:31], a[96:99], v[48:51], v[16:31]
    ds_read_b128 v[60:63], v9 offset:27648
    v_mfma_f32_32x32x16_bf16 v[32:47], v[48:51], a[240:243], v[32:47]
    s_waitcnt lgkmcnt(2)
    v_mfma_f32_32x32x16_bf16 v[16:31], a[100:103], v[52:55], v[16:31]
    ds_read_b128 v[48:51], v9 offset:28672
    v_mfma_f32_32x32x16_bf16 v[32:47], v[52:55], a[244:247], v[32:47]
    s_waitcnt lgkmcnt(2)
    v_mfma_f32_32x32x16_bf16 v[16:31], a[104:107], v[56:59], v[16:31]
    ds_read_b128 v[52:55], v9 offset:29696
    v_mfma_f32_32x32x16_bf16 v[32:47], v[56:59], a[248:251], v[32:47]
    s_waitcnt lgkmcnt(2)
    v_mfma_f32_32x32x16_bf16 v[16:31], a[108:111], v[60:63], v[16:31]
    ds_read_b128 v[56:59], v9 offset:30720
    v_mfma_f32_32x32x16_bf16 v[32:47], v[60:63], a[252:255], v[32:47]
    s_waitcnt lgkmcnt(2)
    v_mfma_f32_32x32x16_bf16 v[16:31], a[112:115], v[48:51], v[16:31]
    ds_read_b128 v[60:63], v9 offset:31744
    v_mfma_f32_32x32x16_bf16 v[32:47], v[48:51], v[152:155], v[32:47]
    s_waitcnt lgkmcnt(2)
    v_mfma_f32_32x32x16_bf16 v[16:31], a[116:119], v[52:55], v[16:31]
    ds_read_b128 v[48:51], v9 offset:32768
    v_mfma_f32_32x32x16_bf16 v[32:47], v[52:55], v[156:159], v[32:47]
    s_waitcnt lgkmcnt(2)
    v_mfma_f32_32x32x16_bf16 v[16:31], a[120:123], v[56:59], v[16:31]
    ds_read_b128 v[52:55], v9 offset:33792
    v_mfma_f32_32x32x16_bf16 v[32:47], v[56:59], v[160:163], v[32:47]
    s_waitcnt lgkmcnt(2)
    v_mfma_f32_32x32x16_bf16 v[16:31], a[124:127], v[60:63], v[16:31]
    v_cmp_eq_u32 s[76:77], 1, v2
    v_cmp_eq_u32 vcc, 2, v2
    s_cmp_eq_u64 s[76:77], -1
    s_cselect_b32 s38, 1, 0
    ds_read_b128 v[56:59], v9 offset:34816
    v_mfma_f32_32x32x16_bf16 v[32:47], v[60:63], v[164:167], v[32:47]
    s_cmp_lg_u32 s38, 0
    s_cselect_b64 exec, 1, 0
    v_mov_b32 v15, s32
    ds_write_b32 v184, v15
    v_mov_b32 v2, 2
    s_mov_b64 exec, -1
    s_waitcnt lgkmcnt(3)
    v_mfma_f32_32x32x16_bf16 v[16:31], a[128:131], v[48:51], v[16:31]
    s_add_u32 s32, s32, s38
    s_mul_i32 s38, s38, 22528
    s_add_u32 s33, s33, s38
    ds_read_b128 v[60:63], v9 offset:35840
    v_mfma_f32_32x32x16_bf16 v[32:47], v[48:51], v[168:171], v[32:47]
    s_cmp_eq_u64 vcc, 0
    s_cselect_b32 s38, s32, 0x7fff
    s_waitcnt lgkmcnt(3)
    v_mfma_f32_32x32x16_bf16 v[16:31], a[132:135], v[52:55], v[16:31]
    s_cmp_le_u32 s38, s39
    s_cselect_b64 exec, -1, 0
    v_mov_b32 v2, 2
    buffer_load_dword v2, v1, s[8:11], s33 offen sc1
    s_mov_b64 exec, -1
    v_mfma_f32_32x32x16_bf16 v[32:47], v[52:55], v[172:175], v[32:47]
    s_waitcnt lgkmcnt(2)
    v_mfma_f32_32x32x16_bf16 v[16:31], a[136:139], v[56:59], v[16:31]
    v_mfma_f32_32x32x16_bf16 v[32:47], v[56:59], v[176:179], v[32:47]
    s_waitcnt lgkmcnt(0)
    v_mfma_f32_32x32x16_bf16 v[16:31], a[140:143], v[60:63], v[16:31]
    v_mfma_f32_32x32x16_bf16 v[32:47], v[60:63], v[180:183], v[32:47]
    s_add_u32 s51, s46, 16777216
    s_nop 2
    v_pk_fma_f32 v[16:17], v[16:17], v[148:149], v[100:101] op_sel_hi:[1,0,1] neg_lo:[0,0,1] neg_hi:[0,0,1]
    v_pk_fma_f32 v[18:19], v[18:19], v[148:149], v[102:103] op_sel_hi:[1,0,1] neg_lo:[0,0,1] neg_hi:[0,0,1]
    v_pk_fma_f32 v[20:21], v[20:21], v[148:149], v[104:105] op_sel_hi:[1,0,1] neg_lo:[0,0,1] neg_hi:[0,0,1]
    v_pk_fma_f32 v[22:23], v[22:23], v[148:149], v[106:107] op_sel_hi:[1,0,1] neg_lo:[0,0,1] neg_hi:[0,0,1]
    v_pk_fma_f32 v[24:25], v[24:25], v[148:149], v[108:109] op_sel_hi:[1,0,1] neg_lo:[0,0,1] neg_hi:[0,0,1]
    v_pk_fma_f32 v[26:27], v[26:27], v[148:149], v[110:111] op_sel_hi:[1,0,1] neg_lo:[0,0,1] neg_hi:[0,0,1]
    v_pk_fma_f32 v[28:29], v[28:29], v[148:149], v[112:113] op_sel_hi:[1,0,1] neg_lo:[0,0,1] neg_hi:[0,0,1]
    v_pk_fma_f32 v[30:31], v[30:31], v[148:149], v[114:115] op_sel_hi:[1,0,1] neg_lo:[0,0,1] neg_hi:[0,0,1]
    v_cvt_pk_bf16_f32 v188, v16, v24
    v_cvt_pk_bf16_f32 v189, v17, v25
    v_cvt_pk_bf16_f32 v190, v18, v26
    v_cvt_pk_bf16_f32 v191, v19, v27
    buffer_store_dwordx4 v[188:191], v14, s[8:11], s46 offen offset:0 sc1
    v_cvt_pk_bf16_f32 v192, v20, v28
    v_cvt_pk_bf16_f32 v193, v21, v29
    v_cvt_pk_bf16_f32 v194, v22, v30
    v_cvt_pk_bf16_f32 v195, v23, v31
    buffer_store_dwordx4 v[192:195], v14, s[8:11], s46 offen offset:512 sc1
    v_pk_fma_f32 v[32:33], v[32:33], v[116:117], v[132:133] neg_lo:[0,0,1] neg_hi:[0,0,1]
    v_pk_fma_f32 v[34:35], v[34:35], v[118:119], v[134:135] neg_lo:[0,0,1] neg_hi:[0,0,1]
    v_pk_fma_f32 v[36:37], v[36:37], v[120:121], v[136:137] neg_lo:[0,0,1] neg_hi:[0,0,1]
    v_pk_fma_f32 v[38:39], v[38:39], v[122:123], v[138:139] neg_lo:[0,0,1] neg_hi:[0,0,1]
    v_pk_fma_f32 v[40:41], v[40:41], v[124:125], v[140:141] neg_lo:[0,0,1] neg_hi:[0,0,1]
    v_pk_fma_f32 v[42:43], v[42:43], v[126:127], v[142:143] neg_lo:[0,0,1] neg_hi:[0,0,1]
    v_pk_fma_f32 v[44:45], v[44:45], v[128:129], v[144:145] neg_lo:[0,0,1] neg_hi:[0,0,1]
    v_pk_fma_f32 v[46:47], v[46:47], v[130:131], v[146:147] neg_lo:[0,0,1] neg_hi:[0,0,1]
    v_cvt_pk_bf16_f32 v196, v32, v33
    v_cvt_pk_bf16_f32 v197, v34, v35
    v_cvt_pk_bf16_f32 v198, v40, v41
    v_cvt_pk_bf16_f32 v199, v42, v43
    buffer_store_dwordx4 v[196:199], v14, s[8:11], s51 offen offset:0 sc1
    v_cvt_pk_bf16_f32 v200, v36, v37
    v_cvt_pk_bf16_f32 v201, v38, v39
    v_cvt_pk_bf16_f32 v202, v44, v45
    v_cvt_pk_bf16_f32 v203, v46, v47
    buffer_store_dwordx4 v[200:203], v14, s[8:11], s51 offen offset:512 sc1
    s_mul_i32 s43, s57, 22528
    s_add_u32 s43, s43, s49
    s_branch LpKV_head
LpKV_f_4:
    v_mfma_f32_32x32x16_bf16 v[16:31], a[76:79], v[60:63], v[16:31]
    s_add_u32 m0, s59, 0
    s_add_u32 s47, s41, 0
    buffer_load_dwordx4 v0, s[8:11], s47 offen offset:0 lds
    ds_read_b128 v[56:59], v9 offset:22528
    v_mfma_f32_32x32x16_bf16 v[32:47], v[60:63], a[220:223], v[32:47]
    s_waitcnt lgkmcnt(2)
    v_mfma_f32_32x32x16_bf16 v[16:31], a[80:83], v[48:51], v[16:31]
    buffer_load_dwordx4 v0, s[8:11], s47 offen offset:1024 lds
    ds_read_b128 v[60:63], v9 offset:23552
    v_mfma_f32_32x32x16_bf16 v[32:47], v[48:51], a[224:227], v[32:47]
    s_waitcnt lgkmcnt(2)
    v_mfma_f32_32x32x16_bf16 v[16:31], a[84:87], v[52:55], v[16:31]
    buffer_load_dwordx4 v0, s[8:11], s47 offen offset:2048 lds
    ds_read_b128 v[48:51], v9 offset:24576
    v_mfma_f32_32x32x16_bf16 v[32:47], v[52:55], a[228:231], v[32:47]
    s_waitcnt lgkmcnt(2)
    v_mfma_f32_32x32x16_bf16 v[16:31], a[88:91], v[56:59], v[16:31]
    buffer_load_dwordx4 v0, s[8:11], s47 offen offset:3072 lds
    ds_read_b128 v[52:55], v9 offset:25600
    v_mfma_f32_32x32x16_bf16 v[32:47], v[56:59], a[232:235], v[32:47]
    s_waitcnt lgkmcnt(2)
    v_mfma_f32_32x32x16_bf16 v[16:31], a[92:95], v[60:63], v[16:31]
    s_add_u32 m0, s59, 4096
    s_add_u32 s47, s41, 4096
    buffer_load_dwordx4 v0, s[8:11], s47 offen offset:0 lds
    ds_read_b128 v[56:59], v9 offset:26624
    v_mfma_f32_32x32x16_bf16 v[32:47], v[60:63], a[236:239], v[32:47]
    s_waitcnt lgkmcnt(2)
    v_mfma_f32_32x32x16_bf16 v[16:31], a[96:99], v[48:51], v[16:31]
    buffer_load_dwordx4 v0, s[8:11], s47 offen offset:1024 lds
    ds_read_b128 v[60:63], v9 offset:27648
    v_mfma_f32_32x32x16_bf16 v[32:47], v[48:51], a[240:243], v[32:47]
    s_waitcnt lgkmcnt(2)
    v_mfma_f32_32x32x16_bf16 v[16:31], a[100:103], v[52:55], v[16:31]
    buffer_load_dwordx4 v0, s[8:11], s47 offen offset:2048 lds
    ds_read_b128 v[48:51], v9 offset:28672
    v_mfma_f32_32x32x16_bf16 v[32:47], v[52:55], a[244:247], v[32:47]
    s_waitcnt lgkmcnt(2)
    v_mfma_f32_32x32x16_bf16 v[16:31], a[104:107], v[56:59], v[16:31]
    buffer_load_dwordx4 v0, s[8:11], s47 offen offset:3072 lds
    ds_read_b128 v[52:55], v9 offset:29696
    v_mfma_f32_32x32x16_bf16 v[32:47], v[56:59], a[248:251], v[32:47]
    s_waitcnt lgkmcnt(2)
    v_mfma_f32_32x32x16_bf16 v[16:31], a[108:111], v[60:63], v[16:31]
    s_add_u32 m0, s59, 8192
    s_add_u32 s47, s41, 8192
    buffer_load_dwordx4 v0, s[8:11], s47 offen offset:0 lds
    ds_read_b128 v[56:59], v9 offset:30720
    v_mfma_f32_32x32x16_bf16 v[32:47], v[60:63], a[252:255], v[32:47]
    s_waitcnt lgkmcnt(2)
    v_mfma_f32_32x32x16_bf16 v[16:31], a[112:115], v[48:51], v[16:31]
    s_mul_i32 s48, s36, 786432
    s_mul_i32 s18, s37, 6144
    s_add_u32 s48, s48, s18
    s_add_u32 s48, s48, 16125952
    s_add_u32 m0, s66, 4096
    s_nop 0
    buffer_load_dwordx4 v0, s[8:11], s48 offen lds
    ds_read_b128 v[60:63], v9 offset:31744
    v_mfma_f32_32x32x16_bf16 v[32:47], v[48:51], v[152:155], v[32:47]
    s_waitcnt lgkmcnt(2)
    v_mfma_f32_32x32x16_bf16 v[16:31], a[116:119], v[52:55], v[16:31]
    s_add_u32 m0, s66, s67
    s_sub_u32 s48, s48, 4096
    s_add_u32 s48, s48, s67
    buffer_load_dwordx4 v0, s[8:11], s48 offen lds
    ds_read_b128 v[48:51], v9 offset:32768
    v_mfma_f32_32x32x16_bf16 v[32:47], v[52:55], v[156:159], v[32:47]
    s_waitcnt lgkmcnt(2)
    v_mfma_f32_32x32x16_bf16 v[16:31], a[120:123], v[56:59], v[16:31]
    ds_read_b128 v[52:55], v9 offset:33792
    v_mfma_f32_32x32x16_bf16 v[32:47], v[56:59], v[160:163], v[32:47]
    s_waitcnt lgkmcnt(2)
    v_mfma_f32_32x32x16_bf16 v[16:31], a[124:127], v[60:63], v[16:31]
    v_cmp_eq_u32 s[76:77], 1, v2
    v_cmp_eq_u32 vcc, 2, v2
    s_cmp_eq_u64 s[76:77], -1
    s_cselect_b32 s38, 1, 0
    ds_read_b128 v[56:59], v9 offset:34816
    v_mfma_f32_32x32x16_bf16 v[32:47], v[60:63], v[164:167], v[32:47]
    s_cmp_lg_u32 s38, 0
    s_cselect_b64 exec, 1, 0
    v_mov_b32 v15, s32
    ds_write_b32 v184, v15
    v_mov_b32 v2, 2
    s_mov_b64 exec, -1
    s_waitcnt lgkmcnt(3)
    v_mfma_f32_32x32x16_bf16 v[16:31], a[128:131], v[48:51], v[16:31]
    s_add_u32 s32, s32, s38
    s_mul_i32 s38, s38, 22528
    s_add_u32 s33, s33, s38
    ds_read_b128 v[60:63], v9 offset:35840
    v_mfma_f32_32x32x16_bf16 v[32:47], v[48:51], v[168:171], v[32:47]
    s_cmp_eq_u64 vcc, 0
    s_cselect_b32 s38, s32, 0x7fff
    s_waitcnt lgkmcnt(3)
    v_mfma_f32_32x32x16_bf16 v[16:31], a[132:135], v[52:55], v[16:31]
    s_cmp_le_u32 s38, s39
    s_cselect_b64 exec, -1, 0
    v_mov_b32 v2, 2
    buffer_load_dword v2, v1, s[8:11], s33 offen sc1
    s_mov_b64 exec, -1
    v_mfma_f32_32x32x16_bf16 v[32:47], v[52:55], v[172:175], v[32:47]
    s_waitcnt lgkmcnt(2)
    v_mfma_f32_32x32x16_bf16 v[16:31], a[136:139], v[56:59], v[16:31]
    v_mfma_f32_32x32x16_bf16 v[32:47], v[56:59], v[176:179], v[32:47]
    s_waitcnt lgkmcnt(0)
    v_mfma_f32_32x32x16_bf16 v[16:31], a[140:143], v[60:63], v[16:31]
    v_mfma_f32_32x32x16_bf16 v[32:47], v[60:63], v[180:183], v[32:47]
    s_add_u32 s51, s46, 16777216
    s_nop 2
    v_pk_fma_f32 v[16:17], v[16:17], v[148:149], v[100:101] op_sel_hi:[1,0,1] neg_lo:[0,0,1] neg_hi:[0,0,1]
    v_pk_fma_f32 v[18:19], v[18:19], v[148:149], v[102:103] op_sel_hi:[1,0,1] neg_lo:[0,0,1] neg_hi:[0,0,1]
    v_pk_fma_f32 v[20:21], v[20:21], v[148:149], v[104:105] op_sel_hi:[1,0,1] neg_lo:[0,0,1] neg_hi:[0,0,1]
    v_pk_fma_f32 v[22:23], v[22:23], v[148:149], v[106:107] op_sel_hi:[1,0,1] neg_lo:[0,0,1] neg_hi:[0,0,1]
    v_pk_fma_f32 v[24:25], v[24:25], v[148:149], v[108:109] op_sel_hi:[1,0,1] neg_lo:[0,0,1] neg_hi:[0,0,1]
    v_pk_fma_f32 v[26:27], v[26:27], v[148:149], v[110:111] op_sel_hi:[1,0,1] neg_lo:[0,0,1] neg_hi:[0,0,1]
    v_pk_fma_f32 v[28:29], v[28:29], v[148:149], v[112:113] op_sel_hi:[1,0,1] neg_lo:[0,0,1] neg_hi:[0,0,1]
    v_pk_fma_f32 v[30:31], v[30:31], v[148:149], v[114:115] op_sel_hi:[1,0,1] neg_lo:[0,0,1] neg_hi:[0,0,1]
    v_cvt_pk_bf16_f32 v188, v16, v24
    v_cvt_pk_bf16_f32 v189, v17, v25
    v_cvt_pk_bf16_f32 v190, v18, v26
    v_cvt_pk_bf16_f32 v191, v19, v27
    buffer_store_dwordx4 v[188:191], v14, s[8:11], s46 offen offset:0 sc1
    v_cvt_pk_bf16_f32 v192, v20, v28
    v_cvt_pk_bf16_f32 v193, v21, v29
    v_cvt_pk_bf16_f32 v194, v22, v30
    v_cvt_pk_bf16_f32 v195, v23, v31
    buffer_store_dwordx4 v[192:195], v14, s[8:11], s46 offen offset:512 sc1
    v_pk_fma_f32 v[32:33], v[32:33], v[116:117], v[132:133] neg_lo:[0,0,1] neg_hi:[0,0,1]
    v_pk_fma_f32 v[34:35], v[34:35], v[118:119], v[134:135] neg_lo:[0,0,1] neg_hi:[0,0,1]
    v_pk_fma_f32 v[36:37], v[36:37], v[120:121], v[136:137] neg_lo:[0,0,1] neg_hi:[0,0,1]
    v_pk_fma_f32 v[38:39], v[38:39], v[122:123], v[138:139] neg_lo:[0,0,1] neg_hi:[0,0,1]
    v_pk_fma_f32 v[40:41], v[40:41], v[124:125], v[140:141] neg_lo:[0,0,1] neg_hi:[0,0,1]
    v_pk_fma_f32 v[42:43], v[42:43], v[126:127], v[142:143] neg_lo:[0,0,1] neg_hi:[0,0,1]
    v_pk_fma_f32 v[44:45], v[44:45], v[128:129], v[144:145] neg_lo:[0,0,1] neg_hi:[0,0,1]
    v_pk_fma_f32 v[46:47], v[46:47], v[130:131], v[146:147] neg_lo:[0,0,1] neg_hi:[0,0,1]
    v_cvt_pk_bf16_f32 v196, v32, v33
    v_cvt_pk_bf16_f32 v197, v34, v35
    v_cvt_pk_bf16_f32 v198, v40, v41
    v_cvt_pk_bf16_f32 v199, v42, v43
    buffer_store_dwordx4 v[196:199], v14, s[8:11], s51 offen offset:0 sc1
    v_cvt_pk_bf16_f32 v200, v36, v37
    v_cvt_pk_bf16_f32 v201, v38, v39
    v_cvt_pk_bf16_f32 v202, v44, v45
    v_cvt_pk_bf16_f32 v203, v46, v47
    buffer_store_dwordx4 v[200:203], v14, s[8:11], s51 offen offset:512 sc1
    s_mul_i32 s43, s57, 22528
    s_add_u32 s43, s43, s49
    s_branch LpKV_head
LpKV_none:
    ds_read_b32 v15, v184
    s_waitcnt lgkmcnt(0)
    v_readfirstlane_b32 s17, v15
    s_nop 0
    s_cmp_lt_i32 s17, s37
    s_cbranch_scc1 LpKV_nopost
    s_add_u32 m0, s59, 0
    s_add_u32 s47, s41, 0
    buffer_load_dwordx4 v0, s[8:11], s47 offen offset:0 lds
    buffer_load_dwordx4 v0, s[8:11], s47 offen offset:1024 lds
    buffer_load_dwordx4 v0, s[8:11], s47 offen offset:2048 lds
    buffer_load_dwordx4 v0, s[8:11], s47 offen offset:3072 lds
    s_add_u32 m0, s59, 4096
    s_add_u32 s47, s41, 4096
    buffer_load_dwordx4 v0, s[8:11], s47 offen offset:0 lds
    buffer_load_dwordx4 v0, s[8:11], s47 offen offset:1024 lds
    buffer_load_dwordx4 v0, s[8:11], s47 offen offset:2048 lds
    buffer_load_dwordx4 v0, s[8:11], s47 offen offset:3072 lds
    s_add_u32 m0, s59, 8192
    s_add_u32 s47, s41, 8192
    buffer_load_dwordx4 v0, s[8:11], s47 offen offset:0 lds
    s_mul_i32 s48, s36, 786432
    s_mul_i32 s18, s37, 6144
    s_add_u32 s48, s48, s18
    s_add_u32 s48, s48, 16125952
    s_add_u32 m0, s66, 4096
    s_nop 0
    buffer_load_dwordx4 v0, s[8:11], s48 offen lds
    s_add_u32 m0, s66, s67
    s_sub_u32 s48, s48, 4096
    s_add_u32 s48, s48, s67
    buffer_load_dwordx4 v0, s[8:11], s48 offen lds
    s_waitcnt vmcnt(11)
    s_cmp_lg_u32 s43, 0
    s_cselect_b64 exec, 3, 0
    buffer_store_dword v3, v185, s[8:11], s43 offen sc1
    s_mov_b64 exec, -1
    s_mov_b32 s43, 0
    s_waitcnt vmcnt(1) lgkmcnt(0)
    s_branch LpKV_head2
LpKV_nopost:
    s_waitcnt vmcnt(0)
    s_cmp_lg_u32 s43, 0
    s_cselect_b64 exec, 3, 0
    buffer_store_dword v3, v185, s[8:11], s43 offen sc1
    s_mov_b64 exec, -1
    s_mov_b32 s43, 0
    s_cmp_ge_u32 s37, 64
    s_cbranch_scc1 LpKV_end
LpKV_wait:
    s_mov_b32 s16, 0
    s_cmp_lg_u32 s14, 0
    s_cbranch_scc1 LpKV_wl
LpKV_wp:
    buffer_load_dword v2, v1, s[8:11], s60 offen sc1
    s_add_u32 s16, s16, 1
    s_cmp_gt_u32 s16, 100000
    s_cbranch_scc1 LpKV_giveup
    s_waitcnt vmcnt(0)
    v_cmp_eq_u32 vcc, 0, v2
    s_nop 0
    s_cbranch_vccz LpKV_wok
    s_sleep 4
    s_branch LpKV_wp
LpKV_giveup:
    v_mov_b32 v5, -2
    ds_write_b32 v184, v5
    s_waitcnt lgkmcnt(0)
    s_branch L_role_p_abort
LpKV_wok:
    v_mov_b32 v5, s37
    ds_write_b32 v184, v5
    s_branch LpKV_go
LpKV_wl:
    ds_read_b32 v15, v184
    s_add_u32 s16, s16, 1
    s_cmp_gt_u32 s16, 1600000
    s_cbranch_scc1 L_role_p_abort
    s_waitcnt lgkmcnt(0)
    v_readfirstlane_b32 s17, v15
    s_nop 0
    s_cmp_eq_u32 s17, -2
    s_cbranch_scc1 L_role_p_abort
    s_cmp_ge_i32 s17, s37
    s_cbranch_scc1 LpKV_go
    s_sleep 1
    s_branch LpKV_wl
LpKV_go:
    s_add_u32 m0, s59, 0
    s_add_u32 s47, s41, 0
    buffer_load_dwordx4 v0, s[8:11], s47 offen offset:0 lds
    buffer_load_dwordx4 v0, s[8:11], s47 offen offset:1024 lds
    buffer_load_dwordx4 v0, s[8:11], s47 offen offset:2048 lds
    buffer_load_dwordx4 v0, s[8:11], s47 offen offset:3072 lds
    s_add_u32 m0, s59, 4096
    s_add_u32 s47, s41, 4096
    buffer_load_dwordx4 v0, s[8:11], s47 offen offset:0 lds
    buffer_load_dwordx4 v0, s[8:11], s47 offen offset:1024 lds
    buffer_load_dwordx4 v0, s[8:11], s47 offen offset:2048 lds
    buffer_load_dwordx4 v0, s[8:11], s47 offen offset:3072 lds
    s_add_u32 m0, s59, 8192
    s_add_u32 s47, s41, 8192
    buffer_load_dwordx4 v0, s[8:11], s47 offen offset:0 lds
    s_mul_i32 s48, s36, 786432
    s_mul_i32 s18, s37, 6144
    s_add_u32 s48, s48, s18
    s_add_u32 s48, s48, 16125952
    s_add_u32 m0, s66, 4096
    s_nop 0
    buffer_load_dwordx4 v0, s[8:11], s48 offen lds
    s_add_u32 m0, s66, s67
    s_sub_u32 s48, s48, 4096
    s_add_u32 s48, s48, s67
    buffer_load_dwordx4 v0, s[8:11], s48 offen lds
    s_waitcnt vmcnt(0) lgkmcnt(0)
    s_branch LpKV_head2
LpKV_end:
    s_branch L_role_p_exit
L_role_p_abort:
    s_waitcnt lgkmcnt(0)
    s_mov_b64 exec, -1
    v_mov_b32 v0, 60
    s_lshl_b32 s5, s3, 8
    s_or_b32 s5, s5, s4
    s_or_b32 s5, s5, 0x10000
    v_mov_b32 v1, s5
    global_store_dword v0, v1, s[12:13]
    s_endpgm
L_role_p_exit:
    s_endpgm
.p2align 6
L_role_awo:
    v_and_b32 v5, 63, v0
    v_lshlrev_b32 v0, 4, v5
    v_and_b32 v7, 15, v5
    v_lshrrev_b32 v8, 4, v5
    v_min_u32 v1, 63, v5
    v_lshrrev_b32 v6, 2, v1
    v_and_b32 v1, 3, v1
    v_lshlrev_b32 v1, 2, v1
    v_lshl_add_u32 v1, v6, 7, v1
    v_mov_b32 v3, 1
    v_mov_b32 v4, 0
    s_mov_b32 s44, 0x05040100
    s_mov_b32 s45, 0x07060302
    s_load_dwordx2 s[20:21], s[0:1], 16
    s_mov_b32 s22, 663552
    s_mov_b32 s23, 0x00020000
    s_waitcnt lgkmcnt(0)
    s_and_b32 s21, s21, 0xffff
    s_cmp_ge_u32 s15, 3
    s_cselect_b32 s63, 1, 0
    s_cselect_b32 s17, 3, 0
    s_sub_u32 s15, s15, s17
    s_lshl_b32 s50, s15, 2
    s_add_u32 s50, s50, s14
    s_cmp_eq_u32 s63, 0
    s_cbranch_scc1 Lao_gate_ng
    s_cmp_lg_u32 s14, 0
    s_cbranch_scc1 Lao_gate_d
    v_mov_b32 v5, 48
    s_mov_b32 s16, 0
Lao_gate:
    global_load_dword v6, v5, s[12:13] sc1
    s_add_u32 s16, s16, 1
    s_cmp_gt_u32 s16, 100000
    s_cbranch_scc1 L_role_awo_abort
    s_waitcnt vmcnt(0)
    v_cmp_gt_u32 vcc, 32, v6
    s_nop 0
    s_cbranch_vccz Lao_gate_d
    s_sleep 100
    s_branch Lao_gate
Lao_gate_d:
    s_barrier
Lao_gate_ng:
    v_lshrrev_b32 v5, 7, v0
    v_and_b32 v6, 0x70, v0
    v_mul_u32_u24 v16, 1152, v5
    v_add_u32 v16, v16, v6
    v_lshrrev_b32 v17, 1, v5
    v_mul_u32_u24 v17, 18, v17
    v_and_b32 v5, 1, v5
    v_add_u32 v17, v17, v5
    v_add_u32 v17, 16, v17
    v_mul_u32_u24 v17, 1152, v17
    v_add_u32 v17, v17, v6
    v_lshrrev_b32 v5, 2, v7
    v_lshl_add_u32 v5, v8, 3, v5
    v_lshlrev_b32 v18, 7, v5
    v_and_b32 v5, 3, v7
    v_lshl_add_u32 v19, v5, 3, v18
    v_lshl_add_u32 v18, v5, 4, v18
    s_lshl_b32 s46, s14, 15
    v_add_u32 v18, s46, v18
    v_add_u32 v19, s46, v19
    s_mul_i32 s49, s50, 96
    s_add_u32 m0, s46, 0
    s_add_u32 s17, s49, 0
    buffer_load_dwordx4 v16, s[20:23], s17 offen lds
    s_add_u32 m0, s46, 1024
    s_add_u32 s17, s49, 9216
    buffer_load_dwordx4 v16, s[20:23], s17 offen lds
    s_add_u32 m0, s46, 2048
    s_add_u32 s17, s49, 20736
    buffer_load_dwordx4 v16, s[20:23], s17 offen lds
    s_add_u32 m0, s46, 3072
    s_add_u32 s17, s49, 29952
    buffer_load_dwordx4 v16, s[20:23], s17 offen lds
    s_add_u32 m0, s46, 4096
    s_add_u32 s17, s49, 41472
    buffer_load_dwordx4 v16, s[20:23], s17 offen lds
    s_add_u32 m0, s46, 5120
    s_add_u32 s17, s49, 50688
    buffer_load_dwordx4 v16, s[20:23], s17 offen lds
    s_add_u32 m0, s46, 6144
    s_add_u32 s17, s49, 62208
    buffer_load_dwordx4 v16, s[20:23], s17 offen lds
    s_add_u32 m0, s46, 7168
    s_add_u32 s17, s49, 71424
    buffer_load_dwordx4 v16, s[20:23], s17 offen lds
    s_add_u32 m0, s46, 8192
    s_add_u32 s17, s49, 82944
    buffer_load_dwordx4 v16, s[20:23], s17 offen lds
    s_add_u32 m0, s46, 9216
    s_add_u32 s17, s49, 92160
    buffer_load_dwordx4 v16, s[20:23], s17 offen lds
    s_add_u32 m0, s46, 10240
    s_add_u32 s17, s49, 103680
    buffer_load_dwordx4 v16, s[20:23], s17 offen lds
    s_add_u32 m0, s46, 11264
    s_add_u32 s17, s49, 112896
    buffer_load_dwordx4 v16, s[20:23], s17 offen lds
    s_add_u32 m0, s46, 12288
    s_add_u32 s17, s49, 124416
    buffer_load_dwordx4 v16, s[20:23], s17 offen lds
    s_add_u32 m0, s46, 13312
    s_add_u32 s17, s49, 133632
    buffer_load_dwordx4 v16, s[20:23], s17 offen lds
    s_add_u32 m0, s46, 14336
    s_add_u32 s17, s49, 145152
    buffer_load_dwordx4 v16, s[20:23], s17 offen lds
    s_add_u32 m0, s46, 15360
    s_add_u32 s17, s49, 154368
    buffer_load_dwordx4 v16, s[20:23], s17 offen lds
    s_add_u32 m0, s46, 16384
    s_add_u32 s17, s49, 165888
    buffer_load_dwordx4 v16, s[20:23], s17 offen lds
    s_add_u32 m0, s46, 17408
    s_add_u32 s17, s49, 175104
    buffer_load_dwordx4 v16, s[20:23], s17 offen lds
    s_add_u32 m0, s46, 18432
    s_add_u32 s17, s49, 186624
    buffer_load_dwordx4 v16, s[20:23], s17 offen lds
    s_add_u32 m0, s46, 19456
    s_add_u32 s17, s49, 195840
    buffer_load_dwordx4 v16, s[20:23], s17 offen lds
    s_add_u32 m0, s46, 20480
    s_add_u32 s17, s49, 207360
    buffer_load_dwordx4 v16, s[20:23], s17 offen lds
    s_add_u32 m0, s46, 21504
    s_add_u32 s17, s49, 216576
    buffer_load_dwordx4 v16, s[20:23], s17 offen lds
    s_add_u32 m0, s46, 22528
    s_add_u32 s17, s49, 228096
    buffer_load_dwordx4 v16, s[20:23], s17 offen lds
    s_add_u32 m0, s46, 23552
    s_add_u32 s17, s49, 237312
    buffer_load_dwordx4 v16, s[20:23], s17 offen lds
    s_add_u32 m0, s46, 24576
    s_add_u32 s17, s49, 248832
    buffer_load_dwordx4 v16, s[20:23], s17 offen lds
    s_add_u32 m0, s46, 25600
    s_add_u32 s17, s49, 258048
    buffer_load_dwordx4 v16, s[20:23], s17 offen lds
    s_add_u32 m0, s46, 26624
    s_add_u32 s17, s49, 269568
    buffer_load_dwordx4 v16, s[20:23], s17 offen lds
    s_add_u32 m0, s46, 27648
    s_add_u32 s17, s49, 278784
    buffer_load_dwordx4 v16, s[20:23], s17 offen lds
    s_add_u32 m0, s46, 28672
    s_add_u32 s17, s49, 290304
    buffer_load_dwordx4 v16, s[20:23], s17 offen lds
    s_add_u32 m0, s46, 29696
    s_add_u32 s17, s49, 299520
    buffer_load_dwordx4 v16, s[20:23], s17 offen lds
    s_add_u32 m0, s46, 30720
    s_add_u32 s17, s49, 311040
    buffer_load_dwordx4 v16, s[20:23], s17 offen lds
    s_add_u32 m0, s46, 31744
    s_add_u32 s17, s49, 320256
    buffer_load_dwordx4 v16, s[20:23], s17 offen lds
    s_waitcnt vmcnt(28)
    ds_read_b64_tr_b16 a[0:1], v18 offset:0
    ds_read_b64_tr_b16 a[2:3], v18 offset:512
    ds_read_b64_tr_b16 a[4:5], v18 offset:8
    ds_read_b64_tr_b16 a[6:7], v18 offset:520
    ds_read_b64_tr_b16 a[8:9], v19 offset:64
    ds_read_b64_tr_b16 a[10:11], v19 offset:576
    s_waitcnt lgkmcnt(0)
    s_add_u32 m0, s46, 0
    s_add_u32 s17, s49, 331776
    buffer_load_dwordx4 v16, s[20:23], s17 offen lds
    s_add_u32 m0, s46, 1024
    s_add_u32 s17, s49, 340992
    buffer_load_dwordx4 v16, s[20:23], s17 offen lds
    s_add_u32 m0, s46, 2048
    s_add_u32 s17, s49, 352512
    buffer_load_dwordx4 v16, s[20:23], s17 offen lds
    s_add_u32 m0, s46, 3072
    s_add_u32 s17, s49, 361728
    buffer_load_dwordx4 v16, s[20:23], s17 offen lds
    s_waitcnt vmcnt(28)
    ds_read_b64_tr_b16 a[12:13], v18 offset:4096
    ds_read_b64_tr_b16 a[14:15], v18 offset:4608
    ds_read_b64_tr_b16 a[16:17], v18 offset:4104
    ds_read_b64_tr_b16 a[18:19], v18 offset:4616
    ds_read_b64_tr_b16 a[20:21], v19 offset:4160
    ds_read_b64_tr_b16 a[22:23], v19 offset:4672
    s_waitcnt lgkmcnt(0)
    s_add_u32 m0, s46, 4096
    s_add_u32 s17, s49, 373248
    buffer_load_dwordx4 v16, s[20:23], s17 offen lds
    s_add_u32 m0, s46, 5120
    s_add_u32 s17, s49, 382464
    buffer_load_dwordx4 v16, s[20:23], s17 offen lds
    s_add_u32 m0, s46, 6144
    s_add_u32 s17, s49, 393984
    buffer_load_dwordx4 v16, s[20:23], s17 offen lds
    s_add_u32 m0, s46, 7168
    s_add_u32 s17, s49, 403200
    buffer_load_dwordx4 v16, s[20:23], s17 offen lds
    s_waitcnt vmcnt(28)
    ds_read_b64_tr_b16 a[24:25], v18 offset:8192
    ds_read_b64_tr_b16 a[26:27], v18 offset:8704
    ds_read_b64_tr_b16 a[28:29], v18 offset:8200
    ds_read_b64_tr_b16 a[30:31], v18 offset:8712
    ds_read_b64_tr_b16 a[32:33], v19 offset:8256
    ds_read_b64_tr_b16 a[34:35], v19 offset:8768
    s_waitcnt lgkmcnt(0)
    s_add_u32 m0, s46, 8192
    s_add_u32 s17, s49, 414720
    buffer_load_dwordx4 v16, s[20:23], s17 offen lds
    s_add_u32 m0, s46, 9216
    s_add_u32 s17, s49, 423936
    buffer_load_dwordx4 v16, s[20:23], s17 offen lds
    s_add_u32 m0, s46, 10240
    s_add_u32 s17, s49, 435456
    buffer_load_dwordx4 v16, s[20:23], s17 offen lds
    s_add_u32 m0, s46, 11264
    s_add_u32 s17, s49, 444672
    buffer_load_dwordx4 v16, s[20:23], s17 offen lds
    s_waitcnt vmcnt(28)
    ds_read_b64_tr_b16 a[36:37], v18 offset:12288
    ds_read_b64_tr_b16 a[38:39], v18 offset:12800
    ds_read_b64_tr_b16 a[40:41], v18 offset:12296
    ds_read_b64_tr_b16 a[42:43], v18 offset:12808
    ds_read_b64_tr_b16 a[44:45], v19 offset:12352
    ds_read_b64_tr_b16 a[46:47], v19 offset:12864
    s_waitcnt lgkmcnt(0)
    s_add_u32 m0, s46, 12288
    s_add_u32 s17, s49, 456192
    buffer_load_dwordx4 v16, s[20:23], s17 offen lds
    s_add_u32 m0, s46, 13312
    s_add_u32 s17, s49, 465408
    buffer_load_dwordx4 v16, s[20:23], s17 offen lds
    s_add_u32 m0, s46, 14336
    s_add_u32 s17, s49, 476928
    buffer_load_dwordx4 v16, s[20:23], s17 offen lds
    s_add_u32 m0, s46, 15360
    s_add_u32 s17, s49, 486144
    buffer_load_dwordx4 v16, s[20:23], s17 offen lds
    s_waitcnt vmcnt(28)
    ds_read_b64_tr_b16 a[48:49], v18 offset:16384
    ds_read_b64_tr_b16 a[50:51], v18 offset:16896
    ds_read_b64_tr_b16 a[52:53], v18 offset:16392
    ds_read_b64_tr_b16 a[54:55], v18 offset:16904
    ds_read_b64_tr_b16 a[56:57], v19 offset:16448
    ds_read_b64_tr_b16 a[58:59], v19 offset:16960
    s_waitcnt lgkmcnt(0)
    s_add_u32 m0, s46, 16384
    s_add_u32 s17, s49, 497664
    buffer_load_dwordx4 v16, s[20:23], s17 offen lds
    s_add_u32 m0, s46, 17408
    s_add_u32 s17, s49, 506880
    buffer_load_dwordx4 v16, s[20:23], s17 offen lds
    s_add_u32 m0, s46, 18432
    s_add_u32 s17, s49, 518400
    buffer_load_dwordx4 v16, s[20:23], s17 offen lds
    s_add_u32 m0, s46, 19456
    s_add_u32 s17, s49, 527616
    buffer_load_dwordx4 v16, s[20:23], s17 offen lds
    s_waitcnt vmcnt(28)
    ds_read_b64_tr_b16 a[60:61], v18 offset:20480
    ds_read_b64_tr_b16 a[62:63], v18 offset:20992
    ds_read_b64_tr_b16 a[64:65], v18 offset:20488
    ds_read_b64_tr_b16 a[66:67], v18 offset:21000
    ds_read_b64_tr_b16 a[68:69], v19 offset:20544
    ds_read_b64_tr_b16 a[70:71], v19 offset:21056
    s_waitcnt lgkmcnt(0)
    s_add_u32 m0, s46, 20480
    s_add_u32 s17, s49, 539136
    buffer_load_dwordx4 v16, s[20:23], s17 offen lds
    s_add_u32 m0, s46, 21504
    s_add_u32 s17, s49, 548352
    buffer_load_dwordx4 v16, s[20:23], s17 offen lds
    s_add_u32 m0, s46, 22528
    s_add_u32 s17, s49, 559872
    buffer_load_dwordx4 v16, s[20:23], s17 offen lds
    s_add_u32 m0, s46, 23552
    s_add_u32 s17, s49, 569088
    buffer_load_dwordx4 v16, s[20:23], s17 offen lds
    s_waitcnt vmcnt(28)
    ds_read_b64_tr_b16 a[72:73], v18 offset:24576
    ds_read_b64_tr_b16 a[74:75], v18 offset:25088
    ds_read_b64_tr_b16 a[76:77], v18 offset:24584
    ds_read_b64_tr_b16 a[78:79], v18 offset:25096
    ds_read_b64_tr_b16 a[80:81], v19 offset:24640
    ds_read_b64_tr_b16 a[82:83], v19 offset:25152
    s_waitcnt lgkmcnt(0)
    s_add_u32 m0, s46, 24576
    s_add_u32 s17, s49, 580608
    buffer_load_dwordx4 v16, s[20:23], s17 offen lds
    s_add_u32 m0, s46, 25600
    s_add_u32 s17, s49, 589824
    buffer_load_dwordx4 v16, s[20:23], s17 offen lds
    s_add_u32 m0, s46, 26624
    s_add_u32 s17, s49, 601344
    buffer_load_dwordx4 v16, s[20:23], s17 offen lds
    s_add_u32 m0, s46, 27648
    s_add_u32 s17, s49, 610560
    buffer_load_dwordx4 v16, s[20:23], s17 offen lds
    s_waitcnt vmcnt(28)
    ds_read_b64_tr_b16 a[84:85], v18 offset:28672
    ds_read_b64_tr_b16 a[86:87], v18 offset:29184
    ds_read_b64_tr_b16 a[88:89], v18 offset:28680
    ds_read_b64_tr_b16 a[90:91], v18 offset:29192
    ds_read_b64_tr_b16 a[92:93], v19 offset:28736
    ds_read_b64_tr_b16 a[94:95], v19 offset:29248
    s_waitcnt lgkmcnt(0)
    s_add_u32 m0, s46, 28672
    s_add_u32 s17, s49, 622080
    buffer_load_dwordx4 v16, s[20:23], s17 offen lds
    s_add_u32 m0, s46, 29696
    s_add_u32 s17, s49, 631296
    buffer_load_dwordx4 v16, s[20:23], s17 offen lds
    s_add_u32 m0, s46, 30720
    s_add_u32 s17, s49, 642816
    buffer_load_dwordx4 v16, s[20:23], s17 offen lds
    s_add_u32 m0, s46, 31744
    s_add_u32 s17, s49, 652032
    buffer_load_dwordx4 v16, s[20:23], s17 offen lds
    s_waitcnt vmcnt(28)
    ds_read_b64_tr_b16 a[96:97], v18 offset:0
    ds_read_b64_tr_b16 a[98:99], v18 offset:512
    ds_read_b64_tr_b16 a[100:101], v18 offset:8
    ds_read_b64_tr_b16 a[102:103], v18 offset:520
    ds_read_b64_tr_b16 a[104:105], v19 offset:64
    ds_read_b64_tr_b16 a[106:107], v19 offset:576
    s_waitcnt lgkmcnt(0)
    s_add_u32 m0, s46, 0
    s_add_u32 s17, s49, 0
    buffer_load_dwordx4 v17, s[20:23], s17 offen lds
    s_add_u32 m0, s46, 1024
    s_add_u32 s17, s49, 82944
    buffer_load_dwordx4 v17, s[20:23], s17 offen lds
    s_add_u32 m0, s46, 2048
    s_add_u32 s17, s49, 165888
    buffer_load_dwordx4 v17, s[20:23], s17 offen lds
    s_add_u32 m0, s46, 3072
    s_add_u32 s17, s49, 248832
    buffer_load_dwordx4 v17, s[20:23], s17 offen lds
    s_waitcnt vmcnt(28)
    ds_read_b64_tr_b16 a[108:109], v18 offset:4096
    ds_read_b64_tr_b16 a[110:111], v18 offset:4608
    ds_read_b64_tr_b16 a[112:113], v18 offset:4104
    ds_read_b64_tr_b16 a[114:115], v18 offset:4616
    ds_read_b64_tr_b16 a[116:117], v19 offset:4160
    ds_read_b64_tr_b16 a[118:119], v19 offset:4672
    s_waitcnt lgkmcnt(0)
    s_add_u32 m0, s46, 4096
    s_add_u32 s17, s49, 331776
    buffer_load_dwordx4 v17, s[20:23], s17 offen lds
    s_add_u32 m0, s46, 5120
    s_add_u32 s17, s49, 414720
    buffer_load_dwordx4 v17, s[20:23], s17 offen lds
    s_add_u32 m0, s46, 6144
    s_add_u32 s17, s49, 497664
    buffer_load_dwordx4 v17, s[20:23], s17 offen lds
    s_add_u32 m0, s46, 7168
    s_add_u32 s17, s49, 580608
    buffer_load_dwordx4 v17, s[20:23], s17 offen lds
    s_waitcnt vmcnt(28)
    ds_read_b64_tr_b16 a[120:121], v18 offset:8192
    ds_read_b64_tr_b16 a[122:123], v18 offset:8704
    ds_read_b64_tr_b16 a[124:125], v18 offset:8200
    ds_read_b64_tr_b16 a[126:127], v18 offset:8712
    ds_read_b64_tr_b16 a[128:129], v19 offset:8256
    ds_read_b64_tr_b16 a[130:131], v19 offset:8768
    s_waitcnt lgkmcnt(0)
    s_waitcnt vmcnt(24)
    ds_read_b64_tr_b16 a[132:133], v18 offset:12288
    ds_read_b64_tr_b16 a[134:135], v18 offset:12800
    ds_read_b64_tr_b16 a[136:137], v18 offset:12296
    ds_read_b64_tr_b16 a[138:139], v18 offset:12808
    ds_read_b64_tr_b16 a[140:141], v19 offset:12352
    ds_read_b64_tr_b16 a[142:143], v19 offset:12864
    s_waitcnt lgkmcnt(0)
    s_waitcnt vmcnt(20)
    ds_read_b64_tr_b16 a[144:145], v18 offset:16384
    ds_read_b64_tr_b16 a[146:147], v18 offset:16896
    ds_read_b64_tr_b16 a[148:149], v18 offset:16392
    ds_read_b64_tr_b16 a[150:151], v18 offset:16904
    ds_read_b64_tr_b16 a[152:153], v19 offset:16448
    ds_read_b64_tr_b16 a[154:155], v19 offset:16960
    s_waitcnt lgkmcnt(0)
    s_waitcnt vmcnt(16)
    ds_read_b64_tr_b16 a[156:157], v18 offset:20480
    ds_read_b64_tr_b16 a[158:159], v18 offset:20992
    ds_read_b64_tr_b16 a[160:161], v18 offset:20488
    ds_read_b64_tr_b16 a[162:163], v18 offset:21000
    ds_read_b64_tr_b16 a[164:165], v19 offset:20544
    ds_read_b64_tr_b16 a[166:167], v19 offset:21056
    s_waitcnt lgkmcnt(0)
    s_waitcnt vmcnt(12)
    ds_read_b64_tr_b16 a[168:169], v18 offset:24576
    ds_read_b64_tr_b16 a[170:171], v18 offset:25088
    ds_read_b64_tr_b16 a[172:173], v18 offset:24584
    ds_read_b64_tr_b16 a[174:175], v18 offset:25096
    ds_read_b64_tr_b16 a[176:177], v19 offset:24640
    ds_read_b64_tr_b16 a[178:179], v19 offset:25152
    s_waitcnt lgkmcnt(0)
    s_waitcnt vmcnt(8)
    ds_read_b64_tr_b16 a[180:181], v18 offset:28672
    ds_read_b64_tr_b16 a[182:183], v18 offset:29184
    ds_read_b64_tr_b16 a[184:185], v18 offset:28680
    ds_read_b64_tr_b16 a[186:187], v18 offset:29192
    ds_read_b64_tr_b16 a[188:189], v19 offset:28736
    ds_read_b64_tr_b16 a[190:191], v19 offset:29248
    s_waitcnt lgkmcnt(0)
    s_waitcnt vmcnt(4)
    ds_read_b64_tr_b16 a[192:193], v18 offset:0
    ds_read_b64_tr_b16 a[194:195], v18 offset:512
    ds_read_b64_tr_b16 a[196:197], v18 offset:8
    ds_read_b64_tr_b16 a[198:199], v18 offset:520
    ds_read_b64_tr_b16 a[200:201], v19 offset:64
    ds_read_b64_tr_b16 a[202:203], v19 offset:576
    s_waitcnt lgkmcnt(0)
    s_waitcnt vmcnt(0)
    ds_read_b64_tr_b16 a[204:205], v18 offset:4096
    ds_read_b64_tr_b16 a[206:207], v18 offset:4608
    ds_read_b64_tr_b16 a[208:209], v18 offset:4104
    ds_read_b64_tr_b16 a[210:211], v18 offset:4616
    ds_read_b64_tr_b16 a[212:213], v19 offset:4160
    ds_read_b64_tr_b16 a[214:215], v19 offset:4672
    s_waitcnt lgkmcnt(0)
    s_barrier
    v_lshlrev_b32 v5, 4, v7
    v_lshl_add_u32 v10, v8, 9, v5
    s_mul_i32 s17, s50, 3072
    v_add_u32 v10, s17, v10
    v_lshrrev_b32 v6, 1, v8
    v_lshl_add_u32 v12, v6, 9, v5
    v_and_b32 v6, 1, v8
    v_lshl_add_u32 v12, v6, 3, v12
    s_add_u32 s17, s17, 2048
    v_add_u32 v12, s17, v12
    s_lshr_b32 s17, s50, 1
    s_lshl_b32 s17, s17, 9
    s_and_b32 s18, s50, 1
    s_lshl_b32 s18, s18, 3
    s_add_u32 s17, s17, s18
    v_add_u32 v11, s17, v5
    s_lshl_b32 s49, s15, 7
    s_lshl_b32 s17, s14, 2
    s_add_u32 s49, s49, s17
    s_add_u32 s49, s49, 3584
    s_mov_b32 s36, s63
    s_mov_b32 s34, s63
    s_mul_i32 s58, s14, 9216
    s_mul_i32 s64, s63, 2359296
    s_add_u32 s64, s64, s58
    s_add_u32 s64, s64, 17301504
    s_mul_i32 s61, s63, 1441792
    s_add_u32 s61, s61, 1536
    s_mov_b32 s37, 0
    s_mov_b32 s40, 36864
    s_mov_b32 s59, s58
    s_mov_b32 s43, 0
    s_mov_b32 s62, 1
    s_mov_b32 s28, s8
    s_mov_b32 s29, s9
    s_mov_b32 s30, 0
    s_mov_b32 s31, 0x00020000
    v_mov_b32 v184, 74752
    v_mov_b32 v5, -1
    ds_write_b32 v184, v5
    s_waitcnt lgkmcnt(0)
    s_cmp_lg_u32 s14, 0
    s_cbranch_scc1 Lawo_inia_d
    v_mov_b32 v5, 40
    s_mov_b32 s16, 0
Lawo_inia:
    global_load_dword v6, v5, s[12:13] sc1
    s_add_u32 s16, s16, 1
    s_cmp_gt_u32 s16, 100000
    s_cbranch_scc1 L_role_awo_abort
    s_waitcnt vmcnt(0)
    v_cmp_gt_u32 vcc, 128, v6
    s_nop 0
    s_cbranch_vccz Lawo_inia_d
    s_sleep 8
    s_branch Lawo_inia
Lawo_inia_d:
    s_barrier
    s_cmp_eq_u32 s63, 0
    s_cbranch_scc1 Lawo_ini_sk
    s_cmp_lg_u32 s14, 0
    s_cbranch_scc1 Lawo_inib_d
    v_mov_b32 v5, 160
    s_mov_b32 s16, 0
Lawo_inib:
    global_load_dword v6, v5, s[12:13] sc1
    s_add_u32 s16, s16, 1
    s_cmp_gt_u32 s16, 100000
    s_cbranch_scc1 L_role_awo_abort
    s_waitcnt vmcnt(0)
    v_cmp_gt_u32 vcc, 64, v6
    s_nop 0
    s_cbranch_vccz Lawo_inib_d
    s_sleep 8
    s_branch Lawo_inib
Lawo_inib_d:
    s_barrier
Lawo_ini_sk:
    s_mul_i32 s41, s37, 36864
    s_add_u32 s41, s41, s64
    s_mul_i32 s60, s37, 22528
    s_add_u32 s60, s60, s61
    s_cmp_lt_u32 s37, 64
    s_cselect_b32 s60, s60, 2883584
    s_branch Lawo_wait
Lawo_head:
    s_waitcnt vmcnt(6)
Lawo_head2:
    s_barrier
    ds_read_b32 v15, v184
    s_xor_b32 s40, s40, 36864
    s_xor_b32 s59, s59, 36864
    s_mov_b32 s35, s37
    s_lshl_b32 s57, s34, 6
    s_add_u32 s57, s57, s35
    s_add_u32 s37, s37, 1
    s_mov_b32 s39, 0
    s_mov_b32 s54, 0
    s_mul_i32 s41, s37, 36864
    s_add_u32 s41, s41, s64
    s_mul_i32 s60, s37, 22528
    s_add_u32 s60, s60, s61
    s_cmp_lt_u32 s37, 64
    s_cselect_b32 s60, s60, 2883584
    v_lshlrev_b32 v9, 9, v8
    v_lshl_add_u32 v9, v7, 4, v9
    v_add_u32 v9, s40, v9
    ds_read_b128 v[40:43], v9 offset:0
    ds_read_b128 v[44:47], v9 offset:256
    ds_read_b128 v[48:51], v9 offset:2048
    ds_read_b128 v[52:55], v9 offset:2304
    ds_read_b128 v[56:59], v9 offset:4096
    v_lshlrev_b32 v16, 16, v64
    v_and_b32 v17, 0xffff0000, v64
    v_lshlrev_b32 v18, 16, v65
    v_and_b32 v19, 0xffff0000, v65
    v_lshlrev_b32 v20, 16, v66
    v_and_b32 v21, 0xffff0000, v66
    v_lshlrev_b32 v22, 16, v67
    v_and_b32 v23, 0xffff0000, v67
    v_lshlrev_b32 v24, 16, v68
    v_and_b32 v25, 0xffff0000, v68
    v_lshlrev_b32 v26, 16, v69
    v_and_b32 v27, 0xffff0000, v69
    v_lshlrev_b32 v28, 16, v72
    v_and_b32 v29, 0xffff0000, v72
    v_lshlrev_b32 v30, 16, v73
    v_and_b32 v31, 0xffff0000, v73
    v_lshlrev_b32 v32, 16, v74
    v_and_b32 v33, 0xffff0000, v74
    v_lshlrev_b32 v34, 16, v75
    v_and_b32 v35, 0xffff0000, v75
    v_lshlrev_b32 v36, 16, v76
    v_and_b32 v37, 0xffff0000, v76
    v_lshlrev_b32 v38, 16, v77
    v_and_b32 v39, 0xffff0000, v77
    s_waitcnt lgkmcnt(4)
    v_mfma_f32_16x16x32_bf16 v[16:19], a[0:3], v[40:43], v[16:19]
    ds_read_b128 v[60:63], v9 offset:4352
    v_mfma_f32_16x16x32_bf16 v[20:23], a[4:7], v[40:43], v[20:23]
    s_mul_i32 s46, s34, 4718592
    v_mfma_f32_16x16x32_bf16 v[24:27], a[8:11], v[40:43], v[24:27]
    s_waitcnt lgkmcnt(4)
    v_mfma_f32_16x16x32_bf16 v[28:31], a[0:3], v[44:47], v[28:31]
    ds_read_b128 v[40:43], v9 offset:6144
    v_mfma_f32_16x16x32_bf16 v[32:35], a[4:7], v[44:47], v[32:35]
    s_mul_i32 s51, s35, 36864
    v_mfma_f32_16x16x32_bf16 v[36:39], a[8:11], v[44:47], v[36:39]
    v_readfirstlane_b32 s17, v15
    s_nop 0
    s_add_u32 s18, s17, 1
    s_max_i32 s32, s18, s37
    s_add_u32 s39, s37, 1
    s_min_u32 s39, s39, 63
    s_mul_i32 s33, s32, 22528
    s_add_u32 s33, s33, s61
    s_cmp_eq_u32 s14, 0
    s_cselect_b32 s18, s32, 0x7fff
    v_mov_b32 v2, 2
    s_cmp_le_u32 s18, s39
    s_cselect_b64 exec, -1, 0
    buffer_load_dword v2, v1, s[8:11], s33 offen sc1
    s_mov_b64 exec, -1
    s_cmp_ge_i32 s17, s37
    s_cbranch_scc1 Lawo_f_5
    s_waitcnt lgkmcnt(4)
    v_mfma_f32_16x16x32_bf16 v[16:19], a[12:15], v[48:51], v[16:19]
    ds_read_b128 v[44:47], v9 offset:6400
    v_mfma_f32_16x16x32_bf16 v[20:23], a[16:19], v[48:51], v[20:23]
    s_add_u32 s46, s46, s51
    v_mfma_f32_16x16x32_bf16 v[24:27], a[20:23], v[48:51], v[24:27]
    s_waitcnt lgkmcnt(4)
    v_mfma_f32_16x16x32_bf16 v[28:31], a[12:15], v[52:55], v[28:31]
    ds_read_b128 v[48:51], v9 offset:8192
    v_mfma_f32_16x16x32_bf16 v[32:35], a[16:19], v[52:55], v[32:35]
    s_add_u32 s46, s46, 8650752
    v_mfma_f32_16x16x32_bf16 v[36:39], a[20:23], v[52:55], v[36:39]
    s_waitcnt lgkmcnt(4)
    v_mfma_f32_16x16x32_bf16 v[16:19], a[24:27], v[56:59], v[16:19]
    ds_read_b128 v[52:55], v9 offset:8448
    v_mfma_f32_16x16x32_bf16 v[20:23], a[28:31], v[56:59], v[20:23]
    s_mul_i32 s52, s34, 786432
    v_mfma_f32_16x16x32_bf16 v[24:27], a[32:35], v[56:59], v[24:27]
    s_waitcnt lgkmcnt(4)
    v_mfma_f32_16x16x32_bf16 v[28:31], a[24:27], v[60:63], v[28:31]
    ds_read_b128 v[56:59], v9 offset:10240
    v_mfma_f32_16x16x32_bf16 v[32:35], a[28:31], v[60:63], v[32:35]
    s_mul_i32 s51, s35, 6144
    v_mfma_f32_16x16x32_bf16 v[36:39], a[32:35], v[60:63], v[36:39]
    s_waitcnt lgkmcnt(4)
    v_mfma_f32_16x16x32_bf16 v[16:19], a[36:39], v[40:43], v[16:19]
    ds_read_b128 v[60:63], v9 offset:10496
    v_mfma_f32_16x16x32_bf16 v[20:23], a[40:43], v[40:43], v[20:23]
    s_add_u32 s52, s52, s51
    v_mfma_f32_16x16x32_bf16 v[24:27], a[44:47], v[40:43], v[24:27]
    s_waitcnt lgkmcnt(4)
    v_mfma_f32_16x16x32_bf16 v[28:31], a[36:39], v[44:47], v[28:31]
    ds_read_b128 v[40:43], v9 offset:12288
    v_mfma_f32_16x16x32_bf16 v[32:35], a[40:43], v[44:47], v[32:35]
    s_add_u32 s52, s52, 16121856
    v_mfma_f32_16x16x32_bf16 v[36:39], a[44:47], v[44:47], v[36:39]
    s_waitcnt lgkmcnt(4)
    v_mfma_f32_16x16x32_bf16 v[16:19], a[48:51], v[48:51], v[16:19]
    ds_read_b128 v[44:47], v9 offset:12544
    v_mfma_f32_16x16x32_bf16 v[20:23], a[52:55], v[48:51], v[20:23]
    v_mfma_f32_16x16x32_bf16 v[24:27], a[56:59], v[48:51], v[24:27]
    s_waitcnt lgkmcnt(4)
    v_mfma_f32_16x16x32_bf16 v[28:31], a[48:51], v[52:55], v[28:31]
    ds_read_b128 v[48:51], v9 offset:14336
    v_mfma_f32_16x16x32_bf16 v[32:35], a[52:55], v[52:55], v[32:35]
    v_mfma_f32_16x16x32_bf16 v[36:39], a[56:59], v[52:55], v[36:39]
    s_waitcnt lgkmcnt(4)
    v_mfma_f32_16x16x32_bf16 v[16:19], a[60:63], v[56:59], v[16:19]
    ds_read_b128 v[52:55], v9 offset:14592
    v_mfma_f32_16x16x32_bf16 v[20:23], a[64:67], v[56:59], v[20:23]
    v_mfma_f32_16x16x32_bf16 v[24:27], a[68:71], v[56:59], v[24:27]
    s_waitcnt lgkmcnt(4)
    v_mfma_f32_16x16x32_bf16 v[28:31], a[60:63], v[60:63], v[28:31]
    v_cmp_eq_u32 s[76:77], 1, v2
    v_cmp_eq_u32 vcc, 2, v2
    ds_read_b128 v[56:59], v9 offset:16384
    v_mfma_f32_16x16x32_bf16 v[32:35], a[64:67], v[60:63], v[32:35]
    s_cmp_eq_u64 s[76:77], -1
    s_cselect_b32 s38, 1, 0
    v_mfma_f32_16x16x32_bf16 v[36:39], a[68:71], v[60:63], v[36:39]
    s_cmp_lg_u32 s38, 0
    s_cselect_b64 exec, 1, 0
    v_mov_b32 v15, s32
    ds_write_b32 v184, v15
    v_mov_b32 v2, 2
    s_mov_b64 exec, -1
    s_waitcnt lgkmcnt(5)
    v_mfma_f32_16x16x32_bf16 v[16:19], a[72:75], v[40:43], v[16:19]
    ds_read_b128 v[60:63], v9 offset:16640
    v_mfma_f32_16x16x32_bf16 v[20:23], a[76:79], v[40:43], v[20:23]
    s_add_u32 s32, s32, s38
    s_mul_i32 s38, s38, 22528
    s_add_u32 s33, s33, s38
    v_mfma_f32_16x16x32_bf16 v[24:27], a[80:83], v[40:43], v[24:27]
    s_cmp_eq_u64 vcc, 0
    s_cselect_b32 s38, s32, 0x7fff
    s_waitcnt lgkmcnt(5)
    v_mfma_f32_16x16x32_bf16 v[28:31], a[72:75], v[44:47], v[28:31]
    s_cmp_le_u32 s38, s39
    s_cselect_b64 exec, -1, 0
    v_mov_b32 v2, 2
    buffer_load_dword v2, v1, s[8:11], s33 offen sc1
    s_mov_b64 exec, -1
    ds_read_b128 v[40:43], v9 offset:18432
    v_mfma_f32_16x16x32_bf16 v[32:35], a[76:79], v[44:47], v[32:35]
    v_mfma_f32_16x16x32_bf16 v[36:39], a[80:83], v[44:47], v[36:39]
    ds_read_b32 v15, v184
    s_waitcnt lgkmcnt(6)
    v_mfma_f32_16x16x32_bf16 v[16:19], a[84:87], v[48:51], v[16:19]
    ds_read_b128 v[44:47], v9 offset:18688
    v_mfma_f32_16x16x32_bf16 v[20:23], a[88:91], v[48:51], v[20:23]
    v_mfma_f32_16x16x32_bf16 v[24:27], a[92:95], v[48:51], v[24:27]
    s_waitcnt lgkmcnt(6)
    v_mfma_f32_16x16x32_bf16 v[28:31], a[84:87], v[52:55], v[28:31]
    ds_read_b128 v[48:51], v9 offset:20480
    v_mfma_f32_16x16x32_bf16 v[32:35], a[88:91], v[52:55], v[32:35]
    v_mfma_f32_16x16x32_bf16 v[36:39], a[92:95], v[52:55], v[36:39]
    s_waitcnt lgkmcnt(2)
    v_readfirstlane_b32 s17, v15
    s_nop 0
    s_cmp_ge_i32 s17, s37
    s_cbranch_scc1 Lawo_f_6
    v_mfma_f32_16x16x32_bf16 v[16:19], a[96:99], v[56:59], v[16:19]
    ds_read_b128 v[52:55], v9 offset:20736
    v_mfma_f32_16x16x32_bf16 v[20:23], a[100:103], v[56:59], v[20:23]
    v_mfma_f32_16x16x32_bf16 v[24:27], a[104:107], v[56:59], v[24:27]
    v_mfma_f32_16x16x32_bf16 v[28:31], a[96:99], v[60:63], v[28:31]
    ds_read_b128 v[56:59], v9 offset:22528
    v_mfma_f32_16x16x32_bf16 v[32:35], a[100:103], v[60:63], v[32:35]
    v_mfma_f32_16x16x32_bf16 v[36:39], a[104:107], v[60:63], v[36:39]
    s_waitcnt vmcnt(2)
    s_cmp_lg_u32 s43, 0
    s_cselect_b64 exec, 1, 0
    buffer_store_dword v3, v4, s[8:11], s43 offen sc1
    s_mov_b64 exec, -1
    s_mov_b32 s43, 0
    v_mfma_f32_16x16x32_bf16 v[16:19], a[108:111], v[40:43], v[16:19]
    ds_read_b128 v[60:63], v9 offset:22784
    v_mfma_f32_16x16x32_bf16 v[20:23], a[112:115], v[40:43], v[20:23]
    v_mfma_f32_16x16x32_bf16 v[24:27], a[116:119], v[40:43], v[24:27]
    s_waitcnt lgkmcnt(4)
    v_mfma_f32_16x16x32_bf16 v[28:31], a[108:111], v[44:47], v[28:31]
    ds_read_b128 v[40:43], v9 offset:24576
    v_mfma_f32_16x16x32_bf16 v[32:35], a[112:115], v[44:47], v[32:35]
    v_mfma_f32_16x16x32_bf16 v[36:39], a[116:119], v[44:47], v[36:39]
    s_waitcnt lgkmcnt(4)
    v_mfma_f32_16x16x32_bf16 v[16:19], a[120:123], v[48:51], v[16:19]
    ds_read_b128 v[44:47], v9 offset:24832
    v_mfma_f32_16x16x32_bf16 v[20:23], a[124:127], v[48:51], v[20:23]
    v_mfma_f32_16x16x32_bf16 v[24:27], a[128:131], v[48:51], v[24:27]
    s_waitcnt lgkmcnt(4)
    v_mfma_f32_16x16x32_bf16 v[28:31], a[120:123], v[52:55], v[28:31]
    ds_read_b128 v[48:51], v9 offset:26624
    v_mfma_f32_16x16x32_bf16 v[32:35], a[124:127], v[52:55], v[32:35]
    v_mfma_f32_16x16x32_bf16 v[36:39], a[128:131], v[52:55], v[36:39]
    s_waitcnt lgkmcnt(4)
    v_mfma_f32_16x16x32_bf16 v[16:19], a[132:135], v[56:59], v[16:19]
    ds_read_b128 v[52:55], v9 offset:26880
    v_mfma_f32_16x16x32_bf16 v[20:23], a[136:139], v[56:59], v[20:23]
    v_mfma_f32_16x16x32_bf16 v[24:27], a[140:143], v[56:59], v[24:27]
    s_waitcnt lgkmcnt(4)
    v_mfma_f32_16x16x32_bf16 v[28:31], a[132:135], v[60:63], v[28:31]
    ds_read_b128 v[56:59], v9 offset:28672
    v_mfma_f32_16x16x32_bf16 v[32:35], a[136:139], v[60:63], v[32:35]
    v_mfma_f32_16x16x32_bf16 v[36:39], a[140:143], v[60:63], v[36:39]
    s_waitcnt lgkmcnt(4)
    v_mfma_f32_16x16x32_bf16 v[16:19], a[144:147], v[40:43], v[16:19]
    ds_read_b128 v[60:63], v9 offset:28928
    v_mfma_f32_16x16x32_bf16 v[20:23], a[148:151], v[40:43], v[20:23]
    v_mfma_f32_16x16x32_bf16 v[24:27], a[152:155], v[40:43], v[24:27]
    s_waitcnt lgkmcnt(4)
    v_mfma_f32_16x16x32_bf16 v[28:31], a[144:147], v[44:47], v[28:31]
    ds_read_b128 v[40:43], v9 offset:30720
    v_mfma_f32_16x16x32_bf16 v[32:35], a[148:151], v[44:47], v[32:35]
    v_mfma_f32_16x16x32_bf16 v[36:39], a[152:155], v[44:47], v[36:39]
    s_waitcnt lgkmcnt(4)
    v_mfma_f32_16x16x32_bf16 v[16:19], a[156:159], v[48:51], v[16:19]
    ds_read_b128 v[44:47], v9 offset:30976
    v_mfma_f32_16x16x32_bf16 v[20:23], a[160:163], v[48:51], v[20:23]
    v_mfma_f32_16x16x32_bf16 v[24:27], a[164:167], v[48:51], v[24:27]
    s_waitcnt lgkmcnt(4)
    v_mfma_f32_16x16x32_bf16 v[28:31], a[156:159], v[52:55], v[28:31]
    ds_read_b128 v[48:51], v9 offset:32768
    v_mfma_f32_16x16x32_bf16 v[32:35], a[160:163], v[52:55], v[32:35]
    v_mfma_f32_16x16x32_bf16 v[36:39], a[164:167], v[52:55], v[36:39]
    s_waitcnt lgkmcnt(4)
    v_mfma_f32_16x16x32_bf16 v[16:19], a[168:171], v[56:59], v[16:19]
    ds_read_b128 v[52:55], v9 offset:33024
    v_mfma_f32_16x16x32_bf16 v[20:23], a[172:175], v[56:59], v[20:23]
    v_mfma_f32_16x16x32_bf16 v[24:27], a[176:179], v[56:59], v[24:27]
    s_waitcnt lgkmcnt(4)
    v_mfma_f32_16x16x32_bf16 v[28:31], a[168:171], v[60:63], v[28:31]
    v_cmp_eq_u32 s[76:77], 1, v2
    v_cmp_eq_u32 vcc, 2, v2
    ds_read_b128 v[56:59], v9 offset:34816
    v_mfma_f32_16x16x32_bf16 v[32:35], a[172:175], v[60:63], v[32:35]
    s_cmp_eq_u64 s[76:77], -1
    s_cselect_b32 s38, 1, 0
    v_mfma_f32_16x16x32_bf16 v[36:39], a[176:179], v[60:63], v[36:39]
    s_cmp_lg_u32 s38, 0
    s_cselect_b64 exec, 1, 0
    v_mov_b32 v15, s32
    ds_write_b32 v184, v15
    v_mov_b32 v2, 2
    s_mov_b64 exec, -1
    s_waitcnt lgkmcnt(5)
    v_mfma_f32_16x16x32_bf16 v[16:19], a[180:183], v[40:43], v[16:19]
    ds_read_b128 v[60:63], v9 offset:35072
    v_mfma_f32_16x16x32_bf16 v[20:23], a[184:187], v[40:43], v[20:23]
    s_add_u32 s32, s32, s38
    s_mul_i32 s38, s38, 22528
    s_add_u32 s33, s33, s38
    v_mfma_f32_16x16x32_bf16 v[24:27], a[188:191], v[40:43], v[24:27]
    s_cmp_eq_u64 vcc, 0
    s_cselect_b32 s38, s32, 0x7fff
    s_waitcnt lgkmcnt(5)
    v_mfma_f32_16x16x32_bf16 v[28:31], a[180:183], v[44:47], v[28:31]
    s_cmp_le_u32 s38, s39
    s_cselect_b64 exec, -1, 0
    v_mov_b32 v2, 2
    buffer_load_dword v2, v1, s[8:11], s33 offen sc1
    s_mov_b64 exec, -1
    v_mfma_f32_16x16x32_bf16 v[32:35], a[184:187], v[44:47], v[32:35]
    v_mfma_f32_16x16x32_bf16 v[36:39], a[188:191], v[44:47], v[36:39]
    s_waitcnt lgkmcnt(4)
    v_mfma_f32_16x16x32_bf16 v[16:19], a[192:195], v[48:51], v[16:19]
    v_mfma_f32_16x16x32_bf16 v[20:23], a[196:199], v[48:51], v[20:23]
    v_mfma_f32_16x16x32_bf16 v[24:27], a[200:203], v[48:51], v[24:27]
    s_waitcnt lgkmcnt(3)
    v_mfma_f32_16x16x32_bf16 v[28:31], a[192:195], v[52:55], v[28:31]
    v_mfma_f32_16x16x32_bf16 v[32:35], a[196:199], v[52:55], v[32:35]
    v_mfma_f32_16x16x32_bf16 v[36:39], a[200:203], v[52:55], v[36:39]
    s_waitcnt lgkmcnt(2)
    v_mfma_f32_16x16x32_bf16 v[16:19], a[204:207], v[56:59], v[16:19]
    v_mfma_f32_16x16x32_bf16 v[20:23], a[208:211], v[56:59], v[20:23]
    v_mfma_f32_16x16x32_bf16 v[24:27], a[212:215], v[56:59], v[24:27]
    s_waitcnt lgkmcnt(0)
    v_mfma_f32_16x16x32_bf16 v[28:31], a[204:207], v[60:63], v[28:31]
    v_mfma_f32_16x16x32_bf16 v[32:35], a[208:211], v[60:63], v[32:35]
    v_mfma_f32_16x16x32_bf16 v[36:39], a[212:215], v[60:63], v[36:39]
    v_mov_b32 v88, 0x3f803f80
    v_cvt_pk_bf16_f32 v96, v16, v17
    v_cvt_pk_bf16_f32 v97, v18, v19
    v_cvt_pk_bf16_f32 v98, v20, v21
    v_cvt_pk_bf16_f32 v99, v22, v23
    v_cvt_pk_bf16_f32 v100, v24, v25
    v_cvt_pk_bf16_f32 v101, v26, v27
    buffer_store_dwordx4 v[96:99], v10, s[8:11], s46 offen offset:0 sc1
    buffer_store_dwordx2 v[100:101], v12, s[8:11], s46 offen offset:0 sc1
    v_cvt_pk_bf16_f32 v104, v28, v29
    v_cvt_pk_bf16_f32 v105, v30, v31
    v_cvt_pk_bf16_f32 v106, v32, v33
    v_cvt_pk_bf16_f32 v107, v34, v35
    v_cvt_pk_bf16_f32 v108, v36, v37
    v_cvt_pk_bf16_f32 v109, v38, v39
    buffer_store_dwordx4 v[104:107], v10, s[8:11], s46 offen offset:256 sc1
    buffer_store_dwordx2 v[108:109], v12, s[8:11], s46 offen offset:256 sc1
    v_mov_b32 v80, 0
    v_mov_b32 v81, 0
    v_mov_b32 v84, 0
    v_mov_b32 v85, 0
    v_dot2c_f32_bf16 v80, v96, v88
    v_dot2c_f32_bf16 v81, v96, v96
    v_dot2c_f32_bf16 v84, v104, v88
    v_dot2c_f32_bf16 v85, v104, v104
    v_dot2c_f32_bf16 v80, v97, v88
    v_dot2c_f32_bf16 v81, v97, v97
    v_dot2c_f32_bf16 v84, v105, v88
    v_dot2c_f32_bf16 v85, v105, v105
    v_dot2c_f32_bf16 v80, v98, v88
    v_dot2c_f32_bf16 v81, v98, v98
    v_dot2c_f32_bf16 v84, v106, v88
    v_dot2c_f32_bf16 v85, v106, v106
    v_dot2c_f32_bf16 v80, v99, v88
    v_dot2c_f32_bf16 v81, v99, v99
    v_dot2c_f32_bf16 v84, v107, v88
    v_dot2c_f32_bf16 v85, v107, v107
    v_dot2c_f32_bf16 v80, v100, v88
    v_dot2c_f32_bf16 v81, v100, v100
    v_dot2c_f32_bf16 v84, v108, v88
    v_dot2c_f32_bf16 v85, v108, v108
    v_dot2c_f32_bf16 v80, v101, v88
    v_dot2c_f32_bf16 v81, v101, v101
    v_dot2c_f32_bf16 v84, v109, v88
    v_dot2c_f32_bf16 v85, v109, v109
    s_nop 2
    v_mov_b32 v82, v80
    v_mov_b32 v83, v81
    v_mov_b32 v86, v84
    v_mov_b32 v87, v85
    v_permlane32_swap_b32 v80, v82
    v_permlane32_swap_b32 v81, v83
    v_permlane32_swap_b32 v84, v86
    v_permlane32_swap_b32 v85, v87
    v_add_f32 v80, v80, v82
    v_add_f32 v81, v81, v83
    v_add_f32 v84, v84, v86
    v_add_f32 v85, v85, v87
    v_mov_b32 v82, v80
    v_mov_b32 v83, v81
    v_mov_b32 v86, v84
    v_mov_b32 v87, v85
    v_permlane16_swap_b32 v80, v82
    v_permlane16_swap_b32 v81, v83
    v_permlane16_swap_b32 v84, v86
    v_permlane16_swap_b32 v85, v87
    v_add_f32 v80, v80, v82
    v_add_f32 v81, v81, v83
    v_add_f32 v84, v84, v86
    v_add_f32 v85, v85, v87
    s_mov_b64 exec, 0xffff
    buffer_store_dwordx2 v[80:81], v11, s[8:11], s52 offen offset:0 sc1
    buffer_store_dwordx2 v[84:85], v11, s[8:11], s52 offen offset:256 sc1
    s_mov_b64 exec, -1
    s_mul_i32 s43, s57, 22528
    s_add_u32 s43, s43, s49
    s_branch Lawo_none
Lawo_f_5:
    s_waitcnt lgkmcnt(4)
    v_mfma_f32_16x16x32_bf16 v[16:19], a[12:15], v[48:51], v[16:19]
    ds_read_b128 v[44:47], v9 offset:6400
    v_mfma_f32_16x16x32_bf16 v[20:23], a[16:19], v[48:51], v[20:23]
    s_add_u32 s46, s46, s51
    v_mfma_f32_16x16x32_bf16 v[24:27], a[20:23], v[48:51], v[24:27]
    s_add_u32 m0, s59, 0
    s_add_u32 s47, s41, 0
    buffer_load_dwordx4 v0, s[8:11], s47 offen offset:0 lds
    s_waitcnt lgkmcnt(4)
    v_mfma_f32_16x16x32_bf16 v[28:31], a[12:15], v[52:55], v[28:31]
    buffer_load_dwordx4 v0, s[8:11], s47 offen offset:1024 lds
    ds_read_b128 v[48:51], v9 offset:8192
    v_mfma_f32_16x16x32_bf16 v[32:35], a[16:19], v[52:55], v[32:35]
    s_add_u32 s46, s46, 8650752
    v_mfma_f32_16x16x32_bf16 v[36:39], a[20:23], v[52:55], v[36:39]
    s_waitcnt lgkmcnt(4)
    v_mfma_f32_16x16x32_bf16 v[16:19], a[24:27], v[56:59], v[16:19]
    buffer_load_dwordx4 v0, s[8:11], s47 offen offset:2048 lds
    ds_read_b128 v[52:55], v9 offset:8448
    v_mfma_f32_16x16x32_bf16 v[20:23], a[28:31], v[56:59], v[20:23]
    s_mul_i32 s52, s34, 786432
    v_mfma_f32_16x16x32_bf16 v[24:27], a[32:35], v[56:59], v[24:27]
    s_waitcnt lgkmcnt(4)
    v_mfma_f32_16x16x32_bf16 v[28:31], a[24:27], v[60:63], v[28:31]
    buffer_load_dwordx4 v0, s[8:11], s47 offen offset:3072 lds
    ds_read_b128 v[56:59], v9 offset:10240
    v_mfma_f32_16x16x32_bf16 v[32:35], a[28:31], v[60:63], v[32:35]
    s_mul_i32 s51, s35, 6144
    v_mfma_f32_16x16x32_bf16 v[36:39], a[32:35], v[60:63], v[36:39]
    s_waitcnt lgkmcnt(4)
    v_mfma_f32_16x16x32_bf16 v[16:19], a[36:39], v[40:43], v[16:19]
    ds_read_b128 v[60:63], v9 offset:10496
    v_mfma_f32_16x16x32_bf16 v[20:23], a[40:43], v[40:43], v[20:23]
    s_add_u32 s52, s52, s51
    v_mfma_f32_16x16x32_bf16 v[24:27], a[44:47], v[40:43], v[24:27]
    s_add_u32 m0, s59, 4096
    s_add_u32 s47, s41, 4096
    buffer_load_dwordx4 v0, s[8:11], s47 offen offset:0 lds
    s_waitcnt lgkmcnt(4)
    v_mfma_f32_16x16x32_bf16 v[28:31], a[36:39], v[44:47], v[28:31]
    buffer_load_dwordx4 v0, s[8:11], s47 offen offset:1024 lds
    ds_read_b128 v[40:43], v9 offset:12288
    v_mfma_f32_16x16x32_bf16 v[32:35], a[40:43], v[44:47], v[32:35]
    s_add_u32 s52, s52, 16121856
    v_mfma_f32_16x16x32_bf16 v[36:39], a[44:47], v[44:47], v[36:39]
    s_waitcnt lgkmcnt(4)
    v_mfma_f32_16x16x32_bf16 v[16:19], a[48:51], v[48:51], v[16:19]
    buffer_load_dwordx4 v0, s[8:11], s47 offen offset:2048 lds
    ds_read_b128 v[44:47], v9 offset:12544
    v_mfma_f32_16x16x32_bf16 v[20:23], a[52:55], v[48:51], v[20:23]
    v_mfma_f32_16x16x32_bf16 v[24:27], a[56:59], v[48:51], v[24:27]
    s_waitcnt lgkmcnt(4)
    v_mfma_f32_16x16x32_bf16 v[28:31], a[48:51], v[52:55], v[28:31]
    buffer_load_dwordx4 v0, s[8:11], s47 offen offset:3072 lds
    ds_read_b128 v[48:51], v9 offset:14336
    v_mfma_f32_16x16x32_bf16 v[32:35], a[52:55], v[52:55], v[32:35]
    v_mfma_f32_16x16x32_bf16 v[36:39], a[56:59], v[52:55], v[36:39]
    s_waitcnt lgkmcnt(4)
    v_mfma_f32_16x16x32_bf16 v[16:19], a[60:63], v[56:59], v[16:19]
    ds_read_b128 v[52:55], v9 offset:14592
    v_mfma_f32_16x16x32_bf16 v[20:23], a[64:67], v[56:59], v[20:23]
    s_add_u32 m0, s59, 8192
    s_add_u32 s47, s41, 8192
    buffer_load_dwordx4 v0, s[8:11], s47 offen offset:0 lds
    v_mfma_f32_16x16x32_bf16 v[24:27], a[68:71], v[56:59], v[24:27]
    s_waitcnt lgkmcnt(4)
    v_mfma_f32_16x16x32_bf16 v[28:31], a[60:63], v[60:63], v[28:31]
    s_mul_i32 s48, s36, 4718592
    s_mul_i32 s18, s37, 36864
    s_add_u32 s48, s48, s18
    s_add_u32 s48, s48, 6291456
    buffer_load_dwordx4 v[64:67], v10, s[8:11], s48 offen offset:0
    ds_read_b128 v[56:59], v9 offset:16384
    v_mfma_f32_16x16x32_bf16 v[32:35], a[64:67], v[60:63], v[32:35]
    v_cmp_eq_u32 s[76:77], 1, v2
    v_cmp_eq_u32 vcc, 2, v2
    v_mfma_f32_16x16x32_bf16 v[36:39], a[68:71], v[60:63], v[36:39]
    s_cmp_eq_u64 s[76:77], -1
    s_cselect_b32 s38, 1, 0
    s_waitcnt lgkmcnt(4)
    v_mfma_f32_16x16x32_bf16 v[16:19], a[72:75], v[40:43], v[16:19]
    s_cmp_lg_u32 s38, 0
    s_cselect_b64 exec, 1, 0
    v_mov_b32 v15, s32
    ds_write_b32 v184, v15
    v_mov_b32 v2, 2
    s_mov_b64 exec, -1
    ds_read_b128 v[60:63], v9 offset:16640
    v_mfma_f32_16x16x32_bf16 v[20:23], a[76:79], v[40:43], v[20:23]
    s_add_u32 s32, s32, s38
    s_mul_i32 s38, s38, 22528
    s_add_u32 s33, s33, s38
    v_mfma_f32_16x16x32_bf16 v[24:27], a[80:83], v[40:43], v[24:27]
    s_cmp_eq_u64 vcc, 0
    s_cselect_b32 s38, s32, 0x7fff
    s_waitcnt lgkmcnt(5)
    v_mfma_f32_16x16x32_bf16 v[28:31], a[72:75], v[44:47], v[28:31]
    s_cmp_le_u32 s38, s39
    s_cselect_b64 exec, -1, 0
    v_mov_b32 v2, 2
    buffer_load_dword v2, v1, s[8:11], s33 offen sc1
    s_mov_b64 exec, -1
    ds_read_b128 v[40:43], v9 offset:18432
    v_mfma_f32_16x16x32_bf16 v[32:35], a[76:79], v[44:47], v[32:35]
    buffer_load_dwordx2 v[68:69], v12, s[8:11], s48 offen offset:0
    buffer_load_dwordx4 v[72:75], v10, s[8:11], s48 offen offset:256
    v_mfma_f32_16x16x32_bf16 v[36:39], a[80:83], v[44:47], v[36:39]
    s_waitcnt lgkmcnt(5)
    v_mfma_f32_16x16x32_bf16 v[16:19], a[84:87], v[48:51], v[16:19]
    buffer_load_dwordx2 v[76:77], v12, s[8:11], s48 offen offset:256
    ds_read_b128 v[44:47], v9 offset:18688
    v_mfma_f32_16x16x32_bf16 v[20:23], a[88:91], v[48:51], v[20:23]
    v_mfma_f32_16x16x32_bf16 v[24:27], a[92:95], v[48:51], v[24:27]
    s_waitcnt lgkmcnt(5)
    v_mfma_f32_16x16x32_bf16 v[28:31], a[84:87], v[52:55], v[28:31]
    ds_read_b128 v[48:51], v9 offset:20480
    v_mfma_f32_16x16x32_bf16 v[32:35], a[88:91], v[52:55], v[32:35]
    v_mfma_f32_16x16x32_bf16 v[36:39], a[92:95], v[52:55], v[36:39]
    s_waitcnt lgkmcnt(5)
    v_mfma_f32_16x16x32_bf16 v[16:19], a[96:99], v[56:59], v[16:19]
    ds_read_b128 v[52:55], v9 offset:20736
    v_mfma_f32_16x16x32_bf16 v[20:23], a[100:103], v[56:59], v[20:23]
    v_mfma_f32_16x16x32_bf16 v[24:27], a[104:107], v[56:59], v[24:27]
    s_waitcnt lgkmcnt(4)
    v_mfma_f32_16x16x32_bf16 v[28:31], a[96:99], v[60:63], v[28:31]
    ds_read_b128 v[56:59], v9 offset:22528
    v_mfma_f32_16x16x32_bf16 v[32:35], a[100:103], v[60:63], v[32:35]
    v_mfma_f32_16x16x32_bf16 v[36:39], a[104:107], v[60:63], v[36:39]
    s_waitcnt vmcnt(15)
    s_cmp_lg_u32 s43, 0
    s_cselect_b64 exec, 1, 0
    buffer_store_dword v3, v4, s[8:11], s43 offen sc1
    s_mov_b64 exec, -1
    s_mov_b32 s43, 0
    s_waitcnt lgkmcnt(4)
    v_mfma_f32_16x16x32_bf16 v[16:19], a[108:111], v[40:43], v[16:19]
    ds_read_b128 v[60:63], v9 offset:22784
    v_mfma_f32_16x16x32_bf16 v[20:23], a[112:115], v[40:43], v[20:23]
    v_mfma_f32_16x16x32_bf16 v[24:27], a[116:119], v[40:43], v[24:27]
    s_waitcnt lgkmcnt(4)
    v_mfma_f32_16x16x32_bf16 v[28:31], a[108:111], v[44:47], v[28:31]
    ds_read_b128 v[40:43], v9 offset:24576
    v_mfma_f32_16x16x32_bf16 v[32:35], a[112:115], v[44:47], v[32:35]
    v_mfma_f32_16x16x32_bf16 v[36:39], a[116:119], v[44:47], v[36:39]
    s_waitcnt lgkmcnt(4)
    v_mfma_f32_16x16x32_bf16 v[16:19], a[120:123], v[48:51], v[16:19]
    ds_read_b128 v[44:47], v9 offset:24832
    v_mfma_f32_16x16x32_bf16 v[20:23], a[124:127], v[48:51], v[20:23]
    v_mfma_f32_16x16x32_bf16 v[24:27], a[128:131], v[48:51], v[24:27]
    s_waitcnt lgkmcnt(4)
    v_mfma_f32_16x16x32_bf16 v[28:31], a[120:123], v[52:55], v[28:31]
    ds_read_b128 v[48:51], v9 offset:26624
    v_mfma_f32_16x16x32_bf16 v[32:35], a[124:127], v[52:55], v[32:35]
    v_mfma_f32_16x16x32_bf16 v[36:39], a[128:131], v[52:55], v[36:39]
    s_waitcnt lgkmcnt(4)
    v_mfma_f32_16x16x32_bf16 v[16:19], a[132:135], v[56:59], v[16:19]
    ds_read_b128 v[52:55], v9 offset:26880
    v_mfma_f32_16x16x32_bf16 v[20:23], a[136:139], v[56:59], v[20:23]
    v_mfma_f32_16x16x32_bf16 v[24:27], a[140:143], v[56:59], v[24:27]
    s_waitcnt lgkmcnt(4)
    v_mfma_f32_16x16x32_bf16 v[28:31], a[132:135], v[60:63], v[28:31]
    ds_read_b128 v[56:59], v9 offset:28672
    v_mfma_f32_16x16x32_bf16 v[32:35], a[136:139], v[60:63], v[32:35]
    v_mfma_f32_16x16x32_bf16 v[36:39], a[140:143], v[60:63], v[36:39]
    s_waitcnt lgkmcnt(4)
    v_mfma_f32_16x16x32_bf16 v[16:19], a[144:147], v[40:43], v[16:19]
    ds_read_b128 v[60:63], v9 offset:28928
    v_mfma_f32_16x16x32_bf16 v[20:23], a[148:151], v[40:43], v[20:23]
    v_mfma_f32_16x16x32_bf16 v[24:27], a[152:155], v[40:43], v[24:27]
    s_waitcnt lgkmcnt(4)
    v_mfma_f32_16x16x32_bf16 v[28:31], a[144:147], v[44:47], v[28:31]
    ds_read_b128 v[40:43], v9 offset:30720
    v_mfma_f32_16x16x32_bf16 v[32:35], a[148:151], v[44:47], v[32:35]
    v_mfma_f32_16x16x32_bf16 v[36:39], a[152:155], v[44:47], v[36:39]
    s_waitcnt lgkmcnt(4)
    v_mfma_f32_16x16x32_bf16 v[16:19], a[156:159], v[48:51], v[16:19]
    ds_read_b128 v[44:47], v9 offset:30976
    v_mfma_f32_16x16x32_bf16 v[20:23], a[160:163], v[48:51], v[20:23]
    v_mfma_f32_16x16x32_bf16 v[24:27], a[164:167], v[48:51], v[24:27]
    s_waitcnt lgkmcnt(4)
    v_mfma_f32_16x16x32_bf16 v[28:31], a[156:159], v[52:55], v[28:31]
    ds_read_b128 v[48:51], v9 offset:32768
    v_mfma_f32_16x16x32_bf16 v[32:35], a[160:163], v[52:55], v[32:35]
    v_mfma_f32_16x16x32_bf16 v[36:39], a[164:167], v[52:55], v[36:39]
    s_waitcnt lgkmcnt(4)
    v_mfma_f32_16x16x32_bf16 v[16:19], a[168:171], v[56:59], v[16:19]
    ds_read_b128 v[52:55], v9 offset:33024
    v_mfma_f32_16x16x32_bf16 v[20:23], a[172:175], v[56:59], v[20:23]
    v_mfma_f32_16x16x32_bf16 v[24:27], a[176:179], v[56:59], v[24:27]
    s_waitcnt lgkmcnt(4)
    v_mfma_f32_16x16x32_bf16 v[28:31], a[168:171], v[60:63], v[28:31]
    v_cmp_eq_u32 s[76:77], 1, v2
    v_cmp_eq_u32 vcc, 2, v2
    ds_read_b128 v[56:59], v9 offset:34816
    v_mfma_f32_16x16x32_bf16 v[32:35], a[172:175], v[60:63], v[32:35]
    s_cmp_eq_u64 s[76:77], -1
    s_cselect_b32 s38, 1, 0
    v_mfma_f32_16x16x32_bf16 v[36:39], a[176:179], v[60:63], v[36:39]
    s_cmp_lg_u32 s38, 0
    s_cselect_b64 exec, 1, 0
    v_mov_b32 v15, s32
    ds_write_b32 v184, v15
    v_mov_b32 v2, 2
    s_mov_b64 exec, -1
    s_waitcnt lgkmcnt(5)
    v_mfma_f32_16x16x32_bf16 v[16:19], a[180:183], v[40:43], v[16:19]
    ds_read_b128 v[60:63], v9 offset:35072
    v_mfma_f32_16x16x32_bf16 v[20:23], a[184:187], v[40:43], v[20:23]
    s_add_u32 s32, s32, s38
    s_mul_i32 s38, s38, 22528
    s_add_u32 s33, s33, s38
    v_mfma_f32_16x16x32_bf16 v[24:27], a[188:191], v[40:43], v[24:27]
    s_cmp_eq_u64 vcc, 0
    s_cselect_b32 s38, s32, 0x7fff
    s_waitcnt lgkmcnt(5)
    v_mfma_f32_16x16x32_bf16 v[28:31], a[180:183], v[44:47], v[28:31]
    s_cmp_le_u32 s38, s39
    s_cselect_b64 exec, -1, 0
    v_mov_b32 v2, 2
    buffer_load_dword v2, v1, s[8:11], s33 offen sc1
    s_mov_b64 exec, -1
    v_mfma_f32_16x16x32_bf16 v[32:35], a[184:187], v[44:47], v[32:35]
    v_mfma_f32_16x16x32_bf16 v[36:39], a[188:191], v[44:47], v[36:39]
    s_waitcnt lgkmcnt(4)
    v_mfma_f32_16x16x32_bf16 v[16:19], a[192:195], v[48:51], v[16:19]
    v_mfma_f32_16x16x32_bf16 v[20:23], a[196:199], v[48:51], v[20:23]
    v_mfma_f32_16x16x32_bf16 v[24:27], a[200:203], v[48:51], v[24:27]
    s_waitcnt lgkmcnt(3)
    v_mfma_f32_16x16x32_bf16 v[28:31], a[192:195], v[52:55], v[28:31]
    v_mfma_f32_16x16x32_bf16 v[32:35], a[196:199], v[52:55], v[32:35]
    v_mfma_f32_16x16x32_bf16 v[36:39], a[200:203], v[52:55], v[36:39]
    s_waitcnt lgkmcnt(2)
    v_mfma_f32_16x16x32_bf16 v[16:19], a[204:207], v[56:59], v[16:19]
    v_mfma_f32_16x16x32_bf16 v[20:23], a[208:211], v[56:59], v[20:23]
    v_mfma_f32_16x16x32_bf16 v[24:27], a[212:215], v[56:59], v[24:27]
    s_waitcnt lgkmcnt(0)
    v_mfma_f32_16x16x32_bf16 v[28:31], a[204:207], v[60:63], v[28:31]
    v_mfma_f32_16x16x32_bf16 v[32:35], a[208:211], v[60:63], v[32:35]
    v_mfma_f32_16x16x32_bf16 v[36:39], a[212:215], v[60:63], v[36:39]
    v_mov_b32 v88, 0x3f803f80
    v_cvt_pk_bf16_f32 v96, v16, v17
    v_cvt_pk_bf16_f32 v97, v18, v19
    v_cvt_pk_bf16_f32 v98, v20, v21
    v_cvt_pk_bf16_f32 v99, v22, v23
    v_cvt_pk_bf16_f32 v100, v24, v25
    v_cvt_pk_bf16_f32 v101, v26, v27
    buffer_store_dwordx4 v[96:99], v10, s[8:11], s46 offen offset:0 sc1
    buffer_store_dwordx2 v[100:101], v12, s[8:11], s46 offen offset:0 sc1
    v_cvt_pk_bf16_f32 v104, v28, v29
    v_cvt_pk_bf16_f32 v105, v30, v31
    v_cvt_pk_bf16_f32 v106, v32, v33
    v_cvt_pk_bf16_f32 v107, v34, v35
    v_cvt_pk_bf16_f32 v108, v36, v37
    v_cvt_pk_bf16_f32 v109, v38, v39
    buffer_store_dwordx4 v[104:107], v10, s[8:11], s46 offen offset:256 sc1
    buffer_store_dwordx2 v[108:109], v12, s[8:11], s46 offen offset:256 sc1
    v_mov_b32 v80, 0
    v_mov_b32 v81, 0
    v_mov_b32 v84, 0
    v_mov_b32 v85, 0
    v_dot2c_f32_bf16 v80, v96, v88
    v_dot2c_f32_bf16 v81, v96, v96
    v_dot2c_f32_bf16 v84, v104, v88
    v_dot2c_f32_bf16 v85, v104, v104
    v_dot2c_f32_bf16 v80, v97, v88
    v_dot2c_f32_bf16 v81, v97, v97
    v_dot2c_f32_bf16 v84, v105, v88
    v_dot2c_f32_bf16 v85, v105, v105
    v_dot2c_f32_bf16 v80, v98, v88
    v_dot2c_f32_bf16 v81, v98, v98
    v_dot2c_f32_bf16 v84, v106, v88
    v_dot2c_f32_bf16 v85, v106, v106
    v_dot2c_f32_bf16 v80, v99, v88
    v_dot2c_f32_bf16 v81, v99, v99
    v_dot2c_f32_bf16 v84, v107, v88
    v_dot2c_f32_bf16 v85, v107, v107
    v_dot2c_f32_bf16 v80, v100, v88
    v_dot2c_f32_bf16 v81, v100, v100
    v_dot2c_f32_bf16 v84, v108, v88
    v_dot2c_f32_bf16 v85, v108, v108
    v_dot2c_f32_bf16 v80, v101, v88
    v_dot2c_f32_bf16 v81, v101, v101
    v_dot2c_f32_bf16 v84, v109, v88
    v_dot2c_f32_bf16 v85, v109, v109
    s_nop 2
    v_mov_b32 v82, v80
    v_mov_b32 v83, v81
    v_mov_b32 v86, v84
    v_mov_b32 v87, v85
    v_permlane32_swap_b32 v80, v82
    v_permlane32_swap_b32 v81, v83
    v_permlane32_swap_b32 v84, v86
    v_permlane32_swap_b32 v85, v87
    v_add_f32 v80, v80, v82
    v_add_f32 v81, v81, v83
    v_add_f32 v84, v84, v86
    v_add_f32 v85, v85, v87
    v_mov_b32 v82, v80
    v_mov_b32 v83, v81
    v_mov_b32 v86, v84
    v_mov_b32 v87, v85
    v_permlane16_swap_b32 v80, v82
    v_permlane16_swap_b32 v81, v83
    v_permlane16_swap_b32 v84, v86
    v_permlane16_swap_b32 v85, v87
    v_add_f32 v80, v80, v82
    v_add_f32 v81, v81, v83
    v_add_f32 v84, v84, v86
    v_add_f32 v85, v85, v87
    s_mov_b64 exec, 0xffff
    buffer_store_dwordx2 v[80:81], v11, s[8:11], s52 offen offset:0 sc1
    buffer_store_dwordx2 v[84:85], v11, s[8:11], s52 offen offset:256 sc1
    s_mov_b64 exec, -1
    s_mul_i32 s43, s57, 22528
    s_add_u32 s43, s43, s49
    s_branch Lawo_head
Lawo_f_6:
    v_mfma_f32_16x16x32_bf16 v[16:19], a[96:99], v[56:59], v[16:19]
    ds_read_b128 v[52:55], v9 offset:20736
    v_mfma_f32_16x16x32_bf16 v[20:23], a[100:103], v[56:59], v[20:23]
    s_add_u32 m0, s59, 0
    s_add_u32 s47, s41, 0
    buffer_load_dwordx4 v0, s[8:11], s47 offen offset:0 lds
    v_mfma_f32_16x16x32_bf16 v[24:27], a[104:107], v[56:59], v[24:27]
    v_mfma_f32_16x16x32_bf16 v[28:31], a[96:99], v[60:63], v[28:31]
    buffer_load_dwordx4 v0, s[8:11], s47 offen offset:1024 lds
    ds_read_b128 v[56:59], v9 offset:22528
    v_mfma_f32_16x16x32_bf16 v[32:35], a[100:103], v[60:63], v[32:35]
    v_mfma_f32_16x16x32_bf16 v[36:39], a[104:107], v[60:63], v[36:39]
    s_waitcnt vmcnt(4)
    s_cmp_lg_u32 s43, 0
    s_cselect_b64 exec, 1, 0
    buffer_store_dword v3, v4, s[8:11], s43 offen sc1
    s_mov_b64 exec, -1
    s_mov_b32 s43, 0
    v_mfma_f32_16x16x32_bf16 v[16:19], a[108:111], v[40:43], v[16:19]
    buffer_load_dwordx4 v0, s[8:11], s47 offen offset:2048 lds
    ds_read_b128 v[60:63], v9 offset:22784
    v_mfma_f32_16x16x32_bf16 v[20:23], a[112:115], v[40:43], v[20:23]
    v_mfma_f32_16x16x32_bf16 v[24:27], a[116:119], v[40:43], v[24:27]
    s_waitcnt lgkmcnt(4)
    v_mfma_f32_16x16x32_bf16 v[28:31], a[108:111], v[44:47], v[28:31]
    buffer_load_dwordx4 v0, s[8:11], s47 offen offset:3072 lds
    ds_read_b128 v[40:43], v9 offset:24576
    v_mfma_f32_16x16x32_bf16 v[32:35], a[112:115], v[44:47], v[32:35]
    v_mfma_f32_16x16x32_bf16 v[36:39], a[116:119], v[44:47], v[36:39]
    s_waitcnt lgkmcnt(4)
    v_mfma_f32_16x16x32_bf16 v[16:19], a[120:123], v[48:51], v[16:19]
    ds_read_b128 v[44:47], v9 offset:24832
    v_mfma_f32_16x16x32_bf16 v[20:23], a[124:127], v[48:51], v[20:23]
    s_add_u32 m0, s59, 4096
    s_add_u32 s47, s41, 4096
    buffer_load_dwordx4 v0, s[8:11], s47 offen offset:0 lds
    v_mfma_f32_16x16x32_bf16 v[24:27], a[128:131], v[48:51], v[24:27]
    s_waitcnt lgkmcnt(4)
    v_mfma_f32_16x16x32_bf16 v[28:31], a[120:123], v[52:55], v[28:31]
    buffer_load_dwordx4 v0, s[8:11], s47 offen offset:1024 lds
    ds_read_b128 v[48:51], v9 offset:26624
    v_mfma_f32_16x16x32_bf16 v[32:35], a[124:127], v[52:55], v[32:35]
    v_mfma_f32_16x16x32_bf16 v[36:39], a[128:131], v[52:55], v[36:39]
    s_waitcnt lgkmcnt(4)
    v_mfma_f32_16x16x32_bf16 v[16:19], a[132:135], v[56:59], v[16:19]
    buffer_load_dwordx4 v0, s[8:11], s47 offen offset:2048 lds
    ds_read_b128 v[52:55], v9 offset:26880
    v_mfma_f32_16x16x32_bf16 v[20:23], a[136:139], v[56:59], v[20:23]
    v_mfma_f32_16x16x32_bf16 v[24:27], a[140:143], v[56:59], v[24:27]
    s_waitcnt lgkmcnt(4)
    v_mfma_f32_16x16x32_bf16 v[28:31], a[132:135], v[60:63], v[28:31]
    buffer_load_dwordx4 v0, s[8:11], s47 offen offset:3072 lds
    ds_read_b128 v[56:59], v9 offset:28672
    v_mfma_f32_16x16x32_bf16 v[32:35], a[136:139], v[60:63], v[32:35]
    v_mfma_f32_16x16x32_bf16 v[36:39], a[140:143], v[60:63], v[36:39]
    s_waitcnt lgkmcnt(4)
    v_mfma_f32_16x16x32_bf16 v[16:19], a[144:147], v[40:43], v[16:19]
    ds_read_b128 v[60:63], v9 offset:28928
    v_mfma_f32_16x16x32_bf16 v[20:23], a[148:151], v[40:43], v[20:23]
    s_add_u32 m0, s59, 8192
    s_add_u32 s47, s41, 8192
    buffer_load_dwordx4 v0, s[8:11], s47 offen offset:0 lds
    v_mfma_f32_16x16x32_bf16 v[24:27], a[152:155], v[40:43], v[24:27]
    s_waitcnt lgkmcnt(4)
    v_mfma_f32_16x16x32_bf16 v[28:31], a[144:147], v[44:47], v[28:31]
    s_mul_i32 s48, s36, 4718592
    s_mul_i32 s18, s37, 36864
    s_add_u32 s48, s48, s18
    s_add_u32 s48, s48, 6291456
    buffer_load_dwordx4 v[64:67], v10, s[8:11], s48 offen offset:0
    ds_read_b128 v[40:43], v9 offset:30720
    v_mfma_f32_16x16x32_bf16 v[32:35], a[148:151], v[44:47], v[32:35]
    v_mfma_f32_16x16x32_bf16 v[36:39], a[152:155], v[44:47], v[36:39]
    s_waitcnt lgkmcnt(4)
    v_mfma_f32_16x16x32_bf16 v[16:19], a[156:159], v[48:51], v[16:19]
    buffer_load_dwordx2 v[68:69], v12, s[8:11], s48 offen offset:0
    ds_read_b128 v[44:47], v9 offset:30976
    v_mfma_f32_16x16x32_bf16 v[20:23], a[160:163], v[48:51], v[20:23]
    v_mfma_f32_16x16x32_bf16 v[24:27], a[164:167], v[48:51], v[24:27]
    s_waitcnt lgkmcnt(4)
    v_mfma_f32_16x16x32_bf16 v[28:31], a[156:159], v[52:55], v[28:31]
    buffer_load_dwordx4 v[72:75], v10, s[8:11], s48 offen offset:256
    ds_read_b128 v[48:51], v9 offset:32768
    v_mfma_f32_16x16x32_bf16 v[32:35], a[160:163], v[52:55], v[32:35]
    v_mfma_f32_16x16x32_bf16 v[36:39], a[164:167], v[52:55], v[36:39]
    s_waitcnt lgkmcnt(4)
    v_mfma_f32_16x16x32_bf16 v[16:19], a[168:171], v[56:59], v[16:19]
    buffer_load_dwordx2 v[76:77], v12, s[8:11], s48 offen offset:256
    ds_read_b128 v[52:55], v9 offset:33024
    v_mfma_f32_16x16x32_bf16 v[20:23], a[172:175], v[56:59], v[20:23]
    v_mfma_f32_16x16x32_bf16 v[24:27], a[176:179], v[56:59], v[24:27]
    s_waitcnt lgkmcnt(4)
    v_mfma_f32_16x16x32_bf16 v[28:31], a[168:171], v[60:63], v[28:31]
    v_cmp_eq_u32 s[76:77], 1, v2
    v_cmp_eq_u32 vcc, 2, v2
    ds_read_b128 v[56:59], v9 offset:34816
    v_mfma_f32_16x16x32_bf16 v[32:35], a[172:175], v[60:63], v[32:35]
    s_cmp_eq_u64 s[76:77], -1
    s_cselect_b32 s38, 1, 0
    v_mfma_f32_16x16x32_bf16 v[36:39], a[176:179], v[60:63], v[36:39]
    s_cmp_lg_u32 s38, 0
    s_cselect_b64 exec, 1, 0
    v_mov_b32 v15, s32
    ds_write_b32 v184, v15
    v_mov_b32 v2, 2
    s_mov_b64 exec, -1
    s_waitcnt lgkmcnt(5)
    v_mfma_f32_16x16x32_bf16 v[16:19], a[180:183], v[40:43], v[16:19]
    ds_read_b128 v[60:63], v9 offset:35072
    v_mfma_f32_16x16x32_bf16 v[20:23], a[184:187], v[40:43], v[20:23]
    s_add_u32 s32, s32, s38
    s_mul_i32 s38, s38, 22528
    s_add_u32 s33, s33, s38
    v_mfma_f32_16x16x32_bf16 v[24:27], a[188:191], v[40:43], v[24:27]
    s_cmp_eq_u64 vcc, 0
    s_cselect_b32 s38, s32, 0x7fff
    s_waitcnt lgkmcnt(5)
    v_mfma_f32_16x16x32_bf16 v[28:31], a[180:183], v[44:47], v[28:31]
    s_cmp_le_u32 s38, s39
    s_cselect_b64 exec, -1, 0
    v_mov_b32 v2, 2
    buffer_load_dword v2, v1, s[8:11], s33 offen sc1
    s_mov_b64 exec, -1
    v_mfma_f32_16x16x32_bf16 v[32:35], a[184:187], v[44:47], v[32:35]
    v_mfma_f32_16x16x32_bf16 v[36:39], a[188:191], v[44:47], v[36:39]
    s_waitcnt lgkmcnt(4)
    v_mfma_f32_16x16x32_bf16 v[16:19], a[192:195], v[48:51], v[16:19]
    v_mfma_f32_16x16x32_bf16 v[20:23], a[196:199], v[48:51], v[20:23]
    v_mfma_f32_16x16x32_bf16 v[24:27], a[200:203], v[48:51], v[24:27]
    s_waitcnt lgkmcnt(3)
    v_mfma_f32_16x16x32_bf16 v[28:31], a[192:195], v[52:55], v[28:31]
    v_mfma_f32_16x16x32_bf16 v[32:35], a[196:199], v[52:55], v[32:35]
    v_mfma_f32_16x16x32_bf16 v[36:39], a[200:203], v[52:55], v[36:39]
    s_waitcnt lgkmcnt(2)
    v_mfma_f32_16x16x32_bf16 v[16:19], a[204:207], v[56:59], v[16:19]
    v_mfma_f32_16x16x32_bf16 v[20:23], a[208:211], v[56:59], v[20:23]
    v_mfma_f32_16x16x32_bf16 v[24:27], a[212:215], v[56:59], v[24:27]
    s_waitcnt lgkmcnt(0)
    v_mfma_f32_16x16x32_bf16 v[28:31], a[204:207], v[60:63], v[28:31]
    v_mfma_f32_16x16x32_bf16 v[32:35], a[208:211], v[60:63], v[32:35]
    v_mfma_f32_16x16x32_bf16 v[36:39], a[212:215], v[60:63], v[36:39]
    v_mov_b32 v88, 0x3f803f80
    v_cvt_pk_bf16_f32 v96, v16, v17
    v_cvt_pk_bf16_f32 v97, v18, v19
    v_cvt_pk_bf16_f32 v98, v20, v21
    v_cvt_pk_bf16_f32 v99, v22, v23
    v_cvt_pk_bf16_f32 v100, v24, v25
    v_cvt_pk_bf16_f32 v101, v26, v27
    buffer_store_dwordx4 v[96:99], v10, s[8:11], s46 offen offset:0 sc1
    buffer_store_dwordx2 v[100:101], v12, s[8:11], s46 offen offset:0 sc1
    v_cvt_pk_bf16_f32 v104, v28, v29
    v_cvt_pk_bf16_f32 v105, v30, v31
    v_cvt_pk_bf16_f32 v106, v32, v33
    v_cvt_pk_bf16_f32 v107, v34, v35
    v_cvt_pk_bf16_f32 v108, v36, v37
    v_cvt_pk_bf16_f32 v109, v38, v39
    buffer_store_dwordx4 v[104:107], v10, s[8:11], s46 offen offset:256 sc1
    buffer_store_dwordx2 v[108:109], v12, s[8:11], s46 offen offset:256 sc1
    v_mov_b32 v80, 0
    v_mov_b32 v81, 0
    v_mov_b32 v84, 0
    v_mov_b32 v85, 0
    v_dot2c_f32_bf16 v80, v96, v88
    v_dot2c_f32_bf16 v81, v96, v96
    v_dot2c_f32_bf16 v84, v104, v88
    v_dot2c_f32_bf16 v85, v104, v104
    v_dot2c_f32_bf16 v80, v97, v88
    v_dot2c_f32_bf16 v81, v97, v97
    v_dot2c_f32_bf16 v84, v105, v88
    v_dot2c_f32_bf16 v85, v105, v105
    v_dot2c_f32_bf16 v80, v98, v88
    v_dot2c_f32_bf16 v81, v98, v98
    v_dot2c_f32_bf16 v84, v106, v88
    v_dot2c_f32_bf16 v85, v106, v106
    v_dot2c_f32_bf16 v80, v99, v88
    v_dot2c_f32_bf16 v81, v99, v99
    v_dot2c_f32_bf16 v84, v107, v88
    v_dot2c_f32_bf16 v85, v107, v107
    v_dot2c_f32_bf16 v80, v100, v88
    v_dot2c_f32_bf16 v81, v100, v100
    v_dot2c_f32_bf16 v84, v108, v88
    v_dot2c_f32_bf16 v85, v108, v108
    v_dot2c_f32_bf16 v80, v101, v88
    v_dot2c_f32_bf16 v81, v101, v101
    v_dot2c_f32_bf16 v84, v109, v88
    v_dot2c_f32_bf16 v85, v109, v109
    s_nop 2
    v_mov_b32 v82, v80
    v_mov_b32 v83, v81
    v_mov_b32 v86, v84
    v_mov_b32 v87, v85
    v_permlane32_swap_b32 v80, v82
    v_permlane32_swap_b32 v81, v83
    v_permlane32_swap_b32 v84, v86
    v_permlane32_swap_b32 v85, v87
    v_add_f32 v80, v80, v82
    v_add_f32 v81, v81, v83
    v_add_f32 v84, v84, v86
    v_add_f32 v85, v85, v87
    v_mov_b32 v82, v80
    v_mov_b32 v83, v81
    v_mov_b32 v86, v84
    v_mov_b32 v87, v85
    v_permlane16_swap_b32 v80, v82
    v_permlane16_swap_b32 v81, v83
    v_permlane16_swap_b32 v84, v86
    v_permlane16_swap_b32 v85, v87
    v_add_f32 v80, v80, v82
    v_add_f32 v81, v81, v83
    v_add_f32 v84, v84, v86
    v_add_f32 v85, v85, v87
    s_mov_b64 exec, 0xffff
    buffer_store_dwordx2 v[80:81], v11, s[8:11], s52 offen offset:0 sc1
    buffer_store_dwordx2 v[84:85], v11, s[8:11], s52 offen offset:256 sc1
    s_mov_b64 exec, -1
    s_mul_i32 s43, s57, 22528
    s_add_u32 s43, s43, s49
    s_branch Lawo_head
Lawo_none:
    ds_read_b32 v15, v184
    s_waitcnt lgkmcnt(0)
    v_readfirstlane_b32 s17, v15
    s_nop 0
    s_cmp_lt_i32 s17, s37
    s_cbranch_scc1 Lawo_nopost
    s_add_u32 m0, s59, 0
    s_add_u32 s47, s41, 0
    buffer_load_dwordx4 v0, s[8:11], s47 offen offset:0 lds
    buffer_load_dwordx4 v0, s[8:11], s47 offen offset:1024 lds
    buffer_load_dwordx4 v0, s[8:11], s47 offen offset:2048 lds
    buffer_load_dwordx4 v0, s[8:11], s47 offen offset:3072 lds
    s_add_u32 m0, s59, 4096
    s_add_u32 s47, s41, 4096
    buffer_load_dwordx4 v0, s[8:11], s47 offen offset:0 lds
    buffer_load_dwordx4 v0, s[8:11], s47 offen offset:1024 lds
    buffer_load_dwordx4 v0, s[8:11], s47 offen offset:2048 lds
    buffer_load_dwordx4 v0, s[8:11], s47 offen offset:3072 lds
    s_add_u32 m0, s59, 8192
    s_add_u32 s47, s41, 8192
    buffer_load_dwordx4 v0, s[8:11], s47 offen offset:0 lds
    s_mul_i32 s48, s36, 4718592
    s_mul_i32 s18, s37, 36864
    s_add_u32 s48, s48, s18
    s_add_u32 s48, s48, 6291456
    buffer_load_dwordx4 v[64:67], v10, s[8:11], s48 offen offset:0
    buffer_load_dwordx2 v[68:69], v12, s[8:11], s48 offen offset:0
    buffer_load_dwordx4 v[72:75], v10, s[8:11], s48 offen offset:256
    buffer_load_dwordx2 v[76:77], v12, s[8:11], s48 offen offset:256
    s_waitcnt vmcnt(13)
    s_cmp_lg_u32 s43, 0
    s_cselect_b64 exec, 1, 0
    buffer_store_dword v3, v4, s[8:11], s43 offen sc1
    s_mov_b64 exec, -1
    s_mov_b32 s43, 0
    s_waitcnt vmcnt(1) lgkmcnt(0)
    s_branch Lawo_head2
Lawo_nopost:
    s_waitcnt vmcnt(0)
    s_cmp_lg_u32 s43, 0
    s_cselect_b64 exec, 1, 0
    buffer_store_dword v3, v4, s[8:11], s43 offen sc1
    s_mov_b64 exec, -1
    s_mov_b32 s43, 0
    s_cmp_ge_u32 s37, 64
    s_cbranch_scc1 Lawo_end
Lawo_wait:
    s_mov_b32 s16, 0
    s_cmp_lg_u32 s14, 0
    s_cbranch_scc1 Lawo_wl
Lawo_wp:
    buffer_load_dword v2, v1, s[8:11], s60 offen sc1
    s_add_u32 s16, s16, 1
    s_cmp_gt_u32 s16, 100000
    s_cbranch_scc1 Lawo_giveup
    s_waitcnt vmcnt(0)
    v_cmp_eq_u32 vcc, 0, v2
    s_nop 0
    s_cbranch_vccz Lawo_wok
    s_sleep 4
    s_branch Lawo_wp
Lawo_giveup:
    v_mov_b32 v5, -2
    ds_write_b32 v184, v5
    s_waitcnt lgkmcnt(0)
    s_branch L_role_awo_abort
Lawo_wok:
    v_mov_b32 v5, s37
    ds_write_b32 v184, v5
    s_branch Lawo_go
Lawo_wl:
    ds_read_b32 v15, v184
    s_add_u32 s16, s16, 1
    s_cmp_gt_u32 s16, 1600000
    s_cbranch_scc1 L_role_awo_abort
    s_waitcnt lgkmcnt(0)
    v_readfirstlane_b32 s17, v15
    s_nop 0
    s_cmp_eq_u32 s17, -2
    s_cbranch_scc1 L_role_awo_abort
    s_cmp_ge_i32 s17, s37
    s_cbranch_scc1 Lawo_go
    s_sleep 1
    s_branch Lawo_wl
Lawo_go:
    s_add_u32 m0, s59, 0
    s_add_u32 s47, s41, 0
    buffer_load_dwordx4 v0, s[8:11], s47 offen offset:0 lds
    buffer_load_dwordx4 v0, s[8:11], s47 offen offset:1024 lds
    buffer_load_dwordx4 v0, s[8:11], s47 offen offset:2048 lds
    buffer_load_dwordx4 v0, s[8:11], s47 offen offset:3072 lds
    s_add_u32 m0, s59, 4096
    s_add_u32 s47, s41, 4096
    buffer_load_dwordx4 v0, s[8:11], s47 offen offset:0 lds
    buffer_load_dwordx4 v0, s[8:11], s47 offen offset:1024 lds
    buffer_load_dwordx4 v0, s[8:11], s47 offen offset:2048 lds
    buffer_load_dwordx4 v0, s[8:11], s47 offen offset:3072 lds
    s_add_u32 m0, s59, 8192
    s_add_u32 s47, s41, 8192
    buffer_load_dwordx4 v0, s[8:11], s47 offen offset:0 lds
    s_mul_i32 s48, s36, 4718592
    s_mul_i32 s18, s37, 36864
    s_add_u32 s48, s48, s18
    s_add_u32 s48, s48, 6291456
    buffer_load_dwordx4 v[64:67], v10, s[8:11], s48 offen offset:0
    buffer_load_dwordx2 v[68:69], v12, s[8:11], s48 offen offset:0
    buffer_load_dwordx4 v[72:75], v10, s[8:11], s48 offen offset:256
    buffer_load_dwordx2 v[76:77], v12, s[8:11], s48 offen offset:256
    s_waitcnt vmcnt(0) lgkmcnt(0)
    s_branch Lawo_head2
Lawo_end:
    s_branch L_role_awo_exit
L_role_awo_abort:
    s_waitcnt lgkmcnt(0)
    s_mov_b64 exec, -1
    v_mov_b32 v0, 60
    s_lshl_b32 s5, s3, 8
    s_or_b32 s5, s5, s4
    s_or_b32 s5, s5, 0x10000
    v_mov_b32 v1, s5
    global_store_dword v0, v1, s[12:13]
    s_endpgm
L_role_awo_exit:
    s_endpgm
.p2align 6
L_role_aq:
    v_and_b32 v5, 63, v0
    v_lshlrev_b32 v0, 4, v5
    v_and_b32 v7, 15, v5
    v_lshrrev_b32 v8, 4, v5
    v_min_u32 v1, 47, v5
    v_lshrrev_b32 v6, 2, v1
    v_and_b32 v1, 3, v1
    v_lshlrev_b32 v1, 2, v1
    v_lshl_add_u32 v1, v6, 7, v1
    v_mov_b32 v3, 1
    v_mov_b32 v4, 0
    s_mov_b32 s44, 0x05040100
    s_mov_b32 s45, 0x07060302
    s_lshr_b32 s63, s15, 4
    s_and_b32 s15, s15, 15
    s_lshr_b32 s50, s15, 1
    s_lshl_b32 s50, s50, 2
    s_and_b32 s17, s15, 1
    s_add_u32 s50, s50, s17
    s_and_b32 s17, s14, 2
    s_add_u32 s50, s50, s17
    s_and_b32 s51, s14, 1
    s_cmp_eq_u32 s63, 0
    s_cbranch_scc1 Laq_gate_ng
    s_cmp_lg_u32 s14, 0
    s_cbranch_scc1 Laq_gate_d
    v_mov_b32 v5, 48
    s_mov_b32 s16, 0
Laq_gate:
    global_load_dword v6, v5, s[12:13] sc1
    s_add_u32 s16, s16, 1
    s_cmp_gt_u32 s16, 100000
    s_cbranch_scc1 L_role_aq_abort
    s_waitcnt vmcnt(0)
    v_cmp_gt_u32 vcc, 32, v6
    s_nop 0
    s_cbranch_vccz Laq_gate_d
    s_sleep 100
    s_branch Laq_gate
Laq_gate_d:
    s_barrier
Laq_gate_ng:
    s_load_dwordx2 s[20:21], s[0:1], 8
    s_mov_b32 s22, 1990656
    s_mov_b32 s23, 0x00020000
    s_waitcnt lgkmcnt(0)
    s_and_b32 s21, s21, 0xffff
    v_lshrrev_b32 v5, 7, v0
    v_mul_u32_u24 v16, 3456, v5
    v_and_b32 v5, 0x70, v0
    v_add_u32 v16, v16, v5
    s_lshr_b32 s17, s14, 1
    s_mul_i32 s46, s17, 72
    v_lshrrev_b32 v5, 2, v7
    v_lshl_add_u32 v5, v8, 3, v5
    v_and_b32 v6, 3, v7
    v_lshlrev_b32 v17, 7, v5
    v_lshl_add_u32 v17, v6, 3, v17
    v_add_u32 v17, s46, v17
    v_lshlrev_b32 v18, 5, v5
    v_min_u32 v6, 1, v6
    v_lshl_add_u32 v18, v6, 4, v18
    s_mul_i32 s17, s17, 3072
    s_add_u32 s17, s17, 36864
    v_add_u32 v18, s17, v18
    s_sub_u32 s17, s50, s14
    s_lshr_b32 s17, s14, 1
    s_lshl_b32 s17, s17, 1
    s_sub_u32 s17, s50, s17
    s_mul_i32 s49, s17, 36
    s_mul_i32 s17, s14, 82944
    s_add_u32 s49, s49, s17
    s_mul_i32 s47, s14, 3072
    v_lshrrev_b32 v21, 4, v0
    s_lshl_b32 s17, s14, 6
    v_add_u32 v21, s17, v21
    v_cmp_le_u32 vcc, 96, v21
    s_nop 1
    v_cndmask_b32 v5, 0, 1, vcc
    v_mul_u32_u24 v6, 96, v5
    v_sub_u32 v6, v21, v6
    v_lshlrev_b32 v19, 7, v6
    v_mul_u32_u24 v20, 72, v5
    v_add_u32 v19, v19, v20
    v_add_u32 v19, 32, v19
    v_lshlrev_b32 v20, 5, v21
    v_add_u32 v20, 36864, v20
    v_mov_b32 v24, 0
    v_mov_b32 v25, 0
    v_mov_b32 v26, 0
    v_mov_b32 v27, 0
    v_mov_b32 v31, 0
    s_cmp_eq_u32 s14, 3
    s_cselect_b64 s[76:77], 0, -1
    s_mov_b64 exec, s[76:77]
    v_add_u32 v22, 0, v20
    ds_write_b128 v22, v[24:27] offset:16
    v_add_u32 v22, 43008, v20
    ds_write_b128 v22, v[24:27] offset:16
    v_add_u32 v22, 86016, v20
    ds_write_b128 v22, v[24:27] offset:16
    s_mov_b64 exec, -1
    s_add_u32 m0, s47, 0
    s_add_u32 s17, s49, 0
    buffer_load_dwordx4 v16, s[20:23], s17 offen lds
    s_add_u32 m0, s47, 1024
    s_add_u32 s17, s49, 27648
    buffer_load_dwordx4 v16, s[20:23], s17 offen lds
    s_add_u32 m0, s47, 2048
    s_add_u32 s17, s49, 55296
    buffer_load_dwordx4 v16, s[20:23], s17 offen lds
    s_add_u32 m0, s47, 12288
    s_add_u32 s17, s49, 1152
    buffer_load_dwordx4 v16, s[20:23], s17 offen lds
    s_add_u32 m0, s47, 13312
    s_add_u32 s17, s49, 28800
    buffer_load_dwordx4 v16, s[20:23], s17 offen lds
    s_add_u32 m0, s47, 14336
    s_add_u32 s17, s49, 56448
    buffer_load_dwordx4 v16, s[20:23], s17 offen lds
    s_add_u32 m0, s47, 24576
    s_add_u32 s17, s49, 2304
    buffer_load_dwordx4 v16, s[20:23], s17 offen lds
    s_add_u32 m0, s47, 25600
    s_add_u32 s17, s49, 29952
    buffer_load_dwordx4 v16, s[20:23], s17 offen lds
    s_add_u32 m0, s47, 26624
    s_add_u32 s17, s49, 57600
    buffer_load_dwordx4 v16, s[20:23], s17 offen lds
    s_add_u32 m0, s47, 43008
    s_add_u32 s17, s49, 331776
    buffer_load_dwordx4 v16, s[20:23], s17 offen lds
    s_add_u32 m0, s47, 44032
    s_add_u32 s17, s49, 359424
    buffer_load_dwordx4 v16, s[20:23], s17 offen lds
    s_add_u32 m0, s47, 45056
    s_add_u32 s17, s49, 387072
    buffer_load_dwordx4 v16, s[20:23], s17 offen lds
    s_add_u32 m0, s47, 55296
    s_add_u32 s17, s49, 332928
    buffer_load_dwordx4 v16, s[20:23], s17 offen lds
    s_add_u32 m0, s47, 56320
    s_add_u32 s17, s49, 360576
    buffer_load_dwordx4 v16, s[20:23], s17 offen lds
    s_add_u32 m0, s47, 57344
    s_add_u32 s17, s49, 388224
    buffer_load_dwordx4 v16, s[20:23], s17 offen lds
    s_add_u32 m0, s47, 67584
    s_add_u32 s17, s49, 334080
    buffer_load_dwordx4 v16, s[20:23], s17 offen lds
    s_add_u32 m0, s47, 68608
    s_add_u32 s17, s49, 361728
    buffer_load_dwordx4 v16, s[20:23], s17 offen lds
    s_add_u32 m0, s47, 69632
    s_add_u32 s17, s49, 389376
    buffer_load_dwordx4 v16, s[20:23], s17 offen lds
    s_add_u32 m0, s47, 86016
    s_add_u32 s17, s49, 663552
    buffer_load_dwordx4 v16, s[20:23], s17 offen lds
    s_add_u32 m0, s47, 87040
    s_add_u32 s17, s49, 691200
    buffer_load_dwordx4 v16, s[20:23], s17 offen lds
    s_add_u32 m0, s47, 88064
    s_add_u32 s17, s49, 718848
    buffer_load_dwordx4 v16, s[20:23], s17 offen lds
    s_add_u32 m0, s47, 98304
    s_add_u32 s17, s49, 664704
    buffer_load_dwordx4 v16, s[20:23], s17 offen lds
    s_add_u32 m0, s47, 99328
    s_add_u32 s17, s49, 692352
    buffer_load_dwordx4 v16, s[20:23], s17 offen lds
    s_add_u32 m0, s47, 100352
    s_add_u32 s17, s49, 720000
    buffer_load_dwordx4 v16, s[20:23], s17 offen lds
    s_add_u32 m0, s47, 110592
    s_add_u32 s17, s49, 665856
    buffer_load_dwordx4 v16, s[20:23], s17 offen lds
    s_add_u32 m0, s47, 111616
    s_add_u32 s17, s49, 693504
    buffer_load_dwordx4 v16, s[20:23], s17 offen lds
    s_add_u32 m0, s47, 112640
    s_add_u32 s17, s49, 721152
    buffer_load_dwordx4 v16, s[20:23], s17 offen lds
    s_waitcnt vmcnt(18) lgkmcnt(0)
    s_barrier
    s_mov_b64 exec, s[76:77]
    v_add_u32 v22, 0, v19
    ds_read_b32 v28, v22 offset:0
    ds_read_b32 v29, v22 offset:12288
    ds_read_b32 v30, v22 offset:24576
    s_waitcnt lgkmcnt(0)
    v_add_u32 v22, 0, v20
    ds_write_b128 v22, v[28:31]
    s_mov_b64 exec, -1
    v_add_u32 v22, 0, v17
    v_add_u32 v23, 0, v18
    ds_read_b64_tr_b16 v[152:153], v22 offset:0
    ds_read_b64_tr_b16 v[154:155], v22 offset:512
    ds_read_b64_tr_b16 v[224:225], v22 offset:12288
    ds_read_b64_tr_b16 v[226:227], v22 offset:12800
    ds_read_b64_tr_b16 a[112:113], v22 offset:24576
    ds_read_b64_tr_b16 a[114:115], v22 offset:25088
    ds_read_b64_tr_b16 v[156:157], v22 offset:4096
    ds_read_b64_tr_b16 v[158:159], v22 offset:4608
    ds_read_b64_tr_b16 v[228:229], v22 offset:16384
    ds_read_b64_tr_b16 v[230:231], v22 offset:16896
    ds_read_b64_tr_b16 a[116:117], v22 offset:28672
    ds_read_b64_tr_b16 a[118:119], v22 offset:29184
    ds_read_b64_tr_b16 v[160:161], v22 offset:8192
    ds_read_b64_tr_b16 v[162:163], v22 offset:8704
    ds_read_b64_tr_b16 v[232:233], v22 offset:20480
    ds_read_b64_tr_b16 v[234:235], v22 offset:20992
    ds_read_b64_tr_b16 a[120:121], v22 offset:32768
    ds_read_b64_tr_b16 a[122:123], v22 offset:33280
    s_waitcnt lgkmcnt(0)
    s_barrier
    ds_read_b64_tr_b16 a[40:41], v23 offset:0
    ds_read_b64_tr_b16 a[42:43], v23 offset:128
    ds_read_b64_tr_b16 a[184:185], v23 offset:8
    ds_read_b64_tr_b16 a[186:187], v23 offset:136
    ds_read_b64_tr_b16 a[44:45], v23 offset:1024
    ds_read_b64_tr_b16 a[46:47], v23 offset:1152
    ds_read_b64_tr_b16 a[188:189], v23 offset:1032
    ds_read_b64_tr_b16 a[190:191], v23 offset:1160
    ds_read_b64_tr_b16 a[48:49], v23 offset:2048
    ds_read_b64_tr_b16 a[50:51], v23 offset:2176
    ds_read_b64_tr_b16 a[192:193], v23 offset:2056
    ds_read_b64_tr_b16 a[194:195], v23 offset:2184
    s_waitcnt vmcnt(9) lgkmcnt(0)
    s_barrier
    s_add_u32 m0, s47, 0
    s_add_u32 s17, s49, 995328
    buffer_load_dwordx4 v16, s[20:23], s17 offen lds
    s_add_u32 m0, s47, 1024
    s_add_u32 s17, s49, 1022976
    buffer_load_dwordx4 v16, s[20:23], s17 offen lds
    s_add_u32 m0, s47, 2048
    s_add_u32 s17, s49, 1050624
    buffer_load_dwordx4 v16, s[20:23], s17 offen lds
    s_add_u32 m0, s47, 12288
    s_add_u32 s17, s49, 996480
    buffer_load_dwordx4 v16, s[20:23], s17 offen lds
    s_add_u32 m0, s47, 13312
    s_add_u32 s17, s49, 1024128
    buffer_load_dwordx4 v16, s[20:23], s17 offen lds
    s_add_u32 m0, s47, 14336
    s_add_u32 s17, s49, 1051776
    buffer_load_dwordx4 v16, s[20:23], s17 offen lds
    s_add_u32 m0, s47, 24576
    s_add_u32 s17, s49, 997632
    buffer_load_dwordx4 v16, s[20:23], s17 offen lds
    s_add_u32 m0, s47, 25600
    s_add_u32 s17, s49, 1025280
    buffer_load_dwordx4 v16, s[20:23], s17 offen lds
    s_add_u32 m0, s47, 26624
    s_add_u32 s17, s49, 1052928
    buffer_load_dwordx4 v16, s[20:23], s17 offen lds
    s_mov_b64 exec, s[76:77]
    v_add_u32 v22, 43008, v19
    ds_read_b32 v28, v22 offset:0
    ds_read_b32 v29, v22 offset:12288
    ds_read_b32 v30, v22 offset:24576
    s_waitcnt lgkmcnt(0)
    v_add_u32 v22, 43008, v20
    ds_write_b128 v22, v[28:31]
    s_mov_b64 exec, -1
    v_add_u32 v22, 43008, v17
    v_add_u32 v23, 43008, v18
    ds_read_b64_tr_b16 v[164:165], v22 offset:0
    ds_read_b64_tr_b16 v[166:167], v22 offset:512
    ds_read_b64_tr_b16 v[236:237], v22 offset:12288
    ds_read_b64_tr_b16 v[238:239], v22 offset:12800
    ds_read_b64_tr_b16 a[124:125], v22 offset:24576
    ds_read_b64_tr_b16 a[126:127], v22 offset:25088
    ds_read_b64_tr_b16 v[168:169], v22 offset:4096
    ds_read_b64_tr_b16 v[170:171], v22 offset:4608
    ds_read_b64_tr_b16 v[240:241], v22 offset:16384
    ds_read_b64_tr_b16 v[242:243], v22 offset:16896
    ds_read_b64_tr_b16 a[128:129], v22 offset:28672
    ds_read_b64_tr_b16 a[130:131], v22 offset:29184
    ds_read_b64_tr_b16 v[172:173], v22 offset:8192
    ds_read_b64_tr_b16 v[174:175], v22 offset:8704
    ds_read_b64_tr_b16 v[244:245], v22 offset:20480
    ds_read_b64_tr_b16 v[246:247], v22 offset:20992
    ds_read_b64_tr_b16 a[132:133], v22 offset:32768
    ds_read_b64_tr_b16 a[134:135], v22 offset:33280
    s_waitcnt lgkmcnt(0)
    s_barrier
    ds_read_b64_tr_b16 a[52:53], v23 offset:0
    ds_read_b64_tr_b16 a[54:55], v23 offset:128
    ds_read_b64_tr_b16 a[196:197], v23 offset:8
    ds_read_b64_tr_b16 a[198:199], v23 offset:136
    ds_read_b64_tr_b16 a[56:57], v23 offset:1024
    ds_read_b64_tr_b16 a[58:59], v23 offset:1152
    ds_read_b64_tr_b16 a[200:201], v23 offset:1032
    ds_read_b64_tr_b16 a[202:203], v23 offset:1160
    ds_read_b64_tr_b16 a[60:61], v23 offset:2048
    ds_read_b64_tr_b16 a[62:63], v23 offset:2176
    ds_read_b64_tr_b16 a[204:205], v23 offset:2056
    ds_read_b64_tr_b16 a[206:207], v23 offset:2184
    s_waitcnt vmcnt(9) lgkmcnt(0)
    s_barrier
    s_add_u32 m0, s47, 43008
    s_add_u32 s17, s49, 1327104
    buffer_load_dwordx4 v16, s[20:23], s17 offen lds
    s_add_u32 m0, s47, 44032
    s_add_u32 s17, s49, 1354752
    buffer_load_dwordx4 v16, s[20:23], s17 offen lds
    s_add_u32 m0, s47, 45056
    s_add_u32 s17, s49, 1382400
    buffer_load_dwordx4 v16, s[20:23], s17 offen lds
    s_add_u32 m0, s47, 55296
    s_add_u32 s17, s49, 1328256
    buffer_load_dwordx4 v16, s[20:23], s17 offen lds
    s_add_u32 m0, s47, 56320
    s_add_u32 s17, s49, 1355904
    buffer_load_dwordx4 v16, s[20:23], s17 offen lds
    s_add_u32 m0, s47, 57344
    s_add_u32 s17, s49, 1383552
    buffer_load_dwordx4 v16, s[20:23], s17 offen lds
    s_add_u32 m0, s47, 67584
    s_add_u32 s17, s49, 1329408
    buffer_load_dwordx4 v16, s[20:23], s17 offen lds
    s_add_u32 m0, s47, 68608
    s_add_u32 s17, s49, 1357056
    buffer_load_dwordx4 v16, s[20:23], s17 offen lds
    s_add_u32 m0, s47, 69632
    s_add_u32 s17, s49, 1384704
    buffer_load_dwordx4 v16, s[20:23], s17 offen lds
    s_mov_b64 exec, s[76:77]
    v_add_u32 v22, 86016, v19
    ds_read_b32 v28, v22 offset:0
    ds_read_b32 v29, v22 offset:12288
    ds_read_b32 v30, v22 offset:24576
    s_waitcnt lgkmcnt(0)
    v_add_u32 v22, 86016, v20
    ds_write_b128 v22, v[28:31]
    s_mov_b64 exec, -1
    v_add_u32 v22, 86016, v17
    v_add_u32 v23, 86016, v18
    ds_read_b64_tr_b16 v[176:177], v22 offset:0
    ds_read_b64_tr_b16 v[178:179], v22 offset:512
    ds_read_b64_tr_b16 v[248:249], v22 offset:12288
    ds_read_b64_tr_b16 v[250:251], v22 offset:12800
    ds_read_b64_tr_b16 a[136:137], v22 offset:24576
    ds_read_b64_tr_b16 a[138:139], v22 offset:25088
    ds_read_b64_tr_b16 v[180:181], v22 offset:4096
    ds_read_b64_tr_b16 v[182:183], v22 offset:4608
    ds_read_b64_tr_b16 v[252:253], v22 offset:16384
    ds_read_b64_tr_b16 v[254:255], v22 offset:16896
    ds_read_b64_tr_b16 a[140:141], v22 offset:28672
    ds_read_b64_tr_b16 a[142:143], v22 offset:29184
    ds_read_b64_tr_b16 v[184:185], v22 offset:8192
    ds_read_b64_tr_b16 v[186:187], v22 offset:8704
    ds_read_b64_tr_b16 a[0:1], v22 offset:20480
    ds_read_b64_tr_b16 a[2:3], v22 offset:20992
    ds_read_b64_tr_b16 a[144:145], v22 offset:32768
    ds_read_b64_tr_b16 a[146:147], v22 offset:33280
    s_waitcnt lgkmcnt(0)
    s_barrier
    ds_read_b64_tr_b16 a[64:65], v23 offset:0
    ds_read_b64_tr_b16 a[66:67], v23 offset:128
    ds_read_b64_tr_b16 a[208:209], v23 offset:8
    ds_read_b64_tr_b16 a[210:211], v23 offset:136
    ds_read_b64_tr_b16 a[68:69], v23 offset:1024
    ds_read_b64_tr_b16 a[70:71], v23 offset:1152
    ds_read_b64_tr_b16 a[212:213], v23 offset:1032
    ds_read_b64_tr_b16 a[214:215], v23 offset:1160
    ds_read_b64_tr_b16 a[72:73], v23 offset:2048
    ds_read_b64_tr_b16 a[74:75], v23 offset:2176
    ds_read_b64_tr_b16 a[216:217], v23 offset:2056
    ds_read_b64_tr_b16 a[218:219], v23 offset:2184
    s_waitcnt vmcnt(9) lgkmcnt(0)
    s_barrier
    s_add_u32 m0, s47, 86016
    s_add_u32 s17, s49, 1658880
    buffer_load_dwordx4 v16, s[20:23], s17 offen lds
    s_add_u32 m0, s47, 87040
    s_add_u32 s17, s49, 1686528
    buffer_load_dwordx4 v16, s[20:23], s17 offen lds
    s_add_u32 m0, s47, 88064
    s_add_u32 s17, s49, 1714176
    buffer_load_dwordx4 v16, s[20:23], s17 offen lds
    s_add_u32 m0, s47, 98304
    s_add_u32 s17, s49, 1660032
    buffer_load_dwordx4 v16, s[20:23], s17 offen lds
    s_add_u32 m0, s47, 99328
    s_add_u32 s17, s49, 1687680
    buffer_load_dwordx4 v16, s[20:23], s17 offen lds
    s_add_u32 m0, s47, 100352
    s_add_u32 s17, s49, 1715328
    buffer_load_dwordx4 v16, s[20:23], s17 offen lds
    s_add_u32 m0, s47, 110592
    s_add_u32 s17, s49, 1661184
    buffer_load_dwordx4 v16, s[20:23], s17 offen lds
    s_add_u32 m0, s47, 111616
    s_add_u32 s17, s49, 1688832
    buffer_load_dwordx4 v16, s[20:23], s17 offen lds
    s_add_u32 m0, s47, 112640
    s_add_u32 s17, s49, 1716480
    buffer_load_dwordx4 v16, s[20:23], s17 offen lds
    s_mov_b64 exec, s[76:77]
    v_add_u32 v22, 0, v19
    ds_read_b32 v28, v22 offset:0
    ds_read_b32 v29, v22 offset:12288
    ds_read_b32 v30, v22 offset:24576
    s_waitcnt lgkmcnt(0)
    v_add_u32 v22, 0, v20
    ds_write_b128 v22, v[28:31]
    s_mov_b64 exec, -1
    v_add_u32 v22, 0, v17
    v_add_u32 v23, 0, v18
    ds_read_b64_tr_b16 v[188:189], v22 offset:0
    ds_read_b64_tr_b16 v[190:191], v22 offset:512
    ds_read_b64_tr_b16 a[4:5], v22 offset:12288
    ds_read_b64_tr_b16 a[6:7], v22 offset:12800
    ds_read_b64_tr_b16 a[148:149], v22 offset:24576
    ds_read_b64_tr_b16 a[150:151], v22 offset:25088
    ds_read_b64_tr_b16 v[192:193], v22 offset:4096
    ds_read_b64_tr_b16 v[194:195], v22 offset:4608
    ds_read_b64_tr_b16 a[8:9], v22 offset:16384
    ds_read_b64_tr_b16 a[10:11], v22 offset:16896
    ds_read_b64_tr_b16 a[152:153], v22 offset:28672
    ds_read_b64_tr_b16 a[154:155], v22 offset:29184
    ds_read_b64_tr_b16 v[196:197], v22 offset:8192
    ds_read_b64_tr_b16 v[198:199], v22 offset:8704
    ds_read_b64_tr_b16 a[12:13], v22 offset:20480
    ds_read_b64_tr_b16 a[14:15], v22 offset:20992
    ds_read_b64_tr_b16 a[156:157], v22 offset:32768
    ds_read_b64_tr_b16 a[158:159], v22 offset:33280
    s_waitcnt lgkmcnt(0)
    s_barrier
    ds_read_b64_tr_b16 a[76:77], v23 offset:0
    ds_read_b64_tr_b16 a[78:79], v23 offset:128
    ds_read_b64_tr_b16 a[220:221], v23 offset:8
    ds_read_b64_tr_b16 a[222:223], v23 offset:136
    ds_read_b64_tr_b16 a[80:81], v23 offset:1024
    ds_read_b64_tr_b16 a[82:83], v23 offset:1152
    ds_read_b64_tr_b16 a[224:225], v23 offset:1032
    ds_read_b64_tr_b16 a[226:227], v23 offset:1160
    ds_read_b64_tr_b16 a[84:85], v23 offset:2048
    ds_read_b64_tr_b16 a[86:87], v23 offset:2176
    ds_read_b64_tr_b16 a[228:229], v23 offset:2056
    ds_read_b64_tr_b16 a[230:231], v23 offset:2184
    s_waitcnt vmcnt(9) lgkmcnt(0)
    s_barrier
    s_mov_b64 exec, s[76:77]
    v_add_u32 v22, 43008, v19
    ds_read_b32 v28, v22 offset:0
    ds_read_b32 v29, v22 offset:12288
    ds_read_b32 v30, v22 offset:24576
    s_waitcnt lgkmcnt(0)
    v_add_u32 v22, 43008, v20
    ds_write_b128 v22, v[28:31]
    s_mov_b64 exec, -1
    v_add_u32 v22, 43008, v17
    v_add_u32 v23, 43008, v18
    ds_read_b64_tr_b16 v[200:201], v22 offset:0
    ds_read_b64_tr_b16 v[202:203], v22 offset:512
    ds_read_b64_tr_b16 a[16:17], v22 offset:12288
    ds_read_b64_tr_b16 a[18:19], v22 offset:12800
    ds_read_b64_tr_b16 a[160:161], v22 offset:24576
    ds_read_b64_tr_b16 a[162:163], v22 offset:25088
    ds_read_b64_tr_b16 v[204:205], v22 offset:4096
    ds_read_b64_tr_b16 v[206:207], v22 offset:4608
    ds_read_b64_tr_b16 a[20:21], v22 offset:16384
    ds_read_b64_tr_b16 a[22:23], v22 offset:16896
    ds_read_b64_tr_b16 a[164:165], v22 offset:28672
    ds_read_b64_tr_b16 a[166:167], v22 offset:29184
    ds_read_b64_tr_b16 v[208:209], v22 offset:8192
    ds_read_b64_tr_b16 v[210:211], v22 offset:8704
    ds_read_b64_tr_b16 a[24:25], v22 offset:20480
    ds_read_b64_tr_b16 a[26:27], v22 offset:20992
    ds_read_b64_tr_b16 a[168:169], v22 offset:32768
    ds_read_b64_tr_b16 a[170:171], v22 offset:33280
    s_waitcnt lgkmcnt(0)
    s_barrier
    ds_read_b64_tr_b16 a[88:89], v23 offset:0
    ds_read_b64_tr_b16 a[90:91], v23 offset:128
    ds_read_b64_tr_b16 a[232:233], v23 offset:8
    ds_read_b64_tr_b16 a[234:235], v23 offset:136
    ds_read_b64_tr_b16 a[92:93], v23 offset:1024
    ds_read_b64_tr_b16 a[94:95], v23 offset:1152
    ds_read_b64_tr_b16 a[236:237], v23 offset:1032
    ds_read_b64_tr_b16 a[238:239], v23 offset:1160
    ds_read_b64_tr_b16 a[96:97], v23 offset:2048
    ds_read_b64_tr_b16 a[98:99], v23 offset:2176
    ds_read_b64_tr_b16 a[240:241], v23 offset:2056
    ds_read_b64_tr_b16 a[242:243], v23 offset:2184
    s_waitcnt vmcnt(0) lgkmcnt(0)
    s_barrier
    s_mov_b64 exec, s[76:77]
    v_add_u32 v22, 86016, v19
    ds_read_b32 v28, v22 offset:0
    ds_read_b32 v29, v22 offset:12288
    ds_read_b32 v30, v22 offset:24576
    s_waitcnt lgkmcnt(0)
    v_add_u32 v22, 86016, v20
    ds_write_b128 v22, v[28:31]
    s_mov_b64 exec, -1
    v_add_u32 v22, 86016, v17
    v_add_u32 v23, 86016, v18
    ds_read_b64_tr_b16 v[212:213], v22 offset:0
    ds_read_b64_tr_b16 v[214:215], v22 offset:512
    ds_read_b64_tr_b16 a[28:29], v22 offset:12288
    ds_read_b64_tr_b16 a[30:31], v22 offset:12800
    ds_read_b64_tr_b16 a[172:173], v22 offset:24576
    ds_read_b64_tr_b16 a[174:175], v22 offset:25088
    ds_read_b64_tr_b16 v[216:217], v22 offset:4096
    ds_read_b64_tr_b16 v[218:219], v22 offset:4608
    ds_read_b64_tr_b16 a[32:33], v22 offset:16384
    ds_read_b64_tr_b16 a[34:35], v22 offset:16896
    ds_read_b64_tr_b16 a[176:177], v22 offset:28672
    ds_read_b64_tr_b16 a[178:179], v22 offset:29184
    ds_read_b64_tr_b16 v[220:221], v22 offset:8192
    ds_read_b64_tr_b16 v[222:223], v22 offset:8704
    ds_read_b64_tr_b16 a[36:37], v22 offset:20480
    ds_read_b64_tr_b16 a[38:39], v22 offset:20992
    ds_read_b64_tr_b16 a[180:181], v22 offset:32768
    ds_read_b64_tr_b16 a[182:183], v22 offset:33280
    s_waitcnt lgkmcnt(0)
    s_barrier
    ds_read_b64_tr_b16 a[100:101], v23 offset:0
    ds_read_b64_tr_b16 a[102:103], v23 offset:128
    ds_read_b64_tr_b16 a[244:245], v23 offset:8
    ds_read_b64_tr_b16 a[246:247], v23 offset:136
    ds_read_b64_tr_b16 a[104:105], v23 offset:1024
    ds_read_b64_tr_b16 a[106:107], v23 offset:1152
    ds_read_b64_tr_b16 a[248:249], v23 offset:1032
    ds_read_b64_tr_b16 a[250:251], v23 offset:1160
    ds_read_b64_tr_b16 a[108:109], v23 offset:2048
    ds_read_b64_tr_b16 a[110:111], v23 offset:2176
    ds_read_b64_tr_b16 a[252:253], v23 offset:2056
    ds_read_b64_tr_b16 a[254:255], v23 offset:2184
    s_waitcnt lgkmcnt(0)
    s_barrier
    v_mov_b32 v56, 0x3f803f80
    v_mov_b32 v57, 0x3f803f80
    v_mov_b32 v58, 0x3f803f80
    v_mov_b32 v59, 0x3f803f80
    s_nop 1
    v_mfma_f32_16x16x32_bf16 v[36:39], v[152:155], v[56:59], 0
    v_mfma_f32_16x16x32_bf16 v[40:43], v[224:227], v[56:59], 0
    v_mfma_f32_16x16x32_bf16 v[44:47], a[40:43], v[56:59], 0
    v_mfma_f32_16x16x32_bf16 v[48:51], v[56:59], a[112:115], 0
    v_mfma_f32_16x16x32_bf16 v[52:55], v[56:59], a[184:187], 0
    v_mfma_f32_16x16x32_bf16 v[36:39], v[156:159], v[56:59], v[36:39]
    v_mfma_f32_16x16x32_bf16 v[40:43], v[228:231], v[56:59], v[40:43]
    v_mfma_f32_16x16x32_bf16 v[44:47], a[44:47], v[56:59], v[44:47]
    v_mfma_f32_16x16x32_bf16 v[48:51], v[56:59], a[116:119], v[48:51]
    v_mfma_f32_16x16x32_bf16 v[52:55], v[56:59], a[188:191], v[52:55]
    v_mfma_f32_16x16x32_bf16 v[36:39], v[160:163], v[56:59], v[36:39]
    v_mfma_f32_16x16x32_bf16 v[40:43], v[232:235], v[56:59], v[40:43]
    v_mfma_f32_16x16x32_bf16 v[44:47], a[48:51], v[56:59], v[44:47]
    v_mfma_f32_16x16x32_bf16 v[48:51], v[56:59], a[120:123], v[48:51]
    v_mfma_f32_16x16x32_bf16 v[52:55], v[56:59], a[192:195], v[52:55]
    v_mfma_f32_16x16x32_bf16 v[36:39], v[164:167], v[56:59], v[36:39]
    v_mfma_f32_16x16x32_bf16 v[40:43], v[236:239], v[56:59], v[40:43]
    v_mfma_f32_16x16x32_bf16 v[44:47], a[52:55], v[56:59], v[44:47]
    v_mfma_f32_16x16x32_bf16 v[48:51], v[56:59], a[124:127], v[48:51]
    v_mfma_f32_16x16x32_bf16 v[52:55], v[56:59], a[196:199], v[52:55]
    v_mfma_f32_16x16x32_bf16 v[36:39], v[168:171], v[56:59], v[36:39]
    v_mfma_f32_16x16x32_bf16 v[40:43], v[240:243], v[56:59], v[40:43]
    v_mfma_f32_16x16x32_bf16 v[44:47], a[56:59], v[56:59], v[44:47]
    v_mfma_f32_16x16x32_bf16 v[48:51], v[56:59], a[128:131], v[48:51]
    v_mfma_f32_16x16x32_bf16 v[52:55], v[56:59], a[200:203], v[52:55]
    v_mfma_f32_16x16x32_bf16 v[36:39], v[172:175], v[56:59], v[36:39]
    v_mfma_f32_16x16x32_bf16 v[40:43], v[244:247], v[56:59], v[40:43]
    v_mfma_f32_16x16x32_bf16 v[44:47], a[60:63], v[56:59], v[44:47]
    v_mfma_f32_16x16x32_bf16 v[48:51], v[56:59], a[132:135], v[48:51]
    v_mfma_f32_16x16x32_bf16 v[52:55], v[56:59], a[204:207], v[52:55]
    v_mfma_f32_16x16x32_bf16 v[36:39], v[176:179], v[56:59], v[36:39]
    v_mfma_f32_16x16x32_bf16 v[40:43], v[248:251], v[56:59], v[40:43]
    v_mfma_f32_16x16x32_bf16 v[44:47], a[64:67], v[56:59], v[44:47]
    v_mfma_f32_16x16x32_bf16 v[48:51], v[56:59], a[136:139], v[48:51]
    v_mfma_f32_16x16x32_bf16 v[52:55], v[56:59], a[208:211], v[52:55]
    v_mfma_f32_16x16x32_bf16 v[36:39], v[180:183], v[56:59], v[36:39]
    v_mfma_f32_16x16x32_bf16 v[40:43], v[252:255], v[56:59], v[40:43]
    v_mfma_f32_16x16x32_bf16 v[44:47], a[68:71], v[56:59], v[44:47]
    v_mfma_f32_16x16x32_bf16 v[48:51], v[56:59], a[140:143], v[48:51]
    v_mfma_f32_16x16x32_bf16 v[52:55], v[56:59], a[212:215], v[52:55]
    v_mfma_f32_16x16x32_bf16 v[36:39], v[184:187], v[56:59], v[36:39]
    v_mfma_f32_16x16x32_bf16 v[40:43], a[0:3], v[56:59], v[40:43]
    v_mfma_f32_16x16x32_bf16 v[44:47], a[72:75], v[56:59], v[44:47]
    v_mfma_f32_16x16x32_bf16 v[48:51], v[56:59], a[144:147], v[48:51]
    v_mfma_f32_16x16x32_bf16 v[52:55], v[56:59], a[216:219], v[52:55]
    v_mfma_f32_16x16x32_bf16 v[36:39], v[188:191], v[56:59], v[36:39]
    v_mfma_f32_16x16x32_bf16 v[40:43], a[4:7], v[56:59], v[40:43]
    v_mfma_f32_16x16x32_bf16 v[44:47], a[76:79], v[56:59], v[44:47]
    v_mfma_f32_16x16x32_bf16 v[48:51], v[56:59], a[148:151], v[48:51]
    v_mfma_f32_16x16x32_bf16 v[52:55], v[56:59], a[220:223], v[52:55]
    v_mfma_f32_16x16x32_bf16 v[36:39], v[192:195], v[56:59], v[36:39]
    v_mfma_f32_16x16x32_bf16 v[40:43], a[8:11], v[56:59], v[40:43]
    v_mfma_f32_16x16x32_bf16 v[44:47], a[80:83], v[56:59], v[44:47]
    v_mfma_f32_16x16x32_bf16 v[48:51], v[56:59], a[152:155], v[48:51]
    v_mfma_f32_16x16x32_bf16 v[52:55], v[56:59], a[224:227], v[52:55]
    v_mfma_f32_16x16x32_bf16 v[36:39], v[196:199], v[56:59], v[36:39]
    v_mfma_f32_16x16x32_bf16 v[40:43], a[12:15], v[56:59], v[40:43]
    v_mfma_f32_16x16x32_bf16 v[44:47], a[84:87], v[56:59], v[44:47]
    v_mfma_f32_16x16x32_bf16 v[48:51], v[56:59], a[156:159], v[48:51]
    v_mfma_f32_16x16x32_bf16 v[52:55], v[56:59], a[228:231], v[52:55]
    v_mfma_f32_16x16x32_bf16 v[36:39], v[200:203], v[56:59], v[36:39]
    v_mfma_f32_16x16x32_bf16 v[40:43], a[16:19], v[56:59], v[40:43]
    v_mfma_f32_16x16x32_bf16 v[44:47], a[88:91], v[56:59], v[44:47]
    v_mfma_f32_16x16x32_bf16 v[48:51], v[56:59], a[160:163], v[48:51]
    v_mfma_f32_16x16x32_bf16 v[52:55], v[56:59], a[232:235], v[52:55]
    v_mfma_f32_16x16x32_bf16 v[36:39], v[204:207], v[56:59], v[36:39]
    v_mfma_f32_16x16x32_bf16 v[40:43], a[20:23], v[56:59], v[40:43]
    v_mfma_f32_16x16x32_bf16 v[44:47], a[92:95], v[56:59], v[44:47]
    v_mfma_f32_16x16x32_bf16 v[48:51], v[56:59], a[164:167], v[48:51]
    v_mfma_f32_16x16x32_bf16 v[52:55], v[56:59], a[236:239], v[52:55]
    v_mfma_f32_16x16x32_bf16 v[36:39], v[208:211], v[56:59], v[36:39]
    v_mfma_f32_16x16x32_bf16 v[40:43], a[24:27], v[56:59], v[40:43]
    v_mfma_f32_16x16x32_bf16 v[44:47], a[96:99], v[56:59], v[44:47]
    v_mfma_f32_16x16x32_bf16 v[48:51], v[56:59], a[168:171], v[48:51]
    v_mfma_f32_16x16x32_bf16 v[52:55], v[56:59], a[240:243], v[52:55]
    v_mfma_f32_16x16x32_bf16 v[36:39], v[212:215], v[56:59], v[36:39]
    v_mfma_f32_16x16x32_bf16 v[40:43], a[28:31], v[56:59], v[40:43]
    v_mfma_f32_16x16x32_bf16 v[44:47], a[100:103], v[56:59], v[44:47]
    v_mfma_f32_16x16x32_bf16 v[48:51], v[56:59], a[172:175], v[48:51]
    v_mfma_f32_16x16x32_bf16 v[52:55], v[56:59], a[244:247], v[52:55]
    v_mfma_f32_16x16x32_bf16 v[36:39], v[216:219], v[56:59], v[36:39]
    v_mfma_f32_16x16x32_bf16 v[40:43], a[32:35], v[56:59], v[40:43]
    v_mfma_f32_16x16x32_bf16 v[44:47], a[104:107], v[56:59], v[44:47]
    v_mfma_f32_16x16x32_bf16 v[48:51], v[56:59], a[176:179], v[48:51]
    v_mfma_f32_16x16x32_bf16 v[52:55], v[56:59], a[248:251], v[52:55]
    v_mfma_f32_16x16x32_bf16 v[36:39], v[220:223], v[56:59], v[36:39]
    v_mfma_f32_16x16x32_bf16 v[40:43], a[36:39], v[56:59], v[40:43]
    v_mfma_f32_16x16x32_bf16 v[44:47], a[108:111], v[56:59], v[44:47]
    v_mfma_f32_16x16x32_bf16 v[48:51], v[56:59], a[180:183], v[48:51]
    v_mfma_f32_16x16x32_bf16 v[52:55], v[56:59], a[252:255], v[52:55]
    v_lshlrev_b32 v10, 5, v7
    s_lshl_b32 s17, s51, 4
    v_add_u32 v10, s17, v10
    v_mul_u32_u24 v6, 1536, v8
    v_add_u32 v10, v10, v6
    s_lshl_b32 s17, s14, 7
    s_add_u32 s17, s17, 73728
    v_lshl_add_u32 v11, v7, 3, s17
    v_lshl_add_u32 v12, v8, 5, s17
    v_lshlrev_b32 v13, 5, v7
    s_lshl_b32 s17, s51, 4
    v_add_u32 v13, s17, v13
    s_lshr_b32 s17, s50, 2
    s_add_u32 s17, s17, 64
    s_lshl_b32 s17, s17, 9
    s_and_b32 s18, s50, 3
    s_lshl_b32 s18, s18, 2
    s_add_u32 s17, s17, s18
    v_add_u32 v14, s17, v13
    v_lshrrev_b32 v5, 1, v8
    v_lshl_add_u32 v13, v5, 9, v13
    v_and_b32 v5, 1, v8
    v_lshl_add_u32 v13, v5, 3, v13
    s_lshl_b32 s17, s50, 10
    v_add_u32 v13, s17, v13
    s_lshl_b32 s49, s15, 7
    s_lshl_b32 s17, s14, 2
    s_add_u32 s49, s49, s17
    s_add_u32 s49, s49, 1536
    s_mov_b32 s52, 0x3eae1a93
    v_mov_b32 v6, 0xf149f2ca
    v_lshl_add_u32 v5, v8, 2, 0
    v_sub_u32 v5, v5, v7
    v_cmp_le_i32 vcc, 9, v5
    s_nop 1
    v_cndmask_b32 v72, v6, v4, vcc
    v_add_u32 v5, 7, v5
    v_cmp_ge_u32 vcc, 7, v5
    s_nop 1
    v_cndmask_b32 v76, v6, v4, vcc
    v_lshl_add_u32 v5, v8, 2, 1
    v_sub_u32 v5, v5, v7
    v_cmp_le_i32 vcc, 9, v5
    s_nop 1
    v_cndmask_b32 v73, v6, v4, vcc
    v_add_u32 v5, 7, v5
    v_cmp_ge_u32 vcc, 7, v5
    s_nop 1
    v_cndmask_b32 v77, v6, v4, vcc
    v_lshl_add_u32 v5, v8, 2, 2
    v_sub_u32 v5, v5, v7
    v_cmp_le_i32 vcc, 9, v5
    s_nop 1
    v_cndmask_b32 v74, v6, v4, vcc
    v_add_u32 v5, 7, v5
    v_cmp_ge_u32 vcc, 7, v5
    s_nop 1
    v_cndmask_b32 v78, v6, v4, vcc
    v_lshl_add_u32 v5, v8, 2, 3
    v_sub_u32 v5, v5, v7
    v_cmp_le_i32 vcc, 9, v5
    s_nop 1
    v_cndmask_b32 v75, v6, v4, vcc
    v_add_u32 v5, 7, v5
    v_cmp_ge_u32 vcc, 7, v5
    s_nop 1
    v_cndmask_b32 v79, v6, v4, vcc
    v_mov_b32 v112, 0
    v_mov_b32 v113, 0
    v_mov_b32 v114, 0
    v_mov_b32 v115, 0
    v_mov_b32 v136, 0
    v_mov_b32 v137, 0
    v_mov_b32 v138, 0
    v_mov_b32 v139, 0
    v_mov_b32 v140, 0
    v_mov_b32 v141, 0
    v_mov_b32 v142, 0
    v_mov_b32 v143, 0
    v_mov_b32 v116, 0x3f803f80
    v_mov_b32 v117, 0x3f803f80
    v_mov_b32 v118, 0x3f803f80
    v_mov_b32 v119, 0x3f803f80
    v_mov_b32 v131, 0
    v_mov_b32 v135, 0
    s_mov_b64 exec, 0xff
    v_lshrrev_b32 v6, 2, v0
    v_lshlrev_b32 v5, 5, v6
    v_and_b32 v5, 128, v5
    v_lshrrev_b32 v6, 1, v6
    v_and_or_b32 v5, v6, 12, v5
    s_mov_b32 s16, 0
Laq_pure:
    global_load_dword v6, v5, s[12:13] sc1
    s_add_u32 s16, s16, 1
    s_cmp_gt_u32 s16, 100000
    s_cbranch_scc1 L_role_aq_abort
    s_mov_b32 s6, 0
    s_waitcnt vmcnt(0)
    v_readlane_b32 s7, v6, 0
    s_nop 0
    s_add_u32 s6, s6, s7
    v_readlane_b32 s7, v6, 1
    s_nop 0
    s_add_u32 s6, s6, s7
    v_readlane_b32 s7, v6, 2
    s_nop 0
    s_add_u32 s6, s6, s7
    v_readlane_b32 s7, v6, 3
    s_nop 0
    s_add_u32 s6, s6, s7
    v_readlane_b32 s7, v6, 4
    s_nop 0
    s_add_u32 s6, s6, s7
    v_readlane_b32 s7, v6, 5
    s_nop 0
    s_add_u32 s6, s6, s7
    v_readlane_b32 s7, v6, 6
    s_nop 0
    s_add_u32 s6, s6, s7
    v_readlane_b32 s7, v6, 7
    s_nop 0
    s_add_u32 s6, s6, s7
    v_readlane_b32 s7, v6, s3
    s_nop 0
    s_cmp_ge_u32 s7, 32
    s_cselect_b32 s78, 0, -1
    s_cselect_b32 s6, 256, s6
    s_cmp_lt_u32 s6, 256
    s_cbranch_scc1 Laq_pure
    s_mov_b32 s79, s78
    s_mov_b64 exec, -1
    s_mov_b32 s36, s63
    s_mov_b32 s34, s63
    s_mul_i32 s58, s14, 9216
    s_mul_i32 s64, s63, 4718592
    s_add_u32 s64, s64, s58
    s_add_u32 s64, s64, 6291456
    s_mul_i32 s61, s63, 1441792
    s_add_u32 s61, s61, 0
    s_mov_b32 s37, 0
    s_mov_b32 s40, 36864
    s_mov_b32 s59, s58
    s_mov_b32 s43, 0
    s_mov_b32 s62, 1
    s_mov_b32 s28, s8
    s_mov_b32 s29, s9
    s_mov_b32 s30, 0
    s_mov_b32 s31, 0x00020000
    v_mov_b32 v110, 74752
    v_mov_b32 v5, -1
    ds_write_b32 v110, v5
    s_waitcnt lgkmcnt(0)
    s_cmp_lg_u32 s14, 0
    s_cbranch_scc1 Laq_inia_d
    v_mov_b32 v5, 40
    s_mov_b32 s16, 0
Laq_inia:
    global_load_dword v6, v5, s[12:13] sc1
    s_add_u32 s16, s16, 1
    s_cmp_gt_u32 s16, 100000
    s_cbranch_scc1 L_role_aq_abort
    s_waitcnt vmcnt(0)
    v_cmp_gt_u32 vcc, 128, v6
    s_nop 0
    s_cbranch_vccz Laq_inia_d
    s_sleep 8
    s_branch Laq_inia
Laq_inia_d:
    s_barrier
    s_cmp_eq_u32 s63, 0
    s_cbranch_scc1 Laq_ini_sk
    s_cmp_lg_u32 s14, 0
    s_cbranch_scc1 Laq_inib_d
    v_mov_b32 v5, 160
    s_mov_b32 s16, 0
Laq_inib:
    global_load_dword v6, v5, s[12:13] sc1
    s_add_u32 s16, s16, 1
    s_cmp_gt_u32 s16, 100000
    s_cbranch_scc1 L_role_aq_abort
    s_waitcnt vmcnt(0)
    v_cmp_gt_u32 vcc, 64, v6
    s_nop 0
    s_cbranch_vccz Laq_inib_d
    s_sleep 8
    s_branch Laq_inib
Laq_inib_d:
    s_barrier
Laq_ini_sk:
    s_mul_i32 s41, s37, 36864
    s_add_u32 s41, s41, s64
    s_mul_i32 s60, s37, 22528
    s_add_u32 s60, s60, s61
    s_cmp_lt_u32 s37, 64
    s_cselect_b32 s60, s60, 2883584
    s_branch Laq_wait
Laq_head:
    s_waitcnt vmcnt(4)
Laq_head2:
    s_barrier
    ds_read_b32 v15, v110
    s_xor_b32 s40, s40, 36864
    s_xor_b32 s59, s59, 36864
    s_mov_b32 s35, s37
    s_lshl_b32 s57, s34, 6
    s_add_u32 s57, s57, s35
    s_add_u32 s37, s37, 1
    s_mov_b32 s39, 0
    s_mov_b32 s54, 0
    s_mul_i32 s41, s37, 36864
    s_add_u32 s41, s41, s64
    s_mul_i32 s60, s37, 22528
    s_add_u32 s60, s60, s61
    s_cmp_lt_u32 s37, 64
    s_cselect_b32 s60, s60, 2883584
    v_lshlrev_b32 v9, 9, v8
    v_lshl_add_u32 v9, v7, 5, v9
    s_lshl_b32 s17, s51, 4
    s_add_u32 s17, s17, s40
    v_add_u32 v9, s17, v9
    ds_read_b128 v[56:59], v9 offset:0
    ds_read_b128 v[60:63], v9 offset:2048
    ds_read_b128 v[64:67], v9 offset:4096
    s_waitcnt lgkmcnt(2)
    v_mfma_f32_16x16x32_bf16 v[16:19], v[152:155], v[56:59], 0
    v_add_f32 v80, v80, v84
    v_mfma_f32_16x16x32_bf16 v[20:23], v[224:227], v[56:59], 0
    v_add_f32 v81, v81, v85
    v_mfma_f32_16x16x32_bf16 v[24:27], a[40:43], v[56:59], 0
    v_add_f32 v82, v82, v86
    ds_read_b128 v[56:59], v9 offset:6144
    s_waitcnt lgkmcnt(2)
    v_mfma_f32_16x16x32_bf16 v[16:19], v[156:159], v[60:63], v[16:19]
    v_add_f32 v83, v83, v87
    v_mfma_f32_16x16x32_bf16 v[20:23], v[228:231], v[60:63], v[20:23]
    v_add_f32 v80, v80, v88
    v_mfma_f32_16x16x32_bf16 v[24:27], a[44:47], v[60:63], v[24:27]
    v_add_f32 v81, v81, v89
    v_readfirstlane_b32 s17, v15
    s_nop 0
    s_add_u32 s18, s17, 1
    s_max_i32 s32, s18, s37
    s_add_u32 s39, s37, 1
    s_min_u32 s39, s39, 63
    s_mul_i32 s33, s32, 22528
    s_add_u32 s33, s33, s61
    s_cmp_eq_u32 s14, 0
    s_cselect_b32 s18, s32, 0x7fff
    v_mov_b32 v2, 2
    s_cmp_le_u32 s18, s39
    s_cselect_b64 exec, -1, 0
    buffer_load_dword v2, v1, s[8:11], s33 offen sc1
    s_mov_b64 exec, -1
    s_cmp_ge_i32 s17, s37
    s_cbranch_scc1 Laq_f_7
    ds_read_b128 v[60:63], v9 offset:8192
    s_waitcnt lgkmcnt(2)
    v_mfma_f32_16x16x32_bf16 v[16:19], v[160:163], v[64:67], v[16:19]
    v_add_f32 v82, v82, v90
    v_mfma_f32_16x16x32_bf16 v[20:23], v[232:235], v[64:67], v[20:23]
    v_add_f32 v83, v83, v91
    v_mfma_f32_16x16x32_bf16 v[24:27], a[48:51], v[64:67], v[24:27]
    v_add_f32 v80, v80, v82
    ds_read_b128 v[64:67], v9 offset:10240
    s_waitcnt lgkmcnt(2)
    v_mfma_f32_16x16x32_bf16 v[16:19], v[164:167], v[56:59], v[16:19]
    v_add_f32 v81, v81, v83
    v_mfma_f32_16x16x32_bf16 v[20:23], v[236:239], v[56:59], v[20:23]
    v_mov_b32 v82, v80
    v_mfma_f32_16x16x32_bf16 v[24:27], a[52:55], v[56:59], v[24:27]
    v_mov_b32 v83, v81
    ds_read_b128 v[56:59], v9 offset:12288
    s_waitcnt lgkmcnt(2)
    v_mfma_f32_16x16x32_bf16 v[16:19], v[168:171], v[60:63], v[16:19]
    v_permlane32_swap_b32 v80, v82
    v_mfma_f32_16x16x32_bf16 v[20:23], v[240:243], v[60:63], v[20:23]
    v_permlane32_swap_b32 v81, v83
    v_mfma_f32_16x16x32_bf16 v[24:27], a[56:59], v[60:63], v[24:27]
    v_add_f32 v80, v80, v82
    ds_read_b128 v[60:63], v9 offset:14336
    s_waitcnt lgkmcnt(2)
    v_mfma_f32_16x16x32_bf16 v[16:19], v[172:175], v[64:67], v[16:19]
    v_add_f32 v81, v81, v83
    v_mfma_f32_16x16x32_bf16 v[20:23], v[244:247], v[64:67], v[20:23]
    v_mov_b32 v82, v80
    v_mfma_f32_16x16x32_bf16 v[24:27], a[60:63], v[64:67], v[24:27]
    v_mov_b32 v83, v81
    s_waitcnt vmcnt(1)
    s_cmp_lg_u32 s43, 0
    s_cselect_b64 exec, 1, 0
    buffer_store_dword v3, v4, s[8:11], s43 offen
    s_and_b64 exec, exec, s[78:79]
    buffer_store_dword v3, v4, s[8:11], s43 offen sc1
    s_mov_b64 exec, -1
    s_mov_b32 s43, 0
    ds_read_b128 v[64:67], v9 offset:16384
    s_waitcnt lgkmcnt(2)
    v_mfma_f32_16x16x32_bf16 v[16:19], v[176:179], v[56:59], v[16:19]
    v_permlane16_swap_b32 v80, v82
    v_mfma_f32_16x16x32_bf16 v[20:23], v[248:251], v[56:59], v[20:23]
    v_permlane16_swap_b32 v81, v83
    v_mfma_f32_16x16x32_bf16 v[24:27], a[64:67], v[56:59], v[24:27]
    v_add_f32 v80, v80, v82
    ds_read_b128 v[56:59], v9 offset:18432
    s_waitcnt lgkmcnt(2)
    v_mfma_f32_16x16x32_bf16 v[16:19], v[180:183], v[60:63], v[16:19]
    v_add_f32 v81, v81, v83
    v_mfma_f32_16x16x32_bf16 v[20:23], v[252:255], v[60:63], v[20:23]
    v_mul_f32 v80, 0x3ae38e39, v80
    v_mfma_f32_16x16x32_bf16 v[24:27], a[68:71], v[60:63], v[24:27]
    v_mul_f32 v81, 0x3ae38e39, v81
    ds_read_b128 v[60:63], v9 offset:20480
    s_waitcnt lgkmcnt(2)
    v_mfma_f32_16x16x32_bf16 v[16:19], v[184:187], v[64:67], v[16:19]
    v_fma_f32 v81, -v80, v80, v81
    v_mfma_f32_16x16x32_bf16 v[20:23], a[0:3], v[64:67], v[20:23]
    v_max_f32 v81, 0, v81
    v_mfma_f32_16x16x32_bf16 v[24:27], a[72:75], v[64:67], v[24:27]
    v_add_f32 v81, 0x3727c5ac, v81
    ds_read_b128 v[64:67], v9 offset:22528
    s_waitcnt lgkmcnt(2)
    v_mfma_f32_16x16x32_bf16 v[16:19], v[188:191], v[56:59], v[16:19]
    v_rsq_f32 v92, v81
    v_mfma_f32_16x16x32_bf16 v[20:23], a[4:7], v[56:59], v[20:23]
    v_mul_f32 v93, v80, v92
    v_mfma_f32_16x16x32_bf16 v[24:27], a[76:79], v[56:59], v[24:27]
    ds_write_b64 v11, v[92:93]
    ds_read_b128 v[56:59], v9 offset:24576
    s_waitcnt lgkmcnt(3)
    v_mfma_f32_16x16x32_bf16 v[16:19], v[192:195], v[60:63], v[16:19]
    ds_read_b128 v[96:99], v12
    v_mfma_f32_16x16x32_bf16 v[20:23], a[8:11], v[60:63], v[20:23]
    ds_read_b128 v[100:103], v12 offset:16
    v_mfma_f32_16x16x32_bf16 v[24:27], a[80:83], v[60:63], v[24:27]
    ds_read_b128 v[60:63], v9 offset:26624
    s_waitcnt lgkmcnt(5)
    v_mfma_f32_16x16x32_bf16 v[16:19], v[196:199], v[64:67], v[16:19]
    v_mfma_f32_16x16x32_bf16 v[20:23], a[12:15], v[64:67], v[20:23]
    v_mfma_f32_16x16x32_bf16 v[24:27], a[84:87], v[64:67], v[24:27]
    ds_read_b128 v[64:67], v9 offset:28672
    s_waitcnt lgkmcnt(4)
    v_mfma_f32_16x16x32_bf16 v[16:19], v[200:203], v[56:59], v[16:19]
    v_mfma_f32_16x16x32_bf16 v[20:23], a[16:19], v[56:59], v[20:23]
    v_mfma_f32_16x16x32_bf16 v[24:27], a[88:91], v[56:59], v[24:27]
    ds_read_b128 v[56:59], v9 offset:30720
    s_waitcnt lgkmcnt(2)
    v_mfma_f32_16x16x32_bf16 v[16:19], v[204:207], v[60:63], v[16:19]
    v_mfma_f32_16x16x32_bf16 v[20:23], a[20:23], v[60:63], v[20:23]
    v_mfma_f32_16x16x32_bf16 v[24:27], a[92:95], v[60:63], v[24:27]
    ds_read_b128 v[60:63], v9 offset:32768
    s_waitcnt lgkmcnt(2)
    v_mfma_f32_16x16x32_bf16 v[16:19], v[208:211], v[64:67], v[16:19]
    v_mfma_f32_16x16x32_bf16 v[20:23], a[24:27], v[64:67], v[20:23]
    v_mfma_f32_16x16x32_bf16 v[24:27], a[96:99], v[64:67], v[24:27]
    ds_read_b128 v[64:67], v9 offset:34816
    s_waitcnt lgkmcnt(2)
    v_mfma_f32_16x16x32_bf16 v[16:19], v[212:215], v[56:59], v[16:19]
    v_cmp_eq_u32 s[76:77], 1, v2
    v_cmp_eq_u32 vcc, 2, v2
    v_mfma_f32_16x16x32_bf16 v[20:23], a[28:31], v[56:59], v[20:23]
    s_cmp_eq_u64 s[76:77], -1
    s_cselect_b32 s38, 1, 0
    v_mfma_f32_16x16x32_bf16 v[24:27], a[100:103], v[56:59], v[24:27]
    s_cmp_lg_u32 s38, 0
    s_cselect_b64 exec, 1, 0
    v_mov_b32 v15, s32
    ds_write_b32 v110, v15
    v_mov_b32 v2, 2
    s_mov_b64 exec, -1
    ds_read_b128 v[56:59], v9 offset:0
    s_waitcnt lgkmcnt(3)
    v_mfma_f32_16x16x32_bf16 v[16:19], v[216:219], v[60:63], v[16:19]
    s_add_u32 s32, s32, s38
    s_mul_i32 s38, s38, 22528
    s_add_u32 s33, s33, s38
    v_mfma_f32_16x16x32_bf16 v[20:23], a[32:35], v[60:63], v[20:23]
    s_cmp_eq_u64 vcc, 0
    s_cselect_b32 s38, s32, 0x7fff
    v_mfma_f32_16x16x32_bf16 v[24:27], a[104:107], v[60:63], v[24:27]
    s_cmp_le_u32 s38, s39
    s_cselect_b64 exec, -1, 0
    v_mov_b32 v2, 2
    buffer_load_dword v2, v1, s[8:11], s33 offen sc1
    s_mov_b64 exec, -1
    ds_read_b128 v[60:63], v9 offset:2048
    s_waitcnt lgkmcnt(3)
    v_mfma_f32_16x16x32_bf16 v[16:19], v[220:223], v[64:67], v[16:19]
    v_mfma_f32_16x16x32_bf16 v[20:23], a[36:39], v[64:67], v[20:23]
    v_mfma_f32_16x16x32_bf16 v[24:27], a[108:111], v[64:67], v[24:27]
    ds_read_b32 v15, v110
    ds_read_b128 v[64:67], v9 offset:4096
    s_waitcnt lgkmcnt(3)
    v_mfma_f32_16x16x32_bf16 v[28:31], v[56:59], a[112:115], 0
    v_mfma_f32_16x16x32_bf16 v[32:35], v[56:59], a[184:187], 0
    ds_read_b128 v[56:59], v9 offset:6144
    s_waitcnt lgkmcnt(3)
    v_mfma_f32_16x16x32_bf16 v[28:31], v[60:63], a[116:119], v[28:31]
    v_mul_f32 v94, v93, v36
    v_fma_f32 v16, v16, v92, -v94
    v_mfma_f32_16x16x32_bf16 v[32:35], v[60:63], a[188:191], v[32:35]
    v_mul_f32 v94, v93, v37
    v_fma_f32 v17, v17, v92, -v94
    s_waitcnt lgkmcnt(2)
    v_readfirstlane_b32 s17, v15
    s_nop 0
    s_cmp_ge_i32 s17, s37
    s_cbranch_scc1 Laq_f_8
    ds_read_b128 v[60:63], v9 offset:8192
    s_waitcnt lgkmcnt(2)
    v_mfma_f32_16x16x32_bf16 v[28:31], v[64:67], a[120:123], v[28:31]
    v_mul_f32 v94, v93, v38
    v_fma_f32 v18, v18, v92, -v94
    v_mfma_f32_16x16x32_bf16 v[32:35], v[64:67], a[192:195], v[32:35]
    v_mul_f32 v94, v93, v39
    v_fma_f32 v19, v19, v92, -v94
    ds_read_b128 v[64:67], v9 offset:10240
    s_waitcnt lgkmcnt(2)
    v_mfma_f32_16x16x32_bf16 v[28:31], v[56:59], a[124:127], v[28:31]
    v_mul_f32 v94, v93, v44
    v_fma_f32 v24, v24, v92, -v94
    v_mfma_f32_16x16x32_bf16 v[32:35], v[56:59], a[196:199], v[32:35]
    v_mul_f32 v94, v93, v45
    v_fma_f32 v25, v25, v92, -v94
    ds_read_b128 v[56:59], v9 offset:12288
    s_waitcnt lgkmcnt(2)
    v_mfma_f32_16x16x32_bf16 v[28:31], v[60:63], a[128:131], v[28:31]
    v_mul_f32 v94, v93, v46
    v_fma_f32 v26, v26, v92, -v94
    v_mfma_f32_16x16x32_bf16 v[32:35], v[60:63], a[200:203], v[32:35]
    v_mul_f32 v94, v93, v47
    v_fma_f32 v27, v27, v92, -v94
    ds_read_b128 v[60:63], v9 offset:14336
    s_waitcnt lgkmcnt(2)
    v_mfma_f32_16x16x32_bf16 v[28:31], v[64:67], a[132:135], v[28:31]
    v_mul_f32 v94, v93, v40
    v_fma_f32 v20, v20, v92, -v94
    v_mfma_f32_16x16x32_bf16 v[32:35], v[64:67], a[204:207], v[32:35]
    v_mul_f32 v94, v93, v41
    v_fma_f32 v21, v21, v92, -v94
    ds_read_b128 v[64:67], v9 offset:16384
    s_waitcnt lgkmcnt(2)
    v_mfma_f32_16x16x32_bf16 v[28:31], v[56:59], a[136:139], v[28:31]
    v_mul_f32 v94, v93, v42
    v_fma_f32 v22, v22, v92, -v94
    v_mfma_f32_16x16x32_bf16 v[32:35], v[56:59], a[208:211], v[32:35]
    v_mul_f32 v94, v93, v43
    v_fma_f32 v23, v23, v92, -v94
    ds_read_b128 v[56:59], v9 offset:18432
    s_waitcnt lgkmcnt(2)
    v_mfma_f32_16x16x32_bf16 v[28:31], v[60:63], a[140:143], v[28:31]
    v_cvt_pk_bf16_f32 v128, v16, v17
    v_cvt_pk_bf16_f32 v129, v18, v19
    v_mfma_f32_16x16x32_bf16 v[32:35], v[60:63], a[212:215], v[32:35]
    v_cvt_pk_bf16_f32 v130, v24, v25
    v_cvt_pk_bf16_f32 v132, v20, v21
    ds_read_b128 v[60:63], v9 offset:20480
    s_waitcnt lgkmcnt(2)
    v_mfma_f32_16x16x32_bf16 v[28:31], v[64:67], a[144:147], v[28:31]
    v_cvt_pk_bf16_f32 v133, v22, v23
    v_cvt_pk_bf16_f32 v134, v26, v27
    v_mfma_f32_16x16x32_bf16 v[32:35], v[64:67], a[216:219], v[32:35]
    s_cmp_eq_u32 s35, 0
    s_cselect_b32 s46, 0xf149f2ca, 0
    ds_read_b128 v[64:67], v9 offset:22528
    s_waitcnt lgkmcnt(2)
    v_mfma_f32_16x16x32_bf16 v[28:31], v[56:59], a[148:151], v[28:31]
    v_mfma_f32_16x16x32_bf16 v[144:147], v[112:115], v[128:131], 0
    v_mfma_f32_16x16x32_bf16 v[32:35], v[56:59], a[220:223], v[32:35]
    v_mfma_f32_16x16x32_bf16 v[148:151], v[132:135], v[128:131], 0
    ds_read_b128 v[56:59], v9 offset:24576
    s_waitcnt lgkmcnt(2)
    v_mfma_f32_16x16x32_bf16 v[28:31], v[60:63], a[152:155], v[28:31]
    v_mov_b32 v112, v132
    v_mfma_f32_16x16x32_bf16 v[32:35], v[60:63], a[224:227], v[32:35]
    v_mov_b32 v113, v133
    v_mov_b32 v114, v134
    ds_read_b128 v[60:63], v9 offset:26624
    s_waitcnt lgkmcnt(2)
    v_mfma_f32_16x16x32_bf16 v[28:31], v[64:67], a[156:159], v[28:31]
    v_mfma_f32_16x16x32_bf16 v[32:35], v[64:67], a[228:231], v[32:35]
    v_fma_f32 v144, v144, s52, v72
    ds_read_b128 v[64:67], v9 offset:28672
    s_waitcnt lgkmcnt(2)
    v_mfma_f32_16x16x32_bf16 v[28:31], v[56:59], a[160:163], v[28:31]
    v_fma_f32 v145, v145, s52, v73
    v_fma_f32 v146, v146, s52, v74
    v_fma_f32 v147, v147, s52, v75
    v_mfma_f32_16x16x32_bf16 v[32:35], v[56:59], a[232:235], v[32:35]
    v_fma_f32 v148, v148, s52, v76
    v_fma_f32 v149, v149, s52, v77
    v_fma_f32 v150, v150, s52, v78
    ds_read_b128 v[56:59], v9 offset:30720
    s_waitcnt lgkmcnt(2)
    v_mfma_f32_16x16x32_bf16 v[28:31], v[60:63], a[164:167], v[28:31]
    v_fma_f32 v151, v151, s52, v79
    v_add_f32 v144, s46, v144
    v_add_f32 v145, s46, v145
    v_mfma_f32_16x16x32_bf16 v[32:35], v[60:63], a[236:239], v[32:35]
    v_add_f32 v146, s46, v146
    v_add_f32 v147, s46, v147
    v_max3_f32 v5, v144, v145, v146
    ds_read_b128 v[60:63], v9 offset:32768
    s_waitcnt lgkmcnt(2)
    v_mfma_f32_16x16x32_bf16 v[28:31], v[64:67], a[168:171], v[28:31]
    v_max3_f32 v5, v5, v147, v148
    v_max3_f32 v5, v5, v149, v150
    v_max_f32 v5, v5, v151
    v_mfma_f32_16x16x32_bf16 v[32:35], v[64:67], a[240:243], v[32:35]
    v_mov_b32 v6, v5
    s_nop 1
    v_permlane32_swap_b32 v5, v6
    ds_read_b128 v[64:67], v9 offset:34816
    s_waitcnt lgkmcnt(2)
    v_mfma_f32_16x16x32_bf16 v[28:31], v[56:59], a[172:175], v[28:31]
    v_max_f32 v5, v5, v6
    v_mov_b32 v6, v5
    v_mfma_f32_16x16x32_bf16 v[32:35], v[56:59], a[244:247], v[32:35]
    s_nop 0
    v_permlane16_swap_b32 v5, v6
    v_max_f32 v5, v5, v6
    v_sub_f32 v144, v144, v5
    s_waitcnt lgkmcnt(1)
    v_mfma_f32_16x16x32_bf16 v[28:31], v[60:63], a[176:179], v[28:31]
    v_sub_f32 v145, v145, v5
    v_sub_f32 v146, v146, v5
    v_sub_f32 v147, v147, v5
    v_mfma_f32_16x16x32_bf16 v[32:35], v[60:63], a[248:251], v[32:35]
    v_sub_f32 v148, v148, v5
    v_sub_f32 v149, v149, v5
    v_sub_f32 v150, v150, v5
    s_waitcnt lgkmcnt(0)
    v_mfma_f32_16x16x32_bf16 v[28:31], v[64:67], a[180:183], v[28:31]
    v_sub_f32 v151, v151, v5
    v_exp_f32 v144, v144
    v_exp_f32 v145, v145
    v_mfma_f32_16x16x32_bf16 v[32:35], v[64:67], a[252:255], v[32:35]
    v_exp_f32 v146, v146
    v_exp_f32 v147, v147
    v_exp_f32 v148, v148
    v_cmp_eq_u32 s[76:77], 1, v2
    v_cmp_eq_u32 vcc, 2, v2
    s_cmp_eq_u64 s[76:77], -1
    s_cselect_b32 s38, 1, 0
    s_cmp_lg_u32 s38, 0
    s_cselect_b64 exec, 1, 0
    v_mov_b32 v15, s32
    ds_write_b32 v110, v15
    v_mov_b32 v2, 2
    s_mov_b64 exec, -1
    s_add_u32 s32, s32, s38
    s_mul_i32 s38, s38, 22528
    s_add_u32 s33, s33, s38
    s_cmp_eq_u64 vcc, 0
    s_cselect_b32 s38, s32, 0x7fff
    s_cmp_le_u32 s38, s39
    s_cselect_b64 exec, -1, 0
    v_mov_b32 v2, 2
    buffer_load_dword v2, v1, s[8:11], s33 offen sc1
    s_mov_b64 exec, -1
    v_exp_f32 v149, v149
    v_exp_f32 v150, v150
    v_exp_f32 v151, v151
    v_cvt_pk_bf16_f32 v68, v144, v145
    v_cvt_pk_bf16_f32 v69, v146, v147
    v_cvt_pk_bf16_f32 v70, v148, v149
    v_cvt_pk_bf16_f32 v71, v150, v151
    s_nop 1
    v_mfma_f32_16x16x32_bf16 v[16:19], v[116:119], v[68:71], 0
    s_mul_i32 s46, s57, 36864
    s_add_u32 s46, s46, 17301504
    s_nop 5
    v_rcp_f32 v6, v16
    v_mul_f32 v94, v97, v48
    v_fma_f32 v28, v28, v96, -v94
    v_mul_f32 v94, v99, v49
    v_fma_f32 v29, v29, v98, -v94
    v_mul_f32 v94, v101, v50
    v_fma_f32 v30, v30, v100, -v94
    v_mul_f32 v94, v103, v51
    v_fma_f32 v31, v31, v102, -v94
    v_cvt_pk_bf16_f32 v138, v28, v29
    v_cvt_pk_bf16_f32 v139, v30, v31
    v_mul_f32 v94, v97, v52
    v_fma_f32 v32, v32, v96, -v94
    v_mfma_f32_16x16x32_bf16 v[20:23], v[136:139], v[68:71], 0
    v_mul_f32 v94, v99, v53
    v_fma_f32 v33, v33, v98, -v94
    v_mul_f32 v94, v101, v54
    v_fma_f32 v34, v34, v100, -v94
    v_mul_f32 v94, v103, v55
    v_fma_f32 v35, v35, v102, -v94
    v_cvt_pk_bf16_f32 v142, v32, v33
    v_cvt_pk_bf16_f32 v143, v34, v35
    v_mov_b32 v136, v138
    v_mov_b32 v137, v139
    v_mfma_f32_16x16x32_bf16 v[24:27], v[140:143], v[68:71], 0
    v_mul_f32 v20, v6, v20
    v_mul_f32 v21, v6, v21
    v_mul_f32 v22, v6, v22
    v_mul_f32 v23, v6, v23
    v_cvt_pk_bf16_f32 v20, v20, v21
    v_cvt_pk_bf16_f32 v21, v22, v23
    s_mov_b64 exec, -1
    buffer_store_dwordx2 v[20:21], v13, s[8:11], s46 offen
    s_and_b64 exec, exec, s[78:79]
    buffer_store_dwordx2 v[20:21], v13, s[8:11], s46 offen sc1
    s_mov_b64 exec, -1
    v_mov_b32 v140, v142
    v_mov_b32 v141, v143
    v_mul_f32 v24, v6, v24
    v_mul_f32 v25, v6, v25
    v_cvt_pk_bf16_f32 v24, v24, v25
    s_mov_b64 exec, 0xffff
    buffer_store_dword v24, v14, s[8:11], s46 offen
    s_and_b64 exec, exec, s[78:79]
    buffer_store_dword v24, v14, s[8:11], s46 offen sc1
    s_mov_b64 exec, -1
    s_mul_i32 s43, s57, 22528
    s_add_u32 s43, s43, s49
    s_branch Laq_none
Laq_f_7:
    ds_read_b128 v[60:63], v9 offset:8192
    s_waitcnt lgkmcnt(2)
    v_mfma_f32_16x16x32_bf16 v[16:19], v[160:163], v[64:67], v[16:19]
    v_add_f32 v82, v82, v90
    v_mfma_f32_16x16x32_bf16 v[20:23], v[232:235], v[64:67], v[20:23]
    v_add_f32 v83, v83, v91
    v_mfma_f32_16x16x32_bf16 v[24:27], a[48:51], v[64:67], v[24:27]
    v_add_f32 v80, v80, v82
    ds_read_b128 v[64:67], v9 offset:10240
    s_waitcnt lgkmcnt(2)
    v_mfma_f32_16x16x32_bf16 v[16:19], v[164:167], v[56:59], v[16:19]
    v_add_f32 v81, v81, v83
    v_mfma_f32_16x16x32_bf16 v[20:23], v[236:239], v[56:59], v[20:23]
    v_mov_b32 v82, v80
    v_mfma_f32_16x16x32_bf16 v[24:27], a[52:55], v[56:59], v[24:27]
    v_mov_b32 v83, v81
    ds_read_b128 v[56:59], v9 offset:12288
    s_waitcnt lgkmcnt(2)
    v_mfma_f32_16x16x32_bf16 v[16:19], v[168:171], v[60:63], v[16:19]
    v_permlane32_swap_b32 v80, v82
    v_mfma_f32_16x16x32_bf16 v[20:23], v[240:243], v[60:63], v[20:23]
    v_permlane32_swap_b32 v81, v83
    v_mfma_f32_16x16x32_bf16 v[24:27], a[56:59], v[60:63], v[24:27]
    v_add_f32 v80, v80, v82
    ds_read_b128 v[60:63], v9 offset:14336
    s_waitcnt lgkmcnt(2)
    v_mfma_f32_16x16x32_bf16 v[16:19], v[172:175], v[64:67], v[16:19]
    v_add_f32 v81, v81, v83
    v_mfma_f32_16x16x32_bf16 v[20:23], v[244:247], v[64:67], v[20:23]
    v_mov_b32 v82, v80
    v_mfma_f32_16x16x32_bf16 v[24:27], a[60:63], v[64:67], v[24:27]
    v_mov_b32 v83, v81
    s_waitcnt vmcnt(1)
    s_cmp_lg_u32 s43, 0
    s_cselect_b64 exec, 1, 0
    buffer_store_dword v3, v4, s[8:11], s43 offen
    s_and_b64 exec, exec, s[78:79]
    buffer_store_dword v3, v4, s[8:11], s43 offen sc1
    s_mov_b64 exec, -1
    s_mov_b32 s43, 0
    ds_read_b128 v[64:67], v9 offset:16384
    s_waitcnt lgkmcnt(2)
    v_mfma_f32_16x16x32_bf16 v[16:19], v[176:179], v[56:59], v[16:19]
    v_permlane16_swap_b32 v80, v82
    v_mfma_f32_16x16x32_bf16 v[20:23], v[248:251], v[56:59], v[20:23]
    v_permlane16_swap_b32 v81, v83
    v_mfma_f32_16x16x32_bf16 v[24:27], a[64:67], v[56:59], v[24:27]
    v_add_f32 v80, v80, v82
    ds_read_b128 v[56:59], v9 offset:18432
    s_waitcnt lgkmcnt(2)
    v_mfma_f32_16x16x32_bf16 v[16:19], v[180:183], v[60:63], v[16:19]
    v_add_f32 v81, v81, v83
    v_mfma_f32_16x16x32_bf16 v[20:23], v[252:255], v[60:63], v[20:23]
    v_mul_f32 v80, 0x3ae38e39, v80
    v_mfma_f32_16x16x32_bf16 v[24:27], a[68:71], v[60:63], v[24:27]
    v_mul_f32 v81, 0x3ae38e39, v81
    ds_read_b128 v[60:63], v9 offset:20480
    s_waitcnt lgkmcnt(2)
    v_mfma_f32_16x16x32_bf16 v[16:19], v[184:187], v[64:67], v[16:19]
    v_fma_f32 v81, -v80, v80, v81
    v_mfma_f32_16x16x32_bf16 v[20:23], a[0:3], v[64:67], v[20:23]
    v_max_f32 v81, 0, v81
    v_mfma_f32_16x16x32_bf16 v[24:27], a[72:75], v[64:67], v[24:27]
    v_add_f32 v81, 0x3727c5ac, v81
    ds_read_b128 v[64:67], v9 offset:22528
    s_waitcnt lgkmcnt(2)
    v_mfma_f32_16x16x32_bf16 v[16:19], v[188:191], v[56:59], v[16:19]
    v_rsq_f32 v92, v81
    v_mfma_f32_16x16x32_bf16 v[20:23], a[4:7], v[56:59], v[20:23]
    v_mul_f32 v93, v80, v92
    v_mfma_f32_16x16x32_bf16 v[24:27], a[76:79], v[56:59], v[24:27]
    ds_write_b64 v11, v[92:93]
    ds_read_b128 v[56:59], v9 offset:24576
    s_waitcnt lgkmcnt(3)
    v_mfma_f32_16x16x32_bf16 v[16:19], v[192:195], v[60:63], v[16:19]
    ds_read_b128 v[96:99], v12
    v_mfma_f32_16x16x32_bf16 v[20:23], a[8:11], v[60:63], v[20:23]
    ds_read_b128 v[100:103], v12 offset:16
    v_mfma_f32_16x16x32_bf16 v[24:27], a[80:83], v[60:63], v[24:27]
    s_add_u32 m0, s59, 0
    s_add_u32 s47, s41, 0
    buffer_load_dwordx4 v0, s[8:11], s47 offen offset:0 lds
    ds_read_b128 v[60:63], v9 offset:26624
    s_waitcnt lgkmcnt(5)
    v_mfma_f32_16x16x32_bf16 v[16:19], v[196:199], v[64:67], v[16:19]
    buffer_load_dwordx4 v0, s[8:11], s47 offen offset:1024 lds
    buffer_load_dwordx4 v0, s[8:11], s47 offen offset:2048 lds
    buffer_load_dwordx4 v0, s[8:11], s47 offen offset:3072 lds
    v_mfma_f32_16x16x32_bf16 v[20:23], a[12:15], v[64:67], v[20:23]
    s_add_u32 m0, s59, 4096
    s_add_u32 s47, s41, 4096
    buffer_load_dwordx4 v0, s[8:11], s47 offen offset:0 lds
    v_mfma_f32_16x16x32_bf16 v[24:27], a[84:87], v[64:67], v[24:27]
    buffer_load_dwordx4 v0, s[8:11], s47 offen offset:1024 lds
    buffer_load_dwordx4 v0, s[8:11], s47 offen offset:2048 lds
    buffer_load_dwordx4 v0, s[8:11], s47 offen offset:3072 lds
    ds_read_b128 v[64:67], v9 offset:28672
    s_waitcnt lgkmcnt(4)
    v_mfma_f32_16x16x32_bf16 v[16:19], v[200:203], v[56:59], v[16:19]
    s_add_u32 m0, s59, 8192
    s_add_u32 s47, s41, 8192
    buffer_load_dwordx4 v0, s[8:11], s47 offen offset:0 lds
    v_mfma_f32_16x16x32_bf16 v[20:23], a[16:19], v[56:59], v[20:23]
    v_mfma_f32_16x16x32_bf16 v[24:27], a[88:91], v[56:59], v[24:27]
    ds_read_b128 v[56:59], v9 offset:30720
    s_waitcnt lgkmcnt(2)
    v_mfma_f32_16x16x32_bf16 v[16:19], v[204:207], v[60:63], v[16:19]
    v_mfma_f32_16x16x32_bf16 v[20:23], a[20:23], v[60:63], v[20:23]
    v_mfma_f32_16x16x32_bf16 v[24:27], a[92:95], v[60:63], v[24:27]
    ds_read_b128 v[60:63], v9 offset:32768
    s_waitcnt lgkmcnt(2)
    v_mfma_f32_16x16x32_bf16 v[16:19], v[208:211], v[64:67], v[16:19]
    v_mfma_f32_16x16x32_bf16 v[20:23], a[24:27], v[64:67], v[20:23]
    v_mfma_f32_16x16x32_bf16 v[24:27], a[96:99], v[64:67], v[24:27]
    ds_read_b128 v[64:67], v9 offset:34816
    s_waitcnt lgkmcnt(2)
    v_mfma_f32_16x16x32_bf16 v[16:19], v[212:215], v[56:59], v[16:19]
    v_cmp_eq_u32 s[76:77], 1, v2
    v_cmp_eq_u32 vcc, 2, v2
    v_mfma_f32_16x16x32_bf16 v[20:23], a[28:31], v[56:59], v[20:23]
    s_cmp_eq_u64 s[76:77], -1
    s_cselect_b32 s38, 1, 0
    v_mfma_f32_16x16x32_bf16 v[24:27], a[100:103], v[56:59], v[24:27]
    s_cmp_lg_u32 s38, 0
    s_cselect_b64 exec, 1, 0
    v_mov_b32 v15, s32
    ds_write_b32 v110, v15
    v_mov_b32 v2, 2
    s_mov_b64 exec, -1
    ds_read_b128 v[56:59], v9 offset:0
    s_waitcnt lgkmcnt(3)
    v_mfma_f32_16x16x32_bf16 v[16:19], v[216:219], v[60:63], v[16:19]
    s_add_u32 s32, s32, s38
    s_mul_i32 s38, s38, 22528
    s_add_u32 s33, s33, s38
    v_mfma_f32_16x16x32_bf16 v[20:23], a[32:35], v[60:63], v[20:23]
    s_cmp_eq_u64 vcc, 0
    s_cselect_b32 s38, s32, 0x7fff
    v_mfma_f32_16x16x32_bf16 v[24:27], a[104:107], v[60:63], v[24:27]
    s_cmp_le_u32 s38, s39
    s_cselect_b64 exec, -1, 0
    v_mov_b32 v2, 2
    buffer_load_dword v2, v1, s[8:11], s33 offen sc1
    s_mov_b64 exec, -1
    ds_read_b128 v[60:63], v9 offset:2048
    s_waitcnt lgkmcnt(3)
    v_mfma_f32_16x16x32_bf16 v[16:19], v[220:223], v[64:67], v[16:19]
    s_mul_i32 s48, s36, 786432
    s_mul_i32 s18, s37, 6144
    s_add_u32 s48, s48, s18
    s_add_u32 s48, s48, 15728640
    buffer_load_dwordx4 v[80:83], v10, s[8:11], s48 offen offset:0
    v_mfma_f32_16x16x32_bf16 v[20:23], a[36:39], v[64:67], v[20:23]
    v_mfma_f32_16x16x32_bf16 v[24:27], a[108:111], v[64:67], v[24:27]
    ds_read_b128 v[64:67], v9 offset:4096
    s_waitcnt lgkmcnt(2)
    v_mfma_f32_16x16x32_bf16 v[28:31], v[56:59], a[112:115], 0
    buffer_load_dwordx4 v[84:87], v10, s[8:11], s48 offen offset:512
    v_mfma_f32_16x16x32_bf16 v[32:35], v[56:59], a[184:187], 0
    ds_read_b128 v[56:59], v9 offset:6144
    s_waitcnt lgkmcnt(2)
    v_mfma_f32_16x16x32_bf16 v[28:31], v[60:63], a[116:119], v[28:31]
    buffer_load_dwordx4 v[88:91], v10, s[8:11], s48 offen offset:1024
    v_mul_f32 v94, v93, v36
    v_fma_f32 v16, v16, v92, -v94
    v_mfma_f32_16x16x32_bf16 v[32:35], v[60:63], a[188:191], v[32:35]
    v_mul_f32 v94, v93, v37
    v_fma_f32 v17, v17, v92, -v94
    ds_read_b128 v[60:63], v9 offset:8192
    s_waitcnt lgkmcnt(2)
    v_mfma_f32_16x16x32_bf16 v[28:31], v[64:67], a[120:123], v[28:31]
    v_mul_f32 v94, v93, v38
    v_fma_f32 v18, v18, v92, -v94
    v_mfma_f32_16x16x32_bf16 v[32:35], v[64:67], a[192:195], v[32:35]
    v_mul_f32 v94, v93, v39
    v_fma_f32 v19, v19, v92, -v94
    ds_read_b128 v[64:67], v9 offset:10240
    s_waitcnt lgkmcnt(2)
    v_mfma_f32_16x16x32_bf16 v[28:31], v[56:59], a[124:127], v[28:31]
    v_mul_f32 v94, v93, v44
    v_fma_f32 v24, v24, v92, -v94
    v_mfma_f32_16x16x32_bf16 v[32:35], v[56:59], a[196:199], v[32:35]
    v_mul_f32 v94, v93, v45
    v_fma_f32 v25, v25, v92, -v94
    ds_read_b128 v[56:59], v9 offset:12288
    s_waitcnt lgkmcnt(2)
    v_mfma_f32_16x16x32_bf16 v[28:31], v[60:63], a[128:131], v[28:31]
    v_mul_f32 v94, v93, v46
    v_fma_f32 v26, v26, v92, -v94
    v_mfma_f32_16x16x32_bf16 v[32:35], v[60:63], a[200:203], v[32:35]
    v_mul_f32 v94, v93, v47
    v_fma_f32 v27, v27, v92, -v94
    ds_read_b128 v[60:63], v9 offset:14336
    s_waitcnt lgkmcnt(2)
    v_mfma_f32_16x16x32_bf16 v[28:31], v[64:67], a[132:135], v[28:31]
    v_mul_f32 v94, v93, v40
    v_fma_f32 v20, v20, v92, -v94
    v_mfma_f32_16x16x32_bf16 v[32:35], v[64:67], a[204:207], v[32:35]
    v_mul_f32 v94, v93, v41
    v_fma_f32 v21, v21, v92, -v94
    ds_read_b128 v[64:67], v9 offset:16384
    s_waitcnt lgkmcnt(2)
    v_mfma_f32_16x16x32_bf16 v[28:31], v[56:59], a[136:139], v[28:31]
    v_mul_f32 v94, v93, v42
    v_fma_f32 v22, v22, v92, -v94
    v_mfma_f32_16x16x32_bf16 v[32:35], v[56:59], a[208:211], v[32:35]
    v_mul_f32 v94, v93, v43
    v_fma_f32 v23, v23, v92, -v94
    ds_read_b128 v[56:59], v9 offset:18432
    s_waitcnt lgkmcnt(2)
    v_mfma_f32_16x16x32_bf16 v[28:31], v[60:63], a[140:143], v[28:31]
    v_cvt_pk_bf16_f32 v128, v16, v17
    v_cvt_pk_bf16_f32 v129, v18, v19
    v_mfma_f32_16x16x32_bf16 v[32:35], v[60:63], a[212:215], v[32:35]
    v_cvt_pk_bf16_f32 v130, v24, v25
    v_cvt_pk_bf16_f32 v132, v20, v21
    ds_read_b128 v[60:63], v9 offset:20480
    s_waitcnt lgkmcnt(2)
    v_mfma_f32_16x16x32_bf16 v[28:31], v[64:67], a[144:147], v[28:31]
    v_cvt_pk_bf16_f32 v133, v22, v23
    v_cvt_pk_bf16_f32 v134, v26, v27
    v_mfma_f32_16x16x32_bf16 v[32:35], v[64:67], a[216:219], v[32:35]
    s_cmp_eq_u32 s35, 0
    s_cselect_b32 s46, 0xf149f2ca, 0
    ds_read_b128 v[64:67], v9 offset:22528
    s_waitcnt lgkmcnt(2)
    v_mfma_f32_16x16x32_bf16 v[28:31], v[56:59], a[148:151], v[28:31]
    v_mfma_f32_16x16x32_bf16 v[144:147], v[112:115], v[128:131], 0
    v_mfma_f32_16x16x32_bf16 v[32:35], v[56:59], a[220:223], v[32:35]
    v_mfma_f32_16x16x32_bf16 v[148:151], v[132:135], v[128:131], 0
    ds_read_b128 v[56:59], v9 offset:24576
    s_waitcnt lgkmcnt(2)
    v_mfma_f32_16x16x32_bf16 v[28:31], v[60:63], a[152:155], v[28:31]
    v_mov_b32 v112, v132
    v_mfma_f32_16x16x32_bf16 v[32:35], v[60:63], a[224:227], v[32:35]
    v_mov_b32 v113, v133
    v_mov_b32 v114, v134
    ds_read_b128 v[60:63], v9 offset:26624
    s_waitcnt lgkmcnt(2)
    v_mfma_f32_16x16x32_bf16 v[28:31], v[64:67], a[156:159], v[28:31]
    v_mfma_f32_16x16x32_bf16 v[32:35], v[64:67], a[228:231], v[32:35]
    v_fma_f32 v144, v144, s52, v72
    ds_read_b128 v[64:67], v9 offset:28672
    s_waitcnt lgkmcnt(2)
    v_mfma_f32_16x16x32_bf16 v[28:31], v[56:59], a[160:163], v[28:31]
    v_fma_f32 v145, v145, s52, v73
    v_fma_f32 v146, v146, s52, v74
    v_fma_f32 v147, v147, s52, v75
    v_mfma_f32_16x16x32_bf16 v[32:35], v[56:59], a[232:235], v[32:35]
    v_fma_f32 v148, v148, s52, v76
    v_fma_f32 v149, v149, s52, v77
    v_fma_f32 v150, v150, s52, v78
    ds_read_b128 v[56:59], v9 offset:30720
    s_waitcnt lgkmcnt(2)
    v_mfma_f32_16x16x32_bf16 v[28:31], v[60:63], a[164:167], v[28:31]
    v_fma_f32 v151, v151, s52, v79
    v_add_f32 v144, s46, v144
    v_add_f32 v145, s46, v145
    v_mfma_f32_16x16x32_bf16 v[32:35], v[60:63], a[236:239], v[32:35]
    v_add_f32 v146, s46, v146
    v_add_f32 v147, s46, v147
    v_max3_f32 v5, v144, v145, v146
    ds_read_b128 v[60:63], v9 offset:32768
    s_waitcnt lgkmcnt(2)
    v_mfma_f32_16x16x32_bf16 v[28:31], v[64:67], a[168:171], v[28:31]
    v_max3_f32 v5, v5, v147, v148
    v_max3_f32 v5, v5, v149, v150
    v_max_f32 v5, v5, v151
    v_mfma_f32_16x16x32_bf16 v[32:35], v[64:67], a[240:243], v[32:35]
    v_mov_b32 v6, v5
    s_nop 1
    v_permlane32_swap_b32 v5, v6
    ds_read_b128 v[64:67], v9 offset:34816
    s_waitcnt lgkmcnt(2)
    v_mfma_f32_16x16x32_bf16 v[28:31], v[56:59], a[172:175], v[28:31]
    v_max_f32 v5, v5, v6
    v_mov_b32 v6, v5
    v_mfma_f32_16x16x32_bf16 v[32:35], v[56:59], a[244:247], v[32:35]
    s_nop 0
    v_permlane16_swap_b32 v5, v6
    v_max_f32 v5, v5, v6
    v_sub_f32 v144, v144, v5
    s_waitcnt lgkmcnt(1)
    v_mfma_f32_16x16x32_bf16 v[28:31], v[60:63], a[176:179], v[28:31]
    v_sub_f32 v145, v145, v5
    v_sub_f32 v146, v146, v5
    v_sub_f32 v147, v147, v5
    v_mfma_f32_16x16x32_bf16 v[32:35], v[60:63], a[248:251], v[32:35]
    v_sub_f32 v148, v148, v5
    v_sub_f32 v149, v149, v5
    v_sub_f32 v150, v150, v5
    s_waitcnt lgkmcnt(0)
    v_mfma_f32_16x16x32_bf16 v[28:31], v[64:67], a[180:183], v[28:31]
    v_sub_f32 v151, v151, v5
    v_exp_f32 v144, v144
    v_exp_f32 v145, v145
    v_mfma_f32_16x16x32_bf16 v[32:35], v[64:67], a[252:255], v[32:35]
    v_exp_f32 v146, v146
    v_exp_f32 v147, v147
    v_exp_f32 v148, v148
    v_cmp_eq_u32 s[76:77], 1, v2
    v_cmp_eq_u32 vcc, 2, v2
    s_cmp_eq_u64 s[76:77], -1
    s_cselect_b32 s38, 1, 0
    s_cmp_lg_u32 s38, 0
    s_cselect_b64 exec, 1, 0
    v_mov_b32 v15, s32
    ds_write_b32 v110, v15
    v_mov_b32 v2, 2
    s_mov_b64 exec, -1
    s_add_u32 s32, s32, s38
    s_mul_i32 s38, s38, 22528
    s_add_u32 s33, s33, s38
    s_cmp_eq_u64 vcc, 0
    s_cselect_b32 s38, s32, 0x7fff
    s_cmp_le_u32 s38, s39
    s_cselect_b64 exec, -1, 0
    v_mov_b32 v2, 2
    buffer_load_dword v2, v1, s[8:11], s33 offen sc1
    s_mov_b64 exec, -1
    v_exp_f32 v149, v149
    v_exp_f32 v150, v150
    v_exp_f32 v151, v151
    v_cvt_pk_bf16_f32 v68, v144, v145
    v_cvt_pk_bf16_f32 v69, v146, v147
    v_cvt_pk_bf16_f32 v70, v148, v149
    v_cvt_pk_bf16_f32 v71, v150, v151
    s_nop 1
    v_mfma_f32_16x16x32_bf16 v[16:19], v[116:119], v[68:71], 0
    s_mul_i32 s46, s57, 36864
    s_add_u32 s46, s46, 17301504
    s_nop 5
    v_rcp_f32 v6, v16
    v_mul_f32 v94, v97, v48
    v_fma_f32 v28, v28, v96, -v94
    v_mul_f32 v94, v99, v49
    v_fma_f32 v29, v29, v98, -v94
    v_mul_f32 v94, v101, v50
    v_fma_f32 v30, v30, v100, -v94
    v_mul_f32 v94, v103, v51
    v_fma_f32 v31, v31, v102, -v94
    v_cvt_pk_bf16_f32 v138, v28, v29
    v_cvt_pk_bf16_f32 v139, v30, v31
    v_mul_f32 v94, v97, v52
    v_fma_f32 v32, v32, v96, -v94
    v_mfma_f32_16x16x32_bf16 v[20:23], v[136:139], v[68:71], 0
    v_mul_f32 v94, v99, v53
    v_fma_f32 v33, v33, v98, -v94
    v_mul_f32 v94, v101, v54
    v_fma_f32 v34, v34, v100, -v94
    v_mul_f32 v94, v103, v55
    v_fma_f32 v35, v35, v102, -v94
    v_cvt_pk_bf16_f32 v142, v32, v33
    v_cvt_pk_bf16_f32 v143, v34, v35
    v_mov_b32 v136, v138
    v_mov_b32 v137, v139
    v_mfma_f32_16x16x32_bf16 v[24:27], v[140:143], v[68:71], 0
    v_mul_f32 v20, v6, v20
    v_mul_f32 v21, v6, v21
    v_mul_f32 v22, v6, v22
    v_mul_f32 v23, v6, v23
    v_cvt_pk_bf16_f32 v20, v20, v21
    v_cvt_pk_bf16_f32 v21, v22, v23
    s_mov_b64 exec, -1
    buffer_store_dwordx2 v[20:21], v13, s[8:11], s46 offen
    s_and_b64 exec, exec, s[78:79]
    buffer_store_dwordx2 v[20:21], v13, s[8:11], s46 offen sc1
    s_mov_b64 exec, -1
    v_mov_b32 v140, v142
    v_mov_b32 v141, v143
    v_mul_f32 v24, v6, v24
    v_mul_f32 v25, v6, v25
    v_cvt_pk_bf16_f32 v24, v24, v25
    s_mov_b64 exec, 0xffff
    buffer_store_dword v24, v14, s[8:11], s46 offen
    s_and_b64 exec, exec, s[78:79]
    buffer_store_dword v24, v14, s[8:11], s46 offen sc1
    s_mov_b64 exec, -1
    s_mul_i32 s43, s57, 22528
    s_add_u32 s43, s43, s49
    s_branch Laq_head
Laq_f_8:
    ds_read_b128 v[60:63], v9 offset:8192
    s_waitcnt lgkmcnt(2)
    v_mfma_f32_16x16x32_bf16 v[28:31], v[64:67], a[120:123], v[28:31]
    v_mul_f32 v94, v93, v38
    v_fma_f32 v18, v18, v92, -v94
    v_mfma_f32_16x16x32_bf16 v[32:35], v[64:67], a[192:195], v[32:35]
    v_mul_f32 v94, v93, v39
    v_fma_f32 v19, v19, v92, -v94
    ds_read_b128 v[64:67], v9 offset:10240
    s_waitcnt lgkmcnt(2)
    v_mfma_f32_16x16x32_bf16 v[28:31], v[56:59], a[124:127], v[28:31]
    v_mul_f32 v94, v93, v44
    v_fma_f32 v24, v24, v92, -v94
    v_mfma_f32_16x16x32_bf16 v[32:35], v[56:59], a[196:199], v[32:35]
    v_mul_f32 v94, v93, v45
    v_fma_f32 v25, v25, v92, -v94
    ds_read_b128 v[56:59], v9 offset:12288
    s_waitcnt lgkmcnt(2)
    v_mfma_f32_16x16x32_bf16 v[28:31], v[60:63], a[128:131], v[28:31]
    v_mul_f32 v94, v93, v46
    v_fma_f32 v26, v26, v92, -v94
    v_mfma_f32_16x16x32_bf16 v[32:35], v[60:63], a[200:203], v[32:35]
    v_mul_f32 v94, v93, v47
    v_fma_f32 v27, v27, v92, -v94
    ds_read_b128 v[60:63], v9 offset:14336
    s_waitcnt lgkmcnt(2)
    v_mfma_f32_16x16x32_bf16 v[28:31], v[64:67], a[132:135], v[28:31]
    v_mul_f32 v94, v93, v40
    v_fma_f32 v20, v20, v92, -v94
    v_mfma_f32_16x16x32_bf16 v[32:35], v[64:67], a[204:207], v[32:35]
    v_mul_f32 v94, v93, v41
    v_fma_f32 v21, v21, v92, -v94
    ds_read_b128 v[64:67], v9 offset:16384
    s_waitcnt lgkmcnt(2)
    v_mfma_f32_16x16x32_bf16 v[28:31], v[56:59], a[136:139], v[28:31]
    v_mul_f32 v94, v93, v42
    v_fma_f32 v22, v22, v92, -v94
    v_mfma_f32_16x16x32_bf16 v[32:35], v[56:59], a[208:211], v[32:35]
    v_mul_f32 v94, v93, v43
    v_fma_f32 v23, v23, v92, -v94
    ds_read_b128 v[56:59], v9 offset:18432
    s_waitcnt lgkmcnt(2)
    v_mfma_f32_16x16x32_bf16 v[28:31], v[60:63], a[140:143], v[28:31]
    v_cvt_pk_bf16_f32 v128, v16, v17
    v_cvt_pk_bf16_f32 v129, v18, v19
    v_mfma_f32_16x16x32_bf16 v[32:35], v[60:63], a[212:215], v[32:35]
    v_cvt_pk_bf16_f32 v130, v24, v25
    v_cvt_pk_bf16_f32 v132, v20, v21
    ds_read_b128 v[60:63], v9 offset:20480
    s_waitcnt lgkmcnt(2)
    v_mfma_f32_16x16x32_bf16 v[28:31], v[64:67], a[144:147], v[28:31]
    v_cvt_pk_bf16_f32 v133, v22, v23
    v_cvt_pk_bf16_f32 v134, v26, v27
    v_mfma_f32_16x16x32_bf16 v[32:35], v[64:67], a[216:219], v[32:35]
    s_cmp_eq_u32 s35, 0
    s_cselect_b32 s46, 0xf149f2ca, 0
    ds_read_b128 v[64:67], v9 offset:22528
    s_waitcnt lgkmcnt(2)
    v_mfma_f32_16x16x32_bf16 v[28:31], v[56:59], a[148:151], v[28:31]
    s_add_u32 m0, s59, 0
    s_add_u32 s47, s41, 0
    buffer_load_dwordx4 v0, s[8:11], s47 offen offset:0 lds
    v_mfma_f32_16x16x32_bf16 v[144:147], v[112:115], v[128:131], 0
    buffer_load_dwordx4 v0, s[8:11], s47 offen offset:1024 lds
    buffer_load_dwordx4 v0, s[8:11], s47 offen offset:2048 lds
    buffer_load_dwordx4 v0, s[8:11], s47 offen offset:3072 lds
    v_mfma_f32_16x16x32_bf16 v[32:35], v[56:59], a[220:223], v[32:35]
    s_add_u32 m0, s59, 4096
    s_add_u32 s47, s41, 4096
    buffer_load_dwordx4 v0, s[8:11], s47 offen offset:0 lds
    v_mfma_f32_16x16x32_bf16 v[148:151], v[132:135], v[128:131], 0
    buffer_load_dwordx4 v0, s[8:11], s47 offen offset:1024 lds
    buffer_load_dwordx4 v0, s[8:11], s47 offen offset:2048 lds
    buffer_load_dwordx4 v0, s[8:11], s47 offen offset:3072 lds
    ds_read_b128 v[56:59], v9 offset:24576
    s_waitcnt lgkmcnt(2)
    v_mfma_f32_16x16x32_bf16 v[28:31], v[60:63], a[152:155], v[28:31]
    v_mov_b32 v112, v132
    v_mfma_f32_16x16x32_bf16 v[32:35], v[60:63], a[224:227], v[32:35]
    v_mov_b32 v113, v133
    v_mov_b32 v114, v134
    ds_read_b128 v[60:63], v9 offset:26624
    s_waitcnt lgkmcnt(2)
    v_mfma_f32_16x16x32_bf16 v[28:31], v[64:67], a[156:159], v[28:31]
    s_add_u32 m0, s59, 8192
    s_add_u32 s47, s41, 8192
    buffer_load_dwordx4 v0, s[8:11], s47 offen offset:0 lds
    v_mfma_f32_16x16x32_bf16 v[32:35], v[64:67], a[228:231], v[32:35]
    s_mul_i32 s48, s36, 786432
    s_mul_i32 s18, s37, 6144
    s_add_u32 s48, s48, s18
    s_add_u32 s48, s48, 15728640
    buffer_load_dwordx4 v[80:83], v10, s[8:11], s48 offen offset:0
    v_fma_f32 v144, v144, s52, v72
    ds_read_b128 v[64:67], v9 offset:28672
    s_waitcnt lgkmcnt(2)
    v_mfma_f32_16x16x32_bf16 v[28:31], v[56:59], a[160:163], v[28:31]
    v_fma_f32 v145, v145, s52, v73
    v_fma_f32 v146, v146, s52, v74
    v_fma_f32 v147, v147, s52, v75
    v_mfma_f32_16x16x32_bf16 v[32:35], v[56:59], a[232:235], v[32:35]
    v_fma_f32 v148, v148, s52, v76
    v_fma_f32 v149, v149, s52, v77
    v_fma_f32 v150, v150, s52, v78
    ds_read_b128 v[56:59], v9 offset:30720
    s_waitcnt lgkmcnt(2)
    v_mfma_f32_16x16x32_bf16 v[28:31], v[60:63], a[164:167], v[28:31]
    v_fma_f32 v151, v151, s52, v79
    v_add_f32 v144, s46, v144
    v_add_f32 v145, s46, v145
    v_mfma_f32_16x16x32_bf16 v[32:35], v[60:63], a[236:239], v[32:35]
    v_add_f32 v146, s46, v146
    v_add_f32 v147, s46, v147
    v_max3_f32 v5, v144, v145, v146
    ds_read_b128 v[60:63], v9 offset:32768
    s_waitcnt lgkmcnt(2)
    v_mfma_f32_16x16x32_bf16 v[28:31], v[64:67], a[168:171], v[28:31]
    v_max3_f32 v5, v5, v147, v148
    v_max3_f32 v5, v5, v149, v150
    v_max_f32 v5, v5, v151
    v_mfma_f32_16x16x32_bf16 v[32:35], v[64:67], a[240:243], v[32:35]
    buffer_load_dwordx4 v[84:87], v10, s[8:11], s48 offen offset:512
    v_mov_b32 v6, v5
    s_nop 1
    v_permlane32_swap_b32 v5, v6
    ds_read_b128 v[64:67], v9 offset:34816
    s_waitcnt lgkmcnt(2)
    v_mfma_f32_16x16x32_bf16 v[28:31], v[56:59], a[172:175], v[28:31]
    buffer_load_dwordx4 v[88:91], v10, s[8:11], s48 offen offset:1024
    v_max_f32 v5, v5, v6
    v_mov_b32 v6, v5
    v_mfma_f32_16x16x32_bf16 v[32:35], v[56:59], a[244:247], v[32:35]
    s_nop 0
    v_permlane16_swap_b32 v5, v6
    v_max_f32 v5, v5, v6
    v_sub_f32 v144, v144, v5
    s_waitcnt lgkmcnt(1)
    v_mfma_f32_16x16x32_bf16 v[28:31], v[60:63], a[176:179], v[28:31]
    v_sub_f32 v145, v145, v5
    v_sub_f32 v146, v146, v5
    v_sub_f32 v147, v147, v5
    v_mfma_f32_16x16x32_bf16 v[32:35], v[60:63], a[248:251], v[32:35]
    v_sub_f32 v148, v148, v5
    v_sub_f32 v149, v149, v5
    v_sub_f32 v150, v150, v5
    s_waitcnt lgkmcnt(0)
    v_mfma_f32_16x16x32_bf16 v[28:31], v[64:67], a[180:183], v[28:31]
    v_sub_f32 v151, v151, v5
    v_exp_f32 v144, v144
    v_exp_f32 v145, v145
    v_mfma_f32_16x16x32_bf16 v[32:35], v[64:67], a[252:255], v[32:35]
    v_exp_f32 v146, v146
    v_exp_f32 v147, v147
    v_exp_f32 v148, v148
    v_cmp_eq_u32 s[76:77], 1, v2
    v_cmp_eq_u32 vcc, 2, v2
    s_cmp_eq_u64 s[76:77], -1
    s_cselect_b32 s38, 1, 0
    s_cmp_lg_u32 s38, 0
    s_cselect_b64 exec, 1, 0
    v_mov_b32 v15, s32
    ds_write_b32 v110, v15
    v_mov_b32 v2, 2
    s_mov_b64 exec, -1
    s_add_u32 s32, s32, s38
    s_mul_i32 s38, s38, 22528
    s_add_u32 s33, s33, s38
    s_cmp_eq_u64 vcc, 0
    s_cselect_b32 s38, s32, 0x7fff
    s_cmp_le_u32 s38, s39
    s_cselect_b64 exec, -1, 0
    v_mov_b32 v2, 2
    buffer_load_dword v2, v1, s[8:11], s33 offen sc1
    s_mov_b64 exec, -1
    v_exp_f32 v149, v149
    v_exp_f32 v150, v150
    v_exp_f32 v151, v151
    v_cvt_pk_bf16_f32 v68, v144, v145
    v_cvt_pk_bf16_f32 v69, v146, v147
    v_cvt_pk_bf16_f32 v70, v148, v149
    v_cvt_pk_bf16_f32 v71, v150, v151
    s_nop 1
    v_mfma_f32_16x16x32_bf16 v[16:19], v[116:119], v[68:71], 0
    s_mul_i32 s46, s57, 36864
    s_add_u32 s46, s46, 17301504
    s_nop 5
    v_rcp_f32 v6, v16
    v_mul_f32 v94, v97, v48
    v_fma_f32 v28, v28, v96, -v94
    v_mul_f32 v94, v99, v49
    v_fma_f32 v29, v29, v98, -v94
    v_mul_f32 v94, v101, v50
    v_fma_f32 v30, v30, v100, -v94
    v_mul_f32 v94, v103, v51
    v_fma_f32 v31, v31, v102, -v94
    v_cvt_pk_bf16_f32 v138, v28, v29
    v_cvt_pk_bf16_f32 v139, v30, v31
    v_mul_f32 v94, v97, v52
    v_fma_f32 v32, v32, v96, -v94
    v_mfma_f32_16x16x32_bf16 v[20:23], v[136:139], v[68:71], 0
    v_mul_f32 v94, v99, v53
    v_fma_f32 v33, v33, v98, -v94
    v_mul_f32 v94, v101, v54
    v_fma_f32 v34, v34, v100, -v94
    v_mul_f32 v94, v103, v55
    v_fma_f32 v35, v35, v102, -v94
    v_cvt_pk_bf16_f32 v142, v32, v33
    v_cvt_pk_bf16_f32 v143, v34, v35
    v_mov_b32 v136, v138
    v_mov_b32 v137, v139
    v_mfma_f32_16x16x32_bf16 v[24:27], v[140:143], v[68:71], 0
    v_mul_f32 v20, v6, v20
    v_mul_f32 v21, v6, v21
    v_mul_f32 v22, v6, v22
    v_mul_f32 v23, v6, v23
    v_cvt_pk_bf16_f32 v20, v20, v21
    v_cvt_pk_bf16_f32 v21, v22, v23
    s_mov_b64 exec, -1
    buffer_store_dwordx2 v[20:21], v13, s[8:11], s46 offen
    s_and_b64 exec, exec, s[78:79]
    buffer_store_dwordx2 v[20:21], v13, s[8:11], s46 offen sc1
    s_mov_b64 exec, -1
    v_mov_b32 v140, v142
    v_mov_b32 v141, v143
    v_mul_f32 v24, v6, v24
    v_mul_f32 v25, v6, v25
    v_cvt_pk_bf16_f32 v24, v24, v25
    s_mov_b64 exec, 0xffff
    buffer_store_dword v24, v14, s[8:11], s46 offen
    s_and_b64 exec, exec, s[78:79]
    buffer_store_dword v24, v14, s[8:11], s46 offen sc1
    s_mov_b64 exec, -1
    s_mul_i32 s43, s57, 22528
    s_add_u32 s43, s43, s49
    s_branch Laq_head
Laq_none:
    ds_read_b32 v15, v110
    s_waitcnt lgkmcnt(0)
    v_readfirstlane_b32 s17, v15
    s_nop 0
    s_cmp_lt_i32 s17, s37
    s_cbranch_scc1 Laq_nopost
    s_add_u32 m0, s59, 0
    s_add_u32 s47, s41, 0
    buffer_load_dwordx4 v0, s[8:11], s47 offen offset:0 lds
    buffer_load_dwordx4 v0, s[8:11], s47 offen offset:1024 lds
    buffer_load_dwordx4 v0, s[8:11], s47 offen offset:2048 lds
    buffer_load_dwordx4 v0, s[8:11], s47 offen offset:3072 lds
    s_add_u32 m0, s59, 4096
    s_add_u32 s47, s41, 4096
    buffer_load_dwordx4 v0, s[8:11], s47 offen offset:0 lds
    buffer_load_dwordx4 v0, s[8:11], s47 offen offset:1024 lds
    buffer_load_dwordx4 v0, s[8:11], s47 offen offset:2048 lds
    buffer_load_dwordx4 v0, s[8:11], s47 offen offset:3072 lds
    s_add_u32 m0, s59, 8192
    s_add_u32 s47, s41, 8192
    buffer_load_dwordx4 v0, s[8:11], s47 offen offset:0 lds
    s_mul_i32 s48, s36, 786432
    s_mul_i32 s18, s37, 6144
    s_add_u32 s48, s48, s18
    s_add_u32 s48, s48, 15728640
    buffer_load_dwordx4 v[80:83], v10, s[8:11], s48 offen offset:0
    buffer_load_dwordx4 v[84:87], v10, s[8:11], s48 offen offset:512
    buffer_load_dwordx4 v[88:91], v10, s[8:11], s48 offen offset:1024
    s_waitcnt vmcnt(12)
    s_cmp_lg_u32 s43, 0
    s_cselect_b64 exec, 1, 0
    buffer_store_dword v3, v4, s[8:11], s43 offen
    s_and_b64 exec, exec, s[78:79]
    buffer_store_dword v3, v4, s[8:11], s43 offen sc1
    s_mov_b64 exec, -1
    s_mov_b32 s43, 0
    s_waitcnt vmcnt(2) lgkmcnt(0)
    s_branch Laq_head2
Laq_nopost:
    s_waitcnt vmcnt(0)
    s_cmp_lg_u32 s43, 0
    s_cselect_b64 exec, 1, 0
    buffer_store_dword v3, v4, s[8:11], s43 offen
    s_and_b64 exec, exec, s[78:79]
    buffer_store_dword v3, v4, s[8:11], s43 offen sc1
    s_mov_b64 exec, -1
    s_mov_b32 s43, 0
    s_cmp_ge_u32 s37, 64
    s_cbranch_scc1 Laq_end
Laq_wait:
    s_mov_b32 s16, 0
    s_cmp_lg_u32 s14, 0
    s_cbranch_scc1 Laq_wl
Laq_wp:
    buffer_load_dword v2, v1, s[8:11], s60 offen sc1
    s_add_u32 s16, s16, 1
    s_cmp_gt_u32 s16, 100000
    s_cbranch_scc1 Laq_giveup
    s_waitcnt vmcnt(0)
    v_cmp_eq_u32 vcc, 0, v2
    s_nop 0
    s_cbranch_vccz Laq_wok
    s_sleep 4
    s_branch Laq_wp
Laq_giveup:
    v_mov_b32 v5, -2
    ds_write_b32 v110, v5
    s_waitcnt lgkmcnt(0)
    s_branch L_role_aq_abort
Laq_wok:
    v_mov_b32 v5, s37
    ds_write_b32 v110, v5
    s_branch Laq_go
Laq_wl:
    ds_read_b32 v15, v110
    s_add_u32 s16, s16, 1
    s_cmp_gt_u32 s16, 1600000
    s_cbranch_scc1 L_role_aq_abort
    s_waitcnt lgkmcnt(0)
    v_readfirstlane_b32 s17, v15
    s_nop 0
    s_cmp_eq_u32 s17, -2
    s_cbranch_scc1 L_role_aq_abort
    s_cmp_ge_i32 s17, s37
    s_cbranch_scc1 Laq_go
    s_sleep 1
    s_branch Laq_wl
Laq_go:
    s_add_u32 m0, s59, 0
    s_add_u32 s47, s41, 0
    buffer_load_dwordx4 v0, s[8:11], s47 offen offset:0 lds
    buffer_load_dwordx4 v0, s[8:11], s47 offen offset:1024 lds
    buffer_load_dwordx4 v0, s[8:11], s47 offen offset:2048 lds
    buffer_load_dwordx4 v0, s[8:11], s47 offen offset:3072 lds
    s_add_u32 m0, s59, 4096
    s_add_u32 s47, s41, 4096
    buffer_load_dwordx4 v0, s[8:11], s47 offen offset:0 lds
    buffer_load_dwordx4 v0, s[8:11], s47 offen offset:1024 lds
    buffer_load_dwordx4 v0, s[8:11], s47 offen offset:2048 lds
    buffer_load_dwordx4 v0, s[8:11], s47 offen offset:3072 lds
    s_add_u32 m0, s59, 8192
    s_add_u32 s47, s41, 8192
    buffer_load_dwordx4 v0, s[8:11], s47 offen offset:0 lds
    s_mul_i32 s48, s36, 786432
    s_mul_i32 s18, s37, 6144
    s_add_u32 s48, s48, s18
    s_add_u32 s48, s48, 15728640
    buffer_load_dwordx4 v[80:83], v10, s[8:11], s48 offen offset:0
    buffer_load_dwordx4 v[84:87], v10, s[8:11], s48 offen offset:512
    buffer_load_dwordx4 v[88:91], v10, s[8:11], s48 offen offset:1024
    s_waitcnt vmcnt(0) lgkmcnt(0)
    s_branch Laq_head2
Laq_end:
    s_branch L_role_aq_exit
L_role_aq_abort:
    s_waitcnt lgkmcnt(0)
    s_mov_b64 exec, -1
    v_mov_b32 v0, 60
    s_lshl_b32 s5, s3, 8
    s_or_b32 s5, s5, s4
    s_or_b32 s5, s5, 0x10000
    v_mov_b32 v1, s5
    global_store_dword v0, v1, s[12:13]
    s_endpgm
L_role_aq_exit:
    s_endpgm
.p2align 6
L_role_ta:
    v_and_b32 v5, 63, v0
    v_lshlrev_b32 v0, 4, v5
    v_and_b32 v7, 15, v5
    v_lshrrev_b32 v8, 4, v5
    v_min_u32 v1, 12, v5
    v_lshrrev_b32 v6, 2, v1
    v_and_b32 v1, 3, v1
    v_lshlrev_b32 v1, 2, v1
    v_lshl_add_u32 v1, v6, 7, v1
    v_mov_b32 v3, 1
    v_mov_b32 v4, 0
    s_mov_b32 s44, 0x05040100
    s_mov_b32 s45, 0x07060302
    s_cmp_ge_u32 s15, 11
    s_cselect_b32 s36, 1, 0
    s_cselect_b32 s17, 11, 0
    s_sub_u32 s17, s15, s17
    s_mul_i32 s50, s17, 3
    s_add_u32 s50, s50, s14
    s_cmp_eq_u32 s14, 3
    s_cselect_b32 s50, 32, s50
    s_mov_b32 s40, s50
    s_mov_b32 s37, 0
    s_mov_b32 s52, 0x3e0293ee
    v_lshrrev_b32 v5, 2, v7
    v_and_b32 v6, 1, v7
    v_lshl_add_u32 v5, v5, 1, v6
    v_lshlrev_b32 v9, 8, v5
    v_lshl_add_u32 v9, v8, 4, v9
    v_lshrrev_b32 v10, 1, v0
    v_mov_b32 v11, 384
    v_mov_b32 v6, 0xf149f2ca
    v_mov_b32 v21, 0
    v_mov_b32 v22, 0
    s_mul_i32 s42, s36, 1441792
    s_lshl_b32 s17, s50, 9
    s_add_u32 s42, s42, s17
    s_add_u32 s42, s42, 5376
    s_mul_i32 s51, s36, 50331648
    s_lshl_b32 s17, s50, 13
    s_add_u32 s51, s51, s17
    s_add_u32 s51, s51, 44040192
    s_lshl_b32 s47, s36, 11
    s_add_u32 s47, s47, s50
    s_lshl_b32 s48, s47, 13
    s_add_u32 s48, s48, 144703488
    s_lshl_b32 s47, s47, 12
    s_add_u32 s47, s47, 27262976
    s_mul_i32 s43, s36, 1441792
    s_lshr_b32 s17, s50, 2
    s_lshl_b32 s17, s17, 7
    s_add_u32 s43, s43, s17
    s_and_b32 s17, s50, 3
    s_lshl_b32 s17, s17, 2
    s_add_u32 s43, s43, s17
    s_add_u32 s43, s43, 4224
    s_mov_b32 s28, s8
    s_mov_b32 s29, s9
    s_mov_b32 s30, 0
    s_mov_b32 s31, 0x00020000
    s_mov_b32 s39, 0
    s_mov_b32 s38, 0
    s_mov_b32 s49, 0
    s_mov_b32 s20, s8
    s_mov_b32 s21, s9
    s_mov_b32 s22, 0
    s_mov_b32 s23, 0x00020000
    v_mov_b32 v16, 0x3f803f80
    v_lshl_add_u32 v5, v8, 2, 0
    v_cmp_le_u32 vcc, v5, v7
    s_nop 1
    v_cndmask_b32 v236, v6, v4, vcc
    v_mov_b32 v17, 0x3f803f80
    v_lshl_add_u32 v5, v8, 2, 1
    v_cmp_le_u32 vcc, v5, v7
    s_nop 1
    v_cndmask_b32 v237, v6, v4, vcc
    v_mov_b32 v18, 0x3f803f80
    v_lshl_add_u32 v5, v8, 2, 2
    v_cmp_le_u32 vcc, v5, v7
    s_nop 1
    v_cndmask_b32 v238, v6, v4, vcc
    v_mov_b32 v19, 0x3f803f80
    v_lshl_add_u32 v5, v8, 2, 3
    v_cmp_le_u32 vcc, v5, v7
    s_nop 1
    v_cndmask_b32 v239, v6, v4, vcc
    v_mov_b32 v15, 0
    s_cmp_lg_u32 s14, 0
    s_cbranch_scc1 Lta_inia_d
    v_mov_b32 v5, 40
    s_mov_b32 s16, 0
Lta_inia:
    global_load_dword v6, v5, s[12:13] sc1
    s_add_u32 s16, s16, 1
    s_cmp_gt_u32 s16, 100000
    s_cbranch_scc1 L_role_ta_abort
    s_waitcnt vmcnt(0)
    v_cmp_gt_u32 vcc, 128, v6
    s_nop 0
    s_cbranch_vccz Lta_inia_d
    s_sleep 8
    s_branch Lta_inia
Lta_inia_d:
    s_barrier
    s_cmp_eq_u32 s36, 0
    s_cbranch_scc1 Lta_ini_sk
    s_cmp_lg_u32 s14, 0
    s_cbranch_scc1 Lta_inib_d
    v_mov_b32 v5, 160
    s_mov_b32 s16, 0
Lta_inib:
    global_load_dword v6, v5, s[12:13] sc1
    s_add_u32 s16, s16, 1
    s_cmp_gt_u32 s16, 100000
    s_cbranch_scc1 L_role_ta_abort
    s_waitcnt vmcnt(0)
    v_cmp_gt_u32 vcc, 64, v6
    s_nop 0
    s_cbranch_vccz Lta_inib_d
    s_sleep 8
    s_branch Lta_inib
Lta_inib_d:
    s_barrier
Lta_ini_sk:
    s_cmp_ge_u32 s40, 32
    s_cbranch_scc1 L_role_ta_exit
Lta0:
    s_cmp_eq_u32 s39, 1
    s_cbranch_scc1 Lta0_have
    s_waitcnt vmcnt(0)
    s_cmp_lg_u32 s49, 0
    s_cselect_b64 exec, 1, 0
    buffer_store_dword v3, v4, s[8:11], s43 offen sc1
    s_mov_b64 exec, -1
    s_add_u32 s43, s43, s49
    s_mov_b32 s49, 0
    s_mov_b32 s16, 0
Lta0_f:
    buffer_load_dword v2, v1, s[8:11], s42 offen sc1
    s_add_u32 s16, s16, 1
    s_cmp_gt_u32 s16, 100000
    s_cbranch_scc1 L_role_ta_abort
    s_waitcnt vmcnt(0)
    v_cmp_eq_u32 vcc, 0, v2
    s_nop 0
    s_and_b32 s17, vcc_lo, 0xfff
    s_cbranch_scc0 Lta0_fd
    s_sleep 4
    s_branch Lta0_f
Lta0_fd:
    s_add_u32 s46, s51, 0
    buffer_load_dwordx4 v[140:143], v0, s[8:11], s46 offen offset:0
    buffer_load_dwordx4 v[144:147], v0, s[8:11], s46 offen offset:1024
    buffer_load_dwordx4 v[148:151], v0, s[8:11], s46 offen offset:2048
    buffer_load_dwordx4 v[152:155], v0, s[8:11], s46 offen offset:3072
    s_add_u32 s46, s51, 4096
    buffer_load_dwordx4 v[156:159], v0, s[8:11], s46 offen offset:0
    buffer_load_dwordx4 v[160:163], v0, s[8:11], s46 offen offset:1024
    buffer_load_dwordx4 v[164:167], v0, s[8:11], s46 offen offset:2048
    buffer_load_dwordx4 v[168:171], v0, s[8:11], s46 offen offset:3072
    s_add_u32 s46, s51, 16777216
    buffer_load_dwordx4 v[172:175], v0, s[8:11], s46 offen offset:0
    buffer_load_dwordx4 v[176:179], v0, s[8:11], s46 offen offset:1024
    buffer_load_dwordx4 v[180:183], v0, s[8:11], s46 offen offset:2048
    buffer_load_dwordx4 v[184:187], v0, s[8:11], s46 offen offset:3072
    s_add_u32 s46, s51, 16781312
    buffer_load_dwordx4 v[188:191], v0, s[8:11], s46 offen offset:0
    buffer_load_dwordx4 v[192:195], v0, s[8:11], s46 offen offset:1024
    buffer_load_dwordx4 v[196:199], v0, s[8:11], s46 offen offset:2048
    buffer_load_dwordx4 v[200:203], v0, s[8:11], s46 offen offset:3072
    s_add_u32 s46, s51, 33554432
    buffer_load_dwordx4 v[204:207], v0, s[8:11], s46 offen offset:0
    buffer_load_dwordx4 v[208:211], v0, s[8:11], s46 offen offset:1024
    buffer_load_dwordx4 v[212:215], v0, s[8:11], s46 offen offset:2048
    buffer_load_dwordx4 v[216:219], v0, s[8:11], s46 offen offset:3072
    s_add_u32 s46, s51, 33558528
    buffer_load_dwordx4 v[220:223], v0, s[8:11], s46 offen offset:0
    buffer_load_dwordx4 v[224:227], v0, s[8:11], s46 offen offset:1024
    buffer_load_dwordx4 v[228:231], v0, s[8:11], s46 offen offset:2048
    buffer_load_dwordx4 v[232:235], v0, s[8:11], s46 offen offset:3072
    s_waitcnt vmcnt(0)
Lta0_have:
    buffer_load_dword v2, v11, s[8:11], s42 offen sc1
    s_waitcnt vmcnt(5)
    v_cmp_eq_u32 vcc, 0, v15
    s_add_u32 s51, s51, 262144
    s_add_u32 s37, s37, 1
    s_mov_b32 s62, s38
    s_and_b32 s17, vcc_lo, 0xfff
    s_cselect_b32 s39, 0, 1
    s_cmp_eq_u64 vcc, 0
    s_cselect_b32 s38, 1, 0
    s_cmp_lt_u32 s37, 64
    s_cselect_b32 s39, s39, 0
    s_cselect_b32 s38, s38, 0
    s_cmp_eq_u32 s39, 1
    s_cselect_b32 s30, 268435456, 0
    s_cmp_eq_u32 s38, 1
    s_cselect_b32 s22, 268435456, 0
    v_mfma_f32_16x16x32_bf16 v[32:35], v[172:175], v[140:143], 0
    s_add_u32 s46, s51, 0
    buffer_load_dwordx4 a[0:3], v0, s[28:31], s46 offen offset:0
    v_mfma_f32_16x16x32_bf16 v[36:39], v[172:175], v[144:147], 0
    buffer_load_dwordx4 a[4:7], v0, s[28:31], s46 offen offset:1024
    v_mfma_f32_16x16x32_bf16 v[40:43], v[176:179], v[144:147], 0
    buffer_load_dwordx4 a[8:11], v0, s[28:31], s46 offen offset:2048
    v_mfma_f32_16x16x32_bf16 v[32:35], v[180:183], v[148:151], v[32:35]
    buffer_load_dwordx4 a[12:15], v0, s[28:31], s46 offen offset:3072
    v_mfma_f32_16x16x32_bf16 v[36:39], v[180:183], v[152:155], v[36:39]
    s_add_u32 s46, s51, 4096
    buffer_load_dwordx4 a[16:19], v0, s[28:31], s46 offen offset:0
    v_mfma_f32_16x16x32_bf16 v[40:43], v[184:187], v[152:155], v[40:43]
    buffer_load_dwordx4 a[20:23], v0, s[28:31], s46 offen offset:1024
    v_mfma_f32_16x16x32_bf16 v[32:35], v[188:191], v[156:159], v[32:35]
    v_mfma_f32_16x16x32_bf16 v[36:39], v[188:191], v[160:163], v[36:39]
    v_mfma_f32_16x16x32_bf16 v[40:43], v[192:195], v[160:163], v[40:43]
    v_mfma_f32_16x16x32_bf16 v[32:35], v[196:199], v[164:167], v[32:35]
    v_mfma_f32_16x16x32_bf16 v[36:39], v[196:199], v[168:171], v[36:39]
    v_mfma_f32_16x16x32_bf16 v[40:43], v[200:203], v[168:171], v[40:43]
    s_waitcnt vmcnt(7)
    s_cmp_lg_u32 s49, 0
    s_cselect_b64 exec, 1, 0
    buffer_store_dword v3, v4, s[8:11], s43 offen sc1
    s_mov_b64 exec, -1
    s_add_u32 s43, s43, s49
    s_mov_b32 s49, 0
    s_cmp_eq_u32 s62, 1
    s_cbranch_scc1 Lta0_km
    s_waitcnt vmcnt(6)
    v_cmp_eq_u32 vcc, 0, v2
    s_nop 0
    s_cbranch_vccz Lta0_r
    s_mov_b32 s16, 0
Lta0_rp:
    buffer_load_dword v2, v11, s[8:11], s42 offen sc1
    s_add_u32 s16, s16, 1
    s_cmp_gt_u32 s16, 100000
    s_cbranch_scc1 L_role_ta_abort
    s_waitcnt vmcnt(0)
    v_cmp_eq_u32 vcc, 0, v2
    s_nop 0
    s_cbranch_vccnz Lta0_rp
Lta0_r:
    buffer_load_dwordx4 a[96:99], v9, s[8:11], s47 offen offset:0
    buffer_load_dwordx4 a[100:103], v9, s[8:11], s47 offen offset:64
    buffer_load_dwordx4 a[104:107], v9, s[8:11], s47 offen offset:128
    buffer_load_dwordx4 a[108:111], v9, s[8:11], s47 offen offset:192
    buffer_load_dwordx2 a[112:113], v10, s[8:11], s47 offen offset:2048
    buffer_load_dwordx2 a[114:115], v10, s[8:11], s47 offen offset:2560
    buffer_load_dwordx2 a[116:117], v10, s[8:11], s47 offen offset:3072
    buffer_load_dwordx2 a[118:119], v10, s[8:11], s47 offen offset:3584
Lta0_km:
    s_add_u32 s42, s42, 22528
    s_add_u32 s47, s47, 131072
    v_fma_f32 v32, v32, s52, v236
    v_fma_f32 v33, v33, s52, v237
    v_fma_f32 v34, v34, s52, v238
    v_fma_f32 v35, v35, s52, v239
    buffer_load_dwordx4 a[24:27], v0, s[28:31], s46 offen offset:2048
    buffer_load_dwordx4 a[28:31], v0, s[28:31], s46 offen offset:3072
    v_mul_f32 v36, s52, v36
    v_mul_f32 v37, s52, v37
    v_mul_f32 v38, s52, v38
    v_mul_f32 v39, s52, v39
    s_add_u32 s46, s51, 16777216
    buffer_load_dwordx4 a[32:35], v0, s[28:31], s46 offen offset:0
    buffer_load_dwordx4 a[36:39], v0, s[28:31], s46 offen offset:1024
    v_fma_f32 v40, v40, s52, v236
    v_fma_f32 v41, v41, s52, v237
    v_fma_f32 v42, v42, s52, v238
    v_fma_f32 v43, v43, s52, v239
    buffer_load_dwordx4 a[40:43], v0, s[28:31], s46 offen offset:2048
    buffer_load_dwordx4 a[44:47], v0, s[28:31], s46 offen offset:3072
    s_waitcnt vmcnt(13)
    v_mfma_f32_16x16x32_bf16 v[44:47], a[96:99], v[140:143], 0
    v_mfma_f32_16x16x32_bf16 v[48:51], a[96:99], v[144:147], 0
    s_add_u32 s46, s51, 16781312
    buffer_load_dwordx4 a[48:51], v0, s[28:31], s46 offen offset:0
    s_waitcnt vmcnt(13)
    v_mfma_f32_16x16x32_bf16 v[44:47], a[100:103], v[148:151], v[44:47]
    v_mfma_f32_16x16x32_bf16 v[48:51], a[100:103], v[152:155], v[48:51]
    buffer_load_dwordx4 a[52:55], v0, s[28:31], s46 offen offset:1024
    s_waitcnt vmcnt(13)
    v_mfma_f32_16x16x32_bf16 v[44:47], a[104:107], v[156:159], v[44:47]
    v_mfma_f32_16x16x32_bf16 v[48:51], a[104:107], v[160:163], v[48:51]
    buffer_load_dwordx4 a[56:59], v0, s[28:31], s46 offen offset:2048
    s_waitcnt vmcnt(13)
    v_mfma_f32_16x16x32_bf16 v[44:47], a[108:111], v[164:167], v[44:47]
    v_mfma_f32_16x16x32_bf16 v[48:51], a[108:111], v[168:171], v[48:51]
    buffer_load_dwordx4 a[60:63], v0, s[28:31], s46 offen offset:3072
    v_max3_f32 v5, v32, v33, v34
    v_max_f32 v5, v5, v35
    s_nop 0
    v_mul_f32 v44, s52, v44
    v_mul_f32 v45, s52, v45
    v_max3_f32 v5, v5, v44, v45
    v_mov_b32 v6, v5
    s_add_u32 s46, s51, 33554432
    buffer_load_dwordx4 a[64:67], v0, s[28:31], s46 offen offset:0
    v_permlane32_swap_b32 v5, v6
    v_max_f32 v5, v5, v6
    v_mov_b32 v6, v5
    buffer_load_dwordx4 a[68:71], v0, s[28:31], s46 offen offset:1024
    s_nop 0
    v_permlane16_swap_b32 v5, v6
    v_max_f32 v5, v5, v6
    v_sub_f32 v32, v32, v5
    v_sub_f32 v33, v33, v5
    v_sub_f32 v34, v34, v5
    v_sub_f32 v35, v35, v5
    v_sub_f32 v44, v44, v5
    v_sub_f32 v45, v45, v5
    v_exp_f32 v32, v32
    v_exp_f32 v33, v33
    v_exp_f32 v34, v34
    v_exp_f32 v35, v35
    v_exp_f32 v44, v44
    v_exp_f32 v45, v45
    v_cvt_pk_bf16_f32 v24, v32, v33
    v_cvt_pk_bf16_f32 v25, v34, v35
    v_mov_b32 v26, 0
    v_mov_b32 v27, 0
    v_cvt_pk_bf16_f32 v20, v44, v45
    v_cvt_pk_bf16_f32 v23, v44, v45
    v_mfma_f32_16x16x32_bf16 v[28:31], v[16:19], v[24:27], 0
    v_mfma_f32_16x16x32_bf16 v[76:79], v[204:207], v[24:27], 0
    v_mfma_f32_16x16x32_bf16 v[80:83], v[208:211], v[24:27], 0
    s_add_u32 s17, s42, 22528
    buffer_load_dword v15, v1, s[8:11], s17 offen sc1
    v_mfma_f32_16x16x32_bf16 v[84:87], v[212:215], v[24:27], 0
    v_mfma_f32_16x16x32_bf16 v[88:91], v[216:219], v[24:27], 0
    buffer_load_dwordx4 a[72:75], v0, s[28:31], s46 offen offset:2048
    v_mfma_f32_16x16x32_bf16 v[92:95], v[220:223], v[24:27], 0
    v_mfma_f32_16x16x32_bf16 v[96:99], v[224:227], v[24:27], 0
    buffer_load_dwordx4 a[76:79], v0, s[28:31], s46 offen offset:3072
    v_mfma_f32_16x16x16_bf16 v[28:31], v[16:17], v[20:21], v[28:31]
    v_mfma_f32_16x16x32_bf16 v[100:103], v[228:231], v[24:27], 0
    v_mfma_f32_16x16x32_bf16 v[104:107], v[232:235], v[24:27], 0
    s_add_u32 s46, s51, 33558528
    buffer_load_dwordx4 a[80:83], v0, s[28:31], s46 offen offset:0
    s_waitcnt vmcnt(19)
    v_mfma_f32_16x16x16_bf16 v[76:79], a[112:113], v[20:21], v[76:79]
    v_mfma_f32_16x16x16_bf16 v[80:83], a[112:113], v[22:23], v[80:83]
    v_rcp_f32 v6, v28
    s_waitcnt vmcnt(18)
    v_mfma_f32_16x16x16_bf16 v[84:87], a[114:115], v[20:21], v[84:87]
    v_mfma_f32_16x16x16_bf16 v[88:91], a[114:115], v[22:23], v[88:91]
    v_mul_f32 v76, v6, v76
    v_mul_f32 v80, v6, v80
    v_cvt_pk_bf16_f32 v108, v76, v80
    v_mul_f32 v77, v6, v77
    v_mul_f32 v81, v6, v81
    v_cvt_pk_bf16_f32 v109, v77, v81
    v_mul_f32 v78, v6, v78
    v_mul_f32 v82, v6, v82
    v_cvt_pk_bf16_f32 v110, v78, v82
    v_mul_f32 v79, v6, v79
    v_mul_f32 v83, v6, v83
    v_cvt_pk_bf16_f32 v111, v79, v83
    s_add_u32 s17, s48, 0
    buffer_store_dwordx4 v[108:111], v0, s[8:11], s17 offen offset:0 sc1
    buffer_load_dwordx4 a[84:87], v0, s[28:31], s46 offen offset:1024
    s_waitcnt vmcnt(19)
    v_mfma_f32_16x16x16_bf16 v[92:95], a[116:117], v[20:21], v[92:95]
    v_mfma_f32_16x16x16_bf16 v[96:99], a[116:117], v[22:23], v[96:99]
    v_mul_f32 v84, v6, v84
    v_mul_f32 v88, v6, v88
    v_cvt_pk_bf16_f32 v112, v84, v88
    v_mul_f32 v85, v6, v85
    v_mul_f32 v89, v6, v89
    v_cvt_pk_bf16_f32 v113, v85, v89
    v_mul_f32 v86, v6, v86
    v_mul_f32 v90, v6, v90
    v_cvt_pk_bf16_f32 v114, v86, v90
    v_mul_f32 v87, v6, v87
    v_mul_f32 v91, v6, v91
    v_cvt_pk_bf16_f32 v115, v87, v91
    buffer_store_dwordx4 v[112:115], v0, s[8:11], s17 offen offset:2048 sc1
    buffer_load_dwordx4 a[88:91], v0, s[28:31], s46 offen offset:2048
    s_waitcnt vmcnt(20)
    v_mfma_f32_16x16x16_bf16 v[100:103], a[118:119], v[20:21], v[100:103]
    v_mfma_f32_16x16x16_bf16 v[104:107], a[118:119], v[22:23], v[104:107]
    v_mul_f32 v92, v6, v92
    v_mul_f32 v96, v6, v96
    v_cvt_pk_bf16_f32 v116, v92, v96
    v_mul_f32 v93, v6, v93
    v_mul_f32 v97, v6, v97
    v_cvt_pk_bf16_f32 v117, v93, v97
    v_mul_f32 v94, v6, v94
    v_mul_f32 v98, v6, v98
    v_cvt_pk_bf16_f32 v118, v94, v98
    v_mul_f32 v95, v6, v95
    v_mul_f32 v99, v6, v99
    v_cvt_pk_bf16_f32 v119, v95, v99
    s_add_u32 s17, s48, 4096
    buffer_store_dwordx4 v[116:119], v0, s[8:11], s17 offen offset:0 sc1
    buffer_load_dwordx4 a[92:95], v0, s[28:31], s46 offen offset:3072
    v_mul_f32 v100, v6, v100
    v_mul_f32 v104, v6, v104
    v_cvt_pk_bf16_f32 v120, v100, v104
    v_mul_f32 v101, v6, v101
    v_mul_f32 v105, v6, v105
    v_cvt_pk_bf16_f32 v121, v101, v105
    v_mul_f32 v102, v6, v102
    v_mul_f32 v106, v6, v106
    v_cvt_pk_bf16_f32 v122, v102, v106
    v_mul_f32 v103, v6, v103
    v_mul_f32 v107, v6, v107
    v_cvt_pk_bf16_f32 v123, v103, v107
    buffer_store_dwordx4 v[120:123], v0, s[8:11], s17 offen offset:2048 sc1
    buffer_load_dwordx4 a[120:123], v9, s[20:23], s47 offen offset:0
    v_max3_f32 v5, v36, v37, v38
    v_max_f32 v5, v5, v39
    v_max3_f32 v5, v5, v40, v41
    v_max3_f32 v5, v5, v42, v43
    v_mul_f32 v48, s52, v48
    v_mul_f32 v49, s52, v49
    v_max3_f32 v5, v5, v48, v49
    v_mov_b32 v6, v5
    buffer_load_dwordx4 a[124:127], v9, s[20:23], s47 offen offset:64
    s_nop 0
    v_permlane32_swap_b32 v5, v6
    v_max_f32 v5, v5, v6
    v_mov_b32 v6, v5
    buffer_load_dwordx4 a[128:131], v9, s[20:23], s47 offen offset:128
    s_nop 0
    v_permlane16_swap_b32 v5, v6
    v_max_f32 v5, v5, v6
    v_sub_f32 v36, v36, v5
    v_sub_f32 v37, v37, v5
    v_sub_f32 v38, v38, v5
    v_sub_f32 v39, v39, v5
    v_sub_f32 v40, v40, v5
    v_sub_f32 v41, v41, v5
    v_sub_f32 v42, v42, v5
    v_sub_f32 v43, v43, v5
    v_sub_f32 v48, v48, v5
    v_sub_f32 v49, v49, v5
    v_exp_f32 v36, v36
    v_exp_f32 v37, v37
    v_exp_f32 v38, v38
    v_exp_f32 v39, v39
    v_exp_f32 v40, v40
    v_exp_f32 v41, v41
    v_exp_f32 v42, v42
    v_exp_f32 v43, v43
    v_exp_f32 v48, v48
    v_exp_f32 v49, v49
    v_cvt_pk_bf16_f32 v24, v36, v37
    v_cvt_pk_bf16_f32 v25, v38, v39
    v_cvt_pk_bf16_f32 v26, v40, v41
    v_cvt_pk_bf16_f32 v27, v42, v43
    v_cvt_pk_bf16_f32 v20, v48, v49
    v_cvt_pk_bf16_f32 v23, v48, v49
    v_mfma_f32_16x16x32_bf16 v[28:31], v[16:19], v[24:27], 0
    v_mfma_f32_16x16x32_bf16 v[76:79], v[204:207], v[24:27], 0
    v_mfma_f32_16x16x32_bf16 v[80:83], v[208:211], v[24:27], 0
    buffer_load_dwordx4 a[132:135], v9, s[20:23], s47 offen offset:192
    v_mfma_f32_16x16x32_bf16 v[84:87], v[212:215], v[24:27], 0
    v_mfma_f32_16x16x32_bf16 v[88:91], v[216:219], v[24:27], 0
    buffer_load_dwordx2 a[136:137], v10, s[20:23], s47 offen offset:2048
    v_mfma_f32_16x16x32_bf16 v[92:95], v[220:223], v[24:27], 0
    v_mfma_f32_16x16x32_bf16 v[96:99], v[224:227], v[24:27], 0
    buffer_load_dwordx2 a[138:139], v10, s[20:23], s47 offen offset:2560
    v_mfma_f32_16x16x16_bf16 v[28:31], v[16:17], v[20:21], v[28:31]
    v_mfma_f32_16x16x32_bf16 v[100:103], v[228:231], v[24:27], 0
    v_mfma_f32_16x16x32_bf16 v[104:107], v[232:235], v[24:27], 0
    buffer_load_dwordx2 a[140:141], v10, s[20:23], s47 offen offset:3072
    buffer_load_dwordx2 a[142:143], v10, s[20:23], s47 offen offset:3584
    v_mfma_f32_16x16x16_bf16 v[76:79], a[112:113], v[20:21], v[76:79]
    v_mfma_f32_16x16x16_bf16 v[80:83], a[112:113], v[22:23], v[80:83]
    v_rcp_f32 v6, v28
    v_mfma_f32_16x16x16_bf16 v[84:87], a[114:115], v[20:21], v[84:87]
    v_mfma_f32_16x16x16_bf16 v[88:91], a[114:115], v[22:23], v[88:91]
    v_mul_f32 v76, v6, v76
    v_mul_f32 v80, v6, v80
    v_cvt_pk_bf16_f32 v124, v76, v80
    v_mul_f32 v77, v6, v77
    v_mul_f32 v81, v6, v81
    v_cvt_pk_bf16_f32 v125, v77, v81
    v_mul_f32 v78, v6, v78
    v_mul_f32 v82, v6, v82
    v_cvt_pk_bf16_f32 v126, v78, v82
    v_mul_f32 v79, v6, v79
    v_mul_f32 v83, v6, v83
    v_cvt_pk_bf16_f32 v127, v79, v83
    s_add_u32 s17, s48, 0
    buffer_store_dwordx4 v[124:127], v0, s[8:11], s17 offen offset:1024 sc1
    v_mfma_f32_16x16x16_bf16 v[92:95], a[116:117], v[20:21], v[92:95]
    v_mfma_f32_16x16x16_bf16 v[96:99], a[116:117], v[22:23], v[96:99]
    v_mul_f32 v84, v6, v84
    v_mul_f32 v88, v6, v88
    v_cvt_pk_bf16_f32 v128, v84, v88
    v_mul_f32 v85, v6, v85
    v_mul_f32 v89, v6, v89
    v_cvt_pk_bf16_f32 v129, v85, v89
    v_mul_f32 v86, v6, v86
    v_mul_f32 v90, v6, v90
    v_cvt_pk_bf16_f32 v130, v86, v90
    v_mul_f32 v87, v6, v87
    v_mul_f32 v91, v6, v91
    v_cvt_pk_bf16_f32 v131, v87, v91
    buffer_store_dwordx4 v[128:131], v0, s[8:11], s17 offen offset:3072 sc1
    v_mfma_f32_16x16x16_bf16 v[100:103], a[118:119], v[20:21], v[100:103]
    v_mfma_f32_16x16x16_bf16 v[104:107], a[118:119], v[22:23], v[104:107]
    v_mul_f32 v92, v6, v92
    v_mul_f32 v96, v6, v96
    v_cvt_pk_bf16_f32 v132, v92, v96
    v_mul_f32 v93, v6, v93
    v_mul_f32 v97, v6, v97
    v_cvt_pk_bf16_f32 v133, v93, v97
    v_mul_f32 v94, v6, v94
    v_mul_f32 v98, v6, v98
    v_cvt_pk_bf16_f32 v134, v94, v98
    v_mul_f32 v95, v6, v95
    v_mul_f32 v99, v6, v99
    v_cvt_pk_bf16_f32 v135, v95, v99
    s_add_u32 s17, s48, 4096
    buffer_store_dwordx4 v[132:135], v0, s[8:11], s17 offen offset:1024 sc1
    v_mul_f32 v100, v6, v100
    v_mul_f32 v104, v6, v104
    v_cvt_pk_bf16_f32 v136, v100, v104
    v_mul_f32 v101, v6, v101
    v_mul_f32 v105, v6, v105
    v_cvt_pk_bf16_f32 v137, v101, v105
    v_mul_f32 v102, v6, v102
    v_mul_f32 v106, v6, v106
    v_cvt_pk_bf16_f32 v138, v102, v106
    v_mul_f32 v103, v6, v103
    v_mul_f32 v107, v6, v107
    v_cvt_pk_bf16_f32 v139, v103, v107
    buffer_store_dwordx4 v[136:139], v0, s[8:11], s17 offen offset:3072 sc1
    s_add_u32 s48, s48, 262144
    s_mov_b32 s49, 22528
    s_cmp_ge_u32 s37, 64
    s_cbranch_scc1 Lta_end
Lta1:
    s_cmp_eq_u32 s39, 1
    s_cbranch_scc1 Lta1_have
    s_waitcnt vmcnt(0)
    s_cmp_lg_u32 s49, 0
    s_cselect_b64 exec, 1, 0
    buffer_store_dword v3, v4, s[8:11], s43 offen sc1
    s_mov_b64 exec, -1
    s_add_u32 s43, s43, s49
    s_mov_b32 s49, 0
    s_mov_b32 s16, 0
Lta1_f:
    buffer_load_dword v2, v1, s[8:11], s42 offen sc1
    s_add_u32 s16, s16, 1
    s_cmp_gt_u32 s16, 100000
    s_cbranch_scc1 L_role_ta_abort
    s_waitcnt vmcnt(0)
    v_cmp_eq_u32 vcc, 0, v2
    s_nop 0
    s_and_b32 s17, vcc_lo, 0xfff
    s_cbranch_scc0 Lta1_fd
    s_sleep 4
    s_branch Lta1_f
Lta1_fd:
    s_add_u32 s46, s51, 0
    buffer_load_dwordx4 a[0:3], v0, s[8:11], s46 offen offset:0
    buffer_load_dwordx4 a[4:7], v0, s[8:11], s46 offen offset:1024
    buffer_load_dwordx4 a[8:11], v0, s[8:11], s46 offen offset:2048
    buffer_load_dwordx4 a[12:15], v0, s[8:11], s46 offen offset:3072
    s_add_u32 s46, s51, 4096
    buffer_load_dwordx4 a[16:19], v0, s[8:11], s46 offen offset:0
    buffer_load_dwordx4 a[20:23], v0, s[8:11], s46 offen offset:1024
    buffer_load_dwordx4 a[24:27], v0, s[8:11], s46 offen offset:2048
    buffer_load_dwordx4 a[28:31], v0, s[8:11], s46 offen offset:3072
    s_add_u32 s46, s51, 16777216
    buffer_load_dwordx4 a[32:35], v0, s[8:11], s46 offen offset:0
    buffer_load_dwordx4 a[36:39], v0, s[8:11], s46 offen offset:1024
    buffer_load_dwordx4 a[40:43], v0, s[8:11], s46 offen offset:2048
    buffer_load_dwordx4 a[44:47], v0, s[8:11], s46 offen offset:3072
    s_add_u32 s46, s51, 16781312
    buffer_load_dwordx4 a[48:51], v0, s[8:11], s46 offen offset:0
    buffer_load_dwordx4 a[52:55], v0, s[8:11], s46 offen offset:1024
    buffer_load_dwordx4 a[56:59], v0, s[8:11], s46 offen offset:2048
    buffer_load_dwordx4 a[60:63], v0, s[8:11], s46 offen offset:3072
    s_add_u32 s46, s51, 33554432
    buffer_load_dwordx4 a[64:67], v0, s[8:11], s46 offen offset:0
    buffer_load_dwordx4 a[68:71], v0, s[8:11], s46 offen offset:1024
    buffer_load_dwordx4 a[72:75], v0, s[8:11], s46 offen offset:2048
    buffer_load_dwordx4 a[76:79], v0, s[8:11], s46 offen offset:3072
    s_add_u32 s46, s51, 33558528
    buffer_load_dwordx4 a[80:83], v0, s[8:11], s46 offen offset:0
    buffer_load_dwordx4 a[84:87], v0, s[8:11], s46 offen offset:1024
    buffer_load_dwordx4 a[88:91], v0, s[8:11], s46 offen offset:2048
    buffer_load_dwordx4 a[92:95], v0, s[8:11], s46 offen offset:3072
    s_waitcnt vmcnt(0)
Lta1_have:
    buffer_load_dword v2, v11, s[8:11], s42 offen sc1
    s_waitcnt vmcnt(5)
    v_cmp_eq_u32 vcc, 0, v15
    s_add_u32 s51, s51, 262144
    s_add_u32 s37, s37, 1
    s_mov_b32 s62, s38
    s_and_b32 s17, vcc_lo, 0xfff
    s_cselect_b32 s39, 0, 1
    s_cmp_eq_u64 vcc, 0
    s_cselect_b32 s38, 1, 0
    s_cmp_lt_u32 s37, 64
    s_cselect_b32 s39, s39, 0
    s_cselect_b32 s38, s38, 0
    s_cmp_eq_u32 s39, 1
    s_cselect_b32 s30, 268435456, 0
    s_cmp_eq_u32 s38, 1
    s_cselect_b32 s22, 268435456, 0
    v_mfma_f32_16x16x32_bf16 v[32:35], a[32:35], a[0:3], 0
    s_add_u32 s46, s51, 0
    buffer_load_dwordx4 v[140:143], v0, s[28:31], s46 offen offset:0
    v_mfma_f32_16x16x32_bf16 v[36:39], a[32:35], a[4:7], 0
    buffer_load_dwordx4 v[144:147], v0, s[28:31], s46 offen offset:1024
    v_mfma_f32_16x16x32_bf16 v[40:43], a[36:39], a[4:7], 0
    buffer_load_dwordx4 v[148:151], v0, s[28:31], s46 offen offset:2048
    v_mfma_f32_16x16x32_bf16 v[32:35], a[40:43], a[8:11], v[32:35]
    buffer_load_dwordx4 v[152:155], v0, s[28:31], s46 offen offset:3072
    v_mfma_f32_16x16x32_bf16 v[36:39], a[40:43], a[12:15], v[36:39]
    s_add_u32 s46, s51, 4096
    buffer_load_dwordx4 v[156:159], v0, s[28:31], s46 offen offset:0
    v_mfma_f32_16x16x32_bf16 v[40:43], a[44:47], a[12:15], v[40:43]
    buffer_load_dwordx4 v[160:163], v0, s[28:31], s46 offen offset:1024
    v_mfma_f32_16x16x32_bf16 v[32:35], a[48:51], a[16:19], v[32:35]
    v_mfma_f32_16x16x32_bf16 v[36:39], a[48:51], a[20:23], v[36:39]
    v_mfma_f32_16x16x32_bf16 v[40:43], a[52:55], a[20:23], v[40:43]
    v_mfma_f32_16x16x32_bf16 v[32:35], a[56:59], a[24:27], v[32:35]
    v_mfma_f32_16x16x32_bf16 v[36:39], a[56:59], a[28:31], v[36:39]
    v_mfma_f32_16x16x32_bf16 v[40:43], a[60:63], a[28:31], v[40:43]
    s_waitcnt vmcnt(7)
    s_cmp_lg_u32 s49, 0
    s_cselect_b64 exec, 1, 0
    buffer_store_dword v3, v4, s[8:11], s43 offen sc1
    s_mov_b64 exec, -1
    s_add_u32 s43, s43, s49
    s_mov_b32 s49, 0
    s_cmp_eq_u32 s62, 1
    s_cbranch_scc1 Lta1_km
    s_waitcnt vmcnt(6)
    v_cmp_eq_u32 vcc, 0, v2
    s_nop 0
    s_cbranch_vccz Lta1_r
    s_mov_b32 s16, 0
Lta1_rp:
    buffer_load_dword v2, v11, s[8:11], s42 offen sc1
    s_add_u32 s16, s16, 1
    s_cmp_gt_u32 s16, 100000
    s_cbranch_scc1 L_role_ta_abort
    s_waitcnt vmcnt(0)
    v_cmp_eq_u32 vcc, 0, v2
    s_nop 0
    s_cbranch_vccnz Lta1_rp
Lta1_r:
    buffer_load_dwordx4 a[120:123], v9, s[8:11], s47 offen offset:0
    buffer_load_dwordx4 a[124:127], v9, s[8:11], s47 offen offset:64
    buffer_load_dwordx4 a[128:131], v9, s[8:11], s47 offen offset:128
    buffer_load_dwordx4 a[132:135], v9, s[8:11], s47 offen offset:192
    buffer_load_dwordx2 a[136:137], v10, s[8:11], s47 offen offset:2048
    buffer_load_dwordx2 a[138:139], v10, s[8:11], s47 offen offset:2560
    buffer_load_dwordx2 a[140:141], v10, s[8:11], s47 offen offset:3072
    buffer_load_dwordx2 a[142:143], v10, s[8:11], s47 offen offset:3584
Lta1_km:
    s_add_u32 s42, s42, 22528
    s_add_u32 s47, s47, 131072
    v_fma_f32 v32, v32, s52, v236
    v_fma_f32 v33, v33, s52, v237
    v_fma_f32 v34, v34, s52, v238
    v_fma_f32 v35, v35, s52, v239
    buffer_load_dwordx4 v[164:167], v0, s[28:31], s46 offen offset:2048
    buffer_load_dwordx4 v[168:171], v0, s[28:31], s46 offen offset:3072
    v_mul_f32 v36, s52, v36
    v_mul_f32 v37, s52, v37
    v_mul_f32 v38, s52, v38
    v_mul_f32 v39, s52, v39
    s_add_u32 s46, s51, 16777216
    buffer_load_dwordx4 v[172:175], v0, s[28:31], s46 offen offset:0
    buffer_load_dwordx4 v[176:179], v0, s[28:31], s46 offen offset:1024
    v_fma_f32 v40, v40, s52, v236
    v_fma_f32 v41, v41, s52, v237
    v_fma_f32 v42, v42, s52, v238
    v_fma_f32 v43, v43, s52, v239
    buffer_load_dwordx4 v[180:183], v0, s[28:31], s46 offen offset:2048
    buffer_load_dwordx4 v[184:187], v0, s[28:31], s46 offen offset:3072
    s_waitcnt vmcnt(13)
    v_mfma_f32_16x16x32_bf16 v[44:47], a[120:123], a[0:3], 0
    v_mfma_f32_16x16x32_bf16 v[48:51], a[120:123], a[4:7], 0
    s_add_u32 s46, s51, 16781312
    buffer_load_dwordx4 v[188:191], v0, s[28:31], s46 offen offset:0
    s_waitcnt vmcnt(13)
    v_mfma_f32_16x16x32_bf16 v[44:47], a[124:127], a[8:11], v[44:47]
    v_mfma_f32_16x16x32_bf16 v[48:51], a[124:127], a[12:15], v[48:51]
    buffer_load_dwordx4 v[192:195], v0, s[28:31], s46 offen offset:1024
    s_waitcnt vmcnt(13)
    v_mfma_f32_16x16x32_bf16 v[44:47], a[128:131], a[16:19], v[44:47]
    v_mfma_f32_16x16x32_bf16 v[48:51], a[128:131], a[20:23], v[48:51]
    buffer_load_dwordx4 v[196:199], v0, s[28:31], s46 offen offset:2048
    s_waitcnt vmcnt(13)
    v_mfma_f32_16x16x32_bf16 v[44:47], a[132:135], a[24:27], v[44:47]
    v_mfma_f32_16x16x32_bf16 v[48:51], a[132:135], a[28:31], v[48:51]
    buffer_load_dwordx4 v[200:203], v0, s[28:31], s46 offen offset:3072
    v_max3_f32 v5, v32, v33, v34
    v_max_f32 v5, v5, v35
    s_nop 0
    v_mul_f32 v44, s52, v44
    v_mul_f32 v45, s52, v45
    v_max3_f32 v5, v5, v44, v45
    v_mov_b32 v6, v5
    s_add_u32 s46, s51, 33554432
    buffer_load_dwordx4 v[204:207], v0, s[28:31], s46 offen offset:0
    v_permlane32_swap_b32 v5, v6
    v_max_f32 v5, v5, v6
    v_mov_b32 v6, v5
    buffer_load_dwordx4 v[208:211], v0, s[28:31], s46 offen offset:1024
    s_nop 0
    v_permlane16_swap_b32 v5, v6
    v_max_f32 v5, v5, v6
    v_sub_f32 v32, v32, v5
    v_sub_f32 v33, v33, v5
    v_sub_f32 v34, v34, v5
    v_sub_f32 v35, v35, v5
    v_sub_f32 v44, v44, v5
    v_sub_f32 v45, v45, v5
    v_exp_f32 v32, v32
    v_exp_f32 v33, v33
    v_exp_f32 v34, v34
    v_exp_f32 v35, v35
    v_exp_f32 v44, v44
    v_exp_f32 v45, v45
    v_cvt_pk_bf16_f32 v24, v32, v33
    v_cvt_pk_bf16_f32 v25, v34, v35
    v_mov_b32 v26, 0
    v_mov_b32 v27, 0
    v_cvt_pk_bf16_f32 v20, v44, v45
    v_cvt_pk_bf16_f32 v23, v44, v45
    v_mfma_f32_16x16x32_bf16 v[28:31], v[16:19], v[24:27], 0
    v_mfma_f32_16x16x32_bf16 v[76:79], a[64:67], v[24:27], 0
    v_mfma_f32_16x16x32_bf16 v[80:83], a[68:71], v[24:27], 0
    s_add_u32 s17, s42, 22528
    buffer_load_dword v15, v1, s[8:11], s17 offen sc1
    v_mfma_f32_16x16x32_bf16 v[84:87], a[72:75], v[24:27], 0
    v_mfma_f32_16x16x32_bf16 v[88:91], a[76:79], v[24:27], 0
    buffer_load_dwordx4 v[212:215], v0, s[28:31], s46 offen offset:2048
    v_mfma_f32_16x16x32_bf16 v[92:95], a[80:83], v[24:27], 0
    v_mfma_f32_16x16x32_bf16 v[96:99], a[84:87], v[24:27], 0
    buffer_load_dwordx4 v[216:219], v0, s[28:31], s46 offen offset:3072
    v_mfma_f32_16x16x16_bf16 v[28:31], v[16:17], v[20:21], v[28:31]
    v_mfma_f32_16x16x32_bf16 v[100:103], a[88:91], v[24:27], 0
    v_mfma_f32_16x16x32_bf16 v[104:107], a[92:95], v[24:27], 0
    s_add_u32 s46, s51, 33558528
    buffer_load_dwordx4 v[220:223], v0, s[28:31], s46 offen offset:0
    s_waitcnt vmcnt(19)
    v_mfma_f32_16x16x16_bf16 v[76:79], a[136:137], v[20:21], v[76:79]
    v_mfma_f32_16x16x16_bf16 v[80:83], a[136:137], v[22:23], v[80:83]
    v_rcp_f32 v6, v28
    s_waitcnt vmcnt(18)
    v_mfma_f32_16x16x16_bf16 v[84:87], a[138:139], v[20:21], v[84:87]
    v_mfma_f32_16x16x16_bf16 v[88:91], a[138:139], v[22:23], v[88:91]
    v_mul_f32 v76, v6, v76
    v_mul_f32 v80, v6, v80
    v_cvt_pk_bf16_f32 v108, v76, v80
    v_mul_f32 v77, v6, v77
    v_mul_f32 v81, v6, v81
    v_cvt_pk_bf16_f32 v109, v77, v81
    v_mul_f32 v78, v6, v78
    v_mul_f32 v82, v6, v82
    v_cvt_pk_bf16_f32 v110, v78, v82
    v_mul_f32 v79, v6, v79
    v_mul_f32 v83, v6, v83
    v_cvt_pk_bf16_f32 v111, v79, v83
    s_add_u32 s17, s48, 0
    buffer_store_dwordx4 v[108:111], v0, s[8:11], s17 offen offset:0 sc1
    buffer_load_dwordx4 v[224:227], v0, s[28:31], s46 offen offset:1024
    s_waitcnt vmcnt(19)
    v_mfma_f32_16x16x16_bf16 v[92:95], a[140:141], v[20:21], v[92:95]
    v_mfma_f32_16x16x16_bf16 v[96:99], a[140:141], v[22:23], v[96:99]
    v_mul_f32 v84, v6, v84
    v_mul_f32 v88, v6, v88
    v_cvt_pk_bf16_f32 v112, v84, v88
    v_mul_f32 v85, v6, v85
    v_mul_f32 v89, v6, v89
    v_cvt_pk_bf16_f32 v113, v85, v89
    v_mul_f32 v86, v6, v86
    v_mul_f32 v90, v6, v90
    v_cvt_pk_bf16_f32 v114, v86, v90
    v_mul_f32 v87, v6, v87
    v_mul_f32 v91, v6, v91
    v_cvt_pk_bf16_f32 v115, v87, v91
    buffer_store_dwordx4 v[112:115], v0, s[8:11], s17 offen offset:2048 sc1
    buffer_load_dwordx4 v[228:231], v0, s[28:31], s46 offen offset:2048
    s_waitcnt vmcnt(20)
    v_mfma_f32_16x16x16_bf16 v[100:103], a[142:143], v[20:21], v[100:103]
    v_mfma_f32_16x16x16_bf16 v[104:107], a[142:143], v[22:23], v[104:107]
    v_mul_f32 v92, v6, v92
    v_mul_f32 v96, v6, v96
    v_cvt_pk_bf16_f32 v116, v92, v96
    v_mul_f32 v93, v6, v93
    v_mul_f32 v97, v6, v97
    v_cvt_pk_bf16_f32 v117, v93, v97
    v_mul_f32 v94, v6, v94
    v_mul_f32 v98, v6, v98
    v_cvt_pk_bf16_f32 v118, v94, v98
    v_mul_f32 v95, v6, v95
    v_mul_f32 v99, v6, v99
    v_cvt_pk_bf16_f32 v119, v95, v99
    s_add_u32 s17, s48, 4096
    buffer_store_dwordx4 v[116:119], v0, s[8:11], s17 offen offset:0 sc1
    buffer_load_dwordx4 v[232:235], v0, s[28:31], s46 offen offset:3072
    v_mul_f32 v100, v6, v100
    v_mul_f32 v104, v6, v104
    v_cvt_pk_bf16_f32 v120, v100, v104
    v_mul_f32 v101, v6, v101
    v_mul_f32 v105, v6, v105
    v_cvt_pk_bf16_f32 v121, v101, v105
    v_mul_f32 v102, v6, v102
    v_mul_f32 v106, v6, v106
    v_cvt_pk_bf16_f32 v122, v102, v106
    v_mul_f32 v103, v6, v103
    v_mul_f32 v107, v6, v107
    v_cvt_pk_bf16_f32 v123, v103, v107
    buffer_store_dwordx4 v[120:123], v0, s[8:11], s17 offen offset:2048 sc1
    buffer_load_dwordx4 a[96:99], v9, s[20:23], s47 offen offset:0
    v_max3_f32 v5, v36, v37, v38
    v_max_f32 v5, v5, v39
    v_max3_f32 v5, v5, v40, v41
    v_max3_f32 v5, v5, v42, v43
    v_mul_f32 v48, s52, v48
    v_mul_f32 v49, s52, v49
    v_max3_f32 v5, v5, v48, v49
    v_mov_b32 v6, v5
    buffer_load_dwordx4 a[100:103], v9, s[20:23], s47 offen offset:64
    s_nop 0
    v_permlane32_swap_b32 v5, v6
    v_max_f32 v5, v5, v6
    v_mov_b32 v6, v5
    buffer_load_dwordx4 a[104:107], v9, s[20:23], s47 offen offset:128
    s_nop 0
    v_permlane16_swap_b32 v5, v6
    v_max_f32 v5, v5, v6
    v_sub_f32 v36, v36, v5
    v_sub_f32 v37, v37, v5
    v_sub_f32 v38, v38, v5
    v_sub_f32 v39, v39, v5
    v_sub_f32 v40, v40, v5
    v_sub_f32 v41, v41, v5
    v_sub_f32 v42, v42, v5
    v_sub_f32 v43, v43, v5
    v_sub_f32 v48, v48, v5
    v_sub_f32 v49, v49, v5
    v_exp_f32 v36, v36
    v_exp_f32 v37, v37
    v_exp_f32 v38, v38
    v_exp_f32 v39, v39
    v_exp_f32 v40, v40
    v_exp_f32 v41, v41
    v_exp_f32 v42, v42
    v_exp_f32 v43, v43
    v_exp_f32 v48, v48
    v_exp_f32 v49, v49
    v_cvt_pk_bf16_f32 v24, v36, v37
    v_cvt_pk_bf16_f32 v25, v38, v39
    v_cvt_pk_bf16_f32 v26, v40, v41
    v_cvt_pk_bf16_f32 v27, v42, v43
    v_cvt_pk_bf16_f32 v20, v48, v49
    v_cvt_pk_bf16_f32 v23, v48, v49
    v_mfma_f32_16x16x32_bf16 v[28:31], v[16:19], v[24:27], 0
    v_mfma_f32_16x16x32_bf16 v[76:79], a[64:67], v[24:27], 0
    v_mfma_f32_16x16x32_bf16 v[80:83], a[68:71], v[24:27], 0
    buffer_load_dwordx4 a[108:111], v9, s[20:23], s47 offen offset:192
    v_mfma_f32_16x16x32_bf16 v[84:87], a[72:75], v[24:27], 0
    v_mfma_f32_16x16x32_bf16 v[88:91], a[76:79], v[24:27], 0
    buffer_load_dwordx2 a[112:113], v10, s[20:23], s47 offen offset:2048
    v_mfma_f32_16x16x32_bf16 v[92:95], a[80:83], v[24:27], 0
    v_mfma_f32_16x16x32_bf16 v[96:99], a[84:87], v[24:27], 0
    buffer_load_dwordx2 a[114:115], v10, s[20:23], s47 offen offset:2560
    v_mfma_f32_16x16x16_bf16 v[28:31], v[16:17], v[20:21], v[28:31]
    v_mfma_f32_16x16x32_bf16 v[100:103], a[88:91], v[24:27], 0
    v_mfma_f32_16x16x32_bf16 v[104:107], a[92:95], v[24:27], 0
    buffer_load_dwordx2 a[116:117], v10, s[20:23], s47 offen offset:3072
    buffer_load_dwordx2 a[118:119], v10, s[20:23], s47 offen offset:3584
    v_mfma_f32_16x16x16_bf16 v[76:79], a[136:137], v[20:21], v[76:79]
    v_mfma_f32_16x16x16_bf16 v[80:83], a[136:137], v[22:23], v[80:83]
    v_rcp_f32 v6, v28
    v_mfma_f32_16x16x16_bf16 v[84:87], a[138:139], v[20:21], v[84:87]
    v_mfma_f32_16x16x16_bf16 v[88:91], a[138:139], v[22:23], v[88:91]
    v_mul_f32 v76, v6, v76
    v_mul_f32 v80, v6, v80
    v_cvt_pk_bf16_f32 v124, v76, v80
    v_mul_f32 v77, v6, v77
    v_mul_f32 v81, v6, v81
    v_cvt_pk_bf16_f32 v125, v77, v81
    v_mul_f32 v78, v6, v78
    v_mul_f32 v82, v6, v82
    v_cvt_pk_bf16_f32 v126, v78, v82
    v_mul_f32 v79, v6, v79
    v_mul_f32 v83, v6, v83
    v_cvt_pk_bf16_f32 v127, v79, v83
    s_add_u32 s17, s48, 0
    buffer_store_dwordx4 v[124:127], v0, s[8:11], s17 offen offset:1024 sc1
    v_mfma_f32_16x16x16_bf16 v[92:95], a[140:141], v[20:21], v[92:95]
    v_mfma_f32_16x16x16_bf16 v[96:99], a[140:141], v[22:23], v[96:99]
    v_mul_f32 v84, v6, v84
    v_mul_f32 v88, v6, v88
    v_cvt_pk_bf16_f32 v128, v84, v88
    v_mul_f32 v85, v6, v85
    v_mul_f32 v89, v6, v89
    v_cvt_pk_bf16_f32 v129, v85, v89
    v_mul_f32 v86, v6, v86
    v_mul_f32 v90, v6, v90
    v_cvt_pk_bf16_f32 v130, v86, v90
    v_mul_f32 v87, v6, v87
    v_mul_f32 v91, v6, v91
    v_cvt_pk_bf16_f32 v131, v87, v91
    buffer_store_dwordx4 v[128:131], v0, s[8:11], s17 offen offset:3072 sc1
    v_mfma_f32_16x16x16_bf16 v[100:103], a[142:143], v[20:21], v[100:103]
    v_mfma_f32_16x16x16_bf16 v[104:107], a[142:143], v[22:23], v[104:107]
    v_mul_f32 v92, v6, v92
    v_mul_f32 v96, v6, v96
    v_cvt_pk_bf16_f32 v132, v92, v96
    v_mul_f32 v93, v6, v93
    v_mul_f32 v97, v6, v97
    v_cvt_pk_bf16_f32 v133, v93, v97
    v_mul_f32 v94, v6, v94
    v_mul_f32 v98, v6, v98
    v_cvt_pk_bf16_f32 v134, v94, v98
    v_mul_f32 v95, v6, v95
    v_mul_f32 v99, v6, v99
    v_cvt_pk_bf16_f32 v135, v95, v99
    s_add_u32 s17, s48, 4096
    buffer_store_dwordx4 v[132:135], v0, s[8:11], s17 offen offset:1024 sc1
    v_mul_f32 v100, v6, v100
    v_mul_f32 v104, v6, v104
    v_cvt_pk_bf16_f32 v136, v100, v104
    v_mul_f32 v101, v6, v101
    v_mul_f32 v105, v6, v105
    v_cvt_pk_bf16_f32 v137, v101, v105
    v_mul_f32 v102, v6, v102
    v_mul_f32 v106, v6, v106
    v_cvt_pk_bf16_f32 v138, v102, v106
    v_mul_f32 v103, v6, v103
    v_mul_f32 v107, v6, v107
    v_cvt_pk_bf16_f32 v139, v103, v107
    buffer_store_dwordx4 v[136:139], v0, s[8:11], s17 offen offset:3072 sc1
    s_add_u32 s48, s48, 262144
    s_mov_b32 s49, 22528
    s_cmp_ge_u32 s37, 64
    s_cbranch_scc1 Lta_end
    s_branch Lta0
Lta_end:
    s_waitcnt vmcnt(0)
    s_mov_b64 exec, 1
    buffer_store_dword v3, v4, s[8:11], s43 offen sc1
    s_mov_b64 exec, -1
    s_branch L_role_ta_exit
L_role_ta_abort:
    s_waitcnt lgkmcnt(0)
    s_mov_b64 exec, -1
    v_mov_b32 v0, 60
    s_lshl_b32 s5, s3, 8
    s_or_b32 s5, s5, s4
    s_or_b32 s5, s5, 0x10000
    v_mov_b32 v1, s5
    global_store_dword v0, v1, s[12:13]
    s_endpgm
L_role_ta_exit:
    s_endpgm
.p2align 6
L_role_tw:
    v_and_b32 v5, 63, v0
    v_lshlrev_b32 v0, 4, v5
    v_and_b32 v7, 15, v5
    v_lshrrev_b32 v8, 4, v5
    v_min_u32 v1, 31, v5
    v_lshrrev_b32 v6, 2, v1
    v_and_b32 v1, 3, v1
    v_lshlrev_b32 v1, 2, v1
    v_lshl_add_u32 v1, v6, 7, v1
    v_mov_b32 v3, 1
    v_mov_b32 v4, 0
    s_mov_b32 s44, 0x05040100
    s_mov_b32 s45, 0x07060302
    s_cmp_lg_u32 s14, 0
    s_cbranch_scc1 Ltw_gate_d
    v_mov_b32 v5, 48
    s_mov_b32 s16, 0
Ltw_gate:
    global_load_dword v6, v5, s[12:13] sc1
    s_add_u32 s16, s16, 1
    s_cmp_gt_u32 s16, 100000
    s_cbranch_scc1 L_role_tw_abort
    s_waitcnt vmcnt(0)
    v_cmp_gt_u32 vcc, 32, v6
    s_nop 0
    s_cbranch_vccz Ltw_gate_d
    s_sleep 100
    s_branch Ltw_gate
Ltw_gate_d:
    s_barrier
    s_load_dwordx2 s[20:21], s[0:1], 64
    s_mov_b32 s22, 4718592
    s_mov_b32 s23, 0x00020000
    s_waitcnt lgkmcnt(0)
    s_and_b32 s21, s21, 0xffff
    s_load_dwordx2 s[24:25], s[0:1], 80
    s_mov_b32 s26, 2359296
    s_mov_b32 s27, 0x00020000
    s_waitcnt lgkmcnt(0)
    s_and_b32 s25, s25, 0xffff
    s_mul_i32 s17, s15, 43
    s_lshr_b32 s32, s17, 9
    s_mul_i32 s17, s32, 12
    s_sub_u32 s50, s15, s17
    s_add_u32 s33, s32, 30
    s_cmp_eq_u32 s32, 2
    s_cselect_b32 s33, 0, s33
    s_cselect_b32 s32, 64, s32
    s_mul_i32 s49, s50, 96
    s_mul_i32 s17, s14, 1179648
    s_add_u32 s49, s49, s17
    v_mul_u32_u24 v5, 4608, v8
    v_lshl_add_u32 v9, v7, 2, v5
    v_add_u32 v10, 18432, v9
    v_and_b32 v6, 14, v7
    v_lshl_add_u32 v12, v6, 1, v5
    v_add_u32 v12, 64, v12
    v_add_u32 v13, 18432, v12
    v_and_b32 v5, 1, v7
    v_mov_b32 v11, s44
    v_mov_b32 v6, s45
    v_cmp_eq_u32 vcc, 1, v5
    s_nop 1
    v_cndmask_b32 v11, v11, v6, vcc
    s_add_u32 s17, s49, 0
    buffer_load_dword v16, v9, s[20:23], s17 offen
    buffer_load_dword v17, v10, s[20:23], s17 offen
    buffer_load_dword v18, v12, s[20:23], s17 offen
    buffer_load_dword v19, v13, s[20:23], s17 offen
    s_add_u32 s17, s49, 1152
    buffer_load_dword v20, v9, s[20:23], s17 offen
    buffer_load_dword v21, v10, s[20:23], s17 offen
    buffer_load_dword v22, v12, s[20:23], s17 offen
    buffer_load_dword v23, v13, s[20:23], s17 offen
    s_add_u32 s17, s49, 2304
    buffer_load_dword v24, v9, s[20:23], s17 offen
    buffer_load_dword v25, v10, s[20:23], s17 offen
    buffer_load_dword v26, v12, s[20:23], s17 offen
    buffer_load_dword v27, v13, s[20:23], s17 offen
    s_add_u32 s17, s49, 3456
    buffer_load_dword v28, v9, s[20:23], s17 offen
    buffer_load_dword v29, v10, s[20:23], s17 offen
    buffer_load_dword v30, v12, s[20:23], s17 offen
    buffer_load_dword v31, v13, s[20:23], s17 offen
    s_add_u32 s17, s49, 36864
    buffer_load_dword v32, v9, s[20:23], s17 offen
    buffer_load_dword v33, v10, s[20:23], s17 offen
    buffer_load_dword v34, v12, s[20:23], s17 offen
    buffer_load_dword v35, v13, s[20:23], s17 offen
    s_add_u32 s17, s49, 38016
    buffer_load_dword v36, v9, s[20:23], s17 offen
    buffer_load_dword v37, v10, s[20:23], s17 offen
    buffer_load_dword v38, v12, s[20:23], s17 offen
    buffer_load_dword v39, v13, s[20:23], s17 offen
    s_add_u32 s17, s49, 39168
    buffer_load_dword v40, v9, s[20:23], s17 offen
    buffer_load_dword v41, v10, s[20:23], s17 offen
    buffer_load_dword v42, v12, s[20:23], s17 offen
    buffer_load_dword v43, v13, s[20:23], s17 offen
    s_add_u32 s17, s49, 40320
    buffer_load_dword v44, v9, s[20:23], s17 offen
    buffer_load_dword v45, v10, s[20:23], s17 offen
    buffer_load_dword v46, v12, s[20:23], s17 offen
    buffer_load_dword v47, v13, s[20:23], s17 offen
    s_add_u32 s17, s49, 73728
    buffer_load_dword v48, v9, s[20:23], s17 offen
    buffer_load_dword v49, v10, s[20:23], s17 offen
    buffer_load_dword v50, v12, s[20:23], s17 offen
    buffer_load_dword v51, v13, s[20:23], s17 offen
    s_add_u32 s17, s49, 74880
    buffer_load_dword v52, v9, s[20:23], s17 offen
    buffer_load_dword v53, v10, s[20:23], s17 offen
    buffer_load_dword v54, v12, s[20:23], s17 offen
    buffer_load_dword v55, v13, s[20:23], s17 offen
    s_add_u32 s17, s49, 76032
    buffer_load_dword v56, v9, s[20:23], s17 offen
    buffer_load_dword v57, v10, s[20:23], s17 offen
    buffer_load_dword v58, v12, s[20:23], s17 offen
    buffer_load_dword v59, v13, s[20:23], s17 offen
    s_add_u32 s17, s49, 77184
    buffer_load_dword v60, v9, s[20:23], s17 offen
    buffer_load_dword v61, v10, s[20:23], s17 offen
    buffer_load_dword v62, v12, s[20:23], s17 offen
    buffer_load_dword v63, v13, s[20:23], s17 offen
    s_add_u32 s17, s49, 110592
    buffer_load_dword v64, v9, s[20:23], s17 offen
    buffer_load_dword v65, v10, s[20:23], s17 offen
    buffer_load_dword v66, v12, s[20:23], s17 offen
    buffer_load_dword v67, v13, s[20:23], s17 offen
    s_add_u32 s17, s49, 111744
    buffer_load_dword v68, v9, s[20:23], s17 offen
    buffer_load_dword v69, v10, s[20:23], s17 offen
    buffer_load_dword v70, v12, s[20:23], s17 offen
    buffer_load_dword v71, v13, s[20:23], s17 offen
    s_add_u32 s17, s49, 112896
    buffer_load_dword v72, v9, s[20:23], s17 offen
    buffer_load_dword v73, v10, s[20:23], s17 offen
    buffer_load_dword v74, v12, s[20:23], s17 offen
    buffer_load_dword v75, v13, s[20:23], s17 offen
    s_waitcnt vmcnt(58)
    v_perm_b32 v5, v17, v16, s44
    v_perm_b32 v6, v17, v16, s45
    s_waitcnt vmcnt(56)
    v_perm_b32 v128, v19, v18, v11
    v_accvgpr_write_b32 a0, v5
    v_accvgpr_write_b32 a4, v6
    s_add_u32 s17, s49, 114048
    buffer_load_dword v76, v9, s[20:23], s17 offen
    buffer_load_dword v77, v10, s[20:23], s17 offen
    buffer_load_dword v78, v12, s[20:23], s17 offen
    buffer_load_dword v79, v13, s[20:23], s17 offen
    s_waitcnt vmcnt(58)
    v_perm_b32 v5, v21, v20, s44
    v_perm_b32 v6, v21, v20, s45
    s_waitcnt vmcnt(56)
    v_perm_b32 v129, v23, v22, v11
    v_accvgpr_write_b32 a1, v5
    v_accvgpr_write_b32 a5, v6
    s_add_u32 s17, s49, 147456
    buffer_load_dword v80, v9, s[20:23], s17 offen
    buffer_load_dword v81, v10, s[20:23], s17 offen
    buffer_load_dword v82, v12, s[20:23], s17 offen
    buffer_load_dword v83, v13, s[20:23], s17 offen
    s_waitcnt vmcnt(58)
    v_perm_b32 v5, v25, v24, s44
    v_perm_b32 v6, v25, v24, s45
    s_waitcnt vmcnt(56)
    v_perm_b32 v130, v27, v26, v11
    v_accvgpr_write_b32 a2, v5
    v_accvgpr_write_b32 a6, v6
    s_add_u32 s17, s49, 148608
    buffer_load_dword v84, v9, s[20:23], s17 offen
    buffer_load_dword v85, v10, s[20:23], s17 offen
    buffer_load_dword v86, v12, s[20:23], s17 offen
    buffer_load_dword v87, v13, s[20:23], s17 offen
    s_waitcnt vmcnt(58)
    v_perm_b32 v5, v29, v28, s44
    v_perm_b32 v6, v29, v28, s45
    s_waitcnt vmcnt(56)
    v_perm_b32 v131, v31, v30, v11
    v_accvgpr_write_b32 a3, v5
    v_accvgpr_write_b32 a7, v6
    s_add_u32 s17, s49, 149760
    buffer_load_dword v88, v9, s[20:23], s17 offen
    buffer_load_dword v89, v10, s[20:23], s17 offen
    buffer_load_dword v90, v12, s[20:23], s17 offen
    buffer_load_dword v91, v13, s[20:23], s17 offen
    s_waitcnt vmcnt(58)
    v_perm_b32 v5, v33, v32, s44
    v_perm_b32 v6, v33, v32, s45
    s_waitcnt vmcnt(56)
    v_perm_b32 v132, v35, v34, v11
    v_accvgpr_write_b32 a8, v5
    v_accvgpr_write_b32 a12, v6
    s_add_u32 s17, s49, 150912
    buffer_load_dword v92, v9, s[20:23], s17 offen
    buffer_load_dword v93, v10, s[20:23], s17 offen
    buffer_load_dword v94, v12, s[20:23], s17 offen
    buffer_load_dword v95, v13, s[20:23], s17 offen
    s_waitcnt vmcnt(58)
    v_perm_b32 v5, v37, v36, s44
    v_perm_b32 v6, v37, v36, s45
    s_waitcnt vmcnt(56)
    v_perm_b32 v133, v39, v38, v11
    v_accvgpr_write_b32 a9, v5
    v_accvgpr_write_b32 a13, v6
    s_add_u32 s17, s49, 184320
    buffer_load_dword v96, v9, s[20:23], s17 offen
    buffer_load_dword v97, v10, s[20:23], s17 offen
    buffer_load_dword v98, v12, s[20:23], s17 offen
    buffer_load_dword v99, v13, s[20:23], s17 offen
    s_waitcnt vmcnt(58)
    v_perm_b32 v5, v41, v40, s44
    v_perm_b32 v6, v41, v40, s45
    s_waitcnt vmcnt(56)
    v_perm_b32 v134, v43, v42, v11
    v_accvgpr_write_b32 a10, v5
    v_accvgpr_write_b32 a14, v6
    s_add_u32 s17, s49, 185472
    buffer_load_dword v100, v9, s[20:23], s17 offen
    buffer_load_dword v101, v10, s[20:23], s17 offen
    buffer_load_dword v102, v12, s[20:23], s17 offen
    buffer_load_dword v103, v13, s[20:23], s17 offen
    s_waitcnt vmcnt(58)
    v_perm_b32 v5, v45, v44, s44
    v_perm_b32 v6, v45, v44, s45
    s_waitcnt vmcnt(56)
    v_perm_b32 v135, v47, v46, v11
    v_accvgpr_write_b32 a11, v5
    v_accvgpr_write_b32 a15, v6
    s_add_u32 s17, s49, 186624
    buffer_load_dword v104, v9, s[20:23], s17 offen
    buffer_load_dword v105, v10, s[20:23], s17 offen
    buffer_load_dword v106, v12, s[20:23], s17 offen
    buffer_load_dword v107, v13, s[20:23], s17 offen
    s_waitcnt vmcnt(58)
    v_perm_b32 v5, v49, v48, s44
    v_perm_b32 v6, v49, v48, s45
    s_waitcnt vmcnt(56)
    v_perm_b32 v136, v51, v50, v11
    v_accvgpr_write_b32 a16, v5
    v_accvgpr_write_b32 a20, v6
    s_add_u32 s17, s49, 187776
    buffer_load_dword v108, v9, s[20:23], s17 offen
    buffer_load_dword v109, v10, s[20:23], s17 offen
    buffer_load_dword v110, v12, s[20:23], s17 offen
    buffer_load_dword v111, v13, s[20:23], s17 offen
    s_waitcnt vmcnt(58)
    v_perm_b32 v5, v53, v52, s44
    v_perm_b32 v6, v53, v52, s45
    s_waitcnt vmcnt(56)
    v_perm_b32 v137, v55, v54, v11
    v_accvgpr_write_b32 a17, v5
    v_accvgpr_write_b32 a21, v6
    s_add_u32 s17, s49, 221184
    buffer_load_dword v112, v9, s[20:23], s17 offen
    buffer_load_dword v113, v10, s[20:23], s17 offen
    buffer_load_dword v114, v12, s[20:23], s17 offen
    buffer_load_dword v115, v13, s[20:23], s17 offen
    s_waitcnt vmcnt(58)
    v_perm_b32 v5, v57, v56, s44
    v_perm_b32 v6, v57, v56, s45
    s_waitcnt vmcnt(56)
    v_perm_b32 v138, v59, v58, v11
    v_accvgpr_write_b32 a18, v5
    v_accvgpr_write_b32 a22, v6
    s_add_u32 s17, s49, 222336
    buffer_load_dword v116, v9, s[20:23], s17 offen
    buffer_load_dword v117, v10, s[20:23], s17 offen
    buffer_load_dword v118, v12, s[20:23], s17 offen
    buffer_load_dword v119, v13, s[20:23], s17 offen
    s_waitcnt vmcnt(58)
    v_perm_b32 v5, v61, v60, s44
    v_perm_b32 v6, v61, v60, s45
    s_waitcnt vmcnt(56)
    v_perm_b32 v139, v63, v62, v11
    v_accvgpr_write_b32 a19, v5
    v_accvgpr_write_b32 a23, v6
    s_add_u32 s17, s49, 223488
    buffer_load_dword v120, v9, s[20:23], s17 offen
    buffer_load_dword v121, v10, s[20:23], s17 offen
    buffer_load_dword v122, v12, s[20:23], s17 offen
    buffer_load_dword v123, v13, s[20:23], s17 offen
    s_waitcnt vmcnt(58)
    v_perm_b32 v5, v65, v64, s44
    v_perm_b32 v6, v65, v64, s45
    s_waitcnt vmcnt(56)
    v_perm_b32 v140, v67, v66, v11
    v_accvgpr_write_b32 a24, v5
    v_accvgpr_write_b32 a28, v6
    s_add_u32 s17, s49, 224640
    buffer_load_dword v124, v9, s[20:23], s17 offen
    buffer_load_dword v125, v10, s[20:23], s17 offen
    buffer_load_dword v126, v12, s[20:23], s17 offen
    buffer_load_dword v127, v13, s[20:23], s17 offen
    s_waitcnt vmcnt(58)
    v_perm_b32 v5, v69, v68, s44
    v_perm_b32 v6, v69, v68, s45
    s_waitcnt vmcnt(56)
    v_perm_b32 v141, v71, v70, v11
    v_accvgpr_write_b32 a25, v5
    v_accvgpr_write_b32 a29, v6
    s_add_u32 s17, s49, 258048
    buffer_load_dword v16, v9, s[20:23], s17 offen
    buffer_load_dword v17, v10, s[20:23], s17 offen
    buffer_load_dword v18, v12, s[20:23], s17 offen
    buffer_load_dword v19, v13, s[20:23], s17 offen
    s_waitcnt vmcnt(58)
    v_perm_b32 v5, v73, v72, s44
    v_perm_b32 v6, v73, v72, s45
    s_waitcnt vmcnt(56)
    v_perm_b32 v142, v75, v74, v11
    v_accvgpr_write_b32 a26, v5
    v_accvgpr_write_b32 a30, v6
    s_add_u32 s17, s49, 259200
    buffer_load_dword v20, v9, s[20:23], s17 offen
    buffer_load_dword v21, v10, s[20:23], s17 offen
    buffer_load_dword v22, v12, s[20:23], s17 offen
    buffer_load_dword v23, v13, s[20:23], s17 offen
    s_waitcnt vmcnt(58)
    v_perm_b32 v5, v77, v76, s44
    v_perm_b32 v6, v77, v76, s45
    s_waitcnt vmcnt(56)
    v_perm_b32 v143, v79, v78, v11
    v_accvgpr_write_b32 a27, v5
    v_accvgpr_write_b32 a31, v6
    s_add_u32 s17, s49, 260352
    buffer_load_dword v24, v9, s[20:23], s17 offen
    buffer_load_dword v25, v10, s[20:23], s17 offen
    buffer_load_dword v26, v12, s[20:23], s17 offen
    buffer_load_dword v27, v13, s[20:23], s17 offen
    s_waitcnt vmcnt(58)
    v_perm_b32 v5, v81, v80, s44
    v_perm_b32 v6, v81, v80, s45
    s_waitcnt vmcnt(56)
    v_perm_b32 v144, v83, v82, v11
    v_accvgpr_write_b32 a32, v5
    v_accvgpr_write_b32 a36, v6
    s_add_u32 s17, s49, 261504
    buffer_load_dword v28, v9, s[20:23], s17 offen
    buffer_load_dword v29, v10, s[20:23], s17 offen
    buffer_load_dword v30, v12, s[20:23], s17 offen
    buffer_load_dword v31, v13, s[20:23], s17 offen
    s_waitcnt vmcnt(58)
    v_perm_b32 v5, v85, v84, s44
    v_perm_b32 v6, v85, v84, s45
    s_waitcnt vmcnt(56)
    v_perm_b32 v145, v87, v86, v11
    v_accvgpr_write_b32 a33, v5
    v_accvgpr_write_b32 a37, v6
    s_add_u32 s17, s49, 294912
    buffer_load_dword v32, v9, s[20:23], s17 offen
    buffer_load_dword v33, v10, s[20:23], s17 offen
    buffer_load_dword v34, v12, s[20:23], s17 offen
    buffer_load_dword v35, v13, s[20:23], s17 offen
    s_waitcnt vmcnt(58)
    v_perm_b32 v5, v89, v88, s44
    v_perm_b32 v6, v89, v88, s45
    s_waitcnt vmcnt(56)
    v_perm_b32 v146, v91, v90, v11
    v_accvgpr_write_b32 a34, v5
    v_accvgpr_write_b32 a38, v6
    s_add_u32 s17, s49, 296064
    buffer_load_dword v36, v9, s[20:23], s17 offen
    buffer_load_dword v37, v10, s[20:23], s17 offen
    buffer_load_dword v38, v12, s[20:23], s17 offen
    buffer_load_dword v39, v13, s[20:23], s17 offen
    s_waitcnt vmcnt(58)
    v_perm_b32 v5, v93, v92, s44
    v_perm_b32 v6, v93, v92, s45
    s_waitcnt vmcnt(56)
    v_perm_b32 v147, v95, v94, v11
    v_accvgpr_write_b32 a35, v5
    v_accvgpr_write_b32 a39, v6
    s_add_u32 s17, s49, 297216
    buffer_load_dword v40, v9, s[20:23], s17 offen
    buffer_load_dword v41, v10, s[20:23], s17 offen
    buffer_load_dword v42, v12, s[20:23], s17 offen
    buffer_load_dword v43, v13, s[20:23], s17 offen
    s_waitcnt vmcnt(58)
    v_perm_b32 v5, v97, v96, s44
    v_perm_b32 v6, v97, v96, s45
    s_waitcnt vmcnt(56)
    v_perm_b32 v148, v99, v98, v11
    v_accvgpr_write_b32 a40, v5
    v_accvgpr_write_b32 a44, v6
    s_add_u32 s17, s49, 298368
    buffer_load_dword v44, v9, s[20:23], s17 offen
    buffer_load_dword v45, v10, s[20:23], s17 offen
    buffer_load_dword v46, v12, s[20:23], s17 offen
    buffer_load_dword v47, v13, s[20:23], s17 offen
    s_waitcnt vmcnt(58)
    v_perm_b32 v5, v101, v100, s44
    v_perm_b32 v6, v101, v100, s45
    s_waitcnt vmcnt(56)
    v_perm_b32 v149, v103, v102, v11
    v_accvgpr_write_b32 a41, v5
    v_accvgpr_write_b32 a45, v6
    s_add_u32 s17, s49, 331776
    buffer_load_dword v48, v9, s[20:23], s17 offen
    buffer_load_dword v49, v10, s[20:23], s17 offen
    buffer_load_dword v50, v12, s[20:23], s17 offen
    buffer_load_dword v51, v13, s[20:23], s17 offen
    s_waitcnt vmcnt(58)
    v_perm_b32 v5, v105, v104, s44
    v_perm_b32 v6, v105, v104, s45
    s_waitcnt vmcnt(56)
    v_perm_b32 v150, v107, v106, v11
    v_accvgpr_write_b32 a42, v5
    v_accvgpr_write_b32 a46, v6
    s_add_u32 s17, s49, 332928
    buffer_load_dword v52, v9, s[20:23], s17 offen
    buffer_load_dword v53, v10, s[20:23], s17 offen
    buffer_load_dword v54, v12, s[20:23], s17 offen
    buffer_load_dword v55, v13, s[20:23], s17 offen
    s_waitcnt vmcnt(58)
    v_perm_b32 v5, v109, v108, s44
    v_perm_b32 v6, v109, v108, s45
    s_waitcnt vmcnt(56)
    v_perm_b32 v151, v111, v110, v11
    v_accvgpr_write_b32 a43, v5
    v_accvgpr_write_b32 a47, v6
    s_add_u32 s17, s49, 334080
    buffer_load_dword v56, v9, s[20:23], s17 offen
    buffer_load_dword v57, v10, s[20:23], s17 offen
    buffer_load_dword v58, v12, s[20:23], s17 offen
    buffer_load_dword v59, v13, s[20:23], s17 offen
    s_waitcnt vmcnt(58)
    v_perm_b32 v5, v113, v112, s44
    v_perm_b32 v6, v113, v112, s45
    s_waitcnt vmcnt(56)
    v_perm_b32 v152, v115, v114, v11
    v_accvgpr_write_b32 a48, v5
    v_accvgpr_write_b32 a52, v6
    s_add_u32 s17, s49, 335232
    buffer_load_dword v60, v9, s[20:23], s17 offen
    buffer_load_dword v61, v10, s[20:23], s17 offen
    buffer_load_dword v62, v12, s[20:23], s17 offen
    buffer_load_dword v63, v13, s[20:23], s17 offen
    s_waitcnt vmcnt(58)
    v_perm_b32 v5, v117, v116, s44
    v_perm_b32 v6, v117, v116, s45
    s_waitcnt vmcnt(56)
    v_perm_b32 v153, v119, v118, v11
    v_accvgpr_write_b32 a49, v5
    v_accvgpr_write_b32 a53, v6
    s_add_u32 s17, s49, 368640
    buffer_load_dword v64, v9, s[20:23], s17 offen
    buffer_load_dword v65, v10, s[20:23], s17 offen
    buffer_load_dword v66, v12, s[20:23], s17 offen
    buffer_load_dword v67, v13, s[20:23], s17 offen
    s_waitcnt vmcnt(58)
    v_perm_b32 v5, v121, v120, s44
    v_perm_b32 v6, v121, v120, s45
    s_waitcnt vmcnt(56)
    v_perm_b32 v154, v123, v122, v11
    v_accvgpr_write_b32 a50, v5
    v_accvgpr_write_b32 a54, v6
    s_add_u32 s17, s49, 369792
    buffer_load_dword v68, v9, s[20:23], s17 offen
    buffer_load_dword v69, v10, s[20:23], s17 offen
    buffer_load_dword v70, v12, s[20:23], s17 offen
    buffer_load_dword v71, v13, s[20:23], s17 offen
    s_waitcnt vmcnt(58)
    v_perm_b32 v5, v125, v124, s44
    v_perm_b32 v6, v125, v124, s45
    s_waitcnt vmcnt(56)
    v_perm_b32 v155, v127, v126, v11
    v_accvgpr_write_b32 a51, v5
    v_accvgpr_write_b32 a55, v6
    s_add_u32 s17, s49, 370944
    buffer_load_dword v72, v9, s[20:23], s17 offen
    buffer_load_dword v73, v10, s[20:23], s17 offen
    buffer_load_dword v74, v12, s[20:23], s17 offen
    buffer_load_dword v75, v13, s[20:23], s17 offen
    s_waitcnt vmcnt(58)
    v_perm_b32 v5, v17, v16, s44
    v_perm_b32 v6, v17, v16, s45
    s_waitcnt vmcnt(56)
    v_perm_b32 v156, v19, v18, v11
    v_accvgpr_write_b32 a56, v5
    v_accvgpr_write_b32 a60, v6
    s_add_u32 s17, s49, 372096
    buffer_load_dword v76, v9, s[20:23], s17 offen
    buffer_load_dword v77, v10, s[20:23], s17 offen
    buffer_load_dword v78, v12, s[20:23], s17 offen
    buffer_load_dword v79, v13, s[20:23], s17 offen
    s_waitcnt vmcnt(58)
    v_perm_b32 v5, v21, v20, s44
    v_perm_b32 v6, v21, v20, s45
    s_waitcnt vmcnt(56)
    v_perm_b32 v157, v23, v22, v11
    v_accvgpr_write_b32 a57, v5
    v_accvgpr_write_b32 a61, v6
    s_add_u32 s17, s49, 405504
    buffer_load_dword v80, v9, s[20:23], s17 offen
    buffer_load_dword v81, v10, s[20:23], s17 offen
    buffer_load_dword v82, v12, s[20:23], s17 offen
    buffer_load_dword v83, v13, s[20:23], s17 offen
    s_waitcnt vmcnt(58)
    v_perm_b32 v5, v25, v24, s44
    v_perm_b32 v6, v25, v24, s45
    s_waitcnt vmcnt(56)
    v_perm_b32 v158, v27, v26, v11
    v_accvgpr_write_b32 a58, v5
    v_accvgpr_write_b32 a62, v6
    s_add_u32 s17, s49, 406656
    buffer_load_dword v84, v9, s[20:23], s17 offen
    buffer_load_dword v85, v10, s[20:23], s17 offen
    buffer_load_dword v86, v12, s[20:23], s17 offen
    buffer_load_dword v87, v13, s[20:23], s17 offen
    s_waitcnt vmcnt(58)
    v_perm_b32 v5, v29, v28, s44
    v_perm_b32 v6, v29, v28, s45
    s_waitcnt vmcnt(56)
    v_perm_b32 v159, v31, v30, v11
    v_accvgpr_write_b32 a59, v5
    v_accvgpr_write_b32 a63, v6
    s_add_u32 s17, s49, 407808
    buffer_load_dword v88, v9, s[20:23], s17 offen
    buffer_load_dword v89, v10, s[20:23], s17 offen
    buffer_load_dword v90, v12, s[20:23], s17 offen
    buffer_load_dword v91, v13, s[20:23], s17 offen
    s_waitcnt vmcnt(58)
    v_perm_b32 v5, v33, v32, s44
    v_perm_b32 v6, v33, v32, s45
    s_waitcnt vmcnt(56)
    v_perm_b32 v160, v35, v34, v11
    v_accvgpr_write_b32 a64, v5
    v_accvgpr_write_b32 a68, v6
    s_add_u32 s17, s49, 408960
    buffer_load_dword v92, v9, s[20:23], s17 offen
    buffer_load_dword v93, v10, s[20:23], s17 offen
    buffer_load_dword v94, v12, s[20:23], s17 offen
    buffer_load_dword v95, v13, s[20:23], s17 offen
    s_waitcnt vmcnt(58)
    v_perm_b32 v5, v37, v36, s44
    v_perm_b32 v6, v37, v36, s45
    s_waitcnt vmcnt(56)
    v_perm_b32 v161, v39, v38, v11
    v_accvgpr_write_b32 a65, v5
    v_accvgpr_write_b32 a69, v6
    s_add_u32 s17, s49, 442368
    buffer_load_dword v96, v9, s[20:23], s17 offen
    buffer_load_dword v97, v10, s[20:23], s17 offen
    buffer_load_dword v98, v12, s[20:23], s17 offen
    buffer_load_dword v99, v13, s[20:23], s17 offen
    s_waitcnt vmcnt(58)
    v_perm_b32 v5, v41, v40, s44
    v_perm_b32 v6, v41, v40, s45
    s_waitcnt vmcnt(56)
    v_perm_b32 v162, v43, v42, v11
    v_accvgpr_write_b32 a66, v5
    v_accvgpr_write_b32 a70, v6
    s_add_u32 s17, s49, 443520
    buffer_load_dword v100, v9, s[20:23], s17 offen
    buffer_load_dword v101, v10, s[20:23], s17 offen
    buffer_load_dword v102, v12, s[20:23], s17 offen
    buffer_load_dword v103, v13, s[20:23], s17 offen
    s_waitcnt vmcnt(58)
    v_perm_b32 v5, v45, v44, s44
    v_perm_b32 v6, v45, v44, s45
    s_waitcnt vmcnt(56)
    v_perm_b32 v163, v47, v46, v11
    v_accvgpr_write_b32 a67, v5
    v_accvgpr_write_b32 a71, v6
    s_add_u32 s17, s49, 444672
    buffer_load_dword v104, v9, s[20:23], s17 offen
    buffer_load_dword v105, v10, s[20:23], s17 offen
    buffer_load_dword v106, v12, s[20:23], s17 offen
    buffer_load_dword v107, v13, s[20:23], s17 offen
    s_waitcnt vmcnt(58)
    v_perm_b32 v5, v49, v48, s44
    v_perm_b32 v6, v49, v48, s45
    s_waitcnt vmcnt(56)
    v_perm_b32 v164, v51, v50, v11
    v_accvgpr_write_b32 a72, v5
    v_accvgpr_write_b32 a76, v6
    s_add_u32 s17, s49, 445824
    buffer_load_dword v108, v9, s[20:23], s17 offen
    buffer_load_dword v109, v10, s[20:23], s17 offen
    buffer_load_dword v110, v12, s[20:23], s17 offen
    buffer_load_dword v111, v13, s[20:23], s17 offen
    s_waitcnt vmcnt(58)
    v_perm_b32 v5, v53, v52, s44
    v_perm_b32 v6, v53, v52, s45
    s_waitcnt vmcnt(56)
    v_perm_b32 v165, v55, v54, v11
    v_accvgpr_write_b32 a73, v5
    v_accvgpr_write_b32 a77, v6
    s_add_u32 s17, s49, 479232
    buffer_load_dword v112, v9, s[20:23], s17 offen
    buffer_load_dword v113, v10, s[20:23], s17 offen
    buffer_load_dword v114, v12, s[20:23], s17 offen
    buffer_load_dword v115, v13, s[20:23], s17 offen
    s_waitcnt vmcnt(58)
    v_perm_b32 v5, v57, v56, s44
    v_perm_b32 v6, v57, v56, s45
    s_waitcnt vmcnt(56)
    v_perm_b32 v166, v59, v58, v11
    v_accvgpr_write_b32 a74, v5
    v_accvgpr_write_b32 a78, v6
    s_add_u32 s17, s49, 480384
    buffer_load_dword v116, v9, s[20:23], s17 offen
    buffer_load_dword v117, v10, s[20:23], s17 offen
    buffer_load_dword v118, v12, s[20:23], s17 offen
    buffer_load_dword v119, v13, s[20:23], s17 offen
    s_waitcnt vmcnt(58)
    v_perm_b32 v5, v61, v60, s44
    v_perm_b32 v6, v61, v60, s45
    s_waitcnt vmcnt(56)
    v_perm_b32 v167, v63, v62, v11
    v_accvgpr_write_b32 a75, v5
    v_accvgpr_write_b32 a79, v6
    s_add_u32 s17, s49, 481536
    buffer_load_dword v120, v9, s[20:23], s17 offen
    buffer_load_dword v121, v10, s[20:23], s17 offen
    buffer_load_dword v122, v12, s[20:23], s17 offen
    buffer_load_dword v123, v13, s[20:23], s17 offen
    s_waitcnt vmcnt(58)
    v_perm_b32 v5, v65, v64, s44
    v_perm_b32 v6, v65, v64, s45
    s_waitcnt vmcnt(56)
    v_perm_b32 v168, v67, v66, v11
    v_accvgpr_write_b32 a80, v5
    v_accvgpr_write_b32 a84, v6
    s_add_u32 s17, s49, 482688
    buffer_load_dword v124, v9, s[20:23], s17 offen
    buffer_load_dword v125, v10, s[20:23], s17 offen
    buffer_load_dword v126, v12, s[20:23], s17 offen
    buffer_load_dword v127, v13, s[20:23], s17 offen
    s_waitcnt vmcnt(58)
    v_perm_b32 v5, v69, v68, s44
    v_perm_b32 v6, v69, v68, s45
    s_waitcnt vmcnt(56)
    v_perm_b32 v169, v71, v70, v11
    v_accvgpr_write_b32 a81, v5
    v_accvgpr_write_b32 a85, v6
    s_add_u32 s17, s49, 516096
    buffer_load_dword v16, v9, s[20:23], s17 offen
    buffer_load_dword v17, v10, s[20:23], s17 offen
    buffer_load_dword v18, v12, s[20:23], s17 offen
    buffer_load_dword v19, v13, s[20:23], s17 offen
    s_waitcnt vmcnt(58)
    v_perm_b32 v5, v73, v72, s44
    v_perm_b32 v6, v73, v72, s45
    s_waitcnt vmcnt(56)
    v_perm_b32 v170, v75, v74, v11
    v_accvgpr_write_b32 a82, v5
    v_accvgpr_write_b32 a86, v6
    s_add_u32 s17, s49, 517248
    buffer_load_dword v20, v9, s[20:23], s17 offen
    buffer_load_dword v21, v10, s[20:23], s17 offen
    buffer_load_dword v22, v12, s[20:23], s17 offen
    buffer_load_dword v23, v13, s[20:23], s17 offen
    s_waitcnt vmcnt(58)
    v_perm_b32 v5, v77, v76, s44
    v_perm_b32 v6, v77, v76, s45
    s_waitcnt vmcnt(56)
    v_perm_b32 v171, v79, v78, v11
    v_accvgpr_write_b32 a83, v5
    v_accvgpr_write_b32 a87, v6
    s_add_u32 s17, s49, 518400
    buffer_load_dword v24, v9, s[20:23], s17 offen
    buffer_load_dword v25, v10, s[20:23], s17 offen
    buffer_load_dword v26, v12, s[20:23], s17 offen
    buffer_load_dword v27, v13, s[20:23], s17 offen
    s_waitcnt vmcnt(58)
    v_perm_b32 v5, v81, v80, s44
    v_perm_b32 v6, v81, v80, s45
    s_waitcnt vmcnt(56)
    v_perm_b32 v172, v83, v82, v11
    v_accvgpr_write_b32 a88, v5
    v_accvgpr_write_b32 a92, v6
    s_add_u32 s17, s49, 519552
    buffer_load_dword v28, v9, s[20:23], s17 offen
    buffer_load_dword v29, v10, s[20:23], s17 offen
    buffer_load_dword v30, v12, s[20:23], s17 offen
    buffer_load_dword v31, v13, s[20:23], s17 offen
    s_waitcnt vmcnt(58)
    v_perm_b32 v5, v85, v84, s44
    v_perm_b32 v6, v85, v84, s45
    s_waitcnt vmcnt(56)
    v_perm_b32 v173, v87, v86, v11
    v_accvgpr_write_b32 a89, v5
    v_accvgpr_write_b32 a93, v6
    s_add_u32 s17, s49, 552960
    buffer_load_dword v32, v9, s[20:23], s17 offen
    buffer_load_dword v33, v10, s[20:23], s17 offen
    buffer_load_dword v34, v12, s[20:23], s17 offen
    buffer_load_dword v35, v13, s[20:23], s17 offen
    s_waitcnt vmcnt(58)
    v_perm_b32 v5, v89, v88, s44
    v_perm_b32 v6, v89, v88, s45
    s_waitcnt vmcnt(56)
    v_perm_b32 v174, v91, v90, v11
    v_accvgpr_write_b32 a90, v5
    v_accvgpr_write_b32 a94, v6
    s_add_u32 s17, s49, 554112
    buffer_load_dword v36, v9, s[20:23], s17 offen
    buffer_load_dword v37, v10, s[20:23], s17 offen
    buffer_load_dword v38, v12, s[20:23], s17 offen
    buffer_load_dword v39, v13, s[20:23], s17 offen
    s_waitcnt vmcnt(58)
    v_perm_b32 v5, v93, v92, s44
    v_perm_b32 v6, v93, v92, s45
    s_waitcnt vmcnt(56)
    v_perm_b32 v175, v95, v94, v11
    v_accvgpr_write_b32 a91, v5
    v_accvgpr_write_b32 a95, v6
    s_add_u32 s17, s49, 555264
    buffer_load_dword v40, v9, s[20:23], s17 offen
    buffer_load_dword v41, v10, s[20:23], s17 offen
    buffer_load_dword v42, v12, s[20:23], s17 offen
    buffer_load_dword v43, v13, s[20:23], s17 offen
    s_waitcnt vmcnt(58)
    v_perm_b32 v5, v97, v96, s44
    v_perm_b32 v6, v97, v96, s45
    s_waitcnt vmcnt(56)
    v_perm_b32 v176, v99, v98, v11
    v_accvgpr_write_b32 a96, v5
    v_accvgpr_write_b32 a100, v6
    s_add_u32 s17, s49, 556416
    buffer_load_dword v44, v9, s[20:23], s17 offen
    buffer_load_dword v45, v10, s[20:23], s17 offen
    buffer_load_dword v46, v12, s[20:23], s17 offen
    buffer_load_dword v47, v13, s[20:23], s17 offen
    s_waitcnt vmcnt(58)
    v_perm_b32 v5, v101, v100, s44
    v_perm_b32 v6, v101, v100, s45
    s_waitcnt vmcnt(56)
    v_perm_b32 v177, v103, v102, v11
    v_accvgpr_write_b32 a97, v5
    v_accvgpr_write_b32 a101, v6
    s_add_u32 s17, s49, 589824
    buffer_load_dword v48, v9, s[20:23], s17 offen
    buffer_load_dword v49, v10, s[20:23], s17 offen
    buffer_load_dword v50, v12, s[20:23], s17 offen
    buffer_load_dword v51, v13, s[20:23], s17 offen
    s_waitcnt vmcnt(58)
    v_perm_b32 v5, v105, v104, s44
    v_perm_b32 v6, v105, v104, s45
    s_waitcnt vmcnt(56)
    v_perm_b32 v178, v107, v106, v11
    v_accvgpr_write_b32 a98, v5
    v_accvgpr_write_b32 a102, v6
    s_add_u32 s17, s49, 590976
    buffer_load_dword v52, v9, s[20:23], s17 offen
    buffer_load_dword v53, v10, s[20:23], s17 offen
    buffer_load_dword v54, v12, s[20:23], s17 offen
    buffer_load_dword v55, v13, s[20:23], s17 offen
    s_waitcnt vmcnt(58)
    v_perm_b32 v5, v109, v108, s44
    v_perm_b32 v6, v109, v108, s45
    s_waitcnt vmcnt(56)
    v_perm_b32 v179, v111, v110, v11
    v_accvgpr_write_b32 a99, v5
    v_accvgpr_write_b32 a103, v6
    s_add_u32 s17, s49, 592128
    buffer_load_dword v56, v9, s[20:23], s17 offen
    buffer_load_dword v57, v10, s[20:23], s17 offen
    buffer_load_dword v58, v12, s[20:23], s17 offen
    buffer_load_dword v59, v13, s[20:23], s17 offen
    s_waitcnt vmcnt(58)
    v_perm_b32 v5, v113, v112, s44
    v_perm_b32 v6, v113, v112, s45
    s_waitcnt vmcnt(56)
    v_perm_b32 v180, v115, v114, v11
    v_accvgpr_write_b32 a104, v5
    v_accvgpr_write_b32 a108, v6
    s_add_u32 s17, s49, 593280
    buffer_load_dword v60, v9, s[20:23], s17 offen
    buffer_load_dword v61, v10, s[20:23], s17 offen
    buffer_load_dword v62, v12, s[20:23], s17 offen
    buffer_load_dword v63, v13, s[20:23], s17 offen
    s_waitcnt vmcnt(58)
    v_perm_b32 v5, v117, v116, s44
    v_perm_b32 v6, v117, v116, s45
    s_waitcnt vmcnt(56)
    v_perm_b32 v181, v119, v118, v11
    v_accvgpr_write_b32 a105, v5
    v_accvgpr_write_b32 a109, v6
    s_add_u32 s17, s49, 626688
    buffer_load_dword v64, v9, s[20:23], s17 offen
    buffer_load_dword v65, v10, s[20:23], s17 offen
    buffer_load_dword v66, v12, s[20:23], s17 offen
    buffer_load_dword v67, v13, s[20:23], s17 offen
    s_waitcnt vmcnt(58)
    v_perm_b32 v5, v121, v120, s44
    v_perm_b32 v6, v121, v120, s45
    s_waitcnt vmcnt(56)
    v_perm_b32 v182, v123, v122, v11
    v_accvgpr_write_b32 a106, v5
    v_accvgpr_write_b32 a110, v6
    s_add_u32 s17, s49, 627840
    buffer_load_dword v68, v9, s[20:23], s17 offen
    buffer_load_dword v69, v10, s[20:23], s17 offen
    buffer_load_dword v70, v12, s[20:23], s17 offen
    buffer_load_dword v71, v13, s[20:23], s17 offen
    s_waitcnt vmcnt(58)
    v_perm_b32 v5, v125, v124, s44
    v_perm_b32 v6, v125, v124, s45
    s_waitcnt vmcnt(56)
    v_perm_b32 v183, v127, v126, v11
    v_accvgpr_write_b32 a107, v5
    v_accvgpr_write_b32 a111, v6
    s_add_u32 s17, s49, 628992
    buffer_load_dword v72, v9, s[20:23], s17 offen
    buffer_load_dword v73, v10, s[20:23], s17 offen
    buffer_load_dword v74, v12, s[20:23], s17 offen
    buffer_load_dword v75, v13, s[20:23], s17 offen
    s_waitcnt vmcnt(58)
    v_perm_b32 v5, v17, v16, s44
    v_perm_b32 v6, v17, v16, s45
    s_waitcnt vmcnt(56)
    v_perm_b32 v184, v19, v18, v11
    v_accvgpr_write_b32 a112, v5
    v_accvgpr_write_b32 a116, v6
    s_add_u32 s17, s49, 630144
    buffer_load_dword v76, v9, s[20:23], s17 offen
    buffer_load_dword v77, v10, s[20:23], s17 offen
    buffer_load_dword v78, v12, s[20:23], s17 offen
    buffer_load_dword v79, v13, s[20:23], s17 offen
    s_waitcnt vmcnt(58)
    v_perm_b32 v5, v21, v20, s44
    v_perm_b32 v6, v21, v20, s45
    s_waitcnt vmcnt(56)
    v_perm_b32 v185, v23, v22, v11
    v_accvgpr_write_b32 a113, v5
    v_accvgpr_write_b32 a117, v6
    s_add_u32 s17, s49, 663552
    buffer_load_dword v80, v9, s[20:23], s17 offen
    buffer_load_dword v81, v10, s[20:23], s17 offen
    buffer_load_dword v82, v12, s[20:23], s17 offen
    buffer_load_dword v83, v13, s[20:23], s17 offen
    s_waitcnt vmcnt(58)
    v_perm_b32 v5, v25, v24, s44
    v_perm_b32 v6, v25, v24, s45
    s_waitcnt vmcnt(56)
    v_perm_b32 v186, v27, v26, v11
    v_accvgpr_write_b32 a114, v5
    v_accvgpr_write_b32 a118, v6
    s_add_u32 s17, s49, 664704
    buffer_load_dword v84, v9, s[20:23], s17 offen
    buffer_load_dword v85, v10, s[20:23], s17 offen
    buffer_load_dword v86, v12, s[20:23], s17 offen
    buffer_load_dword v87, v13, s[20:23], s17 offen
    s_waitcnt vmcnt(58)
    v_perm_b32 v5, v29, v28, s44
    v_perm_b32 v6, v29, v28, s45
    s_waitcnt vmcnt(56)
    v_perm_b32 v187, v31, v30, v11
    v_accvgpr_write_b32 a115, v5
    v_accvgpr_write_b32 a119, v6
    s_add_u32 s17, s49, 665856
    buffer_load_dword v88, v9, s[20:23], s17 offen
    buffer_load_dword v89, v10, s[20:23], s17 offen
    buffer_load_dword v90, v12, s[20:23], s17 offen
    buffer_load_dword v91, v13, s[20:23], s17 offen
    s_waitcnt vmcnt(58)
    v_perm_b32 v5, v33, v32, s44
    v_perm_b32 v6, v33, v32, s45
    s_waitcnt vmcnt(56)
    v_perm_b32 v188, v35, v34, v11
    v_accvgpr_write_b32 a120, v5
    v_accvgpr_write_b32 a124, v6
    s_add_u32 s17, s49, 667008
    buffer_load_dword v92, v9, s[20:23], s17 offen
    buffer_load_dword v93, v10, s[20:23], s17 offen
    buffer_load_dword v94, v12, s[20:23], s17 offen
    buffer_load_dword v95, v13, s[20:23], s17 offen
    s_waitcnt vmcnt(58)
    v_perm_b32 v5, v37, v36, s44
    v_perm_b32 v6, v37, v36, s45
    s_waitcnt vmcnt(56)
    v_perm_b32 v189, v39, v38, v11
    v_accvgpr_write_b32 a121, v5
    v_accvgpr_write_b32 a125, v6
    s_add_u32 s17, s49, 700416
    buffer_load_dword v96, v9, s[20:23], s17 offen
    buffer_load_dword v97, v10, s[20:23], s17 offen
    buffer_load_dword v98, v12, s[20:23], s17 offen
    buffer_load_dword v99, v13, s[20:23], s17 offen
    s_waitcnt vmcnt(58)
    v_perm_b32 v5, v41, v40, s44
    v_perm_b32 v6, v41, v40, s45
    s_waitcnt vmcnt(56)
    v_perm_b32 v190, v43, v42, v11
    v_accvgpr_write_b32 a122, v5
    v_accvgpr_write_b32 a126, v6
    s_add_u32 s17, s49, 701568
    buffer_load_dword v100, v9, s[20:23], s17 offen
    buffer_load_dword v101, v10, s[20:23], s17 offen
    buffer_load_dword v102, v12, s[20:23], s17 offen
    buffer_load_dword v103, v13, s[20:23], s17 offen
    s_waitcnt vmcnt(58)
    v_perm_b32 v5, v45, v44, s44
    v_perm_b32 v6, v45, v44, s45
    s_waitcnt vmcnt(56)
    v_perm_b32 v191, v47, v46, v11
    v_accvgpr_write_b32 a123, v5
    v_accvgpr_write_b32 a127, v6
    s_add_u32 s17, s49, 702720
    buffer_load_dword v104, v9, s[20:23], s17 offen
    buffer_load_dword v105, v10, s[20:23], s17 offen
    buffer_load_dword v106, v12, s[20:23], s17 offen
    buffer_load_dword v107, v13, s[20:23], s17 offen
    s_waitcnt vmcnt(58)
    v_perm_b32 v5, v49, v48, s44
    v_perm_b32 v6, v49, v48, s45
    s_waitcnt vmcnt(56)
    v_perm_b32 v192, v51, v50, v11
    v_accvgpr_write_b32 a128, v5
    v_accvgpr_write_b32 a132, v6
    s_add_u32 s17, s49, 703872
    buffer_load_dword v108, v9, s[20:23], s17 offen
    buffer_load_dword v109, v10, s[20:23], s17 offen
    buffer_load_dword v110, v12, s[20:23], s17 offen
    buffer_load_dword v111, v13, s[20:23], s17 offen
    s_waitcnt vmcnt(58)
    v_perm_b32 v5, v53, v52, s44
    v_perm_b32 v6, v53, v52, s45
    s_waitcnt vmcnt(56)
    v_perm_b32 v193, v55, v54, v11
    v_accvgpr_write_b32 a129, v5
    v_accvgpr_write_b32 a133, v6
    s_add_u32 s17, s49, 737280
    buffer_load_dword v112, v9, s[20:23], s17 offen
    buffer_load_dword v113, v10, s[20:23], s17 offen
    buffer_load_dword v114, v12, s[20:23], s17 offen
    buffer_load_dword v115, v13, s[20:23], s17 offen
    s_waitcnt vmcnt(58)
    v_perm_b32 v5, v57, v56, s44
    v_perm_b32 v6, v57, v56, s45
    s_waitcnt vmcnt(56)
    v_perm_b32 v194, v59, v58, v11
    v_accvgpr_write_b32 a130, v5
    v_accvgpr_write_b32 a134, v6
    s_add_u32 s17, s49, 738432
    buffer_load_dword v116, v9, s[20:23], s17 offen
    buffer_load_dword v117, v10, s[20:23], s17 offen
    buffer_load_dword v118, v12, s[20:23], s17 offen
    buffer_load_dword v119, v13, s[20:23], s17 offen
    s_waitcnt vmcnt(58)
    v_perm_b32 v5, v61, v60, s44
    v_perm_b32 v6, v61, v60, s45
    s_waitcnt vmcnt(56)
    v_perm_b32 v195, v63, v62, v11
    v_accvgpr_write_b32 a131, v5
    v_accvgpr_write_b32 a135, v6
    s_add_u32 s17, s49, 739584
    buffer_load_dword v120, v9, s[20:23], s17 offen
    buffer_load_dword v121, v10, s[20:23], s17 offen
    buffer_load_dword v122, v12, s[20:23], s17 offen
    buffer_load_dword v123, v13, s[20:23], s17 offen
    s_waitcnt vmcnt(58)
    v_perm_b32 v5, v65, v64, s44
    v_perm_b32 v6, v65, v64, s45
    s_waitcnt vmcnt(56)
    v_perm_b32 v196, v67, v66, v11
    v_accvgpr_write_b32 a136, v5
    v_accvgpr_write_b32 a140, v6
    s_add_u32 s17, s49, 740736
    buffer_load_dword v124, v9, s[20:23], s17 offen
    buffer_load_dword v125, v10, s[20:23], s17 offen
    buffer_load_dword v126, v12, s[20:23], s17 offen
    buffer_load_dword v127, v13, s[20:23], s17 offen
    s_waitcnt vmcnt(58)
    v_perm_b32 v5, v69, v68, s44
    v_perm_b32 v6, v69, v68, s45
    s_waitcnt vmcnt(56)
    v_perm_b32 v197, v71, v70, v11
    v_accvgpr_write_b32 a137, v5
    v_accvgpr_write_b32 a141, v6
    s_add_u32 s17, s49, 774144
    buffer_load_dword v16, v9, s[20:23], s17 offen
    buffer_load_dword v17, v10, s[20:23], s17 offen
    buffer_load_dword v18, v12, s[20:23], s17 offen
    buffer_load_dword v19, v13, s[20:23], s17 offen
    s_waitcnt vmcnt(58)
    v_perm_b32 v5, v73, v72, s44
    v_perm_b32 v6, v73, v72, s45
    s_waitcnt vmcnt(56)
    v_perm_b32 v198, v75, v74, v11
    v_accvgpr_write_b32 a138, v5
    v_accvgpr_write_b32 a142, v6
    s_add_u32 s17, s49, 775296
    buffer_load_dword v20, v9, s[20:23], s17 offen
    buffer_load_dword v21, v10, s[20:23], s17 offen
    buffer_load_dword v22, v12, s[20:23], s17 offen
    buffer_load_dword v23, v13, s[20:23], s17 offen
    s_waitcnt vmcnt(58)
    v_perm_b32 v5, v77, v76, s44
    v_perm_b32 v6, v77, v76, s45
    s_waitcnt vmcnt(56)
    v_perm_b32 v199, v79, v78, v11
    v_accvgpr_write_b32 a139, v5
    v_accvgpr_write_b32 a143, v6
    s_add_u32 s17, s49, 776448
    buffer_load_dword v24, v9, s[20:23], s17 offen
    buffer_load_dword v25, v10, s[20:23], s17 offen
    buffer_load_dword v26, v12, s[20:23], s17 offen
    buffer_load_dword v27, v13, s[20:23], s17 offen
    s_waitcnt vmcnt(58)
    v_perm_b32 v5, v81, v80, s44
    v_perm_b32 v6, v81, v80, s45
    s_waitcnt vmcnt(56)
    v_perm_b32 v200, v83, v82, v11
    v_accvgpr_write_b32 a144, v5
    v_accvgpr_write_b32 a148, v6
    s_add_u32 s17, s49, 777600
    buffer_load_dword v28, v9, s[20:23], s17 offen
    buffer_load_dword v29, v10, s[20:23], s17 offen
    buffer_load_dword v30, v12, s[20:23], s17 offen
    buffer_load_dword v31, v13, s[20:23], s17 offen
    s_waitcnt vmcnt(58)
    v_perm_b32 v5, v85, v84, s44
    v_perm_b32 v6, v85, v84, s45
    s_waitcnt vmcnt(56)
    v_perm_b32 v201, v87, v86, v11
    v_accvgpr_write_b32 a145, v5
    v_accvgpr_write_b32 a149, v6
    s_add_u32 s17, s49, 811008
    buffer_load_dword v32, v9, s[20:23], s17 offen
    buffer_load_dword v33, v10, s[20:23], s17 offen
    buffer_load_dword v34, v12, s[20:23], s17 offen
    buffer_load_dword v35, v13, s[20:23], s17 offen
    s_waitcnt vmcnt(58)
    v_perm_b32 v5, v89, v88, s44
    v_perm_b32 v6, v89, v88, s45
    s_waitcnt vmcnt(56)
    v_perm_b32 v202, v91, v90, v11
    v_accvgpr_write_b32 a146, v5
    v_accvgpr_write_b32 a150, v6
    s_add_u32 s17, s49, 812160
    buffer_load_dword v36, v9, s[20:23], s17 offen
    buffer_load_dword v37, v10, s[20:23], s17 offen
    buffer_load_dword v38, v12, s[20:23], s17 offen
    buffer_load_dword v39, v13, s[20:23], s17 offen
    s_waitcnt vmcnt(58)
    v_perm_b32 v5, v93, v92, s44
    v_perm_b32 v6, v93, v92, s45
    s_waitcnt vmcnt(56)
    v_perm_b32 v203, v95, v94, v11
    v_accvgpr_write_b32 a147, v5
    v_accvgpr_write_b32 a151, v6
    s_add_u32 s17, s49, 813312
    buffer_load_dword v40, v9, s[20:23], s17 offen
    buffer_load_dword v41, v10, s[20:23], s17 offen
    buffer_load_dword v42, v12, s[20:23], s17 offen
    buffer_load_dword v43, v13, s[20:23], s17 offen
    s_waitcnt vmcnt(58)
    v_perm_b32 v5, v97, v96, s44
    v_perm_b32 v6, v97, v96, s45
    s_waitcnt vmcnt(56)
    v_perm_b32 v204, v99, v98, v11
    v_accvgpr_write_b32 a152, v5
    v_accvgpr_write_b32 a156, v6
    s_add_u32 s17, s49, 814464
    buffer_load_dword v44, v9, s[20:23], s17 offen
    buffer_load_dword v45, v10, s[20:23], s17 offen
    buffer_load_dword v46, v12, s[20:23], s17 offen
    buffer_load_dword v47, v13, s[20:23], s17 offen
    s_waitcnt vmcnt(58)
    v_perm_b32 v5, v101, v100, s44
    v_perm_b32 v6, v101, v100, s45
    s_waitcnt vmcnt(56)
    v_perm_b32 v205, v103, v102, v11
    v_accvgpr_write_b32 a153, v5
    v_accvgpr_write_b32 a157, v6
    s_add_u32 s17, s49, 847872
    buffer_load_dword v48, v9, s[20:23], s17 offen
    buffer_load_dword v49, v10, s[20:23], s17 offen
    buffer_load_dword v50, v12, s[20:23], s17 offen
    buffer_load_dword v51, v13, s[20:23], s17 offen
    s_waitcnt vmcnt(58)
    v_perm_b32 v5, v105, v104, s44
    v_perm_b32 v6, v105, v104, s45
    s_waitcnt vmcnt(56)
    v_perm_b32 v206, v107, v106, v11
    v_accvgpr_write_b32 a154, v5
    v_accvgpr_write_b32 a158, v6
    s_add_u32 s17, s49, 849024
    buffer_load_dword v52, v9, s[20:23], s17 offen
    buffer_load_dword v53, v10, s[20:23], s17 offen
    buffer_load_dword v54, v12, s[20:23], s17 offen
    buffer_load_dword v55, v13, s[20:23], s17 offen
    s_waitcnt vmcnt(58)
    v_perm_b32 v5, v109, v108, s44
    v_perm_b32 v6, v109, v108, s45
    s_waitcnt vmcnt(56)
    v_perm_b32 v207, v111, v110, v11
    v_accvgpr_write_b32 a155, v5
    v_accvgpr_write_b32 a159, v6
    s_add_u32 s17, s49, 850176
    buffer_load_dword v56, v9, s[20:23], s17 offen
    buffer_load_dword v57, v10, s[20:23], s17 offen
    buffer_load_dword v58, v12, s[20:23], s17 offen
    buffer_load_dword v59, v13, s[20:23], s17 offen
    s_waitcnt vmcnt(58)
    v_perm_b32 v5, v113, v112, s44
    v_perm_b32 v6, v113, v112, s45
    s_waitcnt vmcnt(56)
    v_perm_b32 v208, v115, v114, v11
    v_accvgpr_write_b32 a160, v5
    v_accvgpr_write_b32 a164, v6
    s_add_u32 s17, s49, 851328
    buffer_load_dword v60, v9, s[20:23], s17 offen
    buffer_load_dword v61, v10, s[20:23], s17 offen
    buffer_load_dword v62, v12, s[20:23], s17 offen
    buffer_load_dword v63, v13, s[20:23], s17 offen
    s_waitcnt vmcnt(58)
    v_perm_b32 v5, v117, v116, s44
    v_perm_b32 v6, v117, v116, s45
    s_waitcnt vmcnt(56)
    v_perm_b32 v209, v119, v118, v11
    v_accvgpr_write_b32 a161, v5
    v_accvgpr_write_b32 a165, v6
    s_add_u32 s17, s49, 884736
    buffer_load_dword v64, v9, s[20:23], s17 offen
    buffer_load_dword v65, v10, s[20:23], s17 offen
    buffer_load_dword v66, v12, s[20:23], s17 offen
    buffer_load_dword v67, v13, s[20:23], s17 offen
    s_waitcnt vmcnt(58)
    v_perm_b32 v5, v121, v120, s44
    v_perm_b32 v6, v121, v120, s45
    s_waitcnt vmcnt(56)
    v_perm_b32 v210, v123, v122, v11
    v_accvgpr_write_b32 a162, v5
    v_accvgpr_write_b32 a166, v6
    s_add_u32 s17, s49, 885888
    buffer_load_dword v68, v9, s[20:23], s17 offen
    buffer_load_dword v69, v10, s[20:23], s17 offen
    buffer_load_dword v70, v12, s[20:23], s17 offen
    buffer_load_dword v71, v13, s[20:23], s17 offen
    s_waitcnt vmcnt(58)
    v_perm_b32 v5, v125, v124, s44
    v_perm_b32 v6, v125, v124, s45
    s_waitcnt vmcnt(56)
    v_perm_b32 v211, v127, v126, v11
    v_accvgpr_write_b32 a163, v5
    v_accvgpr_write_b32 a167, v6
    s_add_u32 s17, s49, 887040
    buffer_load_dword v72, v9, s[20:23], s17 offen
    buffer_load_dword v73, v10, s[20:23], s17 offen
    buffer_load_dword v74, v12, s[20:23], s17 offen
    buffer_load_dword v75, v13, s[20:23], s17 offen
    s_waitcnt vmcnt(58)
    v_perm_b32 v5, v17, v16, s44
    v_perm_b32 v6, v17, v16, s45
    s_waitcnt vmcnt(56)
    v_perm_b32 v212, v19, v18, v11
    v_accvgpr_write_b32 a168, v5
    v_accvgpr_write_b32 a172, v6
    s_add_u32 s17, s49, 888192
    buffer_load_dword v76, v9, s[20:23], s17 offen
    buffer_load_dword v77, v10, s[20:23], s17 offen
    buffer_load_dword v78, v12, s[20:23], s17 offen
    buffer_load_dword v79, v13, s[20:23], s17 offen
    s_waitcnt vmcnt(58)
    v_perm_b32 v5, v21, v20, s44
    v_perm_b32 v6, v21, v20, s45
    s_waitcnt vmcnt(56)
    v_perm_b32 v213, v23, v22, v11
    v_accvgpr_write_b32 a169, v5
    v_accvgpr_write_b32 a173, v6
    s_add_u32 s17, s49, 921600
    buffer_load_dword v80, v9, s[20:23], s17 offen
    buffer_load_dword v81, v10, s[20:23], s17 offen
    buffer_load_dword v82, v12, s[20:23], s17 offen
    buffer_load_dword v83, v13, s[20:23], s17 offen
    s_waitcnt vmcnt(58)
    v_perm_b32 v5, v25, v24, s44
    v_perm_b32 v6, v25, v24, s45
    s_waitcnt vmcnt(56)
    v_perm_b32 v214, v27, v26, v11
    v_accvgpr_write_b32 a170, v5
    v_accvgpr_write_b32 a174, v6
    s_add_u32 s17, s49, 922752
    buffer_load_dword v84, v9, s[20:23], s17 offen
    buffer_load_dword v85, v10, s[20:23], s17 offen
    buffer_load_dword v86, v12, s[20:23], s17 offen
    buffer_load_dword v87, v13, s[20:23], s17 offen
    s_waitcnt vmcnt(58)
    v_perm_b32 v5, v29, v28, s44
    v_perm_b32 v6, v29, v28, s45
    s_waitcnt vmcnt(56)
    v_perm_b32 v215, v31, v30, v11
    v_accvgpr_write_b32 a171, v5
    v_accvgpr_write_b32 a175, v6
    s_add_u32 s17, s49, 923904
    buffer_load_dword v88, v9, s[20:23], s17 offen
    buffer_load_dword v89, v10, s[20:23], s17 offen
    buffer_load_dword v90, v12, s[20:23], s17 offen
    buffer_load_dword v91, v13, s[20:23], s17 offen
    s_waitcnt vmcnt(58)
    v_perm_b32 v5, v33, v32, s44
    v_perm_b32 v6, v33, v32, s45
    s_waitcnt vmcnt(56)
    v_perm_b32 v216, v35, v34, v11
    v_accvgpr_write_b32 a176, v5
    v_accvgpr_write_b32 a180, v6
    s_add_u32 s17, s49, 925056
    buffer_load_dword v92, v9, s[20:23], s17 offen
    buffer_load_dword v93, v10, s[20:23], s17 offen
    buffer_load_dword v94, v12, s[20:23], s17 offen
    buffer_load_dword v95, v13, s[20:23], s17 offen
    s_waitcnt vmcnt(58)
    v_perm_b32 v5, v37, v36, s44
    v_perm_b32 v6, v37, v36, s45
    s_waitcnt vmcnt(56)
    v_perm_b32 v217, v39, v38, v11
    v_accvgpr_write_b32 a177, v5
    v_accvgpr_write_b32 a181, v6
    s_add_u32 s17, s49, 958464
    buffer_load_dword v96, v9, s[20:23], s17 offen
    buffer_load_dword v97, v10, s[20:23], s17 offen
    buffer_load_dword v98, v12, s[20:23], s17 offen
    buffer_load_dword v99, v13, s[20:23], s17 offen
    s_waitcnt vmcnt(58)
    v_perm_b32 v5, v41, v40, s44
    v_perm_b32 v6, v41, v40, s45
    s_waitcnt vmcnt(56)
    v_perm_b32 v218, v43, v42, v11
    v_accvgpr_write_b32 a178, v5
    v_accvgpr_write_b32 a182, v6
    s_add_u32 s17, s49, 959616
    buffer_load_dword v100, v9, s[20:23], s17 offen
    buffer_load_dword v101, v10, s[20:23], s17 offen
    buffer_load_dword v102, v12, s[20:23], s17 offen
    buffer_load_dword v103, v13, s[20:23], s17 offen
    s_waitcnt vmcnt(58)
    v_perm_b32 v5, v45, v44, s44
    v_perm_b32 v6, v45, v44, s45
    s_waitcnt vmcnt(56)
    v_perm_b32 v219, v47, v46, v11
    v_accvgpr_write_b32 a179, v5
    v_accvgpr_write_b32 a183, v6
    s_add_u32 s17, s49, 960768
    buffer_load_dword v104, v9, s[20:23], s17 offen
    buffer_load_dword v105, v10, s[20:23], s17 offen
    buffer_load_dword v106, v12, s[20:23], s17 offen
    buffer_load_dword v107, v13, s[20:23], s17 offen
    s_waitcnt vmcnt(58)
    v_perm_b32 v5, v49, v48, s44
    v_perm_b32 v6, v49, v48, s45
    s_waitcnt vmcnt(56)
    v_perm_b32 v220, v51, v50, v11
    v_accvgpr_write_b32 a184, v5
    v_accvgpr_write_b32 a188, v6
    s_add_u32 s17, s49, 961920
    buffer_load_dword v108, v9, s[20:23], s17 offen
    buffer_load_dword v109, v10, s[20:23], s17 offen
    buffer_load_dword v110, v12, s[20:23], s17 offen
    buffer_load_dword v111, v13, s[20:23], s17 offen
    s_waitcnt vmcnt(58)
    v_perm_b32 v5, v53, v52, s44
    v_perm_b32 v6, v53, v52, s45
    s_waitcnt vmcnt(56)
    v_perm_b32 v221, v55, v54, v11
    v_accvgpr_write_b32 a185, v5
    v_accvgpr_write_b32 a189, v6
    s_add_u32 s17, s49, 995328
    buffer_load_dword v112, v9, s[20:23], s17 offen
    buffer_load_dword v113, v10, s[20:23], s17 offen
    buffer_load_dword v114, v12, s[20:23], s17 offen
    buffer_load_dword v115, v13, s[20:23], s17 offen
    s_waitcnt vmcnt(58)
    v_perm_b32 v5, v57, v56, s44
    v_perm_b32 v6, v57, v56, s45
    s_waitcnt vmcnt(56)
    v_perm_b32 v222, v59, v58, v11
    v_accvgpr_write_b32 a186, v5
    v_accvgpr_write_b32 a190, v6
    s_add_u32 s17, s49, 996480
    buffer_load_dword v116, v9, s[20:23], s17 offen
    buffer_load_dword v117, v10, s[20:23], s17 offen
    buffer_load_dword v118, v12, s[20:23], s17 offen
    buffer_load_dword v119, v13, s[20:23], s17 offen
    s_waitcnt vmcnt(58)
    v_perm_b32 v5, v61, v60, s44
    v_perm_b32 v6, v61, v60, s45
    s_waitcnt vmcnt(56)
    v_perm_b32 v223, v63, v62, v11
    v_accvgpr_write_b32 a187, v5
    v_accvgpr_write_b32 a191, v6
    s_add_u32 s17, s49, 997632
    buffer_load_dword v120, v9, s[20:23], s17 offen
    buffer_load_dword v121, v10, s[20:23], s17 offen
    buffer_load_dword v122, v12, s[20:23], s17 offen
    buffer_load_dword v123, v13, s[20:23], s17 offen
    s_waitcnt vmcnt(58)
    v_perm_b32 v5, v65, v64, s44
    v_perm_b32 v6, v65, v64, s45
    s_waitcnt vmcnt(56)
    v_perm_b32 v224, v67, v66, v11
    v_accvgpr_write_b32 a192, v5
    v_accvgpr_write_b32 a196, v6
    s_add_u32 s17, s49, 998784
    buffer_load_dword v124, v9, s[20:23], s17 offen
    buffer_load_dword v125, v10, s[20:23], s17 offen
    buffer_load_dword v126, v12, s[20:23], s17 offen
    buffer_load_dword v127, v13, s[20:23], s17 offen
    s_waitcnt vmcnt(58)
    v_perm_b32 v5, v69, v68, s44
    v_perm_b32 v6, v69, v68, s45
    s_waitcnt vmcnt(56)
    v_perm_b32 v225, v71, v70, v11
    v_accvgpr_write_b32 a193, v5
    v_accvgpr_write_b32 a197, v6
    s_add_u32 s17, s49, 1032192
    buffer_load_dword v16, v9, s[20:23], s17 offen
    buffer_load_dword v17, v10, s[20:23], s17 offen
    buffer_load_dword v18, v12, s[20:23], s17 offen
    buffer_load_dword v19, v13, s[20:23], s17 offen
    s_waitcnt vmcnt(58)
    v_perm_b32 v5, v73, v72, s44
    v_perm_b32 v6, v73, v72, s45
    s_waitcnt vmcnt(56)
    v_perm_b32 v226, v75, v74, v11
    v_accvgpr_write_b32 a194, v5
    v_accvgpr_write_b32 a198, v6
    s_add_u32 s17, s49, 1033344
    buffer_load_dword v20, v9, s[20:23], s17 offen
    buffer_load_dword v21, v10, s[20:23], s17 offen
    buffer_load_dword v22, v12, s[20:23], s17 offen
    buffer_load_dword v23, v13, s[20:23], s17 offen
    s_waitcnt vmcnt(58)
    v_perm_b32 v5, v77, v76, s44
    v_perm_b32 v6, v77, v76, s45
    s_waitcnt vmcnt(56)
    v_perm_b32 v227, v79, v78, v11
    v_accvgpr_write_b32 a195, v5
    v_accvgpr_write_b32 a199, v6
    s_add_u32 s17, s49, 1034496
    buffer_load_dword v24, v9, s[20:23], s17 offen
    buffer_load_dword v25, v10, s[20:23], s17 offen
    buffer_load_dword v26, v12, s[20:23], s17 offen
    buffer_load_dword v27, v13, s[20:23], s17 offen
    s_waitcnt vmcnt(58)
    v_perm_b32 v5, v81, v80, s44
    v_perm_b32 v6, v81, v80, s45
    s_waitcnt vmcnt(56)
    v_perm_b32 v228, v83, v82, v11
    v_accvgpr_write_b32 a200, v5
    v_accvgpr_write_b32 a204, v6
    s_add_u32 s17, s49, 1035648
    buffer_load_dword v28, v9, s[20:23], s17 offen
    buffer_load_dword v29, v10, s[20:23], s17 offen
    buffer_load_dword v30, v12, s[20:23], s17 offen
    buffer_load_dword v31, v13, s[20:23], s17 offen
    s_waitcnt vmcnt(58)
    v_perm_b32 v5, v85, v84, s44
    v_perm_b32 v6, v85, v84, s45
    s_waitcnt vmcnt(56)
    v_perm_b32 v229, v87, v86, v11
    v_accvgpr_write_b32 a201, v5
    v_accvgpr_write_b32 a205, v6
    s_add_u32 s17, s49, 1069056
    buffer_load_dword v32, v9, s[20:23], s17 offen
    buffer_load_dword v33, v10, s[20:23], s17 offen
    buffer_load_dword v34, v12, s[20:23], s17 offen
    buffer_load_dword v35, v13, s[20:23], s17 offen
    s_waitcnt vmcnt(58)
    v_perm_b32 v5, v89, v88, s44
    v_perm_b32 v6, v89, v88, s45
    s_waitcnt vmcnt(56)
    v_perm_b32 v230, v91, v90, v11
    v_accvgpr_write_b32 a202, v5
    v_accvgpr_write_b32 a206, v6
    s_add_u32 s17, s49, 1070208
    buffer_load_dword v36, v9, s[20:23], s17 offen
    buffer_load_dword v37, v10, s[20:23], s17 offen
    buffer_load_dword v38, v12, s[20:23], s17 offen
    buffer_load_dword v39, v13, s[20:23], s17 offen
    s_waitcnt vmcnt(58)
    v_perm_b32 v5, v93, v92, s44
    v_perm_b32 v6, v93, v92, s45
    s_waitcnt vmcnt(56)
    v_perm_b32 v231, v95, v94, v11
    v_accvgpr_write_b32 a203, v5
    v_accvgpr_write_b32 a207, v6
    s_add_u32 s17, s49, 1071360
    buffer_load_dword v40, v9, s[20:23], s17 offen
    buffer_load_dword v41, v10, s[20:23], s17 offen
    buffer_load_dword v42, v12, s[20:23], s17 offen
    buffer_load_dword v43, v13, s[20:23], s17 offen
    s_waitcnt vmcnt(58)
    v_perm_b32 v5, v97, v96, s44
    v_perm_b32 v6, v97, v96, s45
    s_waitcnt vmcnt(56)
    v_perm_b32 v232, v99, v98, v11
    v_accvgpr_write_b32 a208, v5
    v_accvgpr_write_b32 a212, v6
    s_add_u32 s17, s49, 1072512
    buffer_load_dword v44, v9, s[20:23], s17 offen
    buffer_load_dword v45, v10, s[20:23], s17 offen
    buffer_load_dword v46, v12, s[20:23], s17 offen
    buffer_load_dword v47, v13, s[20:23], s17 offen
    s_waitcnt vmcnt(58)
    v_perm_b32 v5, v101, v100, s44
    v_perm_b32 v6, v101, v100, s45
    s_waitcnt vmcnt(56)
    v_perm_b32 v233, v103, v102, v11
    v_accvgpr_write_b32 a209, v5
    v_accvgpr_write_b32 a213, v6
    s_add_u32 s17, s49, 1105920
    buffer_load_dword v48, v9, s[20:23], s17 offen
    buffer_load_dword v49, v10, s[20:23], s17 offen
    buffer_load_dword v50, v12, s[20:23], s17 offen
    buffer_load_dword v51, v13, s[20:23], s17 offen
    s_waitcnt vmcnt(58)
    v_perm_b32 v5, v105, v104, s44
    v_perm_b32 v6, v105, v104, s45
    s_waitcnt vmcnt(56)
    v_perm_b32 v234, v107, v106, v11
    v_accvgpr_write_b32 a210, v5
    v_accvgpr_write_b32 a214, v6
    s_add_u32 s17, s49, 1107072
    buffer_load_dword v52, v9, s[20:23], s17 offen
    buffer_load_dword v53, v10, s[20:23], s17 offen
    buffer_load_dword v54, v12, s[20:23], s17 offen
    buffer_load_dword v55, v13, s[20:23], s17 offen
    s_waitcnt vmcnt(58)
    v_perm_b32 v5, v109, v108, s44
    v_perm_b32 v6, v109, v108, s45
    s_waitcnt vmcnt(56)
    v_perm_b32 v235, v111, v110, v11
    v_accvgpr_write_b32 a211, v5
    v_accvgpr_write_b32 a215, v6
    s_add_u32 s17, s49, 1108224
    buffer_load_dword v56, v9, s[20:23], s17 offen
    buffer_load_dword v57, v10, s[20:23], s17 offen
    buffer_load_dword v58, v12, s[20:23], s17 offen
    buffer_load_dword v59, v13, s[20:23], s17 offen
    s_waitcnt vmcnt(58)
    v_perm_b32 v5, v113, v112, s44
    v_perm_b32 v6, v113, v112, s45
    s_waitcnt vmcnt(56)
    v_perm_b32 v236, v115, v114, v11
    v_accvgpr_write_b32 a216, v5
    v_accvgpr_write_b32 a220, v6
    s_add_u32 s17, s49, 1109376
    buffer_load_dword v60, v9, s[20:23], s17 offen
    buffer_load_dword v61, v10, s[20:23], s17 offen
    buffer_load_dword v62, v12, s[20:23], s17 offen
    buffer_load_dword v63, v13, s[20:23], s17 offen
    s_waitcnt vmcnt(58)
    v_perm_b32 v5, v117, v116, s44
    v_perm_b32 v6, v117, v116, s45
    s_waitcnt vmcnt(56)
    v_perm_b32 v237, v119, v118, v11
    v_accvgpr_write_b32 a217, v5
    v_accvgpr_write_b32 a221, v6
    s_add_u32 s17, s49, 1142784
    buffer_load_dword v64, v9, s[20:23], s17 offen
    buffer_load_dword v65, v10, s[20:23], s17 offen
    buffer_load_dword v66, v12, s[20:23], s17 offen
    buffer_load_dword v67, v13, s[20:23], s17 offen
    s_waitcnt vmcnt(58)
    v_perm_b32 v5, v121, v120, s44
    v_perm_b32 v6, v121, v120, s45
    s_waitcnt vmcnt(56)
    v_perm_b32 v238, v123, v122, v11
    v_accvgpr_write_b32 a218, v5
    v_accvgpr_write_b32 a222, v6
    s_add_u32 s17, s49, 1143936
    buffer_load_dword v68, v9, s[20:23], s17 offen
    buffer_load_dword v69, v10, s[20:23], s17 offen
    buffer_load_dword v70, v12, s[20:23], s17 offen
    buffer_load_dword v71, v13, s[20:23], s17 offen
    s_waitcnt vmcnt(58)
    v_perm_b32 v5, v125, v124, s44
    v_perm_b32 v6, v125, v124, s45
    s_waitcnt vmcnt(56)
    v_perm_b32 v239, v127, v126, v11
    v_accvgpr_write_b32 a219, v5
    v_accvgpr_write_b32 a223, v6
    s_add_u32 s17, s49, 1145088
    buffer_load_dword v72, v9, s[20:23], s17 offen
    buffer_load_dword v73, v10, s[20:23], s17 offen
    buffer_load_dword v74, v12, s[20:23], s17 offen
    buffer_load_dword v75, v13, s[20:23], s17 offen
    s_waitcnt vmcnt(58)
    v_perm_b32 v5, v17, v16, s44
    v_perm_b32 v6, v17, v16, s45
    s_waitcnt vmcnt(56)
    v_perm_b32 v240, v19, v18, v11
    v_accvgpr_write_b32 a224, v5
    v_accvgpr_write_b32 a228, v6
    s_add_u32 s17, s49, 1146240
    buffer_load_dword v76, v9, s[20:23], s17 offen
    buffer_load_dword v77, v10, s[20:23], s17 offen
    buffer_load_dword v78, v12, s[20:23], s17 offen
    buffer_load_dword v79, v13, s[20:23], s17 offen
    s_waitcnt vmcnt(58)
    v_perm_b32 v5, v21, v20, s44
    v_perm_b32 v6, v21, v20, s45
    s_waitcnt vmcnt(56)
    v_perm_b32 v241, v23, v22, v11
    v_accvgpr_write_b32 a225, v5
    v_accvgpr_write_b32 a229, v6
    s_waitcnt vmcnt(54)
    v_perm_b32 v5, v25, v24, s44
    v_perm_b32 v6, v25, v24, s45
    s_waitcnt vmcnt(52)
    v_perm_b32 v242, v27, v26, v11
    v_accvgpr_write_b32 a226, v5
    v_accvgpr_write_b32 a230, v6
    s_waitcnt vmcnt(50)
    v_perm_b32 v5, v29, v28, s44
    v_perm_b32 v6, v29, v28, s45
    s_waitcnt vmcnt(48)
    v_perm_b32 v243, v31, v30, v11
    v_accvgpr_write_b32 a227, v5
    v_accvgpr_write_b32 a231, v6
    s_waitcnt vmcnt(46)
    v_perm_b32 v5, v33, v32, s44
    v_perm_b32 v6, v33, v32, s45
    s_waitcnt vmcnt(44)
    v_perm_b32 v244, v35, v34, v11
    v_accvgpr_write_b32 a232, v5
    v_accvgpr_write_b32 a236, v6
    s_waitcnt vmcnt(42)
    v_perm_b32 v5, v37, v36, s44
    v_perm_b32 v6, v37, v36, s45
    s_waitcnt vmcnt(40)
    v_perm_b32 v245, v39, v38, v11
    v_accvgpr_write_b32 a233, v5
    v_accvgpr_write_b32 a237, v6
    s_waitcnt vmcnt(38)
    v_perm_b32 v5, v41, v40, s44
    v_perm_b32 v6, v41, v40, s45
    s_waitcnt vmcnt(36)
    v_perm_b32 v246, v43, v42, v11
    v_accvgpr_write_b32 a234, v5
    v_accvgpr_write_b32 a238, v6
    s_waitcnt vmcnt(34)
    v_perm_b32 v5, v45, v44, s44
    v_perm_b32 v6, v45, v44, s45
    s_waitcnt vmcnt(32)
    v_perm_b32 v247, v47, v46, v11
    v_accvgpr_write_b32 a235, v5
    v_accvgpr_write_b32 a239, v6
    s_waitcnt vmcnt(30)
    v_perm_b32 v5, v49, v48, s44
    v_perm_b32 v6, v49, v48, s45
    s_waitcnt vmcnt(28)
    v_perm_b32 v248, v51, v50, v11
    v_accvgpr_write_b32 a240, v5
    v_accvgpr_write_b32 a244, v6
    s_waitcnt vmcnt(26)
    v_perm_b32 v5, v53, v52, s44
    v_perm_b32 v6, v53, v52, s45
    s_waitcnt vmcnt(24)
    v_perm_b32 v249, v55, v54, v11
    v_accvgpr_write_b32 a241, v5
    v_accvgpr_write_b32 a245, v6
    s_waitcnt vmcnt(22)
    v_perm_b32 v5, v57, v56, s44
    v_perm_b32 v6, v57, v56, s45
    s_waitcnt vmcnt(20)
    v_perm_b32 v250, v59, v58, v11
    v_accvgpr_write_b32 a242, v5
    v_accvgpr_write_b32 a246, v6
    s_waitcnt vmcnt(18)
    v_perm_b32 v5, v61, v60, s44
    v_perm_b32 v6, v61, v60, s45
    s_waitcnt vmcnt(16)
    v_perm_b32 v251, v63, v62, v11
    v_accvgpr_write_b32 a243, v5
    v_accvgpr_write_b32 a247, v6
    s_waitcnt vmcnt(14)
    v_perm_b32 v5, v65, v64, s44
    v_perm_b32 v6, v65, v64, s45
    s_waitcnt vmcnt(12)
    v_perm_b32 v252, v67, v66, v11
    v_accvgpr_write_b32 a248, v5
    v_accvgpr_write_b32 a252, v6
    s_waitcnt vmcnt(10)
    v_perm_b32 v5, v69, v68, s44
    v_perm_b32 v6, v69, v68, s45
    s_waitcnt vmcnt(8)
    v_perm_b32 v253, v71, v70, v11
    v_accvgpr_write_b32 a249, v5
    v_accvgpr_write_b32 a253, v6
    s_waitcnt vmcnt(6)
    v_perm_b32 v5, v73, v72, s44
    v_perm_b32 v6, v73, v72, s45
    s_waitcnt vmcnt(4)
    v_perm_b32 v254, v75, v74, v11
    v_accvgpr_write_b32 a250, v5
    v_accvgpr_write_b32 a254, v6
    s_waitcnt vmcnt(2)
    v_perm_b32 v5, v77, v76, s44
    v_perm_b32 v6, v77, v76, s45
    s_waitcnt vmcnt(0)
    v_perm_b32 v255, v79, v78, v11
    v_accvgpr_write_b32 a251, v5
    v_accvgpr_write_b32 a255, v6
    s_and_b32 s51, s14, 1
    s_lshl_b32 s17, s51, 4
    v_add_u32 v5, s17, v7
    v_lshlrev_b32 v14, 4, v5
    v_mul_u32_u24 v13, 1152, v5
    s_mul_i32 s17, s50, 96
    v_add_u32 v13, s17, v13
    s_mul_i32 s17, s50, 3072
    v_add_u32 v12, s17, v14
    s_lshl_b32 s17, s50, 9
    v_add_u32 v14, s17, v14
    s_lshl_b32 s49, s50, 7
    s_lshl_b32 s17, s14, 2
    s_add_u32 s49, s49, s17
    s_add_u32 s49, s49, 1441792
    s_mul_i32 s17, s14, 6144
    v_add_u32 v48, s17, v0
    v_mov_b32 v49, 0x10000
    s_mul_i32 s17, s50, 43
    v_lshrrev_b32 v10, 4, v0
    v_add_u32 v10, s17, v10
    v_min_u32 v10, 511, v10
    v_lshlrev_b32 v10, 7, v10
    s_cmp_gt_u32 s14, 1
    s_cbranch_scc1 Ltw_z
    v_lshl_add_u32 v12, v8, 9, v12
    v_lshl_add_u32 v13, v8, 4, v13
    s_lshl_b32 s58, s14, 16
    s_add_u32 s58, s58, 144703488
    s_mov_b32 s43, 0
    s_mov_b32 s28, s8
    s_mov_b32 s29, s9
    s_mov_b32 s30, 0
    s_mov_b32 s31, 0x00020000
    s_mul_i32 s17, s51, 3072
    v_add_u32 v50, s17, v0
    ds_write2_b32 v49, v4, v4 offset0:0 offset1:1
    s_waitcnt lgkmcnt(0)
    s_cmp_lg_u32 s14, 0
    s_cbranch_scc1 LtwX_inia_d
    v_mov_b32 v5, 40
    s_mov_b32 s16, 0
LtwX_inia:
    global_load_dword v6, v5, s[12:13] sc1
    s_add_u32 s16, s16, 1
    s_cmp_gt_u32 s16, 100000
    s_cbranch_scc1 L_role_tw_abort
    s_waitcnt vmcnt(0)
    v_cmp_gt_u32 vcc, 128, v6
    s_nop 0
    s_cbranch_vccz LtwX_inia_d
    s_sleep 8
    s_branch LtwX_inia
LtwX_inia_d:
    s_barrier
    s_cmp_lg_u32 s14, 0
    s_cbranch_scc1 LtwX_inib_d
    v_mov_b32 v5, 160
    s_mov_b32 s16, 0
LtwX_inib:
    global_load_dword v6, v5, s[12:13] sc1
    s_add_u32 s16, s16, 1
    s_cmp_gt_u32 s16, 100000
    s_cbranch_scc1 L_role_tw_abort
    s_waitcnt vmcnt(0)
    v_cmp_gt_u32 vcc, 64, v6
    s_nop 0
    s_cbranch_vccz LtwX_inib_d
    s_sleep 8
    s_branch LtwX_inib
LtwX_inib_d:
    s_barrier
LtwX_idle:
    s_cmp_lg_u32 s14, 0
    s_cbranch_scc1 LtwX_nw0
    s_mul_i32 s60, s32, 22528
    s_add_u32 s60, s60, 4224
    s_cmp_lt_u32 s32, 64
    s_cselect_b32 s60, s60, 2883584
    s_mul_i32 s61, s33, 22528
    s_add_u32 s61, s61, 1446016
    s_cmp_lt_u32 s33, 64
    s_cselect_b32 s61, s61, 2883584
    s_mov_b32 s16, 0
LtwX_p_9:
    buffer_load_dword v2, v1, s[8:11], s60 offen sc1
    buffer_load_dword v15, v1, s[8:11], s61 offen sc1
    s_add_u32 s16, s16, 1
    s_cmp_gt_u32 s16, 100000
    s_cbranch_scc1 L_role_tw_abort
    s_waitcnt vmcnt(1)
    v_cmp_eq_u32 vcc, 0, v2
    s_waitcnt vmcnt(0)
    v_cmp_eq_u32 s[54:55], 0, v15
    s_nop 0
    s_cmp_eq_u64 s[54:55], 0
    s_cselect_b32 s62, 2, 0
    s_cmp_eq_u64 vcc, 0
    s_cselect_b32 s62, 1, s62
    s_cmp_lg_u32 s62, 0
    s_cbranch_scc1 LtwX_p_9d
    s_sleep 4
    s_branch LtwX_p_9
LtwX_p_9d:
    v_mov_b32 v5, s62
    ds_write_b32 v49, v5
    s_waitcnt lgkmcnt(0)
LtwX_nw0:
    s_barrier
    ds_read_b32 v6, v49
    v_xor_b32 v49, 4, v49
    s_waitcnt lgkmcnt(0)
    v_readfirstlane_b32 s62, v6
    s_nop 0
    s_cmp_eq_u32 s62, 0
    s_cbranch_scc1 L_role_tw_abort
    s_cmp_lt_u32 s33, 29
    s_cselect_b32 s38, 1, 3
    s_cmp_eq_u32 s62, 2
    s_cselect_b32 s36, 1, 0
    s_cselect_b32 s37, s33, s32
    s_cselect_b32 s17, s38, 0
    s_add_u32 s33, s33, s17
    s_cmp_eq_u32 s62, 1
    s_cselect_b32 s17, 2, 0
    s_add_u32 s32, s32, s17
    s_lshl_b32 s56, s36, 6
    s_add_u32 s56, s56, s37
    s_lshl_b32 s46, s56, 18
    s_add_u32 s46, s46, s58
    s_mul_i32 s41, s36, 4718592
    s_mul_i32 s17, s37, 36864
    s_add_u32 s41, s41, s17
    s_add_u32 s41, s41, 8650752
    s_cmp_ge_u32 s37, 64
    s_cbranch_scc1 L_role_tw_abort
    buffer_load_dword v9, v10, s[8:11], s46 offen
    s_add_u32 s48, s46, 0
    buffer_load_dwordx4 v[64:67], v0, s[8:11], s48 offen offset:0
    buffer_load_dwordx4 v[68:71], v0, s[8:11], s48 offen offset:1024
    buffer_load_dwordx4 v[72:75], v0, s[8:11], s48 offen offset:2048
    buffer_load_dwordx4 v[76:79], v0, s[8:11], s48 offen offset:3072
    s_add_u32 s48, s46, 4096
    buffer_load_dwordx4 v[80:83], v0, s[8:11], s48 offen offset:0
    buffer_load_dwordx4 v[84:87], v0, s[8:11], s48 offen offset:1024
    buffer_load_dwordx4 v[88:91], v0, s[8:11], s48 offen offset:2048
    buffer_load_dwordx4 v[92:95], v0, s[8:11], s48 offen offset:3072
    s_add_u32 s48, s46, 8192
    buffer_load_dwordx4 v[96:99], v0, s[8:11], s48 offen offset:0
    buffer_load_dwordx4 v[100:103], v0, s[8:11], s48 offen offset:1024
    buffer_load_dwordx4 v[104:107], v0, s[8:11], s48 offen offset:2048
    buffer_load_dwordx4 v[108:111], v0, s[8:11], s48 offen offset:3072
    s_add_u32 s48, s46, 12288
    buffer_load_dwordx4 v[112:115], v0, s[8:11], s48 offen offset:0
    buffer_load_dwordx4 v[116:119], v0, s[8:11], s48 offen offset:1024
    buffer_load_dwordx4 v[120:123], v0, s[8:11], s48 offen offset:2048
    buffer_load_dwordx4 v[40:43], v12, s[8:11], s41 offen
LtwX_item:
    s_mov_b32 s34, s36
    s_mov_b32 s35, s37
    s_mov_b32 s47, s41
    buffer_load_dwordx4 v[124:127], v0, s[8:11], s48 offen offset:3072
    s_waitcnt vmcnt(15)
    v_mfma_f32_16x16x32_bf16 v[16:19], a[0:3], v[64:67], 0
    v_mfma_f32_16x16x32_bf16 v[20:23], a[4:7], v[64:67], 0
    v_mfma_f32_16x16x32_bf16 v[24:27], v[128:131], v[64:67], 0
    s_add_u32 s48, s46, 16384
    buffer_load_dwordx4 v[64:67], v0, s[8:11], s48 offen offset:0
    s_waitcnt vmcnt(15)
    v_mfma_f32_16x16x32_bf16 v[28:31], a[0:3], v[68:71], 0
    v_mfma_f32_16x16x32_bf16 v[32:35], a[4:7], v[68:71], 0
    v_mfma_f32_16x16x32_bf16 v[36:39], v[128:131], v[68:71], 0
    buffer_load_dwordx4 v[68:71], v0, s[8:11], s48 offen offset:1024
    s_waitcnt vmcnt(15)
    v_mfma_f32_16x16x32_bf16 v[16:19], a[8:11], v[72:75], v[16:19]
    v_mfma_f32_16x16x32_bf16 v[20:23], a[12:15], v[72:75], v[20:23]
    v_mfma_f32_16x16x32_bf16 v[24:27], v[132:135], v[72:75], v[24:27]
    buffer_load_dwordx4 v[72:75], v0, s[8:11], s48 offen offset:2048
    s_waitcnt vmcnt(15)
    v_mfma_f32_16x16x32_bf16 v[28:31], a[8:11], v[76:79], v[28:31]
    v_mfma_f32_16x16x32_bf16 v[32:35], a[12:15], v[76:79], v[32:35]
    v_mfma_f32_16x16x32_bf16 v[36:39], v[132:135], v[76:79], v[36:39]
    buffer_load_dwordx4 v[76:79], v0, s[8:11], s48 offen offset:3072
    s_waitcnt vmcnt(15)
    v_mfma_f32_16x16x32_bf16 v[16:19], a[16:19], v[80:83], v[16:19]
    v_mfma_f32_16x16x32_bf16 v[20:23], a[20:23], v[80:83], v[20:23]
    v_mfma_f32_16x16x32_bf16 v[24:27], v[136:139], v[80:83], v[24:27]
    s_add_u32 s48, s46, 20480
    buffer_load_dwordx4 v[80:83], v0, s[8:11], s48 offen offset:0
    s_waitcnt vmcnt(15)
    v_mfma_f32_16x16x32_bf16 v[28:31], a[16:19], v[84:87], v[28:31]
    v_mfma_f32_16x16x32_bf16 v[32:35], a[20:23], v[84:87], v[32:35]
    v_mfma_f32_16x16x32_bf16 v[36:39], v[136:139], v[84:87], v[36:39]
    buffer_load_dwordx4 v[84:87], v0, s[8:11], s48 offen offset:1024
    s_waitcnt vmcnt(15)
    v_mfma_f32_16x16x32_bf16 v[16:19], a[24:27], v[88:91], v[16:19]
    v_mfma_f32_16x16x32_bf16 v[20:23], a[28:31], v[88:91], v[20:23]
    v_mfma_f32_16x16x32_bf16 v[24:27], v[140:143], v[88:91], v[24:27]
    buffer_load_dwordx4 v[88:91], v0, s[8:11], s48 offen offset:2048
    s_waitcnt vmcnt(15)
    v_mfma_f32_16x16x32_bf16 v[28:31], a[24:27], v[92:95], v[28:31]
    v_mfma_f32_16x16x32_bf16 v[32:35], a[28:31], v[92:95], v[32:35]
    v_mfma_f32_16x16x32_bf16 v[36:39], v[140:143], v[92:95], v[36:39]
    buffer_load_dwordx4 v[92:95], v0, s[8:11], s48 offen offset:3072
    s_waitcnt vmcnt(15)
    v_mfma_f32_16x16x32_bf16 v[16:19], a[32:35], v[96:99], v[16:19]
    v_mfma_f32_16x16x32_bf16 v[20:23], a[36:39], v[96:99], v[20:23]
    v_mfma_f32_16x16x32_bf16 v[24:27], v[144:147], v[96:99], v[24:27]
    s_add_u32 s48, s46, 24576
    buffer_load_dwordx4 v[96:99], v0, s[8:11], s48 offen offset:0
    s_waitcnt vmcnt(15)
    v_mfma_f32_16x16x32_bf16 v[28:31], a[32:35], v[100:103], v[28:31]
    v_mfma_f32_16x16x32_bf16 v[32:35], a[36:39], v[100:103], v[32:35]
    v_mfma_f32_16x16x32_bf16 v[36:39], v[144:147], v[100:103], v[36:39]
    buffer_load_dwordx4 v[100:103], v0, s[8:11], s48 offen offset:1024
    s_waitcnt vmcnt(15)
    v_mfma_f32_16x16x32_bf16 v[16:19], a[40:43], v[104:107], v[16:19]
    v_mfma_f32_16x16x32_bf16 v[20:23], a[44:47], v[104:107], v[20:23]
    v_mfma_f32_16x16x32_bf16 v[24:27], v[148:151], v[104:107], v[24:27]
    buffer_load_dwordx4 v[104:107], v0, s[8:11], s48 offen offset:2048
    s_waitcnt vmcnt(15)
    v_mfma_f32_16x16x32_bf16 v[28:31], a[40:43], v[108:111], v[28:31]
    v_mfma_f32_16x16x32_bf16 v[32:35], a[44:47], v[108:111], v[32:35]
    v_mfma_f32_16x16x32_bf16 v[36:39], v[148:151], v[108:111], v[36:39]
    buffer_load_dwordx4 v[108:111], v0, s[8:11], s48 offen offset:3072
    s_waitcnt vmcnt(15)
    v_mfma_f32_16x16x32_bf16 v[16:19], a[48:51], v[112:115], v[16:19]
    v_mfma_f32_16x16x32_bf16 v[20:23], a[52:55], v[112:115], v[20:23]
    v_mfma_f32_16x16x32_bf16 v[24:27], v[152:155], v[112:115], v[24:27]
    s_add_u32 s48, s46, 28672
    buffer_load_dwordx4 v[112:115], v0, s[8:11], s48 offen offset:0
    s_waitcnt vmcnt(15)
    v_mfma_f32_16x16x32_bf16 v[28:31], a[48:51], v[116:119], v[28:31]
    v_mfma_f32_16x16x32_bf16 v[32:35], a[52:55], v[116:119], v[32:35]
    v_mfma_f32_16x16x32_bf16 v[36:39], v[152:155], v[116:119], v[36:39]
    buffer_load_dwordx4 v[116:119], v0, s[8:11], s48 offen offset:1024
    s_waitcnt vmcnt(15)
    v_mfma_f32_16x16x32_bf16 v[16:19], a[56:59], v[120:123], v[16:19]
    v_mfma_f32_16x16x32_bf16 v[20:23], a[60:63], v[120:123], v[20:23]
    v_mfma_f32_16x16x32_bf16 v[24:27], v[156:159], v[120:123], v[24:27]
    buffer_load_dwordx4 v[120:123], v0, s[8:11], s48 offen offset:2048
    s_waitcnt vmcnt(15)
    v_mfma_f32_16x16x32_bf16 v[28:31], a[56:59], v[124:127], v[28:31]
    v_mfma_f32_16x16x32_bf16 v[32:35], a[60:63], v[124:127], v[32:35]
    v_mfma_f32_16x16x32_bf16 v[36:39], v[156:159], v[124:127], v[36:39]
    buffer_load_dwordx4 v[124:127], v0, s[8:11], s48 offen offset:3072
    s_waitcnt vmcnt(15)
    v_mfma_f32_16x16x32_bf16 v[16:19], a[64:67], v[64:67], v[16:19]
    v_mfma_f32_16x16x32_bf16 v[20:23], a[68:71], v[64:67], v[20:23]
    v_mfma_f32_16x16x32_bf16 v[24:27], v[160:163], v[64:67], v[24:27]
    s_add_u32 s48, s46, 32768
    buffer_load_dwordx4 v[64:67], v0, s[8:11], s48 offen offset:0
    s_waitcnt vmcnt(15)
    v_mfma_f32_16x16x32_bf16 v[28:31], a[64:67], v[68:71], v[28:31]
    v_mfma_f32_16x16x32_bf16 v[32:35], a[68:71], v[68:71], v[32:35]
    v_mfma_f32_16x16x32_bf16 v[36:39], v[160:163], v[68:71], v[36:39]
    s_cmp_lg_u32 s43, 0
    s_cselect_b64 exec, 1, 0
    buffer_store_dword v3, v4, s[8:11], s43 offen sc1
    s_mov_b64 exec, -1
    s_mov_b32 s43, 0
    buffer_load_dwordx4 v[68:71], v0, s[8:11], s48 offen offset:1024
    s_waitcnt vmcnt(16)
    v_mfma_f32_16x16x32_bf16 v[16:19], a[72:75], v[72:75], v[16:19]
    v_mfma_f32_16x16x32_bf16 v[20:23], a[76:79], v[72:75], v[20:23]
    v_mfma_f32_16x16x32_bf16 v[24:27], v[164:167], v[72:75], v[24:27]
    buffer_load_dwordx4 v[72:75], v0, s[8:11], s48 offen offset:2048
    s_waitcnt vmcnt(16)
    v_mfma_f32_16x16x32_bf16 v[28:31], a[72:75], v[76:79], v[28:31]
    v_mfma_f32_16x16x32_bf16 v[32:35], a[76:79], v[76:79], v[32:35]
    v_mfma_f32_16x16x32_bf16 v[36:39], v[164:167], v[76:79], v[36:39]
    buffer_load_dwordx4 v[76:79], v0, s[8:11], s48 offen offset:3072
    s_waitcnt vmcnt(16)
    v_mfma_f32_16x16x32_bf16 v[16:19], a[80:83], v[80:83], v[16:19]
    v_mfma_f32_16x16x32_bf16 v[20:23], a[84:87], v[80:83], v[20:23]
    v_mfma_f32_16x16x32_bf16 v[24:27], v[168:171], v[80:83], v[24:27]
    s_add_u32 s48, s46, 36864
    buffer_load_dwordx4 v[80:83], v0, s[8:11], s48 offen offset:0
    s_waitcnt vmcnt(16)
    v_mfma_f32_16x16x32_bf16 v[28:31], a[80:83], v[84:87], v[28:31]
    v_mfma_f32_16x16x32_bf16 v[32:35], a[84:87], v[84:87], v[32:35]
    v_mfma_f32_16x16x32_bf16 v[36:39], v[168:171], v[84:87], v[36:39]
    buffer_load_dwordx4 v[84:87], v0, s[8:11], s48 offen offset:1024
    s_waitcnt vmcnt(16)
    v_mfma_f32_16x16x32_bf16 v[16:19], a[88:91], v[88:91], v[16:19]
    v_mfma_f32_16x16x32_bf16 v[20:23], a[92:95], v[88:91], v[20:23]
    v_mfma_f32_16x16x32_bf16 v[24:27], v[172:175], v[88:91], v[24:27]
    buffer_load_dwordx4 v[88:91], v0, s[8:11], s48 offen offset:2048
    s_waitcnt vmcnt(16)
    v_mfma_f32_16x16x32_bf16 v[28:31], a[88:91], v[92:95], v[28:31]
    v_mfma_f32_16x16x32_bf16 v[32:35], a[92:95], v[92:95], v[32:35]
    v_mfma_f32_16x16x32_bf16 v[36:39], v[172:175], v[92:95], v[36:39]
    buffer_load_dwordx4 v[92:95], v0, s[8:11], s48 offen offset:3072
    s_waitcnt vmcnt(16)
    v_mfma_f32_16x16x32_bf16 v[16:19], a[96:99], v[96:99], v[16:19]
    v_mfma_f32_16x16x32_bf16 v[20:23], a[100:103], v[96:99], v[20:23]
    v_mfma_f32_16x16x32_bf16 v[24:27], v[176:179], v[96:99], v[24:27]
    s_add_u32 s48, s46, 40960
    buffer_load_dwordx4 v[96:99], v0, s[8:11], s48 offen offset:0
    s_waitcnt vmcnt(16)
    v_mfma_f32_16x16x32_bf16 v[28:31], a[96:99], v[100:103], v[28:31]
    v_mfma_f32_16x16x32_bf16 v[32:35], a[100:103], v[100:103], v[32:35]
    v_mfma_f32_16x16x32_bf16 v[36:39], v[176:179], v[100:103], v[36:39]
    buffer_load_dwordx4 v[100:103], v0, s[8:11], s48 offen offset:1024
    s_waitcnt vmcnt(16)
    v_mfma_f32_16x16x32_bf16 v[16:19], a[104:107], v[104:107], v[16:19]
    v_mfma_f32_16x16x32_bf16 v[20:23], a[108:111], v[104:107], v[20:23]
    v_mfma_f32_16x16x32_bf16 v[24:27], v[180:183], v[104:107], v[24:27]
    s_cmp_lg_u32 s14, 0
    s_cbranch_scc1 LtwX_nw1
    s_mul_i32 s60, s32, 22528
    s_add_u32 s60, s60, 4224
    s_cmp_lt_u32 s32, 64
    s_cselect_b32 s60, s60, 2883584
    s_mul_i32 s61, s33, 22528
    s_add_u32 s61, s61, 1446016
    s_cmp_lt_u32 s33, 64
    s_cselect_b32 s61, s61, 2883584
    buffer_load_dword v2, v1, s[8:11], s60 offen sc1
    buffer_load_dword v15, v1, s[8:11], s61 offen sc1
LtwX_nw1:
    buffer_load_dwordx4 v[104:107], v0, s[8:11], s48 offen offset:2048
    s_waitcnt vmcnt(16)
    v_mfma_f32_16x16x32_bf16 v[28:31], a[104:107], v[108:111], v[28:31]
    v_mfma_f32_16x16x32_bf16 v[32:35], a[108:111], v[108:111], v[32:35]
    v_mfma_f32_16x16x32_bf16 v[36:39], v[180:183], v[108:111], v[36:39]
    buffer_load_dwordx4 v[108:111], v0, s[8:11], s48 offen offset:3072
    s_waitcnt vmcnt(16)
    v_mfma_f32_16x16x32_bf16 v[16:19], a[112:115], v[112:115], v[16:19]
    v_mfma_f32_16x16x32_bf16 v[20:23], a[116:119], v[112:115], v[20:23]
    v_mfma_f32_16x16x32_bf16 v[24:27], v[184:187], v[112:115], v[24:27]
    s_add_u32 s48, s46, 45056
    buffer_load_dwordx4 v[112:115], v0, s[8:11], s48 offen offset:0
    s_waitcnt vmcnt(16)
    v_mfma_f32_16x16x32_bf16 v[28:31], a[112:115], v[116:119], v[28:31]
    v_mfma_f32_16x16x32_bf16 v[32:35], a[116:119], v[116:119], v[32:35]
    v_mfma_f32_16x16x32_bf16 v[36:39], v[184:187], v[116:119], v[36:39]
    buffer_load_dwordx4 v[116:119], v0, s[8:11], s48 offen offset:1024
    s_waitcnt vmcnt(16)
    v_mfma_f32_16x16x32_bf16 v[16:19], a[120:123], v[120:123], v[16:19]
    v_mfma_f32_16x16x32_bf16 v[20:23], a[124:127], v[120:123], v[20:23]
    v_mfma_f32_16x16x32_bf16 v[24:27], v[188:191], v[120:123], v[24:27]
    buffer_load_dwordx4 v[120:123], v0, s[8:11], s48 offen offset:2048
    s_waitcnt vmcnt(16)
    v_mfma_f32_16x16x32_bf16 v[28:31], a[120:123], v[124:127], v[28:31]
    v_mfma_f32_16x16x32_bf16 v[32:35], a[124:127], v[124:127], v[32:35]
    v_mfma_f32_16x16x32_bf16 v[36:39], v[188:191], v[124:127], v[36:39]
    buffer_load_dwordx4 v[124:127], v0, s[8:11], s48 offen offset:3072
    s_waitcnt vmcnt(16)
    v_mfma_f32_16x16x32_bf16 v[16:19], a[128:131], v[64:67], v[16:19]
    v_mfma_f32_16x16x32_bf16 v[20:23], a[132:135], v[64:67], v[20:23]
    v_mfma_f32_16x16x32_bf16 v[24:27], v[192:195], v[64:67], v[24:27]
    s_add_u32 s48, s46, 49152
    buffer_load_dwordx4 v[64:67], v0, s[8:11], s48 offen offset:0
    s_waitcnt vmcnt(15)
    v_mfma_f32_16x16x32_bf16 v[28:31], a[128:131], v[68:71], v[28:31]
    v_mfma_f32_16x16x32_bf16 v[32:35], a[132:135], v[68:71], v[32:35]
    v_mfma_f32_16x16x32_bf16 v[36:39], v[192:195], v[68:71], v[36:39]
    buffer_load_dwordx4 v[68:71], v0, s[8:11], s48 offen offset:1024
    s_waitcnt vmcnt(15)
    v_mfma_f32_16x16x32_bf16 v[16:19], a[136:139], v[72:75], v[16:19]
    v_mfma_f32_16x16x32_bf16 v[20:23], a[140:143], v[72:75], v[20:23]
    v_mfma_f32_16x16x32_bf16 v[24:27], v[196:199], v[72:75], v[24:27]
    buffer_load_dwordx4 v[72:75], v0, s[8:11], s48 offen offset:2048
    s_waitcnt vmcnt(15)
    v_mfma_f32_16x16x32_bf16 v[28:31], a[136:139], v[76:79], v[28:31]
    v_mfma_f32_16x16x32_bf16 v[32:35], a[140:143], v[76:79], v[32:35]
    v_mfma_f32_16x16x32_bf16 v[36:39], v[196:199], v[76:79], v[36:39]
    buffer_load_dwordx4 v[76:79], v0, s[8:11], s48 offen offset:3072
    s_waitcnt vmcnt(15)
    v_mfma_f32_16x16x32_bf16 v[16:19], a[144:147], v[80:83], v[16:19]
    v_mfma_f32_16x16x32_bf16 v[20:23], a[148:151], v[80:83], v[20:23]
    v_mfma_f32_16x16x32_bf16 v[24:27], v[200:203], v[80:83], v[24:27]
    s_add_u32 s48, s46, 53248
    buffer_load_dwordx4 v[80:83], v0, s[8:11], s48 offen offset:0
    s_waitcnt vmcnt(15)
    v_mfma_f32_16x16x32_bf16 v[28:31], a[144:147], v[84:87], v[28:31]
    v_mfma_f32_16x16x32_bf16 v[32:35], a[148:151], v[84:87], v[32:35]
    v_mfma_f32_16x16x32_bf16 v[36:39], v[200:203], v[84:87], v[36:39]
    buffer_load_dwordx4 v[84:87], v0, s[8:11], s48 offen offset:1024
    s_waitcnt vmcnt(15)
    v_mfma_f32_16x16x32_bf16 v[16:19], a[152:155], v[88:91], v[16:19]
    v_mfma_f32_16x16x32_bf16 v[20:23], a[156:159], v[88:91], v[20:23]
    v_mfma_f32_16x16x32_bf16 v[24:27], v[204:207], v[88:91], v[24:27]
    buffer_load_dwordx4 v[88:91], v0, s[8:11], s48 offen offset:2048
    s_waitcnt vmcnt(15)
    v_mfma_f32_16x16x32_bf16 v[28:31], a[152:155], v[92:95], v[28:31]
    v_mfma_f32_16x16x32_bf16 v[32:35], a[156:159], v[92:95], v[32:35]
    v_mfma_f32_16x16x32_bf16 v[36:39], v[204:207], v[92:95], v[36:39]
    buffer_load_dwordx4 v[92:95], v0, s[8:11], s48 offen offset:3072
    s_waitcnt vmcnt(15)
    v_mfma_f32_16x16x32_bf16 v[16:19], a[160:163], v[96:99], v[16:19]
    v_mfma_f32_16x16x32_bf16 v[20:23], a[164:167], v[96:99], v[20:23]
    v_mfma_f32_16x16x32_bf16 v[24:27], v[208:211], v[96:99], v[24:27]
    s_add_u32 s48, s46, 57344
    buffer_load_dwordx4 v[96:99], v0, s[8:11], s48 offen offset:0
    s_waitcnt vmcnt(15)
    v_mfma_f32_16x16x32_bf16 v[28:31], a[160:163], v[100:103], v[28:31]
    v_mfma_f32_16x16x32_bf16 v[32:35], a[164:167], v[100:103], v[32:35]
    v_mfma_f32_16x16x32_bf16 v[36:39], v[208:211], v[100:103], v[36:39]
    buffer_load_dwordx4 v[100:103], v0, s[8:11], s48 offen offset:1024
    s_waitcnt vmcnt(15)
    v_mfma_f32_16x16x32_bf16 v[16:19], a[168:171], v[104:107], v[16:19]
    v_mfma_f32_16x16x32_bf16 v[20:23], a[172:175], v[104:107], v[20:23]
    v_mfma_f32_16x16x32_bf16 v[24:27], v[212:215], v[104:107], v[24:27]
    buffer_load_dwordx4 v[104:107], v0, s[8:11], s48 offen offset:2048
    s_waitcnt vmcnt(15)
    v_mfma_f32_16x16x32_bf16 v[28:31], a[168:171], v[108:111], v[28:31]
    v_mfma_f32_16x16x32_bf16 v[32:35], a[172:175], v[108:111], v[32:35]
    v_mfma_f32_16x16x32_bf16 v[36:39], v[212:215], v[108:111], v[36:39]
    buffer_load_dwordx4 v[108:111], v0, s[8:11], s48 offen offset:3072
    s_waitcnt vmcnt(15)
    v_mfma_f32_16x16x32_bf16 v[16:19], a[176:179], v[112:115], v[16:19]
    v_mfma_f32_16x16x32_bf16 v[20:23], a[180:183], v[112:115], v[20:23]
    v_mfma_f32_16x16x32_bf16 v[24:27], v[216:219], v[112:115], v[24:27]
    s_cmp_lg_u32 s14, 0
    s_cbranch_scc1 LtwX_nw2
    v_cmp_eq_u32 vcc, 0, v2
    v_cmp_eq_u32 s[54:55], 0, v15
    s_nop 0
    s_cmp_eq_u64 s[54:55], 0
    s_cselect_b32 s62, 2, 0
    s_cmp_eq_u64 vcc, 0
    s_cselect_b32 s62, 1, s62
    v_mov_b32 v5, s62
    ds_write_b32 v49, v5
    s_waitcnt lgkmcnt(0)
LtwX_nw2:
    s_barrier
    ds_read_b32 v6, v49
    v_xor_b32 v49, 4, v49
    s_add_u32 s48, s46, 61440
    buffer_load_dwordx4 v[112:115], v0, s[8:11], s48 offen offset:0
    s_waitcnt vmcnt(15)
    v_mfma_f32_16x16x32_bf16 v[28:31], a[176:179], v[116:119], v[28:31]
    v_mfma_f32_16x16x32_bf16 v[32:35], a[180:183], v[116:119], v[32:35]
    v_mfma_f32_16x16x32_bf16 v[36:39], v[216:219], v[116:119], v[36:39]
    buffer_load_dwordx4 v[116:119], v0, s[8:11], s48 offen offset:1024
    s_waitcnt vmcnt(15)
    v_mfma_f32_16x16x32_bf16 v[16:19], a[184:187], v[120:123], v[16:19]
    v_mfma_f32_16x16x32_bf16 v[20:23], a[188:191], v[120:123], v[20:23]
    v_mfma_f32_16x16x32_bf16 v[24:27], v[220:223], v[120:123], v[24:27]
    buffer_load_dwordx4 v[120:123], v0, s[8:11], s48 offen offset:2048
    s_waitcnt vmcnt(15)
    v_mfma_f32_16x16x32_bf16 v[28:31], a[184:187], v[124:127], v[28:31]
    v_mfma_f32_16x16x32_bf16 v[32:35], a[188:191], v[124:127], v[32:35]
    v_mfma_f32_16x16x32_bf16 v[36:39], v[220:223], v[124:127], v[36:39]
    s_waitcnt lgkmcnt(0)
    v_readfirstlane_b32 s62, v6
    s_cmp_lt_u32 s33, 29
    s_cselect_b32 s38, 1, 3
    s_cmp_eq_u32 s62, 2
    s_cselect_b32 s36, 1, 0
    s_cselect_b32 s37, s33, s32
    s_cselect_b32 s17, s38, 0
    s_add_u32 s33, s33, s17
    s_cmp_eq_u32 s62, 1
    s_cselect_b32 s17, 2, 0
    s_add_u32 s32, s32, s17
    s_lshl_b32 s56, s36, 6
    s_add_u32 s56, s56, s37
    buffer_load_dwordx4 v[124:127], v0, s[8:11], s48 offen offset:3072
    s_waitcnt vmcnt(15)
    v_mfma_f32_16x16x32_bf16 v[16:19], a[192:195], v[64:67], v[16:19]
    v_mfma_f32_16x16x32_bf16 v[20:23], a[196:199], v[64:67], v[20:23]
    v_mfma_f32_16x16x32_bf16 v[24:27], v[224:227], v[64:67], v[24:27]
    s_cmp_lt_u32 s37, 64
    s_cselect_b32 s62, s62, 0
    s_lshl_b32 s46, s56, 18
    s_add_u32 s46, s46, s58
    s_mul_i32 s41, s36, 4718592
    s_mul_i32 s17, s37, 36864
    s_add_u32 s41, s41, s17
    s_add_u32 s41, s41, 8650752
    s_cmp_lg_u32 s62, 0
    s_cselect_b32 s30, 268435456, 0
    buffer_load_dword v9, v10, s[28:31], s46 offen
    s_add_u32 s48, s46, 0
    buffer_load_dwordx4 v[64:67], v0, s[28:31], s48 offen offset:0
    s_waitcnt vmcnt(16)
    v_mfma_f32_16x16x32_bf16 v[28:31], a[192:195], v[68:71], v[28:31]
    v_mfma_f32_16x16x32_bf16 v[32:35], a[196:199], v[68:71], v[32:35]
    v_mfma_f32_16x16x32_bf16 v[36:39], v[224:227], v[68:71], v[36:39]
    buffer_load_dwordx4 v[68:71], v0, s[28:31], s48 offen offset:1024
    s_waitcnt vmcnt(16)
    v_mfma_f32_16x16x32_bf16 v[16:19], a[200:203], v[72:75], v[16:19]
    v_mfma_f32_16x16x32_bf16 v[20:23], a[204:207], v[72:75], v[20:23]
    v_mfma_f32_16x16x32_bf16 v[24:27], v[228:231], v[72:75], v[24:27]
    buffer_load_dwordx4 v[72:75], v0, s[28:31], s48 offen offset:2048
    s_waitcnt vmcnt(16)
    v_mfma_f32_16x16x32_bf16 v[28:31], a[200:203], v[76:79], v[28:31]
    v_mfma_f32_16x16x32_bf16 v[32:35], a[204:207], v[76:79], v[32:35]
    v_mfma_f32_16x16x32_bf16 v[36:39], v[228:231], v[76:79], v[36:39]
    buffer_load_dwordx4 v[76:79], v0, s[28:31], s48 offen offset:3072
    s_waitcnt vmcnt(16)
    v_mfma_f32_16x16x32_bf16 v[16:19], a[208:211], v[80:83], v[16:19]
    v_mfma_f32_16x16x32_bf16 v[20:23], a[212:215], v[80:83], v[20:23]
    v_mfma_f32_16x16x32_bf16 v[24:27], v[232:235], v[80:83], v[24:27]
    s_add_u32 s48, s46, 4096
    buffer_load_dwordx4 v[80:83], v0, s[28:31], s48 offen offset:0
    s_waitcnt vmcnt(16)
    v_mfma_f32_16x16x32_bf16 v[28:31], a[208:211], v[84:87], v[28:31]
    v_mfma_f32_16x16x32_bf16 v[32:35], a[212:215], v[84:87], v[32:35]
    v_mfma_f32_16x16x32_bf16 v[36:39], v[232:235], v[84:87], v[36:39]
    buffer_load_dwordx4 v[84:87], v0, s[28:31], s48 offen offset:1024
    s_waitcnt vmcnt(16)
    v_mfma_f32_16x16x32_bf16 v[16:19], a[216:219], v[88:91], v[16:19]
    v_mfma_f32_16x16x32_bf16 v[20:23], a[220:223], v[88:91], v[20:23]
    v_mfma_f32_16x16x32_bf16 v[24:27], v[236:239], v[88:91], v[24:27]
    buffer_load_dwordx4 v[88:91], v0, s[28:31], s48 offen offset:2048
    s_waitcnt vmcnt(16)
    v_mfma_f32_16x16x32_bf16 v[28:31], a[216:219], v[92:95], v[28:31]
    v_mfma_f32_16x16x32_bf16 v[32:35], a[220:223], v[92:95], v[32:35]
    v_mfma_f32_16x16x32_bf16 v[36:39], v[236:239], v[92:95], v[36:39]
    buffer_load_dwordx4 v[92:95], v0, s[28:31], s48 offen offset:3072
    s_waitcnt vmcnt(16)
    v_mfma_f32_16x16x32_bf16 v[16:19], a[224:227], v[96:99], v[16:19]
    v_mfma_f32_16x16x32_bf16 v[20:23], a[228:231], v[96:99], v[20:23]
    v_mfma_f32_16x16x32_bf16 v[24:27], v[240:243], v[96:99], v[24:27]
    s_add_u32 s48, s46, 8192
    buffer_load_dwordx4 v[96:99], v0, s[28:31], s48 offen offset:0
    s_waitcnt vmcnt(16)
    v_mfma_f32_16x16x32_bf16 v[28:31], a[224:227], v[100:103], v[28:31]
    v_mfma_f32_16x16x32_bf16 v[32:35], a[228:231], v[100:103], v[32:35]
    v_mfma_f32_16x16x32_bf16 v[36:39], v[240:243], v[100:103], v[36:39]
    buffer_load_dwordx4 v[100:103], v0, s[28:31], s48 offen offset:1024
    s_waitcnt vmcnt(16)
    v_mfma_f32_16x16x32_bf16 v[16:19], a[232:235], v[104:107], v[16:19]
    v_mfma_f32_16x16x32_bf16 v[20:23], a[236:239], v[104:107], v[20:23]
    v_mfma_f32_16x16x32_bf16 v[24:27], v[244:247], v[104:107], v[24:27]
    buffer_load_dwordx4 v[104:107], v0, s[28:31], s48 offen offset:2048
    s_waitcnt vmcnt(16)
    v_mfma_f32_16x16x32_bf16 v[28:31], a[232:235], v[108:111], v[28:31]
    v_mfma_f32_16x16x32_bf16 v[32:35], a[236:239], v[108:111], v[32:35]
    v_mfma_f32_16x16x32_bf16 v[36:39], v[244:247], v[108:111], v[36:39]
    buffer_load_dwordx4 v[108:111], v0, s[28:31], s48 offen offset:3072
    s_waitcnt vmcnt(16)
    v_mfma_f32_16x16x32_bf16 v[16:19], a[240:243], v[112:115], v[16:19]
    v_mfma_f32_16x16x32_bf16 v[20:23], a[244:247], v[112:115], v[20:23]
    v_mfma_f32_16x16x32_bf16 v[24:27], v[248:251], v[112:115], v[24:27]
    s_add_u32 s48, s46, 12288
    buffer_load_dwordx4 v[112:115], v0, s[28:31], s48 offen offset:0
    s_waitcnt vmcnt(16)
    v_mfma_f32_16x16x32_bf16 v[28:31], a[240:243], v[116:119], v[28:31]
    v_mfma_f32_16x16x32_bf16 v[32:35], a[244:247], v[116:119], v[32:35]
    v_mfma_f32_16x16x32_bf16 v[36:39], v[248:251], v[116:119], v[36:39]
    buffer_load_dwordx4 v[116:119], v0, s[28:31], s48 offen offset:1024
    s_waitcnt vmcnt(16)
    v_mfma_f32_16x16x32_bf16 v[16:19], a[248:251], v[120:123], v[16:19]
    v_mfma_f32_16x16x32_bf16 v[20:23], a[252:255], v[120:123], v[20:23]
    v_mfma_f32_16x16x32_bf16 v[24:27], v[252:255], v[120:123], v[24:27]
    buffer_load_dwordx4 v[120:123], v0, s[28:31], s48 offen offset:2048
    s_waitcnt vmcnt(16)
    v_mfma_f32_16x16x32_bf16 v[28:31], a[248:251], v[124:127], v[28:31]
    v_mfma_f32_16x16x32_bf16 v[32:35], a[252:255], v[124:127], v[32:35]
    v_mfma_f32_16x16x32_bf16 v[36:39], v[252:255], v[124:127], v[36:39]
    s_nop 5
    ds_write_b128 v48, v[16:19] offset:0
    ds_write_b128 v48, v[20:23] offset:1024
    ds_write_b128 v48, v[24:27] offset:2048
    ds_write_b128 v48, v[28:31] offset:3072
    ds_write_b128 v48, v[32:35] offset:4096
    ds_write_b128 v48, v[36:39] offset:5120
    s_waitcnt lgkmcnt(0)
    s_barrier
    ds_read_b128 v[24:27], v50 offset:0
    ds_read_b128 v[28:31], v50 offset:1024
    ds_read_b128 v[32:35], v50 offset:6144
    ds_read_b128 v[36:39], v50 offset:7168
    ds_read_b128 v[56:59], v50 offset:12288
    ds_read_b128 v[60:63], v50 offset:13312
    ds_read_b128 v[124:127], v50 offset:18432
    ds_read_b128 v[52:55], v50 offset:19456
    v_xor_b32 v48, 0x8000, v48
    v_xor_b32 v50, 0x8000, v50
    v_lshlrev_b32 v16, 16, v40
    v_and_b32 v20, 0xffff0000, v40
    v_lshlrev_b32 v17, 16, v41
    v_and_b32 v21, 0xffff0000, v41
    v_lshlrev_b32 v18, 16, v42
    v_and_b32 v22, 0xffff0000, v42
    v_lshlrev_b32 v19, 16, v43
    v_and_b32 v23, 0xffff0000, v43
    buffer_load_dwordx4 v[40:43], v12, s[28:31], s41 offen
    s_waitcnt lgkmcnt(7)
    v_add_f32 v16, v16, v24
    v_add_f32 v17, v17, v25
    v_add_f32 v18, v18, v26
    v_add_f32 v19, v19, v27
    s_waitcnt lgkmcnt(6)
    v_add_f32 v20, v20, v28
    v_add_f32 v21, v21, v29
    v_add_f32 v22, v22, v30
    v_add_f32 v23, v23, v31
    s_waitcnt lgkmcnt(5)
    v_add_f32 v16, v16, v32
    v_add_f32 v17, v17, v33
    v_add_f32 v18, v18, v34
    v_add_f32 v19, v19, v35
    s_waitcnt lgkmcnt(4)
    v_add_f32 v20, v20, v36
    v_add_f32 v21, v21, v37
    v_add_f32 v22, v22, v38
    v_add_f32 v23, v23, v39
    s_waitcnt lgkmcnt(3)
    v_add_f32 v16, v16, v56
    v_add_f32 v17, v17, v57
    v_add_f32 v18, v18, v58
    v_add_f32 v19, v19, v59
    s_waitcnt lgkmcnt(2)
    v_add_f32 v20, v20, v60
    v_add_f32 v21, v21, v61
    v_add_f32 v22, v22, v62
    v_add_f32 v23, v23, v63
    s_waitcnt lgkmcnt(1)
    v_add_f32 v16, v16, v124
    v_add_f32 v17, v17, v125
    v_add_f32 v18, v18, v126
    v_add_f32 v19, v19, v127
    s_waitcnt lgkmcnt(0)
    v_add_f32 v20, v20, v52
    v_add_f32 v21, v21, v53
    v_add_f32 v22, v22, v54
    v_add_f32 v23, v23, v55
    v_cvt_pk_bf16_f32 v52, v16, v20
    v_cvt_pk_bf16_f32 v53, v17, v21
    v_cvt_pk_bf16_f32 v54, v18, v22
    v_cvt_pk_bf16_f32 v55, v19, v23
    s_cmp_eq_u32 s34, 0
    s_cbranch_scc1 LtwX_l0
    s_mul_i32 s17, s35, 36864
    buffer_store_dwordx4 v[52:55], v13, s[24:27], s17 offen sc1
    s_cmp_lg_u32 s62, 0
    s_cbranch_scc1 LtwX_item
LtwX_chk:
    s_min_u32 s17, s32, s33
    s_cmp_lt_u32 s17, 64
    s_cbranch_scc1 LtwX_idle
    s_branch L_role_tw_exit
LtwX_l0:
    s_add_u32 s47, s47, 2359296
    buffer_store_dwordx4 v[52:55], v12, s[8:11], s47 offen sc1
    v_add_f32 v44, v16, v17
    v_mul_f32 v45, v16, v16
    v_fmac_f32 v45, v17, v17
    v_add_f32 v44, v44, v18
    v_fmac_f32 v45, v18, v18
    v_add_f32 v44, v44, v19
    v_fmac_f32 v45, v19, v19
    v_add_f32 v44, v44, v20
    v_fmac_f32 v45, v20, v20
    v_add_f32 v44, v44, v21
    v_fmac_f32 v45, v21, v21
    v_add_f32 v44, v44, v22
    v_fmac_f32 v45, v22, v22
    v_add_f32 v44, v44, v23
    v_fmac_f32 v45, v23, v23
    v_mov_b32 v46, v44
    v_mov_b32 v47, v45
    s_nop 0
    v_permlane32_swap_b32 v44, v46
    v_permlane32_swap_b32 v45, v47
    v_add_f32 v44, v44, v46
    v_add_f32 v45, v45, v47
    v_mov_b32 v46, v44
    v_mov_b32 v47, v45
    s_nop 0
    v_permlane16_swap_b32 v44, v46
    v_permlane16_swap_b32 v45, v47
    v_add_f32 v44, v44, v46
    v_add_f32 v45, v45, v47
    s_mul_i32 s17, s35, 6144
    s_add_u32 s17, s17, 16515072
    s_mov_b64 exec, 0xffff
    buffer_store_dwordx2 v[44:45], v14, s[8:11], s17 offen sc1
    s_mov_b64 exec, -1
    s_mul_i32 s43, s35, 22528
    s_add_u32 s43, s43, s49
    s_cmp_lg_u32 s62, 0
    s_cbranch_scc1 LtwX_item
    s_waitcnt vmcnt(0)
    s_mov_b64 exec, 1
    buffer_store_dword v3, v4, s[8:11], s43 offen sc1
    s_mov_b64 exec, -1
    s_mov_b32 s43, 0
    s_branch LtwX_chk
Ltw_z:
    v_lshrrev_b32 v5, 1, v8
    v_lshl_add_u32 v12, v5, 9, v12
    v_and_b32 v5, 1, v8
    v_lshl_add_u32 v12, v5, 3, v12
    v_add_u32 v12, 2048, v12
    v_lshl_add_u32 v13, v8, 3, v13
    v_add_u32 v13, 64, v13
    v_add_u32 v14, 8, v14
    s_lshl_b32 s58, s14, 16
    s_add_u32 s58, s58, 144703488
    s_mov_b32 s43, 0
    s_mov_b32 s28, s8
    s_mov_b32 s29, s9
    s_mov_b32 s30, 0
    s_mov_b32 s31, 0x00020000
    s_mul_i32 s17, s51, 3072
    v_add_u32 v50, s17, v0
    ds_write2_b32 v49, v4, v4 offset0:0 offset1:1
    s_waitcnt lgkmcnt(0)
    s_cmp_lg_u32 s14, 0
    s_cbranch_scc1 LtwZ_inia_d
    v_mov_b32 v5, 40
    s_mov_b32 s16, 0
LtwZ_inia:
    global_load_dword v6, v5, s[12:13] sc1
    s_add_u32 s16, s16, 1
    s_cmp_gt_u32 s16, 100000
    s_cbranch_scc1 L_role_tw_abort
    s_waitcnt vmcnt(0)
    v_cmp_gt_u32 vcc, 128, v6
    s_nop 0
    s_cbranch_vccz LtwZ_inia_d
    s_sleep 8
    s_branch LtwZ_inia
LtwZ_inia_d:
    s_barrier
    s_cmp_lg_u32 s14, 0
    s_cbranch_scc1 LtwZ_inib_d
    v_mov_b32 v5, 160
    s_mov_b32 s16, 0
LtwZ_inib:
    global_load_dword v6, v5, s[12:13] sc1
    s_add_u32 s16, s16, 1
    s_cmp_gt_u32 s16, 100000
    s_cbranch_scc1 L_role_tw_abort
    s_waitcnt vmcnt(0)
    v_cmp_gt_u32 vcc, 64, v6
    s_nop 0
    s_cbranch_vccz LtwZ_inib_d
    s_sleep 8
    s_branch LtwZ_inib
LtwZ_inib_d:
    s_barrier
LtwZ_idle:
    s_barrier
    ds_read_b32 v6, v49
    v_xor_b32 v49, 4, v49
    s_waitcnt lgkmcnt(0)
    v_readfirstlane_b32 s62, v6
    s_nop 0
    s_cmp_eq_u32 s62, 0
    s_cbranch_scc1 L_role_tw_abort
    s_cmp_lt_u32 s33, 29
    s_cselect_b32 s38, 1, 3
    s_cmp_eq_u32 s62, 2
    s_cselect_b32 s36, 1, 0
    s_cselect_b32 s37, s33, s32
    s_cselect_b32 s17, s38, 0
    s_add_u32 s33, s33, s17
    s_cmp_eq_u32 s62, 1
    s_cselect_b32 s17, 2, 0
    s_add_u32 s32, s32, s17
    s_lshl_b32 s56, s36, 6
    s_add_u32 s56, s56, s37
    s_lshl_b32 s46, s56, 18
    s_add_u32 s46, s46, s58
    s_mul_i32 s41, s36, 4718592
    s_mul_i32 s17, s37, 36864
    s_add_u32 s41, s41, s17
    s_add_u32 s41, s41, 8650752
    s_cmp_ge_u32 s37, 64
    s_cbranch_scc1 L_role_tw_abort
    buffer_load_dword v9, v10, s[8:11], s46 offen
    s_add_u32 s48, s46, 0
    buffer_load_dwordx4 v[64:67], v0, s[8:11], s48 offen offset:0
    buffer_load_dwordx4 v[68:71], v0, s[8:11], s48 offen offset:1024
    buffer_load_dwordx4 v[72:75], v0, s[8:11], s48 offen offset:2048
    buffer_load_dwordx4 v[76:79], v0, s[8:11], s48 offen offset:3072
    s_add_u32 s48, s46, 4096
    buffer_load_dwordx4 v[80:83], v0, s[8:11], s48 offen offset:0
    buffer_load_dwordx4 v[84:87], v0, s[8:11], s48 offen offset:1024
    buffer_load_dwordx4 v[88:91], v0, s[8:11], s48 offen offset:2048
    buffer_load_dwordx4 v[92:95], v0, s[8:11], s48 offen offset:3072
    s_add_u32 s48, s46, 8192
    buffer_load_dwordx4 v[96:99], v0, s[8:11], s48 offen offset:0
    buffer_load_dwordx4 v[100:103], v0, s[8:11], s48 offen offset:1024
    buffer_load_dwordx4 v[104:107], v0, s[8:11], s48 offen offset:2048
    buffer_load_dwordx4 v[108:111], v0, s[8:11], s48 offen offset:3072
    s_add_u32 s48, s46, 12288
    buffer_load_dwordx4 v[112:115], v0, s[8:11], s48 offen offset:0
    buffer_load_dwordx4 v[116:119], v0, s[8:11], s48 offen offset:1024
    buffer_load_dwordx4 v[120:123], v0, s[8:11], s48 offen offset:2048
    buffer_load_dwordx2 v[40:41], v12, s[8:11], s41 offen
LtwZ_item:
    s_mov_b32 s34, s36
    s_mov_b32 s35, s37
    s_mov_b32 s47, s41
    buffer_load_dwordx4 v[124:127], v0, s[8:11], s48 offen offset:3072
    s_waitcnt vmcnt(15)
    v_mfma_f32_16x16x32_bf16 v[16:19], a[0:3], v[64:67], 0
    v_mfma_f32_16x16x32_bf16 v[20:23], a[4:7], v[64:67], 0
    v_mfma_f32_16x16x32_bf16 v[24:27], v[128:131], v[64:67], 0
    s_add_u32 s48, s46, 16384
    buffer_load_dwordx4 v[64:67], v0, s[8:11], s48 offen offset:0
    s_waitcnt vmcnt(15)
    v_mfma_f32_16x16x32_bf16 v[28:31], a[0:3], v[68:71], 0
    v_mfma_f32_16x16x32_bf16 v[32:35], a[4:7], v[68:71], 0
    v_mfma_f32_16x16x32_bf16 v[36:39], v[128:131], v[68:71], 0
    buffer_load_dwordx4 v[68:71], v0, s[8:11], s48 offen offset:1024
    s_waitcnt vmcnt(15)
    v_mfma_f32_16x16x32_bf16 v[16:19], a[8:11], v[72:75], v[16:19]
    v_mfma_f32_16x16x32_bf16 v[20:23], a[12:15], v[72:75], v[20:23]
    v_mfma_f32_16x16x32_bf16 v[24:27], v[132:135], v[72:75], v[24:27]
    buffer_load_dwordx4 v[72:75], v0, s[8:11], s48 offen offset:2048
    s_waitcnt vmcnt(15)
    v_mfma_f32_16x16x32_bf16 v[28:31], a[8:11], v[76:79], v[28:31]
    v_mfma_f32_16x16x32_bf16 v[32:35], a[12:15], v[76:79], v[32:35]
    v_mfma_f32_16x16x32_bf16 v[36:39], v[132:135], v[76:79], v[36:39]
    buffer_load_dwordx4 v[76:79], v0, s[8:11], s48 offen offset:3072
    s_waitcnt vmcnt(15)
    v_mfma_f32_16x16x32_bf16 v[16:19], a[16:19], v[80:83], v[16:19]
    v_mfma_f32_16x16x32_bf16 v[20:23], a[20:23], v[80:83], v[20:23]
    v_mfma_f32_16x16x32_bf16 v[24:27], v[136:139], v[80:83], v[24:27]
    s_add_u32 s48, s46, 20480
    buffer_load_dwordx4 v[80:83], v0, s[8:11], s48 offen offset:0
    s_waitcnt vmcnt(15)
    v_mfma_f32_16x16x32_bf16 v[28:31], a[16:19], v[84:87], v[28:31]
    v_mfma_f32_16x16x32_bf16 v[32:35], a[20:23], v[84:87], v[32:35]
    v_mfma_f32_16x16x32_bf16 v[36:39], v[136:139], v[84:87], v[36:39]
    buffer_load_dwordx4 v[84:87], v0, s[8:11], s48 offen offset:1024
    s_waitcnt vmcnt(15)
    v_mfma_f32_16x16x32_bf16 v[16:19], a[24:27], v[88:91], v[16:19]
    v_mfma_f32_16x16x32_bf16 v[20:23], a[28:31], v[88:91], v[20:23]
    v_mfma_f32_16x16x32_bf16 v[24:27], v[140:143], v[88:91], v[24:27]
    buffer_load_dwordx4 v[88:91], v0, s[8:11], s48 offen offset:2048
    s_waitcnt vmcnt(15)
    v_mfma_f32_16x16x32_bf16 v[28:31], a[24:27], v[92:95], v[28:31]
    v_mfma_f32_16x16x32_bf16 v[32:35], a[28:31], v[92:95], v[32:35]
    v_mfma_f32_16x16x32_bf16 v[36:39], v[140:143], v[92:95], v[36:39]
    buffer_load_dwordx4 v[92:95], v0, s[8:11], s48 offen offset:3072
    s_waitcnt vmcnt(15)
    v_mfma_f32_16x16x32_bf16 v[16:19], a[32:35], v[96:99], v[16:19]
    v_mfma_f32_16x16x32_bf16 v[20:23], a[36:39], v[96:99], v[20:23]
    v_mfma_f32_16x16x32_bf16 v[24:27], v[144:147], v[96:99], v[24:27]
    s_add_u32 s48, s46, 24576
    buffer_load_dwordx4 v[96:99], v0, s[8:11], s48 offen offset:0
    s_waitcnt vmcnt(15)
    v_mfma_f32_16x16x32_bf16 v[28:31], a[32:35], v[100:103], v[28:31]
    v_mfma_f32_16x16x32_bf16 v[32:35], a[36:39], v[100:103], v[32:35]
    v_mfma_f32_16x16x32_bf16 v[36:39], v[144:147], v[100:103], v[36:39]
    buffer_load_dwordx4 v[100:103], v0, s[8:11], s48 offen offset:1024
    s_waitcnt vmcnt(15)
    v_mfma_f32_16x16x32_bf16 v[16:19], a[40:43], v[104:107], v[16:19]
    v_mfma_f32_16x16x32_bf16 v[20:23], a[44:47], v[104:107], v[20:23]
    v_mfma_f32_16x16x32_bf16 v[24:27], v[148:151], v[104:107], v[24:27]
    buffer_load_dwordx4 v[104:107], v0, s[8:11], s48 offen offset:2048
    s_waitcnt vmcnt(15)
    v_mfma_f32_16x16x32_bf16 v[28:31], a[40:43], v[108:111], v[28:31]
    v_mfma_f32_16x16x32_bf16 v[32:35], a[44:47], v[108:111], v[32:35]
    v_mfma_f32_16x16x32_bf16 v[36:39], v[148:151], v[108:111], v[36:39]
    buffer_load_dwordx4 v[108:111], v0, s[8:11], s48 offen offset:3072
    s_waitcnt vmcnt(15)
    v_mfma_f32_16x16x32_bf16 v[16:19], a[48:51], v[112:115], v[16:19]
    v_mfma_f32_16x16x32_bf16 v[20:23], a[52:55], v[112:115], v[20:23]
    v_mfma_f32_16x16x32_bf16 v[24:27], v[152:155], v[112:115], v[24:27]
    s_add_u32 s48, s46, 28672
    buffer_load_dwordx4 v[112:115], v0, s[8:11], s48 offen offset:0
    s_waitcnt vmcnt(15)
    v_mfma_f32_16x16x32_bf16 v[28:31], a[48:51], v[116:119], v[28:31]
    v_mfma_f32_16x16x32_bf16 v[32:35], a[52:55], v[116:119], v[32:35]
    v_mfma_f32_16x16x32_bf16 v[36:39], v[152:155], v[116:119], v[36:39]
    buffer_load_dwordx4 v[116:119], v0, s[8:11], s48 offen offset:1024
    s_waitcnt vmcnt(15)
    v_mfma_f32_16x16x32_bf16 v[16:19], a[56:59], v[120:123], v[16:19]
    v_mfma_f32_16x16x32_bf16 v[20:23], a[60:63], v[120:123], v[20:23]
    v_mfma_f32_16x16x32_bf16 v[24:27], v[156:159], v[120:123], v[24:27]
    buffer_load_dwordx4 v[120:123], v0, s[8:11], s48 offen offset:2048
    s_waitcnt vmcnt(15)
    v_mfma_f32_16x16x32_bf16 v[28:31], a[56:59], v[124:127], v[28:31]
    v_mfma_f32_16x16x32_bf16 v[32:35], a[60:63], v[124:127], v[32:35]
    v_mfma_f32_16x16x32_bf16 v[36:39], v[156:159], v[124:127], v[36:39]
    buffer_load_dwordx4 v[124:127], v0, s[8:11], s48 offen offset:3072
    s_waitcnt vmcnt(15)
    v_mfma_f32_16x16x32_bf16 v[16:19], a[64:67], v[64:67], v[16:19]
    v_mfma_f32_16x16x32_bf16 v[20:23], a[68:71], v[64:67], v[20:23]
    v_mfma_f32_16x16x32_bf16 v[24:27], v[160:163], v[64:67], v[24:27]
    s_add_u32 s48, s46, 32768
    buffer_load_dwordx4 v[64:67], v0, s[8:11], s48 offen offset:0
    s_waitcnt vmcnt(15)
    v_mfma_f32_16x16x32_bf16 v[28:31], a[64:67], v[68:71], v[28:31]
    v_mfma_f32_16x16x32_bf16 v[32:35], a[68:71], v[68:71], v[32:35]
    v_mfma_f32_16x16x32_bf16 v[36:39], v[160:163], v[68:71], v[36:39]
    s_cmp_lg_u32 s43, 0
    s_cselect_b64 exec, 1, 0
    buffer_store_dword v3, v4, s[8:11], s43 offen sc1
    s_mov_b64 exec, -1
    s_mov_b32 s43, 0
    buffer_load_dwordx4 v[68:71], v0, s[8:11], s48 offen offset:1024
    s_waitcnt vmcnt(16)
    v_mfma_f32_16x16x32_bf16 v[16:19], a[72:75], v[72:75], v[16:19]
    v_mfma_f32_16x16x32_bf16 v[20:23], a[76:79], v[72:75], v[20:23]
    v_mfma_f32_16x16x32_bf16 v[24:27], v[164:167], v[72:75], v[24:27]
    buffer_load_dwordx4 v[72:75], v0, s[8:11], s48 offen offset:2048
    s_waitcnt vmcnt(16)
    v_mfma_f32_16x16x32_bf16 v[28:31], a[72:75], v[76:79], v[28:31]
    v_mfma_f32_16x16x32_bf16 v[32:35], a[76:79], v[76:79], v[32:35]
    v_mfma_f32_16x16x32_bf16 v[36:39], v[164:167], v[76:79], v[36:39]
    buffer_load_dwordx4 v[76:79], v0, s[8:11], s48 offen offset:3072
    s_waitcnt vmcnt(16)
    v_mfma_f32_16x16x32_bf16 v[16:19], a[80:83], v[80:83], v[16:19]
    v_mfma_f32_16x16x32_bf16 v[20:23], a[84:87], v[80:83], v[20:23]
    v_mfma_f32_16x16x32_bf16 v[24:27], v[168:171], v[80:83], v[24:27]
    s_add_u32 s48, s46, 36864
    buffer_load_dwordx4 v[80:83], v0, s[8:11], s48 offen offset:0
    s_waitcnt vmcnt(16)
    v_mfma_f32_16x16x32_bf16 v[28:31], a[80:83], v[84:87], v[28:31]
    v_mfma_f32_16x16x32_bf16 v[32:35], a[84:87], v[84:87], v[32:35]
    v_mfma_f32_16x16x32_bf16 v[36:39], v[168:171], v[84:87], v[36:39]
    buffer_load_dwordx4 v[84:87], v0, s[8:11], s48 offen offset:1024
    s_waitcnt vmcnt(16)
    v_mfma_f32_16x16x32_bf16 v[16:19], a[88:91], v[88:91], v[16:19]
    v_mfma_f32_16x16x32_bf16 v[20:23], a[92:95], v[88:91], v[20:23]
    v_mfma_f32_16x16x32_bf16 v[24:27], v[172:175], v[88:91], v[24:27]
    buffer_load_dwordx4 v[88:91], v0, s[8:11], s48 offen offset:2048
    s_waitcnt vmcnt(16)
    v_mfma_f32_16x16x32_bf16 v[28:31], a[88:91], v[92:95], v[28:31]
    v_mfma_f32_16x16x32_bf16 v[32:35], a[92:95], v[92:95], v[32:35]
    v_mfma_f32_16x16x32_bf16 v[36:39], v[172:175], v[92:95], v[36:39]
    buffer_load_dwordx4 v[92:95], v0, s[8:11], s48 offen offset:3072
    s_waitcnt vmcnt(16)
    v_mfma_f32_16x16x32_bf16 v[16:19], a[96:99], v[96:99], v[16:19]
    v_mfma_f32_16x16x32_bf16 v[20:23], a[100:103], v[96:99], v[20:23]
    v_mfma_f32_16x16x32_bf16 v[24:27], v[176:179], v[96:99], v[24:27]
    s_add_u32 s48, s46, 40960
    buffer_load_dwordx4 v[96:99], v0, s[8:11], s48 offen offset:0
    s_waitcnt vmcnt(16)
    v_mfma_f32_16x16x32_bf16 v[28:31], a[96:99], v[100:103], v[28:31]
    v_mfma_f32_16x16x32_bf16 v[32:35], a[100:103], v[100:103], v[32:35]
    v_mfma_f32_16x16x32_bf16 v[36:39], v[176:179], v[100:103], v[36:39]
    buffer_load_dwordx4 v[100:103], v0, s[8:11], s48 offen offset:1024
    s_waitcnt vmcnt(16)
    v_mfma_f32_16x16x32_bf16 v[16:19], a[104:107], v[104:107], v[16:19]
    v_mfma_f32_16x16x32_bf16 v[20:23], a[108:111], v[104:107], v[20:23]
    v_mfma_f32_16x16x32_bf16 v[24:27], v[180:183], v[104:107], v[24:27]
    buffer_load_dwordx4 v[104:107], v0, s[8:11], s48 offen offset:2048
    s_waitcnt vmcnt(16)
    v_mfma_f32_16x16x32_bf16 v[28:31], a[104:107], v[108:111], v[28:31]
    v_mfma_f32_16x16x32_bf16 v[32:35], a[108:111], v[108:111], v[32:35]
    v_mfma_f32_16x16x32_bf16 v[36:39], v[180:183], v[108:111], v[36:39]
    buffer_load_dwordx4 v[108:111], v0, s[8:11], s48 offen offset:3072
    s_waitcnt vmcnt(16)
    v_mfma_f32_16x16x32_bf16 v[16:19], a[112:115], v[112:115], v[16:19]
    v_mfma_f32_16x16x32_bf16 v[20:23], a[116:119], v[112:115], v[20:23]
    v_mfma_f32_16x16x32_bf16 v[24:27], v[184:187], v[112:115], v[24:27]
    s_add_u32 s48, s46, 45056
    buffer_load_dwordx4 v[112:115], v0, s[8:11], s48 offen offset:0
    s_waitcnt vmcnt(16)
    v_mfma_f32_16x16x32_bf16 v[28:31], a[112:115], v[116:119], v[28:31]
    v_mfma_f32_16x16x32_bf16 v[32:35], a[116:119], v[116:119], v[32:35]
    v_mfma_f32_16x16x32_bf16 v[36:39], v[184:187], v[116:119], v[36:39]
    buffer_load_dwordx4 v[116:119], v0, s[8:11], s48 offen offset:1024
    s_waitcnt vmcnt(16)
    v_mfma_f32_16x16x32_bf16 v[16:19], a[120:123], v[120:123], v[16:19]
    v_mfma_f32_16x16x32_bf16 v[20:23], a[124:127], v[120:123], v[20:23]
    v_mfma_f32_16x16x32_bf16 v[24:27], v[188:191], v[120:123], v[24:27]
    buffer_load_dwordx4 v[120:123], v0, s[8:11], s48 offen offset:2048
    s_waitcnt vmcnt(16)
    v_mfma_f32_16x16x32_bf16 v[28:31], a[120:123], v[124:127], v[28:31]
    v_mfma_f32_16x16x32_bf16 v[32:35], a[124:127], v[124:127], v[32:35]
    v_mfma_f32_16x16x32_bf16 v[36:39], v[188:191], v[124:127], v[36:39]
    buffer_load_dwordx4 v[124:127], v0, s[8:11], s48 offen offset:3072
    s_waitcnt vmcnt(16)
    v_mfma_f32_16x16x32_bf16 v[16:19], a[128:131], v[64:67], v[16:19]
    v_mfma_f32_16x16x32_bf16 v[20:23], a[132:135], v[64:67], v[20:23]
    v_mfma_f32_16x16x32_bf16 v[24:27], v[192:195], v[64:67], v[24:27]
    s_add_u32 s48, s46, 49152
    buffer_load_dwordx4 v[64:67], v0, s[8:11], s48 offen offset:0
    s_waitcnt vmcnt(15)
    v_mfma_f32_16x16x32_bf16 v[28:31], a[128:131], v[68:71], v[28:31]
    v_mfma_f32_16x16x32_bf16 v[32:35], a[132:135], v[68:71], v[32:35]
    v_mfma_f32_16x16x32_bf16 v[36:39], v[192:195], v[68:71], v[36:39]
    buffer_load_dwordx4 v[68:71], v0, s[8:11], s48 offen offset:1024
    s_waitcnt vmcnt(15)
    v_mfma_f32_16x16x32_bf16 v[16:19], a[136:139], v[72:75], v[16:19]
    v_mfma_f32_16x16x32_bf16 v[20:23], a[140:143], v[72:75], v[20:23]
    v_mfma_f32_16x16x32_bf16 v[24:27], v[196:199], v[72:75], v[24:27]
    buffer_load_dwordx4 v[72:75], v0, s[8:11], s48 offen offset:2048
    s_waitcnt vmcnt(15)
    v_mfma_f32_16x16x32_bf16 v[28:31], a[136:139], v[76:79], v[28:31]
    v_mfma_f32_16x16x32_bf16 v[32:35], a[140:143], v[76:79], v[32:35]
    v_mfma_f32_16x16x32_bf16 v[36:39], v[196:199], v[76:79], v[36:39]
    buffer_load_dwordx4 v[76:79], v0, s[8:11], s48 offen offset:3072
    s_waitcnt vmcnt(15)
    v_mfma_f32_16x16x32_bf16 v[16:19], a[144:147], v[80:83], v[16:19]
    v_mfma_f32_16x16x32_bf16 v[20:23], a[148:151], v[80:83], v[20:23]
    v_mfma_f32_16x16x32_bf16 v[24:27], v[200:203], v[80:83], v[24:27]
    s_add_u32 s48, s46, 53248
    buffer_load_dwordx4 v[80:83], v0, s[8:11], s48 offen offset:0
    s_waitcnt vmcnt(15)
    v_mfma_f32_16x16x32_bf16 v[28:31], a[144:147], v[84:87], v[28:31]
    v_mfma_f32_16x16x32_bf16 v[32:35], a[148:151], v[84:87], v[32:35]
    v_mfma_f32_16x16x32_bf16 v[36:39], v[200:203], v[84:87], v[36:39]
    buffer_load_dwordx4 v[84:87], v0, s[8:11], s48 offen offset:1024
    s_waitcnt vmcnt(15)
    v_mfma_f32_16x16x32_bf16 v[16:19], a[152:155], v[88:91], v[16:19]
    v_mfma_f32_16x16x32_bf16 v[20:23], a[156:159], v[88:91], v[20:23]
    v_mfma_f32_16x16x32_bf16 v[24:27], v[204:207], v[88:91], v[24:27]
    buffer_load_dwordx4 v[88:91], v0, s[8:11], s48 offen offset:2048
    s_waitcnt vmcnt(15)
    v_mfma_f32_16x16x32_bf16 v[28:31], a[152:155], v[92:95], v[28:31]
    v_mfma_f32_16x16x32_bf16 v[32:35], a[156:159], v[92:95], v[32:35]
    v_mfma_f32_16x16x32_bf16 v[36:39], v[204:207], v[92:95], v[36:39]
    buffer_load_dwordx4 v[92:95], v0, s[8:11], s48 offen offset:3072
    s_waitcnt vmcnt(15)
    v_mfma_f32_16x16x32_bf16 v[16:19], a[160:163], v[96:99], v[16:19]
    v_mfma_f32_16x16x32_bf16 v[20:23], a[164:167], v[96:99], v[20:23]
    v_mfma_f32_16x16x32_bf16 v[24:27], v[208:211], v[96:99], v[24:27]
    s_add_u32 s48, s46, 57344
    buffer_load_dwordx4 v[96:99], v0, s[8:11], s48 offen offset:0
    s_waitcnt vmcnt(15)
    v_mfma_f32_16x16x32_bf16 v[28:31], a[160:163], v[100:103], v[28:31]
    v_mfma_f32_16x16x32_bf16 v[32:35], a[164:167], v[100:103], v[32:35]
    v_mfma_f32_16x16x32_bf16 v[36:39], v[208:211], v[100:103], v[36:39]
    buffer_load_dwordx4 v[100:103], v0, s[8:11], s48 offen offset:1024
    s_waitcnt vmcnt(15)
    v_mfma_f32_16x16x32_bf16 v[16:19], a[168:171], v[104:107], v[16:19]
    v_mfma_f32_16x16x32_bf16 v[20:23], a[172:175], v[104:107], v[20:23]
    v_mfma_f32_16x16x32_bf16 v[24:27], v[212:215], v[104:107], v[24:27]
    buffer_load_dwordx4 v[104:107], v0, s[8:11], s48 offen offset:2048
    s_waitcnt vmcnt(15)
    v_mfma_f32_16x16x32_bf16 v[28:31], a[168:171], v[108:111], v[28:31]
    v_mfma_f32_16x16x32_bf16 v[32:35], a[172:175], v[108:111], v[32:35]
    v_mfma_f32_16x16x32_bf16 v[36:39], v[212:215], v[108:111], v[36:39]
    buffer_load_dwordx4 v[108:111], v0, s[8:11], s48 offen offset:3072
    s_waitcnt vmcnt(15)
    v_mfma_f32_16x16x32_bf16 v[16:19], a[176:179], v[112:115], v[16:19]
    v_mfma_f32_16x16x32_bf16 v[20:23], a[180:183], v[112:115], v[20:23]
    v_mfma_f32_16x16x32_bf16 v[24:27], v[216:219], v[112:115], v[24:27]
    s_barrier
    ds_read_b32 v6, v49
    v_xor_b32 v49, 4, v49
    s_add_u32 s48, s46, 61440
    buffer_load_dwordx4 v[112:115], v0, s[8:11], s48 offen offset:0
    s_waitcnt vmcnt(15)
    v_mfma_f32_16x16x32_bf16 v[28:31], a[176:179], v[116:119], v[28:31]
    v_mfma_f32_16x16x32_bf16 v[32:35], a[180:183], v[116:119], v[32:35]
    v_mfma_f32_16x16x32_bf16 v[36:39], v[216:219], v[116:119], v[36:39]
    buffer_load_dwordx4 v[116:119], v0, s[8:11], s48 offen offset:1024
    s_waitcnt vmcnt(15)
    v_mfma_f32_16x16x32_bf16 v[16:19], a[184:187], v[120:123], v[16:19]
    v_mfma_f32_16x16x32_bf16 v[20:23], a[188:191], v[120:123], v[20:23]
    v_mfma_f32_16x16x32_bf16 v[24:27], v[220:223], v[120:123], v[24:27]
    buffer_load_dwordx4 v[120:123], v0, s[8:11], s48 offen offset:2048
    s_waitcnt vmcnt(15)
    v_mfma_f32_16x16x32_bf16 v[28:31], a[184:187], v[124:127], v[28:31]
    v_mfma_f32_16x16x32_bf16 v[32:35], a[188:191], v[124:127], v[32:35]
    v_mfma_f32_16x16x32_bf16 v[36:39], v[220:223], v[124:127], v[36:39]
    s_waitcnt lgkmcnt(0)
    v_readfirstlane_b32 s62, v6
    s_cmp_lt_u32 s33, 29
    s_cselect_b32 s38, 1, 3
    s_cmp_eq_u32 s62, 2
    s_cselect_b32 s36, 1, 0
    s_cselect_b32 s37, s33, s32
    s_cselect_b32 s17, s38, 0
    s_add_u32 s33, s33, s17
    s_cmp_eq_u32 s62, 1
    s_cselect_b32 s17, 2, 0
    s_add_u32 s32, s32, s17
    s_lshl_b32 s56, s36, 6
    s_add_u32 s56, s56, s37
    buffer_load_dwordx4 v[124:127], v0, s[8:11], s48 offen offset:3072
    s_waitcnt vmcnt(15)
    v_mfma_f32_16x16x32_bf16 v[16:19], a[192:195], v[64:67], v[16:19]
    v_mfma_f32_16x16x32_bf16 v[20:23], a[196:199], v[64:67], v[20:23]
    v_mfma_f32_16x16x32_bf16 v[24:27], v[224:227], v[64:67], v[24:27]
    s_cmp_lt_u32 s37, 64
    s_cselect_b32 s62, s62, 0
    s_lshl_b32 s46, s56, 18
    s_add_u32 s46, s46, s58
    s_mul_i32 s41, s36, 4718592
    s_mul_i32 s17, s37, 36864
    s_add_u32 s41, s41, s17
    s_add_u32 s41, s41, 8650752
    s_cmp_lg_u32 s62, 0
    s_cselect_b32 s30, 268435456, 0
    buffer_load_dword v9, v10, s[28:31], s46 offen
    s_add_u32 s48, s46, 0
    buffer_load_dwordx4 v[64:67], v0, s[28:31], s48 offen offset:0
    s_waitcnt vmcnt(16)
    v_mfma_f32_16x16x32_bf16 v[28:31], a[192:195], v[68:71], v[28:31]
    v_mfma_f32_16x16x32_bf16 v[32:35], a[196:199], v[68:71], v[32:35]
    v_mfma_f32_16x16x32_bf16 v[36:39], v[224:227], v[68:71], v[36:39]
    buffer_load_dwordx4 v[68:71], v0, s[28:31], s48 offen offset:1024
    s_waitcnt vmcnt(16)
    v_mfma_f32_16x16x32_bf16 v[16:19], a[200:203], v[72:75], v[16:19]
    v_mfma_f32_16x16x32_bf16 v[20:23], a[204:207], v[72:75], v[20:23]
    v_mfma_f32_16x16x32_bf16 v[24:27], v[228:231], v[72:75], v[24:27]
    buffer_load_dwordx4 v[72:75], v0, s[28:31], s48 offen offset:2048
    s_waitcnt vmcnt(16)
    v_mfma_f32_16x16x32_bf16 v[28:31], a[200:203], v[76:79], v[28:31]
    v_mfma_f32_16x16x32_bf16 v[32:35], a[204:207], v[76:79], v[32:35]
    v_mfma_f32_16x16x32_bf16 v[36:39], v[228:231], v[76:79], v[36:39]
    buffer_load_dwordx4 v[76:79], v0, s[28:31], s48 offen offset:3072
    s_waitcnt vmcnt(16)
    v_mfma_f32_16x16x32_bf16 v[16:19], a[208:211], v[80:83], v[16:19]
    v_mfma_f32_16x16x32_bf16 v[20:23], a[212:215], v[80:83], v[20:23]
    v_mfma_f32_16x16x32_bf16 v[24:27], v[232:235], v[80:83], v[24:27]
    s_add_u32 s48, s46, 4096
    buffer_load_dwordx4 v[80:83], v0, s[28:31], s48 offen offset:0
    s_waitcnt vmcnt(16)
    v_mfma_f32_16x16x32_bf16 v[28:31], a[208:211], v[84:87], v[28:31]
    v_mfma_f32_16x16x32_bf16 v[32:35], a[212:215], v[84:87], v[32:35]
    v_mfma_f32_16x16x32_bf16 v[36:39], v[232:235], v[84:87], v[36:39]
    buffer_load_dwordx4 v[84:87], v0, s[28:31], s48 offen offset:1024
    s_waitcnt vmcnt(16)
    v_mfma_f32_16x16x32_bf16 v[16:19], a[216:219], v[88:91], v[16:19]
    v_mfma_f32_16x16x32_bf16 v[20:23], a[220:223], v[88:91], v[20:23]
    v_mfma_f32_16x16x32_bf16 v[24:27], v[236:239], v[88:91], v[24:27]
    buffer_load_dwordx4 v[88:91], v0, s[28:31], s48 offen offset:2048
    s_waitcnt vmcnt(16)
    v_mfma_f32_16x16x32_bf16 v[28:31], a[216:219], v[92:95], v[28:31]
    v_mfma_f32_16x16x32_bf16 v[32:35], a[220:223], v[92:95], v[32:35]
    v_mfma_f32_16x16x32_bf16 v[36:39], v[236:239], v[92:95], v[36:39]
    buffer_load_dwordx4 v[92:95], v0, s[28:31], s48 offen offset:3072
    s_waitcnt vmcnt(16)
    v_mfma_f32_16x16x32_bf16 v[16:19], a[224:227], v[96:99], v[16:19]
    v_mfma_f32_16x16x32_bf16 v[20:23], a[228:231], v[96:99], v[20:23]
    v_mfma_f32_16x16x32_bf16 v[24:27], v[240:243], v[96:99], v[24:27]
    s_add_u32 s48, s46, 8192
    buffer_load_dwordx4 v[96:99], v0, s[28:31], s48 offen offset:0
    s_waitcnt vmcnt(16)
    v_mfma_f32_16x16x32_bf16 v[28:31], a[224:227], v[100:103], v[28:31]
    v_mfma_f32_16x16x32_bf16 v[32:35], a[228:231], v[100:103], v[32:35]
    v_mfma_f32_16x16x32_bf16 v[36:39], v[240:243], v[100:103], v[36:39]
    buffer_load_dwordx4 v[100:103], v0, s[28:31], s48 offen offset:1024
    s_waitcnt vmcnt(16)
    v_mfma_f32_16x16x32_bf16 v[16:19], a[232:235], v[104:107], v[16:19]
    v_mfma_f32_16x16x32_bf16 v[20:23], a[236:239], v[104:107], v[20:23]
    v_mfma_f32_16x16x32_bf16 v[24:27], v[244:247], v[104:107], v[24:27]
    buffer_load_dwordx4 v[104:107], v0, s[28:31], s48 offen offset:2048
    s_waitcnt vmcnt(16)
    v_mfma_f32_16x16x32_bf16 v[28:31], a[232:235], v[108:111], v[28:31]
    v_mfma_f32_16x16x32_bf16 v[32:35], a[236:239], v[108:111], v[32:35]
    v_mfma_f32_16x16x32_bf16 v[36:39], v[244:247], v[108:111], v[36:39]
    buffer_load_dwordx4 v[108:111], v0, s[28:31], s48 offen offset:3072
    s_waitcnt vmcnt(16)
    v_mfma_f32_16x16x32_bf16 v[16:19], a[240:243], v[112:115], v[16:19]
    v_mfma_f32_16x16x32_bf16 v[20:23], a[244:247], v[112:115], v[20:23]
    v_mfma_f32_16x16x32_bf16 v[24:27], v[248:251], v[112:115], v[24:27]
    s_add_u32 s48, s46, 12288
    buffer_load_dwordx4 v[112:115], v0, s[28:31], s48 offen offset:0
    s_waitcnt vmcnt(16)
    v_mfma_f32_16x16x32_bf16 v[28:31], a[240:243], v[116:119], v[28:31]
    v_mfma_f32_16x16x32_bf16 v[32:35], a[244:247], v[116:119], v[32:35]
    v_mfma_f32_16x16x32_bf16 v[36:39], v[248:251], v[116:119], v[36:39]
    buffer_load_dwordx4 v[116:119], v0, s[28:31], s48 offen offset:1024
    s_waitcnt vmcnt(16)
    v_mfma_f32_16x16x32_bf16 v[16:19], a[248:251], v[120:123], v[16:19]
    v_mfma_f32_16x16x32_bf16 v[20:23], a[252:255], v[120:123], v[20:23]
    v_mfma_f32_16x16x32_bf16 v[24:27], v[252:255], v[120:123], v[24:27]
    buffer_load_dwordx4 v[120:123], v0, s[28:31], s48 offen offset:2048
    s_waitcnt vmcnt(16)
    v_mfma_f32_16x16x32_bf16 v[28:31], a[248:251], v[124:127], v[28:31]
    v_mfma_f32_16x16x32_bf16 v[32:35], a[252:255], v[124:127], v[32:35]
    v_mfma_f32_16x16x32_bf16 v[36:39], v[252:255], v[124:127], v[36:39]
    s_nop 5
    ds_write_b128 v48, v[16:19] offset:0
    ds_write_b128 v48, v[20:23] offset:1024
    ds_write_b128 v48, v[24:27] offset:2048
    ds_write_b128 v48, v[28:31] offset:3072
    ds_write_b128 v48, v[32:35] offset:4096
    ds_write_b128 v48, v[36:39] offset:5120
    s_waitcnt lgkmcnt(0)
    s_barrier
    ds_read_b128 v[24:27], v50 offset:2048
    ds_read_b128 v[28:31], v50 offset:8192
    ds_read_b128 v[32:35], v50 offset:14336
    ds_read_b128 v[36:39], v50 offset:20480
    v_xor_b32 v48, 0x8000, v48
    v_xor_b32 v50, 0x8000, v50
    v_lshlrev_b32 v16, 16, v40
    v_and_b32 v17, 0xffff0000, v40
    v_lshlrev_b32 v18, 16, v41
    v_and_b32 v19, 0xffff0000, v41
    buffer_load_dwordx2 v[40:41], v12, s[28:31], s41 offen
    s_waitcnt lgkmcnt(3)
    v_add_f32 v16, v16, v24
    v_add_f32 v17, v17, v25
    v_add_f32 v18, v18, v26
    v_add_f32 v19, v19, v27
    s_waitcnt lgkmcnt(2)
    v_add_f32 v16, v16, v28
    v_add_f32 v17, v17, v29
    v_add_f32 v18, v18, v30
    v_add_f32 v19, v19, v31
    s_waitcnt lgkmcnt(1)
    v_add_f32 v16, v16, v32
    v_add_f32 v17, v17, v33
    v_add_f32 v18, v18, v34
    v_add_f32 v19, v19, v35
    s_waitcnt lgkmcnt(0)
    v_add_f32 v16, v16, v36
    v_add_f32 v17, v17, v37
    v_add_f32 v18, v18, v38
    v_add_f32 v19, v19, v39
    v_cvt_pk_bf16_f32 v52, v16, v17
    v_cvt_pk_bf16_f32 v53, v18, v19
    s_cmp_eq_u32 s34, 0
    s_cbranch_scc1 LtwZ_l0
    s_mul_i32 s17, s35, 36864
    buffer_store_dwordx2 v[52:53], v13, s[24:27], s17 offen sc1
    s_cmp_lg_u32 s62, 0
    s_cbranch_scc1 LtwZ_item
LtwZ_chk:
    s_min_u32 s17, s32, s33
    s_cmp_lt_u32 s17, 64
    s_cbranch_scc1 LtwZ_idle
    s_branch L_role_tw_exit
LtwZ_l0:
    s_add_u32 s47, s47, 2359296
    buffer_store_dwordx2 v[52:53], v12, s[8:11], s47 offen sc1
    v_add_f32 v44, v16, v17
    v_mul_f32 v45, v16, v16
    v_fmac_f32 v45, v17, v17
    v_add_f32 v44, v44, v18
    v_fmac_f32 v45, v18, v18
    v_add_f32 v44, v44, v19
    v_fmac_f32 v45, v19, v19
    v_mov_b32 v46, v44
    v_mov_b32 v47, v45
    s_nop 0
    v_permlane32_swap_b32 v44, v46
    v_permlane32_swap_b32 v45, v47
    v_add_f32 v44, v44, v46
    v_add_f32 v45, v45, v47
    v_mov_b32 v46, v44
    v_mov_b32 v47, v45
    s_nop 0
    v_permlane16_swap_b32 v44, v46
    v_permlane16_swap_b32 v45, v47
    v_add_f32 v44, v44, v46
    v_add_f32 v45, v45, v47
    s_mul_i32 s17, s35, 6144
    s_add_u32 s17, s17, 16515072
    s_mov_b64 exec, 0xffff
    buffer_store_dwordx2 v[44:45], v14, s[8:11], s17 offen sc1
    s_mov_b64 exec, -1
    s_mul_i32 s43, s35, 22528
    s_add_u32 s43, s43, s49
    s_cmp_lg_u32 s62, 0
    s_cbranch_scc1 LtwZ_item
    s_waitcnt vmcnt(0)
    s_mov_b64 exec, 1
    buffer_store_dword v3, v4, s[8:11], s43 offen sc1
    s_mov_b64 exec, -1
    s_mov_b32 s43, 0
    s_branch LtwZ_chk
L_role_tw_abort:
    s_waitcnt lgkmcnt(0)
    s_mov_b64 exec, -1
    v_mov_b32 v0, 60
    s_lshl_b32 s5, s3, 8
    s_or_b32 s5, s5, s4
    s_or_b32 s5, s5, 0x10000
    v_mov_b32 v1, s5
    global_store_dword v0, v1, s[12:13]
    s_endpgm
L_role_tw_exit:
    s_endpgm
.p2align 6
L_role_r:
    s_mov_b32 s32, s3
    s_mov_b32 s15, s4
    v_and_b32 v60, 63, v0
    v_and_b32 v61, 15, v60
    v_lshrrev_b32 v62, 4, v60
    v_lshlrev_b32 v0, 4, v60
    s_mul_i32 s17, s14, 34816
    s_add_u32 s17, s17, 23296
    v_add_u32 v8, s17, v0
    s_mov_b32 s50, 0xfffffffe
    s_mov_b32 s44, 0x3e0293ee
    s_mov_b32 s45, 0x3e0293ee
    s_mov_b32 s52, 0x3f803f80
    s_mov_b32 s53, 0x3f803f80
    s_mov_b32 s40, 1
    s_mov_b32 s46, 0x00ff00ff
    s_cmp_eq_u32 s14, 2
    s_cselect_b32 s46, 0x00030003, s46
    s_mov_b32 s47, s46
    v_bfe_u32 v63, v61, 1, 1
    v_mov_b32 v1, 0x4444
    v_mov_b32 v64, 0xeeee
    v_cmp_eq_u32 vcc, 0, v63
    s_nop 1
    v_cndmask_b32 v1, v64, v1, vcc
    v_mul_u32_u24 v64, 1152, v62
    v_lshl_add_u32 v2, v61, 2, v64
    s_lshl_b32 s17, s14, 6
    s_add_u32 s18, s17, 0
    v_add_u32 v2, s18, v2
    v_mul_u32_u24 v64, 288, v61
    v_lshl_add_u32 v3, v62, 4, v64
    v_add_u32 v3, 0, v3
    v_lshrrev_b32 v64, 2, v61
    v_and_b32 v65, 1, v61
    v_lshl_add_u32 v64, v64, 1, v65
    v_mul_u32_u24 v65, 288, v64
    v_lshl_add_u32 v4, v62, 5, v65
    v_lshl_add_u32 v4, v63, 4, v4
    v_add_u32 v4, 4608, v4
    v_xor_b32 v63, 1, v63
    v_mul_u32_u24 v63, 2304, v63
    v_add_u32 v5, v65, v63
    v_lshl_add_u32 v5, v62, 4, v5
    s_add_u32 s18, s17, 4608
    v_add_u32 v5, s18, v5
    s_lshr_b32 s70, s15, 3
    s_bfe_u32 s71, s15, 0x20001
    s_and_b32 s72, s15, 1
    v_bfe_u32 v64, v61, 2, 1
    v_lshl_add_u32 v63, v64, 2, v62
    v_mul_u32_u24 v63, 9216, v63
    v_lshrrev_b32 v65, 3, v61
    v_lshlrev_b32 v65, 2, v65
    v_and_b32 v64, 3, v61
    v_add_u32 v65, v65, v64
    s_lshl_b32 s73, s71, 4
    s_lshl_b32 s17, s72, 3
    s_add_u32 s73, s73, s17
    v_add_u32 v65, s73, v65
    s_lshl_b32 s17, s70, 6
    v_add_u32 v65, s17, v65
    s_cmp_eq_u32 s14, 2
    s_cselect_b32 s17, 2, 4
    v_lshlrev_b32 v65, s17, v65
    v_add_u32 v6, v63, v65
    s_lshl_b32 s17, s14, 12
    v_add_u32 v6, s17, v6
    v_lshrrev_b32 v66, 1, v61
    s_lshl_b32 s17, s14, 2
    v_add_u32 v66, s17, v66
    v_and_b32 v64, 1, v61
    s_lshl_b32 s17, s70, 4
    s_lshl_b32 s18, s71, 2
    s_add_u32 s17, s17, s18
    s_lshl_b32 s18, s72, 1
    s_add_u32 s17, s17, s18
    v_add_u32 v65, s17, v64
    v_lshl_add_u32 v65, v66, 6, v65
    v_lshlrev_b32 v65, 4, v65
    v_lshl_add_u32 v7, v62, 2, v65
    s_lshl_b32 s17, s71, 1
    v_add_u32 v64, s17, v64
    v_mul_u32_u24 v64, 576, v64
    v_lshl_add_u32 v64, v66, 4, v64
    v_lshl_add_u32 v64, v62, 1, v64
    s_mul_i32 s17, s70, 144
    s_lshl_b32 s18, s72, 3
    s_add_u32 s17, s17, s18
    v_add_u32 v64, s17, v64
    v_lshlrev_b32 v67, 1, v64
    s_mul_i32 s48, s32, 1048576
    s_add_u32 s48, s48, 4194304
    s_mul_i32 s17, s15, 9216
    s_add_u32 s17, s17, s48
    s_lshl_b32 s18, s14, 10
    s_add_u32 s38, s17, s18
    s_lshl_b32 s19, s14, 8
    s_add_u32 s39, s17, s19
    s_add_u32 s39, s39, 8192
    s_add_u32 s37, s48, 983040
    s_xor_b32 s36, s37, 16384
    s_add_u32 s34, s37, s18
    s_add_u32 s35, s37, 8192
    s_mul_i32 s17, s32, 50331648
    s_lshl_b32 s19, s15, 13
    s_add_u32 s17, s17, s19
    s_add_u32 s68, s17, 77594624
    s_lshl_b32 s18, s14, 11
    s_add_u32 s17, s17, s18
    s_add_u32 s41, s17, 60817408
    s_add_u32 s42, s17, 77594624
    s_mul_i32 s17, s32, 8388608
    s_lshl_b32 s19, s15, 12
    s_add_u32 s17, s17, s19
    s_add_u32 s43, s17, 27262976
    s_mul_i32 s17, s32, 1441792
    s_lshl_b32 s19, s15, 9
    s_add_u32 s17, s17, s19
    s_add_u32 s66, s17, 5376
    s_mov_b32 s33, 0
    s_add_u32 s62, s48, 0
    s_add_u32 s63, s48, 73728
    s_add_u32 s64, s48, 147456
    s_add_u32 s65, s48, 221184
    s_load_dwordx2 s[20:21], s[0:1], 32
    s_mov_b32 s22, 9216
    s_mov_b32 s23, 0x00020000
    s_waitcnt lgkmcnt(0)
    s_and_b32 s21, s21, 0xffff
    s_cmp_gt_u32 s14, 2
    s_cbranch_scc1 Lr_mem0_done
    s_mov_b64 exec, s[46:47]
    buffer_load_dword v64, v67, s[20:23], 0 offen
    s_waitcnt vmcnt(0)
    v_min_u32 v64, s50, v64
    buffer_store_dword v64, v7, s[8:11], s37 offen sc1
    v_mov_b32 v64, -1
    buffer_store_dword v64, v7, s[8:11], s36 offen sc1
    s_mov_b64 exec, -1
Lr_mem0_done:
    v_mov_b32 v64, 0
    v_mov_b32 v65, 0
    v_mov_b32 v66, 0
    v_mov_b32 v67, 0
    v_lshrrev_b32 v63, 2, v0
    buffer_store_dwordx4 v[64:67], v0, s[8:11], s38 offen sc1
    s_add_u32 s17, s38, 4096
    buffer_store_dwordx4 v[64:67], v0, s[8:11], s17 offen sc1
    buffer_store_dword v64, v63, s[8:11], s39 offen sc1
    s_waitcnt vmcnt(0)
    s_barrier
    s_cmp_lg_u32 s14, 0
    s_cbranch_scc1 Lr_noadd
    s_lshl_b32 s17, s32, 2
    s_add_u32 s17, s17, 192
    v_mov_b32 v63, s17
    v_mov_b32 v64, 1
    s_mov_b64 exec, 1
    global_atomic_add v63, v64, s[12:13]
    s_mov_b64 exec, -1
Lr_noadd:
    s_cmp_lt_u32 s14, 3
    s_cbranch_scc1 Lr_not_w3
    v_lshlrev_b32 v6, 3, v0
    v_lshrrev_b32 v63, 2, v0
    v_and_b32 v7, 12, v63
    v_and_b32 v63, 16, v63
    v_lshl_add_u32 v7, v63, 3, v7
Lr_not_w3:
    s_cmp_eq_u32 s32, 0
    s_cbranch_scc1 Lr_gate_ng
    s_cmp_lg_u32 s14, 0
    s_cbranch_scc1 Lr_gate_d
    v_mov_b32 v63, 48
    s_mov_b32 s16, 0
Lr_gate:
    global_load_dword v64, v63, s[12:13] sc1
    s_add_u32 s16, s16, 1
    s_cmp_gt_u32 s16, 100000
    s_cbranch_scc1 Lr_abort
    s_waitcnt vmcnt(0)
    v_cmp_gt_u32 vcc, 32, v64
    s_nop 0
    s_cbranch_vccz Lr_gate_d
    s_sleep 100
    s_branch Lr_gate
Lr_gate_d:
    s_barrier
Lr_gate_ng:
    s_load_dwordx2 s[20:21], s[0:1], 40
    s_mov_b32 s22, 4718592
    s_mov_b32 s23, 0x00020000
    s_waitcnt lgkmcnt(0)
    s_and_b32 s21, s21, 0xffff
    s_load_dwordx2 s[24:25], s[0:1], 48
    s_mov_b32 s26, 4718592
    s_mov_b32 s27, 0x00020000
    s_waitcnt lgkmcnt(0)
    s_and_b32 s25, s25, 0xffff
    s_load_dwordx2 s[28:29], s[0:1], 56
    s_mov_b32 s30, 4718592
    s_mov_b32 s31, 0x00020000
    s_waitcnt lgkmcnt(0)
    s_and_b32 s29, s29, 0xffff
    s_load_dwordx2 s[76:77], s[0:1], 64
    s_mov_b32 s78, 4718592
    s_mov_b32 s79, 0x00020000
    s_waitcnt lgkmcnt(0)
    s_and_b32 s77, s77, 0xffff
    v_lshrrev_b32 v60, 4, v0
    v_and_b32 v61, 15, v60
    v_lshrrev_b32 v62, 4, v60
    s_mul_i32 s72, s14, 34816
    s_add_u32 s72, s72, 23296
    s_mul_i32 s70, s14, 1179648
    s_lshl_b32 s17, s15, 8
    s_add_u32 s70, s70, s17
    s_mul_i32 s71, s15, 147456
    s_mul_i32 s17, s14, 288
    s_add_u32 s71, s71, s17
    v_and_b32 v63, 1, v62
    v_lshrrev_b32 v64, 1, v61
    v_xor_b32 v64, v64, v63
    v_lshlrev_b32 v64, 5, v64
    v_and_b32 v65, 1, v61
    v_lshl_add_u32 v64, v65, 4, v64
    v_lshl_add_u32 v12, v62, 13, v64
    v_xor_b32 v13, 128, v12
    v_xor_b32 v14, 64, v12
    v_xor_b32 v15, 192, v12
    v_lshrrev_b32 v63, 2, v60
    v_mul_u32_u24 v63, 1152, v63
    v_and_b32 v64, 3, v60
    v_lshl_add_u32 v16, v64, 4, v63
    v_lshrrev_b32 v63, 1, v60
    v_mul_u32_u24 v63, 1152, v63
    v_and_b32 v64, 1, v60
    v_lshl_add_u32 v17, v64, 4, v63
    v_lshrrev_b32 v40, 2, v61
    v_and_b32 v41, 3, v61
    v_and_b32 v63, 1, v62
    v_lshl_add_u32 v42, v63, 2, v40
    v_and_b32 v64, 1, v40
    v_lshl_add_u32 v64, v63, 2, v64
    v_lshrrev_b32 v65, 1, v40
    v_lshl_add_u32 v64, v65, 3, v64
    v_lshlrev_b32 v64, 8, v64
    v_lshl_add_u32 v64, v41, 3, v64
    v_lshrrev_b32 v65, 1, v62
    v_mul_u32_u24 v65, 34816, v65
    v_add_u32 v64, v64, v65
    v_add_u32 v64, 23296, v64
    s_lshl_b32 s17, s14, 1
    s_add_u32 s18, s17, 0
    v_xor_b32 v65, s18, v42
    v_lshl_add_u32 v18, v65, 5, v64
    v_add_u32 v19, 69632, v18
    s_add_u32 s18, s17, 1
    v_xor_b32 v65, s18, v42
    v_lshl_add_u32 v20, v65, 5, v64
    v_add_u32 v21, 69632, v20
    v_lshrrev_b32 v63, 1, v62
    v_lshlrev_b32 v63, 3, v63
    v_and_b32 v64, 1, v62
    v_lshl_add_u32 v63, v64, 1, v63
    v_and_b32 v64, 1, v40
    v_lshl_add_u32 v63, v64, 4, v63
    v_lshrrev_b32 v64, 1, v40
    v_lshl_add_u32 v63, v64, 2, v63
    v_lshlrev_b32 v64, 3, v41
    v_lshl_add_u32 v22, v63, 6, v64
    v_add_u32 v22, s72, v22
    v_lshl_add_u32 v23, v63, 5, v64
    v_add_u32 v23, s72, v23
    s_add_u32 m0, s72, 0
    s_add_u32 s17, s70, 0
    buffer_load_dwordx4 v12, s[20:23], s17 offen lds
    s_add_u32 m0, m0, 1024
    s_add_u32 s17, s70, 32768
    buffer_load_dwordx4 v13, s[20:23], s17 offen lds
    s_add_u32 m0, m0, 1024
    s_add_u32 s17, s70, 65536
    buffer_load_dwordx4 v14, s[20:23], s17 offen lds
    s_add_u32 m0, m0, 1024
    s_add_u32 s17, s70, 98304
    buffer_load_dwordx4 v15, s[20:23], s17 offen lds
    s_add_u32 m0, s72, 4096
    s_add_u32 s17, s70, 0
    buffer_load_dwordx4 v12, s[24:27], s17 offen lds
    s_add_u32 m0, m0, 1024
    s_add_u32 s17, s70, 32768
    buffer_load_dwordx4 v13, s[24:27], s17 offen lds
    s_add_u32 m0, m0, 1024
    s_add_u32 s17, s70, 65536
    buffer_load_dwordx4 v14, s[24:27], s17 offen lds
    s_add_u32 m0, m0, 1024
    s_add_u32 s17, s70, 98304
    buffer_load_dwordx4 v15, s[24:27], s17 offen lds
    s_add_u32 m0, s72, 8192
    s_add_u32 s17, s70, 131072
    buffer_load_dwordx4 v12, s[20:23], s17 offen lds
    s_add_u32 m0, m0, 1024
    s_add_u32 s17, s70, 163840
    buffer_load_dwordx4 v13, s[20:23], s17 offen lds
    s_add_u32 m0, m0, 1024
    s_add_u32 s17, s70, 196608
    buffer_load_dwordx4 v14, s[20:23], s17 offen lds
    s_add_u32 m0, m0, 1024
    s_add_u32 s17, s70, 229376
    buffer_load_dwordx4 v15, s[20:23], s17 offen lds
    s_add_u32 m0, s72, 12288
    s_add_u32 s17, s70, 131072
    buffer_load_dwordx4 v12, s[24:27], s17 offen lds
    s_add_u32 m0, m0, 1024
    s_add_u32 s17, s70, 163840
    buffer_load_dwordx4 v13, s[24:27], s17 offen lds
    s_add_u32 m0, m0, 1024
    s_add_u32 s17, s70, 196608
    buffer_load_dwordx4 v14, s[24:27], s17 offen lds
    s_add_u32 m0, m0, 1024
    s_add_u32 s17, s70, 229376
    buffer_load_dwordx4 v15, s[24:27], s17 offen lds
    s_add_u32 m0, s72, 16384
    s_add_u32 s17, s70, 131072
    buffer_load_dwordx4 v12, s[28:31], s17 offen lds
    s_add_u32 m0, m0, 1024
    s_add_u32 s17, s70, 163840
    buffer_load_dwordx4 v13, s[28:31], s17 offen lds
    s_add_u32 m0, m0, 1024
    s_add_u32 s17, s70, 196608
    buffer_load_dwordx4 v14, s[28:31], s17 offen lds
    s_add_u32 m0, m0, 1024
    s_add_u32 s17, s70, 229376
    buffer_load_dwordx4 v15, s[28:31], s17 offen lds
    s_add_u32 m0, s72, 20480
    s_add_u32 s17, s70, 262144
    buffer_load_dwordx4 v12, s[20:23], s17 offen lds
    s_add_u32 m0, m0, 1024
    s_add_u32 s17, s70, 294912
    buffer_load_dwordx4 v13, s[20:23], s17 offen lds
    s_add_u32 m0, m0, 1024
    s_add_u32 s17, s70, 327680
    buffer_load_dwordx4 v14, s[20:23], s17 offen lds
    s_add_u32 m0, m0, 1024
    s_add_u32 s17, s70, 360448
    buffer_load_dwordx4 v15, s[20:23], s17 offen lds
    s_add_u32 m0, s72, 24576
    s_add_u32 s17, s70, 262144
    buffer_load_dwordx4 v12, s[24:27], s17 offen lds
    s_add_u32 m0, m0, 1024
    s_add_u32 s17, s70, 294912
    buffer_load_dwordx4 v13, s[24:27], s17 offen lds
    s_add_u32 m0, m0, 1024
    s_add_u32 s17, s70, 327680
    buffer_load_dwordx4 v14, s[24:27], s17 offen lds
    s_add_u32 m0, m0, 1024
    s_add_u32 s17, s70, 360448
    buffer_load_dwordx4 v15, s[24:27], s17 offen lds
    s_add_u32 m0, s72, 28672
    s_add_u32 s17, s70, 393216
    buffer_load_dwordx4 v12, s[20:23], s17 offen lds
    s_add_u32 m0, m0, 1024
    s_add_u32 s17, s70, 425984
    buffer_load_dwordx4 v13, s[20:23], s17 offen lds
    s_add_u32 m0, m0, 1024
    s_add_u32 s17, s70, 458752
    buffer_load_dwordx4 v14, s[20:23], s17 offen lds
    s_add_u32 m0, m0, 1024
    s_add_u32 s17, s70, 491520
    buffer_load_dwordx4 v15, s[20:23], s17 offen lds
    s_add_u32 m0, s72, 32768
    s_add_u32 s17, s71, 256
    buffer_load_dwordx4 v17, s[76:79], s17 offen lds
    s_add_u32 m0, m0, 1024
    s_add_u32 s17, s71, 37120
    buffer_load_dwordx4 v17, s[76:79], s17 offen lds
    s_waitcnt vmcnt(30)
    s_barrier
    ds_read_b64_tr_b16 v[72:73], v18 offset:0
    ds_read_b64_tr_b16 v[74:75], v18 offset:512
    ds_read_b64_tr_b16 v[76:77], v19 offset:0
    ds_read_b64_tr_b16 v[78:79], v19 offset:512
    ds_read_b64_tr_b16 v[80:81], v20 offset:0
    ds_read_b64_tr_b16 v[82:83], v20 offset:512
    ds_read_b64_tr_b16 v[84:85], v21 offset:0
    ds_read_b64_tr_b16 v[86:87], v21 offset:512
    s_waitcnt lgkmcnt(0)
    s_waitcnt vmcnt(26)
    s_barrier
    s_add_u32 m0, s72, 0
    s_add_u32 s17, s70, 393216
    buffer_load_dwordx4 v12, s[24:27], s17 offen lds
    s_add_u32 m0, m0, 1024
    s_add_u32 s17, s70, 425984
    buffer_load_dwordx4 v13, s[24:27], s17 offen lds
    s_add_u32 m0, m0, 1024
    s_add_u32 s17, s70, 458752
    buffer_load_dwordx4 v14, s[24:27], s17 offen lds
    s_add_u32 m0, m0, 1024
    s_add_u32 s17, s70, 491520
    buffer_load_dwordx4 v15, s[24:27], s17 offen lds
    ds_read_b64_tr_b16 v[184:185], v18 offset:4096
    ds_read_b64_tr_b16 v[186:187], v18 offset:4608
    ds_read_b64_tr_b16 v[188:189], v19 offset:4096
    ds_read_b64_tr_b16 v[190:191], v19 offset:4608
    ds_read_b64_tr_b16 v[192:193], v20 offset:4096
    ds_read_b64_tr_b16 v[194:195], v20 offset:4608
    ds_read_b64_tr_b16 v[196:197], v21 offset:4096
    ds_read_b64_tr_b16 v[198:199], v21 offset:4608
    s_waitcnt lgkmcnt(0)
    s_waitcnt vmcnt(26)
    s_barrier
    s_add_u32 m0, s72, 4096
    s_add_u32 s17, s70, 393216
    buffer_load_dwordx4 v12, s[28:31], s17 offen lds
    s_add_u32 m0, m0, 1024
    s_add_u32 s17, s70, 425984
    buffer_load_dwordx4 v13, s[28:31], s17 offen lds
    s_add_u32 m0, m0, 1024
    s_add_u32 s17, s70, 458752
    buffer_load_dwordx4 v14, s[28:31], s17 offen lds
    s_add_u32 m0, m0, 1024
    s_add_u32 s17, s70, 491520
    buffer_load_dwordx4 v15, s[28:31], s17 offen lds
    ds_read_b64_tr_b16 v[88:89], v18 offset:8192
    ds_read_b64_tr_b16 v[90:91], v18 offset:8704
    ds_read_b64_tr_b16 v[92:93], v19 offset:8192
    ds_read_b64_tr_b16 v[94:95], v19 offset:8704
    ds_read_b64_tr_b16 v[96:97], v20 offset:8192
    ds_read_b64_tr_b16 v[98:99], v20 offset:8704
    ds_read_b64_tr_b16 v[100:101], v21 offset:8192
    ds_read_b64_tr_b16 v[102:103], v21 offset:8704
    s_waitcnt lgkmcnt(0)
    s_waitcnt vmcnt(26)
    s_barrier
    s_add_u32 m0, s72, 8192
    s_add_u32 s17, s70, 524288
    buffer_load_dwordx4 v12, s[24:27], s17 offen lds
    s_add_u32 m0, m0, 1024
    s_add_u32 s17, s70, 557056
    buffer_load_dwordx4 v13, s[24:27], s17 offen lds
    s_add_u32 m0, m0, 1024
    s_add_u32 s17, s70, 589824
    buffer_load_dwordx4 v14, s[24:27], s17 offen lds
    s_add_u32 m0, m0, 1024
    s_add_u32 s17, s70, 622592
    buffer_load_dwordx4 v15, s[24:27], s17 offen lds
    ds_read_b64_tr_b16 v[200:201], v18 offset:12288
    ds_read_b64_tr_b16 v[202:203], v18 offset:12800
    ds_read_b64_tr_b16 v[204:205], v19 offset:12288
    ds_read_b64_tr_b16 v[206:207], v19 offset:12800
    ds_read_b64_tr_b16 v[208:209], v20 offset:12288
    ds_read_b64_tr_b16 v[210:211], v20 offset:12800
    ds_read_b64_tr_b16 v[212:213], v21 offset:12288
    ds_read_b64_tr_b16 v[214:215], v21 offset:12800
    s_waitcnt lgkmcnt(0)
    s_waitcnt vmcnt(26)
    s_barrier
    s_add_u32 m0, s72, 12288
    s_add_u32 s17, s70, 524288
    buffer_load_dwordx4 v12, s[28:31], s17 offen lds
    s_add_u32 m0, m0, 1024
    s_add_u32 s17, s70, 557056
    buffer_load_dwordx4 v13, s[28:31], s17 offen lds
    s_add_u32 m0, m0, 1024
    s_add_u32 s17, s70, 589824
    buffer_load_dwordx4 v14, s[28:31], s17 offen lds
    s_add_u32 m0, m0, 1024
    s_add_u32 s17, s70, 622592
    buffer_load_dwordx4 v15, s[28:31], s17 offen lds
    ds_read_b64_tr_b16 a[72:73], v18 offset:16384
    ds_read_b64_tr_b16 a[74:75], v18 offset:16896
    ds_read_b64_tr_b16 a[76:77], v19 offset:16384
    ds_read_b64_tr_b16 a[78:79], v19 offset:16896
    ds_read_b64_tr_b16 a[80:81], v20 offset:16384
    ds_read_b64_tr_b16 a[82:83], v20 offset:16896
    ds_read_b64_tr_b16 a[84:85], v21 offset:16384
    ds_read_b64_tr_b16 a[86:87], v21 offset:16896
    s_waitcnt lgkmcnt(0)
    s_waitcnt vmcnt(26)
    s_barrier
    s_add_u32 m0, s72, 16384
    s_add_u32 s17, s70, 655360
    buffer_load_dwordx4 v12, s[20:23], s17 offen lds
    s_add_u32 m0, m0, 1024
    s_add_u32 s17, s70, 688128
    buffer_load_dwordx4 v13, s[20:23], s17 offen lds
    s_add_u32 m0, m0, 1024
    s_add_u32 s17, s70, 720896
    buffer_load_dwordx4 v14, s[20:23], s17 offen lds
    s_add_u32 m0, m0, 1024
    s_add_u32 s17, s70, 753664
    buffer_load_dwordx4 v15, s[20:23], s17 offen lds
    ds_read_b64_tr_b16 v[104:105], v18 offset:20480
    ds_read_b64_tr_b16 v[106:107], v18 offset:20992
    ds_read_b64_tr_b16 v[108:109], v19 offset:20480
    ds_read_b64_tr_b16 v[110:111], v19 offset:20992
    ds_read_b64_tr_b16 v[112:113], v20 offset:20480
    ds_read_b64_tr_b16 v[114:115], v20 offset:20992
    ds_read_b64_tr_b16 v[116:117], v21 offset:20480
    ds_read_b64_tr_b16 v[118:119], v21 offset:20992
    s_waitcnt lgkmcnt(0)
    s_waitcnt vmcnt(26)
    s_barrier
    s_add_u32 m0, s72, 20480
    s_add_u32 s17, s70, 655360
    buffer_load_dwordx4 v12, s[24:27], s17 offen lds
    s_add_u32 m0, m0, 1024
    s_add_u32 s17, s70, 688128
    buffer_load_dwordx4 v13, s[24:27], s17 offen lds
    s_add_u32 m0, m0, 1024
    s_add_u32 s17, s70, 720896
    buffer_load_dwordx4 v14, s[24:27], s17 offen lds
    s_add_u32 m0, m0, 1024
    s_add_u32 s17, s70, 753664
    buffer_load_dwordx4 v15, s[24:27], s17 offen lds
    ds_read_b64_tr_b16 v[216:217], v18 offset:24576
    ds_read_b64_tr_b16 v[218:219], v18 offset:25088
    ds_read_b64_tr_b16 v[220:221], v19 offset:24576
    ds_read_b64_tr_b16 v[222:223], v19 offset:25088
    ds_read_b64_tr_b16 v[224:225], v20 offset:24576
    ds_read_b64_tr_b16 v[226:227], v20 offset:25088
    ds_read_b64_tr_b16 v[228:229], v21 offset:24576
    ds_read_b64_tr_b16 v[230:231], v21 offset:25088
    s_waitcnt lgkmcnt(0)
    s_waitcnt vmcnt(26)
    s_barrier
    s_add_u32 m0, s72, 24576
    s_add_u32 s17, s70, 655360
    buffer_load_dwordx4 v12, s[28:31], s17 offen lds
    s_add_u32 m0, m0, 1024
    s_add_u32 s17, s70, 688128
    buffer_load_dwordx4 v13, s[28:31], s17 offen lds
    s_add_u32 m0, m0, 1024
    s_add_u32 s17, s70, 720896
    buffer_load_dwordx4 v14, s[28:31], s17 offen lds
    s_add_u32 m0, m0, 1024
    s_add_u32 s17, s70, 753664
    buffer_load_dwordx4 v15, s[28:31], s17 offen lds
    ds_read_b64_tr_b16 v[120:121], v18 offset:28672
    ds_read_b64_tr_b16 v[122:123], v18 offset:29184
    ds_read_b64_tr_b16 v[124:125], v19 offset:28672
    ds_read_b64_tr_b16 v[126:127], v19 offset:29184
    ds_read_b64_tr_b16 v[128:129], v20 offset:28672
    ds_read_b64_tr_b16 v[130:131], v20 offset:29184
    ds_read_b64_tr_b16 v[132:133], v21 offset:28672
    ds_read_b64_tr_b16 v[134:135], v21 offset:29184
    s_waitcnt lgkmcnt(0)
    s_waitcnt vmcnt(24)
    s_barrier
    s_add_u32 m0, s72, 28672
    s_add_u32 s17, s70, 786432
    buffer_load_dwordx4 v12, s[24:27], s17 offen lds
    s_add_u32 m0, m0, 1024
    s_add_u32 s17, s70, 819200
    buffer_load_dwordx4 v13, s[24:27], s17 offen lds
    s_add_u32 m0, m0, 1024
    s_add_u32 s17, s70, 851968
    buffer_load_dwordx4 v14, s[24:27], s17 offen lds
    s_add_u32 m0, m0, 1024
    s_add_u32 s17, s70, 884736
    buffer_load_dwordx4 v15, s[24:27], s17 offen lds
    ds_read_b64_tr_b16 v[232:233], v18 offset:0
    ds_read_b64_tr_b16 v[234:235], v18 offset:512
    ds_read_b64_tr_b16 v[236:237], v19 offset:0
    ds_read_b64_tr_b16 v[238:239], v19 offset:512
    ds_read_b64_tr_b16 v[240:241], v20 offset:0
    ds_read_b64_tr_b16 v[242:243], v20 offset:512
    ds_read_b64_tr_b16 v[244:245], v21 offset:0
    ds_read_b64_tr_b16 v[246:247], v21 offset:512
    s_waitcnt lgkmcnt(0)
    s_waitcnt vmcnt(24)
    s_barrier
    s_add_u32 m0, s72, 0
    s_add_u32 s17, s70, 786432
    buffer_load_dwordx4 v12, s[28:31], s17 offen lds
    s_add_u32 m0, m0, 1024
    s_add_u32 s17, s70, 819200
    buffer_load_dwordx4 v13, s[28:31], s17 offen lds
    s_add_u32 m0, m0, 1024
    s_add_u32 s17, s70, 851968
    buffer_load_dwordx4 v14, s[28:31], s17 offen lds
    s_add_u32 m0, m0, 1024
    s_add_u32 s17, s70, 884736
    buffer_load_dwordx4 v15, s[28:31], s17 offen lds
    ds_read_b64_tr_b16 a[88:89], v18 offset:4096
    ds_read_b64_tr_b16 a[90:91], v18 offset:4608
    ds_read_b64_tr_b16 a[92:93], v19 offset:4096
    ds_read_b64_tr_b16 a[94:95], v19 offset:4608
    ds_read_b64_tr_b16 a[96:97], v20 offset:4096
    ds_read_b64_tr_b16 a[98:99], v20 offset:4608
    ds_read_b64_tr_b16 a[100:101], v21 offset:4096
    ds_read_b64_tr_b16 a[102:103], v21 offset:4608
    s_waitcnt lgkmcnt(0)
    s_waitcnt vmcnt(24)
    s_barrier
    s_add_u32 m0, s72, 4096
    s_add_u32 s17, s70, 917504
    buffer_load_dwordx4 v12, s[20:23], s17 offen lds
    s_add_u32 m0, m0, 1024
    s_add_u32 s17, s70, 950272
    buffer_load_dwordx4 v13, s[20:23], s17 offen lds
    s_add_u32 m0, m0, 1024
    s_add_u32 s17, s70, 983040
    buffer_load_dwordx4 v14, s[20:23], s17 offen lds
    s_add_u32 m0, m0, 1024
    s_add_u32 s17, s70, 1015808
    buffer_load_dwordx4 v15, s[20:23], s17 offen lds
    ds_read_b64_tr_b16 v[248:249], v18 offset:8192
    ds_read_b64_tr_b16 v[250:251], v18 offset:8704
    ds_read_b64_tr_b16 v[252:253], v19 offset:8192
    ds_read_b64_tr_b16 v[254:255], v19 offset:8704
    ds_read_b64_tr_b16 a[0:1], v20 offset:8192
    ds_read_b64_tr_b16 a[2:3], v20 offset:8704
    ds_read_b64_tr_b16 a[4:5], v21 offset:8192
    ds_read_b64_tr_b16 a[6:7], v21 offset:8704
    s_waitcnt lgkmcnt(0)
    s_waitcnt vmcnt(24)
    s_barrier
    s_add_u32 m0, s72, 8192
    s_add_u32 s17, s70, 917504
    buffer_load_dwordx4 v12, s[24:27], s17 offen lds
    s_add_u32 m0, m0, 1024
    s_add_u32 s17, s70, 950272
    buffer_load_dwordx4 v13, s[24:27], s17 offen lds
    s_add_u32 m0, m0, 1024
    s_add_u32 s17, s70, 983040
    buffer_load_dwordx4 v14, s[24:27], s17 offen lds
    s_add_u32 m0, m0, 1024
    s_add_u32 s17, s70, 1015808
    buffer_load_dwordx4 v15, s[24:27], s17 offen lds
    ds_read_b64_tr_b16 a[104:105], v18 offset:12288
    ds_read_b64_tr_b16 a[106:107], v18 offset:12800
    ds_read_b64_tr_b16 a[108:109], v19 offset:12288
    ds_read_b64_tr_b16 a[110:111], v19 offset:12800
    ds_read_b64_tr_b16 a[112:113], v20 offset:12288
    ds_read_b64_tr_b16 a[114:115], v20 offset:12800
    ds_read_b64_tr_b16 a[116:117], v21 offset:12288
    ds_read_b64_tr_b16 a[118:119], v21 offset:12800
    s_waitcnt lgkmcnt(0)
    s_waitcnt vmcnt(24)
    s_barrier
    s_add_u32 m0, s72, 12288
    s_add_u32 s17, s70, 917504
    buffer_load_dwordx4 v12, s[28:31], s17 offen lds
    s_add_u32 m0, m0, 1024
    s_add_u32 s17, s70, 950272
    buffer_load_dwordx4 v13, s[28:31], s17 offen lds
    s_add_u32 m0, m0, 1024
    s_add_u32 s17, s70, 983040
    buffer_load_dwordx4 v14, s[28:31], s17 offen lds
    s_add_u32 m0, m0, 1024
    s_add_u32 s17, s70, 1015808
    buffer_load_dwordx4 v15, s[28:31], s17 offen lds
    ds_read_b64_tr_b16 v[136:137], v18 offset:16384
    ds_read_b64_tr_b16 v[138:139], v18 offset:16896
    ds_read_b64_tr_b16 v[140:141], v19 offset:16384
    ds_read_b64_tr_b16 v[142:143], v19 offset:16896
    ds_read_b64_tr_b16 v[144:145], v20 offset:16384
    ds_read_b64_tr_b16 v[146:147], v20 offset:16896
    ds_read_b64_tr_b16 v[148:149], v21 offset:16384
    ds_read_b64_tr_b16 v[150:151], v21 offset:16896
    s_waitcnt lgkmcnt(0)
    s_add_u32 s17, s32, s14
    s_cmp_lg_u32 s17, 0
    s_cbranch_scc1 Lr_nold
    v_mov_b32 v63, 48
    v_mov_b32 v64, 1
    s_mov_b64 exec, 1
    global_atomic_add v63, v64, s[12:13]
    s_mov_b64 exec, -1
Lr_nold:
    s_waitcnt vmcnt(24)
    s_barrier
    s_add_u32 m0, s72, 16384
    s_add_u32 s17, s70, 1048576
    buffer_load_dwordx4 v12, s[20:23], s17 offen lds
    s_add_u32 m0, m0, 1024
    s_add_u32 s17, s70, 1081344
    buffer_load_dwordx4 v13, s[20:23], s17 offen lds
    s_add_u32 m0, m0, 1024
    s_add_u32 s17, s70, 1114112
    buffer_load_dwordx4 v14, s[20:23], s17 offen lds
    s_add_u32 m0, m0, 1024
    s_add_u32 s17, s70, 1146880
    buffer_load_dwordx4 v15, s[20:23], s17 offen lds
    ds_read_b64_tr_b16 a[8:9], v18 offset:20480
    ds_read_b64_tr_b16 a[10:11], v18 offset:20992
    ds_read_b64_tr_b16 a[12:13], v19 offset:20480
    ds_read_b64_tr_b16 a[14:15], v19 offset:20992
    ds_read_b64_tr_b16 a[16:17], v20 offset:20480
    ds_read_b64_tr_b16 a[18:19], v20 offset:20992
    ds_read_b64_tr_b16 a[20:21], v21 offset:20480
    ds_read_b64_tr_b16 a[22:23], v21 offset:20992
    s_waitcnt lgkmcnt(0)
    s_waitcnt vmcnt(24)
    s_barrier
    s_add_u32 m0, s72, 20480
    s_add_u32 s17, s70, 1048576
    buffer_load_dwordx4 v12, s[24:27], s17 offen lds
    s_add_u32 m0, m0, 1024
    s_add_u32 s17, s70, 1081344
    buffer_load_dwordx4 v13, s[24:27], s17 offen lds
    s_add_u32 m0, m0, 1024
    s_add_u32 s17, s70, 1114112
    buffer_load_dwordx4 v14, s[24:27], s17 offen lds
    s_add_u32 m0, m0, 1024
    s_add_u32 s17, s70, 1146880
    buffer_load_dwordx4 v15, s[24:27], s17 offen lds
    ds_read_b64_tr_b16 a[120:121], v18 offset:24576
    ds_read_b64_tr_b16 a[122:123], v18 offset:25088
    ds_read_b64_tr_b16 a[124:125], v19 offset:24576
    ds_read_b64_tr_b16 a[126:127], v19 offset:25088
    ds_read_b64_tr_b16 a[128:129], v20 offset:24576
    ds_read_b64_tr_b16 a[130:131], v20 offset:25088
    ds_read_b64_tr_b16 a[132:133], v21 offset:24576
    ds_read_b64_tr_b16 a[134:135], v21 offset:25088
    s_waitcnt lgkmcnt(0)
    s_waitcnt vmcnt(24)
    s_barrier
    s_add_u32 m0, s72, 24576
    s_add_u32 s17, s70, 1048576
    buffer_load_dwordx4 v12, s[28:31], s17 offen lds
    s_add_u32 m0, m0, 1024
    s_add_u32 s17, s70, 1081344
    buffer_load_dwordx4 v13, s[28:31], s17 offen lds
    s_add_u32 m0, m0, 1024
    s_add_u32 s17, s70, 1114112
    buffer_load_dwordx4 v14, s[28:31], s17 offen lds
    s_add_u32 m0, m0, 1024
    s_add_u32 s17, s70, 1146880
    buffer_load_dwordx4 v15, s[28:31], s17 offen lds
    ds_read_b64_tr_b16 a[24:25], v18 offset:28672
    ds_read_b64_tr_b16 a[26:27], v18 offset:29184
    ds_read_b64_tr_b16 a[28:29], v19 offset:28672
    ds_read_b64_tr_b16 a[30:31], v19 offset:29184
    ds_read_b64_tr_b16 a[32:33], v20 offset:28672
    ds_read_b64_tr_b16 a[34:35], v20 offset:29184
    ds_read_b64_tr_b16 a[36:37], v21 offset:28672
    ds_read_b64_tr_b16 a[38:39], v21 offset:29184
    s_waitcnt lgkmcnt(0)
    s_waitcnt vmcnt(24)
    s_barrier
    ds_read_b64_tr_b16 a[136:137], v18 offset:0
    ds_read_b64_tr_b16 a[138:139], v18 offset:512
    ds_read_b64_tr_b16 a[140:141], v19 offset:0
    ds_read_b64_tr_b16 a[142:143], v19 offset:512
    ds_read_b64_tr_b16 a[144:145], v20 offset:0
    ds_read_b64_tr_b16 a[146:147], v20 offset:512
    ds_read_b64_tr_b16 a[148:149], v21 offset:0
    ds_read_b64_tr_b16 a[150:151], v21 offset:512
    s_waitcnt lgkmcnt(0)
    s_waitcnt vmcnt(20)
    s_barrier
    s_add_u32 m0, s72, 0
    s_add_u32 s17, s70, 0
    buffer_load_dwordx4 v12, s[28:31], s17 offen lds
    s_add_u32 m0, m0, 1024
    s_add_u32 s17, s70, 32768
    buffer_load_dwordx4 v13, s[28:31], s17 offen lds
    s_add_u32 m0, m0, 1024
    s_add_u32 s17, s70, 65536
    buffer_load_dwordx4 v14, s[28:31], s17 offen lds
    s_add_u32 m0, m0, 1024
    s_add_u32 s17, s70, 98304
    buffer_load_dwordx4 v15, s[28:31], s17 offen lds
    ds_read_b64_tr_b16 v[152:153], v18 offset:4096
    ds_read_b64_tr_b16 v[154:155], v18 offset:4608
    ds_read_b64_tr_b16 v[156:157], v19 offset:4096
    ds_read_b64_tr_b16 v[158:159], v19 offset:4608
    ds_read_b64_tr_b16 v[160:161], v20 offset:4096
    ds_read_b64_tr_b16 v[162:163], v20 offset:4608
    ds_read_b64_tr_b16 v[164:165], v21 offset:4096
    ds_read_b64_tr_b16 v[166:167], v21 offset:4608
    s_waitcnt lgkmcnt(0)
    s_waitcnt vmcnt(20)
    s_barrier
    s_add_u32 m0, s72, 4096
    s_add_u32 s17, s70, 262144
    buffer_load_dwordx4 v12, s[28:31], s17 offen lds
    s_add_u32 m0, m0, 1024
    s_add_u32 s17, s70, 294912
    buffer_load_dwordx4 v13, s[28:31], s17 offen lds
    s_add_u32 m0, m0, 1024
    s_add_u32 s17, s70, 327680
    buffer_load_dwordx4 v14, s[28:31], s17 offen lds
    s_add_u32 m0, m0, 1024
    s_add_u32 s17, s70, 360448
    buffer_load_dwordx4 v15, s[28:31], s17 offen lds
    ds_read_b64_tr_b16 a[40:41], v18 offset:8192
    ds_read_b64_tr_b16 a[42:43], v18 offset:8704
    ds_read_b64_tr_b16 a[44:45], v19 offset:8192
    ds_read_b64_tr_b16 a[46:47], v19 offset:8704
    ds_read_b64_tr_b16 a[48:49], v20 offset:8192
    ds_read_b64_tr_b16 a[50:51], v20 offset:8704
    ds_read_b64_tr_b16 a[52:53], v21 offset:8192
    ds_read_b64_tr_b16 a[54:55], v21 offset:8704
    s_waitcnt lgkmcnt(0)
    s_waitcnt vmcnt(20)
    s_barrier
    s_add_u32 m0, s72, 8192
    s_add_u32 s17, s70, 524288
    buffer_load_dwordx4 v12, s[20:23], s17 offen lds
    s_add_u32 m0, m0, 1024
    s_add_u32 s17, s70, 557056
    buffer_load_dwordx4 v13, s[20:23], s17 offen lds
    s_add_u32 m0, m0, 1024
    s_add_u32 s17, s70, 589824
    buffer_load_dwordx4 v14, s[20:23], s17 offen lds
    s_add_u32 m0, m0, 1024
    s_add_u32 s17, s70, 622592
    buffer_load_dwordx4 v15, s[20:23], s17 offen lds
    ds_read_b64_tr_b16 a[152:153], v18 offset:12288
    ds_read_b64_tr_b16 a[154:155], v18 offset:12800
    ds_read_b64_tr_b16 a[156:157], v19 offset:12288
    ds_read_b64_tr_b16 a[158:159], v19 offset:12800
    ds_read_b64_tr_b16 a[160:161], v20 offset:12288
    ds_read_b64_tr_b16 a[162:163], v20 offset:12800
    ds_read_b64_tr_b16 a[164:165], v21 offset:12288
    ds_read_b64_tr_b16 a[166:167], v21 offset:12800
    s_waitcnt lgkmcnt(0)
    s_waitcnt vmcnt(20)
    s_barrier
    s_add_u32 m0, s72, 12288
    s_add_u32 s17, s70, 786432
    buffer_load_dwordx4 v12, s[20:23], s17 offen lds
    s_add_u32 m0, m0, 1024
    s_add_u32 s17, s70, 819200
    buffer_load_dwordx4 v13, s[20:23], s17 offen lds
    s_add_u32 m0, m0, 1024
    s_add_u32 s17, s70, 851968
    buffer_load_dwordx4 v14, s[20:23], s17 offen lds
    s_add_u32 m0, m0, 1024
    s_add_u32 s17, s70, 884736
    buffer_load_dwordx4 v15, s[20:23], s17 offen lds
    ds_read_b64_tr_b16 v[168:169], v18 offset:16384
    ds_read_b64_tr_b16 v[170:171], v18 offset:16896
    ds_read_b64_tr_b16 v[172:173], v19 offset:16384
    ds_read_b64_tr_b16 v[174:175], v19 offset:16896
    ds_read_b64_tr_b16 v[176:177], v20 offset:16384
    ds_read_b64_tr_b16 v[178:179], v20 offset:16896
    ds_read_b64_tr_b16 v[180:181], v21 offset:16384
    ds_read_b64_tr_b16 v[182:183], v21 offset:16896
    s_waitcnt lgkmcnt(0)
    s_waitcnt vmcnt(20)
    s_barrier
    s_add_u32 m0, s72, 16384
    s_add_u32 s17, s71, 0
    buffer_load_dwordx4 v16, s[76:79], s17 offen lds
    s_add_u32 m0, m0, 1024
    s_add_u32 s17, s71, 18432
    buffer_load_dwordx4 v16, s[76:79], s17 offen lds
    s_add_u32 m0, m0, 1024
    s_add_u32 s17, s71, 36864
    buffer_load_dwordx4 v16, s[76:79], s17 offen lds
    s_add_u32 m0, m0, 1024
    s_add_u32 s17, s71, 55296
    buffer_load_dwordx4 v16, s[76:79], s17 offen lds
    ds_read_b64_tr_b16 a[56:57], v18 offset:20480
    ds_read_b64_tr_b16 a[58:59], v18 offset:20992
    ds_read_b64_tr_b16 a[60:61], v19 offset:20480
    ds_read_b64_tr_b16 a[62:63], v19 offset:20992
    ds_read_b64_tr_b16 a[64:65], v20 offset:20480
    ds_read_b64_tr_b16 a[66:67], v20 offset:20992
    ds_read_b64_tr_b16 a[68:69], v21 offset:20480
    ds_read_b64_tr_b16 a[70:71], v21 offset:20992
    s_waitcnt lgkmcnt(0)
    s_waitcnt vmcnt(20)
    s_barrier
    s_add_u32 m0, s72, 20480
    s_add_u32 s17, s71, 73728
    buffer_load_dwordx4 v16, s[76:79], s17 offen lds
    s_add_u32 m0, m0, 1024
    s_add_u32 s17, s71, 92160
    buffer_load_dwordx4 v16, s[76:79], s17 offen lds
    s_add_u32 m0, m0, 1024
    s_add_u32 s17, s71, 110592
    buffer_load_dwordx4 v16, s[76:79], s17 offen lds
    s_add_u32 m0, m0, 1024
    s_add_u32 s17, s71, 129024
    buffer_load_dwordx4 v16, s[76:79], s17 offen lds
    ds_read_b64_tr_b16 a[168:169], v18 offset:24576
    ds_read_b64_tr_b16 a[170:171], v18 offset:25088
    ds_read_b64_tr_b16 a[172:173], v19 offset:24576
    ds_read_b64_tr_b16 a[174:175], v19 offset:25088
    ds_read_b64_tr_b16 a[176:177], v20 offset:24576
    ds_read_b64_tr_b16 a[178:179], v20 offset:25088
    ds_read_b64_tr_b16 a[180:181], v21 offset:24576
    ds_read_b64_tr_b16 a[182:183], v21 offset:25088
    s_waitcnt lgkmcnt(0)
    s_waitcnt vmcnt(20)
    s_barrier
    s_add_u32 m0, s72, 24576
    s_add_u32 s17, s71, 64
    buffer_load_dwordx4 v16, s[76:79], s17 offen lds
    s_add_u32 m0, m0, 1024
    s_add_u32 s17, s71, 18496
    buffer_load_dwordx4 v16, s[76:79], s17 offen lds
    s_add_u32 m0, m0, 1024
    s_add_u32 s17, s71, 36928
    buffer_load_dwordx4 v16, s[76:79], s17 offen lds
    s_add_u32 m0, m0, 1024
    s_add_u32 s17, s71, 55360
    buffer_load_dwordx4 v16, s[76:79], s17 offen lds
    s_add_u32 m0, s72, 28672
    s_add_u32 s17, s71, 73792
    buffer_load_dwordx4 v16, s[76:79], s17 offen lds
    s_add_u32 m0, m0, 1024
    s_add_u32 s17, s71, 92224
    buffer_load_dwordx4 v16, s[76:79], s17 offen lds
    s_add_u32 m0, m0, 1024
    s_add_u32 s17, s71, 110656
    buffer_load_dwordx4 v16, s[76:79], s17 offen lds
    s_add_u32 m0, m0, 1024
    s_add_u32 s17, s71, 129088
    buffer_load_dwordx4 v16, s[76:79], s17 offen lds
    ds_read_b64_tr_b16 v[24:25], v18 offset:0
    ds_read_b64_tr_b16 v[26:27], v18 offset:512
    ds_read_b64_tr_b16 v[28:29], v19 offset:0
    ds_read_b64_tr_b16 v[30:31], v19 offset:512
    ds_read_b64_tr_b16 v[32:33], v20 offset:0
    ds_read_b64_tr_b16 v[34:35], v20 offset:512
    ds_read_b64_tr_b16 v[36:37], v21 offset:0
    ds_read_b64_tr_b16 v[38:39], v21 offset:512
    s_waitcnt lgkmcnt(0)
    s_barrier
    ds_write_b128 v8, v[24:27] offset:0
    ds_write_b128 v8, v[28:31] offset:1024
    ds_write_b128 v8, v[32:35] offset:2048
    ds_write_b128 v8, v[36:39] offset:3072
    s_waitcnt lgkmcnt(0)
    s_waitcnt vmcnt(24)
    s_barrier
    ds_read_b64_tr_b16 v[24:25], v18 offset:4096
    ds_read_b64_tr_b16 v[26:27], v18 offset:4608
    ds_read_b64_tr_b16 v[28:29], v19 offset:4096
    ds_read_b64_tr_b16 v[30:31], v19 offset:4608
    ds_read_b64_tr_b16 v[32:33], v20 offset:4096
    ds_read_b64_tr_b16 v[34:35], v20 offset:4608
    ds_read_b64_tr_b16 v[36:37], v21 offset:4096
    ds_read_b64_tr_b16 v[38:39], v21 offset:4608
    s_waitcnt lgkmcnt(0)
    s_barrier
    ds_write_b128 v8, v[24:27] offset:4096
    ds_write_b128 v8, v[28:31] offset:5120
    ds_write_b128 v8, v[32:35] offset:6144
    ds_write_b128 v8, v[36:39] offset:7168
    s_waitcnt lgkmcnt(0)
    s_waitcnt vmcnt(20)
    s_barrier
    ds_read_b64_tr_b16 v[24:25], v18 offset:8192
    ds_read_b64_tr_b16 v[26:27], v18 offset:8704
    ds_read_b64_tr_b16 v[28:29], v19 offset:8192
    ds_read_b64_tr_b16 v[30:31], v19 offset:8704
    ds_read_b64_tr_b16 v[32:33], v20 offset:8192
    ds_read_b64_tr_b16 v[34:35], v20 offset:8704
    ds_read_b64_tr_b16 v[36:37], v21 offset:8192
    ds_read_b64_tr_b16 v[38:39], v21 offset:8704
    s_waitcnt lgkmcnt(0)
    s_barrier
    ds_write_b128 v8, v[24:27] offset:8192
    ds_write_b128 v8, v[28:31] offset:9216
    ds_write_b128 v8, v[32:35] offset:10240
    ds_write_b128 v8, v[36:39] offset:11264
    s_waitcnt lgkmcnt(0)
    s_waitcnt vmcnt(16)
    s_barrier
    ds_read_b64_tr_b16 v[24:25], v18 offset:12288
    ds_read_b64_tr_b16 v[26:27], v18 offset:12800
    ds_read_b64_tr_b16 v[28:29], v19 offset:12288
    ds_read_b64_tr_b16 v[30:31], v19 offset:12800
    ds_read_b64_tr_b16 v[32:33], v20 offset:12288
    ds_read_b64_tr_b16 v[34:35], v20 offset:12800
    ds_read_b64_tr_b16 v[36:37], v21 offset:12288
    ds_read_b64_tr_b16 v[38:39], v21 offset:12800
    s_waitcnt lgkmcnt(0)
    s_barrier
    ds_write_b128 v8, v[24:27] offset:12288
    ds_write_b128 v8, v[28:31] offset:13312
    ds_write_b128 v8, v[32:35] offset:14336
    ds_write_b128 v8, v[36:39] offset:15360
    s_waitcnt lgkmcnt(0)
    s_barrier
    s_waitcnt vmcnt(12)
    ds_read_b64_tr_b16 a[184:185], v22 offset:16384
    ds_read_b64_tr_b16 a[186:187], v22 offset:16448
    ds_read_b64_tr_b16 a[188:189], v22 offset:18432
    ds_read_b64_tr_b16 a[190:191], v22 offset:18496
    ds_read_b64_tr_b16 a[200:201], v22 offset:16416
    ds_read_b64_tr_b16 a[202:203], v22 offset:16480
    ds_read_b64_tr_b16 a[204:205], v22 offset:18464
    ds_read_b64_tr_b16 a[206:207], v22 offset:18528
    s_waitcnt lgkmcnt(0)
    s_add_u32 m0, s72, 16384
    s_add_u32 s17, s71, 128
    buffer_load_dwordx4 v16, s[76:79], s17 offen lds
    s_add_u32 m0, m0, 1024
    s_add_u32 s17, s71, 18560
    buffer_load_dwordx4 v16, s[76:79], s17 offen lds
    s_add_u32 m0, m0, 1024
    s_add_u32 s17, s71, 36992
    buffer_load_dwordx4 v16, s[76:79], s17 offen lds
    s_add_u32 m0, m0, 1024
    s_add_u32 s17, s71, 55424
    buffer_load_dwordx4 v16, s[76:79], s17 offen lds
    s_waitcnt vmcnt(12)
    ds_read_b64_tr_b16 a[192:193], v22 offset:20480
    ds_read_b64_tr_b16 a[194:195], v22 offset:20544
    ds_read_b64_tr_b16 a[196:197], v22 offset:22528
    ds_read_b64_tr_b16 a[198:199], v22 offset:22592
    ds_read_b64_tr_b16 a[208:209], v22 offset:20512
    ds_read_b64_tr_b16 a[210:211], v22 offset:20576
    ds_read_b64_tr_b16 a[212:213], v22 offset:22560
    ds_read_b64_tr_b16 a[214:215], v22 offset:22624
    s_waitcnt lgkmcnt(0)
    s_add_u32 m0, s72, 20480
    s_add_u32 s17, s71, 73856
    buffer_load_dwordx4 v16, s[76:79], s17 offen lds
    s_add_u32 m0, m0, 1024
    s_add_u32 s17, s71, 92288
    buffer_load_dwordx4 v16, s[76:79], s17 offen lds
    s_add_u32 m0, m0, 1024
    s_add_u32 s17, s71, 110720
    buffer_load_dwordx4 v16, s[76:79], s17 offen lds
    s_add_u32 m0, m0, 1024
    s_add_u32 s17, s71, 129152
    buffer_load_dwordx4 v16, s[76:79], s17 offen lds
    s_waitcnt vmcnt(12)
    ds_read_b64_tr_b16 a[216:217], v22 offset:24576
    ds_read_b64_tr_b16 a[218:219], v22 offset:24640
    ds_read_b64_tr_b16 a[220:221], v22 offset:26624
    ds_read_b64_tr_b16 a[222:223], v22 offset:26688
    ds_read_b64_tr_b16 a[232:233], v22 offset:24608
    ds_read_b64_tr_b16 a[234:235], v22 offset:24672
    ds_read_b64_tr_b16 a[236:237], v22 offset:26656
    ds_read_b64_tr_b16 a[238:239], v22 offset:26720
    s_waitcnt lgkmcnt(0)
    s_add_u32 m0, s72, 24576
    s_add_u32 s17, s71, 192
    buffer_load_dwordx4 v16, s[76:79], s17 offen lds
    s_add_u32 m0, m0, 1024
    s_add_u32 s17, s71, 18624
    buffer_load_dwordx4 v16, s[76:79], s17 offen lds
    s_add_u32 m0, m0, 1024
    s_add_u32 s17, s71, 37056
    buffer_load_dwordx4 v16, s[76:79], s17 offen lds
    s_add_u32 m0, m0, 1024
    s_add_u32 s17, s71, 55488
    buffer_load_dwordx4 v16, s[76:79], s17 offen lds
    s_waitcnt vmcnt(12)
    ds_read_b64_tr_b16 a[224:225], v22 offset:28672
    ds_read_b64_tr_b16 a[226:227], v22 offset:28736
    ds_read_b64_tr_b16 a[228:229], v22 offset:30720
    ds_read_b64_tr_b16 a[230:231], v22 offset:30784
    ds_read_b64_tr_b16 a[240:241], v22 offset:28704
    ds_read_b64_tr_b16 a[242:243], v22 offset:28768
    ds_read_b64_tr_b16 a[244:245], v22 offset:30752
    ds_read_b64_tr_b16 a[246:247], v22 offset:30816
    s_waitcnt lgkmcnt(0)
    s_add_u32 m0, s72, 28672
    s_add_u32 s17, s71, 73920
    buffer_load_dwordx4 v16, s[76:79], s17 offen lds
    s_add_u32 m0, m0, 1024
    s_add_u32 s17, s71, 92352
    buffer_load_dwordx4 v16, s[76:79], s17 offen lds
    s_add_u32 m0, m0, 1024
    s_add_u32 s17, s71, 110784
    buffer_load_dwordx4 v16, s[76:79], s17 offen lds
    s_add_u32 m0, m0, 1024
    s_add_u32 s17, s71, 129216
    buffer_load_dwordx4 v16, s[76:79], s17 offen lds
    s_waitcnt vmcnt(63)
    ds_read_b64_tr_b16 a[248:249], v23 offset:32768
    ds_read_b64_tr_b16 a[250:251], v23 offset:32800
    ds_read_b64_tr_b16 a[252:253], v23 offset:33792
    ds_read_b64_tr_b16 a[254:255], v23 offset:33824
    s_waitcnt lgkmcnt(0)
    s_add_u32 m0, s72, 32768
    s_add_u32 s17, s71, 73984
    buffer_load_dwordx4 v17, s[76:79], s17 offen lds
    s_add_u32 m0, m0, 1024
    s_add_u32 s17, s71, 110848
    buffer_load_dwordx4 v17, s[76:79], s17 offen lds
    s_waitcnt vmcnt(14)
    ds_read_b64_tr_b16 v[24:25], v22 offset:16384
    ds_read_b64_tr_b16 v[26:27], v22 offset:16448
    ds_read_b64_tr_b16 v[28:29], v22 offset:18432
    ds_read_b64_tr_b16 v[30:31], v22 offset:18496
    ds_read_b64_tr_b16 v[32:33], v22 offset:16416
    ds_read_b64_tr_b16 v[34:35], v22 offset:16480
    ds_read_b64_tr_b16 v[36:37], v22 offset:18464
    ds_read_b64_tr_b16 v[38:39], v22 offset:18528
    s_waitcnt lgkmcnt(0)
    ds_write_b128 v8, v[24:27] offset:16384
    ds_write_b128 v8, v[28:31] offset:17408
    ds_write_b128 v8, v[32:35] offset:18432
    ds_write_b128 v8, v[36:39] offset:19456
    s_waitcnt lgkmcnt(0)
    s_waitcnt vmcnt(10)
    ds_read_b64_tr_b16 v[24:25], v22 offset:20480
    ds_read_b64_tr_b16 v[26:27], v22 offset:20544
    ds_read_b64_tr_b16 v[28:29], v22 offset:22528
    ds_read_b64_tr_b16 v[30:31], v22 offset:22592
    ds_read_b64_tr_b16 v[32:33], v22 offset:20512
    ds_read_b64_tr_b16 v[34:35], v22 offset:20576
    ds_read_b64_tr_b16 v[36:37], v22 offset:22560
    ds_read_b64_tr_b16 v[38:39], v22 offset:22624
    s_waitcnt lgkmcnt(0)
    ds_write_b128 v8, v[24:27] offset:20480
    ds_write_b128 v8, v[28:31] offset:21504
    ds_write_b128 v8, v[32:35] offset:22528
    ds_write_b128 v8, v[36:39] offset:23552
    s_waitcnt lgkmcnt(0)
    s_waitcnt vmcnt(6)
    ds_read_b64_tr_b16 v[24:25], v22 offset:24576
    ds_read_b64_tr_b16 v[26:27], v22 offset:24640
    ds_read_b64_tr_b16 v[28:29], v22 offset:26624
    ds_read_b64_tr_b16 v[30:31], v22 offset:26688
    ds_read_b64_tr_b16 v[32:33], v22 offset:24608
    ds_read_b64_tr_b16 v[34:35], v22 offset:24672
    ds_read_b64_tr_b16 v[36:37], v22 offset:26656
    ds_read_b64_tr_b16 v[38:39], v22 offset:26720
    s_waitcnt lgkmcnt(0)
    ds_write_b128 v8, v[24:27] offset:24576
    ds_write_b128 v8, v[28:31] offset:25600
    ds_write_b128 v8, v[32:35] offset:26624
    ds_write_b128 v8, v[36:39] offset:27648
    s_waitcnt lgkmcnt(0)
    s_waitcnt vmcnt(2)
    ds_read_b64_tr_b16 v[24:25], v22 offset:28672
    ds_read_b64_tr_b16 v[26:27], v22 offset:28736
    ds_read_b64_tr_b16 v[28:29], v22 offset:30720
    ds_read_b64_tr_b16 v[30:31], v22 offset:30784
    ds_read_b64_tr_b16 v[32:33], v22 offset:28704
    ds_read_b64_tr_b16 v[34:35], v22 offset:28768
    ds_read_b64_tr_b16 v[36:37], v22 offset:30752
    ds_read_b64_tr_b16 v[38:39], v22 offset:30816
    s_waitcnt lgkmcnt(0)
    ds_write_b128 v8, v[24:27] offset:28672
    ds_write_b128 v8, v[28:31] offset:29696
    ds_write_b128 v8, v[32:35] offset:30720
    ds_write_b128 v8, v[36:39] offset:31744
    s_waitcnt lgkmcnt(0)
    s_waitcnt vmcnt(0)
    ds_read_b64_tr_b16 v[24:25], v23 offset:32768
    ds_read_b64_tr_b16 v[26:27], v23 offset:32800
    ds_read_b64_tr_b16 v[28:29], v23 offset:33792
    ds_read_b64_tr_b16 v[30:31], v23 offset:33824
    s_waitcnt lgkmcnt(0)
    ds_write_b128 v8, v[24:27] offset:32768
    ds_write_b128 v8, v[28:31] offset:33792
    s_waitcnt lgkmcnt(0)
    v_bfe_u32 v9, v0, 4, 4
    v_mov_b32 v10, 0x3f80
    v_mov_b32 v16, 0x3f800000
    v_cmp_eq_u32 vcc, 0, v9
    v_cmp_eq_u32 s[48:49], 1, v9
    s_nop 0
    v_cndmask_b32 v12, 0, v10, vcc
    v_cndmask_b32 v12, v12, v16, s[48:49]
    v_cmp_eq_u32 vcc, 2, v9
    v_cmp_eq_u32 s[48:49], 3, v9
    s_nop 0
    v_cndmask_b32 v13, 0, v10, vcc
    v_cndmask_b32 v13, v13, v16, s[48:49]
    v_cmp_eq_u32 vcc, 4, v9
    v_cmp_eq_u32 s[48:49], 5, v9
    s_nop 0
    v_cndmask_b32 v14, 0, v10, vcc
    v_cndmask_b32 v14, v14, v16, s[48:49]
    v_cmp_eq_u32 vcc, 6, v9
    v_cmp_eq_u32 s[48:49], 7, v9
    s_nop 0
    v_cndmask_b32 v15, 0, v10, vcc
    v_cndmask_b32 v15, v15, v16, s[48:49]
    v_add_u32 v9, 162560, v0
    ds_write_b128 v9, v[12:15]
    s_waitcnt lgkmcnt(0)
    s_mov_b64 exec, 0xff
    v_lshrrev_b32 v14, 2, v0
    v_lshlrev_b32 v12, 5, v14
    v_and_b32 v12, 128, v12
    v_lshrrev_b32 v13, 1, v14
    v_and_or_b32 v12, v13, 12, v12
    s_mov_b32 s16, 0
L_pure:
    global_load_dword v13, v12, s[12:13] sc1
    s_add_u32 s16, s16, 1
    s_cmp_gt_u32 s16, 100000
    s_cbranch_scc1 Lr_abort
    s_mov_b32 s6, 0
    s_waitcnt vmcnt(0)
    v_readlane_b32 s7, v13, 0
    s_nop 0
    s_add_u32 s6, s6, s7
    v_readlane_b32 s7, v13, 1
    s_nop 0
    s_add_u32 s6, s6, s7
    v_readlane_b32 s7, v13, 2
    s_nop 0
    s_add_u32 s6, s6, s7
    v_readlane_b32 s7, v13, 3
    s_nop 0
    s_add_u32 s6, s6, s7
    v_readlane_b32 s7, v13, 4
    s_nop 0
    s_add_u32 s6, s6, s7
    v_readlane_b32 s7, v13, 5
    s_nop 0
    s_add_u32 s6, s6, s7
    v_readlane_b32 s7, v13, 6
    s_nop 0
    s_add_u32 s6, s6, s7
    v_readlane_b32 s7, v13, 7
    s_nop 0
    s_add_u32 s6, s6, s7
    v_readlane_b32 s7, v13, s32
    s_nop 0
    s_cmp_ge_u32 s7, 32
    s_cselect_b32 s51, 1, 0
    s_cselect_b32 s6, 256, s6
    s_cmp_lt_u32 s6, 256
    s_cbranch_scc1 L_pure
    s_mov_b64 exec, -1
    s_lshl_b32 s6, s32, 2
    s_add_u32 s6, s6, 192
    s_cmp_lg_u32 s14, 0
    s_cbranch_scc1 L_team_d
    v_mov_b32 v12, s6
    s_mov_b32 s16, 0
L_team:
    global_load_dword v13, v12, s[12:13] sc1
    s_add_u32 s16, s16, 1
    s_cmp_gt_u32 s16, 100000
    s_cbranch_scc1 Lr_abort
    s_waitcnt vmcnt(0)
    v_cmp_gt_u32 vcc, 32, v13
    s_nop 0
    s_cbranch_vccz L_team_d
    s_sleep 8
    s_branch L_team
L_team_d:
    s_barrier
    s_cmp_lg_u32 s14, 0
    s_cbranch_scc1 L_rpoola_d
    v_mov_b32 v12, 40
    s_mov_b32 s16, 0
L_rpoola:
    global_load_dword v13, v12, s[12:13] sc1
    s_add_u32 s16, s16, 1
    s_cmp_gt_u32 s16, 100000
    s_cbranch_scc1 Lr_abort
    s_waitcnt vmcnt(0)
    v_cmp_gt_u32 vcc, 128, v13
    s_nop 0
    s_cbranch_vccz L_rpoola_d
    s_sleep 8
    s_branch L_rpoola
L_rpoola_d:
    s_barrier
    s_cmp_eq_u32 s32, 0
    s_cbranch_scc1 L_rpool_skip
    s_cmp_lg_u32 s14, 0
    s_cbranch_scc1 L_rpool_d
    v_mov_b32 v12, 160
    s_mov_b32 s16, 0
L_rpool:
    global_load_dword v13, v12, s[12:13] sc1
    s_add_u32 s16, s16, 1
    s_cmp_gt_u32 s16, 100000
    s_cbranch_scc1 Lr_abort
    s_waitcnt vmcnt(0)
    v_cmp_gt_u32 vcc, 64, v13
    s_nop 0
    s_cbranch_vccz L_rpool_d
    s_sleep 8
    s_branch L_rpool
L_rpool_d:
    s_barrier
L_rpool_skip:
    s_barrier
    s_cmp_eq_u32 s51, 0
    s_cbranch_scc1 L_slow
    s_cmp_lg_u32 s14, 0
    s_cbranch_scc1 L_w1_1
    s_mov_b32 s16, 0
    s_add_u32 s17, s66, 128
    v_lshrrev_b32 v10, 2, v0
    v_and_b32 v9, 16, v10
    v_lshlrev_b32 v9, 3, v9
    v_and_or_b32 v10, v10, 12, v9
Lr0f_fw_10:
    buffer_load_dword v9, v10, s[8:11], s17 offen sc1
    s_add_u32 s16, s16, 1
    s_cmp_gt_u32 s16, 100000
    s_cbranch_scc1 Lr_abort
    s_waitcnt vmcnt(0)
    v_cmp_eq_u32 vcc, 0, v9
    s_nop 0
    s_cbranch_vccnz Lr0f_fw_10
    s_mov_b32 m0, 15104
    s_nop 0
    buffer_load_dwordx4 v0, s[8:11], s41 offen offset:0 lds
    buffer_load_dwordx4 v0, s[8:11], s41 offen offset:1024 lds
    s_add_u32 s41, s41, 262144
    s_add_u32 s68, s68, 4278452224
    s_waitcnt vmcnt(0)
    ds_read_b128 v[56:59], v8 offset:0
    ds_read_b128 v[60:63], v8 offset:1024
    ds_read_b128 v[64:67], v8 offset:2048
    ds_read_b128 v[68:71], v8 offset:3072
    v_mov_b64 v[12:13], 0
    v_mov_b64 v[14:15], 0
    v_mov_b64 v[16:17], 0
    v_mov_b64 v[18:19], 0
    v_mov_b64 v[20:21], 0
    v_mov_b64 v[22:23], 0
    v_mov_b64 v[24:25], 0
    v_mov_b64 v[26:27], 0
    v_mov_b64 v[28:29], 0
    v_mov_b64 v[30:31], 0
    v_mov_b64 v[32:33], 0
    v_mov_b64 v[34:35], 0
    buffer_load_dwordx4 v[36:39], v0, s[8:11], s34 offen sc1
    s_waitcnt vmcnt(0) lgkmcnt(0)
Lr0f_step:
    s_mov_b32 s16, 0
Lr0f_alp:
    s_waitcnt vmcnt(2)
    v_max3_u32 v10, v36, v37, v38
    v_max_u32 v10, v10, v39
    v_cmp_eq_u32 vcc, -1, v10
    s_nop 0
    s_cbranch_vccz Lr0f_aok
    buffer_load_dwordx4 v[36:39], v0, s[8:11], s34 offen sc1
    s_add_u32 s16, s16, 1
    s_cmp_gt_u32 s16, 100000
    s_cbranch_scc1 Lr_abort
    s_branch Lr0f_alp
Lr0f_aok:
    ds_write_b128 v0, v[36:39] offset:6912
    v_smfmac_f32_16x16x64_bf16 v[12:15], v[36:39], v[72:79], v1
    v_smfmac_f32_16x16x64_bf16 v[16:19], v[36:39], v[80:87], v1
    v_smfmac_f32_16x16x64_bf16 v[20:23], v[36:39], v[184:191], v1
    s_waitcnt lgkmcnt(0)
    s_barrier
    ds_read_b128 v[48:51], v0 offset:7936
    ds_read_b128 v[52:55], v0 offset:8960
    v_smfmac_f32_16x16x64_bf16 v[28:31], v[36:39], v[56:63], v1
    ds_read_b128 v[56:59], v8 offset:4096
    ds_read_b128 v[60:63], v8 offset:5120
    s_add_u32 s17, s34, 4096
    buffer_load_dwordx4 v[40:43], v0, s[8:11], s17 offen sc1
    v_smfmac_f32_16x16x64_bf16 v[24:27], v[36:39], v[192:199], v1
    v_smfmac_f32_16x16x64_bf16 v[32:35], v[36:39], v[64:71], v1
    ds_read_b128 v[64:67], v8 offset:6144
    ds_read_b128 v[68:71], v8 offset:7168
    s_waitcnt vmcnt(1)
    ds_read_b128 v[36:39], v0 offset:9984
    s_waitcnt lgkmcnt(6)
    v_smfmac_f32_16x16x64_bf16 v[28:31], v[48:51], a[72:79], v1
    v_smfmac_f32_16x16x64_bf16 v[12:15], v[48:51], v[88:95], v1
    buffer_load_dwordx4 v[44:47], v0, s[8:11], s35 offen sc1
    v_smfmac_f32_16x16x64_bf16 v[16:19], v[48:51], v[96:103], v1
    v_smfmac_f32_16x16x64_bf16 v[32:35], v[48:51], a[80:87], v1
    v_smfmac_f32_16x16x64_bf16 v[20:23], v[48:51], v[200:207], v1
    v_smfmac_f32_16x16x64_bf16 v[24:27], v[48:51], v[208:215], v1
    s_waitcnt lgkmcnt(3)
    v_smfmac_f32_16x16x64_bf16 v[28:31], v[52:55], v[56:63], v1
    ds_read_b128 v[56:59], v8 offset:8192
    ds_read_b128 v[60:63], v8 offset:9216
    v_smfmac_f32_16x16x64_bf16 v[12:15], v[52:55], v[104:111], v1
    v_smfmac_f32_16x16x64_bf16 v[16:19], v[52:55], v[112:119], v1
    s_waitcnt lgkmcnt(3)
    v_smfmac_f32_16x16x64_bf16 v[32:35], v[52:55], v[64:71], v1
    ds_read_b128 v[64:67], v8 offset:10240
    ds_read_b128 v[68:71], v8 offset:11264
    v_smfmac_f32_16x16x64_bf16 v[20:23], v[52:55], v[216:223], v1
    v_smfmac_f32_16x16x64_bf16 v[24:27], v[52:55], v[224:231], v1
    s_waitcnt lgkmcnt(4)
    v_smfmac_f32_16x16x64_bf16 v[28:31], v[36:39], a[88:95], v1
    v_smfmac_f32_16x16x64_bf16 v[12:15], v[36:39], v[120:127], v1
    v_smfmac_f32_16x16x64_bf16 v[16:19], v[36:39], v[128:135], v1
    v_smfmac_f32_16x16x64_bf16 v[32:35], v[36:39], a[96:103], v1
    v_smfmac_f32_16x16x64_bf16 v[20:23], v[36:39], v[232:239], v1
    v_smfmac_f32_16x16x64_bf16 v[24:27], v[36:39], v[240:247], v1
    s_waitcnt vmcnt(1)
    v_max3_u32 v10, v40, v41, v42
    v_max_u32 v10, v10, v43
    v_cmp_eq_u32 vcc, -1, v10
    s_nop 0
    s_cbranch_vccnz Lr0f_pb_re
Lr0f_pb_ok:
    ds_write_b128 v0, v[40:43] offset:11008
    s_waitcnt lgkmcnt(3)
    v_smfmac_f32_16x16x64_bf16 v[12:15], v[40:43], v[56:63], v1
    ds_read_b128 v[56:59], v8 offset:12288
    ds_read_b128 v[60:63], v8 offset:13312
    v_smfmac_f32_16x16x64_bf16 v[20:23], v[40:43], v[248:255], v1
    s_waitcnt lgkmcnt(3)
    v_smfmac_f32_16x16x64_bf16 v[16:19], v[40:43], v[64:71], v1
    ds_read_b128 v[64:67], v8 offset:14336
    ds_read_b128 v[68:71], v8 offset:15360
    v_smfmac_f32_16x16x64_bf16 v[24:27], v[40:43], a[0:7], v1
    s_waitcnt lgkmcnt(4)
    s_barrier
    ds_read_b128 v[48:51], v0 offset:13056
    ds_read_b128 v[52:55], v0 offset:12032
    ds_read_b128 v[36:39], v0 offset:14080
    v_smfmac_f32_16x16x64_bf16 v[28:31], v[40:43], a[104:111], v1
    v_smfmac_f32_16x16x64_bf16 v[32:35], v[40:43], a[112:119], v1
    s_waitcnt lgkmcnt(2)
    v_smfmac_f32_16x16x64_bf16 v[12:15], v[48:51], v[56:63], v1
    v_smfmac_f32_16x16x64_bf16 v[16:19], v[48:51], v[64:71], v1
    s_waitcnt lgkmcnt(1)
    v_smfmac_f32_16x16x64_bf16 v[12:15], v[52:55], v[136:143], v1
    v_smfmac_f32_16x16x64_bf16 v[16:19], v[52:55], v[144:151], v1
    s_waitcnt lgkmcnt(0)
    v_smfmac_f32_16x16x64_bf16 v[12:15], v[36:39], v[152:159], v1
    v_smfmac_f32_16x16x64_bf16 v[16:19], v[36:39], v[160:167], v1
    s_waitcnt vmcnt(0)
    v_max3_u32 v10, v44, v45, v46
    v_max_u32 v10, v10, v47
    v_cmp_eq_u32 vcc, -1, v10
    s_nop 0
    s_cbranch_vccnz Lr0f_pc_re
Lr0f_pc_ok:
    v_smfmac_f32_16x16x64_bf16 v[12:15], v[44:47], v[168:175], v1
    v_smfmac_f32_16x16x64_bf16 v[16:19], v[44:47], v[176:183], v1
    v_smfmac_f32_16x16x64_bf16 v[20:23], v[48:51], a[24:31], v1
    buffer_load_dwordx4 v[64:67], v0, s[8:11], s42 offen
    v_smfmac_f32_16x16x64_bf16 v[24:27], v[48:51], a[32:39], v1
    v_smfmac_f32_16x16x64_bf16 v[20:23], v[52:55], a[8:15], v1
    v_add_f32 v12, v12, v14
    v_smfmac_f32_16x16x64_bf16 v[24:27], v[52:55], a[16:23], v1
    v_add_f32 v16, v16, v18
    v_smfmac_f32_16x16x64_bf16 v[20:23], v[36:39], a[40:47], v1
    v_add_f32 v13, v13, v15
    buffer_load_dwordx4 v[68:71], v0, s[8:11], s42 offen offset:1024
    v_smfmac_f32_16x16x64_bf16 v[24:27], v[36:39], a[48:55], v1
    v_add_f32 v17, v17, v19
    v_smfmac_f32_16x16x64_bf16 v[20:23], v[44:47], a[56:63], v1
    v_cvt_pk_bf16_f32 v14, v12, v16
    ds_read_b128 v[56:59], v0 offset:15104
    v_smfmac_f32_16x16x64_bf16 v[24:27], v[44:47], a[64:71], v1
    v_cvt_pk_bf16_f32 v15, v13, v17
    ds_read_b128 v[60:63], v0 offset:16128
    ds_write_b32 v2, v14 offset:576
    ds_write_b32 v2, v15 offset:864
    v_smfmac_f32_16x16x64_bf16 v[28:31], v[48:51], a[136:143], v1
    v_smfmac_f32_16x16x64_bf16 v[32:35], v[48:51], a[144:151], v1
    v_add_f32 v20, v20, v22
    v_add_f32 v24, v24, v26
    v_add_f32 v21, v21, v23
    v_add_f32 v25, v25, v27
    v_cvt_pk_bf16_f32 v22, v20, v24
    v_cvt_pk_bf16_f32 v23, v21, v25
    ds_write_b32 v2, v22 offset:0
    ds_write_b32 v2, v23 offset:288
    v_smfmac_f32_16x16x64_bf16 v[28:31], v[52:55], a[120:127], v1
    v_smfmac_f32_16x16x64_bf16 v[32:35], v[52:55], a[128:135], v1
    s_waitcnt lgkmcnt(0)
    s_barrier
    ds_read_b128 v[40:43], v3 offset:0
    ds_read_b128 v[48:51], v3 offset:64
    ds_read_b128 v[20:23], v3 offset:128
    ds_read_b128 v[52:55], v3 offset:192
    v_smfmac_f32_16x16x64_bf16 v[28:31], v[36:39], a[152:159], v1
    v_smfmac_f32_16x16x64_bf16 v[32:35], v[36:39], a[160:167], v1
    ds_read_b128 v[36:39], v0 offset:17152
    v_lshlrev_b32 v9, 3, v0
    buffer_load_dword v11, v9, s[8:11], s68 offen
    v_smfmac_f32_16x16x64_bf16 v[28:31], v[44:47], a[168:175], v1
    v_smfmac_f32_16x16x64_bf16 v[32:35], v[44:47], a[176:183], v1
    ds_read_b128 v[44:47], v0 offset:18176
    s_waitcnt lgkmcnt(5)
    v_mfma_f32_16x16x32_bf16 v[12:15], v[56:59], v[40:43], 0
    v_mfma_f32_16x16x32_bf16 v[16:19], v[60:63], v[40:43], 0
    v_mfma_f32_16x16x32_bf16 v[24:27], v[40:43], v[40:43], 0
    ds_read_b128 v[56:59], v0 offset:19200
    ds_read_b128 v[60:63], v0 offset:20224
    s_waitcnt lgkmcnt(3)
    v_mfma_f32_16x16x32_bf16 v[12:15], v[36:39], v[48:51], v[12:15]
    v_lshrrev_b32 v10, 1, v0
    v_lshrrev_b32 v9, 9, v0
    s_waitcnt lgkmcnt(2)
    v_mfma_f32_16x16x32_bf16 v[16:19], v[44:47], v[48:51], v[16:19]
    v_lshl_add_u32 v9, v9, 5, v10
    v_add_f32 v28, v28, v30
    v_mfma_f32_16x16x32_bf16 v[24:27], v[48:51], v[48:51], v[24:27]
    v_add_f32 v32, v32, v34
    v_add_f32 v29, v29, v31
    ds_read_b128 v[36:39], v0 offset:21248
    ds_read_b128 v[44:47], v0 offset:22272
    s_waitcnt lgkmcnt(3)
    v_mfma_f32_16x16x32_bf16 v[12:15], v[56:59], v[20:23], v[12:15]
    v_add_f32 v33, v33, v35
    v_cvt_pk_bf16_f32 v30, v28, v29
    s_waitcnt lgkmcnt(2)
    v_mfma_f32_16x16x32_bf16 v[16:19], v[60:63], v[20:23], v[16:19]
    v_cvt_pk_bf16_f32 v31, v32, v33
    ds_read_b64 v[34:35], v9 offset:0
    v_mfma_f32_16x16x32_bf16 v[24:27], v[20:23], v[20:23], v[24:27]
    s_add_u32 s17, s43, 2048
    buffer_store_dwordx2 v[30:31], v10, s[8:11], s17 offen sc1
    s_waitcnt lgkmcnt(2)
    v_mfma_f32_16x16x32_bf16 v[12:15], v[36:39], v[52:55], v[12:15]
    s_waitcnt lgkmcnt(1)
    v_mfma_f32_16x16x32_bf16 v[16:19], v[44:47], v[52:55], v[16:19]
    v_mfma_f32_16x16x32_bf16 v[24:27], v[52:55], v[52:55], v[24:27]
    s_add_u32 s17, s43, 0
    s_waitcnt lgkmcnt(0)
    buffer_store_dwordx2 v[34:35], v10, s[8:11], s17 offen sc1
    s_cmp_eq_u32 s33, 63
    s_cbranch_scc1 Lr0f_last
    ds_read_b128 v[56:59], v8 offset:16384
    ds_read_b128 v[60:63], v8 offset:17408
    v_mov_b64 v[20:21], s[52:53]
    v_mov_b64 v[22:23], s[52:53]
    v_mov_b32 v41, 0
    v_mov_b32 v42, 0
    v_max3_f32 v9, v12, v13, v14
    v_max3_f32 v9, v9, v15, v16
    v_max3_f32 v9, v9, v17, v18
    v_max3_f32 v9, v9, v19, v24
    v_max_f32 v9, v9, v25
    v_mov_b32 v10, v9
    v_mov_b64 v[32:33], 0
    v_mov_b64 v[34:35], 0
    v_permlane32_swap_b32 v9, v10
    v_max_f32 v9, v9, v10
    v_mov_b32 v10, v9
    s_nop 1
    v_permlane16_swap_b32 v9, v10
    v_max_f32 v9, v9, v10
    v_mul_f32 v28, s44, v9
    v_fma_f32 v12, v12, s44, -v28
    v_fma_f32 v13, v13, s44, -v28
    v_fma_f32 v14, v14, s44, -v28
    v_fma_f32 v15, v15, s44, -v28
    v_exp_f32 v12, v12
    v_exp_f32 v13, v13
    v_fma_f32 v16, v16, s44, -v28
    v_fma_f32 v17, v17, s44, -v28
    v_exp_f32 v14, v14
    v_exp_f32 v15, v15
    v_cvt_pk_bf16_f32 v36, v12, v13
    v_fma_f32 v18, v18, s44, -v28
    v_fma_f32 v19, v19, s44, -v28
    v_exp_f32 v16, v16
    v_exp_f32 v17, v17
    v_cvt_pk_bf16_f32 v37, v14, v15
    v_fma_f32 v24, v24, s44, -v28
    v_fma_f32 v25, v25, s44, -v28
    v_exp_f32 v18, v18
    v_exp_f32 v19, v19
    v_cvt_pk_bf16_f32 v38, v16, v17
    v_exp_f32 v24, v24
    v_exp_f32 v25, v25
    v_cvt_pk_bf16_f32 v39, v18, v19
    v_cvt_pk_bf16_f32 v40, v24, v25
    v_cvt_pk_bf16_f32 v43, v24, v25
    v_mfma_f32_16x16x32_bf16 v[52:55], v[20:23], v[36:39], 0
    v_mov_b64 v[12:13], 0
    v_mov_b64 v[14:15], 0
    s_waitcnt vmcnt(4)
    v_mfma_f32_16x16x32_bf16 v[44:47], v[64:67], v[36:39], 0
    v_mov_b64 v[24:25], 0
    v_mov_b64 v[26:27], 0
    s_waitcnt vmcnt(3)
    v_mfma_f32_16x16x32_bf16 v[48:51], v[68:71], v[36:39], 0
    ds_read_b128 v[64:67], v8 offset:20480
    ds_read_b128 v[68:71], v8 offset:21504
    v_mfma_f32_16x16x16_bf16 v[52:55], v[20:21], v[40:41], v[52:55]
    v_mfma_f32_16x16x16_bf16 v[44:47], v[30:31], v[40:41], v[44:47]
    v_mov_b64 v[20:21], 0
    v_mov_b64 v[22:23], 0
    v_mfma_f32_16x16x16_bf16 v[48:51], v[30:31], v[42:43], v[48:51]
    v_mov_b64 v[36:37], 0
    v_mov_b64 v[38:39], 0
    v_mov_b64 v[40:41], 0
    v_mov_b64 v[42:43], 0
    v_rcp_f32 v9, v52
    v_mov_b64 v[52:53], 0
    v_mov_b64 v[54:55], 0
    v_mul_f32 v44, v9, v44
    v_mul_f32 v48, v9, v48
    v_cvt_pk_bf16_f32 v16, v44, v48
    v_mul_f32 v45, v9, v45
    v_mul_f32 v49, v9, v49
    v_cvt_pk_bf16_f32 v17, v45, v49
    v_mul_f32 v46, v9, v46
    v_mul_f32 v50, v9, v50
    v_cvt_pk_bf16_f32 v18, v46, v50
    v_mul_f32 v47, v9, v47
    v_mul_f32 v51, v9, v51
    v_cvt_pk_bf16_f32 v19, v47, v51
    ds_write_b128 v5, v[16:19]
    v_mov_b64 v[28:29], 0
    v_mov_b64 v[30:31], 0
    s_waitcnt lgkmcnt(0)
    s_barrier
    ds_read_b128 v[44:47], v4 offset:0
    ds_read_b128 v[48:51], v4 offset:128
    v_mov_b64 v[16:17], 0
    v_mov_b64 v[18:19], 0
    buffer_load_dwordx4 v0, s[8:11], s41 offen offset:0 lds
    buffer_load_dwordx4 v0, s[8:11], s41 offen offset:1024 lds
    s_waitcnt lgkmcnt(1)
    v_smfmac_f32_16x16x64_bf16 v[12:15], v[44:47], a[184:191], v1
    s_waitcnt lgkmcnt(0)
    v_smfmac_f32_16x16x64_bf16 v[12:15], v[48:51], a[192:199], v1
    v_smfmac_f32_16x16x64_bf16 v[24:27], v[44:47], a[200:207], v1
    v_smfmac_f32_16x16x64_bf16 v[24:27], v[48:51], a[208:215], v1
    v_add_f32 v12, v12, v14
    v_smfmac_f32_16x16x64_bf16 v[20:23], v[44:47], a[216:223], v1
    v_add_f32 v13, v13, v15
    v_smfmac_f32_16x16x64_bf16 v[20:23], v[48:51], a[224:231], v1
    v_cvt_pk_bf16_f32 v12, v12, v13
    v_smfmac_f32_16x16x64_bf16 v[16:19], v[44:47], a[232:239], v1
    v_add_f32 v24, v24, v26
    v_smfmac_f32_16x16x64_bf16 v[16:19], v[48:51], a[240:247], v1
    v_add_f32 v25, v25, v27
    v_smfmac_f32_16x16x64_bf16 v[36:39], v[44:47], v[56:63], v1
    v_cvt_pk_bf16_f32 v13, v24, v25
    v_smfmac_f32_16x16x64_bf16 v[36:39], v[48:51], v[64:71], v1
    v_add_f32 v20, v20, v22
    v_add_f32 v21, v21, v23
    v_cvt_pk_bf16_f32 v14, v20, v21
    v_add_f32 v16, v16, v18
    v_add_f32 v17, v17, v19
    v_cvt_pk_bf16_f32 v15, v16, v17
    v_and_or_b32 v15, v15, -2, s40
    buffer_store_dwordx4 v[12:15], v0, s[8:11], s38 offen
    s_nop 0
    ds_read_b128 v[12:15], v8 offset:18432
    ds_read_b128 v[16:19], v8 offset:19456
    ds_read_b128 v[20:23], v8 offset:22528
    ds_read_b128 v[24:27], v8 offset:23552
    ds_read_b128 v[56:59], v8 offset:24576
    ds_read_b128 v[60:63], v8 offset:25600
    ds_read_b128 v[64:67], v8 offset:28672
    ds_read_b128 v[68:71], v8 offset:29696
    s_waitcnt lgkmcnt(6)
    v_smfmac_f32_16x16x64_bf16 v[40:43], v[44:47], v[12:19], v1
    ds_read_b128 v[12:15], v8 offset:26624
    ds_read_b128 v[16:19], v8 offset:27648
    s_waitcnt lgkmcnt(6)
    v_smfmac_f32_16x16x64_bf16 v[40:43], v[48:51], v[20:27], v1
    ds_read_b128 v[20:23], v8 offset:30720
    ds_read_b128 v[24:27], v8 offset:31744
    s_waitcnt lgkmcnt(6)
    v_smfmac_f32_16x16x64_bf16 v[52:55], v[44:47], v[56:63], v1
    ds_read_b128 v[56:59], v8 offset:32768
    ds_read_b128 v[60:63], v8 offset:33792
    s_waitcnt lgkmcnt(6)
    v_smfmac_f32_16x16x64_bf16 v[52:55], v[48:51], v[64:71], v1
    s_waitcnt lgkmcnt(4)
    v_smfmac_f32_16x16x64_bf16 v[32:35], v[44:47], v[12:19], v1
    s_waitcnt lgkmcnt(2)
    v_smfmac_f32_16x16x64_bf16 v[32:35], v[48:51], v[20:27], v1
    v_smfmac_f32_16x16x64_bf16 v[28:31], v[44:47], a[248:255], v1
    s_waitcnt lgkmcnt(0)
    v_smfmac_f32_16x16x64_bf16 v[28:31], v[48:51], v[56:63], v1
    buffer_load_dwordx4 v[12:15], v6, s[8:11], s62 offen sc1
    buffer_load_dwordx4 v[16:19], v6, s[8:11], s63 offen sc1
    buffer_load_dwordx4 v[20:23], v6, s[8:11], s64 offen sc1
    buffer_load_dwordx4 v[24:27], v6, s[8:11], s65 offen sc1
    v_add_f32 v36, v36, v38
    v_add_f32 v37, v37, v39
    v_cvt_pk_bf16_f32 v36, v36, v37
    v_add_f32 v40, v40, v42
    v_add_f32 v41, v41, v43
    v_cvt_pk_bf16_f32 v37, v40, v41
    v_add_f32 v52, v52, v54
    v_add_f32 v53, v53, v55
    v_cvt_pk_bf16_f32 v38, v52, v53
    v_add_f32 v32, v32, v34
    v_add_f32 v33, v33, v35
    v_cvt_pk_bf16_f32 v39, v32, v33
    v_and_or_b32 v39, v39, -2, s40
    s_add_u32 s17, s38, 4096
    buffer_store_dwordx4 v[36:39], v0, s[8:11], s17 offen
    v_add_f32 v28, v28, v30
    v_add_f32 v29, v29, v31
    v_cvt_pk_bf16_f32 v28, v28, v29
    v_and_or_b32 v28, v28, -2, s40
    v_lshrrev_b32 v9, 2, v0
    buffer_store_dword v28, v9, s[8:11], s39 offen
    v_add_u32 v10, 162560, v0
    ds_read_b128 v[64:67], v10
    s_nop 9
    buffer_load_dwordx4 v[40:43], v6, s[8:11], s62 offen sc1
    buffer_load_dwordx4 v[44:47], v6, s[8:11], s63 offen sc1
    buffer_load_dwordx4 v[48:51], v6, s[8:11], s64 offen sc1
    buffer_load_dwordx4 v[52:55], v6, s[8:11], s65 offen sc1
    s_add_u32 s33, s33, 1
    s_add_u32 s42, s42, 262144
    s_add_u32 s41, s41, 262144
    s_add_u32 s43, s43, 131072
    s_add_u32 s68, s68, 262144
    s_add_u32 s66, s66, 22528
    ds_read_b128 v[56:59], v8 offset:0
    ds_read_b128 v[60:63], v8 offset:1024
    s_waitcnt lgkmcnt(2)
    s_waitcnt vmcnt(9)
    v_mfma_f32_16x16x32_bf16 v[68:71], v[12:15], v[64:67], 0
    v_and_b32 v10, 1, v15
    v_cmp_ne_u32 s[54:55], s40, v10
    s_waitcnt vmcnt(8)
    v_mfma_f32_16x16x32_bf16 v[68:71], v[16:19], v[64:67], v[68:71]
    v_and_b32 v10, 1, v19
    v_cmp_ne_u32 s[56:57], s40, v10
    s_waitcnt vmcnt(7)
    v_mfma_f32_16x16x32_bf16 v[68:71], v[20:23], v[64:67], v[68:71]
    v_and_b32 v10, 1, v23
    v_cmp_ne_u32 s[58:59], s40, v10
    s_waitcnt vmcnt(6)
    v_mfma_f32_16x16x32_bf16 v[68:71], v[24:27], v[64:67], v[68:71]
    v_and_b32 v10, 1, v27
    v_cmp_ne_u32 s[60:61], s40, v10
    s_or_b64 vcc, s[54:55], s[56:57]
    s_or_b64 vcc, vcc, s[58:59]
    s_or_b64 vcc, vcc, s[60:61]
    s_cbranch_scc0 Lr0f_red
    s_mov_b32 s16, 0
Lr0f_p1:
    buffer_load_dwordx4 v[12:15], v6, s[8:11], s62 offen sc1
    buffer_load_dwordx4 v[16:19], v6, s[8:11], s63 offen sc1
    buffer_load_dwordx4 v[20:23], v6, s[8:11], s64 offen sc1
    buffer_load_dwordx4 v[24:27], v6, s[8:11], s65 offen sc1
    s_waitcnt vmcnt(7)
    v_mfma_f32_16x16x32_bf16 v[68:71], v[40:43], v[64:67], 0
    v_and_b32 v10, 1, v43
    v_cmp_ne_u32 s[54:55], s40, v10
    s_waitcnt vmcnt(6)
    v_mfma_f32_16x16x32_bf16 v[68:71], v[44:47], v[64:67], v[68:71]
    v_and_b32 v10, 1, v47
    v_cmp_ne_u32 s[56:57], s40, v10
    s_waitcnt vmcnt(5)
    v_mfma_f32_16x16x32_bf16 v[68:71], v[48:51], v[64:67], v[68:71]
    v_and_b32 v10, 1, v51
    v_cmp_ne_u32 s[58:59], s40, v10
    s_waitcnt vmcnt(4)
    v_mfma_f32_16x16x32_bf16 v[68:71], v[52:55], v[64:67], v[68:71]
    v_and_b32 v10, 1, v55
    v_cmp_ne_u32 s[60:61], s40, v10
    s_or_b64 vcc, s[54:55], s[56:57]
    s_or_b64 vcc, vcc, s[58:59]
    s_or_b64 vcc, vcc, s[60:61]
    s_cbranch_scc0 Lr0f_red
    buffer_load_dwordx4 v[40:43], v6, s[8:11], s62 offen sc1
    buffer_load_dwordx4 v[44:47], v6, s[8:11], s63 offen sc1
    buffer_load_dwordx4 v[48:51], v6, s[8:11], s64 offen sc1
    buffer_load_dwordx4 v[52:55], v6, s[8:11], s65 offen sc1
    s_add_u32 s16, s16, 1
    s_cmp_gt_u32 s16, 100000
    s_cbranch_scc1 Lr_abort
    s_waitcnt vmcnt(7)
    v_mfma_f32_16x16x32_bf16 v[68:71], v[12:15], v[64:67], 0
    v_and_b32 v10, 1, v15
    v_cmp_ne_u32 s[54:55], s40, v10
    s_waitcnt vmcnt(6)
    v_mfma_f32_16x16x32_bf16 v[68:71], v[16:19], v[64:67], v[68:71]
    v_and_b32 v10, 1, v19
    v_cmp_ne_u32 s[56:57], s40, v10
    s_waitcnt vmcnt(5)
    v_mfma_f32_16x16x32_bf16 v[68:71], v[20:23], v[64:67], v[68:71]
    v_and_b32 v10, 1, v23
    v_cmp_ne_u32 s[58:59], s40, v10
    s_waitcnt vmcnt(4)
    v_mfma_f32_16x16x32_bf16 v[68:71], v[24:27], v[64:67], v[68:71]
    v_and_b32 v10, 1, v27
    v_cmp_ne_u32 s[60:61], s40, v10
    s_or_b64 vcc, s[54:55], s[56:57]
    s_or_b64 vcc, vcc, s[58:59]
    s_or_b64 vcc, vcc, s[60:61]
    s_cbranch_scc1 Lr0f_p1
Lr0f_red:
    s_nop 1
    v_permlane16_swap_b32 v68, v70
    v_permlane16_swap_b32 v69, v71
    s_mov_b64 exec, s[46:47]
    v_add_f32 v68, v68, v70
    v_add_f32 v69, v69, v71
    v_cvt_pk_bf16_f32 v68, v68, v69
    v_min_u32 v68, s50, v68
    buffer_store_dword v68, v7, s[8:11], s36 offen
    v_mov_b32 v69, -1
    buffer_store_dword v69, v7, s[8:11], s37 offen
    s_mov_b64 exec, -1
    s_xor_b32 s34, s34, 16384
    s_xor_b32 s35, s35, 16384
    s_xor_b32 s40, s40, 1
    s_xor_b32 s36, s36, 16384
    s_xor_b32 s37, s37, 16384
    s_nop 15
    s_nop 3
    buffer_load_dwordx4 v[36:39], v0, s[8:11], s34 offen sc1
    s_waitcnt vmcnt(3)
    ds_read_b128 v[64:67], v8 offset:2048
    ds_read_b128 v[68:71], v8 offset:3072
    v_mov_b64 v[12:13], 0
    v_mov_b64 v[14:15], 0
    v_mov_b64 v[16:17], 0
    v_mov_b64 v[18:19], 0
    v_mov_b64 v[20:21], 0
    v_mov_b64 v[22:23], 0
    v_mov_b64 v[24:25], 0
    v_mov_b64 v[26:27], 0
    v_mov_b64 v[28:29], 0
    v_mov_b64 v[30:31], 0
    v_mov_b64 v[32:33], 0
    v_mov_b64 v[34:35], 0
    s_nop 9
    buffer_load_dwordx4 v[36:39], v0, s[8:11], s34 offen sc1
    s_nop 15
    s_nop 8
    buffer_load_dwordx4 v[36:39], v0, s[8:11], s34 offen sc1
    s_waitcnt lgkmcnt(0)
    s_branch Lr0f_step
Lr0f_pb_re:
    s_mov_b32 s16, 0
Lr0f_pb_lp:
    s_add_u32 s17, s34, 4096
    buffer_load_dwordx4 v[40:43], v0, s[8:11], s17 offen sc1
    s_add_u32 s16, s16, 1
    s_cmp_gt_u32 s16, 100000
    s_cbranch_scc1 Lr_abort
    s_waitcnt vmcnt(0)
    v_max3_u32 v10, v40, v41, v42
    v_max_u32 v10, v10, v43
    v_cmp_eq_u32 vcc, -1, v10
    s_nop 0
    s_cbranch_vccnz Lr0f_pb_lp
    s_branch Lr0f_pb_ok
Lr0f_pc_re:
    s_mov_b32 s16, 0
Lr0f_pc_lp:
    buffer_load_dwordx4 v[44:47], v0, s[8:11], s35 offen sc1
    s_add_u32 s16, s16, 1
    s_cmp_gt_u32 s16, 100000
    s_cbranch_scc1 Lr_abort
    s_waitcnt vmcnt(0)
    v_max3_u32 v10, v44, v45, v46
    v_max_u32 v10, v10, v47
    v_cmp_eq_u32 vcc, -1, v10
    s_nop 0
    s_cbranch_vccnz Lr0f_pc_lp
    s_branch Lr0f_pc_ok
Lr0f_last:
    s_waitcnt vmcnt(0) lgkmcnt(0)
    s_barrier
    s_branch Lr_exit
L_w1_1:
    s_cmp_lg_u32 s14, 1
    s_cbranch_scc1 L_w2_1
    s_mov_b32 s16, 0
    s_add_u32 s17, s66, 128
    v_lshrrev_b32 v10, 2, v0
    v_and_b32 v9, 16, v10
    v_lshlrev_b32 v9, 3, v9
    v_and_or_b32 v10, v10, 12, v9
Lr1f_fw_11:
    buffer_load_dword v9, v10, s[8:11], s17 offen sc1
    s_add_u32 s16, s16, 1
    s_cmp_gt_u32 s16, 100000
    s_cbranch_scc1 Lr_abort
    s_waitcnt vmcnt(0)
    v_cmp_eq_u32 vcc, 0, v9
    s_nop 0
    s_cbranch_vccnz Lr1f_fw_11
    s_lshl_b32 s67, s32, 5
    s_add_u32 s67, s67, s15
    s_lshl_b32 s67, s67, 12
    s_add_u32 s67, s67, 3145728
    s_mov_b32 m0, 17152
    s_nop 0
    buffer_load_dwordx4 v0, s[8:11], s41 offen offset:0 lds
    buffer_load_dwordx4 v0, s[8:11], s41 offen offset:1024 lds
    s_add_u32 s41, s41, 262144
    s_add_u32 s68, s68, 262144
    s_waitcnt vmcnt(0)
    ds_read_b128 v[56:59], v8 offset:4096
    ds_read_b128 v[60:63], v8 offset:5120
    ds_read_b128 v[64:67], v8 offset:6144
    ds_read_b128 v[68:71], v8 offset:7168
    v_mov_b64 v[12:13], 0
    v_mov_b64 v[14:15], 0
    v_mov_b64 v[16:17], 0
    v_mov_b64 v[18:19], 0
    v_mov_b64 v[20:21], 0
    v_mov_b64 v[22:23], 0
    v_mov_b64 v[24:25], 0
    v_mov_b64 v[26:27], 0
    v_mov_b64 v[28:29], 0
    v_mov_b64 v[30:31], 0
    v_mov_b64 v[32:33], 0
    v_mov_b64 v[34:35], 0
    buffer_load_dwordx4 v[36:39], v0, s[8:11], s34 offen sc1
    s_waitcnt vmcnt(0) lgkmcnt(0)
Lr1f_step:
    s_waitcnt vmcnt(3)
    v_max3_u32 v10, v36, v37, v38
    v_max_u32 v10, v10, v39
    v_cmp_eq_u32 vcc, -1, v10
    s_nop 0
    s_cbranch_vccz Lr1f_aok
    buffer_load_dwordx4 v[36:39], v0, s[8:11], s34 offen sc1
    s_nop 15
    s_nop 8
    buffer_load_dwordx4 v[36:39], v0, s[8:11], s34 offen sc1
    s_mov_b32 s16, 0
Lr1f_alp:
    s_waitcnt vmcnt(2)
    v_max3_u32 v10, v36, v37, v38
    v_max_u32 v10, v10, v39
    v_cmp_eq_u32 vcc, -1, v10
    s_nop 0
    s_cbranch_vccz Lr1f_aok
    buffer_load_dwordx4 v[36:39], v0, s[8:11], s34 offen sc1
    s_add_u32 s16, s16, 1
    s_cmp_gt_u32 s16, 100000
    s_cbranch_scc1 Lr_abort
    s_branch Lr1f_alp
Lr1f_aok:
    ds_write_b128 v0, v[36:39] offset:7936
    v_smfmac_f32_16x16x64_bf16 v[12:15], v[36:39], v[88:95], v1
    v_smfmac_f32_16x16x64_bf16 v[16:19], v[36:39], v[96:103], v1
    v_smfmac_f32_16x16x64_bf16 v[20:23], v[36:39], v[200:207], v1
    s_waitcnt lgkmcnt(0)
    s_barrier
    ds_read_b128 v[48:51], v0 offset:8960
    ds_read_b128 v[52:55], v0 offset:9984
    v_smfmac_f32_16x16x64_bf16 v[28:31], v[36:39], a[72:79], v1
    v_smfmac_f32_16x16x64_bf16 v[24:27], v[36:39], v[208:215], v1
    s_add_u32 s17, s34, 4096
    buffer_load_dwordx4 v[40:43], v0, s[8:11], s17 offen sc1
    v_smfmac_f32_16x16x64_bf16 v[32:35], v[36:39], a[80:87], v1
    s_waitcnt vmcnt(1)
    ds_read_b128 v[36:39], v0 offset:6912
    s_waitcnt lgkmcnt(2)
    v_smfmac_f32_16x16x64_bf16 v[28:31], v[48:51], v[56:63], v1
    ds_read_b128 v[56:59], v8 offset:0
    ds_read_b128 v[60:63], v8 offset:1024
    v_smfmac_f32_16x16x64_bf16 v[12:15], v[48:51], v[104:111], v1
    v_smfmac_f32_16x16x64_bf16 v[16:19], v[48:51], v[112:119], v1
    buffer_load_dwordx4 v[44:47], v0, s[8:11], s35 offen sc1
    v_smfmac_f32_16x16x64_bf16 v[32:35], v[48:51], v[64:71], v1
    ds_read_b128 v[64:67], v8 offset:2048
    ds_read_b128 v[68:71], v8 offset:3072
    v_smfmac_f32_16x16x64_bf16 v[20:23], v[48:51], v[216:223], v1
    v_smfmac_f32_16x16x64_bf16 v[24:27], v[48:51], v[224:231], v1
    s_waitcnt lgkmcnt(5)
    v_smfmac_f32_16x16x64_bf16 v[28:31], v[52:55], a[88:95], v1
    v_smfmac_f32_16x16x64_bf16 v[12:15], v[52:55], v[120:127], v1
    v_smfmac_f32_16x16x64_bf16 v[16:19], v[52:55], v[128:135], v1
    v_smfmac_f32_16x16x64_bf16 v[32:35], v[52:55], a[96:103], v1
    v_smfmac_f32_16x16x64_bf16 v[20:23], v[52:55], v[232:239], v1
    v_smfmac_f32_16x16x64_bf16 v[24:27], v[52:55], v[240:247], v1
    s_waitcnt lgkmcnt(2)
    v_smfmac_f32_16x16x64_bf16 v[28:31], v[36:39], v[56:63], v1
    ds_read_b128 v[56:59], v8 offset:12288
    ds_read_b128 v[60:63], v8 offset:13312
    v_smfmac_f32_16x16x64_bf16 v[12:15], v[36:39], v[72:79], v1
    v_smfmac_f32_16x16x64_bf16 v[16:19], v[36:39], v[80:87], v1
    s_waitcnt lgkmcnt(2)
    v_smfmac_f32_16x16x64_bf16 v[32:35], v[36:39], v[64:71], v1
    ds_read_b128 v[64:67], v8 offset:14336
    ds_read_b128 v[68:71], v8 offset:15360
    v_smfmac_f32_16x16x64_bf16 v[20:23], v[36:39], v[184:191], v1
    v_smfmac_f32_16x16x64_bf16 v[24:27], v[36:39], v[192:199], v1
    s_waitcnt vmcnt(1)
    v_max3_u32 v10, v40, v41, v42
    v_max_u32 v10, v10, v43
    v_cmp_eq_u32 vcc, -1, v10
    s_nop 0
    s_cbranch_vccnz Lr1f_pb_re
Lr1f_pb_ok:
    ds_write_b128 v0, v[40:43] offset:12032
    v_mov_b32 v9, 1
    v_mov_b32 v10, 0
    s_mov_b64 exec, 1
    buffer_store_dword v9, v10, s[8:11], s67 offen offset:384 sc1
    s_mov_b64 exec, -1
    v_smfmac_f32_16x16x64_bf16 v[12:15], v[40:43], v[136:143], v1
    v_smfmac_f32_16x16x64_bf16 v[20:23], v[40:43], a[8:15], v1
    v_smfmac_f32_16x16x64_bf16 v[16:19], v[40:43], v[144:151], v1
    v_smfmac_f32_16x16x64_bf16 v[24:27], v[40:43], a[16:23], v1
    s_waitcnt lgkmcnt(0)
    s_barrier
    ds_read_b128 v[48:51], v0 offset:13056
    ds_read_b128 v[52:55], v0 offset:14080
    ds_read_b128 v[36:39], v0 offset:11008
    v_smfmac_f32_16x16x64_bf16 v[28:31], v[40:43], a[120:127], v1
    v_smfmac_f32_16x16x64_bf16 v[32:35], v[40:43], a[128:135], v1
    s_waitcnt lgkmcnt(2)
    v_smfmac_f32_16x16x64_bf16 v[12:15], v[48:51], v[56:63], v1
    ds_read_b128 v[56:59], v8 offset:8192
    ds_read_b128 v[60:63], v8 offset:9216
    v_smfmac_f32_16x16x64_bf16 v[16:19], v[48:51], v[64:71], v1
    ds_read_b128 v[64:67], v8 offset:10240
    ds_read_b128 v[68:71], v8 offset:11264
    s_waitcnt lgkmcnt(5)
    v_smfmac_f32_16x16x64_bf16 v[12:15], v[52:55], v[152:159], v1
    v_smfmac_f32_16x16x64_bf16 v[16:19], v[52:55], v[160:167], v1
    s_waitcnt vmcnt(1)
    v_max3_u32 v10, v44, v45, v46
    v_max_u32 v10, v10, v47
    v_cmp_eq_u32 vcc, -1, v10
    s_nop 0
    s_cbranch_vccnz Lr1f_pc_re
Lr1f_pc_ok:
    v_smfmac_f32_16x16x64_bf16 v[12:15], v[44:47], v[168:175], v1
    v_smfmac_f32_16x16x64_bf16 v[16:19], v[44:47], v[176:183], v1
    s_waitcnt lgkmcnt(2)
    v_smfmac_f32_16x16x64_bf16 v[12:15], v[36:39], v[56:63], v1
    s_waitcnt lgkmcnt(0)
    v_smfmac_f32_16x16x64_bf16 v[16:19], v[36:39], v[64:71], v1
    v_smfmac_f32_16x16x64_bf16 v[20:23], v[48:51], a[24:31], v1
    v_smfmac_f32_16x16x64_bf16 v[24:27], v[48:51], a[32:39], v1
    buffer_load_dwordx4 v[64:67], v0, s[8:11], s42 offen
    v_smfmac_f32_16x16x64_bf16 v[20:23], v[52:55], a[40:47], v1
    v_add_f32 v12, v12, v14
    v_smfmac_f32_16x16x64_bf16 v[24:27], v[52:55], a[48:55], v1
    v_add_f32 v16, v16, v18
    v_smfmac_f32_16x16x64_bf16 v[20:23], v[36:39], v[248:255], v1
    v_add_f32 v13, v13, v15
    v_smfmac_f32_16x16x64_bf16 v[24:27], v[36:39], a[0:7], v1
    v_add_f32 v17, v17, v19
    buffer_load_dwordx4 v[68:71], v0, s[8:11], s42 offen offset:1024
    v_smfmac_f32_16x16x64_bf16 v[20:23], v[44:47], a[56:63], v1
    v_cvt_pk_bf16_f32 v14, v12, v16
    ds_read_b128 v[56:59], v0 offset:15104
    v_smfmac_f32_16x16x64_bf16 v[24:27], v[44:47], a[64:71], v1
    v_cvt_pk_bf16_f32 v15, v13, v17
    ds_read_b128 v[60:63], v0 offset:16128
    ds_write_b32 v2, v14 offset:576
    ds_write_b32 v2, v15 offset:864
    v_smfmac_f32_16x16x64_bf16 v[28:31], v[48:51], a[136:143], v1
    v_smfmac_f32_16x16x64_bf16 v[32:35], v[48:51], a[144:151], v1
    v_add_f32 v20, v20, v22
    v_add_f32 v24, v24, v26
    v_add_f32 v21, v21, v23
    v_add_f32 v25, v25, v27
    v_cvt_pk_bf16_f32 v22, v20, v24
    v_cvt_pk_bf16_f32 v23, v21, v25
    ds_write_b32 v2, v22 offset:0
    ds_write_b32 v2, v23 offset:288
    v_smfmac_f32_16x16x64_bf16 v[28:31], v[52:55], a[152:159], v1
    v_smfmac_f32_16x16x64_bf16 v[32:35], v[52:55], a[160:167], v1
    s_waitcnt lgkmcnt(0)
    s_barrier
    ds_read_b128 v[40:43], v3 offset:0
    ds_read_b128 v[48:51], v3 offset:64
    ds_read_b128 v[20:23], v3 offset:128
    ds_read_b128 v[52:55], v3 offset:192
    v_smfmac_f32_16x16x64_bf16 v[28:31], v[36:39], a[104:111], v1
    v_smfmac_f32_16x16x64_bf16 v[32:35], v[36:39], a[112:119], v1
    ds_read_b128 v[36:39], v0 offset:17152
    v_smfmac_f32_16x16x64_bf16 v[28:31], v[44:47], a[168:175], v1
    v_smfmac_f32_16x16x64_bf16 v[32:35], v[44:47], a[176:183], v1
    ds_read_b128 v[44:47], v0 offset:18176
    s_waitcnt lgkmcnt(5)
    v_mfma_f32_16x16x32_bf16 v[12:15], v[56:59], v[40:43], 0
    v_mfma_f32_16x16x32_bf16 v[16:19], v[60:63], v[40:43], 0
    v_mfma_f32_16x16x32_bf16 v[24:27], v[40:43], v[40:43], 0
    ds_read_b128 v[56:59], v0 offset:19200
    ds_read_b128 v[60:63], v0 offset:20224
    s_waitcnt lgkmcnt(3)
    v_mfma_f32_16x16x32_bf16 v[12:15], v[36:39], v[48:51], v[12:15]
    v_lshrrev_b32 v10, 1, v0
    v_lshrrev_b32 v9, 9, v0
    s_waitcnt lgkmcnt(2)
    v_mfma_f32_16x16x32_bf16 v[16:19], v[44:47], v[48:51], v[16:19]
    v_lshl_add_u32 v9, v9, 5, v10
    v_add_f32 v28, v28, v30
    v_mfma_f32_16x16x32_bf16 v[24:27], v[48:51], v[48:51], v[24:27]
    v_add_f32 v32, v32, v34
    v_add_f32 v29, v29, v31
    ds_read_b128 v[36:39], v0 offset:21248
    ds_read_b128 v[44:47], v0 offset:22272
    s_waitcnt lgkmcnt(3)
    v_mfma_f32_16x16x32_bf16 v[12:15], v[56:59], v[20:23], v[12:15]
    v_add_f32 v33, v33, v35
    v_cvt_pk_bf16_f32 v30, v28, v29
    s_waitcnt lgkmcnt(2)
    v_mfma_f32_16x16x32_bf16 v[16:19], v[60:63], v[20:23], v[16:19]
    v_cvt_pk_bf16_f32 v31, v32, v33
    ds_read_b64 v[34:35], v9 offset:1152
    v_mfma_f32_16x16x32_bf16 v[24:27], v[20:23], v[20:23], v[24:27]
    s_add_u32 s17, s43, 2560
    buffer_store_dwordx2 v[30:31], v10, s[8:11], s17 offen sc1
    s_waitcnt lgkmcnt(2)
    v_mfma_f32_16x16x32_bf16 v[12:15], v[36:39], v[52:55], v[12:15]
    s_waitcnt lgkmcnt(1)
    v_mfma_f32_16x16x32_bf16 v[16:19], v[44:47], v[52:55], v[16:19]
    v_mfma_f32_16x16x32_bf16 v[24:27], v[52:55], v[52:55], v[24:27]
    s_add_u32 s17, s43, 512
    s_waitcnt lgkmcnt(0)
    buffer_store_dwordx2 v[34:35], v10, s[8:11], s17 offen sc1
    s_cmp_eq_u32 s33, 63
    s_cbranch_scc1 Lr1f_last
    ds_read_b128 v[56:59], v8 offset:16384
    ds_read_b128 v[60:63], v8 offset:17408
    v_mov_b64 v[20:21], s[52:53]
    v_mov_b64 v[22:23], s[52:53]
    v_mov_b32 v41, 0
    v_mov_b32 v42, 0
    v_max3_f32 v9, v12, v13, v14
    v_max3_f32 v9, v9, v15, v16
    v_max3_f32 v9, v9, v17, v18
    v_max3_f32 v9, v9, v19, v24
    v_max_f32 v9, v9, v25
    v_mov_b32 v10, v9
    v_mov_b64 v[32:33], 0
    v_mov_b64 v[34:35], 0
    v_permlane32_swap_b32 v9, v10
    v_max_f32 v9, v9, v10
    v_mov_b32 v10, v9
    s_nop 1
    v_permlane16_swap_b32 v9, v10
    v_max_f32 v9, v9, v10
    v_mul_f32 v28, s44, v9
    v_fma_f32 v12, v12, s44, -v28
    v_fma_f32 v13, v13, s44, -v28
    v_fma_f32 v14, v14, s44, -v28
    v_fma_f32 v15, v15, s44, -v28
    v_exp_f32 v12, v12
    v_exp_f32 v13, v13
    v_fma_f32 v16, v16, s44, -v28
    v_fma_f32 v17, v17, s44, -v28
    v_exp_f32 v14, v14
    v_exp_f32 v15, v15
    v_cvt_pk_bf16_f32 v36, v12, v13
    v_fma_f32 v18, v18, s44, -v28
    v_fma_f32 v19, v19, s44, -v28
    v_exp_f32 v16, v16
    v_exp_f32 v17, v17
    v_cvt_pk_bf16_f32 v37, v14, v15
    v_fma_f32 v24, v24, s44, -v28
    v_fma_f32 v25, v25, s44, -v28
    v_exp_f32 v18, v18
    v_exp_f32 v19, v19
    v_cvt_pk_bf16_f32 v38, v16, v17
    v_exp_f32 v24, v24
    v_exp_f32 v25, v25
    v_cvt_pk_bf16_f32 v39, v18, v19
    v_cvt_pk_bf16_f32 v40, v24, v25
    v_cvt_pk_bf16_f32 v43, v24, v25
    v_mfma_f32_16x16x32_bf16 v[52:55], v[20:23], v[36:39], 0
    v_mov_b64 v[12:13], 0
    v_mov_b64 v[14:15], 0
    s_waitcnt vmcnt(3)
    v_mfma_f32_16x16x32_bf16 v[44:47], v[64:67], v[36:39], 0
    v_mov_b64 v[24:25], 0
    v_mov_b64 v[26:27], 0
    s_waitcnt vmcnt(2)
    v_mfma_f32_16x16x32_bf16 v[48:51], v[68:71], v[36:39], 0
    ds_read_b128 v[64:67], v8 offset:20480
    ds_read_b128 v[68:71], v8 offset:21504
    v_mfma_f32_16x16x16_bf16 v[52:55], v[20:21], v[40:41], v[52:55]
    v_mfma_f32_16x16x16_bf16 v[44:47], v[30:31], v[40:41], v[44:47]
    v_mov_b64 v[20:21], 0
    v_mov_b64 v[22:23], 0
    v_mfma_f32_16x16x16_bf16 v[48:51], v[30:31], v[42:43], v[48:51]
    v_mov_b64 v[36:37], 0
    v_mov_b64 v[38:39], 0
    v_mov_b64 v[40:41], 0
    v_mov_b64 v[42:43], 0
    v_rcp_f32 v9, v52
    v_mov_b64 v[52:53], 0
    v_mov_b64 v[54:55], 0
    v_mul_f32 v44, v9, v44
    v_mul_f32 v48, v9, v48
    v_cvt_pk_bf16_f32 v16, v44, v48
    v_mul_f32 v45, v9, v45
    v_mul_f32 v49, v9, v49
    v_cvt_pk_bf16_f32 v17, v45, v49
    v_mul_f32 v46, v9, v46
    v_mul_f32 v50, v9, v50
    v_cvt_pk_bf16_f32 v18, v46, v50
    v_mul_f32 v47, v9, v47
    v_mul_f32 v51, v9, v51
    v_cvt_pk_bf16_f32 v19, v47, v51
    ds_write_b128 v5, v[16:19]
    v_mov_b64 v[28:29], 0
    v_mov_b64 v[30:31], 0
    s_waitcnt lgkmcnt(0)
    s_barrier
    ds_read_b128 v[44:47], v4 offset:0
    ds_read_b128 v[48:51], v4 offset:128
    v_mov_b64 v[16:17], 0
    v_mov_b64 v[18:19], 0
    buffer_load_dwordx4 v0, s[8:11], s41 offen offset:0 lds
    buffer_load_dwordx4 v0, s[8:11], s41 offen offset:1024 lds
    s_waitcnt lgkmcnt(1)
    v_smfmac_f32_16x16x64_bf16 v[12:15], v[44:47], a[184:191], v1
    s_waitcnt lgkmcnt(0)
    v_smfmac_f32_16x16x64_bf16 v[12:15], v[48:51], a[192:199], v1
    v_smfmac_f32_16x16x64_bf16 v[24:27], v[44:47], a[200:207], v1
    v_smfmac_f32_16x16x64_bf16 v[24:27], v[48:51], a[208:215], v1
    v_add_f32 v12, v12, v14
    v_smfmac_f32_16x16x64_bf16 v[20:23], v[44:47], a[216:223], v1
    v_add_f32 v13, v13, v15
    v_smfmac_f32_16x16x64_bf16 v[20:23], v[48:51], a[224:231], v1
    v_cvt_pk_bf16_f32 v12, v12, v13
    v_smfmac_f32_16x16x64_bf16 v[16:19], v[44:47], a[232:239], v1
    v_add_f32 v24, v24, v26
    v_smfmac_f32_16x16x64_bf16 v[16:19], v[48:51], a[240:247], v1
    v_add_f32 v25, v25, v27
    v_smfmac_f32_16x16x64_bf16 v[36:39], v[44:47], v[56:63], v1
    v_cvt_pk_bf16_f32 v13, v24, v25
    v_smfmac_f32_16x16x64_bf16 v[36:39], v[48:51], v[64:71], v1
    v_add_f32 v20, v20, v22
    v_add_f32 v21, v21, v23
    v_cvt_pk_bf16_f32 v14, v20, v21
    v_add_f32 v16, v16, v18
    v_add_f32 v17, v17, v19
    v_cvt_pk_bf16_f32 v15, v16, v17
    v_and_or_b32 v15, v15, -2, s40
    buffer_store_dwordx4 v[12:15], v0, s[8:11], s38 offen
    s_nop 0
    ds_read_b128 v[12:15], v8 offset:18432
    ds_read_b128 v[16:19], v8 offset:19456
    ds_read_b128 v[20:23], v8 offset:22528
    ds_read_b128 v[24:27], v8 offset:23552
    ds_read_b128 v[56:59], v8 offset:24576
    ds_read_b128 v[60:63], v8 offset:25600
    ds_read_b128 v[64:67], v8 offset:28672
    ds_read_b128 v[68:71], v8 offset:29696
    s_waitcnt lgkmcnt(6)
    v_smfmac_f32_16x16x64_bf16 v[40:43], v[44:47], v[12:19], v1
    ds_read_b128 v[12:15], v8 offset:26624
    ds_read_b128 v[16:19], v8 offset:27648
    s_waitcnt lgkmcnt(6)
    v_smfmac_f32_16x16x64_bf16 v[40:43], v[48:51], v[20:27], v1
    ds_read_b128 v[20:23], v8 offset:30720
    ds_read_b128 v[24:27], v8 offset:31744
    s_waitcnt lgkmcnt(6)
    v_smfmac_f32_16x16x64_bf16 v[52:55], v[44:47], v[56:63], v1
    ds_read_b128 v[56:59], v8 offset:32768
    ds_read_b128 v[60:63], v8 offset:33792
    s_waitcnt lgkmcnt(6)
    v_smfmac_f32_16x16x64_bf16 v[52:55], v[48:51], v[64:71], v1
    s_waitcnt lgkmcnt(4)
    v_smfmac_f32_16x16x64_bf16 v[32:35], v[44:47], v[12:19], v1
    s_waitcnt lgkmcnt(2)
    v_smfmac_f32_16x16x64_bf16 v[32:35], v[48:51], v[20:27], v1
    v_smfmac_f32_16x16x64_bf16 v[28:31], v[44:47], a[248:255], v1
    s_waitcnt lgkmcnt(0)
    v_smfmac_f32_16x16x64_bf16 v[28:31], v[48:51], v[56:63], v1
    v_add_f32 v36, v36, v38
    v_add_f32 v37, v37, v39
    v_cvt_pk_bf16_f32 v36, v36, v37
    v_add_f32 v40, v40, v42
    v_add_f32 v41, v41, v43
    v_cvt_pk_bf16_f32 v37, v40, v41
    v_add_f32 v52, v52, v54
    v_add_f32 v53, v53, v55
    v_cvt_pk_bf16_f32 v38, v52, v53
    v_add_f32 v32, v32, v34
    v_add_f32 v33, v33, v35
    v_cvt_pk_bf16_f32 v39, v32, v33
    v_and_or_b32 v39, v39, -2, s40
    s_add_u32 s17, s38, 4096
    buffer_store_dwordx4 v[36:39], v0, s[8:11], s17 offen
    v_add_f32 v28, v28, v30
    v_add_f32 v29, v29, v31
    v_cvt_pk_bf16_f32 v28, v28, v29
    v_and_or_b32 v28, v28, -2, s40
    v_lshrrev_b32 v9, 2, v0
    buffer_store_dword v28, v9, s[8:11], s39 offen
    v_add_u32 v10, 162560, v0
    ds_read_b128 v[64:67], v10
    s_add_u32 s33, s33, 1
    s_add_u32 s42, s42, 262144
    s_add_u32 s41, s41, 262144
    s_add_u32 s43, s43, 131072
    s_mov_b32 s67, s66
    s_add_u32 s68, s68, 262144
    s_add_u32 s66, s66, 22528
    ds_read_b128 v[56:59], v8 offset:4096
    ds_read_b128 v[60:63], v8 offset:5120
    v_mov_b64 v[12:13], 0
    v_mov_b64 v[14:15], 0
    v_mov_b64 v[16:17], 0
    v_mov_b64 v[18:19], 0
    v_mov_b64 v[20:21], 0
    v_mov_b64 v[22:23], 0
    v_mov_b64 v[24:25], 0
    v_mov_b64 v[26:27], 0
    v_mov_b64 v[28:29], 0
    v_mov_b64 v[30:31], 0
    v_mov_b64 v[32:33], 0
    v_mov_b64 v[34:35], 0
    s_nop 15
    s_nop 15
    s_nop 15
    s_nop 11
    buffer_load_dwordx4 v[40:43], v6, s[8:11], s62 offen sc1
    buffer_load_dwordx4 v[44:47], v6, s[8:11], s63 offen sc1
    buffer_load_dwordx4 v[48:51], v6, s[8:11], s64 offen sc1
    buffer_load_dwordx4 v[52:55], v6, s[8:11], s65 offen sc1
    s_waitcnt lgkmcnt(0)
    s_waitcnt vmcnt(3)
    v_mfma_f32_16x16x32_bf16 v[68:71], v[40:43], v[64:67], 0
    v_and_b32 v10, 1, v43
    v_cmp_ne_u32 s[54:55], s40, v10
    s_waitcnt vmcnt(2)
    v_mfma_f32_16x16x32_bf16 v[68:71], v[44:47], v[64:67], v[68:71]
    v_and_b32 v10, 1, v47
    v_cmp_ne_u32 s[56:57], s40, v10
    s_waitcnt vmcnt(1)
    v_mfma_f32_16x16x32_bf16 v[68:71], v[48:51], v[64:67], v[68:71]
    v_and_b32 v10, 1, v51
    v_cmp_ne_u32 s[58:59], s40, v10
    s_waitcnt vmcnt(0)
    v_mfma_f32_16x16x32_bf16 v[68:71], v[52:55], v[64:67], v[68:71]
    v_and_b32 v10, 1, v55
    v_cmp_ne_u32 s[60:61], s40, v10
    s_or_b64 vcc, s[54:55], s[56:57]
    s_or_b64 vcc, vcc, s[58:59]
    s_or_b64 vcc, vcc, s[60:61]
    s_cbranch_scc0 Lr1f_red
    s_mov_b32 s16, 0
Lr1f_p1:
    s_mov_b64 exec, s[54:55]
    buffer_load_dwordx4 v[40:43], v6, s[8:11], s62 offen sc1
    s_mov_b64 exec, s[56:57]
    buffer_load_dwordx4 v[44:47], v6, s[8:11], s63 offen sc1
    s_mov_b64 exec, s[58:59]
    buffer_load_dwordx4 v[48:51], v6, s[8:11], s64 offen sc1
    s_mov_b64 exec, s[60:61]
    buffer_load_dwordx4 v[52:55], v6, s[8:11], s65 offen sc1
    s_mov_b64 exec, -1
    s_add_u32 s16, s16, 1
    s_cmp_gt_u32 s16, 100000
    s_cbranch_scc1 Lr_abort
    s_waitcnt vmcnt(3)
    v_mfma_f32_16x16x32_bf16 v[68:71], v[40:43], v[64:67], 0
    v_and_b32 v10, 1, v43
    v_cmp_ne_u32 s[54:55], s40, v10
    s_waitcnt vmcnt(2)
    v_mfma_f32_16x16x32_bf16 v[68:71], v[44:47], v[64:67], v[68:71]
    v_and_b32 v10, 1, v47
    v_cmp_ne_u32 s[56:57], s40, v10
    s_waitcnt vmcnt(1)
    v_mfma_f32_16x16x32_bf16 v[68:71], v[48:51], v[64:67], v[68:71]
    v_and_b32 v10, 1, v51
    v_cmp_ne_u32 s[58:59], s40, v10
    s_waitcnt vmcnt(0)
    v_mfma_f32_16x16x32_bf16 v[68:71], v[52:55], v[64:67], v[68:71]
    v_and_b32 v10, 1, v55
    v_cmp_ne_u32 s[60:61], s40, v10
    s_or_b64 vcc, s[54:55], s[56:57]
    s_or_b64 vcc, vcc, s[58:59]
    s_or_b64 vcc, vcc, s[60:61]
    s_cbranch_scc1 Lr1f_p1
Lr1f_red:
    s_xor_b32 s34, s34, 16384
    s_xor_b32 s35, s35, 16384
    buffer_load_dwordx4 v[36:39], v0, s[8:11], s34 offen sc1
    v_permlane16_swap_b32 v68, v70
    v_permlane16_swap_b32 v69, v71
    s_mov_b64 exec, s[46:47]
    v_add_f32 v68, v68, v70
    v_add_f32 v69, v69, v71
    v_cvt_pk_bf16_f32 v68, v68, v69
    v_min_u32 v68, s50, v68
    buffer_store_dword v68, v7, s[8:11], s36 offen
    v_mov_b32 v69, -1
    buffer_store_dword v69, v7, s[8:11], s37 offen
    s_mov_b64 exec, -1
    buffer_load_dwordx4 v[36:39], v0, s[8:11], s34 offen sc1
    s_xor_b32 s40, s40, 1
    s_xor_b32 s36, s36, 16384
    s_xor_b32 s37, s37, 16384
    ds_read_b128 v[64:67], v8 offset:6144
    ds_read_b128 v[68:71], v8 offset:7168
    s_waitcnt lgkmcnt(0)
    s_branch Lr1f_step
Lr1f_pb_re:
    s_mov_b32 s16, 0
Lr1f_pb_lp:
    s_add_u32 s17, s34, 4096
    buffer_load_dwordx4 v[40:43], v0, s[8:11], s17 offen sc1
    s_add_u32 s16, s16, 1
    s_cmp_gt_u32 s16, 100000
    s_cbranch_scc1 Lr_abort
    s_waitcnt vmcnt(0)
    v_max3_u32 v10, v40, v41, v42
    v_max_u32 v10, v10, v43
    v_cmp_eq_u32 vcc, -1, v10
    s_nop 0
    s_cbranch_vccnz Lr1f_pb_lp
    s_branch Lr1f_pb_ok
Lr1f_pc_re:
    s_mov_b32 s16, 0
Lr1f_pc_lp:
    buffer_load_dwordx4 v[44:47], v0, s[8:11], s35 offen sc1
    s_add_u32 s16, s16, 1
    s_cmp_gt_u32 s16, 100000
    s_cbranch_scc1 Lr_abort
    s_waitcnt vmcnt(0)
    v_max3_u32 v10, v44, v45, v46
    v_max_u32 v10, v10, v47
    v_cmp_eq_u32 vcc, -1, v10
    s_nop 0
    s_cbranch_vccnz Lr1f_pc_lp
    s_branch Lr1f_pc_ok
Lr1f_last:
    s_waitcnt vmcnt(0) lgkmcnt(0)
    s_barrier
    s_mov_b32 s67, s66
    v_mov_b32 v9, 1
    v_mov_b32 v10, 0
    s_mov_b64 exec, 1
    buffer_store_dword v9, v10, s[8:11], s67 offen offset:384 sc1
    s_mov_b64 exec, -1
    s_branch Lr_exit
L_w2_1:
    s_cmp_lg_u32 s14, 2
    s_cbranch_scc1 L_w3_1
    s_mov_b32 s16, 0
    s_add_u32 s17, s66, 128
    v_lshrrev_b32 v10, 2, v0
    v_and_b32 v9, 16, v10
    v_lshlrev_b32 v9, 3, v9
    v_and_or_b32 v10, v10, 12, v9
Lr2f_fw_12:
    buffer_load_dword v9, v10, s[8:11], s17 offen sc1
    s_add_u32 s16, s16, 1
    s_cmp_gt_u32 s16, 100000
    s_cbranch_scc1 Lr_abort
    s_waitcnt vmcnt(0)
    v_cmp_eq_u32 vcc, 0, v9
    s_nop 0
    s_cbranch_vccnz Lr2f_fw_12
    s_mov_b32 m0, 19200
    s_nop 0
    buffer_load_dwordx4 v0, s[8:11], s41 offen offset:0 lds
    buffer_load_dwordx4 v0, s[8:11], s41 offen offset:1024 lds
    s_add_u32 s41, s41, 262144
    s_add_u32 s68, s68, 262144
    s_waitcnt vmcnt(0)
    ds_read_b128 v[56:59], v8 offset:4096
    ds_read_b128 v[60:63], v8 offset:5120
    ds_read_b128 v[64:67], v8 offset:6144
    ds_read_b128 v[68:71], v8 offset:7168
    v_mov_b64 v[12:13], 0
    v_mov_b64 v[14:15], 0
    v_mov_b64 v[16:17], 0
    v_mov_b64 v[18:19], 0
    v_mov_b64 v[20:21], 0
    v_mov_b64 v[22:23], 0
    v_mov_b64 v[24:25], 0
    v_mov_b64 v[26:27], 0
    v_mov_b64 v[28:29], 0
    v_mov_b64 v[30:31], 0
    v_mov_b64 v[32:33], 0
    v_mov_b64 v[34:35], 0
    buffer_load_dwordx4 v[36:39], v0, s[8:11], s34 offen sc1
    s_waitcnt vmcnt(0) lgkmcnt(0)
Lr2f_step:
    s_waitcnt vmcnt(3)
    v_max3_u32 v10, v36, v37, v38
    v_max_u32 v10, v10, v39
    v_cmp_eq_u32 vcc, -1, v10
    s_nop 0
    s_cbranch_vccz Lr2f_aok
    buffer_load_dwordx4 v[36:39], v0, s[8:11], s34 offen sc1
    s_nop 15
    s_nop 8
    buffer_load_dwordx4 v[36:39], v0, s[8:11], s34 offen sc1
    s_mov_b32 s16, 0
Lr2f_alp:
    s_waitcnt vmcnt(2)
    v_max3_u32 v10, v36, v37, v38
    v_max_u32 v10, v10, v39
    v_cmp_eq_u32 vcc, -1, v10
    s_nop 0
    s_cbranch_vccz Lr2f_aok
    buffer_load_dwordx4 v[36:39], v0, s[8:11], s34 offen sc1
    s_add_u32 s16, s16, 1
    s_cmp_gt_u32 s16, 100000
    s_cbranch_scc1 Lr_abort
    s_branch Lr2f_alp
Lr2f_aok:
    ds_write_b128 v0, v[36:39] offset:8960
    v_smfmac_f32_16x16x64_bf16 v[12:15], v[36:39], v[104:111], v1
    v_smfmac_f32_16x16x64_bf16 v[16:19], v[36:39], v[112:119], v1
    v_smfmac_f32_16x16x64_bf16 v[20:23], v[36:39], v[216:223], v1
    s_waitcnt lgkmcnt(0)
    s_barrier
    ds_read_b128 v[48:51], v0 offset:9984
    ds_read_b128 v[52:55], v0 offset:6912
    v_smfmac_f32_16x16x64_bf16 v[28:31], v[36:39], v[56:63], v1
    ds_read_b128 v[56:59], v8 offset:0
    ds_read_b128 v[60:63], v8 offset:1024
    v_smfmac_f32_16x16x64_bf16 v[24:27], v[36:39], v[224:231], v1
    v_smfmac_f32_16x16x64_bf16 v[32:35], v[36:39], v[64:71], v1
    ds_read_b128 v[64:67], v8 offset:2048
    ds_read_b128 v[68:71], v8 offset:3072
    s_add_u32 s17, s34, 4096
    buffer_load_dwordx4 v[40:43], v0, s[8:11], s17 offen sc1
    s_waitcnt vmcnt(1)
    ds_read_b128 v[36:39], v0 offset:7936
    s_waitcnt lgkmcnt(6)
    v_smfmac_f32_16x16x64_bf16 v[28:31], v[48:51], a[88:95], v1
    v_smfmac_f32_16x16x64_bf16 v[12:15], v[48:51], v[120:127], v1
    v_smfmac_f32_16x16x64_bf16 v[16:19], v[48:51], v[128:135], v1
    v_smfmac_f32_16x16x64_bf16 v[32:35], v[48:51], a[96:103], v1
    buffer_load_dwordx4 v[44:47], v0, s[8:11], s35 offen sc1
    v_smfmac_f32_16x16x64_bf16 v[20:23], v[48:51], v[232:239], v1
    v_lshrrev_b32 v10, 2, v0
    v_and_b32 v9, 16, v10
    v_lshlrev_b32 v9, 3, v9
    v_and_or_b32 v10, v10, 12, v9
    s_add_u32 s17, s66, 22656
    v_mov_b32 v11, 2
    buffer_load_dword v11, v10, s[8:11], s17 offen sc1
    v_smfmac_f32_16x16x64_bf16 v[24:27], v[48:51], v[240:247], v1
    s_waitcnt lgkmcnt(3)
    v_smfmac_f32_16x16x64_bf16 v[28:31], v[52:55], v[56:63], v1
    ds_read_b128 v[56:59], v8 offset:12288
    ds_read_b128 v[60:63], v8 offset:13312
    v_smfmac_f32_16x16x64_bf16 v[12:15], v[52:55], v[72:79], v1
    v_smfmac_f32_16x16x64_bf16 v[16:19], v[52:55], v[80:87], v1
    s_waitcnt lgkmcnt(3)
    v_smfmac_f32_16x16x64_bf16 v[32:35], v[52:55], v[64:71], v1
    ds_read_b128 v[64:67], v8 offset:14336
    ds_read_b128 v[68:71], v8 offset:15360
    v_smfmac_f32_16x16x64_bf16 v[20:23], v[52:55], v[184:191], v1
    v_smfmac_f32_16x16x64_bf16 v[24:27], v[52:55], v[192:199], v1
    s_waitcnt lgkmcnt(4)
    v_smfmac_f32_16x16x64_bf16 v[28:31], v[36:39], a[72:79], v1
    v_smfmac_f32_16x16x64_bf16 v[12:15], v[36:39], v[88:95], v1
    v_smfmac_f32_16x16x64_bf16 v[16:19], v[36:39], v[96:103], v1
    v_smfmac_f32_16x16x64_bf16 v[32:35], v[36:39], a[80:87], v1
    v_smfmac_f32_16x16x64_bf16 v[20:23], v[36:39], v[200:207], v1
    v_smfmac_f32_16x16x64_bf16 v[24:27], v[36:39], v[208:215], v1
    s_waitcnt vmcnt(2)
    v_max3_u32 v10, v40, v41, v42
    v_max_u32 v10, v10, v43
    v_cmp_eq_u32 vcc, -1, v10
    s_nop 0
    s_cbranch_vccnz Lr2f_pb_re
Lr2f_pb_ok:
    ds_write_b128 v0, v[40:43] offset:13056
    s_waitcnt lgkmcnt(3)
    v_smfmac_f32_16x16x64_bf16 v[12:15], v[40:43], v[56:63], v1
    ds_read_b128 v[56:59], v8 offset:8192
    ds_read_b128 v[60:63], v8 offset:9216
    v_smfmac_f32_16x16x64_bf16 v[20:23], v[40:43], a[24:31], v1
    s_waitcnt lgkmcnt(3)
    v_smfmac_f32_16x16x64_bf16 v[16:19], v[40:43], v[64:71], v1
    ds_read_b128 v[64:67], v8 offset:10240
    ds_read_b128 v[68:71], v8 offset:11264
    v_smfmac_f32_16x16x64_bf16 v[24:27], v[40:43], a[32:39], v1
    s_waitcnt lgkmcnt(4)
    s_barrier
    ds_read_b128 v[48:51], v0 offset:11008
    ds_read_b128 v[52:55], v0 offset:14080
    ds_read_b128 v[36:39], v0 offset:12032
    v_smfmac_f32_16x16x64_bf16 v[28:31], v[40:43], a[136:143], v1
    v_smfmac_f32_16x16x64_bf16 v[32:35], v[40:43], a[144:151], v1
    s_waitcnt lgkmcnt(2)
    v_smfmac_f32_16x16x64_bf16 v[12:15], v[48:51], v[56:63], v1
    v_smfmac_f32_16x16x64_bf16 v[16:19], v[48:51], v[64:71], v1
    s_waitcnt lgkmcnt(1)
    v_smfmac_f32_16x16x64_bf16 v[12:15], v[52:55], v[152:159], v1
    v_smfmac_f32_16x16x64_bf16 v[16:19], v[52:55], v[160:167], v1
    s_waitcnt lgkmcnt(0)
    v_smfmac_f32_16x16x64_bf16 v[12:15], v[36:39], v[136:143], v1
    v_smfmac_f32_16x16x64_bf16 v[16:19], v[36:39], v[144:151], v1
    s_waitcnt vmcnt(1)
    v_max3_u32 v10, v44, v45, v46
    v_max_u32 v10, v10, v47
    v_cmp_eq_u32 vcc, -1, v10
    s_nop 0
    s_cbranch_vccnz Lr2f_pc_re
Lr2f_pc_ok:
    v_smfmac_f32_16x16x64_bf16 v[12:15], v[44:47], v[168:175], v1
    v_smfmac_f32_16x16x64_bf16 v[16:19], v[44:47], v[176:183], v1
    v_smfmac_f32_16x16x64_bf16 v[20:23], v[48:51], v[248:255], v1
    v_smfmac_f32_16x16x64_bf16 v[24:27], v[48:51], a[0:7], v1
    v_smfmac_f32_16x16x64_bf16 v[20:23], v[52:55], a[40:47], v1
    v_add_f32 v12, v12, v14
    buffer_load_dwordx4 v[64:67], v0, s[8:11], s42 offen
    v_smfmac_f32_16x16x64_bf16 v[24:27], v[52:55], a[48:55], v1
    v_add_f32 v16, v16, v18
    v_smfmac_f32_16x16x64_bf16 v[20:23], v[36:39], a[8:15], v1
    v_add_f32 v13, v13, v15
    v_smfmac_f32_16x16x64_bf16 v[24:27], v[36:39], a[16:23], v1
    v_add_f32 v17, v17, v19
    v_smfmac_f32_16x16x64_bf16 v[20:23], v[44:47], a[56:63], v1
    v_cvt_pk_bf16_f32 v14, v12, v16
    ds_read_b128 v[56:59], v0 offset:15104
    buffer_load_dwordx4 v[68:71], v0, s[8:11], s42 offen offset:1024
    v_smfmac_f32_16x16x64_bf16 v[24:27], v[44:47], a[64:71], v1
    v_cvt_pk_bf16_f32 v15, v13, v17
    ds_read_b128 v[60:63], v0 offset:16128
    ds_write_b32 v2, v14 offset:576
    ds_write_b32 v2, v15 offset:864
    v_smfmac_f32_16x16x64_bf16 v[28:31], v[48:51], a[104:111], v1
    v_smfmac_f32_16x16x64_bf16 v[32:35], v[48:51], a[112:119], v1
    v_add_f32 v20, v20, v22
    v_add_f32 v24, v24, v26
    v_add_f32 v21, v21, v23
    v_add_f32 v25, v25, v27
    v_cvt_pk_bf16_f32 v22, v20, v24
    v_cvt_pk_bf16_f32 v23, v21, v25
    ds_write_b32 v2, v22 offset:0
    ds_write_b32 v2, v23 offset:288
    v_smfmac_f32_16x16x64_bf16 v[28:31], v[52:55], a[152:159], v1
    v_smfmac_f32_16x16x64_bf16 v[32:35], v[52:55], a[160:167], v1
    s_waitcnt vmcnt(2)
    v_cmp_eq_u32 vcc, 0, v11
    s_nop 0
    s_cbranch_vccnz Lr2f_flbad
Lr2f_flok:
    s_waitcnt lgkmcnt(0)
    s_barrier
    ds_read_b128 v[40:43], v3 offset:0
    ds_read_b128 v[48:51], v3 offset:64
    ds_read_b128 v[20:23], v3 offset:128
    ds_read_b128 v[52:55], v3 offset:192
    v_smfmac_f32_16x16x64_bf16 v[28:31], v[36:39], a[120:127], v1
    v_smfmac_f32_16x16x64_bf16 v[32:35], v[36:39], a[128:135], v1
    ds_read_b128 v[36:39], v0 offset:17152
    v_smfmac_f32_16x16x64_bf16 v[28:31], v[44:47], a[168:175], v1
    v_smfmac_f32_16x16x64_bf16 v[32:35], v[44:47], a[176:183], v1
    ds_read_b128 v[44:47], v0 offset:18176
    s_waitcnt lgkmcnt(5)
    v_mfma_f32_16x16x32_bf16 v[12:15], v[56:59], v[40:43], 0
    v_mfma_f32_16x16x32_bf16 v[16:19], v[60:63], v[40:43], 0
    v_mfma_f32_16x16x32_bf16 v[24:27], v[40:43], v[40:43], 0
    ds_read_b128 v[56:59], v0 offset:19200
    ds_read_b128 v[60:63], v0 offset:20224
    s_waitcnt lgkmcnt(3)
    v_mfma_f32_16x16x32_bf16 v[12:15], v[36:39], v[48:51], v[12:15]
    v_lshrrev_b32 v10, 1, v0
    v_lshrrev_b32 v9, 9, v0
    s_waitcnt lgkmcnt(2)
    v_mfma_f32_16x16x32_bf16 v[16:19], v[44:47], v[48:51], v[16:19]
    v_lshl_add_u32 v9, v9, 5, v10
    v_add_f32 v28, v28, v30
    v_mfma_f32_16x16x32_bf16 v[24:27], v[48:51], v[48:51], v[24:27]
    v_add_f32 v32, v32, v34
    v_add_f32 v29, v29, v31
    ds_read_b128 v[36:39], v0 offset:21248
    ds_read_b128 v[44:47], v0 offset:22272
    s_waitcnt lgkmcnt(3)
    v_mfma_f32_16x16x32_bf16 v[12:15], v[56:59], v[20:23], v[12:15]
    v_add_f32 v33, v33, v35
    v_cvt_pk_bf16_f32 v30, v28, v29
    s_waitcnt lgkmcnt(2)
    v_mfma_f32_16x16x32_bf16 v[16:19], v[60:63], v[20:23], v[16:19]
    v_cvt_pk_bf16_f32 v31, v32, v33
    ds_read_b64 v[34:35], v9 offset:2304
    v_mfma_f32_16x16x32_bf16 v[24:27], v[20:23], v[20:23], v[24:27]
    s_add_u32 s17, s43, 3072
    buffer_store_dwordx2 v[30:31], v10, s[8:11], s17 offen sc1
    s_waitcnt lgkmcnt(2)
    v_mfma_f32_16x16x32_bf16 v[12:15], v[36:39], v[52:55], v[12:15]
    s_waitcnt lgkmcnt(1)
    v_mfma_f32_16x16x32_bf16 v[16:19], v[44:47], v[52:55], v[16:19]
    v_mfma_f32_16x16x32_bf16 v[24:27], v[52:55], v[52:55], v[24:27]
    s_add_u32 s17, s43, 1024
    s_waitcnt lgkmcnt(0)
    buffer_store_dwordx2 v[34:35], v10, s[8:11], s17 offen sc1
    s_cmp_eq_u32 s33, 63
    s_cbranch_scc1 Lr2f_last
    ds_read_b128 v[56:59], v8 offset:16384
    ds_read_b128 v[60:63], v8 offset:17408
    v_mov_b64 v[20:21], s[52:53]
    v_mov_b64 v[22:23], s[52:53]
    v_mov_b32 v41, 0
    v_mov_b32 v42, 0
    v_max3_f32 v9, v12, v13, v14
    v_max3_f32 v9, v9, v15, v16
    v_max3_f32 v9, v9, v17, v18
    v_max3_f32 v9, v9, v19, v24
    v_max_f32 v9, v9, v25
    v_mov_b32 v10, v9
    v_mov_b64 v[32:33], 0
    v_mov_b64 v[34:35], 0
    v_permlane32_swap_b32 v9, v10
    v_max_f32 v9, v9, v10
    v_mov_b32 v10, v9
    s_nop 1
    v_permlane16_swap_b32 v9, v10
    v_max_f32 v9, v9, v10
    v_mul_f32 v28, s44, v9
    v_fma_f32 v12, v12, s44, -v28
    v_fma_f32 v13, v13, s44, -v28
    v_fma_f32 v14, v14, s44, -v28
    v_fma_f32 v15, v15, s44, -v28
    v_exp_f32 v12, v12
    v_exp_f32 v13, v13
    v_fma_f32 v16, v16, s44, -v28
    v_fma_f32 v17, v17, s44, -v28
    v_exp_f32 v14, v14
    v_exp_f32 v15, v15
    v_cvt_pk_bf16_f32 v36, v12, v13
    v_fma_f32 v18, v18, s44, -v28
    v_fma_f32 v19, v19, s44, -v28
    v_exp_f32 v16, v16
    v_exp_f32 v17, v17
    v_cvt_pk_bf16_f32 v37, v14, v15
    v_fma_f32 v24, v24, s44, -v28
    v_fma_f32 v25, v25, s44, -v28
    v_exp_f32 v18, v18
    v_exp_f32 v19, v19
    v_cvt_pk_bf16_f32 v38, v16, v17
    v_exp_f32 v24, v24
    v_exp_f32 v25, v25
    v_cvt_pk_bf16_f32 v39, v18, v19
    v_cvt_pk_bf16_f32 v40, v24, v25
    v_cvt_pk_bf16_f32 v43, v24, v25
    v_mfma_f32_16x16x32_bf16 v[52:55], v[20:23], v[36:39], 0
    v_mov_b64 v[12:13], 0
    v_mov_b64 v[14:15], 0
    s_waitcnt vmcnt(3)
    v_mfma_f32_16x16x32_bf16 v[44:47], v[64:67], v[36:39], 0
    v_mov_b64 v[24:25], 0
    v_mov_b64 v[26:27], 0
    s_waitcnt vmcnt(2)
    v_mfma_f32_16x16x32_bf16 v[48:51], v[68:71], v[36:39], 0
    ds_read_b128 v[64:67], v8 offset:20480
    ds_read_b128 v[68:71], v8 offset:21504
    v_mfma_f32_16x16x16_bf16 v[52:55], v[20:21], v[40:41], v[52:55]
    v_mfma_f32_16x16x16_bf16 v[44:47], v[30:31], v[40:41], v[44:47]
    v_mov_b64 v[20:21], 0
    v_mov_b64 v[22:23], 0
    v_mfma_f32_16x16x16_bf16 v[48:51], v[30:31], v[42:43], v[48:51]
    v_mov_b64 v[36:37], 0
    v_mov_b64 v[38:39], 0
    v_mov_b64 v[40:41], 0
    v_mov_b64 v[42:43], 0
    v_rcp_f32 v9, v52
    v_mov_b64 v[52:53], 0
    v_mov_b64 v[54:55], 0
    v_mul_f32 v44, v9, v44
    v_mul_f32 v48, v9, v48
    v_cvt_pk_bf16_f32 v16, v44, v48
    v_mul_f32 v45, v9, v45
    v_mul_f32 v49, v9, v49
    v_cvt_pk_bf16_f32 v17, v45, v49
    v_mul_f32 v46, v9, v46
    v_mul_f32 v50, v9, v50
    v_cvt_pk_bf16_f32 v18, v46, v50
    v_mul_f32 v47, v9, v47
    v_mul_f32 v51, v9, v51
    v_cvt_pk_bf16_f32 v19, v47, v51
    ds_write_b128 v5, v[16:19]
    v_mov_b64 v[28:29], 0
    v_mov_b64 v[30:31], 0
    s_waitcnt lgkmcnt(0)
    s_barrier
    ds_read_b128 v[44:47], v4 offset:0
    ds_read_b128 v[48:51], v4 offset:128
    v_mov_b64 v[16:17], 0
    v_mov_b64 v[18:19], 0
    buffer_load_dwordx4 v0, s[8:11], s41 offen offset:0 lds
    buffer_load_dwordx4 v0, s[8:11], s41 offen offset:1024 lds
    s_waitcnt lgkmcnt(1)
    v_smfmac_f32_16x16x64_bf16 v[12:15], v[44:47], a[184:191], v1
    s_waitcnt lgkmcnt(0)
    v_smfmac_f32_16x16x64_bf16 v[12:15], v[48:51], a[192:199], v1
    v_smfmac_f32_16x16x64_bf16 v[24:27], v[44:47], a[200:207], v1
    v_smfmac_f32_16x16x64_bf16 v[24:27], v[48:51], a[208:215], v1
    v_add_f32 v12, v12, v14
    v_smfmac_f32_16x16x64_bf16 v[20:23], v[44:47], a[216:223], v1
    v_add_f32 v13, v13, v15
    v_smfmac_f32_16x16x64_bf16 v[20:23], v[48:51], a[224:231], v1
    v_cvt_pk_bf16_f32 v12, v12, v13
    v_smfmac_f32_16x16x64_bf16 v[16:19], v[44:47], a[232:239], v1
    v_add_f32 v24, v24, v26
    v_smfmac_f32_16x16x64_bf16 v[16:19], v[48:51], a[240:247], v1
    v_add_f32 v25, v25, v27
    v_smfmac_f32_16x16x64_bf16 v[36:39], v[44:47], v[56:63], v1
    v_cvt_pk_bf16_f32 v13, v24, v25
    v_smfmac_f32_16x16x64_bf16 v[36:39], v[48:51], v[64:71], v1
    v_add_f32 v20, v20, v22
    v_add_f32 v21, v21, v23
    v_cvt_pk_bf16_f32 v14, v20, v21
    v_add_f32 v16, v16, v18
    v_add_f32 v17, v17, v19
    v_cvt_pk_bf16_f32 v15, v16, v17
    v_and_or_b32 v15, v15, -2, s40
    buffer_store_dwordx4 v[12:15], v0, s[8:11], s38 offen
    s_nop 0
    ds_read_b128 v[12:15], v8 offset:18432
    ds_read_b128 v[16:19], v8 offset:19456
    ds_read_b128 v[20:23], v8 offset:22528
    ds_read_b128 v[24:27], v8 offset:23552
    ds_read_b128 v[56:59], v8 offset:24576
    ds_read_b128 v[60:63], v8 offset:25600
    ds_read_b128 v[64:67], v8 offset:28672
    ds_read_b128 v[68:71], v8 offset:29696
    s_waitcnt lgkmcnt(6)
    v_smfmac_f32_16x16x64_bf16 v[40:43], v[44:47], v[12:19], v1
    ds_read_b128 v[12:15], v8 offset:26624
    ds_read_b128 v[16:19], v8 offset:27648
    s_waitcnt lgkmcnt(6)
    v_smfmac_f32_16x16x64_bf16 v[40:43], v[48:51], v[20:27], v1
    ds_read_b128 v[20:23], v8 offset:30720
    ds_read_b128 v[24:27], v8 offset:31744
    s_waitcnt lgkmcnt(6)
    v_smfmac_f32_16x16x64_bf16 v[52:55], v[44:47], v[56:63], v1
    ds_read_b128 v[56:59], v8 offset:32768
    ds_read_b128 v[60:63], v8 offset:33792
    s_waitcnt lgkmcnt(6)
    v_smfmac_f32_16x16x64_bf16 v[52:55], v[48:51], v[64:71], v1
    s_waitcnt lgkmcnt(4)
    v_smfmac_f32_16x16x64_bf16 v[32:35], v[44:47], v[12:19], v1
    s_waitcnt lgkmcnt(2)
    v_smfmac_f32_16x16x64_bf16 v[32:35], v[48:51], v[20:27], v1
    v_smfmac_f32_16x16x64_bf16 v[28:31], v[44:47], a[248:255], v1
    s_waitcnt lgkmcnt(0)
    v_smfmac_f32_16x16x64_bf16 v[28:31], v[48:51], v[56:63], v1
    v_add_f32 v36, v36, v38
    v_add_f32 v37, v37, v39
    v_cvt_pk_bf16_f32 v36, v36, v37
    v_add_f32 v40, v40, v42
    v_add_f32 v41, v41, v43
    v_cvt_pk_bf16_f32 v37, v40, v41
    v_add_f32 v52, v52, v54
    v_add_f32 v53, v53, v55
    v_cvt_pk_bf16_f32 v38, v52, v53
    v_add_f32 v32, v32, v34
    v_add_f32 v33, v33, v35
    v_cvt_pk_bf16_f32 v39, v32, v33
    v_and_or_b32 v39, v39, -2, s40
    s_add_u32 s17, s38, 4096
    buffer_store_dwordx4 v[36:39], v0, s[8:11], s17 offen
    v_add_f32 v28, v28, v30
    v_add_f32 v29, v29, v31
    v_cvt_pk_bf16_f32 v28, v28, v29
    v_and_or_b32 v28, v28, -2, s40
    v_lshrrev_b32 v9, 2, v0
    buffer_store_dword v28, v9, s[8:11], s39 offen
    v_add_u32 v10, 162560, v0
    ds_read_b32 v64, v10
    v_mov_b32 v65, 0
    v_mov_b32 v41, 0
    v_mov_b32 v45, 0
    v_mov_b32 v49, 0
    v_mov_b32 v53, 0
    s_add_u32 s33, s33, 1
    s_add_u32 s42, s42, 262144
    s_add_u32 s41, s41, 262144
    s_add_u32 s43, s43, 131072
    s_add_u32 s68, s68, 262144
    s_add_u32 s66, s66, 22528
    ds_read_b128 v[56:59], v8 offset:4096
    ds_read_b128 v[60:63], v8 offset:5120
    v_mov_b64 v[12:13], 0
    v_mov_b64 v[14:15], 0
    v_mov_b64 v[16:17], 0
    v_mov_b64 v[18:19], 0
    v_mov_b64 v[20:21], 0
    v_mov_b64 v[22:23], 0
    v_mov_b64 v[24:25], 0
    v_mov_b64 v[26:27], 0
    v_mov_b64 v[28:29], 0
    v_mov_b64 v[30:31], 0
    v_mov_b64 v[32:33], 0
    v_mov_b64 v[34:35], 0
    s_nop 15
    s_nop 15
    s_nop 15
    s_nop 1
    buffer_load_dword v40, v6, s[8:11], s62 offen sc1
    buffer_load_dword v44, v6, s[8:11], s63 offen sc1
    buffer_load_dword v48, v6, s[8:11], s64 offen sc1
    buffer_load_dword v52, v6, s[8:11], s65 offen sc1
    s_waitcnt lgkmcnt(0)
    s_waitcnt vmcnt(3)
    v_mfma_f32_16x16x16_bf16 v[68:71], v[40:41], v[64:65], 0
    v_and_b32 v10, 1, v40
    v_cmp_ne_u32 s[54:55], s40, v10
    s_waitcnt vmcnt(2)
    v_mfma_f32_16x16x16_bf16 v[68:71], v[44:45], v[64:65], v[68:71]
    v_and_b32 v10, 1, v44
    v_cmp_ne_u32 s[56:57], s40, v10
    s_waitcnt vmcnt(1)
    v_mfma_f32_16x16x16_bf16 v[68:71], v[48:49], v[64:65], v[68:71]
    v_and_b32 v10, 1, v48
    v_cmp_ne_u32 s[58:59], s40, v10
    s_waitcnt vmcnt(0)
    v_mfma_f32_16x16x16_bf16 v[68:71], v[52:53], v[64:65], v[68:71]
    v_and_b32 v10, 1, v52
    v_cmp_ne_u32 s[60:61], s40, v10
    s_or_b64 vcc, s[54:55], s[56:57]
    s_or_b64 vcc, vcc, s[58:59]
    s_or_b64 vcc, vcc, s[60:61]
    s_cbranch_scc0 Lr2f_red
    s_mov_b32 s16, 0
Lr2f_p1:
    s_mov_b64 exec, s[54:55]
    buffer_load_dword v40, v6, s[8:11], s62 offen sc1
    s_mov_b64 exec, s[56:57]
    buffer_load_dword v44, v6, s[8:11], s63 offen sc1
    s_mov_b64 exec, s[58:59]
    buffer_load_dword v48, v6, s[8:11], s64 offen sc1
    s_mov_b64 exec, s[60:61]
    buffer_load_dword v52, v6, s[8:11], s65 offen sc1
    s_mov_b64 exec, -1
    s_add_u32 s16, s16, 1
    s_cmp_gt_u32 s16, 100000
    s_cbranch_scc1 Lr_abort
    s_waitcnt vmcnt(3)
    v_mfma_f32_16x16x16_bf16 v[68:71], v[40:41], v[64:65], 0
    v_and_b32 v10, 1, v40
    v_cmp_ne_u32 s[54:55], s40, v10
    s_waitcnt vmcnt(2)
    v_mfma_f32_16x16x16_bf16 v[68:71], v[44:45], v[64:65], v[68:71]
    v_and_b32 v10, 1, v44
    v_cmp_ne_u32 s[56:57], s40, v10
    s_waitcnt vmcnt(1)
    v_mfma_f32_16x16x16_bf16 v[68:71], v[48:49], v[64:65], v[68:71]
    v_and_b32 v10, 1, v48
    v_cmp_ne_u32 s[58:59], s40, v10
    s_waitcnt vmcnt(0)
    v_mfma_f32_16x16x16_bf16 v[68:71], v[52:53], v[64:65], v[68:71]
    v_and_b32 v10, 1, v52
    v_cmp_ne_u32 s[60:61], s40, v10
    s_or_b64 vcc, s[54:55], s[56:57]
    s_or_b64 vcc, vcc, s[58:59]
    s_or_b64 vcc, vcc, s[60:61]
    s_cbranch_scc1 Lr2f_p1
Lr2f_red:
    s_xor_b32 s34, s34, 16384
    s_xor_b32 s35, s35, 16384
    buffer_load_dwordx4 v[36:39], v0, s[8:11], s34 offen sc1
    v_permlane16_swap_b32 v68, v70
    v_permlane16_swap_b32 v69, v71
    s_mov_b64 exec, s[46:47]
    v_add_f32 v68, v68, v70
    v_add_f32 v69, v69, v71
    v_cvt_pk_bf16_f32 v68, v68, v69
    v_min_u32 v68, s50, v68
    buffer_store_dword v68, v7, s[8:11], s36 offen
    v_mov_b32 v69, -1
    buffer_store_dword v69, v7, s[8:11], s37 offen
    s_mov_b64 exec, -1
    buffer_load_dwordx4 v[36:39], v0, s[8:11], s34 offen sc1
    s_xor_b32 s40, s40, 1
    s_xor_b32 s36, s36, 16384
    s_xor_b32 s37, s37, 16384
    ds_read_b128 v[64:67], v8 offset:6144
    ds_read_b128 v[68:71], v8 offset:7168
    s_waitcnt lgkmcnt(0)
    s_branch Lr2f_step
Lr2f_pb_re:
    s_mov_b32 s16, 0
Lr2f_pb_lp:
    s_add_u32 s17, s34, 4096
    buffer_load_dwordx4 v[40:43], v0, s[8:11], s17 offen sc1
    s_add_u32 s16, s16, 1
    s_cmp_gt_u32 s16, 100000
    s_cbranch_scc1 Lr_abort
    s_waitcnt vmcnt(0)
    v_max3_u32 v10, v40, v41, v42
    v_max_u32 v10, v10, v43
    v_cmp_eq_u32 vcc, -1, v10
    s_nop 0
    s_cbranch_vccnz Lr2f_pb_lp
    s_branch Lr2f_pb_ok
Lr2f_pc_re:
    s_mov_b32 s16, 0
Lr2f_pc_lp:
    buffer_load_dwordx4 v[44:47], v0, s[8:11], s35 offen sc1
    s_add_u32 s16, s16, 1
    s_cmp_gt_u32 s16, 100000
    s_cbranch_scc1 Lr_abort
    s_waitcnt vmcnt(0)
    v_max3_u32 v10, v44, v45, v46
    v_max_u32 v10, v10, v47
    v_cmp_eq_u32 vcc, -1, v10
    s_nop 0
    s_cbranch_vccnz Lr2f_pc_lp
    s_branch Lr2f_pc_ok
Lr2f_flbad:
    s_cmp_eq_u32 s33, 63
    s_cbranch_scc1 Lr2f_flok
    s_mov_b32 s16, 0
    s_add_u32 s17, s66, 22656
    v_lshrrev_b32 v10, 2, v0
    v_and_b32 v9, 16, v10
    v_lshlrev_b32 v9, 3, v9
    v_and_or_b32 v10, v10, 12, v9
Lr2f_fw_13:
    buffer_load_dword v9, v10, s[8:11], s17 offen sc1
    s_add_u32 s16, s16, 1
    s_cmp_gt_u32 s16, 100000
    s_cbranch_scc1 Lr_abort
    s_waitcnt vmcnt(0)
    v_cmp_eq_u32 vcc, 0, v9
    s_nop 0
    s_cbranch_vccnz Lr2f_fw_13
    s_branch Lr2f_flok
Lr2f_last:
    s_waitcnt vmcnt(0) lgkmcnt(0)
    s_barrier
    s_branch Lr_exit
L_w3_1:
    s_mov_b32 s16, 0
    s_add_u32 s17, s66, 128
    v_lshrrev_b32 v10, 2, v0
    v_and_b32 v9, 16, v10
    v_lshlrev_b32 v9, 3, v9
    v_and_or_b32 v10, v10, 12, v9
Lr3f_fw_14:
    buffer_load_dword v9, v10, s[8:11], s17 offen sc1
    s_add_u32 s16, s16, 1
    s_cmp_gt_u32 s16, 100000
    s_cbranch_scc1 Lr_abort
    s_waitcnt vmcnt(0)
    v_cmp_eq_u32 vcc, 0, v9
    s_nop 0
    s_cbranch_vccnz Lr3f_fw_14
    s_mov_b32 m0, 21248
    s_nop 0
    buffer_load_dwordx4 v0, s[8:11], s41 offen offset:0 lds
    buffer_load_dwordx4 v0, s[8:11], s41 offen offset:1024 lds
    s_add_u32 s41, s41, 262144
    s_add_u32 s68, s68, 262144
    s_waitcnt vmcnt(0)
    ds_read_b128 v[56:59], v8 offset:0
    ds_read_b128 v[60:63], v8 offset:1024
    ds_read_b128 v[64:67], v8 offset:2048
    ds_read_b128 v[68:71], v8 offset:3072
    v_mov_b64 v[12:13], 0
    v_mov_b64 v[14:15], 0
    v_mov_b64 v[16:17], 0
    v_mov_b64 v[18:19], 0
    v_mov_b64 v[20:21], 0
    v_mov_b64 v[22:23], 0
    v_mov_b64 v[24:25], 0
    v_mov_b64 v[26:27], 0
    v_mov_b64 v[28:29], 0
    v_mov_b64 v[30:31], 0
    v_mov_b64 v[32:33], 0
    v_mov_b64 v[34:35], 0
    buffer_load_dwordx4 v[36:39], v0, s[8:11], s34 offen sc1
    s_waitcnt vmcnt(0) lgkmcnt(0)
Lr3f_step:
    s_mov_b32 s16, 0
Lr3f_alp:
    s_waitcnt vmcnt(2)
    v_max3_u32 v10, v36, v37, v38
    v_max_u32 v10, v10, v39
    v_cmp_eq_u32 vcc, -1, v10
    s_nop 0
    s_cbranch_vccz Lr3f_aok
    buffer_load_dwordx4 v[36:39], v0, s[8:11], s34 offen sc1
    s_add_u32 s16, s16, 1
    s_cmp_gt_u32 s16, 100000
    s_cbranch_scc1 Lr_abort
    s_branch Lr3f_alp
Lr3f_aok:
    ds_write_b128 v0, v[36:39] offset:9984
    v_smfmac_f32_16x16x64_bf16 v[12:15], v[36:39], v[120:127], v1
    v_smfmac_f32_16x16x64_bf16 v[16:19], v[36:39], v[128:135], v1
    v_smfmac_f32_16x16x64_bf16 v[20:23], v[36:39], v[232:239], v1
    s_waitcnt lgkmcnt(0)
    s_barrier
    ds_read_b128 v[48:51], v0 offset:6912
    ds_read_b128 v[52:55], v0 offset:7936
    v_smfmac_f32_16x16x64_bf16 v[28:31], v[36:39], a[88:95], v1
    v_smfmac_f32_16x16x64_bf16 v[24:27], v[36:39], v[240:247], v1
    v_smfmac_f32_16x16x64_bf16 v[32:35], v[36:39], a[96:103], v1
    s_waitcnt vmcnt(0)
    ds_read_b128 v[36:39], v0 offset:8960
    s_waitcnt lgkmcnt(2)
    v_smfmac_f32_16x16x64_bf16 v[28:31], v[48:51], v[56:63], v1
    ds_read_b128 v[56:59], v8 offset:4096
    ds_read_b128 v[60:63], v8 offset:5120
    s_add_u32 s17, s34, 4096
    buffer_load_dwordx4 v[40:43], v0, s[8:11], s17 offen sc1
    v_smfmac_f32_16x16x64_bf16 v[12:15], v[48:51], v[72:79], v1
    v_smfmac_f32_16x16x64_bf16 v[16:19], v[48:51], v[80:87], v1
    v_smfmac_f32_16x16x64_bf16 v[32:35], v[48:51], v[64:71], v1
    ds_read_b128 v[64:67], v8 offset:6144
    ds_read_b128 v[68:71], v8 offset:7168
    v_smfmac_f32_16x16x64_bf16 v[20:23], v[48:51], v[184:191], v1
    buffer_load_dwordx4 v[44:47], v0, s[8:11], s35 offen sc1
    v_smfmac_f32_16x16x64_bf16 v[24:27], v[48:51], v[192:199], v1
    s_waitcnt lgkmcnt(5)
    v_smfmac_f32_16x16x64_bf16 v[28:31], v[52:55], a[72:79], v1
    v_smfmac_f32_16x16x64_bf16 v[12:15], v[52:55], v[88:95], v1
    v_smfmac_f32_16x16x64_bf16 v[16:19], v[52:55], v[96:103], v1
    v_smfmac_f32_16x16x64_bf16 v[32:35], v[52:55], a[80:87], v1
    v_smfmac_f32_16x16x64_bf16 v[20:23], v[52:55], v[200:207], v1
    v_smfmac_f32_16x16x64_bf16 v[24:27], v[52:55], v[208:215], v1
    s_waitcnt lgkmcnt(2)
    v_smfmac_f32_16x16x64_bf16 v[28:31], v[36:39], v[56:63], v1
    ds_read_b128 v[56:59], v8 offset:8192
    ds_read_b128 v[60:63], v8 offset:9216
    v_smfmac_f32_16x16x64_bf16 v[12:15], v[36:39], v[104:111], v1
    v_smfmac_f32_16x16x64_bf16 v[16:19], v[36:39], v[112:119], v1
    s_waitcnt lgkmcnt(2)
    v_smfmac_f32_16x16x64_bf16 v[32:35], v[36:39], v[64:71], v1
    ds_read_b128 v[64:67], v8 offset:10240
    ds_read_b128 v[68:71], v8 offset:11264
    v_smfmac_f32_16x16x64_bf16 v[20:23], v[36:39], v[216:223], v1
    v_smfmac_f32_16x16x64_bf16 v[24:27], v[36:39], v[224:231], v1
    s_waitcnt vmcnt(1)
    v_max3_u32 v10, v40, v41, v42
    v_max_u32 v10, v10, v43
    v_cmp_eq_u32 vcc, -1, v10
    s_nop 0
    s_cbranch_vccnz Lr3f_pb_re
Lr3f_pb_ok:
    ds_write_b128 v0, v[40:43] offset:14080
    v_smfmac_f32_16x16x64_bf16 v[12:15], v[40:43], v[152:159], v1
    v_smfmac_f32_16x16x64_bf16 v[20:23], v[40:43], a[40:47], v1
    v_smfmac_f32_16x16x64_bf16 v[16:19], v[40:43], v[160:167], v1
    v_smfmac_f32_16x16x64_bf16 v[24:27], v[40:43], a[48:55], v1
    s_waitcnt lgkmcnt(0)
    s_barrier
    ds_read_b128 v[48:51], v0 offset:11008
    ds_read_b128 v[52:55], v0 offset:12032
    ds_read_b128 v[36:39], v0 offset:13056
    v_smfmac_f32_16x16x64_bf16 v[28:31], v[40:43], a[152:159], v1
    v_smfmac_f32_16x16x64_bf16 v[32:35], v[40:43], a[160:167], v1
    s_waitcnt lgkmcnt(2)
    v_smfmac_f32_16x16x64_bf16 v[12:15], v[48:51], v[56:63], v1
    ds_read_b128 v[56:59], v8 offset:12288
    ds_read_b128 v[60:63], v8 offset:13312
    v_smfmac_f32_16x16x64_bf16 v[16:19], v[48:51], v[64:71], v1
    ds_read_b128 v[64:67], v8 offset:14336
    ds_read_b128 v[68:71], v8 offset:15360
    s_waitcnt lgkmcnt(5)
    v_smfmac_f32_16x16x64_bf16 v[12:15], v[52:55], v[136:143], v1
    v_smfmac_f32_16x16x64_bf16 v[16:19], v[52:55], v[144:151], v1
    s_waitcnt vmcnt(0)
    v_max3_u32 v10, v44, v45, v46
    v_max_u32 v10, v10, v47
    v_cmp_eq_u32 vcc, -1, v10
    s_nop 0
    s_cbranch_vccnz Lr3f_pc_re
Lr3f_pc_ok:
    v_smfmac_f32_16x16x64_bf16 v[12:15], v[44:47], v[168:175], v1
    v_smfmac_f32_16x16x64_bf16 v[16:19], v[44:47], v[176:183], v1
    s_waitcnt lgkmcnt(2)
    v_smfmac_f32_16x16x64_bf16 v[12:15], v[36:39], v[56:63], v1
    s_waitcnt lgkmcnt(0)
    v_smfmac_f32_16x16x64_bf16 v[16:19], v[36:39], v[64:71], v1
    v_smfmac_f32_16x16x64_bf16 v[20:23], v[48:51], v[248:255], v1
    v_smfmac_f32_16x16x64_bf16 v[24:27], v[48:51], a[0:7], v1
    v_smfmac_f32_16x16x64_bf16 v[20:23], v[52:55], a[8:15], v1
    v_add_f32 v12, v12, v14
    v_smfmac_f32_16x16x64_bf16 v[24:27], v[52:55], a[16:23], v1
    v_add_f32 v16, v16, v18
    buffer_load_dwordx4 v[64:67], v0, s[8:11], s42 offen
    v_smfmac_f32_16x16x64_bf16 v[20:23], v[36:39], a[24:31], v1
    v_add_f32 v13, v13, v15
    v_smfmac_f32_16x16x64_bf16 v[24:27], v[36:39], a[32:39], v1
    v_add_f32 v17, v17, v19
    v_smfmac_f32_16x16x64_bf16 v[20:23], v[44:47], a[56:63], v1
    v_cvt_pk_bf16_f32 v14, v12, v16
    ds_read_b128 v[56:59], v0 offset:15104
    v_smfmac_f32_16x16x64_bf16 v[24:27], v[44:47], a[64:71], v1
    v_cvt_pk_bf16_f32 v15, v13, v17
    ds_read_b128 v[60:63], v0 offset:16128
    buffer_load_dwordx4 v[68:71], v0, s[8:11], s42 offen offset:1024
    ds_write_b32 v2, v14 offset:576
    ds_write_b32 v2, v15 offset:864
    v_smfmac_f32_16x16x64_bf16 v[28:31], v[48:51], a[104:111], v1
    v_smfmac_f32_16x16x64_bf16 v[32:35], v[48:51], a[112:119], v1
    v_add_f32 v20, v20, v22
    v_add_f32 v24, v24, v26
    v_add_f32 v21, v21, v23
    v_add_f32 v25, v25, v27
    v_cvt_pk_bf16_f32 v22, v20, v24
    v_cvt_pk_bf16_f32 v23, v21, v25
    ds_write_b32 v2, v22 offset:0
    ds_write_b32 v2, v23 offset:288
    v_smfmac_f32_16x16x64_bf16 v[28:31], v[52:55], a[120:127], v1
    v_smfmac_f32_16x16x64_bf16 v[32:35], v[52:55], a[128:135], v1
    s_waitcnt lgkmcnt(0)
    s_barrier
    ds_read_b128 v[40:43], v3 offset:0
    ds_read_b128 v[48:51], v3 offset:64
    ds_read_b128 v[20:23], v3 offset:128
    ds_read_b128 v[52:55], v3 offset:192
    v_smfmac_f32_16x16x64_bf16 v[28:31], v[36:39], a[136:143], v1
    v_smfmac_f32_16x16x64_bf16 v[32:35], v[36:39], a[144:151], v1
    ds_read_b128 v[36:39], v0 offset:17152
    v_lshlrev_b32 v9, 3, v0
    buffer_load_dword v11, v9, s[8:11], s68 offen
    v_smfmac_f32_16x16x64_bf16 v[28:31], v[44:47], a[168:175], v1
    v_smfmac_f32_16x16x64_bf16 v[32:35], v[44:47], a[176:183], v1
    ds_read_b128 v[44:47], v0 offset:18176
    s_waitcnt lgkmcnt(5)
    v_mfma_f32_16x16x32_bf16 v[12:15], v[56:59], v[40:43], 0
    v_mfma_f32_16x16x32_bf16 v[16:19], v[60:63], v[40:43], 0
    v_mfma_f32_16x16x32_bf16 v[24:27], v[40:43], v[40:43], 0
    ds_read_b128 v[56:59], v0 offset:19200
    ds_read_b128 v[60:63], v0 offset:20224
    s_waitcnt lgkmcnt(3)
    v_mfma_f32_16x16x32_bf16 v[12:15], v[36:39], v[48:51], v[12:15]
    v_lshrrev_b32 v10, 1, v0
    v_lshrrev_b32 v9, 9, v0
    s_waitcnt lgkmcnt(2)
    v_mfma_f32_16x16x32_bf16 v[16:19], v[44:47], v[48:51], v[16:19]
    v_lshl_add_u32 v9, v9, 5, v10
    v_add_f32 v28, v28, v30
    v_mfma_f32_16x16x32_bf16 v[24:27], v[48:51], v[48:51], v[24:27]
    v_add_f32 v32, v32, v34
    v_add_f32 v29, v29, v31
    ds_read_b128 v[36:39], v0 offset:21248
    ds_read_b128 v[44:47], v0 offset:22272
    s_waitcnt lgkmcnt(3)
    v_mfma_f32_16x16x32_bf16 v[12:15], v[56:59], v[20:23], v[12:15]
    v_add_f32 v33, v33, v35
    v_cvt_pk_bf16_f32 v30, v28, v29
    s_waitcnt lgkmcnt(2)
    v_mfma_f32_16x16x32_bf16 v[16:19], v[60:63], v[20:23], v[16:19]
    v_cvt_pk_bf16_f32 v31, v32, v33
    ds_read_b64 v[34:35], v9 offset:3456
    v_mfma_f32_16x16x32_bf16 v[24:27], v[20:23], v[20:23], v[24:27]
    s_add_u32 s17, s43, 3584
    buffer_store_dwordx2 v[30:31], v10, s[8:11], s17 offen sc1
    s_waitcnt lgkmcnt(2)
    v_mfma_f32_16x16x32_bf16 v[12:15], v[36:39], v[52:55], v[12:15]
    s_waitcnt lgkmcnt(1)
    v_mfma_f32_16x16x32_bf16 v[16:19], v[44:47], v[52:55], v[16:19]
    v_mfma_f32_16x16x32_bf16 v[24:27], v[52:55], v[52:55], v[24:27]
    s_add_u32 s17, s43, 1536
    s_waitcnt lgkmcnt(0)
    buffer_store_dwordx2 v[34:35], v10, s[8:11], s17 offen sc1
    s_cmp_eq_u32 s33, 63
    s_cbranch_scc1 Lr3f_last
    ds_read_b128 v[56:59], v8 offset:16384
    ds_read_b128 v[60:63], v8 offset:17408
    v_mov_b64 v[20:21], s[52:53]
    v_mov_b64 v[22:23], s[52:53]
    v_mov_b32 v41, 0
    v_mov_b32 v42, 0
    v_max3_f32 v9, v12, v13, v14
    v_max3_f32 v9, v9, v15, v16
    v_max3_f32 v9, v9, v17, v18
    v_max3_f32 v9, v9, v19, v24
    v_max_f32 v9, v9, v25
    v_mov_b32 v10, v9
    v_mov_b64 v[32:33], 0
    v_mov_b64 v[34:35], 0
    v_permlane32_swap_b32 v9, v10
    v_max_f32 v9, v9, v10
    v_mov_b32 v10, v9
    s_nop 1
    v_permlane16_swap_b32 v9, v10
    v_max_f32 v9, v9, v10
    v_mul_f32 v28, s44, v9
    v_fma_f32 v12, v12, s44, -v28
    v_fma_f32 v13, v13, s44, -v28
    v_fma_f32 v14, v14, s44, -v28
    v_fma_f32 v15, v15, s44, -v28
    v_exp_f32 v12, v12
    v_exp_f32 v13, v13
    v_fma_f32 v16, v16, s44, -v28
    v_fma_f32 v17, v17, s44, -v28
    v_exp_f32 v14, v14
    v_exp_f32 v15, v15
    v_cvt_pk_bf16_f32 v36, v12, v13
    v_fma_f32 v18, v18, s44, -v28
    v_fma_f32 v19, v19, s44, -v28
    v_exp_f32 v16, v16
    v_exp_f32 v17, v17
    v_cvt_pk_bf16_f32 v37, v14, v15
    v_fma_f32 v24, v24, s44, -v28
    v_fma_f32 v25, v25, s44, -v28
    v_exp_f32 v18, v18
    v_exp_f32 v19, v19
    v_cvt_pk_bf16_f32 v38, v16, v17
    v_exp_f32 v24, v24
    v_exp_f32 v25, v25
    v_cvt_pk_bf16_f32 v39, v18, v19
    v_cvt_pk_bf16_f32 v40, v24, v25
    v_cvt_pk_bf16_f32 v43, v24, v25
    v_mfma_f32_16x16x32_bf16 v[52:55], v[20:23], v[36:39], 0
    v_mov_b64 v[12:13], 0
    v_mov_b64 v[14:15], 0
    s_waitcnt vmcnt(4)
    v_mfma_f32_16x16x32_bf16 v[44:47], v[64:67], v[36:39], 0
    v_mov_b64 v[24:25], 0
    v_mov_b64 v[26:27], 0
    s_waitcnt vmcnt(3)
    v_mfma_f32_16x16x32_bf16 v[48:51], v[68:71], v[36:39], 0
    ds_read_b128 v[64:67], v8 offset:20480
    ds_read_b128 v[68:71], v8 offset:21504
    v_mfma_f32_16x16x16_bf16 v[52:55], v[20:21], v[40:41], v[52:55]
    v_mfma_f32_16x16x16_bf16 v[44:47], v[30:31], v[40:41], v[44:47]
    v_mov_b64 v[20:21], 0
    v_mov_b64 v[22:23], 0
    v_mfma_f32_16x16x16_bf16 v[48:51], v[30:31], v[42:43], v[48:51]
    v_mov_b64 v[36:37], 0
    v_mov_b64 v[38:39], 0
    v_mov_b64 v[40:41], 0
    v_mov_b64 v[42:43], 0
    v_rcp_f32 v9, v52
    v_mov_b64 v[52:53], 0
    v_mov_b64 v[54:55], 0
    v_mul_f32 v44, v9, v44
    v_mul_f32 v48, v9, v48
    v_cvt_pk_bf16_f32 v16, v44, v48
    v_mul_f32 v45, v9, v45
    v_mul_f32 v49, v9, v49
    v_cvt_pk_bf16_f32 v17, v45, v49
    v_mul_f32 v46, v9, v46
    v_mul_f32 v50, v9, v50
    v_cvt_pk_bf16_f32 v18, v46, v50
    v_mul_f32 v47, v9, v47
    v_mul_f32 v51, v9, v51
    v_cvt_pk_bf16_f32 v19, v47, v51
    ds_write_b128 v5, v[16:19]
    v_mov_b64 v[28:29], 0
    v_mov_b64 v[30:31], 0
    s_waitcnt lgkmcnt(0)
    s_barrier
    ds_read_b128 v[44:47], v4 offset:0
    ds_read_b128 v[48:51], v4 offset:128
    v_mov_b64 v[16:17], 0
    v_mov_b64 v[18:19], 0
    buffer_load_dwordx4 v0, s[8:11], s41 offen offset:0 lds
    buffer_load_dwordx4 v0, s[8:11], s41 offen offset:1024 lds
    s_waitcnt lgkmcnt(1)
    v_smfmac_f32_16x16x64_bf16 v[12:15], v[44:47], a[184:191], v1
    s_waitcnt lgkmcnt(0)
    v_smfmac_f32_16x16x64_bf16 v[12:15], v[48:51], a[192:199], v1
    v_smfmac_f32_16x16x64_bf16 v[24:27], v[44:47], a[200:207], v1
    v_smfmac_f32_16x16x64_bf16 v[24:27], v[48:51], a[208:215], v1
    v_add_f32 v12, v12, v14
    v_smfmac_f32_16x16x64_bf16 v[20:23], v[44:47], a[216:223], v1
    v_add_f32 v13, v13, v15
    v_smfmac_f32_16x16x64_bf16 v[20:23], v[48:51], a[224:231], v1
    v_cvt_pk_bf16_f32 v12, v12, v13
    v_smfmac_f32_16x16x64_bf16 v[16:19], v[44:47], a[232:239], v1
    v_add_f32 v24, v24, v26
    v_smfmac_f32_16x16x64_bf16 v[16:19], v[48:51], a[240:247], v1
    v_add_f32 v25, v25, v27
    v_smfmac_f32_16x16x64_bf16 v[36:39], v[44:47], v[56:63], v1
    v_cvt_pk_bf16_f32 v13, v24, v25
    v_smfmac_f32_16x16x64_bf16 v[36:39], v[48:51], v[64:71], v1
    v_add_f32 v20, v20, v22
    v_add_f32 v21, v21, v23
    v_cvt_pk_bf16_f32 v14, v20, v21
    v_add_f32 v16, v16, v18
    v_add_f32 v17, v17, v19
    v_cvt_pk_bf16_f32 v15, v16, v17
    v_and_or_b32 v15, v15, -2, s40
    buffer_store_dwordx4 v[12:15], v0, s[8:11], s38 offen
    s_nop 0
    ds_read_b128 v[12:15], v8 offset:18432
    ds_read_b128 v[16:19], v8 offset:19456
    ds_read_b128 v[20:23], v8 offset:22528
    ds_read_b128 v[24:27], v8 offset:23552
    ds_read_b128 v[56:59], v8 offset:24576
    ds_read_b128 v[60:63], v8 offset:25600
    ds_read_b128 v[64:67], v8 offset:28672
    ds_read_b128 v[68:71], v8 offset:29696
    s_waitcnt lgkmcnt(6)
    v_smfmac_f32_16x16x64_bf16 v[40:43], v[44:47], v[12:19], v1
    ds_read_b128 v[12:15], v8 offset:26624
    ds_read_b128 v[16:19], v8 offset:27648
    s_waitcnt lgkmcnt(6)
    v_smfmac_f32_16x16x64_bf16 v[40:43], v[48:51], v[20:27], v1
    ds_read_b128 v[20:23], v8 offset:30720
    ds_read_b128 v[24:27], v8 offset:31744
    s_waitcnt lgkmcnt(6)
    v_smfmac_f32_16x16x64_bf16 v[52:55], v[44:47], v[56:63], v1
    ds_read_b128 v[56:59], v8 offset:32768
    ds_read_b128 v[60:63], v8 offset:33792
    s_waitcnt lgkmcnt(6)
    v_smfmac_f32_16x16x64_bf16 v[52:55], v[48:51], v[64:71], v1
    s_waitcnt lgkmcnt(4)
    v_smfmac_f32_16x16x64_bf16 v[32:35], v[44:47], v[12:19], v1
    s_waitcnt lgkmcnt(2)
    v_smfmac_f32_16x16x64_bf16 v[32:35], v[48:51], v[20:27], v1
    v_smfmac_f32_16x16x64_bf16 v[28:31], v[44:47], a[248:255], v1
    s_waitcnt lgkmcnt(0)
    v_smfmac_f32_16x16x64_bf16 v[28:31], v[48:51], v[56:63], v1
    v_add_f32 v36, v36, v38
    v_add_f32 v37, v37, v39
    v_cvt_pk_bf16_f32 v36, v36, v37
    v_add_f32 v40, v40, v42
    v_add_f32 v41, v41, v43
    v_cvt_pk_bf16_f32 v37, v40, v41
    v_add_f32 v52, v52, v54
    v_add_f32 v53, v53, v55
    v_cvt_pk_bf16_f32 v38, v52, v53
    v_add_f32 v32, v32, v34
    v_add_f32 v33, v33, v35
    v_cvt_pk_bf16_f32 v39, v32, v33
    v_and_or_b32 v39, v39, -2, s40
    s_add_u32 s17, s38, 4096
    buffer_store_dwordx4 v[36:39], v0, s[8:11], s17 offen
    v_add_f32 v28, v28, v30
    v_add_f32 v29, v29, v31
    v_cvt_pk_bf16_f32 v28, v28, v29
    v_and_or_b32 v28, v28, -2, s40
    v_lshrrev_b32 v9, 2, v0
    buffer_store_dword v28, v9, s[8:11], s39 offen
    s_xor_b32 s34, s34, 16384
    s_xor_b32 s35, s35, 16384
    s_add_u32 s33, s33, 1
    s_add_u32 s42, s42, 262144
    s_add_u32 s41, s41, 262144
    s_add_u32 s43, s43, 131072
    s_add_u32 s68, s68, 262144
    s_add_u32 s66, s66, 22528
    s_xor_b32 s40, s40, 1
    ds_read_b128 v[56:59], v8 offset:0
    ds_read_b128 v[60:63], v8 offset:1024
    ds_read_b128 v[64:67], v8 offset:2048
    ds_read_b128 v[68:71], v8 offset:3072
    v_mov_b64 v[12:13], 0
    v_mov_b64 v[14:15], 0
    v_mov_b64 v[16:17], 0
    v_mov_b64 v[18:19], 0
    v_mov_b64 v[20:21], 0
    v_mov_b64 v[22:23], 0
    v_mov_b64 v[24:25], 0
    v_mov_b64 v[26:27], 0
    v_mov_b64 v[28:29], 0
    v_mov_b64 v[30:31], 0
    v_mov_b64 v[32:33], 0
    v_mov_b64 v[34:35], 0
    s_sleep 5
    s_nop 9
    buffer_load_dwordx4 v[36:39], v0, s[8:11], s34 offen sc1
    s_nop 15
    s_nop 8
    buffer_load_dwordx4 v[36:39], v0, s[8:11], s34 offen sc1
    s_nop 15
    s_nop 8
    buffer_load_dwordx4 v[36:39], v0, s[8:11], s34 offen sc1
    s_waitcnt lgkmcnt(0)
    s_branch Lr3f_step
Lr3f_pb_re:
    s_mov_b32 s16, 0
Lr3f_pb_lp:
    s_add_u32 s17, s34, 4096
    buffer_load_dwordx4 v[40:43], v0, s[8:11], s17 offen sc1
    s_add_u32 s16, s16, 1
    s_cmp_gt_u32 s16, 100000
    s_cbranch_scc1 Lr_abort
    s_waitcnt vmcnt(0)
    v_max3_u32 v10, v40, v41, v42
    v_max_u32 v10, v10, v43
    v_cmp_eq_u32 vcc, -1, v10
    s_nop 0
    s_cbranch_vccnz Lr3f_pb_lp
    s_branch Lr3f_pb_ok
Lr3f_pc_re:
    s_mov_b32 s16, 0
Lr3f_pc_lp:
    buffer_load_dwordx4 v[44:47], v0, s[8:11], s35 offen sc1
    s_add_u32 s16, s16, 1
    s_cmp_gt_u32 s16, 100000
    s_cbranch_scc1 Lr_abort
    s_waitcnt vmcnt(0)
    v_max3_u32 v10, v44, v45, v46
    v_max_u32 v10, v10, v47
    v_cmp_eq_u32 vcc, -1, v10
    s_nop 0
    s_cbranch_vccnz Lr3f_pc_lp
    s_branch Lr3f_pc_ok
Lr3f_last:
    s_waitcnt vmcnt(0) lgkmcnt(0)
    s_barrier
    s_branch Lr_exit
L_slow:
    s_cmp_lg_u32 s14, 0
    s_cbranch_scc1 L_w1_0
    s_mov_b32 s16, 0
    s_add_u32 s17, s66, 128
    v_lshrrev_b32 v10, 2, v0
    v_and_b32 v9, 16, v10
    v_lshlrev_b32 v9, 3, v9
    v_and_or_b32 v10, v10, 12, v9
Lr0s_fw_15:
    buffer_load_dword v9, v10, s[8:11], s17 offen sc1
    s_add_u32 s16, s16, 1
    s_cmp_gt_u32 s16, 100000
    s_cbranch_scc1 Lr_abort
    s_waitcnt vmcnt(0)
    v_cmp_eq_u32 vcc, 0, v9
    s_nop 0
    s_cbranch_vccnz Lr0s_fw_15
    s_mov_b32 m0, 15104
    s_nop 0
    buffer_load_dwordx4 v0, s[8:11], s41 offen offset:0 lds
    buffer_load_dwordx4 v0, s[8:11], s41 offen offset:1024 lds
    s_add_u32 s41, s41, 262144
    s_add_u32 s68, s68, 4278452224
    s_waitcnt vmcnt(0)
    ds_read_b128 v[56:59], v8 offset:0
    ds_read_b128 v[60:63], v8 offset:1024
    ds_read_b128 v[64:67], v8 offset:2048
    ds_read_b128 v[68:71], v8 offset:3072
    v_mov_b64 v[12:13], 0
    v_mov_b64 v[14:15], 0
    v_mov_b64 v[16:17], 0
    v_mov_b64 v[18:19], 0
    v_mov_b64 v[20:21], 0
    v_mov_b64 v[22:23], 0
    v_mov_b64 v[24:25], 0
    v_mov_b64 v[26:27], 0
    v_mov_b64 v[28:29], 0
    v_mov_b64 v[30:31], 0
    v_mov_b64 v[32:33], 0
    v_mov_b64 v[34:35], 0
    buffer_load_dwordx4 v[36:39], v0, s[8:11], s34 offen sc1
    s_waitcnt vmcnt(0) lgkmcnt(0)
Lr0s_step:
    s_mov_b32 s16, 0
Lr0s_alp:
    s_waitcnt vmcnt(2)
    v_max3_u32 v10, v36, v37, v38
    v_max_u32 v10, v10, v39
    v_cmp_eq_u32 vcc, -1, v10
    s_nop 0
    s_cbranch_vccz Lr0s_aok
    buffer_load_dwordx4 v[36:39], v0, s[8:11], s34 offen sc1
    s_add_u32 s16, s16, 1
    s_cmp_gt_u32 s16, 100000
    s_cbranch_scc1 Lr_abort
    s_branch Lr0s_alp
Lr0s_aok:
    ds_write_b128 v0, v[36:39] offset:6912
    v_smfmac_f32_16x16x64_bf16 v[12:15], v[36:39], v[72:79], v1
    v_smfmac_f32_16x16x64_bf16 v[16:19], v[36:39], v[80:87], v1
    v_smfmac_f32_16x16x64_bf16 v[20:23], v[36:39], v[184:191], v1
    s_waitcnt lgkmcnt(0)
    s_barrier
    ds_read_b128 v[48:51], v0 offset:7936
    ds_read_b128 v[52:55], v0 offset:8960
    v_smfmac_f32_16x16x64_bf16 v[28:31], v[36:39], v[56:63], v1
    ds_read_b128 v[56:59], v8 offset:4096
    ds_read_b128 v[60:63], v8 offset:5120
    s_add_u32 s17, s34, 4096
    buffer_load_dwordx4 v[40:43], v0, s[8:11], s17 offen sc1
    v_smfmac_f32_16x16x64_bf16 v[24:27], v[36:39], v[192:199], v1
    v_smfmac_f32_16x16x64_bf16 v[32:35], v[36:39], v[64:71], v1
    ds_read_b128 v[64:67], v8 offset:6144
    ds_read_b128 v[68:71], v8 offset:7168
    s_waitcnt vmcnt(1)
    ds_read_b128 v[36:39], v0 offset:9984
    s_waitcnt lgkmcnt(6)
    v_smfmac_f32_16x16x64_bf16 v[28:31], v[48:51], a[72:79], v1
    v_smfmac_f32_16x16x64_bf16 v[12:15], v[48:51], v[88:95], v1
    buffer_load_dwordx4 v[44:47], v0, s[8:11], s35 offen sc1
    v_smfmac_f32_16x16x64_bf16 v[16:19], v[48:51], v[96:103], v1
    v_smfmac_f32_16x16x64_bf16 v[32:35], v[48:51], a[80:87], v1
    v_smfmac_f32_16x16x64_bf16 v[20:23], v[48:51], v[200:207], v1
    v_smfmac_f32_16x16x64_bf16 v[24:27], v[48:51], v[208:215], v1
    s_waitcnt lgkmcnt(3)
    v_smfmac_f32_16x16x64_bf16 v[28:31], v[52:55], v[56:63], v1
    ds_read_b128 v[56:59], v8 offset:8192
    ds_read_b128 v[60:63], v8 offset:9216
    v_smfmac_f32_16x16x64_bf16 v[12:15], v[52:55], v[104:111], v1
    v_smfmac_f32_16x16x64_bf16 v[16:19], v[52:55], v[112:119], v1
    s_waitcnt lgkmcnt(3)
    v_smfmac_f32_16x16x64_bf16 v[32:35], v[52:55], v[64:71], v1
    ds_read_b128 v[64:67], v8 offset:10240
    ds_read_b128 v[68:71], v8 offset:11264
    v_smfmac_f32_16x16x64_bf16 v[20:23], v[52:55], v[216:223], v1
    v_smfmac_f32_16x16x64_bf16 v[24:27], v[52:55], v[224:231], v1
    s_waitcnt lgkmcnt(4)
    v_smfmac_f32_16x16x64_bf16 v[28:31], v[36:39], a[88:95], v1
    v_smfmac_f32_16x16x64_bf16 v[12:15], v[36:39], v[120:127], v1
    v_smfmac_f32_16x16x64_bf16 v[16:19], v[36:39], v[128:135], v1
    v_smfmac_f32_16x16x64_bf16 v[32:35], v[36:39], a[96:103], v1
    v_smfmac_f32_16x16x64_bf16 v[20:23], v[36:39], v[232:239], v1
    v_smfmac_f32_16x16x64_bf16 v[24:27], v[36:39], v[240:247], v1
    s_waitcnt vmcnt(1)
    v_max3_u32 v10, v40, v41, v42
    v_max_u32 v10, v10, v43
    v_cmp_eq_u32 vcc, -1, v10
    s_nop 0
    s_cbranch_vccnz Lr0s_pb_re
Lr0s_pb_ok:
    ds_write_b128 v0, v[40:43] offset:11008
    s_waitcnt lgkmcnt(3)
    v_smfmac_f32_16x16x64_bf16 v[12:15], v[40:43], v[56:63], v1
    ds_read_b128 v[56:59], v8 offset:12288
    ds_read_b128 v[60:63], v8 offset:13312
    v_smfmac_f32_16x16x64_bf16 v[20:23], v[40:43], v[248:255], v1
    s_waitcnt lgkmcnt(3)
    v_smfmac_f32_16x16x64_bf16 v[16:19], v[40:43], v[64:71], v1
    ds_read_b128 v[64:67], v8 offset:14336
    ds_read_b128 v[68:71], v8 offset:15360
    v_smfmac_f32_16x16x64_bf16 v[24:27], v[40:43], a[0:7], v1
    s_waitcnt lgkmcnt(4)
    s_barrier
    ds_read_b128 v[48:51], v0 offset:13056
    ds_read_b128 v[52:55], v0 offset:12032
    ds_read_b128 v[36:39], v0 offset:14080
    v_smfmac_f32_16x16x64_bf16 v[28:31], v[40:43], a[104:111], v1
    v_smfmac_f32_16x16x64_bf16 v[32:35], v[40:43], a[112:119], v1
    s_waitcnt lgkmcnt(2)
    v_smfmac_f32_16x16x64_bf16 v[12:15], v[48:51], v[56:63], v1
    v_smfmac_f32_16x16x64_bf16 v[16:19], v[48:51], v[64:71], v1
    s_waitcnt lgkmcnt(1)
    v_smfmac_f32_16x16x64_bf16 v[12:15], v[52:55], v[136:143], v1
    v_smfmac_f32_16x16x64_bf16 v[16:19], v[52:55], v[144:151], v1
    s_waitcnt lgkmcnt(0)
    v_smfmac_f32_16x16x64_bf16 v[12:15], v[36:39], v[152:159], v1
    v_smfmac_f32_16x16x64_bf16 v[16:19], v[36:39], v[160:167], v1
    s_waitcnt vmcnt(0)
    v_max3_u32 v10, v44, v45, v46
    v_max_u32 v10, v10, v47
    v_cmp_eq_u32 vcc, -1, v10
    s_nop 0
    s_cbranch_vccnz Lr0s_pc_re
Lr0s_pc_ok:
    v_smfmac_f32_16x16x64_bf16 v[12:15], v[44:47], v[168:175], v1
    v_smfmac_f32_16x16x64_bf16 v[16:19], v[44:47], v[176:183], v1
    v_smfmac_f32_16x16x64_bf16 v[20:23], v[48:51], a[24:31], v1
    buffer_load_dwordx4 v[64:67], v0, s[8:11], s42 offen
    v_smfmac_f32_16x16x64_bf16 v[24:27], v[48:51], a[32:39], v1
    v_smfmac_f32_16x16x64_bf16 v[20:23], v[52:55], a[8:15], v1
    v_add_f32 v12, v12, v14
    v_smfmac_f32_16x16x64_bf16 v[24:27], v[52:55], a[16:23], v1
    v_add_f32 v16, v16, v18
    v_smfmac_f32_16x16x64_bf16 v[20:23], v[36:39], a[40:47], v1
    v_add_f32 v13, v13, v15
    buffer_load_dwordx4 v[68:71], v0, s[8:11], s42 offen offset:1024
    v_smfmac_f32_16x16x64_bf16 v[24:27], v[36:39], a[48:55], v1
    v_add_f32 v17, v17, v19
    v_smfmac_f32_16x16x64_bf16 v[20:23], v[44:47], a[56:63], v1
    v_cvt_pk_bf16_f32 v14, v12, v16
    ds_read_b128 v[56:59], v0 offset:15104
    v_smfmac_f32_16x16x64_bf16 v[24:27], v[44:47], a[64:71], v1
    v_cvt_pk_bf16_f32 v15, v13, v17
    ds_read_b128 v[60:63], v0 offset:16128
    ds_write_b32 v2, v14 offset:576
    ds_write_b32 v2, v15 offset:864
    v_smfmac_f32_16x16x64_bf16 v[28:31], v[48:51], a[136:143], v1
    v_smfmac_f32_16x16x64_bf16 v[32:35], v[48:51], a[144:151], v1
    v_add_f32 v20, v20, v22
    v_add_f32 v24, v24, v26
    v_add_f32 v21, v21, v23
    v_add_f32 v25, v25, v27
    v_cvt_pk_bf16_f32 v22, v20, v24
    v_cvt_pk_bf16_f32 v23, v21, v25
    ds_write_b32 v2, v22 offset:0
    ds_write_b32 v2, v23 offset:288
    v_smfmac_f32_16x16x64_bf16 v[28:31], v[52:55], a[120:127], v1
    v_smfmac_f32_16x16x64_bf16 v[32:35], v[52:55], a[128:135], v1
    s_waitcnt lgkmcnt(0)
    s_barrier
    ds_read_b128 v[40:43], v3 offset:0
    ds_read_b128 v[48:51], v3 offset:64
    ds_read_b128 v[20:23], v3 offset:128
    ds_read_b128 v[52:55], v3 offset:192
    v_smfmac_f32_16x16x64_bf16 v[28:31], v[36:39], a[152:159], v1
    v_smfmac_f32_16x16x64_bf16 v[32:35], v[36:39], a[160:167], v1
    ds_read_b128 v[36:39], v0 offset:17152
    v_lshlrev_b32 v9, 3, v0
    buffer_load_dword v11, v9, s[8:11], s68 offen
    v_smfmac_f32_16x16x64_bf16 v[28:31], v[44:47], a[168:175], v1
    v_smfmac_f32_16x16x64_bf16 v[32:35], v[44:47], a[176:183], v1
    ds_read_b128 v[44:47], v0 offset:18176
    s_waitcnt lgkmcnt(5)
    v_mfma_f32_16x16x32_bf16 v[12:15], v[56:59], v[40:43], 0
    v_mfma_f32_16x16x32_bf16 v[16:19], v[60:63], v[40:43], 0
    v_mfma_f32_16x16x32_bf16 v[24:27], v[40:43], v[40:43], 0
    ds_read_b128 v[56:59], v0 offset:19200
    ds_read_b128 v[60:63], v0 offset:20224
    s_waitcnt lgkmcnt(3)
    v_mfma_f32_16x16x32_bf16 v[12:15], v[36:39], v[48:51], v[12:15]
    v_lshrrev_b32 v10, 1, v0
    v_lshrrev_b32 v9, 9, v0
    s_waitcnt lgkmcnt(2)
    v_mfma_f32_16x16x32_bf16 v[16:19], v[44:47], v[48:51], v[16:19]
    v_lshl_add_u32 v9, v9, 5, v10
    v_add_f32 v28, v28, v30
    v_mfma_f32_16x16x32_bf16 v[24:27], v[48:51], v[48:51], v[24:27]
    v_add_f32 v32, v32, v34
    v_add_f32 v29, v29, v31
    ds_read_b128 v[36:39], v0 offset:21248
    ds_read_b128 v[44:47], v0 offset:22272
    s_waitcnt lgkmcnt(3)
    v_mfma_f32_16x16x32_bf16 v[12:15], v[56:59], v[20:23], v[12:15]
    v_add_f32 v33, v33, v35
    v_cvt_pk_bf16_f32 v30, v28, v29
    s_waitcnt lgkmcnt(2)
    v_mfma_f32_16x16x32_bf16 v[16:19], v[60:63], v[20:23], v[16:19]
    v_cvt_pk_bf16_f32 v31, v32, v33
    ds_read_b64 v[34:35], v9 offset:0
    v_mfma_f32_16x16x32_bf16 v[24:27], v[20:23], v[20:23], v[24:27]
    s_add_u32 s17, s43, 2048
    buffer_store_dwordx2 v[30:31], v10, s[8:11], s17 offen sc1
    s_waitcnt lgkmcnt(2)
    v_mfma_f32_16x16x32_bf16 v[12:15], v[36:39], v[52:55], v[12:15]
    s_waitcnt lgkmcnt(1)
    v_mfma_f32_16x16x32_bf16 v[16:19], v[44:47], v[52:55], v[16:19]
    v_mfma_f32_16x16x32_bf16 v[24:27], v[52:55], v[52:55], v[24:27]
    s_add_u32 s17, s43, 0
    s_waitcnt lgkmcnt(0)
    buffer_store_dwordx2 v[34:35], v10, s[8:11], s17 offen sc1
    s_cmp_eq_u32 s33, 63
    s_cbranch_scc1 Lr0s_last
    ds_read_b128 v[56:59], v8 offset:16384
    ds_read_b128 v[60:63], v8 offset:17408
    v_mov_b64 v[20:21], s[52:53]
    v_mov_b64 v[22:23], s[52:53]
    v_mov_b32 v41, 0
    v_mov_b32 v42, 0
    v_max3_f32 v9, v12, v13, v14
    v_max3_f32 v9, v9, v15, v16
    v_max3_f32 v9, v9, v17, v18
    v_max3_f32 v9, v9, v19, v24
    v_max_f32 v9, v9, v25
    v_mov_b32 v10, v9
    v_mov_b64 v[32:33], 0
    v_mov_b64 v[34:35], 0
    v_permlane32_swap_b32 v9, v10
    v_max_f32 v9, v9, v10
    v_mov_b32 v10, v9
    s_nop 1
    v_permlane16_swap_b32 v9, v10
    v_max_f32 v9, v9, v10
    v_mul_f32 v28, s44, v9
    v_fma_f32 v12, v12, s44, -v28
    v_fma_f32 v13, v13, s44, -v28
    v_fma_f32 v14, v14, s44, -v28
    v_fma_f32 v15, v15, s44, -v28
    v_exp_f32 v12, v12
    v_exp_f32 v13, v13
    v_fma_f32 v16, v16, s44, -v28
    v_fma_f32 v17, v17, s44, -v28
    v_exp_f32 v14, v14
    v_exp_f32 v15, v15
    v_cvt_pk_bf16_f32 v36, v12, v13
    v_fma_f32 v18, v18, s44, -v28
    v_fma_f32 v19, v19, s44, -v28
    v_exp_f32 v16, v16
    v_exp_f32 v17, v17
    v_cvt_pk_bf16_f32 v37, v14, v15
    v_fma_f32 v24, v24, s44, -v28
    v_fma_f32 v25, v25, s44, -v28
    v_exp_f32 v18, v18
    v_exp_f32 v19, v19
    v_cvt_pk_bf16_f32 v38, v16, v17
    v_exp_f32 v24, v24
    v_exp_f32 v25, v25
    v_cvt_pk_bf16_f32 v39, v18, v19
    v_cvt_pk_bf16_f32 v40, v24, v25
    v_cvt_pk_bf16_f32 v43, v24, v25
    v_mfma_f32_16x16x32_bf16 v[52:55], v[20:23], v[36:39], 0
    v_mov_b64 v[12:13], 0
    v_mov_b64 v[14:15], 0
    s_waitcnt vmcnt(4)
    v_mfma_f32_16x16x32_bf16 v[44:47], v[64:67], v[36:39], 0
    v_mov_b64 v[24:25], 0
    v_mov_b64 v[26:27], 0
    s_waitcnt vmcnt(3)
    v_mfma_f32_16x16x32_bf16 v[48:51], v[68:71], v[36:39], 0
    ds_read_b128 v[64:67], v8 offset:20480
    ds_read_b128 v[68:71], v8 offset:21504
    v_mfma_f32_16x16x16_bf16 v[52:55], v[20:21], v[40:41], v[52:55]
    v_mfma_f32_16x16x16_bf16 v[44:47], v[30:31], v[40:41], v[44:47]
    v_mov_b64 v[20:21], 0
    v_mov_b64 v[22:23], 0
    v_mfma_f32_16x16x16_bf16 v[48:51], v[30:31], v[42:43], v[48:51]
    v_mov_b64 v[36:37], 0
    v_mov_b64 v[38:39], 0
    v_mov_b64 v[40:41], 0
    v_mov_b64 v[42:43], 0
    v_rcp_f32 v9, v52
    v_mov_b64 v[52:53], 0
    v_mov_b64 v[54:55], 0
    v_mul_f32 v44, v9, v44
    v_mul_f32 v48, v9, v48
    v_cvt_pk_bf16_f32 v16, v44, v48
    v_mul_f32 v45, v9, v45
    v_mul_f32 v49, v9, v49
    v_cvt_pk_bf16_f32 v17, v45, v49
    v_mul_f32 v46, v9, v46
    v_mul_f32 v50, v9, v50
    v_cvt_pk_bf16_f32 v18, v46, v50
    v_mul_f32 v47, v9, v47
    v_mul_f32 v51, v9, v51
    v_cvt_pk_bf16_f32 v19, v47, v51
    ds_write_b128 v5, v[16:19]
    v_mov_b64 v[28:29], 0
    v_mov_b64 v[30:31], 0
    s_waitcnt lgkmcnt(0)
    s_barrier
    ds_read_b128 v[44:47], v4 offset:0
    ds_read_b128 v[48:51], v4 offset:128
    v_mov_b64 v[16:17], 0
    v_mov_b64 v[18:19], 0
    buffer_load_dwordx4 v0, s[8:11], s41 offen offset:0 lds
    buffer_load_dwordx4 v0, s[8:11], s41 offen offset:1024 lds
    s_waitcnt lgkmcnt(1)
    v_smfmac_f32_16x16x64_bf16 v[12:15], v[44:47], a[184:191], v1
    s_waitcnt lgkmcnt(0)
    v_smfmac_f32_16x16x64_bf16 v[12:15], v[48:51], a[192:199], v1
    v_smfmac_f32_16x16x64_bf16 v[24:27], v[44:47], a[200:207], v1
    v_smfmac_f32_16x16x64_bf16 v[24:27], v[48:51], a[208:215], v1
    v_add_f32 v12, v12, v14
    v_smfmac_f32_16x16x64_bf16 v[20:23], v[44:47], a[216:223], v1
    v_add_f32 v13, v13, v15
    v_smfmac_f32_16x16x64_bf16 v[20:23], v[48:51], a[224:231], v1
    v_cvt_pk_bf16_f32 v12, v12, v13
    v_smfmac_f32_16x16x64_bf16 v[16:19], v[44:47], a[232:239], v1
    v_add_f32 v24, v24, v26
    v_smfmac_f32_16x16x64_bf16 v[16:19], v[48:51], a[240:247], v1
    v_add_f32 v25, v25, v27
    v_smfmac_f32_16x16x64_bf16 v[36:39], v[44:47], v[56:63], v1
    v_cvt_pk_bf16_f32 v13, v24, v25
    v_smfmac_f32_16x16x64_bf16 v[36:39], v[48:51], v[64:71], v1
    v_add_f32 v20, v20, v22
    v_add_f32 v21, v21, v23
    v_cvt_pk_bf16_f32 v14, v20, v21
    v_add_f32 v16, v16, v18
    v_add_f32 v17, v17, v19
    v_cvt_pk_bf16_f32 v15, v16, v17
    v_and_or_b32 v15, v15, -2, s40
    buffer_store_dwordx4 v[12:15], v0, s[8:11], s38 offen sc1
    s_nop 0
    ds_read_b128 v[12:15], v8 offset:18432
    ds_read_b128 v[16:19], v8 offset:19456
    ds_read_b128 v[20:23], v8 offset:22528
    ds_read_b128 v[24:27], v8 offset:23552
    ds_read_b128 v[56:59], v8 offset:24576
    ds_read_b128 v[60:63], v8 offset:25600
    ds_read_b128 v[64:67], v8 offset:28672
    ds_read_b128 v[68:71], v8 offset:29696
    s_waitcnt lgkmcnt(6)
    v_smfmac_f32_16x16x64_bf16 v[40:43], v[44:47], v[12:19], v1
    ds_read_b128 v[12:15], v8 offset:26624
    ds_read_b128 v[16:19], v8 offset:27648
    s_waitcnt lgkmcnt(6)
    v_smfmac_f32_16x16x64_bf16 v[40:43], v[48:51], v[20:27], v1
    ds_read_b128 v[20:23], v8 offset:30720
    ds_read_b128 v[24:27], v8 offset:31744
    s_waitcnt lgkmcnt(6)
    v_smfmac_f32_16x16x64_bf16 v[52:55], v[44:47], v[56:63], v1
    ds_read_b128 v[56:59], v8 offset:32768
    ds_read_b128 v[60:63], v8 offset:33792
    s_waitcnt lgkmcnt(6)
    v_smfmac_f32_16x16x64_bf16 v[52:55], v[48:51], v[64:71], v1
    s_waitcnt lgkmcnt(4)
    v_smfmac_f32_16x16x64_bf16 v[32:35], v[44:47], v[12:19], v1
    s_waitcnt lgkmcnt(2)
    v_smfmac_f32_16x16x64_bf16 v[32:35], v[48:51], v[20:27], v1
    v_smfmac_f32_16x16x64_bf16 v[28:31], v[44:47], a[248:255], v1
    s_waitcnt lgkmcnt(0)
    v_smfmac_f32_16x16x64_bf16 v[28:31], v[48:51], v[56:63], v1
    buffer_load_dwordx4 v[12:15], v6, s[8:11], s62 offen sc1
    buffer_load_dwordx4 v[16:19], v6, s[8:11], s63 offen sc1
    buffer_load_dwordx4 v[20:23], v6, s[8:11], s64 offen sc1
    buffer_load_dwordx4 v[24:27], v6, s[8:11], s65 offen sc1
    v_add_f32 v36, v36, v38
    v_add_f32 v37, v37, v39
    v_cvt_pk_bf16_f32 v36, v36, v37
    v_add_f32 v40, v40, v42
    v_add_f32 v41, v41, v43
    v_cvt_pk_bf16_f32 v37, v40, v41
    v_add_f32 v52, v52, v54
    v_add_f32 v53, v53, v55
    v_cvt_pk_bf16_f32 v38, v52, v53
    v_add_f32 v32, v32, v34
    v_add_f32 v33, v33, v35
    v_cvt_pk_bf16_f32 v39, v32, v33
    v_and_or_b32 v39, v39, -2, s40
    s_add_u32 s17, s38, 4096
    buffer_store_dwordx4 v[36:39], v0, s[8:11], s17 offen sc1
    v_add_f32 v28, v28, v30
    v_add_f32 v29, v29, v31
    v_cvt_pk_bf16_f32 v28, v28, v29
    v_and_or_b32 v28, v28, -2, s40
    v_lshrrev_b32 v9, 2, v0
    buffer_store_dword v28, v9, s[8:11], s39 offen sc1
    v_add_u32 v10, 162560, v0
    ds_read_b128 v[64:67], v10
    s_nop 9
    buffer_load_dwordx4 v[40:43], v6, s[8:11], s62 offen sc1
    buffer_load_dwordx4 v[44:47], v6, s[8:11], s63 offen sc1
    buffer_load_dwordx4 v[48:51], v6, s[8:11], s64 offen sc1
    buffer_load_dwordx4 v[52:55], v6, s[8:11], s65 offen sc1
    s_add_u32 s33, s33, 1
    s_add_u32 s42, s42, 262144
    s_add_u32 s41, s41, 262144
    s_add_u32 s43, s43, 131072
    s_add_u32 s68, s68, 262144
    s_add_u32 s66, s66, 22528
    ds_read_b128 v[56:59], v8 offset:0
    ds_read_b128 v[60:63], v8 offset:1024
    s_waitcnt lgkmcnt(2)
    s_waitcnt vmcnt(9)
    v_mfma_f32_16x16x32_bf16 v[68:71], v[12:15], v[64:67], 0
    v_and_b32 v10, 1, v15
    v_cmp_ne_u32 s[54:55], s40, v10
    s_waitcnt vmcnt(8)
    v_mfma_f32_16x16x32_bf16 v[68:71], v[16:19], v[64:67], v[68:71]
    v_and_b32 v10, 1, v19
    v_cmp_ne_u32 s[56:57], s40, v10
    s_waitcnt vmcnt(7)
    v_mfma_f32_16x16x32_bf16 v[68:71], v[20:23], v[64:67], v[68:71]
    v_and_b32 v10, 1, v23
    v_cmp_ne_u32 s[58:59], s40, v10
    s_waitcnt vmcnt(6)
    v_mfma_f32_16x16x32_bf16 v[68:71], v[24:27], v[64:67], v[68:71]
    v_and_b32 v10, 1, v27
    v_cmp_ne_u32 s[60:61], s40, v10
    s_or_b64 vcc, s[54:55], s[56:57]
    s_or_b64 vcc, vcc, s[58:59]
    s_or_b64 vcc, vcc, s[60:61]
    s_cbranch_scc0 Lr0s_red
    s_mov_b32 s16, 0
Lr0s_p1:
    buffer_load_dwordx4 v[12:15], v6, s[8:11], s62 offen sc1
    buffer_load_dwordx4 v[16:19], v6, s[8:11], s63 offen sc1
    buffer_load_dwordx4 v[20:23], v6, s[8:11], s64 offen sc1
    buffer_load_dwordx4 v[24:27], v6, s[8:11], s65 offen sc1
    s_waitcnt vmcnt(7)
    v_mfma_f32_16x16x32_bf16 v[68:71], v[40:43], v[64:67], 0
    v_and_b32 v10, 1, v43
    v_cmp_ne_u32 s[54:55], s40, v10
    s_waitcnt vmcnt(6)
    v_mfma_f32_16x16x32_bf16 v[68:71], v[44:47], v[64:67], v[68:71]
    v_and_b32 v10, 1, v47
    v_cmp_ne_u32 s[56:57], s40, v10
    s_waitcnt vmcnt(5)
    v_mfma_f32_16x16x32_bf16 v[68:71], v[48:51], v[64:67], v[68:71]
    v_and_b32 v10, 1, v51
    v_cmp_ne_u32 s[58:59], s40, v10
    s_waitcnt vmcnt(4)
    v_mfma_f32_16x16x32_bf16 v[68:71], v[52:55], v[64:67], v[68:71]
    v_and_b32 v10, 1, v55
    v_cmp_ne_u32 s[60:61], s40, v10
    s_or_b64 vcc, s[54:55], s[56:57]
    s_or_b64 vcc, vcc, s[58:59]
    s_or_b64 vcc, vcc, s[60:61]
    s_cbranch_scc0 Lr0s_red
    buffer_load_dwordx4 v[40:43], v6, s[8:11], s62 offen sc1
    buffer_load_dwordx4 v[44:47], v6, s[8:11], s63 offen sc1
    buffer_load_dwordx4 v[48:51], v6, s[8:11], s64 offen sc1
    buffer_load_dwordx4 v[52:55], v6, s[8:11], s65 offen sc1
    s_add_u32 s16, s16, 1
    s_cmp_gt_u32 s16, 100000
    s_cbranch_scc1 Lr_abort
    s_waitcnt vmcnt(7)
    v_mfma_f32_16x16x32_bf16 v[68:71], v[12:15], v[64:67], 0
    v_and_b32 v10, 1, v15
    v_cmp_ne_u32 s[54:55], s40, v10
    s_waitcnt vmcnt(6)
    v_mfma_f32_16x16x32_bf16 v[68:71], v[16:19], v[64:67], v[68:71]
    v_and_b32 v10, 1, v19
    v_cmp_ne_u32 s[56:57], s40, v10
    s_waitcnt vmcnt(5)
    v_mfma_f32_16x16x32_bf16 v[68:71], v[20:23], v[64:67], v[68:71]
    v_and_b32 v10, 1, v23
    v_cmp_ne_u32 s[58:59], s40, v10
    s_waitcnt vmcnt(4)
    v_mfma_f32_16x16x32_bf16 v[68:71], v[24:27], v[64:67], v[68:71]
    v_and_b32 v10, 1, v27
    v_cmp_ne_u32 s[60:61], s40, v10
    s_or_b64 vcc, s[54:55], s[56:57]
    s_or_b64 vcc, vcc, s[58:59]
    s_or_b64 vcc, vcc, s[60:61]
    s_cbranch_scc1 Lr0s_p1
Lr0s_red:
    s_nop 1
    v_permlane16_swap_b32 v68, v70
    v_permlane16_swap_b32 v69, v71
    s_mov_b64 exec, s[46:47]
    v_add_f32 v68, v68, v70
    v_add_f32 v69, v69, v71
    v_cvt_pk_bf16_f32 v68, v68, v69
    v_min_u32 v68, s50, v68
    buffer_store_dword v68, v7, s[8:11], s36 offen sc1
    v_mov_b32 v69, -1
    buffer_store_dword v69, v7, s[8:11], s37 offen sc1
    s_mov_b64 exec, -1
    s_xor_b32 s34, s34, 16384
    s_xor_b32 s35, s35, 16384
    s_xor_b32 s40, s40, 1
    s_xor_b32 s36, s36, 16384
    s_xor_b32 s37, s37, 16384
    s_nop 15
    s_nop 3
    buffer_load_dwordx4 v[36:39], v0, s[8:11], s34 offen sc1
    s_waitcnt vmcnt(3)
    ds_read_b128 v[64:67], v8 offset:2048
    ds_read_b128 v[68:71], v8 offset:3072
    v_mov_b64 v[12:13], 0
    v_mov_b64 v[14:15], 0
    v_mov_b64 v[16:17], 0
    v_mov_b64 v[18:19], 0
    v_mov_b64 v[20:21], 0
    v_mov_b64 v[22:23], 0
    v_mov_b64 v[24:25], 0
    v_mov_b64 v[26:27], 0
    v_mov_b64 v[28:29], 0
    v_mov_b64 v[30:31], 0
    v_mov_b64 v[32:33], 0
    v_mov_b64 v[34:35], 0
    s_nop 9
    buffer_load_dwordx4 v[36:39], v0, s[8:11], s34 offen sc1
    s_nop 15
    s_nop 8
    buffer_load_dwordx4 v[36:39], v0, s[8:11], s34 offen sc1
    s_waitcnt lgkmcnt(0)
    s_branch Lr0s_step
Lr0s_pb_re:
    s_mov_b32 s16, 0
Lr0s_pb_lp:
    s_add_u32 s17, s34, 4096
    buffer_load_dwordx4 v[40:43], v0, s[8:11], s17 offen sc1
    s_add_u32 s16, s16, 1
    s_cmp_gt_u32 s16, 100000
    s_cbranch_scc1 Lr_abort
    s_waitcnt vmcnt(0)
    v_max3_u32 v10, v40, v41, v42
    v_max_u32 v10, v10, v43
    v_cmp_eq_u32 vcc, -1, v10
    s_nop 0
    s_cbranch_vccnz Lr0s_pb_lp
    s_branch Lr0s_pb_ok
Lr0s_pc_re:
    s_mov_b32 s16, 0
Lr0s_pc_lp:
    buffer_load_dwordx4 v[44:47], v0, s[8:11], s35 offen sc1
    s_add_u32 s16, s16, 1
    s_cmp_gt_u32 s16, 100000
    s_cbranch_scc1 Lr_abort
    s_waitcnt vmcnt(0)
    v_max3_u32 v10, v44, v45, v46
    v_max_u32 v10, v10, v47
    v_cmp_eq_u32 vcc, -1, v10
    s_nop 0
    s_cbranch_vccnz Lr0s_pc_lp
    s_branch Lr0s_pc_ok
Lr0s_last:
    s_waitcnt vmcnt(0) lgkmcnt(0)
    s_barrier
    s_branch Lr_exit
L_w1_0:
    s_cmp_lg_u32 s14, 1
    s_cbranch_scc1 L_w2_0
    s_mov_b32 s16, 0
    s_add_u32 s17, s66, 128
    v_lshrrev_b32 v10, 2, v0
    v_and_b32 v9, 16, v10
    v_lshlrev_b32 v9, 3, v9
    v_and_or_b32 v10, v10, 12, v9
Lr1s_fw_16:
    buffer_load_dword v9, v10, s[8:11], s17 offen sc1
    s_add_u32 s16, s16, 1
    s_cmp_gt_u32 s16, 100000
    s_cbranch_scc1 Lr_abort
    s_waitcnt vmcnt(0)
    v_cmp_eq_u32 vcc, 0, v9
    s_nop 0
    s_cbranch_vccnz Lr1s_fw_16
    s_lshl_b32 s67, s32, 5
    s_add_u32 s67, s67, s15
    s_lshl_b32 s67, s67, 12
    s_add_u32 s67, s67, 3145728
    s_mov_b32 m0, 17152
    s_nop 0
    buffer_load_dwordx4 v0, s[8:11], s41 offen offset:0 lds
    buffer_load_dwordx4 v0, s[8:11], s41 offen offset:1024 lds
    s_add_u32 s41, s41, 262144
    s_add_u32 s68, s68, 262144
    s_waitcnt vmcnt(0)
    ds_read_b128 v[56:59], v8 offset:4096
    ds_read_b128 v[60:63], v8 offset:5120
    ds_read_b128 v[64:67], v8 offset:6144
    ds_read_b128 v[68:71], v8 offset:7168
    v_mov_b64 v[12:13], 0
    v_mov_b64 v[14:15], 0
    v_mov_b64 v[16:17], 0
    v_mov_b64 v[18:19], 0
    v_mov_b64 v[20:21], 0
    v_mov_b64 v[22:23], 0
    v_mov_b64 v[24:25], 0
    v_mov_b64 v[26:27], 0
    v_mov_b64 v[28:29], 0
    v_mov_b64 v[30:31], 0
    v_mov_b64 v[32:33], 0
    v_mov_b64 v[34:35], 0
    buffer_load_dwordx4 v[36:39], v0, s[8:11], s34 offen sc1
    s_waitcnt vmcnt(0) lgkmcnt(0)
Lr1s_step:
    s_waitcnt vmcnt(3)
    v_max3_u32 v10, v36, v37, v38
    v_max_u32 v10, v10, v39
    v_cmp_eq_u32 vcc, -1, v10
    s_nop 0
    s_cbranch_vccz Lr1s_aok
    buffer_load_dwordx4 v[36:39], v0, s[8:11], s34 offen sc1
    s_nop 15
    s_nop 8
    buffer_load_dwordx4 v[36:39], v0, s[8:11], s34 offen sc1
    s_mov_b32 s16, 0
Lr1s_alp:
    s_waitcnt vmcnt(2)
    v_max3_u32 v10, v36, v37, v38
    v_max_u32 v10, v10, v39
    v_cmp_eq_u32 vcc, -1, v10
    s_nop 0
    s_cbranch_vccz Lr1s_aok
    buffer_load_dwordx4 v[36:39], v0, s[8:11], s34 offen sc1
    s_add_u32 s16, s16, 1
    s_cmp_gt_u32 s16, 100000
    s_cbranch_scc1 Lr_abort
    s_branch Lr1s_alp
Lr1s_aok:
    ds_write_b128 v0, v[36:39] offset:7936
    v_smfmac_f32_16x16x64_bf16 v[12:15], v[36:39], v[88:95], v1
    v_smfmac_f32_16x16x64_bf16 v[16:19], v[36:39], v[96:103], v1
    v_smfmac_f32_16x16x64_bf16 v[20:23], v[36:39], v[200:207], v1
    s_waitcnt lgkmcnt(0)
    s_barrier
    ds_read_b128 v[48:51], v0 offset:8960
    ds_read_b128 v[52:55], v0 offset:9984
    v_smfmac_f32_16x16x64_bf16 v[28:31], v[36:39], a[72:79], v1
    v_smfmac_f32_16x16x64_bf16 v[24:27], v[36:39], v[208:215], v1
    s_add_u32 s17, s34, 4096
    buffer_load_dwordx4 v[40:43], v0, s[8:11], s17 offen sc1
    v_smfmac_f32_16x16x64_bf16 v[32:35], v[36:39], a[80:87], v1
    s_waitcnt vmcnt(1)
    ds_read_b128 v[36:39], v0 offset:6912
    s_waitcnt lgkmcnt(2)
    v_smfmac_f32_16x16x64_bf16 v[28:31], v[48:51], v[56:63], v1
    ds_read_b128 v[56:59], v8 offset:0
    ds_read_b128 v[60:63], v8 offset:1024
    v_smfmac_f32_16x16x64_bf16 v[12:15], v[48:51], v[104:111], v1
    v_smfmac_f32_16x16x64_bf16 v[16:19], v[48:51], v[112:119], v1
    buffer_load_dwordx4 v[44:47], v0, s[8:11], s35 offen sc1
    v_smfmac_f32_16x16x64_bf16 v[32:35], v[48:51], v[64:71], v1
    ds_read_b128 v[64:67], v8 offset:2048
    ds_read_b128 v[68:71], v8 offset:3072
    v_smfmac_f32_16x16x64_bf16 v[20:23], v[48:51], v[216:223], v1
    v_smfmac_f32_16x16x64_bf16 v[24:27], v[48:51], v[224:231], v1
    s_waitcnt lgkmcnt(5)
    v_smfmac_f32_16x16x64_bf16 v[28:31], v[52:55], a[88:95], v1
    v_smfmac_f32_16x16x64_bf16 v[12:15], v[52:55], v[120:127], v1
    v_smfmac_f32_16x16x64_bf16 v[16:19], v[52:55], v[128:135], v1
    v_smfmac_f32_16x16x64_bf16 v[32:35], v[52:55], a[96:103], v1
    v_smfmac_f32_16x16x64_bf16 v[20:23], v[52:55], v[232:239], v1
    v_smfmac_f32_16x16x64_bf16 v[24:27], v[52:55], v[240:247], v1
    s_waitcnt lgkmcnt(2)
    v_smfmac_f32_16x16x64_bf16 v[28:31], v[36:39], v[56:63], v1
    ds_read_b128 v[56:59], v8 offset:12288
    ds_read_b128 v[60:63], v8 offset:13312
    v_smfmac_f32_16x16x64_bf16 v[12:15], v[36:39], v[72:79], v1
    v_smfmac_f32_16x16x64_bf16 v[16:19], v[36:39], v[80:87], v1
    s_waitcnt lgkmcnt(2)
    v_smfmac_f32_16x16x64_bf16 v[32:35], v[36:39], v[64:71], v1
    ds_read_b128 v[64:67], v8 offset:14336
    ds_read_b128 v[68:71], v8 offset:15360
    v_smfmac_f32_16x16x64_bf16 v[20:23], v[36:39], v[184:191], v1
    v_smfmac_f32_16x16x64_bf16 v[24:27], v[36:39], v[192:199], v1
    s_waitcnt vmcnt(1)
    v_max3_u32 v10, v40, v41, v42
    v_max_u32 v10, v10, v43
    v_cmp_eq_u32 vcc, -1, v10
    s_nop 0
    s_cbranch_vccnz Lr1s_pb_re
Lr1s_pb_ok:
    ds_write_b128 v0, v[40:43] offset:12032
    v_mov_b32 v9, 1
    v_mov_b32 v10, 0
    s_mov_b64 exec, 1
    buffer_store_dword v9, v10, s[8:11], s67 offen offset:384 sc1
    s_mov_b64 exec, -1
    v_smfmac_f32_16x16x64_bf16 v[12:15], v[40:43], v[136:143], v1
    v_smfmac_f32_16x16x64_bf16 v[20:23], v[40:43], a[8:15], v1
    v_smfmac_f32_16x16x64_bf16 v[16:19], v[40:43], v[144:151], v1
    v_smfmac_f32_16x16x64_bf16 v[24:27], v[40:43], a[16:23], v1
    s_waitcnt lgkmcnt(0)
    s_barrier
    ds_read_b128 v[48:51], v0 offset:13056
    ds_read_b128 v[52:55], v0 offset:14080
    ds_read_b128 v[36:39], v0 offset:11008
    v_smfmac_f32_16x16x64_bf16 v[28:31], v[40:43], a[120:127], v1
    v_smfmac_f32_16x16x64_bf16 v[32:35], v[40:43], a[128:135], v1
    s_waitcnt lgkmcnt(2)
    v_smfmac_f32_16x16x64_bf16 v[12:15], v[48:51], v[56:63], v1
    ds_read_b128 v[56:59], v8 offset:8192
    ds_read_b128 v[60:63], v8 offset:9216
    v_smfmac_f32_16x16x64_bf16 v[16:19], v[48:51], v[64:71], v1
    ds_read_b128 v[64:67], v8 offset:10240
    ds_read_b128 v[68:71], v8 offset:11264
    s_waitcnt lgkmcnt(5)
    v_smfmac_f32_16x16x64_bf16 v[12:15], v[52:55], v[152:159], v1
    v_smfmac_f32_16x16x64_bf16 v[16:19], v[52:55], v[160:167], v1
    s_waitcnt vmcnt(1)
    v_max3_u32 v10, v44, v45, v46
    v_max_u32 v10, v10, v47
    v_cmp_eq_u32 vcc, -1, v10
    s_nop 0
    s_cbranch_vccnz Lr1s_pc_re
Lr1s_pc_ok:
    v_smfmac_f32_16x16x64_bf16 v[12:15], v[44:47], v[168:175], v1
    v_smfmac_f32_16x16x64_bf16 v[16:19], v[44:47], v[176:183], v1
    s_waitcnt lgkmcnt(2)
    v_smfmac_f32_16x16x64_bf16 v[12:15], v[36:39], v[56:63], v1
    s_waitcnt lgkmcnt(0)
    v_smfmac_f32_16x16x64_bf16 v[16:19], v[36:39], v[64:71], v1
    v_smfmac_f32_16x16x64_bf16 v[20:23], v[48:51], a[24:31], v1
    v_smfmac_f32_16x16x64_bf16 v[24:27], v[48:51], a[32:39], v1
    buffer_load_dwordx4 v[64:67], v0, s[8:11], s42 offen
    v_smfmac_f32_16x16x64_bf16 v[20:23], v[52:55], a[40:47], v1
    v_add_f32 v12, v12, v14
    v_smfmac_f32_16x16x64_bf16 v[24:27], v[52:55], a[48:55], v1
    v_add_f32 v16, v16, v18
    v_smfmac_f32_16x16x64_bf16 v[20:23], v[36:39], v[248:255], v1
    v_add_f32 v13, v13, v15
    v_smfmac_f32_16x16x64_bf16 v[24:27], v[36:39], a[0:7], v1
    v_add_f32 v17, v17, v19
    buffer_load_dwordx4 v[68:71], v0, s[8:11], s42 offen offset:1024
    v_smfmac_f32_16x16x64_bf16 v[20:23], v[44:47], a[56:63], v1
    v_cvt_pk_bf16_f32 v14, v12, v16
    ds_read_b128 v[56:59], v0 offset:15104
    v_smfmac_f32_16x16x64_bf16 v[24:27], v[44:47], a[64:71], v1
    v_cvt_pk_bf16_f32 v15, v13, v17
    ds_read_b128 v[60:63], v0 offset:16128
    ds_write_b32 v2, v14 offset:576
    ds_write_b32 v2, v15 offset:864
    v_smfmac_f32_16x16x64_bf16 v[28:31], v[48:51], a[136:143], v1
    v_smfmac_f32_16x16x64_bf16 v[32:35], v[48:51], a[144:151], v1
    v_add_f32 v20, v20, v22
    v_add_f32 v24, v24, v26
    v_add_f32 v21, v21, v23
    v_add_f32 v25, v25, v27
    v_cvt_pk_bf16_f32 v22, v20, v24
    v_cvt_pk_bf16_f32 v23, v21, v25
    ds_write_b32 v2, v22 offset:0
    ds_write_b32 v2, v23 offset:288
    v_smfmac_f32_16x16x64_bf16 v[28:31], v[52:55], a[152:159], v1
    v_smfmac_f32_16x16x64_bf16 v[32:35], v[52:55], a[160:167], v1
    s_waitcnt lgkmcnt(0)
    s_barrier
    ds_read_b128 v[40:43], v3 offset:0
    ds_read_b128 v[48:51], v3 offset:64
    ds_read_b128 v[20:23], v3 offset:128
    ds_read_b128 v[52:55], v3 offset:192
    v_smfmac_f32_16x16x64_bf16 v[28:31], v[36:39], a[104:111], v1
    v_smfmac_f32_16x16x64_bf16 v[32:35], v[36:39], a[112:119], v1
    ds_read_b128 v[36:39], v0 offset:17152
    v_smfmac_f32_16x16x64_bf16 v[28:31], v[44:47], a[168:175], v1
    v_smfmac_f32_16x16x64_bf16 v[32:35], v[44:47], a[176:183], v1
    ds_read_b128 v[44:47], v0 offset:18176
    s_waitcnt lgkmcnt(5)
    v_mfma_f32_16x16x32_bf16 v[12:15], v[56:59], v[40:43], 0
    v_mfma_f32_16x16x32_bf16 v[16:19], v[60:63], v[40:43], 0
    v_mfma_f32_16x16x32_bf16 v[24:27], v[40:43], v[40:43], 0
    ds_read_b128 v[56:59], v0 offset:19200
    ds_read_b128 v[60:63], v0 offset:20224
    s_waitcnt lgkmcnt(3)
    v_mfma_f32_16x16x32_bf16 v[12:15], v[36:39], v[48:51], v[12:15]
    v_lshrrev_b32 v10, 1, v0
    v_lshrrev_b32 v9, 9, v0
    s_waitcnt lgkmcnt(2)
    v_mfma_f32_16x16x32_bf16 v[16:19], v[44:47], v[48:51], v[16:19]
    v_lshl_add_u32 v9, v9, 5, v10
    v_add_f32 v28, v28, v30
    v_mfma_f32_16x16x32_bf16 v[24:27], v[48:51], v[48:51], v[24:27]
    v_add_f32 v32, v32, v34
    v_add_f32 v29, v29, v31
    ds_read_b128 v[36:39], v0 offset:21248
    ds_read_b128 v[44:47], v0 offset:22272
    s_waitcnt lgkmcnt(3)
    v_mfma_f32_16x16x32_bf16 v[12:15], v[56:59], v[20:23], v[12:15]
    v_add_f32 v33, v33, v35
    v_cvt_pk_bf16_f32 v30, v28, v29
    s_waitcnt lgkmcnt(2)
    v_mfma_f32_16x16x32_bf16 v[16:19], v[60:63], v[20:23], v[16:19]
    v_cvt_pk_bf16_f32 v31, v32, v33
    ds_read_b64 v[34:35], v9 offset:1152
    v_mfma_f32_16x16x32_bf16 v[24:27], v[20:23], v[20:23], v[24:27]
    s_add_u32 s17, s43, 2560
    buffer_store_dwordx2 v[30:31], v10, s[8:11], s17 offen sc1
    s_waitcnt lgkmcnt(2)
    v_mfma_f32_16x16x32_bf16 v[12:15], v[36:39], v[52:55], v[12:15]
    s_waitcnt lgkmcnt(1)
    v_mfma_f32_16x16x32_bf16 v[16:19], v[44:47], v[52:55], v[16:19]
    v_mfma_f32_16x16x32_bf16 v[24:27], v[52:55], v[52:55], v[24:27]
    s_add_u32 s17, s43, 512
    s_waitcnt lgkmcnt(0)
    buffer_store_dwordx2 v[34:35], v10, s[8:11], s17 offen sc1
    s_cmp_eq_u32 s33, 63
    s_cbranch_scc1 Lr1s_last
    ds_read_b128 v[56:59], v8 offset:16384
    ds_read_b128 v[60:63], v8 offset:17408
    v_mov_b64 v[20:21], s[52:53]
    v_mov_b64 v[22:23], s[52:53]
    v_mov_b32 v41, 0
    v_mov_b32 v42, 0
    v_max3_f32 v9, v12, v13, v14
    v_max3_f32 v9, v9, v15, v16
    v_max3_f32 v9, v9, v17, v18
    v_max3_f32 v9, v9, v19, v24
    v_max_f32 v9, v9, v25
    v_mov_b32 v10, v9
    v_mov_b64 v[32:33], 0
    v_mov_b64 v[34:35], 0
    v_permlane32_swap_b32 v9, v10
    v_max_f32 v9, v9, v10
    v_mov_b32 v10, v9
    s_nop 1
    v_permlane16_swap_b32 v9, v10
    v_max_f32 v9, v9, v10
    v_mul_f32 v28, s44, v9
    v_fma_f32 v12, v12, s44, -v28
    v_fma_f32 v13, v13, s44, -v28
    v_fma_f32 v14, v14, s44, -v28
    v_fma_f32 v15, v15, s44, -v28
    v_exp_f32 v12, v12
    v_exp_f32 v13, v13
    v_fma_f32 v16, v16, s44, -v28
    v_fma_f32 v17, v17, s44, -v28
    v_exp_f32 v14, v14
    v_exp_f32 v15, v15
    v_cvt_pk_bf16_f32 v36, v12, v13
    v_fma_f32 v18, v18, s44, -v28
    v_fma_f32 v19, v19, s44, -v28
    v_exp_f32 v16, v16
    v_exp_f32 v17, v17
    v_cvt_pk_bf16_f32 v37, v14, v15
    v_fma_f32 v24, v24, s44, -v28
    v_fma_f32 v25, v25, s44, -v28
    v_exp_f32 v18, v18
    v_exp_f32 v19, v19
    v_cvt_pk_bf16_f32 v38, v16, v17
    v_exp_f32 v24, v24
    v_exp_f32 v25, v25
    v_cvt_pk_bf16_f32 v39, v18, v19
    v_cvt_pk_bf16_f32 v40, v24, v25
    v_cvt_pk_bf16_f32 v43, v24, v25
    v_mfma_f32_16x16x32_bf16 v[52:55], v[20:23], v[36:39], 0
    v_mov_b64 v[12:13], 0
    v_mov_b64 v[14:15], 0
    s_waitcnt vmcnt(3)
    v_mfma_f32_16x16x32_bf16 v[44:47], v[64:67], v[36:39], 0
    v_mov_b64 v[24:25], 0
    v_mov_b64 v[26:27], 0
    s_waitcnt vmcnt(2)
    v_mfma_f32_16x16x32_bf16 v[48:51], v[68:71], v[36:39], 0
    ds_read_b128 v[64:67], v8 offset:20480
    ds_read_b128 v[68:71], v8 offset:21504
    v_mfma_f32_16x16x16_bf16 v[52:55], v[20:21], v[40:41], v[52:55]
    v_mfma_f32_16x16x16_bf16 v[44:47], v[30:31], v[40:41], v[44:47]
    v_mov_b64 v[20:21], 0
    v_mov_b64 v[22:23], 0
    v_mfma_f32_16x16x16_bf16 v[48:51], v[30:31], v[42:43], v[48:51]
    v_mov_b64 v[36:37], 0
    v_mov_b64 v[38:39], 0
    v_mov_b64 v[40:41], 0
    v_mov_b64 v[42:43], 0
    v_rcp_f32 v9, v52
    v_mov_b64 v[52:53], 0
    v_mov_b64 v[54:55], 0
    v_mul_f32 v44, v9, v44
    v_mul_f32 v48, v9, v48
    v_cvt_pk_bf16_f32 v16, v44, v48
    v_mul_f32 v45, v9, v45
    v_mul_f32 v49, v9, v49
    v_cvt_pk_bf16_f32 v17, v45, v49
    v_mul_f32 v46, v9, v46
    v_mul_f32 v50, v9, v50
    v_cvt_pk_bf16_f32 v18, v46, v50
    v_mul_f32 v47, v9, v47
    v_mul_f32 v51, v9, v51
    v_cvt_pk_bf16_f32 v19, v47, v51
    ds_write_b128 v5, v[16:19]
    v_mov_b64 v[28:29], 0
    v_mov_b64 v[30:31], 0
    s_waitcnt lgkmcnt(0)
    s_barrier
    ds_read_b128 v[44:47], v4 offset:0
    ds_read_b128 v[48:51], v4 offset:128
    v_mov_b64 v[16:17], 0
    v_mov_b64 v[18:19], 0
    buffer_load_dwordx4 v0, s[8:11], s41 offen offset:0 lds
    buffer_load_dwordx4 v0, s[8:11], s41 offen offset:1024 lds
    s_waitcnt lgkmcnt(1)
    v_smfmac_f32_16x16x64_bf16 v[12:15], v[44:47], a[184:191], v1
    s_waitcnt lgkmcnt(0)
    v_smfmac_f32_16x16x64_bf16 v[12:15], v[48:51], a[192:199], v1
    v_smfmac_f32_16x16x64_bf16 v[24:27], v[44:47], a[200:207], v1
    v_smfmac_f32_16x16x64_bf16 v[24:27], v[48:51], a[208:215], v1
    v_add_f32 v12, v12, v14
    v_smfmac_f32_16x16x64_bf16 v[20:23], v[44:47], a[216:223], v1
    v_add_f32 v13, v13, v15
    v_smfmac_f32_16x16x64_bf16 v[20:23], v[48:51], a[224:231], v1
    v_cvt_pk_bf16_f32 v12, v12, v13
    v_smfmac_f32_16x16x64_bf16 v[16:19], v[44:47], a[232:239], v1
    v_add_f32 v24, v24, v26
    v_smfmac_f32_16x16x64_bf16 v[16:19], v[48:51], a[240:247], v1
    v_add_f32 v25, v25, v27
    v_smfmac_f32_16x16x64_bf16 v[36:39], v[44:47], v[56:63], v1
    v_cvt_pk_bf16_f32 v13, v24, v25
    v_smfmac_f32_16x16x64_bf16 v[36:39], v[48:51], v[64:71], v1
    v_add_f32 v20, v20, v22
    v_add_f32 v21, v21, v23
    v_cvt_pk_bf16_f32 v14, v20, v21
    v_add_f32 v16, v16, v18
    v_add_f32 v17, v17, v19
    v_cvt_pk_bf16_f32 v15, v16, v17
    v_and_or_b32 v15, v15, -2, s40
    buffer_store_dwordx4 v[12:15], v0, s[8:11], s38 offen sc1
    s_nop 0
    ds_read_b128 v[12:15], v8 offset:18432
    ds_read_b128 v[16:19], v8 offset:19456
    ds_read_b128 v[20:23], v8 offset:22528
    ds_read_b128 v[24:27], v8 offset:23552
    ds_read_b128 v[56:59], v8 offset:24576
    ds_read_b128 v[60:63], v8 offset:25600
    ds_read_b128 v[64:67], v8 offset:28672
    ds_read_b128 v[68:71], v8 offset:29696
    s_waitcnt lgkmcnt(6)
    v_smfmac_f32_16x16x64_bf16 v[40:43], v[44:47], v[12:19], v1
    ds_read_b128 v[12:15], v8 offset:26624
    ds_read_b128 v[16:19], v8 offset:27648
    s_waitcnt lgkmcnt(6)
    v_smfmac_f32_16x16x64_bf16 v[40:43], v[48:51], v[20:27], v1
    ds_read_b128 v[20:23], v8 offset:30720
    ds_read_b128 v[24:27], v8 offset:31744
    s_waitcnt lgkmcnt(6)
    v_smfmac_f32_16x16x64_bf16 v[52:55], v[44:47], v[56:63], v1
    ds_read_b128 v[56:59], v8 offset:32768
    ds_read_b128 v[60:63], v8 offset:33792
    s_waitcnt lgkmcnt(6)
    v_smfmac_f32_16x16x64_bf16 v[52:55], v[48:51], v[64:71], v1
    s_waitcnt lgkmcnt(4)
    v_smfmac_f32_16x16x64_bf16 v[32:35], v[44:47], v[12:19], v1
    s_waitcnt lgkmcnt(2)
    v_smfmac_f32_16x16x64_bf16 v[32:35], v[48:51], v[20:27], v1
    v_smfmac_f32_16x16x64_bf16 v[28:31], v[44:47], a[248:255], v1
    s_waitcnt lgkmcnt(0)
    v_smfmac_f32_16x16x64_bf16 v[28:31], v[48:51], v[56:63], v1
    v_add_f32 v36, v36, v38
    v_add_f32 v37, v37, v39
    v_cvt_pk_bf16_f32 v36, v36, v37
    v_add_f32 v40, v40, v42
    v_add_f32 v41, v41, v43
    v_cvt_pk_bf16_f32 v37, v40, v41
    v_add_f32 v52, v52, v54
    v_add_f32 v53, v53, v55
    v_cvt_pk_bf16_f32 v38, v52, v53
    v_add_f32 v32, v32, v34
    v_add_f32 v33, v33, v35
    v_cvt_pk_bf16_f32 v39, v32, v33
    v_and_or_b32 v39, v39, -2, s40
    s_add_u32 s17, s38, 4096
    buffer_store_dwordx4 v[36:39], v0, s[8:11], s17 offen sc1
    v_add_f32 v28, v28, v30
    v_add_f32 v29, v29, v31
    v_cvt_pk_bf16_f32 v28, v28, v29
    v_and_or_b32 v28, v28, -2, s40
    v_lshrrev_b32 v9, 2, v0
    buffer_store_dword v28, v9, s[8:11], s39 offen sc1
    v_add_u32 v10, 162560, v0
    ds_read_b128 v[64:67], v10
    s_add_u32 s33, s33, 1
    s_add_u32 s42, s42, 262144
    s_add_u32 s41, s41, 262144
    s_add_u32 s43, s43, 131072
    s_mov_b32 s67, s66
    s_add_u32 s68, s68, 262144
    s_add_u32 s66, s66, 22528
    ds_read_b128 v[56:59], v8 offset:4096
    ds_read_b128 v[60:63], v8 offset:5120
    v_mov_b64 v[12:13], 0
    v_mov_b64 v[14:15], 0
    v_mov_b64 v[16:17], 0
    v_mov_b64 v[18:19], 0
    v_mov_b64 v[20:21], 0
    v_mov_b64 v[22:23], 0
    v_mov_b64 v[24:25], 0
    v_mov_b64 v[26:27], 0
    v_mov_b64 v[28:29], 0
    v_mov_b64 v[30:31], 0
    v_mov_b64 v[32:33], 0
    v_mov_b64 v[34:35], 0
    s_nop 15
    s_nop 15
    s_nop 15
    s_nop 11
    buffer_load_dwordx4 v[40:43], v6, s[8:11], s62 offen sc1
    buffer_load_dwordx4 v[44:47], v6, s[8:11], s63 offen sc1
    buffer_load_dwordx4 v[48:51], v6, s[8:11], s64 offen sc1
    buffer_load_dwordx4 v[52:55], v6, s[8:11], s65 offen sc1
    s_waitcnt lgkmcnt(0)
    s_waitcnt vmcnt(3)
    v_mfma_f32_16x16x32_bf16 v[68:71], v[40:43], v[64:67], 0
    v_and_b32 v10, 1, v43
    v_cmp_ne_u32 s[54:55], s40, v10
    s_waitcnt vmcnt(2)
    v_mfma_f32_16x16x32_bf16 v[68:71], v[44:47], v[64:67], v[68:71]
    v_and_b32 v10, 1, v47
    v_cmp_ne_u32 s[56:57], s40, v10
    s_waitcnt vmcnt(1)
    v_mfma_f32_16x16x32_bf16 v[68:71], v[48:51], v[64:67], v[68:71]
    v_and_b32 v10, 1, v51
    v_cmp_ne_u32 s[58:59], s40, v10
    s_waitcnt vmcnt(0)
    v_mfma_f32_16x16x32_bf16 v[68:71], v[52:55], v[64:67], v[68:71]
    v_and_b32 v10, 1, v55
    v_cmp_ne_u32 s[60:61], s40, v10
    s_or_b64 vcc, s[54:55], s[56:57]
    s_or_b64 vcc, vcc, s[58:59]
    s_or_b64 vcc, vcc, s[60:61]
    s_cbranch_scc0 Lr1s_red
    s_mov_b32 s16, 0
Lr1s_p1:
    s_mov_b64 exec, s[54:55]
    buffer_load_dwordx4 v[40:43], v6, s[8:11], s62 offen sc1
    s_mov_b64 exec, s[56:57]
    buffer_load_dwordx4 v[44:47], v6, s[8:11], s63 offen sc1
    s_mov_b64 exec, s[58:59]
    buffer_load_dwordx4 v[48:51], v6, s[8:11], s64 offen sc1
    s_mov_b64 exec, s[60:61]
    buffer_load_dwordx4 v[52:55], v6, s[8:11], s65 offen sc1
    s_mov_b64 exec, -1
    s_add_u32 s16, s16, 1
    s_cmp_gt_u32 s16, 100000
    s_cbranch_scc1 Lr_abort
    s_waitcnt vmcnt(3)
    v_mfma_f32_16x16x32_bf16 v[68:71], v[40:43], v[64:67], 0
    v_and_b32 v10, 1, v43
    v_cmp_ne_u32 s[54:55], s40, v10
    s_waitcnt vmcnt(2)
    v_mfma_f32_16x16x32_bf16 v[68:71], v[44:47], v[64:67], v[68:71]
    v_and_b32 v10, 1, v47
    v_cmp_ne_u32 s[56:57], s40, v10
    s_waitcnt vmcnt(1)
    v_mfma_f32_16x16x32_bf16 v[68:71], v[48:51], v[64:67], v[68:71]
    v_and_b32 v10, 1, v51
    v_cmp_ne_u32 s[58:59], s40, v10
    s_waitcnt vmcnt(0)
    v_mfma_f32_16x16x32_bf16 v[68:71], v[52:55], v[64:67], v[68:71]
    v_and_b32 v10, 1, v55
    v_cmp_ne_u32 s[60:61], s40, v10
    s_or_b64 vcc, s[54:55], s[56:57]
    s_or_b64 vcc, vcc, s[58:59]
    s_or_b64 vcc, vcc, s[60:61]
    s_cbranch_scc1 Lr1s_p1
Lr1s_red:
    s_xor_b32 s34, s34, 16384
    s_xor_b32 s35, s35, 16384
    buffer_load_dwordx4 v[36:39], v0, s[8:11], s34 offen sc1
    v_permlane16_swap_b32 v68, v70
    v_permlane16_swap_b32 v69, v71
    s_mov_b64 exec, s[46:47]
    v_add_f32 v68, v68, v70
    v_add_f32 v69, v69, v71
    v_cvt_pk_bf16_f32 v68, v68, v69
    v_min_u32 v68, s50, v68
    buffer_store_dword v68, v7, s[8:11], s36 offen sc1
    v_mov_b32 v69, -1
    buffer_store_dword v69, v7, s[8:11], s37 offen sc1
    s_mov_b64 exec, -1
    buffer_load_dwordx4 v[36:39], v0, s[8:11], s34 offen sc1
    s_xor_b32 s40, s40, 1
    s_xor_b32 s36, s36, 16384
    s_xor_b32 s37, s37, 16384
    ds_read_b128 v[64:67], v8 offset:6144
    ds_read_b128 v[68:71], v8 offset:7168
    s_waitcnt lgkmcnt(0)
    s_branch Lr1s_step
Lr1s_pb_re:
    s_mov_b32 s16, 0
Lr1s_pb_lp:
    s_add_u32 s17, s34, 4096
    buffer_load_dwordx4 v[40:43], v0, s[8:11], s17 offen sc1
    s_add_u32 s16, s16, 1
    s_cmp_gt_u32 s16, 100000
    s_cbranch_scc1 Lr_abort
    s_waitcnt vmcnt(0)
    v_max3_u32 v10, v40, v41, v42
    v_max_u32 v10, v10, v43
    v_cmp_eq_u32 vcc, -1, v10
    s_nop 0
    s_cbranch_vccnz Lr1s_pb_lp
    s_branch Lr1s_pb_ok
Lr1s_pc_re:
    s_mov_b32 s16, 0
Lr1s_pc_lp:
    buffer_load_dwordx4 v[44:47], v0, s[8:11], s35 offen sc1
    s_add_u32 s16, s16, 1
    s_cmp_gt_u32 s16, 100000
    s_cbranch_scc1 Lr_abort
    s_waitcnt vmcnt(0)
    v_max3_u32 v10, v44, v45, v46
    v_max_u32 v10, v10, v47
    v_cmp_eq_u32 vcc, -1, v10
    s_nop 0
    s_cbranch_vccnz Lr1s_pc_lp
    s_branch Lr1s_pc_ok
Lr1s_last:
    s_waitcnt vmcnt(0) lgkmcnt(0)
    s_barrier
    s_mov_b32 s67, s66
    v_mov_b32 v9, 1
    v_mov_b32 v10, 0
    s_mov_b64 exec, 1
    buffer_store_dword v9, v10, s[8:11], s67 offen offset:384 sc1
    s_mov_b64 exec, -1
    s_branch Lr_exit
L_w2_0:
    s_cmp_lg_u32 s14, 2
    s_cbranch_scc1 L_w3_0
    s_mov_b32 s16, 0
    s_add_u32 s17, s66, 128
    v_lshrrev_b32 v10, 2, v0
    v_and_b32 v9, 16, v10
    v_lshlrev_b32 v9, 3, v9
    v_and_or_b32 v10, v10, 12, v9
Lr2s_fw_17:
    buffer_load_dword v9, v10, s[8:11], s17 offen sc1
    s_add_u32 s16, s16, 1
    s_cmp_gt_u32 s16, 100000
    s_cbranch_scc1 Lr_abort
    s_waitcnt vmcnt(0)
    v_cmp_eq_u32 vcc, 0, v9
    s_nop 0
    s_cbranch_vccnz Lr2s_fw_17
    s_mov_b32 m0, 19200
    s_nop 0
    buffer_load_dwordx4 v0, s[8:11], s41 offen offset:0 lds
    buffer_load_dwordx4 v0, s[8:11], s41 offen offset:1024 lds
    s_add_u32 s41, s41, 262144
    s_add_u32 s68, s68, 262144
    s_waitcnt vmcnt(0)
    ds_read_b128 v[56:59], v8 offset:4096
    ds_read_b128 v[60:63], v8 offset:5120
    ds_read_b128 v[64:67], v8 offset:6144
    ds_read_b128 v[68:71], v8 offset:7168
    v_mov_b64 v[12:13], 0
    v_mov_b64 v[14:15], 0
    v_mov_b64 v[16:17], 0
    v_mov_b64 v[18:19], 0
    v_mov_b64 v[20:21], 0
    v_mov_b64 v[22:23], 0
    v_mov_b64 v[24:25], 0
    v_mov_b64 v[26:27], 0
    v_mov_b64 v[28:29], 0
    v_mov_b64 v[30:31], 0
    v_mov_b64 v[32:33], 0
    v_mov_b64 v[34:35], 0
    buffer_load_dwordx4 v[36:39], v0, s[8:11], s34 offen sc1
    s_waitcnt vmcnt(0) lgkmcnt(0)
Lr2s_step:
    s_waitcnt vmcnt(3)
    v_max3_u32 v10, v36, v37, v38
    v_max_u32 v10, v10, v39
    v_cmp_eq_u32 vcc, -1, v10
    s_nop 0
    s_cbranch_vccz Lr2s_aok
    buffer_load_dwordx4 v[36:39], v0, s[8:11], s34 offen sc1
    s_nop 15
    s_nop 8
    buffer_load_dwordx4 v[36:39], v0, s[8:11], s34 offen sc1
    s_mov_b32 s16, 0
Lr2s_alp:
    s_waitcnt vmcnt(2)
    v_max3_u32 v10, v36, v37, v38
    v_max_u32 v10, v10, v39
    v_cmp_eq_u32 vcc, -1, v10
    s_nop 0
    s_cbranch_vccz Lr2s_aok
    buffer_load_dwordx4 v[36:39], v0, s[8:11], s34 offen sc1
    s_add_u32 s16, s16, 1
    s_cmp_gt_u32 s16, 100000
    s_cbranch_scc1 Lr_abort
    s_branch Lr2s_alp
Lr2s_aok:
    ds_write_b128 v0, v[36:39] offset:8960
    v_smfmac_f32_16x16x64_bf16 v[12:15], v[36:39], v[104:111], v1
    v_smfmac_f32_16x16x64_bf16 v[16:19], v[36:39], v[112:119], v1
    v_smfmac_f32_16x16x64_bf16 v[20:23], v[36:39], v[216:223], v1
    s_waitcnt lgkmcnt(0)
    s_barrier
    ds_read_b128 v[48:51], v0 offset:9984
    ds_read_b128 v[52:55], v0 offset:6912
    v_smfmac_f32_16x16x64_bf16 v[28:31], v[36:39], v[56:63], v1
    ds_read_b128 v[56:59], v8 offset:0
    ds_read_b128 v[60:63], v8 offset:1024
    v_smfmac_f32_16x16x64_bf16 v[24:27], v[36:39], v[224:231], v1
    v_smfmac_f32_16x16x64_bf16 v[32:35], v[36:39], v[64:71], v1
    ds_read_b128 v[64:67], v8 offset:2048
    ds_read_b128 v[68:71], v8 offset:3072
    s_add_u32 s17, s34, 4096
    buffer_load_dwordx4 v[40:43], v0, s[8:11], s17 offen sc1
    s_waitcnt vmcnt(1)
    ds_read_b128 v[36:39], v0 offset:7936
    s_waitcnt lgkmcnt(6)
    v_smfmac_f32_16x16x64_bf16 v[28:31], v[48:51], a[88:95], v1
    v_smfmac_f32_16x16x64_bf16 v[12:15], v[48:51], v[120:127], v1
    v_smfmac_f32_16x16x64_bf16 v[16:19], v[48:51], v[128:135], v1
    v_smfmac_f32_16x16x64_bf16 v[32:35], v[48:51], a[96:103], v1
    buffer_load_dwordx4 v[44:47], v0, s[8:11], s35 offen sc1
    v_smfmac_f32_16x16x64_bf16 v[20:23], v[48:51], v[232:239], v1
    v_lshrrev_b32 v10, 2, v0
    v_and_b32 v9, 16, v10
    v_lshlrev_b32 v9, 3, v9
    v_and_or_b32 v10, v10, 12, v9
    s_add_u32 s17, s66, 22656
    v_mov_b32 v11, 2
    buffer_load_dword v11, v10, s[8:11], s17 offen sc1
    v_smfmac_f32_16x16x64_bf16 v[24:27], v[48:51], v[240:247], v1
    s_waitcnt lgkmcnt(3)
    v_smfmac_f32_16x16x64_bf16 v[28:31], v[52:55], v[56:63], v1
    ds_read_b128 v[56:59], v8 offset:12288
    ds_read_b128 v[60:63], v8 offset:13312
    v_smfmac_f32_16x16x64_bf16 v[12:15], v[52:55], v[72:79], v1
    v_smfmac_f32_16x16x64_bf16 v[16:19], v[52:55], v[80:87], v1
    s_waitcnt lgkmcnt(3)
    v_smfmac_f32_16x16x64_bf16 v[32:35], v[52:55], v[64:71], v1
    ds_read_b128 v[64:67], v8 offset:14336
    ds_read_b128 v[68:71], v8 offset:15360
    v_smfmac_f32_16x16x64_bf16 v[20:23], v[52:55], v[184:191], v1
    v_smfmac_f32_16x16x64_bf16 v[24:27], v[52:55], v[192:199], v1
    s_waitcnt lgkmcnt(4)
    v_smfmac_f32_16x16x64_bf16 v[28:31], v[36:39], a[72:79], v1
    v_smfmac_f32_16x16x64_bf16 v[12:15], v[36:39], v[88:95], v1
    v_smfmac_f32_16x16x64_bf16 v[16:19], v[36:39], v[96:103], v1
    v_smfmac_f32_16x16x64_bf16 v[32:35], v[36:39], a[80:87], v1
    v_smfmac_f32_16x16x64_bf16 v[20:23], v[36:39], v[200:207], v1
    v_smfmac_f32_16x16x64_bf16 v[24:27], v[36:39], v[208:215], v1
    s_waitcnt vmcnt(2)
    v_max3_u32 v10, v40, v41, v42
    v_max_u32 v10, v10, v43
    v_cmp_eq_u32 vcc, -1, v10
    s_nop 0
    s_cbranch_vccnz Lr2s_pb_re
Lr2s_pb_ok:
    ds_write_b128 v0, v[40:43] offset:13056
    s_waitcnt lgkmcnt(3)
    v_smfmac_f32_16x16x64_bf16 v[12:15], v[40:43], v[56:63], v1
    ds_read_b128 v[56:59], v8 offset:8192
    ds_read_b128 v[60:63], v8 offset:9216
    v_smfmac_f32_16x16x64_bf16 v[20:23], v[40:43], a[24:31], v1
    s_waitcnt lgkmcnt(3)
    v_smfmac_f32_16x16x64_bf16 v[16:19], v[40:43], v[64:71], v1
    ds_read_b128 v[64:67], v8 offset:10240
    ds_read_b128 v[68:71], v8 offset:11264
    v_smfmac_f32_16x16x64_bf16 v[24:27], v[40:43], a[32:39], v1
    s_waitcnt lgkmcnt(4)
    s_barrier
    ds_read_b128 v[48:51], v0 offset:11008
    ds_read_b128 v[52:55], v0 offset:14080
    ds_read_b128 v[36:39], v0 offset:12032
    v_smfmac_f32_16x16x64_bf16 v[28:31], v[40:43], a[136:143], v1
    v_smfmac_f32_16x16x64_bf16 v[32:35], v[40:43], a[144:151], v1
    s_waitcnt lgkmcnt(2)
    v_smfmac_f32_16x16x64_bf16 v[12:15], v[48:51], v[56:63], v1
    v_smfmac_f32_16x16x64_bf16 v[16:19], v[48:51], v[64:71], v1
    s_waitcnt lgkmcnt(1)
    v_smfmac_f32_16x16x64_bf16 v[12:15], v[52:55], v[152:159], v1
    v_smfmac_f32_16x16x64_bf16 v[16:19], v[52:55], v[160:167], v1
    s_waitcnt lgkmcnt(0)
    v_smfmac_f32_16x16x64_bf16 v[12:15], v[36:39], v[136:143], v1
    v_smfmac_f32_16x16x64_bf16 v[16:19], v[36:39], v[144:151], v1
    s_waitcnt vmcnt(1)
    v_max3_u32 v10, v44, v45, v46
    v_max_u32 v10, v10, v47
    v_cmp_eq_u32 vcc, -1, v10
    s_nop 0
    s_cbranch_vccnz Lr2s_pc_re
Lr2s_pc_ok:
    v_smfmac_f32_16x16x64_bf16 v[12:15], v[44:47], v[168:175], v1
    v_smfmac_f32_16x16x64_bf16 v[16:19], v[44:47], v[176:183], v1
    v_smfmac_f32_16x16x64_bf16 v[20:23], v[48:51], v[248:255], v1
    v_smfmac_f32_16x16x64_bf16 v[24:27], v[48:51], a[0:7], v1
    v_smfmac_f32_16x16x64_bf16 v[20:23], v[52:55], a[40:47], v1
    v_add_f32 v12, v12, v14
    buffer_load_dwordx4 v[64:67], v0, s[8:11], s42 offen
    v_smfmac_f32_16x16x64_bf16 v[24:27], v[52:55], a[48:55], v1
    v_add_f32 v16, v16, v18
    v_smfmac_f32_16x16x64_bf16 v[20:23], v[36:39], a[8:15], v1
    v_add_f32 v13, v13, v15
    v_smfmac_f32_16x16x64_bf16 v[24:27], v[36:39], a[16:23], v1
    v_add_f32 v17, v17, v19
    v_smfmac_f32_16x16x64_bf16 v[20:23], v[44:47], a[56:63], v1
    v_cvt_pk_bf16_f32 v14, v12, v16
    ds_read_b128 v[56:59], v0 offset:15104
    buffer_load_dwordx4 v[68:71], v0, s[8:11], s42 offen offset:1024
    v_smfmac_f32_16x16x64_bf16 v[24:27], v[44:47], a[64:71], v1
    v_cvt_pk_bf16_f32 v15, v13, v17
    ds_read_b128 v[60:63], v0 offset:16128
    ds_write_b32 v2, v14 offset:576
    ds_write_b32 v2, v15 offset:864
    v_smfmac_f32_16x16x64_bf16 v[28:31], v[48:51], a[104:111], v1
    v_smfmac_f32_16x16x64_bf16 v[32:35], v[48:51], a[112:119], v1
    v_add_f32 v20, v20, v22
    v_add_f32 v24, v24, v26
    v_add_f32 v21, v21, v23
    v_add_f32 v25, v25, v27
    v_cvt_pk_bf16_f32 v22, v20, v24
    v_cvt_pk_bf16_f32 v23, v21, v25
    ds_write_b32 v2, v22 offset:0
    ds_write_b32 v2, v23 offset:288
    v_smfmac_f32_16x16x64_bf16 v[28:31], v[52:55], a[152:159], v1
    v_smfmac_f32_16x16x64_bf16 v[32:35], v[52:55], a[160:167], v1
    s_waitcnt vmcnt(2)
    v_cmp_eq_u32 vcc, 0, v11
    s_nop 0
    s_cbranch_vccnz Lr2s_flbad
Lr2s_flok:
    s_waitcnt lgkmcnt(0)
    s_barrier
    ds_read_b128 v[40:43], v3 offset:0
    ds_read_b128 v[48:51], v3 offset:64
    ds_read_b128 v[20:23], v3 offset:128
    ds_read_b128 v[52:55], v3 offset:192
    v_smfmac_f32_16x16x64_bf16 v[28:31], v[36:39], a[120:127], v1
    v_smfmac_f32_16x16x64_bf16 v[32:35], v[36:39], a[128:135], v1
    ds_read_b128 v[36:39], v0 offset:17152
    v_smfmac_f32_16x16x64_bf16 v[28:31], v[44:47], a[168:175], v1
    v_smfmac_f32_16x16x64_bf16 v[32:35], v[44:47], a[176:183], v1
    ds_read_b128 v[44:47], v0 offset:18176
    s_waitcnt lgkmcnt(5)
    v_mfma_f32_16x16x32_bf16 v[12:15], v[56:59], v[40:43], 0
    v_mfma_f32_16x16x32_bf16 v[16:19], v[60:63], v[40:43], 0
    v_mfma_f32_16x16x32_bf16 v[24:27], v[40:43], v[40:43], 0
    ds_read_b128 v[56:59], v0 offset:19200
    ds_read_b128 v[60:63], v0 offset:20224
    s_waitcnt lgkmcnt(3)
    v_mfma_f32_16x16x32_bf16 v[12:15], v[36:39], v[48:51], v[12:15]
    v_lshrrev_b32 v10, 1, v0
    v_lshrrev_b32 v9, 9, v0
    s_waitcnt lgkmcnt(2)
    v_mfma_f32_16x16x32_bf16 v[16:19], v[44:47], v[48:51], v[16:19]
    v_lshl_add_u32 v9, v9, 5, v10
    v_add_f32 v28, v28, v30
    v_mfma_f32_16x16x32_bf16 v[24:27], v[48:51], v[48:51], v[24:27]
    v_add_f32 v32, v32, v34
    v_add_f32 v29, v29, v31
    ds_read_b128 v[36:39], v0 offset:21248
    ds_read_b128 v[44:47], v0 offset:22272
    s_waitcnt lgkmcnt(3)
    v_mfma_f32_16x16x32_bf16 v[12:15], v[56:59], v[20:23], v[12:15]
    v_add_f32 v33, v33, v35
    v_cvt_pk_bf16_f32 v30, v28, v29
    s_waitcnt lgkmcnt(2)
    v_mfma_f32_16x16x32_bf16 v[16:19], v[60:63], v[20:23], v[16:19]
    v_cvt_pk_bf16_f32 v31, v32, v33
    ds_read_b64 v[34:35], v9 offset:2304
    v_mfma_f32_16x16x32_bf16 v[24:27], v[20:23], v[20:23], v[24:27]
    s_add_u32 s17, s43, 3072
    buffer_store_dwordx2 v[30:31], v10, s[8:11], s17 offen sc1
    s_waitcnt lgkmcnt(2)
    v_mfma_f32_16x16x32_bf16 v[12:15], v[36:39], v[52:55], v[12:15]
    s_waitcnt lgkmcnt(1)
    v_mfma_f32_16x16x32_bf16 v[16:19], v[44:47], v[52:55], v[16:19]
    v_mfma_f32_16x16x32_bf16 v[24:27], v[52:55], v[52:55], v[24:27]
    s_add_u32 s17, s43, 1024
    s_waitcnt lgkmcnt(0)
    buffer_store_dwordx2 v[34:35], v10, s[8:11], s17 offen sc1
    s_cmp_eq_u32 s33, 63
    s_cbranch_scc1 Lr2s_last
    ds_read_b128 v[56:59], v8 offset:16384
    ds_read_b128 v[60:63], v8 offset:17408
    v_mov_b64 v[20:21], s[52:53]
    v_mov_b64 v[22:23], s[52:53]
    v_mov_b32 v41, 0
    v_mov_b32 v42, 0
    v_max3_f32 v9, v12, v13, v14
    v_max3_f32 v9, v9, v15, v16
    v_max3_f32 v9, v9, v17, v18
    v_max3_f32 v9, v9, v19, v24
    v_max_f32 v9, v9, v25
    v_mov_b32 v10, v9
    v_mov_b64 v[32:33], 0
    v_mov_b64 v[34:35], 0
    v_permlane32_swap_b32 v9, v10
    v_max_f32 v9, v9, v10
    v_mov_b32 v10, v9
    s_nop 1
    v_permlane16_swap_b32 v9, v10
    v_max_f32 v9, v9, v10
    v_mul_f32 v28, s44, v9
    v_fma_f32 v12, v12, s44, -v28
    v_fma_f32 v13, v13, s44, -v28
    v_fma_f32 v14, v14, s44, -v28
    v_fma_f32 v15, v15, s44, -v28
    v_exp_f32 v12, v12
    v_exp_f32 v13, v13
    v_fma_f32 v16, v16, s44, -v28
    v_fma_f32 v17, v17, s44, -v28
    v_exp_f32 v14, v14
    v_exp_f32 v15, v15
    v_cvt_pk_bf16_f32 v36, v12, v13
    v_fma_f32 v18, v18, s44, -v28
    v_fma_f32 v19, v19, s44, -v28
    v_exp_f32 v16, v16
    v_exp_f32 v17, v17
    v_cvt_pk_bf16_f32 v37, v14, v15
    v_fma_f32 v24, v24, s44, -v28
    v_fma_f32 v25, v25, s44, -v28
    v_exp_f32 v18, v18
    v_exp_f32 v19, v19
    v_cvt_pk_bf16_f32 v38, v16, v17
    v_exp_f32 v24, v24
    v_exp_f32 v25, v25
    v_cvt_pk_bf16_f32 v39, v18, v19
    v_cvt_pk_bf16_f32 v40, v24, v25
    v_cvt_pk_bf16_f32 v43, v24, v25
    v_mfma_f32_16x16x32_bf16 v[52:55], v[20:23], v[36:39], 0
    v_mov_b64 v[12:13], 0
    v_mov_b64 v[14:15], 0
    s_waitcnt vmcnt(3)
    v_mfma_f32_16x16x32_bf16 v[44:47], v[64:67], v[36:39], 0
    v_mov_b64 v[24:25], 0
    v_mov_b64 v[26:27], 0
    s_waitcnt vmcnt(2)
    v_mfma_f32_16x16x32_bf16 v[48:51], v[68:71], v[36:39], 0
    ds_read_b128 v[64:67], v8 offset:20480
    ds_read_b128 v[68:71], v8 offset:21504
    v_mfma_f32_16x16x16_bf16 v[52:55], v[20:21], v[40:41], v[52:55]
    v_mfma_f32_16x16x16_bf16 v[44:47], v[30:31], v[40:41], v[44:47]
    v_mov_b64 v[20:21], 0
    v_mov_b64 v[22:23], 0
    v_mfma_f32_16x16x16_bf16 v[48:51], v[30:31], v[42:43], v[48:51]
    v_mov_b64 v[36:37], 0
    v_mov_b64 v[38:39], 0
    v_mov_b64 v[40:41], 0
    v_mov_b64 v[42:43], 0
    v_rcp_f32 v9, v52
    v_mov_b64 v[52:53], 0
    v_mov_b64 v[54:55], 0
    v_mul_f32 v44, v9, v44
    v_mul_f32 v48, v9, v48
    v_cvt_pk_bf16_f32 v16, v44, v48
    v_mul_f32 v45, v9, v45
    v_mul_f32 v49, v9, v49
    v_cvt_pk_bf16_f32 v17, v45, v49
    v_mul_f32 v46, v9, v46
    v_mul_f32 v50, v9, v50
    v_cvt_pk_bf16_f32 v18, v46, v50
    v_mul_f32 v47, v9, v47
    v_mul_f32 v51, v9, v51
    v_cvt_pk_bf16_f32 v19, v47, v51
    ds_write_b128 v5, v[16:19]
    v_mov_b64 v[28:29], 0
    v_mov_b64 v[30:31], 0
    s_waitcnt lgkmcnt(0)
    s_barrier
    ds_read_b128 v[44:47], v4 offset:0
    ds_read_b128 v[48:51], v4 offset:128
    v_mov_b64 v[16:17], 0
    v_mov_b64 v[18:19], 0
    buffer_load_dwordx4 v0, s[8:11], s41 offen offset:0 lds
    buffer_load_dwordx4 v0, s[8:11], s41 offen offset:1024 lds
    s_waitcnt lgkmcnt(1)
    v_smfmac_f32_16x16x64_bf16 v[12:15], v[44:47], a[184:191], v1
    s_waitcnt lgkmcnt(0)
    v_smfmac_f32_16x16x64_bf16 v[12:15], v[48:51], a[192:199], v1
    v_smfmac_f32_16x16x64_bf16 v[24:27], v[44:47], a[200:207], v1
    v_smfmac_f32_16x16x64_bf16 v[24:27], v[48:51], a[208:215], v1
    v_add_f32 v12, v12, v14
    v_smfmac_f32_16x16x64_bf16 v[20:23], v[44:47], a[216:223], v1
    v_add_f32 v13, v13, v15
    v_smfmac_f32_16x16x64_bf16 v[20:23], v[48:51], a[224:231], v1
    v_cvt_pk_bf16_f32 v12, v12, v13
    v_smfmac_f32_16x16x64_bf16 v[16:19], v[44:47], a[232:239], v1
    v_add_f32 v24, v24, v26
    v_smfmac_f32_16x16x64_bf16 v[16:19], v[48:51], a[240:247], v1
    v_add_f32 v25, v25, v27
    v_smfmac_f32_16x16x64_bf16 v[36:39], v[44:47], v[56:63], v1
    v_cvt_pk_bf16_f32 v13, v24, v25
    v_smfmac_f32_16x16x64_bf16 v[36:39], v[48:51], v[64:71], v1
    v_add_f32 v20, v20, v22
    v_add_f32 v21, v21, v23
    v_cvt_pk_bf16_f32 v14, v20, v21
    v_add_f32 v16, v16, v18
    v_add_f32 v17, v17, v19
    v_cvt_pk_bf16_f32 v15, v16, v17
    v_and_or_b32 v15, v15, -2, s40
    buffer_store_dwordx4 v[12:15], v0, s[8:11], s38 offen sc1
    s_nop 0
    ds_read_b128 v[12:15], v8 offset:18432
    ds_read_b128 v[16:19], v8 offset:19456
    ds_read_b128 v[20:23], v8 offset:22528
    ds_read_b128 v[24:27], v8 offset:23552
    ds_read_b128 v[56:59], v8 offset:24576
    ds_read_b128 v[60:63], v8 offset:25600
    ds_read_b128 v[64:67], v8 offset:28672
    ds_read_b128 v[68:71], v8 offset:29696
    s_waitcnt lgkmcnt(6)
    v_smfmac_f32_16x16x64_bf16 v[40:43], v[44:47], v[12:19], v1
    ds_read_b128 v[12:15], v8 offset:26624
    ds_read_b128 v[16:19], v8 offset:27648
    s_waitcnt lgkmcnt(6)
    v_smfmac_f32_16x16x64_bf16 v[40:43], v[48:51], v[20:27], v1
    ds_read_b128 v[20:23], v8 offset:30720
    ds_read_b128 v[24:27], v8 offset:31744
    s_waitcnt lgkmcnt(6)
    v_smfmac_f32_16x16x64_bf16 v[52:55], v[44:47], v[56:63], v1
    ds_read_b128 v[56:59], v8 offset:32768
    ds_read_b128 v[60:63], v8 offset:33792
    s_waitcnt lgkmcnt(6)
    v_smfmac_f32_16x16x64_bf16 v[52:55], v[48:51], v[64:71], v1
    s_waitcnt lgkmcnt(4)
    v_smfmac_f32_16x16x64_bf16 v[32:35], v[44:47], v[12:19], v1
    s_waitcnt lgkmcnt(2)
    v_smfmac_f32_16x16x64_bf16 v[32:35], v[48:51], v[20:27], v1
    v_smfmac_f32_16x16x64_bf16 v[28:31], v[44:47], a[248:255], v1
    s_waitcnt lgkmcnt(0)
    v_smfmac_f32_16x16x64_bf16 v[28:31], v[48:51], v[56:63], v1
    v_add_f32 v36, v36, v38
    v_add_f32 v37, v37, v39
    v_cvt_pk_bf16_f32 v36, v36, v37
    v_add_f32 v40, v40, v42
    v_add_f32 v41, v41, v43
    v_cvt_pk_bf16_f32 v37, v40, v41
    v_add_f32 v52, v52, v54
    v_add_f32 v53, v53, v55
    v_cvt_pk_bf16_f32 v38, v52, v53
    v_add_f32 v32, v32, v34
    v_add_f32 v33, v33, v35
    v_cvt_pk_bf16_f32 v39, v32, v33
    v_and_or_b32 v39, v39, -2, s40
    s_add_u32 s17, s38, 4096
    buffer_store_dwordx4 v[36:39], v0, s[8:11], s17 offen sc1
    v_add_f32 v28, v28, v30
    v_add_f32 v29, v29, v31
    v_cvt_pk_bf16_f32 v28, v28, v29
    v_and_or_b32 v28, v28, -2, s40
    v_lshrrev_b32 v9, 2, v0
    buffer_store_dword v28, v9, s[8:11], s39 offen sc1
    v_add_u32 v10, 162560, v0
    ds_read_b32 v64, v10
    v_mov_b32 v65, 0
    v_mov_b32 v41, 0
    v_mov_b32 v45, 0
    v_mov_b32 v49, 0
    v_mov_b32 v53, 0
    s_add_u32 s33, s33, 1
    s_add_u32 s42, s42, 262144
    s_add_u32 s41, s41, 262144
    s_add_u32 s43, s43, 131072
    s_add_u32 s68, s68, 262144
    s_add_u32 s66, s66, 22528
    ds_read_b128 v[56:59], v8 offset:4096
    ds_read_b128 v[60:63], v8 offset:5120
    v_mov_b64 v[12:13], 0
    v_mov_b64 v[14:15], 0
    v_mov_b64 v[16:17], 0
    v_mov_b64 v[18:19], 0
    v_mov_b64 v[20:21], 0
    v_mov_b64 v[22:23], 0
    v_mov_b64 v[24:25], 0
    v_mov_b64 v[26:27], 0
    v_mov_b64 v[28:29], 0
    v_mov_b64 v[30:31], 0
    v_mov_b64 v[32:33], 0
    v_mov_b64 v[34:35], 0
    s_nop 15
    s_nop 15
    s_nop 15
    s_nop 1
    buffer_load_dword v40, v6, s[8:11], s62 offen sc1
    buffer_load_dword v44, v6, s[8:11], s63 offen sc1
    buffer_load_dword v48, v6, s[8:11], s64 offen sc1
    buffer_load_dword v52, v6, s[8:11], s65 offen sc1
    s_waitcnt lgkmcnt(0)
    s_waitcnt vmcnt(3)
    v_mfma_f32_16x16x16_bf16 v[68:71], v[40:41], v[64:65], 0
    v_and_b32 v10, 1, v40
    v_cmp_ne_u32 s[54:55], s40, v10
    s_waitcnt vmcnt(2)
    v_mfma_f32_16x16x16_bf16 v[68:71], v[44:45], v[64:65], v[68:71]
    v_and_b32 v10, 1, v44
    v_cmp_ne_u32 s[56:57], s40, v10
    s_waitcnt vmcnt(1)
    v_mfma_f32_16x16x16_bf16 v[68:71], v[48:49], v[64:65], v[68:71]
    v_and_b32 v10, 1, v48
    v_cmp_ne_u32 s[58:59], s40, v10
    s_waitcnt vmcnt(0)
    v_mfma_f32_16x16x16_bf16 v[68:71], v[52:53], v[64:65], v[68:71]
    v_and_b32 v10, 1, v52
    v_cmp_ne_u32 s[60:61], s40, v10
    s_or_b64 vcc, s[54:55], s[56:57]
    s_or_b64 vcc, vcc, s[58:59]
    s_or_b64 vcc, vcc, s[60:61]
    s_cbranch_scc0 Lr2s_red
    s_mov_b32 s16, 0
Lr2s_p1:
    s_mov_b64 exec, s[54:55]
    buffer_load_dword v40, v6, s[8:11], s62 offen sc1
    s_mov_b64 exec, s[56:57]
    buffer_load_dword v44, v6, s[8:11], s63 offen sc1
    s_mov_b64 exec, s[58:59]
    buffer_load_dword v48, v6, s[8:11], s64 offen sc1
    s_mov_b64 exec, s[60:61]
    buffer_load_dword v52, v6, s[8:11], s65 offen sc1
    s_mov_b64 exec, -1
    s_add_u32 s16, s16, 1
    s_cmp_gt_u32 s16, 100000
    s_cbranch_scc1 Lr_abort
    s_waitcnt vmcnt(3)
    v_mfma_f32_16x16x16_bf16 v[68:71], v[40:41], v[64:65], 0
    v_and_b32 v10, 1, v40
    v_cmp_ne_u32 s[54:55], s40, v10
    s_waitcnt vmcnt(2)
    v_mfma_f32_16x16x16_bf16 v[68:71], v[44:45], v[64:65], v[68:71]
    v_and_b32 v10, 1, v44
    v_cmp_ne_u32 s[56:57], s40, v10
    s_waitcnt vmcnt(1)
    v_mfma_f32_16x16x16_bf16 v[68:71], v[48:49], v[64:65], v[68:71]
    v_and_b32 v10, 1, v48
    v_cmp_ne_u32 s[58:59], s40, v10
    s_waitcnt vmcnt(0)
    v_mfma_f32_16x16x16_bf16 v[68:71], v[52:53], v[64:65], v[68:71]
    v_and_b32 v10, 1, v52
    v_cmp_ne_u32 s[60:61], s40, v10
    s_or_b64 vcc, s[54:55], s[56:57]
    s_or_b64 vcc, vcc, s[58:59]
    s_or_b64 vcc, vcc, s[60:61]
    s_cbranch_scc1 Lr2s_p1
Lr2s_red:
    s_xor_b32 s34, s34, 16384
    s_xor_b32 s35, s35, 16384
    buffer_load_dwordx4 v[36:39], v0, s[8:11], s34 offen sc1
    v_permlane16_swap_b32 v68, v70
    v_permlane16_swap_b32 v69, v71
    s_mov_b64 exec, s[46:47]
    v_add_f32 v68, v68, v70
    v_add_f32 v69, v69, v71
    v_cvt_pk_bf16_f32 v68, v68, v69
    v_min_u32 v68, s50, v68
    buffer_store_dword v68, v7, s[8:11], s36 offen sc1
    v_mov_b32 v69, -1
    buffer_store_dword v69, v7, s[8:11], s37 offen sc1
    s_mov_b64 exec, -1
    buffer_load_dwordx4 v[36:39], v0, s[8:11], s34 offen sc1
    s_xor_b32 s40, s40, 1
    s_xor_b32 s36, s36, 16384
    s_xor_b32 s37, s37, 16384
    ds_read_b128 v[64:67], v8 offset:6144
    ds_read_b128 v[68:71], v8 offset:7168
    s_waitcnt lgkmcnt(0)
    s_branch Lr2s_step
Lr2s_pb_re:
    s_mov_b32 s16, 0
Lr2s_pb_lp:
    s_add_u32 s17, s34, 4096
    buffer_load_dwordx4 v[40:43], v0, s[8:11], s17 offen sc1
    s_add_u32 s16, s16, 1
    s_cmp_gt_u32 s16, 100000
    s_cbranch_scc1 Lr_abort
    s_waitcnt vmcnt(0)
    v_max3_u32 v10, v40, v41, v42
    v_max_u32 v10, v10, v43
    v_cmp_eq_u32 vcc, -1, v10
    s_nop 0
    s_cbranch_vccnz Lr2s_pb_lp
    s_branch Lr2s_pb_ok
Lr2s_pc_re:
    s_mov_b32 s16, 0
Lr2s_pc_lp:
    buffer_load_dwordx4 v[44:47], v0, s[8:11], s35 offen sc1
    s_add_u32 s16, s16, 1
    s_cmp_gt_u32 s16, 100000
    s_cbranch_scc1 Lr_abort
    s_waitcnt vmcnt(0)
    v_max3_u32 v10, v44, v45, v46
    v_max_u32 v10, v10, v47
    v_cmp_eq_u32 vcc, -1, v10
    s_nop 0
    s_cbranch_vccnz Lr2s_pc_lp
    s_branch Lr2s_pc_ok
Lr2s_flbad:
    s_cmp_eq_u32 s33, 63
    s_cbranch_scc1 Lr2s_flok
    s_mov_b32 s16, 0
    s_add_u32 s17, s66, 22656
    v_lshrrev_b32 v10, 2, v0
    v_and_b32 v9, 16, v10
    v_lshlrev_b32 v9, 3, v9
    v_and_or_b32 v10, v10, 12, v9
Lr2s_fw_18:
    buffer_load_dword v9, v10, s[8:11], s17 offen sc1
    s_add_u32 s16, s16, 1
    s_cmp_gt_u32 s16, 100000
    s_cbranch_scc1 Lr_abort
    s_waitcnt vmcnt(0)
    v_cmp_eq_u32 vcc, 0, v9
    s_nop 0
    s_cbranch_vccnz Lr2s_fw_18
    s_branch Lr2s_flok
Lr2s_last:
    s_waitcnt vmcnt(0) lgkmcnt(0)
    s_barrier
    s_branch Lr_exit
L_w3_0:
    s_mov_b32 s16, 0
    s_add_u32 s17, s66, 128
    v_lshrrev_b32 v10, 2, v0
    v_and_b32 v9, 16, v10
    v_lshlrev_b32 v9, 3, v9
    v_and_or_b32 v10, v10, 12, v9
Lr3s_fw_19:
    buffer_load_dword v9, v10, s[8:11], s17 offen sc1
    s_add_u32 s16, s16, 1
    s_cmp_gt_u32 s16, 100000
    s_cbranch_scc1 Lr_abort
    s_waitcnt vmcnt(0)
    v_cmp_eq_u32 vcc, 0, v9
    s_nop 0
    s_cbranch_vccnz Lr3s_fw_19
    s_mov_b32 m0, 21248
    s_nop 0
    buffer_load_dwordx4 v0, s[8:11], s41 offen offset:0 lds
    buffer_load_dwordx4 v0, s[8:11], s41 offen offset:1024 lds
    s_add_u32 s41, s41, 262144
    s_add_u32 s68, s68, 262144
    s_waitcnt vmcnt(0)
    ds_read_b128 v[56:59], v8 offset:0
    ds_read_b128 v[60:63], v8 offset:1024
    ds_read_b128 v[64:67], v8 offset:2048
    ds_read_b128 v[68:71], v8 offset:3072
    v_mov_b64 v[12:13], 0
    v_mov_b64 v[14:15], 0
    v_mov_b64 v[16:17], 0
    v_mov_b64 v[18:19], 0
    v_mov_b64 v[20:21], 0
    v_mov_b64 v[22:23], 0
    v_mov_b64 v[24:25], 0
    v_mov_b64 v[26:27], 0
    v_mov_b64 v[28:29], 0
    v_mov_b64 v[30:31], 0
    v_mov_b64 v[32:33], 0
    v_mov_b64 v[34:35], 0
    buffer_load_dwordx4 v[36:39], v0, s[8:11], s34 offen sc1
    s_waitcnt vmcnt(0) lgkmcnt(0)
Lr3s_step:
    s_mov_b32 s16, 0
Lr3s_alp:
    s_waitcnt vmcnt(2)
    v_max3_u32 v10, v36, v37, v38
    v_max_u32 v10, v10, v39
    v_cmp_eq_u32 vcc, -1, v10
    s_nop 0
    s_cbranch_vccz Lr3s_aok
    buffer_load_dwordx4 v[36:39], v0, s[8:11], s34 offen sc1
    s_add_u32 s16, s16, 1
    s_cmp_gt_u32 s16, 100000
    s_cbranch_scc1 Lr_abort
    s_branch Lr3s_alp
Lr3s_aok:
    ds_write_b128 v0, v[36:39] offset:9984
    v_smfmac_f32_16x16x64_bf16 v[12:15], v[36:39], v[120:127], v1
    v_smfmac_f32_16x16x64_bf16 v[16:19], v[36:39], v[128:135], v1
    v_smfmac_f32_16x16x64_bf16 v[20:23], v[36:39], v[232:239], v1
    s_waitcnt lgkmcnt(0)
    s_barrier
    ds_read_b128 v[48:51], v0 offset:6912
    ds_read_b128 v[52:55], v0 offset:7936
    v_smfmac_f32_16x16x64_bf16 v[28:31], v[36:39], a[88:95], v1
    v_smfmac_f32_16x16x64_bf16 v[24:27], v[36:39], v[240:247], v1
    v_smfmac_f32_16x16x64_bf16 v[32:35], v[36:39], a[96:103], v1
    s_waitcnt vmcnt(0)
    ds_read_b128 v[36:39], v0 offset:8960
    s_waitcnt lgkmcnt(2)
    v_smfmac_f32_16x16x64_bf16 v[28:31], v[48:51], v[56:63], v1
    ds_read_b128 v[56:59], v8 offset:4096
    ds_read_b128 v[60:63], v8 offset:5120
    s_add_u32 s17, s34, 4096
    buffer_load_dwordx4 v[40:43], v0, s[8:11], s17 offen sc1
    v_smfmac_f32_16x16x64_bf16 v[12:15], v[48:51], v[72:79], v1
    v_smfmac_f32_16x16x64_bf16 v[16:19], v[48:51], v[80:87], v1
    v_smfmac_f32_16x16x64_bf16 v[32:35], v[48:51], v[64:71], v1
    ds_read_b128 v[64:67], v8 offset:6144
    ds_read_b128 v[68:71], v8 offset:7168
    v_smfmac_f32_16x16x64_bf16 v[20:23], v[48:51], v[184:191], v1
    buffer_load_dwordx4 v[44:47], v0, s[8:11], s35 offen sc1
    v_smfmac_f32_16x16x64_bf16 v[24:27], v[48:51], v[192:199], v1
    s_waitcnt lgkmcnt(5)
    v_smfmac_f32_16x16x64_bf16 v[28:31], v[52:55], a[72:79], v1
    v_smfmac_f32_16x16x64_bf16 v[12:15], v[52:55], v[88:95], v1
    v_smfmac_f32_16x16x64_bf16 v[16:19], v[52:55], v[96:103], v1
    v_smfmac_f32_16x16x64_bf16 v[32:35], v[52:55], a[80:87], v1
    v_smfmac_f32_16x16x64_bf16 v[20:23], v[52:55], v[200:207], v1
    v_smfmac_f32_16x16x64_bf16 v[24:27], v[52:55], v[208:215], v1
    s_waitcnt lgkmcnt(2)
    v_smfmac_f32_16x16x64_bf16 v[28:31], v[36:39], v[56:63], v1
    ds_read_b128 v[56:59], v8 offset:8192
    ds_read_b128 v[60:63], v8 offset:9216
    v_smfmac_f32_16x16x64_bf16 v[12:15], v[36:39], v[104:111], v1
    v_smfmac_f32_16x16x64_bf16 v[16:19], v[36:39], v[112:119], v1
    s_waitcnt lgkmcnt(2)
    v_smfmac_f32_16x16x64_bf16 v[32:35], v[36:39], v[64:71], v1
    ds_read_b128 v[64:67], v8 offset:10240
    ds_read_b128 v[68:71], v8 offset:11264
    v_smfmac_f32_16x16x64_bf16 v[20:23], v[36:39], v[216:223], v1
    v_smfmac_f32_16x16x64_bf16 v[24:27], v[36:39], v[224:231], v1
    s_waitcnt vmcnt(1)
    v_max3_u32 v10, v40, v41, v42
    v_max_u32 v10, v10, v43
    v_cmp_eq_u32 vcc, -1, v10
    s_nop 0
    s_cbranch_vccnz Lr3s_pb_re
Lr3s_pb_ok:
    ds_write_b128 v0, v[40:43] offset:14080
    v_smfmac_f32_16x16x64_bf16 v[12:15], v[40:43], v[152:159], v1
    v_smfmac_f32_16x16x64_bf16 v[20:23], v[40:43], a[40:47], v1
    v_smfmac_f32_16x16x64_bf16 v[16:19], v[40:43], v[160:167], v1
    v_smfmac_f32_16x16x64_bf16 v[24:27], v[40:43], a[48:55], v1
    s_waitcnt lgkmcnt(0)
    s_barrier
    ds_read_b128 v[48:51], v0 offset:11008
    ds_read_b128 v[52:55], v0 offset:12032
    ds_read_b128 v[36:39], v0 offset:13056
    v_smfmac_f32_16x16x64_bf16 v[28:31], v[40:43], a[152:159], v1
    v_smfmac_f32_16x16x64_bf16 v[32:35], v[40:43], a[160:167], v1
    s_waitcnt lgkmcnt(2)
    v_smfmac_f32_16x16x64_bf16 v[12:15], v[48:51], v[56:63], v1
    ds_read_b128 v[56:59], v8 offset:12288
    ds_read_b128 v[60:63], v8 offset:13312
    v_smfmac_f32_16x16x64_bf16 v[16:19], v[48:51], v[64:71], v1
    ds_read_b128 v[64:67], v8 offset:14336
    ds_read_b128 v[68:71], v8 offset:15360
    s_waitcnt lgkmcnt(5)
    v_smfmac_f32_16x16x64_bf16 v[12:15], v[52:55], v[136:143], v1
    v_smfmac_f32_16x16x64_bf16 v[16:19], v[52:55], v[144:151], v1
    s_waitcnt vmcnt(0)
    v_max3_u32 v10, v44, v45, v46
    v_max_u32 v10, v10, v47
    v_cmp_eq_u32 vcc, -1, v10
    s_nop 0
    s_cbranch_vccnz Lr3s_pc_re
Lr3s_pc_ok:
    v_smfmac_f32_16x16x64_bf16 v[12:15], v[44:47], v[168:175], v1
    v_smfmac_f32_16x16x64_bf16 v[16:19], v[44:47], v[176:183], v1
    s_waitcnt lgkmcnt(2)
    v_smfmac_f32_16x16x64_bf16 v[12:15], v[36:39], v[56:63], v1
    s_waitcnt lgkmcnt(0)
    v_smfmac_f32_16x16x64_bf16 v[16:19], v[36:39], v[64:71], v1
    v_smfmac_f32_16x16x64_bf16 v[20:23], v[48:51], v[248:255], v1
    v_smfmac_f32_16x16x64_bf16 v[24:27], v[48:51], a[0:7], v1
    v_smfmac_f32_16x16x64_bf16 v[20:23], v[52:55], a[8:15], v1
    v_add_f32 v12, v12, v14
    v_smfmac_f32_16x16x64_bf16 v[24:27], v[52:55], a[16:23], v1
    v_add_f32 v16, v16, v18
    buffer_load_dwordx4 v[64:67], v0, s[8:11], s42 offen
    v_smfmac_f32_16x16x64_bf16 v[20:23], v[36:39], a[24:31], v1
    v_add_f32 v13, v13, v15
    v_smfmac_f32_16x16x64_bf16 v[24:27], v[36:39], a[32:39], v1
    v_add_f32 v17, v17, v19
    v_smfmac_f32_16x16x64_bf16 v[20:23], v[44:47], a[56:63], v1
    v_cvt_pk_bf16_f32 v14, v12, v16
    ds_read_b128 v[56:59], v0 offset:15104
    v_smfmac_f32_16x16x64_bf16 v[24:27], v[44:47], a[64:71], v1
    v_cvt_pk_bf16_f32 v15, v13, v17
    ds_read_b128 v[60:63], v0 offset:16128
    buffer_load_dwordx4 v[68:71], v0, s[8:11], s42 offen offset:1024
    ds_write_b32 v2, v14 offset:576
    ds_write_b32 v2, v15 offset:864
    v_smfmac_f32_16x16x64_bf16 v[28:31], v[48:51], a[104:111], v1
    v_smfmac_f32_16x16x64_bf16 v[32:35], v[48:51], a[112:119], v1
    v_add_f32 v20, v20, v22
    v_add_f32 v24, v24, v26
    v_add_f32 v21, v21, v23
    v_add_f32 v25, v25, v27
    v_cvt_pk_bf16_f32 v22, v20, v24
    v_cvt_pk_bf16_f32 v23, v21, v25
    ds_write_b32 v2, v22 offset:0
    ds_write_b32 v2, v23 offset:288
    v_smfmac_f32_16x16x64_bf16 v[28:31], v[52:55], a[120:127], v1
    v_smfmac_f32_16x16x64_bf16 v[32:35], v[52:55], a[128:135], v1
    s_waitcnt lgkmcnt(0)
    s_barrier
    ds_read_b128 v[40:43], v3 offset:0
    ds_read_b128 v[48:51], v3 offset:64
    ds_read_b128 v[20:23], v3 offset:128
    ds_read_b128 v[52:55], v3 offset:192
    v_smfmac_f32_16x16x64_bf16 v[28:31], v[36:39], a[136:143], v1
    v_smfmac_f32_16x16x64_bf16 v[32:35], v[36:39], a[144:151], v1
    ds_read_b128 v[36:39], v0 offset:17152
    v_lshlrev_b32 v9, 3, v0
    buffer_load_dword v11, v9, s[8:11], s68 offen
    v_smfmac_f32_16x16x64_bf16 v[28:31], v[44:47], a[168:175], v1
    v_smfmac_f32_16x16x64_bf16 v[32:35], v[44:47], a[176:183], v1
    ds_read_b128 v[44:47], v0 offset:18176
    s_waitcnt lgkmcnt(5)
    v_mfma_f32_16x16x32_bf16 v[12:15], v[56:59], v[40:43], 0
    v_mfma_f32_16x16x32_bf16 v[16:19], v[60:63], v[40:43], 0
    v_mfma_f32_16x16x32_bf16 v[24:27], v[40:43], v[40:43], 0
    ds_read_b128 v[56:59], v0 offset:19200
    ds_read_b128 v[60:63], v0 offset:20224
    s_waitcnt lgkmcnt(3)
    v_mfma_f32_16x16x32_bf16 v[12:15], v[36:39], v[48:51], v[12:15]
    v_lshrrev_b32 v10, 1, v0
    v_lshrrev_b32 v9, 9, v0
    s_waitcnt lgkmcnt(2)
    v_mfma_f32_16x16x32_bf16 v[16:19], v[44:47], v[48:51], v[16:19]
    v_lshl_add_u32 v9, v9, 5, v10
    v_add_f32 v28, v28, v30
    v_mfma_f32_16x16x32_bf16 v[24:27], v[48:51], v[48:51], v[24:27]
    v_add_f32 v32, v32, v34
    v_add_f32 v29, v29, v31
    ds_read_b128 v[36:39], v0 offset:21248
    ds_read_b128 v[44:47], v0 offset:22272
    s_waitcnt lgkmcnt(3)
    v_mfma_f32_16x16x32_bf16 v[12:15], v[56:59], v[20:23], v[12:15]
    v_add_f32 v33, v33, v35
    v_cvt_pk_bf16_f32 v30, v28, v29
    s_waitcnt lgkmcnt(2)
    v_mfma_f32_16x16x32_bf16 v[16:19], v[60:63], v[20:23], v[16:19]
    v_cvt_pk_bf16_f32 v31, v32, v33
    ds_read_b64 v[34:35], v9 offset:3456
    v_mfma_f32_16x16x32_bf16 v[24:27], v[20:23], v[20:23], v[24:27]
    s_add_u32 s17, s43, 3584
    buffer_store_dwordx2 v[30:31], v10, s[8:11], s17 offen sc1
    s_waitcnt lgkmcnt(2)
    v_mfma_f32_16x16x32_bf16 v[12:15], v[36:39], v[52:55], v[12:15]
    s_waitcnt lgkmcnt(1)
    v_mfma_f32_16x16x32_bf16 v[16:19], v[44:47], v[52:55], v[16:19]
    v_mfma_f32_16x16x32_bf16 v[24:27], v[52:55], v[52:55], v[24:27]
    s_add_u32 s17, s43, 1536
    s_waitcnt lgkmcnt(0)
    buffer_store_dwordx2 v[34:35], v10, s[8:11], s17 offen sc1
    s_cmp_eq_u32 s33, 63
    s_cbranch_scc1 Lr3s_last
    ds_read_b128 v[56:59], v8 offset:16384
    ds_read_b128 v[60:63], v8 offset:17408
    v_mov_b64 v[20:21], s[52:53]
    v_mov_b64 v[22:23], s[52:53]
    v_mov_b32 v41, 0
    v_mov_b32 v42, 0
    v_max3_f32 v9, v12, v13, v14
    v_max3_f32 v9, v9, v15, v16
    v_max3_f32 v9, v9, v17, v18
    v_max3_f32 v9, v9, v19, v24
    v_max_f32 v9, v9, v25
    v_mov_b32 v10, v9
    v_mov_b64 v[32:33], 0
    v_mov_b64 v[34:35], 0
    v_permlane32_swap_b32 v9, v10
    v_max_f32 v9, v9, v10
    v_mov_b32 v10, v9
    s_nop 1
    v_permlane16_swap_b32 v9, v10
    v_max_f32 v9, v9, v10
    v_mul_f32 v28, s44, v9
    v_fma_f32 v12, v12, s44, -v28
    v_fma_f32 v13, v13, s44, -v28
    v_fma_f32 v14, v14, s44, -v28
    v_fma_f32 v15, v15, s44, -v28
    v_exp_f32 v12, v12
    v_exp_f32 v13, v13
    v_fma_f32 v16, v16, s44, -v28
    v_fma_f32 v17, v17, s44, -v28
    v_exp_f32 v14, v14
    v_exp_f32 v15, v15
    v_cvt_pk_bf16_f32 v36, v12, v13
    v_fma_f32 v18, v18, s44, -v28
    v_fma_f32 v19, v19, s44, -v28
    v_exp_f32 v16, v16
    v_exp_f32 v17, v17
    v_cvt_pk_bf16_f32 v37, v14, v15
    v_fma_f32 v24, v24, s44, -v28
    v_fma_f32 v25, v25, s44, -v28
    v_exp_f32 v18, v18
    v_exp_f32 v19, v19
    v_cvt_pk_bf16_f32 v38, v16, v17
    v_exp_f32 v24, v24
    v_exp_f32 v25, v25
    v_cvt_pk_bf16_f32 v39, v18, v19
    v_cvt_pk_bf16_f32 v40, v24, v25
    v_cvt_pk_bf16_f32 v43, v24, v25
    v_mfma_f32_16x16x32_bf16 v[52:55], v[20:23], v[36:39], 0
    v_mov_b64 v[12:13], 0
    v_mov_b64 v[14:15], 0
    s_waitcnt vmcnt(4)
    v_mfma_f32_16x16x32_bf16 v[44:47], v[64:67], v[36:39], 0
    v_mov_b64 v[24:25], 0
    v_mov_b64 v[26:27], 0
    s_waitcnt vmcnt(3)
    v_mfma_f32_16x16x32_bf16 v[48:51], v[68:71], v[36:39], 0
    ds_read_b128 v[64:67], v8 offset:20480
    ds_read_b128 v[68:71], v8 offset:21504
    v_mfma_f32_16x16x16_bf16 v[52:55], v[20:21], v[40:41], v[52:55]
    v_mfma_f32_16x16x16_bf16 v[44:47], v[30:31], v[40:41], v[44:47]
    v_mov_b64 v[20:21], 0
    v_mov_b64 v[22:23], 0
    v_mfma_f32_16x16x16_bf16 v[48:51], v[30:31], v[42:43], v[48:51]
    v_mov_b64 v[36:37], 0
    v_mov_b64 v[38:39], 0
    v_mov_b64 v[40:41], 0
    v_mov_b64 v[42:43], 0
    v_rcp_f32 v9, v52
    v_mov_b64 v[52:53], 0
    v_mov_b64 v[54:55], 0
    v_mul_f32 v44, v9, v44
    v_mul_f32 v48, v9, v48
    v_cvt_pk_bf16_f32 v16, v44, v48
    v_mul_f32 v45, v9, v45
    v_mul_f32 v49, v9, v49
    v_cvt_pk_bf16_f32 v17, v45, v49
    v_mul_f32 v46, v9, v46
    v_mul_f32 v50, v9, v50
    v_cvt_pk_bf16_f32 v18, v46, v50
    v_mul_f32 v47, v9, v47
    v_mul_f32 v51, v9, v51
    v_cvt_pk_bf16_f32 v19, v47, v51
    ds_write_b128 v5, v[16:19]
    v_mov_b64 v[28:29], 0
    v_mov_b64 v[30:31], 0
    s_waitcnt lgkmcnt(0)
    s_barrier
    ds_read_b128 v[44:47], v4 offset:0
    ds_read_b128 v[48:51], v4 offset:128
    v_mov_b64 v[16:17], 0
    v_mov_b64 v[18:19], 0
    buffer_load_dwordx4 v0, s[8:11], s41 offen offset:0 lds
    buffer_load_dwordx4 v0, s[8:11], s41 offen offset:1024 lds
    s_waitcnt lgkmcnt(1)
    v_smfmac_f32_16x16x64_bf16 v[12:15], v[44:47], a[184:191], v1
    s_waitcnt lgkmcnt(0)
    v_smfmac_f32_16x16x64_bf16 v[12:15], v[48:51], a[192:199], v1
    v_smfmac_f32_16x16x64_bf16 v[24:27], v[44:47], a[200:207], v1
    v_smfmac_f32_16x16x64_bf16 v[24:27], v[48:51], a[208:215], v1
    v_add_f32 v12, v12, v14
    v_smfmac_f32_16x16x64_bf16 v[20:23], v[44:47], a[216:223], v1
    v_add_f32 v13, v13, v15
    v_smfmac_f32_16x16x64_bf16 v[20:23], v[48:51], a[224:231], v1
    v_cvt_pk_bf16_f32 v12, v12, v13
    v_smfmac_f32_16x16x64_bf16 v[16:19], v[44:47], a[232:239], v1
    v_add_f32 v24, v24, v26
    v_smfmac_f32_16x16x64_bf16 v[16:19], v[48:51], a[240:247], v1
    v_add_f32 v25, v25, v27
    v_smfmac_f32_16x16x64_bf16 v[36:39], v[44:47], v[56:63], v1
    v_cvt_pk_bf16_f32 v13, v24, v25
    v_smfmac_f32_16x16x64_bf16 v[36:39], v[48:51], v[64:71], v1
    v_add_f32 v20, v20, v22
    v_add_f32 v21, v21, v23
    v_cvt_pk_bf16_f32 v14, v20, v21
    v_add_f32 v16, v16, v18
    v_add_f32 v17, v17, v19
    v_cvt_pk_bf16_f32 v15, v16, v17
    v_and_or_b32 v15, v15, -2, s40
    buffer_store_dwordx4 v[12:15], v0, s[8:11], s38 offen sc1
    s_nop 0
    ds_read_b128 v[12:15], v8 offset:18432
    ds_read_b128 v[16:19], v8 offset:19456
    ds_read_b128 v[20:23], v8 offset:22528
    ds_read_b128 v[24:27], v8 offset:23552
    ds_read_b128 v[56:59], v8 offset:24576
    ds_read_b128 v[60:63], v8 offset:25600
    ds_read_b128 v[64:67], v8 offset:28672
    ds_read_b128 v[68:71], v8 offset:29696
    s_waitcnt lgkmcnt(6)
    v_smfmac_f32_16x16x64_bf16 v[40:43], v[44:47], v[12:19], v1
    ds_read_b128 v[12:15], v8 offset:26624
    ds_read_b128 v[16:19], v8 offset:27648
    s_waitcnt lgkmcnt(6)
    v_smfmac_f32_16x16x64_bf16 v[40:43], v[48:51], v[20:27], v1
    ds_read_b128 v[20:23], v8 offset:30720
    ds_read_b128 v[24:27], v8 offset:31744
    s_waitcnt lgkmcnt(6)
    v_smfmac_f32_16x16x64_bf16 v[52:55], v[44:47], v[56:63], v1
    ds_read_b128 v[56:59], v8 offset:32768
    ds_read_b128 v[60:63], v8 offset:33792
    s_waitcnt lgkmcnt(6)
    v_smfmac_f32_16x16x64_bf16 v[52:55], v[48:51], v[64:71], v1
    s_waitcnt lgkmcnt(4)
    v_smfmac_f32_16x16x64_bf16 v[32:35], v[44:47], v[12:19], v1
    s_waitcnt lgkmcnt(2)
    v_smfmac_f32_16x16x64_bf16 v[32:35], v[48:51], v[20:27], v1
    v_smfmac_f32_16x16x64_bf16 v[28:31], v[44:47], a[248:255], v1
    s_waitcnt lgkmcnt(0)
    v_smfmac_f32_16x16x64_bf16 v[28:31], v[48:51], v[56:63], v1
    v_add_f32 v36, v36, v38
    v_add_f32 v37, v37, v39
    v_cvt_pk_bf16_f32 v36, v36, v37
    v_add_f32 v40, v40, v42
    v_add_f32 v41, v41, v43
    v_cvt_pk_bf16_f32 v37, v40, v41
    v_add_f32 v52, v52, v54
    v_add_f32 v53, v53, v55
    v_cvt_pk_bf16_f32 v38, v52, v53
    v_add_f32 v32, v32, v34
    v_add_f32 v33, v33, v35
    v_cvt_pk_bf16_f32 v39, v32, v33
    v_and_or_b32 v39, v39, -2, s40
    s_add_u32 s17, s38, 4096
    buffer_store_dwordx4 v[36:39], v0, s[8:11], s17 offen sc1
    v_add_f32 v28, v28, v30
    v_add_f32 v29, v29, v31
    v_cvt_pk_bf16_f32 v28, v28, v29
    v_and_or_b32 v28, v28, -2, s40
    v_lshrrev_b32 v9, 2, v0
    buffer_store_dword v28, v9, s[8:11], s39 offen sc1
    s_xor_b32 s34, s34, 16384
    s_xor_b32 s35, s35, 16384
    s_add_u32 s33, s33, 1
    s_add_u32 s42, s42, 262144
    s_add_u32 s41, s41, 262144
    s_add_u32 s43, s43, 131072
    s_add_u32 s68, s68, 262144
    s_add_u32 s66, s66, 22528
    s_xor_b32 s40, s40, 1
    ds_read_b128 v[56:59], v8 offset:0
    ds_read_b128 v[60:63], v8 offset:1024
    ds_read_b128 v[64:67], v8 offset:2048
    ds_read_b128 v[68:71], v8 offset:3072
    v_mov_b64 v[12:13], 0
    v_mov_b64 v[14:15], 0
    v_mov_b64 v[16:17], 0
    v_mov_b64 v[18:19], 0
    v_mov_b64 v[20:21], 0
    v_mov_b64 v[22:23], 0
    v_mov_b64 v[24:25], 0
    v_mov_b64 v[26:27], 0
    v_mov_b64 v[28:29], 0
    v_mov_b64 v[30:31], 0
    v_mov_b64 v[32:33], 0
    v_mov_b64 v[34:35], 0
    s_sleep 5
    s_nop 9
    buffer_load_dwordx4 v[36:39], v0, s[8:11], s34 offen sc1
    s_nop 15
    s_nop 8
    buffer_load_dwordx4 v[36:39], v0, s[8:11], s34 offen sc1
    s_nop 15
    s_nop 8
    buffer_load_dwordx4 v[36:39], v0, s[8:11], s34 offen sc1
    s_waitcnt lgkmcnt(0)
    s_branch Lr3s_step
Lr3s_pb_re:
    s_mov_b32 s16, 0
Lr3s_pb_lp:
    s_add_u32 s17, s34, 4096
    buffer_load_dwordx4 v[40:43], v0, s[8:11], s17 offen sc1
    s_add_u32 s16, s16, 1
    s_cmp_gt_u32 s16, 100000
    s_cbranch_scc1 Lr_abort
    s_waitcnt vmcnt(0)
    v_max3_u32 v10, v40, v41, v42
    v_max_u32 v10, v10, v43
    v_cmp_eq_u32 vcc, -1, v10
    s_nop 0
    s_cbranch_vccnz Lr3s_pb_lp
    s_branch Lr3s_pb_ok
Lr3s_pc_re:
    s_mov_b32 s16, 0
Lr3s_pc_lp:
    buffer_load_dwordx4 v[44:47], v0, s[8:11], s35 offen sc1
    s_add_u32 s16, s16, 1
    s_cmp_gt_u32 s16, 100000
    s_cbranch_scc1 Lr_abort
    s_waitcnt vmcnt(0)
    v_max3_u32 v10, v44, v45, v46
    v_max_u32 v10, v10, v47
    v_cmp_eq_u32 vcc, -1, v10
    s_nop 0
    s_cbranch_vccnz Lr3s_pc_lp
    s_branch Lr3s_pc_ok
Lr3s_last:
    s_waitcnt vmcnt(0) lgkmcnt(0)
    s_barrier
    s_branch Lr_exit
Lr_abort:
    s_waitcnt lgkmcnt(0)
    s_mov_b64 exec, -1
    v_mov_b32 v0, 60
    s_lshl_b32 s5, s3, 8
    s_or_b32 s5, s5, s4
    s_or_b32 s5, s5, 0x10000
    v_mov_b32 v1, s5
    global_store_dword v0, v1, s[12:13]
    s_endpgm
Lr_exit:
    s_endpgm
.section .rodata,"a"
.p2align 6
.amdhsa_kernel interleave_layers__sliding_local_dilated__memory_aug_recurrent_mem_tr__prompt_kernel
  .amdhsa_next_free_vgpr 512
  .amdhsa_next_free_sgpr 102
  .amdhsa_accum_offset 256
  .amdhsa_group_segment_fixed_size 0
  .amdhsa_kernarg_size 104
  .amdhsa_user_sgpr_count 2
  .amdhsa_user_sgpr_kernarg_segment_ptr 1
  .amdhsa_system_sgpr_workgroup_id_x 1
.end_amdhsa_kernel
```

```asm
; @launch grid=(256,1,1) block=(256,1,1) lds=163840
.amdgcn_target "amdgcn-amd-amdhsa--gfx950"
.text
.globl interleave_layers__sliding_local_dilated__memory_aug_recurrent_mem_tr__prompt_kernel
.p2align 8
.type interleave_layers__sliding_local_dilated__memory_aug_recurrent_mem_tr__prompt_kernel,@function
interleave_layers__sliding_local_dilated__memory_aug_recurrent_mem_tr__prompt_kernel:
    s_cmp_ge_u32 s2, 256
    s_cbranch_scc1 L_exit
    s_load_dwordx2 s[8:9], s[0:1], 96
    s_mov_b32 s10, 268435456
    s_mov_b32 s11, 0x00020000
    s_waitcnt lgkmcnt(0)
    s_and_b32 s9, s9, 0xffff
    s_load_dwordx2 s[12:13], s[0:1], 88
    v_lshrrev_b32 v1, 6, v0
    s_getreg_b32 s3, hwreg(HW_REG_XCC_ID)
    v_readfirstlane_b32 s14, v1
    s_and_b32 s3, s3, 7
    s_and_b32 s17, s3, 1
    s_lshl_b32 s17, s17, 7
    s_lshl_b32 s18, s3, 1
    s_and_b32 s18, s18, 12
    s_add_u32 s17, s17, s18
    v_mov_b32 v2, 0
    v_mov_b32 v3, 1
    v_mov_b32 v4, s17
    s_mov_b32 s33, 0
    s_waitcnt lgkmcnt(0)
    s_cmp_lg_u32 s14, 0
    s_cbranch_scc1 L_tk_wait
    s_mov_b64 exec, 1
    global_atomic_add v3, v4, v3, s[12:13] sc0
    s_waitcnt vmcnt(0)
    v_readfirstlane_b32 s4, v3
    s_nop 0
    s_cmp_lt_u32 s4, 32
    s_cbranch_scc1 L_tk_have
    v_mov_b32 v3, 1
    v_mov_b32 v4, 32
    global_atomic_add v3, v4, v3, s[12:13] sc0
    s_waitcnt vmcnt(0)
    v_readfirstlane_b32 s5, v3
    s_mov_b64 exec, 0xff
    v_and_b32 v4, 1, v0
    v_lshlrev_b32 v4, 7, v4
    v_lshlrev_b32 v5, 1, v0
    v_and_or_b32 v4, v5, 12, v4
    s_mov_b32 s16, 0
L_hl_poll:
    global_load_dword v5, v4, s[12:13] sc1
    s_add_u32 s16, s16, 1
    s_cmp_gt_u32 s16, 100000
    s_cbranch_scc1 L_abort
    s_mov_b32 s6, 0
    s_waitcnt vmcnt(0)
    v_readlane_b32 s40, v5, 0
    s_nop 0
    s_add_u32 s6, s6, s40
    v_readlane_b32 s41, v5, 1
    s_nop 0
    s_add_u32 s6, s6, s41
    v_readlane_b32 s42, v5, 2
    s_nop 0
    s_add_u32 s6, s6, s42
    v_readlane_b32 s43, v5, 3
    s_nop 0
    s_add_u32 s6, s6, s43
    v_readlane_b32 s44, v5, 4
    s_nop 0
    s_add_u32 s6, s6, s44
    v_readlane_b32 s45, v5, 5
    s_nop 0
    s_add_u32 s6, s6, s45
    v_readlane_b32 s46, v5, 6
    s_nop 0
    s_add_u32 s6, s6, s46
    v_readlane_b32 s47, v5, 7
    s_nop 0
    s_add_u32 s6, s6, s47
    s_cmp_lt_u32 s6, 256
    s_cbranch_scc1 L_hl_poll
    s_mov_b32 s3, 0
    s_mov_b32 s4, 0
    s_min_u32 s6, s47, 32
    s_sub_u32 s7, 32, s6
    s_cmp_lt_u32 s5, s7
    s_cselect_b32 s3, 7, s3
    s_add_u32 s6, s6, s5
    s_cmp_lt_u32 s5, s7
    s_cselect_b32 s4, s6, s4
    s_sub_u32 s5, s5, s7
    s_min_u32 s6, s46, 32
    s_sub_u32 s7, 32, s6
    s_cmp_lt_u32 s5, s7
    s_cselect_b32 s3, 6, s3
    s_add_u32 s6, s6, s5
    s_cmp_lt_u32 s5, s7
    s_cselect_b32 s4, s6, s4
    s_sub_u32 s5, s5, s7
    s_min_u32 s6, s45, 32
    s_sub_u32 s7, 32, s6
    s_cmp_lt_u32 s5, s7
    s_cselect_b32 s3, 5, s3
    s_add_u32 s6, s6, s5
    s_cmp_lt_u32 s5, s7
    s_cselect_b32 s4, s6, s4
    s_sub_u32 s5, s5, s7
    s_min_u32 s6, s44, 32
    s_sub_u32 s7, 32, s6
    s_cmp_lt_u32 s5, s7
    s_cselect_b32 s3, 4, s3
    s_add_u32 s6, s6, s5
    s_cmp_lt_u32 s5, s7
    s_cselect_b32 s4, s6, s4
    s_sub_u32 s5, s5, s7
    s_min_u32 s6, s43, 32
    s_sub_u32 s7, 32, s6
    s_cmp_lt_u32 s5, s7
    s_cselect_b32 s3, 3, s3
    s_add_u32 s6, s6, s5
    s_cmp_lt_u32 s5, s7
    s_cselect_b32 s4, s6, s4
    s_sub_u32 s5, s5, s7
    s_min_u32 s6, s42, 32
    s_sub_u32 s7, 32, s6
    s_cmp_lt_u32 s5, s7
    s_cselect_b32 s3, 2, s3
    s_add_u32 s6, s6, s5
    s_cmp_lt_u32 s5, s7
    s_cselect_b32 s4, s6, s4
    s_sub_u32 s5, s5, s7
    s_min_u32 s6, s41, 32
    s_sub_u32 s7, 32, s6
    s_cmp_lt_u32 s5, s7
    s_cselect_b32 s3, 1, s3
    s_add_u32 s6, s6, s5
    s_cmp_lt_u32 s5, s7
    s_cselect_b32 s4, s6, s4
    s_sub_u32 s5, s5, s7
    s_min_u32 s6, s40, 32
    s_sub_u32 s7, 32, s6
    s_cmp_lt_u32 s5, s7
    s_cselect_b32 s3, 0, s3
    s_add_u32 s6, s6, s5
    s_cmp_lt_u32 s5, s7
    s_cselect_b32 s4, s6, s4
    s_sub_u32 s5, s5, s7
L_tk_have:
    s_lshl_b32 s5, s3, 8
    s_or_b32 s5, s5, s4
    v_mov_b32 v3, s5
    s_mov_b64 exec, 1
    ds_write_b32 v2, v3
    s_mov_b64 exec, -1
L_tk_wait:
    s_waitcnt vmcnt(0) lgkmcnt(0)
    s_barrier
    ds_read_b32 v3, v2
    s_waitcnt lgkmcnt(0)
    v_readfirstlane_b32 s5, v3
    s_nop 0
    s_lshr_b32 s3, s5, 8
    s_and_b32 s4, s5, 255
    s_barrier
    s_cmp_lt_u32 s3, 2
    s_cbranch_scc1 L_role_r
    s_sub_u32 s6, s3, 2
    s_lshl_b32 s6, s6, 5
    s_add_u32 s6, s6, s4
    s_load_dwordx2 s[20:21], s[0:1], 8
    s_mov_b32 s22, 1990656
    s_mov_b32 s23, 0x00020000
    s_waitcnt lgkmcnt(0)
    s_and_b32 s21, s21, 0xffff
    s_load_dwordx2 s[24:25], s[0:1], 16
    s_mov_b32 s26, 663552
    s_mov_b32 s27, 0x00020000
    s_waitcnt lgkmcnt(0)
    s_and_b32 s25, s25, 0xffff
    s_sub_u32 s41, 191, s6
    s_lshl_b32 s41, s41, 15
    v_lshlrev_b32 v254, 7, v0
    buffer_load_dword v255, v254, s[20:23], s41 offen
    s_sub_u32 s41, s41, 1998848
    s_cmp_lt_u32 s41, 688128
    s_cselect_b32 s41, s41, 0x7f000000
    s_waitcnt vmcnt(0)
    buffer_load_dword v255, v254, s[24:27], s41 offen
    s_cmp_ge_u32 s6, 192
    s_cbranch_scc1 Li_end
    s_sub_u32 s41, s6, 64
    s_cmp_lt_u32 s41, 64
    s_cbranch_scc1 Li_end
Li_body:
    v_lshlrev_b32 v7, 4, v0
    v_mov_b32 v12, 0
    v_mov_b32 v13, 0
    v_mov_b32 v14, 0
    v_mov_b32 v15, 0
    s_cmp_ge_u32 s6, 64
    s_cbranch_scc1 Li_rest
    s_load_dwordx2 s[20:21], s[0:1], 0
    s_mov_b32 s22, 2359296
    s_mov_b32 s23, 0x00020000
    s_waitcnt lgkmcnt(0)
    s_and_b32 s21, s21, 0xffff
    v_and_b32 v1, 31, v0
    v_lshrrev_b32 v2, 5, v0
    v_mul_u32_u24 v3, 1152, v1
    v_mul_u32_u24 v5, 144, v2
    v_add_u32 v3, v3, v5
    s_mul_i32 s41, s6, 36864
    buffer_load_dwordx4 v[64:67], v3, s[20:23], s41 offen offset:0
    buffer_load_dwordx4 v[68:71], v3, s[20:23], s41 offen offset:16
    buffer_load_dwordx4 v[72:75], v3, s[20:23], s41 offen offset:32
    buffer_load_dwordx4 v[76:79], v3, s[20:23], s41 offen offset:48
    buffer_load_dwordx4 v[80:83], v3, s[20:23], s41 offen offset:64
    buffer_load_dwordx4 v[84:87], v3, s[20:23], s41 offen offset:80
    buffer_load_dwordx4 v[88:91], v3, s[20:23], s41 offen offset:96
    buffer_load_dwordx4 v[92:95], v3, s[20:23], s41 offen offset:112
    buffer_load_dwordx4 v[96:99], v3, s[20:23], s41 offen offset:128
    v_mul_u32_u24 v4, 4608, v2
    v_lshl_add_u32 v4, v1, 4, v4
    s_mul_i32 s41, s6, 36864
    s_add_u32 s41, s41, 6291456
    s_mul_i32 s42, s6, 6144
    s_add_u32 s42, s42, 15728640
    s_add_u32 s43, s42, 2048
    s_add_u32 s44, s42, 396288
    v_mov_b32 v60, 0
    v_mov_b32 v61, 0
    s_waitcnt vmcnt(8)
    buffer_store_dwordx4 v[64:67], v4, s[8:11], s41 offen offset:0 sc1
    s_waitcnt vmcnt(8)
    buffer_store_dwordx4 v[68:71], v4, s[8:11], s41 offen offset:512 sc1
    s_waitcnt vmcnt(8)
    buffer_store_dwordx4 v[72:75], v4, s[8:11], s41 offen offset:1024 sc1
    s_waitcnt vmcnt(8)
    buffer_store_dwordx4 v[76:79], v4, s[8:11], s41 offen offset:1536 sc1
    s_waitcnt vmcnt(8)
    buffer_store_dwordx4 v[80:83], v4, s[8:11], s41 offen offset:2048 sc1
    s_waitcnt vmcnt(8)
    buffer_store_dwordx4 v[84:87], v4, s[8:11], s41 offen offset:2560 sc1
    s_waitcnt vmcnt(8)
    buffer_store_dwordx4 v[88:91], v4, s[8:11], s41 offen offset:3072 sc1
    s_waitcnt vmcnt(8)
    buffer_store_dwordx4 v[92:95], v4, s[8:11], s41 offen offset:3584 sc1
    v_add_u32 v4, 4096, v4
    s_waitcnt vmcnt(8)
    buffer_store_dwordx4 v[96:99], v4, s[8:11], s41 offen offset:0 sc1
    buffer_store_dwordx4 v[12:15], v7, s[8:11], s43 offen sc1
    v_cmp_gt_u32 vcc, 192, v0
    s_nop 0
    s_and_saveexec_b64 s[46:47], vcc
    s_cbranch_execz Li_z1
    buffer_store_dwordx4 v[12:15], v7, s[8:11], s44 offen sc1
Li_z1:
    s_mov_b64 exec, s[46:47]
    v_mov_b32 v62, 0x3f803f80
    v_dot2c_f32_bf16 v60, v64, v62
    v_dot2c_f32_bf16 v61, v64, v64
    v_dot2c_f32_bf16 v60, v65, v62
    v_dot2c_f32_bf16 v61, v65, v65
    v_dot2c_f32_bf16 v60, v66, v62
    v_dot2c_f32_bf16 v61, v66, v66
    v_dot2c_f32_bf16 v60, v67, v62
    v_dot2c_f32_bf16 v61, v67, v67
    v_dot2c_f32_bf16 v60, v68, v62
    v_dot2c_f32_bf16 v61, v68, v68
    v_dot2c_f32_bf16 v60, v69, v62
    v_dot2c_f32_bf16 v61, v69, v69
    v_dot2c_f32_bf16 v60, v70, v62
    v_dot2c_f32_bf16 v61, v70, v70
    v_dot2c_f32_bf16 v60, v71, v62
    v_dot2c_f32_bf16 v61, v71, v71
    v_dot2c_f32_bf16 v60, v72, v62
    v_dot2c_f32_bf16 v61, v72, v72
    v_dot2c_f32_bf16 v60, v73, v62
    v_dot2c_f32_bf16 v61, v73, v73
    v_dot2c_f32_bf16 v60, v74, v62
    v_dot2c_f32_bf16 v61, v74, v74
    v_dot2c_f32_bf16 v60, v75, v62
    v_dot2c_f32_bf16 v61, v75, v75
    v_dot2c_f32_bf16 v60, v76, v62
    v_dot2c_f32_bf16 v61, v76, v76
    v_dot2c_f32_bf16 v60, v77, v62
    v_dot2c_f32_bf16 v61, v77, v77
    v_dot2c_f32_bf16 v60, v78, v62
    v_dot2c_f32_bf16 v61, v78, v78
    v_dot2c_f32_bf16 v60, v79, v62
    v_dot2c_f32_bf16 v61, v79, v79
    v_dot2c_f32_bf16 v60, v80, v62
    v_dot2c_f32_bf16 v61, v80, v80
    v_dot2c_f32_bf16 v60, v81, v62
    v_dot2c_f32_bf16 v61, v81, v81
    v_dot2c_f32_bf16 v60, v82, v62
    v_dot2c_f32_bf16 v61, v82, v82
    v_dot2c_f32_bf16 v60, v83, v62
    v_dot2c_f32_bf16 v61, v83, v83
    v_dot2c_f32_bf16 v60, v84, v62
    v_dot2c_f32_bf16 v61, v84, v84
    v_dot2c_f32_bf16 v60, v85, v62
    v_dot2c_f32_bf16 v61, v85, v85
    v_dot2c_f32_bf16 v60, v86, v62
    v_dot2c_f32_bf16 v61, v86, v86
    v_dot2c_f32_bf16 v60, v87, v62
    v_dot2c_f32_bf16 v61, v87, v87
    v_dot2c_f32_bf16 v60, v88, v62
    v_dot2c_f32_bf16 v61, v88, v88
    v_dot2c_f32_bf16 v60, v89, v62
    v_dot2c_f32_bf16 v61, v89, v89
    v_dot2c_f32_bf16 v60, v90, v62
    v_dot2c_f32_bf16 v61, v90, v90
    v_dot2c_f32_bf16 v60, v91, v62
    v_dot2c_f32_bf16 v61, v91, v91
    v_dot2c_f32_bf16 v60, v92, v62
    v_dot2c_f32_bf16 v61, v92, v92
    v_dot2c_f32_bf16 v60, v93, v62
    v_dot2c_f32_bf16 v61, v93, v93
    v_dot2c_f32_bf16 v60, v94, v62
    v_dot2c_f32_bf16 v61, v94, v94
    v_dot2c_f32_bf16 v60, v95, v62
    v_dot2c_f32_bf16 v61, v95, v95
    v_dot2c_f32_bf16 v60, v96, v62
    v_dot2c_f32_bf16 v61, v96, v96
    v_dot2c_f32_bf16 v60, v97, v62
    v_dot2c_f32_bf16 v61, v97, v97
    v_dot2c_f32_bf16 v60, v98, v62
    v_dot2c_f32_bf16 v61, v98, v98
    v_dot2c_f32_bf16 v60, v99, v62
    v_dot2c_f32_bf16 v61, v99, v99
    s_nop 3
    v_lshrrev_b32 v5, 1, v2
    v_lshlrev_b32 v5, 9, v5
    v_lshl_add_u32 v5, v1, 4, v5
    v_and_b32 v6, 1, v2
    v_lshl_add_u32 v5, v6, 3, v5
    buffer_store_dwordx2 v[60:61], v5, s[8:11], s42 offen sc1
    s_branch Li_flags
Li_rest:
    s_cmp_ge_u32 s6, 128
    s_cbranch_scc1 Li_pre
    s_sub_u32 s41, s6, 64
    s_mul_i32 s41, s41, 6144
    s_add_u32 s41, s41, 16911360
    v_cmp_gt_u32 vcc, 192, v0
    s_nop 0
    s_and_saveexec_b64 s[42:43], vcc
    s_cbranch_execz Li_rest2
    buffer_store_dwordx4 v[12:15], v7, s[8:11], s41 offen sc1
Li_rest2:
    s_mov_b64 exec, s[42:43]
    s_load_dwordx2 s[20:21], s[0:1], 80
    s_mov_b32 s22, 2359296
    s_mov_b32 s23, 0x00020000
    s_waitcnt lgkmcnt(0)
    s_and_b32 s21, s21, 0xffff
    s_sub_u32 s44, s6, 64
    s_mul_i32 s45, s44, 36864
    s_add_u32 s46, s45, 19660800
    buffer_store_dwordx4 v[12:15], v7, s[8:11], s46 offen sc1
    buffer_store_dwordx4 v[12:15], v7, s[20:23], s45 offen sc1
    s_add_u32 s46, s46, 4096
    s_add_u32 s45, s45, 4096
    buffer_store_dwordx4 v[12:15], v7, s[8:11], s46 offen sc1
    buffer_store_dwordx4 v[12:15], v7, s[20:23], s45 offen sc1
    s_add_u32 s46, s46, 4096
    s_add_u32 s45, s45, 4096
    buffer_store_dwordx4 v[12:15], v7, s[8:11], s46 offen sc1
    buffer_store_dwordx4 v[12:15], v7, s[20:23], s45 offen sc1
    s_add_u32 s46, s46, 4096
    s_add_u32 s45, s45, 4096
    buffer_store_dwordx4 v[12:15], v7, s[8:11], s46 offen sc1
    buffer_store_dwordx4 v[12:15], v7, s[20:23], s45 offen sc1
    s_add_u32 s46, s46, 4096
    s_add_u32 s45, s45, 4096
    buffer_store_dwordx4 v[12:15], v7, s[8:11], s46 offen sc1
    buffer_store_dwordx4 v[12:15], v7, s[20:23], s45 offen sc1
    s_add_u32 s46, s46, 4096
    s_add_u32 s45, s45, 4096
    buffer_store_dwordx4 v[12:15], v7, s[8:11], s46 offen sc1
    buffer_store_dwordx4 v[12:15], v7, s[20:23], s45 offen sc1
    s_add_u32 s46, s46, 4096
    s_add_u32 s45, s45, 4096
    buffer_store_dwordx4 v[12:15], v7, s[8:11], s46 offen sc1
    buffer_store_dwordx4 v[12:15], v7, s[20:23], s45 offen sc1
    s_add_u32 s46, s46, 4096
    s_add_u32 s45, s45, 4096
    buffer_store_dwordx4 v[12:15], v7, s[8:11], s46 offen sc1
    buffer_store_dwordx4 v[12:15], v7, s[20:23], s45 offen sc1
    s_add_u32 s46, s46, 4096
    s_add_u32 s45, s45, 4096
    buffer_store_dwordx4 v[12:15], v7, s[8:11], s46 offen sc1
    buffer_store_dwordx4 v[12:15], v7, s[20:23], s45 offen sc1
    s_mul_i32 s45, s44, 6144
    s_add_u32 s45, s45, 16515072
    buffer_store_dwordx4 v[12:15], v7, s[8:11], s45 offen sc1
    s_add_u32 s46, s45, 4096
    s_add_u32 s45, s45, 393216
    buffer_store_dwordx4 v[12:15], v7, s[8:11], s45 offen sc1
    v_cmp_gt_u32 vcc, 128, v0
    s_nop 0
    s_and_saveexec_b64 s[42:43], vcc
    s_cbranch_execz Li_rest3
    buffer_store_dwordx4 v[12:15], v7, s[8:11], s46 offen sc1
Li_rest3:
    s_mov_b64 exec, s[42:43]
    s_branch Li_flags
Li_pre:
    s_sub_u32 s44, s6, 128
    s_mul_i32 s45, s44, 36864
    s_add_u32 s45, s45, 17301504
    buffer_store_dwordx4 v[12:15], v7, s[8:11], s45 offen sc1
    s_add_u32 s45, s45, 4096
    buffer_store_dwordx4 v[12:15], v7, s[8:11], s45 offen sc1
    s_add_u32 s45, s45, 4096
    buffer_store_dwordx4 v[12:15], v7, s[8:11], s45 offen sc1
    s_add_u32 s45, s45, 4096
    buffer_store_dwordx4 v[12:15], v7, s[8:11], s45 offen sc1
    s_add_u32 s45, s45, 4096
    buffer_store_dwordx4 v[12:15], v7, s[8:11], s45 offen sc1
    s_add_u32 s45, s45, 4096
    buffer_store_dwordx4 v[12:15], v7, s[8:11], s45 offen sc1
    s_add_u32 s45, s45, 4096
    buffer_store_dwordx4 v[12:15], v7, s[8:11], s45 offen sc1
    s_add_u32 s45, s45, 4096
    buffer_store_dwordx4 v[12:15], v7, s[8:11], s45 offen sc1
    s_add_u32 s45, s45, 4096
    buffer_store_dwordx4 v[12:15], v7, s[8:11], s45 offen sc1
    s_mul_i32 s45, s44, 6144
    s_add_u32 s45, s45, 16121856
    v_cmp_gt_u32 vcc, 192, v0
    s_nop 0
    s_and_saveexec_b64 s[46:47], vcc
    s_cbranch_execz Li_z0
    buffer_store_dwordx4 v[12:15], v7, s[8:11], s45 offen sc1
Li_z0:
    s_mov_b64 exec, s[46:47]
    s_cmp_ge_u32 s6, 136
    s_cbranch_scc1 Li_nofl
Li_flags:
    v_cmp_gt_u32 vcc, 96, v0
    s_cmp_lt_u32 s6, 64
    s_cselect_b64 s[42:43], -1, 0
    s_and_b64 vcc, vcc, s[42:43]
    s_cmp_lt_u32 s6, 128
    s_cselect_b32 s44, 0, 0
    v_mov_b32 v12, s44
    v_mov_b32 v13, s44
    v_mov_b32 v14, s44
    v_mov_b32 v15, s44
    v_mov_b32 v9, 1
    v_cndmask_b32 v8, v12, v9, vcc
    v_mov_b32 v9, v8
    v_mov_b32 v10, v8
    v_mov_b32 v11, v8
    s_mul_i32 s41, s6, 22528
    s_sub_u32 s42, s6, 128
    s_lshl_b32 s42, s42, 12
    s_add_u32 s42, s42, 2883584
    s_cmp_ge_u32 s6, 128
    s_cselect_b32 s41, s42, s41
    buffer_store_dwordx4 v[8:11], v7, s[8:11], s41 offen sc1
    s_cbranch_scc1 Li_nofl
    s_add_u32 s41, s41, 4096
    buffer_store_dwordx4 v[12:15], v7, s[8:11], s41 offen sc1
    s_add_u32 s41, s41, 4096
    buffer_store_dwordx4 v[12:15], v7, s[8:11], s41 offen sc1
    s_add_u32 s41, s41, 4096
    buffer_store_dwordx4 v[12:15], v7, s[8:11], s41 offen sc1
    s_add_u32 s41, s41, 4096
    buffer_store_dwordx4 v[12:15], v7, s[8:11], s41 offen sc1
    s_add_u32 s41, s41, 4096
    v_cmp_gt_u32 vcc, 128, v0
    s_nop 0
    s_and_saveexec_b64 s[42:43], vcc
    s_cbranch_execz Li_fl5
    buffer_store_dwordx4 v[12:15], v7, s[8:11], s41 offen sc1
Li_fl5:
    s_mov_b64 exec, s[42:43]
Li_nofl:
    s_waitcnt vmcnt(0)
    s_barrier
    s_cmp_lg_u32 s14, 0
    s_cbranch_scc1 Li_cnt
    s_sub_u32 s41, s6, 64
    s_cmp_lt_u32 s41, 64
    s_cbranch_scc1 Li_l1
    v_mov_b32 v2, 40
    v_mov_b32 v3, 1
    s_mov_b64 exec, 1
    global_atomic_add v2, v3, s[12:13]
    s_mov_b64 exec, -1
    s_branch Li_cnt
Li_l1:
    v_mov_b32 v2, 160
    v_mov_b32 v3, 1
    s_mov_b64 exec, 1
    global_atomic_add v2, v3, s[12:13]
    s_mov_b64 exec, -1
Li_cnt:
    s_cmp_lt_u32 s6, 128
    s_cbranch_scc1 Li_end
    s_sub_u32 s6, s6, 64
    s_branch Li_body
Li_end:
    s_cmp_lg_u32 s3, 2
    s_cbranch_scc1 L_cls2_no
    s_add_u32 s15, s4, 0
    s_cmp_lt_u32 s4, 24
    s_cbranch_scc1 L_role_tw
    s_add_u32 s15, s4, 4294967272
    s_cmp_lt_u32 s4, 32
    s_cbranch_scc1 L_role_p
    s_endpgm
L_cls2_no:
    s_cmp_lg_u32 s3, 3
    s_cbranch_scc1 L_cls3_no
    s_add_u32 s15, s4, 24
    s_cmp_lt_u32 s4, 12
    s_cbranch_scc1 L_role_tw
    s_add_u32 s15, s4, 4294967292
    s_cmp_lt_u32 s4, 32
    s_cbranch_scc1 L_role_p
    s_endpgm
L_cls3_no:
    s_cmp_lg_u32 s3, 4
    s_cbranch_scc1 L_cls4_no
    s_add_u32 s15, s4, 0
    s_cmp_lt_u32 s4, 16
    s_cbranch_scc1 L_role_aq
    s_add_u32 s15, s4, 4294967280
    s_cmp_lt_u32 s4, 19
    s_cbranch_scc1 L_role_awo
    s_add_u32 s15, s4, 9
    s_cmp_lt_u32 s4, 32
    s_cbranch_scc1 L_role_p
    s_endpgm
L_cls4_no:
    s_cmp_lg_u32 s3, 5
    s_cbranch_scc1 L_cls5_no
    s_add_u32 s15, s4, 16
    s_cmp_lt_u32 s4, 16
    s_cbranch_scc1 L_role_aq
    s_add_u32 s15, s4, 4294967283
    s_cmp_lt_u32 s4, 19
    s_cbranch_scc1 L_role_awo
    s_add_u32 s15, s4, 22
    s_cmp_lt_u32 s4, 32
    s_cbranch_scc1 L_role_p
    s_endpgm
L_cls5_no:
    s_cmp_lg_u32 s3, 6
    s_cbranch_scc1 L_cls6_no
    s_add_u32 s15, s4, 0
    s_cmp_lt_u32 s4, 11
    s_cbranch_scc1 L_role_ta
    s_add_u32 s15, s4, 43
    s_cmp_lt_u32 s4, 32
    s_cbranch_scc1 L_role_p
    s_endpgm
L_cls6_no:
    s_cmp_lg_u32 s3, 7
    s_cbranch_scc1 L_cls7_no
    s_add_u32 s15, s4, 11
    s_cmp_lt_u32 s4, 11
    s_cbranch_scc1 L_role_ta
    s_add_u32 s15, s4, 64
    s_cmp_lt_u32 s4, 32
    s_cbranch_scc1 L_role_p
    s_endpgm
L_cls7_no:
L_exit:
    s_endpgm
L_abort:
    s_waitcnt lgkmcnt(0)
    s_mov_b64 exec, -1
    v_mov_b32 v0, 60
    s_lshl_b32 s5, s3, 8
    s_or_b32 s5, s5, s4
    s_or_b32 s5, s5, 0x10000
    v_mov_b32 v1, s5
    global_store_dword v0, v1, s[12:13]
    s_endpgm
.p2align 6
L_role_p:
    v_and_b32 v5, 63, v0
    v_lshlrev_b32 v0, 4, v5
    v_and_b32 v7, 15, v5
    v_lshrrev_b32 v8, 4, v5
    v_min_u32 v1, 11, v5
    v_lshrrev_b32 v6, 2, v1
    v_and_b32 v1, 3, v1
    v_lshlrev_b32 v1, 2, v1
    v_lshl_add_u32 v1, v6, 7, v1
    v_mov_b32 v3, 1
    v_mov_b32 v4, 0
    s_mov_b32 s44, 0x05040100
    s_mov_b32 s45, 0x07060302
    s_cmp_ge_u32 s15, 48
    s_cselect_b32 s63, 1, 0
    s_cselect_b32 s17, 48, 0
    s_sub_u32 s15, s15, s17
    s_cmp_lt_u32 s15, 32
    s_cselect_b32 s50, 1, 0
    s_sub_u32 s17, s15, 32
    s_lshl_b32 s17, s17, 1
    s_cmp_eq_u32 s50, 1
    s_cselect_b32 s51, s15, s17
    s_cselect_b32 s17, 48, 40
    s_cselect_b32 s18, 56, 40
    s_load_dwordx2 s[20:21], s[0:1], s17
    s_load_dwordx2 s[24:25], s[0:1], s18
    s_mov_b32 s22, 4718592
    s_mov_b32 s23, 0x00020000
    s_mov_b32 s26, 4718592
    s_mov_b32 s27, 0x00020000
    s_lshl_b32 s49, s51, 8
    s_mul_i32 s17, s14, 131072
    s_add_u32 s49, s49, s17
    s_cmp_eq_u32 s50, 1
    s_cselect_b32 s17, 0, 256
    s_add_u32 s52, s49, s17
    s_waitcnt lgkmcnt(0)
    s_and_b32 s21, s21, 0xffff
    s_and_b32 s25, s25, 0xffff
    s_cmp_eq_u32 s63, 0
    s_cbranch_scc1 Lp2_gate_ng
    s_cmp_lg_u32 s14, 0
    s_cbranch_scc1 Lp2_gate_d
    v_mov_b32 v5, 48
    s_mov_b32 s16, 0
Lp2_gate:
    global_load_dword v6, v5, s[12:13] sc1
    s_add_u32 s16, s16, 1
    s_cmp_gt_u32 s16, 100000
    s_cbranch_scc1 L_role_p_abort
    s_waitcnt vmcnt(0)
    v_cmp_gt_u32 vcc, 32, v6
    s_nop 0
    s_cbranch_vccz Lp2_gate_d
    s_sleep 100
    s_branch Lp2_gate
Lp2_gate_d:
    s_barrier
Lp2_gate_ng:
    v_lshrrev_b32 v5, 8, v0
    v_bfe_u32 v6, v0, 6, 2
    v_xor_b32 v6, v6, v5
    v_lshlrev_b32 v6, 6, v6
    v_and_b32 v16, 0x30, v0
    v_add_u32 v16, v16, v6
    v_lshl_add_u32 v16, v5, 13, v16
    v_lshrrev_b32 v5, 2, v7
    v_xor_b32 v6, s14, v5
    v_lshlrev_b32 v17, 6, v6
    v_lshrrev_b32 v6, 1, v8
    v_lshl_add_u32 v5, v6, 3, v5
    v_lshl_add_u32 v17, v5, 8, v17
    v_and_b32 v5, 1, v8
    v_lshl_add_u32 v17, v5, 5, v17
    v_and_b32 v5, 3, v7
    v_lshl_add_u32 v17, v5, 3, v17
    v_add_u32 v18, 65536, v17
    s_lshl_b32 s46, s14, 12
    s_add_u32 m0, s46, 0
    s_add_u32 s17, s49, 0
    buffer_load_dwordx4 v16, s[20:23], s17 offen lds
    s_add_u32 m0, m0, 1024
    s_add_u32 s17, s49, 32768
    buffer_load_dwordx4 v16, s[20:23], s17 offen lds
    s_add_u32 m0, m0, 1024
    s_add_u32 s17, s49, 65536
    buffer_load_dwordx4 v16, s[20:23], s17 offen lds
    s_add_u32 m0, m0, 1024
    s_add_u32 s17, s49, 98304
    buffer_load_dwordx4 v16, s[20:23], s17 offen lds
    s_add_u32 m0, s46, 16384
    s_add_u32 s17, s49, 524288
    buffer_load_dwordx4 v16, s[20:23], s17 offen lds
    s_add_u32 m0, m0, 1024
    s_add_u32 s17, s49, 557056
    buffer_load_dwordx4 v16, s[20:23], s17 offen lds
    s_add_u32 m0, m0, 1024
    s_add_u32 s17, s49, 589824
    buffer_load_dwordx4 v16, s[20:23], s17 offen lds
    s_add_u32 m0, m0, 1024
    s_add_u32 s17, s49, 622592
    buffer_load_dwordx4 v16, s[20:23], s17 offen lds
    s_add_u32 m0, s46, 32768
    s_add_u32 s17, s49, 1048576
    buffer_load_dwordx4 v16, s[20:23], s17 offen lds
    s_add_u32 m0, m0, 1024
    s_add_u32 s17, s49, 1081344
    buffer_load_dwordx4 v16, s[20:23], s17 offen lds
    s_add_u32 m0, m0, 1024
    s_add_u32 s17, s49, 1114112
    buffer_load_dwordx4 v16, s[20:23], s17 offen lds
    s_add_u32 m0, m0, 1024
    s_add_u32 s17, s49, 1146880
    buffer_load_dwordx4 v16, s[20:23], s17 offen lds
    s_add_u32 m0, s46, 49152
    s_add_u32 s17, s49, 1572864
    buffer_load_dwordx4 v16, s[20:23], s17 offen lds
    s_add_u32 m0, m0, 1024
    s_add_u32 s17, s49, 1605632
    buffer_load_dwordx4 v16, s[20:23], s17 offen lds
    s_add_u32 m0, m0, 1024
    s_add_u32 s17, s49, 1638400
    buffer_load_dwordx4 v16, s[20:23], s17 offen lds
    s_add_u32 m0, m0, 1024
    s_add_u32 s17, s49, 1671168
    buffer_load_dwordx4 v16, s[20:23], s17 offen lds
    s_add_u32 m0, s46, 65536
    s_add_u32 s17, s49, 2097152
    buffer_load_dwordx4 v16, s[20:23], s17 offen lds
    s_add_u32 m0, m0, 1024
    s_add_u32 s17, s49, 2129920
    buffer_load_dwordx4 v16, s[20:23], s17 offen lds
    s_add_u32 m0, m0, 1024
    s_add_u32 s17, s49, 2162688
    buffer_load_dwordx4 v16, s[20:23], s17 offen lds
    s_add_u32 m0, m0, 1024
    s_add_u32 s17, s49, 2195456
    buffer_load_dwordx4 v16, s[20:23], s17 offen lds
    s_add_u32 m0, s46, 81920
    s_add_u32 s17, s49, 2621440
    buffer_load_dwordx4 v16, s[20:23], s17 offen lds
    s_add_u32 m0, m0, 1024
    s_add_u32 s17, s49, 2654208
    buffer_load_dwordx4 v16, s[20:23], s17 offen lds
    s_add_u32 m0, m0, 1024
    s_add_u32 s17, s49, 2686976
    buffer_load_dwordx4 v16, s[20:23], s17 offen lds
    s_add_u32 m0, m0, 1024
    s_add_u32 s17, s49, 2719744
    buffer_load_dwordx4 v16, s[20:23], s17 offen lds
    s_add_u32 m0, s46, 98304
    s_add_u32 s17, s49, 3145728
    buffer_load_dwordx4 v16, s[20:23], s17 offen lds
    s_add_u32 m0, m0, 1024
    s_add_u32 s17, s49, 3178496
    buffer_load_dwordx4 v16, s[20:23], s17 offen lds
    s_add_u32 m0, m0, 1024
    s_add_u32 s17, s49, 3211264
    buffer_load_dwordx4 v16, s[20:23], s17 offen lds
    s_add_u32 m0, m0, 1024
    s_add_u32 s17, s49, 3244032
    buffer_load_dwordx4 v16, s[20:23], s17 offen lds
    s_waitcnt vmcnt(24)
    s_barrier
    s_add_u32 m0, s46, 114688
    s_add_u32 s17, s49, 3670016
    buffer_load_dwordx4 v16, s[20:23], s17 offen lds
    s_add_u32 m0, m0, 1024
    s_add_u32 s17, s49, 3702784
    buffer_load_dwordx4 v16, s[20:23], s17 offen lds
    s_add_u32 m0, m0, 1024
    s_add_u32 s17, s49, 3735552
    buffer_load_dwordx4 v16, s[20:23], s17 offen lds
    s_add_u32 m0, m0, 1024
    s_add_u32 s17, s49, 3768320
    buffer_load_dwordx4 v16, s[20:23], s17 offen lds
    ds_read_b64_tr_b16 a[0:1], v17 offset:0
    ds_read_b64_tr_b16 a[2:3], v17 offset:1024
    ds_read_b64_tr_b16 a[4:5], v17 offset:4096
    ds_read_b64_tr_b16 a[6:7], v17 offset:5120
    ds_read_b64_tr_b16 a[8:9], v17 offset:8192
    ds_read_b64_tr_b16 a[10:11], v17 offset:9216
    ds_read_b64_tr_b16 a[12:13], v17 offset:12288
    ds_read_b64_tr_b16 a[14:15], v17 offset:13312
    s_waitcnt lgkmcnt(0)
    s_waitcnt vmcnt(24)
    s_barrier
    s_add_u32 m0, s46, 0
    s_add_u32 s17, s49, 4194304
    buffer_load_dwordx4 v16, s[20:23], s17 offen lds
    s_add_u32 m0, m0, 1024
    s_add_u32 s17, s49, 4227072
    buffer_load_dwordx4 v16, s[20:23], s17 offen lds
    s_add_u32 m0, m0, 1024
    s_add_u32 s17, s49, 4259840
    buffer_load_dwordx4 v16, s[20:23], s17 offen lds
    s_add_u32 m0, m0, 1024
    s_add_u32 s17, s49, 4292608
    buffer_load_dwordx4 v16, s[20:23], s17 offen lds
    ds_read_b64_tr_b16 a[16:17], v17 offset:16384
    ds_read_b64_tr_b16 a[18:19], v17 offset:17408
    ds_read_b64_tr_b16 a[20:21], v17 offset:20480
    ds_read_b64_tr_b16 a[22:23], v17 offset:21504
    ds_read_b64_tr_b16 a[24:25], v17 offset:24576
    ds_read_b64_tr_b16 a[26:27], v17 offset:25600
    ds_read_b64_tr_b16 a[28:29], v17 offset:28672
    ds_read_b64_tr_b16 a[30:31], v17 offset:29696
    s_waitcnt lgkmcnt(0)
    s_waitcnt vmcnt(24)
    s_barrier
    s_add_u32 m0, s46, 16384
    s_add_u32 s17, s52, 0
    buffer_load_dwordx4 v16, s[24:27], s17 offen lds
    s_add_u32 m0, m0, 1024
    s_add_u32 s17, s52, 32768
    buffer_load_dwordx4 v16, s[24:27], s17 offen lds
    s_add_u32 m0, m0, 1024
    s_add_u32 s17, s52, 65536
    buffer_load_dwordx4 v16, s[24:27], s17 offen lds
    s_add_u32 m0, m0, 1024
    s_add_u32 s17, s52, 98304
    buffer_load_dwordx4 v16, s[24:27], s17 offen lds
    ds_read_b64_tr_b16 a[32:33], v17 offset:32768
    ds_read_b64_tr_b16 a[34:35], v17 offset:33792
    ds_read_b64_tr_b16 a[36:37], v17 offset:36864
    ds_read_b64_tr_b16 a[38:39], v17 offset:37888
    ds_read_b64_tr_b16 a[40:41], v17 offset:40960
    ds_read_b64_tr_b16 a[42:43], v17 offset:41984
    ds_read_b64_tr_b16 a[44:45], v17 offset:45056
    ds_read_b64_tr_b16 a[46:47], v17 offset:46080
    s_waitcnt lgkmcnt(0)
    s_waitcnt vmcnt(24)
    s_barrier
    s_add_u32 m0, s46, 32768
    s_add_u32 s17, s52, 524288
    buffer_load_dwordx4 v16, s[24:27], s17 offen lds
    s_add_u32 m0, m0, 1024
    s_add_u32 s17, s52, 557056
    buffer_load_dwordx4 v16, s[24:27], s17 offen lds
    s_add_u32 m0, m0, 1024
    s_add_u32 s17, s52, 589824
    buffer_load_dwordx4 v16, s[24:27], s17 offen lds
    s_add_u32 m0, m0, 1024
    s_add_u32 s17, s52, 622592
    buffer_load_dwordx4 v16, s[24:27], s17 offen lds
    ds_read_b64_tr_b16 a[48:49], v17 offset:49152
    ds_read_b64_tr_b16 a[50:51], v17 offset:50176
    ds_read_b64_tr_b16 a[52:53], v17 offset:53248
    ds_read_b64_tr_b16 a[54:55], v17 offset:54272
    ds_read_b64_tr_b16 a[56:57], v17 offset:57344
    ds_read_b64_tr_b16 a[58:59], v17 offset:58368
    ds_read_b64_tr_b16 a[60:61], v17 offset:61440
    ds_read_b64_tr_b16 a[62:63], v17 offset:62464
    s_waitcnt lgkmcnt(0)
    s_waitcnt vmcnt(24)
    s_barrier
    s_add_u32 m0, s46, 49152
    s_add_u32 s17, s52, 1048576
    buffer_load_dwordx4 v16, s[24:27], s17 offen lds
    s_add_u32 m0, m0, 1024
    s_add_u32 s17, s52, 1081344
    buffer_load_dwordx4 v16, s[24:27], s17 offen lds
    s_add_u32 m0, m0, 1024
    s_add_u32 s17, s52, 1114112
    buffer_load_dwordx4 v16, s[24:27], s17 offen lds
    s_add_u32 m0, m0, 1024
    s_add_u32 s17, s52, 1146880
    buffer_load_dwordx4 v16, s[24:27], s17 offen lds
    ds_read_b64_tr_b16 a[64:65], v18 offset:0
    ds_read_b64_tr_b16 a[66:67], v18 offset:1024
    ds_read_b64_tr_b16 a[68:69], v18 offset:4096
    ds_read_b64_tr_b16 a[70:71], v18 offset:5120
    ds_read_b64_tr_b16 a[72:73], v18 offset:8192
    ds_read_b64_tr_b16 a[74:75], v18 offset:9216
    ds_read_b64_tr_b16 a[76:77], v18 offset:12288
    ds_read_b64_tr_b16 a[78:79], v18 offset:13312
    s_waitcnt lgkmcnt(0)
    s_waitcnt vmcnt(24)
    s_barrier
    s_add_u32 m0, s46, 65536
    s_add_u32 s17, s52, 1572864
    buffer_load_dwordx4 v16, s[24:27], s17 offen lds
    s_add_u32 m0, m0, 1024
    s_add_u32 s17, s52, 1605632
    buffer_load_dwordx4 v16, s[24:27], s17 offen lds
    s_add_u32 m0, m0, 1024
    s_add_u32 s17, s52, 1638400
    buffer_load_dwordx4 v16, s[24:27], s17 offen lds
    s_add_u32 m0, m0, 1024
    s_add_u32 s17, s52, 1671168
    buffer_load_dwordx4 v16, s[24:27], s17 offen lds
    ds_read_b64_tr_b16 a[80:81], v18 offset:16384
    ds_read_b64_tr_b16 a[82:83], v18 offset:17408
    ds_read_b64_tr_b16 a[84:85], v18 offset:20480
    ds_read_b64_tr_b16 a[86:87], v18 offset:21504
    ds_read_b64_tr_b16 a[88:89], v18 offset:24576
    ds_read_b64_tr_b16 a[90:91], v18 offset:25600
    ds_read_b64_tr_b16 a[92:93], v18 offset:28672
    ds_read_b64_tr_b16 a[94:95], v18 offset:29696
    s_waitcnt lgkmcnt(0)
    s_waitcnt vmcnt(24)
    s_barrier
    s_add_u32 m0, s46, 81920
    s_add_u32 s17, s52, 2097152
    buffer_load_dwordx4 v16, s[24:27], s17 offen lds
    s_add_u32 m0, m0, 1024
    s_add_u32 s17, s52, 2129920
    buffer_load_dwordx4 v16, s[24:27], s17 offen lds
    s_add_u32 m0, m0, 1024
    s_add_u32 s17, s52, 2162688
    buffer_load_dwordx4 v16, s[24:27], s17 offen lds
    s_add_u32 m0, m0, 1024
    s_add_u32 s17, s52, 2195456
    buffer_load_dwordx4 v16, s[24:27], s17 offen lds
    ds_read_b64_tr_b16 a[96:97], v18 offset:32768
    ds_read_b64_tr_b16 a[98:99], v18 offset:33792
    ds_read_b64_tr_b16 a[100:101], v18 offset:36864
    ds_read_b64_tr_b16 a[102:103], v18 offset:37888
    ds_read_b64_tr_b16 a[104:105], v18 offset:40960
    ds_read_b64_tr_b16 a[106:107], v18 offset:41984
    ds_read_b64_tr_b16 a[108:109], v18 offset:45056
    ds_read_b64_tr_b16 a[110:111], v18 offset:46080
    s_waitcnt lgkmcnt(0)
    s_waitcnt vmcnt(24)
    s_barrier
    s_add_u32 m0, s46, 98304
    s_add_u32 s17, s52, 2621440
    buffer_load_dwordx4 v16, s[24:27], s17 offen lds
    s_add_u32 m0, m0, 1024
    s_add_u32 s17, s52, 2654208
    buffer_load_dwordx4 v16, s[24:27], s17 offen lds
    s_add_u32 m0, m0, 1024
    s_add_u32 s17, s52, 2686976
    buffer_load_dwordx4 v16, s[24:27], s17 offen lds
    s_add_u32 m0, m0, 1024
    s_add_u32 s17, s52, 2719744
    buffer_load_dwordx4 v16, s[24:27], s17 offen lds
    ds_read_b64_tr_b16 a[112:113], v18 offset:49152
    ds_read_b64_tr_b16 a[114:115], v18 offset:50176
    ds_read_b64_tr_b16 a[116:117], v18 offset:53248
    ds_read_b64_tr_b16 a[118:119], v18 offset:54272
    ds_read_b64_tr_b16 a[120:121], v18 offset:57344
    ds_read_b64_tr_b16 a[122:123], v18 offset:58368
    ds_read_b64_tr_b16 a[124:125], v18 offset:61440
    ds_read_b64_tr_b16 a[126:127], v18 offset:62464
    s_waitcnt lgkmcnt(0)
    s_waitcnt vmcnt(24)
    s_barrier
    s_add_u32 m0, s46, 114688
    s_add_u32 s17, s52, 3145728
    buffer_load_dwordx4 v16, s[24:27], s17 offen lds
    s_add_u32 m0, m0, 1024
    s_add_u32 s17, s52, 3178496
    buffer_load_dwordx4 v16, s[24:27], s17 offen lds
    s_add_u32 m0, m0, 1024
    s_add_u32 s17, s52, 3211264
    buffer_load_dwordx4 v16, s[24:27], s17 offen lds
    s_add_u32 m0, m0, 1024
    s_add_u32 s17, s52, 3244032
    buffer_load_dwordx4 v16, s[24:27], s17 offen lds
    ds_read_b64_tr_b16 a[128:129], v17 offset:0
    ds_read_b64_tr_b16 a[130:131], v17 offset:1024
    ds_read_b64_tr_b16 a[132:133], v17 offset:4096
    ds_read_b64_tr_b16 a[134:135], v17 offset:5120
    ds_read_b64_tr_b16 a[136:137], v17 offset:8192
    ds_read_b64_tr_b16 a[138:139], v17 offset:9216
    ds_read_b64_tr_b16 a[140:141], v17 offset:12288
    ds_read_b64_tr_b16 a[142:143], v17 offset:13312
    s_waitcnt lgkmcnt(0)
    s_waitcnt vmcnt(24)
    s_barrier
    s_add_u32 m0, s46, 0
    s_add_u32 s17, s52, 3670016
    buffer_load_dwordx4 v16, s[24:27], s17 offen lds
    s_add_u32 m0, m0, 1024
    s_add_u32 s17, s52, 3702784
    buffer_load_dwordx4 v16, s[24:27], s17 offen lds
    s_add_u32 m0, m0, 1024
    s_add_u32 s17, s52, 3735552
    buffer_load_dwordx4 v16, s[24:27], s17 offen lds
    s_add_u32 m0, m0, 1024
    s_add_u32 s17, s52, 3768320
    buffer_load_dwordx4 v16, s[24:27], s17 offen lds
    ds_read_b64_tr_b16 a[144:145], v17 offset:16384
    ds_read_b64_tr_b16 a[146:147], v17 offset:17408
    ds_read_b64_tr_b16 a[148:149], v17 offset:20480
    ds_read_b64_tr_b16 a[150:151], v17 offset:21504
    ds_read_b64_tr_b16 a[152:153], v17 offset:24576
    ds_read_b64_tr_b16 a[154:155], v17 offset:25600
    ds_read_b64_tr_b16 a[156:157], v17 offset:28672
    ds_read_b64_tr_b16 a[158:159], v17 offset:29696
    s_waitcnt lgkmcnt(0)
    s_waitcnt vmcnt(24)
    s_barrier
    s_add_u32 m0, s46, 16384
    s_add_u32 s17, s52, 4194304
    buffer_load_dwordx4 v16, s[24:27], s17 offen lds
    s_add_u32 m0, m0, 1024
    s_add_u32 s17, s52, 4227072
    buffer_load_dwordx4 v16, s[24:27], s17 offen lds
    s_add_u32 m0, m0, 1024
    s_add_u32 s17, s52, 4259840
    buffer_load_dwordx4 v16, s[24:27], s17 offen lds
    s_add_u32 m0, m0, 1024
    s_add_u32 s17, s52, 4292608
    buffer_load_dwordx4 v16, s[24:27], s17 offen lds
    ds_read_b64_tr_b16 a[160:161], v17 offset:32768
    ds_read_b64_tr_b16 a[162:163], v17 offset:33792
    ds_read_b64_tr_b16 a[164:165], v17 offset:36864
    ds_read_b64_tr_b16 a[166:167], v17 offset:37888
    ds_read_b64_tr_b16 a[168:169], v17 offset:40960
    ds_read_b64_tr_b16 a[170:171], v17 offset:41984
    ds_read_b64_tr_b16 a[172:173], v17 offset:45056
    ds_read_b64_tr_b16 a[174:175], v17 offset:46080
    s_waitcnt lgkmcnt(0)
    s_waitcnt vmcnt(24)
    s_barrier
    ds_read_b64_tr_b16 a[176:177], v17 offset:49152
    ds_read_b64_tr_b16 a[178:179], v17 offset:50176
    ds_read_b64_tr_b16 a[180:181], v17 offset:53248
    ds_read_b64_tr_b16 a[182:183], v17 offset:54272
    ds_read_b64_tr_b16 a[184:185], v17 offset:57344
    ds_read_b64_tr_b16 a[186:187], v17 offset:58368
    ds_read_b64_tr_b16 a[188:189], v17 offset:61440
    ds_read_b64_tr_b16 a[190:191], v17 offset:62464
    s_waitcnt lgkmcnt(0)
    s_waitcnt vmcnt(20)
    s_barrier
    ds_read_b64_tr_b16 a[192:193], v18 offset:0
    ds_read_b64_tr_b16 a[194:195], v18 offset:1024
    ds_read_b64_tr_b16 a[196:197], v18 offset:4096
    ds_read_b64_tr_b16 a[198:199], v18 offset:5120
    ds_read_b64_tr_b16 a[200:201], v18 offset:8192
    ds_read_b64_tr_b16 a[202:203], v18 offset:9216
    ds_read_b64_tr_b16 a[204:205], v18 offset:12288
    ds_read_b64_tr_b16 a[206:207], v18 offset:13312
    s_waitcnt lgkmcnt(0)
    s_waitcnt vmcnt(16)
    s_barrier
    ds_read_b64_tr_b16 a[208:209], v18 offset:16384
    ds_read_b64_tr_b16 a[210:211], v18 offset:17408
    ds_read_b64_tr_b16 a[212:213], v18 offset:20480
    ds_read_b64_tr_b16 a[214:215], v18 offset:21504
    ds_read_b64_tr_b16 a[216:217], v18 offset:24576
    ds_read_b64_tr_b16 a[218:219], v18 offset:25600
    ds_read_b64_tr_b16 a[220:221], v18 offset:28672
    ds_read_b64_tr_b16 a[222:223], v18 offset:29696
    s_waitcnt lgkmcnt(0)
    s_waitcnt vmcnt(12)
    s_barrier
    ds_read_b64_tr_b16 a[224:225], v18 offset:32768
    ds_read_b64_tr_b16 a[226:227], v18 offset:33792
    ds_read_b64_tr_b16 a[228:229], v18 offset:36864
    ds_read_b64_tr_b16 a[230:231], v18 offset:37888
    ds_read_b64_tr_b16 a[232:233], v18 offset:40960
    ds_read_b64_tr_b16 a[234:235], v18 offset:41984
    ds_read_b64_tr_b16 a[236:237], v18 offset:45056
    ds_read_b64_tr_b16 a[238:239], v18 offset:46080
    s_waitcnt lgkmcnt(0)
    s_waitcnt vmcnt(8)
    s_barrier
    ds_read_b64_tr_b16 a[240:241], v18 offset:49152
    ds_read_b64_tr_b16 a[242:243], v18 offset:50176
    ds_read_b64_tr_b16 a[244:245], v18 offset:53248
    ds_read_b64_tr_b16 a[246:247], v18 offset:54272
    ds_read_b64_tr_b16 a[248:249], v18 offset:57344
    ds_read_b64_tr_b16 a[250:251], v18 offset:58368
    ds_read_b64_tr_b16 a[252:253], v18 offset:61440
    ds_read_b64_tr_b16 a[254:255], v18 offset:62464
    s_waitcnt lgkmcnt(0)
    s_waitcnt vmcnt(4)
    s_barrier
    ds_read_b64_tr_b16 v[152:153], v17 offset:0
    ds_read_b64_tr_b16 v[154:155], v17 offset:1024
    ds_read_b64_tr_b16 v[156:157], v17 offset:4096
    ds_read_b64_tr_b16 v[158:159], v17 offset:5120
    ds_read_b64_tr_b16 v[160:161], v17 offset:8192
    ds_read_b64_tr_b16 v[162:163], v17 offset:9216
    ds_read_b64_tr_b16 v[164:165], v17 offset:12288
    ds_read_b64_tr_b16 v[166:167], v17 offset:13312
    s_waitcnt lgkmcnt(0)
    s_waitcnt vmcnt(0)
    s_barrier
    ds_read_b64_tr_b16 v[168:169], v17 offset:16384
    ds_read_b64_tr_b16 v[170:171], v17 offset:17408
    ds_read_b64_tr_b16 v[172:173], v17 offset:20480
    ds_read_b64_tr_b16 v[174:175], v17 offset:21504
    ds_read_b64_tr_b16 v[176:177], v17 offset:24576
    ds_read_b64_tr_b16 v[178:179], v17 offset:25600
    ds_read_b64_tr_b16 v[180:181], v17 offset:28672
    ds_read_b64_tr_b16 v[182:183], v17 offset:29696
    s_waitcnt lgkmcnt(0)
    s_barrier
    v_bfe_u32 v10, v0, 4, 5
    v_lshrrev_b32 v5, 9, v0
    v_lshlrev_b32 v10, 4, v10
    v_mul_u32_u24 v6, 2560, v5
    v_add_u32 v10, v10, v6
    v_add_u32 v10, 114688, v10
    s_lshl_b32 s67, s14, 10
    v_bfe_u32 v6, v0, 8, 1
    v_lshlrev_b32 v14, 10, v6
    v_lshl_add_u32 v14, v7, 4, v14
    v_lshl_add_u32 v14, v5, 8, v14
    s_lshl_b32 s17, s51, 13
    s_lshl_b32 s18, s14, 11
    s_add_u32 s52, s17, s18
    s_add_u32 s52, s52, 44040192
    s_lshl_b32 s49, s51, 9
    s_lshl_b32 s17, s14, 2
    s_add_u32 s49, s49, s17
    s_add_u32 s49, s49, 5376
    s_cmp_eq_u32 s50, 1
    s_cselect_b32 s17, 16777216, 0
    s_cselect_b32 s18, 128, 0
    s_add_u32 s52, s52, s17
    s_add_u32 s49, s49, s18
    s_cmp_eq_u32 s50, 1
    s_cselect_b32 s17, 0, 384
    s_add_u32 s17, s17, 128
    v_lshrrev_b32 v185, 4, v0
    v_mul_lo_u32 v185, v185, s17
    v_mov_b32 v48, 0x3f803f80
    v_mov_b32 v49, 0x3f803f80
    v_mov_b32 v50, 0x3f803f80
    v_mov_b32 v51, 0x3f803f80
    s_lshl_b32 s17, s14, 8
    s_add_u32 s17, s17, 110592
    v_bfe_u32 v5, v0, 4, 5
    v_lshl_add_u32 v12, v5, 2, s17
    v_lshrrev_b32 v5, 9, v0
    v_lshl_add_u32 v13, v5, 4, s17
    s_cmp_eq_u32 s50, 1
    s_cbranch_scc1 Lp2_kv
    v_mfma_f32_32x32x16_bf16 v[84:99], a[0:3], v[48:51], 0
    v_mfma_f32_32x32x16_bf16 v[116:131], a[144:147], v[48:51], 0
    v_mfma_f32_32x32x16_bf16 v[84:99], a[4:7], v[48:51], v[84:99]
    v_mfma_f32_32x32x16_bf16 v[116:131], a[148:151], v[48:51], v[116:131]
    v_mfma_f32_32x32x16_bf16 v[84:99], a[8:11], v[48:51], v[84:99]
    v_mfma_f32_32x32x16_bf16 v[116:131], a[152:155], v[48:51], v[116:131]
    v_mfma_f32_32x32x16_bf16 v[84:99], a[12:15], v[48:51], v[84:99]
    v_mfma_f32_32x32x16_bf16 v[116:131], a[156:159], v[48:51], v[116:131]
    v_mfma_f32_32x32x16_bf16 v[84:99], a[16:19], v[48:51], v[84:99]
    v_mfma_f32_32x32x16_bf16 v[116:131], a[160:163], v[48:51], v[116:131]
    v_mfma_f32_32x32x16_bf16 v[84:99], a[20:23], v[48:51], v[84:99]
    v_mfma_f32_32x32x16_bf16 v[116:131], a[164:167], v[48:51], v[116:131]
    v_mfma_f32_32x32x16_bf16 v[84:99], a[24:27], v[48:51], v[84:99]
    v_mfma_f32_32x32x16_bf16 v[116:131], a[168:171], v[48:51], v[116:131]
    v_mfma_f32_32x32x16_bf16 v[84:99], a[28:31], v[48:51], v[84:99]
    v_mfma_f32_32x32x16_bf16 v[116:131], a[172:175], v[48:51], v[116:131]
    v_mfma_f32_32x32x16_bf16 v[84:99], a[32:35], v[48:51], v[84:99]
    v_mfma_f32_32x32x16_bf16 v[116:131], a[176:179], v[48:51], v[116:131]
    v_mfma_f32_32x32x16_bf16 v[84:99], a[36:39], v[48:51], v[84:99]
    v_mfma_f32_32x32x16_bf16 v[116:131], a[180:183], v[48:51], v[116:131]
    v_mfma_f32_32x32x16_bf16 v[84:99], a[40:43], v[48:51], v[84:99]
    v_mfma_f32_32x32x16_bf16 v[116:131], a[184:187], v[48:51], v[116:131]
    v_mfma_f32_32x32x16_bf16 v[84:99], a[44:47], v[48:51], v[84:99]
    v_mfma_f32_32x32x16_bf16 v[116:131], a[188:191], v[48:51], v[116:131]
    v_mfma_f32_32x32x16_bf16 v[84:99], a[48:51], v[48:51], v[84:99]
    v_mfma_f32_32x32x16_bf16 v[116:131], a[192:195], v[48:51], v[116:131]
    v_mfma_f32_32x32x16_bf16 v[84:99], a[52:55], v[48:51], v[84:99]
    v_mfma_f32_32x32x16_bf16 v[116:131], a[196:199], v[48:51], v[116:131]
    v_mfma_f32_32x32x16_bf16 v[84:99], a[56:59], v[48:51], v[84:99]
    v_mfma_f32_32x32x16_bf16 v[116:131], a[200:203], v[48:51], v[116:131]
    v_mfma_f32_32x32x16_bf16 v[84:99], a[60:63], v[48:51], v[84:99]
    v_mfma_f32_32x32x16_bf16 v[116:131], a[204:207], v[48:51], v[116:131]
    v_mfma_f32_32x32x16_bf16 v[84:99], a[64:67], v[48:51], v[84:99]
    v_mfma_f32_32x32x16_bf16 v[116:131], a[208:211], v[48:51], v[116:131]
    v_mfma_f32_32x32x16_bf16 v[84:99], a[68:71], v[48:51], v[84:99]
    v_mfma_f32_32x32x16_bf16 v[116:131], a[212:215], v[48:51], v[116:131]
    v_mfma_f32_32x32x16_bf16 v[84:99], a[72:75], v[48:51], v[84:99]
    v_mfma_f32_32x32x16_bf16 v[116:131], a[216:219], v[48:51], v[116:131]
    v_mfma_f32_32x32x16_bf16 v[84:99], a[76:79], v[48:51], v[84:99]
    v_mfma_f32_32x32x16_bf16 v[116:131], a[220:223], v[48:51], v[116:131]
    v_mfma_f32_32x32x16_bf16 v[84:99], a[80:83], v[48:51], v[84:99]
    v_mfma_f32_32x32x16_bf16 v[116:131], a[224:227], v[48:51], v[116:131]
    v_mfma_f32_32x32x16_bf16 v[84:99], a[84:87], v[48:51], v[84:99]
    v_mfma_f32_32x32x16_bf16 v[116:131], a[228:231], v[48:51], v[116:131]
    v_mfma_f32_32x32x16_bf16 v[84:99], a[88:91], v[48:51], v[84:99]
    v_mfma_f32_32x32x16_bf16 v[116:131], a[232:235], v[48:51], v[116:131]
    v_mfma_f32_32x32x16_bf16 v[84:99], a[92:95], v[48:51], v[84:99]
    v_mfma_f32_32x32x16_bf16 v[116:131], a[236:239], v[48:51], v[116:131]
    v_mfma_f32_32x32x16_bf16 v[84:99], a[96:99], v[48:51], v[84:99]
    v_mfma_f32_32x32x16_bf16 v[116:131], a[240:243], v[48:51], v[116:131]
    v_mfma_f32_32x32x16_bf16 v[84:99], a[100:103], v[48:51], v[84:99]
    v_mfma_f32_32x32x16_bf16 v[116:131], a[244:247], v[48:51], v[116:131]
    v_mfma_f32_32x32x16_bf16 v[84:99], a[104:107], v[48:51], v[84:99]
    v_mfma_f32_32x32x16_bf16 v[116:131], a[248:251], v[48:51], v[116:131]
    v_mfma_f32_32x32x16_bf16 v[84:99], a[108:111], v[48:51], v[84:99]
    v_mfma_f32_32x32x16_bf16 v[116:131], a[252:255], v[48:51], v[116:131]
    v_mfma_f32_32x32x16_bf16 v[84:99], a[112:115], v[48:51], v[84:99]
    v_mfma_f32_32x32x16_bf16 v[116:131], v[152:155], v[48:51], v[116:131]
    v_mfma_f32_32x32x16_bf16 v[84:99], a[116:119], v[48:51], v[84:99]
    v_mfma_f32_32x32x16_bf16 v[116:131], v[156:159], v[48:51], v[116:131]
    v_mfma_f32_32x32x16_bf16 v[84:99], a[120:123], v[48:51], v[84:99]
    v_mfma_f32_32x32x16_bf16 v[116:131], v[160:163], v[48:51], v[116:131]
    v_mfma_f32_32x32x16_bf16 v[84:99], a[124:127], v[48:51], v[84:99]
    v_mfma_f32_32x32x16_bf16 v[116:131], v[164:167], v[48:51], v[116:131]
    v_mfma_f32_32x32x16_bf16 v[84:99], a[128:131], v[48:51], v[84:99]
    v_mfma_f32_32x32x16_bf16 v[116:131], v[168:171], v[48:51], v[116:131]
    v_mfma_f32_32x32x16_bf16 v[84:99], a[132:135], v[48:51], v[84:99]
    v_mfma_f32_32x32x16_bf16 v[116:131], v[172:175], v[48:51], v[116:131]
    v_mfma_f32_32x32x16_bf16 v[84:99], a[136:139], v[48:51], v[84:99]
    v_mfma_f32_32x32x16_bf16 v[116:131], v[176:179], v[48:51], v[116:131]
    v_mfma_f32_32x32x16_bf16 v[84:99], a[140:143], v[48:51], v[84:99]
    v_mfma_f32_32x32x16_bf16 v[116:131], v[180:183], v[48:51], v[116:131]
    s_mov_b32 s66, 114688
    s_mov_b32 s71, 0x2000
    s_mov_b32 s36, s63
    s_mov_b32 s34, s63
    s_mul_i32 s58, s14, 9216
    s_mul_i32 s64, s63, 4718592
    s_add_u32 s64, s64, s58
    s_add_u32 s64, s64, 8650752
    s_mul_i32 s61, s63, 1441792
    s_add_u32 s61, s61, 3584
    s_mov_b32 s37, 0
    s_mov_b32 s40, 36864
    s_mov_b32 s59, s58
    s_mov_b32 s43, 0
    s_mov_b32 s62, 1
    s_mov_b32 s28, s8
    s_mov_b32 s29, s9
    s_mov_b32 s30, 0
    s_mov_b32 s31, 0x00020000
    v_mov_b32 v184, 74752
    v_mov_b32 v5, -1
    ds_write_b32 v184, v5
    s_waitcnt lgkmcnt(0)
    s_cmp_lg_u32 s14, 0
    s_cbranch_scc1 LpQQ_inia_d
    v_mov_b32 v5, 40
    s_mov_b32 s16, 0
LpQQ_inia:
    global_load_dword v6, v5, s[12:13] sc1
    s_add_u32 s16, s16, 1
    s_cmp_gt_u32 s16, 100000
    s_cbranch_scc1 L_role_p_abort
    s_waitcnt vmcnt(0)
    v_cmp_gt_u32 vcc, 128, v6
    s_nop 0
    s_cbranch_vccz LpQQ_inia_d
    s_sleep 8
    s_branch LpQQ_inia
LpQQ_inia_d:
    s_barrier
    s_cmp_eq_u32 s63, 0
    s_cbranch_scc1 LpQQ_ini_sk
    s_cmp_lg_u32 s14, 0
    s_cbranch_scc1 LpQQ_inib_d
    v_mov_b32 v5, 160
    s_mov_b32 s16, 0
LpQQ_inib:
    global_load_dword v6, v5, s[12:13] sc1
    s_add_u32 s16, s16, 1
    s_cmp_gt_u32 s16, 100000
    s_cbranch_scc1 L_role_p_abort
    s_waitcnt vmcnt(0)
    v_cmp_gt_u32 vcc, 64, v6
    s_nop 0
    s_cbranch_vccz LpQQ_inib_d
    s_sleep 8
    s_branch LpQQ_inib
LpQQ_inib_d:
    s_barrier
LpQQ_ini_sk:
    s_mul_i32 s41, s37, 36864
    s_add_u32 s41, s41, s64
    s_mul_i32 s60, s37, 22528
    s_add_u32 s60, s60, s61
    s_cmp_lt_u32 s37, 64
    s_cselect_b32 s60, s60, 2883584
    s_branch LpQQ_wait
LpQQ_head:
    s_waitcnt vmcnt(4)
LpQQ_head2:
    s_barrier
    ds_read_b32 v15, v184
    s_xor_b32 s40, s40, 36864
    s_xor_b32 s59, s59, 36864
    s_mov_b32 s35, s37
    s_lshl_b32 s57, s34, 6
    s_add_u32 s57, s57, s35
    s_add_u32 s37, s37, 1
    s_mov_b32 s39, 0
    s_mov_b32 s54, 0
    s_xor_b32 s66, s66, 8192
    s_xor_b32 s71, s71, 8192
    s_mul_i32 s41, s37, 36864
    s_add_u32 s41, s41, s64
    s_mul_i32 s60, s37, 22528
    s_add_u32 s60, s60, s61
    s_cmp_lt_u32 s37, 64
    s_cselect_b32 s60, s60, 2883584
    v_add_u32 v9, s40, v0
    v_add_u32 v5, s71, v10
    ds_read_b128 v[48:51], v9 offset:0
    ds_read_b128 v[52:55], v9 offset:1024
    ds_read_b128 v[56:59], v9 offset:2048
    ds_read_b128 v[64:67], v5 offset:0
    ds_read_b128 v[68:71], v5 offset:512
    ds_read_b128 v[72:75], v5 offset:1024
    ds_read_b128 v[76:79], v5 offset:1536
    ds_read_b128 v[80:83], v5 offset:2048
    s_waitcnt lgkmcnt(7)
    v_mfma_f32_32x32x16_bf16 v[16:31], a[0:3], v[48:51], 0
    ds_read_b128 v[60:63], v9 offset:3072
    v_mfma_f32_32x32x16_bf16 v[32:47], a[144:147], v[48:51], 0
    s_waitcnt lgkmcnt(4)
    v_add_f32 v64, v64, v68
    v_add_f32 v65, v65, v69
    v_add_f32 v66, v66, v70
    v_add_f32 v67, v67, v71
    v_mfma_f32_32x32x16_bf16 v[16:31], a[4:7], v[52:55], v[16:31]
    ds_read_b128 v[48:51], v9 offset:4096
    s_waitcnt lgkmcnt(4)
    v_add_f32 v64, v64, v72
    v_add_f32 v65, v65, v73
    v_add_f32 v66, v66, v74
    v_mfma_f32_32x32x16_bf16 v[32:47], a[148:151], v[52:55], v[32:47]
    v_add_f32 v67, v67, v75
    s_waitcnt lgkmcnt(3)
    v_add_f32 v64, v64, v76
    v_add_f32 v65, v65, v77
    v_add_f32 v66, v66, v78
    v_readfirstlane_b32 s17, v15
    s_nop 0
    s_add_u32 s18, s17, 1
    s_max_i32 s32, s18, s37
    s_add_u32 s39, s37, 1
    s_min_u32 s39, s39, 63
    s_mul_i32 s33, s32, 22528
    s_add_u32 s33, s33, s61
    s_cmp_eq_u32 s14, 0
    s_cselect_b32 s18, s32, 0x7fff
    v_mov_b32 v2, 2
    s_cmp_le_u32 s18, s39
    s_cselect_b64 exec, -1, 0
    buffer_load_dword v2, v1, s[8:11], s33 offen sc1
    s_mov_b64 exec, -1
    s_cmp_ge_i32 s17, s37
    s_cbranch_scc1 LpQQ_f_1
    v_mfma_f32_32x32x16_bf16 v[16:31], a[8:11], v[56:59], v[16:31]
    ds_read_b128 v[52:55], v9 offset:5120
    v_add_f32 v67, v67, v79
    s_waitcnt lgkmcnt(3)
    v_add_f32 v64, v64, v80
    v_add_f32 v65, v65, v81
    v_mfma_f32_32x32x16_bf16 v[32:47], a[152:155], v[56:59], v[32:47]
    v_add_f32 v66, v66, v82
    v_add_f32 v67, v67, v83
    v_add_f32 v64, v64, v66
    v_add_f32 v65, v65, v67
    s_waitcnt lgkmcnt(2)
    v_mfma_f32_32x32x16_bf16 v[16:31], a[12:15], v[60:63], v[16:31]
    ds_read_b128 v[56:59], v9 offset:6144
    v_mov_b32 v66, v64
    v_mov_b32 v67, v65
    s_nop 0
    v_permlane32_swap_b32 v64, v66
    v_mfma_f32_32x32x16_bf16 v[32:47], a[156:159], v[60:63], v[32:47]
    v_permlane32_swap_b32 v65, v67
    v_add_f32 v64, v64, v66
    v_add_f32 v65, v65, v67
    v_mul_f32 v64, 0x3ae38e39, v64
    s_waitcnt lgkmcnt(2)
    v_mfma_f32_32x32x16_bf16 v[16:31], a[16:19], v[48:51], v[16:31]
    ds_read_b128 v[60:63], v9 offset:7168
    v_mul_f32 v65, 0x3ae38e39, v65
    v_fma_f32 v65, -v64, v64, v65
    v_max_f32 v65, 0, v65
    v_mfma_f32_32x32x16_bf16 v[32:47], a[160:163], v[48:51], v[32:47]
    v_add_f32 v65, 0x3727c5ac, v65
    v_rsq_f32 v148, v65
    s_nop 0
    v_mul_f32 v149, v64, v148
    v_mul_f32 v100, v149, v84
    s_waitcnt lgkmcnt(2)
    v_mfma_f32_32x32x16_bf16 v[16:31], a[20:23], v[52:55], v[16:31]
    ds_read_b128 v[48:51], v9 offset:8192
    v_mul_f32 v101, v149, v85
    v_mul_f32 v102, v149, v86
    v_mul_f32 v103, v149, v87
    v_mfma_f32_32x32x16_bf16 v[32:47], a[164:167], v[52:55], v[32:47]
    v_mul_f32 v104, v149, v88
    v_mul_f32 v105, v149, v89
    v_mul_f32 v106, v149, v90
    v_mul_f32 v107, v149, v91
    s_waitcnt lgkmcnt(2)
    v_mfma_f32_32x32x16_bf16 v[16:31], a[24:27], v[56:59], v[16:31]
    ds_read_b128 v[52:55], v9 offset:9216
    v_mul_f32 v108, v149, v92
    v_mul_f32 v109, v149, v93
    v_mul_f32 v110, v149, v94
    v_mfma_f32_32x32x16_bf16 v[32:47], a[168:171], v[56:59], v[32:47]
    v_mul_f32 v111, v149, v95
    v_mul_f32 v112, v149, v96
    v_mul_f32 v113, v149, v97
    v_mul_f32 v114, v149, v98
    s_waitcnt lgkmcnt(2)
    v_mfma_f32_32x32x16_bf16 v[16:31], a[28:31], v[60:63], v[16:31]
    ds_read_b128 v[56:59], v9 offset:10240
    v_mul_f32 v115, v149, v99
    v_mul_f32 v132, v149, v116
    v_mul_f32 v133, v149, v117
    v_mfma_f32_32x32x16_bf16 v[32:47], a[172:175], v[60:63], v[32:47]
    v_mul_f32 v134, v149, v118
    v_mul_f32 v135, v149, v119
    v_mul_f32 v136, v149, v120
    v_mul_f32 v137, v149, v121
    s_waitcnt lgkmcnt(2)
    v_mfma_f32_32x32x16_bf16 v[16:31], a[32:35], v[48:51], v[16:31]
    ds_read_b128 v[60:63], v9 offset:11264
    v_mul_f32 v138, v149, v122
    v_mul_f32 v139, v149, v123
    v_mul_f32 v140, v149, v124
    v_mfma_f32_32x32x16_bf16 v[32:47], a[176:179], v[48:51], v[32:47]
    v_mul_f32 v141, v149, v125
    v_mul_f32 v142, v149, v126
    v_mul_f32 v143, v149, v127
    v_mul_f32 v144, v149, v128
    s_waitcnt lgkmcnt(2)
    v_mfma_f32_32x32x16_bf16 v[16:31], a[36:39], v[52:55], v[16:31]
    ds_read_b128 v[48:51], v9 offset:12288
    v_mul_f32 v145, v149, v129
    v_mul_f32 v146, v149, v130
    v_mul_f32 v147, v149, v131
    v_mfma_f32_32x32x16_bf16 v[32:47], a[180:183], v[52:55], v[32:47]
    s_mul_i32 s46, s34, 50331648
    s_lshl_b32 s51, s35, 18
    s_add_u32 s46, s46, s51
    s_add_u32 s46, s46, s52
    s_waitcnt lgkmcnt(2)
    v_mfma_f32_32x32x16_bf16 v[16:31], a[40:43], v[56:59], v[16:31]
    ds_read_b128 v[52:55], v9 offset:13312
    v_mfma_f32_32x32x16_bf16 v[32:47], a[184:187], v[56:59], v[32:47]
    s_waitcnt lgkmcnt(2)
    v_mfma_f32_32x32x16_bf16 v[16:31], a[44:47], v[60:63], v[16:31]
    ds_read_b128 v[56:59], v9 offset:14336
    v_mfma_f32_32x32x16_bf16 v[32:47], a[188:191], v[60:63], v[32:47]
    s_waitcnt lgkmcnt(2)
    v_mfma_f32_32x32x16_bf16 v[16:31], a[48:51], v[48:51], v[16:31]
    ds_read_b128 v[60:63], v9 offset:15360
    v_mfma_f32_32x32x16_bf16 v[32:47], a[192:195], v[48:51], v[32:47]
    s_waitcnt vmcnt(1)
    s_cmp_lg_u32 s43, 0
    s_cselect_b64 exec, 3, 0
    buffer_store_dword v3, v185, s[8:11], s43 offen sc1
    s_mov_b64 exec, -1
    s_mov_b32 s43, 0
    s_waitcnt lgkmcnt(2)
    v_mfma_f32_32x32x16_bf16 v[16:31], a[52:55], v[52:55], v[16:31]
    ds_read_b128 v[48:51], v9 offset:16384
    v_mfma_f32_32x32x16_bf16 v[32:47], a[196:199], v[52:55], v[32:47]
    s_waitcnt lgkmcnt(2)
    v_mfma_f32_32x32x16_bf16 v[16:31], a[56:59], v[56:59], v[16:31]
    v_cmp_eq_u32 s[76:77], 1, v2
    v_cmp_eq_u32 vcc, 2, v2
    s_cmp_eq_u64 s[76:77], -1
    s_cselect_b32 s38, 1, 0
    ds_read_b128 v[52:55], v9 offset:17408
    v_mfma_f32_32x32x16_bf16 v[32:47], a[200:203], v[56:59], v[32:47]
    s_cmp_lg_u32 s38, 0
    s_cselect_b64 exec, 1, 0
    v_mov_b32 v15, s32
    ds_write_b32 v184, v15
    v_mov_b32 v2, 2
    s_mov_b64 exec, -1
    s_waitcnt lgkmcnt(3)
    v_mfma_f32_32x32x16_bf16 v[16:31], a[60:63], v[60:63], v[16:31]
    s_add_u32 s32, s32, s38
    s_mul_i32 s38, s38, 22528
    s_add_u32 s33, s33, s38
    ds_read_b128 v[56:59], v9 offset:18432
    v_mfma_f32_32x32x16_bf16 v[32:47], a[204:207], v[60:63], v[32:47]
    s_cmp_eq_u64 vcc, 0
    s_cselect_b32 s38, s32, 0x7fff
    s_waitcnt lgkmcnt(3)
    v_mfma_f32_32x32x16_bf16 v[16:31], a[64:67], v[48:51], v[16:31]
    ds_read_b128 v[60:63], v9 offset:19456
    v_mfma_f32_32x32x16_bf16 v[32:47], a[208:211], v[48:51], v[32:47]
    s_cmp_le_u32 s38, s39
    s_cselect_b64 exec, -1, 0
    v_mov_b32 v2, 2
    buffer_load_dword v2, v1, s[8:11], s33 offen sc1
    s_mov_b64 exec, -1
    ds_read_b32 v15, v184
    s_waitcnt lgkmcnt(4)
    v_mfma_f32_32x32x16_bf16 v[16:31], a[68:71], v[52:55], v[16:31]
    ds_read_b128 v[48:51], v9 offset:20480
    v_mfma_f32_32x32x16_bf16 v[32:47], a[212:215], v[52:55], v[32:47]
    s_waitcnt lgkmcnt(3)
    v_mfma_f32_32x32x16_bf16 v[16:31], a[72:75], v[56:59], v[16:31]
    ds_read_b128 v[52:55], v9 offset:21504
    v_mfma_f32_32x32x16_bf16 v[32:47], a[216:219], v[56:59], v[32:47]
    s_waitcnt lgkmcnt(2)
    v_readfirstlane_b32 s17, v15
    s_nop 0
    s_cmp_ge_i32 s17, s37
    s_cbranch_scc1 LpQQ_f_2
    v_mfma_f32_32x32x16_bf16 v[16:31], a[76:79], v[60:63], v[16:31]
    ds_read_b128 v[56:59], v9 offset:22528
    v_mfma_f32_32x32x16_bf16 v[32:47], a[220:223], v[60:63], v[32:47]
    s_waitcnt lgkmcnt(2)
    v_mfma_f32_32x32x16_bf16 v[16:31], a[80:83], v[48:51], v[16:31]
    ds_read_b128 v[60:63], v9 offset:23552
    v_mfma_f32_32x32x16_bf16 v[32:47], a[224:227], v[48:51], v[32:47]
    s_waitcnt lgkmcnt(2)
    v_mfma_f32_32x32x16_bf16 v[16:31], a[84:87], v[52:55], v[16:31]
    ds_read_b128 v[48:51], v9 offset:24576
    v_mfma_f32_32x32x16_bf16 v[32:47], a[228:231], v[52:55], v[32:47]
    s_waitcnt lgkmcnt(2)
    v_mfma_f32_32x32x16_bf16 v[16:31], a[88:91], v[56:59], v[16:31]
    ds_read_b128 v[52:55], v9 offset:25600
    v_mfma_f32_32x32x16_bf16 v[32:47], a[232:235], v[56:59], v[32:47]
    s_waitcnt lgkmcnt(2)
    v_mfma_f32_32x32x16_bf16 v[16:31], a[92:95], v[60:63], v[16:31]
    ds_read_b128 v[56:59], v9 offset:26624
    v_mfma_f32_32x32x16_bf16 v[32:47], a[236:239], v[60:63], v[32:47]
    s_waitcnt lgkmcnt(2)
    v_mfma_f32_32x32x16_bf16 v[16:31], a[96:99], v[48:51], v[16:31]
    ds_read_b128 v[60:63], v9 offset:27648
    v_mfma_f32_32x32x16_bf16 v[32:47], a[240:243], v[48:51], v[32:47]
    s_waitcnt lgkmcnt(2)
    v_mfma_f32_32x32x16_bf16 v[16:31], a[100:103], v[52:55], v[16:31]
    ds_read_b128 v[48:51], v9 offset:28672
    v_mfma_f32_32x32x16_bf16 v[32:47], a[244:247], v[52:55], v[32:47]
    s_waitcnt lgkmcnt(2)
    v_mfma_f32_32x32x16_bf16 v[16:31], a[104:107], v[56:59], v[16:31]
    ds_read_b128 v[52:55], v9 offset:29696
    v_mfma_f32_32x32x16_bf16 v[32:47], a[248:251], v[56:59], v[32:47]
    s_waitcnt lgkmcnt(2)
    v_mfma_f32_32x32x16_bf16 v[16:31], a[108:111], v[60:63], v[16:31]
    ds_read_b128 v[56:59], v9 offset:30720
    v_mfma_f32_32x32x16_bf16 v[32:47], a[252:255], v[60:63], v[32:47]
    s_waitcnt lgkmcnt(2)
    v_mfma_f32_32x32x16_bf16 v[16:31], a[112:115], v[48:51], v[16:31]
    ds_read_b128 v[60:63], v9 offset:31744
    v_mfma_f32_32x32x16_bf16 v[32:47], v[152:155], v[48:51], v[32:47]
    s_waitcnt lgkmcnt(2)
    v_mfma_f32_32x32x16_bf16 v[16:31], a[116:119], v[52:55], v[16:31]
    ds_read_b128 v[48:51], v9 offset:32768
    v_mfma_f32_32x32x16_bf16 v[32:47], v[156:159], v[52:55], v[32:47]
    s_waitcnt lgkmcnt(2)
    v_mfma_f32_32x32x16_bf16 v[16:31], a[120:123], v[56:59], v[16:31]
    ds_read_b128 v[52:55], v9 offset:33792
    v_mfma_f32_32x32x16_bf16 v[32:47], v[160:163], v[56:59], v[32:47]
    s_waitcnt lgkmcnt(2)
    v_mfma_f32_32x32x16_bf16 v[16:31], a[124:127], v[60:63], v[16:31]
    v_cmp_eq_u32 s[76:77], 1, v2
    v_cmp_eq_u32 vcc, 2, v2
    s_cmp_eq_u64 s[76:77], -1
    s_cselect_b32 s38, 1, 0
    ds_read_b128 v[56:59], v9 offset:34816
    v_mfma_f32_32x32x16_bf16 v[32:47], v[164:167], v[60:63], v[32:47]
    s_cmp_lg_u32 s38, 0
    s_cselect_b64 exec, 1, 0
    v_mov_b32 v15, s32
    ds_write_b32 v184, v15
    v_mov_b32 v2, 2
    s_mov_b64 exec, -1
    s_waitcnt lgkmcnt(3)
    v_mfma_f32_32x32x16_bf16 v[16:31], a[128:131], v[48:51], v[16:31]
    s_add_u32 s32, s32, s38
    s_mul_i32 s38, s38, 22528
    s_add_u32 s33, s33, s38
    ds_read_b128 v[60:63], v9 offset:35840
    v_mfma_f32_32x32x16_bf16 v[32:47], v[168:171], v[48:51], v[32:47]
    s_cmp_eq_u64 vcc, 0
    s_cselect_b32 s38, s32, 0x7fff
    s_waitcnt lgkmcnt(3)
    v_mfma_f32_32x32x16_bf16 v[16:31], a[132:135], v[52:55], v[16:31]
    s_cmp_le_u32 s38, s39
    s_cselect_b64 exec, -1, 0
    v_mov_b32 v2, 2
    buffer_load_dword v2, v1, s[8:11], s33 offen sc1
    s_mov_b64 exec, -1
    v_mfma_f32_32x32x16_bf16 v[32:47], v[172:175], v[52:55], v[32:47]
    s_waitcnt lgkmcnt(2)
    v_mfma_f32_32x32x16_bf16 v[16:31], a[136:139], v[56:59], v[16:31]
    v_mfma_f32_32x32x16_bf16 v[32:47], v[176:179], v[56:59], v[32:47]
    s_waitcnt lgkmcnt(0)
    v_mfma_f32_32x32x16_bf16 v[16:31], a[140:143], v[60:63], v[16:31]
    v_mfma_f32_32x32x16_bf16 v[32:47], v[180:183], v[60:63], v[32:47]
    s_add_u32 s51, s46, 8192
    s_nop 2
    v_pk_fma_f32 v[16:17], v[16:17], v[148:149], v[100:101] op_sel_hi:[1,0,1] neg_lo:[0,0,1] neg_hi:[0,0,1]
    v_pk_fma_f32 v[18:19], v[18:19], v[148:149], v[102:103] op_sel_hi:[1,0,1] neg_lo:[0,0,1] neg_hi:[0,0,1]
    v_pk_fma_f32 v[20:21], v[20:21], v[148:149], v[104:105] op_sel_hi:[1,0,1] neg_lo:[0,0,1] neg_hi:[0,0,1]
    v_pk_fma_f32 v[22:23], v[22:23], v[148:149], v[106:107] op_sel_hi:[1,0,1] neg_lo:[0,0,1] neg_hi:[0,0,1]
    v_pk_fma_f32 v[24:25], v[24:25], v[148:149], v[108:109] op_sel_hi:[1,0,1] neg_lo:[0,0,1] neg_hi:[0,0,1]
    v_pk_fma_f32 v[26:27], v[26:27], v[148:149], v[110:111] op_sel_hi:[1,0,1] neg_lo:[0,0,1] neg_hi:[0,0,1]
    v_pk_fma_f32 v[28:29], v[28:29], v[148:149], v[112:113] op_sel_hi:[1,0,1] neg_lo:[0,0,1] neg_hi:[0,0,1]
    v_pk_fma_f32 v[30:31], v[30:31], v[148:149], v[114:115] op_sel_hi:[1,0,1] neg_lo:[0,0,1] neg_hi:[0,0,1]
    v_cvt_pk_bf16_f32 v188, v16, v24
    v_cvt_pk_bf16_f32 v189, v17, v25
    v_cvt_pk_bf16_f32 v190, v18, v26
    v_cvt_pk_bf16_f32 v191, v19, v27
    buffer_store_dwordx4 v[188:191], v14, s[8:11], s46 offen offset:0 sc1
    v_cvt_pk_bf16_f32 v192, v20, v28
    v_cvt_pk_bf16_f32 v193, v21, v29
    v_cvt_pk_bf16_f32 v194, v22, v30
    v_cvt_pk_bf16_f32 v195, v23, v31
    buffer_store_dwordx4 v[192:195], v14, s[8:11], s46 offen offset:512 sc1
    v_pk_fma_f32 v[32:33], v[32:33], v[148:149], v[132:133] op_sel_hi:[1,0,1] neg_lo:[0,0,1] neg_hi:[0,0,1]
    v_pk_fma_f32 v[34:35], v[34:35], v[148:149], v[134:135] op_sel_hi:[1,0,1] neg_lo:[0,0,1] neg_hi:[0,0,1]
    v_pk_fma_f32 v[36:37], v[36:37], v[148:149], v[136:137] op_sel_hi:[1,0,1] neg_lo:[0,0,1] neg_hi:[0,0,1]
    v_pk_fma_f32 v[38:39], v[38:39], v[148:149], v[138:139] op_sel_hi:[1,0,1] neg_lo:[0,0,1] neg_hi:[0,0,1]
    v_pk_fma_f32 v[40:41], v[40:41], v[148:149], v[140:141] op_sel_hi:[1,0,1] neg_lo:[0,0,1] neg_hi:[0,0,1]
    v_pk_fma_f32 v[42:43], v[42:43], v[148:149], v[142:143] op_sel_hi:[1,0,1] neg_lo:[0,0,1] neg_hi:[0,0,1]
    v_pk_fma_f32 v[44:45], v[44:45], v[148:149], v[144:145] op_sel_hi:[1,0,1] neg_lo:[0,0,1] neg_hi:[0,0,1]
    v_pk_fma_f32 v[46:47], v[46:47], v[148:149], v[146:147] op_sel_hi:[1,0,1] neg_lo:[0,0,1] neg_hi:[0,0,1]
    v_cvt_pk_bf16_f32 v196, v32, v40
    v_cvt_pk_bf16_f32 v197, v33, v41
    v_cvt_pk_bf16_f32 v198, v34, v42
    v_cvt_pk_bf16_f32 v199, v35, v43
    buffer_store_dwordx4 v[196:199], v14, s[8:11], s51 offen offset:0 sc1
    v_cvt_pk_bf16_f32 v200, v36, v44
    v_cvt_pk_bf16_f32 v201, v37, v45
    v_cvt_pk_bf16_f32 v202, v38, v46
    v_cvt_pk_bf16_f32 v203, v39, v47
    buffer_store_dwordx4 v[200:203], v14, s[8:11], s51 offen offset:512 sc1
    s_mul_i32 s43, s57, 22528
    s_add_u32 s43, s43, s49
    s_branch LpQQ_none
LpQQ_f_1:
    v_mfma_f32_32x32x16_bf16 v[16:31], a[8:11], v[56:59], v[16:31]
    ds_read_b128 v[52:55], v9 offset:5120
    v_add_f32 v67, v67, v79
    s_waitcnt lgkmcnt(3)
    v_add_f32 v64, v64, v80
    v_add_f32 v65, v65, v81
    v_mfma_f32_32x32x16_bf16 v[32:47], a[152:155], v[56:59], v[32:47]
    v_add_f32 v66, v66, v82
    v_add_f32 v67, v67, v83
    v_add_f32 v64, v64, v66
    v_add_f32 v65, v65, v67
    s_waitcnt lgkmcnt(2)
    v_mfma_f32_32x32x16_bf16 v[16:31], a[12:15], v[60:63], v[16:31]
    ds_read_b128 v[56:59], v9 offset:6144
    v_mov_b32 v66, v64
    v_mov_b32 v67, v65
    s_nop 0
    v_permlane32_swap_b32 v64, v66
    v_mfma_f32_32x32x16_bf16 v[32:47], a[156:159], v[60:63], v[32:47]
    v_permlane32_swap_b32 v65, v67
    v_add_f32 v64, v64, v66
    v_add_f32 v65, v65, v67
    v_mul_f32 v64, 0x3ae38e39, v64
    s_waitcnt lgkmcnt(2)
    v_mfma_f32_32x32x16_bf16 v[16:31], a[16:19], v[48:51], v[16:31]
    ds_read_b128 v[60:63], v9 offset:7168
    v_mul_f32 v65, 0x3ae38e39, v65
    v_fma_f32 v65, -v64, v64, v65
    v_max_f32 v65, 0, v65
    v_mfma_f32_32x32x16_bf16 v[32:47], a[160:163], v[48:51], v[32:47]
    v_add_f32 v65, 0x3727c5ac, v65
    v_rsq_f32 v148, v65
    s_nop 0
    v_mul_f32 v149, v64, v148
    v_mul_f32 v100, v149, v84
    s_waitcnt lgkmcnt(2)
    v_mfma_f32_32x32x16_bf16 v[16:31], a[20:23], v[52:55], v[16:31]
    ds_read_b128 v[48:51], v9 offset:8192
    v_mul_f32 v101, v149, v85
    v_mul_f32 v102, v149, v86
    v_mul_f32 v103, v149, v87
    v_mfma_f32_32x32x16_bf16 v[32:47], a[164:167], v[52:55], v[32:47]
    v_mul_f32 v104, v149, v88
    v_mul_f32 v105, v149, v89
    v_mul_f32 v106, v149, v90
    v_mul_f32 v107, v149, v91
    s_waitcnt lgkmcnt(2)
    v_mfma_f32_32x32x16_bf16 v[16:31], a[24:27], v[56:59], v[16:31]
    ds_read_b128 v[52:55], v9 offset:9216
    v_mul_f32 v108, v149, v92
    v_mul_f32 v109, v149, v93
    v_mul_f32 v110, v149, v94
    v_mfma_f32_32x32x16_bf16 v[32:47], a[168:171], v[56:59], v[32:47]
    v_mul_f32 v111, v149, v95
    v_mul_f32 v112, v149, v96
    v_mul_f32 v113, v149, v97
    v_mul_f32 v114, v149, v98
    s_waitcnt lgkmcnt(2)
    v_mfma_f32_32x32x16_bf16 v[16:31], a[28:31], v[60:63], v[16:31]
    ds_read_b128 v[56:59], v9 offset:10240
    v_mul_f32 v115, v149, v99
    v_mul_f32 v132, v149, v116
    v_mul_f32 v133, v149, v117
    v_mfma_f32_32x32x16_bf16 v[32:47], a[172:175], v[60:63], v[32:47]
    v_mul_f32 v134, v149, v118
    v_mul_f32 v135, v149, v119
    v_mul_f32 v136, v149, v120
    v_mul_f32 v137, v149, v121
    s_waitcnt lgkmcnt(2)
    v_mfma_f32_32x32x16_bf16 v[16:31], a[32:35], v[48:51], v[16:31]
    ds_read_b128 v[60:63], v9 offset:11264
    v_mul_f32 v138, v149, v122
    v_mul_f32 v139, v149, v123
    v_mul_f32 v140, v149, v124
    v_mfma_f32_32x32x16_bf16 v[32:47], a[176:179], v[48:51], v[32:47]
    v_mul_f32 v141, v149, v125
    v_mul_f32 v142, v149, v126
    v_mul_f32 v143, v149, v127
    v_mul_f32 v144, v149, v128
    s_waitcnt lgkmcnt(2)
    v_mfma_f32_32x32x16_bf16 v[16:31], a[36:39], v[52:55], v[16:31]
    ds_read_b128 v[48:51], v9 offset:12288
    v_mul_f32 v145, v149, v129
    v_mul_f32 v146, v149, v130
    v_mul_f32 v147, v149, v131
    v_mfma_f32_32x32x16_bf16 v[32:47], a[180:183], v[52:55], v[32:47]
    s_mul_i32 s46, s34, 50331648
    s_lshl_b32 s51, s35, 18
    s_add_u32 s46, s46, s51
    s_add_u32 s46, s46, s52
    s_waitcnt lgkmcnt(2)
    v_mfma_f32_32x32x16_bf16 v[16:31], a[40:43], v[56:59], v[16:31]
    s_add_u32 m0, s59, 0
    s_add_u32 s47, s41, 0
    buffer_load_dwordx4 v0, s[8:11], s47 offen offset:0 lds
    buffer_load_dwordx4 v0, s[8:11], s47 offen offset:1024 lds
    ds_read_b128 v[52:55], v9 offset:13312
    v_mfma_f32_32x32x16_bf16 v[32:47], a[184:187], v[56:59], v[32:47]
    buffer_load_dwordx4 v0, s[8:11], s47 offen offset:2048 lds
    buffer_load_dwordx4 v0, s[8:11], s47 offen offset:3072 lds
    s_add_u32 m0, s59, 4096
    s_add_u32 s47, s41, 4096
    buffer_load_dwordx4 v0, s[8:11], s47 offen offset:0 lds
    s_waitcnt lgkmcnt(2)
    v_mfma_f32_32x32x16_bf16 v[16:31], a[44:47], v[60:63], v[16:31]
    buffer_load_dwordx4 v0, s[8:11], s47 offen offset:1024 lds
    buffer_load_dwordx4 v0, s[8:11], s47 offen offset:2048 lds
    buffer_load_dwordx4 v0, s[8:11], s47 offen offset:3072 lds
    ds_read_b128 v[56:59], v9 offset:14336
    v_mfma_f32_32x32x16_bf16 v[32:47], a[188:191], v[60:63], v[32:47]
    s_add_u32 m0, s59, 8192
    s_add_u32 s47, s41, 8192
    buffer_load_dwordx4 v0, s[8:11], s47 offen offset:0 lds
    s_waitcnt lgkmcnt(2)
    v_mfma_f32_32x32x16_bf16 v[16:31], a[48:51], v[48:51], v[16:31]
    s_mul_i32 s48, s36, 786432
    s_mul_i32 s18, s37, 6144
    s_add_u32 s48, s48, s18
    s_add_u32 s48, s48, 16125952
    s_add_u32 m0, s66, 4096
    s_nop 0
    buffer_load_dwordx4 v0, s[8:11], s48 offen lds
    ds_read_b128 v[60:63], v9 offset:15360
    v_mfma_f32_32x32x16_bf16 v[32:47], a[192:195], v[48:51], v[32:47]
    s_add_u32 m0, s66, s67
    s_sub_u32 s48, s48, 4096
    s_add_u32 s48, s48, s67
    buffer_load_dwordx4 v0, s[8:11], s48 offen lds
    s_waitcnt vmcnt(12)
    s_cmp_lg_u32 s43, 0
    s_cselect_b64 exec, 3, 0
    buffer_store_dword v3, v185, s[8:11], s43 offen sc1
    s_mov_b64 exec, -1
    s_mov_b32 s43, 0
    s_waitcnt lgkmcnt(2)
    v_mfma_f32_32x32x16_bf16 v[16:31], a[52:55], v[52:55], v[16:31]
    ds_read_b128 v[48:51], v9 offset:16384
    v_mfma_f32_32x32x16_bf16 v[32:47], a[196:199], v[52:55], v[32:47]
    s_waitcnt lgkmcnt(2)
    v_mfma_f32_32x32x16_bf16 v[16:31], a[56:59], v[56:59], v[16:31]
    v_cmp_eq_u32 s[76:77], 1, v2
    v_cmp_eq_u32 vcc, 2, v2
    s_cmp_eq_u64 s[76:77], -1
    s_cselect_b32 s38, 1, 0
    ds_read_b128 v[52:55], v9 offset:17408
    v_mfma_f32_32x32x16_bf16 v[32:47], a[200:203], v[56:59], v[32:47]
    s_cmp_lg_u32 s38, 0
    s_cselect_b64 exec, 1, 0
    v_mov_b32 v15, s32
    ds_write_b32 v184, v15
    v_mov_b32 v2, 2
    s_mov_b64 exec, -1
    s_waitcnt lgkmcnt(3)
    v_mfma_f32_32x32x16_bf16 v[16:31], a[60:63], v[60:63], v[16:31]
    s_add_u32 s32, s32, s38
    s_mul_i32 s38, s38, 22528
    s_add_u32 s33, s33, s38
    ds_read_b128 v[56:59], v9 offset:18432
    v_mfma_f32_32x32x16_bf16 v[32:47], a[204:207], v[60:63], v[32:47]
    s_cmp_eq_u64 vcc, 0
    s_cselect_b32 s38, s32, 0x7fff
    s_waitcnt lgkmcnt(3)
    v_mfma_f32_32x32x16_bf16 v[16:31], a[64:67], v[48:51], v[16:31]
    ds_read_b128 v[60:63], v9 offset:19456
    v_mfma_f32_32x32x16_bf16 v[32:47], a[208:211], v[48:51], v[32:47]
    s_cmp_le_u32 s38, s39
    s_cselect_b64 exec, -1, 0
    v_mov_b32 v2, 2
    buffer_load_dword v2, v1, s[8:11], s33 offen sc1
    s_mov_b64 exec, -1
    s_waitcnt lgkmcnt(3)
    v_mfma_f32_32x32x16_bf16 v[16:31], a[68:71], v[52:55], v[16:31]
    ds_read_b128 v[48:51], v9 offset:20480
    v_mfma_f32_32x32x16_bf16 v[32:47], a[212:215], v[52:55], v[32:47]
    s_waitcnt lgkmcnt(2)
    v_mfma_f32_32x32x16_bf16 v[16:31], a[72:75], v[56:59], v[16:31]
    ds_read_b128 v[52:55], v9 offset:21504
    v_mfma_f32_32x32x16_bf16 v[32:47], a[216:219], v[56:59], v[32:47]
    s_waitcnt lgkmcnt(2)
    v_mfma_f32_32x32x16_bf16 v[16:31], a[76:79], v[60:63], v[16:31]
    ds_read_b128 v[56:59], v9 offset:22528
    v_mfma_f32_32x32x16_bf16 v[32:47], a[220:223], v[60:63], v[32:47]
    s_waitcnt lgkmcnt(2)
    v_mfma_f32_32x32x16_bf16 v[16:31], a[80:83], v[48:51], v[16:31]
    ds_read_b128 v[60:63], v9 offset:23552
    v_mfma_f32_32x32x16_bf16 v[32:47], a[224:227], v[48:51], v[32:47]
    s_waitcnt lgkmcnt(2)
    v_mfma_f32_32x32x16_bf16 v[16:31], a[84:87], v[52:55], v[16:31]
    ds_read_b128 v[48:51], v9 offset:24576
    v_mfma_f32_32x32x16_bf16 v[32:47], a[228:231], v[52:55], v[32:47]
    s_waitcnt lgkmcnt(2)
    v_mfma_f32_32x32x16_bf16 v[16:31], a[88:91], v[56:59], v[16:31]
    ds_read_b128 v[52:55], v9 offset:25600
    v_mfma_f32_32x32x16_bf16 v[32:47], a[232:235], v[56:59], v[32:47]
    s_waitcnt lgkmcnt(2)
    v_mfma_f32_32x32x16_bf16 v[16:31], a[92:95], v[60:63], v[16:31]
    ds_read_b128 v[56:59], v9 offset:26624
    v_mfma_f32_32x32x16_bf16 v[32:47], a[236:239], v[60:63], v[32:47]
    s_waitcnt lgkmcnt(2)
    v_mfma_f32_32x32x16_bf16 v[16:31], a[96:99], v[48:51], v[16:31]
    ds_read_b128 v[60:63], v9 offset:27648
    v_mfma_f32_32x32x16_bf16 v[32:47], a[240:243], v[48:51], v[32:47]
    s_waitcnt lgkmcnt(2)
    v_mfma_f32_32x32x16_bf16 v[16:31], a[100:103], v[52:55], v[16:31]
    ds_read_b128 v[48:51], v9 offset:28672
    v_mfma_f32_32x32x16_bf16 v[32:47], a[244:247], v[52:55], v[32:47]
    s_waitcnt lgkmcnt(2)
    v_mfma_f32_32x32x16_bf16 v[16:31], a[104:107], v[56:59], v[16:31]
    ds_read_b128 v[52:55], v9 offset:29696
    v_mfma_f32_32x32x16_bf16 v[32:47], a[248:251], v[56:59], v[32:47]
    s_waitcnt lgkmcnt(2)
    v_mfma_f32_32x32x16_bf16 v[16:31], a[108:111], v[60:63], v[16:31]
    ds_read_b128 v[56:59], v9 offset:30720
    v_mfma_f32_32x32x16_bf16 v[32:47], a[252:255], v[60:63], v[32:47]
    s_waitcnt lgkmcnt(2)
    v_mfma_f32_32x32x16_bf16 v[16:31], a[112:115], v[48:51], v[16:31]
    ds_read_b128 v[60:63], v9 offset:31744
    v_mfma_f32_32x32x16_bf16 v[32:47], v[152:155], v[48:51], v[32:47]
    s_waitcnt lgkmcnt(2)
    v_mfma_f32_32x32x16_bf16 v[16:31], a[116:119], v[52:55], v[16:31]
    ds_read_b128 v[48:51], v9 offset:32768
    v_mfma_f32_32x32x16_bf16 v[32:47], v[156:159], v[52:55], v[32:47]
    s_waitcnt lgkmcnt(2)
    v_mfma_f32_32x32x16_bf16 v[16:31], a[120:123], v[56:59], v[16:31]
    ds_read_b128 v[52:55], v9 offset:33792
    v_mfma_f32_32x32x16_bf16 v[32:47], v[160:163], v[56:59], v[32:47]
    s_waitcnt lgkmcnt(2)
    v_mfma_f32_32x32x16_bf16 v[16:31], a[124:127], v[60:63], v[16:31]
    v_cmp_eq_u32 s[76:77], 1, v2
    v_cmp_eq_u32 vcc, 2, v2
    s_cmp_eq_u64 s[76:77], -1
    s_cselect_b32 s38, 1, 0
    ds_read_b128 v[56:59], v9 offset:34816
    v_mfma_f32_32x32x16_bf16 v[32:47], v[164:167], v[60:63], v[32:47]
    s_cmp_lg_u32 s38, 0
    s_cselect_b64 exec, 1, 0
    v_mov_b32 v15, s32
    ds_write_b32 v184, v15
    v_mov_b32 v2, 2
    s_mov_b64 exec, -1
    s_waitcnt lgkmcnt(3)
    v_mfma_f32_32x32x16_bf16 v[16:31], a[128:131], v[48:51], v[16:31]
    s_add_u32 s32, s32, s38
    s_mul_i32 s38, s38, 22528
    s_add_u32 s33, s33, s38
    ds_read_b128 v[60:63], v9 offset:35840
    v_mfma_f32_32x32x16_bf16 v[32:47], v[168:171], v[48:51], v[32:47]
    s_cmp_eq_u64 vcc, 0
    s_cselect_b32 s38, s32, 0x7fff
    s_waitcnt lgkmcnt(3)
    v_mfma_f32_32x32x16_bf16 v[16:31], a[132:135], v[52:55], v[16:31]
    s_cmp_le_u32 s38, s39
    s_cselect_b64 exec, -1, 0
    v_mov_b32 v2, 2
    buffer_load_dword v2, v1, s[8:11], s33 offen sc1
    s_mov_b64 exec, -1
    v_mfma_f32_32x32x16_bf16 v[32:47], v[172:175], v[52:55], v[32:47]
    s_waitcnt lgkmcnt(2)
    v_mfma_f32_32x32x16_bf16 v[16:31], a[136:139], v[56:59], v[16:31]
    v_mfma_f32_32x32x16_bf16 v[32:47], v[176:179], v[56:59], v[32:47]
    s_waitcnt lgkmcnt(0)
    v_mfma_f32_32x32x16_bf16 v[16:31], a[140:143], v[60:63], v[16:31]
    v_mfma_f32_32x32x16_bf16 v[32:47], v[180:183], v[60:63], v[32:47]
    s_add_u32 s51, s46, 8192
    s_nop 2
    v_pk_fma_f32 v[16:17], v[16:17], v[148:149], v[100:101] op_sel_hi:[1,0,1] neg_lo:[0,0,1] neg_hi:[0,0,1]
    v_pk_fma_f32 v[18:19], v[18:19], v[148:149], v[102:103] op_sel_hi:[1,0,1] neg_lo:[0,0,1] neg_hi:[0,0,1]
    v_pk_fma_f32 v[20:21], v[20:21], v[148:149], v[104:105] op_sel_hi:[1,0,1] neg_lo:[0,0,1] neg_hi:[0,0,1]
    v_pk_fma_f32 v[22:23], v[22:23], v[148:149], v[106:107] op_sel_hi:[1,0,1] neg_lo:[0,0,1] neg_hi:[0,0,1]
    v_pk_fma_f32 v[24:25], v[24:25], v[148:149], v[108:109] op_sel_hi:[1,0,1] neg_lo:[0,0,1] neg_hi:[0,0,1]
    v_pk_fma_f32 v[26:27], v[26:27], v[148:149], v[110:111] op_sel_hi:[1,0,1] neg_lo:[0,0,1] neg_hi:[0,0,1]
    v_pk_fma_f32 v[28:29], v[28:29], v[148:149], v[112:113] op_sel_hi:[1,0,1] neg_lo:[0,0,1] neg_hi:[0,0,1]
    v_pk_fma_f32 v[30:31], v[30:31], v[148:149], v[114:115] op_sel_hi:[1,0,1] neg_lo:[0,0,1] neg_hi:[0,0,1]
    v_cvt_pk_bf16_f32 v188, v16, v24
    v_cvt_pk_bf16_f32 v189, v17, v25
    v_cvt_pk_bf16_f32 v190, v18, v26
    v_cvt_pk_bf16_f32 v191, v19, v27
    buffer_store_dwordx4 v[188:191], v14, s[8:11], s46 offen offset:0 sc1
    v_cvt_pk_bf16_f32 v192, v20, v28
    v_cvt_pk_bf16_f32 v193, v21, v29
    v_cvt_pk_bf16_f32 v194, v22, v30
    v_cvt_pk_bf16_f32 v195, v23, v31
    buffer_store_dwordx4 v[192:195], v14, s[8:11], s46 offen offset:512 sc1
    v_pk_fma_f32 v[32:33], v[32:33], v[148:149], v[132:133] op_sel_hi:[1,0,1] neg_lo:[0,0,1] neg_hi:[0,0,1]
    v_pk_fma_f32 v[34:35], v[34:35], v[148:149], v[134:135] op_sel_hi:[1,0,1] neg_lo:[0,0,1] neg_hi:[0,0,1]
    v_pk_fma_f32 v[36:37], v[36:37], v[148:149], v[136:137] op_sel_hi:[1,0,1] neg_lo:[0,0,1] neg_hi:[0,0,1]
    v_pk_fma_f32 v[38:39], v[38:39], v[148:149], v[138:139] op_sel_hi:[1,0,1] neg_lo:[0,0,1] neg_hi:[0,0,1]
    v_pk_fma_f32 v[40:41], v[40:41], v[148:149], v[140:141] op_sel_hi:[1,0,1] neg_lo:[0,0,1] neg_hi:[0,0,1]
    v_pk_fma_f32 v[42:43], v[42:43], v[148:149], v[142:143] op_sel_hi:[1,0,1] neg_lo:[0,0,1] neg_hi:[0,0,1]
    v_pk_fma_f32 v[44:45], v[44:45], v[148:149], v[144:145] op_sel_hi:[1,0,1] neg_lo:[0,0,1] neg_hi:[0,0,1]
    v_pk_fma_f32 v[46:47], v[46:47], v[148:149], v[146:147] op_sel_hi:[1,0,1] neg_lo:[0,0,1] neg_hi:[0,0,1]
    v_cvt_pk_bf16_f32 v196, v32, v40
    v_cvt_pk_bf16_f32 v197, v33, v41
    v_cvt_pk_bf16_f32 v198, v34, v42
    v_cvt_pk_bf16_f32 v199, v35, v43
    buffer_store_dwordx4 v[196:199], v14, s[8:11], s51 offen offset:0 sc1
    v_cvt_pk_bf16_f32 v200, v36, v44
    v_cvt_pk_bf16_f32 v201, v37, v45
    v_cvt_pk_bf16_f32 v202, v38, v46
    v_cvt_pk_bf16_f32 v203, v39, v47
    buffer_store_dwordx4 v[200:203], v14, s[8:11], s51 offen offset:512 sc1
    s_mul_i32 s43, s57, 22528
    s_add_u32 s43, s43, s49
    s_branch LpQQ_head
LpQQ_f_2:
    v_mfma_f32_32x32x16_bf16 v[16:31], a[76:79], v[60:63], v[16:31]
    s_add_u32 m0, s59, 0
    s_add_u32 s47, s41, 0
    buffer_load_dwordx4 v0, s[8:11], s47 offen offset:0 lds
    ds_read_b128 v[56:59], v9 offset:22528
    v_mfma_f32_32x32x16_bf16 v[32:47], a[220:223], v[60:63], v[32:47]
    s_waitcnt lgkmcnt(2)
    v_mfma_f32_32x32x16_bf16 v[16:31], a[80:83], v[48:51], v[16:31]
    buffer_load_dwordx4 v0, s[8:11], s47 offen offset:1024 lds
    ds_read_b128 v[60:63], v9 offset:23552
    v_mfma_f32_32x32x16_bf16 v[32:47], a[224:227], v[48:51], v[32:47]
    s_waitcnt lgkmcnt(2)
    v_mfma_f32_32x32x16_bf16 v[16:31], a[84:87], v[52:55], v[16:31]
    buffer_load_dwordx4 v0, s[8:11], s47 offen offset:2048 lds
    ds_read_b128 v[48:51], v9 offset:24576
    v_mfma_f32_32x32x16_bf16 v[32:47], a[228:231], v[52:55], v[32:47]
    s_waitcnt lgkmcnt(2)
    v_mfma_f32_32x32x16_bf16 v[16:31], a[88:91], v[56:59], v[16:31]
    buffer_load_dwordx4 v0, s[8:11], s47 offen offset:3072 lds
    ds_read_b128 v[52:55], v9 offset:25600
    v_mfma_f32_32x32x16_bf16 v[32:47], a[232:235], v[56:59], v[32:47]
    s_waitcnt lgkmcnt(2)
    v_mfma_f32_32x32x16_bf16 v[16:31], a[92:95], v[60:63], v[16:31]
    s_add_u32 m0, s59, 4096
    s_add_u32 s47, s41, 4096
    buffer_load_dwordx4 v0, s[8:11], s47 offen offset:0 lds
    ds_read_b128 v[56:59], v9 offset:26624
    v_mfma_f32_32x32x16_bf16 v[32:47], a[236:239], v[60:63], v[32:47]
    s_waitcnt lgkmcnt(2)
    v_mfma_f32_32x32x16_bf16 v[16:31], a[96:99], v[48:51], v[16:31]
    buffer_load_dwordx4 v0, s[8:11], s47 offen offset:1024 lds
    ds_read_b128 v[60:63], v9 offset:27648
    v_mfma_f32_32x32x16_bf16 v[32:47], a[240:243], v[48:51], v[32:47]
    s_waitcnt lgkmcnt(2)
    v_mfma_f32_32x32x16_bf16 v[16:31], a[100:103], v[52:55], v[16:31]
    buffer_load_dwordx4 v0, s[8:11], s47 offen offset:2048 lds
    ds_read_b128 v[48:51], v9 offset:28672
    v_mfma_f32_32x32x16_bf16 v[32:47], a[244:247], v[52:55], v[32:47]
    s_waitcnt lgkmcnt(2)
    v_mfma_f32_32x32x16_bf16 v[16:31], a[104:107], v[56:59], v[16:31]
    buffer_load_dwordx4 v0, s[8:11], s47 offen offset:3072 lds
    ds_read_b128 v[52:55], v9 offset:29696
    v_mfma_f32_32x32x16_bf16 v[32:47], a[248:251], v[56:59], v[32:47]
    s_waitcnt lgkmcnt(2)
    v_mfma_f32_32x32x16_bf16 v[16:31], a[108:111], v[60:63], v[16:31]
    s_add_u32 m0, s59, 8192
    s_add_u32 s47, s41, 8192
    buffer_load_dwordx4 v0, s[8:11], s47 offen offset:0 lds
    ds_read_b128 v[56:59], v9 offset:30720
    v_mfma_f32_32x32x16_bf16 v[32:47], a[252:255], v[60:63], v[32:47]
    s_waitcnt lgkmcnt(2)
    v_mfma_f32_32x32x16_bf16 v[16:31], a[112:115], v[48:51], v[16:31]
    s_mul_i32 s48, s36, 786432
    s_mul_i32 s18, s37, 6144
    s_add_u32 s48, s48, s18
    s_add_u32 s48, s48, 16125952
    s_add_u32 m0, s66, 4096
    s_nop 0
    buffer_load_dwordx4 v0, s[8:11], s48 offen lds
    ds_read_b128 v[60:63], v9 offset:31744
    v_mfma_f32_32x32x16_bf16 v[32:47], v[152:155], v[48:51], v[32:47]
    s_waitcnt lgkmcnt(2)
    v_mfma_f32_32x32x16_bf16 v[16:31], a[116:119], v[52:55], v[16:31]
    s_add_u32 m0, s66, s67
    s_sub_u32 s48, s48, 4096
    s_add_u32 s48, s48, s67
    buffer_load_dwordx4 v0, s[8:11], s48 offen lds
    ds_read_b128 v[48:51], v9 offset:32768
    v_mfma_f32_32x32x16_bf16 v[32:47], v[156:159], v[52:55], v[32:47]
    s_waitcnt lgkmcnt(2)
    v_mfma_f32_32x32x16_bf16 v[16:31], a[120:123], v[56:59], v[16:31]
    ds_read_b128 v[52:55], v9 offset:33792
    v_mfma_f32_32x32x16_bf16 v[32:47], v[160:163], v[56:59], v[32:47]
    s_waitcnt lgkmcnt(2)
    v_mfma_f32_32x32x16_bf16 v[16:31], a[124:127], v[60:63], v[16:31]
    v_cmp_eq_u32 s[76:77], 1, v2
    v_cmp_eq_u32 vcc, 2, v2
    s_cmp_eq_u64 s[76:77], -1
    s_cselect_b32 s38, 1, 0
    ds_read_b128 v[56:59], v9 offset:34816
    v_mfma_f32_32x32x16_bf16 v[32:47], v[164:167], v[60:63], v[32:47]
    s_cmp_lg_u32 s38, 0
    s_cselect_b64 exec, 1, 0
    v_mov_b32 v15, s32
    ds_write_b32 v184, v15
    v_mov_b32 v2, 2
    s_mov_b64 exec, -1
    s_waitcnt lgkmcnt(3)
    v_mfma_f32_32x32x16_bf16 v[16:31], a[128:131], v[48:51], v[16:31]
    s_add_u32 s32, s32, s38
    s_mul_i32 s38, s38, 22528
    s_add_u32 s33, s33, s38
    ds_read_b128 v[60:63], v9 offset:35840
    v_mfma_f32_32x32x16_bf16 v[32:47], v[168:171], v[48:51], v[32:47]
    s_cmp_eq_u64 vcc, 0
    s_cselect_b32 s38, s32, 0x7fff
    s_waitcnt lgkmcnt(3)
    v_mfma_f32_32x32x16_bf16 v[16:31], a[132:135], v[52:55], v[16:31]
    s_cmp_le_u32 s38, s39
    s_cselect_b64 exec, -1, 0
    v_mov_b32 v2, 2
    buffer_load_dword v2, v1, s[8:11], s33 offen sc1
    s_mov_b64 exec, -1
    v_mfma_f32_32x32x16_bf16 v[32:47], v[172:175], v[52:55], v[32:47]
    s_waitcnt lgkmcnt(2)
    v_mfma_f32_32x32x16_bf16 v[16:31], a[136:139], v[56:59], v[16:31]
    v_mfma_f32_32x32x16_bf16 v[32:47], v[176:179], v[56:59], v[32:47]
    s_waitcnt lgkmcnt(0)
    v_mfma_f32_32x32x16_bf16 v[16:31], a[140:143], v[60:63], v[16:31]
    v_mfma_f32_32x32x16_bf16 v[32:47], v[180:183], v[60:63], v[32:47]
    s_add_u32 s51, s46, 8192
    s_nop 2
    v_pk_fma_f32 v[16:17], v[16:17], v[148:149], v[100:101] op_sel_hi:[1,0,1] neg_lo:[0,0,1] neg_hi:[0,0,1]
    v_pk_fma_f32 v[18:19], v[18:19], v[148:149], v[102:103] op_sel_hi:[1,0,1] neg_lo:[0,0,1] neg_hi:[0,0,1]
    v_pk_fma_f32 v[20:21], v[20:21], v[148:149], v[104:105] op_sel_hi:[1,0,1] neg_lo:[0,0,1] neg_hi:[0,0,1]
    v_pk_fma_f32 v[22:23], v[22:23], v[148:149], v[106:107] op_sel_hi:[1,0,1] neg_lo:[0,0,1] neg_hi:[0,0,1]
    v_pk_fma_f32 v[24:25], v[24:25], v[148:149], v[108:109] op_sel_hi:[1,0,1] neg_lo:[0,0,1] neg_hi:[0,0,1]
    v_pk_fma_f32 v[26:27], v[26:27], v[148:149], v[110:111] op_sel_hi:[1,0,1] neg_lo:[0,0,1] neg_hi:[0,0,1]
    v_pk_fma_f32 v[28:29], v[28:29], v[148:149], v[112:113] op_sel_hi:[1,0,1] neg_lo:[0,0,1] neg_hi:[0,0,1]
    v_pk_fma_f32 v[30:31], v[30:31], v[148:149], v[114:115] op_sel_hi:[1,0,1] neg_lo:[0,0,1] neg_hi:[0,0,1]
    v_cvt_pk_bf16_f32 v188, v16, v24
    v_cvt_pk_bf16_f32 v189, v17, v25
    v_cvt_pk_bf16_f32 v190, v18, v26
    v_cvt_pk_bf16_f32 v191, v19, v27
    buffer_store_dwordx4 v[188:191], v14, s[8:11], s46 offen offset:0 sc1
    v_cvt_pk_bf16_f32 v192, v20, v28
    v_cvt_pk_bf16_f32 v193, v21, v29
    v_cvt_pk_bf16_f32 v194, v22, v30
    v_cvt_pk_bf16_f32 v195, v23, v31
    buffer_store_dwordx4 v[192:195], v14, s[8:11], s46 offen offset:512 sc1
    v_pk_fma_f32 v[32:33], v[32:33], v[148:149], v[132:133] op_sel_hi:[1,0,1] neg_lo:[0,0,1] neg_hi:[0,0,1]
    v_pk_fma_f32 v[34:35], v[34:35], v[148:149], v[134:135] op_sel_hi:[1,0,1] neg_lo:[0,0,1] neg_hi:[0,0,1]
    v_pk_fma_f32 v[36:37], v[36:37], v[148:149], v[136:137] op_sel_hi:[1,0,1] neg_lo:[0,0,1] neg_hi:[0,0,1]
    v_pk_fma_f32 v[38:39], v[38:39], v[148:149], v[138:139] op_sel_hi:[1,0,1] neg_lo:[0,0,1] neg_hi:[0,0,1]
    v_pk_fma_f32 v[40:41], v[40:41], v[148:149], v[140:141] op_sel_hi:[1,0,1] neg_lo:[0,0,1] neg_hi:[0,0,1]
    v_pk_fma_f32 v[42:43], v[42:43], v[148:149], v[142:143] op_sel_hi:[1,0,1] neg_lo:[0,0,1] neg_hi:[0,0,1]
    v_pk_fma_f32 v[44:45], v[44:45], v[148:149], v[144:145] op_sel_hi:[1,0,1] neg_lo:[0,0,1] neg_hi:[0,0,1]
    v_pk_fma_f32 v[46:47], v[46:47], v[148:149], v[146:147] op_sel_hi:[1,0,1] neg_lo:[0,0,1] neg_hi:[0,0,1]
    v_cvt_pk_bf16_f32 v196, v32, v40
    v_cvt_pk_bf16_f32 v197, v33, v41
    v_cvt_pk_bf16_f32 v198, v34, v42
    v_cvt_pk_bf16_f32 v199, v35, v43
    buffer_store_dwordx4 v[196:199], v14, s[8:11], s51 offen offset:0 sc1
    v_cvt_pk_bf16_f32 v200, v36, v44
    v_cvt_pk_bf16_f32 v201, v37, v45
    v_cvt_pk_bf16_f32 v202, v38, v46
    v_cvt_pk_bf16_f32 v203, v39, v47
    buffer_store_dwordx4 v[200:203], v14, s[8:11], s51 offen offset:512 sc1
    s_mul_i32 s43, s57, 22528
    s_add_u32 s43, s43, s49
    s_branch LpQQ_head
LpQQ_none:
    ds_read_b32 v15, v184
    s_waitcnt lgkmcnt(0)
    v_readfirstlane_b32 s17, v15
    s_nop 0
    s_cmp_lt_i32 s17, s37
    s_cbranch_scc1 LpQQ_nopost
    s_add_u32 m0, s59, 0
    s_add_u32 s47, s41, 0
    buffer_load_dwordx4 v0, s[8:11], s47 offen offset:0 lds
    buffer_load_dwordx4 v0, s[8:11], s47 offen offset:1024 lds
    buffer_load_dwordx4 v0, s[8:11], s47 offen offset:2048 lds
    buffer_load_dwordx4 v0, s[8:11], s47 offen offset:3072 lds
    s_add_u32 m0, s59, 4096
    s_add_u32 s47, s41, 4096
    buffer_load_dwordx4 v0, s[8:11], s47 offen offset:0 lds
    buffer_load_dwordx4 v0, s[8:11], s47 offen offset:1024 lds
    buffer_load_dwordx4 v0, s[8:11], s47 offen offset:2048 lds
    buffer_load_dwordx4 v0, s[8:11], s47 offen offset:3072 lds
    s_add_u32 m0, s59, 8192
    s_add_u32 s47, s41, 8192
    buffer_load_dwordx4 v0, s[8:11], s47 offen offset:0 lds
    s_mul_i32 s48, s36, 786432
    s_mul_i32 s18, s37, 6144
    s_add_u32 s48, s48, s18
    s_add_u32 s48, s48, 16125952
    s_add_u32 m0, s66, 4096
    s_nop 0
    buffer_load_dwordx4 v0, s[8:11], s48 offen lds
    s_add_u32 m0, s66, s67
    s_sub_u32 s48, s48, 4096
    s_add_u32 s48, s48, s67
    buffer_load_dwordx4 v0, s[8:11], s48 offen lds
    s_waitcnt vmcnt(11)
    s_cmp_lg_u32 s43, 0
    s_cselect_b64 exec, 3, 0
    buffer_store_dword v3, v185, s[8:11], s43 offen sc1
    s_mov_b64 exec, -1
    s_mov_b32 s43, 0
    s_waitcnt vmcnt(1) lgkmcnt(0)
    s_branch LpQQ_head2
LpQQ_nopost:
    s_waitcnt vmcnt(0)
    s_cmp_lg_u32 s43, 0
    s_cselect_b64 exec, 3, 0
    buffer_store_dword v3, v185, s[8:11], s43 offen sc1
    s_mov_b64 exec, -1
    s_mov_b32 s43, 0
    s_cmp_ge_u32 s37, 64
    s_cbranch_scc1 LpQQ_end
LpQQ_wait:
    s_mov_b32 s16, 0
    s_cmp_lg_u32 s14, 0
    s_cbranch_scc1 LpQQ_wl
LpQQ_wp:
    buffer_load_dword v2, v1, s[8:11], s60 offen sc1
    s_add_u32 s16, s16, 1
    s_cmp_gt_u32 s16, 100000
    s_cbranch_scc1 LpQQ_giveup
    s_waitcnt vmcnt(0)
    v_cmp_eq_u32 vcc, 0, v2
    s_nop 0
    s_cbranch_vccz LpQQ_wok
    s_sleep 4
    s_branch LpQQ_wp
LpQQ_giveup:
    v_mov_b32 v5, -2
    ds_write_b32 v184, v5
    s_waitcnt lgkmcnt(0)
    s_branch L_role_p_abort
LpQQ_wok:
    v_mov_b32 v5, s37
    ds_write_b32 v184, v5
    s_branch LpQQ_go
LpQQ_wl:
    ds_read_b32 v15, v184
    s_add_u32 s16, s16, 1
    s_cmp_gt_u32 s16, 1600000
    s_cbranch_scc1 L_role_p_abort
    s_waitcnt lgkmcnt(0)
    v_readfirstlane_b32 s17, v15
    s_nop 0
    s_cmp_eq_u32 s17, -2
    s_cbranch_scc1 L_role_p_abort
    s_cmp_ge_i32 s17, s37
    s_cbranch_scc1 LpQQ_go
    s_sleep 1
    s_branch LpQQ_wl
LpQQ_go:
    s_add_u32 m0, s59, 0
    s_add_u32 s47, s41, 0
    buffer_load_dwordx4 v0, s[8:11], s47 offen offset:0 lds
    buffer_load_dwordx4 v0, s[8:11], s47 offen offset:1024 lds
    buffer_load_dwordx4 v0, s[8:11], s47 offen offset:2048 lds
    buffer_load_dwordx4 v0, s[8:11], s47 offen offset:3072 lds
    s_add_u32 m0, s59, 4096
    s_add_u32 s47, s41, 4096
    buffer_load_dwordx4 v0, s[8:11], s47 offen offset:0 lds
    buffer_load_dwordx4 v0, s[8:11], s47 offen offset:1024 lds
    buffer_load_dwordx4 v0, s[8:11], s47 offen offset:2048 lds
    buffer_load_dwordx4 v0, s[8:11], s47 offen offset:3072 lds
    s_add_u32 m0, s59, 8192
    s_add_u32 s47, s41, 8192
    buffer_load_dwordx4 v0, s[8:11], s47 offen offset:0 lds
    s_mul_i32 s48, s36, 786432
    s_mul_i32 s18, s37, 6144
    s_add_u32 s48, s48, s18
    s_add_u32 s48, s48, 16125952
    s_add_u32 m0, s66, 4096
    s_nop 0
    buffer_load_dwordx4 v0, s[8:11], s48 offen lds
    s_add_u32 m0, s66, s67
    s_sub_u32 s48, s48, 4096
    s_add_u32 s48, s48, s67
    buffer_load_dwordx4 v0, s[8:11], s48 offen lds
    s_waitcnt vmcnt(0) lgkmcnt(0)
    s_branch LpQQ_head2
LpQQ_end:
    s_branch L_role_p_exit
Lp2_kv:
    v_mfma_f32_32x32x16_bf16 v[84:99], a[0:3], v[48:51], 0
    v_mfma_f32_32x32x16_bf16 v[32:47], v[48:51], a[144:147], 0
    v_mfma_f32_32x32x16_bf16 v[84:99], a[4:7], v[48:51], v[84:99]
    v_mfma_f32_32x32x16_bf16 v[32:47], v[48:51], a[148:151], v[32:47]
    v_mfma_f32_32x32x16_bf16 v[84:99], a[8:11], v[48:51], v[84:99]
    v_mfma_f32_32x32x16_bf16 v[32:47], v[48:51], a[152:155], v[32:47]
    v_mfma_f32_32x32x16_bf16 v[84:99], a[12:15], v[48:51], v[84:99]
    v_mfma_f32_32x32x16_bf16 v[32:47], v[48:51], a[156:159], v[32:47]
    v_mfma_f32_32x32x16_bf16 v[84:99], a[16:19], v[48:51], v[84:99]
    v_mfma_f32_32x32x16_bf16 v[32:47], v[48:51], a[160:163], v[32:47]
    v_mfma_f32_32x32x16_bf16 v[84:99], a[20:23], v[48:51], v[84:99]
    v_mfma_f32_32x32x16_bf16 v[32:47], v[48:51], a[164:167], v[32:47]
    v_mfma_f32_32x32x16_bf16 v[84:99], a[24:27], v[48:51], v[84:99]
    v_mfma_f32_32x32x16_bf16 v[32:47], v[48:51], a[168:171], v[32:47]
    v_mfma_f32_32x32x16_bf16 v[84:99], a[28:31], v[48:51], v[84:99]
    v_mfma_f32_32x32x16_bf16 v[32:47], v[48:51], a[172:175], v[32:47]
    v_mfma_f32_32x32x16_bf16 v[84:99], a[32:35], v[48:51], v[84:99]
    v_mfma_f32_32x32x16_bf16 v[32:47], v[48:51], a[176:179], v[32:47]
    v_mfma_f32_32x32x16_bf16 v[84:99], a[36:39], v[48:51], v[84:99]
    v_mfma_f32_32x32x16_bf16 v[32:47], v[48:51], a[180:183], v[32:47]
    v_mfma_f32_32x32x16_bf16 v[84:99], a[40:43], v[48:51], v[84:99]
    v_mfma_f32_32x32x16_bf16 v[32:47], v[48:51], a[184:187], v[32:47]
    v_mfma_f32_32x32x16_bf16 v[84:99], a[44:47], v[48:51], v[84:99]
    v_mfma_f32_32x32x16_bf16 v[32:47], v[48:51], a[188:191], v[32:47]
    v_mfma_f32_32x32x16_bf16 v[84:99], a[48:51], v[48:51], v[84:99]
    v_mfma_f32_32x32x16_bf16 v[32:47], v[48:51], a[192:195], v[32:47]
    v_mfma_f32_32x32x16_bf16 v[84:99], a[52:55], v[48:51], v[84:99]
    v_mfma_f32_32x32x16_bf16 v[32:47], v[48:51], a[196:199], v[32:47]
    v_mfma_f32_32x32x16_bf16 v[84:99], a[56:59], v[48:51], v[84:99]
    v_mfma_f32_32x32x16_bf16 v[32:47], v[48:51], a[200:203], v[32:47]
    v_mfma_f32_32x32x16_bf16 v[84:99], a[60:63], v[48:51], v[84:99]
    v_mfma_f32_32x32x16_bf16 v[32:47], v[48:51], a[204:207], v[32:47]
    v_mfma_f32_32x32x16_bf16 v[84:99], a[64:67], v[48:51], v[84:99]
    v_mfma_f32_32x32x16_bf16 v[32:47], v[48:51], a[208:211], v[32:47]
    v_mfma_f32_32x32x16_bf16 v[84:99], a[68:71], v[48:51], v[84:99]
    v_mfma_f32_32x32x16_bf16 v[32:47], v[48:51], a[212:215], v[32:47]
    v_mfma_f32_32x32x16_bf16 v[84:99], a[72:75], v[48:51], v[84:99]
    v_mfma_f32_32x32x16_bf16 v[32:47], v[48:51], a[216:219], v[32:47]
    v_mfma_f32_32x32x16_bf16 v[84:99], a[76:79], v[48:51], v[84:99]
    v_mfma_f32_32x32x16_bf16 v[32:47], v[48:51], a[220:223], v[32:47]
    v_mfma_f32_32x32x16_bf16 v[84:99], a[80:83], v[48:51], v[84:99]
    v_mfma_f32_32x32x16_bf16 v[32:47], v[48:51], a[224:227], v[32:47]
    v_mfma_f32_32x32x16_bf16 v[84:99], a[84:87], v[48:51], v[84:99]
    v_mfma_f32_32x32x16_bf16 v[32:47], v[48:51], a[228:231], v[32:47]
    v_mfma_f32_32x32x16_bf16 v[84:99], a[88:91], v[48:51], v[84:99]
    v_mfma_f32_32x32x16_bf16 v[32:47], v[48:51], a[232:235], v[32:47]
    v_mfma_f32_32x32x16_bf16 v[84:99], a[92:95], v[48:51], v[84:99]
    v_mfma_f32_32x32x16_bf16 v[32:47], v[48:51], a[236:239], v[32:47]
    v_mfma_f32_32x32x16_bf16 v[84:99], a[96:99], v[48:51], v[84:99]
    v_mfma_f32_32x32x16_bf16 v[32:47], v[48:51], a[240:243], v[32:47]
    v_mfma_f32_32x32x16_bf16 v[84:99], a[100:103], v[48:51], v[84:99]
    v_mfma_f32_32x32x16_bf16 v[32:47], v[48:51], a[244:247], v[32:47]
    v_mfma_f32_32x32x16_bf16 v[84:99], a[104:107], v[48:51], v[84:99]
    v_mfma_f32_32x32x16_bf16 v[32:47], v[48:51], a[248:251], v[32:47]
    v_mfma_f32_32x32x16_bf16 v[84:99], a[108:111], v[48:51], v[84:99]
    v_mfma_f32_32x32x16_bf16 v[32:47], v[48:51], a[252:255], v[32:47]
    v_mfma_f32_32x32x16_bf16 v[84:99], a[112:115], v[48:51], v[84:99]
    v_mfma_f32_32x32x16_bf16 v[32:47], v[48:51], v[152:155], v[32:47]
    v_mfma_f32_32x32x16_bf16 v[84:99], a[116:119], v[48:51], v[84:99]
    v_mfma_f32_32x32x16_bf16 v[32:47], v[48:51], v[156:159], v[32:47]
    v_mfma_f32_32x32x16_bf16 v[84:99], a[120:123], v[48:51], v[84:99]
    v_mfma_f32_32x32x16_bf16 v[32:47], v[48:51], v[160:163], v[32:47]
    v_mfma_f32_32x32x16_bf16 v[84:99], a[124:127], v[48:51], v[84:99]
    v_mfma_f32_32x32x16_bf16 v[32:47], v[48:51], v[164:167], v[32:47]
    v_mfma_f32_32x32x16_bf16 v[84:99], a[128:131], v[48:51], v[84:99]
    v_mfma_f32_32x32x16_bf16 v[32:47], v[48:51], v[168:171], v[32:47]
    v_mfma_f32_32x32x16_bf16 v[84:99], a[132:135], v[48:51], v[84:99]
    v_mfma_f32_32x32x16_bf16 v[32:47], v[48:51], v[172:175], v[32:47]
    v_mfma_f32_32x32x16_bf16 v[84:99], a[136:139], v[48:51], v[84:99]
    v_mfma_f32_32x32x16_bf16 v[32:47], v[48:51], v[176:179], v[32:47]
    v_mfma_f32_32x32x16_bf16 v[84:99], a[140:143], v[48:51], v[84:99]
    v_mfma_f32_32x32x16_bf16 v[32:47], v[48:51], v[180:183], v[32:47]
    s_nop 11
    v_mov_b32 v11, v32
    s_mov_b32 s66, 114688
    s_mov_b32 s71, 0x2000
    s_mov_b32 s36, s63
    s_mov_b32 s34, s63
    s_mul_i32 s58, s14, 9216
    s_mul_i32 s64, s63, 4718592
    s_add_u32 s64, s64, s58
    s_add_u32 s64, s64, 8650752
    s_mul_i32 s61, s63, 1441792
    s_add_u32 s61, s61, 3584
    s_mov_b32 s37, 0
    s_mov_b32 s40, 36864
    s_mov_b32 s59, s58
    s_mov_b32 s43, 0
    s_mov_b32 s62, 1
    s_mov_b32 s28, s8
    s_mov_b32 s29, s9
    s_mov_b32 s30, 0
    s_mov_b32 s31, 0x00020000
    v_mov_b32 v184, 74752
    v_mov_b32 v5, -1
    ds_write_b32 v184, v5
    s_waitcnt lgkmcnt(0)
    s_cmp_lg_u32 s14, 0
    s_cbranch_scc1 LpKV_inia_d
    v_mov_b32 v5, 40
    s_mov_b32 s16, 0
LpKV_inia:
    global_load_dword v6, v5, s[12:13] sc1
    s_add_u32 s16, s16, 1
    s_cmp_gt_u32 s16, 100000
    s_cbranch_scc1 L_role_p_abort
    s_waitcnt vmcnt(0)
    v_cmp_gt_u32 vcc, 128, v6
    s_nop 0
    s_cbranch_vccz LpKV_inia_d
    s_sleep 8
    s_branch LpKV_inia
LpKV_inia_d:
    s_barrier
    s_cmp_eq_u32 s63, 0
    s_cbranch_scc1 LpKV_ini_sk
    s_cmp_lg_u32 s14, 0
    s_cbranch_scc1 LpKV_inib_d
    v_mov_b32 v5, 160
    s_mov_b32 s16, 0
LpKV_inib:
    global_load_dword v6, v5, s[12:13] sc1
    s_add_u32 s16, s16, 1
    s_cmp_gt_u32 s16, 100000
    s_cbranch_scc1 L_role_p_abort
    s_waitcnt vmcnt(0)
    v_cmp_gt_u32 vcc, 64, v6
    s_nop 0
    s_cbranch_vccz LpKV_inib_d
    s_sleep 8
    s_branch LpKV_inib
LpKV_inib_d:
    s_barrier
LpKV_ini_sk:
    s_mul_i32 s41, s37, 36864
    s_add_u32 s41, s41, s64
    s_mul_i32 s60, s37, 22528
    s_add_u32 s60, s60, s61
    s_cmp_lt_u32 s37, 64
    s_cselect_b32 s60, s60, 2883584
    s_branch LpKV_wait
LpKV_head:
    s_waitcnt vmcnt(4)
LpKV_head2:
    s_barrier
    ds_read_b32 v15, v184
    s_xor_b32 s40, s40, 36864
    s_xor_b32 s59, s59, 36864
    s_mov_b32 s35, s37
    s_lshl_b32 s57, s34, 6
    s_add_u32 s57, s57, s35
    s_add_u32 s37, s37, 1
    s_mov_b32 s39, 0
    s_mov_b32 s54, 0
    s_xor_b32 s66, s66, 8192
    s_xor_b32 s71, s71, 8192
    s_mul_i32 s41, s37, 36864
    s_add_u32 s41, s41, s64
    s_mul_i32 s60, s37, 22528
    s_add_u32 s60, s60, s61
    s_cmp_lt_u32 s37, 64
    s_cselect_b32 s60, s60, 2883584
    v_add_u32 v9, s40, v0
    v_add_u32 v5, s71, v10
    ds_read_b128 v[48:51], v9 offset:0
    ds_read_b128 v[52:55], v9 offset:1024
    ds_read_b128 v[56:59], v9 offset:2048
    ds_read_b128 v[64:67], v5 offset:0
    ds_read_b128 v[68:71], v5 offset:512
    ds_read_b128 v[72:75], v5 offset:1024
    ds_read_b128 v[76:79], v5 offset:1536
    ds_read_b128 v[80:83], v5 offset:2048
    s_waitcnt lgkmcnt(7)
    v_mfma_f32_32x32x16_bf16 v[16:31], a[0:3], v[48:51], 0
    ds_read_b128 v[60:63], v9 offset:3072
    v_mfma_f32_32x32x16_bf16 v[32:47], v[48:51], a[144:147], 0
    s_waitcnt lgkmcnt(4)
    v_add_f32 v64, v64, v68
    v_add_f32 v65, v65, v69
    v_add_f32 v66, v66, v70
    v_add_f32 v67, v67, v71
    v_mfma_f32_32x32x16_bf16 v[16:31], a[4:7], v[52:55], v[16:31]
    ds_read_b128 v[48:51], v9 offset:4096
    s_waitcnt lgkmcnt(4)
    v_add_f32 v64, v64, v72
    v_add_f32 v65, v65, v73
    v_add_f32 v66, v66, v74
    v_mfma_f32_32x32x16_bf16 v[32:47], v[52:55], a[148:151], v[32:47]
    v_add_f32 v67, v67, v75
    s_waitcnt lgkmcnt(3)
    v_add_f32 v64, v64, v76
    v_add_f32 v65, v65, v77
    v_add_f32 v66, v66, v78
    v_readfirstlane_b32 s17, v15
    s_nop 0
    s_add_u32 s18, s17, 1
    s_max_i32 s32, s18, s37
    s_add_u32 s39, s37, 1
    s_min_u32 s39, s39, 63
    s_mul_i32 s33, s32, 22528
    s_add_u32 s33, s33, s61
    s_cmp_eq_u32 s14, 0
    s_cselect_b32 s18, s32, 0x7fff
    v_mov_b32 v2, 2
    s_cmp_le_u32 s18, s39
    s_cselect_b64 exec, -1, 0
    buffer_load_dword v2, v1, s[8:11], s33 offen sc1
    s_mov_b64 exec, -1
    s_cmp_ge_i32 s17, s37
    s_cbranch_scc1 LpKV_f_3
    v_mfma_f32_32x32x16_bf16 v[16:31], a[8:11], v[56:59], v[16:31]
    ds_read_b128 v[52:55], v9 offset:5120
    v_add_f32 v67, v67, v79
    s_waitcnt lgkmcnt(3)
    v_add_f32 v64, v64, v80
    v_add_f32 v65, v65, v81
    v_mfma_f32_32x32x16_bf16 v[32:47], v[56:59], a[152:155], v[32:47]
    v_add_f32 v66, v66, v82
    v_add_f32 v67, v67, v83
    v_add_f32 v64, v64, v66
    v_add_f32 v65, v65, v67
    s_waitcnt lgkmcnt(2)
    v_mfma_f32_32x32x16_bf16 v[16:31], a[12:15], v[60:63], v[16:31]
    ds_read_b128 v[56:59], v9 offset:6144
    v_mov_b32 v66, v64
    v_mov_b32 v67, v65
    s_nop 0
    v_permlane32_swap_b32 v64, v66
    v_mfma_f32_32x32x16_bf16 v[32:47], v[60:63], a[156:159], v[32:47]
    v_permlane32_swap_b32 v65, v67
    v_add_f32 v64, v64, v66
    v_add_f32 v65, v65, v67
    v_mul_f32 v64, 0x3ae38e39, v64
    s_waitcnt lgkmcnt(2)
    v_mfma_f32_32x32x16_bf16 v[16:31], a[16:19], v[48:51], v[16:31]
    ds_read_b128 v[60:63], v9 offset:7168
    v_mul_f32 v65, 0x3ae38e39, v65
    v_fma_f32 v65, -v64, v64, v65
    v_max_f32 v65, 0, v65
    v_mfma_f32_32x32x16_bf16 v[32:47], v[48:51], a[160:163], v[32:47]
    v_add_f32 v65, 0x3727c5ac, v65
    v_rsq_f32 v148, v65
    s_nop 0
    v_mul_f32 v149, v64, v148
    v_mul_f32 v100, v149, v84
    s_waitcnt lgkmcnt(2)
    v_mfma_f32_32x32x16_bf16 v[16:31], a[20:23], v[52:55], v[16:31]
    ds_read_b128 v[48:51], v9 offset:8192
    v_mul_f32 v101, v149, v85
    v_mul_f32 v102, v149, v86
    v_mul_f32 v103, v149, v87
    v_mfma_f32_32x32x16_bf16 v[32:47], v[52:55], a[164:167], v[32:47]
    v_mul_f32 v104, v149, v88
    v_mul_f32 v105, v149, v89
    v_mul_f32 v106, v149, v90
    v_mul_f32 v107, v149, v91
    s_waitcnt lgkmcnt(2)
    v_mfma_f32_32x32x16_bf16 v[16:31], a[24:27], v[56:59], v[16:31]
    ds_read_b128 v[52:55], v9 offset:9216
    v_mul_f32 v108, v149, v92
    v_mul_f32 v109, v149, v93
    v_mul_f32 v110, v149, v94
    v_mfma_f32_32x32x16_bf16 v[32:47], v[56:59], a[168:171], v[32:47]
    v_mul_f32 v111, v149, v95
    v_mul_f32 v112, v149, v96
    v_mul_f32 v113, v149, v97
    v_mul_f32 v114, v149, v98
    s_waitcnt lgkmcnt(2)
    v_mfma_f32_32x32x16_bf16 v[16:31], a[28:31], v[60:63], v[16:31]
    ds_read_b128 v[56:59], v9 offset:10240
    v_mul_f32 v115, v149, v99
    ds_write2_b32 v12, v148, v149 offset0:0 offset1:32
    ds_read_b128 v[116:119], v13 offset:0
    v_mfma_f32_32x32x16_bf16 v[32:47], v[60:63], a[172:175], v[32:47]
    ds_read_b128 v[120:123], v13 offset:32
    ds_read_b128 v[124:127], v13 offset:64
    ds_read_b128 v[128:131], v13 offset:96
    ds_read_b128 v[132:135], v13 offset:128
    s_waitcnt lgkmcnt(8)
    v_mfma_f32_32x32x16_bf16 v[16:31], a[32:35], v[48:51], v[16:31]
    ds_read_b128 v[60:63], v9 offset:11264
    ds_read_b128 v[136:139], v13 offset:160
    ds_read_b128 v[140:143], v13 offset:192
    ds_read_b128 v[144:147], v13 offset:224
    v_mfma_f32_32x32x16_bf16 v[32:47], v[48:51], a[176:179], v[32:47]
    s_waitcnt lgkmcnt(11)
    v_mfma_f32_32x32x16_bf16 v[16:31], a[36:39], v[52:55], v[16:31]
    ds_read_b128 v[48:51], v9 offset:12288
    v_mfma_f32_32x32x16_bf16 v[32:47], v[52:55], a[180:183], v[32:47]
    s_waitcnt lgkmcnt(5)
    v_mul_f32 v132, v11, v132
    v_mul_f32 v133, v11, v133
    v_mfma_f32_32x32x16_bf16 v[16:31], a[40:43], v[56:59], v[16:31]
    ds_read_b128 v[52:55], v9 offset:13312
    v_mul_f32 v134, v11, v134
    v_mul_f32 v135, v11, v135
    s_waitcnt lgkmcnt(4)
    v_mul_f32 v136, v11, v136
    v_mfma_f32_32x32x16_bf16 v[32:47], v[56:59], a[184:187], v[32:47]
    v_mul_f32 v137, v11, v137
    v_mul_f32 v138, v11, v138
    v_mul_f32 v139, v11, v139
    s_waitcnt lgkmcnt(3)
    v_mul_f32 v140, v11, v140
    v_mfma_f32_32x32x16_bf16 v[16:31], a[44:47], v[60:63], v[16:31]
    ds_read_b128 v[56:59], v9 offset:14336
    v_mul_f32 v141, v11, v141
    v_mul_f32 v142, v11, v142
    v_mul_f32 v143, v11, v143
    v_mfma_f32_32x32x16_bf16 v[32:47], v[60:63], a[188:191], v[32:47]
    s_waitcnt lgkmcnt(3)
    v_mul_f32 v144, v11, v144
    v_mul_f32 v145, v11, v145
    v_mul_f32 v146, v11, v146
    v_mul_f32 v147, v11, v147
    s_waitcnt lgkmcnt(2)
    v_mfma_f32_32x32x16_bf16 v[16:31], a[48:51], v[48:51], v[16:31]
    ds_read_b128 v[60:63], v9 offset:15360
    s_mul_i32 s46, s34, 50331648
    s_lshl_b32 s51, s35, 18
    s_add_u32 s46, s46, s51
    v_mfma_f32_32x32x16_bf16 v[32:47], v[48:51], a[192:195], v[32:47]
    s_add_u32 s46, s46, s52
    s_waitcnt vmcnt(1)
    s_cmp_lg_u32 s43, 0
    s_cselect_b64 exec, 3, 0
    buffer_store_dword v3, v185, s[8:11], s43 offen sc1
    s_mov_b64 exec, -1
    s_mov_b32 s43, 0
    s_waitcnt lgkmcnt(2)
    v_mfma_f32_32x32x16_bf16 v[16:31], a[52:55], v[52:55], v[16:31]
    ds_read_b128 v[48:51], v9 offset:16384
    v_mfma_f32_32x32x16_bf16 v[32:47], v[52:55], a[196:199], v[32:47]
    s_waitcnt lgkmcnt(2)
    v_mfma_f32_32x32x16_bf16 v[16:31], a[56:59], v[56:59], v[16:31]
    v_cmp_eq_u32 s[76:77], 1, v2
    v_cmp_eq_u32 vcc, 2, v2
    s_cmp_eq_u64 s[76:77], -1
    s_cselect_b32 s38, 1, 0
    ds_read_b128 v[52:55], v9 offset:17408
    v_mfma_f32_32x32x16_bf16 v[32:47], v[56:59], a[200:203], v[32:47]
    s_cmp_lg_u32 s38, 0
    s_cselect_b64 exec, 1, 0
    v_mov_b32 v15, s32
    ds_write_b32 v184, v15
    v_mov_b32 v2, 2
    s_mov_b64 exec, -1
    s_waitcnt lgkmcnt(3)
    v_mfma_f32_32x32x16_bf16 v[16:31], a[60:63], v[60:63], v[16:31]
    s_add_u32 s32, s32, s38
    s_mul_i32 s38, s38, 22528
    s_add_u32 s33, s33, s38
    ds_read_b128 v[56:59], v9 offset:18432
    v_mfma_f32_32x32x16_bf16 v[32:47], v[60:63], a[204:207], v[32:47]
    s_cmp_eq_u64 vcc, 0
    s_cselect_b32 s38, s32, 0x7fff
    s_waitcnt lgkmcnt(3)
    v_mfma_f32_32x32x16_bf16 v[16:31], a[64:67], v[48:51], v[16:31]
    ds_read_b128 v[60:63], v9 offset:19456
    v_mfma_f32_32x32x16_bf16 v[32:47], v[48:51], a[208:211], v[32:47]
    s_cmp_le_u32 s38, s39
    s_cselect_b64 exec, -1, 0
    v_mov_b32 v2, 2
    buffer_load_dword v2, v1, s[8:11], s33 offen sc1
    s_mov_b64 exec, -1
    ds_read_b32 v15, v184
    s_waitcnt lgkmcnt(4)
    v_mfma_f32_32x32x16_bf16 v[16:31], a[68:71], v[52:55], v[16:31]
    ds_read_b128 v[48:51], v9 offset:20480
    v_mfma_f32_32x32x16_bf16 v[32:47], v[52:55], a[212:215], v[32:47]
    s_waitcnt lgkmcnt(3)
    v_mfma_f32_32x32x16_bf16 v[16:31], a[72:75], v[56:59], v[16:31]
    ds_read_b128 v[52:55], v9 offset:21504
    v_mfma_f32_32x32x16_bf16 v[32:47], v[56:59], a[216:219], v[32:47]
    s_waitcnt lgkmcnt(2)
    v_readfirstlane_b32 s17, v15
    s_nop 0
    s_cmp_ge_i32 s17, s37
    s_cbranch_scc1 LpKV_f_4
    v_mfma_f32_32x32x16_bf16 v[16:31], a[76:79], v[60:63], v[16:31]
    ds_read_b128 v[56:59], v9 offset:22528
    v_mfma_f32_32x32x16_bf16 v[32:47], v[60:63], a[220:223], v[32:47]
    s_waitcnt lgkmcnt(2)
    v_mfma_f32_32x32x16_bf16 v[16:31], a[80:83], v[48:51], v[16:31]
    ds_read_b128 v[60:63], v9 offset:23552
    v_mfma_f32_32x32x16_bf16 v[32:47], v[48:51], a[224:227], v[32:47]
    s_waitcnt lgkmcnt(2)
    v_mfma_f32_32x32x16_bf16 v[16:31], a[84:87], v[52:55], v[16:31]
    ds_read_b128 v[48:51], v9 offset:24576
    v_mfma_f32_32x32x16_bf16 v[32:47], v[52:55], a[228:231], v[32:47]
    s_waitcnt lgkmcnt(2)
    v_mfma_f32_32x32x16_bf16 v[16:31], a[88:91], v[56:59], v[16:31]
    ds_read_b128 v[52:55], v9 offset:25600
    v_mfma_f32_32x32x16_bf16 v[32:47], v[56:59], a[232:235], v[32:47]
    s_waitcnt lgkmcnt(2)
    v_mfma_f32_32x32x16_bf16 v[16:31], a[92:95], v[60:63], v[16:31]
    ds_read_b128 v[56:59], v9 offset:26624
    v_mfma_f32_32x32x16_bf16 v[32:47], v[60:63], a[236:239], v[32:47]
    s_waitcnt lgkmcnt(2)
    v_mfma_f32_32x32x16_bf16 v[16:31], a[96:99], v[48:51], v[16:31]
    ds_read_b128 v[60:63], v9 offset:27648
    v_mfma_f32_32x32x16_bf16 v[32:47], v[48:51], a[240:243], v[32:47]
    s_waitcnt lgkmcnt(2)
    v_mfma_f32_32x32x16_bf16 v[16:31], a[100:103], v[52:55], v[16:31]
    ds_read_b128 v[48:51], v9 offset:28672
    v_mfma_f32_32x32x16_bf16 v[32:47], v[52:55], a[244:247], v[32:47]
    s_waitcnt lgkmcnt(2)
    v_mfma_f32_32x32x16_bf16 v[16:31], a[104:107], v[56:59], v[16:31]
    ds_read_b128 v[52:55], v9 offset:29696
    v_mfma_f32_32x32x16_bf16 v[32:47], v[56:59], a[248:251], v[32:47]
    s_waitcnt lgkmcnt(2)
    v_mfma_f32_32x32x16_bf16 v[16:31], a[108:111], v[60:63], v[16:31]
    ds_read_b128 v[56:59], v9 offset:30720
    v_mfma_f32_32x32x16_bf16 v[32:47], v[60:63], a[252:255], v[32:47]
    s_waitcnt lgkmcnt(2)
    v_mfma_f32_32x32x16_bf16 v[16:31], a[112:115], v[48:51], v[16:31]
    ds_read_b128 v[60:63], v9 offset:31744
    v_mfma_f32_32x32x16_bf16 v[32:47], v[48:51], v[152:155], v[32:47]
    s_waitcnt lgkmcnt(2)
    v_mfma_f32_32x32x16_bf16 v[16:31], a[116:119], v[52:55], v[16:31]
    ds_read_b128 v[48:51], v9 offset:32768
    v_mfma_f32_32x32x16_bf16 v[32:47], v[52:55], v[156:159], v[32:47]
    s_waitcnt lgkmcnt(2)
    v_mfma_f32_32x32x16_bf16 v[16:31], a[120:123], v[56:59], v[16:31]
    ds_read_b128 v[52:55], v9 offset:33792
    v_mfma_f32_32x32x16_bf16 v[32:47], v[56:59], v[160:163], v[32:47]
    s_waitcnt lgkmcnt(2)
    v_mfma_f32_32x32x16_bf16 v[16:31], a[124:127], v[60:63], v[16:31]
    v_cmp_eq_u32 s[76:77], 1, v2
    v_cmp_eq_u32 vcc, 2, v2
    s_cmp_eq_u64 s[76:77], -1
    s_cselect_b32 s38, 1, 0
    ds_read_b128 v[56:59], v9 offset:34816
    v_mfma_f32_32x32x16_bf16 v[32:47], v[60:63], v[164:167], v[32:47]
    s_cmp_lg_u32 s38, 0
    s_cselect_b64 exec, 1, 0
    v_mov_b32 v15, s32
    ds_write_b32 v184, v15
    v_mov_b32 v2, 2
    s_mov_b64 exec, -1
    s_waitcnt lgkmcnt(3)
    v_mfma_f32_32x32x16_bf16 v[16:31], a[128:131], v[48:51], v[16:31]
    s_add_u32 s32, s32, s38
    s_mul_i32 s38, s38, 22528
    s_add_u32 s33, s33, s38
    ds_read_b128 v[60:63], v9 offset:35840
    v_mfma_f32_32x32x16_bf16 v[32:47], v[48:51], v[168:171], v[32:47]
    s_cmp_eq_u64 vcc, 0
    s_cselect_b32 s38, s32, 0x7fff
    s_waitcnt lgkmcnt(3)
    v_mfma_f32_32x32x16_bf16 v[16:31], a[132:135], v[52:55], v[16:31]
    s_cmp_le_u32 s38, s39
    s_cselect_b64 exec, -1, 0
    v_mov_b32 v2, 2
    buffer_load_dword v2, v1, s[8:11], s33 offen sc1
    s_mov_b64 exec, -1
    v_mfma_f32_32x32x16_bf16 v[32:47], v[52:55], v[172:175], v[32:47]
    s_waitcnt lgkmcnt(2)
    v_mfma_f32_32x32x16_bf16 v[16:31], a[136:139], v[56:59], v[16:31]
    v_mfma_f32_32x32x16_bf16 v[32:47], v[56:59], v[176:179], v[32:47]
    s_waitcnt lgkmcnt(0)
    v_mfma_f32_32x32x16_bf16 v[16:31], a[140:143], v[60:63], v[16:31]
    v_mfma_f32_32x32x16_bf16 v[32:47], v[60:63], v[180:183], v[32:47]
    s_add_u32 s51, s46, 16777216
    s_nop 2
    v_pk_fma_f32 v[16:17], v[16:17], v[148:149], v[100:101] op_sel_hi:[1,0,1] neg_lo:[0,0,1] neg_hi:[0,0,1]
    v_pk_fma_f32 v[18:19], v[18:19], v[148:149], v[102:103] op_sel_hi:[1,0,1] neg_lo:[0,0,1] neg_hi:[0,0,1]
    v_pk_fma_f32 v[20:21], v[20:21], v[148:149], v[104:105] op_sel_hi:[1,0,1] neg_lo:[0,0,1] neg_hi:[0,0,1]
    v_pk_fma_f32 v[22:23], v[22:23], v[148:149], v[106:107] op_sel_hi:[1,0,1] neg_lo:[0,0,1] neg_hi:[0,0,1]
    v_pk_fma_f32 v[24:25], v[24:25], v[148:149], v[108:109] op_sel_hi:[1,0,1] neg_lo:[0,0,1] neg_hi:[0,0,1]
    v_pk_fma_f32 v[26:27], v[26:27], v[148:149], v[110:111] op_sel_hi:[1,0,1] neg_lo:[0,0,1] neg_hi:[0,0,1]
    v_pk_fma_f32 v[28:29], v[28:29], v[148:149], v[112:113] op_sel_hi:[1,0,1] neg_lo:[0,0,1] neg_hi:[0,0,1]
    v_pk_fma_f32 v[30:31], v[30:31], v[148:149], v[114:115] op_sel_hi:[1,0,1] neg_lo:[0,0,1] neg_hi:[0,0,1]
    v_cvt_pk_bf16_f32 v188, v16, v24
    v_cvt_pk_bf16_f32 v189, v17, v25
    v_cvt_pk_bf16_f32 v190, v18, v26
    v_cvt_pk_bf16_f32 v191, v19, v27
    buffer_store_dwordx4 v[188:191], v14, s[8:11], s46 offen offset:0 sc1
    v_cvt_pk_bf16_f32 v192, v20, v28
    v_cvt_pk_bf16_f32 v193, v21, v29
    v_cvt_pk_bf16_f32 v194, v22, v30
    v_cvt_pk_bf16_f32 v195, v23, v31
    buffer_store_dwordx4 v[192:195], v14, s[8:11], s46 offen offset:512 sc1
    v_pk_fma_f32 v[32:33], v[32:33], v[116:117], v[132:133] neg_lo:[0,0,1] neg_hi:[0,0,1]
    v_pk_fma_f32 v[34:35], v[34:35], v[118:119], v[134:135] neg_lo:[0,0,1] neg_hi:[0,0,1]
    v_pk_fma_f32 v[36:37], v[36:37], v[120:121], v[136:137] neg_lo:[0,0,1] neg_hi:[0,0,1]
    v_pk_fma_f32 v[38:39], v[38:39], v[122:123], v[138:139] neg_lo:[0,0,1] neg_hi:[0,0,1]
    v_pk_fma_f32 v[40:41], v[40:41], v[124:125], v[140:141] neg_lo:[0,0,1] neg_hi:[0,0,1]
    v_pk_fma_f32 v[42:43], v[42:43], v[126:127], v[142:143] neg_lo:[0,0,1] neg_hi:[0,0,1]
    v_pk_fma_f32 v[44:45], v[44:45], v[128:129], v[144:145] neg_lo:[0,0,1] neg_hi:[0,0,1]
    v_pk_fma_f32 v[46:47], v[46:47], v[130:131], v[146:147] neg_lo:[0,0,1] neg_hi:[0,0,1]
    v_cvt_pk_bf16_f32 v196, v32, v33
    v_cvt_pk_bf16_f32 v197, v34, v35
    v_cvt_pk_bf16_f32 v198, v40, v41
    v_cvt_pk_bf16_f32 v199, v42, v43
    buffer_store_dwordx4 v[196:199], v14, s[8:11], s51 offen offset:0 sc1
    v_cvt_pk_bf16_f32 v200, v36, v37
    v_cvt_pk_bf16_f32 v201, v38, v39
    v_cvt_pk_bf16_f32 v202, v44, v45
    v_cvt_pk_bf16_f32 v203, v46, v47
    buffer_store_dwordx4 v[200:203], v14, s[8:11], s51 offen offset:512 sc1
    s_mul_i32 s43, s57, 22528
    s_add_u32 s43, s43, s49
    s_branch LpKV_none
LpKV_f_3:
    v_mfma_f32_32x32x16_bf16 v[16:31], a[8:11], v[56:59], v[16:31]
    ds_read_b128 v[52:55], v9 offset:5120
    v_add_f32 v67, v67, v79
    s_waitcnt lgkmcnt(3)
    v_add_f32 v64, v64, v80
    v_add_f32 v65, v65, v81
    v_mfma_f32_32x32x16_bf16 v[32:47], v[56:59], a[152:155], v[32:47]
    v_add_f32 v66, v66, v82
    v_add_f32 v67, v67, v83
    v_add_f32 v64, v64, v66
    v_add_f32 v65, v65, v67
    s_waitcnt lgkmcnt(2)
    v_mfma_f32_32x32x16_bf16 v[16:31], a[12:15], v[60:63], v[16:31]
    ds_read_b128 v[56:59], v9 offset:6144
    v_mov_b32 v66, v64
    v_mov_b32 v67, v65
    s_nop 0
    v_permlane32_swap_b32 v64, v66
    v_mfma_f32_32x32x16_bf16 v[32:47], v[60:63], a[156:159], v[32:47]
    v_permlane32_swap_b32 v65, v67
    v_add_f32 v64, v64, v66
    v_add_f32 v65, v65, v67
    v_mul_f32 v64, 0x3ae38e39, v64
    s_waitcnt lgkmcnt(2)
    v_mfma_f32_32x32x16_bf16 v[16:31], a[16:19], v[48:51], v[16:31]
    ds_read_b128 v[60:63], v9 offset:7168
    v_mul_f32 v65, 0x3ae38e39, v65
    v_fma_f32 v65, -v64, v64, v65
    v_max_f32 v65, 0, v65
    v_mfma_f32_32x32x16_bf16 v[32:47], v[48:51], a[160:163], v[32:47]
    v_add_f32 v65, 0x3727c5ac, v65
    v_rsq_f32 v148, v65
    s_nop 0
    v_mul_f32 v149, v64, v148
    v_mul_f32 v100, v149, v84
    s_waitcnt lgkmcnt(2)
    v_mfma_f32_32x32x16_bf16 v[16:31], a[20:23], v[52:55], v[16:31]
    ds_read_b128 v[48:51], v9 offset:8192
    v_mul_f32 v101, v149, v85
    v_mul_f32 v102, v149, v86
    v_mul_f32 v103, v149, v87
    v_mfma_f32_32x32x16_bf16 v[32:47], v[52:55], a[164:167], v[32:47]
    v_mul_f32 v104, v149, v88
    v_mul_f32 v105, v149, v89
    v_mul_f32 v106, v149, v90
    v_mul_f32 v107, v149, v91
    s_waitcnt lgkmcnt(2)
    v_mfma_f32_32x32x16_bf16 v[16:31], a[24:27], v[56:59], v[16:31]
    ds_read_b128 v[52:55], v9 offset:9216
    v_mul_f32 v108, v149, v92
    v_mul_f32 v109, v149, v93
    v_mul_f32 v110, v149, v94
    v_mfma_f32_32x32x16_bf16 v[32:47], v[56:59], a[168:171], v[32:47]
    v_mul_f32 v111, v149, v95
    v_mul_f32 v112, v149, v96
    v_mul_f32 v113, v149, v97
    v_mul_f32 v114, v149, v98
    s_waitcnt lgkmcnt(2)
    v_mfma_f32_32x32x16_bf16 v[16:31], a[28:31], v[60:63], v[16:31]
    ds_read_b128 v[56:59], v9 offset:10240
    v_mul_f32 v115, v149, v99
    ds_write2_b32 v12, v148, v149 offset0:0 offset1:32
    ds_read_b128 v[116:119], v13 offset:0
    v_mfma_f32_32x32x16_bf16 v[32:47], v[60:63], a[172:175], v[32:47]
    ds_read_b128 v[120:123], v13 offset:32
    ds_read_b128 v[124:127], v13 offset:64
    ds_read_b128 v[128:131], v13 offset:96
    ds_read_b128 v[132:135], v13 offset:128
    s_waitcnt lgkmcnt(8)
    v_mfma_f32_32x32x16_bf16 v[16:31], a[32:35], v[48:51], v[16:31]
    ds_read_b128 v[60:63], v9 offset:11264
    ds_read_b128 v[136:139], v13 offset:160
    ds_read_b128 v[140:143], v13 offset:192
    ds_read_b128 v[144:147], v13 offset:224
    v_mfma_f32_32x32x16_bf16 v[32:47], v[48:51], a[176:179], v[32:47]
    s_add_u32 m0, s59, 0
    s_add_u32 s47, s41, 0
    buffer_load_dwordx4 v0, s[8:11], s47 offen offset:0 lds
    buffer_load_dwordx4 v0, s[8:11], s47 offen offset:1024 lds
    buffer_load_dwordx4 v0, s[8:11], s47 offen offset:2048 lds
    s_waitcnt lgkmcnt(11)
    v_mfma_f32_32x32x16_bf16 v[16:31], a[36:39], v[52:55], v[16:31]
    buffer_load_dwordx4 v0, s[8:11], s47 offen offset:3072 lds
    s_add_u32 m0, s59, 4096
    s_add_u32 s47, s41, 4096
    buffer_load_dwordx4 v0, s[8:11], s47 offen offset:0 lds
    ds_read_b128 v[48:51], v9 offset:12288
    v_mfma_f32_32x32x16_bf16 v[32:47], v[52:55], a[180:183], v[32:47]
    buffer_load_dwordx4 v0, s[8:11], s47 offen offset:1024 lds
    buffer_load_dwordx4 v0, s[8:11], s47 offen offset:2048 lds
    buffer_load_dwordx4 v0, s[8:11], s47 offen offset:3072 lds
    s_waitcnt lgkmcnt(5)
    v_mul_f32 v132, v11, v132
    v_mul_f32 v133, v11, v133
    v_mfma_f32_32x32x16_bf16 v[16:31], a[40:43], v[56:59], v[16:31]
    ds_read_b128 v[52:55], v9 offset:13312
    v_mul_f32 v134, v11, v134
    v_mul_f32 v135, v11, v135
    s_waitcnt lgkmcnt(4)
    v_mul_f32 v136, v11, v136
    v_mfma_f32_32x32x16_bf16 v[32:47], v[56:59], a[184:187], v[32:47]
    v_mul_f32 v137, v11, v137
    v_mul_f32 v138, v11, v138
    v_mul_f32 v139, v11, v139
    s_waitcnt lgkmcnt(3)
    v_mul_f32 v140, v11, v140
    v_mfma_f32_32x32x16_bf16 v[16:31], a[44:47], v[60:63], v[16:31]
    ds_read_b128 v[56:59], v9 offset:14336
    v_mul_f32 v141, v11, v141
    v_mul_f32 v142, v11, v142
    v_mul_f32 v143, v11, v143
    v_mfma_f32_32x32x16_bf16 v[32:47], v[60:63], a[188:191], v[32:47]
    s_waitcnt lgkmcnt(3)
    v_mul_f32 v144, v11, v144
    v_mul_f32 v145, v11, v145
    v_mul_f32 v146, v11, v146
    v_mul_f32 v147, v11, v147
    s_waitcnt lgkmcnt(2)
    v_mfma_f32_32x32x16_bf16 v[16:31], a[48:51], v[48:51], v[16:31]
    ds_read_b128 v[60:63], v9 offset:15360
    s_mul_i32 s46, s34, 50331648
    s_lshl_b32 s51, s35, 18
    s_add_u32 s46, s46, s51
    v_mfma_f32_32x32x16_bf16 v[32:47], v[48:51], a[192:195], v[32:47]
    s_add_u32 m0, s59, 8192
    s_add_u32 s47, s41, 8192
    buffer_load_dwordx4 v0, s[8:11], s47 offen offset:0 lds
    s_add_u32 s46, s46, s52
    s_waitcnt vmcnt(10)
    s_cmp_lg_u32 s43, 0
    s_cselect_b64 exec, 3, 0
    buffer_store_dword v3, v185, s[8:11], s43 offen sc1
    s_mov_b64 exec, -1
    s_mov_b32 s43, 0
    s_waitcnt lgkmcnt(2)
    v_mfma_f32_32x32x16_bf16 v[16:31], a[52:55], v[52:55], v[16:31]
    s_mul_i32 s48, s36, 786432
    s_mul_i32 s18, s37, 6144
    s_add_u32 s48, s48, s18
    s_add_u32 s48, s48, 16125952
    s_add_u32 m0, s66, 4096
    s_nop 0
    buffer_load_dwordx4 v0, s[8:11], s48 offen lds
    ds_read_b128 v[48:51], v9 offset:16384
    v_mfma_f32_32x32x16_bf16 v[32:47], v[52:55], a[196:199], v[32:47]
    s_add_u32 m0, s66, s67
    s_sub_u32 s48, s48, 4096
    s_add_u32 s48, s48, s67
    buffer_load_dwordx4 v0, s[8:11], s48 offen lds
    s_waitcnt lgkmcnt(2)
    v_mfma_f32_32x32x16_bf16 v[16:31], a[56:59], v[56:59], v[16:31]
    v_cmp_eq_u32 s[76:77], 1, v2
    v_cmp_eq_u32 vcc, 2, v2
    s_cmp_eq_u64 s[76:77], -1
    s_cselect_b32 s38, 1, 0
    ds_read_b128 v[52:55], v9 offset:17408
    v_mfma_f32_32x32x16_bf16 v[32:47], v[56:59], a[200:203], v[32:47]
    s_cmp_lg_u32 s38, 0
    s_cselect_b64 exec, 1, 0
    v_mov_b32 v15, s32
    ds_write_b32 v184, v15
    v_mov_b32 v2, 2
    s_mov_b64 exec, -1
    s_waitcnt lgkmcnt(3)
    v_mfma_f32_32x32x16_bf16 v[16:31], a[60:63], v[60:63], v[16:31]
    s_add_u32 s32, s32, s38
    s_mul_i32 s38, s38, 22528
    s_add_u32 s33, s33, s38
    ds_read_b128 v[56:59], v9 offset:18432
    v_mfma_f32_32x32x16_bf16 v[32:47], v[60:63], a[204:207], v[32:47]
    s_cmp_eq_u64 vcc, 0
    s_cselect_b32 s38, s32, 0x7fff
    s_waitcnt lgkmcnt(3)
    v_mfma_f32_32x32x16_bf16 v[16:31], a[64:67], v[48:51], v[16:31]
    ds_read_b128 v[60:63], v9 offset:19456
    v_mfma_f32_32x32x16_bf16 v[32:47], v[48:51], a[208:211], v[32:47]
    s_cmp_le_u32 s38, s39
    s_cselect_b64 exec, -1, 0
    v_mov_b32 v2, 2
    buffer_load_dword v2, v1, s[8:11], s33 offen sc1
    s_mov_b64 exec, -1
    s_waitcnt lgkmcnt(3)
    v_mfma_f32_32x32x16_bf16 v[16:31], a[68:71], v[52:55], v[16:31]
    ds_read_b128 v[48:51], v9 offset:20480
    v_mfma_f32_32x32x16_bf16 v[32:47], v[52:55], a[212:215], v[32:47]
    s_waitcnt lgkmcnt(2)
    v_mfma_f32_32x32x16_bf16 v[16:31], a[72:75], v[56:59], v[16:31]
    ds_read_b128 v[52:55], v9 offset:21504
    v_mfma_f32_32x32x16_bf16 v[32:47], v[56:59], a[216:219], v[32:47]
    s_waitcnt lgkmcnt(2)
    v_mfma_f32_32x32x16_bf16 v[16:31], a[76:79], v[60:63], v[16:31]
    ds_read_b128 v[56:59], v9 offset:22528
    v_mfma_f32_32x32x16_bf16 v[32:47], v[60:63], a[220:223], v[32:47]
    s_waitcnt lgkmcnt(2)
    v_mfma_f32_32x32x16_bf16 v[16:31], a[80:83], v[48:51], v[16:31]
    ds_read_b128 v[60:63], v9 offset:23552
    v_mfma_f32_32x32x16_bf16 v[32:47], v[48:51], a[224:227], v[32:47]
    s_waitcnt lgkmcnt(2)
    v_mfma_f32_32x32x16_bf16 v[16:31], a[84:87], v[52:55], v[16:31]
    ds_read_b128 v[48:51], v9 offset:24576
    v_mfma_f32_32x32x16_bf16 v[32:47], v[52:55], a[228:231], v[32:47]
    s_waitcnt lgkmcnt(2)
    v_mfma_f32_32x32x16_bf16 v[16:31], a[88:91], v[56:59], v[16:31]
    ds_read_b128 v[52:55], v9 offset:25600
    v_mfma_f32_32x32x16_bf16 v[32:47], v[56:59], a[232:235], v[32:47]
    s_waitcnt lgkmcnt(2)
    v_mfma_f32_32x32x16_bf16 v[16:31], a[92:95], v[60:63], v[16:31]
    ds_read_b128 v[56:59], v9 offset:26624
    v_mfma_f32_32x32x16_bf16 v[32:47], v[60:63], a[236:239], v[32:47]
    s_waitcnt lgkmcnt(2)
    v_mfma_f32_32x32x16_bf16 v[16:31], a[96:99], v[48:51], v[16:31]
    ds_read_b128 v[60:63], v9 offset:27648
    v_mfma_f32_32x32x16_bf16 v[32:47], v[48:51], a[240:243], v[32:47]
    s_waitcnt lgkmcnt(2)
    v_mfma_f32_32x32x16_bf16 v[16:31], a[100:103], v[52:55], v[16:31]
    ds_read_b128 v[48:51], v9 offset:28672
    v_mfma_f32_32x32x16_bf16 v[32:47], v[52:55], a[244:247], v[32:47]
    s_waitcnt lgkmcnt(2)
    v_mfma_f32_32x32x16_bf16 v[16:31], a[104:107], v[56:59], v[16:31]
    ds_read_b128 v[52:55], v9 offset:29696
    v_mfma_f32_32x32x16_bf16 v[32:47], v[56:59], a[248:251], v[32:47]
    s_waitcnt lgkmcnt(2)
    v_mfma_f32_32x32x16_bf16 v[16:31], a[108:111], v[60:63], v[16:31]
    ds_read_b128 v[56:59], v9 offset:30720
    v_mfma_f32_32x32x16_bf16 v[32:47], v[60:63], a[252:255], v[32:47]
    s_waitcnt lgkmcnt(2)
    v_mfma_f32_32x32x16_bf16 v[16:31], a[112:115], v[48:51], v[16:31]
    ds_read_b128 v[60:63], v9 offset:31744
    v_mfma_f32_32x32x16_bf16 v[32:47], v[48:51], v[152:155], v[32:47]
    s_waitcnt lgkmcnt(2)
    v_mfma_f32_32x32x16_bf16 v[16:31], a[116:119], v[52:55], v[16:31]
    ds_read_b128 v[48:51], v9 offset:32768
    v_mfma_f32_32x32x16_bf16 v[32:47], v[52:55], v[156:159], v[32:47]
    s_waitcnt lgkmcnt(2)
    v_mfma_f32_32x32x16_bf16 v[16:31], a[120:123], v[56:59], v[16:31]
    ds_read_b128 v[52:55], v9 offset:33792
    v_mfma_f32_32x32x16_bf16 v[32:47], v[56:59], v[160:163], v[32:47]
    s_waitcnt lgkmcnt(2)
    v_mfma_f32_32x32x16_bf16 v[16:31], a[124:127], v[60:63], v[16:31]
    v_cmp_eq_u32 s[76:77], 1, v2
    v_cmp_eq_u32 vcc, 2, v2
    s_cmp_eq_u64 s[76:77], -1
    s_cselect_b32 s38, 1, 0
    ds_read_b128 v[56:59], v9 offset:34816
    v_mfma_f32_32x32x16_bf16 v[32:47], v[60:63], v[164:167], v[32:47]
    s_cmp_lg_u32 s38, 0
    s_cselect_b64 exec, 1, 0
    v_mov_b32 v15, s32
    ds_write_b32 v184, v15
    v_mov_b32 v2, 2
    s_mov_b64 exec, -1
    s_waitcnt lgkmcnt(3)
    v_mfma_f32_32x32x16_bf16 v[16:31], a[128:131], v[48:51], v[16:31]
    s_add_u32 s32, s32, s38
    s_mul_i32 s38, s38, 22528
    s_add_u32 s33, s33, s38
    ds_read_b128 v[60:63], v9 offset:35840
    v_mfma_f32_32x32x16_bf16 v[32:47], v[48:51], v[168:171], v[32:47]
    s_cmp_eq_u64 vcc, 0
    s_cselect_b32 s38, s32, 0x7fff
    s_waitcnt lgkmcnt(3)
    v_mfma_f32_32x32x16_bf16 v[16:31], a[132:135], v[52:55], v[16:31]
    s_cmp_le_u32 s38, s39
    s_cselect_b64 exec, -1, 0
    v_mov_b32 v2, 2
    buffer_load_dword v2, v1, s[8:11], s33 offen sc1
    s_mov_b64 exec, -1
    v_mfma_f32_32x32x16_bf16 v[32:47], v[52:55], v[172:175], v[32:47]
    s_waitcnt lgkmcnt(2)
    v_mfma_f32_32x32x16_bf16 v[16:31], a[136:139], v[56:59], v[16:31]
    v_mfma_f32_32x32x16_bf16 v[32:47], v[56:59], v[176:179], v[32:47]
    s_waitcnt lgkmcnt(0)
    v_mfma_f32_32x32x16_bf16 v[16:31], a[140:143], v[60:63], v[16:31]
    v_mfma_f32_32x32x16_bf16 v[32:47], v[60:63], v[180:183], v[32:47]
    s_add_u32 s51, s46, 16777216
    s_nop 2
    v_pk_fma_f32 v[16:17], v[16:17], v[148:149], v[100:101] op_sel_hi:[1,0,1] neg_lo:[0,0,1] neg_hi:[0,0,1]
    v_pk_fma_f32 v[18:19], v[18:19], v[148:149], v[102:103] op_sel_hi:[1,0,1] neg_lo:[0,0,1] neg_hi:[0,0,1]
    v_pk_fma_f32 v[20:21], v[20:21], v[148:149], v[104:105] op_sel_hi:[1,0,1] neg_lo:[0,0,1] neg_hi:[0,0,1]
    v_pk_fma_f32 v[22:23], v[22:23], v[148:149], v[106:107] op_sel_hi:[1,0,1] neg_lo:[0,0,1] neg_hi:[0,0,1]
    v_pk_fma_f32 v[24:25], v[24:25], v[148:149], v[108:109] op_sel_hi:[1,0,1] neg_lo:[0,0,1] neg_hi:[0,0,1]
    v_pk_fma_f32 v[26:27], v[26:27], v[148:149], v[110:111] op_sel_hi:[1,0,1] neg_lo:[0,0,1] neg_hi:[0,0,1]
    v_pk_fma_f32 v[28:29], v[28:29], v[148:149], v[112:113] op_sel_hi:[1,0,1] neg_lo:[0,0,1] neg_hi:[0,0,1]
    v_pk_fma_f32 v[30:31], v[30:31], v[148:149], v[114:115] op_sel_hi:[1,0,1] neg_lo:[0,0,1] neg_hi:[0,0,1]
    v_cvt_pk_bf16_f32 v188, v16, v24
    v_cvt_pk_bf16_f32 v189, v17, v25
    v_cvt_pk_bf16_f32 v190, v18, v26
    v_cvt_pk_bf16_f32 v191, v19, v27
    buffer_store_dwordx4 v[188:191], v14, s[8:11], s46 offen offset:0 sc1
    v_cvt_pk_bf16_f32 v192, v20, v28
    v_cvt_pk_bf16_f32 v193, v21, v29
    v_cvt_pk_bf16_f32 v194, v22, v30
    v_cvt_pk_bf16_f32 v195, v23, v31
    buffer_store_dwordx4 v[192:195], v14, s[8:11], s46 offen offset:512 sc1
    v_pk_fma_f32 v[32:33], v[32:33], v[116:117], v[132:133] neg_lo:[0,0,1] neg_hi:[0,0,1]
    v_pk_fma_f32 v[34:35], v[34:35], v[118:119], v[134:135] neg_lo:[0,0,1] neg_hi:[0,0,1]
    v_pk_fma_f32 v[36:37], v[36:37], v[120:121], v[136:137] neg_lo:[0,0,1] neg_hi:[0,0,1]
    v_pk_fma_f32 v[38:39], v[38:39], v[122:123], v[138:139] neg_lo:[0,0,1] neg_hi:[0,0,1]
    v_pk_fma_f32 v[40:41], v[40:41], v[124:125], v[140:141] neg_lo:[0,0,1] neg_hi:[0,0,1]
    v_pk_fma_f32 v[42:43], v[42:43], v[126:127], v[142:143] neg_lo:[0,0,1] neg_hi:[0,0,1]
    v_pk_fma_f32 v[44:45], v[44:45], v[128:129], v[144:145] neg_lo:[0,0,1] neg_hi:[0,0,1]
    v_pk_fma_f32 v[46:47], v[46:47], v[130:131], v[146:147] neg_lo:[0,0,1] neg_hi:[0,0,1]
    v_cvt_pk_bf16_f32 v196, v32, v33
    v_cvt_pk_bf16_f32 v197, v34, v35
    v_cvt_pk_bf16_f32 v198, v40, v41
    v_cvt_pk_bf16_f32 v199, v42, v43
    buffer_store_dwordx4 v[196:199], v14, s[8:11], s51 offen offset:0 sc1
    v_cvt_pk_bf16_f32 v200, v36, v37
    v_cvt_pk_bf16_f32 v201, v38, v39
    v_cvt_pk_bf16_f32 v202, v44, v45
    v_cvt_pk_bf16_f32 v203, v46, v47
    buffer_store_dwordx4 v[200:203], v14, s[8:11], s51 offen offset:512 sc1
    s_mul_i32 s43, s57, 22528
    s_add_u32 s43, s43, s49
    s_branch LpKV_head
LpKV_f_4:
    v_mfma_f32_32x32x16_bf16 v[16:31], a[76:79], v[60:63], v[16:31]
    s_add_u32 m0, s59, 0
    s_add_u32 s47, s41, 0
    buffer_load_dwordx4 v0, s[8:11], s47 offen offset:0 lds
    ds_read_b128 v[56:59], v9 offset:22528
    v_mfma_f32_32x32x16_bf16 v[32:47], v[60:63], a[220:223], v[32:47]
    s_waitcnt lgkmcnt(2)
    v_mfma_f32_32x32x16_bf16 v[16:31], a[80:83], v[48:51], v[16:31]
    buffer_load_dwordx4 v0, s[8:11], s47 offen offset:1024 lds
    ds_read_b128 v[60:63], v9 offset:23552
    v_mfma_f32_32x32x16_bf16 v[32:47], v[48:51], a[224:227], v[32:47]
    s_waitcnt lgkmcnt(2)
    v_mfma_f32_32x32x16_bf16 v[16:31], a[84:87], v[52:55], v[16:31]
    buffer_load_dwordx4 v0, s[8:11], s47 offen offset:2048 lds
    ds_read_b128 v[48:51], v9 offset:24576
    v_mfma_f32_32x32x16_bf16 v[32:47], v[52:55], a[228:231], v[32:47]
    s_waitcnt lgkmcnt(2)
    v_mfma_f32_32x32x16_bf16 v[16:31], a[88:91], v[56:59], v[16:31]
    buffer_load_dwordx4 v0, s[8:11], s47 offen offset:3072 lds
    ds_read_b128 v[52:55], v9 offset:25600
    v_mfma_f32_32x32x16_bf16 v[32:47], v[56:59], a[232:235], v[32:47]
    s_waitcnt lgkmcnt(2)
    v_mfma_f32_32x32x16_bf16 v[16:31], a[92:95], v[60:63], v[16:31]
    s_add_u32 m0, s59, 4096
    s_add_u32 s47, s41, 4096
    buffer_load_dwordx4 v0, s[8:11], s47 offen offset:0 lds
    ds_read_b128 v[56:59], v9 offset:26624
    v_mfma_f32_32x32x16_bf16 v[32:47], v[60:63], a[236:239], v[32:47]
    s_waitcnt lgkmcnt(2)
    v_mfma_f32_32x32x16_bf16 v[16:31], a[96:99], v[48:51], v[16:31]
    buffer_load_dwordx4 v0, s[8:11], s47 offen offset:1024 lds
    ds_read_b128 v[60:63], v9 offset:27648
    v_mfma_f32_32x32x16_bf16 v[32:47], v[48:51], a[240:243], v[32:47]
    s_waitcnt lgkmcnt(2)
    v_mfma_f32_32x32x16_bf16 v[16:31], a[100:103], v[52:55], v[16:31]
    buffer_load_dwordx4 v0, s[8:11], s47 offen offset:2048 lds
    ds_read_b128 v[48:51], v9 offset:28672
    v_mfma_f32_32x32x16_bf16 v[32:47], v[52:55], a[244:247], v[32:47]
    s_waitcnt lgkmcnt(2)
    v_mfma_f32_32x32x16_bf16 v[16:31], a[104:107], v[56:59], v[16:31]
    buffer_load_dwordx4 v0, s[8:11], s47 offen offset:3072 lds
    ds_read_b128 v[52:55], v9 offset:29696
    v_mfma_f32_32x32x16_bf16 v[32:47], v[56:59], a[248:251], v[32:47]
    s_waitcnt lgkmcnt(2)
    v_mfma_f32_32x32x16_bf16 v[16:31], a[108:111], v[60:63], v[16:31]
    s_add_u32 m0, s59, 8192
    s_add_u32 s47, s41, 8192
    buffer_load_dwordx4 v0, s[8:11], s47 offen offset:0 lds
    ds_read_b128 v[56:59], v9 offset:30720
    v_mfma_f32_32x32x16_bf16 v[32:47], v[60:63], a[252:255], v[32:47]
    s_waitcnt lgkmcnt(2)
    v_mfma_f32_32x32x16_bf16 v[16:31], a[112:115], v[48:51], v[16:31]
    s_mul_i32 s48, s36, 786432
    s_mul_i32 s18, s37, 6144
    s_add_u32 s48, s48, s18
    s_add_u32 s48, s48, 16125952
    s_add_u32 m0, s66, 4096
    s_nop 0
    buffer_load_dwordx4 v0, s[8:11], s48 offen lds
    ds_read_b128 v[60:63], v9 offset:31744
    v_mfma_f32_32x32x16_bf16 v[32:47], v[48:51], v[152:155], v[32:47]
    s_waitcnt lgkmcnt(2)
    v_mfma_f32_32x32x16_bf16 v[16:31], a[116:119], v[52:55], v[16:31]
    s_add_u32 m0, s66, s67
    s_sub_u32 s48, s48, 4096
    s_add_u32 s48, s48, s67
    buffer_load_dwordx4 v0, s[8:11], s48 offen lds
    ds_read_b128 v[48:51], v9 offset:32768
    v_mfma_f32_32x32x16_bf16 v[32:47], v[52:55], v[156:159], v[32:47]
    s_waitcnt lgkmcnt(2)
    v_mfma_f32_32x32x16_bf16 v[16:31], a[120:123], v[56:59], v[16:31]
    ds_read_b128 v[52:55], v9 offset:33792
    v_mfma_f32_32x32x16_bf16 v[32:47], v[56:59], v[160:163], v[32:47]
    s_waitcnt lgkmcnt(2)
    v_mfma_f32_32x32x16_bf16 v[16:31], a[124:127], v[60:63], v[16:31]
    v_cmp_eq_u32 s[76:77], 1, v2
    v_cmp_eq_u32 vcc, 2, v2
    s_cmp_eq_u64 s[76:77], -1
    s_cselect_b32 s38, 1, 0
    ds_read_b128 v[56:59], v9 offset:34816
    v_mfma_f32_32x32x16_bf16 v[32:47], v[60:63], v[164:167], v[32:47]
    s_cmp_lg_u32 s38, 0
    s_cselect_b64 exec, 1, 0
    v_mov_b32 v15, s32
    ds_write_b32 v184, v15
    v_mov_b32 v2, 2
    s_mov_b64 exec, -1
    s_waitcnt lgkmcnt(3)
    v_mfma_f32_32x32x16_bf16 v[16:31], a[128:131], v[48:51], v[16:31]
    s_add_u32 s32, s32, s38
    s_mul_i32 s38, s38, 22528
    s_add_u32 s33, s33, s38
    ds_read_b128 v[60:63], v9 offset:35840
    v_mfma_f32_32x32x16_bf16 v[32:47], v[48:51], v[168:171], v[32:47]
    s_cmp_eq_u64 vcc, 0
    s_cselect_b32 s38, s32, 0x7fff
    s_waitcnt lgkmcnt(3)
    v_mfma_f32_32x32x16_bf16 v[16:31], a[132:135], v[52:55], v[16:31]
    s_cmp_le_u32 s38, s39
    s_cselect_b64 exec, -1, 0
    v_mov_b32 v2, 2
    buffer_load_dword v2, v1, s[8:11], s33 offen sc1
    s_mov_b64 exec, -1
    v_mfma_f32_32x32x16_bf16 v[32:47], v[52:55], v[172:175], v[32:47]
    s_waitcnt lgkmcnt(2)
    v_mfma_f32_32x32x16_bf16 v[16:31], a[136:139], v[56:59], v[16:31]
    v_mfma_f32_32x32x16_bf16 v[32:47], v[56:59], v[176:179], v[32:47]
    s_waitcnt lgkmcnt(0)
    v_mfma_f32_32x32x16_bf16 v[16:31], a[140:143], v[60:63], v[16:31]
    v_mfma_f32_32x32x16_bf16 v[32:47], v[60:63], v[180:183], v[32:47]
    s_add_u32 s51, s46, 16777216
    s_nop 2
    v_pk_fma_f32 v[16:17], v[16:17], v[148:149], v[100:101] op_sel_hi:[1,0,1] neg_lo:[0,0,1] neg_hi:[0,0,1]
    v_pk_fma_f32 v[18:19], v[18:19], v[148:149], v[102:103] op_sel_hi:[1,0,1] neg_lo:[0,0,1] neg_hi:[0,0,1]
    v_pk_fma_f32 v[20:21], v[20:21], v[148:149], v[104:105] op_sel_hi:[1,0,1] neg_lo:[0,0,1] neg_hi:[0,0,1]
    v_pk_fma_f32 v[22:23], v[22:23], v[148:149], v[106:107] op_sel_hi:[1,0,1] neg_lo:[0,0,1] neg_hi:[0,0,1]
    v_pk_fma_f32 v[24:25], v[24:25], v[148:149], v[108:109] op_sel_hi:[1,0,1] neg_lo:[0,0,1] neg_hi:[0,0,1]
    v_pk_fma_f32 v[26:27], v[26:27], v[148:149], v[110:111] op_sel_hi:[1,0,1] neg_lo:[0,0,1] neg_hi:[0,0,1]
    v_pk_fma_f32 v[28:29], v[28:29], v[148:149], v[112:113] op_sel_hi:[1,0,1] neg_lo:[0,0,1] neg_hi:[0,0,1]
    v_pk_fma_f32 v[30:31], v[30:31], v[148:149], v[114:115] op_sel_hi:[1,0,1] neg_lo:[0,0,1] neg_hi:[0,0,1]
    v_cvt_pk_bf16_f32 v188, v16, v24
    v_cvt_pk_bf16_f32 v189, v17, v25
    v_cvt_pk_bf16_f32 v190, v18, v26
    v_cvt_pk_bf16_f32 v191, v19, v27
    buffer_store_dwordx4 v[188:191], v14, s[8:11], s46 offen offset:0 sc1
    v_cvt_pk_bf16_f32 v192, v20, v28
    v_cvt_pk_bf16_f32 v193, v21, v29
    v_cvt_pk_bf16_f32 v194, v22, v30
    v_cvt_pk_bf16_f32 v195, v23, v31
    buffer_store_dwordx4 v[192:195], v14, s[8:11], s46 offen offset:512 sc1
    v_pk_fma_f32 v[32:33], v[32:33], v[116:117], v[132:133] neg_lo:[0,0,1] neg_hi:[0,0,1]
    v_pk_fma_f32 v[34:35], v[34:35], v[118:119], v[134:135] neg_lo:[0,0,1] neg_hi:[0,0,1]
    v_pk_fma_f32 v[36:37], v[36:37], v[120:121], v[136:137] neg_lo:[0,0,1] neg_hi:[0,0,1]
    v_pk_fma_f32 v[38:39], v[38:39], v[122:123], v[138:139] neg_lo:[0,0,1] neg_hi:[0,0,1]
    v_pk_fma_f32 v[40:41], v[40:41], v[124:125], v[140:141] neg_lo:[0,0,1] neg_hi:[0,0,1]
    v_pk_fma_f32 v[42:43], v[42:43], v[126:127], v[142:143] neg_lo:[0,0,1] neg_hi:[0,0,1]
    v_pk_fma_f32 v[44:45], v[44:45], v[128:129], v[144:145] neg_lo:[0,0,1] neg_hi:[0,0,1]
    v_pk_fma_f32 v[46:47], v[46:47], v[130:131], v[146:147] neg_lo:[0,0,1] neg_hi:[0,0,1]
    v_cvt_pk_bf16_f32 v196, v32, v33
    v_cvt_pk_bf16_f32 v197, v34, v35
    v_cvt_pk_bf16_f32 v198, v40, v41
    v_cvt_pk_bf16_f32 v199, v42, v43
    buffer_store_dwordx4 v[196:199], v14, s[8:11], s51 offen offset:0 sc1
    v_cvt_pk_bf16_f32 v200, v36, v37
    v_cvt_pk_bf16_f32 v201, v38, v39
    v_cvt_pk_bf16_f32 v202, v44, v45
    v_cvt_pk_bf16_f32 v203, v46, v47
    buffer_store_dwordx4 v[200:203], v14, s[8:11], s51 offen offset:512 sc1
    s_mul_i32 s43, s57, 22528
    s_add_u32 s43, s43, s49
    s_branch LpKV_head
LpKV_none:
    ds_read_b32 v15, v184
    s_waitcnt lgkmcnt(0)
    v_readfirstlane_b32 s17, v15
    s_nop 0
    s_cmp_lt_i32 s17, s37
    s_cbranch_scc1 LpKV_nopost
    s_add_u32 m0, s59, 0
    s_add_u32 s47, s41, 0
    buffer_load_dwordx4 v0, s[8:11], s47 offen offset:0 lds
    buffer_load_dwordx4 v0, s[8:11], s47 offen offset:1024 lds
    buffer_load_dwordx4 v0, s[8:11], s47 offen offset:2048 lds
    buffer_load_dwordx4 v0, s[8:11], s47 offen offset:3072 lds
    s_add_u32 m0, s59, 4096
    s_add_u32 s47, s41, 4096
    buffer_load_dwordx4 v0, s[8:11], s47 offen offset:0 lds
    buffer_load_dwordx4 v0, s[8:11], s47 offen offset:1024 lds
    buffer_load_dwordx4 v0, s[8:11], s47 offen offset:2048 lds
    buffer_load_dwordx4 v0, s[8:11], s47 offen offset:3072 lds
    s_add_u32 m0, s59, 8192
    s_add_u32 s47, s41, 8192
    buffer_load_dwordx4 v0, s[8:11], s47 offen offset:0 lds
    s_mul_i32 s48, s36, 786432
    s_mul_i32 s18, s37, 6144
    s_add_u32 s48, s48, s18
    s_add_u32 s48, s48, 16125952
    s_add_u32 m0, s66, 4096
    s_nop 0
    buffer_load_dwordx4 v0, s[8:11], s48 offen lds
    s_add_u32 m0, s66, s67
    s_sub_u32 s48, s48, 4096
    s_add_u32 s48, s48, s67
    buffer_load_dwordx4 v0, s[8:11], s48 offen lds
    s_waitcnt vmcnt(11)
    s_cmp_lg_u32 s43, 0
    s_cselect_b64 exec, 3, 0
    buffer_store_dword v3, v185, s[8:11], s43 offen sc1
    s_mov_b64 exec, -1
    s_mov_b32 s43, 0
    s_waitcnt vmcnt(1) lgkmcnt(0)
    s_branch LpKV_head2
LpKV_nopost:
    s_waitcnt vmcnt(0)
    s_cmp_lg_u32 s43, 0
    s_cselect_b64 exec, 3, 0
    buffer_store_dword v3, v185, s[8:11], s43 offen sc1
    s_mov_b64 exec, -1
    s_mov_b32 s43, 0
    s_cmp_ge_u32 s37, 64
    s_cbranch_scc1 LpKV_end
LpKV_wait:
    s_mov_b32 s16, 0
    s_cmp_lg_u32 s14, 0
    s_cbranch_scc1 LpKV_wl
LpKV_wp:
    buffer_load_dword v2, v1, s[8:11], s60 offen sc1
    s_add_u32 s16, s16, 1
    s_cmp_gt_u32 s16, 100000
    s_cbranch_scc1 LpKV_giveup
    s_waitcnt vmcnt(0)
    v_cmp_eq_u32 vcc, 0, v2
    s_nop 0
    s_cbranch_vccz LpKV_wok
    s_sleep 4
    s_branch LpKV_wp
LpKV_giveup:
    v_mov_b32 v5, -2
    ds_write_b32 v184, v5
    s_waitcnt lgkmcnt(0)
    s_branch L_role_p_abort
LpKV_wok:
    v_mov_b32 v5, s37
    ds_write_b32 v184, v5
    s_branch LpKV_go
LpKV_wl:
    ds_read_b32 v15, v184
    s_add_u32 s16, s16, 1
    s_cmp_gt_u32 s16, 1600000
    s_cbranch_scc1 L_role_p_abort
    s_waitcnt lgkmcnt(0)
    v_readfirstlane_b32 s17, v15
    s_nop 0
    s_cmp_eq_u32 s17, -2
    s_cbranch_scc1 L_role_p_abort
    s_cmp_ge_i32 s17, s37
    s_cbranch_scc1 LpKV_go
    s_sleep 1
    s_branch LpKV_wl
LpKV_go:
    s_add_u32 m0, s59, 0
    s_add_u32 s47, s41, 0
    buffer_load_dwordx4 v0, s[8:11], s47 offen offset:0 lds
    buffer_load_dwordx4 v0, s[8:11], s47 offen offset:1024 lds
    buffer_load_dwordx4 v0, s[8:11], s47 offen offset:2048 lds
    buffer_load_dwordx4 v0, s[8:11], s47 offen offset:3072 lds
    s_add_u32 m0, s59, 4096
    s_add_u32 s47, s41, 4096
    buffer_load_dwordx4 v0, s[8:11], s47 offen offset:0 lds
    buffer_load_dwordx4 v0, s[8:11], s47 offen offset:1024 lds
    buffer_load_dwordx4 v0, s[8:11], s47 offen offset:2048 lds
    buffer_load_dwordx4 v0, s[8:11], s47 offen offset:3072 lds
    s_add_u32 m0, s59, 8192
    s_add_u32 s47, s41, 8192
    buffer_load_dwordx4 v0, s[8:11], s47 offen offset:0 lds
    s_mul_i32 s48, s36, 786432
    s_mul_i32 s18, s37, 6144
    s_add_u32 s48, s48, s18
    s_add_u32 s48, s48, 16125952
    s_add_u32 m0, s66, 4096
    s_nop 0
    buffer_load_dwordx4 v0, s[8:11], s48 offen lds
    s_add_u32 m0, s66, s67
    s_sub_u32 s48, s48, 4096
    s_add_u32 s48, s48, s67
    buffer_load_dwordx4 v0, s[8:11], s48 offen lds
    s_waitcnt vmcnt(0) lgkmcnt(0)
    s_branch LpKV_head2
LpKV_end:
    s_branch L_role_p_exit
L_role_p_abort:
    s_waitcnt lgkmcnt(0)
    s_mov_b64 exec, -1
    v_mov_b32 v0, 60
    s_lshl_b32 s5, s3, 8
    s_or_b32 s5, s5, s4
    s_or_b32 s5, s5, 0x10000
    v_mov_b32 v1, s5
    global_store_dword v0, v1, s[12:13]
    s_endpgm
L_role_p_exit:
    s_endpgm
.p2align 6
L_role_awo:
    v_and_b32 v5, 63, v0
    v_lshlrev_b32 v0, 4, v5
    v_and_b32 v7, 15, v5
    v_lshrrev_b32 v8, 4, v5
    v_min_u32 v1, 63, v5
    v_lshrrev_b32 v6, 2, v1
    v_and_b32 v1, 3, v1
    v_lshlrev_b32 v1, 2, v1
    v_lshl_add_u32 v1, v6, 7, v1
    v_mov_b32 v3, 1
    v_mov_b32 v4, 0
    s_mov_b32 s44, 0x05040100
    s_mov_b32 s45, 0x07060302
    s_load_dwordx2 s[20:21], s[0:1], 16
    s_mov_b32 s22, 663552
    s_mov_b32 s23, 0x00020000
    s_waitcnt lgkmcnt(0)
    s_and_b32 s21, s21, 0xffff
    s_cmp_ge_u32 s15, 3
    s_cselect_b32 s63, 1, 0
    s_cselect_b32 s17, 3, 0
    s_sub_u32 s15, s15, s17
    s_lshl_b32 s50, s15, 2
    s_add_u32 s50, s50, s14
    s_cmp_eq_u32 s63, 0
    s_cbranch_scc1 Lao_gate_ng
    s_cmp_lg_u32 s14, 0
    s_cbranch_scc1 Lao_gate_d
    v_mov_b32 v5, 48
    s_mov_b32 s16, 0
Lao_gate:
    global_load_dword v6, v5, s[12:13] sc1
    s_add_u32 s16, s16, 1
    s_cmp_gt_u32 s16, 100000
    s_cbranch_scc1 L_role_awo_abort
    s_waitcnt vmcnt(0)
    v_cmp_gt_u32 vcc, 32, v6
    s_nop 0
    s_cbranch_vccz Lao_gate_d
    s_sleep 100
    s_branch Lao_gate
Lao_gate_d:
    s_barrier
Lao_gate_ng:
    v_lshrrev_b32 v5, 7, v0
    v_and_b32 v6, 0x70, v0
    v_mul_u32_u24 v16, 1152, v5
    v_add_u32 v16, v16, v6
    v_lshrrev_b32 v17, 1, v5
    v_mul_u32_u24 v17, 18, v17
    v_and_b32 v5, 1, v5
    v_add_u32 v17, v17, v5
    v_add_u32 v17, 16, v17
    v_mul_u32_u24 v17, 1152, v17
    v_add_u32 v17, v17, v6
    v_lshrrev_b32 v5, 2, v7
    v_lshl_add_u32 v5, v8, 3, v5
    v_lshlrev_b32 v18, 7, v5
    v_and_b32 v5, 3, v7
    v_lshl_add_u32 v19, v5, 3, v18
    v_lshl_add_u32 v18, v5, 4, v18
    s_lshl_b32 s46, s14, 15
    v_add_u32 v18, s46, v18
    v_add_u32 v19, s46, v19
    s_mul_i32 s49, s50, 96
    s_add_u32 m0, s46, 0
    s_add_u32 s17, s49, 0
    buffer_load_dwordx4 v16, s[20:23], s17 offen lds
    s_add_u32 m0, s46, 1024
    s_add_u32 s17, s49, 9216
    buffer_load_dwordx4 v16, s[20:23], s17 offen lds
    s_add_u32 m0, s46, 2048
    s_add_u32 s17, s49, 20736
    buffer_load_dwordx4 v16, s[20:23], s17 offen lds
    s_add_u32 m0, s46, 3072
    s_add_u32 s17, s49, 29952
    buffer_load_dwordx4 v16, s[20:23], s17 offen lds
    s_add_u32 m0, s46, 4096
    s_add_u32 s17, s49, 41472
    buffer_load_dwordx4 v16, s[20:23], s17 offen lds
    s_add_u32 m0, s46, 5120
    s_add_u32 s17, s49, 50688
    buffer_load_dwordx4 v16, s[20:23], s17 offen lds
    s_add_u32 m0, s46, 6144
    s_add_u32 s17, s49, 62208
    buffer_load_dwordx4 v16, s[20:23], s17 offen lds
    s_add_u32 m0, s46, 7168
    s_add_u32 s17, s49, 71424
    buffer_load_dwordx4 v16, s[20:23], s17 offen lds
    s_add_u32 m0, s46, 8192
    s_add_u32 s17, s49, 82944
    buffer_load_dwordx4 v16, s[20:23], s17 offen lds
    s_add_u32 m0, s46, 9216
    s_add_u32 s17, s49, 92160
    buffer_load_dwordx4 v16, s[20:23], s17 offen lds
    s_add_u32 m0, s46, 10240
    s_add_u32 s17, s49, 103680
    buffer_load_dwordx4 v16, s[20:23], s17 offen lds
    s_add_u32 m0, s46, 11264
    s_add_u32 s17, s49, 112896
    buffer_load_dwordx4 v16, s[20:23], s17 offen lds
    s_add_u32 m0, s46, 12288
    s_add_u32 s17, s49, 124416
    buffer_load_dwordx4 v16, s[20:23], s17 offen lds
    s_add_u32 m0, s46, 13312
    s_add_u32 s17, s49, 133632
    buffer_load_dwordx4 v16, s[20:23], s17 offen lds
    s_add_u32 m0, s46, 14336
    s_add_u32 s17, s49, 145152
    buffer_load_dwordx4 v16, s[20:23], s17 offen lds
    s_add_u32 m0, s46, 15360
    s_add_u32 s17, s49, 154368
    buffer_load_dwordx4 v16, s[20:23], s17 offen lds
    s_add_u32 m0, s46, 16384
    s_add_u32 s17, s49, 165888
    buffer_load_dwordx4 v16, s[20:23], s17 offen lds
    s_add_u32 m0, s46, 17408
    s_add_u32 s17, s49, 175104
    buffer_load_dwordx4 v16, s[20:23], s17 offen lds
    s_add_u32 m0, s46, 18432
    s_add_u32 s17, s49, 186624
    buffer_load_dwordx4 v16, s[20:23], s17 offen lds
    s_add_u32 m0, s46, 19456
    s_add_u32 s17, s49, 195840
    buffer_load_dwordx4 v16, s[20:23], s17 offen lds
    s_add_u32 m0, s46, 20480
    s_add_u32 s17, s49, 207360
    buffer_load_dwordx4 v16, s[20:23], s17 offen lds
    s_add_u32 m0, s46, 21504
    s_add_u32 s17, s49, 216576
    buffer_load_dwordx4 v16, s[20:23], s17 offen lds
    s_add_u32 m0, s46, 22528
    s_add_u32 s17, s49, 228096
    buffer_load_dwordx4 v16, s[20:23], s17 offen lds
    s_add_u32 m0, s46, 23552
    s_add_u32 s17, s49, 237312
    buffer_load_dwordx4 v16, s[20:23], s17 offen lds
    s_add_u32 m0, s46, 24576
    s_add_u32 s17, s49, 248832
    buffer_load_dwordx4 v16, s[20:23], s17 offen lds
    s_add_u32 m0, s46, 25600
    s_add_u32 s17, s49, 258048
    buffer_load_dwordx4 v16, s[20:23], s17 offen lds
    s_add_u32 m0, s46, 26624
    s_add_u32 s17, s49, 269568
    buffer_load_dwordx4 v16, s[20:23], s17 offen lds
    s_add_u32 m0, s46, 27648
    s_add_u32 s17, s49, 278784
    buffer_load_dwordx4 v16, s[20:23], s17 offen lds
    s_add_u32 m0, s46, 28672
    s_add_u32 s17, s49, 290304
    buffer_load_dwordx4 v16, s[20:23], s17 offen lds
    s_add_u32 m0, s46, 29696
    s_add_u32 s17, s49, 299520
    buffer_load_dwordx4 v16, s[20:23], s17 offen lds
    s_add_u32 m0, s46, 30720
    s_add_u32 s17, s49, 311040
    buffer_load_dwordx4 v16, s[20:23], s17 offen lds
    s_add_u32 m0, s46, 31744
    s_add_u32 s17, s49, 320256
    buffer_load_dwordx4 v16, s[20:23], s17 offen lds
    s_waitcnt vmcnt(28)
    ds_read_b64_tr_b16 a[0:1], v18 offset:0
    ds_read_b64_tr_b16 a[2:3], v18 offset:512
    ds_read_b64_tr_b16 a[4:5], v18 offset:8
    ds_read_b64_tr_b16 a[6:7], v18 offset:520
    ds_read_b64_tr_b16 a[8:9], v19 offset:64
    ds_read_b64_tr_b16 a[10:11], v19 offset:576
    s_waitcnt lgkmcnt(0)
    s_add_u32 m0, s46, 0
    s_add_u32 s17, s49, 331776
    buffer_load_dwordx4 v16, s[20:23], s17 offen lds
    s_add_u32 m0, s46, 1024
    s_add_u32 s17, s49, 340992
    buffer_load_dwordx4 v16, s[20:23], s17 offen lds
    s_add_u32 m0, s46, 2048
    s_add_u32 s17, s49, 352512
    buffer_load_dwordx4 v16, s[20:23], s17 offen lds
    s_add_u32 m0, s46, 3072
    s_add_u32 s17, s49, 361728
    buffer_load_dwordx4 v16, s[20:23], s17 offen lds
    s_waitcnt vmcnt(28)
    ds_read_b64_tr_b16 a[12:13], v18 offset:4096
    ds_read_b64_tr_b16 a[14:15], v18 offset:4608
    ds_read_b64_tr_b16 a[16:17], v18 offset:4104
    ds_read_b64_tr_b16 a[18:19], v18 offset:4616
    ds_read_b64_tr_b16 a[20:21], v19 offset:4160
    ds_read_b64_tr_b16 a[22:23], v19 offset:4672
    s_waitcnt lgkmcnt(0)
    s_add_u32 m0, s46, 4096
    s_add_u32 s17, s49, 373248
    buffer_load_dwordx4 v16, s[20:23], s17 offen lds
    s_add_u32 m0, s46, 5120
    s_add_u32 s17, s49, 382464
    buffer_load_dwordx4 v16, s[20:23], s17 offen lds
    s_add_u32 m0, s46, 6144
    s_add_u32 s17, s49, 393984
    buffer_load_dwordx4 v16, s[20:23], s17 offen lds
    s_add_u32 m0, s46, 7168
    s_add_u32 s17, s49, 403200
    buffer_load_dwordx4 v16, s[20:23], s17 offen lds
    s_waitcnt vmcnt(28)
    ds_read_b64_tr_b16 a[24:25], v18 offset:8192
    ds_read_b64_tr_b16 a[26:27], v18 offset:8704
    ds_read_b64_tr_b16 a[28:29], v18 offset:8200
    ds_read_b64_tr_b16 a[30:31], v18 offset:8712
    ds_read_b64_tr_b16 a[32:33], v19 offset:8256
    ds_read_b64_tr_b16 a[34:35], v19 offset:8768
    s_waitcnt lgkmcnt(0)
    s_add_u32 m0, s46, 8192
    s_add_u32 s17, s49, 414720
    buffer_load_dwordx4 v16, s[20:23], s17 offen lds
    s_add_u32 m0, s46, 9216
    s_add_u32 s17, s49, 423936
    buffer_load_dwordx4 v16, s[20:23], s17 offen lds
    s_add_u32 m0, s46, 10240
    s_add_u32 s17, s49, 435456
    buffer_load_dwordx4 v16, s[20:23], s17 offen lds
    s_add_u32 m0, s46, 11264
    s_add_u32 s17, s49, 444672
    buffer_load_dwordx4 v16, s[20:23], s17 offen lds
    s_waitcnt vmcnt(28)
    ds_read_b64_tr_b16 a[36:37], v18 offset:12288
    ds_read_b64_tr_b16 a[38:39], v18 offset:12800
    ds_read_b64_tr_b16 a[40:41], v18 offset:12296
    ds_read_b64_tr_b16 a[42:43], v18 offset:12808
    ds_read_b64_tr_b16 a[44:45], v19 offset:12352
    ds_read_b64_tr_b16 a[46:47], v19 offset:12864
    s_waitcnt lgkmcnt(0)
    s_add_u32 m0, s46, 12288
    s_add_u32 s17, s49, 456192
    buffer_load_dwordx4 v16, s[20:23], s17 offen lds
    s_add_u32 m0, s46, 13312
    s_add_u32 s17, s49, 465408
    buffer_load_dwordx4 v16, s[20:23], s17 offen lds
    s_add_u32 m0, s46, 14336
    s_add_u32 s17, s49, 476928
    buffer_load_dwordx4 v16, s[20:23], s17 offen lds
    s_add_u32 m0, s46, 15360
    s_add_u32 s17, s49, 486144
    buffer_load_dwordx4 v16, s[20:23], s17 offen lds
    s_waitcnt vmcnt(28)
    ds_read_b64_tr_b16 a[48:49], v18 offset:16384
    ds_read_b64_tr_b16 a[50:51], v18 offset:16896
    ds_read_b64_tr_b16 a[52:53], v18 offset:16392
    ds_read_b64_tr_b16 a[54:55], v18 offset:16904
    ds_read_b64_tr_b16 a[56:57], v19 offset:16448
    ds_read_b64_tr_b16 a[58:59], v19 offset:16960
    s_waitcnt lgkmcnt(0)
    s_add_u32 m0, s46, 16384
    s_add_u32 s17, s49, 497664
    buffer_load_dwordx4 v16, s[20:23], s17 offen lds
    s_add_u32 m0, s46, 17408
    s_add_u32 s17, s49, 506880
    buffer_load_dwordx4 v16, s[20:23], s17 offen lds
    s_add_u32 m0, s46, 18432
    s_add_u32 s17, s49, 518400
    buffer_load_dwordx4 v16, s[20:23], s17 offen lds
    s_add_u32 m0, s46, 19456
    s_add_u32 s17, s49, 527616
    buffer_load_dwordx4 v16, s[20:23], s17 offen lds
    s_waitcnt vmcnt(28)
    ds_read_b64_tr_b16 a[60:61], v18 offset:20480
    ds_read_b64_tr_b16 a[62:63], v18 offset:20992
    ds_read_b64_tr_b16 a[64:65], v18 offset:20488
    ds_read_b64_tr_b16 a[66:67], v18 offset:21000
    ds_read_b64_tr_b16 a[68:69], v19 offset:20544
    ds_read_b64_tr_b16 a[70:71], v19 offset:21056
    s_waitcnt lgkmcnt(0)
    s_add_u32 m0, s46, 20480
    s_add_u32 s17, s49, 539136
    buffer_load_dwordx4 v16, s[20:23], s17 offen lds
    s_add_u32 m0, s46, 21504
    s_add_u32 s17, s49, 548352
    buffer_load_dwordx4 v16, s[20:23], s17 offen lds
    s_add_u32 m0, s46, 22528
    s_add_u32 s17, s49, 559872
    buffer_load_dwordx4 v16, s[20:23], s17 offen lds
    s_add_u32 m0, s46, 23552
    s_add_u32 s17, s49, 569088
    buffer_load_dwordx4 v16, s[20:23], s17 offen lds
    s_waitcnt vmcnt(28)
    ds_read_b64_tr_b16 a[72:73], v18 offset:24576
    ds_read_b64_tr_b16 a[74:75], v18 offset:25088
    ds_read_b64_tr_b16 a[76:77], v18 offset:24584
    ds_read_b64_tr_b16 a[78:79], v18 offset:25096
    ds_read_b64_tr_b16 a[80:81], v19 offset:24640
    ds_read_b64_tr_b16 a[82:83], v19 offset:25152
    s_waitcnt lgkmcnt(0)
    s_add_u32 m0, s46, 24576
    s_add_u32 s17, s49, 580608
    buffer_load_dwordx4 v16, s[20:23], s17 offen lds
    s_add_u32 m0, s46, 25600
    s_add_u32 s17, s49, 589824
    buffer_load_dwordx4 v16, s[20:23], s17 offen lds
    s_add_u32 m0, s46, 26624
    s_add_u32 s17, s49, 601344
    buffer_load_dwordx4 v16, s[20:23], s17 offen lds
    s_add_u32 m0, s46, 27648
    s_add_u32 s17, s49, 610560
    buffer_load_dwordx4 v16, s[20:23], s17 offen lds
    s_waitcnt vmcnt(28)
    ds_read_b64_tr_b16 a[84:85], v18 offset:28672
    ds_read_b64_tr_b16 a[86:87], v18 offset:29184
    ds_read_b64_tr_b16 a[88:89], v18 offset:28680
    ds_read_b64_tr_b16 a[90:91], v18 offset:29192
    ds_read_b64_tr_b16 a[92:93], v19 offset:28736
    ds_read_b64_tr_b16 a[94:95], v19 offset:29248
    s_waitcnt lgkmcnt(0)
    s_add_u32 m0, s46, 28672
    s_add_u32 s17, s49, 622080
    buffer_load_dwordx4 v16, s[20:23], s17 offen lds
    s_add_u32 m0, s46, 29696
    s_add_u32 s17, s49, 631296
    buffer_load_dwordx4 v16, s[20:23], s17 offen lds
    s_add_u32 m0, s46, 30720
    s_add_u32 s17, s49, 642816
    buffer_load_dwordx4 v16, s[20:23], s17 offen lds
    s_add_u32 m0, s46, 31744
    s_add_u32 s17, s49, 652032
    buffer_load_dwordx4 v16, s[20:23], s17 offen lds
    s_waitcnt vmcnt(28)
    ds_read_b64_tr_b16 a[96:97], v18 offset:0
    ds_read_b64_tr_b16 a[98:99], v18 offset:512
    ds_read_b64_tr_b16 a[100:101], v18 offset:8
    ds_read_b64_tr_b16 a[102:103], v18 offset:520
    ds_read_b64_tr_b16 a[104:105], v19 offset:64
    ds_read_b64_tr_b16 a[106:107], v19 offset:576
    s_waitcnt lgkmcnt(0)
    s_add_u32 m0, s46, 0
    s_add_u32 s17, s49, 0
    buffer_load_dwordx4 v17, s[20:23], s17 offen lds
    s_add_u32 m0, s46, 1024
    s_add_u32 s17, s49, 82944
    buffer_load_dwordx4 v17, s[20:23], s17 offen lds
    s_add_u32 m0, s46, 2048
    s_add_u32 s17, s49, 165888
    buffer_load_dwordx4 v17, s[20:23], s17 offen lds
    s_add_u32 m0, s46, 3072
    s_add_u32 s17, s49, 248832
    buffer_load_dwordx4 v17, s[20:23], s17 offen lds
    s_waitcnt vmcnt(28)
    ds_read_b64_tr_b16 a[108:109], v18 offset:4096
    ds_read_b64_tr_b16 a[110:111], v18 offset:4608
    ds_read_b64_tr_b16 a[112:113], v18 offset:4104
    ds_read_b64_tr_b16 a[114:115], v18 offset:4616
    ds_read_b64_tr_b16 a[116:117], v19 offset:4160
    ds_read_b64_tr_b16 a[118:119], v19 offset:4672
    s_waitcnt lgkmcnt(0)
    s_add_u32 m0, s46, 4096
    s_add_u32 s17, s49, 331776
    buffer_load_dwordx4 v17, s[20:23], s17 offen lds
    s_add_u32 m0, s46, 5120
    s_add_u32 s17, s49, 414720
    buffer_load_dwordx4 v17, s[20:23], s17 offen lds
    s_add_u32 m0, s46, 6144
    s_add_u32 s17, s49, 497664
    buffer_load_dwordx4 v17, s[20:23], s17 offen lds
    s_add_u32 m0, s46, 7168
    s_add_u32 s17, s49, 580608
    buffer_load_dwordx4 v17, s[20:23], s17 offen lds
    s_waitcnt vmcnt(28)
    ds_read_b64_tr_b16 a[120:121], v18 offset:8192
    ds_read_b64_tr_b16 a[122:123], v18 offset:8704
    ds_read_b64_tr_b16 a[124:125], v18 offset:8200
    ds_read_b64_tr_b16 a[126:127], v18 offset:8712
    ds_read_b64_tr_b16 a[128:129], v19 offset:8256
    ds_read_b64_tr_b16 a[130:131], v19 offset:8768
    s_waitcnt lgkmcnt(0)
    s_waitcnt vmcnt(24)
    ds_read_b64_tr_b16 a[132:133], v18 offset:12288
    ds_read_b64_tr_b16 a[134:135], v18 offset:12800
    ds_read_b64_tr_b16 a[136:137], v18 offset:12296
    ds_read_b64_tr_b16 a[138:139], v18 offset:12808
    ds_read_b64_tr_b16 a[140:141], v19 offset:12352
    ds_read_b64_tr_b16 a[142:143], v19 offset:12864
    s_waitcnt lgkmcnt(0)
    s_waitcnt vmcnt(20)
    ds_read_b64_tr_b16 a[144:145], v18 offset:16384
    ds_read_b64_tr_b16 a[146:147], v18 offset:16896
    ds_read_b64_tr_b16 a[148:149], v18 offset:16392
    ds_read_b64_tr_b16 a[150:151], v18 offset:16904
    ds_read_b64_tr_b16 a[152:153], v19 offset:16448
    ds_read_b64_tr_b16 a[154:155], v19 offset:16960
    s_waitcnt lgkmcnt(0)
    s_waitcnt vmcnt(16)
    ds_read_b64_tr_b16 a[156:157], v18 offset:20480
    ds_read_b64_tr_b16 a[158:159], v18 offset:20992
    ds_read_b64_tr_b16 a[160:161], v18 offset:20488
    ds_read_b64_tr_b16 a[162:163], v18 offset:21000
    ds_read_b64_tr_b16 a[164:165], v19 offset:20544
    ds_read_b64_tr_b16 a[166:167], v19 offset:21056
    s_waitcnt lgkmcnt(0)
    s_waitcnt vmcnt(12)
    ds_read_b64_tr_b16 a[168:169], v18 offset:24576
    ds_read_b64_tr_b16 a[170:171], v18 offset:25088
    ds_read_b64_tr_b16 a[172:173], v18 offset:24584
    ds_read_b64_tr_b16 a[174:175], v18 offset:25096
    ds_read_b64_tr_b16 a[176:177], v19 offset:24640
    ds_read_b64_tr_b16 a[178:179], v19 offset:25152
    s_waitcnt lgkmcnt(0)
    s_waitcnt vmcnt(8)
    ds_read_b64_tr_b16 a[180:181], v18 offset:28672
    ds_read_b64_tr_b16 a[182:183], v18 offset:29184
    ds_read_b64_tr_b16 a[184:185], v18 offset:28680
    ds_read_b64_tr_b16 a[186:187], v18 offset:29192
    ds_read_b64_tr_b16 a[188:189], v19 offset:28736
    ds_read_b64_tr_b16 a[190:191], v19 offset:29248
    s_waitcnt lgkmcnt(0)
    s_waitcnt vmcnt(4)
    ds_read_b64_tr_b16 a[192:193], v18 offset:0
    ds_read_b64_tr_b16 a[194:195], v18 offset:512
    ds_read_b64_tr_b16 a[196:197], v18 offset:8
    ds_read_b64_tr_b16 a[198:199], v18 offset:520
    ds_read_b64_tr_b16 a[200:201], v19 offset:64
    ds_read_b64_tr_b16 a[202:203], v19 offset:576
    s_waitcnt lgkmcnt(0)
    s_waitcnt vmcnt(0)
    ds_read_b64_tr_b16 a[204:205], v18 offset:4096
    ds_read_b64_tr_b16 a[206:207], v18 offset:4608
    ds_read_b64_tr_b16 a[208:209], v18 offset:4104
    ds_read_b64_tr_b16 a[210:211], v18 offset:4616
    ds_read_b64_tr_b16 a[212:213], v19 offset:4160
    ds_read_b64_tr_b16 a[214:215], v19 offset:4672
    s_waitcnt lgkmcnt(0)
    s_barrier
    v_lshlrev_b32 v5, 4, v7
    v_lshl_add_u32 v10, v8, 9, v5
    s_mul_i32 s17, s50, 3072
    v_add_u32 v10, s17, v10
    v_lshrrev_b32 v6, 1, v8
    v_lshl_add_u32 v12, v6, 9, v5
    v_and_b32 v6, 1, v8
    v_lshl_add_u32 v12, v6, 3, v12
    s_add_u32 s17, s17, 2048
    v_add_u32 v12, s17, v12
    s_lshr_b32 s17, s50, 1
    s_lshl_b32 s17, s17, 9
    s_and_b32 s18, s50, 1
    s_lshl_b32 s18, s18, 3
    s_add_u32 s17, s17, s18
    v_add_u32 v11, s17, v5
    s_lshl_b32 s49, s15, 7
    s_lshl_b32 s17, s14, 2
    s_add_u32 s49, s49, s17
    s_add_u32 s49, s49, 3584
    s_mov_b32 s36, s63
    s_mov_b32 s34, s63
    s_mul_i32 s58, s14, 9216
    s_mul_i32 s64, s63, 2359296
    s_add_u32 s64, s64, s58
    s_add_u32 s64, s64, 17301504
    s_mul_i32 s61, s63, 1441792
    s_add_u32 s61, s61, 1536
    s_mov_b32 s37, 0
    s_mov_b32 s40, 36864
    s_mov_b32 s59, s58
    s_mov_b32 s43, 0
    s_mov_b32 s62, 1
    s_mov_b32 s28, s8
    s_mov_b32 s29, s9
    s_mov_b32 s30, 0
    s_mov_b32 s31, 0x00020000
    v_mov_b32 v184, 74752
    v_mov_b32 v5, -1
    ds_write_b32 v184, v5
    s_waitcnt lgkmcnt(0)
    s_cmp_lg_u32 s14, 0
    s_cbranch_scc1 Lawo_inia_d
    v_mov_b32 v5, 40
    s_mov_b32 s16, 0
Lawo_inia:
    global_load_dword v6, v5, s[12:13] sc1
    s_add_u32 s16, s16, 1
    s_cmp_gt_u32 s16, 100000
    s_cbranch_scc1 L_role_awo_abort
    s_waitcnt vmcnt(0)
    v_cmp_gt_u32 vcc, 128, v6
    s_nop 0
    s_cbranch_vccz Lawo_inia_d
    s_sleep 8
    s_branch Lawo_inia
Lawo_inia_d:
    s_barrier
    s_cmp_eq_u32 s63, 0
    s_cbranch_scc1 Lawo_ini_sk
    s_cmp_lg_u32 s14, 0
    s_cbranch_scc1 Lawo_inib_d
    v_mov_b32 v5, 160
    s_mov_b32 s16, 0
Lawo_inib:
    global_load_dword v6, v5, s[12:13] sc1
    s_add_u32 s16, s16, 1
    s_cmp_gt_u32 s16, 100000
    s_cbranch_scc1 L_role_awo_abort
    s_waitcnt vmcnt(0)
    v_cmp_gt_u32 vcc, 64, v6
    s_nop 0
    s_cbranch_vccz Lawo_inib_d
    s_sleep 8
    s_branch Lawo_inib
Lawo_inib_d:
    s_barrier
Lawo_ini_sk:
    s_mul_i32 s41, s37, 36864
    s_add_u32 s41, s41, s64
    s_mul_i32 s60, s37, 22528
    s_add_u32 s60, s60, s61
    s_cmp_lt_u32 s37, 64
    s_cselect_b32 s60, s60, 2883584
    s_branch Lawo_wait
Lawo_head:
    s_waitcnt vmcnt(6)
Lawo_head2:
    s_barrier
    ds_read_b32 v15, v184
    s_xor_b32 s40, s40, 36864
    s_xor_b32 s59, s59, 36864
    s_mov_b32 s35, s37
    s_lshl_b32 s57, s34, 6
    s_add_u32 s57, s57, s35
    s_add_u32 s37, s37, 1
    s_mov_b32 s39, 0
    s_mov_b32 s54, 0
    s_mul_i32 s41, s37, 36864
    s_add_u32 s41, s41, s64
    s_mul_i32 s60, s37, 22528
    s_add_u32 s60, s60, s61
    s_cmp_lt_u32 s37, 64
    s_cselect_b32 s60, s60, 2883584
    v_lshlrev_b32 v9, 9, v8
    v_lshl_add_u32 v9, v7, 4, v9
    v_add_u32 v9, s40, v9
    ds_read_b128 v[40:43], v9 offset:0
    ds_read_b128 v[44:47], v9 offset:256
    ds_read_b128 v[48:51], v9 offset:2048
    ds_read_b128 v[52:55], v9 offset:2304
    ds_read_b128 v[56:59], v9 offset:4096
    v_lshlrev_b32 v16, 16, v64
    v_and_b32 v17, 0xffff0000, v64
    v_lshlrev_b32 v18, 16, v65
    v_and_b32 v19, 0xffff0000, v65
    v_lshlrev_b32 v20, 16, v66
    v_and_b32 v21, 0xffff0000, v66
    v_lshlrev_b32 v22, 16, v67
    v_and_b32 v23, 0xffff0000, v67
    v_lshlrev_b32 v24, 16, v68
    v_and_b32 v25, 0xffff0000, v68
    v_lshlrev_b32 v26, 16, v69
    v_and_b32 v27, 0xffff0000, v69
    v_lshlrev_b32 v28, 16, v72
    v_and_b32 v29, 0xffff0000, v72
    v_lshlrev_b32 v30, 16, v73
    v_and_b32 v31, 0xffff0000, v73
    v_lshlrev_b32 v32, 16, v74
    v_and_b32 v33, 0xffff0000, v74
    v_lshlrev_b32 v34, 16, v75
    v_and_b32 v35, 0xffff0000, v75
    v_lshlrev_b32 v36, 16, v76
    v_and_b32 v37, 0xffff0000, v76
    v_lshlrev_b32 v38, 16, v77
    v_and_b32 v39, 0xffff0000, v77
    s_waitcnt lgkmcnt(4)
    v_mfma_f32_16x16x32_bf16 v[16:19], a[0:3], v[40:43], v[16:19]
    ds_read_b128 v[60:63], v9 offset:4352
    v_mfma_f32_16x16x32_bf16 v[20:23], a[4:7], v[40:43], v[20:23]
    s_mul_i32 s46, s34, 4718592
    v_mfma_f32_16x16x32_bf16 v[24:27], a[8:11], v[40:43], v[24:27]
    s_waitcnt lgkmcnt(4)
    v_mfma_f32_16x16x32_bf16 v[28:31], a[0:3], v[44:47], v[28:31]
    ds_read_b128 v[40:43], v9 offset:6144
    v_mfma_f32_16x16x32_bf16 v[32:35], a[4:7], v[44:47], v[32:35]
    s_mul_i32 s51, s35, 36864
    v_mfma_f32_16x16x32_bf16 v[36:39], a[8:11], v[44:47], v[36:39]
    v_readfirstlane_b32 s17, v15
    s_nop 0
    s_add_u32 s18, s17, 1
    s_max_i32 s32, s18, s37
    s_add_u32 s39, s37, 1
    s_min_u32 s39, s39, 63
    s_mul_i32 s33, s32, 22528
    s_add_u32 s33, s33, s61
    s_cmp_eq_u32 s14, 0
    s_cselect_b32 s18, s32, 0x7fff
    v_mov_b32 v2, 2
    s_cmp_le_u32 s18, s39
    s_cselect_b64 exec, -1, 0
    buffer_load_dword v2, v1, s[8:11], s33 offen sc1
    s_mov_b64 exec, -1
    s_cmp_ge_i32 s17, s37
    s_cbranch_scc1 Lawo_f_5
    s_waitcnt lgkmcnt(4)
    v_mfma_f32_16x16x32_bf16 v[16:19], a[12:15], v[48:51], v[16:19]
    ds_read_b128 v[44:47], v9 offset:6400
    v_mfma_f32_16x16x32_bf16 v[20:23], a[16:19], v[48:51], v[20:23]
    s_add_u32 s46, s46, s51
    v_mfma_f32_16x16x32_bf16 v[24:27], a[20:23], v[48:51], v[24:27]
    s_waitcnt lgkmcnt(4)
    v_mfma_f32_16x16x32_bf16 v[28:31], a[12:15], v[52:55], v[28:31]
    ds_read_b128 v[48:51], v9 offset:8192
    v_mfma_f32_16x16x32_bf16 v[32:35], a[16:19], v[52:55], v[32:35]
    s_add_u32 s46, s46, 8650752
    v_mfma_f32_16x16x32_bf16 v[36:39], a[20:23], v[52:55], v[36:39]
    s_waitcnt lgkmcnt(4)
    v_mfma_f32_16x16x32_bf16 v[16:19], a[24:27], v[56:59], v[16:19]
    ds_read_b128 v[52:55], v9 offset:8448
    v_mfma_f32_16x16x32_bf16 v[20:23], a[28:31], v[56:59], v[20:23]
    s_mul_i32 s52, s34, 786432
    v_mfma_f32_16x16x32_bf16 v[24:27], a[32:35], v[56:59], v[24:27]
    s_waitcnt lgkmcnt(4)
    v_mfma_f32_16x16x32_bf16 v[28:31], a[24:27], v[60:63], v[28:31]
    ds_read_b128 v[56:59], v9 offset:10240
    v_mfma_f32_16x16x32_bf16 v[32:35], a[28:31], v[60:63], v[32:35]
    s_mul_i32 s51, s35, 6144
    v_mfma_f32_16x16x32_bf16 v[36:39], a[32:35], v[60:63], v[36:39]
    s_waitcnt lgkmcnt(4)
    v_mfma_f32_16x16x32_bf16 v[16:19], a[36:39], v[40:43], v[16:19]
    ds_read_b128 v[60:63], v9 offset:10496
    v_mfma_f32_16x16x32_bf16 v[20:23], a[40:43], v[40:43], v[20:23]
    s_add_u32 s52, s52, s51
    v_mfma_f32_16x16x32_bf16 v[24:27], a[44:47], v[40:43], v[24:27]
    s_waitcnt lgkmcnt(4)
    v_mfma_f32_16x16x32_bf16 v[28:31], a[36:39], v[44:47], v[28:31]
    ds_read_b128 v[40:43], v9 offset:12288
    v_mfma_f32_16x16x32_bf16 v[32:35], a[40:43], v[44:47], v[32:35]
    s_add_u32 s52, s52, 16121856
    v_mfma_f32_16x16x32_bf16 v[36:39], a[44:47], v[44:47], v[36:39]
    s_waitcnt lgkmcnt(4)
    v_mfma_f32_16x16x32_bf16 v[16:19], a[48:51], v[48:51], v[16:19]
    ds_read_b128 v[44:47], v9 offset:12544
    v_mfma_f32_16x16x32_bf16 v[20:23], a[52:55], v[48:51], v[20:23]
    v_mfma_f32_16x16x32_bf16 v[24:27], a[56:59], v[48:51], v[24:27]
    s_waitcnt lgkmcnt(4)
    v_mfma_f32_16x16x32_bf16 v[28:31], a[48:51], v[52:55], v[28:31]
    ds_read_b128 v[48:51], v9 offset:14336
    v_mfma_f32_16x16x32_bf16 v[32:35], a[52:55], v[52:55], v[32:35]
    v_mfma_f32_16x16x32_bf16 v[36:39], a[56:59], v[52:55], v[36:39]
    s_waitcnt lgkmcnt(4)
    v_mfma_f32_16x16x32_bf16 v[16:19], a[60:63], v[56:59], v[16:19]
    ds_read_b128 v[52:55], v9 offset:14592
    v_mfma_f32_16x16x32_bf16 v[20:23], a[64:67], v[56:59], v[20:23]
    v_mfma_f32_16x16x32_bf16 v[24:27], a[68:71], v[56:59], v[24:27]
    s_waitcnt lgkmcnt(4)
    v_mfma_f32_16x16x32_bf16 v[28:31], a[60:63], v[60:63], v[28:31]
    v_cmp_eq_u32 s[76:77], 1, v2
    v_cmp_eq_u32 vcc, 2, v2
    ds_read_b128 v[56:59], v9 offset:16384
    v_mfma_f32_16x16x32_bf16 v[32:35], a[64:67], v[60:63], v[32:35]
    s_cmp_eq_u64 s[76:77], -1
    s_cselect_b32 s38, 1, 0
    v_mfma_f32_16x16x32_bf16 v[36:39], a[68:71], v[60:63], v[36:39]
    s_cmp_lg_u32 s38, 0
    s_cselect_b64 exec, 1, 0
    v_mov_b32 v15, s32
    ds_write_b32 v184, v15
    v_mov_b32 v2, 2
    s_mov_b64 exec, -1
    s_waitcnt lgkmcnt(5)
    v_mfma_f32_16x16x32_bf16 v[16:19], a[72:75], v[40:43], v[16:19]
    ds_read_b128 v[60:63], v9 offset:16640
    v_mfma_f32_16x16x32_bf16 v[20:23], a[76:79], v[40:43], v[20:23]
    s_add_u32 s32, s32, s38
    s_mul_i32 s38, s38, 22528
    s_add_u32 s33, s33, s38
    v_mfma_f32_16x16x32_bf16 v[24:27], a[80:83], v[40:43], v[24:27]
    s_cmp_eq_u64 vcc, 0
    s_cselect_b32 s38, s32, 0x7fff
    s_waitcnt lgkmcnt(5)
    v_mfma_f32_16x16x32_bf16 v[28:31], a[72:75], v[44:47], v[28:31]
    s_cmp_le_u32 s38, s39
    s_cselect_b64 exec, -1, 0
    v_mov_b32 v2, 2
    buffer_load_dword v2, v1, s[8:11], s33 offen sc1
    s_mov_b64 exec, -1
    ds_read_b128 v[40:43], v9 offset:18432
    v_mfma_f32_16x16x32_bf16 v[32:35], a[76:79], v[44:47], v[32:35]
    v_mfma_f32_16x16x32_bf16 v[36:39], a[80:83], v[44:47], v[36:39]
    ds_read_b32 v15, v184
    s_waitcnt lgkmcnt(6)
    v_mfma_f32_16x16x32_bf16 v[16:19], a[84:87], v[48:51], v[16:19]
    ds_read_b128 v[44:47], v9 offset:18688
    v_mfma_f32_16x16x32_bf16 v[20:23], a[88:91], v[48:51], v[20:23]
    v_mfma_f32_16x16x32_bf16 v[24:27], a[92:95], v[48:51], v[24:27]
    s_waitcnt lgkmcnt(6)
    v_mfma_f32_16x16x32_bf16 v[28:31], a[84:87], v[52:55], v[28:31]
    ds_read_b128 v[48:51], v9 offset:20480
    v_mfma_f32_16x16x32_bf16 v[32:35], a[88:91], v[52:55], v[32:35]
    v_mfma_f32_16x16x32_bf16 v[36:39], a[92:95], v[52:55], v[36:39]
    s_waitcnt lgkmcnt(2)
    v_readfirstlane_b32 s17, v15
    s_nop 0
    s_cmp_ge_i32 s17, s37
    s_cbranch_scc1 Lawo_f_6
    v_mfma_f32_16x16x32_bf16 v[16:19], a[96:99], v[56:59], v[16:19]
    ds_read_b128 v[52:55], v9 offset:20736
    v_mfma_f32_16x16x32_bf16 v[20:23], a[100:103], v[56:59], v[20:23]
    v_mfma_f32_16x16x32_bf16 v[24:27], a[104:107], v[56:59], v[24:27]
    v_mfma_f32_16x16x32_bf16 v[28:31], a[96:99], v[60:63], v[28:31]
    ds_read_b128 v[56:59], v9 offset:22528
    v_mfma_f32_16x16x32_bf16 v[32:35], a[100:103], v[60:63], v[32:35]
    v_mfma_f32_16x16x32_bf16 v[36:39], a[104:107], v[60:63], v[36:39]
    s_waitcnt vmcnt(2)
    s_cmp_lg_u32 s43, 0
    s_cselect_b64 exec, 1, 0
    buffer_store_dword v3, v4, s[8:11], s43 offen sc1
    s_mov_b64 exec, -1
    s_mov_b32 s43, 0
    v_mfma_f32_16x16x32_bf16 v[16:19], a[108:111], v[40:43], v[16:19]
    ds_read_b128 v[60:63], v9 offset:22784
    v_mfma_f32_16x16x32_bf16 v[20:23], a[112:115], v[40:43], v[20:23]
    v_mfma_f32_16x16x32_bf16 v[24:27], a[116:119], v[40:43], v[24:27]
    s_waitcnt lgkmcnt(4)
    v_mfma_f32_16x16x32_bf16 v[28:31], a[108:111], v[44:47], v[28:31]
    ds_read_b128 v[40:43], v9 offset:24576
    v_mfma_f32_16x16x32_bf16 v[32:35], a[112:115], v[44:47], v[32:35]
    v_mfma_f32_16x16x32_bf16 v[36:39], a[116:119], v[44:47], v[36:39]
    s_waitcnt lgkmcnt(4)
    v_mfma_f32_16x16x32_bf16 v[16:19], a[120:123], v[48:51], v[16:19]
    ds_read_b128 v[44:47], v9 offset:24832
    v_mfma_f32_16x16x32_bf16 v[20:23], a[124:127], v[48:51], v[20:23]
    v_mfma_f32_16x16x32_bf16 v[24:27], a[128:131], v[48:51], v[24:27]
    s_waitcnt lgkmcnt(4)
    v_mfma_f32_16x16x32_bf16 v[28:31], a[120:123], v[52:55], v[28:31]
    ds_read_b128 v[48:51], v9 offset:26624
    v_mfma_f32_16x16x32_bf16 v[32:35], a[124:127], v[52:55], v[32:35]
    v_mfma_f32_16x16x32_bf16 v[36:39], a[128:131], v[52:55], v[36:39]
    s_waitcnt lgkmcnt(4)
    v_mfma_f32_16x16x32_bf16 v[16:19], a[132:135], v[56:59], v[16:19]
    ds_read_b128 v[52:55], v9 offset:26880
    v_mfma_f32_16x16x32_bf16 v[20:23], a[136:139], v[56:59], v[20:23]
    v_mfma_f32_16x16x32_bf16 v[24:27], a[140:143], v[56:59], v[24:27]
    s_waitcnt lgkmcnt(4)
    v_mfma_f32_16x16x32_bf16 v[28:31], a[132:135], v[60:63], v[28:31]
    ds_read_b128 v[56:59], v9 offset:28672
    v_mfma_f32_16x16x32_bf16 v[32:35], a[136:139], v[60:63], v[32:35]
    v_mfma_f32_16x16x32_bf16 v[36:39], a[140:143], v[60:63], v[36:39]
    s_waitcnt lgkmcnt(4)
    v_mfma_f32_16x16x32_bf16 v[16:19], a[144:147], v[40:43], v[16:19]
    ds_read_b128 v[60:63], v9 offset:28928
    v_mfma_f32_16x16x32_bf16 v[20:23], a[148:151], v[40:43], v[20:23]
    v_mfma_f32_16x16x32_bf16 v[24:27], a[152:155], v[40:43], v[24:27]
    s_waitcnt lgkmcnt(4)
    v_mfma_f32_16x16x32_bf16 v[28:31], a[144:147], v[44:47], v[28:31]
    ds_read_b128 v[40:43], v9 offset:30720
    v_mfma_f32_16x16x32_bf16 v[32:35], a[148:151], v[44:47], v[32:35]
    v_mfma_f32_16x16x32_bf16 v[36:39], a[152:155], v[44:47], v[36:39]
    s_waitcnt lgkmcnt(4)
    v_mfma_f32_16x16x32_bf16 v[16:19], a[156:159], v[48:51], v[16:19]
    ds_read_b128 v[44:47], v9 offset:30976
    v_mfma_f32_16x16x32_bf16 v[20:23], a[160:163], v[48:51], v[20:23]
    v_mfma_f32_16x16x32_bf16 v[24:27], a[164:167], v[48:51], v[24:27]
    s_waitcnt lgkmcnt(4)
    v_mfma_f32_16x16x32_bf16 v[28:31], a[156:159], v[52:55], v[28:31]
    ds_read_b128 v[48:51], v9 offset:32768
    v_mfma_f32_16x16x32_bf16 v[32:35], a[160:163], v[52:55], v[32:35]
    v_mfma_f32_16x16x32_bf16 v[36:39], a[164:167], v[52:55], v[36:39]
    s_waitcnt lgkmcnt(4)
    v_mfma_f32_16x16x32_bf16 v[16:19], a[168:171], v[56:59], v[16:19]
    ds_read_b128 v[52:55], v9 offset:33024
    v_mfma_f32_16x16x32_bf16 v[20:23], a[172:175], v[56:59], v[20:23]
    v_mfma_f32_16x16x32_bf16 v[24:27], a[176:179], v[56:59], v[24:27]
    s_waitcnt lgkmcnt(4)
    v_mfma_f32_16x16x32_bf16 v[28:31], a[168:171], v[60:63], v[28:31]
    v_cmp_eq_u32 s[76:77], 1, v2
    v_cmp_eq_u32 vcc, 2, v2
    ds_read_b128 v[56:59], v9 offset:34816
    v_mfma_f32_16x16x32_bf16 v[32:35], a[172:175], v[60:63], v[32:35]
    s_cmp_eq_u64 s[76:77], -1
    s_cselect_b32 s38, 1, 0
    v_mfma_f32_16x16x32_bf16 v[36:39], a[176:179], v[60:63], v[36:39]
    s_cmp_lg_u32 s38, 0
    s_cselect_b64 exec, 1, 0
    v_mov_b32 v15, s32
    ds_write_b32 v184, v15
    v_mov_b32 v2, 2
    s_mov_b64 exec, -1
    s_waitcnt lgkmcnt(5)
    v_mfma_f32_16x16x32_bf16 v[16:19], a[180:183], v[40:43], v[16:19]
    ds_read_b128 v[60:63], v9 offset:35072
    v_mfma_f32_16x16x32_bf16 v[20:23], a[184:187], v[40:43], v[20:23]
    s_add_u32 s32, s32, s38
    s_mul_i32 s38, s38, 22528
    s_add_u32 s33, s33, s38
    v_mfma_f32_16x16x32_bf16 v[24:27], a[188:191], v[40:43], v[24:27]
    s_cmp_eq_u64 vcc, 0
    s_cselect_b32 s38, s32, 0x7fff
    s_waitcnt lgkmcnt(5)
    v_mfma_f32_16x16x32_bf16 v[28:31], a[180:183], v[44:47], v[28:31]
    s_cmp_le_u32 s38, s39
    s_cselect_b64 exec, -1, 0
    v_mov_b32 v2, 2
    buffer_load_dword v2, v1, s[8:11], s33 offen sc1
    s_mov_b64 exec, -1
    v_mfma_f32_16x16x32_bf16 v[32:35], a[184:187], v[44:47], v[32:35]
    v_mfma_f32_16x16x32_bf16 v[36:39], a[188:191], v[44:47], v[36:39]
    s_waitcnt lgkmcnt(4)
    v_mfma_f32_16x16x32_bf16 v[16:19], a[192:195], v[48:51], v[16:19]
    v_mfma_f32_16x16x32_bf16 v[20:23], a[196:199], v[48:51], v[20:23]
    v_mfma_f32_16x16x32_bf16 v[24:27], a[200:203], v[48:51], v[24:27]
    s_waitcnt lgkmcnt(3)
    v_mfma_f32_16x16x32_bf16 v[28:31], a[192:195], v[52:55], v[28:31]
    v_mfma_f32_16x16x32_bf16 v[32:35], a[196:199], v[52:55], v[32:35]
    v_mfma_f32_16x16x32_bf16 v[36:39], a[200:203], v[52:55], v[36:39]
    s_waitcnt lgkmcnt(2)
    v_mfma_f32_16x16x32_bf16 v[16:19], a[204:207], v[56:59], v[16:19]
    v_mfma_f32_16x16x32_bf16 v[20:23], a[208:211], v[56:59], v[20:23]
    v_mfma_f32_16x16x32_bf16 v[24:27], a[212:215], v[56:59], v[24:27]
    s_waitcnt lgkmcnt(0)
    v_mfma_f32_16x16x32_bf16 v[28:31], a[204:207], v[60:63], v[28:31]
    v_mfma_f32_16x16x32_bf16 v[32:35], a[208:211], v[60:63], v[32:35]
    v_mfma_f32_16x16x32_bf16 v[36:39], a[212:215], v[60:63], v[36:39]
    v_mov_b32 v88, 0x3f803f80
    v_cvt_pk_bf16_f32 v96, v16, v17
    v_cvt_pk_bf16_f32 v97, v18, v19
    v_cvt_pk_bf16_f32 v98, v20, v21
    v_cvt_pk_bf16_f32 v99, v22, v23
    v_cvt_pk_bf16_f32 v100, v24, v25
    v_cvt_pk_bf16_f32 v101, v26, v27
    buffer_store_dwordx4 v[96:99], v10, s[8:11], s46 offen offset:0 sc1
    buffer_store_dwordx2 v[100:101], v12, s[8:11], s46 offen offset:0 sc1
    v_cvt_pk_bf16_f32 v104, v28, v29
    v_cvt_pk_bf16_f32 v105, v30, v31
    v_cvt_pk_bf16_f32 v106, v32, v33
    v_cvt_pk_bf16_f32 v107, v34, v35
    v_cvt_pk_bf16_f32 v108, v36, v37
    v_cvt_pk_bf16_f32 v109, v38, v39
    buffer_store_dwordx4 v[104:107], v10, s[8:11], s46 offen offset:256 sc1
    buffer_store_dwordx2 v[108:109], v12, s[8:11], s46 offen offset:256 sc1
    v_mov_b32 v80, 0
    v_mov_b32 v81, 0
    v_mov_b32 v84, 0
    v_mov_b32 v85, 0
    v_dot2c_f32_bf16 v80, v96, v88
    v_dot2c_f32_bf16 v81, v96, v96
    v_dot2c_f32_bf16 v84, v104, v88
    v_dot2c_f32_bf16 v85, v104, v104
    v_dot2c_f32_bf16 v80, v97, v88
    v_dot2c_f32_bf16 v81, v97, v97
    v_dot2c_f32_bf16 v84, v105, v88
    v_dot2c_f32_bf16 v85, v105, v105
    v_dot2c_f32_bf16 v80, v98, v88
    v_dot2c_f32_bf16 v81, v98, v98
    v_dot2c_f32_bf16 v84, v106, v88
    v_dot2c_f32_bf16 v85, v106, v106
    v_dot2c_f32_bf16 v80, v99, v88
    v_dot2c_f32_bf16 v81, v99, v99
    v_dot2c_f32_bf16 v84, v107, v88
    v_dot2c_f32_bf16 v85, v107, v107
    v_dot2c_f32_bf16 v80, v100, v88
    v_dot2c_f32_bf16 v81, v100, v100
    v_dot2c_f32_bf16 v84, v108, v88
    v_dot2c_f32_bf16 v85, v108, v108
    v_dot2c_f32_bf16 v80, v101, v88
    v_dot2c_f32_bf16 v81, v101, v101
    v_dot2c_f32_bf16 v84, v109, v88
    v_dot2c_f32_bf16 v85, v109, v109
    s_nop 2
    v_mov_b32 v82, v80
    v_mov_b32 v83, v81
    v_mov_b32 v86, v84
    v_mov_b32 v87, v85
    v_permlane32_swap_b32 v80, v82
    v_permlane32_swap_b32 v81, v83
    v_permlane32_swap_b32 v84, v86
    v_permlane32_swap_b32 v85, v87
    v_add_f32 v80, v80, v82
    v_add_f32 v81, v81, v83
    v_add_f32 v84, v84, v86
    v_add_f32 v85, v85, v87
    v_mov_b32 v82, v80
    v_mov_b32 v83, v81
    v_mov_b32 v86, v84
    v_mov_b32 v87, v85
    v_permlane16_swap_b32 v80, v82
    v_permlane16_swap_b32 v81, v83
    v_permlane16_swap_b32 v84, v86
    v_permlane16_swap_b32 v85, v87
    v_add_f32 v80, v80, v82
    v_add_f32 v81, v81, v83
    v_add_f32 v84, v84, v86
    v_add_f32 v85, v85, v87
    s_mov_b64 exec, 0xffff
    buffer_store_dwordx2 v[80:81], v11, s[8:11], s52 offen offset:0 sc1
    buffer_store_dwordx2 v[84:85], v11, s[8:11], s52 offen offset:256 sc1
    s_mov_b64 exec, -1
    s_mul_i32 s43, s57, 22528
    s_add_u32 s43, s43, s49
    s_branch Lawo_none
Lawo_f_5:
    s_waitcnt lgkmcnt(4)
    v_mfma_f32_16x16x32_bf16 v[16:19], a[12:15], v[48:51], v[16:19]
    ds_read_b128 v[44:47], v9 offset:6400
    v_mfma_f32_16x16x32_bf16 v[20:23], a[16:19], v[48:51], v[20:23]
    s_add_u32 s46, s46, s51
    v_mfma_f32_16x16x32_bf16 v[24:27], a[20:23], v[48:51], v[24:27]
    s_add_u32 m0, s59, 0
    s_add_u32 s47, s41, 0
    buffer_load_dwordx4 v0, s[8:11], s47 offen offset:0 lds
    s_waitcnt lgkmcnt(4)
    v_mfma_f32_16x16x32_bf16 v[28:31], a[12:15], v[52:55], v[28:31]
    buffer_load_dwordx4 v0, s[8:11], s47 offen offset:1024 lds
    ds_read_b128 v[48:51], v9 offset:8192
    v_mfma_f32_16x16x32_bf16 v[32:35], a[16:19], v[52:55], v[32:35]
    s_add_u32 s46, s46, 8650752
    v_mfma_f32_16x16x32_bf16 v[36:39], a[20:23], v[52:55], v[36:39]
    s_waitcnt lgkmcnt(4)
    v_mfma_f32_16x16x32_bf16 v[16:19], a[24:27], v[56:59], v[16:19]
    buffer_load_dwordx4 v0, s[8:11], s47 offen offset:2048 lds
    ds_read_b128 v[52:55], v9 offset:8448
    v_mfma_f32_16x16x32_bf16 v[20:23], a[28:31], v[56:59], v[20:23]
    s_mul_i32 s52, s34, 786432
    v_mfma_f32_16x16x32_bf16 v[24:27], a[32:35], v[56:59], v[24:27]
    s_waitcnt lgkmcnt(4)
    v_mfma_f32_16x16x32_bf16 v[28:31], a[24:27], v[60:63], v[28:31]
    buffer_load_dwordx4 v0, s[8:11], s47 offen offset:3072 lds
    ds_read_b128 v[56:59], v9 offset:10240
    v_mfma_f32_16x16x32_bf16 v[32:35], a[28:31], v[60:63], v[32:35]
    s_mul_i32 s51, s35, 6144
    v_mfma_f32_16x16x32_bf16 v[36:39], a[32:35], v[60:63], v[36:39]
    s_waitcnt lgkmcnt(4)
    v_mfma_f32_16x16x32_bf16 v[16:19], a[36:39], v[40:43], v[16:19]
    ds_read_b128 v[60:63], v9 offset:10496
    v_mfma_f32_16x16x32_bf16 v[20:23], a[40:43], v[40:43], v[20:23]
    s_add_u32 s52, s52, s51
    v_mfma_f32_16x16x32_bf16 v[24:27], a[44:47], v[40:43], v[24:27]
    s_add_u32 m0, s59, 4096
    s_add_u32 s47, s41, 4096
    buffer_load_dwordx4 v0, s[8:11], s47 offen offset:0 lds
    s_waitcnt lgkmcnt(4)
    v_mfma_f32_16x16x32_bf16 v[28:31], a[36:39], v[44:47], v[28:31]
    buffer_load_dwordx4 v0, s[8:11], s47 offen offset:1024 lds
    ds_read_b128 v[40:43], v9 offset:12288
    v_mfma_f32_16x16x32_bf16 v[32:35], a[40:43], v[44:47], v[32:35]
    s_add_u32 s52, s52, 16121856
    v_mfma_f32_16x16x32_bf16 v[36:39], a[44:47], v[44:47], v[36:39]
    s_waitcnt lgkmcnt(4)
    v_mfma_f32_16x16x32_bf16 v[16:19], a[48:51], v[48:51], v[16:19]
    buffer_load_dwordx4 v0, s[8:11], s47 offen offset:2048 lds
    ds_read_b128 v[44:47], v9 offset:12544
    v_mfma_f32_16x16x32_bf16 v[20:23], a[52:55], v[48:51], v[20:23]
    v_mfma_f32_16x16x32_bf16 v[24:27], a[56:59], v[48:51], v[24:27]
    s_waitcnt lgkmcnt(4)
    v_mfma_f32_16x16x32_bf16 v[28:31], a[48:51], v[52:55], v[28:31]
    buffer_load_dwordx4 v0, s[8:11], s47 offen offset:3072 lds
    ds_read_b128 v[48:51], v9 offset:14336
    v_mfma_f32_16x16x32_bf16 v[32:35], a[52:55], v[52:55], v[32:35]
    v_mfma_f32_16x16x32_bf16 v[36:39], a[56:59], v[52:55], v[36:39]
    s_waitcnt lgkmcnt(4)
    v_mfma_f32_16x16x32_bf16 v[16:19], a[60:63], v[56:59], v[16:19]
    ds_read_b128 v[52:55], v9 offset:14592
    v_mfma_f32_16x16x32_bf16 v[20:23], a[64:67], v[56:59], v[20:23]
    s_add_u32 m0, s59, 8192
    s_add_u32 s47, s41, 8192
    buffer_load_dwordx4 v0, s[8:11], s47 offen offset:0 lds
    v_mfma_f32_16x16x32_bf16 v[24:27], a[68:71], v[56:59], v[24:27]
    s_waitcnt lgkmcnt(4)
    v_mfma_f32_16x16x32_bf16 v[28:31], a[60:63], v[60:63], v[28:31]
    s_mul_i32 s48, s36, 4718592
    s_mul_i32 s18, s37, 36864
    s_add_u32 s48, s48, s18
    s_add_u32 s48, s48, 6291456
    buffer_load_dwordx4 v[64:67], v10, s[8:11], s48 offen offset:0
    ds_read_b128 v[56:59], v9 offset:16384
    v_mfma_f32_16x16x32_bf16 v[32:35], a[64:67], v[60:63], v[32:35]
    v_cmp_eq_u32 s[76:77], 1, v2
    v_cmp_eq_u32 vcc, 2, v2
    v_mfma_f32_16x16x32_bf16 v[36:39], a[68:71], v[60:63], v[36:39]
    s_cmp_eq_u64 s[76:77], -1
    s_cselect_b32 s38, 1, 0
    s_waitcnt lgkmcnt(4)
    v_mfma_f32_16x16x32_bf16 v[16:19], a[72:75], v[40:43], v[16:19]
    s_cmp_lg_u32 s38, 0
    s_cselect_b64 exec, 1, 0
    v_mov_b32 v15, s32
    ds_write_b32 v184, v15
    v_mov_b32 v2, 2
    s_mov_b64 exec, -1
    ds_read_b128 v[60:63], v9 offset:16640
    v_mfma_f32_16x16x32_bf16 v[20:23], a[76:79], v[40:43], v[20:23]
    s_add_u32 s32, s32, s38
    s_mul_i32 s38, s38, 22528
    s_add_u32 s33, s33, s38
    v_mfma_f32_16x16x32_bf16 v[24:27], a[80:83], v[40:43], v[24:27]
    s_cmp_eq_u64 vcc, 0
    s_cselect_b32 s38, s32, 0x7fff
    s_waitcnt lgkmcnt(5)
    v_mfma_f32_16x16x32_bf16 v[28:31], a[72:75], v[44:47], v[28:31]
    s_cmp_le_u32 s38, s39
    s_cselect_b64 exec, -1, 0
    v_mov_b32 v2, 2
    buffer_load_dword v2, v1, s[8:11], s33 offen sc1
    s_mov_b64 exec, -1
    ds_read_b128 v[40:43], v9 offset:18432
    v_mfma_f32_16x16x32_bf16 v[32:35], a[76:79], v[44:47], v[32:35]
    buffer_load_dwordx2 v[68:69], v12, s[8:11], s48 offen offset:0
    buffer_load_dwordx4 v[72:75], v10, s[8:11], s48 offen offset:256
    v_mfma_f32_16x16x32_bf16 v[36:39], a[80:83], v[44:47], v[36:39]
    s_waitcnt lgkmcnt(5)
    v_mfma_f32_16x16x32_bf16 v[16:19], a[84:87], v[48:51], v[16:19]
    buffer_load_dwordx2 v[76:77], v12, s[8:11], s48 offen offset:256
    ds_read_b128 v[44:47], v9 offset:18688
    v_mfma_f32_16x16x32_bf16 v[20:23], a[88:91], v[48:51], v[20:23]
    v_mfma_f32_16x16x32_bf16 v[24:27], a[92:95], v[48:51], v[24:27]
    s_waitcnt lgkmcnt(5)
    v_mfma_f32_16x16x32_bf16 v[28:31], a[84:87], v[52:55], v[28:31]
    ds_read_b128 v[48:51], v9 offset:20480
    v_mfma_f32_16x16x32_bf16 v[32:35], a[88:91], v[52:55], v[32:35]
    v_mfma_f32_16x16x32_bf16 v[36:39], a[92:95], v[52:55], v[36:39]
    s_waitcnt lgkmcnt(5)
    v_mfma_f32_16x16x32_bf16 v[16:19], a[96:99], v[56:59], v[16:19]
    ds_read_b128 v[52:55], v9 offset:20736
    v_mfma_f32_16x16x32_bf16 v[20:23], a[100:103], v[56:59], v[20:23]
    v_mfma_f32_16x16x32_bf16 v[24:27], a[104:107], v[56:59], v[24:27]
    s_waitcnt lgkmcnt(4)
    v_mfma_f32_16x16x32_bf16 v[28:31], a[96:99], v[60:63], v[28:31]
    ds_read_b128 v[56:59], v9 offset:22528
    v_mfma_f32_16x16x32_bf16 v[32:35], a[100:103], v[60:63], v[32:35]
    v_mfma_f32_16x16x32_bf16 v[36:39], a[104:107], v[60:63], v[36:39]
    s_waitcnt vmcnt(15)
    s_cmp_lg_u32 s43, 0
    s_cselect_b64 exec, 1, 0
    buffer_store_dword v3, v4, s[8:11], s43 offen sc1
    s_mov_b64 exec, -1
    s_mov_b32 s43, 0
    s_waitcnt lgkmcnt(4)
    v_mfma_f32_16x16x32_bf16 v[16:19], a[108:111], v[40:43], v[16:19]
    ds_read_b128 v[60:63], v9 offset:22784
    v_mfma_f32_16x16x32_bf16 v[20:23], a[112:115], v[40:43], v[20:23]
    v_mfma_f32_16x16x32_bf16 v[24:27], a[116:119], v[40:43], v[24:27]
    s_waitcnt lgkmcnt(4)
    v_mfma_f32_16x16x32_bf16 v[28:31], a[108:111], v[44:47], v[28:31]
    ds_read_b128 v[40:43], v9 offset:24576
    v_mfma_f32_16x16x32_bf16 v[32:35], a[112:115], v[44:47], v[32:35]
    v_mfma_f32_16x16x32_bf16 v[36:39], a[116:119], v[44:47], v[36:39]
    s_waitcnt lgkmcnt(4)
    v_mfma_f32_16x16x32_bf16 v[16:19], a[120:123], v[48:51], v[16:19]
    ds_read_b128 v[44:47], v9 offset:24832
    v_mfma_f32_16x16x32_bf16 v[20:23], a[124:127], v[48:51], v[20:23]
    v_mfma_f32_16x16x32_bf16 v[24:27], a[128:131], v[48:51], v[24:27]
    s_waitcnt lgkmcnt(4)
    v_mfma_f32_16x16x32_bf16 v[28:31], a[120:123], v[52:55], v[28:31]
    ds_read_b128 v[48:51], v9 offset:26624
    v_mfma_f32_16x16x32_bf16 v[32:35], a[124:127], v[52:55], v[32:35]
    v_mfma_f32_16x16x32_bf16 v[36:39], a[128:131], v[52:55], v[36:39]
    s_waitcnt lgkmcnt(4)
    v_mfma_f32_16x16x32_bf16 v[16:19], a[132:135], v[56:59], v[16:19]
    ds_read_b128 v[52:55], v9 offset:26880
    v_mfma_f32_16x16x32_bf16 v[20:23], a[136:139], v[56:59], v[20:23]
    v_mfma_f32_16x16x32_bf16 v[24:27], a[140:143], v[56:59], v[24:27]
    s_waitcnt lgkmcnt(4)
    v_mfma_f32_16x16x32_bf16 v[28:31], a[132:135], v[60:63], v[28:31]
    ds_read_b128 v[56:59], v9 offset:28672
    v_mfma_f32_16x16x32_bf16 v[32:35], a[136:139], v[60:63], v[32:35]
    v_mfma_f32_16x16x32_bf16 v[36:39], a[140:143], v[60:63], v[36:39]
    s_waitcnt lgkmcnt(4)
    v_mfma_f32_16x16x32_bf16 v[16:19], a[144:147], v[40:43], v[16:19]
    ds_read_b128 v[60:63], v9 offset:28928
    v_mfma_f32_16x16x32_bf16 v[20:23], a[148:151], v[40:43], v[20:23]
    v_mfma_f32_16x16x32_bf16 v[24:27], a[152:155], v[40:43], v[24:27]
    s_waitcnt lgkmcnt(4)
    v_mfma_f32_16x16x32_bf16 v[28:31], a[144:147], v[44:47], v[28:31]
    ds_read_b128 v[40:43], v9 offset:30720
    v_mfma_f32_16x16x32_bf16 v[32:35], a[148:151], v[44:47], v[32:35]
    v_mfma_f32_16x16x32_bf16 v[36:39], a[152:155], v[44:47], v[36:39]
    s_waitcnt lgkmcnt(4)
    v_mfma_f32_16x16x32_bf16 v[16:19], a[156:159], v[48:51], v[16:19]
    ds_read_b128 v[44:47], v9 offset:30976
    v_mfma_f32_16x16x32_bf16 v[20:23], a[160:163], v[48:51], v[20:23]
    v_mfma_f32_16x16x32_bf16 v[24:27], a[164:167], v[48:51], v[24:27]
    s_waitcnt lgkmcnt(4)
    v_mfma_f32_16x16x32_bf16 v[28:31], a[156:159], v[52:55], v[28:31]
    ds_read_b128 v[48:51], v9 offset:32768
    v_mfma_f32_16x16x32_bf16 v[32:35], a[160:163], v[52:55], v[32:35]
    v_mfma_f32_16x16x32_bf16 v[36:39], a[164:167], v[52:55], v[36:39]
    s_waitcnt lgkmcnt(4)
    v_mfma_f32_16x16x32_bf16 v[16:19], a[168:171], v[56:59], v[16:19]
    ds_read_b128 v[52:55], v9 offset:33024
    v_mfma_f32_16x16x32_bf16 v[20:23], a[172:175], v[56:59], v[20:23]
    v_mfma_f32_16x16x32_bf16 v[24:27], a[176:179], v[56:59], v[24:27]
    s_waitcnt lgkmcnt(4)
    v_mfma_f32_16x16x32_bf16 v[28:31], a[168:171], v[60:63], v[28:31]
    v_cmp_eq_u32 s[76:77], 1, v2
    v_cmp_eq_u32 vcc, 2, v2
    ds_read_b128 v[56:59], v9 offset:34816
    v_mfma_f32_16x16x32_bf16 v[32:35], a[172:175], v[60:63], v[32:35]
    s_cmp_eq_u64 s[76:77], -1
    s_cselect_b32 s38, 1, 0
    v_mfma_f32_16x16x32_bf16 v[36:39], a[176:179], v[60:63], v[36:39]
    s_cmp_lg_u32 s38, 0
    s_cselect_b64 exec, 1, 0
    v_mov_b32 v15, s32
    ds_write_b32 v184, v15
    v_mov_b32 v2, 2
    s_mov_b64 exec, -1
    s_waitcnt lgkmcnt(5)
    v_mfma_f32_16x16x32_bf16 v[16:19], a[180:183], v[40:43], v[16:19]
    ds_read_b128 v[60:63], v9 offset:35072
    v_mfma_f32_16x16x32_bf16 v[20:23], a[184:187], v[40:43], v[20:23]
    s_add_u32 s32, s32, s38
    s_mul_i32 s38, s38, 22528
    s_add_u32 s33, s33, s38
    v_mfma_f32_16x16x32_bf16 v[24:27], a[188:191], v[40:43], v[24:27]
    s_cmp_eq_u64 vcc, 0
    s_cselect_b32 s38, s32, 0x7fff
    s_waitcnt lgkmcnt(5)
    v_mfma_f32_16x16x32_bf16 v[28:31], a[180:183], v[44:47], v[28:31]
    s_cmp_le_u32 s38, s39
    s_cselect_b64 exec, -1, 0
    v_mov_b32 v2, 2
    buffer_load_dword v2, v1, s[8:11], s33 offen sc1
    s_mov_b64 exec, -1
    v_mfma_f32_16x16x32_bf16 v[32:35], a[184:187], v[44:47], v[32:35]
    v_mfma_f32_16x16x32_bf16 v[36:39], a[188:191], v[44:47], v[36:39]
    s_waitcnt lgkmcnt(4)
    v_mfma_f32_16x16x32_bf16 v[16:19], a[192:195], v[48:51], v[16:19]
    v_mfma_f32_16x16x32_bf16 v[20:23], a[196:199], v[48:51], v[20:23]
    v_mfma_f32_16x16x32_bf16 v[24:27], a[200:203], v[48:51], v[24:27]
    s_waitcnt lgkmcnt(3)
    v_mfma_f32_16x16x32_bf16 v[28:31], a[192:195], v[52:55], v[28:31]
    v_mfma_f32_16x16x32_bf16 v[32:35], a[196:199], v[52:55], v[32:35]
    v_mfma_f32_16x16x32_bf16 v[36:39], a[200:203], v[52:55], v[36:39]
    s_waitcnt lgkmcnt(2)
    v_mfma_f32_16x16x32_bf16 v[16:19], a[204:207], v[56:59], v[16:19]
    v_mfma_f32_16x16x32_bf16 v[20:23], a[208:211], v[56:59], v[20:23]
    v_mfma_f32_16x16x32_bf16 v[24:27], a[212:215], v[56:59], v[24:27]
    s_waitcnt lgkmcnt(0)
    v_mfma_f32_16x16x32_bf16 v[28:31], a[204:207], v[60:63], v[28:31]
    v_mfma_f32_16x16x32_bf16 v[32:35], a[208:211], v[60:63], v[32:35]
    v_mfma_f32_16x16x32_bf16 v[36:39], a[212:215], v[60:63], v[36:39]
    v_mov_b32 v88, 0x3f803f80
    v_cvt_pk_bf16_f32 v96, v16, v17
    v_cvt_pk_bf16_f32 v97, v18, v19
    v_cvt_pk_bf16_f32 v98, v20, v21
    v_cvt_pk_bf16_f32 v99, v22, v23
    v_cvt_pk_bf16_f32 v100, v24, v25
    v_cvt_pk_bf16_f32 v101, v26, v27
    buffer_store_dwordx4 v[96:99], v10, s[8:11], s46 offen offset:0 sc1
    buffer_store_dwordx2 v[100:101], v12, s[8:11], s46 offen offset:0 sc1
    v_cvt_pk_bf16_f32 v104, v28, v29
    v_cvt_pk_bf16_f32 v105, v30, v31
    v_cvt_pk_bf16_f32 v106, v32, v33
    v_cvt_pk_bf16_f32 v107, v34, v35
    v_cvt_pk_bf16_f32 v108, v36, v37
    v_cvt_pk_bf16_f32 v109, v38, v39
    buffer_store_dwordx4 v[104:107], v10, s[8:11], s46 offen offset:256 sc1
    buffer_store_dwordx2 v[108:109], v12, s[8:11], s46 offen offset:256 sc1
    v_mov_b32 v80, 0
    v_mov_b32 v81, 0
    v_mov_b32 v84, 0
    v_mov_b32 v85, 0
    v_dot2c_f32_bf16 v80, v96, v88
    v_dot2c_f32_bf16 v81, v96, v96
    v_dot2c_f32_bf16 v84, v104, v88
    v_dot2c_f32_bf16 v85, v104, v104
    v_dot2c_f32_bf16 v80, v97, v88
    v_dot2c_f32_bf16 v81, v97, v97
    v_dot2c_f32_bf16 v84, v105, v88
    v_dot2c_f32_bf16 v85, v105, v105
    v_dot2c_f32_bf16 v80, v98, v88
    v_dot2c_f32_bf16 v81, v98, v98
    v_dot2c_f32_bf16 v84, v106, v88
    v_dot2c_f32_bf16 v85, v106, v106
    v_dot2c_f32_bf16 v80, v99, v88
    v_dot2c_f32_bf16 v81, v99, v99
    v_dot2c_f32_bf16 v84, v107, v88
    v_dot2c_f32_bf16 v85, v107, v107
    v_dot2c_f32_bf16 v80, v100, v88
    v_dot2c_f32_bf16 v81, v100, v100
    v_dot2c_f32_bf16 v84, v108, v88
    v_dot2c_f32_bf16 v85, v108, v108
    v_dot2c_f32_bf16 v80, v101, v88
    v_dot2c_f32_bf16 v81, v101, v101
    v_dot2c_f32_bf16 v84, v109, v88
    v_dot2c_f32_bf16 v85, v109, v109
    s_nop 2
    v_mov_b32 v82, v80
    v_mov_b32 v83, v81
    v_mov_b32 v86, v84
    v_mov_b32 v87, v85
    v_permlane32_swap_b32 v80, v82
    v_permlane32_swap_b32 v81, v83
    v_permlane32_swap_b32 v84, v86
    v_permlane32_swap_b32 v85, v87
    v_add_f32 v80, v80, v82
    v_add_f32 v81, v81, v83
    v_add_f32 v84, v84, v86
    v_add_f32 v85, v85, v87
    v_mov_b32 v82, v80
    v_mov_b32 v83, v81
    v_mov_b32 v86, v84
    v_mov_b32 v87, v85
    v_permlane16_swap_b32 v80, v82
    v_permlane16_swap_b32 v81, v83
    v_permlane16_swap_b32 v84, v86
    v_permlane16_swap_b32 v85, v87
    v_add_f32 v80, v80, v82
    v_add_f32 v81, v81, v83
    v_add_f32 v84, v84, v86
    v_add_f32 v85, v85, v87
    s_mov_b64 exec, 0xffff
    buffer_store_dwordx2 v[80:81], v11, s[8:11], s52 offen offset:0 sc1
    buffer_store_dwordx2 v[84:85], v11, s[8:11], s52 offen offset:256 sc1
    s_mov_b64 exec, -1
    s_mul_i32 s43, s57, 22528
    s_add_u32 s43, s43, s49
    s_branch Lawo_head
Lawo_f_6:
    v_mfma_f32_16x16x32_bf16 v[16:19], a[96:99], v[56:59], v[16:19]
    ds_read_b128 v[52:55], v9 offset:20736
    v_mfma_f32_16x16x32_bf16 v[20:23], a[100:103], v[56:59], v[20:23]
    s_add_u32 m0, s59, 0
    s_add_u32 s47, s41, 0
    buffer_load_dwordx4 v0, s[8:11], s47 offen offset:0 lds
    v_mfma_f32_16x16x32_bf16 v[24:27], a[104:107], v[56:59], v[24:27]
    v_mfma_f32_16x16x32_bf16 v[28:31], a[96:99], v[60:63], v[28:31]
    buffer_load_dwordx4 v0, s[8:11], s47 offen offset:1024 lds
    ds_read_b128 v[56:59], v9 offset:22528
    v_mfma_f32_16x16x32_bf16 v[32:35], a[100:103], v[60:63], v[32:35]
    v_mfma_f32_16x16x32_bf16 v[36:39], a[104:107], v[60:63], v[36:39]
    s_waitcnt vmcnt(4)
    s_cmp_lg_u32 s43, 0
    s_cselect_b64 exec, 1, 0
    buffer_store_dword v3, v4, s[8:11], s43 offen sc1
    s_mov_b64 exec, -1
    s_mov_b32 s43, 0
    v_mfma_f32_16x16x32_bf16 v[16:19], a[108:111], v[40:43], v[16:19]
    buffer_load_dwordx4 v0, s[8:11], s47 offen offset:2048 lds
    ds_read_b128 v[60:63], v9 offset:22784
    v_mfma_f32_16x16x32_bf16 v[20:23], a[112:115], v[40:43], v[20:23]
    v_mfma_f32_16x16x32_bf16 v[24:27], a[116:119], v[40:43], v[24:27]
    s_waitcnt lgkmcnt(4)
    v_mfma_f32_16x16x32_bf16 v[28:31], a[108:111], v[44:47], v[28:31]
    buffer_load_dwordx4 v0, s[8:11], s47 offen offset:3072 lds
    ds_read_b128 v[40:43], v9 offset:24576
    v_mfma_f32_16x16x32_bf16 v[32:35], a[112:115], v[44:47], v[32:35]
    v_mfma_f32_16x16x32_bf16 v[36:39], a[116:119], v[44:47], v[36:39]
    s_waitcnt lgkmcnt(4)
    v_mfma_f32_16x16x32_bf16 v[16:19], a[120:123], v[48:51], v[16:19]
    ds_read_b128 v[44:47], v9 offset:24832
    v_mfma_f32_16x16x32_bf16 v[20:23], a[124:127], v[48:51], v[20:23]
    s_add_u32 m0, s59, 4096
    s_add_u32 s47, s41, 4096
    buffer_load_dwordx4 v0, s[8:11], s47 offen offset:0 lds
    v_mfma_f32_16x16x32_bf16 v[24:27], a[128:131], v[48:51], v[24:27]
    s_waitcnt lgkmcnt(4)
    v_mfma_f32_16x16x32_bf16 v[28:31], a[120:123], v[52:55], v[28:31]
    buffer_load_dwordx4 v0, s[8:11], s47 offen offset:1024 lds
    ds_read_b128 v[48:51], v9 offset:26624
    v_mfma_f32_16x16x32_bf16 v[32:35], a[124:127], v[52:55], v[32:35]
    v_mfma_f32_16x16x32_bf16 v[36:39], a[128:131], v[52:55], v[36:39]
    s_waitcnt lgkmcnt(4)
    v_mfma_f32_16x16x32_bf16 v[16:19], a[132:135], v[56:59], v[16:19]
    buffer_load_dwordx4 v0, s[8:11], s47 offen offset:2048 lds
    ds_read_b128 v[52:55], v9 offset:26880
    v_mfma_f32_16x16x32_bf16 v[20:23], a[136:139], v[56:59], v[20:23]
    v_mfma_f32_16x16x32_bf16 v[24:27], a[140:143], v[56:59], v[24:27]
    s_waitcnt lgkmcnt(4)
    v_mfma_f32_16x16x32_bf16 v[28:31], a[132:135], v[60:63], v[28:31]
    buffer_load_dwordx4 v0, s[8:11], s47 offen offset:3072 lds
    ds_read_b128 v[56:59], v9 offset:28672
    v_mfma_f32_16x16x32_bf16 v[32:35], a[136:139], v[60:63], v[32:35]
    v_mfma_f32_16x16x32_bf16 v[36:39], a[140:143], v[60:63], v[36:39]
    s_waitcnt lgkmcnt(4)
    v_mfma_f32_16x16x32_bf16 v[16:19], a[144:147], v[40:43], v[16:19]
    ds_read_b128 v[60:63], v9 offset:28928
    v_mfma_f32_16x16x32_bf16 v[20:23], a[148:151], v[40:43], v[20:23]
    s_add_u32 m0, s59, 8192
    s_add_u32 s47, s41, 8192
    buffer_load_dwordx4 v0, s[8:11], s47 offen offset:0 lds
    v_mfma_f32_16x16x32_bf16 v[24:27], a[152:155], v[40:43], v[24:27]
    s_waitcnt lgkmcnt(4)
    v_mfma_f32_16x16x32_bf16 v[28:31], a[144:147], v[44:47], v[28:31]
    s_mul_i32 s48, s36, 4718592
    s_mul_i32 s18, s37, 36864
    s_add_u32 s48, s48, s18
    s_add_u32 s48, s48, 6291456
    buffer_load_dwordx4 v[64:67], v10, s[8:11], s48 offen offset:0
    ds_read_b128 v[40:43], v9 offset:30720
    v_mfma_f32_16x16x32_bf16 v[32:35], a[148:151], v[44:47], v[32:35]
    v_mfma_f32_16x16x32_bf16 v[36:39], a[152:155], v[44:47], v[36:39]
    s_waitcnt lgkmcnt(4)
    v_mfma_f32_16x16x32_bf16 v[16:19], a[156:159], v[48:51], v[16:19]
    buffer_load_dwordx2 v[68:69], v12, s[8:11], s48 offen offset:0
    ds_read_b128 v[44:47], v9 offset:30976
    v_mfma_f32_16x16x32_bf16 v[20:23], a[160:163], v[48:51], v[20:23]
    v_mfma_f32_16x16x32_bf16 v[24:27], a[164:167], v[48:51], v[24:27]
    s_waitcnt lgkmcnt(4)
    v_mfma_f32_16x16x32_bf16 v[28:31], a[156:159], v[52:55], v[28:31]
    buffer_load_dwordx4 v[72:75], v10, s[8:11], s48 offen offset:256
    ds_read_b128 v[48:51], v9 offset:32768
    v_mfma_f32_16x16x32_bf16 v[32:35], a[160:163], v[52:55], v[32:35]
    v_mfma_f32_16x16x32_bf16 v[36:39], a[164:167], v[52:55], v[36:39]
    s_waitcnt lgkmcnt(4)
    v_mfma_f32_16x16x32_bf16 v[16:19], a[168:171], v[56:59], v[16:19]
    buffer_load_dwordx2 v[76:77], v12, s[8:11], s48 offen offset:256
    ds_read_b128 v[52:55], v9 offset:33024
    v_mfma_f32_16x16x32_bf16 v[20:23], a[172:175], v[56:59], v[20:23]
    v_mfma_f32_16x16x32_bf16 v[24:27], a[176:179], v[56:59], v[24:27]
    s_waitcnt lgkmcnt(4)
    v_mfma_f32_16x16x32_bf16 v[28:31], a[168:171], v[60:63], v[28:31]
    v_cmp_eq_u32 s[76:77], 1, v2
    v_cmp_eq_u32 vcc, 2, v2
    ds_read_b128 v[56:59], v9 offset:34816
    v_mfma_f32_16x16x32_bf16 v[32:35], a[172:175], v[60:63], v[32:35]
    s_cmp_eq_u64 s[76:77], -1
    s_cselect_b32 s38, 1, 0
    v_mfma_f32_16x16x32_bf16 v[36:39], a[176:179], v[60:63], v[36:39]
    s_cmp_lg_u32 s38, 0
    s_cselect_b64 exec, 1, 0
    v_mov_b32 v15, s32
    ds_write_b32 v184, v15
    v_mov_b32 v2, 2
    s_mov_b64 exec, -1
    s_waitcnt lgkmcnt(5)
    v_mfma_f32_16x16x32_bf16 v[16:19], a[180:183], v[40:43], v[16:19]
    ds_read_b128 v[60:63], v9 offset:35072
    v_mfma_f32_16x16x32_bf16 v[20:23], a[184:187], v[40:43], v[20:23]
    s_add_u32 s32, s32, s38
    s_mul_i32 s38, s38, 22528
    s_add_u32 s33, s33, s38
    v_mfma_f32_16x16x32_bf16 v[24:27], a[188:191], v[40:43], v[24:27]
    s_cmp_eq_u64 vcc, 0
    s_cselect_b32 s38, s32, 0x7fff
    s_waitcnt lgkmcnt(5)
    v_mfma_f32_16x16x32_bf16 v[28:31], a[180:183], v[44:47], v[28:31]
    s_cmp_le_u32 s38, s39
    s_cselect_b64 exec, -1, 0
    v_mov_b32 v2, 2
    buffer_load_dword v2, v1, s[8:11], s33 offen sc1
    s_mov_b64 exec, -1
    v_mfma_f32_16x16x32_bf16 v[32:35], a[184:187], v[44:47], v[32:35]
    v_mfma_f32_16x16x32_bf16 v[36:39], a[188:191], v[44:47], v[36:39]
    s_waitcnt lgkmcnt(4)
    v_mfma_f32_16x16x32_bf16 v[16:19], a[192:195], v[48:51], v[16:19]
    v_mfma_f32_16x16x32_bf16 v[20:23], a[196:199], v[48:51], v[20:23]
    v_mfma_f32_16x16x32_bf16 v[24:27], a[200:203], v[48:51], v[24:27]
    s_waitcnt lgkmcnt(3)
    v_mfma_f32_16x16x32_bf16 v[28:31], a[192:195], v[52:55], v[28:31]
    v_mfma_f32_16x16x32_bf16 v[32:35], a[196:199], v[52:55], v[32:35]
    v_mfma_f32_16x16x32_bf16 v[36:39], a[200:203], v[52:55], v[36:39]
    s_waitcnt lgkmcnt(2)
    v_mfma_f32_16x16x32_bf16 v[16:19], a[204:207], v[56:59], v[16:19]
    v_mfma_f32_16x16x32_bf16 v[20:23], a[208:211], v[56:59], v[20:23]
    v_mfma_f32_16x16x32_bf16 v[24:27], a[212:215], v[56:59], v[24:27]
    s_waitcnt lgkmcnt(0)
    v_mfma_f32_16x16x32_bf16 v[28:31], a[204:207], v[60:63], v[28:31]
    v_mfma_f32_16x16x32_bf16 v[32:35], a[208:211], v[60:63], v[32:35]
    v_mfma_f32_16x16x32_bf16 v[36:39], a[212:215], v[60:63], v[36:39]
    v_mov_b32 v88, 0x3f803f80
    v_cvt_pk_bf16_f32 v96, v16, v17
    v_cvt_pk_bf16_f32 v97, v18, v19
    v_cvt_pk_bf16_f32 v98, v20, v21
    v_cvt_pk_bf16_f32 v99, v22, v23
    v_cvt_pk_bf16_f32 v100, v24, v25
    v_cvt_pk_bf16_f32 v101, v26, v27
    buffer_store_dwordx4 v[96:99], v10, s[8:11], s46 offen offset:0 sc1
    buffer_store_dwordx2 v[100:101], v12, s[8:11], s46 offen offset:0 sc1
    v_cvt_pk_bf16_f32 v104, v28, v29
    v_cvt_pk_bf16_f32 v105, v30, v31
    v_cvt_pk_bf16_f32 v106, v32, v33
    v_cvt_pk_bf16_f32 v107, v34, v35
    v_cvt_pk_bf16_f32 v108, v36, v37
    v_cvt_pk_bf16_f32 v109, v38, v39
    buffer_store_dwordx4 v[104:107], v10, s[8:11], s46 offen offset:256 sc1
    buffer_store_dwordx2 v[108:109], v12, s[8:11], s46 offen offset:256 sc1
    v_mov_b32 v80, 0
    v_mov_b32 v81, 0
    v_mov_b32 v84, 0
    v_mov_b32 v85, 0
    v_dot2c_f32_bf16 v80, v96, v88
    v_dot2c_f32_bf16 v81, v96, v96
    v_dot2c_f32_bf16 v84, v104, v88
    v_dot2c_f32_bf16 v85, v104, v104
    v_dot2c_f32_bf16 v80, v97, v88
    v_dot2c_f32_bf16 v81, v97, v97
    v_dot2c_f32_bf16 v84, v105, v88
    v_dot2c_f32_bf16 v85, v105, v105
    v_dot2c_f32_bf16 v80, v98, v88
    v_dot2c_f32_bf16 v81, v98, v98
    v_dot2c_f32_bf16 v84, v106, v88
    v_dot2c_f32_bf16 v85, v106, v106
    v_dot2c_f32_bf16 v80, v99, v88
    v_dot2c_f32_bf16 v81, v99, v99
    v_dot2c_f32_bf16 v84, v107, v88
    v_dot2c_f32_bf16 v85, v107, v107
    v_dot2c_f32_bf16 v80, v100, v88
    v_dot2c_f32_bf16 v81, v100, v100
    v_dot2c_f32_bf16 v84, v108, v88
    v_dot2c_f32_bf16 v85, v108, v108
    v_dot2c_f32_bf16 v80, v101, v88
    v_dot2c_f32_bf16 v81, v101, v101
    v_dot2c_f32_bf16 v84, v109, v88
    v_dot2c_f32_bf16 v85, v109, v109
    s_nop 2
    v_mov_b32 v82, v80
    v_mov_b32 v83, v81
    v_mov_b32 v86, v84
    v_mov_b32 v87, v85
    v_permlane32_swap_b32 v80, v82
    v_permlane32_swap_b32 v81, v83
    v_permlane32_swap_b32 v84, v86
    v_permlane32_swap_b32 v85, v87
    v_add_f32 v80, v80, v82
    v_add_f32 v81, v81, v83
    v_add_f32 v84, v84, v86
    v_add_f32 v85, v85, v87
    v_mov_b32 v82, v80
    v_mov_b32 v83, v81
    v_mov_b32 v86, v84
    v_mov_b32 v87, v85
    v_permlane16_swap_b32 v80, v82
    v_permlane16_swap_b32 v81, v83
    v_permlane16_swap_b32 v84, v86
    v_permlane16_swap_b32 v85, v87
    v_add_f32 v80, v80, v82
    v_add_f32 v81, v81, v83
    v_add_f32 v84, v84, v86
    v_add_f32 v85, v85, v87
    s_mov_b64 exec, 0xffff
    buffer_store_dwordx2 v[80:81], v11, s[8:11], s52 offen offset:0 sc1
    buffer_store_dwordx2 v[84:85], v11, s[8:11], s52 offen offset:256 sc1
    s_mov_b64 exec, -1
    s_mul_i32 s43, s57, 22528
    s_add_u32 s43, s43, s49
    s_branch Lawo_head
Lawo_none:
    ds_read_b32 v15, v184
    s_waitcnt lgkmcnt(0)
    v_readfirstlane_b32 s17, v15
    s_nop 0
    s_cmp_lt_i32 s17, s37
    s_cbranch_scc1 Lawo_nopost
    s_add_u32 m0, s59, 0
    s_add_u32 s47, s41, 0
    buffer_load_dwordx4 v0, s[8:11], s47 offen offset:0 lds
    buffer_load_dwordx4 v0, s[8:11], s47 offen offset:1024 lds
    buffer_load_dwordx4 v0, s[8:11], s47 offen offset:2048 lds
    buffer_load_dwordx4 v0, s[8:11], s47 offen offset:3072 lds
    s_add_u32 m0, s59, 4096
    s_add_u32 s47, s41, 4096
    buffer_load_dwordx4 v0, s[8:11], s47 offen offset:0 lds
    buffer_load_dwordx4 v0, s[8:11], s47 offen offset:1024 lds
    buffer_load_dwordx4 v0, s[8:11], s47 offen offset:2048 lds
    buffer_load_dwordx4 v0, s[8:11], s47 offen offset:3072 lds
    s_add_u32 m0, s59, 8192
    s_add_u32 s47, s41, 8192
    buffer_load_dwordx4 v0, s[8:11], s47 offen offset:0 lds
    s_mul_i32 s48, s36, 4718592
    s_mul_i32 s18, s37, 36864
    s_add_u32 s48, s48, s18
    s_add_u32 s48, s48, 6291456
    buffer_load_dwordx4 v[64:67], v10, s[8:11], s48 offen offset:0
    buffer_load_dwordx2 v[68:69], v12, s[8:11], s48 offen offset:0
    buffer_load_dwordx4 v[72:75], v10, s[8:11], s48 offen offset:256
    buffer_load_dwordx2 v[76:77], v12, s[8:11], s48 offen offset:256
    s_waitcnt vmcnt(13)
    s_cmp_lg_u32 s43, 0
    s_cselect_b64 exec, 1, 0
    buffer_store_dword v3, v4, s[8:11], s43 offen sc1
    s_mov_b64 exec, -1
    s_mov_b32 s43, 0
    s_waitcnt vmcnt(1) lgkmcnt(0)
    s_branch Lawo_head2
Lawo_nopost:
    s_waitcnt vmcnt(0)
    s_cmp_lg_u32 s43, 0
    s_cselect_b64 exec, 1, 0
    buffer_store_dword v3, v4, s[8:11], s43 offen sc1
    s_mov_b64 exec, -1
    s_mov_b32 s43, 0
    s_cmp_ge_u32 s37, 64
    s_cbranch_scc1 Lawo_end
Lawo_wait:
    s_mov_b32 s16, 0
    s_cmp_lg_u32 s14, 0
    s_cbranch_scc1 Lawo_wl
Lawo_wp:
    buffer_load_dword v2, v1, s[8:11], s60 offen sc1
    s_add_u32 s16, s16, 1
    s_cmp_gt_u32 s16, 100000
    s_cbranch_scc1 Lawo_giveup
    s_waitcnt vmcnt(0)
    v_cmp_eq_u32 vcc, 0, v2
    s_nop 0
    s_cbranch_vccz Lawo_wok
    s_sleep 4
    s_branch Lawo_wp
Lawo_giveup:
    v_mov_b32 v5, -2
    ds_write_b32 v184, v5
    s_waitcnt lgkmcnt(0)
    s_branch L_role_awo_abort
Lawo_wok:
    v_mov_b32 v5, s37
    ds_write_b32 v184, v5
    s_branch Lawo_go
Lawo_wl:
    ds_read_b32 v15, v184
    s_add_u32 s16, s16, 1
    s_cmp_gt_u32 s16, 1600000
    s_cbranch_scc1 L_role_awo_abort
    s_waitcnt lgkmcnt(0)
    v_readfirstlane_b32 s17, v15
    s_nop 0
    s_cmp_eq_u32 s17, -2
    s_cbranch_scc1 L_role_awo_abort
    s_cmp_ge_i32 s17, s37
    s_cbranch_scc1 Lawo_go
    s_sleep 1
    s_branch Lawo_wl
Lawo_go:
    s_add_u32 m0, s59, 0
    s_add_u32 s47, s41, 0
    buffer_load_dwordx4 v0, s[8:11], s47 offen offset:0 lds
    buffer_load_dwordx4 v0, s[8:11], s47 offen offset:1024 lds
    buffer_load_dwordx4 v0, s[8:11], s47 offen offset:2048 lds
    buffer_load_dwordx4 v0, s[8:11], s47 offen offset:3072 lds
    s_add_u32 m0, s59, 4096
    s_add_u32 s47, s41, 4096
    buffer_load_dwordx4 v0, s[8:11], s47 offen offset:0 lds
    buffer_load_dwordx4 v0, s[8:11], s47 offen offset:1024 lds
    buffer_load_dwordx4 v0, s[8:11], s47 offen offset:2048 lds
    buffer_load_dwordx4 v0, s[8:11], s47 offen offset:3072 lds
    s_add_u32 m0, s59, 8192
    s_add_u32 s47, s41, 8192
    buffer_load_dwordx4 v0, s[8:11], s47 offen offset:0 lds
    s_mul_i32 s48, s36, 4718592
    s_mul_i32 s18, s37, 36864
    s_add_u32 s48, s48, s18
    s_add_u32 s48, s48, 6291456
    buffer_load_dwordx4 v[64:67], v10, s[8:11], s48 offen offset:0
    buffer_load_dwordx2 v[68:69], v12, s[8:11], s48 offen offset:0
    buffer_load_dwordx4 v[72:75], v10, s[8:11], s48 offen offset:256
    buffer_load_dwordx2 v[76:77], v12, s[8:11], s48 offen offset:256
    s_waitcnt vmcnt(0) lgkmcnt(0)
    s_branch Lawo_head2
Lawo_end:
    s_branch L_role_awo_exit
L_role_awo_abort:
    s_waitcnt lgkmcnt(0)
    s_mov_b64 exec, -1
    v_mov_b32 v0, 60
    s_lshl_b32 s5, s3, 8
    s_or_b32 s5, s5, s4
    s_or_b32 s5, s5, 0x10000
    v_mov_b32 v1, s5
    global_store_dword v0, v1, s[12:13]
    s_endpgm
L_role_awo_exit:
    s_endpgm
.p2align 6
L_role_aq:
    v_and_b32 v5, 63, v0
    v_lshlrev_b32 v0, 4, v5
    v_and_b32 v7, 15, v5
    v_lshrrev_b32 v8, 4, v5
    v_min_u32 v1, 47, v5
    v_lshrrev_b32 v6, 2, v1
    v_and_b32 v1, 3, v1
    v_lshlrev_b32 v1, 2, v1
    v_lshl_add_u32 v1, v6, 7, v1
    v_mov_b32 v3, 1
    v_mov_b32 v4, 0
    s_mov_b32 s44, 0x05040100
    s_mov_b32 s45, 0x07060302
    s_lshr_b32 s63, s15, 4
    s_and_b32 s15, s15, 15
    s_lshr_b32 s50, s15, 1
    s_lshl_b32 s50, s50, 2
    s_and_b32 s17, s15, 1
    s_add_u32 s50, s50, s17
    s_and_b32 s17, s14, 2
    s_add_u32 s50, s50, s17
    s_and_b32 s51, s14, 1
    s_cmp_eq_u32 s63, 0
    s_cbranch_scc1 Laq_gate_ng
    s_cmp_lg_u32 s14, 0
    s_cbranch_scc1 Laq_gate_d
    v_mov_b32 v5, 48
    s_mov_b32 s16, 0
Laq_gate:
    global_load_dword v6, v5, s[12:13] sc1
    s_add_u32 s16, s16, 1
    s_cmp_gt_u32 s16, 100000
    s_cbranch_scc1 L_role_aq_abort
    s_waitcnt vmcnt(0)
    v_cmp_gt_u32 vcc, 32, v6
    s_nop 0
    s_cbranch_vccz Laq_gate_d
    s_sleep 100
    s_branch Laq_gate
Laq_gate_d:
    s_barrier
Laq_gate_ng:
    s_load_dwordx2 s[20:21], s[0:1], 8
    s_mov_b32 s22, 1990656
    s_mov_b32 s23, 0x00020000
    s_waitcnt lgkmcnt(0)
    s_and_b32 s21, s21, 0xffff
    v_lshrrev_b32 v5, 7, v0
    v_mul_u32_u24 v16, 3456, v5
    v_and_b32 v5, 0x70, v0
    v_add_u32 v16, v16, v5
    s_lshr_b32 s17, s14, 1
    s_mul_i32 s46, s17, 72
    v_lshrrev_b32 v5, 2, v7
    v_lshl_add_u32 v5, v8, 3, v5
    v_and_b32 v6, 3, v7
    v_lshlrev_b32 v17, 7, v5
    v_lshl_add_u32 v17, v6, 3, v17
    v_add_u32 v17, s46, v17
    v_lshlrev_b32 v18, 5, v5
    v_min_u32 v6, 1, v6
    v_lshl_add_u32 v18, v6, 4, v18
    s_mul_i32 s17, s17, 3072
    s_add_u32 s17, s17, 36864
    v_add_u32 v18, s17, v18
    s_sub_u32 s17, s50, s14
    s_lshr_b32 s17, s14, 1
    s_lshl_b32 s17, s17, 1
    s_sub_u32 s17, s50, s17
    s_mul_i32 s49, s17, 36
    s_mul_i32 s17, s14, 82944
    s_add_u32 s49, s49, s17
    s_mul_i32 s47, s14, 3072
    v_lshrrev_b32 v21, 4, v0
    s_lshl_b32 s17, s14, 6
    v_add_u32 v21, s17, v21
    v_cmp_le_u32 vcc, 96, v21
    s_nop 1
    v_cndmask_b32 v5, 0, 1, vcc
    v_mul_u32_u24 v6, 96, v5
    v_sub_u32 v6, v21, v6
    v_lshlrev_b32 v19, 7, v6
    v_mul_u32_u24 v20, 72, v5
    v_add_u32 v19, v19, v20
    v_add_u32 v19, 32, v19
    v_lshlrev_b32 v20, 5, v21
    v_add_u32 v20, 36864, v20
    v_mov_b32 v24, 0
    v_mov_b32 v25, 0
    v_mov_b32 v26, 0
    v_mov_b32 v27, 0
    v_mov_b32 v31, 0
    s_cmp_eq_u32 s14, 3
    s_cselect_b64 s[76:77], 0, -1
    s_mov_b64 exec, s[76:77]
    v_add_u32 v22, 0, v20
    ds_write_b128 v22, v[24:27] offset:16
    v_add_u32 v22, 43008, v20
    ds_write_b128 v22, v[24:27] offset:16
    v_add_u32 v22, 86016, v20
    ds_write_b128 v22, v[24:27] offset:16
    s_mov_b64 exec, -1
    s_add_u32 m0, s47, 0
    s_add_u32 s17, s49, 0
    buffer_load_dwordx4 v16, s[20:23], s17 offen lds
    s_add_u32 m0, s47, 1024
    s_add_u32 s17, s49, 27648
    buffer_load_dwordx4 v16, s[20:23], s17 offen lds
    s_add_u32 m0, s47, 2048
    s_add_u32 s17, s49, 55296
    buffer_load_dwordx4 v16, s[20:23], s17 offen lds
    s_add_u32 m0, s47, 12288
    s_add_u32 s17, s49, 1152
    buffer_load_dwordx4 v16, s[20:23], s17 offen lds
    s_add_u32 m0, s47, 13312
    s_add_u32 s17, s49, 28800
    buffer_load_dwordx4 v16, s[20:23], s17 offen lds
    s_add_u32 m0, s47, 14336
    s_add_u32 s17, s49, 56448
    buffer_load_dwordx4 v16, s[20:23], s17 offen lds
    s_add_u32 m0, s47, 24576
    s_add_u32 s17, s49, 2304
    buffer_load_dwordx4 v16, s[20:23], s17 offen lds
    s_add_u32 m0, s47, 25600
    s_add_u32 s17, s49, 29952
    buffer_load_dwordx4 v16, s[20:23], s17 offen lds
    s_add_u32 m0, s47, 26624
    s_add_u32 s17, s49, 57600
    buffer_load_dwordx4 v16, s[20:23], s17 offen lds
    s_add_u32 m0, s47, 43008
    s_add_u32 s17, s49, 331776
    buffer_load_dwordx4 v16, s[20:23], s17 offen lds
    s_add_u32 m0, s47, 44032
    s_add_u32 s17, s49, 359424
    buffer_load_dwordx4 v16, s[20:23], s17 offen lds
    s_add_u32 m0, s47, 45056
    s_add_u32 s17, s49, 387072
    buffer_load_dwordx4 v16, s[20:23], s17 offen lds
    s_add_u32 m0, s47, 55296
    s_add_u32 s17, s49, 332928
    buffer_load_dwordx4 v16, s[20:23], s17 offen lds
    s_add_u32 m0, s47, 56320
    s_add_u32 s17, s49, 360576
    buffer_load_dwordx4 v16, s[20:23], s17 offen lds
    s_add_u32 m0, s47, 57344
    s_add_u32 s17, s49, 388224
    buffer_load_dwordx4 v16, s[20:23], s17 offen lds
    s_add_u32 m0, s47, 67584
    s_add_u32 s17, s49, 334080
    buffer_load_dwordx4 v16, s[20:23], s17 offen lds
    s_add_u32 m0, s47, 68608
    s_add_u32 s17, s49, 361728
    buffer_load_dwordx4 v16, s[20:23], s17 offen lds
    s_add_u32 m0, s47, 69632
    s_add_u32 s17, s49, 389376
    buffer_load_dwordx4 v16, s[20:23], s17 offen lds
    s_add_u32 m0, s47, 86016
    s_add_u32 s17, s49, 663552
    buffer_load_dwordx4 v16, s[20:23], s17 offen lds
    s_add_u32 m0, s47, 87040
    s_add_u32 s17, s49, 691200
    buffer_load_dwordx4 v16, s[20:23], s17 offen lds
    s_add_u32 m0, s47, 88064
    s_add_u32 s17, s49, 718848
    buffer_load_dwordx4 v16, s[20:23], s17 offen lds
    s_add_u32 m0, s47, 98304
    s_add_u32 s17, s49, 664704
    buffer_load_dwordx4 v16, s[20:23], s17 offen lds
    s_add_u32 m0, s47, 99328
    s_add_u32 s17, s49, 692352
    buffer_load_dwordx4 v16, s[20:23], s17 offen lds
    s_add_u32 m0, s47, 100352
    s_add_u32 s17, s49, 720000
    buffer_load_dwordx4 v16, s[20:23], s17 offen lds
    s_add_u32 m0, s47, 110592
    s_add_u32 s17, s49, 665856
    buffer_load_dwordx4 v16, s[20:23], s17 offen lds
    s_add_u32 m0, s47, 111616
    s_add_u32 s17, s49, 693504
    buffer_load_dwordx4 v16, s[20:23], s17 offen lds
    s_add_u32 m0, s47, 112640
    s_add_u32 s17, s49, 721152
    buffer_load_dwordx4 v16, s[20:23], s17 offen lds
    s_waitcnt vmcnt(18) lgkmcnt(0)
    s_barrier
    s_mov_b64 exec, s[76:77]
    v_add_u32 v22, 0, v19
    ds_read_b32 v28, v22 offset:0
    ds_read_b32 v29, v22 offset:12288
    ds_read_b32 v30, v22 offset:24576
    s_waitcnt lgkmcnt(0)
    v_add_u32 v22, 0, v20
    ds_write_b128 v22, v[28:31]
    s_mov_b64 exec, -1
    v_add_u32 v22, 0, v17
    v_add_u32 v23, 0, v18
    ds_read_b64_tr_b16 v[152:153], v22 offset:0
    ds_read_b64_tr_b16 v[154:155], v22 offset:512
    ds_read_b64_tr_b16 v[224:225], v22 offset:12288
    ds_read_b64_tr_b16 v[226:227], v22 offset:12800
    ds_read_b64_tr_b16 a[112:113], v22 offset:24576
    ds_read_b64_tr_b16 a[114:115], v22 offset:25088
    ds_read_b64_tr_b16 v[156:157], v22 offset:4096
    ds_read_b64_tr_b16 v[158:159], v22 offset:4608
    ds_read_b64_tr_b16 v[228:229], v22 offset:16384
    ds_read_b64_tr_b16 v[230:231], v22 offset:16896
    ds_read_b64_tr_b16 a[116:117], v22 offset:28672
    ds_read_b64_tr_b16 a[118:119], v22 offset:29184
    ds_read_b64_tr_b16 v[160:161], v22 offset:8192
    ds_read_b64_tr_b16 v[162:163], v22 offset:8704
    ds_read_b64_tr_b16 v[232:233], v22 offset:20480
    ds_read_b64_tr_b16 v[234:235], v22 offset:20992
    ds_read_b64_tr_b16 a[120:121], v22 offset:32768
    ds_read_b64_tr_b16 a[122:123], v22 offset:33280
    s_waitcnt lgkmcnt(0)
    s_barrier
    ds_read_b64_tr_b16 a[40:41], v23 offset:0
    ds_read_b64_tr_b16 a[42:43], v23 offset:128
    ds_read_b64_tr_b16 a[184:185], v23 offset:8
    ds_read_b64_tr_b16 a[186:187], v23 offset:136
    ds_read_b64_tr_b16 a[44:45], v23 offset:1024
    ds_read_b64_tr_b16 a[46:47], v23 offset:1152
    ds_read_b64_tr_b16 a[188:189], v23 offset:1032
    ds_read_b64_tr_b16 a[190:191], v23 offset:1160
    ds_read_b64_tr_b16 a[48:49], v23 offset:2048
    ds_read_b64_tr_b16 a[50:51], v23 offset:2176
    ds_read_b64_tr_b16 a[192:193], v23 offset:2056
    ds_read_b64_tr_b16 a[194:195], v23 offset:2184
    s_waitcnt vmcnt(9) lgkmcnt(0)
    s_barrier
    s_add_u32 m0, s47, 0
    s_add_u32 s17, s49, 995328
    buffer_load_dwordx4 v16, s[20:23], s17 offen lds
    s_add_u32 m0, s47, 1024
    s_add_u32 s17, s49, 1022976
    buffer_load_dwordx4 v16, s[20:23], s17 offen lds
    s_add_u32 m0, s47, 2048
    s_add_u32 s17, s49, 1050624
    buffer_load_dwordx4 v16, s[20:23], s17 offen lds
    s_add_u32 m0, s47, 12288
    s_add_u32 s17, s49, 996480
    buffer_load_dwordx4 v16, s[20:23], s17 offen lds
    s_add_u32 m0, s47, 13312
    s_add_u32 s17, s49, 1024128
    buffer_load_dwordx4 v16, s[20:23], s17 offen lds
    s_add_u32 m0, s47, 14336
    s_add_u32 s17, s49, 1051776
    buffer_load_dwordx4 v16, s[20:23], s17 offen lds
    s_add_u32 m0, s47, 24576
    s_add_u32 s17, s49, 997632
    buffer_load_dwordx4 v16, s[20:23], s17 offen lds
    s_add_u32 m0, s47, 25600
    s_add_u32 s17, s49, 1025280
    buffer_load_dwordx4 v16, s[20:23], s17 offen lds
    s_add_u32 m0, s47, 26624
    s_add_u32 s17, s49, 1052928
    buffer_load_dwordx4 v16, s[20:23], s17 offen lds
    s_mov_b64 exec, s[76:77]
    v_add_u32 v22, 43008, v19
    ds_read_b32 v28, v22 offset:0
    ds_read_b32 v29, v22 offset:12288
    ds_read_b32 v30, v22 offset:24576
    s_waitcnt lgkmcnt(0)
    v_add_u32 v22, 43008, v20
    ds_write_b128 v22, v[28:31]
    s_mov_b64 exec, -1
    v_add_u32 v22, 43008, v17
    v_add_u32 v23, 43008, v18
    ds_read_b64_tr_b16 v[164:165], v22 offset:0
    ds_read_b64_tr_b16 v[166:167], v22 offset:512
    ds_read_b64_tr_b16 v[236:237], v22 offset:12288
    ds_read_b64_tr_b16 v[238:239], v22 offset:12800
    ds_read_b64_tr_b16 a[124:125], v22 offset:24576
    ds_read_b64_tr_b16 a[126:127], v22 offset:25088
    ds_read_b64_tr_b16 v[168:169], v22 offset:4096
    ds_read_b64_tr_b16 v[170:171], v22 offset:4608
    ds_read_b64_tr_b16 v[240:241], v22 offset:16384
    ds_read_b64_tr_b16 v[242:243], v22 offset:16896
    ds_read_b64_tr_b16 a[128:129], v22 offset:28672
    ds_read_b64_tr_b16 a[130:131], v22 offset:29184
    ds_read_b64_tr_b16 v[172:173], v22 offset:8192
    ds_read_b64_tr_b16 v[174:175], v22 offset:8704
    ds_read_b64_tr_b16 v[244:245], v22 offset:20480
    ds_read_b64_tr_b16 v[246:247], v22 offset:20992
    ds_read_b64_tr_b16 a[132:133], v22 offset:32768
    ds_read_b64_tr_b16 a[134:135], v22 offset:33280
    s_waitcnt lgkmcnt(0)
    s_barrier
    ds_read_b64_tr_b16 a[52:53], v23 offset:0
    ds_read_b64_tr_b16 a[54:55], v23 offset:128
    ds_read_b64_tr_b16 a[196:197], v23 offset:8
    ds_read_b64_tr_b16 a[198:199], v23 offset:136
    ds_read_b64_tr_b16 a[56:57], v23 offset:1024
    ds_read_b64_tr_b16 a[58:59], v23 offset:1152
    ds_read_b64_tr_b16 a[200:201], v23 offset:1032
    ds_read_b64_tr_b16 a[202:203], v23 offset:1160
    ds_read_b64_tr_b16 a[60:61], v23 offset:2048
    ds_read_b64_tr_b16 a[62:63], v23 offset:2176
    ds_read_b64_tr_b16 a[204:205], v23 offset:2056
    ds_read_b64_tr_b16 a[206:207], v23 offset:2184
    s_waitcnt vmcnt(9) lgkmcnt(0)
    s_barrier
    s_add_u32 m0, s47, 43008
    s_add_u32 s17, s49, 1327104
    buffer_load_dwordx4 v16, s[20:23], s17 offen lds
    s_add_u32 m0, s47, 44032
    s_add_u32 s17, s49, 1354752
    buffer_load_dwordx4 v16, s[20:23], s17 offen lds
    s_add_u32 m0, s47, 45056
    s_add_u32 s17, s49, 1382400
    buffer_load_dwordx4 v16, s[20:23], s17 offen lds
    s_add_u32 m0, s47, 55296
    s_add_u32 s17, s49, 1328256
    buffer_load_dwordx4 v16, s[20:23], s17 offen lds
    s_add_u32 m0, s47, 56320
    s_add_u32 s17, s49, 1355904
    buffer_load_dwordx4 v16, s[20:23], s17 offen lds
    s_add_u32 m0, s47, 57344
    s_add_u32 s17, s49, 1383552
    buffer_load_dwordx4 v16, s[20:23], s17 offen lds
    s_add_u32 m0, s47, 67584
    s_add_u32 s17, s49, 1329408
    buffer_load_dwordx4 v16, s[20:23], s17 offen lds
    s_add_u32 m0, s47, 68608
    s_add_u32 s17, s49, 1357056
    buffer_load_dwordx4 v16, s[20:23], s17 offen lds
    s_add_u32 m0, s47, 69632
    s_add_u32 s17, s49, 1384704
    buffer_load_dwordx4 v16, s[20:23], s17 offen lds
    s_mov_b64 exec, s[76:77]
    v_add_u32 v22, 86016, v19
    ds_read_b32 v28, v22 offset:0
    ds_read_b32 v29, v22 offset:12288
    ds_read_b32 v30, v22 offset:24576
    s_waitcnt lgkmcnt(0)
    v_add_u32 v22, 86016, v20
    ds_write_b128 v22, v[28:31]
    s_mov_b64 exec, -1
    v_add_u32 v22, 86016, v17
    v_add_u32 v23, 86016, v18
    ds_read_b64_tr_b16 v[176:177], v22 offset:0
    ds_read_b64_tr_b16 v[178:179], v22 offset:512
    ds_read_b64_tr_b16 v[248:249], v22 offset:12288
    ds_read_b64_tr_b16 v[250:251], v22 offset:12800
    ds_read_b64_tr_b16 a[136:137], v22 offset:24576
    ds_read_b64_tr_b16 a[138:139], v22 offset:25088
    ds_read_b64_tr_b16 v[180:181], v22 offset:4096
    ds_read_b64_tr_b16 v[182:183], v22 offset:4608
    ds_read_b64_tr_b16 v[252:253], v22 offset:16384
    ds_read_b64_tr_b16 v[254:255], v22 offset:16896
    ds_read_b64_tr_b16 a[140:141], v22 offset:28672
    ds_read_b64_tr_b16 a[142:143], v22 offset:29184
    ds_read_b64_tr_b16 v[184:185], v22 offset:8192
    ds_read_b64_tr_b16 v[186:187], v22 offset:8704
    ds_read_b64_tr_b16 a[0:1], v22 offset:20480
    ds_read_b64_tr_b16 a[2:3], v22 offset:20992
    ds_read_b64_tr_b16 a[144:145], v22 offset:32768
    ds_read_b64_tr_b16 a[146:147], v22 offset:33280
    s_waitcnt lgkmcnt(0)
    s_barrier
    ds_read_b64_tr_b16 a[64:65], v23 offset:0
    ds_read_b64_tr_b16 a[66:67], v23 offset:128
    ds_read_b64_tr_b16 a[208:209], v23 offset:8
    ds_read_b64_tr_b16 a[210:211], v23 offset:136
    ds_read_b64_tr_b16 a[68:69], v23 offset:1024
    ds_read_b64_tr_b16 a[70:71], v23 offset:1152
    ds_read_b64_tr_b16 a[212:213], v23 offset:1032
    ds_read_b64_tr_b16 a[214:215], v23 offset:1160
    ds_read_b64_tr_b16 a[72:73], v23 offset:2048
    ds_read_b64_tr_b16 a[74:75], v23 offset:2176
    ds_read_b64_tr_b16 a[216:217], v23 offset:2056
    ds_read_b64_tr_b16 a[218:219], v23 offset:2184
    s_waitcnt vmcnt(9) lgkmcnt(0)
    s_barrier
    s_add_u32 m0, s47, 86016
    s_add_u32 s17, s49, 1658880
    buffer_load_dwordx4 v16, s[20:23], s17 offen lds
    s_add_u32 m0, s47, 87040
    s_add_u32 s17, s49, 1686528
    buffer_load_dwordx4 v16, s[20:23], s17 offen lds
    s_add_u32 m0, s47, 88064
    s_add_u32 s17, s49, 1714176
    buffer_load_dwordx4 v16, s[20:23], s17 offen lds
    s_add_u32 m0, s47, 98304
    s_add_u32 s17, s49, 1660032
    buffer_load_dwordx4 v16, s[20:23], s17 offen lds
    s_add_u32 m0, s47, 99328
    s_add_u32 s17, s49, 1687680
    buffer_load_dwordx4 v16, s[20:23], s17 offen lds
    s_add_u32 m0, s47, 100352
    s_add_u32 s17, s49, 1715328
    buffer_load_dwordx4 v16, s[20:23], s17 offen lds
    s_add_u32 m0, s47, 110592
    s_add_u32 s17, s49, 1661184
    buffer_load_dwordx4 v16, s[20:23], s17 offen lds
    s_add_u32 m0, s47, 111616
    s_add_u32 s17, s49, 1688832
    buffer_load_dwordx4 v16, s[20:23], s17 offen lds
    s_add_u32 m0, s47, 112640
    s_add_u32 s17, s49, 1716480
    buffer_load_dwordx4 v16, s[20:23], s17 offen lds
    s_mov_b64 exec, s[76:77]
    v_add_u32 v22, 0, v19
    ds_read_b32 v28, v22 offset:0
    ds_read_b32 v29, v22 offset:12288
    ds_read_b32 v30, v22 offset:24576
    s_waitcnt lgkmcnt(0)
    v_add_u32 v22, 0, v20
    ds_write_b128 v22, v[28:31]
    s_mov_b64 exec, -1
    v_add_u32 v22, 0, v17
    v_add_u32 v23, 0, v18
    ds_read_b64_tr_b16 v[188:189], v22 offset:0
    ds_read_b64_tr_b16 v[190:191], v22 offset:512
    ds_read_b64_tr_b16 a[4:5], v22 offset:12288
    ds_read_b64_tr_b16 a[6:7], v22 offset:12800
    ds_read_b64_tr_b16 a[148:149], v22 offset:24576
    ds_read_b64_tr_b16 a[150:151], v22 offset:25088
    ds_read_b64_tr_b16 v[192:193], v22 offset:4096
    ds_read_b64_tr_b16 v[194:195], v22 offset:4608
    ds_read_b64_tr_b16 a[8:9], v22 offset:16384
    ds_read_b64_tr_b16 a[10:11], v22 offset:16896
    ds_read_b64_tr_b16 a[152:153], v22 offset:28672
    ds_read_b64_tr_b16 a[154:155], v22 offset:29184
    ds_read_b64_tr_b16 v[196:197], v22 offset:8192
    ds_read_b64_tr_b16 v[198:199], v22 offset:8704
    ds_read_b64_tr_b16 a[12:13], v22 offset:20480
    ds_read_b64_tr_b16 a[14:15], v22 offset:20992
    ds_read_b64_tr_b16 a[156:157], v22 offset:32768
    ds_read_b64_tr_b16 a[158:159], v22 offset:33280
    s_waitcnt lgkmcnt(0)
    s_barrier
    ds_read_b64_tr_b16 a[76:77], v23 offset:0
    ds_read_b64_tr_b16 a[78:79], v23 offset:128
    ds_read_b64_tr_b16 a[220:221], v23 offset:8
    ds_read_b64_tr_b16 a[222:223], v23 offset:136
    ds_read_b64_tr_b16 a[80:81], v23 offset:1024
    ds_read_b64_tr_b16 a[82:83], v23 offset:1152
    ds_read_b64_tr_b16 a[224:225], v23 offset:1032
    ds_read_b64_tr_b16 a[226:227], v23 offset:1160
    ds_read_b64_tr_b16 a[84:85], v23 offset:2048
    ds_read_b64_tr_b16 a[86:87], v23 offset:2176
    ds_read_b64_tr_b16 a[228:229], v23 offset:2056
    ds_read_b64_tr_b16 a[230:231], v23 offset:2184
    s_waitcnt vmcnt(9) lgkmcnt(0)
    s_barrier
    s_mov_b64 exec, s[76:77]
    v_add_u32 v22, 43008, v19
    ds_read_b32 v28, v22 offset:0
    ds_read_b32 v29, v22 offset:12288
    ds_read_b32 v30, v22 offset:24576
    s_waitcnt lgkmcnt(0)
    v_add_u32 v22, 43008, v20
    ds_write_b128 v22, v[28:31]
    s_mov_b64 exec, -1
    v_add_u32 v22, 43008, v17
    v_add_u32 v23, 43008, v18
    ds_read_b64_tr_b16 v[200:201], v22 offset:0
    ds_read_b64_tr_b16 v[202:203], v22 offset:512
    ds_read_b64_tr_b16 a[16:17], v22 offset:12288
    ds_read_b64_tr_b16 a[18:19], v22 offset:12800
    ds_read_b64_tr_b16 a[160:161], v22 offset:24576
    ds_read_b64_tr_b16 a[162:163], v22 offset:25088
    ds_read_b64_tr_b16 v[204:205], v22 offset:4096
    ds_read_b64_tr_b16 v[206:207], v22 offset:4608
    ds_read_b64_tr_b16 a[20:21], v22 offset:16384
    ds_read_b64_tr_b16 a[22:23], v22 offset:16896
    ds_read_b64_tr_b16 a[164:165], v22 offset:28672
    ds_read_b64_tr_b16 a[166:167], v22 offset:29184
    ds_read_b64_tr_b16 v[208:209], v22 offset:8192
    ds_read_b64_tr_b16 v[210:211], v22 offset:8704
    ds_read_b64_tr_b16 a[24:25], v22 offset:20480
    ds_read_b64_tr_b16 a[26:27], v22 offset:20992
    ds_read_b64_tr_b16 a[168:169], v22 offset:32768
    ds_read_b64_tr_b16 a[170:171], v22 offset:33280
    s_waitcnt lgkmcnt(0)
    s_barrier
    ds_read_b64_tr_b16 a[88:89], v23 offset:0
    ds_read_b64_tr_b16 a[90:91], v23 offset:128
    ds_read_b64_tr_b16 a[232:233], v23 offset:8
    ds_read_b64_tr_b16 a[234:235], v23 offset:136
    ds_read_b64_tr_b16 a[92:93], v23 offset:1024
    ds_read_b64_tr_b16 a[94:95], v23 offset:1152
    ds_read_b64_tr_b16 a[236:237], v23 offset:1032
    ds_read_b64_tr_b16 a[238:239], v23 offset:1160
    ds_read_b64_tr_b16 a[96:97], v23 offset:2048
    ds_read_b64_tr_b16 a[98:99], v23 offset:2176
    ds_read_b64_tr_b16 a[240:241], v23 offset:2056
    ds_read_b64_tr_b16 a[242:243], v23 offset:2184
    s_waitcnt vmcnt(0) lgkmcnt(0)
    s_barrier
    s_mov_b64 exec, s[76:77]
    v_add_u32 v22, 86016, v19
    ds_read_b32 v28, v22 offset:0
    ds_read_b32 v29, v22 offset:12288
    ds_read_b32 v30, v22 offset:24576
    s_waitcnt lgkmcnt(0)
    v_add_u32 v22, 86016, v20
    ds_write_b128 v22, v[28:31]
    s_mov_b64 exec, -1
    v_add_u32 v22, 86016, v17
    v_add_u32 v23, 86016, v18
    ds_read_b64_tr_b16 v[212:213], v22 offset:0
    ds_read_b64_tr_b16 v[214:215], v22 offset:512
    ds_read_b64_tr_b16 a[28:29], v22 offset:12288
    ds_read_b64_tr_b16 a[30:31], v22 offset:12800
    ds_read_b64_tr_b16 a[172:173], v22 offset:24576
    ds_read_b64_tr_b16 a[174:175], v22 offset:25088
    ds_read_b64_tr_b16 v[216:217], v22 offset:4096
    ds_read_b64_tr_b16 v[218:219], v22 offset:4608
    ds_read_b64_tr_b16 a[32:33], v22 offset:16384
    ds_read_b64_tr_b16 a[34:35], v22 offset:16896
    ds_read_b64_tr_b16 a[176:177], v22 offset:28672
    ds_read_b64_tr_b16 a[178:179], v22 offset:29184
    ds_read_b64_tr_b16 v[220:221], v22 offset:8192
    ds_read_b64_tr_b16 v[222:223], v22 offset:8704
    ds_read_b64_tr_b16 a[36:37], v22 offset:20480
    ds_read_b64_tr_b16 a[38:39], v22 offset:20992
    ds_read_b64_tr_b16 a[180:181], v22 offset:32768
    ds_read_b64_tr_b16 a[182:183], v22 offset:33280
    s_waitcnt lgkmcnt(0)
    s_barrier
    ds_read_b64_tr_b16 a[100:101], v23 offset:0
    ds_read_b64_tr_b16 a[102:103], v23 offset:128
    ds_read_b64_tr_b16 a[244:245], v23 offset:8
    ds_read_b64_tr_b16 a[246:247], v23 offset:136
    ds_read_b64_tr_b16 a[104:105], v23 offset:1024
    ds_read_b64_tr_b16 a[106:107], v23 offset:1152
    ds_read_b64_tr_b16 a[248:249], v23 offset:1032
    ds_read_b64_tr_b16 a[250:251], v23 offset:1160
    ds_read_b64_tr_b16 a[108:109], v23 offset:2048
    ds_read_b64_tr_b16 a[110:111], v23 offset:2176
    ds_read_b64_tr_b16 a[252:253], v23 offset:2056
    ds_read_b64_tr_b16 a[254:255], v23 offset:2184
    s_waitcnt lgkmcnt(0)
    s_barrier
    v_mov_b32 v56, 0x3f803f80
    v_mov_b32 v57, 0x3f803f80
    v_mov_b32 v58, 0x3f803f80
    v_mov_b32 v59, 0x3f803f80
    s_nop 1
    v_mfma_f32_16x16x32_bf16 v[36:39], v[152:155], v[56:59], 0
    v_mfma_f32_16x16x32_bf16 v[40:43], v[224:227], v[56:59], 0
    v_mfma_f32_16x16x32_bf16 v[44:47], a[40:43], v[56:59], 0
    v_mfma_f32_16x16x32_bf16 v[48:51], v[56:59], a[112:115], 0
    v_mfma_f32_16x16x32_bf16 v[52:55], v[56:59], a[184:187], 0
    v_mfma_f32_16x16x32_bf16 v[36:39], v[156:159], v[56:59], v[36:39]
    v_mfma_f32_16x16x32_bf16 v[40:43], v[228:231], v[56:59], v[40:43]
    v_mfma_f32_16x16x32_bf16 v[44:47], a[44:47], v[56:59], v[44:47]
    v_mfma_f32_16x16x32_bf16 v[48:51], v[56:59], a[116:119], v[48:51]
    v_mfma_f32_16x16x32_bf16 v[52:55], v[56:59], a[188:191], v[52:55]
    v_mfma_f32_16x16x32_bf16 v[36:39], v[160:163], v[56:59], v[36:39]
    v_mfma_f32_16x16x32_bf16 v[40:43], v[232:235], v[56:59], v[40:43]
    v_mfma_f32_16x16x32_bf16 v[44:47], a[48:51], v[56:59], v[44:47]
    v_mfma_f32_16x16x32_bf16 v[48:51], v[56:59], a[120:123], v[48:51]
    v_mfma_f32_16x16x32_bf16 v[52:55], v[56:59], a[192:195], v[52:55]
    v_mfma_f32_16x16x32_bf16 v[36:39], v[164:167], v[56:59], v[36:39]
    v_mfma_f32_16x16x32_bf16 v[40:43], v[236:239], v[56:59], v[40:43]
    v_mfma_f32_16x16x32_bf16 v[44:47], a[52:55], v[56:59], v[44:47]
    v_mfma_f32_16x16x32_bf16 v[48:51], v[56:59], a[124:127], v[48:51]
    v_mfma_f32_16x16x32_bf16 v[52:55], v[56:59], a[196:199], v[52:55]
    v_mfma_f32_16x16x32_bf16 v[36:39], v[168:171], v[56:59], v[36:39]
    v_mfma_f32_16x16x32_bf16 v[40:43], v[240:243], v[56:59], v[40:43]
    v_mfma_f32_16x16x32_bf16 v[44:47], a[56:59], v[56:59], v[44:47]
    v_mfma_f32_16x16x32_bf16 v[48:51], v[56:59], a[128:131], v[48:51]
    v_mfma_f32_16x16x32_bf16 v[52:55], v[56:59], a[200:203], v[52:55]
    v_mfma_f32_16x16x32_bf16 v[36:39], v[172:175], v[56:59], v[36:39]
    v_mfma_f32_16x16x32_bf16 v[40:43], v[244:247], v[56:59], v[40:43]
    v_mfma_f32_16x16x32_bf16 v[44:47], a[60:63], v[56:59], v[44:47]
    v_mfma_f32_16x16x32_bf16 v[48:51], v[56:59], a[132:135], v[48:51]
    v_mfma_f32_16x16x32_bf16 v[52:55], v[56:59], a[204:207], v[52:55]
    v_mfma_f32_16x16x32_bf16 v[36:39], v[176:179], v[56:59], v[36:39]
    v_mfma_f32_16x16x32_bf16 v[40:43], v[248:251], v[56:59], v[40:43]
    v_mfma_f32_16x16x32_bf16 v[44:47], a[64:67], v[56:59], v[44:47]
    v_mfma_f32_16x16x32_bf16 v[48:51], v[56:59], a[136:139], v[48:51]
    v_mfma_f32_16x16x32_bf16 v[52:55], v[56:59], a[208:211], v[52:55]
    v_mfma_f32_16x16x32_bf16 v[36:39], v[180:183], v[56:59], v[36:39]
    v_mfma_f32_16x16x32_bf16 v[40:43], v[252:255], v[56:59], v[40:43]
    v_mfma_f32_16x16x32_bf16 v[44:47], a[68:71], v[56:59], v[44:47]
    v_mfma_f32_16x16x32_bf16 v[48:51], v[56:59], a[140:143], v[48:51]
    v_mfma_f32_16x16x32_bf16 v[52:55], v[56:59], a[212:215], v[52:55]
    v_mfma_f32_16x16x32_bf16 v[36:39], v[184:187], v[56:59], v[36:39]
    v_mfma_f32_16x16x32_bf16 v[40:43], a[0:3], v[56:59], v[40:43]
    v_mfma_f32_16x16x32_bf16 v[44:47], a[72:75], v[56:59], v[44:47]
    v_mfma_f32_16x16x32_bf16 v[48:51], v[56:59], a[144:147], v[48:51]
    v_mfma_f32_16x16x32_bf16 v[52:55], v[56:59], a[216:219], v[52:55]
    v_mfma_f32_16x16x32_bf16 v[36:39], v[188:191], v[56:59], v[36:39]
    v_mfma_f32_16x16x32_bf16 v[40:43], a[4:7], v[56:59], v[40:43]
    v_mfma_f32_16x16x32_bf16 v[44:47], a[76:79], v[56:59], v[44:47]
    v_mfma_f32_16x16x32_bf16 v[48:51], v[56:59], a[148:151], v[48:51]
    v_mfma_f32_16x16x32_bf16 v[52:55], v[56:59], a[220:223], v[52:55]
    v_mfma_f32_16x16x32_bf16 v[36:39], v[192:195], v[56:59], v[36:39]
    v_mfma_f32_16x16x32_bf16 v[40:43], a[8:11], v[56:59], v[40:43]
    v_mfma_f32_16x16x32_bf16 v[44:47], a[80:83], v[56:59], v[44:47]
    v_mfma_f32_16x16x32_bf16 v[48:51], v[56:59], a[152:155], v[48:51]
    v_mfma_f32_16x16x32_bf16 v[52:55], v[56:59], a[224:227], v[52:55]
    v_mfma_f32_16x16x32_bf16 v[36:39], v[196:199], v[56:59], v[36:39]
    v_mfma_f32_16x16x32_bf16 v[40:43], a[12:15], v[56:59], v[40:43]
    v_mfma_f32_16x16x32_bf16 v[44:47], a[84:87], v[56:59], v[44:47]
    v_mfma_f32_16x16x32_bf16 v[48:51], v[56:59], a[156:159], v[48:51]
    v_mfma_f32_16x16x32_bf16 v[52:55], v[56:59], a[228:231], v[52:55]
    v_mfma_f32_16x16x32_bf16 v[36:39], v[200:203], v[56:59], v[36:39]
    v_mfma_f32_16x16x32_bf16 v[40:43], a[16:19], v[56:59], v[40:43]
    v_mfma_f32_16x16x32_bf16 v[44:47], a[88:91], v[56:59], v[44:47]
    v_mfma_f32_16x16x32_bf16 v[48:51], v[56:59], a[160:163], v[48:51]
    v_mfma_f32_16x16x32_bf16 v[52:55], v[56:59], a[232:235], v[52:55]
    v_mfma_f32_16x16x32_bf16 v[36:39], v[204:207], v[56:59], v[36:39]
    v_mfma_f32_16x16x32_bf16 v[40:43], a[20:23], v[56:59], v[40:43]
    v_mfma_f32_16x16x32_bf16 v[44:47], a[92:95], v[56:59], v[44:47]
    v_mfma_f32_16x16x32_bf16 v[48:51], v[56:59], a[164:167], v[48:51]
    v_mfma_f32_16x16x32_bf16 v[52:55], v[56:59], a[236:239], v[52:55]
    v_mfma_f32_16x16x32_bf16 v[36:39], v[208:211], v[56:59], v[36:39]
    v_mfma_f32_16x16x32_bf16 v[40:43], a[24:27], v[56:59], v[40:43]
    v_mfma_f32_16x16x32_bf16 v[44:47], a[96:99], v[56:59], v[44:47]
    v_mfma_f32_16x16x32_bf16 v[48:51], v[56:59], a[168:171], v[48:51]
    v_mfma_f32_16x16x32_bf16 v[52:55], v[56:59], a[240:243], v[52:55]
    v_mfma_f32_16x16x32_bf16 v[36:39], v[212:215], v[56:59], v[36:39]
    v_mfma_f32_16x16x32_bf16 v[40:43], a[28:31], v[56:59], v[40:43]
    v_mfma_f32_16x16x32_bf16 v[44:47], a[100:103], v[56:59], v[44:47]
    v_mfma_f32_16x16x32_bf16 v[48:51], v[56:59], a[172:175], v[48:51]
    v_mfma_f32_16x16x32_bf16 v[52:55], v[56:59], a[244:247], v[52:55]
    v_mfma_f32_16x16x32_bf16 v[36:39], v[216:219], v[56:59], v[36:39]
    v_mfma_f32_16x16x32_bf16 v[40:43], a[32:35], v[56:59], v[40:43]
    v_mfma_f32_16x16x32_bf16 v[44:47], a[104:107], v[56:59], v[44:47]
    v_mfma_f32_16x16x32_bf16 v[48:51], v[56:59], a[176:179], v[48:51]
    v_mfma_f32_16x16x32_bf16 v[52:55], v[56:59], a[248:251], v[52:55]
    v_mfma_f32_16x16x32_bf16 v[36:39], v[220:223], v[56:59], v[36:39]
    v_mfma_f32_16x16x32_bf16 v[40:43], a[36:39], v[56:59], v[40:43]
    v_mfma_f32_16x16x32_bf16 v[44:47], a[108:111], v[56:59], v[44:47]
    v_mfma_f32_16x16x32_bf16 v[48:51], v[56:59], a[180:183], v[48:51]
    v_mfma_f32_16x16x32_bf16 v[52:55], v[56:59], a[252:255], v[52:55]
    v_lshlrev_b32 v10, 5, v7
    s_lshl_b32 s17, s51, 4
    v_add_u32 v10, s17, v10
    v_mul_u32_u24 v6, 1536, v8
    v_add_u32 v10, v10, v6
    s_lshl_b32 s17, s14, 7
    s_add_u32 s17, s17, 73728
    v_lshl_add_u32 v11, v7, 3, s17
    v_lshl_add_u32 v12, v8, 5, s17
    v_lshlrev_b32 v13, 5, v7
    s_lshl_b32 s17, s51, 4
    v_add_u32 v13, s17, v13
    s_lshr_b32 s17, s50, 2
    s_add_u32 s17, s17, 64
    s_lshl_b32 s17, s17, 9
    s_and_b32 s18, s50, 3
    s_lshl_b32 s18, s18, 2
    s_add_u32 s17, s17, s18
    v_add_u32 v14, s17, v13
    v_lshrrev_b32 v5, 1, v8
    v_lshl_add_u32 v13, v5, 9, v13
    v_and_b32 v5, 1, v8
    v_lshl_add_u32 v13, v5, 3, v13
    s_lshl_b32 s17, s50, 10
    v_add_u32 v13, s17, v13
    s_lshl_b32 s49, s15, 7
    s_lshl_b32 s17, s14, 2
    s_add_u32 s49, s49, s17
    s_add_u32 s49, s49, 1536
    s_mov_b32 s52, 0x3eae1a93
    v_mov_b32 v6, 0xf149f2ca
    v_lshl_add_u32 v5, v8, 2, 0
    v_sub_u32 v5, v5, v7
    v_cmp_le_i32 vcc, 9, v5
    s_nop 1
    v_cndmask_b32 v72, v6, v4, vcc
    v_add_u32 v5, 7, v5
    v_cmp_ge_u32 vcc, 7, v5
    s_nop 1
    v_cndmask_b32 v76, v6, v4, vcc
    v_lshl_add_u32 v5, v8, 2, 1
    v_sub_u32 v5, v5, v7
    v_cmp_le_i32 vcc, 9, v5
    s_nop 1
    v_cndmask_b32 v73, v6, v4, vcc
    v_add_u32 v5, 7, v5
    v_cmp_ge_u32 vcc, 7, v5
    s_nop 1
    v_cndmask_b32 v77, v6, v4, vcc
    v_lshl_add_u32 v5, v8, 2, 2
    v_sub_u32 v5, v5, v7
    v_cmp_le_i32 vcc, 9, v5
    s_nop 1
    v_cndmask_b32 v74, v6, v4, vcc
    v_add_u32 v5, 7, v5
    v_cmp_ge_u32 vcc, 7, v5
    s_nop 1
    v_cndmask_b32 v78, v6, v4, vcc
    v_lshl_add_u32 v5, v8, 2, 3
    v_sub_u32 v5, v5, v7
    v_cmp_le_i32 vcc, 9, v5
    s_nop 1
    v_cndmask_b32 v75, v6, v4, vcc
    v_add_u32 v5, 7, v5
    v_cmp_ge_u32 vcc, 7, v5
    s_nop 1
    v_cndmask_b32 v79, v6, v4, vcc
    v_mov_b32 v112, 0
    v_mov_b32 v113, 0
    v_mov_b32 v114, 0
    v_mov_b32 v115, 0
    v_mov_b32 v136, 0
    v_mov_b32 v137, 0
    v_mov_b32 v138, 0
    v_mov_b32 v139, 0
    v_mov_b32 v140, 0
    v_mov_b32 v141, 0
    v_mov_b32 v142, 0
    v_mov_b32 v143, 0
    v_mov_b32 v116, 0x3f803f80
    v_mov_b32 v117, 0x3f803f80
    v_mov_b32 v118, 0x3f803f80
    v_mov_b32 v119, 0x3f803f80
    v_mov_b32 v131, 0
    v_mov_b32 v135, 0
    s_mov_b64 exec, 0xff
    v_lshrrev_b32 v6, 2, v0
    v_lshlrev_b32 v5, 5, v6
    v_and_b32 v5, 128, v5
    v_lshrrev_b32 v6, 1, v6
    v_and_or_b32 v5, v6, 12, v5
    s_mov_b32 s16, 0
Laq_pure:
    global_load_dword v6, v5, s[12:13] sc1
    s_add_u32 s16, s16, 1
    s_cmp_gt_u32 s16, 100000
    s_cbranch_scc1 L_role_aq_abort
    s_mov_b32 s6, 0
    s_waitcnt vmcnt(0)
    v_readlane_b32 s7, v6, 0
    s_nop 0
    s_add_u32 s6, s6, s7
    v_readlane_b32 s7, v6, 1
    s_nop 0
    s_add_u32 s6, s6, s7
    v_readlane_b32 s7, v6, 2
    s_nop 0
    s_add_u32 s6, s6, s7
    v_readlane_b32 s7, v6, 3
    s_nop 0
    s_add_u32 s6, s6, s7
    v_readlane_b32 s7, v6, 4
    s_nop 0
    s_add_u32 s6, s6, s7
    v_readlane_b32 s7, v6, 5
    s_nop 0
    s_add_u32 s6, s6, s7
    v_readlane_b32 s7, v6, 6
    s_nop 0
    s_add_u32 s6, s6, s7
    v_readlane_b32 s7, v6, 7
    s_nop 0
    s_add_u32 s6, s6, s7
    v_readlane_b32 s7, v6, s3
    s_nop 0
    s_cmp_ge_u32 s7, 32
    s_cselect_b32 s78, 0, -1
    s_cselect_b32 s6, 256, s6
    s_cmp_lt_u32 s6, 256
    s_cbranch_scc1 Laq_pure
    s_mov_b32 s79, s78
    s_mov_b64 exec, -1
    s_mov_b32 s36, s63
    s_mov_b32 s34, s63
    s_mul_i32 s58, s14, 9216
    s_mul_i32 s64, s63, 4718592
    s_add_u32 s64, s64, s58
    s_add_u32 s64, s64, 6291456
    s_mul_i32 s61, s63, 1441792
    s_add_u32 s61, s61, 0
    s_mov_b32 s37, 0
    s_mov_b32 s40, 36864
    s_mov_b32 s59, s58
    s_mov_b32 s43, 0
    s_mov_b32 s62, 1
    s_mov_b32 s28, s8
    s_mov_b32 s29, s9
    s_mov_b32 s30, 0
    s_mov_b32 s31, 0x00020000
    v_mov_b32 v110, 74752
    v_mov_b32 v5, -1
    ds_write_b32 v110, v5
    s_waitcnt lgkmcnt(0)
    s_cmp_lg_u32 s14, 0
    s_cbranch_scc1 Laq_inia_d
    v_mov_b32 v5, 40
    s_mov_b32 s16, 0
Laq_inia:
    global_load_dword v6, v5, s[12:13] sc1
    s_add_u32 s16, s16, 1
    s_cmp_gt_u32 s16, 100000
    s_cbranch_scc1 L_role_aq_abort
    s_waitcnt vmcnt(0)
    v_cmp_gt_u32 vcc, 128, v6
    s_nop 0
    s_cbranch_vccz Laq_inia_d
    s_sleep 8
    s_branch Laq_inia
Laq_inia_d:
    s_barrier
    s_cmp_eq_u32 s63, 0
    s_cbranch_scc1 Laq_ini_sk
    s_cmp_lg_u32 s14, 0
    s_cbranch_scc1 Laq_inib_d
    v_mov_b32 v5, 160
    s_mov_b32 s16, 0
Laq_inib:
    global_load_dword v6, v5, s[12:13] sc1
    s_add_u32 s16, s16, 1
    s_cmp_gt_u32 s16, 100000
    s_cbranch_scc1 L_role_aq_abort
    s_waitcnt vmcnt(0)
    v_cmp_gt_u32 vcc, 64, v6
    s_nop 0
    s_cbranch_vccz Laq_inib_d
    s_sleep 8
    s_branch Laq_inib
Laq_inib_d:
    s_barrier
Laq_ini_sk:
    s_mul_i32 s41, s37, 36864
    s_add_u32 s41, s41, s64
    s_mul_i32 s60, s37, 22528
    s_add_u32 s60, s60, s61
    s_cmp_lt_u32 s37, 64
    s_cselect_b32 s60, s60, 2883584
    s_branch Laq_wait
Laq_head:
    s_waitcnt vmcnt(4)
Laq_head2:
    s_barrier
    ds_read_b32 v15, v110
    s_xor_b32 s40, s40, 36864
    s_xor_b32 s59, s59, 36864
    s_mov_b32 s35, s37
    s_lshl_b32 s57, s34, 6
    s_add_u32 s57, s57, s35
    s_add_u32 s37, s37, 1
    s_mov_b32 s39, 0
    s_mov_b32 s54, 0
    s_mul_i32 s41, s37, 36864
    s_add_u32 s41, s41, s64
    s_mul_i32 s60, s37, 22528
    s_add_u32 s60, s60, s61
    s_cmp_lt_u32 s37, 64
    s_cselect_b32 s60, s60, 2883584
    v_lshlrev_b32 v9, 9, v8
    v_lshl_add_u32 v9, v7, 5, v9
    s_lshl_b32 s17, s51, 4
    s_add_u32 s17, s17, s40
    v_add_u32 v9, s17, v9
    ds_read_b128 v[56:59], v9 offset:0
    ds_read_b128 v[60:63], v9 offset:2048
    ds_read_b128 v[64:67], v9 offset:4096
    s_waitcnt lgkmcnt(2)
    v_mfma_f32_16x16x32_bf16 v[16:19], v[152:155], v[56:59], 0
    v_add_f32 v80, v80, v84
    v_mfma_f32_16x16x32_bf16 v[20:23], v[224:227], v[56:59], 0
    v_add_f32 v81, v81, v85
    v_mfma_f32_16x16x32_bf16 v[24:27], a[40:43], v[56:59], 0
    v_add_f32 v82, v82, v86
    ds_read_b128 v[56:59], v9 offset:6144
    s_waitcnt lgkmcnt(2)
    v_mfma_f32_16x16x32_bf16 v[16:19], v[156:159], v[60:63], v[16:19]
    v_add_f32 v83, v83, v87
    v_mfma_f32_16x16x32_bf16 v[20:23], v[228:231], v[60:63], v[20:23]
    v_add_f32 v80, v80, v88
    v_mfma_f32_16x16x32_bf16 v[24:27], a[44:47], v[60:63], v[24:27]
    v_add_f32 v81, v81, v89
    v_readfirstlane_b32 s17, v15
    s_nop 0
    s_add_u32 s18, s17, 1
    s_max_i32 s32, s18, s37
    s_add_u32 s39, s37, 1
    s_min_u32 s39, s39, 63
    s_mul_i32 s33, s32, 22528
    s_add_u32 s33, s33, s61
    s_cmp_eq_u32 s14, 0
    s_cselect_b32 s18, s32, 0x7fff
    v_mov_b32 v2, 2
    s_cmp_le_u32 s18, s39
    s_cselect_b64 exec, -1, 0
    buffer_load_dword v2, v1, s[8:11], s33 offen sc1
    s_mov_b64 exec, -1
    s_cmp_ge_i32 s17, s37
    s_cbranch_scc1 Laq_f_7
    ds_read_b128 v[60:63], v9 offset:8192
    s_waitcnt lgkmcnt(2)
    v_mfma_f32_16x16x32_bf16 v[16:19], v[160:163], v[64:67], v[16:19]
    v_add_f32 v82, v82, v90
    v_mfma_f32_16x16x32_bf16 v[20:23], v[232:235], v[64:67], v[20:23]
    v_add_f32 v83, v83, v91
    v_mfma_f32_16x16x32_bf16 v[24:27], a[48:51], v[64:67], v[24:27]
    v_add_f32 v80, v80, v82
    ds_read_b128 v[64:67], v9 offset:10240
    s_waitcnt lgkmcnt(2)
    v_mfma_f32_16x16x32_bf16 v[16:19], v[164:167], v[56:59], v[16:19]
    v_add_f32 v81, v81, v83
    v_mfma_f32_16x16x32_bf16 v[20:23], v[236:239], v[56:59], v[20:23]
    v_mov_b32 v82, v80
    v_mfma_f32_16x16x32_bf16 v[24:27], a[52:55], v[56:59], v[24:27]
    v_mov_b32 v83, v81
    ds_read_b128 v[56:59], v9 offset:12288
    s_waitcnt lgkmcnt(2)
    v_mfma_f32_16x16x32_bf16 v[16:19], v[168:171], v[60:63], v[16:19]
    v_permlane32_swap_b32 v80, v82
    v_mfma_f32_16x16x32_bf16 v[20:23], v[240:243], v[60:63], v[20:23]
    v_permlane32_swap_b32 v81, v83
    v_mfma_f32_16x16x32_bf16 v[24:27], a[56:59], v[60:63], v[24:27]
    v_add_f32 v80, v80, v82
    ds_read_b128 v[60:63], v9 offset:14336
    s_waitcnt lgkmcnt(2)
    v_mfma_f32_16x16x32_bf16 v[16:19], v[172:175], v[64:67], v[16:19]
    v_add_f32 v81, v81, v83
    v_mfma_f32_16x16x32_bf16 v[20:23], v[244:247], v[64:67], v[20:23]
    v_mov_b32 v82, v80
    v_mfma_f32_16x16x32_bf16 v[24:27], a[60:63], v[64:67], v[24:27]
    v_mov_b32 v83, v81
    s_waitcnt vmcnt(1)
    s_cmp_lg_u32 s43, 0
    s_cselect_b64 exec, 1, 0
    buffer_store_dword v3, v4, s[8:11], s43 offen
    s_and_b64 exec, exec, s[78:79]
    buffer_store_dword v3, v4, s[8:11], s43 offen sc1
    s_mov_b64 exec, -1
    s_mov_b32 s43, 0
    ds_read_b128 v[64:67], v9 offset:16384
    s_waitcnt lgkmcnt(2)
    v_mfma_f32_16x16x32_bf16 v[16:19], v[176:179], v[56:59], v[16:19]
    v_permlane16_swap_b32 v80, v82
    v_mfma_f32_16x16x32_bf16 v[20:23], v[248:251], v[56:59], v[20:23]
    v_permlane16_swap_b32 v81, v83
    v_mfma_f32_16x16x32_bf16 v[24:27], a[64:67], v[56:59], v[24:27]
    v_add_f32 v80, v80, v82
    ds_read_b128 v[56:59], v9 offset:18432
    s_waitcnt lgkmcnt(2)
    v_mfma_f32_16x16x32_bf16 v[16:19], v[180:183], v[60:63], v[16:19]
    v_add_f32 v81, v81, v83
    v_mfma_f32_16x16x32_bf16 v[20:23], v[252:255], v[60:63], v[20:23]
    v_mul_f32 v80, 0x3ae38e39, v80
    v_mfma_f32_16x16x32_bf16 v[24:27], a[68:71], v[60:63], v[24:27]
    v_mul_f32 v81, 0x3ae38e39, v81
    ds_read_b128 v[60:63], v9 offset:20480
    s_waitcnt lgkmcnt(2)
    v_mfma_f32_16x16x32_bf16 v[16:19], v[184:187], v[64:67], v[16:19]
    v_fma_f32 v81, -v80, v80, v81
    v_mfma_f32_16x16x32_bf16 v[20:23], a[0:3], v[64:67], v[20:23]
    v_max_f32 v81, 0, v81
    v_mfma_f32_16x16x32_bf16 v[24:27], a[72:75], v[64:67], v[24:27]
    v_add_f32 v81, 0x3727c5ac, v81
    ds_read_b128 v[64:67], v9 offset:22528
    s_waitcnt lgkmcnt(2)
    v_mfma_f32_16x16x32_bf16 v[16:19], v[188:191], v[56:59], v[16:19]
    v_rsq_f32 v92, v81
    v_mfma_f32_16x16x32_bf16 v[20:23], a[4:7], v[56:59], v[20:23]
    v_mul_f32 v93, v80, v92
    v_mfma_f32_16x16x32_bf16 v[24:27], a[76:79], v[56:59], v[24:27]
    ds_write_b64 v11, v[92:93]
    ds_read_b128 v[56:59], v9 offset:24576
    s_waitcnt lgkmcnt(3)
    v_mfma_f32_16x16x32_bf16 v[16:19], v[192:195], v[60:63], v[16:19]
    ds_read_b128 v[96:99], v12
    v_mfma_f32_16x16x32_bf16 v[20:23], a[8:11], v[60:63], v[20:23]
    ds_read_b128 v[100:103], v12 offset:16
    v_mfma_f32_16x16x32_bf16 v[24:27], a[80:83], v[60:63], v[24:27]
    ds_read_b128 v[60:63], v9 offset:26624
    s_waitcnt lgkmcnt(5)
    v_mfma_f32_16x16x32_bf16 v[16:19], v[196:199], v[64:67], v[16:19]
    v_mfma_f32_16x16x32_bf16 v[20:23], a[12:15], v[64:67], v[20:23]
    v_mfma_f32_16x16x32_bf16 v[24:27], a[84:87], v[64:67], v[24:27]
    ds_read_b128 v[64:67], v9 offset:28672
    s_waitcnt lgkmcnt(4)
    v_mfma_f32_16x16x32_bf16 v[16:19], v[200:203], v[56:59], v[16:19]
    v_mfma_f32_16x16x32_bf16 v[20:23], a[16:19], v[56:59], v[20:23]
    v_mfma_f32_16x16x32_bf16 v[24:27], a[88:91], v[56:59], v[24:27]
    ds_read_b128 v[56:59], v9 offset:30720
    s_waitcnt lgkmcnt(2)
    v_mfma_f32_16x16x32_bf16 v[16:19], v[204:207], v[60:63], v[16:19]
    v_mfma_f32_16x16x32_bf16 v[20:23], a[20:23], v[60:63], v[20:23]
    v_mfma_f32_16x16x32_bf16 v[24:27], a[92:95], v[60:63], v[24:27]
    ds_read_b128 v[60:63], v9 offset:32768
    s_waitcnt lgkmcnt(2)
    v_mfma_f32_16x16x32_bf16 v[16:19], v[208:211], v[64:67], v[16:19]
    v_mfma_f32_16x16x32_bf16 v[20:23], a[24:27], v[64:67], v[20:23]
    v_mfma_f32_16x16x32_bf16 v[24:27], a[96:99], v[64:67], v[24:27]
    ds_read_b128 v[64:67], v9 offset:34816
    s_waitcnt lgkmcnt(2)
    v_mfma_f32_16x16x32_bf16 v[16:19], v[212:215], v[56:59], v[16:19]
    v_cmp_eq_u32 s[76:77], 1, v2
    v_cmp_eq_u32 vcc, 2, v2
    v_mfma_f32_16x16x32_bf16 v[20:23], a[28:31], v[56:59], v[20:23]
    s_cmp_eq_u64 s[76:77], -1
    s_cselect_b32 s38, 1, 0
    v_mfma_f32_16x16x32_bf16 v[24:27], a[100:103], v[56:59], v[24:27]
    s_cmp_lg_u32 s38, 0
    s_cselect_b64 exec, 1, 0
    v_mov_b32 v15, s32
    ds_write_b32 v110, v15
    v_mov_b32 v2, 2
    s_mov_b64 exec, -1
    ds_read_b128 v[56:59], v9 offset:0
    s_waitcnt lgkmcnt(3)
    v_mfma_f32_16x16x32_bf16 v[16:19], v[216:219], v[60:63], v[16:19]
    s_add_u32 s32, s32, s38
    s_mul_i32 s38, s38, 22528
    s_add_u32 s33, s33, s38
    v_mfma_f32_16x16x32_bf16 v[20:23], a[32:35], v[60:63], v[20:23]
    s_cmp_eq_u64 vcc, 0
    s_cselect_b32 s38, s32, 0x7fff
    v_mfma_f32_16x16x32_bf16 v[24:27], a[104:107], v[60:63], v[24:27]
    s_cmp_le_u32 s38, s39
    s_cselect_b64 exec, -1, 0
    v_mov_b32 v2, 2
    buffer_load_dword v2, v1, s[8:11], s33 offen sc1
    s_mov_b64 exec, -1
    ds_read_b128 v[60:63], v9 offset:2048
    s_waitcnt lgkmcnt(3)
    v_mfma_f32_16x16x32_bf16 v[16:19], v[220:223], v[64:67], v[16:19]
    v_mfma_f32_16x16x32_bf16 v[20:23], a[36:39], v[64:67], v[20:23]
    v_mfma_f32_16x16x32_bf16 v[24:27], a[108:111], v[64:67], v[24:27]
    ds_read_b32 v15, v110
    ds_read_b128 v[64:67], v9 offset:4096
    s_waitcnt lgkmcnt(3)
    v_mfma_f32_16x16x32_bf16 v[28:31], v[56:59], a[112:115], 0
    v_mfma_f32_16x16x32_bf16 v[32:35], v[56:59], a[184:187], 0
    ds_read_b128 v[56:59], v9 offset:6144
    s_waitcnt lgkmcnt(3)
    v_mfma_f32_16x16x32_bf16 v[28:31], v[60:63], a[116:119], v[28:31]
    v_mul_f32 v94, v93, v36
    v_fma_f32 v16, v16, v92, -v94
    v_mfma_f32_16x16x32_bf16 v[32:35], v[60:63], a[188:191], v[32:35]
    v_mul_f32 v94, v93, v37
    v_fma_f32 v17, v17, v92, -v94
    s_waitcnt lgkmcnt(2)
    v_readfirstlane_b32 s17, v15
    s_nop 0
    s_cmp_ge_i32 s17, s37
    s_cbranch_scc1 Laq_f_8
    ds_read_b128 v[60:63], v9 offset:8192
    s_waitcnt lgkmcnt(2)
    v_mfma_f32_16x16x32_bf16 v[28:31], v[64:67], a[120:123], v[28:31]
    v_mul_f32 v94, v93, v38
    v_fma_f32 v18, v18, v92, -v94
    v_mfma_f32_16x16x32_bf16 v[32:35], v[64:67], a[192:195], v[32:35]
    v_mul_f32 v94, v93, v39
    v_fma_f32 v19, v19, v92, -v94
    ds_read_b128 v[64:67], v9 offset:10240
    s_waitcnt lgkmcnt(2)
    v_mfma_f32_16x16x32_bf16 v[28:31], v[56:59], a[124:127], v[28:31]
    v_mul_f32 v94, v93, v44
    v_fma_f32 v24, v24, v92, -v94
    v_mfma_f32_16x16x32_bf16 v[32:35], v[56:59], a[196:199], v[32:35]
    v_mul_f32 v94, v93, v45
    v_fma_f32 v25, v25, v92, -v94
    ds_read_b128 v[56:59], v9 offset:12288
    s_waitcnt lgkmcnt(2)
    v_mfma_f32_16x16x32_bf16 v[28:31], v[60:63], a[128:131], v[28:31]
    v_mul_f32 v94, v93, v46
    v_fma_f32 v26, v26, v92, -v94
    v_mfma_f32_16x16x32_bf16 v[32:35], v[60:63], a[200:203], v[32:35]
    v_mul_f32 v94, v93, v47
    v_fma_f32 v27, v27, v92, -v94
    ds_read_b128 v[60:63], v9 offset:14336
    s_waitcnt lgkmcnt(2)
    v_mfma_f32_16x16x32_bf16 v[28:31], v[64:67], a[132:135], v[28:31]
    v_mul_f32 v94, v93, v40
    v_fma_f32 v20, v20, v92, -v94
    v_mfma_f32_16x16x32_bf16 v[32:35], v[64:67], a[204:207], v[32:35]
    v_mul_f32 v94, v93, v41
    v_fma_f32 v21, v21, v92, -v94
    ds_read_b128 v[64:67], v9 offset:16384
    s_waitcnt lgkmcnt(2)
    v_mfma_f32_16x16x32_bf16 v[28:31], v[56:59], a[136:139], v[28:31]
    v_mul_f32 v94, v93, v42
    v_fma_f32 v22, v22, v92, -v94
    v_mfma_f32_16x16x32_bf16 v[32:35], v[56:59], a[208:211], v[32:35]
    v_mul_f32 v94, v93, v43
    v_fma_f32 v23, v23, v92, -v94
    ds_read_b128 v[56:59], v9 offset:18432
    s_waitcnt lgkmcnt(2)
    v_mfma_f32_16x16x32_bf16 v[28:31], v[60:63], a[140:143], v[28:31]
    v_cvt_pk_bf16_f32 v128, v16, v17
    v_cvt_pk_bf16_f32 v129, v18, v19
    v_mfma_f32_16x16x32_bf16 v[32:35], v[60:63], a[212:215], v[32:35]
    v_cvt_pk_bf16_f32 v130, v24, v25
    v_cvt_pk_bf16_f32 v132, v20, v21
    ds_read_b128 v[60:63], v9 offset:20480
    s_waitcnt lgkmcnt(2)
    v_mfma_f32_16x16x32_bf16 v[28:31], v[64:67], a[144:147], v[28:31]
    v_cvt_pk_bf16_f32 v133, v22, v23
    v_cvt_pk_bf16_f32 v134, v26, v27
    v_mfma_f32_16x16x32_bf16 v[32:35], v[64:67], a[216:219], v[32:35]
    s_cmp_eq_u32 s35, 0
    s_cselect_b32 s46, 0xf149f2ca, 0
    ds_read_b128 v[64:67], v9 offset:22528
    s_waitcnt lgkmcnt(2)
    v_mfma_f32_16x16x32_bf16 v[28:31], v[56:59], a[148:151], v[28:31]
    v_mfma_f32_16x16x32_bf16 v[144:147], v[112:115], v[128:131], 0
    v_mfma_f32_16x16x32_bf16 v[32:35], v[56:59], a[220:223], v[32:35]
    v_mfma_f32_16x16x32_bf16 v[148:151], v[132:135], v[128:131], 0
    ds_read_b128 v[56:59], v9 offset:24576
    s_waitcnt lgkmcnt(2)
    v_mfma_f32_16x16x32_bf16 v[28:31], v[60:63], a[152:155], v[28:31]
    v_mov_b32 v112, v132
    v_mfma_f32_16x16x32_bf16 v[32:35], v[60:63], a[224:227], v[32:35]
    v_mov_b32 v113, v133
    v_mov_b32 v114, v134
    ds_read_b128 v[60:63], v9 offset:26624
    s_waitcnt lgkmcnt(2)
    v_mfma_f32_16x16x32_bf16 v[28:31], v[64:67], a[156:159], v[28:31]
    v_mfma_f32_16x16x32_bf16 v[32:35], v[64:67], a[228:231], v[32:35]
    v_fma_f32 v144, v144, s52, v72
    ds_read_b128 v[64:67], v9 offset:28672
    s_waitcnt lgkmcnt(2)
    v_mfma_f32_16x16x32_bf16 v[28:31], v[56:59], a[160:163], v[28:31]
    v_fma_f32 v145, v145, s52, v73
    v_fma_f32 v146, v146, s52, v74
    v_fma_f32 v147, v147, s52, v75
    v_mfma_f32_16x16x32_bf16 v[32:35], v[56:59], a[232:235], v[32:35]
    v_fma_f32 v148, v148, s52, v76
    v_fma_f32 v149, v149, s52, v77
    v_fma_f32 v150, v150, s52, v78
    ds_read_b128 v[56:59], v9 offset:30720
    s_waitcnt lgkmcnt(2)
    v_mfma_f32_16x16x32_bf16 v[28:31], v[60:63], a[164:167], v[28:31]
    v_fma_f32 v151, v151, s52, v79
    v_add_f32 v144, s46, v144
    v_add_f32 v145, s46, v145
    v_mfma_f32_16x16x32_bf16 v[32:35], v[60:63], a[236:239], v[32:35]
    v_add_f32 v146, s46, v146
    v_add_f32 v147, s46, v147
    v_max3_f32 v5, v144, v145, v146
    ds_read_b128 v[60:63], v9 offset:32768
    s_waitcnt lgkmcnt(2)
    v_mfma_f32_16x16x32_bf16 v[28:31], v[64:67], a[168:171], v[28:31]
    v_max3_f32 v5, v5, v147, v148
    v_max3_f32 v5, v5, v149, v150
    v_max_f32 v5, v5, v151
    v_mfma_f32_16x16x32_bf16 v[32:35], v[64:67], a[240:243], v[32:35]
    v_mov_b32 v6, v5
    s_nop 1
    v_permlane32_swap_b32 v5, v6
    ds_read_b128 v[64:67], v9 offset:34816
    s_waitcnt lgkmcnt(2)
    v_mfma_f32_16x16x32_bf16 v[28:31], v[56:59], a[172:175], v[28:31]
    v_max_f32 v5, v5, v6
    v_mov_b32 v6, v5
    v_mfma_f32_16x16x32_bf16 v[32:35], v[56:59], a[244:247], v[32:35]
    s_nop 0
    v_permlane16_swap_b32 v5, v6
    v_max_f32 v5, v5, v6
    v_sub_f32 v144, v144, v5
    s_waitcnt lgkmcnt(1)
    v_mfma_f32_16x16x32_bf16 v[28:31], v[60:63], a[176:179], v[28:31]
    v_sub_f32 v145, v145, v5
    v_sub_f32 v146, v146, v5
    v_sub_f32 v147, v147, v5
    v_mfma_f32_16x16x32_bf16 v[32:35], v[60:63], a[248:251], v[32:35]
    v_sub_f32 v148, v148, v5
    v_sub_f32 v149, v149, v5
    v_sub_f32 v150, v150, v5
    s_waitcnt lgkmcnt(0)
    v_mfma_f32_16x16x32_bf16 v[28:31], v[64:67], a[180:183], v[28:31]
    v_sub_f32 v151, v151, v5
    v_exp_f32 v144, v144
    v_exp_f32 v145, v145
    v_mfma_f32_16x16x32_bf16 v[32:35], v[64:67], a[252:255], v[32:35]
    v_exp_f32 v146, v146
    v_exp_f32 v147, v147
    v_exp_f32 v148, v148
    v_cmp_eq_u32 s[76:77], 1, v2
    v_cmp_eq_u32 vcc, 2, v2
    s_cmp_eq_u64 s[76:77], -1
    s_cselect_b32 s38, 1, 0
    s_cmp_lg_u32 s38, 0
    s_cselect_b64 exec, 1, 0
    v_mov_b32 v15, s32
    ds_write_b32 v110, v15
    v_mov_b32 v2, 2
    s_mov_b64 exec, -1
    s_add_u32 s32, s32, s38
    s_mul_i32 s38, s38, 22528
    s_add_u32 s33, s33, s38
    s_cmp_eq_u64 vcc, 0
    s_cselect_b32 s38, s32, 0x7fff
    s_cmp_le_u32 s38, s39
    s_cselect_b64 exec, -1, 0
    v_mov_b32 v2, 2
    buffer_load_dword v2, v1, s[8:11], s33 offen sc1
    s_mov_b64 exec, -1
    v_exp_f32 v149, v149
    v_exp_f32 v150, v150
    v_exp_f32 v151, v151
    v_cvt_pk_bf16_f32 v68, v144, v145
    v_cvt_pk_bf16_f32 v69, v146, v147
    v_cvt_pk_bf16_f32 v70, v148, v149
    v_cvt_pk_bf16_f32 v71, v150, v151
    s_nop 1
    v_mfma_f32_16x16x32_bf16 v[16:19], v[116:119], v[68:71], 0
    s_mul_i32 s46, s57, 36864
    s_add_u32 s46, s46, 17301504
    s_nop 5
    v_rcp_f32 v6, v16
    v_mul_f32 v94, v97, v48
    v_fma_f32 v28, v28, v96, -v94
    v_mul_f32 v94, v99, v49
    v_fma_f32 v29, v29, v98, -v94
    v_mul_f32 v94, v101, v50
    v_fma_f32 v30, v30, v100, -v94
    v_mul_f32 v94, v103, v51
    v_fma_f32 v31, v31, v102, -v94
    v_cvt_pk_bf16_f32 v138, v28, v29
    v_cvt_pk_bf16_f32 v139, v30, v31
    v_mul_f32 v94, v97, v52
    v_fma_f32 v32, v32, v96, -v94
    v_mfma_f32_16x16x32_bf16 v[20:23], v[136:139], v[68:71], 0
    v_mul_f32 v94, v99, v53
    v_fma_f32 v33, v33, v98, -v94
    v_mul_f32 v94, v101, v54
    v_fma_f32 v34, v34, v100, -v94
    v_mul_f32 v94, v103, v55
    v_fma_f32 v35, v35, v102, -v94
    v_cvt_pk_bf16_f32 v142, v32, v33
    v_cvt_pk_bf16_f32 v143, v34, v35
    v_mov_b32 v136, v138
    v_mov_b32 v137, v139
    v_mfma_f32_16x16x32_bf16 v[24:27], v[140:143], v[68:71], 0
    v_mul_f32 v20, v6, v20
    v_mul_f32 v21, v6, v21
    v_mul_f32 v22, v6, v22
    v_mul_f32 v23, v6, v23
    v_cvt_pk_bf16_f32 v20, v20, v21
    v_cvt_pk_bf16_f32 v21, v22, v23
    s_mov_b64 exec, -1
    buffer_store_dwordx2 v[20:21], v13, s[8:11], s46 offen
    s_and_b64 exec, exec, s[78:79]
    buffer_store_dwordx2 v[20:21], v13, s[8:11], s46 offen sc1
    s_mov_b64 exec, -1
    v_mov_b32 v140, v142
    v_mov_b32 v141, v143
    v_mul_f32 v24, v6, v24
    v_mul_f32 v25, v6, v25
    v_cvt_pk_bf16_f32 v24, v24, v25
    s_mov_b64 exec, 0xffff
    buffer_store_dword v24, v14, s[8:11], s46 offen
    s_and_b64 exec, exec, s[78:79]
    buffer_store_dword v24, v14, s[8:11], s46 offen sc1
    s_mov_b64 exec, -1
    s_mul_i32 s43, s57, 22528
    s_add_u32 s43, s43, s49
    s_branch Laq_none
Laq_f_7:
    ds_read_b128 v[60:63], v9 offset:8192
    s_waitcnt lgkmcnt(2)
    v_mfma_f32_16x16x32_bf16 v[16:19], v[160:163], v[64:67], v[16:19]
    v_add_f32 v82, v82, v90
    v_mfma_f32_16x16x32_bf16 v[20:23], v[232:235], v[64:67], v[20:23]
    v_add_f32 v83, v83, v91
    v_mfma_f32_16x16x32_bf16 v[24:27], a[48:51], v[64:67], v[24:27]
    v_add_f32 v80, v80, v82
    ds_read_b128 v[64:67], v9 offset:10240
    s_waitcnt lgkmcnt(2)
    v_mfma_f32_16x16x32_bf16 v[16:19], v[164:167], v[56:59], v[16:19]
    v_add_f32 v81, v81, v83
    v_mfma_f32_16x16x32_bf16 v[20:23], v[236:239], v[56:59], v[20:23]
    v_mov_b32 v82, v80
    v_mfma_f32_16x16x32_bf16 v[24:27], a[52:55], v[56:59], v[24:27]
    v_mov_b32 v83, v81
    ds_read_b128 v[56:59], v9 offset:12288
    s_waitcnt lgkmcnt(2)
    v_mfma_f32_16x16x32_bf16 v[16:19], v[168:171], v[60:63], v[16:19]
    v_permlane32_swap_b32 v80, v82
    v_mfma_f32_16x16x32_bf16 v[20:23], v[240:243], v[60:63], v[20:23]
    v_permlane32_swap_b32 v81, v83
    v_mfma_f32_16x16x32_bf16 v[24:27], a[56:59], v[60:63], v[24:27]
    v_add_f32 v80, v80, v82
    ds_read_b128 v[60:63], v9 offset:14336
    s_waitcnt lgkmcnt(2)
    v_mfma_f32_16x16x32_bf16 v[16:19], v[172:175], v[64:67], v[16:19]
    v_add_f32 v81, v81, v83
    v_mfma_f32_16x16x32_bf16 v[20:23], v[244:247], v[64:67], v[20:23]
    v_mov_b32 v82, v80
    v_mfma_f32_16x16x32_bf16 v[24:27], a[60:63], v[64:67], v[24:27]
    v_mov_b32 v83, v81
    s_waitcnt vmcnt(1)
    s_cmp_lg_u32 s43, 0
    s_cselect_b64 exec, 1, 0
    buffer_store_dword v3, v4, s[8:11], s43 offen
    s_and_b64 exec, exec, s[78:79]
    buffer_store_dword v3, v4, s[8:11], s43 offen sc1
    s_mov_b64 exec, -1
    s_mov_b32 s43, 0
    ds_read_b128 v[64:67], v9 offset:16384
    s_waitcnt lgkmcnt(2)
    v_mfma_f32_16x16x32_bf16 v[16:19], v[176:179], v[56:59], v[16:19]
    v_permlane16_swap_b32 v80, v82
    v_mfma_f32_16x16x32_bf16 v[20:23], v[248:251], v[56:59], v[20:23]
    v_permlane16_swap_b32 v81, v83
    v_mfma_f32_16x16x32_bf16 v[24:27], a[64:67], v[56:59], v[24:27]
    v_add_f32 v80, v80, v82
    ds_read_b128 v[56:59], v9 offset:18432
    s_waitcnt lgkmcnt(2)
    v_mfma_f32_16x16x32_bf16 v[16:19], v[180:183], v[60:63], v[16:19]
    v_add_f32 v81, v81, v83
    v_mfma_f32_16x16x32_bf16 v[20:23], v[252:255], v[60:63], v[20:23]
    v_mul_f32 v80, 0x3ae38e39, v80
    v_mfma_f32_16x16x32_bf16 v[24:27], a[68:71], v[60:63], v[24:27]
    v_mul_f32 v81, 0x3ae38e39, v81
    ds_read_b128 v[60:63], v9 offset:20480
    s_waitcnt lgkmcnt(2)
    v_mfma_f32_16x16x32_bf16 v[16:19], v[184:187], v[64:67], v[16:19]
    v_fma_f32 v81, -v80, v80, v81
    v_mfma_f32_16x16x32_bf16 v[20:23], a[0:3], v[64:67], v[20:23]
    v_max_f32 v81, 0, v81
    v_mfma_f32_16x16x32_bf16 v[24:27], a[72:75], v[64:67], v[24:27]
    v_add_f32 v81, 0x3727c5ac, v81
    ds_read_b128 v[64:67], v9 offset:22528
    s_waitcnt lgkmcnt(2)
    v_mfma_f32_16x16x32_bf16 v[16:19], v[188:191], v[56:59], v[16:19]
    v_rsq_f32 v92, v81
    v_mfma_f32_16x16x32_bf16 v[20:23], a[4:7], v[56:59], v[20:23]
    v_mul_f32 v93, v80, v92
    v_mfma_f32_16x16x32_bf16 v[24:27], a[76:79], v[56:59], v[24:27]
    ds_write_b64 v11, v[92:93]
    ds_read_b128 v[56:59], v9 offset:24576
    s_waitcnt lgkmcnt(3)
    v_mfma_f32_16x16x32_bf16 v[16:19], v[192:195], v[60:63], v[16:19]
    ds_read_b128 v[96:99], v12
    v_mfma_f32_16x16x32_bf16 v[20:23], a[8:11], v[60:63], v[20:23]
    ds_read_b128 v[100:103], v12 offset:16
    v_mfma_f32_16x16x32_bf16 v[24:27], a[80:83], v[60:63], v[24:27]
    s_add_u32 m0, s59, 0
    s_add_u32 s47, s41, 0
    buffer_load_dwordx4 v0, s[8:11], s47 offen offset:0 lds
    ds_read_b128 v[60:63], v9 offset:26624
    s_waitcnt lgkmcnt(5)
    v_mfma_f32_16x16x32_bf16 v[16:19], v[196:199], v[64:67], v[16:19]
    buffer_load_dwordx4 v0, s[8:11], s47 offen offset:1024 lds
    buffer_load_dwordx4 v0, s[8:11], s47 offen offset:2048 lds
    buffer_load_dwordx4 v0, s[8:11], s47 offen offset:3072 lds
    v_mfma_f32_16x16x32_bf16 v[20:23], a[12:15], v[64:67], v[20:23]
    s_add_u32 m0, s59, 4096
    s_add_u32 s47, s41, 4096
    buffer_load_dwordx4 v0, s[8:11], s47 offen offset:0 lds
    v_mfma_f32_16x16x32_bf16 v[24:27], a[84:87], v[64:67], v[24:27]
    buffer_load_dwordx4 v0, s[8:11], s47 offen offset:1024 lds
    buffer_load_dwordx4 v0, s[8:11], s47 offen offset:2048 lds
    buffer_load_dwordx4 v0, s[8:11], s47 offen offset:3072 lds
    ds_read_b128 v[64:67], v9 offset:28672
    s_waitcnt lgkmcnt(4)
    v_mfma_f32_16x16x32_bf16 v[16:19], v[200:203], v[56:59], v[16:19]
    s_add_u32 m0, s59, 8192
    s_add_u32 s47, s41, 8192
    buffer_load_dwordx4 v0, s[8:11], s47 offen offset:0 lds
    v_mfma_f32_16x16x32_bf16 v[20:23], a[16:19], v[56:59], v[20:23]
    v_mfma_f32_16x16x32_bf16 v[24:27], a[88:91], v[56:59], v[24:27]
    ds_read_b128 v[56:59], v9 offset:30720
    s_waitcnt lgkmcnt(2)
    v_mfma_f32_16x16x32_bf16 v[16:19], v[204:207], v[60:63], v[16:19]
    v_mfma_f32_16x16x32_bf16 v[20:23], a[20:23], v[60:63], v[20:23]
    v_mfma_f32_16x16x32_bf16 v[24:27], a[92:95], v[60:63], v[24:27]
    ds_read_b128 v[60:63], v9 offset:32768
    s_waitcnt lgkmcnt(2)
    v_mfma_f32_16x16x32_bf16 v[16:19], v[208:211], v[64:67], v[16:19]
    v_mfma_f32_16x16x32_bf16 v[20:23], a[24:27], v[64:67], v[20:23]
    v_mfma_f32_16x16x32_bf16 v[24:27], a[96:99], v[64:67], v[24:27]
    ds_read_b128 v[64:67], v9 offset:34816
    s_waitcnt lgkmcnt(2)
    v_mfma_f32_16x16x32_bf16 v[16:19], v[212:215], v[56:59], v[16:19]
    v_cmp_eq_u32 s[76:77], 1, v2
    v_cmp_eq_u32 vcc, 2, v2
    v_mfma_f32_16x16x32_bf16 v[20:23], a[28:31], v[56:59], v[20:23]
    s_cmp_eq_u64 s[76:77], -1
    s_cselect_b32 s38, 1, 0
    v_mfma_f32_16x16x32_bf16 v[24:27], a[100:103], v[56:59], v[24:27]
    s_cmp_lg_u32 s38, 0
    s_cselect_b64 exec, 1, 0
    v_mov_b32 v15, s32
    ds_write_b32 v110, v15
    v_mov_b32 v2, 2
    s_mov_b64 exec, -1
    ds_read_b128 v[56:59], v9 offset:0
    s_waitcnt lgkmcnt(3)
    v_mfma_f32_16x16x32_bf16 v[16:19], v[216:219], v[60:63], v[16:19]
    s_add_u32 s32, s32, s38
    s_mul_i32 s38, s38, 22528
    s_add_u32 s33, s33, s38
    v_mfma_f32_16x16x32_bf16 v[20:23], a[32:35], v[60:63], v[20:23]
    s_cmp_eq_u64 vcc, 0
    s_cselect_b32 s38, s32, 0x7fff
    v_mfma_f32_16x16x32_bf16 v[24:27], a[104:107], v[60:63], v[24:27]
    s_cmp_le_u32 s38, s39
    s_cselect_b64 exec, -1, 0
    v_mov_b32 v2, 2
    buffer_load_dword v2, v1, s[8:11], s33 offen sc1
    s_mov_b64 exec, -1
    ds_read_b128 v[60:63], v9 offset:2048
    s_waitcnt lgkmcnt(3)
    v_mfma_f32_16x16x32_bf16 v[16:19], v[220:223], v[64:67], v[16:19]
    s_mul_i32 s48, s36, 786432
    s_mul_i32 s18, s37, 6144
    s_add_u32 s48, s48, s18
    s_add_u32 s48, s48, 15728640
    buffer_load_dwordx4 v[80:83], v10, s[8:11], s48 offen offset:0
    v_mfma_f32_16x16x32_bf16 v[20:23], a[36:39], v[64:67], v[20:23]
    v_mfma_f32_16x16x32_bf16 v[24:27], a[108:111], v[64:67], v[24:27]
    ds_read_b128 v[64:67], v9 offset:4096
    s_waitcnt lgkmcnt(2)
    v_mfma_f32_16x16x32_bf16 v[28:31], v[56:59], a[112:115], 0
    buffer_load_dwordx4 v[84:87], v10, s[8:11], s48 offen offset:512
    v_mfma_f32_16x16x32_bf16 v[32:35], v[56:59], a[184:187], 0
    ds_read_b128 v[56:59], v9 offset:6144
    s_waitcnt lgkmcnt(2)
    v_mfma_f32_16x16x32_bf16 v[28:31], v[60:63], a[116:119], v[28:31]
    buffer_load_dwordx4 v[88:91], v10, s[8:11], s48 offen offset:1024
    v_mul_f32 v94, v93, v36
    v_fma_f32 v16, v16, v92, -v94
    v_mfma_f32_16x16x32_bf16 v[32:35], v[60:63], a[188:191], v[32:35]
    v_mul_f32 v94, v93, v37
    v_fma_f32 v17, v17, v92, -v94
    ds_read_b128 v[60:63], v9 offset:8192
    s_waitcnt lgkmcnt(2)
    v_mfma_f32_16x16x32_bf16 v[28:31], v[64:67], a[120:123], v[28:31]
    v_mul_f32 v94, v93, v38
    v_fma_f32 v18, v18, v92, -v94
    v_mfma_f32_16x16x32_bf16 v[32:35], v[64:67], a[192:195], v[32:35]
    v_mul_f32 v94, v93, v39
    v_fma_f32 v19, v19, v92, -v94
    ds_read_b128 v[64:67], v9 offset:10240
    s_waitcnt lgkmcnt(2)
    v_mfma_f32_16x16x32_bf16 v[28:31], v[56:59], a[124:127], v[28:31]
    v_mul_f32 v94, v93, v44
    v_fma_f32 v24, v24, v92, -v94
    v_mfma_f32_16x16x32_bf16 v[32:35], v[56:59], a[196:199], v[32:35]
    v_mul_f32 v94, v93, v45
    v_fma_f32 v25, v25, v92, -v94
    ds_read_b128 v[56:59], v9 offset:12288
    s_waitcnt lgkmcnt(2)
    v_mfma_f32_16x16x32_bf16 v[28:31], v[60:63], a[128:131], v[28:31]
    v_mul_f32 v94, v93, v46
    v_fma_f32 v26, v26, v92, -v94
    v_mfma_f32_16x16x32_bf16 v[32:35], v[60:63], a[200:203], v[32:35]
    v_mul_f32 v94, v93, v47
    v_fma_f32 v27, v27, v92, -v94
    ds_read_b128 v[60:63], v9 offset:14336
    s_waitcnt lgkmcnt(2)
    v_mfma_f32_16x16x32_bf16 v[28:31], v[64:67], a[132:135], v[28:31]
    v_mul_f32 v94, v93, v40
    v_fma_f32 v20, v20, v92, -v94
    v_mfma_f32_16x16x32_bf16 v[32:35], v[64:67], a[204:207], v[32:35]
    v_mul_f32 v94, v93, v41
    v_fma_f32 v21, v21, v92, -v94
    ds_read_b128 v[64:67], v9 offset:16384
    s_waitcnt lgkmcnt(2)
    v_mfma_f32_16x16x32_bf16 v[28:31], v[56:59], a[136:139], v[28:31]
    v_mul_f32 v94, v93, v42
    v_fma_f32 v22, v22, v92, -v94
    v_mfma_f32_16x16x32_bf16 v[32:35], v[56:59], a[208:211], v[32:35]
    v_mul_f32 v94, v93, v43
    v_fma_f32 v23, v23, v92, -v94
    ds_read_b128 v[56:59], v9 offset:18432
    s_waitcnt lgkmcnt(2)
    v_mfma_f32_16x16x32_bf16 v[28:31], v[60:63], a[140:143], v[28:31]
    v_cvt_pk_bf16_f32 v128, v16, v17
    v_cvt_pk_bf16_f32 v129, v18, v19
    v_mfma_f32_16x16x32_bf16 v[32:35], v[60:63], a[212:215], v[32:35]
    v_cvt_pk_bf16_f32 v130, v24, v25
    v_cvt_pk_bf16_f32 v132, v20, v21
    ds_read_b128 v[60:63], v9 offset:20480
    s_waitcnt lgkmcnt(2)
    v_mfma_f32_16x16x32_bf16 v[28:31], v[64:67], a[144:147], v[28:31]
    v_cvt_pk_bf16_f32 v133, v22, v23
    v_cvt_pk_bf16_f32 v134, v26, v27
    v_mfma_f32_16x16x32_bf16 v[32:35], v[64:67], a[216:219], v[32:35]
    s_cmp_eq_u32 s35, 0
    s_cselect_b32 s46, 0xf149f2ca, 0
    ds_read_b128 v[64:67], v9 offset:22528
    s_waitcnt lgkmcnt(2)
    v_mfma_f32_16x16x32_bf16 v[28:31], v[56:59], a[148:151], v[28:31]
    v_mfma_f32_16x16x32_bf16 v[144:147], v[112:115], v[128:131], 0
    v_mfma_f32_16x16x32_bf16 v[32:35], v[56:59], a[220:223], v[32:35]
    v_mfma_f32_16x16x32_bf16 v[148:151], v[132:135], v[128:131], 0
    ds_read_b128 v[56:59], v9 offset:24576
    s_waitcnt lgkmcnt(2)
    v_mfma_f32_16x16x32_bf16 v[28:31], v[60:63], a[152:155], v[28:31]
    v_mov_b32 v112, v132
    v_mfma_f32_16x16x32_bf16 v[32:35], v[60:63], a[224:227], v[32:35]
    v_mov_b32 v113, v133
    v_mov_b32 v114, v134
    ds_read_b128 v[60:63], v9 offset:26624
    s_waitcnt lgkmcnt(2)
    v_mfma_f32_16x16x32_bf16 v[28:31], v[64:67], a[156:159], v[28:31]
    v_mfma_f32_16x16x32_bf16 v[32:35], v[64:67], a[228:231], v[32:35]
    v_fma_f32 v144, v144, s52, v72
    ds_read_b128 v[64:67], v9 offset:28672
    s_waitcnt lgkmcnt(2)
    v_mfma_f32_16x16x32_bf16 v[28:31], v[56:59], a[160:163], v[28:31]
    v_fma_f32 v145, v145, s52, v73
    v_fma_f32 v146, v146, s52, v74
    v_fma_f32 v147, v147, s52, v75
    v_mfma_f32_16x16x32_bf16 v[32:35], v[56:59], a[232:235], v[32:35]
    v_fma_f32 v148, v148, s52, v76
    v_fma_f32 v149, v149, s52, v77
    v_fma_f32 v150, v150, s52, v78
    ds_read_b128 v[56:59], v9 offset:30720
    s_waitcnt lgkmcnt(2)
    v_mfma_f32_16x16x32_bf16 v[28:31], v[60:63], a[164:167], v[28:31]
    v_fma_f32 v151, v151, s52, v79
    v_add_f32 v144, s46, v144
    v_add_f32 v145, s46, v145
    v_mfma_f32_16x16x32_bf16 v[32:35], v[60:63], a[236:239], v[32:35]
    v_add_f32 v146, s46, v146
    v_add_f32 v147, s46, v147
    v_max3_f32 v5, v144, v145, v146
    ds_read_b128 v[60:63], v9 offset:32768
    s_waitcnt lgkmcnt(2)
    v_mfma_f32_16x16x32_bf16 v[28:31], v[64:67], a[168:171], v[28:31]
    v_max3_f32 v5, v5, v147, v148
    v_max3_f32 v5, v5, v149, v150
    v_max_f32 v5, v5, v151
    v_mfma_f32_16x16x32_bf16 v[32:35], v[64:67], a[240:243], v[32:35]
    v_mov_b32 v6, v5
    s_nop 1
    v_permlane32_swap_b32 v5, v6
    ds_read_b128 v[64:67], v9 offset:34816
    s_waitcnt lgkmcnt(2)
    v_mfma_f32_16x16x32_bf16 v[28:31], v[56:59], a[172:175], v[28:31]
    v_max_f32 v5, v5, v6
    v_mov_b32 v6, v5
    v_mfma_f32_16x16x32_bf16 v[32:35], v[56:59], a[244:247], v[32:35]
    s_nop 0
    v_permlane16_swap_b32 v5, v6
    v_max_f32 v5, v5, v6
    v_sub_f32 v144, v144, v5
    s_waitcnt lgkmcnt(1)
    v_mfma_f32_16x16x32_bf16 v[28:31], v[60:63], a[176:179], v[28:31]
    v_sub_f32 v145, v145, v5
    v_sub_f32 v146, v146, v5
    v_sub_f32 v147, v147, v5
    v_mfma_f32_16x16x32_bf16 v[32:35], v[60:63], a[248:251], v[32:35]
    v_sub_f32 v148, v148, v5
    v_sub_f32 v149, v149, v5
    v_sub_f32 v150, v150, v5
    s_waitcnt lgkmcnt(0)
    v_mfma_f32_16x16x32_bf16 v[28:31], v[64:67], a[180:183], v[28:31]
    v_sub_f32 v151, v151, v5
    v_exp_f32 v144, v144
    v_exp_f32 v145, v145
    v_mfma_f32_16x16x32_bf16 v[32:35], v[64:67], a[252:255], v[32:35]
    v_exp_f32 v146, v146
    v_exp_f32 v147, v147
    v_exp_f32 v148, v148
    v_cmp_eq_u32 s[76:77], 1, v2
    v_cmp_eq_u32 vcc, 2, v2
    s_cmp_eq_u64 s[76:77], -1
    s_cselect_b32 s38, 1, 0
    s_cmp_lg_u32 s38, 0
    s_cselect_b64 exec, 1, 0
    v_mov_b32 v15, s32
    ds_write_b32 v110, v15
    v_mov_b32 v2, 2
    s_mov_b64 exec, -1
    s_add_u32 s32, s32, s38
    s_mul_i32 s38, s38, 22528
    s_add_u32 s33, s33, s38
    s_cmp_eq_u64 vcc, 0
    s_cselect_b32 s38, s32, 0x7fff
    s_cmp_le_u32 s38, s39
    s_cselect_b64 exec, -1, 0
    v_mov_b32 v2, 2
    buffer_load_dword v2, v1, s[8:11], s33 offen sc1
    s_mov_b64 exec, -1
    v_exp_f32 v149, v149
    v_exp_f32 v150, v150
    v_exp_f32 v151, v151
    v_cvt_pk_bf16_f32 v68, v144, v145
    v_cvt_pk_bf16_f32 v69, v146, v147
    v_cvt_pk_bf16_f32 v70, v148, v149
    v_cvt_pk_bf16_f32 v71, v150, v151
    s_nop 1
    v_mfma_f32_16x16x32_bf16 v[16:19], v[116:119], v[68:71], 0
    s_mul_i32 s46, s57, 36864
    s_add_u32 s46, s46, 17301504
    s_nop 5
    v_rcp_f32 v6, v16
    v_mul_f32 v94, v97, v48
    v_fma_f32 v28, v28, v96, -v94
    v_mul_f32 v94, v99, v49
    v_fma_f32 v29, v29, v98, -v94
    v_mul_f32 v94, v101, v50
    v_fma_f32 v30, v30, v100, -v94
    v_mul_f32 v94, v103, v51
    v_fma_f32 v31, v31, v102, -v94
    v_cvt_pk_bf16_f32 v138, v28, v29
    v_cvt_pk_bf16_f32 v139, v30, v31
    v_mul_f32 v94, v97, v52
    v_fma_f32 v32, v32, v96, -v94
    v_mfma_f32_16x16x32_bf16 v[20:23], v[136:139], v[68:71], 0
    v_mul_f32 v94, v99, v53
    v_fma_f32 v33, v33, v98, -v94
    v_mul_f32 v94, v101, v54
    v_fma_f32 v34, v34, v100, -v94
    v_mul_f32 v94, v103, v55
    v_fma_f32 v35, v35, v102, -v94
    v_cvt_pk_bf16_f32 v142, v32, v33
    v_cvt_pk_bf16_f32 v143, v34, v35
    v_mov_b32 v136, v138
    v_mov_b32 v137, v139
    v_mfma_f32_16x16x32_bf16 v[24:27], v[140:143], v[68:71], 0
    v_mul_f32 v20, v6, v20
    v_mul_f32 v21, v6, v21
    v_mul_f32 v22, v6, v22
    v_mul_f32 v23, v6, v23
    v_cvt_pk_bf16_f32 v20, v20, v21
    v_cvt_pk_bf16_f32 v21, v22, v23
    s_mov_b64 exec, -1
    buffer_store_dwordx2 v[20:21], v13, s[8:11], s46 offen
    s_and_b64 exec, exec, s[78:79]
    buffer_store_dwordx2 v[20:21], v13, s[8:11], s46 offen sc1
    s_mov_b64 exec, -1
    v_mov_b32 v140, v142
    v_mov_b32 v141, v143
    v_mul_f32 v24, v6, v24
    v_mul_f32 v25, v6, v25
    v_cvt_pk_bf16_f32 v24, v24, v25
    s_mov_b64 exec, 0xffff
    buffer_store_dword v24, v14, s[8:11], s46 offen
    s_and_b64 exec, exec, s[78:79]
    buffer_store_dword v24, v14, s[8:11], s46 offen sc1
    s_mov_b64 exec, -1
    s_mul_i32 s43, s57, 22528
    s_add_u32 s43, s43, s49
    s_branch Laq_head
Laq_f_8:
    ds_read_b128 v[60:63], v9 offset:8192
    s_waitcnt lgkmcnt(2)
    v_mfma_f32_16x16x32_bf16 v[28:31], v[64:67], a[120:123], v[28:31]
    v_mul_f32 v94, v93, v38
    v_fma_f32 v18, v18, v92, -v94
    v_mfma_f32_16x16x32_bf16 v[32:35], v[64:67], a[192:195], v[32:35]
    v_mul_f32 v94, v93, v39
    v_fma_f32 v19, v19, v92, -v94
    ds_read_b128 v[64:67], v9 offset:10240
    s_waitcnt lgkmcnt(2)
    v_mfma_f32_16x16x32_bf16 v[28:31], v[56:59], a[124:127], v[28:31]
    v_mul_f32 v94, v93, v44
    v_fma_f32 v24, v24, v92, -v94
    v_mfma_f32_16x16x32_bf16 v[32:35], v[56:59], a[196:199], v[32:35]
    v_mul_f32 v94, v93, v45
    v_fma_f32 v25, v25, v92, -v94
    ds_read_b128 v[56:59], v9 offset:12288
    s_waitcnt lgkmcnt(2)
    v_mfma_f32_16x16x32_bf16 v[28:31], v[60:63], a[128:131], v[28:31]
    v_mul_f32 v94, v93, v46
    v_fma_f32 v26, v26, v92, -v94
    v_mfma_f32_16x16x32_bf16 v[32:35], v[60:63], a[200:203], v[32:35]
    v_mul_f32 v94, v93, v47
    v_fma_f32 v27, v27, v92, -v94
    ds_read_b128 v[60:63], v9 offset:14336
    s_waitcnt lgkmcnt(2)
    v_mfma_f32_16x16x32_bf16 v[28:31], v[64:67], a[132:135], v[28:31]
    v_mul_f32 v94, v93, v40
    v_fma_f32 v20, v20, v92, -v94
    v_mfma_f32_16x16x32_bf16 v[32:35], v[64:67], a[204:207], v[32:35]
    v_mul_f32 v94, v93, v41
    v_fma_f32 v21, v21, v92, -v94
    ds_read_b128 v[64:67], v9 offset:16384
    s_waitcnt lgkmcnt(2)
    v_mfma_f32_16x16x32_bf16 v[28:31], v[56:59], a[136:139], v[28:31]
    v_mul_f32 v94, v93, v42
    v_fma_f32 v22, v22, v92, -v94
    v_mfma_f32_16x16x32_bf16 v[32:35], v[56:59], a[208:211], v[32:35]
    v_mul_f32 v94, v93, v43
    v_fma_f32 v23, v23, v92, -v94
    ds_read_b128 v[56:59], v9 offset:18432
    s_waitcnt lgkmcnt(2)
    v_mfma_f32_16x16x32_bf16 v[28:31], v[60:63], a[140:143], v[28:31]
    v_cvt_pk_bf16_f32 v128, v16, v17
    v_cvt_pk_bf16_f32 v129, v18, v19
    v_mfma_f32_16x16x32_bf16 v[32:35], v[60:63], a[212:215], v[32:35]
    v_cvt_pk_bf16_f32 v130, v24, v25
    v_cvt_pk_bf16_f32 v132, v20, v21
    ds_read_b128 v[60:63], v9 offset:20480
    s_waitcnt lgkmcnt(2)
    v_mfma_f32_16x16x32_bf16 v[28:31], v[64:67], a[144:147], v[28:31]
    v_cvt_pk_bf16_f32 v133, v22, v23
    v_cvt_pk_bf16_f32 v134, v26, v27
    v_mfma_f32_16x16x32_bf16 v[32:35], v[64:67], a[216:219], v[32:35]
    s_cmp_eq_u32 s35, 0
    s_cselect_b32 s46, 0xf149f2ca, 0
    ds_read_b128 v[64:67], v9 offset:22528
    s_waitcnt lgkmcnt(2)
    v_mfma_f32_16x16x32_bf16 v[28:31], v[56:59], a[148:151], v[28:31]
    s_add_u32 m0, s59, 0
    s_add_u32 s47, s41, 0
    buffer_load_dwordx4 v0, s[8:11], s47 offen offset:0 lds
    v_mfma_f32_16x16x32_bf16 v[144:147], v[112:115], v[128:131], 0
    buffer_load_dwordx4 v0, s[8:11], s47 offen offset:1024 lds
    buffer_load_dwordx4 v0, s[8:11], s47 offen offset:2048 lds
    buffer_load_dwordx4 v0, s[8:11], s47 offen offset:3072 lds
    v_mfma_f32_16x16x32_bf16 v[32:35], v[56:59], a[220:223], v[32:35]
    s_add_u32 m0, s59, 4096
    s_add_u32 s47, s41, 4096
    buffer_load_dwordx4 v0, s[8:11], s47 offen offset:0 lds
    v_mfma_f32_16x16x32_bf16 v[148:151], v[132:135], v[128:131], 0
    buffer_load_dwordx4 v0, s[8:11], s47 offen offset:1024 lds
    buffer_load_dwordx4 v0, s[8:11], s47 offen offset:2048 lds
    buffer_load_dwordx4 v0, s[8:11], s47 offen offset:3072 lds
    ds_read_b128 v[56:59], v9 offset:24576
    s_waitcnt lgkmcnt(2)
    v_mfma_f32_16x16x32_bf16 v[28:31], v[60:63], a[152:155], v[28:31]
    v_mov_b32 v112, v132
    v_mfma_f32_16x16x32_bf16 v[32:35], v[60:63], a[224:227], v[32:35]
    v_mov_b32 v113, v133
    v_mov_b32 v114, v134
    ds_read_b128 v[60:63], v9 offset:26624
    s_waitcnt lgkmcnt(2)
    v_mfma_f32_16x16x32_bf16 v[28:31], v[64:67], a[156:159], v[28:31]
    s_add_u32 m0, s59, 8192
    s_add_u32 s47, s41, 8192
    buffer_load_dwordx4 v0, s[8:11], s47 offen offset:0 lds
    v_mfma_f32_16x16x32_bf16 v[32:35], v[64:67], a[228:231], v[32:35]
    s_mul_i32 s48, s36, 786432
    s_mul_i32 s18, s37, 6144
    s_add_u32 s48, s48, s18
    s_add_u32 s48, s48, 15728640
    buffer_load_dwordx4 v[80:83], v10, s[8:11], s48 offen offset:0
    v_fma_f32 v144, v144, s52, v72
    ds_read_b128 v[64:67], v9 offset:28672
    s_waitcnt lgkmcnt(2)
    v_mfma_f32_16x16x32_bf16 v[28:31], v[56:59], a[160:163], v[28:31]
    v_fma_f32 v145, v145, s52, v73
    v_fma_f32 v146, v146, s52, v74
    v_fma_f32 v147, v147, s52, v75
    v_mfma_f32_16x16x32_bf16 v[32:35], v[56:59], a[232:235], v[32:35]
    v_fma_f32 v148, v148, s52, v76
    v_fma_f32 v149, v149, s52, v77
    v_fma_f32 v150, v150, s52, v78
    ds_read_b128 v[56:59], v9 offset:30720
    s_waitcnt lgkmcnt(2)
    v_mfma_f32_16x16x32_bf16 v[28:31], v[60:63], a[164:167], v[28:31]
    v_fma_f32 v151, v151, s52, v79
    v_add_f32 v144, s46, v144
    v_add_f32 v145, s46, v145
    v_mfma_f32_16x16x32_bf16 v[32:35], v[60:63], a[236:239], v[32:35]
    v_add_f32 v146, s46, v146
    v_add_f32 v147, s46, v147
    v_max3_f32 v5, v144, v145, v146
    ds_read_b128 v[60:63], v9 offset:32768
    s_waitcnt lgkmcnt(2)
    v_mfma_f32_16x16x32_bf16 v[28:31], v[64:67], a[168:171], v[28:31]
    v_max3_f32 v5, v5, v147, v148
    v_max3_f32 v5, v5, v149, v150
    v_max_f32 v5, v5, v151
    v_mfma_f32_16x16x32_bf16 v[32:35], v[64:67], a[240:243], v[32:35]
    buffer_load_dwordx4 v[84:87], v10, s[8:11], s48 offen offset:512
    v_mov_b32 v6, v5
    s_nop 1
    v_permlane32_swap_b32 v5, v6
    ds_read_b128 v[64:67], v9 offset:34816
    s_waitcnt lgkmcnt(2)
    v_mfma_f32_16x16x32_bf16 v[28:31], v[56:59], a[172:175], v[28:31]
    buffer_load_dwordx4 v[88:91], v10, s[8:11], s48 offen offset:1024
    v_max_f32 v5, v5, v6
    v_mov_b32 v6, v5
    v_mfma_f32_16x16x32_bf16 v[32:35], v[56:59], a[244:247], v[32:35]
    s_nop 0
    v_permlane16_swap_b32 v5, v6
    v_max_f32 v5, v5, v6
    v_sub_f32 v144, v144, v5
    s_waitcnt lgkmcnt(1)
    v_mfma_f32_16x16x32_bf16 v[28:31], v[60:63], a[176:179], v[28:31]
    v_sub_f32 v145, v145, v5
    v_sub_f32 v146, v146, v5
    v_sub_f32 v147, v147, v5
    v_mfma_f32_16x16x32_bf16 v[32:35], v[60:63], a[248:251], v[32:35]
    v_sub_f32 v148, v148, v5
    v_sub_f32 v149, v149, v5
    v_sub_f32 v150, v150, v5
    s_waitcnt lgkmcnt(0)
    v_mfma_f32_16x16x32_bf16 v[28:31], v[64:67], a[180:183], v[28:31]
    v_sub_f32 v151, v151, v5
    v_exp_f32 v144, v144
    v_exp_f32 v145, v145
    v_mfma_f32_16x16x32_bf16 v[32:35], v[64:67], a[252:255], v[32:35]
    v_exp_f32 v146, v146
    v_exp_f32 v147, v147
    v_exp_f32 v148, v148
    v_cmp_eq_u32 s[76:77], 1, v2
    v_cmp_eq_u32 vcc, 2, v2
    s_cmp_eq_u64 s[76:77], -1
    s_cselect_b32 s38, 1, 0
    s_cmp_lg_u32 s38, 0
    s_cselect_b64 exec, 1, 0
    v_mov_b32 v15, s32
    ds_write_b32 v110, v15
    v_mov_b32 v2, 2
    s_mov_b64 exec, -1
    s_add_u32 s32, s32, s38
    s_mul_i32 s38, s38, 22528
    s_add_u32 s33, s33, s38
    s_cmp_eq_u64 vcc, 0
    s_cselect_b32 s38, s32, 0x7fff
    s_cmp_le_u32 s38, s39
    s_cselect_b64 exec, -1, 0
    v_mov_b32 v2, 2
    buffer_load_dword v2, v1, s[8:11], s33 offen sc1
    s_mov_b64 exec, -1
    v_exp_f32 v149, v149
    v_exp_f32 v150, v150
    v_exp_f32 v151, v151
    v_cvt_pk_bf16_f32 v68, v144, v145
    v_cvt_pk_bf16_f32 v69, v146, v147
    v_cvt_pk_bf16_f32 v70, v148, v149
    v_cvt_pk_bf16_f32 v71, v150, v151
    s_nop 1
    v_mfma_f32_16x16x32_bf16 v[16:19], v[116:119], v[68:71], 0
    s_mul_i32 s46, s57, 36864
    s_add_u32 s46, s46, 17301504
    s_nop 5
    v_rcp_f32 v6, v16
    v_mul_f32 v94, v97, v48
    v_fma_f32 v28, v28, v96, -v94
    v_mul_f32 v94, v99, v49
    v_fma_f32 v29, v29, v98, -v94
    v_mul_f32 v94, v101, v50
    v_fma_f32 v30, v30, v100, -v94
    v_mul_f32 v94, v103, v51
    v_fma_f32 v31, v31, v102, -v94
    v_cvt_pk_bf16_f32 v138, v28, v29
    v_cvt_pk_bf16_f32 v139, v30, v31
    v_mul_f32 v94, v97, v52
    v_fma_f32 v32, v32, v96, -v94
    v_mfma_f32_16x16x32_bf16 v[20:23], v[136:139], v[68:71], 0
    v_mul_f32 v94, v99, v53
    v_fma_f32 v33, v33, v98, -v94
    v_mul_f32 v94, v101, v54
    v_fma_f32 v34, v34, v100, -v94
    v_mul_f32 v94, v103, v55
    v_fma_f32 v35, v35, v102, -v94
    v_cvt_pk_bf16_f32 v142, v32, v33
    v_cvt_pk_bf16_f32 v143, v34, v35
    v_mov_b32 v136, v138
    v_mov_b32 v137, v139
    v_mfma_f32_16x16x32_bf16 v[24:27], v[140:143], v[68:71], 0
    v_mul_f32 v20, v6, v20
    v_mul_f32 v21, v6, v21
    v_mul_f32 v22, v6, v22
    v_mul_f32 v23, v6, v23
    v_cvt_pk_bf16_f32 v20, v20, v21
    v_cvt_pk_bf16_f32 v21, v22, v23
    s_mov_b64 exec, -1
    buffer_store_dwordx2 v[20:21], v13, s[8:11], s46 offen
    s_and_b64 exec, exec, s[78:79]
    buffer_store_dwordx2 v[20:21], v13, s[8:11], s46 offen sc1
    s_mov_b64 exec, -1
    v_mov_b32 v140, v142
    v_mov_b32 v141, v143
    v_mul_f32 v24, v6, v24
    v_mul_f32 v25, v6, v25
    v_cvt_pk_bf16_f32 v24, v24, v25
    s_mov_b64 exec, 0xffff
    buffer_store_dword v24, v14, s[8:11], s46 offen
    s_and_b64 exec, exec, s[78:79]
    buffer_store_dword v24, v14, s[8:11], s46 offen sc1
    s_mov_b64 exec, -1
    s_mul_i32 s43, s57, 22528
    s_add_u32 s43, s43, s49
    s_branch Laq_head
Laq_none:
    ds_read_b32 v15, v110
    s_waitcnt lgkmcnt(0)
    v_readfirstlane_b32 s17, v15
    s_nop 0
    s_cmp_lt_i32 s17, s37
    s_cbranch_scc1 Laq_nopost
    s_add_u32 m0, s59, 0
    s_add_u32 s47, s41, 0
    buffer_load_dwordx4 v0, s[8:11], s47 offen offset:0 lds
    buffer_load_dwordx4 v0, s[8:11], s47 offen offset:1024 lds
    buffer_load_dwordx4 v0, s[8:11], s47 offen offset:2048 lds
    buffer_load_dwordx4 v0, s[8:11], s47 offen offset:3072 lds
    s_add_u32 m0, s59, 4096
    s_add_u32 s47, s41, 4096
    buffer_load_dwordx4 v0, s[8:11], s47 offen offset:0 lds
    buffer_load_dwordx4 v0, s[8:11], s47 offen offset:1024 lds
    buffer_load_dwordx4 v0, s[8:11], s47 offen offset:2048 lds
    buffer_load_dwordx4 v0, s[8:11], s47 offen offset:3072 lds
    s_add_u32 m0, s59, 8192
    s_add_u32 s47, s41, 8192
    buffer_load_dwordx4 v0, s[8:11], s47 offen offset:0 lds
    s_mul_i32 s48, s36, 786432
    s_mul_i32 s18, s37, 6144
    s_add_u32 s48, s48, s18
    s_add_u32 s48, s48, 15728640
    buffer_load_dwordx4 v[80:83], v10, s[8:11], s48 offen offset:0
    buffer_load_dwordx4 v[84:87], v10, s[8:11], s48 offen offset:512
    buffer_load_dwordx4 v[88:91], v10, s[8:11], s48 offen offset:1024
    s_waitcnt vmcnt(12)
    s_cmp_lg_u32 s43, 0
    s_cselect_b64 exec, 1, 0
    buffer_store_dword v3, v4, s[8:11], s43 offen
    s_and_b64 exec, exec, s[78:79]
    buffer_store_dword v3, v4, s[8:11], s43 offen sc1
    s_mov_b64 exec, -1
    s_mov_b32 s43, 0
    s_waitcnt vmcnt(2) lgkmcnt(0)
    s_branch Laq_head2
Laq_nopost:
    s_waitcnt vmcnt(0)
    s_cmp_lg_u32 s43, 0
    s_cselect_b64 exec, 1, 0
    buffer_store_dword v3, v4, s[8:11], s43 offen
    s_and_b64 exec, exec, s[78:79]
    buffer_store_dword v3, v4, s[8:11], s43 offen sc1
    s_mov_b64 exec, -1
    s_mov_b32 s43, 0
    s_cmp_ge_u32 s37, 64
    s_cbranch_scc1 Laq_end
Laq_wait:
    s_mov_b32 s16, 0
    s_cmp_lg_u32 s14, 0
    s_cbranch_scc1 Laq_wl
Laq_wp:
    buffer_load_dword v2, v1, s[8:11], s60 offen sc1
    s_add_u32 s16, s16, 1
    s_cmp_gt_u32 s16, 100000
    s_cbranch_scc1 Laq_giveup
    s_waitcnt vmcnt(0)
    v_cmp_eq_u32 vcc, 0, v2
    s_nop 0
    s_cbranch_vccz Laq_wok
    s_sleep 4
    s_branch Laq_wp
Laq_giveup:
    v_mov_b32 v5, -2
    ds_write_b32 v110, v5
    s_waitcnt lgkmcnt(0)
    s_branch L_role_aq_abort
Laq_wok:
    v_mov_b32 v5, s37
    ds_write_b32 v110, v5
    s_branch Laq_go
Laq_wl:
    ds_read_b32 v15, v110
    s_add_u32 s16, s16, 1
    s_cmp_gt_u32 s16, 1600000
    s_cbranch_scc1 L_role_aq_abort
    s_waitcnt lgkmcnt(0)
    v_readfirstlane_b32 s17, v15
    s_nop 0
    s_cmp_eq_u32 s17, -2
    s_cbranch_scc1 L_role_aq_abort
    s_cmp_ge_i32 s17, s37
    s_cbranch_scc1 Laq_go
    s_sleep 1
    s_branch Laq_wl
Laq_go:
    s_add_u32 m0, s59, 0
    s_add_u32 s47, s41, 0
    buffer_load_dwordx4 v0, s[8:11], s47 offen offset:0 lds
    buffer_load_dwordx4 v0, s[8:11], s47 offen offset:1024 lds
    buffer_load_dwordx4 v0, s[8:11], s47 offen offset:2048 lds
    buffer_load_dwordx4 v0, s[8:11], s47 offen offset:3072 lds
    s_add_u32 m0, s59, 4096
    s_add_u32 s47, s41, 4096
    buffer_load_dwordx4 v0, s[8:11], s47 offen offset:0 lds
    buffer_load_dwordx4 v0, s[8:11], s47 offen offset:1024 lds
    buffer_load_dwordx4 v0, s[8:11], s47 offen offset:2048 lds
    buffer_load_dwordx4 v0, s[8:11], s47 offen offset:3072 lds
    s_add_u32 m0, s59, 8192
    s_add_u32 s47, s41, 8192
    buffer_load_dwordx4 v0, s[8:11], s47 offen offset:0 lds
    s_mul_i32 s48, s36, 786432
    s_mul_i32 s18, s37, 6144
    s_add_u32 s48, s48, s18
    s_add_u32 s48, s48, 15728640
    buffer_load_dwordx4 v[80:83], v10, s[8:11], s48 offen offset:0
    buffer_load_dwordx4 v[84:87], v10, s[8:11], s48 offen offset:512
    buffer_load_dwordx4 v[88:91], v10, s[8:11], s48 offen offset:1024
    s_waitcnt vmcnt(0) lgkmcnt(0)
    s_branch Laq_head2
Laq_end:
    s_branch L_role_aq_exit
L_role_aq_abort:
    s_waitcnt lgkmcnt(0)
    s_mov_b64 exec, -1
    v_mov_b32 v0, 60
    s_lshl_b32 s5, s3, 8
    s_or_b32 s5, s5, s4
    s_or_b32 s5, s5, 0x10000
    v_mov_b32 v1, s5
    global_store_dword v0, v1, s[12:13]
    s_endpgm
L_role_aq_exit:
    s_endpgm
.p2align 6
L_role_ta:
    v_and_b32 v5, 63, v0
    v_lshlrev_b32 v0, 4, v5
    v_and_b32 v7, 15, v5
    v_lshrrev_b32 v8, 4, v5
    v_min_u32 v1, 12, v5
    v_lshrrev_b32 v6, 2, v1
    v_and_b32 v1, 3, v1
    v_lshlrev_b32 v1, 2, v1
    v_lshl_add_u32 v1, v6, 7, v1
    v_mov_b32 v3, 1
    v_mov_b32 v4, 0
    s_mov_b32 s44, 0x05040100
    s_mov_b32 s45, 0x07060302
    s_cmp_ge_u32 s15, 11
    s_cselect_b32 s36, 1, 0
    s_cselect_b32 s17, 11, 0
    s_sub_u32 s17, s15, s17
    s_mul_i32 s50, s17, 3
    s_add_u32 s50, s50, s14
    s_cmp_eq_u32 s14, 3
    s_cselect_b32 s50, 32, s50
    s_mov_b32 s40, s50
    s_mov_b32 s37, 0
    s_mov_b32 s52, 0x3e0293ee
    v_lshrrev_b32 v5, 2, v7
    v_and_b32 v6, 1, v7
    v_lshl_add_u32 v5, v5, 1, v6
    v_lshlrev_b32 v9, 8, v5
    v_lshl_add_u32 v9, v8, 4, v9
    v_lshrrev_b32 v10, 1, v0
    v_mov_b32 v11, 384
    v_mov_b32 v6, 0xf149f2ca
    v_mov_b32 v21, 0
    v_mov_b32 v22, 0
    s_mul_i32 s42, s36, 1441792
    s_lshl_b32 s17, s50, 9
    s_add_u32 s42, s42, s17
    s_add_u32 s42, s42, 5376
    s_mul_i32 s51, s36, 50331648
    s_lshl_b32 s17, s50, 13
    s_add_u32 s51, s51, s17
    s_add_u32 s51, s51, 44040192
    s_lshl_b32 s47, s36, 11
    s_add_u32 s47, s47, s50
    s_lshl_b32 s48, s47, 13
    s_add_u32 s48, s48, 144703488
    s_lshl_b32 s47, s47, 12
    s_add_u32 s47, s47, 27262976
    s_mul_i32 s43, s36, 1441792
    s_lshr_b32 s17, s50, 2
    s_lshl_b32 s17, s17, 7
    s_add_u32 s43, s43, s17
    s_and_b32 s17, s50, 3
    s_lshl_b32 s17, s17, 2
    s_add_u32 s43, s43, s17
    s_add_u32 s43, s43, 4224
    s_mov_b32 s28, s8
    s_mov_b32 s29, s9
    s_mov_b32 s30, 0
    s_mov_b32 s31, 0x00020000
    s_mov_b32 s39, 0
    s_mov_b32 s38, 0
    s_mov_b32 s49, 0
    s_mov_b32 s20, s8
    s_mov_b32 s21, s9
    s_mov_b32 s22, 0
    s_mov_b32 s23, 0x00020000
    v_mov_b32 v16, 0x3f803f80
    v_lshl_add_u32 v5, v8, 2, 0
    v_cmp_le_u32 vcc, v5, v7
    s_nop 1
    v_cndmask_b32 v236, v6, v4, vcc
    v_mov_b32 v17, 0x3f803f80
    v_lshl_add_u32 v5, v8, 2, 1
    v_cmp_le_u32 vcc, v5, v7
    s_nop 1
    v_cndmask_b32 v237, v6, v4, vcc
    v_mov_b32 v18, 0x3f803f80
    v_lshl_add_u32 v5, v8, 2, 2
    v_cmp_le_u32 vcc, v5, v7
    s_nop 1
    v_cndmask_b32 v238, v6, v4, vcc
    v_mov_b32 v19, 0x3f803f80
    v_lshl_add_u32 v5, v8, 2, 3
    v_cmp_le_u32 vcc, v5, v7
    s_nop 1
    v_cndmask_b32 v239, v6, v4, vcc
    v_mov_b32 v15, 0
    s_cmp_lg_u32 s14, 0
    s_cbranch_scc1 Lta_inia_d
    v_mov_b32 v5, 40
    s_mov_b32 s16, 0
Lta_inia:
    global_load_dword v6, v5, s[12:13] sc1
    s_add_u32 s16, s16, 1
    s_cmp_gt_u32 s16, 100000
    s_cbranch_scc1 L_role_ta_abort
    s_waitcnt vmcnt(0)
    v_cmp_gt_u32 vcc, 128, v6
    s_nop 0
    s_cbranch_vccz Lta_inia_d
    s_sleep 8
    s_branch Lta_inia
Lta_inia_d:
    s_barrier
    s_cmp_eq_u32 s36, 0
    s_cbranch_scc1 Lta_ini_sk
    s_cmp_lg_u32 s14, 0
    s_cbranch_scc1 Lta_inib_d
    v_mov_b32 v5, 160
    s_mov_b32 s16, 0
Lta_inib:
    global_load_dword v6, v5, s[12:13] sc1
    s_add_u32 s16, s16, 1
    s_cmp_gt_u32 s16, 100000
    s_cbranch_scc1 L_role_ta_abort
    s_waitcnt vmcnt(0)
    v_cmp_gt_u32 vcc, 64, v6
    s_nop 0
    s_cbranch_vccz Lta_inib_d
    s_sleep 8
    s_branch Lta_inib
Lta_inib_d:
    s_barrier
Lta_ini_sk:
    s_cmp_ge_u32 s40, 32
    s_cbranch_scc1 L_role_ta_exit
Lta0:
    s_cmp_eq_u32 s39, 1
    s_cbranch_scc1 Lta0_have
    s_waitcnt vmcnt(0)
    s_cmp_lg_u32 s49, 0
    s_cselect_b64 exec, 1, 0
    buffer_store_dword v3, v4, s[8:11], s43 offen sc1
    s_mov_b64 exec, -1
    s_add_u32 s43, s43, s49
    s_mov_b32 s49, 0
    s_mov_b32 s16, 0
Lta0_f:
    buffer_load_dword v2, v1, s[8:11], s42 offen sc1
    s_add_u32 s16, s16, 1
    s_cmp_gt_u32 s16, 100000
    s_cbranch_scc1 L_role_ta_abort
    s_waitcnt vmcnt(0)
    v_cmp_eq_u32 vcc, 0, v2
    s_nop 0
    s_and_b32 s17, vcc_lo, 0xfff
    s_cbranch_scc0 Lta0_fd
    s_sleep 4
    s_branch Lta0_f
Lta0_fd:
    s_add_u32 s46, s51, 0
    buffer_load_dwordx4 v[140:143], v0, s[8:11], s46 offen offset:0
    buffer_load_dwordx4 v[144:147], v0, s[8:11], s46 offen offset:1024
    buffer_load_dwordx4 v[148:151], v0, s[8:11], s46 offen offset:2048
    buffer_load_dwordx4 v[152:155], v0, s[8:11], s46 offen offset:3072
    s_add_u32 s46, s51, 4096
    buffer_load_dwordx4 v[156:159], v0, s[8:11], s46 offen offset:0
    buffer_load_dwordx4 v[160:163], v0, s[8:11], s46 offen offset:1024
    buffer_load_dwordx4 v[164:167], v0, s[8:11], s46 offen offset:2048
    buffer_load_dwordx4 v[168:171], v0, s[8:11], s46 offen offset:3072
    s_add_u32 s46, s51, 16777216
    buffer_load_dwordx4 v[172:175], v0, s[8:11], s46 offen offset:0
    buffer_load_dwordx4 v[176:179], v0, s[8:11], s46 offen offset:1024
    buffer_load_dwordx4 v[180:183], v0, s[8:11], s46 offen offset:2048
    buffer_load_dwordx4 v[184:187], v0, s[8:11], s46 offen offset:3072
    s_add_u32 s46, s51, 16781312
    buffer_load_dwordx4 v[188:191], v0, s[8:11], s46 offen offset:0
    buffer_load_dwordx4 v[192:195], v0, s[8:11], s46 offen offset:1024
    buffer_load_dwordx4 v[196:199], v0, s[8:11], s46 offen offset:2048
    buffer_load_dwordx4 v[200:203], v0, s[8:11], s46 offen offset:3072
    s_add_u32 s46, s51, 33554432
    buffer_load_dwordx4 v[204:207], v0, s[8:11], s46 offen offset:0
    buffer_load_dwordx4 v[208:211], v0, s[8:11], s46 offen offset:1024
    buffer_load_dwordx4 v[212:215], v0, s[8:11], s46 offen offset:2048
    buffer_load_dwordx4 v[216:219], v0, s[8:11], s46 offen offset:3072
    s_add_u32 s46, s51, 33558528
    buffer_load_dwordx4 v[220:223], v0, s[8:11], s46 offen offset:0
    buffer_load_dwordx4 v[224:227], v0, s[8:11], s46 offen offset:1024
    buffer_load_dwordx4 v[228:231], v0, s[8:11], s46 offen offset:2048
    buffer_load_dwordx4 v[232:235], v0, s[8:11], s46 offen offset:3072
    s_waitcnt vmcnt(0)
Lta0_have:
    buffer_load_dword v2, v11, s[8:11], s42 offen sc1
    s_waitcnt vmcnt(5)
    v_cmp_eq_u32 vcc, 0, v15
    s_add_u32 s51, s51, 262144
    s_add_u32 s37, s37, 1
    s_mov_b32 s62, s38
    s_and_b32 s17, vcc_lo, 0xfff
    s_cselect_b32 s39, 0, 1
    s_cmp_eq_u64 vcc, 0
    s_cselect_b32 s38, 1, 0
    s_cmp_lt_u32 s37, 64
    s_cselect_b32 s39, s39, 0
    s_cselect_b32 s38, s38, 0
    s_cmp_eq_u32 s39, 1
    s_cselect_b32 s30, 268435456, 0
    s_cmp_eq_u32 s38, 1
    s_cselect_b32 s22, 268435456, 0
    v_mfma_f32_16x16x32_bf16 v[32:35], v[172:175], v[140:143], 0
    s_add_u32 s46, s51, 0
    buffer_load_dwordx4 a[0:3], v0, s[28:31], s46 offen offset:0
    v_mfma_f32_16x16x32_bf16 v[36:39], v[172:175], v[144:147], 0
    buffer_load_dwordx4 a[4:7], v0, s[28:31], s46 offen offset:1024
    v_mfma_f32_16x16x32_bf16 v[40:43], v[176:179], v[144:147], 0
    buffer_load_dwordx4 a[8:11], v0, s[28:31], s46 offen offset:2048
    v_mfma_f32_16x16x32_bf16 v[32:35], v[180:183], v[148:151], v[32:35]
    buffer_load_dwordx4 a[12:15], v0, s[28:31], s46 offen offset:3072
    v_mfma_f32_16x16x32_bf16 v[36:39], v[180:183], v[152:155], v[36:39]
    s_add_u32 s46, s51, 4096
    buffer_load_dwordx4 a[16:19], v0, s[28:31], s46 offen offset:0
    v_mfma_f32_16x16x32_bf16 v[40:43], v[184:187], v[152:155], v[40:43]
    buffer_load_dwordx4 a[20:23], v0, s[28:31], s46 offen offset:1024
    v_mfma_f32_16x16x32_bf16 v[32:35], v[188:191], v[156:159], v[32:35]
    v_mfma_f32_16x16x32_bf16 v[36:39], v[188:191], v[160:163], v[36:39]
    v_mfma_f32_16x16x32_bf16 v[40:43], v[192:195], v[160:163], v[40:43]
    v_mfma_f32_16x16x32_bf16 v[32:35], v[196:199], v[164:167], v[32:35]
    v_mfma_f32_16x16x32_bf16 v[36:39], v[196:199], v[168:171], v[36:39]
    v_mfma_f32_16x16x32_bf16 v[40:43], v[200:203], v[168:171], v[40:43]
    s_waitcnt vmcnt(7)
    s_cmp_lg_u32 s49, 0
    s_cselect_b64 exec, 1, 0
    buffer_store_dword v3, v4, s[8:11], s43 offen sc1
    s_mov_b64 exec, -1
    s_add_u32 s43, s43, s49
    s_mov_b32 s49, 0
    s_cmp_eq_u32 s62, 1
    s_cbranch_scc1 Lta0_km
    s_waitcnt vmcnt(6)
    v_cmp_eq_u32 vcc, 0, v2
    s_nop 0
    s_cbranch_vccz Lta0_r
    s_mov_b32 s16, 0
Lta0_rp:
    buffer_load_dword v2, v11, s[8:11], s42 offen sc1
    s_add_u32 s16, s16, 1
    s_cmp_gt_u32 s16, 100000
    s_cbranch_scc1 L_role_ta_abort
    s_waitcnt vmcnt(0)
    v_cmp_eq_u32 vcc, 0, v2
    s_nop 0
    s_cbranch_vccnz Lta0_rp
Lta0_r:
    buffer_load_dwordx4 a[96:99], v9, s[8:11], s47 offen offset:0
    buffer_load_dwordx4 a[100:103], v9, s[8:11], s47 offen offset:64
    buffer_load_dwordx4 a[104:107], v9, s[8:11], s47 offen offset:128
    buffer_load_dwordx4 a[108:111], v9, s[8:11], s47 offen offset:192
    buffer_load_dwordx2 a[112:113], v10, s[8:11], s47 offen offset:2048
    buffer_load_dwordx2 a[114:115], v10, s[8:11], s47 offen offset:2560
    buffer_load_dwordx2 a[116:117], v10, s[8:11], s47 offen offset:3072
    buffer_load_dwordx2 a[118:119], v10, s[8:11], s47 offen offset:3584
Lta0_km:
    s_add_u32 s42, s42, 22528
    s_add_u32 s47, s47, 131072
    v_fma_f32 v32, v32, s52, v236
    v_fma_f32 v33, v33, s52, v237
    v_fma_f32 v34, v34, s52, v238
    v_fma_f32 v35, v35, s52, v239
    buffer_load_dwordx4 a[24:27], v0, s[28:31], s46 offen offset:2048
    buffer_load_dwordx4 a[28:31], v0, s[28:31], s46 offen offset:3072
    v_mul_f32 v36, s52, v36
    v_mul_f32 v37, s52, v37
    v_mul_f32 v38, s52, v38
    v_mul_f32 v39, s52, v39
    s_add_u32 s46, s51, 16777216
    buffer_load_dwordx4 a[32:35], v0, s[28:31], s46 offen offset:0
    buffer_load_dwordx4 a[36:39], v0, s[28:31], s46 offen offset:1024
    v_fma_f32 v40, v40, s52, v236
    v_fma_f32 v41, v41, s52, v237
    v_fma_f32 v42, v42, s52, v238
    v_fma_f32 v43, v43, s52, v239
    buffer_load_dwordx4 a[40:43], v0, s[28:31], s46 offen offset:2048
    buffer_load_dwordx4 a[44:47], v0, s[28:31], s46 offen offset:3072
    s_waitcnt vmcnt(13)
    v_mfma_f32_16x16x32_bf16 v[44:47], a[96:99], v[140:143], 0
    v_mfma_f32_16x16x32_bf16 v[48:51], a[96:99], v[144:147], 0
    s_add_u32 s46, s51, 16781312
    buffer_load_dwordx4 a[48:51], v0, s[28:31], s46 offen offset:0
    s_waitcnt vmcnt(13)
    v_mfma_f32_16x16x32_bf16 v[44:47], a[100:103], v[148:151], v[44:47]
    v_mfma_f32_16x16x32_bf16 v[48:51], a[100:103], v[152:155], v[48:51]
    buffer_load_dwordx4 a[52:55], v0, s[28:31], s46 offen offset:1024
    s_waitcnt vmcnt(13)
    v_mfma_f32_16x16x32_bf16 v[44:47], a[104:107], v[156:159], v[44:47]
    v_mfma_f32_16x16x32_bf16 v[48:51], a[104:107], v[160:163], v[48:51]
    buffer_load_dwordx4 a[56:59], v0, s[28:31], s46 offen offset:2048
    s_waitcnt vmcnt(13)
    v_mfma_f32_16x16x32_bf16 v[44:47], a[108:111], v[164:167], v[44:47]
    v_mfma_f32_16x16x32_bf16 v[48:51], a[108:111], v[168:171], v[48:51]
    buffer_load_dwordx4 a[60:63], v0, s[28:31], s46 offen offset:3072
    v_max3_f32 v5, v32, v33, v34
    v_max_f32 v5, v5, v35
    s_nop 0
    v_mul_f32 v44, s52, v44
    v_mul_f32 v45, s52, v45
    v_max3_f32 v5, v5, v44, v45
    v_mov_b32 v6, v5
    s_add_u32 s46, s51, 33554432
    buffer_load_dwordx4 a[64:67], v0, s[28:31], s46 offen offset:0
    v_permlane32_swap_b32 v5, v6
    v_max_f32 v5, v5, v6
    v_mov_b32 v6, v5
    buffer_load_dwordx4 a[68:71], v0, s[28:31], s46 offen offset:1024
    s_nop 0
    v_permlane16_swap_b32 v5, v6
    v_max_f32 v5, v5, v6
    v_sub_f32 v32, v32, v5
    v_sub_f32 v33, v33, v5
    v_sub_f32 v34, v34, v5
    v_sub_f32 v35, v35, v5
    v_sub_f32 v44, v44, v5
    v_sub_f32 v45, v45, v5
    v_exp_f32 v32, v32
    v_exp_f32 v33, v33
    v_exp_f32 v34, v34
    v_exp_f32 v35, v35
    v_exp_f32 v44, v44
    v_exp_f32 v45, v45
    v_cvt_pk_bf16_f32 v24, v32, v33
    v_cvt_pk_bf16_f32 v25, v34, v35
    v_mov_b32 v26, 0
    v_mov_b32 v27, 0
    v_cvt_pk_bf16_f32 v20, v44, v45
    v_cvt_pk_bf16_f32 v23, v44, v45
    v_mfma_f32_16x16x32_bf16 v[28:31], v[16:19], v[24:27], 0
    v_mfma_f32_16x16x32_bf16 v[76:79], v[204:207], v[24:27], 0
    v_mfma_f32_16x16x32_bf16 v[80:83], v[208:211], v[24:27], 0
    s_add_u32 s17, s42, 22528
    buffer_load_dword v15, v1, s[8:11], s17 offen sc1
    v_mfma_f32_16x16x32_bf16 v[84:87], v[212:215], v[24:27], 0
    v_mfma_f32_16x16x32_bf16 v[88:91], v[216:219], v[24:27], 0
    buffer_load_dwordx4 a[72:75], v0, s[28:31], s46 offen offset:2048
    v_mfma_f32_16x16x32_bf16 v[92:95], v[220:223], v[24:27], 0
    v_mfma_f32_16x16x32_bf16 v[96:99], v[224:227], v[24:27], 0
    buffer_load_dwordx4 a[76:79], v0, s[28:31], s46 offen offset:3072
    v_mfma_f32_16x16x16_bf16 v[28:31], v[16:17], v[20:21], v[28:31]
    v_mfma_f32_16x16x32_bf16 v[100:103], v[228:231], v[24:27], 0
    v_mfma_f32_16x16x32_bf16 v[104:107], v[232:235], v[24:27], 0
    s_add_u32 s46, s51, 33558528
    buffer_load_dwordx4 a[80:83], v0, s[28:31], s46 offen offset:0
    s_waitcnt vmcnt(19)
    v_mfma_f32_16x16x16_bf16 v[76:79], a[112:113], v[20:21], v[76:79]
    v_mfma_f32_16x16x16_bf16 v[80:83], a[112:113], v[22:23], v[80:83]
    v_rcp_f32 v6, v28
    s_waitcnt vmcnt(18)
    v_mfma_f32_16x16x16_bf16 v[84:87], a[114:115], v[20:21], v[84:87]
    v_mfma_f32_16x16x16_bf16 v[88:91], a[114:115], v[22:23], v[88:91]
    v_mul_f32 v76, v6, v76
    v_mul_f32 v80, v6, v80
    v_cvt_pk_bf16_f32 v108, v76, v80
    v_mul_f32 v77, v6, v77
    v_mul_f32 v81, v6, v81
    v_cvt_pk_bf16_f32 v109, v77, v81
    v_mul_f32 v78, v6, v78
    v_mul_f32 v82, v6, v82
    v_cvt_pk_bf16_f32 v110, v78, v82
    v_mul_f32 v79, v6, v79
    v_mul_f32 v83, v6, v83
    v_cvt_pk_bf16_f32 v111, v79, v83
    s_add_u32 s17, s48, 0
    buffer_store_dwordx4 v[108:111], v0, s[8:11], s17 offen offset:0 sc1
    buffer_load_dwordx4 a[84:87], v0, s[28:31], s46 offen offset:1024
    s_waitcnt vmcnt(19)
    v_mfma_f32_16x16x16_bf16 v[92:95], a[116:117], v[20:21], v[92:95]
    v_mfma_f32_16x16x16_bf16 v[96:99], a[116:117], v[22:23], v[96:99]
    v_mul_f32 v84, v6, v84
    v_mul_f32 v88, v6, v88
    v_cvt_pk_bf16_f32 v112, v84, v88
    v_mul_f32 v85, v6, v85
    v_mul_f32 v89, v6, v89
    v_cvt_pk_bf16_f32 v113, v85, v89
    v_mul_f32 v86, v6, v86
    v_mul_f32 v90, v6, v90
    v_cvt_pk_bf16_f32 v114, v86, v90
    v_mul_f32 v87, v6, v87
    v_mul_f32 v91, v6, v91
    v_cvt_pk_bf16_f32 v115, v87, v91
    buffer_store_dwordx4 v[112:115], v0, s[8:11], s17 offen offset:2048 sc1
    buffer_load_dwordx4 a[88:91], v0, s[28:31], s46 offen offset:2048
    s_waitcnt vmcnt(20)
    v_mfma_f32_16x16x16_bf16 v[100:103], a[118:119], v[20:21], v[100:103]
    v_mfma_f32_16x16x16_bf16 v[104:107], a[118:119], v[22:23], v[104:107]
    v_mul_f32 v92, v6, v92
    v_mul_f32 v96, v6, v96
    v_cvt_pk_bf16_f32 v116, v92, v96
    v_mul_f32 v93, v6, v93
    v_mul_f32 v97, v6, v97
    v_cvt_pk_bf16_f32 v117, v93, v97
    v_mul_f32 v94, v6, v94
    v_mul_f32 v98, v6, v98
    v_cvt_pk_bf16_f32 v118, v94, v98
    v_mul_f32 v95, v6, v95
    v_mul_f32 v99, v6, v99
    v_cvt_pk_bf16_f32 v119, v95, v99
    s_add_u32 s17, s48, 4096
    buffer_store_dwordx4 v[116:119], v0, s[8:11], s17 offen offset:0 sc1
    buffer_load_dwordx4 a[92:95], v0, s[28:31], s46 offen offset:3072
    v_mul_f32 v100, v6, v100
    v_mul_f32 v104, v6, v104
    v_cvt_pk_bf16_f32 v120, v100, v104
    v_mul_f32 v101, v6, v101
    v_mul_f32 v105, v6, v105
    v_cvt_pk_bf16_f32 v121, v101, v105
    v_mul_f32 v102, v6, v102
    v_mul_f32 v106, v6, v106
    v_cvt_pk_bf16_f32 v122, v102, v106
    v_mul_f32 v103, v6, v103
    v_mul_f32 v107, v6, v107
    v_cvt_pk_bf16_f32 v123, v103, v107
    buffer_store_dwordx4 v[120:123], v0, s[8:11], s17 offen offset:2048 sc1
    buffer_load_dwordx4 a[120:123], v9, s[20:23], s47 offen offset:0
    v_max3_f32 v5, v36, v37, v38
    v_max_f32 v5, v5, v39
    v_max3_f32 v5, v5, v40, v41
    v_max3_f32 v5, v5, v42, v43
    v_mul_f32 v48, s52, v48
    v_mul_f32 v49, s52, v49
    v_max3_f32 v5, v5, v48, v49
    v_mov_b32 v6, v5
    buffer_load_dwordx4 a[124:127], v9, s[20:23], s47 offen offset:64
    s_nop 0
    v_permlane32_swap_b32 v5, v6
    v_max_f32 v5, v5, v6
    v_mov_b32 v6, v5
    buffer_load_dwordx4 a[128:131], v9, s[20:23], s47 offen offset:128
    s_nop 0
    v_permlane16_swap_b32 v5, v6
    v_max_f32 v5, v5, v6
    v_sub_f32 v36, v36, v5
    v_sub_f32 v37, v37, v5
    v_sub_f32 v38, v38, v5
    v_sub_f32 v39, v39, v5
    v_sub_f32 v40, v40, v5
    v_sub_f32 v41, v41, v5
    v_sub_f32 v42, v42, v5
    v_sub_f32 v43, v43, v5
    v_sub_f32 v48, v48, v5
    v_sub_f32 v49, v49, v5
    v_exp_f32 v36, v36
    v_exp_f32 v37, v37
    v_exp_f32 v38, v38
    v_exp_f32 v39, v39
    v_exp_f32 v40, v40
    v_exp_f32 v41, v41
    v_exp_f32 v42, v42
    v_exp_f32 v43, v43
    v_exp_f32 v48, v48
    v_exp_f32 v49, v49
    v_cvt_pk_bf16_f32 v24, v36, v37
    v_cvt_pk_bf16_f32 v25, v38, v39
    v_cvt_pk_bf16_f32 v26, v40, v41
    v_cvt_pk_bf16_f32 v27, v42, v43
    v_cvt_pk_bf16_f32 v20, v48, v49
    v_cvt_pk_bf16_f32 v23, v48, v49
    v_mfma_f32_16x16x32_bf16 v[28:31], v[16:19], v[24:27], 0
    v_mfma_f32_16x16x32_bf16 v[76:79], v[204:207], v[24:27], 0
    v_mfma_f32_16x16x32_bf16 v[80:83], v[208:211], v[24:27], 0
    buffer_load_dwordx4 a[132:135], v9, s[20:23], s47 offen offset:192
    v_mfma_f32_16x16x32_bf16 v[84:87], v[212:215], v[24:27], 0
    v_mfma_f32_16x16x32_bf16 v[88:91], v[216:219], v[24:27], 0
    buffer_load_dwordx2 a[136:137], v10, s[20:23], s47 offen offset:2048
    v_mfma_f32_16x16x32_bf16 v[92:95], v[220:223], v[24:27], 0
    v_mfma_f32_16x16x32_bf16 v[96:99], v[224:227], v[24:27], 0
    buffer_load_dwordx2 a[138:139], v10, s[20:23], s47 offen offset:2560
    v_mfma_f32_16x16x16_bf16 v[28:31], v[16:17], v[20:21], v[28:31]
    v_mfma_f32_16x16x32_bf16 v[100:103], v[228:231], v[24:27], 0
    v_mfma_f32_16x16x32_bf16 v[104:107], v[232:235], v[24:27], 0
    buffer_load_dwordx2 a[140:141], v10, s[20:23], s47 offen offset:3072
    buffer_load_dwordx2 a[142:143], v10, s[20:23], s47 offen offset:3584
    v_mfma_f32_16x16x16_bf16 v[76:79], a[112:113], v[20:21], v[76:79]
    v_mfma_f32_16x16x16_bf16 v[80:83], a[112:113], v[22:23], v[80:83]
    v_rcp_f32 v6, v28
    v_mfma_f32_16x16x16_bf16 v[84:87], a[114:115], v[20:21], v[84:87]
    v_mfma_f32_16x16x16_bf16 v[88:91], a[114:115], v[22:23], v[88:91]
    v_mul_f32 v76, v6, v76
    v_mul_f32 v80, v6, v80
    v_cvt_pk_bf16_f32 v124, v76, v80
    v_mul_f32 v77, v6, v77
    v_mul_f32 v81, v6, v81
    v_cvt_pk_bf16_f32 v125, v77, v81
    v_mul_f32 v78, v6, v78
    v_mul_f32 v82, v6, v82
    v_cvt_pk_bf16_f32 v126, v78, v82
    v_mul_f32 v79, v6, v79
    v_mul_f32 v83, v6, v83
    v_cvt_pk_bf16_f32 v127, v79, v83
    s_add_u32 s17, s48, 0
    buffer_store_dwordx4 v[124:127], v0, s[8:11], s17 offen offset:1024 sc1
    v_mfma_f32_16x16x16_bf16 v[92:95], a[116:117], v[20:21], v[92:95]
    v_mfma_f32_16x16x16_bf16 v[96:99], a[116:117], v[22:23], v[96:99]
    v_mul_f32 v84, v6, v84
    v_mul_f32 v88, v6, v88
    v_cvt_pk_bf16_f32 v128, v84, v88
    v_mul_f32 v85, v6, v85
    v_mul_f32 v89, v6, v89
    v_cvt_pk_bf16_f32 v129, v85, v89
    v_mul_f32 v86, v6, v86
    v_mul_f32 v90, v6, v90
    v_cvt_pk_bf16_f32 v130, v86, v90
    v_mul_f32 v87, v6, v87
    v_mul_f32 v91, v6, v91
    v_cvt_pk_bf16_f32 v131, v87, v91
    buffer_store_dwordx4 v[128:131], v0, s[8:11], s17 offen offset:3072 sc1
    v_mfma_f32_16x16x16_bf16 v[100:103], a[118:119], v[20:21], v[100:103]
    v_mfma_f32_16x16x16_bf16 v[104:107], a[118:119], v[22:23], v[104:107]
    v_mul_f32 v92, v6, v92
    v_mul_f32 v96, v6, v96
    v_cvt_pk_bf16_f32 v132, v92, v96
    v_mul_f32 v93, v6, v93
    v_mul_f32 v97, v6, v97
    v_cvt_pk_bf16_f32 v133, v93, v97
    v_mul_f32 v94, v6, v94
    v_mul_f32 v98, v6, v98
    v_cvt_pk_bf16_f32 v134, v94, v98
    v_mul_f32 v95, v6, v95
    v_mul_f32 v99, v6, v99
    v_cvt_pk_bf16_f32 v135, v95, v99
    s_add_u32 s17, s48, 4096
    buffer_store_dwordx4 v[132:135], v0, s[8:11], s17 offen offset:1024 sc1
    v_mul_f32 v100, v6, v100
    v_mul_f32 v104, v6, v104
    v_cvt_pk_bf16_f32 v136, v100, v104
    v_mul_f32 v101, v6, v101
    v_mul_f32 v105, v6, v105
    v_cvt_pk_bf16_f32 v137, v101, v105
    v_mul_f32 v102, v6, v102
    v_mul_f32 v106, v6, v106
    v_cvt_pk_bf16_f32 v138, v102, v106
    v_mul_f32 v103, v6, v103
    v_mul_f32 v107, v6, v107
    v_cvt_pk_bf16_f32 v139, v103, v107
    buffer_store_dwordx4 v[136:139], v0, s[8:11], s17 offen offset:3072 sc1
    s_add_u32 s48, s48, 262144
    s_mov_b32 s49, 22528
    s_cmp_ge_u32 s37, 64
    s_cbranch_scc1 Lta_end
Lta1:
    s_cmp_eq_u32 s39, 1
    s_cbranch_scc1 Lta1_have
    s_waitcnt vmcnt(0)
    s_cmp_lg_u32 s49, 0
    s_cselect_b64 exec, 1, 0
    buffer_store_dword v3, v4, s[8:11], s43 offen sc1
    s_mov_b64 exec, -1
    s_add_u32 s43, s43, s49
    s_mov_b32 s49, 0
    s_mov_b32 s16, 0
Lta1_f:
    buffer_load_dword v2, v1, s[8:11], s42 offen sc1
    s_add_u32 s16, s16, 1
    s_cmp_gt_u32 s16, 100000
    s_cbranch_scc1 L_role_ta_abort
    s_waitcnt vmcnt(0)
    v_cmp_eq_u32 vcc, 0, v2
    s_nop 0
    s_and_b32 s17, vcc_lo, 0xfff
    s_cbranch_scc0 Lta1_fd
    s_sleep 4
    s_branch Lta1_f
Lta1_fd:
    s_add_u32 s46, s51, 0
    buffer_load_dwordx4 a[0:3], v0, s[8:11], s46 offen offset:0
    buffer_load_dwordx4 a[4:7], v0, s[8:11], s46 offen offset:1024
    buffer_load_dwordx4 a[8:11], v0, s[8:11], s46 offen offset:2048
    buffer_load_dwordx4 a[12:15], v0, s[8:11], s46 offen offset:3072
    s_add_u32 s46, s51, 4096
    buffer_load_dwordx4 a[16:19], v0, s[8:11], s46 offen offset:0
    buffer_load_dwordx4 a[20:23], v0, s[8:11], s46 offen offset:1024
    buffer_load_dwordx4 a[24:27], v0, s[8:11], s46 offen offset:2048
    buffer_load_dwordx4 a[28:31], v0, s[8:11], s46 offen offset:3072
    s_add_u32 s46, s51, 16777216
    buffer_load_dwordx4 a[32:35], v0, s[8:11], s46 offen offset:0
    buffer_load_dwordx4 a[36:39], v0, s[8:11], s46 offen offset:1024
    buffer_load_dwordx4 a[40:43], v0, s[8:11], s46 offen offset:2048
    buffer_load_dwordx4 a[44:47], v0, s[8:11], s46 offen offset:3072
    s_add_u32 s46, s51, 16781312
    buffer_load_dwordx4 a[48:51], v0, s[8:11], s46 offen offset:0
    buffer_load_dwordx4 a[52:55], v0, s[8:11], s46 offen offset:1024
    buffer_load_dwordx4 a[56:59], v0, s[8:11], s46 offen offset:2048
    buffer_load_dwordx4 a[60:63], v0, s[8:11], s46 offen offset:3072
    s_add_u32 s46, s51, 33554432
    buffer_load_dwordx4 a[64:67], v0, s[8:11], s46 offen offset:0
    buffer_load_dwordx4 a[68:71], v0, s[8:11], s46 offen offset:1024
    buffer_load_dwordx4 a[72:75], v0, s[8:11], s46 offen offset:2048
    buffer_load_dwordx4 a[76:79], v0, s[8:11], s46 offen offset:3072
    s_add_u32 s46, s51, 33558528
    buffer_load_dwordx4 a[80:83], v0, s[8:11], s46 offen offset:0
    buffer_load_dwordx4 a[84:87], v0, s[8:11], s46 offen offset:1024
    buffer_load_dwordx4 a[88:91], v0, s[8:11], s46 offen offset:2048
    buffer_load_dwordx4 a[92:95], v0, s[8:11], s46 offen offset:3072
    s_waitcnt vmcnt(0)
Lta1_have:
    buffer_load_dword v2, v11, s[8:11], s42 offen sc1
    s_waitcnt vmcnt(5)
    v_cmp_eq_u32 vcc, 0, v15
    s_add_u32 s51, s51, 262144
    s_add_u32 s37, s37, 1
    s_mov_b32 s62, s38
    s_and_b32 s17, vcc_lo, 0xfff
    s_cselect_b32 s39, 0, 1
    s_cmp_eq_u64 vcc, 0
    s_cselect_b32 s38, 1, 0
    s_cmp_lt_u32 s37, 64
    s_cselect_b32 s39, s39, 0
    s_cselect_b32 s38, s38, 0
    s_cmp_eq_u32 s39, 1
    s_cselect_b32 s30, 268435456, 0
    s_cmp_eq_u32 s38, 1
    s_cselect_b32 s22, 268435456, 0
    v_mfma_f32_16x16x32_bf16 v[32:35], a[32:35], a[0:3], 0
    s_add_u32 s46, s51, 0
    buffer_load_dwordx4 v[140:143], v0, s[28:31], s46 offen offset:0
    v_mfma_f32_16x16x32_bf16 v[36:39], a[32:35], a[4:7], 0
    buffer_load_dwordx4 v[144:147], v0, s[28:31], s46 offen offset:1024
    v_mfma_f32_16x16x32_bf16 v[40:43], a[36:39], a[4:7], 0
    buffer_load_dwordx4 v[148:151], v0, s[28:31], s46 offen offset:2048
    v_mfma_f32_16x16x32_bf16 v[32:35], a[40:43], a[8:11], v[32:35]
    buffer_load_dwordx4 v[152:155], v0, s[28:31], s46 offen offset:3072
    v_mfma_f32_16x16x32_bf16 v[36:39], a[40:43], a[12:15], v[36:39]
    s_add_u32 s46, s51, 4096
    buffer_load_dwordx4 v[156:159], v0, s[28:31], s46 offen offset:0
    v_mfma_f32_16x16x32_bf16 v[40:43], a[44:47], a[12:15], v[40:43]
    buffer_load_dwordx4 v[160:163], v0, s[28:31], s46 offen offset:1024
    v_mfma_f32_16x16x32_bf16 v[32:35], a[48:51], a[16:19], v[32:35]
    v_mfma_f32_16x16x32_bf16 v[36:39], a[48:51], a[20:23], v[36:39]
    v_mfma_f32_16x16x32_bf16 v[40:43], a[52:55], a[20:23], v[40:43]
    v_mfma_f32_16x16x32_bf16 v[32:35], a[56:59], a[24:27], v[32:35]
    v_mfma_f32_16x16x32_bf16 v[36:39], a[56:59], a[28:31], v[36:39]
    v_mfma_f32_16x16x32_bf16 v[40:43], a[60:63], a[28:31], v[40:43]
    s_waitcnt vmcnt(7)
    s_cmp_lg_u32 s49, 0
    s_cselect_b64 exec, 1, 0
    buffer_store_dword v3, v4, s[8:11], s43 offen sc1
    s_mov_b64 exec, -1
    s_add_u32 s43, s43, s49
    s_mov_b32 s49, 0
    s_cmp_eq_u32 s62, 1
    s_cbranch_scc1 Lta1_km
    s_waitcnt vmcnt(6)
    v_cmp_eq_u32 vcc, 0, v2
    s_nop 0
    s_cbranch_vccz Lta1_r
    s_mov_b32 s16, 0
Lta1_rp:
    buffer_load_dword v2, v11, s[8:11], s42 offen sc1
    s_add_u32 s16, s16, 1
    s_cmp_gt_u32 s16, 100000
    s_cbranch_scc1 L_role_ta_abort
    s_waitcnt vmcnt(0)
    v_cmp_eq_u32 vcc, 0, v2
    s_nop 0
    s_cbranch_vccnz Lta1_rp
Lta1_r:
    buffer_load_dwordx4 a[120:123], v9, s[8:11], s47 offen offset:0
    buffer_load_dwordx4 a[124:127], v9, s[8:11], s47 offen offset:64
    buffer_load_dwordx4 a[128:131], v9, s[8:11], s47 offen offset:128
    buffer_load_dwordx4 a[132:135], v9, s[8:11], s47 offen offset:192
    buffer_load_dwordx2 a[136:137], v10, s[8:11], s47 offen offset:2048
    buffer_load_dwordx2 a[138:139], v10, s[8:11], s47 offen offset:2560
    buffer_load_dwordx2 a[140:141], v10, s[8:11], s47 offen offset:3072
    buffer_load_dwordx2 a[142:143], v10, s[8:11], s47 offen offset:3584
Lta1_km:
    s_add_u32 s42, s42, 22528
    s_add_u32 s47, s47, 131072
    v_fma_f32 v32, v32, s52, v236
    v_fma_f32 v33, v33, s52, v237
    v_fma_f32 v34, v34, s52, v238
    v_fma_f32 v35, v35, s52, v239
    buffer_load_dwordx4 v[164:167], v0, s[28:31], s46 offen offset:2048
    buffer_load_dwordx4 v[168:171], v0, s[28:31], s46 offen offset:3072
    v_mul_f32 v36, s52, v36
    v_mul_f32 v37, s52, v37
    v_mul_f32 v38, s52, v38
    v_mul_f32 v39, s52, v39
    s_add_u32 s46, s51, 16777216
    buffer_load_dwordx4 v[172:175], v0, s[28:31], s46 offen offset:0
    buffer_load_dwordx4 v[176:179], v0, s[28:31], s46 offen offset:1024
    v_fma_f32 v40, v40, s52, v236
    v_fma_f32 v41, v41, s52, v237
    v_fma_f32 v42, v42, s52, v238
    v_fma_f32 v43, v43, s52, v239
    buffer_load_dwordx4 v[180:183], v0, s[28:31], s46 offen offset:2048
    buffer_load_dwordx4 v[184:187], v0, s[28:31], s46 offen offset:3072
    s_waitcnt vmcnt(13)
    v_mfma_f32_16x16x32_bf16 v[44:47], a[120:123], a[0:3], 0
    v_mfma_f32_16x16x32_bf16 v[48:51], a[120:123], a[4:7], 0
    s_add_u32 s46, s51, 16781312
    buffer_load_dwordx4 v[188:191], v0, s[28:31], s46 offen offset:0
    s_waitcnt vmcnt(13)
    v_mfma_f32_16x16x32_bf16 v[44:47], a[124:127], a[8:11], v[44:47]
    v_mfma_f32_16x16x32_bf16 v[48:51], a[124:127], a[12:15], v[48:51]
    buffer_load_dwordx4 v[192:195], v0, s[28:31], s46 offen offset:1024
    s_waitcnt vmcnt(13)
    v_mfma_f32_16x16x32_bf16 v[44:47], a[128:131], a[16:19], v[44:47]
    v_mfma_f32_16x16x32_bf16 v[48:51], a[128:131], a[20:23], v[48:51]
    buffer_load_dwordx4 v[196:199], v0, s[28:31], s46 offen offset:2048
    s_waitcnt vmcnt(13)
    v_mfma_f32_16x16x32_bf16 v[44:47], a[132:135], a[24:27], v[44:47]
    v_mfma_f32_16x16x32_bf16 v[48:51], a[132:135], a[28:31], v[48:51]
    buffer_load_dwordx4 v[200:203], v0, s[28:31], s46 offen offset:3072
    v_max3_f32 v5, v32, v33, v34
    v_max_f32 v5, v5, v35
    s_nop 0
    v_mul_f32 v44, s52, v44
    v_mul_f32 v45, s52, v45
    v_max3_f32 v5, v5, v44, v45
    v_mov_b32 v6, v5
    s_add_u32 s46, s51, 33554432
    buffer_load_dwordx4 v[204:207], v0, s[28:31], s46 offen offset:0
    v_permlane32_swap_b32 v5, v6
    v_max_f32 v5, v5, v6
    v_mov_b32 v6, v5
    buffer_load_dwordx4 v[208:211], v0, s[28:31], s46 offen offset:1024
    s_nop 0
    v_permlane16_swap_b32 v5, v6
    v_max_f32 v5, v5, v6
    v_sub_f32 v32, v32, v5
    v_sub_f32 v33, v33, v5
    v_sub_f32 v34, v34, v5
    v_sub_f32 v35, v35, v5
    v_sub_f32 v44, v44, v5
    v_sub_f32 v45, v45, v5
    v_exp_f32 v32, v32
    v_exp_f32 v33, v33
    v_exp_f32 v34, v34
    v_exp_f32 v35, v35
    v_exp_f32 v44, v44
    v_exp_f32 v45, v45
    v_cvt_pk_bf16_f32 v24, v32, v33
    v_cvt_pk_bf16_f32 v25, v34, v35
    v_mov_b32 v26, 0
    v_mov_b32 v27, 0
    v_cvt_pk_bf16_f32 v20, v44, v45
    v_cvt_pk_bf16_f32 v23, v44, v45
    v_mfma_f32_16x16x32_bf16 v[28:31], v[16:19], v[24:27], 0
    v_mfma_f32_16x16x32_bf16 v[76:79], a[64:67], v[24:27], 0
    v_mfma_f32_16x16x32_bf16 v[80:83], a[68:71], v[24:27], 0
    s_add_u32 s17, s42, 22528
    buffer_load_dword v15, v1, s[8:11], s17 offen sc1
    v_mfma_f32_16x16x32_bf16 v[84:87], a[72:75], v[24:27], 0
    v_mfma_f32_16x16x32_bf16 v[88:91], a[76:79], v[24:27], 0
    buffer_load_dwordx4 v[212:215], v0, s[28:31], s46 offen offset:2048
    v_mfma_f32_16x16x32_bf16 v[92:95], a[80:83], v[24:27], 0
    v_mfma_f32_16x16x32_bf16 v[96:99], a[84:87], v[24:27], 0
    buffer_load_dwordx4 v[216:219], v0, s[28:31], s46 offen offset:3072
    v_mfma_f32_16x16x16_bf16 v[28:31], v[16:17], v[20:21], v[28:31]
    v_mfma_f32_16x16x32_bf16 v[100:103], a[88:91], v[24:27], 0
    v_mfma_f32_16x16x32_bf16 v[104:107], a[92:95], v[24:27], 0
    s_add_u32 s46, s51, 33558528
    buffer_load_dwordx4 v[220:223], v0, s[28:31], s46 offen offset:0
    s_waitcnt vmcnt(19)
    v_mfma_f32_16x16x16_bf16 v[76:79], a[136:137], v[20:21], v[76:79]
    v_mfma_f32_16x16x16_bf16 v[80:83], a[136:137], v[22:23], v[80:83]
    v_rcp_f32 v6, v28
    s_waitcnt vmcnt(18)
    v_mfma_f32_16x16x16_bf16 v[84:87], a[138:139], v[20:21], v[84:87]
    v_mfma_f32_16x16x16_bf16 v[88:91], a[138:139], v[22:23], v[88:91]
    v_mul_f32 v76, v6, v76
    v_mul_f32 v80, v6, v80
    v_cvt_pk_bf16_f32 v108, v76, v80
    v_mul_f32 v77, v6, v77
    v_mul_f32 v81, v6, v81
    v_cvt_pk_bf16_f32 v109, v77, v81
    v_mul_f32 v78, v6, v78
    v_mul_f32 v82, v6, v82
    v_cvt_pk_bf16_f32 v110, v78, v82
    v_mul_f32 v79, v6, v79
    v_mul_f32 v83, v6, v83
    v_cvt_pk_bf16_f32 v111, v79, v83
    s_add_u32 s17, s48, 0
    buffer_store_dwordx4 v[108:111], v0, s[8:11], s17 offen offset:0 sc1
    buffer_load_dwordx4 v[224:227], v0, s[28:31], s46 offen offset:1024
    s_waitcnt vmcnt(19)
    v_mfma_f32_16x16x16_bf16 v[92:95], a[140:141], v[20:21], v[92:95]
    v_mfma_f32_16x16x16_bf16 v[96:99], a[140:141], v[22:23], v[96:99]
    v_mul_f32 v84, v6, v84
    v_mul_f32 v88, v6, v88
    v_cvt_pk_bf16_f32 v112, v84, v88
    v_mul_f32 v85, v6, v85
    v_mul_f32 v89, v6, v89
    v_cvt_pk_bf16_f32 v113, v85, v89
    v_mul_f32 v86, v6, v86
    v_mul_f32 v90, v6, v90
    v_cvt_pk_bf16_f32 v114, v86, v90
    v_mul_f32 v87, v6, v87
    v_mul_f32 v91, v6, v91
    v_cvt_pk_bf16_f32 v115, v87, v91
    buffer_store_dwordx4 v[112:115], v0, s[8:11], s17 offen offset:2048 sc1
    buffer_load_dwordx4 v[228:231], v0, s[28:31], s46 offen offset:2048
    s_waitcnt vmcnt(20)
    v_mfma_f32_16x16x16_bf16 v[100:103], a[142:143], v[20:21], v[100:103]
    v_mfma_f32_16x16x16_bf16 v[104:107], a[142:143], v[22:23], v[104:107]
    v_mul_f32 v92, v6, v92
    v_mul_f32 v96, v6, v96
    v_cvt_pk_bf16_f32 v116, v92, v96
    v_mul_f32 v93, v6, v93
    v_mul_f32 v97, v6, v97
    v_cvt_pk_bf16_f32 v117, v93, v97
    v_mul_f32 v94, v6, v94
    v_mul_f32 v98, v6, v98
    v_cvt_pk_bf16_f32 v118, v94, v98
    v_mul_f32 v95, v6, v95
    v_mul_f32 v99, v6, v99
    v_cvt_pk_bf16_f32 v119, v95, v99
    s_add_u32 s17, s48, 4096
    buffer_store_dwordx4 v[116:119], v0, s[8:11], s17 offen offset:0 sc1
    buffer_load_dwordx4 v[232:235], v0, s[28:31], s46 offen offset:3072
    v_mul_f32 v100, v6, v100
    v_mul_f32 v104, v6, v104
    v_cvt_pk_bf16_f32 v120, v100, v104
    v_mul_f32 v101, v6, v101
    v_mul_f32 v105, v6, v105
    v_cvt_pk_bf16_f32 v121, v101, v105
    v_mul_f32 v102, v6, v102
    v_mul_f32 v106, v6, v106
    v_cvt_pk_bf16_f32 v122, v102, v106
    v_mul_f32 v103, v6, v103
    v_mul_f32 v107, v6, v107
    v_cvt_pk_bf16_f32 v123, v103, v107
    buffer_store_dwordx4 v[120:123], v0, s[8:11], s17 offen offset:2048 sc1
    buffer_load_dwordx4 a[96:99], v9, s[20:23], s47 offen offset:0
    v_max3_f32 v5, v36, v37, v38
    v_max_f32 v5, v5, v39
    v_max3_f32 v5, v5, v40, v41
    v_max3_f32 v5, v5, v42, v43
    v_mul_f32 v48, s52, v48
    v_mul_f32 v49, s52, v49
    v_max3_f32 v5, v5, v48, v49
    v_mov_b32 v6, v5
    buffer_load_dwordx4 a[100:103], v9, s[20:23], s47 offen offset:64
    s_nop 0
    v_permlane32_swap_b32 v5, v6
    v_max_f32 v5, v5, v6
    v_mov_b32 v6, v5
    buffer_load_dwordx4 a[104:107], v9, s[20:23], s47 offen offset:128
    s_nop 0
    v_permlane16_swap_b32 v5, v6
    v_max_f32 v5, v5, v6
    v_sub_f32 v36, v36, v5
    v_sub_f32 v37, v37, v5
    v_sub_f32 v38, v38, v5
    v_sub_f32 v39, v39, v5
    v_sub_f32 v40, v40, v5
    v_sub_f32 v41, v41, v5
    v_sub_f32 v42, v42, v5
    v_sub_f32 v43, v43, v5
    v_sub_f32 v48, v48, v5
    v_sub_f32 v49, v49, v5
    v_exp_f32 v36, v36
    v_exp_f32 v37, v37
    v_exp_f32 v38, v38
    v_exp_f32 v39, v39
    v_exp_f32 v40, v40
    v_exp_f32 v41, v41
    v_exp_f32 v42, v42
    v_exp_f32 v43, v43
    v_exp_f32 v48, v48
    v_exp_f32 v49, v49
    v_cvt_pk_bf16_f32 v24, v36, v37
    v_cvt_pk_bf16_f32 v25, v38, v39
    v_cvt_pk_bf16_f32 v26, v40, v41
    v_cvt_pk_bf16_f32 v27, v42, v43
    v_cvt_pk_bf16_f32 v20, v48, v49
    v_cvt_pk_bf16_f32 v23, v48, v49
    v_mfma_f32_16x16x32_bf16 v[28:31], v[16:19], v[24:27], 0
    v_mfma_f32_16x16x32_bf16 v[76:79], a[64:67], v[24:27], 0
    v_mfma_f32_16x16x32_bf16 v[80:83], a[68:71], v[24:27], 0
    buffer_load_dwordx4 a[108:111], v9, s[20:23], s47 offen offset:192
    v_mfma_f32_16x16x32_bf16 v[84:87], a[72:75], v[24:27], 0
    v_mfma_f32_16x16x32_bf16 v[88:91], a[76:79], v[24:27], 0
    buffer_load_dwordx2 a[112:113], v10, s[20:23], s47 offen offset:2048
    v_mfma_f32_16x16x32_bf16 v[92:95], a[80:83], v[24:27], 0
    v_mfma_f32_16x16x32_bf16 v[96:99], a[84:87], v[24:27], 0
    buffer_load_dwordx2 a[114:115], v10, s[20:23], s47 offen offset:2560
    v_mfma_f32_16x16x16_bf16 v[28:31], v[16:17], v[20:21], v[28:31]
    v_mfma_f32_16x16x32_bf16 v[100:103], a[88:91], v[24:27], 0
    v_mfma_f32_16x16x32_bf16 v[104:107], a[92:95], v[24:27], 0
    buffer_load_dwordx2 a[116:117], v10, s[20:23], s47 offen offset:3072
    buffer_load_dwordx2 a[118:119], v10, s[20:23], s47 offen offset:3584
    v_mfma_f32_16x16x16_bf16 v[76:79], a[136:137], v[20:21], v[76:79]
    v_mfma_f32_16x16x16_bf16 v[80:83], a[136:137], v[22:23], v[80:83]
    v_rcp_f32 v6, v28
    v_mfma_f32_16x16x16_bf16 v[84:87], a[138:139], v[20:21], v[84:87]
    v_mfma_f32_16x16x16_bf16 v[88:91], a[138:139], v[22:23], v[88:91]
    v_mul_f32 v76, v6, v76
    v_mul_f32 v80, v6, v80
    v_cvt_pk_bf16_f32 v124, v76, v80
    v_mul_f32 v77, v6, v77
    v_mul_f32 v81, v6, v81
    v_cvt_pk_bf16_f32 v125, v77, v81
    v_mul_f32 v78, v6, v78
    v_mul_f32 v82, v6, v82
    v_cvt_pk_bf16_f32 v126, v78, v82
    v_mul_f32 v79, v6, v79
    v_mul_f32 v83, v6, v83
    v_cvt_pk_bf16_f32 v127, v79, v83
    s_add_u32 s17, s48, 0
    buffer_store_dwordx4 v[124:127], v0, s[8:11], s17 offen offset:1024 sc1
    v_mfma_f32_16x16x16_bf16 v[92:95], a[140:141], v[20:21], v[92:95]
    v_mfma_f32_16x16x16_bf16 v[96:99], a[140:141], v[22:23], v[96:99]
    v_mul_f32 v84, v6, v84
    v_mul_f32 v88, v6, v88
    v_cvt_pk_bf16_f32 v128, v84, v88
    v_mul_f32 v85, v6, v85
    v_mul_f32 v89, v6, v89
    v_cvt_pk_bf16_f32 v129, v85, v89
    v_mul_f32 v86, v6, v86
    v_mul_f32 v90, v6, v90
    v_cvt_pk_bf16_f32 v130, v86, v90
    v_mul_f32 v87, v6, v87
    v_mul_f32 v91, v6, v91
    v_cvt_pk_bf16_f32 v131, v87, v91
    buffer_store_dwordx4 v[128:131], v0, s[8:11], s17 offen offset:3072 sc1
    v_mfma_f32_16x16x16_bf16 v[100:103], a[142:143], v[20:21], v[100:103]
    v_mfma_f32_16x16x16_bf16 v[104:107], a[142:143], v[22:23], v[104:107]
    v_mul_f32 v92, v6, v92
    v_mul_f32 v96, v6, v96
    v_cvt_pk_bf16_f32 v132, v92, v96
    v_mul_f32 v93, v6, v93
    v_mul_f32 v97, v6, v97
    v_cvt_pk_bf16_f32 v133, v93, v97
    v_mul_f32 v94, v6, v94
    v_mul_f32 v98, v6, v98
    v_cvt_pk_bf16_f32 v134, v94, v98
    v_mul_f32 v95, v6, v95
    v_mul_f32 v99, v6, v99
    v_cvt_pk_bf16_f32 v135, v95, v99
    s_add_u32 s17, s48, 4096
    buffer_store_dwordx4 v[132:135], v0, s[8:11], s17 offen offset:1024 sc1
    v_mul_f32 v100, v6, v100
    v_mul_f32 v104, v6, v104
    v_cvt_pk_bf16_f32 v136, v100, v104
    v_mul_f32 v101, v6, v101
    v_mul_f32 v105, v6, v105
    v_cvt_pk_bf16_f32 v137, v101, v105
    v_mul_f32 v102, v6, v102
    v_mul_f32 v106, v6, v106
    v_cvt_pk_bf16_f32 v138, v102, v106
    v_mul_f32 v103, v6, v103
    v_mul_f32 v107, v6, v107
    v_cvt_pk_bf16_f32 v139, v103, v107
    buffer_store_dwordx4 v[136:139], v0, s[8:11], s17 offen offset:3072 sc1
    s_add_u32 s48, s48, 262144
    s_mov_b32 s49, 22528
    s_cmp_ge_u32 s37, 64
    s_cbranch_scc1 Lta_end
    s_branch Lta0
Lta_end:
    s_waitcnt vmcnt(0)
    s_mov_b64 exec, 1
    buffer_store_dword v3, v4, s[8:11], s43 offen sc1
    s_mov_b64 exec, -1
    s_branch L_role_ta_exit
L_role_ta_abort:
    s_waitcnt lgkmcnt(0)
    s_mov_b64 exec, -1
    v_mov_b32 v0, 60
    s_lshl_b32 s5, s3, 8
    s_or_b32 s5, s5, s4
    s_or_b32 s5, s5, 0x10000
    v_mov_b32 v1, s5
    global_store_dword v0, v1, s[12:13]
    s_endpgm
L_role_ta_exit:
    s_endpgm
.p2align 6
L_role_tw:
    v_and_b32 v5, 63, v0
    v_lshlrev_b32 v0, 4, v5
    v_and_b32 v7, 15, v5
    v_lshrrev_b32 v8, 4, v5
    v_min_u32 v1, 31, v5
    v_lshrrev_b32 v6, 2, v1
    v_and_b32 v1, 3, v1
    v_lshlrev_b32 v1, 2, v1
    v_lshl_add_u32 v1, v6, 7, v1
    v_mov_b32 v3, 1
    v_mov_b32 v4, 0
    s_mov_b32 s44, 0x05040100
    s_mov_b32 s45, 0x07060302
    s_cmp_lg_u32 s14, 0
    s_cbranch_scc1 Ltw_gate_d
    v_mov_b32 v5, 48
    s_mov_b32 s16, 0
Ltw_gate:
    global_load_dword v6, v5, s[12:13] sc1
    s_add_u32 s16, s16, 1
    s_cmp_gt_u32 s16, 100000
    s_cbranch_scc1 L_role_tw_abort
    s_waitcnt vmcnt(0)
    v_cmp_gt_u32 vcc, 32, v6
    s_nop 0
    s_cbranch_vccz Ltw_gate_d
    s_sleep 100
    s_branch Ltw_gate
Ltw_gate_d:
    s_barrier
    s_load_dwordx2 s[20:21], s[0:1], 64
    s_mov_b32 s22, 4718592
    s_mov_b32 s23, 0x00020000
    s_waitcnt lgkmcnt(0)
    s_and_b32 s21, s21, 0xffff
    s_load_dwordx2 s[24:25], s[0:1], 80
    s_mov_b32 s26, 2359296
    s_mov_b32 s27, 0x00020000
    s_waitcnt lgkmcnt(0)
    s_and_b32 s25, s25, 0xffff
    s_mul_i32 s17, s15, 43
    s_lshr_b32 s32, s17, 9
    s_mul_i32 s17, s32, 12
    s_sub_u32 s50, s15, s17
    s_add_u32 s33, s32, 30
    s_cmp_eq_u32 s32, 2
    s_cselect_b32 s33, 0, s33
    s_cselect_b32 s32, 64, s32
    s_mul_i32 s49, s50, 96
    s_mul_i32 s17, s14, 1179648
    s_add_u32 s49, s49, s17
    v_mul_u32_u24 v5, 4608, v8
    v_lshl_add_u32 v9, v7, 2, v5
    v_add_u32 v10, 18432, v9
    v_and_b32 v6, 14, v7
    v_lshl_add_u32 v12, v6, 1, v5
    v_add_u32 v12, 64, v12
    v_add_u32 v13, 18432, v12
    v_and_b32 v5, 1, v7
    v_mov_b32 v11, s44
    v_mov_b32 v6, s45
    v_cmp_eq_u32 vcc, 1, v5
    s_nop 1
    v_cndmask_b32 v11, v11, v6, vcc
    s_add_u32 s17, s49, 0
    buffer_load_dword v16, v9, s[20:23], s17 offen
    buffer_load_dword v17, v10, s[20:23], s17 offen
    buffer_load_dword v18, v12, s[20:23], s17 offen
    buffer_load_dword v19, v13, s[20:23], s17 offen
    s_add_u32 s17, s49, 1152
    buffer_load_dword v20, v9, s[20:23], s17 offen
    buffer_load_dword v21, v10, s[20:23], s17 offen
    buffer_load_dword v22, v12, s[20:23], s17 offen
    buffer_load_dword v23, v13, s[20:23], s17 offen
    s_add_u32 s17, s49, 2304
    buffer_load_dword v24, v9, s[20:23], s17 offen
    buffer_load_dword v25, v10, s[20:23], s17 offen
    buffer_load_dword v26, v12, s[20:23], s17 offen
    buffer_load_dword v27, v13, s[20:23], s17 offen
    s_add_u32 s17, s49, 3456
    buffer_load_dword v28, v9, s[20:23], s17 offen
    buffer_load_dword v29, v10, s[20:23], s17 offen
    buffer_load_dword v30, v12, s[20:23], s17 offen
    buffer_load_dword v31, v13, s[20:23], s17 offen
    s_add_u32 s17, s49, 36864
    buffer_load_dword v32, v9, s[20:23], s17 offen
    buffer_load_dword v33, v10, s[20:23], s17 offen
    buffer_load_dword v34, v12, s[20:23], s17 offen
    buffer_load_dword v35, v13, s[20:23], s17 offen
    s_add_u32 s17, s49, 38016
    buffer_load_dword v36, v9, s[20:23], s17 offen
    buffer_load_dword v37, v10, s[20:23], s17 offen
    buffer_load_dword v38, v12, s[20:23], s17 offen
    buffer_load_dword v39, v13, s[20:23], s17 offen
    s_add_u32 s17, s49, 39168
    buffer_load_dword v40, v9, s[20:23], s17 offen
    buffer_load_dword v41, v10, s[20:23], s17 offen
    buffer_load_dword v42, v12, s[20:23], s17 offen
    buffer_load_dword v43, v13, s[20:23], s17 offen
    s_add_u32 s17, s49, 40320
    buffer_load_dword v44, v9, s[20:23], s17 offen
    buffer_load_dword v45, v10, s[20:23], s17 offen
    buffer_load_dword v46, v12, s[20:23], s17 offen
    buffer_load_dword v47, v13, s[20:23], s17 offen
    s_add_u32 s17, s49, 73728
    buffer_load_dword v48, v9, s[20:23], s17 offen
    buffer_load_dword v49, v10, s[20:23], s17 offen
    buffer_load_dword v50, v12, s[20:23], s17 offen
    buffer_load_dword v51, v13, s[20:23], s17 offen
    s_add_u32 s17, s49, 74880
    buffer_load_dword v52, v9, s[20:23], s17 offen
    buffer_load_dword v53, v10, s[20:23], s17 offen
    buffer_load_dword v54, v12, s[20:23], s17 offen
    buffer_load_dword v55, v13, s[20:23], s17 offen
    s_add_u32 s17, s49, 76032
    buffer_load_dword v56, v9, s[20:23], s17 offen
    buffer_load_dword v57, v10, s[20:23], s17 offen
    buffer_load_dword v58, v12, s[20:23], s17 offen
    buffer_load_dword v59, v13, s[20:23], s17 offen
    s_add_u32 s17, s49, 77184
    buffer_load_dword v60, v9, s[20:23], s17 offen
    buffer_load_dword v61, v10, s[20:23], s17 offen
    buffer_load_dword v62, v12, s[20:23], s17 offen
    buffer_load_dword v63, v13, s[20:23], s17 offen
    s_add_u32 s17, s49, 110592
    buffer_load_dword v64, v9, s[20:23], s17 offen
    buffer_load_dword v65, v10, s[20:23], s17 offen
    buffer_load_dword v66, v12, s[20:23], s17 offen
    buffer_load_dword v67, v13, s[20:23], s17 offen
    s_add_u32 s17, s49, 111744
    buffer_load_dword v68, v9, s[20:23], s17 offen
    buffer_load_dword v69, v10, s[20:23], s17 offen
    buffer_load_dword v70, v12, s[20:23], s17 offen
    buffer_load_dword v71, v13, s[20:23], s17 offen
    s_add_u32 s17, s49, 112896
    buffer_load_dword v72, v9, s[20:23], s17 offen
    buffer_load_dword v73, v10, s[20:23], s17 offen
    buffer_load_dword v74, v12, s[20:23], s17 offen
    buffer_load_dword v75, v13, s[20:23], s17 offen
    s_waitcnt vmcnt(58)
    v_perm_b32 v5, v17, v16, s44
    v_perm_b32 v6, v17, v16, s45
    s_waitcnt vmcnt(56)
    v_perm_b32 v128, v19, v18, v11
    v_accvgpr_write_b32 a0, v5
    v_accvgpr_write_b32 a4, v6
    s_add_u32 s17, s49, 114048
    buffer_load_dword v76, v9, s[20:23], s17 offen
    buffer_load_dword v77, v10, s[20:23], s17 offen
    buffer_load_dword v78, v12, s[20:23], s17 offen
    buffer_load_dword v79, v13, s[20:23], s17 offen
    s_waitcnt vmcnt(58)
    v_perm_b32 v5, v21, v20, s44
    v_perm_b32 v6, v21, v20, s45
    s_waitcnt vmcnt(56)
    v_perm_b32 v129, v23, v22, v11
    v_accvgpr_write_b32 a1, v5
    v_accvgpr_write_b32 a5, v6
    s_add_u32 s17, s49, 147456
    buffer_load_dword v80, v9, s[20:23], s17 offen
    buffer_load_dword v81, v10, s[20:23], s17 offen
    buffer_load_dword v82, v12, s[20:23], s17 offen
    buffer_load_dword v83, v13, s[20:23], s17 offen
    s_waitcnt vmcnt(58)
    v_perm_b32 v5, v25, v24, s44
    v_perm_b32 v6, v25, v24, s45
    s_waitcnt vmcnt(56)
    v_perm_b32 v130, v27, v26, v11
    v_accvgpr_write_b32 a2, v5
    v_accvgpr_write_b32 a6, v6
    s_add_u32 s17, s49, 148608
    buffer_load_dword v84, v9, s[20:23], s17 offen
    buffer_load_dword v85, v10, s[20:23], s17 offen
    buffer_load_dword v86, v12, s[20:23], s17 offen
    buffer_load_dword v87, v13, s[20:23], s17 offen
    s_waitcnt vmcnt(58)
    v_perm_b32 v5, v29, v28, s44
    v_perm_b32 v6, v29, v28, s45
    s_waitcnt vmcnt(56)
    v_perm_b32 v131, v31, v30, v11
    v_accvgpr_write_b32 a3, v5
    v_accvgpr_write_b32 a7, v6
    s_add_u32 s17, s49, 149760
    buffer_load_dword v88, v9, s[20:23], s17 offen
    buffer_load_dword v89, v10, s[20:23], s17 offen
    buffer_load_dword v90, v12, s[20:23], s17 offen
    buffer_load_dword v91, v13, s[20:23], s17 offen
    s_waitcnt vmcnt(58)
    v_perm_b32 v5, v33, v32, s44
    v_perm_b32 v6, v33, v32, s45
    s_waitcnt vmcnt(56)
    v_perm_b32 v132, v35, v34, v11
    v_accvgpr_write_b32 a8, v5
    v_accvgpr_write_b32 a12, v6
    s_add_u32 s17, s49, 150912
    buffer_load_dword v92, v9, s[20:23], s17 offen
    buffer_load_dword v93, v10, s[20:23], s17 offen
    buffer_load_dword v94, v12, s[20:23], s17 offen
    buffer_load_dword v95, v13, s[20:23], s17 offen
    s_waitcnt vmcnt(58)
    v_perm_b32 v5, v37, v36, s44
    v_perm_b32 v6, v37, v36, s45
    s_waitcnt vmcnt(56)
    v_perm_b32 v133, v39, v38, v11
    v_accvgpr_write_b32 a9, v5
    v_accvgpr_write_b32 a13, v6
    s_add_u32 s17, s49, 184320
    buffer_load_dword v96, v9, s[20:23], s17 offen
    buffer_load_dword v97, v10, s[20:23], s17 offen
    buffer_load_dword v98, v12, s[20:23], s17 offen
    buffer_load_dword v99, v13, s[20:23], s17 offen
    s_waitcnt vmcnt(58)
    v_perm_b32 v5, v41, v40, s44
    v_perm_b32 v6, v41, v40, s45
    s_waitcnt vmcnt(56)
    v_perm_b32 v134, v43, v42, v11
    v_accvgpr_write_b32 a10, v5
    v_accvgpr_write_b32 a14, v6
    s_add_u32 s17, s49, 185472
    buffer_load_dword v100, v9, s[20:23], s17 offen
    buffer_load_dword v101, v10, s[20:23], s17 offen
    buffer_load_dword v102, v12, s[20:23], s17 offen
    buffer_load_dword v103, v13, s[20:23], s17 offen
    s_waitcnt vmcnt(58)
    v_perm_b32 v5, v45, v44, s44
    v_perm_b32 v6, v45, v44, s45
    s_waitcnt vmcnt(56)
    v_perm_b32 v135, v47, v46, v11
    v_accvgpr_write_b32 a11, v5
    v_accvgpr_write_b32 a15, v6
    s_add_u32 s17, s49, 186624
    buffer_load_dword v104, v9, s[20:23], s17 offen
    buffer_load_dword v105, v10, s[20:23], s17 offen
    buffer_load_dword v106, v12, s[20:23], s17 offen
    buffer_load_dword v107, v13, s[20:23], s17 offen
    s_waitcnt vmcnt(58)
    v_perm_b32 v5, v49, v48, s44
    v_perm_b32 v6, v49, v48, s45
    s_waitcnt vmcnt(56)
    v_perm_b32 v136, v51, v50, v11
    v_accvgpr_write_b32 a16, v5
    v_accvgpr_write_b32 a20, v6
    s_add_u32 s17, s49, 187776
    buffer_load_dword v108, v9, s[20:23], s17 offen
    buffer_load_dword v109, v10, s[20:23], s17 offen
    buffer_load_dword v110, v12, s[20:23], s17 offen
    buffer_load_dword v111, v13, s[20:23], s17 offen
    s_waitcnt vmcnt(58)
    v_perm_b32 v5, v53, v52, s44
    v_perm_b32 v6, v53, v52, s45
    s_waitcnt vmcnt(56)
    v_perm_b32 v137, v55, v54, v11
    v_accvgpr_write_b32 a17, v5
    v_accvgpr_write_b32 a21, v6
    s_add_u32 s17, s49, 221184
    buffer_load_dword v112, v9, s[20:23], s17 offen
    buffer_load_dword v113, v10, s[20:23], s17 offen
    buffer_load_dword v114, v12, s[20:23], s17 offen
    buffer_load_dword v115, v13, s[20:23], s17 offen
    s_waitcnt vmcnt(58)
    v_perm_b32 v5, v57, v56, s44
    v_perm_b32 v6, v57, v56, s45
    s_waitcnt vmcnt(56)
    v_perm_b32 v138, v59, v58, v11
    v_accvgpr_write_b32 a18, v5
    v_accvgpr_write_b32 a22, v6
    s_add_u32 s17, s49, 222336
    buffer_load_dword v116, v9, s[20:23], s17 offen
    buffer_load_dword v117, v10, s[20:23], s17 offen
    buffer_load_dword v118, v12, s[20:23], s17 offen
    buffer_load_dword v119, v13, s[20:23], s17 offen
    s_waitcnt vmcnt(58)
    v_perm_b32 v5, v61, v60, s44
    v_perm_b32 v6, v61, v60, s45
    s_waitcnt vmcnt(56)
    v_perm_b32 v139, v63, v62, v11
    v_accvgpr_write_b32 a19, v5
    v_accvgpr_write_b32 a23, v6
    s_add_u32 s17, s49, 223488
    buffer_load_dword v120, v9, s[20:23], s17 offen
    buffer_load_dword v121, v10, s[20:23], s17 offen
    buffer_load_dword v122, v12, s[20:23], s17 offen
    buffer_load_dword v123, v13, s[20:23], s17 offen
    s_waitcnt vmcnt(58)
    v_perm_b32 v5, v65, v64, s44
    v_perm_b32 v6, v65, v64, s45
    s_waitcnt vmcnt(56)
    v_perm_b32 v140, v67, v66, v11
    v_accvgpr_write_b32 a24, v5
    v_accvgpr_write_b32 a28, v6
    s_add_u32 s17, s49, 224640
    buffer_load_dword v124, v9, s[20:23], s17 offen
    buffer_load_dword v125, v10, s[20:23], s17 offen
    buffer_load_dword v126, v12, s[20:23], s17 offen
    buffer_load_dword v127, v13, s[20:23], s17 offen
    s_waitcnt vmcnt(58)
    v_perm_b32 v5, v69, v68, s44
    v_perm_b32 v6, v69, v68, s45
    s_waitcnt vmcnt(56)
    v_perm_b32 v141, v71, v70, v11
    v_accvgpr_write_b32 a25, v5
    v_accvgpr_write_b32 a29, v6
    s_add_u32 s17, s49, 258048
    buffer_load_dword v16, v9, s[20:23], s17 offen
    buffer_load_dword v17, v10, s[20:23], s17 offen
    buffer_load_dword v18, v12, s[20:23], s17 offen
    buffer_load_dword v19, v13, s[20:23], s17 offen
    s_waitcnt vmcnt(58)
    v_perm_b32 v5, v73, v72, s44
    v_perm_b32 v6, v73, v72, s45
    s_waitcnt vmcnt(56)
    v_perm_b32 v142, v75, v74, v11
    v_accvgpr_write_b32 a26, v5
    v_accvgpr_write_b32 a30, v6
    s_add_u32 s17, s49, 259200
    buffer_load_dword v20, v9, s[20:23], s17 offen
    buffer_load_dword v21, v10, s[20:23], s17 offen
    buffer_load_dword v22, v12, s[20:23], s17 offen
    buffer_load_dword v23, v13, s[20:23], s17 offen
    s_waitcnt vmcnt(58)
    v_perm_b32 v5, v77, v76, s44
    v_perm_b32 v6, v77, v76, s45
    s_waitcnt vmcnt(56)
    v_perm_b32 v143, v79, v78, v11
    v_accvgpr_write_b32 a27, v5
    v_accvgpr_write_b32 a31, v6
    s_add_u32 s17, s49, 260352
    buffer_load_dword v24, v9, s[20:23], s17 offen
    buffer_load_dword v25, v10, s[20:23], s17 offen
    buffer_load_dword v26, v12, s[20:23], s17 offen
    buffer_load_dword v27, v13, s[20:23], s17 offen
    s_waitcnt vmcnt(58)
    v_perm_b32 v5, v81, v80, s44
    v_perm_b32 v6, v81, v80, s45
    s_waitcnt vmcnt(56)
    v_perm_b32 v144, v83, v82, v11
    v_accvgpr_write_b32 a32, v5
    v_accvgpr_write_b32 a36, v6
    s_add_u32 s17, s49, 261504
    buffer_load_dword v28, v9, s[20:23], s17 offen
    buffer_load_dword v29, v10, s[20:23], s17 offen
    buffer_load_dword v30, v12, s[20:23], s17 offen
    buffer_load_dword v31, v13, s[20:23], s17 offen
    s_waitcnt vmcnt(58)
    v_perm_b32 v5, v85, v84, s44
    v_perm_b32 v6, v85, v84, s45
    s_waitcnt vmcnt(56)
    v_perm_b32 v145, v87, v86, v11
    v_accvgpr_write_b32 a33, v5
    v_accvgpr_write_b32 a37, v6
    s_add_u32 s17, s49, 294912
    buffer_load_dword v32, v9, s[20:23], s17 offen
    buffer_load_dword v33, v10, s[20:23], s17 offen
    buffer_load_dword v34, v12, s[20:23], s17 offen
    buffer_load_dword v35, v13, s[20:23], s17 offen
    s_waitcnt vmcnt(58)
    v_perm_b32 v5, v89, v88, s44
    v_perm_b32 v6, v89, v88, s45
    s_waitcnt vmcnt(56)
    v_perm_b32 v146, v91, v90, v11
    v_accvgpr_write_b32 a34, v5
    v_accvgpr_write_b32 a38, v6
    s_add_u32 s17, s49, 296064
    buffer_load_dword v36, v9, s[20:23], s17 offen
    buffer_load_dword v37, v10, s[20:23], s17 offen
    buffer_load_dword v38, v12, s[20:23], s17 offen
    buffer_load_dword v39, v13, s[20:23], s17 offen
    s_waitcnt vmcnt(58)
    v_perm_b32 v5, v93, v92, s44
    v_perm_b32 v6, v93, v92, s45
    s_waitcnt vmcnt(56)
    v_perm_b32 v147, v95, v94, v11
    v_accvgpr_write_b32 a35, v5
    v_accvgpr_write_b32 a39, v6
    s_add_u32 s17, s49, 297216
    buffer_load_dword v40, v9, s[20:23], s17 offen
    buffer_load_dword v41, v10, s[20:23], s17 offen
    buffer_load_dword v42, v12, s[20:23], s17 offen
    buffer_load_dword v43, v13, s[20:23], s17 offen
    s_waitcnt vmcnt(58)
    v_perm_b32 v5, v97, v96, s44
    v_perm_b32 v6, v97, v96, s45
    s_waitcnt vmcnt(56)
    v_perm_b32 v148, v99, v98, v11
    v_accvgpr_write_b32 a40, v5
    v_accvgpr_write_b32 a44, v6
    s_add_u32 s17, s49, 298368
    buffer_load_dword v44, v9, s[20:23], s17 offen
    buffer_load_dword v45, v10, s[20:23], s17 offen
    buffer_load_dword v46, v12, s[20:23], s17 offen
    buffer_load_dword v47, v13, s[20:23], s17 offen
    s_waitcnt vmcnt(58)
    v_perm_b32 v5, v101, v100, s44
    v_perm_b32 v6, v101, v100, s45
    s_waitcnt vmcnt(56)
    v_perm_b32 v149, v103, v102, v11
    v_accvgpr_write_b32 a41, v5
    v_accvgpr_write_b32 a45, v6
    s_add_u32 s17, s49, 331776
    buffer_load_dword v48, v9, s[20:23], s17 offen
    buffer_load_dword v49, v10, s[20:23], s17 offen
    buffer_load_dword v50, v12, s[20:23], s17 offen
    buffer_load_dword v51, v13, s[20:23], s17 offen
    s_waitcnt vmcnt(58)
    v_perm_b32 v5, v105, v104, s44
    v_perm_b32 v6, v105, v104, s45
    s_waitcnt vmcnt(56)
    v_perm_b32 v150, v107, v106, v11
    v_accvgpr_write_b32 a42, v5
    v_accvgpr_write_b32 a46, v6
    s_add_u32 s17, s49, 332928
    buffer_load_dword v52, v9, s[20:23], s17 offen
    buffer_load_dword v53, v10, s[20:23], s17 offen
    buffer_load_dword v54, v12, s[20:23], s17 offen
    buffer_load_dword v55, v13, s[20:23], s17 offen
    s_waitcnt vmcnt(58)
    v_perm_b32 v5, v109, v108, s44
    v_perm_b32 v6, v109, v108, s45
    s_waitcnt vmcnt(56)
    v_perm_b32 v151, v111, v110, v11
    v_accvgpr_write_b32 a43, v5
    v_accvgpr_write_b32 a47, v6
    s_add_u32 s17, s49, 334080
    buffer_load_dword v56, v9, s[20:23], s17 offen
    buffer_load_dword v57, v10, s[20:23], s17 offen
    buffer_load_dword v58, v12, s[20:23], s17 offen
    buffer_load_dword v59, v13, s[20:23], s17 offen
    s_waitcnt vmcnt(58)
    v_perm_b32 v5, v113, v112, s44
    v_perm_b32 v6, v113, v112, s45
    s_waitcnt vmcnt(56)
    v_perm_b32 v152, v115, v114, v11
    v_accvgpr_write_b32 a48, v5
    v_accvgpr_write_b32 a52, v6
    s_add_u32 s17, s49, 335232
    buffer_load_dword v60, v9, s[20:23], s17 offen
    buffer_load_dword v61, v10, s[20:23], s17 offen
    buffer_load_dword v62, v12, s[20:23], s17 offen
    buffer_load_dword v63, v13, s[20:23], s17 offen
    s_waitcnt vmcnt(58)
    v_perm_b32 v5, v117, v116, s44
    v_perm_b32 v6, v117, v116, s45
    s_waitcnt vmcnt(56)
    v_perm_b32 v153, v119, v118, v11
    v_accvgpr_write_b32 a49, v5
    v_accvgpr_write_b32 a53, v6
    s_add_u32 s17, s49, 368640
    buffer_load_dword v64, v9, s[20:23], s17 offen
    buffer_load_dword v65, v10, s[20:23], s17 offen
    buffer_load_dword v66, v12, s[20:23], s17 offen
    buffer_load_dword v67, v13, s[20:23], s17 offen
    s_waitcnt vmcnt(58)
    v_perm_b32 v5, v121, v120, s44
    v_perm_b32 v6, v121, v120, s45
    s_waitcnt vmcnt(56)
    v_perm_b32 v154, v123, v122, v11
    v_accvgpr_write_b32 a50, v5
    v_accvgpr_write_b32 a54, v6
    s_add_u32 s17, s49, 369792
    buffer_load_dword v68, v9, s[20:23], s17 offen
    buffer_load_dword v69, v10, s[20:23], s17 offen
    buffer_load_dword v70, v12, s[20:23], s17 offen
    buffer_load_dword v71, v13, s[20:23], s17 offen
    s_waitcnt vmcnt(58)
    v_perm_b32 v5, v125, v124, s44
    v_perm_b32 v6, v125, v124, s45
    s_waitcnt vmcnt(56)
    v_perm_b32 v155, v127, v126, v11
    v_accvgpr_write_b32 a51, v5
    v_accvgpr_write_b32 a55, v6
    s_add_u32 s17, s49, 370944
    buffer_load_dword v72, v9, s[20:23], s17 offen
    buffer_load_dword v73, v10, s[20:23], s17 offen
    buffer_load_dword v74, v12, s[20:23], s17 offen
    buffer_load_dword v75, v13, s[20:23], s17 offen
    s_waitcnt vmcnt(58)
    v_perm_b32 v5, v17, v16, s44
    v_perm_b32 v6, v17, v16, s45
    s_waitcnt vmcnt(56)
    v_perm_b32 v156, v19, v18, v11
    v_accvgpr_write_b32 a56, v5
    v_accvgpr_write_b32 a60, v6
    s_add_u32 s17, s49, 372096
    buffer_load_dword v76, v9, s[20:23], s17 offen
    buffer_load_dword v77, v10, s[20:23], s17 offen
    buffer_load_dword v78, v12, s[20:23], s17 offen
    buffer_load_dword v79, v13, s[20:23], s17 offen
    s_waitcnt vmcnt(58)
    v_perm_b32 v5, v21, v20, s44
    v_perm_b32 v6, v21, v20, s45
    s_waitcnt vmcnt(56)
    v_perm_b32 v157, v23, v22, v11
    v_accvgpr_write_b32 a57, v5
    v_accvgpr_write_b32 a61, v6
    s_add_u32 s17, s49, 405504
    buffer_load_dword v80, v9, s[20:23], s17 offen
    buffer_load_dword v81, v10, s[20:23], s17 offen
    buffer_load_dword v82, v12, s[20:23], s17 offen
    buffer_load_dword v83, v13, s[20:23], s17 offen
    s_waitcnt vmcnt(58)
    v_perm_b32 v5, v25, v24, s44
    v_perm_b32 v6, v25, v24, s45
    s_waitcnt vmcnt(56)
    v_perm_b32 v158, v27, v26, v11
    v_accvgpr_write_b32 a58, v5
    v_accvgpr_write_b32 a62, v6
    s_add_u32 s17, s49, 406656
    buffer_load_dword v84, v9, s[20:23], s17 offen
    buffer_load_dword v85, v10, s[20:23], s17 offen
    buffer_load_dword v86, v12, s[20:23], s17 offen
    buffer_load_dword v87, v13, s[20:23], s17 offen
    s_waitcnt vmcnt(58)
    v_perm_b32 v5, v29, v28, s44
    v_perm_b32 v6, v29, v28, s45
    s_waitcnt vmcnt(56)
    v_perm_b32 v159, v31, v30, v11
    v_accvgpr_write_b32 a59, v5
    v_accvgpr_write_b32 a63, v6
    s_add_u32 s17, s49, 407808
    buffer_load_dword v88, v9, s[20:23], s17 offen
    buffer_load_dword v89, v10, s[20:23], s17 offen
    buffer_load_dword v90, v12, s[20:23], s17 offen
    buffer_load_dword v91, v13, s[20:23], s17 offen
    s_waitcnt vmcnt(58)
    v_perm_b32 v5, v33, v32, s44
    v_perm_b32 v6, v33, v32, s45
    s_waitcnt vmcnt(56)
    v_perm_b32 v160, v35, v34, v11
    v_accvgpr_write_b32 a64, v5
    v_accvgpr_write_b32 a68, v6
    s_add_u32 s17, s49, 408960
    buffer_load_dword v92, v9, s[20:23], s17 offen
    buffer_load_dword v93, v10, s[20:23], s17 offen
    buffer_load_dword v94, v12, s[20:23], s17 offen
    buffer_load_dword v95, v13, s[20:23], s17 offen
    s_waitcnt vmcnt(58)
    v_perm_b32 v5, v37, v36, s44
    v_perm_b32 v6, v37, v36, s45
    s_waitcnt vmcnt(56)
    v_perm_b32 v161, v39, v38, v11
    v_accvgpr_write_b32 a65, v5
    v_accvgpr_write_b32 a69, v6
    s_add_u32 s17, s49, 442368
    buffer_load_dword v96, v9, s[20:23], s17 offen
    buffer_load_dword v97, v10, s[20:23], s17 offen
    buffer_load_dword v98, v12, s[20:23], s17 offen
    buffer_load_dword v99, v13, s[20:23], s17 offen
    s_waitcnt vmcnt(58)
    v_perm_b32 v5, v41, v40, s44
    v_perm_b32 v6, v41, v40, s45
    s_waitcnt vmcnt(56)
    v_perm_b32 v162, v43, v42, v11
    v_accvgpr_write_b32 a66, v5
    v_accvgpr_write_b32 a70, v6
    s_add_u32 s17, s49, 443520
    buffer_load_dword v100, v9, s[20:23], s17 offen
    buffer_load_dword v101, v10, s[20:23], s17 offen
    buffer_load_dword v102, v12, s[20:23], s17 offen
    buffer_load_dword v103, v13, s[20:23], s17 offen
    s_waitcnt vmcnt(58)
    v_perm_b32 v5, v45, v44, s44
    v_perm_b32 v6, v45, v44, s45
    s_waitcnt vmcnt(56)
    v_perm_b32 v163, v47, v46, v11
    v_accvgpr_write_b32 a67, v5
    v_accvgpr_write_b32 a71, v6
    s_add_u32 s17, s49, 444672
    buffer_load_dword v104, v9, s[20:23], s17 offen
    buffer_load_dword v105, v10, s[20:23], s17 offen
    buffer_load_dword v106, v12, s[20:23], s17 offen
    buffer_load_dword v107, v13, s[20:23], s17 offen
    s_waitcnt vmcnt(58)
    v_perm_b32 v5, v49, v48, s44
    v_perm_b32 v6, v49, v48, s45
    s_waitcnt vmcnt(56)
    v_perm_b32 v164, v51, v50, v11
    v_accvgpr_write_b32 a72, v5
    v_accvgpr_write_b32 a76, v6
    s_add_u32 s17, s49, 445824
    buffer_load_dword v108, v9, s[20:23], s17 offen
    buffer_load_dword v109, v10, s[20:23], s17 offen
    buffer_load_dword v110, v12, s[20:23], s17 offen
    buffer_load_dword v111, v13, s[20:23], s17 offen
    s_waitcnt vmcnt(58)
    v_perm_b32 v5, v53, v52, s44
    v_perm_b32 v6, v53, v52, s45
    s_waitcnt vmcnt(56)
    v_perm_b32 v165, v55, v54, v11
    v_accvgpr_write_b32 a73, v5
    v_accvgpr_write_b32 a77, v6
    s_add_u32 s17, s49, 479232
    buffer_load_dword v112, v9, s[20:23], s17 offen
    buffer_load_dword v113, v10, s[20:23], s17 offen
    buffer_load_dword v114, v12, s[20:23], s17 offen
    buffer_load_dword v115, v13, s[20:23], s17 offen
    s_waitcnt vmcnt(58)
    v_perm_b32 v5, v57, v56, s44
    v_perm_b32 v6, v57, v56, s45
    s_waitcnt vmcnt(56)
    v_perm_b32 v166, v59, v58, v11
    v_accvgpr_write_b32 a74, v5
    v_accvgpr_write_b32 a78, v6
    s_add_u32 s17, s49, 480384
    buffer_load_dword v116, v9, s[20:23], s17 offen
    buffer_load_dword v117, v10, s[20:23], s17 offen
    buffer_load_dword v118, v12, s[20:23], s17 offen
    buffer_load_dword v119, v13, s[20:23], s17 offen
    s_waitcnt vmcnt(58)
    v_perm_b32 v5, v61, v60, s44
    v_perm_b32 v6, v61, v60, s45
    s_waitcnt vmcnt(56)
    v_perm_b32 v167, v63, v62, v11
    v_accvgpr_write_b32 a75, v5
    v_accvgpr_write_b32 a79, v6
    s_add_u32 s17, s49, 481536
    buffer_load_dword v120, v9, s[20:23], s17 offen
    buffer_load_dword v121, v10, s[20:23], s17 offen
    buffer_load_dword v122, v12, s[20:23], s17 offen
    buffer_load_dword v123, v13, s[20:23], s17 offen
    s_waitcnt vmcnt(58)
    v_perm_b32 v5, v65, v64, s44
    v_perm_b32 v6, v65, v64, s45
    s_waitcnt vmcnt(56)
    v_perm_b32 v168, v67, v66, v11
    v_accvgpr_write_b32 a80, v5
    v_accvgpr_write_b32 a84, v6
    s_add_u32 s17, s49, 482688
    buffer_load_dword v124, v9, s[20:23], s17 offen
    buffer_load_dword v125, v10, s[20:23], s17 offen
    buffer_load_dword v126, v12, s[20:23], s17 offen
    buffer_load_dword v127, v13, s[20:23], s17 offen
    s_waitcnt vmcnt(58)
    v_perm_b32 v5, v69, v68, s44
    v_perm_b32 v6, v69, v68, s45
    s_waitcnt vmcnt(56)
    v_perm_b32 v169, v71, v70, v11
    v_accvgpr_write_b32 a81, v5
    v_accvgpr_write_b32 a85, v6
    s_add_u32 s17, s49, 516096
    buffer_load_dword v16, v9, s[20:23], s17 offen
    buffer_load_dword v17, v10, s[20:23], s17 offen
    buffer_load_dword v18, v12, s[20:23], s17 offen
    buffer_load_dword v19, v13, s[20:23], s17 offen
    s_waitcnt vmcnt(58)
    v_perm_b32 v5, v73, v72, s44
    v_perm_b32 v6, v73, v72, s45
    s_waitcnt vmcnt(56)
    v_perm_b32 v170, v75, v74, v11
    v_accvgpr_write_b32 a82, v5
    v_accvgpr_write_b32 a86, v6
    s_add_u32 s17, s49, 517248
    buffer_load_dword v20, v9, s[20:23], s17 offen
    buffer_load_dword v21, v10, s[20:23], s17 offen
    buffer_load_dword v22, v12, s[20:23], s17 offen
    buffer_load_dword v23, v13, s[20:23], s17 offen
    s_waitcnt vmcnt(58)
    v_perm_b32 v5, v77, v76, s44
    v_perm_b32 v6, v77, v76, s45
    s_waitcnt vmcnt(56)
    v_perm_b32 v171, v79, v78, v11
    v_accvgpr_write_b32 a83, v5
    v_accvgpr_write_b32 a87, v6
    s_add_u32 s17, s49, 518400
    buffer_load_dword v24, v9, s[20:23], s17 offen
    buffer_load_dword v25, v10, s[20:23], s17 offen
    buffer_load_dword v26, v12, s[20:23], s17 offen
    buffer_load_dword v27, v13, s[20:23], s17 offen
    s_waitcnt vmcnt(58)
    v_perm_b32 v5, v81, v80, s44
    v_perm_b32 v6, v81, v80, s45
    s_waitcnt vmcnt(56)
    v_perm_b32 v172, v83, v82, v11
    v_accvgpr_write_b32 a88, v5
    v_accvgpr_write_b32 a92, v6
    s_add_u32 s17, s49, 519552
    buffer_load_dword v28, v9, s[20:23], s17 offen
    buffer_load_dword v29, v10, s[20:23], s17 offen
    buffer_load_dword v30, v12, s[20:23], s17 offen
    buffer_load_dword v31, v13, s[20:23], s17 offen
    s_waitcnt vmcnt(58)
    v_perm_b32 v5, v85, v84, s44
    v_perm_b32 v6, v85, v84, s45
    s_waitcnt vmcnt(56)
    v_perm_b32 v173, v87, v86, v11
    v_accvgpr_write_b32 a89, v5
    v_accvgpr_write_b32 a93, v6
    s_add_u32 s17, s49, 552960
    buffer_load_dword v32, v9, s[20:23], s17 offen
    buffer_load_dword v33, v10, s[20:23], s17 offen
    buffer_load_dword v34, v12, s[20:23], s17 offen
    buffer_load_dword v35, v13, s[20:23], s17 offen
    s_waitcnt vmcnt(58)
    v_perm_b32 v5, v89, v88, s44
    v_perm_b32 v6, v89, v88, s45
    s_waitcnt vmcnt(56)
    v_perm_b32 v174, v91, v90, v11
    v_accvgpr_write_b32 a90, v5
    v_accvgpr_write_b32 a94, v6
    s_add_u32 s17, s49, 554112
    buffer_load_dword v36, v9, s[20:23], s17 offen
    buffer_load_dword v37, v10, s[20:23], s17 offen
    buffer_load_dword v38, v12, s[20:23], s17 offen
    buffer_load_dword v39, v13, s[20:23], s17 offen
    s_waitcnt vmcnt(58)
    v_perm_b32 v5, v93, v92, s44
    v_perm_b32 v6, v93, v92, s45
    s_waitcnt vmcnt(56)
    v_perm_b32 v175, v95, v94, v11
    v_accvgpr_write_b32 a91, v5
    v_accvgpr_write_b32 a95, v6
    s_add_u32 s17, s49, 555264
    buffer_load_dword v40, v9, s[20:23], s17 offen
    buffer_load_dword v41, v10, s[20:23], s17 offen
    buffer_load_dword v42, v12, s[20:23], s17 offen
    buffer_load_dword v43, v13, s[20:23], s17 offen
    s_waitcnt vmcnt(58)
    v_perm_b32 v5, v97, v96, s44
    v_perm_b32 v6, v97, v96, s45
    s_waitcnt vmcnt(56)
    v_perm_b32 v176, v99, v98, v11
    v_accvgpr_write_b32 a96, v5
    v_accvgpr_write_b32 a100, v6
    s_add_u32 s17, s49, 556416
    buffer_load_dword v44, v9, s[20:23], s17 offen
    buffer_load_dword v45, v10, s[20:23], s17 offen
    buffer_load_dword v46, v12, s[20:23], s17 offen
    buffer_load_dword v47, v13, s[20:23], s17 offen
    s_waitcnt vmcnt(58)
    v_perm_b32 v5, v101, v100, s44
    v_perm_b32 v6, v101, v100, s45
    s_waitcnt vmcnt(56)
    v_perm_b32 v177, v103, v102, v11
    v_accvgpr_write_b32 a97, v5
    v_accvgpr_write_b32 a101, v6
    s_add_u32 s17, s49, 589824
    buffer_load_dword v48, v9, s[20:23], s17 offen
    buffer_load_dword v49, v10, s[20:23], s17 offen
    buffer_load_dword v50, v12, s[20:23], s17 offen
    buffer_load_dword v51, v13, s[20:23], s17 offen
    s_waitcnt vmcnt(58)
    v_perm_b32 v5, v105, v104, s44
    v_perm_b32 v6, v105, v104, s45
    s_waitcnt vmcnt(56)
    v_perm_b32 v178, v107, v106, v11
    v_accvgpr_write_b32 a98, v5
    v_accvgpr_write_b32 a102, v6
    s_add_u32 s17, s49, 590976
    buffer_load_dword v52, v9, s[20:23], s17 offen
    buffer_load_dword v53, v10, s[20:23], s17 offen
    buffer_load_dword v54, v12, s[20:23], s17 offen
    buffer_load_dword v55, v13, s[20:23], s17 offen
    s_waitcnt vmcnt(58)
    v_perm_b32 v5, v109, v108, s44
    v_perm_b32 v6, v109, v108, s45
    s_waitcnt vmcnt(56)
    v_perm_b32 v179, v111, v110, v11
    v_accvgpr_write_b32 a99, v5
    v_accvgpr_write_b32 a103, v6
    s_add_u32 s17, s49, 592128
    buffer_load_dword v56, v9, s[20:23], s17 offen
    buffer_load_dword v57, v10, s[20:23], s17 offen
    buffer_load_dword v58, v12, s[20:23], s17 offen
    buffer_load_dword v59, v13, s[20:23], s17 offen
    s_waitcnt vmcnt(58)
    v_perm_b32 v5, v113, v112, s44
    v_perm_b32 v6, v113, v112, s45
    s_waitcnt vmcnt(56)
    v_perm_b32 v180, v115, v114, v11
    v_accvgpr_write_b32 a104, v5
    v_accvgpr_write_b32 a108, v6
    s_add_u32 s17, s49, 593280
    buffer_load_dword v60, v9, s[20:23], s17 offen
    buffer_load_dword v61, v10, s[20:23], s17 offen
    buffer_load_dword v62, v12, s[20:23], s17 offen
    buffer_load_dword v63, v13, s[20:23], s17 offen
    s_waitcnt vmcnt(58)
    v_perm_b32 v5, v117, v116, s44
    v_perm_b32 v6, v117, v116, s45
    s_waitcnt vmcnt(56)
    v_perm_b32 v181, v119, v118, v11
    v_accvgpr_write_b32 a105, v5
    v_accvgpr_write_b32 a109, v6
    s_add_u32 s17, s49, 626688
    buffer_load_dword v64, v9, s[20:23], s17 offen
    buffer_load_dword v65, v10, s[20:23], s17 offen
    buffer_load_dword v66, v12, s[20:23], s17 offen
    buffer_load_dword v67, v13, s[20:23], s17 offen
    s_waitcnt vmcnt(58)
    v_perm_b32 v5, v121, v120, s44
    v_perm_b32 v6, v121, v120, s45
    s_waitcnt vmcnt(56)
    v_perm_b32 v182, v123, v122, v11
    v_accvgpr_write_b32 a106, v5
    v_accvgpr_write_b32 a110, v6
    s_add_u32 s17, s49, 627840
    buffer_load_dword v68, v9, s[20:23], s17 offen
    buffer_load_dword v69, v10, s[20:23], s17 offen
    buffer_load_dword v70, v12, s[20:23], s17 offen
    buffer_load_dword v71, v13, s[20:23], s17 offen
    s_waitcnt vmcnt(58)
    v_perm_b32 v5, v125, v124, s44
    v_perm_b32 v6, v125, v124, s45
    s_waitcnt vmcnt(56)
    v_perm_b32 v183, v127, v126, v11
    v_accvgpr_write_b32 a107, v5
    v_accvgpr_write_b32 a111, v6
    s_add_u32 s17, s49, 628992
    buffer_load_dword v72, v9, s[20:23], s17 offen
    buffer_load_dword v73, v10, s[20:23], s17 offen
    buffer_load_dword v74, v12, s[20:23], s17 offen
    buffer_load_dword v75, v13, s[20:23], s17 offen
    s_waitcnt vmcnt(58)
    v_perm_b32 v5, v17, v16, s44
    v_perm_b32 v6, v17, v16, s45
    s_waitcnt vmcnt(56)
    v_perm_b32 v184, v19, v18, v11
    v_accvgpr_write_b32 a112, v5
    v_accvgpr_write_b32 a116, v6
    s_add_u32 s17, s49, 630144
    buffer_load_dword v76, v9, s[20:23], s17 offen
    buffer_load_dword v77, v10, s[20:23], s17 offen
    buffer_load_dword v78, v12, s[20:23], s17 offen
    buffer_load_dword v79, v13, s[20:23], s17 offen
    s_waitcnt vmcnt(58)
    v_perm_b32 v5, v21, v20, s44
    v_perm_b32 v6, v21, v20, s45
    s_waitcnt vmcnt(56)
    v_perm_b32 v185, v23, v22, v11
    v_accvgpr_write_b32 a113, v5
    v_accvgpr_write_b32 a117, v6
    s_add_u32 s17, s49, 663552
    buffer_load_dword v80, v9, s[20:23], s17 offen
    buffer_load_dword v81, v10, s[20:23], s17 offen
    buffer_load_dword v82, v12, s[20:23], s17 offen
    buffer_load_dword v83, v13, s[20:23], s17 offen
    s_waitcnt vmcnt(58)
    v_perm_b32 v5, v25, v24, s44
    v_perm_b32 v6, v25, v24, s45
    s_waitcnt vmcnt(56)
    v_perm_b32 v186, v27, v26, v11
    v_accvgpr_write_b32 a114, v5
    v_accvgpr_write_b32 a118, v6
    s_add_u32 s17, s49, 664704
    buffer_load_dword v84, v9, s[20:23], s17 offen
    buffer_load_dword v85, v10, s[20:23], s17 offen
    buffer_load_dword v86, v12, s[20:23], s17 offen
    buffer_load_dword v87, v13, s[20:23], s17 offen
    s_waitcnt vmcnt(58)
    v_perm_b32 v5, v29, v28, s44
    v_perm_b32 v6, v29, v28, s45
    s_waitcnt vmcnt(56)
    v_perm_b32 v187, v31, v30, v11
    v_accvgpr_write_b32 a115, v5
    v_accvgpr_write_b32 a119, v6
    s_add_u32 s17, s49, 665856
    buffer_load_dword v88, v9, s[20:23], s17 offen
    buffer_load_dword v89, v10, s[20:23], s17 offen
    buffer_load_dword v90, v12, s[20:23], s17 offen
    buffer_load_dword v91, v13, s[20:23], s17 offen
    s_waitcnt vmcnt(58)
    v_perm_b32 v5, v33, v32, s44
    v_perm_b32 v6, v33, v32, s45
    s_waitcnt vmcnt(56)
    v_perm_b32 v188, v35, v34, v11
    v_accvgpr_write_b32 a120, v5
    v_accvgpr_write_b32 a124, v6
    s_add_u32 s17, s49, 667008
    buffer_load_dword v92, v9, s[20:23], s17 offen
    buffer_load_dword v93, v10, s[20:23], s17 offen
    buffer_load_dword v94, v12, s[20:23], s17 offen
    buffer_load_dword v95, v13, s[20:23], s17 offen
    s_waitcnt vmcnt(58)
    v_perm_b32 v5, v37, v36, s44
    v_perm_b32 v6, v37, v36, s45
    s_waitcnt vmcnt(56)
    v_perm_b32 v189, v39, v38, v11
    v_accvgpr_write_b32 a121, v5
    v_accvgpr_write_b32 a125, v6
    s_add_u32 s17, s49, 700416
    buffer_load_dword v96, v9, s[20:23], s17 offen
    buffer_load_dword v97, v10, s[20:23], s17 offen
    buffer_load_dword v98, v12, s[20:23], s17 offen
    buffer_load_dword v99, v13, s[20:23], s17 offen
    s_waitcnt vmcnt(58)
    v_perm_b32 v5, v41, v40, s44
    v_perm_b32 v6, v41, v40, s45
    s_waitcnt vmcnt(56)
    v_perm_b32 v190, v43, v42, v11
    v_accvgpr_write_b32 a122, v5
    v_accvgpr_write_b32 a126, v6
    s_add_u32 s17, s49, 701568
    buffer_load_dword v100, v9, s[20:23], s17 offen
    buffer_load_dword v101, v10, s[20:23], s17 offen
    buffer_load_dword v102, v12, s[20:23], s17 offen
    buffer_load_dword v103, v13, s[20:23], s17 offen
    s_waitcnt vmcnt(58)
    v_perm_b32 v5, v45, v44, s44
    v_perm_b32 v6, v45, v44, s45
    s_waitcnt vmcnt(56)
    v_perm_b32 v191, v47, v46, v11
    v_accvgpr_write_b32 a123, v5
    v_accvgpr_write_b32 a127, v6
    s_add_u32 s17, s49, 702720
    buffer_load_dword v104, v9, s[20:23], s17 offen
    buffer_load_dword v105, v10, s[20:23], s17 offen
    buffer_load_dword v106, v12, s[20:23], s17 offen
    buffer_load_dword v107, v13, s[20:23], s17 offen
    s_waitcnt vmcnt(58)
    v_perm_b32 v5, v49, v48, s44
    v_perm_b32 v6, v49, v48, s45
    s_waitcnt vmcnt(56)
    v_perm_b32 v192, v51, v50, v11
    v_accvgpr_write_b32 a128, v5
    v_accvgpr_write_b32 a132, v6
    s_add_u32 s17, s49, 703872
    buffer_load_dword v108, v9, s[20:23], s17 offen
    buffer_load_dword v109, v10, s[20:23], s17 offen
    buffer_load_dword v110, v12, s[20:23], s17 offen
    buffer_load_dword v111, v13, s[20:23], s17 offen
    s_waitcnt vmcnt(58)
    v_perm_b32 v5, v53, v52, s44
    v_perm_b32 v6, v53, v52, s45
    s_waitcnt vmcnt(56)
    v_perm_b32 v193, v55, v54, v11
    v_accvgpr_write_b32 a129, v5
    v_accvgpr_write_b32 a133, v6
    s_add_u32 s17, s49, 737280
    buffer_load_dword v112, v9, s[20:23], s17 offen
    buffer_load_dword v113, v10, s[20:23], s17 offen
    buffer_load_dword v114, v12, s[20:23], s17 offen
    buffer_load_dword v115, v13, s[20:23], s17 offen
    s_waitcnt vmcnt(58)
    v_perm_b32 v5, v57, v56, s44
    v_perm_b32 v6, v57, v56, s45
    s_waitcnt vmcnt(56)
    v_perm_b32 v194, v59, v58, v11
    v_accvgpr_write_b32 a130, v5
    v_accvgpr_write_b32 a134, v6
    s_add_u32 s17, s49, 738432
    buffer_load_dword v116, v9, s[20:23], s17 offen
    buffer_load_dword v117, v10, s[20:23], s17 offen
    buffer_load_dword v118, v12, s[20:23], s17 offen
    buffer_load_dword v119, v13, s[20:23], s17 offen
    s_waitcnt vmcnt(58)
    v_perm_b32 v5, v61, v60, s44
    v_perm_b32 v6, v61, v60, s45
    s_waitcnt vmcnt(56)
    v_perm_b32 v195, v63, v62, v11
    v_accvgpr_write_b32 a131, v5
    v_accvgpr_write_b32 a135, v6
    s_add_u32 s17, s49, 739584
    buffer_load_dword v120, v9, s[20:23], s17 offen
    buffer_load_dword v121, v10, s[20:23], s17 offen
    buffer_load_dword v122, v12, s[20:23], s17 offen
    buffer_load_dword v123, v13, s[20:23], s17 offen
    s_waitcnt vmcnt(58)
    v_perm_b32 v5, v65, v64, s44
    v_perm_b32 v6, v65, v64, s45
    s_waitcnt vmcnt(56)
    v_perm_b32 v196, v67, v66, v11
    v_accvgpr_write_b32 a136, v5
    v_accvgpr_write_b32 a140, v6
    s_add_u32 s17, s49, 740736
    buffer_load_dword v124, v9, s[20:23], s17 offen
    buffer_load_dword v125, v10, s[20:23], s17 offen
    buffer_load_dword v126, v12, s[20:23], s17 offen
    buffer_load_dword v127, v13, s[20:23], s17 offen
    s_waitcnt vmcnt(58)
    v_perm_b32 v5, v69, v68, s44
    v_perm_b32 v6, v69, v68, s45
    s_waitcnt vmcnt(56)
    v_perm_b32 v197, v71, v70, v11
    v_accvgpr_write_b32 a137, v5
    v_accvgpr_write_b32 a141, v6
    s_add_u32 s17, s49, 774144
    buffer_load_dword v16, v9, s[20:23], s17 offen
    buffer_load_dword v17, v10, s[20:23], s17 offen
    buffer_load_dword v18, v12, s[20:23], s17 offen
    buffer_load_dword v19, v13, s[20:23], s17 offen
    s_waitcnt vmcnt(58)
    v_perm_b32 v5, v73, v72, s44
    v_perm_b32 v6, v73, v72, s45
    s_waitcnt vmcnt(56)
    v_perm_b32 v198, v75, v74, v11
    v_accvgpr_write_b32 a138, v5
    v_accvgpr_write_b32 a142, v6
    s_add_u32 s17, s49, 775296
    buffer_load_dword v20, v9, s[20:23], s17 offen
    buffer_load_dword v21, v10, s[20:23], s17 offen
    buffer_load_dword v22, v12, s[20:23], s17 offen
    buffer_load_dword v23, v13, s[20:23], s17 offen
    s_waitcnt vmcnt(58)
    v_perm_b32 v5, v77, v76, s44
    v_perm_b32 v6, v77, v76, s45
    s_waitcnt vmcnt(56)
    v_perm_b32 v199, v79, v78, v11
    v_accvgpr_write_b32 a139, v5
    v_accvgpr_write_b32 a143, v6
    s_add_u32 s17, s49, 776448
    buffer_load_dword v24, v9, s[20:23], s17 offen
    buffer_load_dword v25, v10, s[20:23], s17 offen
    buffer_load_dword v26, v12, s[20:23], s17 offen
    buffer_load_dword v27, v13, s[20:23], s17 offen
    s_waitcnt vmcnt(58)
    v_perm_b32 v5, v81, v80, s44
    v_perm_b32 v6, v81, v80, s45
    s_waitcnt vmcnt(56)
    v_perm_b32 v200, v83, v82, v11
    v_accvgpr_write_b32 a144, v5
    v_accvgpr_write_b32 a148, v6
    s_add_u32 s17, s49, 777600
    buffer_load_dword v28, v9, s[20:23], s17 offen
    buffer_load_dword v29, v10, s[20:23], s17 offen
    buffer_load_dword v30, v12, s[20:23], s17 offen
    buffer_load_dword v31, v13, s[20:23], s17 offen
    s_waitcnt vmcnt(58)
    v_perm_b32 v5, v85, v84, s44
    v_perm_b32 v6, v85, v84, s45
    s_waitcnt vmcnt(56)
    v_perm_b32 v201, v87, v86, v11
    v_accvgpr_write_b32 a145, v5
    v_accvgpr_write_b32 a149, v6
    s_add_u32 s17, s49, 811008
    buffer_load_dword v32, v9, s[20:23], s17 offen
    buffer_load_dword v33, v10, s[20:23], s17 offen
    buffer_load_dword v34, v12, s[20:23], s17 offen
    buffer_load_dword v35, v13, s[20:23], s17 offen
    s_waitcnt vmcnt(58)
    v_perm_b32 v5, v89, v88, s44
    v_perm_b32 v6, v89, v88, s45
    s_waitcnt vmcnt(56)
    v_perm_b32 v202, v91, v90, v11
    v_accvgpr_write_b32 a146, v5
    v_accvgpr_write_b32 a150, v6
    s_add_u32 s17, s49, 812160
    buffer_load_dword v36, v9, s[20:23], s17 offen
    buffer_load_dword v37, v10, s[20:23], s17 offen
    buffer_load_dword v38, v12, s[20:23], s17 offen
    buffer_load_dword v39, v13, s[20:23], s17 offen
    s_waitcnt vmcnt(58)
    v_perm_b32 v5, v93, v92, s44
    v_perm_b32 v6, v93, v92, s45
    s_waitcnt vmcnt(56)
    v_perm_b32 v203, v95, v94, v11
    v_accvgpr_write_b32 a147, v5
    v_accvgpr_write_b32 a151, v6
    s_add_u32 s17, s49, 813312
    buffer_load_dword v40, v9, s[20:23], s17 offen
    buffer_load_dword v41, v10, s[20:23], s17 offen
    buffer_load_dword v42, v12, s[20:23], s17 offen
    buffer_load_dword v43, v13, s[20:23], s17 offen
    s_waitcnt vmcnt(58)
    v_perm_b32 v5, v97, v96, s44
    v_perm_b32 v6, v97, v96, s45
    s_waitcnt vmcnt(56)
    v_perm_b32 v204, v99, v98, v11
    v_accvgpr_write_b32 a152, v5
    v_accvgpr_write_b32 a156, v6
    s_add_u32 s17, s49, 814464
    buffer_load_dword v44, v9, s[20:23], s17 offen
    buffer_load_dword v45, v10, s[20:23], s17 offen
    buffer_load_dword v46, v12, s[20:23], s17 offen
    buffer_load_dword v47, v13, s[20:23], s17 offen
    s_waitcnt vmcnt(58)
    v_perm_b32 v5, v101, v100, s44
    v_perm_b32 v6, v101, v100, s45
    s_waitcnt vmcnt(56)
    v_perm_b32 v205, v103, v102, v11
    v_accvgpr_write_b32 a153, v5
    v_accvgpr_write_b32 a157, v6
    s_add_u32 s17, s49, 847872
    buffer_load_dword v48, v9, s[20:23], s17 offen
    buffer_load_dword v49, v10, s[20:23], s17 offen
    buffer_load_dword v50, v12, s[20:23], s17 offen
    buffer_load_dword v51, v13, s[20:23], s17 offen
    s_waitcnt vmcnt(58)
    v_perm_b32 v5, v105, v104, s44
    v_perm_b32 v6, v105, v104, s45
    s_waitcnt vmcnt(56)
    v_perm_b32 v206, v107, v106, v11
    v_accvgpr_write_b32 a154, v5
    v_accvgpr_write_b32 a158, v6
    s_add_u32 s17, s49, 849024
    buffer_load_dword v52, v9, s[20:23], s17 offen
    buffer_load_dword v53, v10, s[20:23], s17 offen
    buffer_load_dword v54, v12, s[20:23], s17 offen
    buffer_load_dword v55, v13, s[20:23], s17 offen
    s_waitcnt vmcnt(58)
    v_perm_b32 v5, v109, v108, s44
    v_perm_b32 v6, v109, v108, s45
    s_waitcnt vmcnt(56)
    v_perm_b32 v207, v111, v110, v11
    v_accvgpr_write_b32 a155, v5
    v_accvgpr_write_b32 a159, v6
    s_add_u32 s17, s49, 850176
    buffer_load_dword v56, v9, s[20:23], s17 offen
    buffer_load_dword v57, v10, s[20:23], s17 offen
    buffer_load_dword v58, v12, s[20:23], s17 offen
    buffer_load_dword v59, v13, s[20:23], s17 offen
    s_waitcnt vmcnt(58)
    v_perm_b32 v5, v113, v112, s44
    v_perm_b32 v6, v113, v112, s45
    s_waitcnt vmcnt(56)
    v_perm_b32 v208, v115, v114, v11
    v_accvgpr_write_b32 a160, v5
    v_accvgpr_write_b32 a164, v6
    s_add_u32 s17, s49, 851328
    buffer_load_dword v60, v9, s[20:23], s17 offen
    buffer_load_dword v61, v10, s[20:23], s17 offen
    buffer_load_dword v62, v12, s[20:23], s17 offen
    buffer_load_dword v63, v13, s[20:23], s17 offen
    s_waitcnt vmcnt(58)
    v_perm_b32 v5, v117, v116, s44
    v_perm_b32 v6, v117, v116, s45
    s_waitcnt vmcnt(56)
    v_perm_b32 v209, v119, v118, v11
    v_accvgpr_write_b32 a161, v5
    v_accvgpr_write_b32 a165, v6
    s_add_u32 s17, s49, 884736
    buffer_load_dword v64, v9, s[20:23], s17 offen
    buffer_load_dword v65, v10, s[20:23], s17 offen
    buffer_load_dword v66, v12, s[20:23], s17 offen
    buffer_load_dword v67, v13, s[20:23], s17 offen
    s_waitcnt vmcnt(58)
    v_perm_b32 v5, v121, v120, s44
    v_perm_b32 v6, v121, v120, s45
    s_waitcnt vmcnt(56)
    v_perm_b32 v210, v123, v122, v11
    v_accvgpr_write_b32 a162, v5
    v_accvgpr_write_b32 a166, v6
    s_add_u32 s17, s49, 885888
    buffer_load_dword v68, v9, s[20:23], s17 offen
    buffer_load_dword v69, v10, s[20:23], s17 offen
    buffer_load_dword v70, v12, s[20:23], s17 offen
    buffer_load_dword v71, v13, s[20:23], s17 offen
    s_waitcnt vmcnt(58)
    v_perm_b32 v5, v125, v124, s44
    v_perm_b32 v6, v125, v124, s45
    s_waitcnt vmcnt(56)
    v_perm_b32 v211, v127, v126, v11
    v_accvgpr_write_b32 a163, v5
    v_accvgpr_write_b32 a167, v6
    s_add_u32 s17, s49, 887040
    buffer_load_dword v72, v9, s[20:23], s17 offen
    buffer_load_dword v73, v10, s[20:23], s17 offen
    buffer_load_dword v74, v12, s[20:23], s17 offen
    buffer_load_dword v75, v13, s[20:23], s17 offen
    s_waitcnt vmcnt(58)
    v_perm_b32 v5, v17, v16, s44
    v_perm_b32 v6, v17, v16, s45
    s_waitcnt vmcnt(56)
    v_perm_b32 v212, v19, v18, v11
    v_accvgpr_write_b32 a168, v5
    v_accvgpr_write_b32 a172, v6
    s_add_u32 s17, s49, 888192
    buffer_load_dword v76, v9, s[20:23], s17 offen
    buffer_load_dword v77, v10, s[20:23], s17 offen
    buffer_load_dword v78, v12, s[20:23], s17 offen
    buffer_load_dword v79, v13, s[20:23], s17 offen
    s_waitcnt vmcnt(58)
    v_perm_b32 v5, v21, v20, s44
    v_perm_b32 v6, v21, v20, s45
    s_waitcnt vmcnt(56)
    v_perm_b32 v213, v23, v22, v11
    v_accvgpr_write_b32 a169, v5
    v_accvgpr_write_b32 a173, v6
    s_add_u32 s17, s49, 921600
    buffer_load_dword v80, v9, s[20:23], s17 offen
    buffer_load_dword v81, v10, s[20:23], s17 offen
    buffer_load_dword v82, v12, s[20:23], s17 offen
    buffer_load_dword v83, v13, s[20:23], s17 offen
    s_waitcnt vmcnt(58)
    v_perm_b32 v5, v25, v24, s44
    v_perm_b32 v6, v25, v24, s45
    s_waitcnt vmcnt(56)
    v_perm_b32 v214, v27, v26, v11
    v_accvgpr_write_b32 a170, v5
    v_accvgpr_write_b32 a174, v6
    s_add_u32 s17, s49, 922752
    buffer_load_dword v84, v9, s[20:23], s17 offen
    buffer_load_dword v85, v10, s[20:23], s17 offen
    buffer_load_dword v86, v12, s[20:23], s17 offen
    buffer_load_dword v87, v13, s[20:23], s17 offen
    s_waitcnt vmcnt(58)
    v_perm_b32 v5, v29, v28, s44
    v_perm_b32 v6, v29, v28, s45
    s_waitcnt vmcnt(56)
    v_perm_b32 v215, v31, v30, v11
    v_accvgpr_write_b32 a171, v5
    v_accvgpr_write_b32 a175, v6
    s_add_u32 s17, s49, 923904
    buffer_load_dword v88, v9, s[20:23], s17 offen
    buffer_load_dword v89, v10, s[20:23], s17 offen
    buffer_load_dword v90, v12, s[20:23], s17 offen
    buffer_load_dword v91, v13, s[20:23], s17 offen
    s_waitcnt vmcnt(58)
    v_perm_b32 v5, v33, v32, s44
    v_perm_b32 v6, v33, v32, s45
    s_waitcnt vmcnt(56)
    v_perm_b32 v216, v35, v34, v11
    v_accvgpr_write_b32 a176, v5
    v_accvgpr_write_b32 a180, v6
    s_add_u32 s17, s49, 925056
    buffer_load_dword v92, v9, s[20:23], s17 offen
    buffer_load_dword v93, v10, s[20:23], s17 offen
    buffer_load_dword v94, v12, s[20:23], s17 offen
    buffer_load_dword v95, v13, s[20:23], s17 offen
    s_waitcnt vmcnt(58)
    v_perm_b32 v5, v37, v36, s44
    v_perm_b32 v6, v37, v36, s45
    s_waitcnt vmcnt(56)
    v_perm_b32 v217, v39, v38, v11
    v_accvgpr_write_b32 a177, v5
    v_accvgpr_write_b32 a181, v6
    s_add_u32 s17, s49, 958464
    buffer_load_dword v96, v9, s[20:23], s17 offen
    buffer_load_dword v97, v10, s[20:23], s17 offen
    buffer_load_dword v98, v12, s[20:23], s17 offen
    buffer_load_dword v99, v13, s[20:23], s17 offen
    s_waitcnt vmcnt(58)
    v_perm_b32 v5, v41, v40, s44
    v_perm_b32 v6, v41, v40, s45
    s_waitcnt vmcnt(56)
    v_perm_b32 v218, v43, v42, v11
    v_accvgpr_write_b32 a178, v5
    v_accvgpr_write_b32 a182, v6
    s_add_u32 s17, s49, 959616
    buffer_load_dword v100, v9, s[20:23], s17 offen
    buffer_load_dword v101, v10, s[20:23], s17 offen
    buffer_load_dword v102, v12, s[20:23], s17 offen
    buffer_load_dword v103, v13, s[20:23], s17 offen
    s_waitcnt vmcnt(58)
    v_perm_b32 v5, v45, v44, s44
    v_perm_b32 v6, v45, v44, s45
    s_waitcnt vmcnt(56)
    v_perm_b32 v219, v47, v46, v11
    v_accvgpr_write_b32 a179, v5
    v_accvgpr_write_b32 a183, v6
    s_add_u32 s17, s49, 960768
    buffer_load_dword v104, v9, s[20:23], s17 offen
    buffer_load_dword v105, v10, s[20:23], s17 offen
    buffer_load_dword v106, v12, s[20:23], s17 offen
    buffer_load_dword v107, v13, s[20:23], s17 offen
    s_waitcnt vmcnt(58)
    v_perm_b32 v5, v49, v48, s44
    v_perm_b32 v6, v49, v48, s45
    s_waitcnt vmcnt(56)
    v_perm_b32 v220, v51, v50, v11
    v_accvgpr_write_b32 a184, v5
    v_accvgpr_write_b32 a188, v6
    s_add_u32 s17, s49, 961920
    buffer_load_dword v108, v9, s[20:23], s17 offen
    buffer_load_dword v109, v10, s[20:23], s17 offen
    buffer_load_dword v110, v12, s[20:23], s17 offen
    buffer_load_dword v111, v13, s[20:23], s17 offen
    s_waitcnt vmcnt(58)
    v_perm_b32 v5, v53, v52, s44
    v_perm_b32 v6, v53, v52, s45
    s_waitcnt vmcnt(56)
    v_perm_b32 v221, v55, v54, v11
    v_accvgpr_write_b32 a185, v5
    v_accvgpr_write_b32 a189, v6
    s_add_u32 s17, s49, 995328
    buffer_load_dword v112, v9, s[20:23], s17 offen
    buffer_load_dword v113, v10, s[20:23], s17 offen
    buffer_load_dword v114, v12, s[20:23], s17 offen
    buffer_load_dword v115, v13, s[20:23], s17 offen
    s_waitcnt vmcnt(58)
    v_perm_b32 v5, v57, v56, s44
    v_perm_b32 v6, v57, v56, s45
    s_waitcnt vmcnt(56)
    v_perm_b32 v222, v59, v58, v11
    v_accvgpr_write_b32 a186, v5
    v_accvgpr_write_b32 a190, v6
    s_add_u32 s17, s49, 996480
    buffer_load_dword v116, v9, s[20:23], s17 offen
    buffer_load_dword v117, v10, s[20:23], s17 offen
    buffer_load_dword v118, v12, s[20:23], s17 offen
    buffer_load_dword v119, v13, s[20:23], s17 offen
    s_waitcnt vmcnt(58)
    v_perm_b32 v5, v61, v60, s44
    v_perm_b32 v6, v61, v60, s45
    s_waitcnt vmcnt(56)
    v_perm_b32 v223, v63, v62, v11
    v_accvgpr_write_b32 a187, v5
    v_accvgpr_write_b32 a191, v6
    s_add_u32 s17, s49, 997632
    buffer_load_dword v120, v9, s[20:23], s17 offen
    buffer_load_dword v121, v10, s[20:23], s17 offen
    buffer_load_dword v122, v12, s[20:23], s17 offen
    buffer_load_dword v123, v13, s[20:23], s17 offen
    s_waitcnt vmcnt(58)
    v_perm_b32 v5, v65, v64, s44
    v_perm_b32 v6, v65, v64, s45
    s_waitcnt vmcnt(56)
    v_perm_b32 v224, v67, v66, v11
    v_accvgpr_write_b32 a192, v5
    v_accvgpr_write_b32 a196, v6
    s_add_u32 s17, s49, 998784
    buffer_load_dword v124, v9, s[20:23], s17 offen
    buffer_load_dword v125, v10, s[20:23], s17 offen
    buffer_load_dword v126, v12, s[20:23], s17 offen
    buffer_load_dword v127, v13, s[20:23], s17 offen
    s_waitcnt vmcnt(58)
    v_perm_b32 v5, v69, v68, s44
    v_perm_b32 v6, v69, v68, s45
    s_waitcnt vmcnt(56)
    v_perm_b32 v225, v71, v70, v11
    v_accvgpr_write_b32 a193, v5
    v_accvgpr_write_b32 a197, v6
    s_add_u32 s17, s49, 1032192
    buffer_load_dword v16, v9, s[20:23], s17 offen
    buffer_load_dword v17, v10, s[20:23], s17 offen
    buffer_load_dword v18, v12, s[20:23], s17 offen
    buffer_load_dword v19, v13, s[20:23], s17 offen
    s_waitcnt vmcnt(58)
    v_perm_b32 v5, v73, v72, s44
    v_perm_b32 v6, v73, v72, s45
    s_waitcnt vmcnt(56)
    v_perm_b32 v226, v75, v74, v11
    v_accvgpr_write_b32 a194, v5
    v_accvgpr_write_b32 a198, v6
    s_add_u32 s17, s49, 1033344
    buffer_load_dword v20, v9, s[20:23], s17 offen
    buffer_load_dword v21, v10, s[20:23], s17 offen
    buffer_load_dword v22, v12, s[20:23], s17 offen
    buffer_load_dword v23, v13, s[20:23], s17 offen
    s_waitcnt vmcnt(58)
    v_perm_b32 v5, v77, v76, s44
    v_perm_b32 v6, v77, v76, s45
    s_waitcnt vmcnt(56)
    v_perm_b32 v227, v79, v78, v11
    v_accvgpr_write_b32 a195, v5
    v_accvgpr_write_b32 a199, v6
    s_add_u32 s17, s49, 1034496
    buffer_load_dword v24, v9, s[20:23], s17 offen
    buffer_load_dword v25, v10, s[20:23], s17 offen
    buffer_load_dword v26, v12, s[20:23], s17 offen
    buffer_load_dword v27, v13, s[20:23], s17 offen
    s_waitcnt vmcnt(58)
    v_perm_b32 v5, v81, v80, s44
    v_perm_b32 v6, v81, v80, s45
    s_waitcnt vmcnt(56)
    v_perm_b32 v228, v83, v82, v11
    v_accvgpr_write_b32 a200, v5
    v_accvgpr_write_b32 a204, v6
    s_add_u32 s17, s49, 1035648
    buffer_load_dword v28, v9, s[20:23], s17 offen
    buffer_load_dword v29, v10, s[20:23], s17 offen
    buffer_load_dword v30, v12, s[20:23], s17 offen
    buffer_load_dword v31, v13, s[20:23], s17 offen
    s_waitcnt vmcnt(58)
    v_perm_b32 v5, v85, v84, s44
    v_perm_b32 v6, v85, v84, s45
    s_waitcnt vmcnt(56)
    v_perm_b32 v229, v87, v86, v11
    v_accvgpr_write_b32 a201, v5
    v_accvgpr_write_b32 a205, v6
    s_add_u32 s17, s49, 1069056
    buffer_load_dword v32, v9, s[20:23], s17 offen
    buffer_load_dword v33, v10, s[20:23], s17 offen
    buffer_load_dword v34, v12, s[20:23], s17 offen
    buffer_load_dword v35, v13, s[20:23], s17 offen
    s_waitcnt vmcnt(58)
    v_perm_b32 v5, v89, v88, s44
    v_perm_b32 v6, v89, v88, s45
    s_waitcnt vmcnt(56)
    v_perm_b32 v230, v91, v90, v11
    v_accvgpr_write_b32 a202, v5
    v_accvgpr_write_b32 a206, v6
    s_add_u32 s17, s49, 1070208
    buffer_load_dword v36, v9, s[20:23], s17 offen
    buffer_load_dword v37, v10, s[20:23], s17 offen
    buffer_load_dword v38, v12, s[20:23], s17 offen
    buffer_load_dword v39, v13, s[20:23], s17 offen
    s_waitcnt vmcnt(58)
    v_perm_b32 v5, v93, v92, s44
    v_perm_b32 v6, v93, v92, s45
    s_waitcnt vmcnt(56)
    v_perm_b32 v231, v95, v94, v11
    v_accvgpr_write_b32 a203, v5
    v_accvgpr_write_b32 a207, v6
    s_add_u32 s17, s49, 1071360
    buffer_load_dword v40, v9, s[20:23], s17 offen
    buffer_load_dword v41, v10, s[20:23], s17 offen
    buffer_load_dword v42, v12, s[20:23], s17 offen
    buffer_load_dword v43, v13, s[20:23], s17 offen
    s_waitcnt vmcnt(58)
    v_perm_b32 v5, v97, v96, s44
    v_perm_b32 v6, v97, v96, s45
    s_waitcnt vmcnt(56)
    v_perm_b32 v232, v99, v98, v11
    v_accvgpr_write_b32 a208, v5
    v_accvgpr_write_b32 a212, v6
    s_add_u32 s17, s49, 1072512
    buffer_load_dword v44, v9, s[20:23], s17 offen
    buffer_load_dword v45, v10, s[20:23], s17 offen
    buffer_load_dword v46, v12, s[20:23], s17 offen
    buffer_load_dword v47, v13, s[20:23], s17 offen
    s_waitcnt vmcnt(58)
    v_perm_b32 v5, v101, v100, s44
    v_perm_b32 v6, v101, v100, s45
    s_waitcnt vmcnt(56)
    v_perm_b32 v233, v103, v102, v11
    v_accvgpr_write_b32 a209, v5
    v_accvgpr_write_b32 a213, v6
    s_add_u32 s17, s49, 1105920
    buffer_load_dword v48, v9, s[20:23], s17 offen
    buffer_load_dword v49, v10, s[20:23], s17 offen
    buffer_load_dword v50, v12, s[20:23], s17 offen
    buffer_load_dword v51, v13, s[20:23], s17 offen
    s_waitcnt vmcnt(58)
    v_perm_b32 v5, v105, v104, s44
    v_perm_b32 v6, v105, v104, s45
    s_waitcnt vmcnt(56)
    v_perm_b32 v234, v107, v106, v11
    v_accvgpr_write_b32 a210, v5
    v_accvgpr_write_b32 a214, v6
    s_add_u32 s17, s49, 1107072
    buffer_load_dword v52, v9, s[20:23], s17 offen
    buffer_load_dword v53, v10, s[20:23], s17 offen
    buffer_load_dword v54, v12, s[20:23], s17 offen
    buffer_load_dword v55, v13, s[20:23], s17 offen
    s_waitcnt vmcnt(58)
    v_perm_b32 v5, v109, v108, s44
    v_perm_b32 v6, v109, v108, s45
    s_waitcnt vmcnt(56)
    v_perm_b32 v235, v111, v110, v11
    v_accvgpr_write_b32 a211, v5
    v_accvgpr_write_b32 a215, v6
    s_add_u32 s17, s49, 1108224
    buffer_load_dword v56, v9, s[20:23], s17 offen
    buffer_load_dword v57, v10, s[20:23], s17 offen
    buffer_load_dword v58, v12, s[20:23], s17 offen
    buffer_load_dword v59, v13, s[20:23], s17 offen
    s_waitcnt vmcnt(58)
    v_perm_b32 v5, v113, v112, s44
    v_perm_b32 v6, v113, v112, s45
    s_waitcnt vmcnt(56)
    v_perm_b32 v236, v115, v114, v11
    v_accvgpr_write_b32 a216, v5
    v_accvgpr_write_b32 a220, v6
    s_add_u32 s17, s49, 1109376
    buffer_load_dword v60, v9, s[20:23], s17 offen
    buffer_load_dword v61, v10, s[20:23], s17 offen
    buffer_load_dword v62, v12, s[20:23], s17 offen
    buffer_load_dword v63, v13, s[20:23], s17 offen
    s_waitcnt vmcnt(58)
    v_perm_b32 v5, v117, v116, s44
    v_perm_b32 v6, v117, v116, s45
    s_waitcnt vmcnt(56)
    v_perm_b32 v237, v119, v118, v11
    v_accvgpr_write_b32 a217, v5
    v_accvgpr_write_b32 a221, v6
    s_add_u32 s17, s49, 1142784
    buffer_load_dword v64, v9, s[20:23], s17 offen
    buffer_load_dword v65, v10, s[20:23], s17 offen
    buffer_load_dword v66, v12, s[20:23], s17 offen
    buffer_load_dword v67, v13, s[20:23], s17 offen
    s_waitcnt vmcnt(58)
    v_perm_b32 v5, v121, v120, s44
    v_perm_b32 v6, v121, v120, s45
    s_waitcnt vmcnt(56)
    v_perm_b32 v238, v123, v122, v11
    v_accvgpr_write_b32 a218, v5
    v_accvgpr_write_b32 a222, v6
    s_add_u32 s17, s49, 1143936
    buffer_load_dword v68, v9, s[20:23], s17 offen
    buffer_load_dword v69, v10, s[20:23], s17 offen
    buffer_load_dword v70, v12, s[20:23], s17 offen
    buffer_load_dword v71, v13, s[20:23], s17 offen
    s_waitcnt vmcnt(58)
    v_perm_b32 v5, v125, v124, s44
    v_perm_b32 v6, v125, v124, s45
    s_waitcnt vmcnt(56)
    v_perm_b32 v239, v127, v126, v11
    v_accvgpr_write_b32 a219, v5
    v_accvgpr_write_b32 a223, v6
    s_add_u32 s17, s49, 1145088
    buffer_load_dword v72, v9, s[20:23], s17 offen
    buffer_load_dword v73, v10, s[20:23], s17 offen
    buffer_load_dword v74, v12, s[20:23], s17 offen
    buffer_load_dword v75, v13, s[20:23], s17 offen
    s_waitcnt vmcnt(58)
    v_perm_b32 v5, v17, v16, s44
    v_perm_b32 v6, v17, v16, s45
    s_waitcnt vmcnt(56)
    v_perm_b32 v240, v19, v18, v11
    v_accvgpr_write_b32 a224, v5
    v_accvgpr_write_b32 a228, v6
    s_add_u32 s17, s49, 1146240
    buffer_load_dword v76, v9, s[20:23], s17 offen
    buffer_load_dword v77, v10, s[20:23], s17 offen
    buffer_load_dword v78, v12, s[20:23], s17 offen
    buffer_load_dword v79, v13, s[20:23], s17 offen
    s_waitcnt vmcnt(58)
    v_perm_b32 v5, v21, v20, s44
    v_perm_b32 v6, v21, v20, s45
    s_waitcnt vmcnt(56)
    v_perm_b32 v241, v23, v22, v11
    v_accvgpr_write_b32 a225, v5
    v_accvgpr_write_b32 a229, v6
    s_waitcnt vmcnt(54)
    v_perm_b32 v5, v25, v24, s44
    v_perm_b32 v6, v25, v24, s45
    s_waitcnt vmcnt(52)
    v_perm_b32 v242, v27, v26, v11
    v_accvgpr_write_b32 a226, v5
    v_accvgpr_write_b32 a230, v6
    s_waitcnt vmcnt(50)
    v_perm_b32 v5, v29, v28, s44
    v_perm_b32 v6, v29, v28, s45
    s_waitcnt vmcnt(48)
    v_perm_b32 v243, v31, v30, v11
    v_accvgpr_write_b32 a227, v5
    v_accvgpr_write_b32 a231, v6
    s_waitcnt vmcnt(46)
    v_perm_b32 v5, v33, v32, s44
    v_perm_b32 v6, v33, v32, s45
    s_waitcnt vmcnt(44)
    v_perm_b32 v244, v35, v34, v11
    v_accvgpr_write_b32 a232, v5
    v_accvgpr_write_b32 a236, v6
    s_waitcnt vmcnt(42)
    v_perm_b32 v5, v37, v36, s44
    v_perm_b32 v6, v37, v36, s45
    s_waitcnt vmcnt(40)
    v_perm_b32 v245, v39, v38, v11
    v_accvgpr_write_b32 a233, v5
    v_accvgpr_write_b32 a237, v6
    s_waitcnt vmcnt(38)
    v_perm_b32 v5, v41, v40, s44
    v_perm_b32 v6, v41, v40, s45
    s_waitcnt vmcnt(36)
    v_perm_b32 v246, v43, v42, v11
    v_accvgpr_write_b32 a234, v5
    v_accvgpr_write_b32 a238, v6
    s_waitcnt vmcnt(34)
    v_perm_b32 v5, v45, v44, s44
    v_perm_b32 v6, v45, v44, s45
    s_waitcnt vmcnt(32)
    v_perm_b32 v247, v47, v46, v11
    v_accvgpr_write_b32 a235, v5
    v_accvgpr_write_b32 a239, v6
    s_waitcnt vmcnt(30)
    v_perm_b32 v5, v49, v48, s44
    v_perm_b32 v6, v49, v48, s45
    s_waitcnt vmcnt(28)
    v_perm_b32 v248, v51, v50, v11
    v_accvgpr_write_b32 a240, v5
    v_accvgpr_write_b32 a244, v6
    s_waitcnt vmcnt(26)
    v_perm_b32 v5, v53, v52, s44
    v_perm_b32 v6, v53, v52, s45
    s_waitcnt vmcnt(24)
    v_perm_b32 v249, v55, v54, v11
    v_accvgpr_write_b32 a241, v5
    v_accvgpr_write_b32 a245, v6
    s_waitcnt vmcnt(22)
    v_perm_b32 v5, v57, v56, s44
    v_perm_b32 v6, v57, v56, s45
    s_waitcnt vmcnt(20)
    v_perm_b32 v250, v59, v58, v11
    v_accvgpr_write_b32 a242, v5
    v_accvgpr_write_b32 a246, v6
    s_waitcnt vmcnt(18)
    v_perm_b32 v5, v61, v60, s44
    v_perm_b32 v6, v61, v60, s45
    s_waitcnt vmcnt(16)
    v_perm_b32 v251, v63, v62, v11
    v_accvgpr_write_b32 a243, v5
    v_accvgpr_write_b32 a247, v6
    s_waitcnt vmcnt(14)
    v_perm_b32 v5, v65, v64, s44
    v_perm_b32 v6, v65, v64, s45
    s_waitcnt vmcnt(12)
    v_perm_b32 v252, v67, v66, v11
    v_accvgpr_write_b32 a248, v5
    v_accvgpr_write_b32 a252, v6
    s_waitcnt vmcnt(10)
    v_perm_b32 v5, v69, v68, s44
    v_perm_b32 v6, v69, v68, s45
    s_waitcnt vmcnt(8)
    v_perm_b32 v253, v71, v70, v11
    v_accvgpr_write_b32 a249, v5
    v_accvgpr_write_b32 a253, v6
    s_waitcnt vmcnt(6)
    v_perm_b32 v5, v73, v72, s44
    v_perm_b32 v6, v73, v72, s45
    s_waitcnt vmcnt(4)
    v_perm_b32 v254, v75, v74, v11
    v_accvgpr_write_b32 a250, v5
    v_accvgpr_write_b32 a254, v6
    s_waitcnt vmcnt(2)
    v_perm_b32 v5, v77, v76, s44
    v_perm_b32 v6, v77, v76, s45
    s_waitcnt vmcnt(0)
    v_perm_b32 v255, v79, v78, v11
    v_accvgpr_write_b32 a251, v5
    v_accvgpr_write_b32 a255, v6
    s_and_b32 s51, s14, 1
    s_lshl_b32 s17, s51, 4
    v_add_u32 v5, s17, v7
    v_lshlrev_b32 v14, 4, v5
    v_mul_u32_u24 v13, 1152, v5
    s_mul_i32 s17, s50, 96
    v_add_u32 v13, s17, v13
    s_mul_i32 s17, s50, 3072
    v_add_u32 v12, s17, v14
    s_lshl_b32 s17, s50, 9
    v_add_u32 v14, s17, v14
    s_lshl_b32 s49, s50, 7
    s_lshl_b32 s17, s14, 2
    s_add_u32 s49, s49, s17
    s_add_u32 s49, s49, 1441792
    s_mul_i32 s17, s14, 6144
    v_add_u32 v48, s17, v0
    v_mov_b32 v49, 0x10000
    s_mul_i32 s17, s50, 43
    v_lshrrev_b32 v10, 4, v0
    v_add_u32 v10, s17, v10
    v_min_u32 v10, 511, v10
    v_lshlrev_b32 v10, 7, v10
    s_cmp_gt_u32 s14, 1
    s_cbranch_scc1 Ltw_z
    v_lshl_add_u32 v12, v8, 9, v12
    v_lshl_add_u32 v13, v8, 4, v13
    s_lshl_b32 s58, s14, 16
    s_add_u32 s58, s58, 144703488
    s_mov_b32 s43, 0
    s_mov_b32 s28, s8
    s_mov_b32 s29, s9
    s_mov_b32 s30, 0
    s_mov_b32 s31, 0x00020000
    s_mul_i32 s17, s51, 3072
    v_add_u32 v50, s17, v0
    ds_write2_b32 v49, v4, v4 offset0:0 offset1:1
    s_waitcnt lgkmcnt(0)
    s_cmp_lg_u32 s14, 0
    s_cbranch_scc1 LtwX_inia_d
    v_mov_b32 v5, 40
    s_mov_b32 s16, 0
LtwX_inia:
    global_load_dword v6, v5, s[12:13] sc1
    s_add_u32 s16, s16, 1
    s_cmp_gt_u32 s16, 100000
    s_cbranch_scc1 L_role_tw_abort
    s_waitcnt vmcnt(0)
    v_cmp_gt_u32 vcc, 128, v6
    s_nop 0
    s_cbranch_vccz LtwX_inia_d
    s_sleep 8
    s_branch LtwX_inia
LtwX_inia_d:
    s_barrier
    s_cmp_lg_u32 s14, 0
    s_cbranch_scc1 LtwX_inib_d
    v_mov_b32 v5, 160
    s_mov_b32 s16, 0
LtwX_inib:
    global_load_dword v6, v5, s[12:13] sc1
    s_add_u32 s16, s16, 1
    s_cmp_gt_u32 s16, 100000
    s_cbranch_scc1 L_role_tw_abort
    s_waitcnt vmcnt(0)
    v_cmp_gt_u32 vcc, 64, v6
    s_nop 0
    s_cbranch_vccz LtwX_inib_d
    s_sleep 8
    s_branch LtwX_inib
LtwX_inib_d:
    s_barrier
LtwX_idle:
    s_cmp_lg_u32 s14, 0
    s_cbranch_scc1 LtwX_nw0
    s_mul_i32 s60, s32, 22528
    s_add_u32 s60, s60, 4224
    s_cmp_lt_u32 s32, 64
    s_cselect_b32 s60, s60, 2883584
    s_mul_i32 s61, s33, 22528
    s_add_u32 s61, s61, 1446016
    s_cmp_lt_u32 s33, 64
    s_cselect_b32 s61, s61, 2883584
    s_mov_b32 s16, 0
LtwX_p_9:
    buffer_load_dword v2, v1, s[8:11], s60 offen sc1
    buffer_load_dword v15, v1, s[8:11], s61 offen sc1
    s_add_u32 s16, s16, 1
    s_cmp_gt_u32 s16, 100000
    s_cbranch_scc1 L_role_tw_abort
    s_waitcnt vmcnt(1)
    v_cmp_eq_u32 vcc, 0, v2
    s_waitcnt vmcnt(0)
    v_cmp_eq_u32 s[54:55], 0, v15
    s_nop 0
    s_cmp_eq_u64 s[54:55], 0
    s_cselect_b32 s62, 2, 0
    s_cmp_eq_u64 vcc, 0
    s_cselect_b32 s62, 1, s62
    s_cmp_lg_u32 s62, 0
    s_cbranch_scc1 LtwX_p_9d
    s_sleep 4
    s_branch LtwX_p_9
LtwX_p_9d:
    v_mov_b32 v5, s62
    ds_write_b32 v49, v5
    s_waitcnt lgkmcnt(0)
LtwX_nw0:
    s_barrier
    ds_read_b32 v6, v49
    v_xor_b32 v49, 4, v49
    s_waitcnt lgkmcnt(0)
    v_readfirstlane_b32 s62, v6
    s_nop 0
    s_cmp_eq_u32 s62, 0
    s_cbranch_scc1 L_role_tw_abort
    s_cmp_lt_u32 s33, 29
    s_cselect_b32 s38, 1, 3
    s_cmp_eq_u32 s62, 2
    s_cselect_b32 s36, 1, 0
    s_cselect_b32 s37, s33, s32
    s_cselect_b32 s17, s38, 0
    s_add_u32 s33, s33, s17
    s_cmp_eq_u32 s62, 1
    s_cselect_b32 s17, 2, 0
    s_add_u32 s32, s32, s17
    s_lshl_b32 s56, s36, 6
    s_add_u32 s56, s56, s37
    s_lshl_b32 s46, s56, 18
    s_add_u32 s46, s46, s58
    s_mul_i32 s41, s36, 4718592
    s_mul_i32 s17, s37, 36864
    s_add_u32 s41, s41, s17
    s_add_u32 s41, s41, 8650752
    s_cmp_ge_u32 s37, 64
    s_cbranch_scc1 L_role_tw_abort
    s_add_u32 s48, s46, 0
    buffer_load_dwordx4 v[64:67], v0, s[8:11], s48 offen offset:0
    buffer_load_dwordx4 v[68:71], v0, s[8:11], s48 offen offset:1024
    buffer_load_dwordx4 v[72:75], v0, s[8:11], s48 offen offset:2048
    buffer_load_dwordx4 v[76:79], v0, s[8:11], s48 offen offset:3072
    s_add_u32 s48, s46, 4096
    buffer_load_dwordx4 v[80:83], v0, s[8:11], s48 offen offset:0
    buffer_load_dwordx4 v[84:87], v0, s[8:11], s48 offen offset:1024
    buffer_load_dwordx4 v[88:91], v0, s[8:11], s48 offen offset:2048
    buffer_load_dwordx4 v[92:95], v0, s[8:11], s48 offen offset:3072
    s_add_u32 s48, s46, 8192
    buffer_load_dwordx4 v[96:99], v0, s[8:11], s48 offen offset:0
    buffer_load_dwordx4 v[100:103], v0, s[8:11], s48 offen offset:1024
    buffer_load_dwordx4 v[104:107], v0, s[8:11], s48 offen offset:2048
    buffer_load_dwordx4 v[108:111], v0, s[8:11], s48 offen offset:3072
    s_add_u32 s48, s46, 12288
    buffer_load_dwordx4 v[112:115], v0, s[8:11], s48 offen offset:0
    buffer_load_dwordx4 v[116:119], v0, s[8:11], s48 offen offset:1024
    buffer_load_dwordx4 v[120:123], v0, s[8:11], s48 offen offset:2048
    buffer_load_dwordx4 v[40:43], v12, s[8:11], s41 offen
LtwX_item:
    s_mov_b32 s34, s36
    s_mov_b32 s35, s37
    s_mov_b32 s47, s41
    buffer_load_dwordx4 v[124:127], v0, s[8:11], s48 offen offset:3072
    s_waitcnt vmcnt(16)
    v_mfma_f32_16x16x32_bf16 v[16:19], a[0:3], v[64:67], 0
    v_mfma_f32_16x16x32_bf16 v[20:23], a[4:7], v[64:67], 0
    v_mfma_f32_16x16x32_bf16 v[24:27], v[128:131], v[64:67], 0
    s_add_u32 s48, s46, 16384
    buffer_load_dwordx4 v[64:67], v0, s[8:11], s48 offen offset:0
    s_waitcnt vmcnt(16)
    v_mfma_f32_16x16x32_bf16 v[28:31], a[0:3], v[68:71], 0
    v_mfma_f32_16x16x32_bf16 v[32:35], a[4:7], v[68:71], 0
    v_mfma_f32_16x16x32_bf16 v[36:39], v[128:131], v[68:71], 0
    buffer_load_dwordx4 v[68:71], v0, s[8:11], s48 offen offset:1024
    s_waitcnt vmcnt(16)
    v_mfma_f32_16x16x32_bf16 v[16:19], a[8:11], v[72:75], v[16:19]
    v_mfma_f32_16x16x32_bf16 v[20:23], a[12:15], v[72:75], v[20:23]
    v_mfma_f32_16x16x32_bf16 v[24:27], v[132:135], v[72:75], v[24:27]
    buffer_load_dwordx4 v[72:75], v0, s[8:11], s48 offen offset:2048
    s_waitcnt vmcnt(16)
    v_mfma_f32_16x16x32_bf16 v[28:31], a[8:11], v[76:79], v[28:31]
    v_mfma_f32_16x16x32_bf16 v[32:35], a[12:15], v[76:79], v[32:35]
    v_mfma_f32_16x16x32_bf16 v[36:39], v[132:135], v[76:79], v[36:39]
    buffer_load_dwordx4 v[76:79], v0, s[8:11], s48 offen offset:3072
    s_waitcnt vmcnt(16)
    v_mfma_f32_16x16x32_bf16 v[16:19], a[16:19], v[80:83], v[16:19]
    v_mfma_f32_16x16x32_bf16 v[20:23], a[20:23], v[80:83], v[20:23]
    v_mfma_f32_16x16x32_bf16 v[24:27], v[136:139], v[80:83], v[24:27]
    s_add_u32 s48, s46, 20480
    buffer_load_dwordx4 v[80:83], v0, s[8:11], s48 offen offset:0
    s_waitcnt vmcnt(16)
    v_mfma_f32_16x16x32_bf16 v[28:31], a[16:19], v[84:87], v[28:31]
    v_mfma_f32_16x16x32_bf16 v[32:35], a[20:23], v[84:87], v[32:35]
    v_mfma_f32_16x16x32_bf16 v[36:39], v[136:139], v[84:87], v[36:39]
    buffer_load_dwordx4 v[84:87], v0, s[8:11], s48 offen offset:1024
    s_waitcnt vmcnt(16)
    v_mfma_f32_16x16x32_bf16 v[16:19], a[24:27], v[88:91], v[16:19]
    v_mfma_f32_16x16x32_bf16 v[20:23], a[28:31], v[88:91], v[20:23]
    v_mfma_f32_16x16x32_bf16 v[24:27], v[140:143], v[88:91], v[24:27]
    buffer_load_dwordx4 v[88:91], v0, s[8:11], s48 offen offset:2048
    s_waitcnt vmcnt(16)
    v_mfma_f32_16x16x32_bf16 v[28:31], a[24:27], v[92:95], v[28:31]
    v_mfma_f32_16x16x32_bf16 v[32:35], a[28:31], v[92:95], v[32:35]
    v_mfma_f32_16x16x32_bf16 v[36:39], v[140:143], v[92:95], v[36:39]
    buffer_load_dwordx4 v[92:95], v0, s[8:11], s48 offen offset:3072
    s_waitcnt vmcnt(16)
    v_mfma_f32_16x16x32_bf16 v[16:19], a[32:35], v[96:99], v[16:19]
    v_mfma_f32_16x16x32_bf16 v[20:23], a[36:39], v[96:99], v[20:23]
    v_mfma_f32_16x16x32_bf16 v[24:27], v[144:147], v[96:99], v[24:27]
    s_add_u32 s48, s46, 24576
    buffer_load_dwordx4 v[96:99], v0, s[8:11], s48 offen offset:0
    s_waitcnt vmcnt(16)
    v_mfma_f32_16x16x32_bf16 v[28:31], a[32:35], v[100:103], v[28:31]
    v_mfma_f32_16x16x32_bf16 v[32:35], a[36:39], v[100:103], v[32:35]
    v_mfma_f32_16x16x32_bf16 v[36:39], v[144:147], v[100:103], v[36:39]
    buffer_load_dwordx4 v[100:103], v0, s[8:11], s48 offen offset:1024
    s_waitcnt vmcnt(16)
    v_mfma_f32_16x16x32_bf16 v[16:19], a[40:43], v[104:107], v[16:19]
    v_mfma_f32_16x16x32_bf16 v[20:23], a[44:47], v[104:107], v[20:23]
    v_mfma_f32_16x16x32_bf16 v[24:27], v[148:151], v[104:107], v[24:27]
    buffer_load_dwordx4 v[104:107], v0, s[8:11], s48 offen offset:2048
    s_waitcnt vmcnt(16)
    v_mfma_f32_16x16x32_bf16 v[28:31], a[40:43], v[108:111], v[28:31]
    v_mfma_f32_16x16x32_bf16 v[32:35], a[44:47], v[108:111], v[32:35]
    v_mfma_f32_16x16x32_bf16 v[36:39], v[148:151], v[108:111], v[36:39]
    buffer_load_dwordx4 v[108:111], v0, s[8:11], s48 offen offset:3072
    s_waitcnt vmcnt(16)
    v_mfma_f32_16x16x32_bf16 v[16:19], a[48:51], v[112:115], v[16:19]
    v_mfma_f32_16x16x32_bf16 v[20:23], a[52:55], v[112:115], v[20:23]
    v_mfma_f32_16x16x32_bf16 v[24:27], v[152:155], v[112:115], v[24:27]
    s_add_u32 s48, s46, 28672
    buffer_load_dwordx4 v[112:115], v0, s[8:11], s48 offen offset:0
    s_waitcnt vmcnt(16)
    v_mfma_f32_16x16x32_bf16 v[28:31], a[48:51], v[116:119], v[28:31]
    v_mfma_f32_16x16x32_bf16 v[32:35], a[52:55], v[116:119], v[32:35]
    v_mfma_f32_16x16x32_bf16 v[36:39], v[152:155], v[116:119], v[36:39]
    buffer_load_dwordx4 v[116:119], v0, s[8:11], s48 offen offset:1024
    s_waitcnt vmcnt(16)
    v_mfma_f32_16x16x32_bf16 v[16:19], a[56:59], v[120:123], v[16:19]
    v_mfma_f32_16x16x32_bf16 v[20:23], a[60:63], v[120:123], v[20:23]
    v_mfma_f32_16x16x32_bf16 v[24:27], v[156:159], v[120:123], v[24:27]
    buffer_load_dwordx4 v[120:123], v0, s[8:11], s48 offen offset:2048
    s_waitcnt vmcnt(15)
    v_mfma_f32_16x16x32_bf16 v[28:31], a[56:59], v[124:127], v[28:31]
    v_mfma_f32_16x16x32_bf16 v[32:35], a[60:63], v[124:127], v[32:35]
    v_mfma_f32_16x16x32_bf16 v[36:39], v[156:159], v[124:127], v[36:39]
    buffer_load_dwordx4 v[124:127], v0, s[8:11], s48 offen offset:3072
    s_waitcnt vmcnt(15)
    v_mfma_f32_16x16x32_bf16 v[16:19], a[64:67], v[64:67], v[16:19]
    v_mfma_f32_16x16x32_bf16 v[20:23], a[68:71], v[64:67], v[20:23]
    v_mfma_f32_16x16x32_bf16 v[24:27], v[160:163], v[64:67], v[24:27]
    s_add_u32 s48, s46, 32768
    buffer_load_dwordx4 v[64:67], v0, s[8:11], s48 offen offset:0
    s_waitcnt vmcnt(15)
    v_mfma_f32_16x16x32_bf16 v[28:31], a[64:67], v[68:71], v[28:31]
    v_mfma_f32_16x16x32_bf16 v[32:35], a[68:71], v[68:71], v[32:35]
    v_mfma_f32_16x16x32_bf16 v[36:39], v[160:163], v[68:71], v[36:39]
    s_cmp_lg_u32 s43, 0
    s_cselect_b64 exec, 1, 0
    buffer_store_dword v3, v4, s[8:11], s43 offen sc1
    s_mov_b64 exec, -1
    s_mov_b32 s43, 0
    buffer_load_dwordx4 v[68:71], v0, s[8:11], s48 offen offset:1024
    s_waitcnt vmcnt(16)
    v_mfma_f32_16x16x32_bf16 v[16:19], a[72:75], v[72:75], v[16:19]
    v_mfma_f32_16x16x32_bf16 v[20:23], a[76:79], v[72:75], v[20:23]
    v_mfma_f32_16x16x32_bf16 v[24:27], v[164:167], v[72:75], v[24:27]
    buffer_load_dwordx4 v[72:75], v0, s[8:11], s48 offen offset:2048
    s_waitcnt vmcnt(16)
    v_mfma_f32_16x16x32_bf16 v[28:31], a[72:75], v[76:79], v[28:31]
    v_mfma_f32_16x16x32_bf16 v[32:35], a[76:79], v[76:79], v[32:35]
    v_mfma_f32_16x16x32_bf16 v[36:39], v[164:167], v[76:79], v[36:39]
    buffer_load_dwordx4 v[76:79], v0, s[8:11], s48 offen offset:3072
    s_waitcnt vmcnt(16)
    v_mfma_f32_16x16x32_bf16 v[16:19], a[80:83], v[80:83], v[16:19]
    v_mfma_f32_16x16x32_bf16 v[20:23], a[84:87], v[80:83], v[20:23]
    v_mfma_f32_16x16x32_bf16 v[24:27], v[168:171], v[80:83], v[24:27]
    s_add_u32 s48, s46, 36864
    buffer_load_dwordx4 v[80:83], v0, s[8:11], s48 offen offset:0
    s_waitcnt vmcnt(16)
    v_mfma_f32_16x16x32_bf16 v[28:31], a[80:83], v[84:87], v[28:31]
    v_mfma_f32_16x16x32_bf16 v[32:35], a[84:87], v[84:87], v[32:35]
    v_mfma_f32_16x16x32_bf16 v[36:39], v[168:171], v[84:87], v[36:39]
    buffer_load_dwordx4 v[84:87], v0, s[8:11], s48 offen offset:1024
    s_waitcnt vmcnt(16)
    v_mfma_f32_16x16x32_bf16 v[16:19], a[88:91], v[88:91], v[16:19]
    v_mfma_f32_16x16x32_bf16 v[20:23], a[92:95], v[88:91], v[20:23]
    v_mfma_f32_16x16x32_bf16 v[24:27], v[172:175], v[88:91], v[24:27]
    buffer_load_dwordx4 v[88:91], v0, s[8:11], s48 offen offset:2048
    s_waitcnt vmcnt(16)
    v_mfma_f32_16x16x32_bf16 v[28:31], a[88:91], v[92:95], v[28:31]
    v_mfma_f32_16x16x32_bf16 v[32:35], a[92:95], v[92:95], v[32:35]
    v_mfma_f32_16x16x32_bf16 v[36:39], v[172:175], v[92:95], v[36:39]
    buffer_load_dwordx4 v[92:95], v0, s[8:11], s48 offen offset:3072
    s_waitcnt vmcnt(16)
    v_mfma_f32_16x16x32_bf16 v[16:19], a[96:99], v[96:99], v[16:19]
    v_mfma_f32_16x16x32_bf16 v[20:23], a[100:103], v[96:99], v[20:23]
    v_mfma_f32_16x16x32_bf16 v[24:27], v[176:179], v[96:99], v[24:27]
    s_add_u32 s48, s46, 40960
    buffer_load_dwordx4 v[96:99], v0, s[8:11], s48 offen offset:0
    s_waitcnt vmcnt(16)
    v_mfma_f32_16x16x32_bf16 v[28:31], a[96:99], v[100:103], v[28:31]
    v_mfma_f32_16x16x32_bf16 v[32:35], a[100:103], v[100:103], v[32:35]
    v_mfma_f32_16x16x32_bf16 v[36:39], v[176:179], v[100:103], v[36:39]
    buffer_load_dwordx4 v[100:103], v0, s[8:11], s48 offen offset:1024
    s_waitcnt vmcnt(16)
    v_mfma_f32_16x16x32_bf16 v[16:19], a[104:107], v[104:107], v[16:19]
    v_mfma_f32_16x16x32_bf16 v[20:23], a[108:111], v[104:107], v[20:23]
    v_mfma_f32_16x16x32_bf16 v[24:27], v[180:183], v[104:107], v[24:27]
    s_cmp_lg_u32 s14, 0
    s_cbranch_scc1 LtwX_nw1
    s_mul_i32 s60, s32, 22528
    s_add_u32 s60, s60, 4224
    s_cmp_lt_u32 s32, 64
    s_cselect_b32 s60, s60, 2883584
    s_mul_i32 s61, s33, 22528
    s_add_u32 s61, s61, 1446016
    s_cmp_lt_u32 s33, 64
    s_cselect_b32 s61, s61, 2883584
    buffer_load_dword v2, v1, s[8:11], s60 offen sc1
    buffer_load_dword v15, v1, s[8:11], s61 offen sc1
LtwX_nw1:
    buffer_load_dwordx4 v[104:107], v0, s[8:11], s48 offen offset:2048
    s_waitcnt vmcnt(16)
    v_mfma_f32_16x16x32_bf16 v[28:31], a[104:107], v[108:111], v[28:31]
    v_mfma_f32_16x16x32_bf16 v[32:35], a[108:111], v[108:111], v[32:35]
    v_mfma_f32_16x16x32_bf16 v[36:39], v[180:183], v[108:111], v[36:39]
    buffer_load_dwordx4 v[108:111], v0, s[8:11], s48 offen offset:3072
    s_waitcnt vmcnt(16)
    v_mfma_f32_16x16x32_bf16 v[16:19], a[112:115], v[112:115], v[16:19]
    v_mfma_f32_16x16x32_bf16 v[20:23], a[116:119], v[112:115], v[20:23]
    v_mfma_f32_16x16x32_bf16 v[24:27], v[184:187], v[112:115], v[24:27]
    s_add_u32 s48, s46, 45056
    buffer_load_dwordx4 v[112:115], v0, s[8:11], s48 offen offset:0
    s_waitcnt vmcnt(16)
    v_mfma_f32_16x16x32_bf16 v[28:31], a[112:115], v[116:119], v[28:31]
    v_mfma_f32_16x16x32_bf16 v[32:35], a[116:119], v[116:119], v[32:35]
    v_mfma_f32_16x16x32_bf16 v[36:39], v[184:187], v[116:119], v[36:39]
    buffer_load_dwordx4 v[116:119], v0, s[8:11], s48 offen offset:1024
    s_waitcnt vmcnt(16)
    v_mfma_f32_16x16x32_bf16 v[16:19], a[120:123], v[120:123], v[16:19]
    v_mfma_f32_16x16x32_bf16 v[20:23], a[124:127], v[120:123], v[20:23]
    v_mfma_f32_16x16x32_bf16 v[24:27], v[188:191], v[120:123], v[24:27]
    buffer_load_dwordx4 v[120:123], v0, s[8:11], s48 offen offset:2048
    s_waitcnt vmcnt(16)
    v_mfma_f32_16x16x32_bf16 v[28:31], a[120:123], v[124:127], v[28:31]
    v_mfma_f32_16x16x32_bf16 v[32:35], a[124:127], v[124:127], v[32:35]
    v_mfma_f32_16x16x32_bf16 v[36:39], v[188:191], v[124:127], v[36:39]
    buffer_load_dwordx4 v[124:127], v0, s[8:11], s48 offen offset:3072
    s_waitcnt vmcnt(16)
    v_mfma_f32_16x16x32_bf16 v[16:19], a[128:131], v[64:67], v[16:19]
    v_mfma_f32_16x16x32_bf16 v[20:23], a[132:135], v[64:67], v[20:23]
    v_mfma_f32_16x16x32_bf16 v[24:27], v[192:195], v[64:67], v[24:27]
    s_add_u32 s48, s46, 49152
    buffer_load_dwordx4 v[64:67], v0, s[8:11], s48 offen offset:0
    s_waitcnt vmcnt(15)
    v_mfma_f32_16x16x32_bf16 v[28:31], a[128:131], v[68:71], v[28:31]
    v_mfma_f32_16x16x32_bf16 v[32:35], a[132:135], v[68:71], v[32:35]
    v_mfma_f32_16x16x32_bf16 v[36:39], v[192:195], v[68:71], v[36:39]
    buffer_load_dwordx4 v[68:71], v0, s[8:11], s48 offen offset:1024
    s_waitcnt vmcnt(15)
    v_mfma_f32_16x16x32_bf16 v[16:19], a[136:139], v[72:75], v[16:19]
    v_mfma_f32_16x16x32_bf16 v[20:23], a[140:143], v[72:75], v[20:23]
    v_mfma_f32_16x16x32_bf16 v[24:27], v[196:199], v[72:75], v[24:27]
    buffer_load_dwordx4 v[72:75], v0, s[8:11], s48 offen offset:2048
    s_waitcnt vmcnt(15)
    v_mfma_f32_16x16x32_bf16 v[28:31], a[136:139], v[76:79], v[28:31]
    v_mfma_f32_16x16x32_bf16 v[32:35], a[140:143], v[76:79], v[32:35]
    v_mfma_f32_16x16x32_bf16 v[36:39], v[196:199], v[76:79], v[36:39]
    buffer_load_dwordx4 v[76:79], v0, s[8:11], s48 offen offset:3072
    s_waitcnt vmcnt(15)
    v_mfma_f32_16x16x32_bf16 v[16:19], a[144:147], v[80:83], v[16:19]
    v_mfma_f32_16x16x32_bf16 v[20:23], a[148:151], v[80:83], v[20:23]
    v_mfma_f32_16x16x32_bf16 v[24:27], v[200:203], v[80:83], v[24:27]
    s_add_u32 s48, s46, 53248
    buffer_load_dwordx4 v[80:83], v0, s[8:11], s48 offen offset:0
    s_waitcnt vmcnt(15)
    v_mfma_f32_16x16x32_bf16 v[28:31], a[144:147], v[84:87], v[28:31]
    v_mfma_f32_16x16x32_bf16 v[32:35], a[148:151], v[84:87], v[32:35]
    v_mfma_f32_16x16x32_bf16 v[36:39], v[200:203], v[84:87], v[36:39]
    buffer_load_dwordx4 v[84:87], v0, s[8:11], s48 offen offset:1024
    s_waitcnt vmcnt(15)
    v_mfma_f32_16x16x32_bf16 v[16:19], a[152:155], v[88:91], v[16:19]
    v_mfma_f32_16x16x32_bf16 v[20:23], a[156:159], v[88:91], v[20:23]
    v_mfma_f32_16x16x32_bf16 v[24:27], v[204:207], v[88:91], v[24:27]
    buffer_load_dwordx4 v[88:91], v0, s[8:11], s48 offen offset:2048
    s_waitcnt vmcnt(15)
    v_mfma_f32_16x16x32_bf16 v[28:31], a[152:155], v[92:95], v[28:31]
    v_mfma_f32_16x16x32_bf16 v[32:35], a[156:159], v[92:95], v[32:35]
    v_mfma_f32_16x16x32_bf16 v[36:39], v[204:207], v[92:95], v[36:39]
    buffer_load_dwordx4 v[92:95], v0, s[8:11], s48 offen offset:3072
    s_waitcnt vmcnt(15)
    v_mfma_f32_16x16x32_bf16 v[16:19], a[160:163], v[96:99], v[16:19]
    v_mfma_f32_16x16x32_bf16 v[20:23], a[164:167], v[96:99], v[20:23]
    v_mfma_f32_16x16x32_bf16 v[24:27], v[208:211], v[96:99], v[24:27]
    s_add_u32 s48, s46, 57344
    buffer_load_dwordx4 v[96:99], v0, s[8:11], s48 offen offset:0
    s_waitcnt vmcnt(15)
    v_mfma_f32_16x16x32_bf16 v[28:31], a[160:163], v[100:103], v[28:31]
    v_mfma_f32_16x16x32_bf16 v[32:35], a[164:167], v[100:103], v[32:35]
    v_mfma_f32_16x16x32_bf16 v[36:39], v[208:211], v[100:103], v[36:39]
    buffer_load_dwordx4 v[100:103], v0, s[8:11], s48 offen offset:1024
    s_waitcnt vmcnt(15)
    v_mfma_f32_16x16x32_bf16 v[16:19], a[168:171], v[104:107], v[16:19]
    v_mfma_f32_16x16x32_bf16 v[20:23], a[172:175], v[104:107], v[20:23]
    v_mfma_f32_16x16x32_bf16 v[24:27], v[212:215], v[104:107], v[24:27]
    buffer_load_dwordx4 v[104:107], v0, s[8:11], s48 offen offset:2048
    s_waitcnt vmcnt(15)
    v_mfma_f32_16x16x32_bf16 v[28:31], a[168:171], v[108:111], v[28:31]
    v_mfma_f32_16x16x32_bf16 v[32:35], a[172:175], v[108:111], v[32:35]
    v_mfma_f32_16x16x32_bf16 v[36:39], v[212:215], v[108:111], v[36:39]
    buffer_load_dwordx4 v[108:111], v0, s[8:11], s48 offen offset:3072
    s_waitcnt vmcnt(15)
    v_mfma_f32_16x16x32_bf16 v[16:19], a[176:179], v[112:115], v[16:19]
    v_mfma_f32_16x16x32_bf16 v[20:23], a[180:183], v[112:115], v[20:23]
    v_mfma_f32_16x16x32_bf16 v[24:27], v[216:219], v[112:115], v[24:27]
    s_cmp_lg_u32 s14, 0
    s_cbranch_scc1 LtwX_nw2
    v_cmp_eq_u32 vcc, 0, v2
    v_cmp_eq_u32 s[54:55], 0, v15
    s_nop 0
    s_cmp_eq_u64 s[54:55], 0
    s_cselect_b32 s62, 2, 0
    s_cmp_eq_u64 vcc, 0
    s_cselect_b32 s62, 1, s62
    v_mov_b32 v5, s62
    ds_write_b32 v49, v5
    s_waitcnt lgkmcnt(0)
LtwX_nw2:
    s_barrier
    ds_read_b32 v6, v49
    v_xor_b32 v49, 4, v49
    s_add_u32 s48, s46, 61440
    buffer_load_dwordx4 v[112:115], v0, s[8:11], s48 offen offset:0
    s_waitcnt vmcnt(15)
    v_mfma_f32_16x16x32_bf16 v[28:31], a[176:179], v[116:119], v[28:31]
    v_mfma_f32_16x16x32_bf16 v[32:35], a[180:183], v[116:119], v[32:35]
    v_mfma_f32_16x16x32_bf16 v[36:39], v[216:219], v[116:119], v[36:39]
    buffer_load_dwordx4 v[116:119], v0, s[8:11], s48 offen offset:1024
    s_waitcnt vmcnt(15)
    v_mfma_f32_16x16x32_bf16 v[16:19], a[184:187], v[120:123], v[16:19]
    v_mfma_f32_16x16x32_bf16 v[20:23], a[188:191], v[120:123], v[20:23]
    v_mfma_f32_16x16x32_bf16 v[24:27], v[220:223], v[120:123], v[24:27]
    buffer_load_dwordx4 v[120:123], v0, s[8:11], s48 offen offset:2048
    s_waitcnt vmcnt(15)
    v_mfma_f32_16x16x32_bf16 v[28:31], a[184:187], v[124:127], v[28:31]
    v_mfma_f32_16x16x32_bf16 v[32:35], a[188:191], v[124:127], v[32:35]
    v_mfma_f32_16x16x32_bf16 v[36:39], v[220:223], v[124:127], v[36:39]
    s_waitcnt lgkmcnt(0)
    v_readfirstlane_b32 s62, v6
    s_cmp_lt_u32 s33, 29
    s_cselect_b32 s38, 1, 3
    s_cmp_eq_u32 s62, 2
    s_cselect_b32 s36, 1, 0
    s_cselect_b32 s37, s33, s32
    s_cselect_b32 s17, s38, 0
    s_add_u32 s33, s33, s17
    s_cmp_eq_u32 s62, 1
    s_cselect_b32 s17, 2, 0
    s_add_u32 s32, s32, s17
    s_lshl_b32 s56, s36, 6
    s_add_u32 s56, s56, s37
    buffer_load_dwordx4 v[124:127], v0, s[8:11], s48 offen offset:3072
    s_waitcnt vmcnt(15)
    v_mfma_f32_16x16x32_bf16 v[16:19], a[192:195], v[64:67], v[16:19]
    v_mfma_f32_16x16x32_bf16 v[20:23], a[196:199], v[64:67], v[20:23]
    v_mfma_f32_16x16x32_bf16 v[24:27], v[224:227], v[64:67], v[24:27]
    s_cmp_lt_u32 s37, 64
    s_cselect_b32 s62, s62, 0
    s_lshl_b32 s46, s56, 18
    s_add_u32 s46, s46, s58
    s_mul_i32 s41, s36, 4718592
    s_mul_i32 s17, s37, 36864
    s_add_u32 s41, s41, s17
    s_add_u32 s41, s41, 8650752
    s_cmp_lg_u32 s62, 0
    s_cselect_b32 s30, 268435456, 0
    s_add_u32 s48, s46, 0
    buffer_load_dwordx4 v[64:67], v0, s[28:31], s48 offen offset:0
    s_waitcnt vmcnt(15)
    v_mfma_f32_16x16x32_bf16 v[28:31], a[192:195], v[68:71], v[28:31]
    v_mfma_f32_16x16x32_bf16 v[32:35], a[196:199], v[68:71], v[32:35]
    v_mfma_f32_16x16x32_bf16 v[36:39], v[224:227], v[68:71], v[36:39]
    buffer_load_dwordx4 v[68:71], v0, s[28:31], s48 offen offset:1024
    s_waitcnt vmcnt(15)
    v_mfma_f32_16x16x32_bf16 v[16:19], a[200:203], v[72:75], v[16:19]
    v_mfma_f32_16x16x32_bf16 v[20:23], a[204:207], v[72:75], v[20:23]
    v_mfma_f32_16x16x32_bf16 v[24:27], v[228:231], v[72:75], v[24:27]
    buffer_load_dwordx4 v[72:75], v0, s[28:31], s48 offen offset:2048
    s_waitcnt vmcnt(15)
    v_mfma_f32_16x16x32_bf16 v[28:31], a[200:203], v[76:79], v[28:31]
    v_mfma_f32_16x16x32_bf16 v[32:35], a[204:207], v[76:79], v[32:35]
    v_mfma_f32_16x16x32_bf16 v[36:39], v[228:231], v[76:79], v[36:39]
    buffer_load_dwordx4 v[76:79], v0, s[28:31], s48 offen offset:3072
    s_waitcnt vmcnt(15)
    v_mfma_f32_16x16x32_bf16 v[16:19], a[208:211], v[80:83], v[16:19]
    v_mfma_f32_16x16x32_bf16 v[20:23], a[212:215], v[80:83], v[20:23]
    v_mfma_f32_16x16x32_bf16 v[24:27], v[232:235], v[80:83], v[24:27]
    s_add_u32 s48, s46, 4096
    buffer_load_dwordx4 v[80:83], v0, s[28:31], s48 offen offset:0
    s_waitcnt vmcnt(15)
    v_mfma_f32_16x16x32_bf16 v[28:31], a[208:211], v[84:87], v[28:31]
    v_mfma_f32_16x16x32_bf16 v[32:35], a[212:215], v[84:87], v[32:35]
    v_mfma_f32_16x16x32_bf16 v[36:39], v[232:235], v[84:87], v[36:39]
    buffer_load_dwordx4 v[84:87], v0, s[28:31], s48 offen offset:1024
    s_waitcnt vmcnt(15)
    v_mfma_f32_16x16x32_bf16 v[16:19], a[216:219], v[88:91], v[16:19]
    v_mfma_f32_16x16x32_bf16 v[20:23], a[220:223], v[88:91], v[20:23]
    v_mfma_f32_16x16x32_bf16 v[24:27], v[236:239], v[88:91], v[24:27]
    buffer_load_dwordx4 v[88:91], v0, s[28:31], s48 offen offset:2048
    s_waitcnt vmcnt(15)
    v_mfma_f32_16x16x32_bf16 v[28:31], a[216:219], v[92:95], v[28:31]
    v_mfma_f32_16x16x32_bf16 v[32:35], a[220:223], v[92:95], v[32:35]
    v_mfma_f32_16x16x32_bf16 v[36:39], v[236:239], v[92:95], v[36:39]
    buffer_load_dwordx4 v[92:95], v0, s[28:31], s48 offen offset:3072
    s_waitcnt vmcnt(15)
    v_mfma_f32_16x16x32_bf16 v[16:19], a[224:227], v[96:99], v[16:19]
    v_mfma_f32_16x16x32_bf16 v[20:23], a[228:231], v[96:99], v[20:23]
    v_mfma_f32_16x16x32_bf16 v[24:27], v[240:243], v[96:99], v[24:27]
    s_add_u32 s48, s46, 8192
    buffer_load_dwordx4 v[96:99], v0, s[28:31], s48 offen offset:0
    s_waitcnt vmcnt(15)
    v_mfma_f32_16x16x32_bf16 v[28:31], a[224:227], v[100:103], v[28:31]
    v_mfma_f32_16x16x32_bf16 v[32:35], a[228:231], v[100:103], v[32:35]
    v_mfma_f32_16x16x32_bf16 v[36:39], v[240:243], v[100:103], v[36:39]
    buffer_load_dwordx4 v[100:103], v0, s[28:31], s48 offen offset:1024
    s_waitcnt vmcnt(15)
    v_mfma_f32_16x16x32_bf16 v[16:19], a[232:235], v[104:107], v[16:19]
    v_mfma_f32_16x16x32_bf16 v[20:23], a[236:239], v[104:107], v[20:23]
    v_mfma_f32_16x16x32_bf16 v[24:27], v[244:247], v[104:107], v[24:27]
    buffer_load_dwordx4 v[104:107], v0, s[28:31], s48 offen offset:2048
    s_waitcnt vmcnt(15)
    v_mfma_f32_16x16x32_bf16 v[28:31], a[232:235], v[108:111], v[28:31]
    v_mfma_f32_16x16x32_bf16 v[32:35], a[236:239], v[108:111], v[32:35]
    v_mfma_f32_16x16x32_bf16 v[36:39], v[244:247], v[108:111], v[36:39]
    buffer_load_dwordx4 v[108:111], v0, s[28:31], s48 offen offset:3072
    s_waitcnt vmcnt(15)
    v_mfma_f32_16x16x32_bf16 v[16:19], a[240:243], v[112:115], v[16:19]
    v_mfma_f32_16x16x32_bf16 v[20:23], a[244:247], v[112:115], v[20:23]
    v_mfma_f32_16x16x32_bf16 v[24:27], v[248:251], v[112:115], v[24:27]
    s_add_u32 s48, s46, 12288
    buffer_load_dwordx4 v[112:115], v0, s[28:31], s48 offen offset:0
    s_waitcnt vmcnt(15)
    v_mfma_f32_16x16x32_bf16 v[28:31], a[240:243], v[116:119], v[28:31]
    v_mfma_f32_16x16x32_bf16 v[32:35], a[244:247], v[116:119], v[32:35]
    v_mfma_f32_16x16x32_bf16 v[36:39], v[248:251], v[116:119], v[36:39]
    buffer_load_dwordx4 v[116:119], v0, s[28:31], s48 offen offset:1024
    s_waitcnt vmcnt(15)
    v_mfma_f32_16x16x32_bf16 v[16:19], a[248:251], v[120:123], v[16:19]
    v_mfma_f32_16x16x32_bf16 v[20:23], a[252:255], v[120:123], v[20:23]
    v_mfma_f32_16x16x32_bf16 v[24:27], v[252:255], v[120:123], v[24:27]
    buffer_load_dwordx4 v[120:123], v0, s[28:31], s48 offen offset:2048
    s_waitcnt vmcnt(15)
    v_mfma_f32_16x16x32_bf16 v[28:31], a[248:251], v[124:127], v[28:31]
    v_mfma_f32_16x16x32_bf16 v[32:35], a[252:255], v[124:127], v[32:35]
    v_mfma_f32_16x16x32_bf16 v[36:39], v[252:255], v[124:127], v[36:39]
    s_nop 5
    ds_write_b128 v48, v[16:19] offset:0
    ds_write_b128 v48, v[20:23] offset:1024
    ds_write_b128 v48, v[24:27] offset:2048
    ds_write_b128 v48, v[28:31] offset:3072
    ds_write_b128 v48, v[32:35] offset:4096
    ds_write_b128 v48, v[36:39] offset:5120
    s_waitcnt lgkmcnt(0)
    s_barrier
    ds_read_b128 v[24:27], v50 offset:0
    ds_read_b128 v[28:31], v50 offset:1024
    ds_read_b128 v[32:35], v50 offset:6144
    ds_read_b128 v[36:39], v50 offset:7168
    ds_read_b128 v[56:59], v50 offset:12288
    ds_read_b128 v[60:63], v50 offset:13312
    ds_read_b128 v[124:127], v50 offset:18432
    ds_read_b128 v[52:55], v50 offset:19456
    v_xor_b32 v48, 0x8000, v48
    v_xor_b32 v50, 0x8000, v50
    v_lshlrev_b32 v16, 16, v40
    v_and_b32 v20, 0xffff0000, v40
    v_lshlrev_b32 v17, 16, v41
    v_and_b32 v21, 0xffff0000, v41
    v_lshlrev_b32 v18, 16, v42
    v_and_b32 v22, 0xffff0000, v42
    v_lshlrev_b32 v19, 16, v43
    v_and_b32 v23, 0xffff0000, v43
    buffer_load_dwordx4 v[40:43], v12, s[28:31], s41 offen
    s_waitcnt lgkmcnt(7)
    v_add_f32 v16, v16, v24
    v_add_f32 v17, v17, v25
    v_add_f32 v18, v18, v26
    v_add_f32 v19, v19, v27
    s_waitcnt lgkmcnt(6)
    v_add_f32 v20, v20, v28
    v_add_f32 v21, v21, v29
    v_add_f32 v22, v22, v30
    v_add_f32 v23, v23, v31
    s_waitcnt lgkmcnt(5)
    v_add_f32 v16, v16, v32
    v_add_f32 v17, v17, v33
    v_add_f32 v18, v18, v34
    v_add_f32 v19, v19, v35
    s_waitcnt lgkmcnt(4)
    v_add_f32 v20, v20, v36
    v_add_f32 v21, v21, v37
    v_add_f32 v22, v22, v38
    v_add_f32 v23, v23, v39
    s_waitcnt lgkmcnt(3)
    v_add_f32 v16, v16, v56
    v_add_f32 v17, v17, v57
    v_add_f32 v18, v18, v58
    v_add_f32 v19, v19, v59
    s_waitcnt lgkmcnt(2)
    v_add_f32 v20, v20, v60
    v_add_f32 v21, v21, v61
    v_add_f32 v22, v22, v62
    v_add_f32 v23, v23, v63
    s_waitcnt lgkmcnt(1)
    v_add_f32 v16, v16, v124
    v_add_f32 v17, v17, v125
    v_add_f32 v18, v18, v126
    v_add_f32 v19, v19, v127
    s_waitcnt lgkmcnt(0)
    v_add_f32 v20, v20, v52
    v_add_f32 v21, v21, v53
    v_add_f32 v22, v22, v54
    v_add_f32 v23, v23, v55
    v_cvt_pk_bf16_f32 v52, v16, v20
    v_cvt_pk_bf16_f32 v53, v17, v21
    v_cvt_pk_bf16_f32 v54, v18, v22
    v_cvt_pk_bf16_f32 v55, v19, v23
    s_cmp_eq_u32 s34, 0
    s_cbranch_scc1 LtwX_l0
    s_mul_i32 s17, s35, 36864
    buffer_store_dwordx4 v[52:55], v13, s[24:27], s17 offen sc1
    s_cmp_lg_u32 s62, 0
    s_cbranch_scc1 LtwX_item
LtwX_chk:
    s_min_u32 s17, s32, s33
    s_cmp_lt_u32 s17, 64
    s_cbranch_scc1 LtwX_idle
    s_branch L_role_tw_exit
LtwX_l0:
    s_add_u32 s47, s47, 2359296
    buffer_store_dwordx4 v[52:55], v12, s[8:11], s47 offen sc1
    v_add_f32 v44, v16, v17
    v_mul_f32 v45, v16, v16
    v_fmac_f32 v45, v17, v17
    v_add_f32 v44, v44, v18
    v_fmac_f32 v45, v18, v18
    v_add_f32 v44, v44, v19
    v_fmac_f32 v45, v19, v19
    v_add_f32 v44, v44, v20
    v_fmac_f32 v45, v20, v20
    v_add_f32 v44, v44, v21
    v_fmac_f32 v45, v21, v21
    v_add_f32 v44, v44, v22
    v_fmac_f32 v45, v22, v22
    v_add_f32 v44, v44, v23
    v_fmac_f32 v45, v23, v23
    v_mov_b32 v46, v44
    v_mov_b32 v47, v45
    s_nop 0
    v_permlane32_swap_b32 v44, v46
    v_permlane32_swap_b32 v45, v47
    v_add_f32 v44, v44, v46
    v_add_f32 v45, v45, v47
    v_mov_b32 v46, v44
    v_mov_b32 v47, v45
    s_nop 0
    v_permlane16_swap_b32 v44, v46
    v_permlane16_swap_b32 v45, v47
    v_add_f32 v44, v44, v46
    v_add_f32 v45, v45, v47
    s_mul_i32 s17, s35, 6144
    s_add_u32 s17, s17, 16515072
    s_mov_b64 exec, 0xffff
    buffer_store_dwordx2 v[44:45], v14, s[8:11], s17 offen sc1
    s_mov_b64 exec, -1
    s_mul_i32 s43, s35, 22528
    s_add_u32 s43, s43, s49
    s_cmp_lg_u32 s62, 0
    s_cbranch_scc1 LtwX_item
    s_waitcnt vmcnt(0)
    s_mov_b64 exec, 1
    buffer_store_dword v3, v4, s[8:11], s43 offen sc1
    s_mov_b64 exec, -1
    s_mov_b32 s43, 0
    s_branch LtwX_chk
Ltw_z:
    v_lshrrev_b32 v5, 1, v8
    v_lshl_add_u32 v12, v5, 9, v12
    v_and_b32 v5, 1, v8
    v_lshl_add_u32 v12, v5, 3, v12
    v_add_u32 v12, 2048, v12
    v_lshl_add_u32 v13, v8, 3, v13
    v_add_u32 v13, 64, v13
    v_add_u32 v14, 8, v14
    s_lshl_b32 s58, s14, 16
    s_add_u32 s58, s58, 144703488
    s_mov_b32 s43, 0
    s_mov_b32 s28, s8
    s_mov_b32 s29, s9
    s_mov_b32 s30, 0
    s_mov_b32 s31, 0x00020000
    s_mul_i32 s17, s51, 3072
    v_add_u32 v50, s17, v0
    ds_write2_b32 v49, v4, v4 offset0:0 offset1:1
    s_waitcnt lgkmcnt(0)
    s_cmp_lg_u32 s14, 0
    s_cbranch_scc1 LtwZ_inia_d
    v_mov_b32 v5, 40
    s_mov_b32 s16, 0
LtwZ_inia:
    global_load_dword v6, v5, s[12:13] sc1
    s_add_u32 s16, s16, 1
    s_cmp_gt_u32 s16, 100000
    s_cbranch_scc1 L_role_tw_abort
    s_waitcnt vmcnt(0)
    v_cmp_gt_u32 vcc, 128, v6
    s_nop 0
    s_cbranch_vccz LtwZ_inia_d
    s_sleep 8
    s_branch LtwZ_inia
LtwZ_inia_d:
    s_barrier
    s_cmp_lg_u32 s14, 0
    s_cbranch_scc1 LtwZ_inib_d
    v_mov_b32 v5, 160
    s_mov_b32 s16, 0
LtwZ_inib:
    global_load_dword v6, v5, s[12:13] sc1
    s_add_u32 s16, s16, 1
    s_cmp_gt_u32 s16, 100000
    s_cbranch_scc1 L_role_tw_abort
    s_waitcnt vmcnt(0)
    v_cmp_gt_u32 vcc, 64, v6
    s_nop 0
    s_cbranch_vccz LtwZ_inib_d
    s_sleep 8
    s_branch LtwZ_inib
LtwZ_inib_d:
    s_barrier
LtwZ_idle:
    s_barrier
    ds_read_b32 v6, v49
    v_xor_b32 v49, 4, v49
    s_waitcnt lgkmcnt(0)
    v_readfirstlane_b32 s62, v6
    s_nop 0
    s_cmp_eq_u32 s62, 0
    s_cbranch_scc1 L_role_tw_abort
    s_cmp_lt_u32 s33, 29
    s_cselect_b32 s38, 1, 3
    s_cmp_eq_u32 s62, 2
    s_cselect_b32 s36, 1, 0
    s_cselect_b32 s37, s33, s32
    s_cselect_b32 s17, s38, 0
    s_add_u32 s33, s33, s17
    s_cmp_eq_u32 s62, 1
    s_cselect_b32 s17, 2, 0
    s_add_u32 s32, s32, s17
    s_lshl_b32 s56, s36, 6
    s_add_u32 s56, s56, s37
    s_lshl_b32 s46, s56, 18
    s_add_u32 s46, s46, s58
    s_mul_i32 s41, s36, 4718592
    s_mul_i32 s17, s37, 36864
    s_add_u32 s41, s41, s17
    s_add_u32 s41, s41, 8650752
    s_cmp_ge_u32 s37, 64
    s_cbranch_scc1 L_role_tw_abort
    s_add_u32 s48, s46, 0
    buffer_load_dwordx4 v[64:67], v0, s[8:11], s48 offen offset:0
    buffer_load_dwordx4 v[68:71], v0, s[8:11], s48 offen offset:1024
    buffer_load_dwordx4 v[72:75], v0, s[8:11], s48 offen offset:2048
    buffer_load_dwordx4 v[76:79], v0, s[8:11], s48 offen offset:3072
    s_add_u32 s48, s46, 4096
    buffer_load_dwordx4 v[80:83], v0, s[8:11], s48 offen offset:0
    buffer_load_dwordx4 v[84:87], v0, s[8:11], s48 offen offset:1024
    buffer_load_dwordx4 v[88:91], v0, s[8:11], s48 offen offset:2048
    buffer_load_dwordx4 v[92:95], v0, s[8:11], s48 offen offset:3072
    s_add_u32 s48, s46, 8192
    buffer_load_dwordx4 v[96:99], v0, s[8:11], s48 offen offset:0
    buffer_load_dwordx4 v[100:103], v0, s[8:11], s48 offen offset:1024
    buffer_load_dwordx4 v[104:107], v0, s[8:11], s48 offen offset:2048
    buffer_load_dwordx4 v[108:111], v0, s[8:11], s48 offen offset:3072
    s_add_u32 s48, s46, 12288
    buffer_load_dwordx4 v[112:115], v0, s[8:11], s48 offen offset:0
    buffer_load_dwordx4 v[116:119], v0, s[8:11], s48 offen offset:1024
    buffer_load_dwordx4 v[120:123], v0, s[8:11], s48 offen offset:2048
    buffer_load_dwordx2 v[40:41], v12, s[8:11], s41 offen
LtwZ_item:
    s_mov_b32 s34, s36
    s_mov_b32 s35, s37
    s_mov_b32 s47, s41
    buffer_load_dwordx4 v[124:127], v0, s[8:11], s48 offen offset:3072
    s_waitcnt vmcnt(16)
    v_mfma_f32_16x16x32_bf16 v[16:19], a[0:3], v[64:67], 0
    v_mfma_f32_16x16x32_bf16 v[20:23], a[4:7], v[64:67], 0
    v_mfma_f32_16x16x32_bf16 v[24:27], v[128:131], v[64:67], 0
    s_add_u32 s48, s46, 16384
    buffer_load_dwordx4 v[64:67], v0, s[8:11], s48 offen offset:0
    s_waitcnt vmcnt(16)
    v_mfma_f32_16x16x32_bf16 v[28:31], a[0:3], v[68:71], 0
    v_mfma_f32_16x16x32_bf16 v[32:35], a[4:7], v[68:71], 0
    v_mfma_f32_16x16x32_bf16 v[36:39], v[128:131], v[68:71], 0
    buffer_load_dwordx4 v[68:71], v0, s[8:11], s48 offen offset:1024
    s_waitcnt vmcnt(16)
    v_mfma_f32_16x16x32_bf16 v[16:19], a[8:11], v[72:75], v[16:19]
    v_mfma_f32_16x16x32_bf16 v[20:23], a[12:15], v[72:75], v[20:23]
    v_mfma_f32_16x16x32_bf16 v[24:27], v[132:135], v[72:75], v[24:27]
    buffer_load_dwordx4 v[72:75], v0, s[8:11], s48 offen offset:2048
    s_waitcnt vmcnt(16)
    v_mfma_f32_16x16x32_bf16 v[28:31], a[8:11], v[76:79], v[28:31]
    v_mfma_f32_16x16x32_bf16 v[32:35], a[12:15], v[76:79], v[32:35]
    v_mfma_f32_16x16x32_bf16 v[36:39], v[132:135], v[76:79], v[36:39]
    buffer_load_dwordx4 v[76:79], v0, s[8:11], s48 offen offset:3072
    s_waitcnt vmcnt(16)
    v_mfma_f32_16x16x32_bf16 v[16:19], a[16:19], v[80:83], v[16:19]
    v_mfma_f32_16x16x32_bf16 v[20:23], a[20:23], v[80:83], v[20:23]
    v_mfma_f32_16x16x32_bf16 v[24:27], v[136:139], v[80:83], v[24:27]
    s_add_u32 s48, s46, 20480
    buffer_load_dwordx4 v[80:83], v0, s[8:11], s48 offen offset:0
    s_waitcnt vmcnt(16)
    v_mfma_f32_16x16x32_bf16 v[28:31], a[16:19], v[84:87], v[28:31]
    v_mfma_f32_16x16x32_bf16 v[32:35], a[20:23], v[84:87], v[32:35]
    v_mfma_f32_16x16x32_bf16 v[36:39], v[136:139], v[84:87], v[36:39]
    buffer_load_dwordx4 v[84:87], v0, s[8:11], s48 offen offset:1024
    s_waitcnt vmcnt(16)
    v_mfma_f32_16x16x32_bf16 v[16:19], a[24:27], v[88:91], v[16:19]
    v_mfma_f32_16x16x32_bf16 v[20:23], a[28:31], v[88:91], v[20:23]
    v_mfma_f32_16x16x32_bf16 v[24:27], v[140:143], v[88:91], v[24:27]
    buffer_load_dwordx4 v[88:91], v0, s[8:11], s48 offen offset:2048
    s_waitcnt vmcnt(16)
    v_mfma_f32_16x16x32_bf16 v[28:31], a[24:27], v[92:95], v[28:31]
    v_mfma_f32_16x16x32_bf16 v[32:35], a[28:31], v[92:95], v[32:35]
    v_mfma_f32_16x16x32_bf16 v[36:39], v[140:143], v[92:95], v[36:39]
    buffer_load_dwordx4 v[92:95], v0, s[8:11], s48 offen offset:3072
    s_waitcnt vmcnt(16)
    v_mfma_f32_16x16x32_bf16 v[16:19], a[32:35], v[96:99], v[16:19]
    v_mfma_f32_16x16x32_bf16 v[20:23], a[36:39], v[96:99], v[20:23]
    v_mfma_f32_16x16x32_bf16 v[24:27], v[144:147], v[96:99], v[24:27]
    s_add_u32 s48, s46, 24576
    buffer_load_dwordx4 v[96:99], v0, s[8:11], s48 offen offset:0
    s_waitcnt vmcnt(16)
    v_mfma_f32_16x16x32_bf16 v[28:31], a[32:35], v[100:103], v[28:31]
    v_mfma_f32_16x16x32_bf16 v[32:35], a[36:39], v[100:103], v[32:35]
    v_mfma_f32_16x16x32_bf16 v[36:39], v[144:147], v[100:103], v[36:39]
    buffer_load_dwordx4 v[100:103], v0, s[8:11], s48 offen offset:1024
    s_waitcnt vmcnt(16)
    v_mfma_f32_16x16x32_bf16 v[16:19], a[40:43], v[104:107], v[16:19]
    v_mfma_f32_16x16x32_bf16 v[20:23], a[44:47], v[104:107], v[20:23]
    v_mfma_f32_16x16x32_bf16 v[24:27], v[148:151], v[104:107], v[24:27]
    buffer_load_dwordx4 v[104:107], v0, s[8:11], s48 offen offset:2048
    s_waitcnt vmcnt(16)
    v_mfma_f32_16x16x32_bf16 v[28:31], a[40:43], v[108:111], v[28:31]
    v_mfma_f32_16x16x32_bf16 v[32:35], a[44:47], v[108:111], v[32:35]
    v_mfma_f32_16x16x32_bf16 v[36:39], v[148:151], v[108:111], v[36:39]
    buffer_load_dwordx4 v[108:111], v0, s[8:11], s48 offen offset:3072
    s_waitcnt vmcnt(16)
    v_mfma_f32_16x16x32_bf16 v[16:19], a[48:51], v[112:115], v[16:19]
    v_mfma_f32_16x16x32_bf16 v[20:23], a[52:55], v[112:115], v[20:23]
    v_mfma_f32_16x16x32_bf16 v[24:27], v[152:155], v[112:115], v[24:27]
    s_add_u32 s48, s46, 28672
    buffer_load_dwordx4 v[112:115], v0, s[8:11], s48 offen offset:0
    s_waitcnt vmcnt(16)
    v_mfma_f32_16x16x32_bf16 v[28:31], a[48:51], v[116:119], v[28:31]
    v_mfma_f32_16x16x32_bf16 v[32:35], a[52:55], v[116:119], v[32:35]
    v_mfma_f32_16x16x32_bf16 v[36:39], v[152:155], v[116:119], v[36:39]
    buffer_load_dwordx4 v[116:119], v0, s[8:11], s48 offen offset:1024
    s_waitcnt vmcnt(16)
    v_mfma_f32_16x16x32_bf16 v[16:19], a[56:59], v[120:123], v[16:19]
    v_mfma_f32_16x16x32_bf16 v[20:23], a[60:63], v[120:123], v[20:23]
    v_mfma_f32_16x16x32_bf16 v[24:27], v[156:159], v[120:123], v[24:27]
    buffer_load_dwordx4 v[120:123], v0, s[8:11], s48 offen offset:2048
    s_waitcnt vmcnt(15)
    v_mfma_f32_16x16x32_bf16 v[28:31], a[56:59], v[124:127], v[28:31]
    v_mfma_f32_16x16x32_bf16 v[32:35], a[60:63], v[124:127], v[32:35]
    v_mfma_f32_16x16x32_bf16 v[36:39], v[156:159], v[124:127], v[36:39]
    buffer_load_dwordx4 v[124:127], v0, s[8:11], s48 offen offset:3072
    s_waitcnt vmcnt(15)
    v_mfma_f32_16x16x32_bf16 v[16:19], a[64:67], v[64:67], v[16:19]
    v_mfma_f32_16x16x32_bf16 v[20:23], a[68:71], v[64:67], v[20:23]
    v_mfma_f32_16x16x32_bf16 v[24:27], v[160:163], v[64:67], v[24:27]
    s_add_u32 s48, s46, 32768
    buffer_load_dwordx4 v[64:67], v0, s[8:11], s48 offen offset:0
    s_waitcnt vmcnt(15)
    v_mfma_f32_16x16x32_bf16 v[28:31], a[64:67], v[68:71], v[28:31]
    v_mfma_f32_16x16x32_bf16 v[32:35], a[68:71], v[68:71], v[32:35]
    v_mfma_f32_16x16x32_bf16 v[36:39], v[160:163], v[68:71], v[36:39]
    s_cmp_lg_u32 s43, 0
    s_cselect_b64 exec, 1, 0
    buffer_store_dword v3, v4, s[8:11], s43 offen sc1
    s_mov_b64 exec, -1
    s_mov_b32 s43, 0
    buffer_load_dwordx4 v[68:71], v0, s[8:11], s48 offen offset:1024
    s_waitcnt vmcnt(16)
    v_mfma_f32_16x16x32_bf16 v[16:19], a[72:75], v[72:75], v[16:19]
    v_mfma_f32_16x16x32_bf16 v[20:23], a[76:79], v[72:75], v[20:23]
    v_mfma_f32_16x16x32_bf16 v[24:27], v[164:167], v[72:75], v[24:27]
    buffer_load_dwordx4 v[72:75], v0, s[8:11], s48 offen offset:2048
    s_waitcnt vmcnt(16)
    v_mfma_f32_16x16x32_bf16 v[28:31], a[72:75], v[76:79], v[28:31]
    v_mfma_f32_16x16x32_bf16 v[32:35], a[76:79], v[76:79], v[32:35]
    v_mfma_f32_16x16x32_bf16 v[36:39], v[164:167], v[76:79], v[36:39]
    buffer_load_dwordx4 v[76:79], v0, s[8:11], s48 offen offset:3072
    s_waitcnt vmcnt(16)
    v_mfma_f32_16x16x32_bf16 v[16:19], a[80:83], v[80:83], v[16:19]
    v_mfma_f32_16x16x32_bf16 v[20:23], a[84:87], v[80:83], v[20:23]
    v_mfma_f32_16x16x32_bf16 v[24:27], v[168:171], v[80:83], v[24:27]
    s_add_u32 s48, s46, 36864
    buffer_load_dwordx4 v[80:83], v0, s[8:11], s48 offen offset:0
    s_waitcnt vmcnt(16)
    v_mfma_f32_16x16x32_bf16 v[28:31], a[80:83], v[84:87], v[28:31]
    v_mfma_f32_16x16x32_bf16 v[32:35], a[84:87], v[84:87], v[32:35]
    v_mfma_f32_16x16x32_bf16 v[36:39], v[168:171], v[84:87], v[36:39]
    buffer_load_dwordx4 v[84:87], v0, s[8:11], s48 offen offset:1024
    s_waitcnt vmcnt(16)
    v_mfma_f32_16x16x32_bf16 v[16:19], a[88:91], v[88:91], v[16:19]
    v_mfma_f32_16x16x32_bf16 v[20:23], a[92:95], v[88:91], v[20:23]
    v_mfma_f32_16x16x32_bf16 v[24:27], v[172:175], v[88:91], v[24:27]
    buffer_load_dwordx4 v[88:91], v0, s[8:11], s48 offen offset:2048
    s_waitcnt vmcnt(16)
    v_mfma_f32_16x16x32_bf16 v[28:31], a[88:91], v[92:95], v[28:31]
    v_mfma_f32_16x16x32_bf16 v[32:35], a[92:95], v[92:95], v[32:35]
    v_mfma_f32_16x16x32_bf16 v[36:39], v[172:175], v[92:95], v[36:39]
    buffer_load_dwordx4 v[92:95], v0, s[8:11], s48 offen offset:3072
    s_waitcnt vmcnt(16)
    v_mfma_f32_16x16x32_bf16 v[16:19], a[96:99], v[96:99], v[16:19]
    v_mfma_f32_16x16x32_bf16 v[20:23], a[100:103], v[96:99], v[20:23]
    v_mfma_f32_16x16x32_bf16 v[24:27], v[176:179], v[96:99], v[24:27]
    s_add_u32 s48, s46, 40960
    buffer_load_dwordx4 v[96:99], v0, s[8:11], s48 offen offset:0
    s_waitcnt vmcnt(16)
    v_mfma_f32_16x16x32_bf16 v[28:31], a[96:99], v[100:103], v[28:31]
    v_mfma_f32_16x16x32_bf16 v[32:35], a[100:103], v[100:103], v[32:35]
    v_mfma_f32_16x16x32_bf16 v[36:39], v[176:179], v[100:103], v[36:39]
    buffer_load_dwordx4 v[100:103], v0, s[8:11], s48 offen offset:1024
    s_waitcnt vmcnt(16)
    v_mfma_f32_16x16x32_bf16 v[16:19], a[104:107], v[104:107], v[16:19]
    v_mfma_f32_16x16x32_bf16 v[20:23], a[108:111], v[104:107], v[20:23]
    v_mfma_f32_16x16x32_bf16 v[24:27], v[180:183], v[104:107], v[24:27]
    buffer_load_dwordx4 v[104:107], v0, s[8:11], s48 offen offset:2048
    s_waitcnt vmcnt(16)
    v_mfma_f32_16x16x32_bf16 v[28:31], a[104:107], v[108:111], v[28:31]
    v_mfma_f32_16x16x32_bf16 v[32:35], a[108:111], v[108:111], v[32:35]
    v_mfma_f32_16x16x32_bf16 v[36:39], v[180:183], v[108:111], v[36:39]
    buffer_load_dwordx4 v[108:111], v0, s[8:11], s48 offen offset:3072
    s_waitcnt vmcnt(16)
    v_mfma_f32_16x16x32_bf16 v[16:19], a[112:115], v[112:115], v[16:19]
    v_mfma_f32_16x16x32_bf16 v[20:23], a[116:119], v[112:115], v[20:23]
    v_mfma_f32_16x16x32_bf16 v[24:27], v[184:187], v[112:115], v[24:27]
    s_add_u32 s48, s46, 45056
    buffer_load_dwordx4 v[112:115], v0, s[8:11], s48 offen offset:0
    s_waitcnt vmcnt(16)
    v_mfma_f32_16x16x32_bf16 v[28:31], a[112:115], v[116:119], v[28:31]
    v_mfma_f32_16x16x32_bf16 v[32:35], a[116:119], v[116:119], v[32:35]
    v_mfma_f32_16x16x32_bf16 v[36:39], v[184:187], v[116:119], v[36:39]
    buffer_load_dwordx4 v[116:119], v0, s[8:11], s48 offen offset:1024
    s_waitcnt vmcnt(16)
    v_mfma_f32_16x16x32_bf16 v[16:19], a[120:123], v[120:123], v[16:19]
    v_mfma_f32_16x16x32_bf16 v[20:23], a[124:127], v[120:123], v[20:23]
    v_mfma_f32_16x16x32_bf16 v[24:27], v[188:191], v[120:123], v[24:27]
    buffer_load_dwordx4 v[120:123], v0, s[8:11], s48 offen offset:2048
    s_waitcnt vmcnt(16)
    v_mfma_f32_16x16x32_bf16 v[28:31], a[120:123], v[124:127], v[28:31]
    v_mfma_f32_16x16x32_bf16 v[32:35], a[124:127], v[124:127], v[32:35]
    v_mfma_f32_16x16x32_bf16 v[36:39], v[188:191], v[124:127], v[36:39]
    buffer_load_dwordx4 v[124:127], v0, s[8:11], s48 offen offset:3072
    s_waitcnt vmcnt(16)
    v_mfma_f32_16x16x32_bf16 v[16:19], a[128:131], v[64:67], v[16:19]
    v_mfma_f32_16x16x32_bf16 v[20:23], a[132:135], v[64:67], v[20:23]
    v_mfma_f32_16x16x32_bf16 v[24:27], v[192:195], v[64:67], v[24:27]
    s_add_u32 s48, s46, 49152
    buffer_load_dwordx4 v[64:67], v0, s[8:11], s48 offen offset:0
    s_waitcnt vmcnt(15)
    v_mfma_f32_16x16x32_bf16 v[28:31], a[128:131], v[68:71], v[28:31]
    v_mfma_f32_16x16x32_bf16 v[32:35], a[132:135], v[68:71], v[32:35]
    v_mfma_f32_16x16x32_bf16 v[36:39], v[192:195], v[68:71], v[36:39]
    buffer_load_dwordx4 v[68:71], v0, s[8:11], s48 offen offset:1024
    s_waitcnt vmcnt(15)
    v_mfma_f32_16x16x32_bf16 v[16:19], a[136:139], v[72:75], v[16:19]
    v_mfma_f32_16x16x32_bf16 v[20:23], a[140:143], v[72:75], v[20:23]
    v_mfma_f32_16x16x32_bf16 v[24:27], v[196:199], v[72:75], v[24:27]
    buffer_load_dwordx4 v[72:75], v0, s[8:11], s48 offen offset:2048
    s_waitcnt vmcnt(15)
    v_mfma_f32_16x16x32_bf16 v[28:31], a[136:139], v[76:79], v[28:31]
    v_mfma_f32_16x16x32_bf16 v[32:35], a[140:143], v[76:79], v[32:35]
    v_mfma_f32_16x16x32_bf16 v[36:39], v[196:199], v[76:79], v[36:39]
    buffer_load_dwordx4 v[76:79], v0, s[8:11], s48 offen offset:3072
    s_waitcnt vmcnt(15)
    v_mfma_f32_16x16x32_bf16 v[16:19], a[144:147], v[80:83], v[16:19]
    v_mfma_f32_16x16x32_bf16 v[20:23], a[148:151], v[80:83], v[20:23]
    v_mfma_f32_16x16x32_bf16 v[24:27], v[200:203], v[80:83], v[24:27]
    s_add_u32 s48, s46, 53248
    buffer_load_dwordx4 v[80:83], v0, s[8:11], s48 offen offset:0
    s_waitcnt vmcnt(15)
    v_mfma_f32_16x16x32_bf16 v[28:31], a[144:147], v[84:87], v[28:31]
    v_mfma_f32_16x16x32_bf16 v[32:35], a[148:151], v[84:87], v[32:35]
    v_mfma_f32_16x16x32_bf16 v[36:39], v[200:203], v[84:87], v[36:39]
    buffer_load_dwordx4 v[84:87], v0, s[8:11], s48 offen offset:1024
    s_waitcnt vmcnt(15)
    v_mfma_f32_16x16x32_bf16 v[16:19], a[152:155], v[88:91], v[16:19]
    v_mfma_f32_16x16x32_bf16 v[20:23], a[156:159], v[88:91], v[20:23]
    v_mfma_f32_16x16x32_bf16 v[24:27], v[204:207], v[88:91], v[24:27]
    buffer_load_dwordx4 v[88:91], v0, s[8:11], s48 offen offset:2048
    s_waitcnt vmcnt(15)
    v_mfma_f32_16x16x32_bf16 v[28:31], a[152:155], v[92:95], v[28:31]
    v_mfma_f32_16x16x32_bf16 v[32:35], a[156:159], v[92:95], v[32:35]
    v_mfma_f32_16x16x32_bf16 v[36:39], v[204:207], v[92:95], v[36:39]
    buffer_load_dwordx4 v[92:95], v0, s[8:11], s48 offen offset:3072
    s_waitcnt vmcnt(15)
    v_mfma_f32_16x16x32_bf16 v[16:19], a[160:163], v[96:99], v[16:19]
    v_mfma_f32_16x16x32_bf16 v[20:23], a[164:167], v[96:99], v[20:23]
    v_mfma_f32_16x16x32_bf16 v[24:27], v[208:211], v[96:99], v[24:27]
    s_add_u32 s48, s46, 57344
    buffer_load_dwordx4 v[96:99], v0, s[8:11], s48 offen offset:0
    s_waitcnt vmcnt(15)
    v_mfma_f32_16x16x32_bf16 v[28:31], a[160:163], v[100:103], v[28:31]
    v_mfma_f32_16x16x32_bf16 v[32:35], a[164:167], v[100:103], v[32:35]
    v_mfma_f32_16x16x32_bf16 v[36:39], v[208:211], v[100:103], v[36:39]
    buffer_load_dwordx4 v[100:103], v0, s[8:11], s48 offen offset:1024
    s_waitcnt vmcnt(15)
    v_mfma_f32_16x16x32_bf16 v[16:19], a[168:171], v[104:107], v[16:19]
    v_mfma_f32_16x16x32_bf16 v[20:23], a[172:175], v[104:107], v[20:23]
    v_mfma_f32_16x16x32_bf16 v[24:27], v[212:215], v[104:107], v[24:27]
    buffer_load_dwordx4 v[104:107], v0, s[8:11], s48 offen offset:2048
    s_waitcnt vmcnt(15)
    v_mfma_f32_16x16x32_bf16 v[28:31], a[168:171], v[108:111], v[28:31]
    v_mfma_f32_16x16x32_bf16 v[32:35], a[172:175], v[108:111], v[32:35]
    v_mfma_f32_16x16x32_bf16 v[36:39], v[212:215], v[108:111], v[36:39]
    buffer_load_dwordx4 v[108:111], v0, s[8:11], s48 offen offset:3072
    s_waitcnt vmcnt(15)
    v_mfma_f32_16x16x32_bf16 v[16:19], a[176:179], v[112:115], v[16:19]
    v_mfma_f32_16x16x32_bf16 v[20:23], a[180:183], v[112:115], v[20:23]
    v_mfma_f32_16x16x32_bf16 v[24:27], v[216:219], v[112:115], v[24:27]
    s_barrier
    ds_read_b32 v6, v49
    v_xor_b32 v49, 4, v49
    s_add_u32 s48, s46, 61440
    buffer_load_dwordx4 v[112:115], v0, s[8:11], s48 offen offset:0
    s_waitcnt vmcnt(15)
    v_mfma_f32_16x16x32_bf16 v[28:31], a[176:179], v[116:119], v[28:31]
    v_mfma_f32_16x16x32_bf16 v[32:35], a[180:183], v[116:119], v[32:35]
    v_mfma_f32_16x16x32_bf16 v[36:39], v[216:219], v[116:119], v[36:39]
    buffer_load_dwordx4 v[116:119], v0, s[8:11], s48 offen offset:1024
    s_waitcnt vmcnt(15)
    v_mfma_f32_16x16x32_bf16 v[16:19], a[184:187], v[120:123], v[16:19]
    v_mfma_f32_16x16x32_bf16 v[20:23], a[188:191], v[120:123], v[20:23]
    v_mfma_f32_16x16x32_bf16 v[24:27], v[220:223], v[120:123], v[24:27]
    buffer_load_dwordx4 v[120:123], v0, s[8:11], s48 offen offset:2048
    s_waitcnt vmcnt(15)
    v_mfma_f32_16x16x32_bf16 v[28:31], a[184:187], v[124:127], v[28:31]
    v_mfma_f32_16x16x32_bf16 v[32:35], a[188:191], v[124:127], v[32:35]
    v_mfma_f32_16x16x32_bf16 v[36:39], v[220:223], v[124:127], v[36:39]
    s_waitcnt lgkmcnt(0)
    v_readfirstlane_b32 s62, v6
    s_cmp_lt_u32 s33, 29
    s_cselect_b32 s38, 1, 3
    s_cmp_eq_u32 s62, 2
    s_cselect_b32 s36, 1, 0
    s_cselect_b32 s37, s33, s32
    s_cselect_b32 s17, s38, 0
    s_add_u32 s33, s33, s17
    s_cmp_eq_u32 s62, 1
    s_cselect_b32 s17, 2, 0
    s_add_u32 s32, s32, s17
    s_lshl_b32 s56, s36, 6
    s_add_u32 s56, s56, s37
    buffer_load_dwordx4 v[124:127], v0, s[8:11], s48 offen offset:3072
    s_waitcnt vmcnt(15)
    v_mfma_f32_16x16x32_bf16 v[16:19], a[192:195], v[64:67], v[16:19]
    v_mfma_f32_16x16x32_bf16 v[20:23], a[196:199], v[64:67], v[20:23]
    v_mfma_f32_16x16x32_bf16 v[24:27], v[224:227], v[64:67], v[24:27]
    s_cmp_lt_u32 s37, 64
    s_cselect_b32 s62, s62, 0
    s_lshl_b32 s46, s56, 18
    s_add_u32 s46, s46, s58
    s_mul_i32 s41, s36, 4718592
    s_mul_i32 s17, s37, 36864
    s_add_u32 s41, s41, s17
    s_add_u32 s41, s41, 8650752
    s_cmp_lg_u32 s62, 0
    s_cselect_b32 s30, 268435456, 0
    s_add_u32 s48, s46, 0
    buffer_load_dwordx4 v[64:67], v0, s[28:31], s48 offen offset:0
    s_waitcnt vmcnt(15)
    v_mfma_f32_16x16x32_bf16 v[28:31], a[192:195], v[68:71], v[28:31]
    v_mfma_f32_16x16x32_bf16 v[32:35], a[196:199], v[68:71], v[32:35]
    v_mfma_f32_16x16x32_bf16 v[36:39], v[224:227], v[68:71], v[36:39]
    buffer_load_dwordx4 v[68:71], v0, s[28:31], s48 offen offset:1024
    s_waitcnt vmcnt(15)
    v_mfma_f32_16x16x32_bf16 v[16:19], a[200:203], v[72:75], v[16:19]
    v_mfma_f32_16x16x32_bf16 v[20:23], a[204:207], v[72:75], v[20:23]
    v_mfma_f32_16x16x32_bf16 v[24:27], v[228:231], v[72:75], v[24:27]
    buffer_load_dwordx4 v[72:75], v0, s[28:31], s48 offen offset:2048
    s_waitcnt vmcnt(15)
    v_mfma_f32_16x16x32_bf16 v[28:31], a[200:203], v[76:79], v[28:31]
    v_mfma_f32_16x16x32_bf16 v[32:35], a[204:207], v[76:79], v[32:35]
    v_mfma_f32_16x16x32_bf16 v[36:39], v[228:231], v[76:79], v[36:39]
    buffer_load_dwordx4 v[76:79], v0, s[28:31], s48 offen offset:3072
    s_waitcnt vmcnt(15)
    v_mfma_f32_16x16x32_bf16 v[16:19], a[208:211], v[80:83], v[16:19]
    v_mfma_f32_16x16x32_bf16 v[20:23], a[212:215], v[80:83], v[20:23]
    v_mfma_f32_16x16x32_bf16 v[24:27], v[232:235], v[80:83], v[24:27]
    s_add_u32 s48, s46, 4096
    buffer_load_dwordx4 v[80:83], v0, s[28:31], s48 offen offset:0
    s_waitcnt vmcnt(15)
    v_mfma_f32_16x16x32_bf16 v[28:31], a[208:211], v[84:87], v[28:31]
    v_mfma_f32_16x16x32_bf16 v[32:35], a[212:215], v[84:87], v[32:35]
    v_mfma_f32_16x16x32_bf16 v[36:39], v[232:235], v[84:87], v[36:39]
    buffer_load_dwordx4 v[84:87], v0, s[28:31], s48 offen offset:1024
    s_waitcnt vmcnt(15)
    v_mfma_f32_16x16x32_bf16 v[16:19], a[216:219], v[88:91], v[16:19]
    v_mfma_f32_16x16x32_bf16 v[20:23], a[220:223], v[88:91], v[20:23]
    v_mfma_f32_16x16x32_bf16 v[24:27], v[236:239], v[88:91], v[24:27]
    buffer_load_dwordx4 v[88:91], v0, s[28:31], s48 offen offset:2048
    s_waitcnt vmcnt(15)
    v_mfma_f32_16x16x32_bf16 v[28:31], a[216:219], v[92:95], v[28:31]
    v_mfma_f32_16x16x32_bf16 v[32:35], a[220:223], v[92:95], v[32:35]
    v_mfma_f32_16x16x32_bf16 v[36:39], v[236:239], v[92:95], v[36:39]
    buffer_load_dwordx4 v[92:95], v0, s[28:31], s48 offen offset:3072
    s_waitcnt vmcnt(15)
    v_mfma_f32_16x16x32_bf16 v[16:19], a[224:227], v[96:99], v[16:19]
    v_mfma_f32_16x16x32_bf16 v[20:23], a[228:231], v[96:99], v[20:23]
    v_mfma_f32_16x16x32_bf16 v[24:27], v[240:243], v[96:99], v[24:27]
    s_add_u32 s48, s46, 8192
    buffer_load_dwordx4 v[96:99], v0, s[28:31], s48 offen offset:0
    s_waitcnt vmcnt(15)
    v_mfma_f32_16x16x32_bf16 v[28:31], a[224:227], v[100:103], v[28:31]
    v_mfma_f32_16x16x32_bf16 v[32:35], a[228:231], v[100:103], v[32:35]
    v_mfma_f32_16x16x32_bf16 v[36:39], v[240:243], v[100:103], v[36:39]
    buffer_load_dwordx4 v[100:103], v0, s[28:31], s48 offen offset:1024
    s_waitcnt vmcnt(15)
    v_mfma_f32_16x16x32_bf16 v[16:19], a[232:235], v[104:107], v[16:19]
    v_mfma_f32_16x16x32_bf16 v[20:23], a[236:239], v[104:107], v[20:23]
    v_mfma_f32_16x16x32_bf16 v[24:27], v[244:247], v[104:107], v[24:27]
    buffer_load_dwordx4 v[104:107], v0, s[28:31], s48 offen offset:2048
    s_waitcnt vmcnt(15)
    v_mfma_f32_16x16x32_bf16 v[28:31], a[232:235], v[108:111], v[28:31]
    v_mfma_f32_16x16x32_bf16 v[32:35], a[236:239], v[108:111], v[32:35]
    v_mfma_f32_16x16x32_bf16 v[36:39], v[244:247], v[108:111], v[36:39]
    buffer_load_dwordx4 v[108:111], v0, s[28:31], s48 offen offset:3072
    s_waitcnt vmcnt(15)
    v_mfma_f32_16x16x32_bf16 v[16:19], a[240:243], v[112:115], v[16:19]
    v_mfma_f32_16x16x32_bf16 v[20:23], a[244:247], v[112:115], v[20:23]
    v_mfma_f32_16x16x32_bf16 v[24:27], v[248:251], v[112:115], v[24:27]
    s_add_u32 s48, s46, 12288
    buffer_load_dwordx4 v[112:115], v0, s[28:31], s48 offen offset:0
    s_waitcnt vmcnt(15)
    v_mfma_f32_16x16x32_bf16 v[28:31], a[240:243], v[116:119], v[28:31]
    v_mfma_f32_16x16x32_bf16 v[32:35], a[244:247], v[116:119], v[32:35]
    v_mfma_f32_16x16x32_bf16 v[36:39], v[248:251], v[116:119], v[36:39]
    buffer_load_dwordx4 v[116:119], v0, s[28:31], s48 offen offset:1024
    s_waitcnt vmcnt(15)
    v_mfma_f32_16x16x32_bf16 v[16:19], a[248:251], v[120:123], v[16:19]
    v_mfma_f32_16x16x32_bf16 v[20:23], a[252:255], v[120:123], v[20:23]
    v_mfma_f32_16x16x32_bf16 v[24:27], v[252:255], v[120:123], v[24:27]
    buffer_load_dwordx4 v[120:123], v0, s[28:31], s48 offen offset:2048
    s_waitcnt vmcnt(15)
    v_mfma_f32_16x16x32_bf16 v[28:31], a[248:251], v[124:127], v[28:31]
    v_mfma_f32_16x16x32_bf16 v[32:35], a[252:255], v[124:127], v[32:35]
    v_mfma_f32_16x16x32_bf16 v[36:39], v[252:255], v[124:127], v[36:39]
    s_nop 5
    ds_write_b128 v48, v[16:19] offset:0
    ds_write_b128 v48, v[20:23] offset:1024
    ds_write_b128 v48, v[24:27] offset:2048
    ds_write_b128 v48, v[28:31] offset:3072
    ds_write_b128 v48, v[32:35] offset:4096
    ds_write_b128 v48, v[36:39] offset:5120
    s_waitcnt lgkmcnt(0)
    s_barrier
    ds_read_b128 v[24:27], v50 offset:2048
    ds_read_b128 v[28:31], v50 offset:8192
    ds_read_b128 v[32:35], v50 offset:14336
    ds_read_b128 v[36:39], v50 offset:20480
    v_xor_b32 v48, 0x8000, v48
    v_xor_b32 v50, 0x8000, v50
    v_lshlrev_b32 v16, 16, v40
    v_and_b32 v17, 0xffff0000, v40
    v_lshlrev_b32 v18, 16, v41
    v_and_b32 v19, 0xffff0000, v41
    buffer_load_dwordx2 v[40:41], v12, s[28:31], s41 offen
    s_waitcnt lgkmcnt(3)
    v_add_f32 v16, v16, v24
    v_add_f32 v17, v17, v25
    v_add_f32 v18, v18, v26
    v_add_f32 v19, v19, v27
    s_waitcnt lgkmcnt(2)
    v_add_f32 v16, v16, v28
    v_add_f32 v17, v17, v29
    v_add_f32 v18, v18, v30
    v_add_f32 v19, v19, v31
    s_waitcnt lgkmcnt(1)
    v_add_f32 v16, v16, v32
    v_add_f32 v17, v17, v33
    v_add_f32 v18, v18, v34
    v_add_f32 v19, v19, v35
    s_waitcnt lgkmcnt(0)
    v_add_f32 v16, v16, v36
    v_add_f32 v17, v17, v37
    v_add_f32 v18, v18, v38
    v_add_f32 v19, v19, v39
    v_cvt_pk_bf16_f32 v52, v16, v17
    v_cvt_pk_bf16_f32 v53, v18, v19
    s_cmp_eq_u32 s34, 0
    s_cbranch_scc1 LtwZ_l0
    s_mul_i32 s17, s35, 36864
    buffer_store_dwordx2 v[52:53], v13, s[24:27], s17 offen sc1
    s_cmp_lg_u32 s62, 0
    s_cbranch_scc1 LtwZ_item
LtwZ_chk:
    s_min_u32 s17, s32, s33
    s_cmp_lt_u32 s17, 64
    s_cbranch_scc1 LtwZ_idle
    s_branch L_role_tw_exit
LtwZ_l0:
    s_add_u32 s47, s47, 2359296
    buffer_store_dwordx2 v[52:53], v12, s[8:11], s47 offen sc1
    v_add_f32 v44, v16, v17
    v_mul_f32 v45, v16, v16
    v_fmac_f32 v45, v17, v17
    v_add_f32 v44, v44, v18
    v_fmac_f32 v45, v18, v18
    v_add_f32 v44, v44, v19
    v_fmac_f32 v45, v19, v19
    v_mov_b32 v46, v44
    v_mov_b32 v47, v45
    s_nop 0
    v_permlane32_swap_b32 v44, v46
    v_permlane32_swap_b32 v45, v47
    v_add_f32 v44, v44, v46
    v_add_f32 v45, v45, v47
    v_mov_b32 v46, v44
    v_mov_b32 v47, v45
    s_nop 0
    v_permlane16_swap_b32 v44, v46
    v_permlane16_swap_b32 v45, v47
    v_add_f32 v44, v44, v46
    v_add_f32 v45, v45, v47
    s_mul_i32 s17, s35, 6144
    s_add_u32 s17, s17, 16515072
    s_mov_b64 exec, 0xffff
    buffer_store_dwordx2 v[44:45], v14, s[8:11], s17 offen sc1
    s_mov_b64 exec, -1
    s_mul_i32 s43, s35, 22528
    s_add_u32 s43, s43, s49
    s_cmp_lg_u32 s62, 0
    s_cbranch_scc1 LtwZ_item
    s_waitcnt vmcnt(0)
    s_mov_b64 exec, 1
    buffer_store_dword v3, v4, s[8:11], s43 offen sc1
    s_mov_b64 exec, -1
    s_mov_b32 s43, 0
    s_branch LtwZ_chk
L_role_tw_abort:
    s_waitcnt lgkmcnt(0)
    s_mov_b64 exec, -1
    v_mov_b32 v0, 60
    s_lshl_b32 s5, s3, 8
    s_or_b32 s5, s5, s4
    s_or_b32 s5, s5, 0x10000
    v_mov_b32 v1, s5
    global_store_dword v0, v1, s[12:13]
    s_endpgm
L_role_tw_exit:
    s_endpgm
.p2align 6
L_role_r:
    s_mov_b32 s32, s3
    s_mov_b32 s15, s4
    v_and_b32 v60, 63, v0
    v_and_b32 v61, 15, v60
    v_lshrrev_b32 v62, 4, v60
    v_lshlrev_b32 v0, 4, v60
    s_mul_i32 s17, s14, 34816
    s_add_u32 s17, s17, 23296
    v_add_u32 v8, s17, v0
    s_mov_b32 s50, 0xfffffffe
    s_mov_b32 s44, 0x3e0293ee
    s_mov_b32 s45, 0x3e0293ee
    s_mov_b32 s52, 0x3f803f80
    s_mov_b32 s53, 0x3f803f80
    s_mov_b32 s40, 1
    s_mov_b32 s46, 0x00ff00ff
    s_cmp_eq_u32 s14, 2
    s_cselect_b32 s46, 0x00030003, s46
    s_mov_b32 s47, s46
    v_bfe_u32 v63, v61, 1, 1
    v_mov_b32 v1, 0x4444
    v_mov_b32 v64, 0xeeee
    v_cmp_eq_u32 vcc, 0, v63
    s_nop 1
    v_cndmask_b32 v1, v64, v1, vcc
    v_mul_u32_u24 v64, 1152, v62
    v_lshl_add_u32 v2, v61, 2, v64
    s_lshl_b32 s17, s14, 6
    s_add_u32 s18, s17, 0
    v_add_u32 v2, s18, v2
    v_mul_u32_u24 v64, 288, v61
    v_lshl_add_u32 v3, v62, 4, v64
    v_add_u32 v3, 0, v3
    v_lshrrev_b32 v64, 2, v61
    v_and_b32 v65, 1, v61
    v_lshl_add_u32 v64, v64, 1, v65
    v_mul_u32_u24 v65, 288, v64
    v_lshl_add_u32 v4, v62, 5, v65
    v_lshl_add_u32 v4, v63, 4, v4
    v_add_u32 v4, 4608, v4
    v_xor_b32 v63, 1, v63
    v_mul_u32_u24 v63, 2304, v63
    v_add_u32 v5, v65, v63
    v_lshl_add_u32 v5, v62, 4, v5
    s_add_u32 s18, s17, 4608
    v_add_u32 v5, s18, v5
    s_lshr_b32 s70, s15, 3
    s_bfe_u32 s71, s15, 0x20001
    s_and_b32 s72, s15, 1
    v_bfe_u32 v64, v61, 2, 1
    v_lshl_add_u32 v63, v64, 2, v62
    v_mul_u32_u24 v63, 9216, v63
    v_lshrrev_b32 v65, 3, v61
    v_lshlrev_b32 v65, 2, v65
    v_and_b32 v64, 3, v61
    v_add_u32 v65, v65, v64
    s_lshl_b32 s73, s71, 4
    s_lshl_b32 s17, s72, 3
    s_add_u32 s73, s73, s17
    v_add_u32 v65, s73, v65
    s_lshl_b32 s17, s70, 6
    v_add_u32 v65, s17, v65
    s_cmp_eq_u32 s14, 2
    s_cselect_b32 s17, 2, 4
    v_lshlrev_b32 v65, s17, v65
    v_add_u32 v6, v63, v65
    s_lshl_b32 s17, s14, 12
    v_add_u32 v6, s17, v6
    v_lshrrev_b32 v66, 1, v61
    s_lshl_b32 s17, s14, 2
    v_add_u32 v66, s17, v66
    v_and_b32 v64, 1, v61
    s_lshl_b32 s17, s70, 4
    s_lshl_b32 s18, s71, 2
    s_add_u32 s17, s17, s18
    s_lshl_b32 s18, s72, 1
    s_add_u32 s17, s17, s18
    v_add_u32 v65, s17, v64
    v_lshl_add_u32 v65, v66, 6, v65
    v_lshlrev_b32 v65, 4, v65
    v_lshl_add_u32 v7, v62, 2, v65
    s_lshl_b32 s17, s71, 1
    v_add_u32 v64, s17, v64
    v_mul_u32_u24 v64, 576, v64
    v_lshl_add_u32 v64, v66, 4, v64
    v_lshl_add_u32 v64, v62, 1, v64
    s_mul_i32 s17, s70, 144
    s_lshl_b32 s18, s72, 3
    s_add_u32 s17, s17, s18
    v_add_u32 v64, s17, v64
    v_lshlrev_b32 v67, 1, v64
    s_mul_i32 s48, s32, 1048576
    s_add_u32 s48, s48, 4194304
    s_mul_i32 s17, s15, 9216
    s_add_u32 s17, s17, s48
    s_lshl_b32 s18, s14, 10
    s_add_u32 s38, s17, s18
    s_lshl_b32 s19, s14, 8
    s_add_u32 s39, s17, s19
    s_add_u32 s39, s39, 8192
    s_add_u32 s37, s48, 983040
    s_xor_b32 s36, s37, 16384
    s_add_u32 s34, s37, s18
    s_add_u32 s35, s37, 8192
    s_mul_i32 s17, s32, 50331648
    s_lshl_b32 s19, s15, 13
    s_add_u32 s17, s17, s19
    s_add_u32 s68, s17, 77594624
    s_lshl_b32 s18, s14, 11
    s_add_u32 s17, s17, s18
    s_add_u32 s41, s17, 60817408
    s_add_u32 s42, s17, 77594624
    s_mul_i32 s17, s32, 8388608
    s_lshl_b32 s19, s15, 12
    s_add_u32 s17, s17, s19
    s_add_u32 s43, s17, 27262976
    s_mul_i32 s17, s32, 1441792
    s_lshl_b32 s19, s15, 9
    s_add_u32 s17, s17, s19
    s_add_u32 s66, s17, 5376
    s_mov_b32 s33, 0
    s_add_u32 s62, s48, 0
    s_add_u32 s63, s48, 73728
    s_add_u32 s64, s48, 147456
    s_add_u32 s65, s48, 221184
    s_load_dwordx2 s[20:21], s[0:1], 32
    s_mov_b32 s22, 9216
    s_mov_b32 s23, 0x00020000
    s_waitcnt lgkmcnt(0)
    s_and_b32 s21, s21, 0xffff
    s_cmp_gt_u32 s14, 2
    s_cbranch_scc1 Lr_mem0_done
    s_mov_b64 exec, s[46:47]
    buffer_load_dword v64, v67, s[20:23], 0 offen
    s_waitcnt vmcnt(0)
    v_min_u32 v64, s50, v64
    buffer_store_dword v64, v7, s[8:11], s37 offen sc1
    v_mov_b32 v64, -1
    buffer_store_dword v64, v7, s[8:11], s36 offen sc1
    s_mov_b64 exec, -1
Lr_mem0_done:
    v_mov_b32 v64, 0
    v_mov_b32 v65, 0
    v_mov_b32 v66, 0
    v_mov_b32 v67, 0
    v_lshrrev_b32 v63, 2, v0
    buffer_store_dwordx4 v[64:67], v0, s[8:11], s38 offen sc1
    s_add_u32 s17, s38, 4096
    buffer_store_dwordx4 v[64:67], v0, s[8:11], s17 offen sc1
    buffer_store_dword v64, v63, s[8:11], s39 offen sc1
    s_waitcnt vmcnt(0)
    s_barrier
    s_cmp_lg_u32 s14, 0
    s_cbranch_scc1 Lr_noadd
    s_lshl_b32 s17, s32, 2
    s_add_u32 s17, s17, 192
    v_mov_b32 v63, s17
    v_mov_b32 v64, 1
    s_mov_b64 exec, 1
    global_atomic_add v63, v64, s[12:13]
    s_mov_b64 exec, -1
Lr_noadd:
    s_cmp_lt_u32 s14, 3
    s_cbranch_scc1 Lr_not_w3
    v_lshlrev_b32 v6, 3, v0
    v_lshrrev_b32 v63, 2, v0
    v_and_b32 v7, 12, v63
    v_and_b32 v63, 16, v63
    v_lshl_add_u32 v7, v63, 3, v7
Lr_not_w3:
    s_cmp_eq_u32 s32, 0
    s_cbranch_scc1 Lr_gate_ng
    s_cmp_lg_u32 s14, 0
    s_cbranch_scc1 Lr_gate_d
    v_mov_b32 v63, 48
    s_mov_b32 s16, 0
Lr_gate:
    global_load_dword v64, v63, s[12:13] sc1
    s_add_u32 s16, s16, 1
    s_cmp_gt_u32 s16, 100000
    s_cbranch_scc1 Lr_abort
    s_waitcnt vmcnt(0)
    v_cmp_gt_u32 vcc, 32, v64
    s_nop 0
    s_cbranch_vccz Lr_gate_d
    s_sleep 100
    s_branch Lr_gate
Lr_gate_d:
    s_barrier
Lr_gate_ng:
    s_load_dwordx2 s[20:21], s[0:1], 40
    s_mov_b32 s22, 4718592
    s_mov_b32 s23, 0x00020000
    s_waitcnt lgkmcnt(0)
    s_and_b32 s21, s21, 0xffff
    s_load_dwordx2 s[24:25], s[0:1], 48
    s_mov_b32 s26, 4718592
    s_mov_b32 s27, 0x00020000
    s_waitcnt lgkmcnt(0)
    s_and_b32 s25, s25, 0xffff
    s_load_dwordx2 s[28:29], s[0:1], 56
    s_mov_b32 s30, 4718592
    s_mov_b32 s31, 0x00020000
    s_waitcnt lgkmcnt(0)
    s_and_b32 s29, s29, 0xffff
    s_load_dwordx2 s[76:77], s[0:1], 64
    s_mov_b32 s78, 4718592
    s_mov_b32 s79, 0x00020000
    s_waitcnt lgkmcnt(0)
    s_and_b32 s77, s77, 0xffff
    v_lshrrev_b32 v60, 4, v0
    v_and_b32 v61, 15, v60
    v_lshrrev_b32 v62, 4, v60
    s_mul_i32 s72, s14, 34816
    s_add_u32 s72, s72, 23296
    s_mul_i32 s70, s14, 1179648
    s_lshl_b32 s17, s15, 8
    s_add_u32 s70, s70, s17
    s_mul_i32 s71, s15, 147456
    s_mul_i32 s17, s14, 288
    s_add_u32 s71, s71, s17
    v_and_b32 v63, 1, v62
    v_lshrrev_b32 v64, 1, v61
    v_xor_b32 v64, v64, v63
    v_lshlrev_b32 v64, 5, v64
    v_and_b32 v65, 1, v61
    v_lshl_add_u32 v64, v65, 4, v64
    v_lshl_add_u32 v12, v62, 13, v64
    v_xor_b32 v13, 128, v12
    v_xor_b32 v14, 64, v12
    v_xor_b32 v15, 192, v12
    v_lshrrev_b32 v63, 2, v60
    v_mul_u32_u24 v63, 1152, v63
    v_and_b32 v64, 3, v60
    v_lshl_add_u32 v16, v64, 4, v63
    v_lshrrev_b32 v63, 1, v60
    v_mul_u32_u24 v63, 1152, v63
    v_and_b32 v64, 1, v60
    v_lshl_add_u32 v17, v64, 4, v63
    v_lshrrev_b32 v40, 2, v61
    v_and_b32 v41, 3, v61
    v_and_b32 v63, 1, v62
    v_lshl_add_u32 v42, v63, 2, v40
    v_and_b32 v64, 1, v40
    v_lshl_add_u32 v64, v63, 2, v64
    v_lshrrev_b32 v65, 1, v40
    v_lshl_add_u32 v64, v65, 3, v64
    v_lshlrev_b32 v64, 8, v64
    v_lshl_add_u32 v64, v41, 3, v64
    v_lshrrev_b32 v65, 1, v62
    v_mul_u32_u24 v65, 34816, v65
    v_add_u32 v64, v64, v65
    v_add_u32 v64, 23296, v64
    s_lshl_b32 s17, s14, 1
    s_add_u32 s18, s17, 0
    v_xor_b32 v65, s18, v42
    v_lshl_add_u32 v18, v65, 5, v64
    v_add_u32 v19, 69632, v18
    s_add_u32 s18, s17, 1
    v_xor_b32 v65, s18, v42
    v_lshl_add_u32 v20, v65, 5, v64
    v_add_u32 v21, 69632, v20
    v_lshrrev_b32 v63, 1, v62
    v_lshlrev_b32 v63, 3, v63
    v_and_b32 v64, 1, v62
    v_lshl_add_u32 v63, v64, 1, v63
    v_and_b32 v64, 1, v40
    v_lshl_add_u32 v63, v64, 4, v63
    v_lshrrev_b32 v64, 1, v40
    v_lshl_add_u32 v63, v64, 2, v63
    v_lshlrev_b32 v64, 3, v41
    v_lshl_add_u32 v22, v63, 6, v64
    v_add_u32 v22, s72, v22
    v_lshl_add_u32 v23, v63, 5, v64
    v_add_u32 v23, s72, v23
    s_add_u32 m0, s72, 0
    s_add_u32 s17, s70, 0
    buffer_load_dwordx4 v12, s[20:23], s17 offen lds
    s_add_u32 m0, m0, 1024
    s_add_u32 s17, s70, 32768
    buffer_load_dwordx4 v13, s[20:23], s17 offen lds
    s_add_u32 m0, m0, 1024
    s_add_u32 s17, s70, 65536
    buffer_load_dwordx4 v14, s[20:23], s17 offen lds
    s_add_u32 m0, m0, 1024
    s_add_u32 s17, s70, 98304
    buffer_load_dwordx4 v15, s[20:23], s17 offen lds
    s_add_u32 m0, s72, 4096
    s_add_u32 s17, s70, 0
    buffer_load_dwordx4 v12, s[24:27], s17 offen lds
    s_add_u32 m0, m0, 1024
    s_add_u32 s17, s70, 32768
    buffer_load_dwordx4 v13, s[24:27], s17 offen lds
    s_add_u32 m0, m0, 1024
    s_add_u32 s17, s70, 65536
    buffer_load_dwordx4 v14, s[24:27], s17 offen lds
    s_add_u32 m0, m0, 1024
    s_add_u32 s17, s70, 98304
    buffer_load_dwordx4 v15, s[24:27], s17 offen lds
    s_add_u32 m0, s72, 8192
    s_add_u32 s17, s70, 131072
    buffer_load_dwordx4 v12, s[20:23], s17 offen lds
    s_add_u32 m0, m0, 1024
    s_add_u32 s17, s70, 163840
    buffer_load_dwordx4 v13, s[20:23], s17 offen lds
    s_add_u32 m0, m0, 1024
    s_add_u32 s17, s70, 196608
    buffer_load_dwordx4 v14, s[20:23], s17 offen lds
    s_add_u32 m0, m0, 1024
    s_add_u32 s17, s70, 229376
    buffer_load_dwordx4 v15, s[20:23], s17 offen lds
    s_add_u32 m0, s72, 12288
    s_add_u32 s17, s70, 131072
    buffer_load_dwordx4 v12, s[24:27], s17 offen lds
    s_add_u32 m0, m0, 1024
    s_add_u32 s17, s70, 163840
    buffer_load_dwordx4 v13, s[24:27], s17 offen lds
    s_add_u32 m0, m0, 1024
    s_add_u32 s17, s70, 196608
    buffer_load_dwordx4 v14, s[24:27], s17 offen lds
    s_add_u32 m0, m0, 1024
    s_add_u32 s17, s70, 229376
    buffer_load_dwordx4 v15, s[24:27], s17 offen lds
    s_add_u32 m0, s72, 16384
    s_add_u32 s17, s70, 131072
    buffer_load_dwordx4 v12, s[28:31], s17 offen lds
    s_add_u32 m0, m0, 1024
    s_add_u32 s17, s70, 163840
    buffer_load_dwordx4 v13, s[28:31], s17 offen lds
    s_add_u32 m0, m0, 1024
    s_add_u32 s17, s70, 196608
    buffer_load_dwordx4 v14, s[28:31], s17 offen lds
    s_add_u32 m0, m0, 1024
    s_add_u32 s17, s70, 229376
    buffer_load_dwordx4 v15, s[28:31], s17 offen lds
    s_add_u32 m0, s72, 20480
    s_add_u32 s17, s70, 262144
    buffer_load_dwordx4 v12, s[20:23], s17 offen lds
    s_add_u32 m0, m0, 1024
    s_add_u32 s17, s70, 294912
    buffer_load_dwordx4 v13, s[20:23], s17 offen lds
    s_add_u32 m0, m0, 1024
    s_add_u32 s17, s70, 327680
    buffer_load_dwordx4 v14, s[20:23], s17 offen lds
    s_add_u32 m0, m0, 1024
    s_add_u32 s17, s70, 360448
    buffer_load_dwordx4 v15, s[20:23], s17 offen lds
    s_add_u32 m0, s72, 24576
    s_add_u32 s17, s70, 262144
    buffer_load_dwordx4 v12, s[24:27], s17 offen lds
    s_add_u32 m0, m0, 1024
    s_add_u32 s17, s70, 294912
    buffer_load_dwordx4 v13, s[24:27], s17 offen lds
    s_add_u32 m0, m0, 1024
    s_add_u32 s17, s70, 327680
    buffer_load_dwordx4 v14, s[24:27], s17 offen lds
    s_add_u32 m0, m0, 1024
    s_add_u32 s17, s70, 360448
    buffer_load_dwordx4 v15, s[24:27], s17 offen lds
    s_add_u32 m0, s72, 28672
    s_add_u32 s17, s70, 393216
    buffer_load_dwordx4 v12, s[20:23], s17 offen lds
    s_add_u32 m0, m0, 1024
    s_add_u32 s17, s70, 425984
    buffer_load_dwordx4 v13, s[20:23], s17 offen lds
    s_add_u32 m0, m0, 1024
    s_add_u32 s17, s70, 458752
    buffer_load_dwordx4 v14, s[20:23], s17 offen lds
    s_add_u32 m0, m0, 1024
    s_add_u32 s17, s70, 491520
    buffer_load_dwordx4 v15, s[20:23], s17 offen lds
    s_add_u32 m0, s72, 32768
    s_add_u32 s17, s71, 256
    buffer_load_dwordx4 v17, s[76:79], s17 offen lds
    s_add_u32 m0, m0, 1024
    s_add_u32 s17, s71, 37120
    buffer_load_dwordx4 v17, s[76:79], s17 offen lds
    s_waitcnt vmcnt(30)
    s_barrier
    ds_read_b64_tr_b16 v[72:73], v18 offset:0
    ds_read_b64_tr_b16 v[74:75], v18 offset:512
    ds_read_b64_tr_b16 v[76:77], v19 offset:0
    ds_read_b64_tr_b16 v[78:79], v19 offset:512
    ds_read_b64_tr_b16 v[80:81], v20 offset:0
    ds_read_b64_tr_b16 v[82:83], v20 offset:512
    ds_read_b64_tr_b16 v[84:85], v21 offset:0
    ds_read_b64_tr_b16 v[86:87], v21 offset:512
    s_waitcnt lgkmcnt(0)
    s_waitcnt vmcnt(26)
    s_barrier
    s_add_u32 m0, s72, 0
    s_add_u32 s17, s70, 393216
    buffer_load_dwordx4 v12, s[24:27], s17 offen lds
    s_add_u32 m0, m0, 1024
    s_add_u32 s17, s70, 425984
    buffer_load_dwordx4 v13, s[24:27], s17 offen lds
    s_add_u32 m0, m0, 1024
    s_add_u32 s17, s70, 458752
    buffer_load_dwordx4 v14, s[24:27], s17 offen lds
    s_add_u32 m0, m0, 1024
    s_add_u32 s17, s70, 491520
    buffer_load_dwordx4 v15, s[24:27], s17 offen lds
    ds_read_b64_tr_b16 v[184:185], v18 offset:4096
    ds_read_b64_tr_b16 v[186:187], v18 offset:4608
    ds_read_b64_tr_b16 v[188:189], v19 offset:4096
    ds_read_b64_tr_b16 v[190:191], v19 offset:4608
    ds_read_b64_tr_b16 v[192:193], v20 offset:4096
    ds_read_b64_tr_b16 v[194:195], v20 offset:4608
    ds_read_b64_tr_b16 v[196:197], v21 offset:4096
    ds_read_b64_tr_b16 v[198:199], v21 offset:4608
    s_waitcnt lgkmcnt(0)
    s_waitcnt vmcnt(26)
    s_barrier
    s_add_u32 m0, s72, 4096
    s_add_u32 s17, s70, 393216
    buffer_load_dwordx4 v12, s[28:31], s17 offen lds
    s_add_u32 m0, m0, 1024
    s_add_u32 s17, s70, 425984
    buffer_load_dwordx4 v13, s[28:31], s17 offen lds
    s_add_u32 m0, m0, 1024
    s_add_u32 s17, s70, 458752
    buffer_load_dwordx4 v14, s[28:31], s17 offen lds
    s_add_u32 m0, m0, 1024
    s_add_u32 s17, s70, 491520
    buffer_load_dwordx4 v15, s[28:31], s17 offen lds
    ds_read_b64_tr_b16 v[88:89], v18 offset:8192
    ds_read_b64_tr_b16 v[90:91], v18 offset:8704
    ds_read_b64_tr_b16 v[92:93], v19 offset:8192
    ds_read_b64_tr_b16 v[94:95], v19 offset:8704
    ds_read_b64_tr_b16 v[96:97], v20 offset:8192
    ds_read_b64_tr_b16 v[98:99], v20 offset:8704
    ds_read_b64_tr_b16 v[100:101], v21 offset:8192
    ds_read_b64_tr_b16 v[102:103], v21 offset:8704
    s_waitcnt lgkmcnt(0)
    s_waitcnt vmcnt(26)
    s_barrier
    s_add_u32 m0, s72, 8192
    s_add_u32 s17, s70, 524288
    buffer_load_dwordx4 v12, s[24:27], s17 offen lds
    s_add_u32 m0, m0, 1024
    s_add_u32 s17, s70, 557056
    buffer_load_dwordx4 v13, s[24:27], s17 offen lds
    s_add_u32 m0, m0, 1024
    s_add_u32 s17, s70, 589824
    buffer_load_dwordx4 v14, s[24:27], s17 offen lds
    s_add_u32 m0, m0, 1024
    s_add_u32 s17, s70, 622592
    buffer_load_dwordx4 v15, s[24:27], s17 offen lds
    ds_read_b64_tr_b16 v[200:201], v18 offset:12288
    ds_read_b64_tr_b16 v[202:203], v18 offset:12800
    ds_read_b64_tr_b16 v[204:205], v19 offset:12288
    ds_read_b64_tr_b16 v[206:207], v19 offset:12800
    ds_read_b64_tr_b16 v[208:209], v20 offset:12288
    ds_read_b64_tr_b16 v[210:211], v20 offset:12800
    ds_read_b64_tr_b16 v[212:213], v21 offset:12288
    ds_read_b64_tr_b16 v[214:215], v21 offset:12800
    s_waitcnt lgkmcnt(0)
    s_waitcnt vmcnt(26)
    s_barrier
    s_add_u32 m0, s72, 12288
    s_add_u32 s17, s70, 524288
    buffer_load_dwordx4 v12, s[28:31], s17 offen lds
    s_add_u32 m0, m0, 1024
    s_add_u32 s17, s70, 557056
    buffer_load_dwordx4 v13, s[28:31], s17 offen lds
    s_add_u32 m0, m0, 1024
    s_add_u32 s17, s70, 589824
    buffer_load_dwordx4 v14, s[28:31], s17 offen lds
    s_add_u32 m0, m0, 1024
    s_add_u32 s17, s70, 622592
    buffer_load_dwordx4 v15, s[28:31], s17 offen lds
    ds_read_b64_tr_b16 a[72:73], v18 offset:16384
    ds_read_b64_tr_b16 a[74:75], v18 offset:16896
    ds_read_b64_tr_b16 a[76:77], v19 offset:16384
    ds_read_b64_tr_b16 a[78:79], v19 offset:16896
    ds_read_b64_tr_b16 a[80:81], v20 offset:16384
    ds_read_b64_tr_b16 a[82:83], v20 offset:16896
    ds_read_b64_tr_b16 a[84:85], v21 offset:16384
    ds_read_b64_tr_b16 a[86:87], v21 offset:16896
    s_waitcnt lgkmcnt(0)
    s_waitcnt vmcnt(26)
    s_barrier
    s_add_u32 m0, s72, 16384
    s_add_u32 s17, s70, 655360
    buffer_load_dwordx4 v12, s[20:23], s17 offen lds
    s_add_u32 m0, m0, 1024
    s_add_u32 s17, s70, 688128
    buffer_load_dwordx4 v13, s[20:23], s17 offen lds
    s_add_u32 m0, m0, 1024
    s_add_u32 s17, s70, 720896
    buffer_load_dwordx4 v14, s[20:23], s17 offen lds
    s_add_u32 m0, m0, 1024
    s_add_u32 s17, s70, 753664
    buffer_load_dwordx4 v15, s[20:23], s17 offen lds
    ds_read_b64_tr_b16 v[104:105], v18 offset:20480
    ds_read_b64_tr_b16 v[106:107], v18 offset:20992
    ds_read_b64_tr_b16 v[108:109], v19 offset:20480
    ds_read_b64_tr_b16 v[110:111], v19 offset:20992
    ds_read_b64_tr_b16 v[112:113], v20 offset:20480
    ds_read_b64_tr_b16 v[114:115], v20 offset:20992
    ds_read_b64_tr_b16 v[116:117], v21 offset:20480
    ds_read_b64_tr_b16 v[118:119], v21 offset:20992
    s_waitcnt lgkmcnt(0)
    s_waitcnt vmcnt(26)
    s_barrier
    s_add_u32 m0, s72, 20480
    s_add_u32 s17, s70, 655360
    buffer_load_dwordx4 v12, s[24:27], s17 offen lds
    s_add_u32 m0, m0, 1024
    s_add_u32 s17, s70, 688128
    buffer_load_dwordx4 v13, s[24:27], s17 offen lds
    s_add_u32 m0, m0, 1024
    s_add_u32 s17, s70, 720896
    buffer_load_dwordx4 v14, s[24:27], s17 offen lds
    s_add_u32 m0, m0, 1024
    s_add_u32 s17, s70, 753664
    buffer_load_dwordx4 v15, s[24:27], s17 offen lds
    ds_read_b64_tr_b16 v[216:217], v18 offset:24576
    ds_read_b64_tr_b16 v[218:219], v18 offset:25088
    ds_read_b64_tr_b16 v[220:221], v19 offset:24576
    ds_read_b64_tr_b16 v[222:223], v19 offset:25088
    ds_read_b64_tr_b16 v[224:225], v20 offset:24576
    ds_read_b64_tr_b16 v[226:227], v20 offset:25088
    ds_read_b64_tr_b16 v[228:229], v21 offset:24576
    ds_read_b64_tr_b16 v[230:231], v21 offset:25088
    s_waitcnt lgkmcnt(0)
    s_waitcnt vmcnt(26)
    s_barrier
    s_add_u32 m0, s72, 24576
    s_add_u32 s17, s70, 655360
    buffer_load_dwordx4 v12, s[28:31], s17 offen lds
    s_add_u32 m0, m0, 1024
    s_add_u32 s17, s70, 688128
    buffer_load_dwordx4 v13, s[28:31], s17 offen lds
    s_add_u32 m0, m0, 1024
    s_add_u32 s17, s70, 720896
    buffer_load_dwordx4 v14, s[28:31], s17 offen lds
    s_add_u32 m0, m0, 1024
    s_add_u32 s17, s70, 753664
    buffer_load_dwordx4 v15, s[28:31], s17 offen lds
    ds_read_b64_tr_b16 v[120:121], v18 offset:28672
    ds_read_b64_tr_b16 v[122:123], v18 offset:29184
    ds_read_b64_tr_b16 v[124:125], v19 offset:28672
    ds_read_b64_tr_b16 v[126:127], v19 offset:29184
    ds_read_b64_tr_b16 v[128:129], v20 offset:28672
    ds_read_b64_tr_b16 v[130:131], v20 offset:29184
    ds_read_b64_tr_b16 v[132:133], v21 offset:28672
    ds_read_b64_tr_b16 v[134:135], v21 offset:29184
    s_waitcnt lgkmcnt(0)
    s_waitcnt vmcnt(24)
    s_barrier
    s_add_u32 m0, s72, 28672
    s_add_u32 s17, s70, 786432
    buffer_load_dwordx4 v12, s[24:27], s17 offen lds
    s_add_u32 m0, m0, 1024
    s_add_u32 s17, s70, 819200
    buffer_load_dwordx4 v13, s[24:27], s17 offen lds
    s_add_u32 m0, m0, 1024
    s_add_u32 s17, s70, 851968
    buffer_load_dwordx4 v14, s[24:27], s17 offen lds
    s_add_u32 m0, m0, 1024
    s_add_u32 s17, s70, 884736
    buffer_load_dwordx4 v15, s[24:27], s17 offen lds
    ds_read_b64_tr_b16 v[232:233], v18 offset:0
    ds_read_b64_tr_b16 v[234:235], v18 offset:512
    ds_read_b64_tr_b16 v[236:237], v19 offset:0
    ds_read_b64_tr_b16 v[238:239], v19 offset:512
    ds_read_b64_tr_b16 v[240:241], v20 offset:0
    ds_read_b64_tr_b16 v[242:243], v20 offset:512
    ds_read_b64_tr_b16 v[244:245], v21 offset:0
    ds_read_b64_tr_b16 v[246:247], v21 offset:512
    s_waitcnt lgkmcnt(0)
    s_waitcnt vmcnt(24)
    s_barrier
    s_add_u32 m0, s72, 0
    s_add_u32 s17, s70, 786432
    buffer_load_dwordx4 v12, s[28:31], s17 offen lds
    s_add_u32 m0, m0, 1024
    s_add_u32 s17, s70, 819200
    buffer_load_dwordx4 v13, s[28:31], s17 offen lds
    s_add_u32 m0, m0, 1024
    s_add_u32 s17, s70, 851968
    buffer_load_dwordx4 v14, s[28:31], s17 offen lds
    s_add_u32 m0, m0, 1024
    s_add_u32 s17, s70, 884736
    buffer_load_dwordx4 v15, s[28:31], s17 offen lds
    ds_read_b64_tr_b16 a[88:89], v18 offset:4096
    ds_read_b64_tr_b16 a[90:91], v18 offset:4608
    ds_read_b64_tr_b16 a[92:93], v19 offset:4096
    ds_read_b64_tr_b16 a[94:95], v19 offset:4608
    ds_read_b64_tr_b16 a[96:97], v20 offset:4096
    ds_read_b64_tr_b16 a[98:99], v20 offset:4608
    ds_read_b64_tr_b16 a[100:101], v21 offset:4096
    ds_read_b64_tr_b16 a[102:103], v21 offset:4608
    s_waitcnt lgkmcnt(0)
    s_waitcnt vmcnt(24)
    s_barrier
    s_add_u32 m0, s72, 4096
    s_add_u32 s17, s70, 917504
    buffer_load_dwordx4 v12, s[20:23], s17 offen lds
    s_add_u32 m0, m0, 1024
    s_add_u32 s17, s70, 950272
    buffer_load_dwordx4 v13, s[20:23], s17 offen lds
    s_add_u32 m0, m0, 1024
    s_add_u32 s17, s70, 983040
    buffer_load_dwordx4 v14, s[20:23], s17 offen lds
    s_add_u32 m0, m0, 1024
    s_add_u32 s17, s70, 1015808
    buffer_load_dwordx4 v15, s[20:23], s17 offen lds
    ds_read_b64_tr_b16 v[248:249], v18 offset:8192
    ds_read_b64_tr_b16 v[250:251], v18 offset:8704
    ds_read_b64_tr_b16 v[252:253], v19 offset:8192
    ds_read_b64_tr_b16 v[254:255], v19 offset:8704
    ds_read_b64_tr_b16 a[0:1], v20 offset:8192
    ds_read_b64_tr_b16 a[2:3], v20 offset:8704
    ds_read_b64_tr_b16 a[4:5], v21 offset:8192
    ds_read_b64_tr_b16 a[6:7], v21 offset:8704
    s_waitcnt lgkmcnt(0)
    s_waitcnt vmcnt(24)
    s_barrier
    s_add_u32 m0, s72, 8192
    s_add_u32 s17, s70, 917504
    buffer_load_dwordx4 v12, s[24:27], s17 offen lds
    s_add_u32 m0, m0, 1024
    s_add_u32 s17, s70, 950272
    buffer_load_dwordx4 v13, s[24:27], s17 offen lds
    s_add_u32 m0, m0, 1024
    s_add_u32 s17, s70, 983040
    buffer_load_dwordx4 v14, s[24:27], s17 offen lds
    s_add_u32 m0, m0, 1024
    s_add_u32 s17, s70, 1015808
    buffer_load_dwordx4 v15, s[24:27], s17 offen lds
    ds_read_b64_tr_b16 a[104:105], v18 offset:12288
    ds_read_b64_tr_b16 a[106:107], v18 offset:12800
    ds_read_b64_tr_b16 a[108:109], v19 offset:12288
    ds_read_b64_tr_b16 a[110:111], v19 offset:12800
    ds_read_b64_tr_b16 a[112:113], v20 offset:12288
    ds_read_b64_tr_b16 a[114:115], v20 offset:12800
    ds_read_b64_tr_b16 a[116:117], v21 offset:12288
    ds_read_b64_tr_b16 a[118:119], v21 offset:12800
    s_waitcnt lgkmcnt(0)
    s_waitcnt vmcnt(24)
    s_barrier
    s_add_u32 m0, s72, 12288
    s_add_u32 s17, s70, 917504
    buffer_load_dwordx4 v12, s[28:31], s17 offen lds
    s_add_u32 m0, m0, 1024
    s_add_u32 s17, s70, 950272
    buffer_load_dwordx4 v13, s[28:31], s17 offen lds
    s_add_u32 m0, m0, 1024
    s_add_u32 s17, s70, 983040
    buffer_load_dwordx4 v14, s[28:31], s17 offen lds
    s_add_u32 m0, m0, 1024
    s_add_u32 s17, s70, 1015808
    buffer_load_dwordx4 v15, s[28:31], s17 offen lds
    ds_read_b64_tr_b16 v[136:137], v18 offset:16384
    ds_read_b64_tr_b16 v[138:139], v18 offset:16896
    ds_read_b64_tr_b16 v[140:141], v19 offset:16384
    ds_read_b64_tr_b16 v[142:143], v19 offset:16896
    ds_read_b64_tr_b16 v[144:145], v20 offset:16384
    ds_read_b64_tr_b16 v[146:147], v20 offset:16896
    ds_read_b64_tr_b16 v[148:149], v21 offset:16384
    ds_read_b64_tr_b16 v[150:151], v21 offset:16896
    s_waitcnt lgkmcnt(0)
    s_add_u32 s17, s32, s14
    s_cmp_lg_u32 s17, 0
    s_cbranch_scc1 Lr_nold
    v_mov_b32 v63, 48
    v_mov_b32 v64, 1
    s_mov_b64 exec, 1
    global_atomic_add v63, v64, s[12:13]
    s_mov_b64 exec, -1
Lr_nold:
    s_waitcnt vmcnt(24)
    s_barrier
    s_add_u32 m0, s72, 16384
    s_add_u32 s17, s70, 1048576
    buffer_load_dwordx4 v12, s[20:23], s17 offen lds
    s_add_u32 m0, m0, 1024
    s_add_u32 s17, s70, 1081344
    buffer_load_dwordx4 v13, s[20:23], s17 offen lds
    s_add_u32 m0, m0, 1024
    s_add_u32 s17, s70, 1114112
    buffer_load_dwordx4 v14, s[20:23], s17 offen lds
    s_add_u32 m0, m0, 1024
    s_add_u32 s17, s70, 1146880
    buffer_load_dwordx4 v15, s[20:23], s17 offen lds
    ds_read_b64_tr_b16 a[8:9], v18 offset:20480
    ds_read_b64_tr_b16 a[10:11], v18 offset:20992
    ds_read_b64_tr_b16 a[12:13], v19 offset:20480
    ds_read_b64_tr_b16 a[14:15], v19 offset:20992
    ds_read_b64_tr_b16 a[16:17], v20 offset:20480
    ds_read_b64_tr_b16 a[18:19], v20 offset:20992
    ds_read_b64_tr_b16 a[20:21], v21 offset:20480
    ds_read_b64_tr_b16 a[22:23], v21 offset:20992
    s_waitcnt lgkmcnt(0)
    s_waitcnt vmcnt(24)
    s_barrier
    s_add_u32 m0, s72, 20480
    s_add_u32 s17, s70, 1048576
    buffer_load_dwordx4 v12, s[24:27], s17 offen lds
    s_add_u32 m0, m0, 1024
    s_add_u32 s17, s70, 1081344
    buffer_load_dwordx4 v13, s[24:27], s17 offen lds
    s_add_u32 m0, m0, 1024
    s_add_u32 s17, s70, 1114112
    buffer_load_dwordx4 v14, s[24:27], s17 offen lds
    s_add_u32 m0, m0, 1024
    s_add_u32 s17, s70, 1146880
    buffer_load_dwordx4 v15, s[24:27], s17 offen lds
    ds_read_b64_tr_b16 a[120:121], v18 offset:24576
    ds_read_b64_tr_b16 a[122:123], v18 offset:25088
    ds_read_b64_tr_b16 a[124:125], v19 offset:24576
    ds_read_b64_tr_b16 a[126:127], v19 offset:25088
    ds_read_b64_tr_b16 a[128:129], v20 offset:24576
    ds_read_b64_tr_b16 a[130:131], v20 offset:25088
    ds_read_b64_tr_b16 a[132:133], v21 offset:24576
    ds_read_b64_tr_b16 a[134:135], v21 offset:25088
    s_waitcnt lgkmcnt(0)
    s_waitcnt vmcnt(24)
    s_barrier
    s_add_u32 m0, s72, 24576
    s_add_u32 s17, s70, 1048576
    buffer_load_dwordx4 v12, s[28:31], s17 offen lds
    s_add_u32 m0, m0, 1024
    s_add_u32 s17, s70, 1081344
    buffer_load_dwordx4 v13, s[28:31], s17 offen lds
    s_add_u32 m0, m0, 1024
    s_add_u32 s17, s70, 1114112
    buffer_load_dwordx4 v14, s[28:31], s17 offen lds
    s_add_u32 m0, m0, 1024
    s_add_u32 s17, s70, 1146880
    buffer_load_dwordx4 v15, s[28:31], s17 offen lds
    ds_read_b64_tr_b16 a[24:25], v18 offset:28672
    ds_read_b64_tr_b16 a[26:27], v18 offset:29184
    ds_read_b64_tr_b16 a[28:29], v19 offset:28672
    ds_read_b64_tr_b16 a[30:31], v19 offset:29184
    ds_read_b64_tr_b16 a[32:33], v20 offset:28672
    ds_read_b64_tr_b16 a[34:35], v20 offset:29184
    ds_read_b64_tr_b16 a[36:37], v21 offset:28672
    ds_read_b64_tr_b16 a[38:39], v21 offset:29184
    s_waitcnt lgkmcnt(0)
    s_waitcnt vmcnt(24)
    s_barrier
    ds_read_b64_tr_b16 a[136:137], v18 offset:0
    ds_read_b64_tr_b16 a[138:139], v18 offset:512
    ds_read_b64_tr_b16 a[140:141], v19 offset:0
    ds_read_b64_tr_b16 a[142:143], v19 offset:512
    ds_read_b64_tr_b16 a[144:145], v20 offset:0
    ds_read_b64_tr_b16 a[146:147], v20 offset:512
    ds_read_b64_tr_b16 a[148:149], v21 offset:0
    ds_read_b64_tr_b16 a[150:151], v21 offset:512
    s_waitcnt lgkmcnt(0)
    s_waitcnt vmcnt(20)
    s_barrier
    s_add_u32 m0, s72, 0
    s_add_u32 s17, s70, 0
    buffer_load_dwordx4 v12, s[28:31], s17 offen lds
    s_add_u32 m0, m0, 1024
    s_add_u32 s17, s70, 32768
    buffer_load_dwordx4 v13, s[28:31], s17 offen lds
    s_add_u32 m0, m0, 1024
    s_add_u32 s17, s70, 65536
    buffer_load_dwordx4 v14, s[28:31], s17 offen lds
    s_add_u32 m0, m0, 1024
    s_add_u32 s17, s70, 98304
    buffer_load_dwordx4 v15, s[28:31], s17 offen lds
    ds_read_b64_tr_b16 v[152:153], v18 offset:4096
    ds_read_b64_tr_b16 v[154:155], v18 offset:4608
    ds_read_b64_tr_b16 v[156:157], v19 offset:4096
    ds_read_b64_tr_b16 v[158:159], v19 offset:4608
    ds_read_b64_tr_b16 v[160:161], v20 offset:4096
    ds_read_b64_tr_b16 v[162:163], v20 offset:4608
    ds_read_b64_tr_b16 v[164:165], v21 offset:4096
    ds_read_b64_tr_b16 v[166:167], v21 offset:4608
    s_waitcnt lgkmcnt(0)
    s_waitcnt vmcnt(20)
    s_barrier
    s_add_u32 m0, s72, 4096
    s_add_u32 s17, s70, 262144
    buffer_load_dwordx4 v12, s[28:31], s17 offen lds
    s_add_u32 m0, m0, 1024
    s_add_u32 s17, s70, 294912
    buffer_load_dwordx4 v13, s[28:31], s17 offen lds
    s_add_u32 m0, m0, 1024
    s_add_u32 s17, s70, 327680
    buffer_load_dwordx4 v14, s[28:31], s17 offen lds
    s_add_u32 m0, m0, 1024
    s_add_u32 s17, s70, 360448
    buffer_load_dwordx4 v15, s[28:31], s17 offen lds
    ds_read_b64_tr_b16 a[40:41], v18 offset:8192
    ds_read_b64_tr_b16 a[42:43], v18 offset:8704
    ds_read_b64_tr_b16 a[44:45], v19 offset:8192
    ds_read_b64_tr_b16 a[46:47], v19 offset:8704
    ds_read_b64_tr_b16 a[48:49], v20 offset:8192
    ds_read_b64_tr_b16 a[50:51], v20 offset:8704
    ds_read_b64_tr_b16 a[52:53], v21 offset:8192
    ds_read_b64_tr_b16 a[54:55], v21 offset:8704
    s_waitcnt lgkmcnt(0)
    s_waitcnt vmcnt(20)
    s_barrier
    s_add_u32 m0, s72, 8192
    s_add_u32 s17, s70, 524288
    buffer_load_dwordx4 v12, s[20:23], s17 offen lds
    s_add_u32 m0, m0, 1024
    s_add_u32 s17, s70, 557056
    buffer_load_dwordx4 v13, s[20:23], s17 offen lds
    s_add_u32 m0, m0, 1024
    s_add_u32 s17, s70, 589824
    buffer_load_dwordx4 v14, s[20:23], s17 offen lds
    s_add_u32 m0, m0, 1024
    s_add_u32 s17, s70, 622592
    buffer_load_dwordx4 v15, s[20:23], s17 offen lds
    ds_read_b64_tr_b16 a[152:153], v18 offset:12288
    ds_read_b64_tr_b16 a[154:155], v18 offset:12800
    ds_read_b64_tr_b16 a[156:157], v19 offset:12288
    ds_read_b64_tr_b16 a[158:159], v19 offset:12800
    ds_read_b64_tr_b16 a[160:161], v20 offset:12288
    ds_read_b64_tr_b16 a[162:163], v20 offset:12800
    ds_read_b64_tr_b16 a[164:165], v21 offset:12288
    ds_read_b64_tr_b16 a[166:167], v21 offset:12800
    s_waitcnt lgkmcnt(0)
    s_waitcnt vmcnt(20)
    s_barrier
    s_add_u32 m0, s72, 12288
    s_add_u32 s17, s70, 786432
    buffer_load_dwordx4 v12, s[20:23], s17 offen lds
    s_add_u32 m0, m0, 1024
    s_add_u32 s17, s70, 819200
    buffer_load_dwordx4 v13, s[20:23], s17 offen lds
    s_add_u32 m0, m0, 1024
    s_add_u32 s17, s70, 851968
    buffer_load_dwordx4 v14, s[20:23], s17 offen lds
    s_add_u32 m0, m0, 1024
    s_add_u32 s17, s70, 884736
    buffer_load_dwordx4 v15, s[20:23], s17 offen lds
    ds_read_b64_tr_b16 v[168:169], v18 offset:16384
    ds_read_b64_tr_b16 v[170:171], v18 offset:16896
    ds_read_b64_tr_b16 v[172:173], v19 offset:16384
    ds_read_b64_tr_b16 v[174:175], v19 offset:16896
    ds_read_b64_tr_b16 v[176:177], v20 offset:16384
    ds_read_b64_tr_b16 v[178:179], v20 offset:16896
    ds_read_b64_tr_b16 v[180:181], v21 offset:16384
    ds_read_b64_tr_b16 v[182:183], v21 offset:16896
    s_waitcnt lgkmcnt(0)
    s_waitcnt vmcnt(20)
    s_barrier
    s_add_u32 m0, s72, 16384
    s_add_u32 s17, s71, 0
    buffer_load_dwordx4 v16, s[76:79], s17 offen lds
    s_add_u32 m0, m0, 1024
    s_add_u32 s17, s71, 18432
    buffer_load_dwordx4 v16, s[76:79], s17 offen lds
    s_add_u32 m0, m0, 1024
    s_add_u32 s17, s71, 36864
    buffer_load_dwordx4 v16, s[76:79], s17 offen lds
    s_add_u32 m0, m0, 1024
    s_add_u32 s17, s71, 55296
    buffer_load_dwordx4 v16, s[76:79], s17 offen lds
    ds_read_b64_tr_b16 a[56:57], v18 offset:20480
    ds_read_b64_tr_b16 a[58:59], v18 offset:20992
    ds_read_b64_tr_b16 a[60:61], v19 offset:20480
    ds_read_b64_tr_b16 a[62:63], v19 offset:20992
    ds_read_b64_tr_b16 a[64:65], v20 offset:20480
    ds_read_b64_tr_b16 a[66:67], v20 offset:20992
    ds_read_b64_tr_b16 a[68:69], v21 offset:20480
    ds_read_b64_tr_b16 a[70:71], v21 offset:20992
    s_waitcnt lgkmcnt(0)
    s_waitcnt vmcnt(20)
    s_barrier
    s_add_u32 m0, s72, 20480
    s_add_u32 s17, s71, 73728
    buffer_load_dwordx4 v16, s[76:79], s17 offen lds
    s_add_u32 m0, m0, 1024
    s_add_u32 s17, s71, 92160
    buffer_load_dwordx4 v16, s[76:79], s17 offen lds
    s_add_u32 m0, m0, 1024
    s_add_u32 s17, s71, 110592
    buffer_load_dwordx4 v16, s[76:79], s17 offen lds
    s_add_u32 m0, m0, 1024
    s_add_u32 s17, s71, 129024
    buffer_load_dwordx4 v16, s[76:79], s17 offen lds
    ds_read_b64_tr_b16 a[168:169], v18 offset:24576
    ds_read_b64_tr_b16 a[170:171], v18 offset:25088
    ds_read_b64_tr_b16 a[172:173], v19 offset:24576
    ds_read_b64_tr_b16 a[174:175], v19 offset:25088
    ds_read_b64_tr_b16 a[176:177], v20 offset:24576
    ds_read_b64_tr_b16 a[178:179], v20 offset:25088
    ds_read_b64_tr_b16 a[180:181], v21 offset:24576
    ds_read_b64_tr_b16 a[182:183], v21 offset:25088
    s_waitcnt lgkmcnt(0)
    s_waitcnt vmcnt(20)
    s_barrier
    s_add_u32 m0, s72, 24576
    s_add_u32 s17, s71, 64
    buffer_load_dwordx4 v16, s[76:79], s17 offen lds
    s_add_u32 m0, m0, 1024
    s_add_u32 s17, s71, 18496
    buffer_load_dwordx4 v16, s[76:79], s17 offen lds
    s_add_u32 m0, m0, 1024
    s_add_u32 s17, s71, 36928
    buffer_load_dwordx4 v16, s[76:79], s17 offen lds
    s_add_u32 m0, m0, 1024
    s_add_u32 s17, s71, 55360
    buffer_load_dwordx4 v16, s[76:79], s17 offen lds
    s_add_u32 m0, s72, 28672
    s_add_u32 s17, s71, 73792
    buffer_load_dwordx4 v16, s[76:79], s17 offen lds
    s_add_u32 m0, m0, 1024
    s_add_u32 s17, s71, 92224
    buffer_load_dwordx4 v16, s[76:79], s17 offen lds
    s_add_u32 m0, m0, 1024
    s_add_u32 s17, s71, 110656
    buffer_load_dwordx4 v16, s[76:79], s17 offen lds
    s_add_u32 m0, m0, 1024
    s_add_u32 s17, s71, 129088
    buffer_load_dwordx4 v16, s[76:79], s17 offen lds
    ds_read_b64_tr_b16 v[24:25], v18 offset:0
    ds_read_b64_tr_b16 v[26:27], v18 offset:512
    ds_read_b64_tr_b16 v[28:29], v19 offset:0
    ds_read_b64_tr_b16 v[30:31], v19 offset:512
    ds_read_b64_tr_b16 v[32:33], v20 offset:0
    ds_read_b64_tr_b16 v[34:35], v20 offset:512
    ds_read_b64_tr_b16 v[36:37], v21 offset:0
    ds_read_b64_tr_b16 v[38:39], v21 offset:512
    s_waitcnt lgkmcnt(0)
    s_barrier
    ds_write_b128 v8, v[24:27] offset:0
    ds_write_b128 v8, v[28:31] offset:1024
    ds_write_b128 v8, v[32:35] offset:2048
    ds_write_b128 v8, v[36:39] offset:3072
    s_waitcnt lgkmcnt(0)
    s_waitcnt vmcnt(24)
    s_barrier
    ds_read_b64_tr_b16 v[24:25], v18 offset:4096
    ds_read_b64_tr_b16 v[26:27], v18 offset:4608
    ds_read_b64_tr_b16 v[28:29], v19 offset:4096
    ds_read_b64_tr_b16 v[30:31], v19 offset:4608
    ds_read_b64_tr_b16 v[32:33], v20 offset:4096
    ds_read_b64_tr_b16 v[34:35], v20 offset:4608
    ds_read_b64_tr_b16 v[36:37], v21 offset:4096
    ds_read_b64_tr_b16 v[38:39], v21 offset:4608
    s_waitcnt lgkmcnt(0)
    s_barrier
    ds_write_b128 v8, v[24:27] offset:4096
    ds_write_b128 v8, v[28:31] offset:5120
    ds_write_b128 v8, v[32:35] offset:6144
    ds_write_b128 v8, v[36:39] offset:7168
    s_waitcnt lgkmcnt(0)
    s_waitcnt vmcnt(20)
    s_barrier
    ds_read_b64_tr_b16 v[24:25], v18 offset:8192
    ds_read_b64_tr_b16 v[26:27], v18 offset:8704
    ds_read_b64_tr_b16 v[28:29], v19 offset:8192
    ds_read_b64_tr_b16 v[30:31], v19 offset:8704
    ds_read_b64_tr_b16 v[32:33], v20 offset:8192
    ds_read_b64_tr_b16 v[34:35], v20 offset:8704
    ds_read_b64_tr_b16 v[36:37], v21 offset:8192
    ds_read_b64_tr_b16 v[38:39], v21 offset:8704
    s_waitcnt lgkmcnt(0)
    s_barrier
    ds_write_b128 v8, v[24:27] offset:8192
    ds_write_b128 v8, v[28:31] offset:9216
    ds_write_b128 v8, v[32:35] offset:10240
    ds_write_b128 v8, v[36:39] offset:11264
    s_waitcnt lgkmcnt(0)
    s_waitcnt vmcnt(16)
    s_barrier
    ds_read_b64_tr_b16 v[24:25], v18 offset:12288
    ds_read_b64_tr_b16 v[26:27], v18 offset:12800
    ds_read_b64_tr_b16 v[28:29], v19 offset:12288
    ds_read_b64_tr_b16 v[30:31], v19 offset:12800
    ds_read_b64_tr_b16 v[32:33], v20 offset:12288
    ds_read_b64_tr_b16 v[34:35], v20 offset:12800
    ds_read_b64_tr_b16 v[36:37], v21 offset:12288
    ds_read_b64_tr_b16 v[38:39], v21 offset:12800
    s_waitcnt lgkmcnt(0)
    s_barrier
    ds_write_b128 v8, v[24:27] offset:12288
    ds_write_b128 v8, v[28:31] offset:13312
    ds_write_b128 v8, v[32:35] offset:14336
    ds_write_b128 v8, v[36:39] offset:15360
    s_waitcnt lgkmcnt(0)
    s_barrier
    s_waitcnt vmcnt(12)
    ds_read_b64_tr_b16 a[184:185], v22 offset:16384
    ds_read_b64_tr_b16 a[186:187], v22 offset:16448
    ds_read_b64_tr_b16 a[188:189], v22 offset:18432
    ds_read_b64_tr_b16 a[190:191], v22 offset:18496
    ds_read_b64_tr_b16 a[200:201], v22 offset:16416
    ds_read_b64_tr_b16 a[202:203], v22 offset:16480
    ds_read_b64_tr_b16 a[204:205], v22 offset:18464
    ds_read_b64_tr_b16 a[206:207], v22 offset:18528
    s_waitcnt lgkmcnt(0)
    s_add_u32 m0, s72, 16384
    s_add_u32 s17, s71, 128
    buffer_load_dwordx4 v16, s[76:79], s17 offen lds
    s_add_u32 m0, m0, 1024
    s_add_u32 s17, s71, 18560
    buffer_load_dwordx4 v16, s[76:79], s17 offen lds
    s_add_u32 m0, m0, 1024
    s_add_u32 s17, s71, 36992
    buffer_load_dwordx4 v16, s[76:79], s17 offen lds
    s_add_u32 m0, m0, 1024
    s_add_u32 s17, s71, 55424
    buffer_load_dwordx4 v16, s[76:79], s17 offen lds
    s_waitcnt vmcnt(12)
    ds_read_b64_tr_b16 a[192:193], v22 offset:20480
    ds_read_b64_tr_b16 a[194:195], v22 offset:20544
    ds_read_b64_tr_b16 a[196:197], v22 offset:22528
    ds_read_b64_tr_b16 a[198:199], v22 offset:22592
    ds_read_b64_tr_b16 a[208:209], v22 offset:20512
    ds_read_b64_tr_b16 a[210:211], v22 offset:20576
    ds_read_b64_tr_b16 a[212:213], v22 offset:22560
    ds_read_b64_tr_b16 a[214:215], v22 offset:22624
    s_waitcnt lgkmcnt(0)
    s_add_u32 m0, s72, 20480
    s_add_u32 s17, s71, 73856
    buffer_load_dwordx4 v16, s[76:79], s17 offen lds
    s_add_u32 m0, m0, 1024
    s_add_u32 s17, s71, 92288
    buffer_load_dwordx4 v16, s[76:79], s17 offen lds
    s_add_u32 m0, m0, 1024
    s_add_u32 s17, s71, 110720
    buffer_load_dwordx4 v16, s[76:79], s17 offen lds
    s_add_u32 m0, m0, 1024
    s_add_u32 s17, s71, 129152
    buffer_load_dwordx4 v16, s[76:79], s17 offen lds
    s_waitcnt vmcnt(12)
    ds_read_b64_tr_b16 a[216:217], v22 offset:24576
    ds_read_b64_tr_b16 a[218:219], v22 offset:24640
    ds_read_b64_tr_b16 a[220:221], v22 offset:26624
    ds_read_b64_tr_b16 a[222:223], v22 offset:26688
    ds_read_b64_tr_b16 a[232:233], v22 offset:24608
    ds_read_b64_tr_b16 a[234:235], v22 offset:24672
    ds_read_b64_tr_b16 a[236:237], v22 offset:26656
    ds_read_b64_tr_b16 a[238:239], v22 offset:26720
    s_waitcnt lgkmcnt(0)
    s_add_u32 m0, s72, 24576
    s_add_u32 s17, s71, 192
    buffer_load_dwordx4 v16, s[76:79], s17 offen lds
    s_add_u32 m0, m0, 1024
    s_add_u32 s17, s71, 18624
    buffer_load_dwordx4 v16, s[76:79], s17 offen lds
    s_add_u32 m0, m0, 1024
    s_add_u32 s17, s71, 37056
    buffer_load_dwordx4 v16, s[76:79], s17 offen lds
    s_add_u32 m0, m0, 1024
    s_add_u32 s17, s71, 55488
    buffer_load_dwordx4 v16, s[76:79], s17 offen lds
    s_waitcnt vmcnt(12)
    ds_read_b64_tr_b16 a[224:225], v22 offset:28672
    ds_read_b64_tr_b16 a[226:227], v22 offset:28736
    ds_read_b64_tr_b16 a[228:229], v22 offset:30720
    ds_read_b64_tr_b16 a[230:231], v22 offset:30784
    ds_read_b64_tr_b16 a[240:241], v22 offset:28704
    ds_read_b64_tr_b16 a[242:243], v22 offset:28768
    ds_read_b64_tr_b16 a[244:245], v22 offset:30752
    ds_read_b64_tr_b16 a[246:247], v22 offset:30816
    s_waitcnt lgkmcnt(0)
    s_add_u32 m0, s72, 28672
    s_add_u32 s17, s71, 73920
    buffer_load_dwordx4 v16, s[76:79], s17 offen lds
    s_add_u32 m0, m0, 1024
    s_add_u32 s17, s71, 92352
    buffer_load_dwordx4 v16, s[76:79], s17 offen lds
    s_add_u32 m0, m0, 1024
    s_add_u32 s17, s71, 110784
    buffer_load_dwordx4 v16, s[76:79], s17 offen lds
    s_add_u32 m0, m0, 1024
    s_add_u32 s17, s71, 129216
    buffer_load_dwordx4 v16, s[76:79], s17 offen lds
    s_waitcnt vmcnt(63)
    ds_read_b64_tr_b16 a[248:249], v23 offset:32768
    ds_read_b64_tr_b16 a[250:251], v23 offset:32800
    ds_read_b64_tr_b16 a[252:253], v23 offset:33792
    ds_read_b64_tr_b16 a[254:255], v23 offset:33824
    s_waitcnt lgkmcnt(0)
    s_add_u32 m0, s72, 32768
    s_add_u32 s17, s71, 73984
    buffer_load_dwordx4 v17, s[76:79], s17 offen lds
    s_add_u32 m0, m0, 1024
    s_add_u32 s17, s71, 110848
    buffer_load_dwordx4 v17, s[76:79], s17 offen lds
    s_waitcnt vmcnt(14)
    ds_read_b64_tr_b16 v[24:25], v22 offset:16384
    ds_read_b64_tr_b16 v[26:27], v22 offset:16448
    ds_read_b64_tr_b16 v[28:29], v22 offset:18432
    ds_read_b64_tr_b16 v[30:31], v22 offset:18496
    ds_read_b64_tr_b16 v[32:33], v22 offset:16416
    ds_read_b64_tr_b16 v[34:35], v22 offset:16480
    ds_read_b64_tr_b16 v[36:37], v22 offset:18464
    ds_read_b64_tr_b16 v[38:39], v22 offset:18528
    s_waitcnt lgkmcnt(0)
    ds_write_b128 v8, v[24:27] offset:16384
    ds_write_b128 v8, v[28:31] offset:17408
    ds_write_b128 v8, v[32:35] offset:18432
    ds_write_b128 v8, v[36:39] offset:19456
    s_waitcnt lgkmcnt(0)
    s_waitcnt vmcnt(10)
    ds_read_b64_tr_b16 v[24:25], v22 offset:20480
    ds_read_b64_tr_b16 v[26:27], v22 offset:20544
    ds_read_b64_tr_b16 v[28:29], v22 offset:22528
    ds_read_b64_tr_b16 v[30:31], v22 offset:22592
    ds_read_b64_tr_b16 v[32:33], v22 offset:20512
    ds_read_b64_tr_b16 v[34:35], v22 offset:20576
    ds_read_b64_tr_b16 v[36:37], v22 offset:22560
    ds_read_b64_tr_b16 v[38:39], v22 offset:22624
    s_waitcnt lgkmcnt(0)
    ds_write_b128 v8, v[24:27] offset:20480
    ds_write_b128 v8, v[28:31] offset:21504
    ds_write_b128 v8, v[32:35] offset:22528
    ds_write_b128 v8, v[36:39] offset:23552
    s_waitcnt lgkmcnt(0)
    s_waitcnt vmcnt(6)
    ds_read_b64_tr_b16 v[24:25], v22 offset:24576
    ds_read_b64_tr_b16 v[26:27], v22 offset:24640
    ds_read_b64_tr_b16 v[28:29], v22 offset:26624
    ds_read_b64_tr_b16 v[30:31], v22 offset:26688
    ds_read_b64_tr_b16 v[32:33], v22 offset:24608
    ds_read_b64_tr_b16 v[34:35], v22 offset:24672
    ds_read_b64_tr_b16 v[36:37], v22 offset:26656
    ds_read_b64_tr_b16 v[38:39], v22 offset:26720
    s_waitcnt lgkmcnt(0)
    ds_write_b128 v8, v[24:27] offset:24576
    ds_write_b128 v8, v[28:31] offset:25600
    ds_write_b128 v8, v[32:35] offset:26624
    ds_write_b128 v8, v[36:39] offset:27648
    s_waitcnt lgkmcnt(0)
    s_waitcnt vmcnt(2)
    ds_read_b64_tr_b16 v[24:25], v22 offset:28672
    ds_read_b64_tr_b16 v[26:27], v22 offset:28736
    ds_read_b64_tr_b16 v[28:29], v22 offset:30720
    ds_read_b64_tr_b16 v[30:31], v22 offset:30784
    ds_read_b64_tr_b16 v[32:33], v22 offset:28704
    ds_read_b64_tr_b16 v[34:35], v22 offset:28768
    ds_read_b64_tr_b16 v[36:37], v22 offset:30752
    ds_read_b64_tr_b16 v[38:39], v22 offset:30816
    s_waitcnt lgkmcnt(0)
    ds_write_b128 v8, v[24:27] offset:28672
    ds_write_b128 v8, v[28:31] offset:29696
    ds_write_b128 v8, v[32:35] offset:30720
    ds_write_b128 v8, v[36:39] offset:31744
    s_waitcnt lgkmcnt(0)
    s_waitcnt vmcnt(0)
    ds_read_b64_tr_b16 v[24:25], v23 offset:32768
    ds_read_b64_tr_b16 v[26:27], v23 offset:32800
    ds_read_b64_tr_b16 v[28:29], v23 offset:33792
    ds_read_b64_tr_b16 v[30:31], v23 offset:33824
    s_waitcnt lgkmcnt(0)
    ds_write_b128 v8, v[24:27] offset:32768
    ds_write_b128 v8, v[28:31] offset:33792
    s_waitcnt lgkmcnt(0)
    v_bfe_u32 v9, v0, 4, 4
    v_mov_b32 v10, 0x3f80
    v_mov_b32 v16, 0x3f800000
    v_cmp_eq_u32 vcc, 0, v9
    v_cmp_eq_u32 s[48:49], 1, v9
    s_nop 0
    v_cndmask_b32 v12, 0, v10, vcc
    v_cndmask_b32 v12, v12, v16, s[48:49]
    v_cmp_eq_u32 vcc, 2, v9
    v_cmp_eq_u32 s[48:49], 3, v9
    s_nop 0
    v_cndmask_b32 v13, 0, v10, vcc
    v_cndmask_b32 v13, v13, v16, s[48:49]
    v_cmp_eq_u32 vcc, 4, v9
    v_cmp_eq_u32 s[48:49], 5, v9
    s_nop 0
    v_cndmask_b32 v14, 0, v10, vcc
    v_cndmask_b32 v14, v14, v16, s[48:49]
    v_cmp_eq_u32 vcc, 6, v9
    v_cmp_eq_u32 s[48:49], 7, v9
    s_nop 0
    v_cndmask_b32 v15, 0, v10, vcc
    v_cndmask_b32 v15, v15, v16, s[48:49]
    v_add_u32 v9, 162560, v0
    ds_write_b128 v9, v[12:15]
    s_waitcnt lgkmcnt(0)
    s_mov_b64 exec, 0xff
    v_lshrrev_b32 v14, 2, v0
    v_lshlrev_b32 v12, 5, v14
    v_and_b32 v12, 128, v12
    v_lshrrev_b32 v13, 1, v14
    v_and_or_b32 v12, v13, 12, v12
    s_mov_b32 s16, 0
L_pure:
    global_load_dword v13, v12, s[12:13] sc1
    s_add_u32 s16, s16, 1
    s_cmp_gt_u32 s16, 100000
    s_cbranch_scc1 Lr_abort
    s_mov_b32 s6, 0
    s_waitcnt vmcnt(0)
    v_readlane_b32 s7, v13, 0
    s_nop 0
    s_add_u32 s6, s6, s7
    v_readlane_b32 s7, v13, 1
    s_nop 0
    s_add_u32 s6, s6, s7
    v_readlane_b32 s7, v13, 2
    s_nop 0
    s_add_u32 s6, s6, s7
    v_readlane_b32 s7, v13, 3
    s_nop 0
    s_add_u32 s6, s6, s7
    v_readlane_b32 s7, v13, 4
    s_nop 0
    s_add_u32 s6, s6, s7
    v_readlane_b32 s7, v13, 5
    s_nop 0
    s_add_u32 s6, s6, s7
    v_readlane_b32 s7, v13, 6
    s_nop 0
    s_add_u32 s6, s6, s7
    v_readlane_b32 s7, v13, 7
    s_nop 0
    s_add_u32 s6, s6, s7
    v_readlane_b32 s7, v13, s32
    s_nop 0
    s_cmp_ge_u32 s7, 32
    s_cselect_b32 s51, 1, 0
    s_cselect_b32 s6, 256, s6
    s_cmp_lt_u32 s6, 256
    s_cbranch_scc1 L_pure
    s_mov_b64 exec, -1
    s_lshl_b32 s6, s32, 2
    s_add_u32 s6, s6, 192
    s_cmp_lg_u32 s14, 0
    s_cbranch_scc1 L_team_d
    v_mov_b32 v12, s6
    s_mov_b32 s16, 0
L_team:
    global_load_dword v13, v12, s[12:13] sc1
    s_add_u32 s16, s16, 1
    s_cmp_gt_u32 s16, 100000
    s_cbranch_scc1 Lr_abort
    s_waitcnt vmcnt(0)
    v_cmp_gt_u32 vcc, 32, v13
    s_nop 0
    s_cbranch_vccz L_team_d
    s_sleep 8
    s_branch L_team
L_team_d:
    s_barrier
    s_cmp_lg_u32 s14, 0
    s_cbranch_scc1 L_rpoola_d
    v_mov_b32 v12, 40
    s_mov_b32 s16, 0
L_rpoola:
    global_load_dword v13, v12, s[12:13] sc1
    s_add_u32 s16, s16, 1
    s_cmp_gt_u32 s16, 100000
    s_cbranch_scc1 Lr_abort
    s_waitcnt vmcnt(0)
    v_cmp_gt_u32 vcc, 128, v13
    s_nop 0
    s_cbranch_vccz L_rpoola_d
    s_sleep 8
    s_branch L_rpoola
L_rpoola_d:
    s_barrier
    s_cmp_eq_u32 s32, 0
    s_cbranch_scc1 L_rpool_skip
    s_cmp_lg_u32 s14, 0
    s_cbranch_scc1 L_rpool_d
    v_mov_b32 v12, 160
    s_mov_b32 s16, 0
L_rpool:
    global_load_dword v13, v12, s[12:13] sc1
    s_add_u32 s16, s16, 1
    s_cmp_gt_u32 s16, 100000
    s_cbranch_scc1 Lr_abort
    s_waitcnt vmcnt(0)
    v_cmp_gt_u32 vcc, 64, v13
    s_nop 0
    s_cbranch_vccz L_rpool_d
    s_sleep 8
    s_branch L_rpool
L_rpool_d:
    s_barrier
L_rpool_skip:
    s_barrier
    s_cmp_eq_u32 s51, 0
    s_cbranch_scc1 L_slow
    s_cmp_lg_u32 s14, 0
    s_cbranch_scc1 L_w1_1
    s_mov_b32 s16, 0
    s_add_u32 s17, s66, 128
    v_lshrrev_b32 v10, 2, v0
    v_and_b32 v9, 16, v10
    v_lshlrev_b32 v9, 3, v9
    v_and_or_b32 v10, v10, 12, v9
Lr0f_fw_10:
    buffer_load_dword v9, v10, s[8:11], s17 offen sc1
    s_add_u32 s16, s16, 1
    s_cmp_gt_u32 s16, 100000
    s_cbranch_scc1 Lr_abort
    s_waitcnt vmcnt(0)
    v_cmp_eq_u32 vcc, 0, v9
    s_nop 0
    s_cbranch_vccnz Lr0f_fw_10
    s_mov_b32 m0, 15104
    s_nop 0
    buffer_load_dwordx4 v0, s[8:11], s41 offen offset:0 lds
    buffer_load_dwordx4 v0, s[8:11], s41 offen offset:1024 lds
    s_add_u32 s41, s41, 262144
    s_add_u32 s68, s68, 4278452224
    s_waitcnt vmcnt(0)
    ds_read_b128 v[56:59], v8 offset:0
    ds_read_b128 v[60:63], v8 offset:1024
    ds_read_b128 v[64:67], v8 offset:2048
    ds_read_b128 v[68:71], v8 offset:3072
    v_mov_b64 v[12:13], 0
    v_mov_b64 v[14:15], 0
    v_mov_b64 v[16:17], 0
    v_mov_b64 v[18:19], 0
    v_mov_b64 v[20:21], 0
    v_mov_b64 v[22:23], 0
    v_mov_b64 v[24:25], 0
    v_mov_b64 v[26:27], 0
    v_mov_b64 v[28:29], 0
    v_mov_b64 v[30:31], 0
    v_mov_b64 v[32:33], 0
    v_mov_b64 v[34:35], 0
    buffer_load_dwordx4 v[36:39], v0, s[8:11], s34 offen sc1
    s_waitcnt vmcnt(0) lgkmcnt(0)
Lr0f_step:
    s_mov_b32 s16, 0
Lr0f_alp:
    s_waitcnt vmcnt(2)
    v_max3_u32 v10, v36, v37, v38
    v_max_u32 v10, v10, v39
    v_cmp_eq_u32 vcc, -1, v10
    s_nop 0
    s_cbranch_vccz Lr0f_aok
    buffer_load_dwordx4 v[36:39], v0, s[8:11], s34 offen sc1
    s_add_u32 s16, s16, 1
    s_cmp_gt_u32 s16, 100000
    s_cbranch_scc1 Lr_abort
    s_branch Lr0f_alp
Lr0f_aok:
    ds_write_b128 v0, v[36:39] offset:6912
    v_smfmac_f32_16x16x64_bf16 v[12:15], v[36:39], v[72:79], v1
    v_smfmac_f32_16x16x64_bf16 v[16:19], v[36:39], v[80:87], v1
    v_smfmac_f32_16x16x64_bf16 v[20:23], v[36:39], v[184:191], v1
    s_waitcnt lgkmcnt(0)
    s_barrier
    ds_read_b128 v[48:51], v0 offset:7936
    ds_read_b128 v[52:55], v0 offset:8960
    v_smfmac_f32_16x16x64_bf16 v[28:31], v[36:39], v[56:63], v1
    ds_read_b128 v[56:59], v8 offset:4096
    ds_read_b128 v[60:63], v8 offset:5120
    s_add_u32 s17, s34, 4096
    buffer_load_dwordx4 v[40:43], v0, s[8:11], s17 offen sc1
    v_smfmac_f32_16x16x64_bf16 v[24:27], v[36:39], v[192:199], v1
    v_smfmac_f32_16x16x64_bf16 v[32:35], v[36:39], v[64:71], v1
    ds_read_b128 v[64:67], v8 offset:6144
    ds_read_b128 v[68:71], v8 offset:7168
    s_waitcnt vmcnt(1)
    ds_read_b128 v[36:39], v0 offset:9984
    s_waitcnt lgkmcnt(6)
    v_smfmac_f32_16x16x64_bf16 v[28:31], v[48:51], a[72:79], v1
    v_smfmac_f32_16x16x64_bf16 v[12:15], v[48:51], v[88:95], v1
    buffer_load_dwordx4 v[44:47], v0, s[8:11], s35 offen sc1
    v_smfmac_f32_16x16x64_bf16 v[16:19], v[48:51], v[96:103], v1
    v_smfmac_f32_16x16x64_bf16 v[32:35], v[48:51], a[80:87], v1
    v_smfmac_f32_16x16x64_bf16 v[20:23], v[48:51], v[200:207], v1
    v_smfmac_f32_16x16x64_bf16 v[24:27], v[48:51], v[208:215], v1
    s_waitcnt lgkmcnt(3)
    v_smfmac_f32_16x16x64_bf16 v[28:31], v[52:55], v[56:63], v1
    ds_read_b128 v[56:59], v8 offset:8192
    ds_read_b128 v[60:63], v8 offset:9216
    v_smfmac_f32_16x16x64_bf16 v[12:15], v[52:55], v[104:111], v1
    v_smfmac_f32_16x16x64_bf16 v[16:19], v[52:55], v[112:119], v1
    s_waitcnt lgkmcnt(3)
    v_smfmac_f32_16x16x64_bf16 v[32:35], v[52:55], v[64:71], v1
    ds_read_b128 v[64:67], v8 offset:10240
    ds_read_b128 v[68:71], v8 offset:11264
    v_smfmac_f32_16x16x64_bf16 v[20:23], v[52:55], v[216:223], v1
    v_smfmac_f32_16x16x64_bf16 v[24:27], v[52:55], v[224:231], v1
    s_waitcnt lgkmcnt(4)
    v_smfmac_f32_16x16x64_bf16 v[28:31], v[36:39], a[88:95], v1
    v_smfmac_f32_16x16x64_bf16 v[12:15], v[36:39], v[120:127], v1
    v_smfmac_f32_16x16x64_bf16 v[16:19], v[36:39], v[128:135], v1
    v_smfmac_f32_16x16x64_bf16 v[32:35], v[36:39], a[96:103], v1
    v_smfmac_f32_16x16x64_bf16 v[20:23], v[36:39], v[232:239], v1
    v_smfmac_f32_16x16x64_bf16 v[24:27], v[36:39], v[240:247], v1
    s_waitcnt vmcnt(1)
    v_max3_u32 v10, v40, v41, v42
    v_max_u32 v10, v10, v43
    v_cmp_eq_u32 vcc, -1, v10
    s_nop 0
    s_cbranch_vccnz Lr0f_pb_re
Lr0f_pb_ok:
    ds_write_b128 v0, v[40:43] offset:11008
    s_waitcnt lgkmcnt(3)
    v_smfmac_f32_16x16x64_bf16 v[12:15], v[40:43], v[56:63], v1
    ds_read_b128 v[56:59], v8 offset:12288
    ds_read_b128 v[60:63], v8 offset:13312
    v_smfmac_f32_16x16x64_bf16 v[20:23], v[40:43], v[248:255], v1
    s_waitcnt lgkmcnt(3)
    v_smfmac_f32_16x16x64_bf16 v[16:19], v[40:43], v[64:71], v1
    ds_read_b128 v[64:67], v8 offset:14336
    ds_read_b128 v[68:71], v8 offset:15360
    v_smfmac_f32_16x16x64_bf16 v[24:27], v[40:43], a[0:7], v1
    s_waitcnt lgkmcnt(4)
    s_barrier
    ds_read_b128 v[48:51], v0 offset:13056
    ds_read_b128 v[52:55], v0 offset:12032
    ds_read_b128 v[36:39], v0 offset:14080
    v_smfmac_f32_16x16x64_bf16 v[28:31], v[40:43], a[104:111], v1
    v_smfmac_f32_16x16x64_bf16 v[32:35], v[40:43], a[112:119], v1
    s_waitcnt lgkmcnt(2)
    v_smfmac_f32_16x16x64_bf16 v[12:15], v[48:51], v[56:63], v1
    v_smfmac_f32_16x16x64_bf16 v[16:19], v[48:51], v[64:71], v1
    s_waitcnt lgkmcnt(1)
    v_smfmac_f32_16x16x64_bf16 v[12:15], v[52:55], v[136:143], v1
    v_smfmac_f32_16x16x64_bf16 v[16:19], v[52:55], v[144:151], v1
    s_waitcnt lgkmcnt(0)
    v_smfmac_f32_16x16x64_bf16 v[12:15], v[36:39], v[152:159], v1
    v_smfmac_f32_16x16x64_bf16 v[16:19], v[36:39], v[160:167], v1
    s_waitcnt vmcnt(0)
    v_max3_u32 v10, v44, v45, v46
    v_max_u32 v10, v10, v47
    v_cmp_eq_u32 vcc, -1, v10
    s_nop 0
    s_cbranch_vccnz Lr0f_pc_re
Lr0f_pc_ok:
    v_smfmac_f32_16x16x64_bf16 v[12:15], v[44:47], v[168:175], v1
    v_smfmac_f32_16x16x64_bf16 v[16:19], v[44:47], v[176:183], v1
    v_smfmac_f32_16x16x64_bf16 v[20:23], v[48:51], a[24:31], v1
    buffer_load_dwordx4 v[64:67], v0, s[8:11], s42 offen
    v_smfmac_f32_16x16x64_bf16 v[24:27], v[48:51], a[32:39], v1
    v_smfmac_f32_16x16x64_bf16 v[20:23], v[52:55], a[8:15], v1
    v_add_f32 v12, v12, v14
    v_smfmac_f32_16x16x64_bf16 v[24:27], v[52:55], a[16:23], v1
    v_add_f32 v16, v16, v18
    v_smfmac_f32_16x16x64_bf16 v[20:23], v[36:39], a[40:47], v1
    v_add_f32 v13, v13, v15
    buffer_load_dwordx4 v[68:71], v0, s[8:11], s42 offen offset:1024
    v_smfmac_f32_16x16x64_bf16 v[24:27], v[36:39], a[48:55], v1
    v_add_f32 v17, v17, v19
    v_smfmac_f32_16x16x64_bf16 v[20:23], v[44:47], a[56:63], v1
    v_cvt_pk_bf16_f32 v14, v12, v16
    ds_read_b128 v[56:59], v0 offset:15104
    v_smfmac_f32_16x16x64_bf16 v[24:27], v[44:47], a[64:71], v1
    v_cvt_pk_bf16_f32 v15, v13, v17
    ds_read_b128 v[60:63], v0 offset:16128
    ds_write_b32 v2, v14 offset:576
    ds_write_b32 v2, v15 offset:864
    v_smfmac_f32_16x16x64_bf16 v[28:31], v[48:51], a[136:143], v1
    v_smfmac_f32_16x16x64_bf16 v[32:35], v[48:51], a[144:151], v1
    v_add_f32 v20, v20, v22
    v_add_f32 v24, v24, v26
    v_add_f32 v21, v21, v23
    v_add_f32 v25, v25, v27
    v_cvt_pk_bf16_f32 v22, v20, v24
    v_cvt_pk_bf16_f32 v23, v21, v25
    ds_write_b32 v2, v22 offset:0
    ds_write_b32 v2, v23 offset:288
    v_smfmac_f32_16x16x64_bf16 v[28:31], v[52:55], a[120:127], v1
    v_smfmac_f32_16x16x64_bf16 v[32:35], v[52:55], a[128:135], v1
    s_waitcnt lgkmcnt(0)
    s_barrier
    ds_read_b128 v[40:43], v3 offset:0
    ds_read_b128 v[48:51], v3 offset:64
    ds_read_b128 v[20:23], v3 offset:128
    ds_read_b128 v[52:55], v3 offset:192
    v_smfmac_f32_16x16x64_bf16 v[28:31], v[36:39], a[152:159], v1
    v_smfmac_f32_16x16x64_bf16 v[32:35], v[36:39], a[160:167], v1
    ds_read_b128 v[36:39], v0 offset:17152
    v_lshlrev_b32 v9, 3, v0
    buffer_load_dword v11, v9, s[8:11], s68 offen
    v_smfmac_f32_16x16x64_bf16 v[28:31], v[44:47], a[168:175], v1
    v_smfmac_f32_16x16x64_bf16 v[32:35], v[44:47], a[176:183], v1
    ds_read_b128 v[44:47], v0 offset:18176
    s_waitcnt lgkmcnt(5)
    v_mfma_f32_16x16x32_bf16 v[12:15], v[56:59], v[40:43], 0
    v_mfma_f32_16x16x32_bf16 v[16:19], v[60:63], v[40:43], 0
    v_mfma_f32_16x16x32_bf16 v[24:27], v[40:43], v[40:43], 0
    ds_read_b128 v[56:59], v0 offset:19200
    ds_read_b128 v[60:63], v0 offset:20224
    s_waitcnt lgkmcnt(3)
    v_mfma_f32_16x16x32_bf16 v[12:15], v[36:39], v[48:51], v[12:15]
    v_lshrrev_b32 v10, 1, v0
    v_lshrrev_b32 v9, 9, v0
    s_waitcnt lgkmcnt(2)
    v_mfma_f32_16x16x32_bf16 v[16:19], v[44:47], v[48:51], v[16:19]
    v_lshl_add_u32 v9, v9, 5, v10
    v_add_f32 v28, v28, v30
    v_mfma_f32_16x16x32_bf16 v[24:27], v[48:51], v[48:51], v[24:27]
    v_add_f32 v32, v32, v34
    v_add_f32 v29, v29, v31
    ds_read_b128 v[36:39], v0 offset:21248
    ds_read_b128 v[44:47], v0 offset:22272
    s_waitcnt lgkmcnt(3)
    v_mfma_f32_16x16x32_bf16 v[12:15], v[56:59], v[20:23], v[12:15]
    v_add_f32 v33, v33, v35
    v_cvt_pk_bf16_f32 v30, v28, v29
    s_waitcnt lgkmcnt(2)
    v_mfma_f32_16x16x32_bf16 v[16:19], v[60:63], v[20:23], v[16:19]
    v_cvt_pk_bf16_f32 v31, v32, v33
    ds_read_b64 v[34:35], v9 offset:0
    v_mfma_f32_16x16x32_bf16 v[24:27], v[20:23], v[20:23], v[24:27]
    s_add_u32 s17, s43, 2048
    buffer_store_dwordx2 v[30:31], v10, s[8:11], s17 offen sc1
    s_waitcnt lgkmcnt(2)
    v_mfma_f32_16x16x32_bf16 v[12:15], v[36:39], v[52:55], v[12:15]
    s_waitcnt lgkmcnt(1)
    v_mfma_f32_16x16x32_bf16 v[16:19], v[44:47], v[52:55], v[16:19]
    v_mfma_f32_16x16x32_bf16 v[24:27], v[52:55], v[52:55], v[24:27]
    s_add_u32 s17, s43, 0
    s_waitcnt lgkmcnt(0)
    buffer_store_dwordx2 v[34:35], v10, s[8:11], s17 offen sc1
    s_cmp_eq_u32 s33, 63
    s_cbranch_scc1 Lr0f_last
    ds_read_b128 v[56:59], v8 offset:16384
    ds_read_b128 v[60:63], v8 offset:17408
    v_mov_b64 v[20:21], s[52:53]
    v_mov_b64 v[22:23], s[52:53]
    v_mov_b32 v41, 0
    v_mov_b32 v42, 0
    v_max3_f32 v9, v12, v13, v14
    v_max3_f32 v9, v9, v15, v16
    v_max3_f32 v9, v9, v17, v18
    v_max3_f32 v9, v9, v19, v24
    v_max_f32 v9, v9, v25
    v_mov_b32 v10, v9
    v_mov_b64 v[32:33], 0
    v_mov_b64 v[34:35], 0
    v_permlane32_swap_b32 v9, v10
    v_max_f32 v9, v9, v10
    v_mov_b32 v10, v9
    s_nop 1
    v_permlane16_swap_b32 v9, v10
    v_max_f32 v9, v9, v10
    v_mul_f32 v28, s44, v9
    v_fma_f32 v12, v12, s44, -v28
    v_fma_f32 v13, v13, s44, -v28
    v_fma_f32 v14, v14, s44, -v28
    v_fma_f32 v15, v15, s44, -v28
    v_exp_f32 v12, v12
    v_exp_f32 v13, v13
    v_fma_f32 v16, v16, s44, -v28
    v_fma_f32 v17, v17, s44, -v28
    v_exp_f32 v14, v14
    v_exp_f32 v15, v15
    v_cvt_pk_bf16_f32 v36, v12, v13
    v_fma_f32 v18, v18, s44, -v28
    v_fma_f32 v19, v19, s44, -v28
    v_exp_f32 v16, v16
    v_exp_f32 v17, v17
    v_cvt_pk_bf16_f32 v37, v14, v15
    v_fma_f32 v24, v24, s44, -v28
    v_fma_f32 v25, v25, s44, -v28
    v_exp_f32 v18, v18
    v_exp_f32 v19, v19
    v_cvt_pk_bf16_f32 v38, v16, v17
    v_exp_f32 v24, v24
    v_exp_f32 v25, v25
    v_cvt_pk_bf16_f32 v39, v18, v19
    v_cvt_pk_bf16_f32 v40, v24, v25
    v_cvt_pk_bf16_f32 v43, v24, v25
    v_mfma_f32_16x16x32_bf16 v[52:55], v[20:23], v[36:39], 0
    v_mov_b64 v[12:13], 0
    v_mov_b64 v[14:15], 0
    s_waitcnt vmcnt(4)
    v_mfma_f32_16x16x32_bf16 v[44:47], v[64:67], v[36:39], 0
    v_mov_b64 v[24:25], 0
    v_mov_b64 v[26:27], 0
    s_waitcnt vmcnt(3)
    v_mfma_f32_16x16x32_bf16 v[48:51], v[68:71], v[36:39], 0
    ds_read_b128 v[64:67], v8 offset:20480
    ds_read_b128 v[68:71], v8 offset:21504
    v_mfma_f32_16x16x16_bf16 v[52:55], v[20:21], v[40:41], v[52:55]
    v_mfma_f32_16x16x16_bf16 v[44:47], v[30:31], v[40:41], v[44:47]
    v_mov_b64 v[20:21], 0
    v_mov_b64 v[22:23], 0
    v_mfma_f32_16x16x16_bf16 v[48:51], v[30:31], v[42:43], v[48:51]
    v_mov_b64 v[36:37], 0
    v_mov_b64 v[38:39], 0
    v_mov_b64 v[40:41], 0
    v_mov_b64 v[42:43], 0
    v_rcp_f32 v9, v52
    v_mov_b64 v[52:53], 0
    v_mov_b64 v[54:55], 0
    v_mul_f32 v44, v9, v44
    v_mul_f32 v48, v9, v48
    v_cvt_pk_bf16_f32 v16, v44, v48
    v_mul_f32 v45, v9, v45
    v_mul_f32 v49, v9, v49
    v_cvt_pk_bf16_f32 v17, v45, v49
    v_mul_f32 v46, v9, v46
    v_mul_f32 v50, v9, v50
    v_cvt_pk_bf16_f32 v18, v46, v50
    v_mul_f32 v47, v9, v47
    v_mul_f32 v51, v9, v51
    v_cvt_pk_bf16_f32 v19, v47, v51
    ds_write_b128 v5, v[16:19]
    v_mov_b64 v[28:29], 0
    v_mov_b64 v[30:31], 0
    s_waitcnt lgkmcnt(0)
    s_barrier
    ds_read_b128 v[44:47], v4 offset:0
    ds_read_b128 v[48:51], v4 offset:128
    v_mov_b64 v[16:17], 0
    v_mov_b64 v[18:19], 0
    buffer_load_dwordx4 v0, s[8:11], s41 offen offset:0 lds
    buffer_load_dwordx4 v0, s[8:11], s41 offen offset:1024 lds
    s_waitcnt lgkmcnt(1)
    v_smfmac_f32_16x16x64_bf16 v[12:15], v[44:47], a[184:191], v1
    s_waitcnt lgkmcnt(0)
    v_smfmac_f32_16x16x64_bf16 v[12:15], v[48:51], a[192:199], v1
    v_smfmac_f32_16x16x64_bf16 v[24:27], v[44:47], a[200:207], v1
    v_smfmac_f32_16x16x64_bf16 v[24:27], v[48:51], a[208:215], v1
    v_add_f32 v12, v12, v14
    v_smfmac_f32_16x16x64_bf16 v[20:23], v[44:47], a[216:223], v1
    v_add_f32 v13, v13, v15
    v_smfmac_f32_16x16x64_bf16 v[20:23], v[48:51], a[224:231], v1
    v_cvt_pk_bf16_f32 v12, v12, v13
    v_smfmac_f32_16x16x64_bf16 v[16:19], v[44:47], a[232:239], v1
    v_add_f32 v24, v24, v26
    v_smfmac_f32_16x16x64_bf16 v[16:19], v[48:51], a[240:247], v1
    v_add_f32 v25, v25, v27
    v_smfmac_f32_16x16x64_bf16 v[36:39], v[44:47], v[56:63], v1
    v_cvt_pk_bf16_f32 v13, v24, v25
    v_smfmac_f32_16x16x64_bf16 v[36:39], v[48:51], v[64:71], v1
    v_add_f32 v20, v20, v22
    v_add_f32 v21, v21, v23
    v_cvt_pk_bf16_f32 v14, v20, v21
    v_add_f32 v16, v16, v18
    v_add_f32 v17, v17, v19
    v_cvt_pk_bf16_f32 v15, v16, v17
    v_and_or_b32 v15, v15, -2, s40
    buffer_store_dwordx4 v[12:15], v0, s[8:11], s38 offen
    s_nop 0
    ds_read_b128 v[12:15], v8 offset:18432
    ds_read_b128 v[16:19], v8 offset:19456
    ds_read_b128 v[20:23], v8 offset:22528
    ds_read_b128 v[24:27], v8 offset:23552
    ds_read_b128 v[56:59], v8 offset:24576
    ds_read_b128 v[60:63], v8 offset:25600
    ds_read_b128 v[64:67], v8 offset:28672
    ds_read_b128 v[68:71], v8 offset:29696
    s_waitcnt lgkmcnt(6)
    v_smfmac_f32_16x16x64_bf16 v[40:43], v[44:47], v[12:19], v1
    ds_read_b128 v[12:15], v8 offset:26624
    ds_read_b128 v[16:19], v8 offset:27648
    s_waitcnt lgkmcnt(6)
    v_smfmac_f32_16x16x64_bf16 v[40:43], v[48:51], v[20:27], v1
    ds_read_b128 v[20:23], v8 offset:30720
    ds_read_b128 v[24:27], v8 offset:31744
    s_waitcnt lgkmcnt(6)
    v_smfmac_f32_16x16x64_bf16 v[52:55], v[44:47], v[56:63], v1
    ds_read_b128 v[56:59], v8 offset:32768
    ds_read_b128 v[60:63], v8 offset:33792
    s_waitcnt lgkmcnt(6)
    v_smfmac_f32_16x16x64_bf16 v[52:55], v[48:51], v[64:71], v1
    s_waitcnt lgkmcnt(4)
    v_smfmac_f32_16x16x64_bf16 v[32:35], v[44:47], v[12:19], v1
    s_waitcnt lgkmcnt(2)
    v_smfmac_f32_16x16x64_bf16 v[32:35], v[48:51], v[20:27], v1
    v_smfmac_f32_16x16x64_bf16 v[28:31], v[44:47], a[248:255], v1
    s_waitcnt lgkmcnt(0)
    v_smfmac_f32_16x16x64_bf16 v[28:31], v[48:51], v[56:63], v1
    buffer_load_dwordx4 v[12:15], v6, s[8:11], s62 offen sc1
    buffer_load_dwordx4 v[16:19], v6, s[8:11], s63 offen sc1
    buffer_load_dwordx4 v[20:23], v6, s[8:11], s64 offen sc1
    buffer_load_dwordx4 v[24:27], v6, s[8:11], s65 offen sc1
    v_add_f32 v36, v36, v38
    v_add_f32 v37, v37, v39
    v_cvt_pk_bf16_f32 v36, v36, v37
    v_add_f32 v40, v40, v42
    v_add_f32 v41, v41, v43
    v_cvt_pk_bf16_f32 v37, v40, v41
    v_add_f32 v52, v52, v54
    v_add_f32 v53, v53, v55
    v_cvt_pk_bf16_f32 v38, v52, v53
    v_add_f32 v32, v32, v34
    v_add_f32 v33, v33, v35
    v_cvt_pk_bf16_f32 v39, v32, v33
    v_and_or_b32 v39, v39, -2, s40
    s_add_u32 s17, s38, 4096
    buffer_store_dwordx4 v[36:39], v0, s[8:11], s17 offen
    v_add_f32 v28, v28, v30
    v_add_f32 v29, v29, v31
    v_cvt_pk_bf16_f32 v28, v28, v29
    v_and_or_b32 v28, v28, -2, s40
    v_lshrrev_b32 v9, 2, v0
    buffer_store_dword v28, v9, s[8:11], s39 offen
    v_add_u32 v10, 162560, v0
    ds_read_b128 v[64:67], v10
    s_nop 9
    buffer_load_dwordx4 v[40:43], v6, s[8:11], s62 offen sc1
    buffer_load_dwordx4 v[44:47], v6, s[8:11], s63 offen sc1
    buffer_load_dwordx4 v[48:51], v6, s[8:11], s64 offen sc1
    buffer_load_dwordx4 v[52:55], v6, s[8:11], s65 offen sc1
    s_add_u32 s33, s33, 1
    s_add_u32 s42, s42, 262144
    s_add_u32 s41, s41, 262144
    s_add_u32 s43, s43, 131072
    s_add_u32 s68, s68, 262144
    s_add_u32 s66, s66, 22528
    ds_read_b128 v[56:59], v8 offset:0
    ds_read_b128 v[60:63], v8 offset:1024
    s_waitcnt lgkmcnt(2)
    s_waitcnt vmcnt(9)
    v_mfma_f32_16x16x32_bf16 v[68:71], v[12:15], v[64:67], 0
    v_and_b32 v10, 1, v15
    v_cmp_ne_u32 s[54:55], s40, v10
    s_waitcnt vmcnt(8)
    v_mfma_f32_16x16x32_bf16 v[68:71], v[16:19], v[64:67], v[68:71]
    v_and_b32 v10, 1, v19
    v_cmp_ne_u32 s[56:57], s40, v10
    s_waitcnt vmcnt(7)
    v_mfma_f32_16x16x32_bf16 v[68:71], v[20:23], v[64:67], v[68:71]
    v_and_b32 v10, 1, v23
    v_cmp_ne_u32 s[58:59], s40, v10
    s_waitcnt vmcnt(6)
    v_mfma_f32_16x16x32_bf16 v[68:71], v[24:27], v[64:67], v[68:71]
    v_and_b32 v10, 1, v27
    v_cmp_ne_u32 s[60:61], s40, v10
    s_or_b64 vcc, s[54:55], s[56:57]
    s_or_b64 vcc, vcc, s[58:59]
    s_or_b64 vcc, vcc, s[60:61]
    s_cbranch_scc0 Lr0f_red
    s_mov_b32 s16, 0
Lr0f_p1:
    buffer_load_dwordx4 v[12:15], v6, s[8:11], s62 offen sc1
    buffer_load_dwordx4 v[16:19], v6, s[8:11], s63 offen sc1
    buffer_load_dwordx4 v[20:23], v6, s[8:11], s64 offen sc1
    buffer_load_dwordx4 v[24:27], v6, s[8:11], s65 offen sc1
    s_waitcnt vmcnt(7)
    v_mfma_f32_16x16x32_bf16 v[68:71], v[40:43], v[64:67], 0
    v_and_b32 v10, 1, v43
    v_cmp_ne_u32 s[54:55], s40, v10
    s_waitcnt vmcnt(6)
    v_mfma_f32_16x16x32_bf16 v[68:71], v[44:47], v[64:67], v[68:71]
    v_and_b32 v10, 1, v47
    v_cmp_ne_u32 s[56:57], s40, v10
    s_waitcnt vmcnt(5)
    v_mfma_f32_16x16x32_bf16 v[68:71], v[48:51], v[64:67], v[68:71]
    v_and_b32 v10, 1, v51
    v_cmp_ne_u32 s[58:59], s40, v10
    s_waitcnt vmcnt(4)
    v_mfma_f32_16x16x32_bf16 v[68:71], v[52:55], v[64:67], v[68:71]
    v_and_b32 v10, 1, v55
    v_cmp_ne_u32 s[60:61], s40, v10
    s_or_b64 vcc, s[54:55], s[56:57]
    s_or_b64 vcc, vcc, s[58:59]
    s_or_b64 vcc, vcc, s[60:61]
    s_cbranch_scc0 Lr0f_red
    buffer_load_dwordx4 v[40:43], v6, s[8:11], s62 offen sc1
    buffer_load_dwordx4 v[44:47], v6, s[8:11], s63 offen sc1
    buffer_load_dwordx4 v[48:51], v6, s[8:11], s64 offen sc1
    buffer_load_dwordx4 v[52:55], v6, s[8:11], s65 offen sc1
    s_add_u32 s16, s16, 1
    s_cmp_gt_u32 s16, 100000
    s_cbranch_scc1 Lr_abort
    s_waitcnt vmcnt(7)
    v_mfma_f32_16x16x32_bf16 v[68:71], v[12:15], v[64:67], 0
    v_and_b32 v10, 1, v15
    v_cmp_ne_u32 s[54:55], s40, v10
    s_waitcnt vmcnt(6)
    v_mfma_f32_16x16x32_bf16 v[68:71], v[16:19], v[64:67], v[68:71]
    v_and_b32 v10, 1, v19
    v_cmp_ne_u32 s[56:57], s40, v10
    s_waitcnt vmcnt(5)
    v_mfma_f32_16x16x32_bf16 v[68:71], v[20:23], v[64:67], v[68:71]
    v_and_b32 v10, 1, v23
    v_cmp_ne_u32 s[58:59], s40, v10
    s_waitcnt vmcnt(4)
    v_mfma_f32_16x16x32_bf16 v[68:71], v[24:27], v[64:67], v[68:71]
    v_and_b32 v10, 1, v27
    v_cmp_ne_u32 s[60:61], s40, v10
    s_or_b64 vcc, s[54:55], s[56:57]
    s_or_b64 vcc, vcc, s[58:59]
    s_or_b64 vcc, vcc, s[60:61]
    s_cbranch_scc1 Lr0f_p1
Lr0f_red:
    s_nop 1
    v_permlane16_swap_b32 v68, v70
    v_permlane16_swap_b32 v69, v71
    s_mov_b64 exec, s[46:47]
    v_add_f32 v68, v68, v70
    v_add_f32 v69, v69, v71
    v_cvt_pk_bf16_f32 v68, v68, v69
    v_min_u32 v68, s50, v68
    buffer_store_dword v68, v7, s[8:11], s36 offen
    v_mov_b32 v69, -1
    buffer_store_dword v69, v7, s[8:11], s37 offen
    s_mov_b64 exec, -1
    s_xor_b32 s34, s34, 16384
    s_xor_b32 s35, s35, 16384
    s_xor_b32 s40, s40, 1
    s_xor_b32 s36, s36, 16384
    s_xor_b32 s37, s37, 16384
    s_nop 15
    s_nop 3
    buffer_load_dwordx4 v[36:39], v0, s[8:11], s34 offen sc1
    s_waitcnt vmcnt(3)
    ds_read_b128 v[64:67], v8 offset:2048
    ds_read_b128 v[68:71], v8 offset:3072
    v_mov_b64 v[12:13], 0
    v_mov_b64 v[14:15], 0
    v_mov_b64 v[16:17], 0
    v_mov_b64 v[18:19], 0
    v_mov_b64 v[20:21], 0
    v_mov_b64 v[22:23], 0
    v_mov_b64 v[24:25], 0
    v_mov_b64 v[26:27], 0
    v_mov_b64 v[28:29], 0
    v_mov_b64 v[30:31], 0
    v_mov_b64 v[32:33], 0
    v_mov_b64 v[34:35], 0
    s_nop 9
    buffer_load_dwordx4 v[36:39], v0, s[8:11], s34 offen sc1
    s_nop 15
    s_nop 8
    buffer_load_dwordx4 v[36:39], v0, s[8:11], s34 offen sc1
    s_waitcnt lgkmcnt(0)
    s_branch Lr0f_step
Lr0f_pb_re:
    s_mov_b32 s16, 0
Lr0f_pb_lp:
    s_add_u32 s17, s34, 4096
    buffer_load_dwordx4 v[40:43], v0, s[8:11], s17 offen sc1
    s_add_u32 s16, s16, 1
    s_cmp_gt_u32 s16, 100000
    s_cbranch_scc1 Lr_abort
    s_waitcnt vmcnt(0)
    v_max3_u32 v10, v40, v41, v42
    v_max_u32 v10, v10, v43
    v_cmp_eq_u32 vcc, -1, v10
    s_nop 0
    s_cbranch_vccnz Lr0f_pb_lp
    s_branch Lr0f_pb_ok
Lr0f_pc_re:
    s_mov_b32 s16, 0
Lr0f_pc_lp:
    buffer_load_dwordx4 v[44:47], v0, s[8:11], s35 offen sc1
    s_add_u32 s16, s16, 1
    s_cmp_gt_u32 s16, 100000
    s_cbranch_scc1 Lr_abort
    s_waitcnt vmcnt(0)
    v_max3_u32 v10, v44, v45, v46
    v_max_u32 v10, v10, v47
    v_cmp_eq_u32 vcc, -1, v10
    s_nop 0
    s_cbranch_vccnz Lr0f_pc_lp
    s_branch Lr0f_pc_ok
Lr0f_last:
    s_waitcnt vmcnt(0) lgkmcnt(0)
    s_barrier
    s_branch Lr_exit
L_w1_1:
    s_cmp_lg_u32 s14, 1
    s_cbranch_scc1 L_w2_1
    s_mov_b32 s16, 0
    s_add_u32 s17, s66, 128
    v_lshrrev_b32 v10, 2, v0
    v_and_b32 v9, 16, v10
    v_lshlrev_b32 v9, 3, v9
    v_and_or_b32 v10, v10, 12, v9
Lr1f_fw_11:
    buffer_load_dword v9, v10, s[8:11], s17 offen sc1
    s_add_u32 s16, s16, 1
    s_cmp_gt_u32 s16, 100000
    s_cbranch_scc1 Lr_abort
    s_waitcnt vmcnt(0)
    v_cmp_eq_u32 vcc, 0, v9
    s_nop 0
    s_cbranch_vccnz Lr1f_fw_11
    s_lshl_b32 s67, s32, 5
    s_add_u32 s67, s67, s15
    s_lshl_b32 s67, s67, 12
    s_add_u32 s67, s67, 3145728
    s_mov_b32 m0, 17152
    s_nop 0
    buffer_load_dwordx4 v0, s[8:11], s41 offen offset:0 lds
    buffer_load_dwordx4 v0, s[8:11], s41 offen offset:1024 lds
    s_add_u32 s41, s41, 262144
    s_add_u32 s68, s68, 262144
    s_waitcnt vmcnt(0)
    ds_read_b128 v[56:59], v8 offset:4096
    ds_read_b128 v[60:63], v8 offset:5120
    ds_read_b128 v[64:67], v8 offset:6144
    ds_read_b128 v[68:71], v8 offset:7168
    v_mov_b64 v[12:13], 0
    v_mov_b64 v[14:15], 0
    v_mov_b64 v[16:17], 0
    v_mov_b64 v[18:19], 0
    v_mov_b64 v[20:21], 0
    v_mov_b64 v[22:23], 0
    v_mov_b64 v[24:25], 0
    v_mov_b64 v[26:27], 0
    v_mov_b64 v[28:29], 0
    v_mov_b64 v[30:31], 0
    v_mov_b64 v[32:33], 0
    v_mov_b64 v[34:35], 0
    buffer_load_dwordx4 v[36:39], v0, s[8:11], s34 offen sc1
    s_waitcnt vmcnt(0) lgkmcnt(0)
Lr1f_step:
    s_waitcnt vmcnt(3)
    v_max3_u32 v10, v36, v37, v38
    v_max_u32 v10, v10, v39
    v_cmp_eq_u32 vcc, -1, v10
    s_nop 0
    s_cbranch_vccz Lr1f_aok
    buffer_load_dwordx4 v[36:39], v0, s[8:11], s34 offen sc1
    s_nop 15
    s_nop 8
    buffer_load_dwordx4 v[36:39], v0, s[8:11], s34 offen sc1
    s_mov_b32 s16, 0
Lr1f_alp:
    s_waitcnt vmcnt(2)
    v_max3_u32 v10, v36, v37, v38
    v_max_u32 v10, v10, v39
    v_cmp_eq_u32 vcc, -1, v10
    s_nop 0
    s_cbranch_vccz Lr1f_aok
    buffer_load_dwordx4 v[36:39], v0, s[8:11], s34 offen sc1
    s_add_u32 s16, s16, 1
    s_cmp_gt_u32 s16, 100000
    s_cbranch_scc1 Lr_abort
    s_branch Lr1f_alp
Lr1f_aok:
    ds_write_b128 v0, v[36:39] offset:7936
    v_smfmac_f32_16x16x64_bf16 v[12:15], v[36:39], v[88:95], v1
    v_smfmac_f32_16x16x64_bf16 v[16:19], v[36:39], v[96:103], v1
    v_smfmac_f32_16x16x64_bf16 v[20:23], v[36:39], v[200:207], v1
    s_waitcnt lgkmcnt(0)
    s_barrier
    ds_read_b128 v[48:51], v0 offset:8960
    ds_read_b128 v[52:55], v0 offset:9984
    v_smfmac_f32_16x16x64_bf16 v[28:31], v[36:39], a[72:79], v1
    v_smfmac_f32_16x16x64_bf16 v[24:27], v[36:39], v[208:215], v1
    s_add_u32 s17, s34, 4096
    buffer_load_dwordx4 v[40:43], v0, s[8:11], s17 offen sc1
    v_smfmac_f32_16x16x64_bf16 v[32:35], v[36:39], a[80:87], v1
    s_waitcnt vmcnt(1)
    ds_read_b128 v[36:39], v0 offset:6912
    s_waitcnt lgkmcnt(2)
    v_smfmac_f32_16x16x64_bf16 v[28:31], v[48:51], v[56:63], v1
    ds_read_b128 v[56:59], v8 offset:0
    ds_read_b128 v[60:63], v8 offset:1024
    v_smfmac_f32_16x16x64_bf16 v[12:15], v[48:51], v[104:111], v1
    v_smfmac_f32_16x16x64_bf16 v[16:19], v[48:51], v[112:119], v1
    buffer_load_dwordx4 v[44:47], v0, s[8:11], s35 offen sc1
    v_smfmac_f32_16x16x64_bf16 v[32:35], v[48:51], v[64:71], v1
    ds_read_b128 v[64:67], v8 offset:2048
    ds_read_b128 v[68:71], v8 offset:3072
    v_smfmac_f32_16x16x64_bf16 v[20:23], v[48:51], v[216:223], v1
    v_smfmac_f32_16x16x64_bf16 v[24:27], v[48:51], v[224:231], v1
    s_waitcnt lgkmcnt(5)
    v_smfmac_f32_16x16x64_bf16 v[28:31], v[52:55], a[88:95], v1
    v_smfmac_f32_16x16x64_bf16 v[12:15], v[52:55], v[120:127], v1
    v_smfmac_f32_16x16x64_bf16 v[16:19], v[52:55], v[128:135], v1
    v_smfmac_f32_16x16x64_bf16 v[32:35], v[52:55], a[96:103], v1
    v_smfmac_f32_16x16x64_bf16 v[20:23], v[52:55], v[232:239], v1
    v_smfmac_f32_16x16x64_bf16 v[24:27], v[52:55], v[240:247], v1
    s_waitcnt lgkmcnt(2)
    v_smfmac_f32_16x16x64_bf16 v[28:31], v[36:39], v[56:63], v1
    ds_read_b128 v[56:59], v8 offset:12288
    ds_read_b128 v[60:63], v8 offset:13312
    v_smfmac_f32_16x16x64_bf16 v[12:15], v[36:39], v[72:79], v1
    v_smfmac_f32_16x16x64_bf16 v[16:19], v[36:39], v[80:87], v1
    s_waitcnt lgkmcnt(2)
    v_smfmac_f32_16x16x64_bf16 v[32:35], v[36:39], v[64:71], v1
    ds_read_b128 v[64:67], v8 offset:14336
    ds_read_b128 v[68:71], v8 offset:15360
    v_smfmac_f32_16x16x64_bf16 v[20:23], v[36:39], v[184:191], v1
    v_smfmac_f32_16x16x64_bf16 v[24:27], v[36:39], v[192:199], v1
    s_waitcnt vmcnt(1)
    v_max3_u32 v10, v40, v41, v42
    v_max_u32 v10, v10, v43
    v_cmp_eq_u32 vcc, -1, v10
    s_nop 0
    s_cbranch_vccnz Lr1f_pb_re
Lr1f_pb_ok:
    ds_write_b128 v0, v[40:43] offset:12032
    v_mov_b32 v9, 1
    v_mov_b32 v10, 0
    s_mov_b64 exec, 1
    buffer_store_dword v9, v10, s[8:11], s67 offen offset:384 sc1
    s_mov_b64 exec, -1
    v_smfmac_f32_16x16x64_bf16 v[12:15], v[40:43], v[136:143], v1
    v_smfmac_f32_16x16x64_bf16 v[20:23], v[40:43], a[8:15], v1
    v_smfmac_f32_16x16x64_bf16 v[16:19], v[40:43], v[144:151], v1
    v_smfmac_f32_16x16x64_bf16 v[24:27], v[40:43], a[16:23], v1
    s_waitcnt lgkmcnt(0)
    s_barrier
    ds_read_b128 v[48:51], v0 offset:13056
    ds_read_b128 v[52:55], v0 offset:14080
    ds_read_b128 v[36:39], v0 offset:11008
    v_smfmac_f32_16x16x64_bf16 v[28:31], v[40:43], a[120:127], v1
    v_smfmac_f32_16x16x64_bf16 v[32:35], v[40:43], a[128:135], v1
    s_waitcnt lgkmcnt(2)
    v_smfmac_f32_16x16x64_bf16 v[12:15], v[48:51], v[56:63], v1
    ds_read_b128 v[56:59], v8 offset:8192
    ds_read_b128 v[60:63], v8 offset:9216
    v_smfmac_f32_16x16x64_bf16 v[16:19], v[48:51], v[64:71], v1
    ds_read_b128 v[64:67], v8 offset:10240
    ds_read_b128 v[68:71], v8 offset:11264
    s_waitcnt lgkmcnt(5)
    v_smfmac_f32_16x16x64_bf16 v[12:15], v[52:55], v[152:159], v1
    v_smfmac_f32_16x16x64_bf16 v[16:19], v[52:55], v[160:167], v1
    s_waitcnt vmcnt(1)
    v_max3_u32 v10, v44, v45, v46
    v_max_u32 v10, v10, v47
    v_cmp_eq_u32 vcc, -1, v10
    s_nop 0
    s_cbranch_vccnz Lr1f_pc_re
Lr1f_pc_ok:
    v_smfmac_f32_16x16x64_bf16 v[12:15], v[44:47], v[168:175], v1
    v_smfmac_f32_16x16x64_bf16 v[16:19], v[44:47], v[176:183], v1
    s_waitcnt lgkmcnt(2)
    v_smfmac_f32_16x16x64_bf16 v[12:15], v[36:39], v[56:63], v1
    s_waitcnt lgkmcnt(0)
    v_smfmac_f32_16x16x64_bf16 v[16:19], v[36:39], v[64:71], v1
    v_smfmac_f32_16x16x64_bf16 v[20:23], v[48:51], a[24:31], v1
    v_smfmac_f32_16x16x64_bf16 v[24:27], v[48:51], a[32:39], v1
    buffer_load_dwordx4 v[64:67], v0, s[8:11], s42 offen
    v_smfmac_f32_16x16x64_bf16 v[20:23], v[52:55], a[40:47], v1
    v_add_f32 v12, v12, v14
    v_smfmac_f32_16x16x64_bf16 v[24:27], v[52:55], a[48:55], v1
    v_add_f32 v16, v16, v18
    v_smfmac_f32_16x16x64_bf16 v[20:23], v[36:39], v[248:255], v1
    v_add_f32 v13, v13, v15
    v_smfmac_f32_16x16x64_bf16 v[24:27], v[36:39], a[0:7], v1
    v_add_f32 v17, v17, v19
    buffer_load_dwordx4 v[68:71], v0, s[8:11], s42 offen offset:1024
    v_smfmac_f32_16x16x64_bf16 v[20:23], v[44:47], a[56:63], v1
    v_cvt_pk_bf16_f32 v14, v12, v16
    ds_read_b128 v[56:59], v0 offset:15104
    v_smfmac_f32_16x16x64_bf16 v[24:27], v[44:47], a[64:71], v1
    v_cvt_pk_bf16_f32 v15, v13, v17
    ds_read_b128 v[60:63], v0 offset:16128
    ds_write_b32 v2, v14 offset:576
    ds_write_b32 v2, v15 offset:864
    v_smfmac_f32_16x16x64_bf16 v[28:31], v[48:51], a[136:143], v1
    v_smfmac_f32_16x16x64_bf16 v[32:35], v[48:51], a[144:151], v1
    v_add_f32 v20, v20, v22
    v_add_f32 v24, v24, v26
    v_add_f32 v21, v21, v23
    v_add_f32 v25, v25, v27
    v_cvt_pk_bf16_f32 v22, v20, v24
    v_cvt_pk_bf16_f32 v23, v21, v25
    ds_write_b32 v2, v22 offset:0
    ds_write_b32 v2, v23 offset:288
    v_smfmac_f32_16x16x64_bf16 v[28:31], v[52:55], a[152:159], v1
    v_smfmac_f32_16x16x64_bf16 v[32:35], v[52:55], a[160:167], v1
    s_waitcnt lgkmcnt(0)
    s_barrier
    ds_read_b128 v[40:43], v3 offset:0
    ds_read_b128 v[48:51], v3 offset:64
    ds_read_b128 v[20:23], v3 offset:128
    ds_read_b128 v[52:55], v3 offset:192
    v_smfmac_f32_16x16x64_bf16 v[28:31], v[36:39], a[104:111], v1
    v_smfmac_f32_16x16x64_bf16 v[32:35], v[36:39], a[112:119], v1
    ds_read_b128 v[36:39], v0 offset:17152
    v_smfmac_f32_16x16x64_bf16 v[28:31], v[44:47], a[168:175], v1
    v_smfmac_f32_16x16x64_bf16 v[32:35], v[44:47], a[176:183], v1
    ds_read_b128 v[44:47], v0 offset:18176
    s_waitcnt lgkmcnt(5)
    v_mfma_f32_16x16x32_bf16 v[12:15], v[56:59], v[40:43], 0
    v_mfma_f32_16x16x32_bf16 v[16:19], v[60:63], v[40:43], 0
    v_mfma_f32_16x16x32_bf16 v[24:27], v[40:43], v[40:43], 0
    ds_read_b128 v[56:59], v0 offset:19200
    ds_read_b128 v[60:63], v0 offset:20224
    s_waitcnt lgkmcnt(3)
    v_mfma_f32_16x16x32_bf16 v[12:15], v[36:39], v[48:51], v[12:15]
    v_lshrrev_b32 v10, 1, v0
    v_lshrrev_b32 v9, 9, v0
    s_waitcnt lgkmcnt(2)
    v_mfma_f32_16x16x32_bf16 v[16:19], v[44:47], v[48:51], v[16:19]
    v_lshl_add_u32 v9, v9, 5, v10
    v_add_f32 v28, v28, v30
    v_mfma_f32_16x16x32_bf16 v[24:27], v[48:51], v[48:51], v[24:27]
    v_add_f32 v32, v32, v34
    v_add_f32 v29, v29, v31
    ds_read_b128 v[36:39], v0 offset:21248
    ds_read_b128 v[44:47], v0 offset:22272
    s_waitcnt lgkmcnt(3)
    v_mfma_f32_16x16x32_bf16 v[12:15], v[56:59], v[20:23], v[12:15]
    v_add_f32 v33, v33, v35
    v_cvt_pk_bf16_f32 v30, v28, v29
    s_waitcnt lgkmcnt(2)
    v_mfma_f32_16x16x32_bf16 v[16:19], v[60:63], v[20:23], v[16:19]
    v_cvt_pk_bf16_f32 v31, v32, v33
    ds_read_b64 v[34:35], v9 offset:1152
    v_mfma_f32_16x16x32_bf16 v[24:27], v[20:23], v[20:23], v[24:27]
    s_add_u32 s17, s43, 2560
    buffer_store_dwordx2 v[30:31], v10, s[8:11], s17 offen sc1
    s_waitcnt lgkmcnt(2)
    v_mfma_f32_16x16x32_bf16 v[12:15], v[36:39], v[52:55], v[12:15]
    s_waitcnt lgkmcnt(1)
    v_mfma_f32_16x16x32_bf16 v[16:19], v[44:47], v[52:55], v[16:19]
    v_mfma_f32_16x16x32_bf16 v[24:27], v[52:55], v[52:55], v[24:27]
    s_add_u32 s17, s43, 512
    s_waitcnt lgkmcnt(0)
    buffer_store_dwordx2 v[34:35], v10, s[8:11], s17 offen sc1
    s_cmp_eq_u32 s33, 63
    s_cbranch_scc1 Lr1f_last
    ds_read_b128 v[56:59], v8 offset:16384
    ds_read_b128 v[60:63], v8 offset:17408
    v_mov_b64 v[20:21], s[52:53]
    v_mov_b64 v[22:23], s[52:53]
    v_mov_b32 v41, 0
    v_mov_b32 v42, 0
    v_max3_f32 v9, v12, v13, v14
    v_max3_f32 v9, v9, v15, v16
    v_max3_f32 v9, v9, v17, v18
    v_max3_f32 v9, v9, v19, v24
    v_max_f32 v9, v9, v25
    v_mov_b32 v10, v9
    v_mov_b64 v[32:33], 0
    v_mov_b64 v[34:35], 0
    v_permlane32_swap_b32 v9, v10
    v_max_f32 v9, v9, v10
    v_mov_b32 v10, v9
    s_nop 1
    v_permlane16_swap_b32 v9, v10
    v_max_f32 v9, v9, v10
    v_mul_f32 v28, s44, v9
    v_fma_f32 v12, v12, s44, -v28
    v_fma_f32 v13, v13, s44, -v28
    v_fma_f32 v14, v14, s44, -v28
    v_fma_f32 v15, v15, s44, -v28
    v_exp_f32 v12, v12
    v_exp_f32 v13, v13
    v_fma_f32 v16, v16, s44, -v28
    v_fma_f32 v17, v17, s44, -v28
    v_exp_f32 v14, v14
    v_exp_f32 v15, v15
    v_cvt_pk_bf16_f32 v36, v12, v13
    v_fma_f32 v18, v18, s44, -v28
    v_fma_f32 v19, v19, s44, -v28
    v_exp_f32 v16, v16
    v_exp_f32 v17, v17
    v_cvt_pk_bf16_f32 v37, v14, v15
    v_fma_f32 v24, v24, s44, -v28
    v_fma_f32 v25, v25, s44, -v28
    v_exp_f32 v18, v18
    v_exp_f32 v19, v19
    v_cvt_pk_bf16_f32 v38, v16, v17
    v_exp_f32 v24, v24
    v_exp_f32 v25, v25
    v_cvt_pk_bf16_f32 v39, v18, v19
    v_cvt_pk_bf16_f32 v40, v24, v25
    v_cvt_pk_bf16_f32 v43, v24, v25
    v_mfma_f32_16x16x32_bf16 v[52:55], v[20:23], v[36:39], 0
    v_mov_b64 v[12:13], 0
    v_mov_b64 v[14:15], 0
    s_waitcnt vmcnt(3)
    v_mfma_f32_16x16x32_bf16 v[44:47], v[64:67], v[36:39], 0
    v_mov_b64 v[24:25], 0
    v_mov_b64 v[26:27], 0
    s_waitcnt vmcnt(2)
    v_mfma_f32_16x16x32_bf16 v[48:51], v[68:71], v[36:39], 0
    ds_read_b128 v[64:67], v8 offset:20480
    ds_read_b128 v[68:71], v8 offset:21504
    v_mfma_f32_16x16x16_bf16 v[52:55], v[20:21], v[40:41], v[52:55]
    v_mfma_f32_16x16x16_bf16 v[44:47], v[30:31], v[40:41], v[44:47]
    v_mov_b64 v[20:21], 0
    v_mov_b64 v[22:23], 0
    v_mfma_f32_16x16x16_bf16 v[48:51], v[30:31], v[42:43], v[48:51]
    v_mov_b64 v[36:37], 0
    v_mov_b64 v[38:39], 0
    v_mov_b64 v[40:41], 0
    v_mov_b64 v[42:43], 0
    v_rcp_f32 v9, v52
    v_mov_b64 v[52:53], 0
    v_mov_b64 v[54:55], 0
    v_mul_f32 v44, v9, v44
    v_mul_f32 v48, v9, v48
    v_cvt_pk_bf16_f32 v16, v44, v48
    v_mul_f32 v45, v9, v45
    v_mul_f32 v49, v9, v49
    v_cvt_pk_bf16_f32 v17, v45, v49
    v_mul_f32 v46, v9, v46
    v_mul_f32 v50, v9, v50
    v_cvt_pk_bf16_f32 v18, v46, v50
    v_mul_f32 v47, v9, v47
    v_mul_f32 v51, v9, v51
    v_cvt_pk_bf16_f32 v19, v47, v51
    ds_write_b128 v5, v[16:19]
    v_mov_b64 v[28:29], 0
    v_mov_b64 v[30:31], 0
    s_waitcnt lgkmcnt(0)
    s_barrier
    ds_read_b128 v[44:47], v4 offset:0
    ds_read_b128 v[48:51], v4 offset:128
    v_mov_b64 v[16:17], 0
    v_mov_b64 v[18:19], 0
    buffer_load_dwordx4 v0, s[8:11], s41 offen offset:0 lds
    buffer_load_dwordx4 v0, s[8:11], s41 offen offset:1024 lds
    s_waitcnt lgkmcnt(1)
    v_smfmac_f32_16x16x64_bf16 v[12:15], v[44:47], a[184:191], v1
    s_waitcnt lgkmcnt(0)
    v_smfmac_f32_16x16x64_bf16 v[12:15], v[48:51], a[192:199], v1
    v_smfmac_f32_16x16x64_bf16 v[24:27], v[44:47], a[200:207], v1
    v_smfmac_f32_16x16x64_bf16 v[24:27], v[48:51], a[208:215], v1
    v_add_f32 v12, v12, v14
    v_smfmac_f32_16x16x64_bf16 v[20:23], v[44:47], a[216:223], v1
    v_add_f32 v13, v13, v15
    v_smfmac_f32_16x16x64_bf16 v[20:23], v[48:51], a[224:231], v1
    v_cvt_pk_bf16_f32 v12, v12, v13
    v_smfmac_f32_16x16x64_bf16 v[16:19], v[44:47], a[232:239], v1
    v_add_f32 v24, v24, v26
    v_smfmac_f32_16x16x64_bf16 v[16:19], v[48:51], a[240:247], v1
    v_add_f32 v25, v25, v27
    v_smfmac_f32_16x16x64_bf16 v[36:39], v[44:47], v[56:63], v1
    v_cvt_pk_bf16_f32 v13, v24, v25
    v_smfmac_f32_16x16x64_bf16 v[36:39], v[48:51], v[64:71], v1
    v_add_f32 v20, v20, v22
    v_add_f32 v21, v21, v23
    v_cvt_pk_bf16_f32 v14, v20, v21
    v_add_f32 v16, v16, v18
    v_add_f32 v17, v17, v19
    v_cvt_pk_bf16_f32 v15, v16, v17
    v_and_or_b32 v15, v15, -2, s40
    buffer_store_dwordx4 v[12:15], v0, s[8:11], s38 offen
    s_nop 0
    ds_read_b128 v[12:15], v8 offset:18432
    ds_read_b128 v[16:19], v8 offset:19456
    ds_read_b128 v[20:23], v8 offset:22528
    ds_read_b128 v[24:27], v8 offset:23552
    ds_read_b128 v[56:59], v8 offset:24576
    ds_read_b128 v[60:63], v8 offset:25600
    ds_read_b128 v[64:67], v8 offset:28672
    ds_read_b128 v[68:71], v8 offset:29696
    s_waitcnt lgkmcnt(6)
    v_smfmac_f32_16x16x64_bf16 v[40:43], v[44:47], v[12:19], v1
    ds_read_b128 v[12:15], v8 offset:26624
    ds_read_b128 v[16:19], v8 offset:27648
    s_waitcnt lgkmcnt(6)
    v_smfmac_f32_16x16x64_bf16 v[40:43], v[48:51], v[20:27], v1
    ds_read_b128 v[20:23], v8 offset:30720
    ds_read_b128 v[24:27], v8 offset:31744
    s_waitcnt lgkmcnt(6)
    v_smfmac_f32_16x16x64_bf16 v[52:55], v[44:47], v[56:63], v1
    ds_read_b128 v[56:59], v8 offset:32768
    ds_read_b128 v[60:63], v8 offset:33792
    s_waitcnt lgkmcnt(6)
    v_smfmac_f32_16x16x64_bf16 v[52:55], v[48:51], v[64:71], v1
    s_waitcnt lgkmcnt(4)
    v_smfmac_f32_16x16x64_bf16 v[32:35], v[44:47], v[12:19], v1
    s_waitcnt lgkmcnt(2)
    v_smfmac_f32_16x16x64_bf16 v[32:35], v[48:51], v[20:27], v1
    v_smfmac_f32_16x16x64_bf16 v[28:31], v[44:47], a[248:255], v1
    s_waitcnt lgkmcnt(0)
    v_smfmac_f32_16x16x64_bf16 v[28:31], v[48:51], v[56:63], v1
    v_add_f32 v36, v36, v38
    v_add_f32 v37, v37, v39
    v_cvt_pk_bf16_f32 v36, v36, v37
    v_add_f32 v40, v40, v42
    v_add_f32 v41, v41, v43
    v_cvt_pk_bf16_f32 v37, v40, v41
    v_add_f32 v52, v52, v54
    v_add_f32 v53, v53, v55
    v_cvt_pk_bf16_f32 v38, v52, v53
    v_add_f32 v32, v32, v34
    v_add_f32 v33, v33, v35
    v_cvt_pk_bf16_f32 v39, v32, v33
    v_and_or_b32 v39, v39, -2, s40
    s_add_u32 s17, s38, 4096
    buffer_store_dwordx4 v[36:39], v0, s[8:11], s17 offen
    v_add_f32 v28, v28, v30
    v_add_f32 v29, v29, v31
    v_cvt_pk_bf16_f32 v28, v28, v29
    v_and_or_b32 v28, v28, -2, s40
    v_lshrrev_b32 v9, 2, v0
    buffer_store_dword v28, v9, s[8:11], s39 offen
    v_add_u32 v10, 162560, v0
    ds_read_b128 v[64:67], v10
    s_add_u32 s33, s33, 1
    s_add_u32 s42, s42, 262144
    s_add_u32 s41, s41, 262144
    s_add_u32 s43, s43, 131072
    s_mov_b32 s67, s66
    s_add_u32 s68, s68, 262144
    s_add_u32 s66, s66, 22528
    ds_read_b128 v[56:59], v8 offset:4096
    ds_read_b128 v[60:63], v8 offset:5120
    v_mov_b64 v[12:13], 0
    v_mov_b64 v[14:15], 0
    v_mov_b64 v[16:17], 0
    v_mov_b64 v[18:19], 0
    v_mov_b64 v[20:21], 0
    v_mov_b64 v[22:23], 0
    v_mov_b64 v[24:25], 0
    v_mov_b64 v[26:27], 0
    v_mov_b64 v[28:29], 0
    v_mov_b64 v[30:31], 0
    v_mov_b64 v[32:33], 0
    v_mov_b64 v[34:35], 0
    s_nop 15
    s_nop 15
    s_nop 15
    s_nop 11
    buffer_load_dwordx4 v[40:43], v6, s[8:11], s62 offen sc1
    buffer_load_dwordx4 v[44:47], v6, s[8:11], s63 offen sc1
    buffer_load_dwordx4 v[48:51], v6, s[8:11], s64 offen sc1
    buffer_load_dwordx4 v[52:55], v6, s[8:11], s65 offen sc1
    s_waitcnt lgkmcnt(0)
    s_waitcnt vmcnt(3)
    v_mfma_f32_16x16x32_bf16 v[68:71], v[40:43], v[64:67], 0
    v_and_b32 v10, 1, v43
    v_cmp_ne_u32 s[54:55], s40, v10
    s_waitcnt vmcnt(2)
    v_mfma_f32_16x16x32_bf16 v[68:71], v[44:47], v[64:67], v[68:71]
    v_and_b32 v10, 1, v47
    v_cmp_ne_u32 s[56:57], s40, v10
    s_waitcnt vmcnt(1)
    v_mfma_f32_16x16x32_bf16 v[68:71], v[48:51], v[64:67], v[68:71]
    v_and_b32 v10, 1, v51
    v_cmp_ne_u32 s[58:59], s40, v10
    s_waitcnt vmcnt(0)
    v_mfma_f32_16x16x32_bf16 v[68:71], v[52:55], v[64:67], v[68:71]
    v_and_b32 v10, 1, v55
    v_cmp_ne_u32 s[60:61], s40, v10
    s_or_b64 vcc, s[54:55], s[56:57]
    s_or_b64 vcc, vcc, s[58:59]
    s_or_b64 vcc, vcc, s[60:61]
    s_cbranch_scc0 Lr1f_red
    s_mov_b32 s16, 0
Lr1f_p1:
    s_mov_b64 exec, s[54:55]
    buffer_load_dwordx4 v[40:43], v6, s[8:11], s62 offen sc1
    s_mov_b64 exec, s[56:57]
    buffer_load_dwordx4 v[44:47], v6, s[8:11], s63 offen sc1
    s_mov_b64 exec, s[58:59]
    buffer_load_dwordx4 v[48:51], v6, s[8:11], s64 offen sc1
    s_mov_b64 exec, s[60:61]
    buffer_load_dwordx4 v[52:55], v6, s[8:11], s65 offen sc1
    s_mov_b64 exec, -1
    s_add_u32 s16, s16, 1
    s_cmp_gt_u32 s16, 100000
    s_cbranch_scc1 Lr_abort
    s_waitcnt vmcnt(3)
    v_mfma_f32_16x16x32_bf16 v[68:71], v[40:43], v[64:67], 0
    v_and_b32 v10, 1, v43
    v_cmp_ne_u32 s[54:55], s40, v10
    s_waitcnt vmcnt(2)
    v_mfma_f32_16x16x32_bf16 v[68:71], v[44:47], v[64:67], v[68:71]
    v_and_b32 v10, 1, v47
    v_cmp_ne_u32 s[56:57], s40, v10
    s_waitcnt vmcnt(1)
    v_mfma_f32_16x16x32_bf16 v[68:71], v[48:51], v[64:67], v[68:71]
    v_and_b32 v10, 1, v51
    v_cmp_ne_u32 s[58:59], s40, v10
    s_waitcnt vmcnt(0)
    v_mfma_f32_16x16x32_bf16 v[68:71], v[52:55], v[64:67], v[68:71]
    v_and_b32 v10, 1, v55
    v_cmp_ne_u32 s[60:61], s40, v10
    s_or_b64 vcc, s[54:55], s[56:57]
    s_or_b64 vcc, vcc, s[58:59]
    s_or_b64 vcc, vcc, s[60:61]
    s_cbranch_scc1 Lr1f_p1
Lr1f_red:
    s_xor_b32 s34, s34, 16384
    s_xor_b32 s35, s35, 16384
    buffer_load_dwordx4 v[36:39], v0, s[8:11], s34 offen sc1
    v_permlane16_swap_b32 v68, v70
    v_permlane16_swap_b32 v69, v71
    s_mov_b64 exec, s[46:47]
    v_add_f32 v68, v68, v70
    v_add_f32 v69, v69, v71
    v_cvt_pk_bf16_f32 v68, v68, v69
    v_min_u32 v68, s50, v68
    buffer_store_dword v68, v7, s[8:11], s36 offen
    v_mov_b32 v69, -1
    buffer_store_dword v69, v7, s[8:11], s37 offen
    s_mov_b64 exec, -1
    buffer_load_dwordx4 v[36:39], v0, s[8:11], s34 offen sc1
    s_xor_b32 s40, s40, 1
    s_xor_b32 s36, s36, 16384
    s_xor_b32 s37, s37, 16384
    ds_read_b128 v[64:67], v8 offset:6144
    ds_read_b128 v[68:71], v8 offset:7168
    s_waitcnt lgkmcnt(0)
    s_branch Lr1f_step
Lr1f_pb_re:
    s_mov_b32 s16, 0
Lr1f_pb_lp:
    s_add_u32 s17, s34, 4096
    buffer_load_dwordx4 v[40:43], v0, s[8:11], s17 offen sc1
    s_add_u32 s16, s16, 1
    s_cmp_gt_u32 s16, 100000
    s_cbranch_scc1 Lr_abort
    s_waitcnt vmcnt(0)
    v_max3_u32 v10, v40, v41, v42
    v_max_u32 v10, v10, v43
    v_cmp_eq_u32 vcc, -1, v10
    s_nop 0
    s_cbranch_vccnz Lr1f_pb_lp
    s_branch Lr1f_pb_ok
Lr1f_pc_re:
    s_mov_b32 s16, 0
Lr1f_pc_lp:
    buffer_load_dwordx4 v[44:47], v0, s[8:11], s35 offen sc1
    s_add_u32 s16, s16, 1
    s_cmp_gt_u32 s16, 100000
    s_cbranch_scc1 Lr_abort
    s_waitcnt vmcnt(0)
    v_max3_u32 v10, v44, v45, v46
    v_max_u32 v10, v10, v47
    v_cmp_eq_u32 vcc, -1, v10
    s_nop 0
    s_cbranch_vccnz Lr1f_pc_lp
    s_branch Lr1f_pc_ok
Lr1f_last:
    s_waitcnt vmcnt(0) lgkmcnt(0)
    s_barrier
    s_mov_b32 s67, s66
    v_mov_b32 v9, 1
    v_mov_b32 v10, 0
    s_mov_b64 exec, 1
    buffer_store_dword v9, v10, s[8:11], s67 offen offset:384 sc1
    s_mov_b64 exec, -1
    s_branch Lr_exit
L_w2_1:
    s_cmp_lg_u32 s14, 2
    s_cbranch_scc1 L_w3_1
    s_mov_b32 s16, 0
    s_add_u32 s17, s66, 128
    v_lshrrev_b32 v10, 2, v0
    v_and_b32 v9, 16, v10
    v_lshlrev_b32 v9, 3, v9
    v_and_or_b32 v10, v10, 12, v9
Lr2f_fw_12:
    buffer_load_dword v9, v10, s[8:11], s17 offen sc1
    s_add_u32 s16, s16, 1
    s_cmp_gt_u32 s16, 100000
    s_cbranch_scc1 Lr_abort
    s_waitcnt vmcnt(0)
    v_cmp_eq_u32 vcc, 0, v9
    s_nop 0
    s_cbranch_vccnz Lr2f_fw_12
    s_mov_b32 m0, 19200
    s_nop 0
    buffer_load_dwordx4 v0, s[8:11], s41 offen offset:0 lds
    buffer_load_dwordx4 v0, s[8:11], s41 offen offset:1024 lds
    s_add_u32 s41, s41, 262144
    s_add_u32 s68, s68, 262144
    s_waitcnt vmcnt(0)
    ds_read_b128 v[56:59], v8 offset:4096
    ds_read_b128 v[60:63], v8 offset:5120
    ds_read_b128 v[64:67], v8 offset:6144
    ds_read_b128 v[68:71], v8 offset:7168
    v_mov_b64 v[12:13], 0
    v_mov_b64 v[14:15], 0
    v_mov_b64 v[16:17], 0
    v_mov_b64 v[18:19], 0
    v_mov_b64 v[20:21], 0
    v_mov_b64 v[22:23], 0
    v_mov_b64 v[24:25], 0
    v_mov_b64 v[26:27], 0
    v_mov_b64 v[28:29], 0
    v_mov_b64 v[30:31], 0
    v_mov_b64 v[32:33], 0
    v_mov_b64 v[34:35], 0
    buffer_load_dwordx4 v[36:39], v0, s[8:11], s34 offen sc1
    s_waitcnt vmcnt(0) lgkmcnt(0)
Lr2f_step:
    s_waitcnt vmcnt(3)
    v_max3_u32 v10, v36, v37, v38
    v_max_u32 v10, v10, v39
    v_cmp_eq_u32 vcc, -1, v10
    s_nop 0
    s_cbranch_vccz Lr2f_aok
    buffer_load_dwordx4 v[36:39], v0, s[8:11], s34 offen sc1
    s_nop 15
    s_nop 8
    buffer_load_dwordx4 v[36:39], v0, s[8:11], s34 offen sc1
    s_mov_b32 s16, 0
Lr2f_alp:
    s_waitcnt vmcnt(2)
    v_max3_u32 v10, v36, v37, v38
    v_max_u32 v10, v10, v39
    v_cmp_eq_u32 vcc, -1, v10
    s_nop 0
    s_cbranch_vccz Lr2f_aok
    buffer_load_dwordx4 v[36:39], v0, s[8:11], s34 offen sc1
    s_add_u32 s16, s16, 1
    s_cmp_gt_u32 s16, 100000
    s_cbranch_scc1 Lr_abort
    s_branch Lr2f_alp
Lr2f_aok:
    ds_write_b128 v0, v[36:39] offset:8960
    v_smfmac_f32_16x16x64_bf16 v[12:15], v[36:39], v[104:111], v1
    v_smfmac_f32_16x16x64_bf16 v[16:19], v[36:39], v[112:119], v1
    v_smfmac_f32_16x16x64_bf16 v[20:23], v[36:39], v[216:223], v1
    s_waitcnt lgkmcnt(0)
    s_barrier
    ds_read_b128 v[48:51], v0 offset:9984
    ds_read_b128 v[52:55], v0 offset:6912
    v_smfmac_f32_16x16x64_bf16 v[28:31], v[36:39], v[56:63], v1
    ds_read_b128 v[56:59], v8 offset:0
    ds_read_b128 v[60:63], v8 offset:1024
    v_smfmac_f32_16x16x64_bf16 v[24:27], v[36:39], v[224:231], v1
    v_smfmac_f32_16x16x64_bf16 v[32:35], v[36:39], v[64:71], v1
    ds_read_b128 v[64:67], v8 offset:2048
    ds_read_b128 v[68:71], v8 offset:3072
    s_add_u32 s17, s34, 4096
    buffer_load_dwordx4 v[40:43], v0, s[8:11], s17 offen sc1
    s_waitcnt vmcnt(1)
    ds_read_b128 v[36:39], v0 offset:7936
    s_waitcnt lgkmcnt(6)
    v_smfmac_f32_16x16x64_bf16 v[28:31], v[48:51], a[88:95], v1
    v_smfmac_f32_16x16x64_bf16 v[12:15], v[48:51], v[120:127], v1
    v_smfmac_f32_16x16x64_bf16 v[16:19], v[48:51], v[128:135], v1
    v_smfmac_f32_16x16x64_bf16 v[32:35], v[48:51], a[96:103], v1
    buffer_load_dwordx4 v[44:47], v0, s[8:11], s35 offen sc1
    v_smfmac_f32_16x16x64_bf16 v[20:23], v[48:51], v[232:239], v1
    v_lshrrev_b32 v10, 2, v0
    v_and_b32 v9, 16, v10
    v_lshlrev_b32 v9, 3, v9
    v_and_or_b32 v10, v10, 12, v9
    s_add_u32 s17, s66, 22656
    v_mov_b32 v11, 2
    buffer_load_dword v11, v10, s[8:11], s17 offen sc1
    v_smfmac_f32_16x16x64_bf16 v[24:27], v[48:51], v[240:247], v1
    s_waitcnt lgkmcnt(3)
    v_smfmac_f32_16x16x64_bf16 v[28:31], v[52:55], v[56:63], v1
    ds_read_b128 v[56:59], v8 offset:12288
    ds_read_b128 v[60:63], v8 offset:13312
    v_smfmac_f32_16x16x64_bf16 v[12:15], v[52:55], v[72:79], v1
    v_smfmac_f32_16x16x64_bf16 v[16:19], v[52:55], v[80:87], v1
    s_waitcnt lgkmcnt(3)
    v_smfmac_f32_16x16x64_bf16 v[32:35], v[52:55], v[64:71], v1
    ds_read_b128 v[64:67], v8 offset:14336
    ds_read_b128 v[68:71], v8 offset:15360
    v_smfmac_f32_16x16x64_bf16 v[20:23], v[52:55], v[184:191], v1
    v_smfmac_f32_16x16x64_bf16 v[24:27], v[52:55], v[192:199], v1
    s_waitcnt lgkmcnt(4)
    v_smfmac_f32_16x16x64_bf16 v[28:31], v[36:39], a[72:79], v1
    v_smfmac_f32_16x16x64_bf16 v[12:15], v[36:39], v[88:95], v1
    v_smfmac_f32_16x16x64_bf16 v[16:19], v[36:39], v[96:103], v1
    v_smfmac_f32_16x16x64_bf16 v[32:35], v[36:39], a[80:87], v1
    v_smfmac_f32_16x16x64_bf16 v[20:23], v[36:39], v[200:207], v1
    v_smfmac_f32_16x16x64_bf16 v[24:27], v[36:39], v[208:215], v1
    s_waitcnt vmcnt(2)
    v_max3_u32 v10, v40, v41, v42
    v_max_u32 v10, v10, v43
    v_cmp_eq_u32 vcc, -1, v10
    s_nop 0
    s_cbranch_vccnz Lr2f_pb_re
Lr2f_pb_ok:
    ds_write_b128 v0, v[40:43] offset:13056
    s_waitcnt lgkmcnt(3)
    v_smfmac_f32_16x16x64_bf16 v[12:15], v[40:43], v[56:63], v1
    ds_read_b128 v[56:59], v8 offset:8192
    ds_read_b128 v[60:63], v8 offset:9216
    v_smfmac_f32_16x16x64_bf16 v[20:23], v[40:43], a[24:31], v1
    s_waitcnt lgkmcnt(3)
    v_smfmac_f32_16x16x64_bf16 v[16:19], v[40:43], v[64:71], v1
    ds_read_b128 v[64:67], v8 offset:10240
    ds_read_b128 v[68:71], v8 offset:11264
    v_smfmac_f32_16x16x64_bf16 v[24:27], v[40:43], a[32:39], v1
    s_waitcnt lgkmcnt(4)
    s_barrier
    ds_read_b128 v[48:51], v0 offset:11008
    ds_read_b128 v[52:55], v0 offset:14080
    ds_read_b128 v[36:39], v0 offset:12032
    v_smfmac_f32_16x16x64_bf16 v[28:31], v[40:43], a[136:143], v1
    v_smfmac_f32_16x16x64_bf16 v[32:35], v[40:43], a[144:151], v1
    s_waitcnt lgkmcnt(2)
    v_smfmac_f32_16x16x64_bf16 v[12:15], v[48:51], v[56:63], v1
    v_smfmac_f32_16x16x64_bf16 v[16:19], v[48:51], v[64:71], v1
    s_waitcnt lgkmcnt(1)
    v_smfmac_f32_16x16x64_bf16 v[12:15], v[52:55], v[152:159], v1
    v_smfmac_f32_16x16x64_bf16 v[16:19], v[52:55], v[160:167], v1
    s_waitcnt lgkmcnt(0)
    v_smfmac_f32_16x16x64_bf16 v[12:15], v[36:39], v[136:143], v1
    v_smfmac_f32_16x16x64_bf16 v[16:19], v[36:39], v[144:151], v1
    s_waitcnt vmcnt(1)
    v_max3_u32 v10, v44, v45, v46
    v_max_u32 v10, v10, v47
    v_cmp_eq_u32 vcc, -1, v10
    s_nop 0
    s_cbranch_vccnz Lr2f_pc_re
Lr2f_pc_ok:
    v_smfmac_f32_16x16x64_bf16 v[12:15], v[44:47], v[168:175], v1
    v_smfmac_f32_16x16x64_bf16 v[16:19], v[44:47], v[176:183], v1
    v_smfmac_f32_16x16x64_bf16 v[20:23], v[48:51], v[248:255], v1
    v_smfmac_f32_16x16x64_bf16 v[24:27], v[48:51], a[0:7], v1
    v_smfmac_f32_16x16x64_bf16 v[20:23], v[52:55], a[40:47], v1
    v_add_f32 v12, v12, v14
    buffer_load_dwordx4 v[64:67], v0, s[8:11], s42 offen
    v_smfmac_f32_16x16x64_bf16 v[24:27], v[52:55], a[48:55], v1
    v_add_f32 v16, v16, v18
    v_smfmac_f32_16x16x64_bf16 v[20:23], v[36:39], a[8:15], v1
    v_add_f32 v13, v13, v15
    v_smfmac_f32_16x16x64_bf16 v[24:27], v[36:39], a[16:23], v1
    v_add_f32 v17, v17, v19
    v_smfmac_f32_16x16x64_bf16 v[20:23], v[44:47], a[56:63], v1
    v_cvt_pk_bf16_f32 v14, v12, v16
    ds_read_b128 v[56:59], v0 offset:15104
    buffer_load_dwordx4 v[68:71], v0, s[8:11], s42 offen offset:1024
    v_smfmac_f32_16x16x64_bf16 v[24:27], v[44:47], a[64:71], v1
    v_cvt_pk_bf16_f32 v15, v13, v17
    ds_read_b128 v[60:63], v0 offset:16128
    ds_write_b32 v2, v14 offset:576
    ds_write_b32 v2, v15 offset:864
    v_smfmac_f32_16x16x64_bf16 v[28:31], v[48:51], a[104:111], v1
    v_smfmac_f32_16x16x64_bf16 v[32:35], v[48:51], a[112:119], v1
    v_add_f32 v20, v20, v22
    v_add_f32 v24, v24, v26
    v_add_f32 v21, v21, v23
    v_add_f32 v25, v25, v27
    v_cvt_pk_bf16_f32 v22, v20, v24
    v_cvt_pk_bf16_f32 v23, v21, v25
    ds_write_b32 v2, v22 offset:0
    ds_write_b32 v2, v23 offset:288
    v_smfmac_f32_16x16x64_bf16 v[28:31], v[52:55], a[152:159], v1
    v_smfmac_f32_16x16x64_bf16 v[32:35], v[52:55], a[160:167], v1
    s_waitcnt vmcnt(2)
    v_cmp_eq_u32 vcc, 0, v11
    s_nop 0
    s_cbranch_vccnz Lr2f_flbad
Lr2f_flok:
    s_waitcnt lgkmcnt(0)
    s_barrier
    ds_read_b128 v[40:43], v3 offset:0
    ds_read_b128 v[48:51], v3 offset:64
    ds_read_b128 v[20:23], v3 offset:128
    ds_read_b128 v[52:55], v3 offset:192
    v_smfmac_f32_16x16x64_bf16 v[28:31], v[36:39], a[120:127], v1
    v_smfmac_f32_16x16x64_bf16 v[32:35], v[36:39], a[128:135], v1
    ds_read_b128 v[36:39], v0 offset:17152
    v_smfmac_f32_16x16x64_bf16 v[28:31], v[44:47], a[168:175], v1
    v_smfmac_f32_16x16x64_bf16 v[32:35], v[44:47], a[176:183], v1
    ds_read_b128 v[44:47], v0 offset:18176
    s_waitcnt lgkmcnt(5)
    v_mfma_f32_16x16x32_bf16 v[12:15], v[56:59], v[40:43], 0
    v_mfma_f32_16x16x32_bf16 v[16:19], v[60:63], v[40:43], 0
    v_mfma_f32_16x16x32_bf16 v[24:27], v[40:43], v[40:43], 0
    ds_read_b128 v[56:59], v0 offset:19200
    ds_read_b128 v[60:63], v0 offset:20224
    s_waitcnt lgkmcnt(3)
    v_mfma_f32_16x16x32_bf16 v[12:15], v[36:39], v[48:51], v[12:15]
    v_lshrrev_b32 v10, 1, v0
    v_lshrrev_b32 v9, 9, v0
    s_waitcnt lgkmcnt(2)
    v_mfma_f32_16x16x32_bf16 v[16:19], v[44:47], v[48:51], v[16:19]
    v_lshl_add_u32 v9, v9, 5, v10
    v_add_f32 v28, v28, v30
    v_mfma_f32_16x16x32_bf16 v[24:27], v[48:51], v[48:51], v[24:27]
    v_add_f32 v32, v32, v34
    v_add_f32 v29, v29, v31
    ds_read_b128 v[36:39], v0 offset:21248
    ds_read_b128 v[44:47], v0 offset:22272
    s_waitcnt lgkmcnt(3)
    v_mfma_f32_16x16x32_bf16 v[12:15], v[56:59], v[20:23], v[12:15]
    v_add_f32 v33, v33, v35
    v_cvt_pk_bf16_f32 v30, v28, v29
    s_waitcnt lgkmcnt(2)
    v_mfma_f32_16x16x32_bf16 v[16:19], v[60:63], v[20:23], v[16:19]
    v_cvt_pk_bf16_f32 v31, v32, v33
    ds_read_b64 v[34:35], v9 offset:2304
    v_mfma_f32_16x16x32_bf16 v[24:27], v[20:23], v[20:23], v[24:27]
    s_add_u32 s17, s43, 3072
    buffer_store_dwordx2 v[30:31], v10, s[8:11], s17 offen sc1
    s_waitcnt lgkmcnt(2)
    v_mfma_f32_16x16x32_bf16 v[12:15], v[36:39], v[52:55], v[12:15]
    s_waitcnt lgkmcnt(1)
    v_mfma_f32_16x16x32_bf16 v[16:19], v[44:47], v[52:55], v[16:19]
    v_mfma_f32_16x16x32_bf16 v[24:27], v[52:55], v[52:55], v[24:27]
    s_add_u32 s17, s43, 1024
    s_waitcnt lgkmcnt(0)
    buffer_store_dwordx2 v[34:35], v10, s[8:11], s17 offen sc1
    s_cmp_eq_u32 s33, 63
    s_cbranch_scc1 Lr2f_last
    ds_read_b128 v[56:59], v8 offset:16384
    ds_read_b128 v[60:63], v8 offset:17408
    v_mov_b64 v[20:21], s[52:53]
    v_mov_b64 v[22:23], s[52:53]
    v_mov_b32 v41, 0
    v_mov_b32 v42, 0
    v_max3_f32 v9, v12, v13, v14
    v_max3_f32 v9, v9, v15, v16
    v_max3_f32 v9, v9, v17, v18
    v_max3_f32 v9, v9, v19, v24
    v_max_f32 v9, v9, v25
    v_mov_b32 v10, v9
    v_mov_b64 v[32:33], 0
    v_mov_b64 v[34:35], 0
    v_permlane32_swap_b32 v9, v10
    v_max_f32 v9, v9, v10
    v_mov_b32 v10, v9
    s_nop 1
    v_permlane16_swap_b32 v9, v10
    v_max_f32 v9, v9, v10
    v_mul_f32 v28, s44, v9
    v_fma_f32 v12, v12, s44, -v28
    v_fma_f32 v13, v13, s44, -v28
    v_fma_f32 v14, v14, s44, -v28
    v_fma_f32 v15, v15, s44, -v28
    v_exp_f32 v12, v12
    v_exp_f32 v13, v13
    v_fma_f32 v16, v16, s44, -v28
    v_fma_f32 v17, v17, s44, -v28
    v_exp_f32 v14, v14
    v_exp_f32 v15, v15
    v_cvt_pk_bf16_f32 v36, v12, v13
    v_fma_f32 v18, v18, s44, -v28
    v_fma_f32 v19, v19, s44, -v28
    v_exp_f32 v16, v16
    v_exp_f32 v17, v17
    v_cvt_pk_bf16_f32 v37, v14, v15
    v_fma_f32 v24, v24, s44, -v28
    v_fma_f32 v25, v25, s44, -v28
    v_exp_f32 v18, v18
    v_exp_f32 v19, v19
    v_cvt_pk_bf16_f32 v38, v16, v17
    v_exp_f32 v24, v24
    v_exp_f32 v25, v25
    v_cvt_pk_bf16_f32 v39, v18, v19
    v_cvt_pk_bf16_f32 v40, v24, v25
    v_cvt_pk_bf16_f32 v43, v24, v25
    v_mfma_f32_16x16x32_bf16 v[52:55], v[20:23], v[36:39], 0
    v_mov_b64 v[12:13], 0
    v_mov_b64 v[14:15], 0
    s_waitcnt vmcnt(3)
    v_mfma_f32_16x16x32_bf16 v[44:47], v[64:67], v[36:39], 0
    v_mov_b64 v[24:25], 0
    v_mov_b64 v[26:27], 0
    s_waitcnt vmcnt(2)
    v_mfma_f32_16x16x32_bf16 v[48:51], v[68:71], v[36:39], 0
    ds_read_b128 v[64:67], v8 offset:20480
    ds_read_b128 v[68:71], v8 offset:21504
    v_mfma_f32_16x16x16_bf16 v[52:55], v[20:21], v[40:41], v[52:55]
    v_mfma_f32_16x16x16_bf16 v[44:47], v[30:31], v[40:41], v[44:47]
    v_mov_b64 v[20:21], 0
    v_mov_b64 v[22:23], 0
    v_mfma_f32_16x16x16_bf16 v[48:51], v[30:31], v[42:43], v[48:51]
    v_mov_b64 v[36:37], 0
    v_mov_b64 v[38:39], 0
    v_mov_b64 v[40:41], 0
    v_mov_b64 v[42:43], 0
    v_rcp_f32 v9, v52
    v_mov_b64 v[52:53], 0
    v_mov_b64 v[54:55], 0
    v_mul_f32 v44, v9, v44
    v_mul_f32 v48, v9, v48
    v_cvt_pk_bf16_f32 v16, v44, v48
    v_mul_f32 v45, v9, v45
    v_mul_f32 v49, v9, v49
    v_cvt_pk_bf16_f32 v17, v45, v49
    v_mul_f32 v46, v9, v46
    v_mul_f32 v50, v9, v50
    v_cvt_pk_bf16_f32 v18, v46, v50
    v_mul_f32 v47, v9, v47
    v_mul_f32 v51, v9, v51
    v_cvt_pk_bf16_f32 v19, v47, v51
    ds_write_b128 v5, v[16:19]
    v_mov_b64 v[28:29], 0
    v_mov_b64 v[30:31], 0
    s_waitcnt lgkmcnt(0)
    s_barrier
    ds_read_b128 v[44:47], v4 offset:0
    ds_read_b128 v[48:51], v4 offset:128
    v_mov_b64 v[16:17], 0
    v_mov_b64 v[18:19], 0
    buffer_load_dwordx4 v0, s[8:11], s41 offen offset:0 lds
    buffer_load_dwordx4 v0, s[8:11], s41 offen offset:1024 lds
    s_waitcnt lgkmcnt(1)
    v_smfmac_f32_16x16x64_bf16 v[12:15], v[44:47], a[184:191], v1
    s_waitcnt lgkmcnt(0)
    v_smfmac_f32_16x16x64_bf16 v[12:15], v[48:51], a[192:199], v1
    v_smfmac_f32_16x16x64_bf16 v[24:27], v[44:47], a[200:207], v1
    v_smfmac_f32_16x16x64_bf16 v[24:27], v[48:51], a[208:215], v1
    v_add_f32 v12, v12, v14
    v_smfmac_f32_16x16x64_bf16 v[20:23], v[44:47], a[216:223], v1
    v_add_f32 v13, v13, v15
    v_smfmac_f32_16x16x64_bf16 v[20:23], v[48:51], a[224:231], v1
    v_cvt_pk_bf16_f32 v12, v12, v13
    v_smfmac_f32_16x16x64_bf16 v[16:19], v[44:47], a[232:239], v1
    v_add_f32 v24, v24, v26
    v_smfmac_f32_16x16x64_bf16 v[16:19], v[48:51], a[240:247], v1
    v_add_f32 v25, v25, v27
    v_smfmac_f32_16x16x64_bf16 v[36:39], v[44:47], v[56:63], v1
    v_cvt_pk_bf16_f32 v13, v24, v25
    v_smfmac_f32_16x16x64_bf16 v[36:39], v[48:51], v[64:71], v1
    v_add_f32 v20, v20, v22
    v_add_f32 v21, v21, v23
    v_cvt_pk_bf16_f32 v14, v20, v21
    v_add_f32 v16, v16, v18
    v_add_f32 v17, v17, v19
    v_cvt_pk_bf16_f32 v15, v16, v17
    v_and_or_b32 v15, v15, -2, s40
    buffer_store_dwordx4 v[12:15], v0, s[8:11], s38 offen
    s_nop 0
    ds_read_b128 v[12:15], v8 offset:18432
    ds_read_b128 v[16:19], v8 offset:19456
    ds_read_b128 v[20:23], v8 offset:22528
    ds_read_b128 v[24:27], v8 offset:23552
    ds_read_b128 v[56:59], v8 offset:24576
    ds_read_b128 v[60:63], v8 offset:25600
    ds_read_b128 v[64:67], v8 offset:28672
    ds_read_b128 v[68:71], v8 offset:29696
    s_waitcnt lgkmcnt(6)
    v_smfmac_f32_16x16x64_bf16 v[40:43], v[44:47], v[12:19], v1
    ds_read_b128 v[12:15], v8 offset:26624
    ds_read_b128 v[16:19], v8 offset:27648
    s_waitcnt lgkmcnt(6)
    v_smfmac_f32_16x16x64_bf16 v[40:43], v[48:51], v[20:27], v1
    ds_read_b128 v[20:23], v8 offset:30720
    ds_read_b128 v[24:27], v8 offset:31744
    s_waitcnt lgkmcnt(6)
    v_smfmac_f32_16x16x64_bf16 v[52:55], v[44:47], v[56:63], v1
    ds_read_b128 v[56:59], v8 offset:32768
    ds_read_b128 v[60:63], v8 offset:33792
    s_waitcnt lgkmcnt(6)
    v_smfmac_f32_16x16x64_bf16 v[52:55], v[48:51], v[64:71], v1
    s_waitcnt lgkmcnt(4)
    v_smfmac_f32_16x16x64_bf16 v[32:35], v[44:47], v[12:19], v1
    s_waitcnt lgkmcnt(2)
    v_smfmac_f32_16x16x64_bf16 v[32:35], v[48:51], v[20:27], v1
    v_smfmac_f32_16x16x64_bf16 v[28:31], v[44:47], a[248:255], v1
    s_waitcnt lgkmcnt(0)
    v_smfmac_f32_16x16x64_bf16 v[28:31], v[48:51], v[56:63], v1
    v_add_f32 v36, v36, v38
    v_add_f32 v37, v37, v39
    v_cvt_pk_bf16_f32 v36, v36, v37
    v_add_f32 v40, v40, v42
    v_add_f32 v41, v41, v43
    v_cvt_pk_bf16_f32 v37, v40, v41
    v_add_f32 v52, v52, v54
    v_add_f32 v53, v53, v55
    v_cvt_pk_bf16_f32 v38, v52, v53
    v_add_f32 v32, v32, v34
    v_add_f32 v33, v33, v35
    v_cvt_pk_bf16_f32 v39, v32, v33
    v_and_or_b32 v39, v39, -2, s40
    s_add_u32 s17, s38, 4096
    buffer_store_dwordx4 v[36:39], v0, s[8:11], s17 offen
    v_add_f32 v28, v28, v30
    v_add_f32 v29, v29, v31
    v_cvt_pk_bf16_f32 v28, v28, v29
    v_and_or_b32 v28, v28, -2, s40
    v_lshrrev_b32 v9, 2, v0
    buffer_store_dword v28, v9, s[8:11], s39 offen
    v_add_u32 v10, 162560, v0
    ds_read_b32 v64, v10
    v_mov_b32 v65, 0
    v_mov_b32 v41, 0
    v_mov_b32 v45, 0
    v_mov_b32 v49, 0
    v_mov_b32 v53, 0
    s_add_u32 s33, s33, 1
    s_add_u32 s42, s42, 262144
    s_add_u32 s41, s41, 262144
    s_add_u32 s43, s43, 131072
    s_add_u32 s68, s68, 262144
    s_add_u32 s66, s66, 22528
    ds_read_b128 v[56:59], v8 offset:4096
    ds_read_b128 v[60:63], v8 offset:5120
    v_mov_b64 v[12:13], 0
    v_mov_b64 v[14:15], 0
    v_mov_b64 v[16:17], 0
    v_mov_b64 v[18:19], 0
    v_mov_b64 v[20:21], 0
    v_mov_b64 v[22:23], 0
    v_mov_b64 v[24:25], 0
    v_mov_b64 v[26:27], 0
    v_mov_b64 v[28:29], 0
    v_mov_b64 v[30:31], 0
    v_mov_b64 v[32:33], 0
    v_mov_b64 v[34:35], 0
    s_nop 15
    s_nop 15
    s_nop 15
    s_nop 1
    buffer_load_dword v40, v6, s[8:11], s62 offen sc1
    buffer_load_dword v44, v6, s[8:11], s63 offen sc1
    buffer_load_dword v48, v6, s[8:11], s64 offen sc1
    buffer_load_dword v52, v6, s[8:11], s65 offen sc1
    s_waitcnt lgkmcnt(0)
    s_waitcnt vmcnt(3)
    v_mfma_f32_16x16x16_bf16 v[68:71], v[40:41], v[64:65], 0
    v_and_b32 v10, 1, v40
    v_cmp_ne_u32 s[54:55], s40, v10
    s_waitcnt vmcnt(2)
    v_mfma_f32_16x16x16_bf16 v[68:71], v[44:45], v[64:65], v[68:71]
    v_and_b32 v10, 1, v44
    v_cmp_ne_u32 s[56:57], s40, v10
    s_waitcnt vmcnt(1)
    v_mfma_f32_16x16x16_bf16 v[68:71], v[48:49], v[64:65], v[68:71]
    v_and_b32 v10, 1, v48
    v_cmp_ne_u32 s[58:59], s40, v10
    s_waitcnt vmcnt(0)
    v_mfma_f32_16x16x16_bf16 v[68:71], v[52:53], v[64:65], v[68:71]
    v_and_b32 v10, 1, v52
    v_cmp_ne_u32 s[60:61], s40, v10
    s_or_b64 vcc, s[54:55], s[56:57]
    s_or_b64 vcc, vcc, s[58:59]
    s_or_b64 vcc, vcc, s[60:61]
    s_cbranch_scc0 Lr2f_red
    s_mov_b32 s16, 0
Lr2f_p1:
    s_mov_b64 exec, s[54:55]
    buffer_load_dword v40, v6, s[8:11], s62 offen sc1
    s_mov_b64 exec, s[56:57]
    buffer_load_dword v44, v6, s[8:11], s63 offen sc1
    s_mov_b64 exec, s[58:59]
    buffer_load_dword v48, v6, s[8:11], s64 offen sc1
    s_mov_b64 exec, s[60:61]
    buffer_load_dword v52, v6, s[8:11], s65 offen sc1
    s_mov_b64 exec, -1
    s_add_u32 s16, s16, 1
    s_cmp_gt_u32 s16, 100000
    s_cbranch_scc1 Lr_abort
    s_waitcnt vmcnt(3)
    v_mfma_f32_16x16x16_bf16 v[68:71], v[40:41], v[64:65], 0
    v_and_b32 v10, 1, v40
    v_cmp_ne_u32 s[54:55], s40, v10
    s_waitcnt vmcnt(2)
    v_mfma_f32_16x16x16_bf16 v[68:71], v[44:45], v[64:65], v[68:71]
    v_and_b32 v10, 1, v44
    v_cmp_ne_u32 s[56:57], s40, v10
    s_waitcnt vmcnt(1)
    v_mfma_f32_16x16x16_bf16 v[68:71], v[48:49], v[64:65], v[68:71]
    v_and_b32 v10, 1, v48
    v_cmp_ne_u32 s[58:59], s40, v10
    s_waitcnt vmcnt(0)
    v_mfma_f32_16x16x16_bf16 v[68:71], v[52:53], v[64:65], v[68:71]
    v_and_b32 v10, 1, v52
    v_cmp_ne_u32 s[60:61], s40, v10
    s_or_b64 vcc, s[54:55], s[56:57]
    s_or_b64 vcc, vcc, s[58:59]
    s_or_b64 vcc, vcc, s[60:61]
    s_cbranch_scc1 Lr2f_p1
Lr2f_red:
    s_xor_b32 s34, s34, 16384
    s_xor_b32 s35, s35, 16384
    buffer_load_dwordx4 v[36:39], v0, s[8:11], s34 offen sc1
    v_permlane16_swap_b32 v68, v70
    v_permlane16_swap_b32 v69, v71
    s_mov_b64 exec, s[46:47]
    v_add_f32 v68, v68, v70
    v_add_f32 v69, v69, v71
    v_cvt_pk_bf16_f32 v68, v68, v69
    v_min_u32 v68, s50, v68
    buffer_store_dword v68, v7, s[8:11], s36 offen
    v_mov_b32 v69, -1
    buffer_store_dword v69, v7, s[8:11], s37 offen
    s_mov_b64 exec, -1
    buffer_load_dwordx4 v[36:39], v0, s[8:11], s34 offen sc1
    s_xor_b32 s40, s40, 1
    s_xor_b32 s36, s36, 16384
    s_xor_b32 s37, s37, 16384
    ds_read_b128 v[64:67], v8 offset:6144
    ds_read_b128 v[68:71], v8 offset:7168
    s_waitcnt lgkmcnt(0)
    s_branch Lr2f_step
Lr2f_pb_re:
    s_mov_b32 s16, 0
Lr2f_pb_lp:
    s_add_u32 s17, s34, 4096
    buffer_load_dwordx4 v[40:43], v0, s[8:11], s17 offen sc1
    s_add_u32 s16, s16, 1
    s_cmp_gt_u32 s16, 100000
    s_cbranch_scc1 Lr_abort
    s_waitcnt vmcnt(0)
    v_max3_u32 v10, v40, v41, v42
    v_max_u32 v10, v10, v43
    v_cmp_eq_u32 vcc, -1, v10
    s_nop 0
    s_cbranch_vccnz Lr2f_pb_lp
    s_branch Lr2f_pb_ok
Lr2f_pc_re:
    s_mov_b32 s16, 0
Lr2f_pc_lp:
    buffer_load_dwordx4 v[44:47], v0, s[8:11], s35 offen sc1
    s_add_u32 s16, s16, 1
    s_cmp_gt_u32 s16, 100000
    s_cbranch_scc1 Lr_abort
    s_waitcnt vmcnt(0)
    v_max3_u32 v10, v44, v45, v46
    v_max_u32 v10, v10, v47
    v_cmp_eq_u32 vcc, -1, v10
    s_nop 0
    s_cbranch_vccnz Lr2f_pc_lp
    s_branch Lr2f_pc_ok
Lr2f_flbad:
    s_cmp_eq_u32 s33, 63
    s_cbranch_scc1 Lr2f_flok
    s_mov_b32 s16, 0
    s_add_u32 s17, s66, 22656
    v_lshrrev_b32 v10, 2, v0
    v_and_b32 v9, 16, v10
    v_lshlrev_b32 v9, 3, v9
    v_and_or_b32 v10, v10, 12, v9
Lr2f_fw_13:
    buffer_load_dword v9, v10, s[8:11], s17 offen sc1
    s_add_u32 s16, s16, 1
    s_cmp_gt_u32 s16, 100000
    s_cbranch_scc1 Lr_abort
    s_waitcnt vmcnt(0)
    v_cmp_eq_u32 vcc, 0, v9
    s_nop 0
    s_cbranch_vccnz Lr2f_fw_13
    s_branch Lr2f_flok
Lr2f_last:
    s_waitcnt vmcnt(0) lgkmcnt(0)
    s_barrier
    s_branch Lr_exit
L_w3_1:
    s_mov_b32 s16, 0
    s_add_u32 s17, s66, 128
    v_lshrrev_b32 v10, 2, v0
    v_and_b32 v9, 16, v10
    v_lshlrev_b32 v9, 3, v9
    v_and_or_b32 v10, v10, 12, v9
Lr3f_fw_14:
    buffer_load_dword v9, v10, s[8:11], s17 offen sc1
    s_add_u32 s16, s16, 1
    s_cmp_gt_u32 s16, 100000
    s_cbranch_scc1 Lr_abort
    s_waitcnt vmcnt(0)
    v_cmp_eq_u32 vcc, 0, v9
    s_nop 0
    s_cbranch_vccnz Lr3f_fw_14
    s_mov_b32 m0, 21248
    s_nop 0
    buffer_load_dwordx4 v0, s[8:11], s41 offen offset:0 lds
    buffer_load_dwordx4 v0, s[8:11], s41 offen offset:1024 lds
    s_add_u32 s41, s41, 262144
    s_add_u32 s68, s68, 262144
    s_waitcnt vmcnt(0)
    ds_read_b128 v[56:59], v8 offset:0
    ds_read_b128 v[60:63], v8 offset:1024
    ds_read_b128 v[64:67], v8 offset:2048
    ds_read_b128 v[68:71], v8 offset:3072
    v_mov_b64 v[12:13], 0
    v_mov_b64 v[14:15], 0
    v_mov_b64 v[16:17], 0
    v_mov_b64 v[18:19], 0
    v_mov_b64 v[20:21], 0
    v_mov_b64 v[22:23], 0
    v_mov_b64 v[24:25], 0
    v_mov_b64 v[26:27], 0
    v_mov_b64 v[28:29], 0
    v_mov_b64 v[30:31], 0
    v_mov_b64 v[32:33], 0
    v_mov_b64 v[34:35], 0
    buffer_load_dwordx4 v[36:39], v0, s[8:11], s34 offen sc1
    s_waitcnt vmcnt(0) lgkmcnt(0)
Lr3f_step:
    s_mov_b32 s16, 0
Lr3f_alp:
    s_waitcnt vmcnt(2)
    v_max3_u32 v10, v36, v37, v38
    v_max_u32 v10, v10, v39
    v_cmp_eq_u32 vcc, -1, v10
    s_nop 0
    s_cbranch_vccz Lr3f_aok
    buffer_load_dwordx4 v[36:39], v0, s[8:11], s34 offen sc1
    s_add_u32 s16, s16, 1
    s_cmp_gt_u32 s16, 100000
    s_cbranch_scc1 Lr_abort
    s_branch Lr3f_alp
Lr3f_aok:
    ds_write_b128 v0, v[36:39] offset:9984
    v_smfmac_f32_16x16x64_bf16 v[12:15], v[36:39], v[120:127], v1
    v_smfmac_f32_16x16x64_bf16 v[16:19], v[36:39], v[128:135], v1
    v_smfmac_f32_16x16x64_bf16 v[20:23], v[36:39], v[232:239], v1
    s_waitcnt lgkmcnt(0)
    s_barrier
    ds_read_b128 v[48:51], v0 offset:6912
    ds_read_b128 v[52:55], v0 offset:7936
    v_smfmac_f32_16x16x64_bf16 v[28:31], v[36:39], a[88:95], v1
    v_smfmac_f32_16x16x64_bf16 v[24:27], v[36:39], v[240:247], v1
    v_smfmac_f32_16x16x64_bf16 v[32:35], v[36:39], a[96:103], v1
    s_waitcnt vmcnt(0)
    ds_read_b128 v[36:39], v0 offset:8960
    s_waitcnt lgkmcnt(2)
    v_smfmac_f32_16x16x64_bf16 v[28:31], v[48:51], v[56:63], v1
    ds_read_b128 v[56:59], v8 offset:4096
    ds_read_b128 v[60:63], v8 offset:5120
    s_add_u32 s17, s34, 4096
    buffer_load_dwordx4 v[40:43], v0, s[8:11], s17 offen sc1
    v_smfmac_f32_16x16x64_bf16 v[12:15], v[48:51], v[72:79], v1
    v_smfmac_f32_16x16x64_bf16 v[16:19], v[48:51], v[80:87], v1
    v_smfmac_f32_16x16x64_bf16 v[32:35], v[48:51], v[64:71], v1
    ds_read_b128 v[64:67], v8 offset:6144
    ds_read_b128 v[68:71], v8 offset:7168
    v_smfmac_f32_16x16x64_bf16 v[20:23], v[48:51], v[184:191], v1
    buffer_load_dwordx4 v[44:47], v0, s[8:11], s35 offen sc1
    v_smfmac_f32_16x16x64_bf16 v[24:27], v[48:51], v[192:199], v1
    s_waitcnt lgkmcnt(5)
    v_smfmac_f32_16x16x64_bf16 v[28:31], v[52:55], a[72:79], v1
    v_smfmac_f32_16x16x64_bf16 v[12:15], v[52:55], v[88:95], v1
    v_smfmac_f32_16x16x64_bf16 v[16:19], v[52:55], v[96:103], v1
    v_smfmac_f32_16x16x64_bf16 v[32:35], v[52:55], a[80:87], v1
    v_smfmac_f32_16x16x64_bf16 v[20:23], v[52:55], v[200:207], v1
    v_smfmac_f32_16x16x64_bf16 v[24:27], v[52:55], v[208:215], v1
    s_waitcnt lgkmcnt(2)
    v_smfmac_f32_16x16x64_bf16 v[28:31], v[36:39], v[56:63], v1
    ds_read_b128 v[56:59], v8 offset:8192
    ds_read_b128 v[60:63], v8 offset:9216
    v_smfmac_f32_16x16x64_bf16 v[12:15], v[36:39], v[104:111], v1
    v_smfmac_f32_16x16x64_bf16 v[16:19], v[36:39], v[112:119], v1
    s_waitcnt lgkmcnt(2)
    v_smfmac_f32_16x16x64_bf16 v[32:35], v[36:39], v[64:71], v1
    ds_read_b128 v[64:67], v8 offset:10240
    ds_read_b128 v[68:71], v8 offset:11264
    v_smfmac_f32_16x16x64_bf16 v[20:23], v[36:39], v[216:223], v1
    v_smfmac_f32_16x16x64_bf16 v[24:27], v[36:39], v[224:231], v1
    s_waitcnt vmcnt(1)
    v_max3_u32 v10, v40, v41, v42
    v_max_u32 v10, v10, v43
    v_cmp_eq_u32 vcc, -1, v10
    s_nop 0
    s_cbranch_vccnz Lr3f_pb_re
Lr3f_pb_ok:
    ds_write_b128 v0, v[40:43] offset:14080
    v_smfmac_f32_16x16x64_bf16 v[12:15], v[40:43], v[152:159], v1
    v_smfmac_f32_16x16x64_bf16 v[20:23], v[40:43], a[40:47], v1
    v_smfmac_f32_16x16x64_bf16 v[16:19], v[40:43], v[160:167], v1
    v_smfmac_f32_16x16x64_bf16 v[24:27], v[40:43], a[48:55], v1
    s_waitcnt lgkmcnt(0)
    s_barrier
    ds_read_b128 v[48:51], v0 offset:11008
    ds_read_b128 v[52:55], v0 offset:12032
    ds_read_b128 v[36:39], v0 offset:13056
    v_smfmac_f32_16x16x64_bf16 v[28:31], v[40:43], a[152:159], v1
    v_smfmac_f32_16x16x64_bf16 v[32:35], v[40:43], a[160:167], v1
    s_waitcnt lgkmcnt(2)
    v_smfmac_f32_16x16x64_bf16 v[12:15], v[48:51], v[56:63], v1
    ds_read_b128 v[56:59], v8 offset:12288
    ds_read_b128 v[60:63], v8 offset:13312
    v_smfmac_f32_16x16x64_bf16 v[16:19], v[48:51], v[64:71], v1
    ds_read_b128 v[64:67], v8 offset:14336
    ds_read_b128 v[68:71], v8 offset:15360
    s_waitcnt lgkmcnt(5)
    v_smfmac_f32_16x16x64_bf16 v[12:15], v[52:55], v[136:143], v1
    v_smfmac_f32_16x16x64_bf16 v[16:19], v[52:55], v[144:151], v1
    s_waitcnt vmcnt(0)
    v_max3_u32 v10, v44, v45, v46
    v_max_u32 v10, v10, v47
    v_cmp_eq_u32 vcc, -1, v10
    s_nop 0
    s_cbranch_vccnz Lr3f_pc_re
Lr3f_pc_ok:
    v_smfmac_f32_16x16x64_bf16 v[12:15], v[44:47], v[168:175], v1
    v_smfmac_f32_16x16x64_bf16 v[16:19], v[44:47], v[176:183], v1
    s_waitcnt lgkmcnt(2)
    v_smfmac_f32_16x16x64_bf16 v[12:15], v[36:39], v[56:63], v1
    s_waitcnt lgkmcnt(0)
    v_smfmac_f32_16x16x64_bf16 v[16:19], v[36:39], v[64:71], v1
    v_smfmac_f32_16x16x64_bf16 v[20:23], v[48:51], v[248:255], v1
    v_smfmac_f32_16x16x64_bf16 v[24:27], v[48:51], a[0:7], v1
    v_smfmac_f32_16x16x64_bf16 v[20:23], v[52:55], a[8:15], v1
    v_add_f32 v12, v12, v14
    v_smfmac_f32_16x16x64_bf16 v[24:27], v[52:55], a[16:23], v1
    v_add_f32 v16, v16, v18
    buffer_load_dwordx4 v[64:67], v0, s[8:11], s42 offen
    v_smfmac_f32_16x16x64_bf16 v[20:23], v[36:39], a[24:31], v1
    v_add_f32 v13, v13, v15
    v_smfmac_f32_16x16x64_bf16 v[24:27], v[36:39], a[32:39], v1
    v_add_f32 v17, v17, v19
    v_smfmac_f32_16x16x64_bf16 v[20:23], v[44:47], a[56:63], v1
    v_cvt_pk_bf16_f32 v14, v12, v16
    ds_read_b128 v[56:59], v0 offset:15104
    v_smfmac_f32_16x16x64_bf16 v[24:27], v[44:47], a[64:71], v1
    v_cvt_pk_bf16_f32 v15, v13, v17
    ds_read_b128 v[60:63], v0 offset:16128
    buffer_load_dwordx4 v[68:71], v0, s[8:11], s42 offen offset:1024
    ds_write_b32 v2, v14 offset:576
    ds_write_b32 v2, v15 offset:864
    v_smfmac_f32_16x16x64_bf16 v[28:31], v[48:51], a[104:111], v1
    v_smfmac_f32_16x16x64_bf16 v[32:35], v[48:51], a[112:119], v1
    v_add_f32 v20, v20, v22
    v_add_f32 v24, v24, v26
    v_add_f32 v21, v21, v23
    v_add_f32 v25, v25, v27
    v_cvt_pk_bf16_f32 v22, v20, v24
    v_cvt_pk_bf16_f32 v23, v21, v25
    ds_write_b32 v2, v22 offset:0
    ds_write_b32 v2, v23 offset:288
    v_smfmac_f32_16x16x64_bf16 v[28:31], v[52:55], a[120:127], v1
    v_smfmac_f32_16x16x64_bf16 v[32:35], v[52:55], a[128:135], v1
    s_waitcnt lgkmcnt(0)
    s_barrier
    ds_read_b128 v[40:43], v3 offset:0
    ds_read_b128 v[48:51], v3 offset:64
    ds_read_b128 v[20:23], v3 offset:128
    ds_read_b128 v[52:55], v3 offset:192
    v_smfmac_f32_16x16x64_bf16 v[28:31], v[36:39], a[136:143], v1
    v_smfmac_f32_16x16x64_bf16 v[32:35], v[36:39], a[144:151], v1
    ds_read_b128 v[36:39], v0 offset:17152
    v_lshlrev_b32 v9, 3, v0
    buffer_load_dword v11, v9, s[8:11], s68 offen
    v_smfmac_f32_16x16x64_bf16 v[28:31], v[44:47], a[168:175], v1
    v_smfmac_f32_16x16x64_bf16 v[32:35], v[44:47], a[176:183], v1
    ds_read_b128 v[44:47], v0 offset:18176
    s_waitcnt lgkmcnt(5)
    v_mfma_f32_16x16x32_bf16 v[12:15], v[56:59], v[40:43], 0
    v_mfma_f32_16x16x32_bf16 v[16:19], v[60:63], v[40:43], 0
    v_mfma_f32_16x16x32_bf16 v[24:27], v[40:43], v[40:43], 0
    ds_read_b128 v[56:59], v0 offset:19200
    ds_read_b128 v[60:63], v0 offset:20224
    s_waitcnt lgkmcnt(3)
    v_mfma_f32_16x16x32_bf16 v[12:15], v[36:39], v[48:51], v[12:15]
    v_lshrrev_b32 v10, 1, v0
    v_lshrrev_b32 v9, 9, v0
    s_waitcnt lgkmcnt(2)
    v_mfma_f32_16x16x32_bf16 v[16:19], v[44:47], v[48:51], v[16:19]
    v_lshl_add_u32 v9, v9, 5, v10
    v_add_f32 v28, v28, v30
    v_mfma_f32_16x16x32_bf16 v[24:27], v[48:51], v[48:51], v[24:27]
    v_add_f32 v32, v32, v34
    v_add_f32 v29, v29, v31
    ds_read_b128 v[36:39], v0 offset:21248
    ds_read_b128 v[44:47], v0 offset:22272
    s_waitcnt lgkmcnt(3)
    v_mfma_f32_16x16x32_bf16 v[12:15], v[56:59], v[20:23], v[12:15]
    v_add_f32 v33, v33, v35
    v_cvt_pk_bf16_f32 v30, v28, v29
    s_waitcnt lgkmcnt(2)
    v_mfma_f32_16x16x32_bf16 v[16:19], v[60:63], v[20:23], v[16:19]
    v_cvt_pk_bf16_f32 v31, v32, v33
    ds_read_b64 v[34:35], v9 offset:3456
    v_mfma_f32_16x16x32_bf16 v[24:27], v[20:23], v[20:23], v[24:27]
    s_add_u32 s17, s43, 3584
    buffer_store_dwordx2 v[30:31], v10, s[8:11], s17 offen sc1
    s_waitcnt lgkmcnt(2)
    v_mfma_f32_16x16x32_bf16 v[12:15], v[36:39], v[52:55], v[12:15]
    s_waitcnt lgkmcnt(1)
    v_mfma_f32_16x16x32_bf16 v[16:19], v[44:47], v[52:55], v[16:19]
    v_mfma_f32_16x16x32_bf16 v[24:27], v[52:55], v[52:55], v[24:27]
    s_add_u32 s17, s43, 1536
    s_waitcnt lgkmcnt(0)
    buffer_store_dwordx2 v[34:35], v10, s[8:11], s17 offen sc1
    s_cmp_eq_u32 s33, 63
    s_cbranch_scc1 Lr3f_last
    ds_read_b128 v[56:59], v8 offset:16384
    ds_read_b128 v[60:63], v8 offset:17408
    v_mov_b64 v[20:21], s[52:53]
    v_mov_b64 v[22:23], s[52:53]
    v_mov_b32 v41, 0
    v_mov_b32 v42, 0
    v_max3_f32 v9, v12, v13, v14
    v_max3_f32 v9, v9, v15, v16
    v_max3_f32 v9, v9, v17, v18
    v_max3_f32 v9, v9, v19, v24
    v_max_f32 v9, v9, v25
    v_mov_b32 v10, v9
    v_mov_b64 v[32:33], 0
    v_mov_b64 v[34:35], 0
    v_permlane32_swap_b32 v9, v10
    v_max_f32 v9, v9, v10
    v_mov_b32 v10, v9
    s_nop 1
    v_permlane16_swap_b32 v9, v10
    v_max_f32 v9, v9, v10
    v_mul_f32 v28, s44, v9
    v_fma_f32 v12, v12, s44, -v28
    v_fma_f32 v13, v13, s44, -v28
    v_fma_f32 v14, v14, s44, -v28
    v_fma_f32 v15, v15, s44, -v28
    v_exp_f32 v12, v12
    v_exp_f32 v13, v13
    v_fma_f32 v16, v16, s44, -v28
    v_fma_f32 v17, v17, s44, -v28
    v_exp_f32 v14, v14
    v_exp_f32 v15, v15
    v_cvt_pk_bf16_f32 v36, v12, v13
    v_fma_f32 v18, v18, s44, -v28
    v_fma_f32 v19, v19, s44, -v28
    v_exp_f32 v16, v16
    v_exp_f32 v17, v17
    v_cvt_pk_bf16_f32 v37, v14, v15
    v_fma_f32 v24, v24, s44, -v28
    v_fma_f32 v25, v25, s44, -v28
    v_exp_f32 v18, v18
    v_exp_f32 v19, v19
    v_cvt_pk_bf16_f32 v38, v16, v17
    v_exp_f32 v24, v24
    v_exp_f32 v25, v25
    v_cvt_pk_bf16_f32 v39, v18, v19
    v_cvt_pk_bf16_f32 v40, v24, v25
    v_cvt_pk_bf16_f32 v43, v24, v25
    v_mfma_f32_16x16x32_bf16 v[52:55], v[20:23], v[36:39], 0
    v_mov_b64 v[12:13], 0
    v_mov_b64 v[14:15], 0
    s_waitcnt vmcnt(4)
    v_mfma_f32_16x16x32_bf16 v[44:47], v[64:67], v[36:39], 0
    v_mov_b64 v[24:25], 0
    v_mov_b64 v[26:27], 0
    s_waitcnt vmcnt(3)
    v_mfma_f32_16x16x32_bf16 v[48:51], v[68:71], v[36:39], 0
    ds_read_b128 v[64:67], v8 offset:20480
    ds_read_b128 v[68:71], v8 offset:21504
    v_mfma_f32_16x16x16_bf16 v[52:55], v[20:21], v[40:41], v[52:55]
    v_mfma_f32_16x16x16_bf16 v[44:47], v[30:31], v[40:41], v[44:47]
    v_mov_b64 v[20:21], 0
    v_mov_b64 v[22:23], 0
    v_mfma_f32_16x16x16_bf16 v[48:51], v[30:31], v[42:43], v[48:51]
    v_mov_b64 v[36:37], 0
    v_mov_b64 v[38:39], 0
    v_mov_b64 v[40:41], 0
    v_mov_b64 v[42:43], 0
    v_rcp_f32 v9, v52
    v_mov_b64 v[52:53], 0
    v_mov_b64 v[54:55], 0
    v_mul_f32 v44, v9, v44
    v_mul_f32 v48, v9, v48
    v_cvt_pk_bf16_f32 v16, v44, v48
    v_mul_f32 v45, v9, v45
    v_mul_f32 v49, v9, v49
    v_cvt_pk_bf16_f32 v17, v45, v49
    v_mul_f32 v46, v9, v46
    v_mul_f32 v50, v9, v50
    v_cvt_pk_bf16_f32 v18, v46, v50
    v_mul_f32 v47, v9, v47
    v_mul_f32 v51, v9, v51
    v_cvt_pk_bf16_f32 v19, v47, v51
    ds_write_b128 v5, v[16:19]
    v_mov_b64 v[28:29], 0
    v_mov_b64 v[30:31], 0
    s_waitcnt lgkmcnt(0)
    s_barrier
    ds_read_b128 v[44:47], v4 offset:0
    ds_read_b128 v[48:51], v4 offset:128
    v_mov_b64 v[16:17], 0
    v_mov_b64 v[18:19], 0
    buffer_load_dwordx4 v0, s[8:11], s41 offen offset:0 lds
    buffer_load_dwordx4 v0, s[8:11], s41 offen offset:1024 lds
    s_waitcnt lgkmcnt(1)
    v_smfmac_f32_16x16x64_bf16 v[12:15], v[44:47], a[184:191], v1
    s_waitcnt lgkmcnt(0)
    v_smfmac_f32_16x16x64_bf16 v[12:15], v[48:51], a[192:199], v1
    v_smfmac_f32_16x16x64_bf16 v[24:27], v[44:47], a[200:207], v1
    v_smfmac_f32_16x16x64_bf16 v[24:27], v[48:51], a[208:215], v1
    v_add_f32 v12, v12, v14
    v_smfmac_f32_16x16x64_bf16 v[20:23], v[44:47], a[216:223], v1
    v_add_f32 v13, v13, v15
    v_smfmac_f32_16x16x64_bf16 v[20:23], v[48:51], a[224:231], v1
    v_cvt_pk_bf16_f32 v12, v12, v13
    v_smfmac_f32_16x16x64_bf16 v[16:19], v[44:47], a[232:239], v1
    v_add_f32 v24, v24, v26
    v_smfmac_f32_16x16x64_bf16 v[16:19], v[48:51], a[240:247], v1
    v_add_f32 v25, v25, v27
    v_smfmac_f32_16x16x64_bf16 v[36:39], v[44:47], v[56:63], v1
    v_cvt_pk_bf16_f32 v13, v24, v25
    v_smfmac_f32_16x16x64_bf16 v[36:39], v[48:51], v[64:71], v1
    v_add_f32 v20, v20, v22
    v_add_f32 v21, v21, v23
    v_cvt_pk_bf16_f32 v14, v20, v21
    v_add_f32 v16, v16, v18
    v_add_f32 v17, v17, v19
    v_cvt_pk_bf16_f32 v15, v16, v17
    v_and_or_b32 v15, v15, -2, s40
    buffer_store_dwordx4 v[12:15], v0, s[8:11], s38 offen
    s_nop 0
    ds_read_b128 v[12:15], v8 offset:18432
    ds_read_b128 v[16:19], v8 offset:19456
    ds_read_b128 v[20:23], v8 offset:22528
    ds_read_b128 v[24:27], v8 offset:23552
    ds_read_b128 v[56:59], v8 offset:24576
    ds_read_b128 v[60:63], v8 offset:25600
    ds_read_b128 v[64:67], v8 offset:28672
    ds_read_b128 v[68:71], v8 offset:29696
    s_waitcnt lgkmcnt(6)
    v_smfmac_f32_16x16x64_bf16 v[40:43], v[44:47], v[12:19], v1
    ds_read_b128 v[12:15], v8 offset:26624
    ds_read_b128 v[16:19], v8 offset:27648
    s_waitcnt lgkmcnt(6)
    v_smfmac_f32_16x16x64_bf16 v[40:43], v[48:51], v[20:27], v1
    ds_read_b128 v[20:23], v8 offset:30720
    ds_read_b128 v[24:27], v8 offset:31744
    s_waitcnt lgkmcnt(6)
    v_smfmac_f32_16x16x64_bf16 v[52:55], v[44:47], v[56:63], v1
    ds_read_b128 v[56:59], v8 offset:32768
    ds_read_b128 v[60:63], v8 offset:33792
    s_waitcnt lgkmcnt(6)
    v_smfmac_f32_16x16x64_bf16 v[52:55], v[48:51], v[64:71], v1
    s_waitcnt lgkmcnt(4)
    v_smfmac_f32_16x16x64_bf16 v[32:35], v[44:47], v[12:19], v1
    s_waitcnt lgkmcnt(2)
    v_smfmac_f32_16x16x64_bf16 v[32:35], v[48:51], v[20:27], v1
    v_smfmac_f32_16x16x64_bf16 v[28:31], v[44:47], a[248:255], v1
    s_waitcnt lgkmcnt(0)
    v_smfmac_f32_16x16x64_bf16 v[28:31], v[48:51], v[56:63], v1
    v_add_f32 v36, v36, v38
    v_add_f32 v37, v37, v39
    v_cvt_pk_bf16_f32 v36, v36, v37
    v_add_f32 v40, v40, v42
    v_add_f32 v41, v41, v43
    v_cvt_pk_bf16_f32 v37, v40, v41
    v_add_f32 v52, v52, v54
    v_add_f32 v53, v53, v55
    v_cvt_pk_bf16_f32 v38, v52, v53
    v_add_f32 v32, v32, v34
    v_add_f32 v33, v33, v35
    v_cvt_pk_bf16_f32 v39, v32, v33
    v_and_or_b32 v39, v39, -2, s40
    s_add_u32 s17, s38, 4096
    buffer_store_dwordx4 v[36:39], v0, s[8:11], s17 offen
    v_add_f32 v28, v28, v30
    v_add_f32 v29, v29, v31
    v_cvt_pk_bf16_f32 v28, v28, v29
    v_and_or_b32 v28, v28, -2, s40
    v_lshrrev_b32 v9, 2, v0
    buffer_store_dword v28, v9, s[8:11], s39 offen
    s_xor_b32 s34, s34, 16384
    s_xor_b32 s35, s35, 16384
    s_add_u32 s33, s33, 1
    s_add_u32 s42, s42, 262144
    s_add_u32 s41, s41, 262144
    s_add_u32 s43, s43, 131072
    s_add_u32 s68, s68, 262144
    s_add_u32 s66, s66, 22528
    s_xor_b32 s40, s40, 1
    ds_read_b128 v[56:59], v8 offset:0
    ds_read_b128 v[60:63], v8 offset:1024
    ds_read_b128 v[64:67], v8 offset:2048
    ds_read_b128 v[68:71], v8 offset:3072
    v_mov_b64 v[12:13], 0
    v_mov_b64 v[14:15], 0
    v_mov_b64 v[16:17], 0
    v_mov_b64 v[18:19], 0
    v_mov_b64 v[20:21], 0
    v_mov_b64 v[22:23], 0
    v_mov_b64 v[24:25], 0
    v_mov_b64 v[26:27], 0
    v_mov_b64 v[28:29], 0
    v_mov_b64 v[30:31], 0
    v_mov_b64 v[32:33], 0
    v_mov_b64 v[34:35], 0
    s_sleep 5
    s_nop 9
    buffer_load_dwordx4 v[36:39], v0, s[8:11], s34 offen sc1
    s_nop 15
    s_nop 8
    buffer_load_dwordx4 v[36:39], v0, s[8:11], s34 offen sc1
    s_nop 15
    s_nop 8
    buffer_load_dwordx4 v[36:39], v0, s[8:11], s34 offen sc1
    s_waitcnt lgkmcnt(0)
    s_branch Lr3f_step
Lr3f_pb_re:
    s_mov_b32 s16, 0
Lr3f_pb_lp:
    s_add_u32 s17, s34, 4096
    buffer_load_dwordx4 v[40:43], v0, s[8:11], s17 offen sc1
    s_add_u32 s16, s16, 1
    s_cmp_gt_u32 s16, 100000
    s_cbranch_scc1 Lr_abort
    s_waitcnt vmcnt(0)
    v_max3_u32 v10, v40, v41, v42
    v_max_u32 v10, v10, v43
    v_cmp_eq_u32 vcc, -1, v10
    s_nop 0
    s_cbranch_vccnz Lr3f_pb_lp
    s_branch Lr3f_pb_ok
Lr3f_pc_re:
    s_mov_b32 s16, 0
Lr3f_pc_lp:
    buffer_load_dwordx4 v[44:47], v0, s[8:11], s35 offen sc1
    s_add_u32 s16, s16, 1
    s_cmp_gt_u32 s16, 100000
    s_cbranch_scc1 Lr_abort
    s_waitcnt vmcnt(0)
    v_max3_u32 v10, v44, v45, v46
    v_max_u32 v10, v10, v47
    v_cmp_eq_u32 vcc, -1, v10
    s_nop 0
    s_cbranch_vccnz Lr3f_pc_lp
    s_branch Lr3f_pc_ok
Lr3f_last:
    s_waitcnt vmcnt(0) lgkmcnt(0)
    s_barrier
    s_branch Lr_exit
L_slow:
    s_cmp_lg_u32 s14, 0
    s_cbranch_scc1 L_w1_0
    s_mov_b32 s16, 0
    s_add_u32 s17, s66, 128
    v_lshrrev_b32 v10, 2, v0
    v_and_b32 v9, 16, v10
    v_lshlrev_b32 v9, 3, v9
    v_and_or_b32 v10, v10, 12, v9
Lr0s_fw_15:
    buffer_load_dword v9, v10, s[8:11], s17 offen sc1
    s_add_u32 s16, s16, 1
    s_cmp_gt_u32 s16, 100000
    s_cbranch_scc1 Lr_abort
    s_waitcnt vmcnt(0)
    v_cmp_eq_u32 vcc, 0, v9
    s_nop 0
    s_cbranch_vccnz Lr0s_fw_15
    s_mov_b32 m0, 15104
    s_nop 0
    buffer_load_dwordx4 v0, s[8:11], s41 offen offset:0 lds
    buffer_load_dwordx4 v0, s[8:11], s41 offen offset:1024 lds
    s_add_u32 s41, s41, 262144
    s_add_u32 s68, s68, 4278452224
    s_waitcnt vmcnt(0)
    ds_read_b128 v[56:59], v8 offset:0
    ds_read_b128 v[60:63], v8 offset:1024
    ds_read_b128 v[64:67], v8 offset:2048
    ds_read_b128 v[68:71], v8 offset:3072
    v_mov_b64 v[12:13], 0
    v_mov_b64 v[14:15], 0
    v_mov_b64 v[16:17], 0
    v_mov_b64 v[18:19], 0
    v_mov_b64 v[20:21], 0
    v_mov_b64 v[22:23], 0
    v_mov_b64 v[24:25], 0
    v_mov_b64 v[26:27], 0
    v_mov_b64 v[28:29], 0
    v_mov_b64 v[30:31], 0
    v_mov_b64 v[32:33], 0
    v_mov_b64 v[34:35], 0
    buffer_load_dwordx4 v[36:39], v0, s[8:11], s34 offen sc1
    s_waitcnt vmcnt(0) lgkmcnt(0)
Lr0s_step:
    s_mov_b32 s16, 0
Lr0s_alp:
    s_waitcnt vmcnt(2)
    v_max3_u32 v10, v36, v37, v38
    v_max_u32 v10, v10, v39
    v_cmp_eq_u32 vcc, -1, v10
    s_nop 0
    s_cbranch_vccz Lr0s_aok
    buffer_load_dwordx4 v[36:39], v0, s[8:11], s34 offen sc1
    s_add_u32 s16, s16, 1
    s_cmp_gt_u32 s16, 100000
    s_cbranch_scc1 Lr_abort
    s_branch Lr0s_alp
Lr0s_aok:
    ds_write_b128 v0, v[36:39] offset:6912
    v_smfmac_f32_16x16x64_bf16 v[12:15], v[36:39], v[72:79], v1
    v_smfmac_f32_16x16x64_bf16 v[16:19], v[36:39], v[80:87], v1
    v_smfmac_f32_16x16x64_bf16 v[20:23], v[36:39], v[184:191], v1
    s_waitcnt lgkmcnt(0)
    s_barrier
    ds_read_b128 v[48:51], v0 offset:7936
    ds_read_b128 v[52:55], v0 offset:8960
    v_smfmac_f32_16x16x64_bf16 v[28:31], v[36:39], v[56:63], v1
    ds_read_b128 v[56:59], v8 offset:4096
    ds_read_b128 v[60:63], v8 offset:5120
    s_add_u32 s17, s34, 4096
    buffer_load_dwordx4 v[40:43], v0, s[8:11], s17 offen sc1
    v_smfmac_f32_16x16x64_bf16 v[24:27], v[36:39], v[192:199], v1
    v_smfmac_f32_16x16x64_bf16 v[32:35], v[36:39], v[64:71], v1
    ds_read_b128 v[64:67], v8 offset:6144
    ds_read_b128 v[68:71], v8 offset:7168
    s_waitcnt vmcnt(1)
    ds_read_b128 v[36:39], v0 offset:9984
    s_waitcnt lgkmcnt(6)
    v_smfmac_f32_16x16x64_bf16 v[28:31], v[48:51], a[72:79], v1
    v_smfmac_f32_16x16x64_bf16 v[12:15], v[48:51], v[88:95], v1
    buffer_load_dwordx4 v[44:47], v0, s[8:11], s35 offen sc1
    v_smfmac_f32_16x16x64_bf16 v[16:19], v[48:51], v[96:103], v1
    v_smfmac_f32_16x16x64_bf16 v[32:35], v[48:51], a[80:87], v1
    v_smfmac_f32_16x16x64_bf16 v[20:23], v[48:51], v[200:207], v1
    v_smfmac_f32_16x16x64_bf16 v[24:27], v[48:51], v[208:215], v1
    s_waitcnt lgkmcnt(3)
    v_smfmac_f32_16x16x64_bf16 v[28:31], v[52:55], v[56:63], v1
    ds_read_b128 v[56:59], v8 offset:8192
    ds_read_b128 v[60:63], v8 offset:9216
    v_smfmac_f32_16x16x64_bf16 v[12:15], v[52:55], v[104:111], v1
    v_smfmac_f32_16x16x64_bf16 v[16:19], v[52:55], v[112:119], v1
    s_waitcnt lgkmcnt(3)
    v_smfmac_f32_16x16x64_bf16 v[32:35], v[52:55], v[64:71], v1
    ds_read_b128 v[64:67], v8 offset:10240
    ds_read_b128 v[68:71], v8 offset:11264
    v_smfmac_f32_16x16x64_bf16 v[20:23], v[52:55], v[216:223], v1
    v_smfmac_f32_16x16x64_bf16 v[24:27], v[52:55], v[224:231], v1
    s_waitcnt lgkmcnt(4)
    v_smfmac_f32_16x16x64_bf16 v[28:31], v[36:39], a[88:95], v1
    v_smfmac_f32_16x16x64_bf16 v[12:15], v[36:39], v[120:127], v1
    v_smfmac_f32_16x16x64_bf16 v[16:19], v[36:39], v[128:135], v1
    v_smfmac_f32_16x16x64_bf16 v[32:35], v[36:39], a[96:103], v1
    v_smfmac_f32_16x16x64_bf16 v[20:23], v[36:39], v[232:239], v1
    v_smfmac_f32_16x16x64_bf16 v[24:27], v[36:39], v[240:247], v1
    s_waitcnt vmcnt(1)
    v_max3_u32 v10, v40, v41, v42
    v_max_u32 v10, v10, v43
    v_cmp_eq_u32 vcc, -1, v10
    s_nop 0
    s_cbranch_vccnz Lr0s_pb_re
Lr0s_pb_ok:
    ds_write_b128 v0, v[40:43] offset:11008
    s_waitcnt lgkmcnt(3)
    v_smfmac_f32_16x16x64_bf16 v[12:15], v[40:43], v[56:63], v1
    ds_read_b128 v[56:59], v8 offset:12288
    ds_read_b128 v[60:63], v8 offset:13312
    v_smfmac_f32_16x16x64_bf16 v[20:23], v[40:43], v[248:255], v1
    s_waitcnt lgkmcnt(3)
    v_smfmac_f32_16x16x64_bf16 v[16:19], v[40:43], v[64:71], v1
    ds_read_b128 v[64:67], v8 offset:14336
    ds_read_b128 v[68:71], v8 offset:15360
    v_smfmac_f32_16x16x64_bf16 v[24:27], v[40:43], a[0:7], v1
    s_waitcnt lgkmcnt(4)
    s_barrier
    ds_read_b128 v[48:51], v0 offset:13056
    ds_read_b128 v[52:55], v0 offset:12032
    ds_read_b128 v[36:39], v0 offset:14080
    v_smfmac_f32_16x16x64_bf16 v[28:31], v[40:43], a[104:111], v1
    v_smfmac_f32_16x16x64_bf16 v[32:35], v[40:43], a[112:119], v1
    s_waitcnt lgkmcnt(2)
    v_smfmac_f32_16x16x64_bf16 v[12:15], v[48:51], v[56:63], v1
    v_smfmac_f32_16x16x64_bf16 v[16:19], v[48:51], v[64:71], v1
    s_waitcnt lgkmcnt(1)
    v_smfmac_f32_16x16x64_bf16 v[12:15], v[52:55], v[136:143], v1
    v_smfmac_f32_16x16x64_bf16 v[16:19], v[52:55], v[144:151], v1
    s_waitcnt lgkmcnt(0)
    v_smfmac_f32_16x16x64_bf16 v[12:15], v[36:39], v[152:159], v1
    v_smfmac_f32_16x16x64_bf16 v[16:19], v[36:39], v[160:167], v1
    s_waitcnt vmcnt(0)
    v_max3_u32 v10, v44, v45, v46
    v_max_u32 v10, v10, v47
    v_cmp_eq_u32 vcc, -1, v10
    s_nop 0
    s_cbranch_vccnz Lr0s_pc_re
Lr0s_pc_ok:
    v_smfmac_f32_16x16x64_bf16 v[12:15], v[44:47], v[168:175], v1
    v_smfmac_f32_16x16x64_bf16 v[16:19], v[44:47], v[176:183], v1
    v_smfmac_f32_16x16x64_bf16 v[20:23], v[48:51], a[24:31], v1
    buffer_load_dwordx4 v[64:67], v0, s[8:11], s42 offen
    v_smfmac_f32_16x16x64_bf16 v[24:27], v[48:51], a[32:39], v1
    v_smfmac_f32_16x16x64_bf16 v[20:23], v[52:55], a[8:15], v1
    v_add_f32 v12, v12, v14
    v_smfmac_f32_16x16x64_bf16 v[24:27], v[52:55], a[16:23], v1
    v_add_f32 v16, v16, v18
    v_smfmac_f32_16x16x64_bf16 v[20:23], v[36:39], a[40:47], v1
    v_add_f32 v13, v13, v15
    buffer_load_dwordx4 v[68:71], v0, s[8:11], s42 offen offset:1024
    v_smfmac_f32_16x16x64_bf16 v[24:27], v[36:39], a[48:55], v1
    v_add_f32 v17, v17, v19
    v_smfmac_f32_16x16x64_bf16 v[20:23], v[44:47], a[56:63], v1
    v_cvt_pk_bf16_f32 v14, v12, v16
    ds_read_b128 v[56:59], v0 offset:15104
    v_smfmac_f32_16x16x64_bf16 v[24:27], v[44:47], a[64:71], v1
    v_cvt_pk_bf16_f32 v15, v13, v17
    ds_read_b128 v[60:63], v0 offset:16128
    ds_write_b32 v2, v14 offset:576
    ds_write_b32 v2, v15 offset:864
    v_smfmac_f32_16x16x64_bf16 v[28:31], v[48:51], a[136:143], v1
    v_smfmac_f32_16x16x64_bf16 v[32:35], v[48:51], a[144:151], v1
    v_add_f32 v20, v20, v22
    v_add_f32 v24, v24, v26
    v_add_f32 v21, v21, v23
    v_add_f32 v25, v25, v27
    v_cvt_pk_bf16_f32 v22, v20, v24
    v_cvt_pk_bf16_f32 v23, v21, v25
    ds_write_b32 v2, v22 offset:0
    ds_write_b32 v2, v23 offset:288
    v_smfmac_f32_16x16x64_bf16 v[28:31], v[52:55], a[120:127], v1
    v_smfmac_f32_16x16x64_bf16 v[32:35], v[52:55], a[128:135], v1
    s_waitcnt lgkmcnt(0)
    s_barrier
    ds_read_b128 v[40:43], v3 offset:0
    ds_read_b128 v[48:51], v3 offset:64
    ds_read_b128 v[20:23], v3 offset:128
    ds_read_b128 v[52:55], v3 offset:192
    v_smfmac_f32_16x16x64_bf16 v[28:31], v[36:39], a[152:159], v1
    v_smfmac_f32_16x16x64_bf16 v[32:35], v[36:39], a[160:167], v1
    ds_read_b128 v[36:39], v0 offset:17152
    v_lshlrev_b32 v9, 3, v0
    buffer_load_dword v11, v9, s[8:11], s68 offen
    v_smfmac_f32_16x16x64_bf16 v[28:31], v[44:47], a[168:175], v1
    v_smfmac_f32_16x16x64_bf16 v[32:35], v[44:47], a[176:183], v1
    ds_read_b128 v[44:47], v0 offset:18176
    s_waitcnt lgkmcnt(5)
    v_mfma_f32_16x16x32_bf16 v[12:15], v[56:59], v[40:43], 0
    v_mfma_f32_16x16x32_bf16 v[16:19], v[60:63], v[40:43], 0
    v_mfma_f32_16x16x32_bf16 v[24:27], v[40:43], v[40:43], 0
    ds_read_b128 v[56:59], v0 offset:19200
    ds_read_b128 v[60:63], v0 offset:20224
    s_waitcnt lgkmcnt(3)
    v_mfma_f32_16x16x32_bf16 v[12:15], v[36:39], v[48:51], v[12:15]
    v_lshrrev_b32 v10, 1, v0
    v_lshrrev_b32 v9, 9, v0
    s_waitcnt lgkmcnt(2)
    v_mfma_f32_16x16x32_bf16 v[16:19], v[44:47], v[48:51], v[16:19]
    v_lshl_add_u32 v9, v9, 5, v10
    v_add_f32 v28, v28, v30
    v_mfma_f32_16x16x32_bf16 v[24:27], v[48:51], v[48:51], v[24:27]
    v_add_f32 v32, v32, v34
    v_add_f32 v29, v29, v31
    ds_read_b128 v[36:39], v0 offset:21248
    ds_read_b128 v[44:47], v0 offset:22272
    s_waitcnt lgkmcnt(3)
    v_mfma_f32_16x16x32_bf16 v[12:15], v[56:59], v[20:23], v[12:15]
    v_add_f32 v33, v33, v35
    v_cvt_pk_bf16_f32 v30, v28, v29
    s_waitcnt lgkmcnt(2)
    v_mfma_f32_16x16x32_bf16 v[16:19], v[60:63], v[20:23], v[16:19]
    v_cvt_pk_bf16_f32 v31, v32, v33
    ds_read_b64 v[34:35], v9 offset:0
    v_mfma_f32_16x16x32_bf16 v[24:27], v[20:23], v[20:23], v[24:27]
    s_add_u32 s17, s43, 2048
    buffer_store_dwordx2 v[30:31], v10, s[8:11], s17 offen sc1
    s_waitcnt lgkmcnt(2)
    v_mfma_f32_16x16x32_bf16 v[12:15], v[36:39], v[52:55], v[12:15]
    s_waitcnt lgkmcnt(1)
    v_mfma_f32_16x16x32_bf16 v[16:19], v[44:47], v[52:55], v[16:19]
    v_mfma_f32_16x16x32_bf16 v[24:27], v[52:55], v[52:55], v[24:27]
    s_add_u32 s17, s43, 0
    s_waitcnt lgkmcnt(0)
    buffer_store_dwordx2 v[34:35], v10, s[8:11], s17 offen sc1
    s_cmp_eq_u32 s33, 63
    s_cbranch_scc1 Lr0s_last
    ds_read_b128 v[56:59], v8 offset:16384
    ds_read_b128 v[60:63], v8 offset:17408
    v_mov_b64 v[20:21], s[52:53]
    v_mov_b64 v[22:23], s[52:53]
    v_mov_b32 v41, 0
    v_mov_b32 v42, 0
    v_max3_f32 v9, v12, v13, v14
    v_max3_f32 v9, v9, v15, v16
    v_max3_f32 v9, v9, v17, v18
    v_max3_f32 v9, v9, v19, v24
    v_max_f32 v9, v9, v25
    v_mov_b32 v10, v9
    v_mov_b64 v[32:33], 0
    v_mov_b64 v[34:35], 0
    v_permlane32_swap_b32 v9, v10
    v_max_f32 v9, v9, v10
    v_mov_b32 v10, v9
    s_nop 1
    v_permlane16_swap_b32 v9, v10
    v_max_f32 v9, v9, v10
    v_mul_f32 v28, s44, v9
    v_fma_f32 v12, v12, s44, -v28
    v_fma_f32 v13, v13, s44, -v28
    v_fma_f32 v14, v14, s44, -v28
    v_fma_f32 v15, v15, s44, -v28
    v_exp_f32 v12, v12
    v_exp_f32 v13, v13
    v_fma_f32 v16, v16, s44, -v28
    v_fma_f32 v17, v17, s44, -v28
    v_exp_f32 v14, v14
    v_exp_f32 v15, v15
    v_cvt_pk_bf16_f32 v36, v12, v13
    v_fma_f32 v18, v18, s44, -v28
    v_fma_f32 v19, v19, s44, -v28
    v_exp_f32 v16, v16
    v_exp_f32 v17, v17
    v_cvt_pk_bf16_f32 v37, v14, v15
    v_fma_f32 v24, v24, s44, -v28
    v_fma_f32 v25, v25, s44, -v28
    v_exp_f32 v18, v18
    v_exp_f32 v19, v19
    v_cvt_pk_bf16_f32 v38, v16, v17
    v_exp_f32 v24, v24
    v_exp_f32 v25, v25
    v_cvt_pk_bf16_f32 v39, v18, v19
    v_cvt_pk_bf16_f32 v40, v24, v25
    v_cvt_pk_bf16_f32 v43, v24, v25
    v_mfma_f32_16x16x32_bf16 v[52:55], v[20:23], v[36:39], 0
    v_mov_b64 v[12:13], 0
    v_mov_b64 v[14:15], 0
    s_waitcnt vmcnt(4)
    v_mfma_f32_16x16x32_bf16 v[44:47], v[64:67], v[36:39], 0
    v_mov_b64 v[24:25], 0
    v_mov_b64 v[26:27], 0
    s_waitcnt vmcnt(3)
    v_mfma_f32_16x16x32_bf16 v[48:51], v[68:71], v[36:39], 0
    ds_read_b128 v[64:67], v8 offset:20480
    ds_read_b128 v[68:71], v8 offset:21504
    v_mfma_f32_16x16x16_bf16 v[52:55], v[20:21], v[40:41], v[52:55]
    v_mfma_f32_16x16x16_bf16 v[44:47], v[30:31], v[40:41], v[44:47]
    v_mov_b64 v[20:21], 0
    v_mov_b64 v[22:23], 0
    v_mfma_f32_16x16x16_bf16 v[48:51], v[30:31], v[42:43], v[48:51]
    v_mov_b64 v[36:37], 0
    v_mov_b64 v[38:39], 0
    v_mov_b64 v[40:41], 0
    v_mov_b64 v[42:43], 0
    v_rcp_f32 v9, v52
    v_mov_b64 v[52:53], 0
    v_mov_b64 v[54:55], 0
    v_mul_f32 v44, v9, v44
    v_mul_f32 v48, v9, v48
    v_cvt_pk_bf16_f32 v16, v44, v48
    v_mul_f32 v45, v9, v45
    v_mul_f32 v49, v9, v49
    v_cvt_pk_bf16_f32 v17, v45, v49
    v_mul_f32 v46, v9, v46
    v_mul_f32 v50, v9, v50
    v_cvt_pk_bf16_f32 v18, v46, v50
    v_mul_f32 v47, v9, v47
    v_mul_f32 v51, v9, v51
    v_cvt_pk_bf16_f32 v19, v47, v51
    ds_write_b128 v5, v[16:19]
    v_mov_b64 v[28:29], 0
    v_mov_b64 v[30:31], 0
    s_waitcnt lgkmcnt(0)
    s_barrier
    ds_read_b128 v[44:47], v4 offset:0
    ds_read_b128 v[48:51], v4 offset:128
    v_mov_b64 v[16:17], 0
    v_mov_b64 v[18:19], 0
    buffer_load_dwordx4 v0, s[8:11], s41 offen offset:0 lds
    buffer_load_dwordx4 v0, s[8:11], s41 offen offset:1024 lds
    s_waitcnt lgkmcnt(1)
    v_smfmac_f32_16x16x64_bf16 v[12:15], v[44:47], a[184:191], v1
    s_waitcnt lgkmcnt(0)
    v_smfmac_f32_16x16x64_bf16 v[12:15], v[48:51], a[192:199], v1
    v_smfmac_f32_16x16x64_bf16 v[24:27], v[44:47], a[200:207], v1
    v_smfmac_f32_16x16x64_bf16 v[24:27], v[48:51], a[208:215], v1
    v_add_f32 v12, v12, v14
    v_smfmac_f32_16x16x64_bf16 v[20:23], v[44:47], a[216:223], v1
    v_add_f32 v13, v13, v15
    v_smfmac_f32_16x16x64_bf16 v[20:23], v[48:51], a[224:231], v1
    v_cvt_pk_bf16_f32 v12, v12, v13
    v_smfmac_f32_16x16x64_bf16 v[16:19], v[44:47], a[232:239], v1
    v_add_f32 v24, v24, v26
    v_smfmac_f32_16x16x64_bf16 v[16:19], v[48:51], a[240:247], v1
    v_add_f32 v25, v25, v27
    v_smfmac_f32_16x16x64_bf16 v[36:39], v[44:47], v[56:63], v1
    v_cvt_pk_bf16_f32 v13, v24, v25
    v_smfmac_f32_16x16x64_bf16 v[36:39], v[48:51], v[64:71], v1
    v_add_f32 v20, v20, v22
    v_add_f32 v21, v21, v23
    v_cvt_pk_bf16_f32 v14, v20, v21
    v_add_f32 v16, v16, v18
    v_add_f32 v17, v17, v19
    v_cvt_pk_bf16_f32 v15, v16, v17
    v_and_or_b32 v15, v15, -2, s40
    buffer_store_dwordx4 v[12:15], v0, s[8:11], s38 offen sc1
    s_nop 0
    ds_read_b128 v[12:15], v8 offset:18432
    ds_read_b128 v[16:19], v8 offset:19456
    ds_read_b128 v[20:23], v8 offset:22528
    ds_read_b128 v[24:27], v8 offset:23552
    ds_read_b128 v[56:59], v8 offset:24576
    ds_read_b128 v[60:63], v8 offset:25600
    ds_read_b128 v[64:67], v8 offset:28672
    ds_read_b128 v[68:71], v8 offset:29696
    s_waitcnt lgkmcnt(6)
    v_smfmac_f32_16x16x64_bf16 v[40:43], v[44:47], v[12:19], v1
    ds_read_b128 v[12:15], v8 offset:26624
    ds_read_b128 v[16:19], v8 offset:27648
    s_waitcnt lgkmcnt(6)
    v_smfmac_f32_16x16x64_bf16 v[40:43], v[48:51], v[20:27], v1
    ds_read_b128 v[20:23], v8 offset:30720
    ds_read_b128 v[24:27], v8 offset:31744
    s_waitcnt lgkmcnt(6)
    v_smfmac_f32_16x16x64_bf16 v[52:55], v[44:47], v[56:63], v1
    ds_read_b128 v[56:59], v8 offset:32768
    ds_read_b128 v[60:63], v8 offset:33792
    s_waitcnt lgkmcnt(6)
    v_smfmac_f32_16x16x64_bf16 v[52:55], v[48:51], v[64:71], v1
    s_waitcnt lgkmcnt(4)
    v_smfmac_f32_16x16x64_bf16 v[32:35], v[44:47], v[12:19], v1
    s_waitcnt lgkmcnt(2)
    v_smfmac_f32_16x16x64_bf16 v[32:35], v[48:51], v[20:27], v1
    v_smfmac_f32_16x16x64_bf16 v[28:31], v[44:47], a[248:255], v1
    s_waitcnt lgkmcnt(0)
    v_smfmac_f32_16x16x64_bf16 v[28:31], v[48:51], v[56:63], v1
    buffer_load_dwordx4 v[12:15], v6, s[8:11], s62 offen sc1
    buffer_load_dwordx4 v[16:19], v6, s[8:11], s63 offen sc1
    buffer_load_dwordx4 v[20:23], v6, s[8:11], s64 offen sc1
    buffer_load_dwordx4 v[24:27], v6, s[8:11], s65 offen sc1
    v_add_f32 v36, v36, v38
    v_add_f32 v37, v37, v39
    v_cvt_pk_bf16_f32 v36, v36, v37
    v_add_f32 v40, v40, v42
    v_add_f32 v41, v41, v43
    v_cvt_pk_bf16_f32 v37, v40, v41
    v_add_f32 v52, v52, v54
    v_add_f32 v53, v53, v55
    v_cvt_pk_bf16_f32 v38, v52, v53
    v_add_f32 v32, v32, v34
    v_add_f32 v33, v33, v35
    v_cvt_pk_bf16_f32 v39, v32, v33
    v_and_or_b32 v39, v39, -2, s40
    s_add_u32 s17, s38, 4096
    buffer_store_dwordx4 v[36:39], v0, s[8:11], s17 offen sc1
    v_add_f32 v28, v28, v30
    v_add_f32 v29, v29, v31
    v_cvt_pk_bf16_f32 v28, v28, v29
    v_and_or_b32 v28, v28, -2, s40
    v_lshrrev_b32 v9, 2, v0
    buffer_store_dword v28, v9, s[8:11], s39 offen sc1
    v_add_u32 v10, 162560, v0
    ds_read_b128 v[64:67], v10
    s_nop 9
    buffer_load_dwordx4 v[40:43], v6, s[8:11], s62 offen sc1
    buffer_load_dwordx4 v[44:47], v6, s[8:11], s63 offen sc1
    buffer_load_dwordx4 v[48:51], v6, s[8:11], s64 offen sc1
    buffer_load_dwordx4 v[52:55], v6, s[8:11], s65 offen sc1
    s_add_u32 s33, s33, 1
    s_add_u32 s42, s42, 262144
    s_add_u32 s41, s41, 262144
    s_add_u32 s43, s43, 131072
    s_add_u32 s68, s68, 262144
    s_add_u32 s66, s66, 22528
    ds_read_b128 v[56:59], v8 offset:0
    ds_read_b128 v[60:63], v8 offset:1024
    s_waitcnt lgkmcnt(2)
    s_waitcnt vmcnt(9)
    v_mfma_f32_16x16x32_bf16 v[68:71], v[12:15], v[64:67], 0
    v_and_b32 v10, 1, v15
    v_cmp_ne_u32 s[54:55], s40, v10
    s_waitcnt vmcnt(8)
    v_mfma_f32_16x16x32_bf16 v[68:71], v[16:19], v[64:67], v[68:71]
    v_and_b32 v10, 1, v19
    v_cmp_ne_u32 s[56:57], s40, v10
    s_waitcnt vmcnt(7)
    v_mfma_f32_16x16x32_bf16 v[68:71], v[20:23], v[64:67], v[68:71]
    v_and_b32 v10, 1, v23
    v_cmp_ne_u32 s[58:59], s40, v10
    s_waitcnt vmcnt(6)
    v_mfma_f32_16x16x32_bf16 v[68:71], v[24:27], v[64:67], v[68:71]
    v_and_b32 v10, 1, v27
    v_cmp_ne_u32 s[60:61], s40, v10
    s_or_b64 vcc, s[54:55], s[56:57]
    s_or_b64 vcc, vcc, s[58:59]
    s_or_b64 vcc, vcc, s[60:61]
    s_cbranch_scc0 Lr0s_red
    s_mov_b32 s16, 0
Lr0s_p1:
    buffer_load_dwordx4 v[12:15], v6, s[8:11], s62 offen sc1
    buffer_load_dwordx4 v[16:19], v6, s[8:11], s63 offen sc1
    buffer_load_dwordx4 v[20:23], v6, s[8:11], s64 offen sc1
    buffer_load_dwordx4 v[24:27], v6, s[8:11], s65 offen sc1
    s_waitcnt vmcnt(7)
    v_mfma_f32_16x16x32_bf16 v[68:71], v[40:43], v[64:67], 0
    v_and_b32 v10, 1, v43
    v_cmp_ne_u32 s[54:55], s40, v10
    s_waitcnt vmcnt(6)
    v_mfma_f32_16x16x32_bf16 v[68:71], v[44:47], v[64:67], v[68:71]
    v_and_b32 v10, 1, v47
    v_cmp_ne_u32 s[56:57], s40, v10
    s_waitcnt vmcnt(5)
    v_mfma_f32_16x16x32_bf16 v[68:71], v[48:51], v[64:67], v[68:71]
    v_and_b32 v10, 1, v51
    v_cmp_ne_u32 s[58:59], s40, v10
    s_waitcnt vmcnt(4)
    v_mfma_f32_16x16x32_bf16 v[68:71], v[52:55], v[64:67], v[68:71]
    v_and_b32 v10, 1, v55
    v_cmp_ne_u32 s[60:61], s40, v10
    s_or_b64 vcc, s[54:55], s[56:57]
    s_or_b64 vcc, vcc, s[58:59]
    s_or_b64 vcc, vcc, s[60:61]
    s_cbranch_scc0 Lr0s_red
    buffer_load_dwordx4 v[40:43], v6, s[8:11], s62 offen sc1
    buffer_load_dwordx4 v[44:47], v6, s[8:11], s63 offen sc1
    buffer_load_dwordx4 v[48:51], v6, s[8:11], s64 offen sc1
    buffer_load_dwordx4 v[52:55], v6, s[8:11], s65 offen sc1
    s_add_u32 s16, s16, 1
    s_cmp_gt_u32 s16, 100000
    s_cbranch_scc1 Lr_abort
    s_waitcnt vmcnt(7)
    v_mfma_f32_16x16x32_bf16 v[68:71], v[12:15], v[64:67], 0
    v_and_b32 v10, 1, v15
    v_cmp_ne_u32 s[54:55], s40, v10
    s_waitcnt vmcnt(6)
    v_mfma_f32_16x16x32_bf16 v[68:71], v[16:19], v[64:67], v[68:71]
    v_and_b32 v10, 1, v19
    v_cmp_ne_u32 s[56:57], s40, v10
    s_waitcnt vmcnt(5)
    v_mfma_f32_16x16x32_bf16 v[68:71], v[20:23], v[64:67], v[68:71]
    v_and_b32 v10, 1, v23
    v_cmp_ne_u32 s[58:59], s40, v10
    s_waitcnt vmcnt(4)
    v_mfma_f32_16x16x32_bf16 v[68:71], v[24:27], v[64:67], v[68:71]
    v_and_b32 v10, 1, v27
    v_cmp_ne_u32 s[60:61], s40, v10
    s_or_b64 vcc, s[54:55], s[56:57]
    s_or_b64 vcc, vcc, s[58:59]
    s_or_b64 vcc, vcc, s[60:61]
    s_cbranch_scc1 Lr0s_p1
Lr0s_red:
    s_nop 1
    v_permlane16_swap_b32 v68, v70
    v_permlane16_swap_b32 v69, v71
    s_mov_b64 exec, s[46:47]
    v_add_f32 v68, v68, v70
    v_add_f32 v69, v69, v71
    v_cvt_pk_bf16_f32 v68, v68, v69
    v_min_u32 v68, s50, v68
    buffer_store_dword v68, v7, s[8:11], s36 offen sc1
    v_mov_b32 v69, -1
    buffer_store_dword v69, v7, s[8:11], s37 offen sc1
    s_mov_b64 exec, -1
    s_xor_b32 s34, s34, 16384
    s_xor_b32 s35, s35, 16384
    s_xor_b32 s40, s40, 1
    s_xor_b32 s36, s36, 16384
    s_xor_b32 s37, s37, 16384
    s_nop 15
    s_nop 3
    buffer_load_dwordx4 v[36:39], v0, s[8:11], s34 offen sc1
    s_waitcnt vmcnt(3)
    ds_read_b128 v[64:67], v8 offset:2048
    ds_read_b128 v[68:71], v8 offset:3072
    v_mov_b64 v[12:13], 0
    v_mov_b64 v[14:15], 0
    v_mov_b64 v[16:17], 0
    v_mov_b64 v[18:19], 0
    v_mov_b64 v[20:21], 0
    v_mov_b64 v[22:23], 0
    v_mov_b64 v[24:25], 0
    v_mov_b64 v[26:27], 0
    v_mov_b64 v[28:29], 0
    v_mov_b64 v[30:31], 0
    v_mov_b64 v[32:33], 0
    v_mov_b64 v[34:35], 0
    s_nop 9
    buffer_load_dwordx4 v[36:39], v0, s[8:11], s34 offen sc1
    s_nop 15
    s_nop 8
    buffer_load_dwordx4 v[36:39], v0, s[8:11], s34 offen sc1
    s_waitcnt lgkmcnt(0)
    s_branch Lr0s_step
Lr0s_pb_re:
    s_mov_b32 s16, 0
Lr0s_pb_lp:
    s_add_u32 s17, s34, 4096
    buffer_load_dwordx4 v[40:43], v0, s[8:11], s17 offen sc1
    s_add_u32 s16, s16, 1
    s_cmp_gt_u32 s16, 100000
    s_cbranch_scc1 Lr_abort
    s_waitcnt vmcnt(0)
    v_max3_u32 v10, v40, v41, v42
    v_max_u32 v10, v10, v43
    v_cmp_eq_u32 vcc, -1, v10
    s_nop 0
    s_cbranch_vccnz Lr0s_pb_lp
    s_branch Lr0s_pb_ok
Lr0s_pc_re:
    s_mov_b32 s16, 0
Lr0s_pc_lp:
    buffer_load_dwordx4 v[44:47], v0, s[8:11], s35 offen sc1
    s_add_u32 s16, s16, 1
    s_cmp_gt_u32 s16, 100000
    s_cbranch_scc1 Lr_abort
    s_waitcnt vmcnt(0)
    v_max3_u32 v10, v44, v45, v46
    v_max_u32 v10, v10, v47
    v_cmp_eq_u32 vcc, -1, v10
    s_nop 0
    s_cbranch_vccnz Lr0s_pc_lp
    s_branch Lr0s_pc_ok
Lr0s_last:
    s_waitcnt vmcnt(0) lgkmcnt(0)
    s_barrier
    s_branch Lr_exit
L_w1_0:
    s_cmp_lg_u32 s14, 1
    s_cbranch_scc1 L_w2_0
    s_mov_b32 s16, 0
    s_add_u32 s17, s66, 128
    v_lshrrev_b32 v10, 2, v0
    v_and_b32 v9, 16, v10
    v_lshlrev_b32 v9, 3, v9
    v_and_or_b32 v10, v10, 12, v9
Lr1s_fw_16:
    buffer_load_dword v9, v10, s[8:11], s17 offen sc1
    s_add_u32 s16, s16, 1
    s_cmp_gt_u32 s16, 100000
    s_cbranch_scc1 Lr_abort
    s_waitcnt vmcnt(0)
    v_cmp_eq_u32 vcc, 0, v9
    s_nop 0
    s_cbranch_vccnz Lr1s_fw_16
    s_lshl_b32 s67, s32, 5
    s_add_u32 s67, s67, s15
    s_lshl_b32 s67, s67, 12
    s_add_u32 s67, s67, 3145728
    s_mov_b32 m0, 17152
    s_nop 0
    buffer_load_dwordx4 v0, s[8:11], s41 offen offset:0 lds
    buffer_load_dwordx4 v0, s[8:11], s41 offen offset:1024 lds
    s_add_u32 s41, s41, 262144
    s_add_u32 s68, s68, 262144
    s_waitcnt vmcnt(0)
    ds_read_b128 v[56:59], v8 offset:4096
    ds_read_b128 v[60:63], v8 offset:5120
    ds_read_b128 v[64:67], v8 offset:6144
    ds_read_b128 v[68:71], v8 offset:7168
    v_mov_b64 v[12:13], 0
    v_mov_b64 v[14:15], 0
    v_mov_b64 v[16:17], 0
    v_mov_b64 v[18:19], 0
    v_mov_b64 v[20:21], 0
    v_mov_b64 v[22:23], 0
    v_mov_b64 v[24:25], 0
    v_mov_b64 v[26:27], 0
    v_mov_b64 v[28:29], 0
    v_mov_b64 v[30:31], 0
    v_mov_b64 v[32:33], 0
    v_mov_b64 v[34:35], 0
    buffer_load_dwordx4 v[36:39], v0, s[8:11], s34 offen sc1
    s_waitcnt vmcnt(0) lgkmcnt(0)
Lr1s_step:
    s_waitcnt vmcnt(3)
    v_max3_u32 v10, v36, v37, v38
    v_max_u32 v10, v10, v39
    v_cmp_eq_u32 vcc, -1, v10
    s_nop 0
    s_cbranch_vccz Lr1s_aok
    buffer_load_dwordx4 v[36:39], v0, s[8:11], s34 offen sc1
    s_nop 15
    s_nop 8
    buffer_load_dwordx4 v[36:39], v0, s[8:11], s34 offen sc1
    s_mov_b32 s16, 0
Lr1s_alp:
    s_waitcnt vmcnt(2)
    v_max3_u32 v10, v36, v37, v38
    v_max_u32 v10, v10, v39
    v_cmp_eq_u32 vcc, -1, v10
    s_nop 0
    s_cbranch_vccz Lr1s_aok
    buffer_load_dwordx4 v[36:39], v0, s[8:11], s34 offen sc1
    s_add_u32 s16, s16, 1
    s_cmp_gt_u32 s16, 100000
    s_cbranch_scc1 Lr_abort
    s_branch Lr1s_alp
Lr1s_aok:
    ds_write_b128 v0, v[36:39] offset:7936
    v_smfmac_f32_16x16x64_bf16 v[12:15], v[36:39], v[88:95], v1
    v_smfmac_f32_16x16x64_bf16 v[16:19], v[36:39], v[96:103], v1
    v_smfmac_f32_16x16x64_bf16 v[20:23], v[36:39], v[200:207], v1
    s_waitcnt lgkmcnt(0)
    s_barrier
    ds_read_b128 v[48:51], v0 offset:8960
    ds_read_b128 v[52:55], v0 offset:9984
    v_smfmac_f32_16x16x64_bf16 v[28:31], v[36:39], a[72:79], v1
    v_smfmac_f32_16x16x64_bf16 v[24:27], v[36:39], v[208:215], v1
    s_add_u32 s17, s34, 4096
    buffer_load_dwordx4 v[40:43], v0, s[8:11], s17 offen sc1
    v_smfmac_f32_16x16x64_bf16 v[32:35], v[36:39], a[80:87], v1
    s_waitcnt vmcnt(1)
    ds_read_b128 v[36:39], v0 offset:6912
    s_waitcnt lgkmcnt(2)
    v_smfmac_f32_16x16x64_bf16 v[28:31], v[48:51], v[56:63], v1
    ds_read_b128 v[56:59], v8 offset:0
    ds_read_b128 v[60:63], v8 offset:1024
    v_smfmac_f32_16x16x64_bf16 v[12:15], v[48:51], v[104:111], v1
    v_smfmac_f32_16x16x64_bf16 v[16:19], v[48:51], v[112:119], v1
    buffer_load_dwordx4 v[44:47], v0, s[8:11], s35 offen sc1
    v_smfmac_f32_16x16x64_bf16 v[32:35], v[48:51], v[64:71], v1
    ds_read_b128 v[64:67], v8 offset:2048
    ds_read_b128 v[68:71], v8 offset:3072
    v_smfmac_f32_16x16x64_bf16 v[20:23], v[48:51], v[216:223], v1
    v_smfmac_f32_16x16x64_bf16 v[24:27], v[48:51], v[224:231], v1
    s_waitcnt lgkmcnt(5)
    v_smfmac_f32_16x16x64_bf16 v[28:31], v[52:55], a[88:95], v1
    v_smfmac_f32_16x16x64_bf16 v[12:15], v[52:55], v[120:127], v1
    v_smfmac_f32_16x16x64_bf16 v[16:19], v[52:55], v[128:135], v1
    v_smfmac_f32_16x16x64_bf16 v[32:35], v[52:55], a[96:103], v1
    v_smfmac_f32_16x16x64_bf16 v[20:23], v[52:55], v[232:239], v1
    v_smfmac_f32_16x16x64_bf16 v[24:27], v[52:55], v[240:247], v1
    s_waitcnt lgkmcnt(2)
    v_smfmac_f32_16x16x64_bf16 v[28:31], v[36:39], v[56:63], v1
    ds_read_b128 v[56:59], v8 offset:12288
    ds_read_b128 v[60:63], v8 offset:13312
    v_smfmac_f32_16x16x64_bf16 v[12:15], v[36:39], v[72:79], v1
    v_smfmac_f32_16x16x64_bf16 v[16:19], v[36:39], v[80:87], v1
    s_waitcnt lgkmcnt(2)
    v_smfmac_f32_16x16x64_bf16 v[32:35], v[36:39], v[64:71], v1
    ds_read_b128 v[64:67], v8 offset:14336
    ds_read_b128 v[68:71], v8 offset:15360
    v_smfmac_f32_16x16x64_bf16 v[20:23], v[36:39], v[184:191], v1
    v_smfmac_f32_16x16x64_bf16 v[24:27], v[36:39], v[192:199], v1
    s_waitcnt vmcnt(1)
    v_max3_u32 v10, v40, v41, v42
    v_max_u32 v10, v10, v43
    v_cmp_eq_u32 vcc, -1, v10
    s_nop 0
    s_cbranch_vccnz Lr1s_pb_re
Lr1s_pb_ok:
    ds_write_b128 v0, v[40:43] offset:12032
    v_mov_b32 v9, 1
    v_mov_b32 v10, 0
    s_mov_b64 exec, 1
    buffer_store_dword v9, v10, s[8:11], s67 offen offset:384 sc1
    s_mov_b64 exec, -1
    v_smfmac_f32_16x16x64_bf16 v[12:15], v[40:43], v[136:143], v1
    v_smfmac_f32_16x16x64_bf16 v[20:23], v[40:43], a[8:15], v1
    v_smfmac_f32_16x16x64_bf16 v[16:19], v[40:43], v[144:151], v1
    v_smfmac_f32_16x16x64_bf16 v[24:27], v[40:43], a[16:23], v1
    s_waitcnt lgkmcnt(0)
    s_barrier
    ds_read_b128 v[48:51], v0 offset:13056
    ds_read_b128 v[52:55], v0 offset:14080
    ds_read_b128 v[36:39], v0 offset:11008
    v_smfmac_f32_16x16x64_bf16 v[28:31], v[40:43], a[120:127], v1
    v_smfmac_f32_16x16x64_bf16 v[32:35], v[40:43], a[128:135], v1
    s_waitcnt lgkmcnt(2)
    v_smfmac_f32_16x16x64_bf16 v[12:15], v[48:51], v[56:63], v1
    ds_read_b128 v[56:59], v8 offset:8192
    ds_read_b128 v[60:63], v8 offset:9216
    v_smfmac_f32_16x16x64_bf16 v[16:19], v[48:51], v[64:71], v1
    ds_read_b128 v[64:67], v8 offset:10240
    ds_read_b128 v[68:71], v8 offset:11264
    s_waitcnt lgkmcnt(5)
    v_smfmac_f32_16x16x64_bf16 v[12:15], v[52:55], v[152:159], v1
    v_smfmac_f32_16x16x64_bf16 v[16:19], v[52:55], v[160:167], v1
    s_waitcnt vmcnt(1)
    v_max3_u32 v10, v44, v45, v46
    v_max_u32 v10, v10, v47
    v_cmp_eq_u32 vcc, -1, v10
    s_nop 0
    s_cbranch_vccnz Lr1s_pc_re
Lr1s_pc_ok:
    v_smfmac_f32_16x16x64_bf16 v[12:15], v[44:47], v[168:175], v1
    v_smfmac_f32_16x16x64_bf16 v[16:19], v[44:47], v[176:183], v1
    s_waitcnt lgkmcnt(2)
    v_smfmac_f32_16x16x64_bf16 v[12:15], v[36:39], v[56:63], v1
    s_waitcnt lgkmcnt(0)
    v_smfmac_f32_16x16x64_bf16 v[16:19], v[36:39], v[64:71], v1
    v_smfmac_f32_16x16x64_bf16 v[20:23], v[48:51], a[24:31], v1
    v_smfmac_f32_16x16x64_bf16 v[24:27], v[48:51], a[32:39], v1
    buffer_load_dwordx4 v[64:67], v0, s[8:11], s42 offen
    v_smfmac_f32_16x16x64_bf16 v[20:23], v[52:55], a[40:47], v1
    v_add_f32 v12, v12, v14
    v_smfmac_f32_16x16x64_bf16 v[24:27], v[52:55], a[48:55], v1
    v_add_f32 v16, v16, v18
    v_smfmac_f32_16x16x64_bf16 v[20:23], v[36:39], v[248:255], v1
    v_add_f32 v13, v13, v15
    v_smfmac_f32_16x16x64_bf16 v[24:27], v[36:39], a[0:7], v1
    v_add_f32 v17, v17, v19
    buffer_load_dwordx4 v[68:71], v0, s[8:11], s42 offen offset:1024
    v_smfmac_f32_16x16x64_bf16 v[20:23], v[44:47], a[56:63], v1
    v_cvt_pk_bf16_f32 v14, v12, v16
    ds_read_b128 v[56:59], v0 offset:15104
    v_smfmac_f32_16x16x64_bf16 v[24:27], v[44:47], a[64:71], v1
    v_cvt_pk_bf16_f32 v15, v13, v17
    ds_read_b128 v[60:63], v0 offset:16128
    ds_write_b32 v2, v14 offset:576
    ds_write_b32 v2, v15 offset:864
    v_smfmac_f32_16x16x64_bf16 v[28:31], v[48:51], a[136:143], v1
    v_smfmac_f32_16x16x64_bf16 v[32:35], v[48:51], a[144:151], v1
    v_add_f32 v20, v20, v22
    v_add_f32 v24, v24, v26
    v_add_f32 v21, v21, v23
    v_add_f32 v25, v25, v27
    v_cvt_pk_bf16_f32 v22, v20, v24
    v_cvt_pk_bf16_f32 v23, v21, v25
    ds_write_b32 v2, v22 offset:0
    ds_write_b32 v2, v23 offset:288
    v_smfmac_f32_16x16x64_bf16 v[28:31], v[52:55], a[152:159], v1
    v_smfmac_f32_16x16x64_bf16 v[32:35], v[52:55], a[160:167], v1
    s_waitcnt lgkmcnt(0)
    s_barrier
    ds_read_b128 v[40:43], v3 offset:0
    ds_read_b128 v[48:51], v3 offset:64
    ds_read_b128 v[20:23], v3 offset:128
    ds_read_b128 v[52:55], v3 offset:192
    v_smfmac_f32_16x16x64_bf16 v[28:31], v[36:39], a[104:111], v1
    v_smfmac_f32_16x16x64_bf16 v[32:35], v[36:39], a[112:119], v1
    ds_read_b128 v[36:39], v0 offset:17152
    v_smfmac_f32_16x16x64_bf16 v[28:31], v[44:47], a[168:175], v1
    v_smfmac_f32_16x16x64_bf16 v[32:35], v[44:47], a[176:183], v1
    ds_read_b128 v[44:47], v0 offset:18176
    s_waitcnt lgkmcnt(5)
    v_mfma_f32_16x16x32_bf16 v[12:15], v[56:59], v[40:43], 0
    v_mfma_f32_16x16x32_bf16 v[16:19], v[60:63], v[40:43], 0
    v_mfma_f32_16x16x32_bf16 v[24:27], v[40:43], v[40:43], 0
    ds_read_b128 v[56:59], v0 offset:19200
    ds_read_b128 v[60:63], v0 offset:20224
    s_waitcnt lgkmcnt(3)
    v_mfma_f32_16x16x32_bf16 v[12:15], v[36:39], v[48:51], v[12:15]
    v_lshrrev_b32 v10, 1, v0
    v_lshrrev_b32 v9, 9, v0
    s_waitcnt lgkmcnt(2)
    v_mfma_f32_16x16x32_bf16 v[16:19], v[44:47], v[48:51], v[16:19]
    v_lshl_add_u32 v9, v9, 5, v10
    v_add_f32 v28, v28, v30
    v_mfma_f32_16x16x32_bf16 v[24:27], v[48:51], v[48:51], v[24:27]
    v_add_f32 v32, v32, v34
    v_add_f32 v29, v29, v31
    ds_read_b128 v[36:39], v0 offset:21248
    ds_read_b128 v[44:47], v0 offset:22272
    s_waitcnt lgkmcnt(3)
    v_mfma_f32_16x16x32_bf16 v[12:15], v[56:59], v[20:23], v[12:15]
    v_add_f32 v33, v33, v35
    v_cvt_pk_bf16_f32 v30, v28, v29
    s_waitcnt lgkmcnt(2)
    v_mfma_f32_16x16x32_bf16 v[16:19], v[60:63], v[20:23], v[16:19]
    v_cvt_pk_bf16_f32 v31, v32, v33
    ds_read_b64 v[34:35], v9 offset:1152
    v_mfma_f32_16x16x32_bf16 v[24:27], v[20:23], v[20:23], v[24:27]
    s_add_u32 s17, s43, 2560
    buffer_store_dwordx2 v[30:31], v10, s[8:11], s17 offen sc1
    s_waitcnt lgkmcnt(2)
    v_mfma_f32_16x16x32_bf16 v[12:15], v[36:39], v[52:55], v[12:15]
    s_waitcnt lgkmcnt(1)
    v_mfma_f32_16x16x32_bf16 v[16:19], v[44:47], v[52:55], v[16:19]
    v_mfma_f32_16x16x32_bf16 v[24:27], v[52:55], v[52:55], v[24:27]
    s_add_u32 s17, s43, 512
    s_waitcnt lgkmcnt(0)
    buffer_store_dwordx2 v[34:35], v10, s[8:11], s17 offen sc1
    s_cmp_eq_u32 s33, 63
    s_cbranch_scc1 Lr1s_last
    ds_read_b128 v[56:59], v8 offset:16384
    ds_read_b128 v[60:63], v8 offset:17408
    v_mov_b64 v[20:21], s[52:53]
    v_mov_b64 v[22:23], s[52:53]
    v_mov_b32 v41, 0
    v_mov_b32 v42, 0
    v_max3_f32 v9, v12, v13, v14
    v_max3_f32 v9, v9, v15, v16
    v_max3_f32 v9, v9, v17, v18
    v_max3_f32 v9, v9, v19, v24
    v_max_f32 v9, v9, v25
    v_mov_b32 v10, v9
    v_mov_b64 v[32:33], 0
    v_mov_b64 v[34:35], 0
    v_permlane32_swap_b32 v9, v10
    v_max_f32 v9, v9, v10
    v_mov_b32 v10, v9
    s_nop 1
    v_permlane16_swap_b32 v9, v10
    v_max_f32 v9, v9, v10
    v_mul_f32 v28, s44, v9
    v_fma_f32 v12, v12, s44, -v28
    v_fma_f32 v13, v13, s44, -v28
    v_fma_f32 v14, v14, s44, -v28
    v_fma_f32 v15, v15, s44, -v28
    v_exp_f32 v12, v12
    v_exp_f32 v13, v13
    v_fma_f32 v16, v16, s44, -v28
    v_fma_f32 v17, v17, s44, -v28
    v_exp_f32 v14, v14
    v_exp_f32 v15, v15
    v_cvt_pk_bf16_f32 v36, v12, v13
    v_fma_f32 v18, v18, s44, -v28
    v_fma_f32 v19, v19, s44, -v28
    v_exp_f32 v16, v16
    v_exp_f32 v17, v17
    v_cvt_pk_bf16_f32 v37, v14, v15
    v_fma_f32 v24, v24, s44, -v28
    v_fma_f32 v25, v25, s44, -v28
    v_exp_f32 v18, v18
    v_exp_f32 v19, v19
    v_cvt_pk_bf16_f32 v38, v16, v17
    v_exp_f32 v24, v24
    v_exp_f32 v25, v25
    v_cvt_pk_bf16_f32 v39, v18, v19
    v_cvt_pk_bf16_f32 v40, v24, v25
    v_cvt_pk_bf16_f32 v43, v24, v25
    v_mfma_f32_16x16x32_bf16 v[52:55], v[20:23], v[36:39], 0
    v_mov_b64 v[12:13], 0
    v_mov_b64 v[14:15], 0
    s_waitcnt vmcnt(3)
    v_mfma_f32_16x16x32_bf16 v[44:47], v[64:67], v[36:39], 0
    v_mov_b64 v[24:25], 0
    v_mov_b64 v[26:27], 0
    s_waitcnt vmcnt(2)
    v_mfma_f32_16x16x32_bf16 v[48:51], v[68:71], v[36:39], 0
    ds_read_b128 v[64:67], v8 offset:20480
    ds_read_b128 v[68:71], v8 offset:21504
    v_mfma_f32_16x16x16_bf16 v[52:55], v[20:21], v[40:41], v[52:55]
    v_mfma_f32_16x16x16_bf16 v[44:47], v[30:31], v[40:41], v[44:47]
    v_mov_b64 v[20:21], 0
    v_mov_b64 v[22:23], 0
    v_mfma_f32_16x16x16_bf16 v[48:51], v[30:31], v[42:43], v[48:51]
    v_mov_b64 v[36:37], 0
    v_mov_b64 v[38:39], 0
    v_mov_b64 v[40:41], 0
    v_mov_b64 v[42:43], 0
    v_rcp_f32 v9, v52
    v_mov_b64 v[52:53], 0
    v_mov_b64 v[54:55], 0
    v_mul_f32 v44, v9, v44
    v_mul_f32 v48, v9, v48
    v_cvt_pk_bf16_f32 v16, v44, v48
    v_mul_f32 v45, v9, v45
    v_mul_f32 v49, v9, v49
    v_cvt_pk_bf16_f32 v17, v45, v49
    v_mul_f32 v46, v9, v46
    v_mul_f32 v50, v9, v50
    v_cvt_pk_bf16_f32 v18, v46, v50
    v_mul_f32 v47, v9, v47
    v_mul_f32 v51, v9, v51
    v_cvt_pk_bf16_f32 v19, v47, v51
    ds_write_b128 v5, v[16:19]
    v_mov_b64 v[28:29], 0
    v_mov_b64 v[30:31], 0
    s_waitcnt lgkmcnt(0)
    s_barrier
    ds_read_b128 v[44:47], v4 offset:0
    ds_read_b128 v[48:51], v4 offset:128
    v_mov_b64 v[16:17], 0
    v_mov_b64 v[18:19], 0
    buffer_load_dwordx4 v0, s[8:11], s41 offen offset:0 lds
    buffer_load_dwordx4 v0, s[8:11], s41 offen offset:1024 lds
    s_waitcnt lgkmcnt(1)
    v_smfmac_f32_16x16x64_bf16 v[12:15], v[44:47], a[184:191], v1
    s_waitcnt lgkmcnt(0)
    v_smfmac_f32_16x16x64_bf16 v[12:15], v[48:51], a[192:199], v1
    v_smfmac_f32_16x16x64_bf16 v[24:27], v[44:47], a[200:207], v1
    v_smfmac_f32_16x16x64_bf16 v[24:27], v[48:51], a[208:215], v1
    v_add_f32 v12, v12, v14
    v_smfmac_f32_16x16x64_bf16 v[20:23], v[44:47], a[216:223], v1
    v_add_f32 v13, v13, v15
    v_smfmac_f32_16x16x64_bf16 v[20:23], v[48:51], a[224:231], v1
    v_cvt_pk_bf16_f32 v12, v12, v13
    v_smfmac_f32_16x16x64_bf16 v[16:19], v[44:47], a[232:239], v1
    v_add_f32 v24, v24, v26
    v_smfmac_f32_16x16x64_bf16 v[16:19], v[48:51], a[240:247], v1
    v_add_f32 v25, v25, v27
    v_smfmac_f32_16x16x64_bf16 v[36:39], v[44:47], v[56:63], v1
    v_cvt_pk_bf16_f32 v13, v24, v25
    v_smfmac_f32_16x16x64_bf16 v[36:39], v[48:51], v[64:71], v1
    v_add_f32 v20, v20, v22
    v_add_f32 v21, v21, v23
    v_cvt_pk_bf16_f32 v14, v20, v21
    v_add_f32 v16, v16, v18
    v_add_f32 v17, v17, v19
    v_cvt_pk_bf16_f32 v15, v16, v17
    v_and_or_b32 v15, v15, -2, s40
    buffer_store_dwordx4 v[12:15], v0, s[8:11], s38 offen sc1
    s_nop 0
    ds_read_b128 v[12:15], v8 offset:18432
    ds_read_b128 v[16:19], v8 offset:19456
    ds_read_b128 v[20:23], v8 offset:22528
    ds_read_b128 v[24:27], v8 offset:23552
    ds_read_b128 v[56:59], v8 offset:24576
    ds_read_b128 v[60:63], v8 offset:25600
    ds_read_b128 v[64:67], v8 offset:28672
    ds_read_b128 v[68:71], v8 offset:29696
    s_waitcnt lgkmcnt(6)
    v_smfmac_f32_16x16x64_bf16 v[40:43], v[44:47], v[12:19], v1
    ds_read_b128 v[12:15], v8 offset:26624
    ds_read_b128 v[16:19], v8 offset:27648
    s_waitcnt lgkmcnt(6)
    v_smfmac_f32_16x16x64_bf16 v[40:43], v[48:51], v[20:27], v1
    ds_read_b128 v[20:23], v8 offset:30720
    ds_read_b128 v[24:27], v8 offset:31744
    s_waitcnt lgkmcnt(6)
    v_smfmac_f32_16x16x64_bf16 v[52:55], v[44:47], v[56:63], v1
    ds_read_b128 v[56:59], v8 offset:32768
    ds_read_b128 v[60:63], v8 offset:33792
    s_waitcnt lgkmcnt(6)
    v_smfmac_f32_16x16x64_bf16 v[52:55], v[48:51], v[64:71], v1
    s_waitcnt lgkmcnt(4)
    v_smfmac_f32_16x16x64_bf16 v[32:35], v[44:47], v[12:19], v1
    s_waitcnt lgkmcnt(2)
    v_smfmac_f32_16x16x64_bf16 v[32:35], v[48:51], v[20:27], v1
    v_smfmac_f32_16x16x64_bf16 v[28:31], v[44:47], a[248:255], v1
    s_waitcnt lgkmcnt(0)
    v_smfmac_f32_16x16x64_bf16 v[28:31], v[48:51], v[56:63], v1
    v_add_f32 v36, v36, v38
    v_add_f32 v37, v37, v39
    v_cvt_pk_bf16_f32 v36, v36, v37
    v_add_f32 v40, v40, v42
    v_add_f32 v41, v41, v43
    v_cvt_pk_bf16_f32 v37, v40, v41
    v_add_f32 v52, v52, v54
    v_add_f32 v53, v53, v55
    v_cvt_pk_bf16_f32 v38, v52, v53
    v_add_f32 v32, v32, v34
    v_add_f32 v33, v33, v35
    v_cvt_pk_bf16_f32 v39, v32, v33
    v_and_or_b32 v39, v39, -2, s40
    s_add_u32 s17, s38, 4096
    buffer_store_dwordx4 v[36:39], v0, s[8:11], s17 offen sc1
    v_add_f32 v28, v28, v30
    v_add_f32 v29, v29, v31
    v_cvt_pk_bf16_f32 v28, v28, v29
    v_and_or_b32 v28, v28, -2, s40
    v_lshrrev_b32 v9, 2, v0
    buffer_store_dword v28, v9, s[8:11], s39 offen sc1
    v_add_u32 v10, 162560, v0
    ds_read_b128 v[64:67], v10
    s_add_u32 s33, s33, 1
    s_add_u32 s42, s42, 262144
    s_add_u32 s41, s41, 262144
    s_add_u32 s43, s43, 131072
    s_mov_b32 s67, s66
    s_add_u32 s68, s68, 262144
    s_add_u32 s66, s66, 22528
    ds_read_b128 v[56:59], v8 offset:4096
    ds_read_b128 v[60:63], v8 offset:5120
    v_mov_b64 v[12:13], 0
    v_mov_b64 v[14:15], 0
    v_mov_b64 v[16:17], 0
    v_mov_b64 v[18:19], 0
    v_mov_b64 v[20:21], 0
    v_mov_b64 v[22:23], 0
    v_mov_b64 v[24:25], 0
    v_mov_b64 v[26:27], 0
    v_mov_b64 v[28:29], 0
    v_mov_b64 v[30:31], 0
    v_mov_b64 v[32:33], 0
    v_mov_b64 v[34:35], 0
    s_nop 15
    s_nop 15
    s_nop 15
    s_nop 11
    buffer_load_dwordx4 v[40:43], v6, s[8:11], s62 offen sc1
    buffer_load_dwordx4 v[44:47], v6, s[8:11], s63 offen sc1
    buffer_load_dwordx4 v[48:51], v6, s[8:11], s64 offen sc1
    buffer_load_dwordx4 v[52:55], v6, s[8:11], s65 offen sc1
    s_waitcnt lgkmcnt(0)
    s_waitcnt vmcnt(3)
    v_mfma_f32_16x16x32_bf16 v[68:71], v[40:43], v[64:67], 0
    v_and_b32 v10, 1, v43
    v_cmp_ne_u32 s[54:55], s40, v10
    s_waitcnt vmcnt(2)
    v_mfma_f32_16x16x32_bf16 v[68:71], v[44:47], v[64:67], v[68:71]
    v_and_b32 v10, 1, v47
    v_cmp_ne_u32 s[56:57], s40, v10
    s_waitcnt vmcnt(1)
    v_mfma_f32_16x16x32_bf16 v[68:71], v[48:51], v[64:67], v[68:71]
    v_and_b32 v10, 1, v51
    v_cmp_ne_u32 s[58:59], s40, v10
    s_waitcnt vmcnt(0)
    v_mfma_f32_16x16x32_bf16 v[68:71], v[52:55], v[64:67], v[68:71]
    v_and_b32 v10, 1, v55
    v_cmp_ne_u32 s[60:61], s40, v10
    s_or_b64 vcc, s[54:55], s[56:57]
    s_or_b64 vcc, vcc, s[58:59]
    s_or_b64 vcc, vcc, s[60:61]
    s_cbranch_scc0 Lr1s_red
    s_mov_b32 s16, 0
Lr1s_p1:
    s_mov_b64 exec, s[54:55]
    buffer_load_dwordx4 v[40:43], v6, s[8:11], s62 offen sc1
    s_mov_b64 exec, s[56:57]
    buffer_load_dwordx4 v[44:47], v6, s[8:11], s63 offen sc1
    s_mov_b64 exec, s[58:59]
    buffer_load_dwordx4 v[48:51], v6, s[8:11], s64 offen sc1
    s_mov_b64 exec, s[60:61]
    buffer_load_dwordx4 v[52:55], v6, s[8:11], s65 offen sc1
    s_mov_b64 exec, -1
    s_add_u32 s16, s16, 1
    s_cmp_gt_u32 s16, 100000
    s_cbranch_scc1 Lr_abort
    s_waitcnt vmcnt(3)
    v_mfma_f32_16x16x32_bf16 v[68:71], v[40:43], v[64:67], 0
    v_and_b32 v10, 1, v43
    v_cmp_ne_u32 s[54:55], s40, v10
    s_waitcnt vmcnt(2)
    v_mfma_f32_16x16x32_bf16 v[68:71], v[44:47], v[64:67], v[68:71]
    v_and_b32 v10, 1, v47
    v_cmp_ne_u32 s[56:57], s40, v10
    s_waitcnt vmcnt(1)
    v_mfma_f32_16x16x32_bf16 v[68:71], v[48:51], v[64:67], v[68:71]
    v_and_b32 v10, 1, v51
    v_cmp_ne_u32 s[58:59], s40, v10
    s_waitcnt vmcnt(0)
    v_mfma_f32_16x16x32_bf16 v[68:71], v[52:55], v[64:67], v[68:71]
    v_and_b32 v10, 1, v55
    v_cmp_ne_u32 s[60:61], s40, v10
    s_or_b64 vcc, s[54:55], s[56:57]
    s_or_b64 vcc, vcc, s[58:59]
    s_or_b64 vcc, vcc, s[60:61]
    s_cbranch_scc1 Lr1s_p1
Lr1s_red:
    s_xor_b32 s34, s34, 16384
    s_xor_b32 s35, s35, 16384
    buffer_load_dwordx4 v[36:39], v0, s[8:11], s34 offen sc1
    v_permlane16_swap_b32 v68, v70
    v_permlane16_swap_b32 v69, v71
    s_mov_b64 exec, s[46:47]
    v_add_f32 v68, v68, v70
    v_add_f32 v69, v69, v71
    v_cvt_pk_bf16_f32 v68, v68, v69
    v_min_u32 v68, s50, v68
    buffer_store_dword v68, v7, s[8:11], s36 offen sc1
    v_mov_b32 v69, -1
    buffer_store_dword v69, v7, s[8:11], s37 offen sc1
    s_mov_b64 exec, -1
    buffer_load_dwordx4 v[36:39], v0, s[8:11], s34 offen sc1
    s_xor_b32 s40, s40, 1
    s_xor_b32 s36, s36, 16384
    s_xor_b32 s37, s37, 16384
    ds_read_b128 v[64:67], v8 offset:6144
    ds_read_b128 v[68:71], v8 offset:7168
    s_waitcnt lgkmcnt(0)
    s_branch Lr1s_step
Lr1s_pb_re:
    s_mov_b32 s16, 0
Lr1s_pb_lp:
    s_add_u32 s17, s34, 4096
    buffer_load_dwordx4 v[40:43], v0, s[8:11], s17 offen sc1
    s_add_u32 s16, s16, 1
    s_cmp_gt_u32 s16, 100000
    s_cbranch_scc1 Lr_abort
    s_waitcnt vmcnt(0)
    v_max3_u32 v10, v40, v41, v42
    v_max_u32 v10, v10, v43
    v_cmp_eq_u32 vcc, -1, v10
    s_nop 0
    s_cbranch_vccnz Lr1s_pb_lp
    s_branch Lr1s_pb_ok
Lr1s_pc_re:
    s_mov_b32 s16, 0
Lr1s_pc_lp:
    buffer_load_dwordx4 v[44:47], v0, s[8:11], s35 offen sc1
    s_add_u32 s16, s16, 1
    s_cmp_gt_u32 s16, 100000
    s_cbranch_scc1 Lr_abort
    s_waitcnt vmcnt(0)
    v_max3_u32 v10, v44, v45, v46
    v_max_u32 v10, v10, v47
    v_cmp_eq_u32 vcc, -1, v10
    s_nop 0
    s_cbranch_vccnz Lr1s_pc_lp
    s_branch Lr1s_pc_ok
Lr1s_last:
    s_waitcnt vmcnt(0) lgkmcnt(0)
    s_barrier
    s_mov_b32 s67, s66
    v_mov_b32 v9, 1
    v_mov_b32 v10, 0
    s_mov_b64 exec, 1
    buffer_store_dword v9, v10, s[8:11], s67 offen offset:384 sc1
    s_mov_b64 exec, -1
    s_branch Lr_exit
L_w2_0:
    s_cmp_lg_u32 s14, 2
    s_cbranch_scc1 L_w3_0
    s_mov_b32 s16, 0
    s_add_u32 s17, s66, 128
    v_lshrrev_b32 v10, 2, v0
    v_and_b32 v9, 16, v10
    v_lshlrev_b32 v9, 3, v9
    v_and_or_b32 v10, v10, 12, v9
Lr2s_fw_17:
    buffer_load_dword v9, v10, s[8:11], s17 offen sc1
    s_add_u32 s16, s16, 1
    s_cmp_gt_u32 s16, 100000
    s_cbranch_scc1 Lr_abort
    s_waitcnt vmcnt(0)
    v_cmp_eq_u32 vcc, 0, v9
    s_nop 0
    s_cbranch_vccnz Lr2s_fw_17
    s_mov_b32 m0, 19200
    s_nop 0
    buffer_load_dwordx4 v0, s[8:11], s41 offen offset:0 lds
    buffer_load_dwordx4 v0, s[8:11], s41 offen offset:1024 lds
    s_add_u32 s41, s41, 262144
    s_add_u32 s68, s68, 262144
    s_waitcnt vmcnt(0)
    ds_read_b128 v[56:59], v8 offset:4096
    ds_read_b128 v[60:63], v8 offset:5120
    ds_read_b128 v[64:67], v8 offset:6144
    ds_read_b128 v[68:71], v8 offset:7168
    v_mov_b64 v[12:13], 0
    v_mov_b64 v[14:15], 0
    v_mov_b64 v[16:17], 0
    v_mov_b64 v[18:19], 0
    v_mov_b64 v[20:21], 0
    v_mov_b64 v[22:23], 0
    v_mov_b64 v[24:25], 0
    v_mov_b64 v[26:27], 0
    v_mov_b64 v[28:29], 0
    v_mov_b64 v[30:31], 0
    v_mov_b64 v[32:33], 0
    v_mov_b64 v[34:35], 0
    buffer_load_dwordx4 v[36:39], v0, s[8:11], s34 offen sc1
    s_waitcnt vmcnt(0) lgkmcnt(0)
Lr2s_step:
    s_waitcnt vmcnt(3)
    v_max3_u32 v10, v36, v37, v38
    v_max_u32 v10, v10, v39
    v_cmp_eq_u32 vcc, -1, v10
    s_nop 0
    s_cbranch_vccz Lr2s_aok
    buffer_load_dwordx4 v[36:39], v0, s[8:11], s34 offen sc1
    s_nop 15
    s_nop 8
    buffer_load_dwordx4 v[36:39], v0, s[8:11], s34 offen sc1
    s_mov_b32 s16, 0
Lr2s_alp:
    s_waitcnt vmcnt(2)
    v_max3_u32 v10, v36, v37, v38
    v_max_u32 v10, v10, v39
    v_cmp_eq_u32 vcc, -1, v10
    s_nop 0
    s_cbranch_vccz Lr2s_aok
    buffer_load_dwordx4 v[36:39], v0, s[8:11], s34 offen sc1
    s_add_u32 s16, s16, 1
    s_cmp_gt_u32 s16, 100000
    s_cbranch_scc1 Lr_abort
    s_branch Lr2s_alp
Lr2s_aok:
    ds_write_b128 v0, v[36:39] offset:8960
    v_smfmac_f32_16x16x64_bf16 v[12:15], v[36:39], v[104:111], v1
    v_smfmac_f32_16x16x64_bf16 v[16:19], v[36:39], v[112:119], v1
    v_smfmac_f32_16x16x64_bf16 v[20:23], v[36:39], v[216:223], v1
    s_waitcnt lgkmcnt(0)
    s_barrier
    ds_read_b128 v[48:51], v0 offset:9984
    ds_read_b128 v[52:55], v0 offset:6912
    v_smfmac_f32_16x16x64_bf16 v[28:31], v[36:39], v[56:63], v1
    ds_read_b128 v[56:59], v8 offset:0
    ds_read_b128 v[60:63], v8 offset:1024
    v_smfmac_f32_16x16x64_bf16 v[24:27], v[36:39], v[224:231], v1
    v_smfmac_f32_16x16x64_bf16 v[32:35], v[36:39], v[64:71], v1
    ds_read_b128 v[64:67], v8 offset:2048
    ds_read_b128 v[68:71], v8 offset:3072
    s_add_u32 s17, s34, 4096
    buffer_load_dwordx4 v[40:43], v0, s[8:11], s17 offen sc1
    s_waitcnt vmcnt(1)
    ds_read_b128 v[36:39], v0 offset:7936
    s_waitcnt lgkmcnt(6)
    v_smfmac_f32_16x16x64_bf16 v[28:31], v[48:51], a[88:95], v1
    v_smfmac_f32_16x16x64_bf16 v[12:15], v[48:51], v[120:127], v1
    v_smfmac_f32_16x16x64_bf16 v[16:19], v[48:51], v[128:135], v1
    v_smfmac_f32_16x16x64_bf16 v[32:35], v[48:51], a[96:103], v1
    buffer_load_dwordx4 v[44:47], v0, s[8:11], s35 offen sc1
    v_smfmac_f32_16x16x64_bf16 v[20:23], v[48:51], v[232:239], v1
    v_lshrrev_b32 v10, 2, v0
    v_and_b32 v9, 16, v10
    v_lshlrev_b32 v9, 3, v9
    v_and_or_b32 v10, v10, 12, v9
    s_add_u32 s17, s66, 22656
    v_mov_b32 v11, 2
    buffer_load_dword v11, v10, s[8:11], s17 offen sc1
    v_smfmac_f32_16x16x64_bf16 v[24:27], v[48:51], v[240:247], v1
    s_waitcnt lgkmcnt(3)
    v_smfmac_f32_16x16x64_bf16 v[28:31], v[52:55], v[56:63], v1
    ds_read_b128 v[56:59], v8 offset:12288
    ds_read_b128 v[60:63], v8 offset:13312
    v_smfmac_f32_16x16x64_bf16 v[12:15], v[52:55], v[72:79], v1
    v_smfmac_f32_16x16x64_bf16 v[16:19], v[52:55], v[80:87], v1
    s_waitcnt lgkmcnt(3)
    v_smfmac_f32_16x16x64_bf16 v[32:35], v[52:55], v[64:71], v1
    ds_read_b128 v[64:67], v8 offset:14336
    ds_read_b128 v[68:71], v8 offset:15360
    v_smfmac_f32_16x16x64_bf16 v[20:23], v[52:55], v[184:191], v1
    v_smfmac_f32_16x16x64_bf16 v[24:27], v[52:55], v[192:199], v1
    s_waitcnt lgkmcnt(4)
    v_smfmac_f32_16x16x64_bf16 v[28:31], v[36:39], a[72:79], v1
    v_smfmac_f32_16x16x64_bf16 v[12:15], v[36:39], v[88:95], v1
    v_smfmac_f32_16x16x64_bf16 v[16:19], v[36:39], v[96:103], v1
    v_smfmac_f32_16x16x64_bf16 v[32:35], v[36:39], a[80:87], v1
    v_smfmac_f32_16x16x64_bf16 v[20:23], v[36:39], v[200:207], v1
    v_smfmac_f32_16x16x64_bf16 v[24:27], v[36:39], v[208:215], v1
    s_waitcnt vmcnt(2)
    v_max3_u32 v10, v40, v41, v42
    v_max_u32 v10, v10, v43
    v_cmp_eq_u32 vcc, -1, v10
    s_nop 0
    s_cbranch_vccnz Lr2s_pb_re
Lr2s_pb_ok:
    ds_write_b128 v0, v[40:43] offset:13056
    s_waitcnt lgkmcnt(3)
    v_smfmac_f32_16x16x64_bf16 v[12:15], v[40:43], v[56:63], v1
    ds_read_b128 v[56:59], v8 offset:8192
    ds_read_b128 v[60:63], v8 offset:9216
    v_smfmac_f32_16x16x64_bf16 v[20:23], v[40:43], a[24:31], v1
    s_waitcnt lgkmcnt(3)
    v_smfmac_f32_16x16x64_bf16 v[16:19], v[40:43], v[64:71], v1
    ds_read_b128 v[64:67], v8 offset:10240
    ds_read_b128 v[68:71], v8 offset:11264
    v_smfmac_f32_16x16x64_bf16 v[24:27], v[40:43], a[32:39], v1
    s_waitcnt lgkmcnt(4)
    s_barrier
    ds_read_b128 v[48:51], v0 offset:11008
    ds_read_b128 v[52:55], v0 offset:14080
    ds_read_b128 v[36:39], v0 offset:12032
    v_smfmac_f32_16x16x64_bf16 v[28:31], v[40:43], a[136:143], v1
    v_smfmac_f32_16x16x64_bf16 v[32:35], v[40:43], a[144:151], v1
    s_waitcnt lgkmcnt(2)
    v_smfmac_f32_16x16x64_bf16 v[12:15], v[48:51], v[56:63], v1
    v_smfmac_f32_16x16x64_bf16 v[16:19], v[48:51], v[64:71], v1
    s_waitcnt lgkmcnt(1)
    v_smfmac_f32_16x16x64_bf16 v[12:15], v[52:55], v[152:159], v1
    v_smfmac_f32_16x16x64_bf16 v[16:19], v[52:55], v[160:167], v1
    s_waitcnt lgkmcnt(0)
    v_smfmac_f32_16x16x64_bf16 v[12:15], v[36:39], v[136:143], v1
    v_smfmac_f32_16x16x64_bf16 v[16:19], v[36:39], v[144:151], v1
    s_waitcnt vmcnt(1)
    v_max3_u32 v10, v44, v45, v46
    v_max_u32 v10, v10, v47
    v_cmp_eq_u32 vcc, -1, v10
    s_nop 0
    s_cbranch_vccnz Lr2s_pc_re
Lr2s_pc_ok:
    v_smfmac_f32_16x16x64_bf16 v[12:15], v[44:47], v[168:175], v1
    v_smfmac_f32_16x16x64_bf16 v[16:19], v[44:47], v[176:183], v1
    v_smfmac_f32_16x16x64_bf16 v[20:23], v[48:51], v[248:255], v1
    v_smfmac_f32_16x16x64_bf16 v[24:27], v[48:51], a[0:7], v1
    v_smfmac_f32_16x16x64_bf16 v[20:23], v[52:55], a[40:47], v1
    v_add_f32 v12, v12, v14
    buffer_load_dwordx4 v[64:67], v0, s[8:11], s42 offen
    v_smfmac_f32_16x16x64_bf16 v[24:27], v[52:55], a[48:55], v1
    v_add_f32 v16, v16, v18
    v_smfmac_f32_16x16x64_bf16 v[20:23], v[36:39], a[8:15], v1
    v_add_f32 v13, v13, v15
    v_smfmac_f32_16x16x64_bf16 v[24:27], v[36:39], a[16:23], v1
    v_add_f32 v17, v17, v19
    v_smfmac_f32_16x16x64_bf16 v[20:23], v[44:47], a[56:63], v1
    v_cvt_pk_bf16_f32 v14, v12, v16
    ds_read_b128 v[56:59], v0 offset:15104
    buffer_load_dwordx4 v[68:71], v0, s[8:11], s42 offen offset:1024
    v_smfmac_f32_16x16x64_bf16 v[24:27], v[44:47], a[64:71], v1
    v_cvt_pk_bf16_f32 v15, v13, v17
    ds_read_b128 v[60:63], v0 offset:16128
    ds_write_b32 v2, v14 offset:576
    ds_write_b32 v2, v15 offset:864
    v_smfmac_f32_16x16x64_bf16 v[28:31], v[48:51], a[104:111], v1
    v_smfmac_f32_16x16x64_bf16 v[32:35], v[48:51], a[112:119], v1
    v_add_f32 v20, v20, v22
    v_add_f32 v24, v24, v26
    v_add_f32 v21, v21, v23
    v_add_f32 v25, v25, v27
    v_cvt_pk_bf16_f32 v22, v20, v24
    v_cvt_pk_bf16_f32 v23, v21, v25
    ds_write_b32 v2, v22 offset:0
    ds_write_b32 v2, v23 offset:288
    v_smfmac_f32_16x16x64_bf16 v[28:31], v[52:55], a[152:159], v1
    v_smfmac_f32_16x16x64_bf16 v[32:35], v[52:55], a[160:167], v1
    s_waitcnt vmcnt(2)
    v_cmp_eq_u32 vcc, 0, v11
    s_nop 0
    s_cbranch_vccnz Lr2s_flbad
Lr2s_flok:
    s_waitcnt lgkmcnt(0)
    s_barrier
    ds_read_b128 v[40:43], v3 offset:0
    ds_read_b128 v[48:51], v3 offset:64
    ds_read_b128 v[20:23], v3 offset:128
    ds_read_b128 v[52:55], v3 offset:192
    v_smfmac_f32_16x16x64_bf16 v[28:31], v[36:39], a[120:127], v1
    v_smfmac_f32_16x16x64_bf16 v[32:35], v[36:39], a[128:135], v1
    ds_read_b128 v[36:39], v0 offset:17152
    v_smfmac_f32_16x16x64_bf16 v[28:31], v[44:47], a[168:175], v1
    v_smfmac_f32_16x16x64_bf16 v[32:35], v[44:47], a[176:183], v1
    ds_read_b128 v[44:47], v0 offset:18176
    s_waitcnt lgkmcnt(5)
    v_mfma_f32_16x16x32_bf16 v[12:15], v[56:59], v[40:43], 0
    v_mfma_f32_16x16x32_bf16 v[16:19], v[60:63], v[40:43], 0
    v_mfma_f32_16x16x32_bf16 v[24:27], v[40:43], v[40:43], 0
    ds_read_b128 v[56:59], v0 offset:19200
    ds_read_b128 v[60:63], v0 offset:20224
    s_waitcnt lgkmcnt(3)
    v_mfma_f32_16x16x32_bf16 v[12:15], v[36:39], v[48:51], v[12:15]
    v_lshrrev_b32 v10, 1, v0
    v_lshrrev_b32 v9, 9, v0
    s_waitcnt lgkmcnt(2)
    v_mfma_f32_16x16x32_bf16 v[16:19], v[44:47], v[48:51], v[16:19]
    v_lshl_add_u32 v9, v9, 5, v10
    v_add_f32 v28, v28, v30
    v_mfma_f32_16x16x32_bf16 v[24:27], v[48:51], v[48:51], v[24:27]
    v_add_f32 v32, v32, v34
    v_add_f32 v29, v29, v31
    ds_read_b128 v[36:39], v0 offset:21248
    ds_read_b128 v[44:47], v0 offset:22272
    s_waitcnt lgkmcnt(3)
    v_mfma_f32_16x16x32_bf16 v[12:15], v[56:59], v[20:23], v[12:15]
    v_add_f32 v33, v33, v35
    v_cvt_pk_bf16_f32 v30, v28, v29
    s_waitcnt lgkmcnt(2)
    v_mfma_f32_16x16x32_bf16 v[16:19], v[60:63], v[20:23], v[16:19]
    v_cvt_pk_bf16_f32 v31, v32, v33
    ds_read_b64 v[34:35], v9 offset:2304
    v_mfma_f32_16x16x32_bf16 v[24:27], v[20:23], v[20:23], v[24:27]
    s_add_u32 s17, s43, 3072
    buffer_store_dwordx2 v[30:31], v10, s[8:11], s17 offen sc1
    s_waitcnt lgkmcnt(2)
    v_mfma_f32_16x16x32_bf16 v[12:15], v[36:39], v[52:55], v[12:15]
    s_waitcnt lgkmcnt(1)
    v_mfma_f32_16x16x32_bf16 v[16:19], v[44:47], v[52:55], v[16:19]
    v_mfma_f32_16x16x32_bf16 v[24:27], v[52:55], v[52:55], v[24:27]
    s_add_u32 s17, s43, 1024
    s_waitcnt lgkmcnt(0)
    buffer_store_dwordx2 v[34:35], v10, s[8:11], s17 offen sc1
    s_cmp_eq_u32 s33, 63
    s_cbranch_scc1 Lr2s_last
    ds_read_b128 v[56:59], v8 offset:16384
    ds_read_b128 v[60:63], v8 offset:17408
    v_mov_b64 v[20:21], s[52:53]
    v_mov_b64 v[22:23], s[52:53]
    v_mov_b32 v41, 0
    v_mov_b32 v42, 0
    v_max3_f32 v9, v12, v13, v14
    v_max3_f32 v9, v9, v15, v16
    v_max3_f32 v9, v9, v17, v18
    v_max3_f32 v9, v9, v19, v24
    v_max_f32 v9, v9, v25
    v_mov_b32 v10, v9
    v_mov_b64 v[32:33], 0
    v_mov_b64 v[34:35], 0
    v_permlane32_swap_b32 v9, v10
    v_max_f32 v9, v9, v10
    v_mov_b32 v10, v9
    s_nop 1
    v_permlane16_swap_b32 v9, v10
    v_max_f32 v9, v9, v10
    v_mul_f32 v28, s44, v9
    v_fma_f32 v12, v12, s44, -v28
    v_fma_f32 v13, v13, s44, -v28
    v_fma_f32 v14, v14, s44, -v28
    v_fma_f32 v15, v15, s44, -v28
    v_exp_f32 v12, v12
    v_exp_f32 v13, v13
    v_fma_f32 v16, v16, s44, -v28
    v_fma_f32 v17, v17, s44, -v28
    v_exp_f32 v14, v14
    v_exp_f32 v15, v15
    v_cvt_pk_bf16_f32 v36, v12, v13
    v_fma_f32 v18, v18, s44, -v28
    v_fma_f32 v19, v19, s44, -v28
    v_exp_f32 v16, v16
    v_exp_f32 v17, v17
    v_cvt_pk_bf16_f32 v37, v14, v15
    v_fma_f32 v24, v24, s44, -v28
    v_fma_f32 v25, v25, s44, -v28
    v_exp_f32 v18, v18
    v_exp_f32 v19, v19
    v_cvt_pk_bf16_f32 v38, v16, v17
    v_exp_f32 v24, v24
    v_exp_f32 v25, v25
    v_cvt_pk_bf16_f32 v39, v18, v19
    v_cvt_pk_bf16_f32 v40, v24, v25
    v_cvt_pk_bf16_f32 v43, v24, v25
    v_mfma_f32_16x16x32_bf16 v[52:55], v[20:23], v[36:39], 0
    v_mov_b64 v[12:13], 0
    v_mov_b64 v[14:15], 0
    s_waitcnt vmcnt(3)
    v_mfma_f32_16x16x32_bf16 v[44:47], v[64:67], v[36:39], 0
    v_mov_b64 v[24:25], 0
    v_mov_b64 v[26:27], 0
    s_waitcnt vmcnt(2)
    v_mfma_f32_16x16x32_bf16 v[48:51], v[68:71], v[36:39], 0
    ds_read_b128 v[64:67], v8 offset:20480
    ds_read_b128 v[68:71], v8 offset:21504
    v_mfma_f32_16x16x16_bf16 v[52:55], v[20:21], v[40:41], v[52:55]
    v_mfma_f32_16x16x16_bf16 v[44:47], v[30:31], v[40:41], v[44:47]
    v_mov_b64 v[20:21], 0
    v_mov_b64 v[22:23], 0
    v_mfma_f32_16x16x16_bf16 v[48:51], v[30:31], v[42:43], v[48:51]
    v_mov_b64 v[36:37], 0
    v_mov_b64 v[38:39], 0
    v_mov_b64 v[40:41], 0
    v_mov_b64 v[42:43], 0
    v_rcp_f32 v9, v52
    v_mov_b64 v[52:53], 0
    v_mov_b64 v[54:55], 0
    v_mul_f32 v44, v9, v44
    v_mul_f32 v48, v9, v48
    v_cvt_pk_bf16_f32 v16, v44, v48
    v_mul_f32 v45, v9, v45
    v_mul_f32 v49, v9, v49
    v_cvt_pk_bf16_f32 v17, v45, v49
    v_mul_f32 v46, v9, v46
    v_mul_f32 v50, v9, v50
    v_cvt_pk_bf16_f32 v18, v46, v50
    v_mul_f32 v47, v9, v47
    v_mul_f32 v51, v9, v51
    v_cvt_pk_bf16_f32 v19, v47, v51
    ds_write_b128 v5, v[16:19]
    v_mov_b64 v[28:29], 0
    v_mov_b64 v[30:31], 0
    s_waitcnt lgkmcnt(0)
    s_barrier
    ds_read_b128 v[44:47], v4 offset:0
    ds_read_b128 v[48:51], v4 offset:128
    v_mov_b64 v[16:17], 0
    v_mov_b64 v[18:19], 0
    buffer_load_dwordx4 v0, s[8:11], s41 offen offset:0 lds
    buffer_load_dwordx4 v0, s[8:11], s41 offen offset:1024 lds
    s_waitcnt lgkmcnt(1)
    v_smfmac_f32_16x16x64_bf16 v[12:15], v[44:47], a[184:191], v1
    s_waitcnt lgkmcnt(0)
    v_smfmac_f32_16x16x64_bf16 v[12:15], v[48:51], a[192:199], v1
    v_smfmac_f32_16x16x64_bf16 v[24:27], v[44:47], a[200:207], v1
    v_smfmac_f32_16x16x64_bf16 v[24:27], v[48:51], a[208:215], v1
    v_add_f32 v12, v12, v14
    v_smfmac_f32_16x16x64_bf16 v[20:23], v[44:47], a[216:223], v1
    v_add_f32 v13, v13, v15
    v_smfmac_f32_16x16x64_bf16 v[20:23], v[48:51], a[224:231], v1
    v_cvt_pk_bf16_f32 v12, v12, v13
    v_smfmac_f32_16x16x64_bf16 v[16:19], v[44:47], a[232:239], v1
    v_add_f32 v24, v24, v26
    v_smfmac_f32_16x16x64_bf16 v[16:19], v[48:51], a[240:247], v1
    v_add_f32 v25, v25, v27
    v_smfmac_f32_16x16x64_bf16 v[36:39], v[44:47], v[56:63], v1
    v_cvt_pk_bf16_f32 v13, v24, v25
    v_smfmac_f32_16x16x64_bf16 v[36:39], v[48:51], v[64:71], v1
    v_add_f32 v20, v20, v22
    v_add_f32 v21, v21, v23
    v_cvt_pk_bf16_f32 v14, v20, v21
    v_add_f32 v16, v16, v18
    v_add_f32 v17, v17, v19
    v_cvt_pk_bf16_f32 v15, v16, v17
    v_and_or_b32 v15, v15, -2, s40
    buffer_store_dwordx4 v[12:15], v0, s[8:11], s38 offen sc1
    s_nop 0
    ds_read_b128 v[12:15], v8 offset:18432
    ds_read_b128 v[16:19], v8 offset:19456
    ds_read_b128 v[20:23], v8 offset:22528
    ds_read_b128 v[24:27], v8 offset:23552
    ds_read_b128 v[56:59], v8 offset:24576
    ds_read_b128 v[60:63], v8 offset:25600
    ds_read_b128 v[64:67], v8 offset:28672
    ds_read_b128 v[68:71], v8 offset:29696
    s_waitcnt lgkmcnt(6)
    v_smfmac_f32_16x16x64_bf16 v[40:43], v[44:47], v[12:19], v1
    ds_read_b128 v[12:15], v8 offset:26624
    ds_read_b128 v[16:19], v8 offset:27648
    s_waitcnt lgkmcnt(6)
    v_smfmac_f32_16x16x64_bf16 v[40:43], v[48:51], v[20:27], v1
    ds_read_b128 v[20:23], v8 offset:30720
    ds_read_b128 v[24:27], v8 offset:31744
    s_waitcnt lgkmcnt(6)
    v_smfmac_f32_16x16x64_bf16 v[52:55], v[44:47], v[56:63], v1
    ds_read_b128 v[56:59], v8 offset:32768
    ds_read_b128 v[60:63], v8 offset:33792
    s_waitcnt lgkmcnt(6)
    v_smfmac_f32_16x16x64_bf16 v[52:55], v[48:51], v[64:71], v1
    s_waitcnt lgkmcnt(4)
    v_smfmac_f32_16x16x64_bf16 v[32:35], v[44:47], v[12:19], v1
    s_waitcnt lgkmcnt(2)
    v_smfmac_f32_16x16x64_bf16 v[32:35], v[48:51], v[20:27], v1
    v_smfmac_f32_16x16x64_bf16 v[28:31], v[44:47], a[248:255], v1
    s_waitcnt lgkmcnt(0)
    v_smfmac_f32_16x16x64_bf16 v[28:31], v[48:51], v[56:63], v1
    v_add_f32 v36, v36, v38
    v_add_f32 v37, v37, v39
    v_cvt_pk_bf16_f32 v36, v36, v37
    v_add_f32 v40, v40, v42
    v_add_f32 v41, v41, v43
    v_cvt_pk_bf16_f32 v37, v40, v41
    v_add_f32 v52, v52, v54
    v_add_f32 v53, v53, v55
    v_cvt_pk_bf16_f32 v38, v52, v53
    v_add_f32 v32, v32, v34
    v_add_f32 v33, v33, v35
    v_cvt_pk_bf16_f32 v39, v32, v33
    v_and_or_b32 v39, v39, -2, s40
    s_add_u32 s17, s38, 4096
    buffer_store_dwordx4 v[36:39], v0, s[8:11], s17 offen sc1
    v_add_f32 v28, v28, v30
    v_add_f32 v29, v29, v31
    v_cvt_pk_bf16_f32 v28, v28, v29
    v_and_or_b32 v28, v28, -2, s40
    v_lshrrev_b32 v9, 2, v0
    buffer_store_dword v28, v9, s[8:11], s39 offen sc1
    v_add_u32 v10, 162560, v0
    ds_read_b32 v64, v10
    v_mov_b32 v65, 0
    v_mov_b32 v41, 0
    v_mov_b32 v45, 0
    v_mov_b32 v49, 0
    v_mov_b32 v53, 0
    s_add_u32 s33, s33, 1
    s_add_u32 s42, s42, 262144
    s_add_u32 s41, s41, 262144
    s_add_u32 s43, s43, 131072
    s_add_u32 s68, s68, 262144
    s_add_u32 s66, s66, 22528
    ds_read_b128 v[56:59], v8 offset:4096
    ds_read_b128 v[60:63], v8 offset:5120
    v_mov_b64 v[12:13], 0
    v_mov_b64 v[14:15], 0
    v_mov_b64 v[16:17], 0
    v_mov_b64 v[18:19], 0
    v_mov_b64 v[20:21], 0
    v_mov_b64 v[22:23], 0
    v_mov_b64 v[24:25], 0
    v_mov_b64 v[26:27], 0
    v_mov_b64 v[28:29], 0
    v_mov_b64 v[30:31], 0
    v_mov_b64 v[32:33], 0
    v_mov_b64 v[34:35], 0
    s_nop 15
    s_nop 15
    s_nop 15
    s_nop 1
    buffer_load_dword v40, v6, s[8:11], s62 offen sc1
    buffer_load_dword v44, v6, s[8:11], s63 offen sc1
    buffer_load_dword v48, v6, s[8:11], s64 offen sc1
    buffer_load_dword v52, v6, s[8:11], s65 offen sc1
    s_waitcnt lgkmcnt(0)
    s_waitcnt vmcnt(3)
    v_mfma_f32_16x16x16_bf16 v[68:71], v[40:41], v[64:65], 0
    v_and_b32 v10, 1, v40
    v_cmp_ne_u32 s[54:55], s40, v10
    s_waitcnt vmcnt(2)
    v_mfma_f32_16x16x16_bf16 v[68:71], v[44:45], v[64:65], v[68:71]
    v_and_b32 v10, 1, v44
    v_cmp_ne_u32 s[56:57], s40, v10
    s_waitcnt vmcnt(1)
    v_mfma_f32_16x16x16_bf16 v[68:71], v[48:49], v[64:65], v[68:71]
    v_and_b32 v10, 1, v48
    v_cmp_ne_u32 s[58:59], s40, v10
    s_waitcnt vmcnt(0)
    v_mfma_f32_16x16x16_bf16 v[68:71], v[52:53], v[64:65], v[68:71]
    v_and_b32 v10, 1, v52
    v_cmp_ne_u32 s[60:61], s40, v10
    s_or_b64 vcc, s[54:55], s[56:57]
    s_or_b64 vcc, vcc, s[58:59]
    s_or_b64 vcc, vcc, s[60:61]
    s_cbranch_scc0 Lr2s_red
    s_mov_b32 s16, 0
Lr2s_p1:
    s_mov_b64 exec, s[54:55]
    buffer_load_dword v40, v6, s[8:11], s62 offen sc1
    s_mov_b64 exec, s[56:57]
    buffer_load_dword v44, v6, s[8:11], s63 offen sc1
    s_mov_b64 exec, s[58:59]
    buffer_load_dword v48, v6, s[8:11], s64 offen sc1
    s_mov_b64 exec, s[60:61]
    buffer_load_dword v52, v6, s[8:11], s65 offen sc1
    s_mov_b64 exec, -1
    s_add_u32 s16, s16, 1
    s_cmp_gt_u32 s16, 100000
    s_cbranch_scc1 Lr_abort
    s_waitcnt vmcnt(3)
    v_mfma_f32_16x16x16_bf16 v[68:71], v[40:41], v[64:65], 0
    v_and_b32 v10, 1, v40
    v_cmp_ne_u32 s[54:55], s40, v10
    s_waitcnt vmcnt(2)
    v_mfma_f32_16x16x16_bf16 v[68:71], v[44:45], v[64:65], v[68:71]
    v_and_b32 v10, 1, v44
    v_cmp_ne_u32 s[56:57], s40, v10
    s_waitcnt vmcnt(1)
    v_mfma_f32_16x16x16_bf16 v[68:71], v[48:49], v[64:65], v[68:71]
    v_and_b32 v10, 1, v48
    v_cmp_ne_u32 s[58:59], s40, v10
    s_waitcnt vmcnt(0)
    v_mfma_f32_16x16x16_bf16 v[68:71], v[52:53], v[64:65], v[68:71]
    v_and_b32 v10, 1, v52
    v_cmp_ne_u32 s[60:61], s40, v10
    s_or_b64 vcc, s[54:55], s[56:57]
    s_or_b64 vcc, vcc, s[58:59]
    s_or_b64 vcc, vcc, s[60:61]
    s_cbranch_scc1 Lr2s_p1
Lr2s_red:
    s_xor_b32 s34, s34, 16384
    s_xor_b32 s35, s35, 16384
    buffer_load_dwordx4 v[36:39], v0, s[8:11], s34 offen sc1
    v_permlane16_swap_b32 v68, v70
    v_permlane16_swap_b32 v69, v71
    s_mov_b64 exec, s[46:47]
    v_add_f32 v68, v68, v70
    v_add_f32 v69, v69, v71
    v_cvt_pk_bf16_f32 v68, v68, v69
    v_min_u32 v68, s50, v68
    buffer_store_dword v68, v7, s[8:11], s36 offen sc1
    v_mov_b32 v69, -1
    buffer_store_dword v69, v7, s[8:11], s37 offen sc1
    s_mov_b64 exec, -1
    buffer_load_dwordx4 v[36:39], v0, s[8:11], s34 offen sc1
    s_xor_b32 s40, s40, 1
    s_xor_b32 s36, s36, 16384
    s_xor_b32 s37, s37, 16384
    ds_read_b128 v[64:67], v8 offset:6144
    ds_read_b128 v[68:71], v8 offset:7168
    s_waitcnt lgkmcnt(0)
    s_branch Lr2s_step
Lr2s_pb_re:
    s_mov_b32 s16, 0
Lr2s_pb_lp:
    s_add_u32 s17, s34, 4096
    buffer_load_dwordx4 v[40:43], v0, s[8:11], s17 offen sc1
    s_add_u32 s16, s16, 1
    s_cmp_gt_u32 s16, 100000
    s_cbranch_scc1 Lr_abort
    s_waitcnt vmcnt(0)
    v_max3_u32 v10, v40, v41, v42
    v_max_u32 v10, v10, v43
    v_cmp_eq_u32 vcc, -1, v10
    s_nop 0
    s_cbranch_vccnz Lr2s_pb_lp
    s_branch Lr2s_pb_ok
Lr2s_pc_re:
    s_mov_b32 s16, 0
Lr2s_pc_lp:
    buffer_load_dwordx4 v[44:47], v0, s[8:11], s35 offen sc1
    s_add_u32 s16, s16, 1
    s_cmp_gt_u32 s16, 100000
    s_cbranch_scc1 Lr_abort
    s_waitcnt vmcnt(0)
    v_max3_u32 v10, v44, v45, v46
    v_max_u32 v10, v10, v47
    v_cmp_eq_u32 vcc, -1, v10
    s_nop 0
    s_cbranch_vccnz Lr2s_pc_lp
    s_branch Lr2s_pc_ok
Lr2s_flbad:
    s_cmp_eq_u32 s33, 63
    s_cbranch_scc1 Lr2s_flok
    s_mov_b32 s16, 0
    s_add_u32 s17, s66, 22656
    v_lshrrev_b32 v10, 2, v0
    v_and_b32 v9, 16, v10
    v_lshlrev_b32 v9, 3, v9
    v_and_or_b32 v10, v10, 12, v9
Lr2s_fw_18:
    buffer_load_dword v9, v10, s[8:11], s17 offen sc1
    s_add_u32 s16, s16, 1
    s_cmp_gt_u32 s16, 100000
    s_cbranch_scc1 Lr_abort
    s_waitcnt vmcnt(0)
    v_cmp_eq_u32 vcc, 0, v9
    s_nop 0
    s_cbranch_vccnz Lr2s_fw_18
    s_branch Lr2s_flok
Lr2s_last:
    s_waitcnt vmcnt(0) lgkmcnt(0)
    s_barrier
    s_branch Lr_exit
L_w3_0:
    s_mov_b32 s16, 0
    s_add_u32 s17, s66, 128
    v_lshrrev_b32 v10, 2, v0
    v_and_b32 v9, 16, v10
    v_lshlrev_b32 v9, 3, v9
    v_and_or_b32 v10, v10, 12, v9
Lr3s_fw_19:
    buffer_load_dword v9, v10, s[8:11], s17 offen sc1
    s_add_u32 s16, s16, 1
    s_cmp_gt_u32 s16, 100000
    s_cbranch_scc1 Lr_abort
    s_waitcnt vmcnt(0)
    v_cmp_eq_u32 vcc, 0, v9
    s_nop 0
    s_cbranch_vccnz Lr3s_fw_19
    s_mov_b32 m0, 21248
    s_nop 0
    buffer_load_dwordx4 v0, s[8:11], s41 offen offset:0 lds
    buffer_load_dwordx4 v0, s[8:11], s41 offen offset:1024 lds
    s_add_u32 s41, s41, 262144
    s_add_u32 s68, s68, 262144
    s_waitcnt vmcnt(0)
    ds_read_b128 v[56:59], v8 offset:0
    ds_read_b128 v[60:63], v8 offset:1024
    ds_read_b128 v[64:67], v8 offset:2048
    ds_read_b128 v[68:71], v8 offset:3072
    v_mov_b64 v[12:13], 0
    v_mov_b64 v[14:15], 0
    v_mov_b64 v[16:17], 0
    v_mov_b64 v[18:19], 0
    v_mov_b64 v[20:21], 0
    v_mov_b64 v[22:23], 0
    v_mov_b64 v[24:25], 0
    v_mov_b64 v[26:27], 0
    v_mov_b64 v[28:29], 0
    v_mov_b64 v[30:31], 0
    v_mov_b64 v[32:33], 0
    v_mov_b64 v[34:35], 0
    buffer_load_dwordx4 v[36:39], v0, s[8:11], s34 offen sc1
    s_waitcnt vmcnt(0) lgkmcnt(0)
Lr3s_step:
    s_mov_b32 s16, 0
Lr3s_alp:
    s_waitcnt vmcnt(2)
    v_max3_u32 v10, v36, v37, v38
    v_max_u32 v10, v10, v39
    v_cmp_eq_u32 vcc, -1, v10
    s_nop 0
    s_cbranch_vccz Lr3s_aok
    buffer_load_dwordx4 v[36:39], v0, s[8:11], s34 offen sc1
    s_add_u32 s16, s16, 1
    s_cmp_gt_u32 s16, 100000
    s_cbranch_scc1 Lr_abort
    s_branch Lr3s_alp
Lr3s_aok:
    ds_write_b128 v0, v[36:39] offset:9984
    v_smfmac_f32_16x16x64_bf16 v[12:15], v[36:39], v[120:127], v1
    v_smfmac_f32_16x16x64_bf16 v[16:19], v[36:39], v[128:135], v1
    v_smfmac_f32_16x16x64_bf16 v[20:23], v[36:39], v[232:239], v1
    s_waitcnt lgkmcnt(0)
    s_barrier
    ds_read_b128 v[48:51], v0 offset:6912
    ds_read_b128 v[52:55], v0 offset:7936
    v_smfmac_f32_16x16x64_bf16 v[28:31], v[36:39], a[88:95], v1
    v_smfmac_f32_16x16x64_bf16 v[24:27], v[36:39], v[240:247], v1
    v_smfmac_f32_16x16x64_bf16 v[32:35], v[36:39], a[96:103], v1
    s_waitcnt vmcnt(0)
    ds_read_b128 v[36:39], v0 offset:8960
    s_waitcnt lgkmcnt(2)
    v_smfmac_f32_16x16x64_bf16 v[28:31], v[48:51], v[56:63], v1
    ds_read_b128 v[56:59], v8 offset:4096
    ds_read_b128 v[60:63], v8 offset:5120
    s_add_u32 s17, s34, 4096
    buffer_load_dwordx4 v[40:43], v0, s[8:11], s17 offen sc1
    v_smfmac_f32_16x16x64_bf16 v[12:15], v[48:51], v[72:79], v1
    v_smfmac_f32_16x16x64_bf16 v[16:19], v[48:51], v[80:87], v1
    v_smfmac_f32_16x16x64_bf16 v[32:35], v[48:51], v[64:71], v1
    ds_read_b128 v[64:67], v8 offset:6144
    ds_read_b128 v[68:71], v8 offset:7168
    v_smfmac_f32_16x16x64_bf16 v[20:23], v[48:51], v[184:191], v1
    buffer_load_dwordx4 v[44:47], v0, s[8:11], s35 offen sc1
    v_smfmac_f32_16x16x64_bf16 v[24:27], v[48:51], v[192:199], v1
    s_waitcnt lgkmcnt(5)
    v_smfmac_f32_16x16x64_bf16 v[28:31], v[52:55], a[72:79], v1
    v_smfmac_f32_16x16x64_bf16 v[12:15], v[52:55], v[88:95], v1
    v_smfmac_f32_16x16x64_bf16 v[16:19], v[52:55], v[96:103], v1
    v_smfmac_f32_16x16x64_bf16 v[32:35], v[52:55], a[80:87], v1
    v_smfmac_f32_16x16x64_bf16 v[20:23], v[52:55], v[200:207], v1
    v_smfmac_f32_16x16x64_bf16 v[24:27], v[52:55], v[208:215], v1
    s_waitcnt lgkmcnt(2)
    v_smfmac_f32_16x16x64_bf16 v[28:31], v[36:39], v[56:63], v1
    ds_read_b128 v[56:59], v8 offset:8192
    ds_read_b128 v[60:63], v8 offset:9216
    v_smfmac_f32_16x16x64_bf16 v[12:15], v[36:39], v[104:111], v1
    v_smfmac_f32_16x16x64_bf16 v[16:19], v[36:39], v[112:119], v1
    s_waitcnt lgkmcnt(2)
    v_smfmac_f32_16x16x64_bf16 v[32:35], v[36:39], v[64:71], v1
    ds_read_b128 v[64:67], v8 offset:10240
    ds_read_b128 v[68:71], v8 offset:11264
    v_smfmac_f32_16x16x64_bf16 v[20:23], v[36:39], v[216:223], v1
    v_smfmac_f32_16x16x64_bf16 v[24:27], v[36:39], v[224:231], v1
    s_waitcnt vmcnt(1)
    v_max3_u32 v10, v40, v41, v42
    v_max_u32 v10, v10, v43
    v_cmp_eq_u32 vcc, -1, v10
    s_nop 0
    s_cbranch_vccnz Lr3s_pb_re
Lr3s_pb_ok:
    ds_write_b128 v0, v[40:43] offset:14080
    v_smfmac_f32_16x16x64_bf16 v[12:15], v[40:43], v[152:159], v1
    v_smfmac_f32_16x16x64_bf16 v[20:23], v[40:43], a[40:47], v1
    v_smfmac_f32_16x16x64_bf16 v[16:19], v[40:43], v[160:167], v1
    v_smfmac_f32_16x16x64_bf16 v[24:27], v[40:43], a[48:55], v1
    s_waitcnt lgkmcnt(0)
    s_barrier
    ds_read_b128 v[48:51], v0 offset:11008
    ds_read_b128 v[52:55], v0 offset:12032
    ds_read_b128 v[36:39], v0 offset:13056
    v_smfmac_f32_16x16x64_bf16 v[28:31], v[40:43], a[152:159], v1
    v_smfmac_f32_16x16x64_bf16 v[32:35], v[40:43], a[160:167], v1
    s_waitcnt lgkmcnt(2)
    v_smfmac_f32_16x16x64_bf16 v[12:15], v[48:51], v[56:63], v1
    ds_read_b128 v[56:59], v8 offset:12288
    ds_read_b128 v[60:63], v8 offset:13312
    v_smfmac_f32_16x16x64_bf16 v[16:19], v[48:51], v[64:71], v1
    ds_read_b128 v[64:67], v8 offset:14336
    ds_read_b128 v[68:71], v8 offset:15360
    s_waitcnt lgkmcnt(5)
    v_smfmac_f32_16x16x64_bf16 v[12:15], v[52:55], v[136:143], v1
    v_smfmac_f32_16x16x64_bf16 v[16:19], v[52:55], v[144:151], v1
    s_waitcnt vmcnt(0)
    v_max3_u32 v10, v44, v45, v46
    v_max_u32 v10, v10, v47
    v_cmp_eq_u32 vcc, -1, v10
    s_nop 0
    s_cbranch_vccnz Lr3s_pc_re
Lr3s_pc_ok:
    v_smfmac_f32_16x16x64_bf16 v[12:15], v[44:47], v[168:175], v1
    v_smfmac_f32_16x16x64_bf16 v[16:19], v[44:47], v[176:183], v1
    s_waitcnt lgkmcnt(2)
    v_smfmac_f32_16x16x64_bf16 v[12:15], v[36:39], v[56:63], v1
    s_waitcnt lgkmcnt(0)
    v_smfmac_f32_16x16x64_bf16 v[16:19], v[36:39], v[64:71], v1
    v_smfmac_f32_16x16x64_bf16 v[20:23], v[48:51], v[248:255], v1
    v_smfmac_f32_16x16x64_bf16 v[24:27], v[48:51], a[0:7], v1
    v_smfmac_f32_16x16x64_bf16 v[20:23], v[52:55], a[8:15], v1
    v_add_f32 v12, v12, v14
    v_smfmac_f32_16x16x64_bf16 v[24:27], v[52:55], a[16:23], v1
    v_add_f32 v16, v16, v18
    buffer_load_dwordx4 v[64:67], v0, s[8:11], s42 offen
    v_smfmac_f32_16x16x64_bf16 v[20:23], v[36:39], a[24:31], v1
    v_add_f32 v13, v13, v15
    v_smfmac_f32_16x16x64_bf16 v[24:27], v[36:39], a[32:39], v1
    v_add_f32 v17, v17, v19
    v_smfmac_f32_16x16x64_bf16 v[20:23], v[44:47], a[56:63], v1
    v_cvt_pk_bf16_f32 v14, v12, v16
    ds_read_b128 v[56:59], v0 offset:15104
    v_smfmac_f32_16x16x64_bf16 v[24:27], v[44:47], a[64:71], v1
    v_cvt_pk_bf16_f32 v15, v13, v17
    ds_read_b128 v[60:63], v0 offset:16128
    buffer_load_dwordx4 v[68:71], v0, s[8:11], s42 offen offset:1024
    ds_write_b32 v2, v14 offset:576
    ds_write_b32 v2, v15 offset:864
    v_smfmac_f32_16x16x64_bf16 v[28:31], v[48:51], a[104:111], v1
    v_smfmac_f32_16x16x64_bf16 v[32:35], v[48:51], a[112:119], v1
    v_add_f32 v20, v20, v22
    v_add_f32 v24, v24, v26
    v_add_f32 v21, v21, v23
    v_add_f32 v25, v25, v27
    v_cvt_pk_bf16_f32 v22, v20, v24
    v_cvt_pk_bf16_f32 v23, v21, v25
    ds_write_b32 v2, v22 offset:0
    ds_write_b32 v2, v23 offset:288
    v_smfmac_f32_16x16x64_bf16 v[28:31], v[52:55], a[120:127], v1
    v_smfmac_f32_16x16x64_bf16 v[32:35], v[52:55], a[128:135], v1
    s_waitcnt lgkmcnt(0)
    s_barrier
    ds_read_b128 v[40:43], v3 offset:0
    ds_read_b128 v[48:51], v3 offset:64
    ds_read_b128 v[20:23], v3 offset:128
    ds_read_b128 v[52:55], v3 offset:192
    v_smfmac_f32_16x16x64_bf16 v[28:31], v[36:39], a[136:143], v1
    v_smfmac_f32_16x16x64_bf16 v[32:35], v[36:39], a[144:151], v1
    ds_read_b128 v[36:39], v0 offset:17152
    v_lshlrev_b32 v9, 3, v0
    buffer_load_dword v11, v9, s[8:11], s68 offen
    v_smfmac_f32_16x16x64_bf16 v[28:31], v[44:47], a[168:175], v1
    v_smfmac_f32_16x16x64_bf16 v[32:35], v[44:47], a[176:183], v1
    ds_read_b128 v[44:47], v0 offset:18176
    s_waitcnt lgkmcnt(5)
    v_mfma_f32_16x16x32_bf16 v[12:15], v[56:59], v[40:43], 0
    v_mfma_f32_16x16x32_bf16 v[16:19], v[60:63], v[40:43], 0
    v_mfma_f32_16x16x32_bf16 v[24:27], v[40:43], v[40:43], 0
    ds_read_b128 v[56:59], v0 offset:19200
    ds_read_b128 v[60:63], v0 offset:20224
    s_waitcnt lgkmcnt(3)
    v_mfma_f32_16x16x32_bf16 v[12:15], v[36:39], v[48:51], v[12:15]
    v_lshrrev_b32 v10, 1, v0
    v_lshrrev_b32 v9, 9, v0
    s_waitcnt lgkmcnt(2)
    v_mfma_f32_16x16x32_bf16 v[16:19], v[44:47], v[48:51], v[16:19]
    v_lshl_add_u32 v9, v9, 5, v10
    v_add_f32 v28, v28, v30
    v_mfma_f32_16x16x32_bf16 v[24:27], v[48:51], v[48:51], v[24:27]
    v_add_f32 v32, v32, v34
    v_add_f32 v29, v29, v31
    ds_read_b128 v[36:39], v0 offset:21248
    ds_read_b128 v[44:47], v0 offset:22272
    s_waitcnt lgkmcnt(3)
    v_mfma_f32_16x16x32_bf16 v[12:15], v[56:59], v[20:23], v[12:15]
    v_add_f32 v33, v33, v35
    v_cvt_pk_bf16_f32 v30, v28, v29
    s_waitcnt lgkmcnt(2)
    v_mfma_f32_16x16x32_bf16 v[16:19], v[60:63], v[20:23], v[16:19]
    v_cvt_pk_bf16_f32 v31, v32, v33
    ds_read_b64 v[34:35], v9 offset:3456
    v_mfma_f32_16x16x32_bf16 v[24:27], v[20:23], v[20:23], v[24:27]
    s_add_u32 s17, s43, 3584
    buffer_store_dwordx2 v[30:31], v10, s[8:11], s17 offen sc1
    s_waitcnt lgkmcnt(2)
    v_mfma_f32_16x16x32_bf16 v[12:15], v[36:39], v[52:55], v[12:15]
    s_waitcnt lgkmcnt(1)
    v_mfma_f32_16x16x32_bf16 v[16:19], v[44:47], v[52:55], v[16:19]
    v_mfma_f32_16x16x32_bf16 v[24:27], v[52:55], v[52:55], v[24:27]
    s_add_u32 s17, s43, 1536
    s_waitcnt lgkmcnt(0)
    buffer_store_dwordx2 v[34:35], v10, s[8:11], s17 offen sc1
    s_cmp_eq_u32 s33, 63
    s_cbranch_scc1 Lr3s_last
    ds_read_b128 v[56:59], v8 offset:16384
    ds_read_b128 v[60:63], v8 offset:17408
    v_mov_b64 v[20:21], s[52:53]
    v_mov_b64 v[22:23], s[52:53]
    v_mov_b32 v41, 0
    v_mov_b32 v42, 0
    v_max3_f32 v9, v12, v13, v14
    v_max3_f32 v9, v9, v15, v16
    v_max3_f32 v9, v9, v17, v18
    v_max3_f32 v9, v9, v19, v24
    v_max_f32 v9, v9, v25
    v_mov_b32 v10, v9
    v_mov_b64 v[32:33], 0
    v_mov_b64 v[34:35], 0
    v_permlane32_swap_b32 v9, v10
    v_max_f32 v9, v9, v10
    v_mov_b32 v10, v9
    s_nop 1
    v_permlane16_swap_b32 v9, v10
    v_max_f32 v9, v9, v10
    v_mul_f32 v28, s44, v9
    v_fma_f32 v12, v12, s44, -v28
    v_fma_f32 v13, v13, s44, -v28
    v_fma_f32 v14, v14, s44, -v28
    v_fma_f32 v15, v15, s44, -v28
    v_exp_f32 v12, v12
    v_exp_f32 v13, v13
    v_fma_f32 v16, v16, s44, -v28
    v_fma_f32 v17, v17, s44, -v28
    v_exp_f32 v14, v14
    v_exp_f32 v15, v15
    v_cvt_pk_bf16_f32 v36, v12, v13
    v_fma_f32 v18, v18, s44, -v28
    v_fma_f32 v19, v19, s44, -v28
    v_exp_f32 v16, v16
    v_exp_f32 v17, v17
    v_cvt_pk_bf16_f32 v37, v14, v15
    v_fma_f32 v24, v24, s44, -v28
    v_fma_f32 v25, v25, s44, -v28
    v_exp_f32 v18, v18
    v_exp_f32 v19, v19
    v_cvt_pk_bf16_f32 v38, v16, v17
    v_exp_f32 v24, v24
    v_exp_f32 v25, v25
    v_cvt_pk_bf16_f32 v39, v18, v19
    v_cvt_pk_bf16_f32 v40, v24, v25
    v_cvt_pk_bf16_f32 v43, v24, v25
    v_mfma_f32_16x16x32_bf16 v[52:55], v[20:23], v[36:39], 0
    v_mov_b64 v[12:13], 0
    v_mov_b64 v[14:15], 0
    s_waitcnt vmcnt(4)
    v_mfma_f32_16x16x32_bf16 v[44:47], v[64:67], v[36:39], 0
    v_mov_b64 v[24:25], 0
    v_mov_b64 v[26:27], 0
    s_waitcnt vmcnt(3)
    v_mfma_f32_16x16x32_bf16 v[48:51], v[68:71], v[36:39], 0
    ds_read_b128 v[64:67], v8 offset:20480
    ds_read_b128 v[68:71], v8 offset:21504
    v_mfma_f32_16x16x16_bf16 v[52:55], v[20:21], v[40:41], v[52:55]
    v_mfma_f32_16x16x16_bf16 v[44:47], v[30:31], v[40:41], v[44:47]
    v_mov_b64 v[20:21], 0
    v_mov_b64 v[22:23], 0
    v_mfma_f32_16x16x16_bf16 v[48:51], v[30:31], v[42:43], v[48:51]
    v_mov_b64 v[36:37], 0
    v_mov_b64 v[38:39], 0
    v_mov_b64 v[40:41], 0
    v_mov_b64 v[42:43], 0
    v_rcp_f32 v9, v52
    v_mov_b64 v[52:53], 0
    v_mov_b64 v[54:55], 0
    v_mul_f32 v44, v9, v44
    v_mul_f32 v48, v9, v48
    v_cvt_pk_bf16_f32 v16, v44, v48
    v_mul_f32 v45, v9, v45
    v_mul_f32 v49, v9, v49
    v_cvt_pk_bf16_f32 v17, v45, v49
    v_mul_f32 v46, v9, v46
    v_mul_f32 v50, v9, v50
    v_cvt_pk_bf16_f32 v18, v46, v50
    v_mul_f32 v47, v9, v47
    v_mul_f32 v51, v9, v51
    v_cvt_pk_bf16_f32 v19, v47, v51
    ds_write_b128 v5, v[16:19]
    v_mov_b64 v[28:29], 0
    v_mov_b64 v[30:31], 0
    s_waitcnt lgkmcnt(0)
    s_barrier
    ds_read_b128 v[44:47], v4 offset:0
    ds_read_b128 v[48:51], v4 offset:128
    v_mov_b64 v[16:17], 0
    v_mov_b64 v[18:19], 0
    buffer_load_dwordx4 v0, s[8:11], s41 offen offset:0 lds
    buffer_load_dwordx4 v0, s[8:11], s41 offen offset:1024 lds
    s_waitcnt lgkmcnt(1)
    v_smfmac_f32_16x16x64_bf16 v[12:15], v[44:47], a[184:191], v1
    s_waitcnt lgkmcnt(0)
    v_smfmac_f32_16x16x64_bf16 v[12:15], v[48:51], a[192:199], v1
    v_smfmac_f32_16x16x64_bf16 v[24:27], v[44:47], a[200:207], v1
    v_smfmac_f32_16x16x64_bf16 v[24:27], v[48:51], a[208:215], v1
    v_add_f32 v12, v12, v14
    v_smfmac_f32_16x16x64_bf16 v[20:23], v[44:47], a[216:223], v1
    v_add_f32 v13, v13, v15
    v_smfmac_f32_16x16x64_bf16 v[20:23], v[48:51], a[224:231], v1
    v_cvt_pk_bf16_f32 v12, v12, v13
    v_smfmac_f32_16x16x64_bf16 v[16:19], v[44:47], a[232:239], v1
    v_add_f32 v24, v24, v26
    v_smfmac_f32_16x16x64_bf16 v[16:19], v[48:51], a[240:247], v1
    v_add_f32 v25, v25, v27
    v_smfmac_f32_16x16x64_bf16 v[36:39], v[44:47], v[56:63], v1
    v_cvt_pk_bf16_f32 v13, v24, v25
    v_smfmac_f32_16x16x64_bf16 v[36:39], v[48:51], v[64:71], v1
    v_add_f32 v20, v20, v22
    v_add_f32 v21, v21, v23
    v_cvt_pk_bf16_f32 v14, v20, v21
    v_add_f32 v16, v16, v18
    v_add_f32 v17, v17, v19
    v_cvt_pk_bf16_f32 v15, v16, v17
    v_and_or_b32 v15, v15, -2, s40
    buffer_store_dwordx4 v[12:15], v0, s[8:11], s38 offen sc1
    s_nop 0
    ds_read_b128 v[12:15], v8 offset:18432
    ds_read_b128 v[16:19], v8 offset:19456
    ds_read_b128 v[20:23], v8 offset:22528
    ds_read_b128 v[24:27], v8 offset:23552
    ds_read_b128 v[56:59], v8 offset:24576
    ds_read_b128 v[60:63], v8 offset:25600
    ds_read_b128 v[64:67], v8 offset:28672
    ds_read_b128 v[68:71], v8 offset:29696
    s_waitcnt lgkmcnt(6)
    v_smfmac_f32_16x16x64_bf16 v[40:43], v[44:47], v[12:19], v1
    ds_read_b128 v[12:15], v8 offset:26624
    ds_read_b128 v[16:19], v8 offset:27648
    s_waitcnt lgkmcnt(6)
    v_smfmac_f32_16x16x64_bf16 v[40:43], v[48:51], v[20:27], v1
    ds_read_b128 v[20:23], v8 offset:30720
    ds_read_b128 v[24:27], v8 offset:31744
    s_waitcnt lgkmcnt(6)
    v_smfmac_f32_16x16x64_bf16 v[52:55], v[44:47], v[56:63], v1
    ds_read_b128 v[56:59], v8 offset:32768
    ds_read_b128 v[60:63], v8 offset:33792
    s_waitcnt lgkmcnt(6)
    v_smfmac_f32_16x16x64_bf16 v[52:55], v[48:51], v[64:71], v1
    s_waitcnt lgkmcnt(4)
    v_smfmac_f32_16x16x64_bf16 v[32:35], v[44:47], v[12:19], v1
    s_waitcnt lgkmcnt(2)
    v_smfmac_f32_16x16x64_bf16 v[32:35], v[48:51], v[20:27], v1
    v_smfmac_f32_16x16x64_bf16 v[28:31], v[44:47], a[248:255], v1
    s_waitcnt lgkmcnt(0)
    v_smfmac_f32_16x16x64_bf16 v[28:31], v[48:51], v[56:63], v1
    v_add_f32 v36, v36, v38
    v_add_f32 v37, v37, v39
    v_cvt_pk_bf16_f32 v36, v36, v37
    v_add_f32 v40, v40, v42
    v_add_f32 v41, v41, v43
    v_cvt_pk_bf16_f32 v37, v40, v41
    v_add_f32 v52, v52, v54
    v_add_f32 v53, v53, v55
    v_cvt_pk_bf16_f32 v38, v52, v53
    v_add_f32 v32, v32, v34
    v_add_f32 v33, v33, v35
    v_cvt_pk_bf16_f32 v39, v32, v33
    v_and_or_b32 v39, v39, -2, s40
    s_add_u32 s17, s38, 4096
    buffer_store_dwordx4 v[36:39], v0, s[8:11], s17 offen sc1
    v_add_f32 v28, v28, v30
    v_add_f32 v29, v29, v31
    v_cvt_pk_bf16_f32 v28, v28, v29
    v_and_or_b32 v28, v28, -2, s40
    v_lshrrev_b32 v9, 2, v0
    buffer_store_dword v28, v9, s[8:11], s39 offen sc1
    s_xor_b32 s34, s34, 16384
    s_xor_b32 s35, s35, 16384
    s_add_u32 s33, s33, 1
    s_add_u32 s42, s42, 262144
    s_add_u32 s41, s41, 262144
    s_add_u32 s43, s43, 131072
    s_add_u32 s68, s68, 262144
    s_add_u32 s66, s66, 22528
    s_xor_b32 s40, s40, 1
    ds_read_b128 v[56:59], v8 offset:0
    ds_read_b128 v[60:63], v8 offset:1024
    ds_read_b128 v[64:67], v8 offset:2048
    ds_read_b128 v[68:71], v8 offset:3072
    v_mov_b64 v[12:13], 0
    v_mov_b64 v[14:15], 0
    v_mov_b64 v[16:17], 0
    v_mov_b64 v[18:19], 0
    v_mov_b64 v[20:21], 0
    v_mov_b64 v[22:23], 0
    v_mov_b64 v[24:25], 0
    v_mov_b64 v[26:27], 0
    v_mov_b64 v[28:29], 0
    v_mov_b64 v[30:31], 0
    v_mov_b64 v[32:33], 0
    v_mov_b64 v[34:35], 0
    s_sleep 5
    s_nop 9
    buffer_load_dwordx4 v[36:39], v0, s[8:11], s34 offen sc1
    s_nop 15
    s_nop 8
    buffer_load_dwordx4 v[36:39], v0, s[8:11], s34 offen sc1
    s_nop 15
    s_nop 8
    buffer_load_dwordx4 v[36:39], v0, s[8:11], s34 offen sc1
    s_waitcnt lgkmcnt(0)
    s_branch Lr3s_step
Lr3s_pb_re:
    s_mov_b32 s16, 0
Lr3s_pb_lp:
    s_add_u32 s17, s34, 4096
    buffer_load_dwordx4 v[40:43], v0, s[8:11], s17 offen sc1
    s_add_u32 s16, s16, 1
    s_cmp_gt_u32 s16, 100000
    s_cbranch_scc1 Lr_abort
    s_waitcnt vmcnt(0)
    v_max3_u32 v10, v40, v41, v42
    v_max_u32 v10, v10, v43
    v_cmp_eq_u32 vcc, -1, v10
    s_nop 0
    s_cbranch_vccnz Lr3s_pb_lp
    s_branch Lr3s_pb_ok
Lr3s_pc_re:
    s_mov_b32 s16, 0
Lr3s_pc_lp:
    buffer_load_dwordx4 v[44:47], v0, s[8:11], s35 offen sc1
    s_add_u32 s16, s16, 1
    s_cmp_gt_u32 s16, 100000
    s_cbranch_scc1 Lr_abort
    s_waitcnt vmcnt(0)
    v_max3_u32 v10, v44, v45, v46
    v_max_u32 v10, v10, v47
    v_cmp_eq_u32 vcc, -1, v10
    s_nop 0
    s_cbranch_vccnz Lr3s_pc_lp
    s_branch Lr3s_pc_ok
Lr3s_last:
    s_waitcnt vmcnt(0) lgkmcnt(0)
    s_barrier
    s_branch Lr_exit
Lr_abort:
    s_waitcnt lgkmcnt(0)
    s_mov_b64 exec, -1
    v_mov_b32 v0, 60
    s_lshl_b32 s5, s3, 8
    s_or_b32 s5, s5, s4
    s_or_b32 s5, s5, 0x10000
    v_mov_b32 v1, s5
    global_store_dword v0, v1, s[12:13]
    s_endpgm
Lr_exit:
    s_endpgm
.section .rodata,"a"
.p2align 6
.amdhsa_kernel interleave_layers__sliding_local_dilated__memory_aug_recurrent_mem_tr__prompt_kernel
  .amdhsa_next_free_vgpr 512
  .amdhsa_next_free_sgpr 102
  .amdhsa_accum_offset 256
  .amdhsa_group_segment_fixed_size 0
  .amdhsa_kernarg_size 104
  .amdhsa_user_sgpr_count 2
  .amdhsa_user_sgpr_kernarg_segment_ptr 1
  .amdhsa_system_sgpr_workgroup_id_x 1
.end_amdhsa_kernel
```

```asm
; @launch grid=(256,1,1) block=(256,1,1) lds=163840
.amdgcn_target "amdgcn-amd-amdhsa--gfx950"
.text
.globl interleave_layers__sliding_local_dilated__memory_aug_recurrent_mem_tr__prompt_kernel
.p2align 8
.type interleave_layers__sliding_local_dilated__memory_aug_recurrent_mem_tr__prompt_kernel,@function
interleave_layers__sliding_local_dilated__memory_aug_recurrent_mem_tr__prompt_kernel:
    s_cmp_ge_u32 s2, 256
    s_cbranch_scc1 L_exit
    s_load_dwordx2 s[8:9], s[0:1], 96
    s_mov_b32 s10, 268435456
    s_mov_b32 s11, 0x00020000
    s_waitcnt lgkmcnt(0)
    s_and_b32 s9, s9, 0xffff
    s_load_dwordx2 s[12:13], s[0:1], 88
    v_lshrrev_b32 v1, 6, v0
    s_getreg_b32 s3, hwreg(HW_REG_XCC_ID)
    v_readfirstlane_b32 s14, v1
    s_and_b32 s3, s3, 7
    s_and_b32 s17, s3, 1
    s_lshl_b32 s17, s17, 7
    s_lshl_b32 s18, s3, 1
    s_and_b32 s18, s18, 12
    s_add_u32 s17, s17, s18
    v_mov_b32 v2, 0
    v_mov_b32 v3, 1
    v_mov_b32 v4, s17
    s_mov_b32 s33, 0
    s_waitcnt lgkmcnt(0)
    s_cmp_lg_u32 s14, 0
    s_cbranch_scc1 L_tk_wait
    s_mov_b64 exec, 1
    global_atomic_add v3, v4, v3, s[12:13] sc0
    s_waitcnt vmcnt(0)
    v_readfirstlane_b32 s4, v3
    s_nop 0
    s_cmp_lt_u32 s4, 32
    s_cbranch_scc1 L_tk_have
    v_mov_b32 v3, 1
    v_mov_b32 v4, 32
    global_atomic_add v3, v4, v3, s[12:13] sc0
    s_waitcnt vmcnt(0)
    v_readfirstlane_b32 s5, v3
    s_mov_b64 exec, 0xff
    v_and_b32 v4, 1, v0
    v_lshlrev_b32 v4, 7, v4
    v_lshlrev_b32 v5, 1, v0
    v_and_or_b32 v4, v5, 12, v4
    s_mov_b32 s16, 0
L_hl_poll:
    global_load_dword v5, v4, s[12:13] sc1
    s_add_u32 s16, s16, 1
    s_cmp_gt_u32 s16, 100000
    s_cbranch_scc1 L_abort
    s_mov_b32 s6, 0
    s_waitcnt vmcnt(0)
    v_readlane_b32 s40, v5, 0
    s_nop 0
    s_add_u32 s6, s6, s40
    v_readlane_b32 s41, v5, 1
    s_nop 0
    s_add_u32 s6, s6, s41
    v_readlane_b32 s42, v5, 2
    s_nop 0
    s_add_u32 s6, s6, s42
    v_readlane_b32 s43, v5, 3
    s_nop 0
    s_add_u32 s6, s6, s43
    v_readlane_b32 s44, v5, 4
    s_nop 0
    s_add_u32 s6, s6, s44
    v_readlane_b32 s45, v5, 5
    s_nop 0
    s_add_u32 s6, s6, s45
    v_readlane_b32 s46, v5, 6
    s_nop 0
    s_add_u32 s6, s6, s46
    v_readlane_b32 s47, v5, 7
    s_nop 0
    s_add_u32 s6, s6, s47
    s_cmp_lt_u32 s6, 256
    s_cbranch_scc1 L_hl_poll
    s_mov_b32 s3, 0
    s_mov_b32 s4, 0
    s_min_u32 s6, s47, 32
    s_sub_u32 s7, 32, s6
    s_cmp_lt_u32 s5, s7
    s_cselect_b32 s3, 7, s3
    s_add_u32 s6, s6, s5
    s_cmp_lt_u32 s5, s7
    s_cselect_b32 s4, s6, s4
    s_sub_u32 s5, s5, s7
    s_min_u32 s6, s46, 32
    s_sub_u32 s7, 32, s6
    s_cmp_lt_u32 s5, s7
    s_cselect_b32 s3, 6, s3
    s_add_u32 s6, s6, s5
    s_cmp_lt_u32 s5, s7
    s_cselect_b32 s4, s6, s4
    s_sub_u32 s5, s5, s7
    s_min_u32 s6, s45, 32
    s_sub_u32 s7, 32, s6
    s_cmp_lt_u32 s5, s7
    s_cselect_b32 s3, 5, s3
    s_add_u32 s6, s6, s5
    s_cmp_lt_u32 s5, s7
    s_cselect_b32 s4, s6, s4
    s_sub_u32 s5, s5, s7
    s_min_u32 s6, s44, 32
    s_sub_u32 s7, 32, s6
    s_cmp_lt_u32 s5, s7
    s_cselect_b32 s3, 4, s3
    s_add_u32 s6, s6, s5
    s_cmp_lt_u32 s5, s7
    s_cselect_b32 s4, s6, s4
    s_sub_u32 s5, s5, s7
    s_min_u32 s6, s43, 32
    s_sub_u32 s7, 32, s6
    s_cmp_lt_u32 s5, s7
    s_cselect_b32 s3, 3, s3
    s_add_u32 s6, s6, s5
    s_cmp_lt_u32 s5, s7
    s_cselect_b32 s4, s6, s4
    s_sub_u32 s5, s5, s7
    s_min_u32 s6, s42, 32
    s_sub_u32 s7, 32, s6
    s_cmp_lt_u32 s5, s7
    s_cselect_b32 s3, 2, s3
    s_add_u32 s6, s6, s5
    s_cmp_lt_u32 s5, s7
    s_cselect_b32 s4, s6, s4
    s_sub_u32 s5, s5, s7
    s_min_u32 s6, s41, 32
    s_sub_u32 s7, 32, s6
    s_cmp_lt_u32 s5, s7
    s_cselect_b32 s3, 1, s3
    s_add_u32 s6, s6, s5
    s_cmp_lt_u32 s5, s7
    s_cselect_b32 s4, s6, s4
    s_sub_u32 s5, s5, s7
    s_min_u32 s6, s40, 32
    s_sub_u32 s7, 32, s6
    s_cmp_lt_u32 s5, s7
    s_cselect_b32 s3, 0, s3
    s_add_u32 s6, s6, s5
    s_cmp_lt_u32 s5, s7
    s_cselect_b32 s4, s6, s4
    s_sub_u32 s5, s5, s7
L_tk_have:
    s_lshl_b32 s5, s3, 8
    s_or_b32 s5, s5, s4
    v_mov_b32 v3, s5
    s_mov_b64 exec, 1
    ds_write_b32 v2, v3
    s_mov_b64 exec, -1
L_tk_wait:
    s_waitcnt vmcnt(0) lgkmcnt(0)
    s_barrier
    ds_read_b32 v3, v2
    s_waitcnt lgkmcnt(0)
    v_readfirstlane_b32 s5, v3
    s_nop 0
    s_lshr_b32 s3, s5, 8
    s_and_b32 s4, s5, 255
    s_barrier
    s_cmp_lt_u32 s3, 2
    s_cbranch_scc1 L_role_r
    s_sub_u32 s6, s3, 2
    s_lshl_b32 s6, s6, 5
    s_add_u32 s6, s6, s4
    s_load_dwordx2 s[20:21], s[0:1], 8
    s_mov_b32 s22, 1990656
    s_mov_b32 s23, 0x00020000
    s_waitcnt lgkmcnt(0)
    s_and_b32 s21, s21, 0xffff
    s_load_dwordx2 s[24:25], s[0:1], 16
    s_mov_b32 s26, 663552
    s_mov_b32 s27, 0x00020000
    s_waitcnt lgkmcnt(0)
    s_and_b32 s25, s25, 0xffff
    s_sub_u32 s41, 191, s6
    s_lshl_b32 s41, s41, 15
    v_lshlrev_b32 v254, 7, v0
    buffer_load_dword v255, v254, s[20:23], s41 offen
    s_sub_u32 s41, s41, 1998848
    s_cmp_lt_u32 s41, 688128
    s_cselect_b32 s41, s41, 0x7f000000
    s_waitcnt vmcnt(0)
    buffer_load_dword v255, v254, s[24:27], s41 offen
    s_cmp_ge_u32 s6, 192
    s_cbranch_scc1 Li_end
    s_sub_u32 s41, s6, 64
    s_cmp_lt_u32 s41, 64
    s_cbranch_scc1 Li_end
Li_body:
    v_lshlrev_b32 v7, 4, v0
    v_mov_b32 v12, 0
    v_mov_b32 v13, 0
    v_mov_b32 v14, 0
    v_mov_b32 v15, 0
    s_cmp_ge_u32 s6, 64
    s_cbranch_scc1 Li_rest
    s_load_dwordx2 s[20:21], s[0:1], 0
    s_mov_b32 s22, 2359296
    s_mov_b32 s23, 0x00020000
    s_waitcnt lgkmcnt(0)
    s_and_b32 s21, s21, 0xffff
    v_and_b32 v1, 31, v0
    v_lshrrev_b32 v2, 5, v0
    v_mul_u32_u24 v3, 1152, v1
    v_mul_u32_u24 v5, 144, v2
    v_add_u32 v3, v3, v5
    s_mul_i32 s41, s6, 36864
    buffer_load_dwordx4 v[64:67], v3, s[20:23], s41 offen offset:0
    buffer_load_dwordx4 v[68:71], v3, s[20:23], s41 offen offset:16
    buffer_load_dwordx4 v[72:75], v3, s[20:23], s41 offen offset:32
    buffer_load_dwordx4 v[76:79], v3, s[20:23], s41 offen offset:48
    buffer_load_dwordx4 v[80:83], v3, s[20:23], s41 offen offset:64
    buffer_load_dwordx4 v[84:87], v3, s[20:23], s41 offen offset:80
    buffer_load_dwordx4 v[88:91], v3, s[20:23], s41 offen offset:96
    buffer_load_dwordx4 v[92:95], v3, s[20:23], s41 offen offset:112
    buffer_load_dwordx4 v[96:99], v3, s[20:23], s41 offen offset:128
    v_mul_u32_u24 v4, 4608, v2
    v_lshl_add_u32 v4, v1, 4, v4
    s_mul_i32 s41, s6, 36864
    s_add_u32 s41, s41, 6291456
    s_mul_i32 s42, s6, 6144
    s_add_u32 s42, s42, 15728640
    s_add_u32 s43, s42, 2048
    s_add_u32 s44, s42, 396288
    v_mov_b32 v60, 0
    v_mov_b32 v61, 0
    s_waitcnt vmcnt(8)
    buffer_store_dwordx4 v[64:67], v4, s[8:11], s41 offen offset:0 sc1
    s_waitcnt vmcnt(8)
    buffer_store_dwordx4 v[68:71], v4, s[8:11], s41 offen offset:512 sc1
    s_waitcnt vmcnt(8)
    buffer_store_dwordx4 v[72:75], v4, s[8:11], s41 offen offset:1024 sc1
    s_waitcnt vmcnt(8)
    buffer_store_dwordx4 v[76:79], v4, s[8:11], s41 offen offset:1536 sc1
    s_waitcnt vmcnt(8)
    buffer_store_dwordx4 v[80:83], v4, s[8:11], s41 offen offset:2048 sc1
    s_waitcnt vmcnt(8)
    buffer_store_dwordx4 v[84:87], v4, s[8:11], s41 offen offset:2560 sc1
    s_waitcnt vmcnt(8)
    buffer_store_dwordx4 v[88:91], v4, s[8:11], s41 offen offset:3072 sc1
    s_waitcnt vmcnt(8)
    buffer_store_dwordx4 v[92:95], v4, s[8:11], s41 offen offset:3584 sc1
    v_add_u32 v4, 4096, v4
    s_waitcnt vmcnt(8)
    buffer_store_dwordx4 v[96:99], v4, s[8:11], s41 offen offset:0 sc1
    buffer_store_dwordx4 v[12:15], v7, s[8:11], s43 offen sc1
    v_cmp_gt_u32 vcc, 192, v0
    s_nop 0
    s_and_saveexec_b64 s[46:47], vcc
    s_cbranch_execz Li_z1
    buffer_store_dwordx4 v[12:15], v7, s[8:11], s44 offen sc1
Li_z1:
    s_mov_b64 exec, s[46:47]
    v_mov_b32 v62, 0x3f803f80
    v_dot2c_f32_bf16 v60, v64, v62
    v_dot2c_f32_bf16 v61, v64, v64
    v_dot2c_f32_bf16 v60, v65, v62
    v_dot2c_f32_bf16 v61, v65, v65
    v_dot2c_f32_bf16 v60, v66, v62
    v_dot2c_f32_bf16 v61, v66, v66
    v_dot2c_f32_bf16 v60, v67, v62
    v_dot2c_f32_bf16 v61, v67, v67
    v_dot2c_f32_bf16 v60, v68, v62
    v_dot2c_f32_bf16 v61, v68, v68
    v_dot2c_f32_bf16 v60, v69, v62
    v_dot2c_f32_bf16 v61, v69, v69
    v_dot2c_f32_bf16 v60, v70, v62
    v_dot2c_f32_bf16 v61, v70, v70
    v_dot2c_f32_bf16 v60, v71, v62
    v_dot2c_f32_bf16 v61, v71, v71
    v_dot2c_f32_bf16 v60, v72, v62
    v_dot2c_f32_bf16 v61, v72, v72
    v_dot2c_f32_bf16 v60, v73, v62
    v_dot2c_f32_bf16 v61, v73, v73
    v_dot2c_f32_bf16 v60, v74, v62
    v_dot2c_f32_bf16 v61, v74, v74
    v_dot2c_f32_bf16 v60, v75, v62
    v_dot2c_f32_bf16 v61, v75, v75
    v_dot2c_f32_bf16 v60, v76, v62
    v_dot2c_f32_bf16 v61, v76, v76
    v_dot2c_f32_bf16 v60, v77, v62
    v_dot2c_f32_bf16 v61, v77, v77
    v_dot2c_f32_bf16 v60, v78, v62
    v_dot2c_f32_bf16 v61, v78, v78
    v_dot2c_f32_bf16 v60, v79, v62
    v_dot2c_f32_bf16 v61, v79, v79
    v_dot2c_f32_bf16 v60, v80, v62
    v_dot2c_f32_bf16 v61, v80, v80
    v_dot2c_f32_bf16 v60, v81, v62
    v_dot2c_f32_bf16 v61, v81, v81
    v_dot2c_f32_bf16 v60, v82, v62
    v_dot2c_f32_bf16 v61, v82, v82
    v_dot2c_f32_bf16 v60, v83, v62
    v_dot2c_f32_bf16 v61, v83, v83
    v_dot2c_f32_bf16 v60, v84, v62
    v_dot2c_f32_bf16 v61, v84, v84
    v_dot2c_f32_bf16 v60, v85, v62
    v_dot2c_f32_bf16 v61, v85, v85
    v_dot2c_f32_bf16 v60, v86, v62
    v_dot2c_f32_bf16 v61, v86, v86
    v_dot2c_f32_bf16 v60, v87, v62
    v_dot2c_f32_bf16 v61, v87, v87
    v_dot2c_f32_bf16 v60, v88, v62
    v_dot2c_f32_bf16 v61, v88, v88
    v_dot2c_f32_bf16 v60, v89, v62
    v_dot2c_f32_bf16 v61, v89, v89
    v_dot2c_f32_bf16 v60, v90, v62
    v_dot2c_f32_bf16 v61, v90, v90
    v_dot2c_f32_bf16 v60, v91, v62
    v_dot2c_f32_bf16 v61, v91, v91
    v_dot2c_f32_bf16 v60, v92, v62
    v_dot2c_f32_bf16 v61, v92, v92
    v_dot2c_f32_bf16 v60, v93, v62
    v_dot2c_f32_bf16 v61, v93, v93
    v_dot2c_f32_bf16 v60, v94, v62
    v_dot2c_f32_bf16 v61, v94, v94
    v_dot2c_f32_bf16 v60, v95, v62
    v_dot2c_f32_bf16 v61, v95, v95
    v_dot2c_f32_bf16 v60, v96, v62
    v_dot2c_f32_bf16 v61, v96, v96
    v_dot2c_f32_bf16 v60, v97, v62
    v_dot2c_f32_bf16 v61, v97, v97
    v_dot2c_f32_bf16 v60, v98, v62
    v_dot2c_f32_bf16 v61, v98, v98
    v_dot2c_f32_bf16 v60, v99, v62
    v_dot2c_f32_bf16 v61, v99, v99
    s_nop 3
    v_lshrrev_b32 v5, 1, v2
    v_lshlrev_b32 v5, 9, v5
    v_lshl_add_u32 v5, v1, 4, v5
    v_and_b32 v6, 1, v2
    v_lshl_add_u32 v5, v6, 3, v5
    buffer_store_dwordx2 v[60:61], v5, s[8:11], s42 offen sc1
    s_branch Li_flags
Li_rest:
    s_cmp_ge_u32 s6, 128
    s_cbranch_scc1 Li_pre
    s_sub_u32 s41, s6, 64
    s_mul_i32 s41, s41, 6144
    s_add_u32 s41, s41, 16911360
    v_cmp_gt_u32 vcc, 192, v0
    s_nop 0
    s_and_saveexec_b64 s[42:43], vcc
    s_cbranch_execz Li_rest2
    buffer_store_dwordx4 v[12:15], v7, s[8:11], s41 offen sc1
Li_rest2:
    s_mov_b64 exec, s[42:43]
    s_load_dwordx2 s[20:21], s[0:1], 80
    s_mov_b32 s22, 2359296
    s_mov_b32 s23, 0x00020000
    s_waitcnt lgkmcnt(0)
    s_and_b32 s21, s21, 0xffff
    s_sub_u32 s44, s6, 64
    s_mul_i32 s45, s44, 36864
    s_add_u32 s46, s45, 19660800
    buffer_store_dwordx4 v[12:15], v7, s[8:11], s46 offen sc1
    buffer_store_dwordx4 v[12:15], v7, s[20:23], s45 offen sc1
    s_add_u32 s46, s46, 4096
    s_add_u32 s45, s45, 4096
    buffer_store_dwordx4 v[12:15], v7, s[8:11], s46 offen sc1
    buffer_store_dwordx4 v[12:15], v7, s[20:23], s45 offen sc1
    s_add_u32 s46, s46, 4096
    s_add_u32 s45, s45, 4096
    buffer_store_dwordx4 v[12:15], v7, s[8:11], s46 offen sc1
    buffer_store_dwordx4 v[12:15], v7, s[20:23], s45 offen sc1
    s_add_u32 s46, s46, 4096
    s_add_u32 s45, s45, 4096
    buffer_store_dwordx4 v[12:15], v7, s[8:11], s46 offen sc1
    buffer_store_dwordx4 v[12:15], v7, s[20:23], s45 offen sc1
    s_add_u32 s46, s46, 4096
    s_add_u32 s45, s45, 4096
    buffer_store_dwordx4 v[12:15], v7, s[8:11], s46 offen sc1
    buffer_store_dwordx4 v[12:15], v7, s[20:23], s45 offen sc1
    s_add_u32 s46, s46, 4096
    s_add_u32 s45, s45, 4096
    buffer_store_dwordx4 v[12:15], v7, s[8:11], s46 offen sc1
    buffer_store_dwordx4 v[12:15], v7, s[20:23], s45 offen sc1
    s_add_u32 s46, s46, 4096
    s_add_u32 s45, s45, 4096
    buffer_store_dwordx4 v[12:15], v7, s[8:11], s46 offen sc1
    buffer_store_dwordx4 v[12:15], v7, s[20:23], s45 offen sc1
    s_add_u32 s46, s46, 4096
    s_add_u32 s45, s45, 4096
    buffer_store_dwordx4 v[12:15], v7, s[8:11], s46 offen sc1
    buffer_store_dwordx4 v[12:15], v7, s[20:23], s45 offen sc1
    s_add_u32 s46, s46, 4096
    s_add_u32 s45, s45, 4096
    buffer_store_dwordx4 v[12:15], v7, s[8:11], s46 offen sc1
    buffer_store_dwordx4 v[12:15], v7, s[20:23], s45 offen sc1
    s_mul_i32 s45, s44, 6144
    s_add_u32 s45, s45, 16515072
    buffer_store_dwordx4 v[12:15], v7, s[8:11], s45 offen sc1
    s_add_u32 s46, s45, 4096
    s_add_u32 s45, s45, 393216
    buffer_store_dwordx4 v[12:15], v7, s[8:11], s45 offen sc1
    v_cmp_gt_u32 vcc, 128, v0
    s_nop 0
    s_and_saveexec_b64 s[42:43], vcc
    s_cbranch_execz Li_rest3
    buffer_store_dwordx4 v[12:15], v7, s[8:11], s46 offen sc1
Li_rest3:
    s_mov_b64 exec, s[42:43]
    s_branch Li_flags
Li_pre:
    s_sub_u32 s44, s6, 128
    s_mul_i32 s45, s44, 36864
    s_add_u32 s45, s45, 17301504
    buffer_store_dwordx4 v[12:15], v7, s[8:11], s45 offen sc1
    s_add_u32 s45, s45, 4096
    buffer_store_dwordx4 v[12:15], v7, s[8:11], s45 offen sc1
    s_add_u32 s45, s45, 4096
    buffer_store_dwordx4 v[12:15], v7, s[8:11], s45 offen sc1
    s_add_u32 s45, s45, 4096
    buffer_store_dwordx4 v[12:15], v7, s[8:11], s45 offen sc1
    s_add_u32 s45, s45, 4096
    buffer_store_dwordx4 v[12:15], v7, s[8:11], s45 offen sc1
    s_add_u32 s45, s45, 4096
    buffer_store_dwordx4 v[12:15], v7, s[8:11], s45 offen sc1
    s_add_u32 s45, s45, 4096
    buffer_store_dwordx4 v[12:15], v7, s[8:11], s45 offen sc1
    s_add_u32 s45, s45, 4096
    buffer_store_dwordx4 v[12:15], v7, s[8:11], s45 offen sc1
    s_add_u32 s45, s45, 4096
    buffer_store_dwordx4 v[12:15], v7, s[8:11], s45 offen sc1
    s_mul_i32 s45, s44, 6144
    s_add_u32 s45, s45, 16121856
    v_cmp_gt_u32 vcc, 192, v0
    s_nop 0
    s_and_saveexec_b64 s[46:47], vcc
    s_cbranch_execz Li_z0
    buffer_store_dwordx4 v[12:15], v7, s[8:11], s45 offen sc1
Li_z0:
    s_mov_b64 exec, s[46:47]
    s_cmp_ge_u32 s6, 136
    s_cbranch_scc1 Li_nofl
Li_flags:
    v_cmp_gt_u32 vcc, 96, v0
    s_cmp_lt_u32 s6, 64
    s_cselect_b64 s[42:43], -1, 0
    s_and_b64 vcc, vcc, s[42:43]
    s_cmp_lt_u32 s6, 128
    s_cselect_b32 s44, 0, 0
    v_mov_b32 v12, s44
    v_mov_b32 v13, s44
    v_mov_b32 v14, s44
    v_mov_b32 v15, s44
    v_mov_b32 v9, 1
    v_cndmask_b32 v8, v12, v9, vcc
    v_mov_b32 v9, v8
    v_mov_b32 v10, v8
    v_mov_b32 v11, v8
    s_mul_i32 s41, s6, 22528
    s_sub_u32 s42, s6, 128
    s_lshl_b32 s42, s42, 12
    s_add_u32 s42, s42, 2883584
    s_cmp_ge_u32 s6, 128
    s_cselect_b32 s41, s42, s41
    buffer_store_dwordx4 v[8:11], v7, s[8:11], s41 offen sc1
    s_cbranch_scc1 Li_nofl
    s_add_u32 s41, s41, 4096
    buffer_store_dwordx4 v[12:15], v7, s[8:11], s41 offen sc1
    s_add_u32 s41, s41, 4096
    buffer_store_dwordx4 v[12:15], v7, s[8:11], s41 offen sc1
    s_add_u32 s41, s41, 4096
    buffer_store_dwordx4 v[12:15], v7, s[8:11], s41 offen sc1
    s_add_u32 s41, s41, 4096
    buffer_store_dwordx4 v[12:15], v7, s[8:11], s41 offen sc1
    s_add_u32 s41, s41, 4096
    v_cmp_gt_u32 vcc, 128, v0
    s_nop 0
    s_and_saveexec_b64 s[42:43], vcc
    s_cbranch_execz Li_fl5
    buffer_store_dwordx4 v[12:15], v7, s[8:11], s41 offen sc1
Li_fl5:
    s_mov_b64 exec, s[42:43]
Li_nofl:
    s_waitcnt vmcnt(0)
    s_barrier
    s_cmp_lg_u32 s14, 0
    s_cbranch_scc1 Li_cnt
    s_sub_u32 s41, s6, 64
    s_cmp_lt_u32 s41, 64
    s_cbranch_scc1 Li_l1
    v_mov_b32 v2, 40
    v_mov_b32 v3, 1
    s_mov_b64 exec, 1
    global_atomic_add v2, v3, s[12:13]
    s_mov_b64 exec, -1
    s_branch Li_cnt
Li_l1:
    v_mov_b32 v2, 160
    v_mov_b32 v3, 1
    s_mov_b64 exec, 1
    global_atomic_add v2, v3, s[12:13]
    s_mov_b64 exec, -1
Li_cnt:
    s_cmp_lt_u32 s6, 128
    s_cbranch_scc1 Li_end
    s_sub_u32 s6, s6, 64
    s_branch Li_body
Li_end:
    s_cmp_lg_u32 s3, 2
    s_cbranch_scc1 L_cls2_no
    s_add_u32 s15, s4, 0
    s_cmp_lt_u32 s4, 24
    s_cbranch_scc1 L_role_tw
    s_add_u32 s15, s4, 4294967272
    s_cmp_lt_u32 s4, 32
    s_cbranch_scc1 L_role_p
    s_endpgm
L_cls2_no:
    s_cmp_lg_u32 s3, 3
    s_cbranch_scc1 L_cls3_no
    s_add_u32 s15, s4, 24
    s_cmp_lt_u32 s4, 12
    s_cbranch_scc1 L_role_tw
    s_add_u32 s15, s4, 4294967292
    s_cmp_lt_u32 s4, 32
    s_cbranch_scc1 L_role_p
    s_endpgm
L_cls3_no:
    s_cmp_lg_u32 s3, 4
    s_cbranch_scc1 L_cls4_no
    s_add_u32 s15, s4, 0
    s_cmp_lt_u32 s4, 16
    s_cbranch_scc1 L_role_aq
    s_add_u32 s15, s4, 4294967280
    s_cmp_lt_u32 s4, 19
    s_cbranch_scc1 L_role_awo
    s_add_u32 s15, s4, 9
    s_cmp_lt_u32 s4, 32
    s_cbranch_scc1 L_role_p
    s_endpgm
L_cls4_no:
    s_cmp_lg_u32 s3, 5
    s_cbranch_scc1 L_cls5_no
    s_add_u32 s15, s4, 16
    s_cmp_lt_u32 s4, 16
    s_cbranch_scc1 L_role_aq
    s_add_u32 s15, s4, 4294967283
    s_cmp_lt_u32 s4, 19
    s_cbranch_scc1 L_role_awo
    s_add_u32 s15, s4, 22
    s_cmp_lt_u32 s4, 32
    s_cbranch_scc1 L_role_p
    s_endpgm
L_cls5_no:
    s_cmp_lg_u32 s3, 6
    s_cbranch_scc1 L_cls6_no
    s_add_u32 s15, s4, 0
    s_cmp_lt_u32 s4, 11
    s_cbranch_scc1 L_role_ta
    s_add_u32 s15, s4, 43
    s_cmp_lt_u32 s4, 32
    s_cbranch_scc1 L_role_p
    s_endpgm
L_cls6_no:
    s_cmp_lg_u32 s3, 7
    s_cbranch_scc1 L_cls7_no
    s_add_u32 s15, s4, 11
    s_cmp_lt_u32 s4, 11
    s_cbranch_scc1 L_role_ta
    s_add_u32 s15, s4, 64
    s_cmp_lt_u32 s4, 32
    s_cbranch_scc1 L_role_p
    s_endpgm
L_cls7_no:
L_exit:
    s_endpgm
L_abort:
    s_waitcnt lgkmcnt(0)
    s_mov_b64 exec, -1
    v_mov_b32 v0, 60
    s_lshl_b32 s5, s3, 8
    s_or_b32 s5, s5, s4
    s_or_b32 s5, s5, 0x10000
    v_mov_b32 v1, s5
    global_store_dword v0, v1, s[12:13]
    s_endpgm
.p2align 6
L_role_p:
    v_and_b32 v5, 63, v0
    v_lshlrev_b32 v0, 4, v5
    v_and_b32 v7, 15, v5
    v_lshrrev_b32 v8, 4, v5
    v_min_u32 v1, 11, v5
    v_lshrrev_b32 v6, 2, v1
    v_and_b32 v1, 3, v1
    v_lshlrev_b32 v1, 2, v1
    v_lshl_add_u32 v1, v6, 7, v1
    v_mov_b32 v3, 1
    v_mov_b32 v4, 0
    s_mov_b32 s44, 0x05040100
    s_mov_b32 s45, 0x07060302
    s_cmp_ge_u32 s15, 48
    s_cselect_b32 s63, 1, 0
    s_cselect_b32 s17, 48, 0
    s_sub_u32 s15, s15, s17
    s_cmp_lt_u32 s15, 32
    s_cselect_b32 s50, 1, 0
    s_sub_u32 s17, s15, 32
    s_lshl_b32 s17, s17, 1
    s_cmp_eq_u32 s50, 1
    s_cselect_b32 s51, s15, s17
    s_cselect_b32 s17, 48, 40
    s_cselect_b32 s18, 56, 40
    s_load_dwordx2 s[20:21], s[0:1], s17
    s_load_dwordx2 s[24:25], s[0:1], s18
    s_mov_b32 s22, 4718592
    s_mov_b32 s23, 0x00020000
    s_mov_b32 s26, 4718592
    s_mov_b32 s27, 0x00020000
    s_lshl_b32 s49, s51, 8
    s_mul_i32 s17, s14, 131072
    s_add_u32 s49, s49, s17
    s_cmp_eq_u32 s50, 1
    s_cselect_b32 s17, 0, 256
    s_add_u32 s52, s49, s17
    s_waitcnt lgkmcnt(0)
    s_and_b32 s21, s21, 0xffff
    s_and_b32 s25, s25, 0xffff
    s_cmp_eq_u32 s63, 0
    s_cbranch_scc1 Lp2_gate_ng
    s_cmp_lg_u32 s14, 0
    s_cbranch_scc1 Lp2_gate_d
    v_mov_b32 v5, 48
    s_mov_b32 s16, 0
Lp2_gate:
    global_load_dword v6, v5, s[12:13] sc1
    s_add_u32 s16, s16, 1
    s_cmp_gt_u32 s16, 100000
    s_cbranch_scc1 L_role_p_abort
    s_waitcnt vmcnt(0)
    v_cmp_gt_u32 vcc, 32, v6
    s_nop 0
    s_cbranch_vccz Lp2_gate_d
    s_sleep 100
    s_branch Lp2_gate
Lp2_gate_d:
    s_barrier
Lp2_gate_ng:
    v_lshrrev_b32 v5, 8, v0
    v_bfe_u32 v6, v0, 6, 2
    v_xor_b32 v6, v6, v5
    v_lshlrev_b32 v6, 6, v6
    v_and_b32 v16, 0x30, v0
    v_add_u32 v16, v16, v6
    v_lshl_add_u32 v16, v5, 13, v16
    v_lshrrev_b32 v5, 2, v7
    v_xor_b32 v6, s14, v5
    v_lshlrev_b32 v17, 6, v6
    v_lshrrev_b32 v6, 1, v8
    v_lshl_add_u32 v5, v6, 3, v5
    v_lshl_add_u32 v17, v5, 8, v17
    v_and_b32 v5, 1, v8
    v_lshl_add_u32 v17, v5, 5, v17
    v_and_b32 v5, 3, v7
    v_lshl_add_u32 v17, v5, 3, v17
    v_add_u32 v18, 65536, v17
    s_lshl_b32 s46, s14, 12
    s_add_u32 m0, s46, 0
    s_add_u32 s17, s49, 0
    buffer_load_dwordx4 v16, s[20:23], s17 offen lds
    s_add_u32 m0, m0, 1024
    s_add_u32 s17, s49, 32768
    buffer_load_dwordx4 v16, s[20:23], s17 offen lds
    s_add_u32 m0, m0, 1024
    s_add_u32 s17, s49, 65536
    buffer_load_dwordx4 v16, s[20:23], s17 offen lds
    s_add_u32 m0, m0, 1024
    s_add_u32 s17, s49, 98304
    buffer_load_dwordx4 v16, s[20:23], s17 offen lds
    s_add_u32 m0, s46, 16384
    s_add_u32 s17, s49, 524288
    buffer_load_dwordx4 v16, s[20:23], s17 offen lds
    s_add_u32 m0, m0, 1024
    s_add_u32 s17, s49, 557056
    buffer_load_dwordx4 v16, s[20:23], s17 offen lds
    s_add_u32 m0, m0, 1024
    s_add_u32 s17, s49, 589824
    buffer_load_dwordx4 v16, s[20:23], s17 offen lds
    s_add_u32 m0, m0, 1024
    s_add_u32 s17, s49, 622592
    buffer_load_dwordx4 v16, s[20:23], s17 offen lds
    s_add_u32 m0, s46, 32768
    s_add_u32 s17, s49, 1048576
    buffer_load_dwordx4 v16, s[20:23], s17 offen lds
    s_add_u32 m0, m0, 1024
    s_add_u32 s17, s49, 1081344
    buffer_load_dwordx4 v16, s[20:23], s17 offen lds
    s_add_u32 m0, m0, 1024
    s_add_u32 s17, s49, 1114112
    buffer_load_dwordx4 v16, s[20:23], s17 offen lds
    s_add_u32 m0, m0, 1024
    s_add_u32 s17, s49, 1146880
    buffer_load_dwordx4 v16, s[20:23], s17 offen lds
    s_add_u32 m0, s46, 49152
    s_add_u32 s17, s49, 1572864
    buffer_load_dwordx4 v16, s[20:23], s17 offen lds
    s_add_u32 m0, m0, 1024
    s_add_u32 s17, s49, 1605632
    buffer_load_dwordx4 v16, s[20:23], s17 offen lds
    s_add_u32 m0, m0, 1024
    s_add_u32 s17, s49, 1638400
    buffer_load_dwordx4 v16, s[20:23], s17 offen lds
    s_add_u32 m0, m0, 1024
    s_add_u32 s17, s49, 1671168
    buffer_load_dwordx4 v16, s[20:23], s17 offen lds
    s_add_u32 m0, s46, 65536
    s_add_u32 s17, s49, 2097152
    buffer_load_dwordx4 v16, s[20:23], s17 offen lds
    s_add_u32 m0, m0, 1024
    s_add_u32 s17, s49, 2129920
    buffer_load_dwordx4 v16, s[20:23], s17 offen lds
    s_add_u32 m0, m0, 1024
    s_add_u32 s17, s49, 2162688
    buffer_load_dwordx4 v16, s[20:23], s17 offen lds
    s_add_u32 m0, m0, 1024
    s_add_u32 s17, s49, 2195456
    buffer_load_dwordx4 v16, s[20:23], s17 offen lds
    s_add_u32 m0, s46, 81920
    s_add_u32 s17, s49, 2621440
    buffer_load_dwordx4 v16, s[20:23], s17 offen lds
    s_add_u32 m0, m0, 1024
    s_add_u32 s17, s49, 2654208
    buffer_load_dwordx4 v16, s[20:23], s17 offen lds
    s_add_u32 m0, m0, 1024
    s_add_u32 s17, s49, 2686976
    buffer_load_dwordx4 v16, s[20:23], s17 offen lds
    s_add_u32 m0, m0, 1024
    s_add_u32 s17, s49, 2719744
    buffer_load_dwordx4 v16, s[20:23], s17 offen lds
    s_add_u32 m0, s46, 98304
    s_add_u32 s17, s49, 3145728
    buffer_load_dwordx4 v16, s[20:23], s17 offen lds
    s_add_u32 m0, m0, 1024
    s_add_u32 s17, s49, 3178496
    buffer_load_dwordx4 v16, s[20:23], s17 offen lds
    s_add_u32 m0, m0, 1024
    s_add_u32 s17, s49, 3211264
    buffer_load_dwordx4 v16, s[20:23], s17 offen lds
    s_add_u32 m0, m0, 1024
    s_add_u32 s17, s49, 3244032
    buffer_load_dwordx4 v16, s[20:23], s17 offen lds
    s_waitcnt vmcnt(24)
    s_barrier
    s_add_u32 m0, s46, 114688
    s_add_u32 s17, s49, 3670016
    buffer_load_dwordx4 v16, s[20:23], s17 offen lds
    s_add_u32 m0, m0, 1024
    s_add_u32 s17, s49, 3702784
    buffer_load_dwordx4 v16, s[20:23], s17 offen lds
    s_add_u32 m0, m0, 1024
    s_add_u32 s17, s49, 3735552
    buffer_load_dwordx4 v16, s[20:23], s17 offen lds
    s_add_u32 m0, m0, 1024
    s_add_u32 s17, s49, 3768320
    buffer_load_dwordx4 v16, s[20:23], s17 offen lds
    ds_read_b64_tr_b16 a[0:1], v17 offset:0
    ds_read_b64_tr_b16 a[2:3], v17 offset:1024
    ds_read_b64_tr_b16 a[4:5], v17 offset:4096
    ds_read_b64_tr_b16 a[6:7], v17 offset:5120
    ds_read_b64_tr_b16 a[8:9], v17 offset:8192
    ds_read_b64_tr_b16 a[10:11], v17 offset:9216
    ds_read_b64_tr_b16 a[12:13], v17 offset:12288
    ds_read_b64_tr_b16 a[14:15], v17 offset:13312
    s_waitcnt lgkmcnt(0)
    s_waitcnt vmcnt(24)
    s_barrier
    s_add_u32 m0, s46, 0
    s_add_u32 s17, s49, 4194304
    buffer_load_dwordx4 v16, s[20:23], s17 offen lds
    s_add_u32 m0, m0, 1024
    s_add_u32 s17, s49, 4227072
    buffer_load_dwordx4 v16, s[20:23], s17 offen lds
    s_add_u32 m0, m0, 1024
    s_add_u32 s17, s49, 4259840
    buffer_load_dwordx4 v16, s[20:23], s17 offen lds
    s_add_u32 m0, m0, 1024
    s_add_u32 s17, s49, 4292608
    buffer_load_dwordx4 v16, s[20:23], s17 offen lds
    ds_read_b64_tr_b16 a[16:17], v17 offset:16384
    ds_read_b64_tr_b16 a[18:19], v17 offset:17408
    ds_read_b64_tr_b16 a[20:21], v17 offset:20480
    ds_read_b64_tr_b16 a[22:23], v17 offset:21504
    ds_read_b64_tr_b16 a[24:25], v17 offset:24576
    ds_read_b64_tr_b16 a[26:27], v17 offset:25600
    ds_read_b64_tr_b16 a[28:29], v17 offset:28672
    ds_read_b64_tr_b16 a[30:31], v17 offset:29696
    s_waitcnt lgkmcnt(0)
    s_waitcnt vmcnt(24)
    s_barrier
    s_add_u32 m0, s46, 16384
    s_add_u32 s17, s52, 0
    buffer_load_dwordx4 v16, s[24:27], s17 offen lds
    s_add_u32 m0, m0, 1024
    s_add_u32 s17, s52, 32768
    buffer_load_dwordx4 v16, s[24:27], s17 offen lds
    s_add_u32 m0, m0, 1024
    s_add_u32 s17, s52, 65536
    buffer_load_dwordx4 v16, s[24:27], s17 offen lds
    s_add_u32 m0, m0, 1024
    s_add_u32 s17, s52, 98304
    buffer_load_dwordx4 v16, s[24:27], s17 offen lds
    ds_read_b64_tr_b16 a[32:33], v17 offset:32768
    ds_read_b64_tr_b16 a[34:35], v17 offset:33792
    ds_read_b64_tr_b16 a[36:37], v17 offset:36864
    ds_read_b64_tr_b16 a[38:39], v17 offset:37888
    ds_read_b64_tr_b16 a[40:41], v17 offset:40960
    ds_read_b64_tr_b16 a[42:43], v17 offset:41984
    ds_read_b64_tr_b16 a[44:45], v17 offset:45056
    ds_read_b64_tr_b16 a[46:47], v17 offset:46080
    s_waitcnt lgkmcnt(0)
    s_waitcnt vmcnt(24)
    s_barrier
    s_add_u32 m0, s46, 32768
    s_add_u32 s17, s52, 524288
    buffer_load_dwordx4 v16, s[24:27], s17 offen lds
    s_add_u32 m0, m0, 1024
    s_add_u32 s17, s52, 557056
    buffer_load_dwordx4 v16, s[24:27], s17 offen lds
    s_add_u32 m0, m0, 1024
    s_add_u32 s17, s52, 589824
    buffer_load_dwordx4 v16, s[24:27], s17 offen lds
    s_add_u32 m0, m0, 1024
    s_add_u32 s17, s52, 622592
    buffer_load_dwordx4 v16, s[24:27], s17 offen lds
    ds_read_b64_tr_b16 a[48:49], v17 offset:49152
    ds_read_b64_tr_b16 a[50:51], v17 offset:50176
    ds_read_b64_tr_b16 a[52:53], v17 offset:53248
    ds_read_b64_tr_b16 a[54:55], v17 offset:54272
    ds_read_b64_tr_b16 a[56:57], v17 offset:57344
    ds_read_b64_tr_b16 a[58:59], v17 offset:58368
    ds_read_b64_tr_b16 a[60:61], v17 offset:61440
    ds_read_b64_tr_b16 a[62:63], v17 offset:62464
    s_waitcnt lgkmcnt(0)
    s_waitcnt vmcnt(24)
    s_barrier
    s_add_u32 m0, s46, 49152
    s_add_u32 s17, s52, 1048576
    buffer_load_dwordx4 v16, s[24:27], s17 offen lds
    s_add_u32 m0, m0, 1024
    s_add_u32 s17, s52, 1081344
    buffer_load_dwordx4 v16, s[24:27], s17 offen lds
    s_add_u32 m0, m0, 1024
    s_add_u32 s17, s52, 1114112
    buffer_load_dwordx4 v16, s[24:27], s17 offen lds
    s_add_u32 m0, m0, 1024
    s_add_u32 s17, s52, 1146880
    buffer_load_dwordx4 v16, s[24:27], s17 offen lds
    ds_read_b64_tr_b16 a[64:65], v18 offset:0
    ds_read_b64_tr_b16 a[66:67], v18 offset:1024
    ds_read_b64_tr_b16 a[68:69], v18 offset:4096
    ds_read_b64_tr_b16 a[70:71], v18 offset:5120
    ds_read_b64_tr_b16 a[72:73], v18 offset:8192
    ds_read_b64_tr_b16 a[74:75], v18 offset:9216
    ds_read_b64_tr_b16 a[76:77], v18 offset:12288
    ds_read_b64_tr_b16 a[78:79], v18 offset:13312
    s_waitcnt lgkmcnt(0)
    s_waitcnt vmcnt(24)
    s_barrier
    s_add_u32 m0, s46, 65536
    s_add_u32 s17, s52, 1572864
    buffer_load_dwordx4 v16, s[24:27], s17 offen lds
    s_add_u32 m0, m0, 1024
    s_add_u32 s17, s52, 1605632
    buffer_load_dwordx4 v16, s[24:27], s17 offen lds
    s_add_u32 m0, m0, 1024
    s_add_u32 s17, s52, 1638400
    buffer_load_dwordx4 v16, s[24:27], s17 offen lds
    s_add_u32 m0, m0, 1024
    s_add_u32 s17, s52, 1671168
    buffer_load_dwordx4 v16, s[24:27], s17 offen lds
    ds_read_b64_tr_b16 a[80:81], v18 offset:16384
    ds_read_b64_tr_b16 a[82:83], v18 offset:17408
    ds_read_b64_tr_b16 a[84:85], v18 offset:20480
    ds_read_b64_tr_b16 a[86:87], v18 offset:21504
    ds_read_b64_tr_b16 a[88:89], v18 offset:24576
    ds_read_b64_tr_b16 a[90:91], v18 offset:25600
    ds_read_b64_tr_b16 a[92:93], v18 offset:28672
    ds_read_b64_tr_b16 a[94:95], v18 offset:29696
    s_waitcnt lgkmcnt(0)
    s_waitcnt vmcnt(24)
    s_barrier
    s_add_u32 m0, s46, 81920
    s_add_u32 s17, s52, 2097152
    buffer_load_dwordx4 v16, s[24:27], s17 offen lds
    s_add_u32 m0, m0, 1024
    s_add_u32 s17, s52, 2129920
    buffer_load_dwordx4 v16, s[24:27], s17 offen lds
    s_add_u32 m0, m0, 1024
    s_add_u32 s17, s52, 2162688
    buffer_load_dwordx4 v16, s[24:27], s17 offen lds
    s_add_u32 m0, m0, 1024
    s_add_u32 s17, s52, 2195456
    buffer_load_dwordx4 v16, s[24:27], s17 offen lds
    ds_read_b64_tr_b16 a[96:97], v18 offset:32768
    ds_read_b64_tr_b16 a[98:99], v18 offset:33792
    ds_read_b64_tr_b16 a[100:101], v18 offset:36864
    ds_read_b64_tr_b16 a[102:103], v18 offset:37888
    ds_read_b64_tr_b16 a[104:105], v18 offset:40960
    ds_read_b64_tr_b16 a[106:107], v18 offset:41984
    ds_read_b64_tr_b16 a[108:109], v18 offset:45056
    ds_read_b64_tr_b16 a[110:111], v18 offset:46080
    s_waitcnt lgkmcnt(0)
    s_waitcnt vmcnt(24)
    s_barrier
    s_add_u32 m0, s46, 98304
    s_add_u32 s17, s52, 2621440
    buffer_load_dwordx4 v16, s[24:27], s17 offen lds
    s_add_u32 m0, m0, 1024
    s_add_u32 s17, s52, 2654208
    buffer_load_dwordx4 v16, s[24:27], s17 offen lds
    s_add_u32 m0, m0, 1024
    s_add_u32 s17, s52, 2686976
    buffer_load_dwordx4 v16, s[24:27], s17 offen lds
    s_add_u32 m0, m0, 1024
    s_add_u32 s17, s52, 2719744
    buffer_load_dwordx4 v16, s[24:27], s17 offen lds
    ds_read_b64_tr_b16 a[112:113], v18 offset:49152
    ds_read_b64_tr_b16 a[114:115], v18 offset:50176
    ds_read_b64_tr_b16 a[116:117], v18 offset:53248
    ds_read_b64_tr_b16 a[118:119], v18 offset:54272
    ds_read_b64_tr_b16 a[120:121], v18 offset:57344
    ds_read_b64_tr_b16 a[122:123], v18 offset:58368
    ds_read_b64_tr_b16 a[124:125], v18 offset:61440
    ds_read_b64_tr_b16 a[126:127], v18 offset:62464
    s_waitcnt lgkmcnt(0)
    s_waitcnt vmcnt(24)
    s_barrier
    s_add_u32 m0, s46, 114688
    s_add_u32 s17, s52, 3145728
    buffer_load_dwordx4 v16, s[24:27], s17 offen lds
    s_add_u32 m0, m0, 1024
    s_add_u32 s17, s52, 3178496
    buffer_load_dwordx4 v16, s[24:27], s17 offen lds
    s_add_u32 m0, m0, 1024
    s_add_u32 s17, s52, 3211264
    buffer_load_dwordx4 v16, s[24:27], s17 offen lds
    s_add_u32 m0, m0, 1024
    s_add_u32 s17, s52, 3244032
    buffer_load_dwordx4 v16, s[24:27], s17 offen lds
    ds_read_b64_tr_b16 a[128:129], v17 offset:0
    ds_read_b64_tr_b16 a[130:131], v17 offset:1024
    ds_read_b64_tr_b16 a[132:133], v17 offset:4096
    ds_read_b64_tr_b16 a[134:135], v17 offset:5120
    ds_read_b64_tr_b16 a[136:137], v17 offset:8192
    ds_read_b64_tr_b16 a[138:139], v17 offset:9216
    ds_read_b64_tr_b16 a[140:141], v17 offset:12288
    ds_read_b64_tr_b16 a[142:143], v17 offset:13312
    s_waitcnt lgkmcnt(0)
    s_waitcnt vmcnt(24)
    s_barrier
    s_add_u32 m0, s46, 0
    s_add_u32 s17, s52, 3670016
    buffer_load_dwordx4 v16, s[24:27], s17 offen lds
    s_add_u32 m0, m0, 1024
    s_add_u32 s17, s52, 3702784
    buffer_load_dwordx4 v16, s[24:27], s17 offen lds
    s_add_u32 m0, m0, 1024
    s_add_u32 s17, s52, 3735552
    buffer_load_dwordx4 v16, s[24:27], s17 offen lds
    s_add_u32 m0, m0, 1024
    s_add_u32 s17, s52, 3768320
    buffer_load_dwordx4 v16, s[24:27], s17 offen lds
    ds_read_b64_tr_b16 a[144:145], v17 offset:16384
    ds_read_b64_tr_b16 a[146:147], v17 offset:17408
    ds_read_b64_tr_b16 a[148:149], v17 offset:20480
    ds_read_b64_tr_b16 a[150:151], v17 offset:21504
    ds_read_b64_tr_b16 a[152:153], v17 offset:24576
    ds_read_b64_tr_b16 a[154:155], v17 offset:25600
    ds_read_b64_tr_b16 a[156:157], v17 offset:28672
    ds_read_b64_tr_b16 a[158:159], v17 offset:29696
    s_waitcnt lgkmcnt(0)
    s_waitcnt vmcnt(24)
    s_barrier
    s_add_u32 m0, s46, 16384
    s_add_u32 s17, s52, 4194304
    buffer_load_dwordx4 v16, s[24:27], s17 offen lds
    s_add_u32 m0, m0, 1024
    s_add_u32 s17, s52, 4227072
    buffer_load_dwordx4 v16, s[24:27], s17 offen lds
    s_add_u32 m0, m0, 1024
    s_add_u32 s17, s52, 4259840
    buffer_load_dwordx4 v16, s[24:27], s17 offen lds
    s_add_u32 m0, m0, 1024
    s_add_u32 s17, s52, 4292608
    buffer_load_dwordx4 v16, s[24:27], s17 offen lds
    ds_read_b64_tr_b16 a[160:161], v17 offset:32768
    ds_read_b64_tr_b16 a[162:163], v17 offset:33792
    ds_read_b64_tr_b16 a[164:165], v17 offset:36864
    ds_read_b64_tr_b16 a[166:167], v17 offset:37888
    ds_read_b64_tr_b16 a[168:169], v17 offset:40960
    ds_read_b64_tr_b16 a[170:171], v17 offset:41984
    ds_read_b64_tr_b16 a[172:173], v17 offset:45056
    ds_read_b64_tr_b16 a[174:175], v17 offset:46080
    s_waitcnt lgkmcnt(0)
    s_waitcnt vmcnt(24)
    s_barrier
    ds_read_b64_tr_b16 a[176:177], v17 offset:49152
    ds_read_b64_tr_b16 a[178:179], v17 offset:50176
    ds_read_b64_tr_b16 a[180:181], v17 offset:53248
    ds_read_b64_tr_b16 a[182:183], v17 offset:54272
    ds_read_b64_tr_b16 a[184:185], v17 offset:57344
    ds_read_b64_tr_b16 a[186:187], v17 offset:58368
    ds_read_b64_tr_b16 a[188:189], v17 offset:61440
    ds_read_b64_tr_b16 a[190:191], v17 offset:62464
    s_waitcnt lgkmcnt(0)
    s_waitcnt vmcnt(20)
    s_barrier
    ds_read_b64_tr_b16 a[192:193], v18 offset:0
    ds_read_b64_tr_b16 a[194:195], v18 offset:1024
    ds_read_b64_tr_b16 a[196:197], v18 offset:4096
    ds_read_b64_tr_b16 a[198:199], v18 offset:5120
    ds_read_b64_tr_b16 a[200:201], v18 offset:8192
    ds_read_b64_tr_b16 a[202:203], v18 offset:9216
    ds_read_b64_tr_b16 a[204:205], v18 offset:12288
    ds_read_b64_tr_b16 a[206:207], v18 offset:13312
    s_waitcnt lgkmcnt(0)
    s_waitcnt vmcnt(16)
    s_barrier
    ds_read_b64_tr_b16 a[208:209], v18 offset:16384
    ds_read_b64_tr_b16 a[210:211], v18 offset:17408
    ds_read_b64_tr_b16 a[212:213], v18 offset:20480
    ds_read_b64_tr_b16 a[214:215], v18 offset:21504
    ds_read_b64_tr_b16 a[216:217], v18 offset:24576
    ds_read_b64_tr_b16 a[218:219], v18 offset:25600
    ds_read_b64_tr_b16 a[220:221], v18 offset:28672
    ds_read_b64_tr_b16 a[222:223], v18 offset:29696
    s_waitcnt lgkmcnt(0)
    s_waitcnt vmcnt(12)
    s_barrier
    ds_read_b64_tr_b16 a[224:225], v18 offset:32768
    ds_read_b64_tr_b16 a[226:227], v18 offset:33792
    ds_read_b64_tr_b16 a[228:229], v18 offset:36864
    ds_read_b64_tr_b16 a[230:231], v18 offset:37888
    ds_read_b64_tr_b16 a[232:233], v18 offset:40960
    ds_read_b64_tr_b16 a[234:235], v18 offset:41984
    ds_read_b64_tr_b16 a[236:237], v18 offset:45056
    ds_read_b64_tr_b16 a[238:239], v18 offset:46080
    s_waitcnt lgkmcnt(0)
    s_waitcnt vmcnt(8)
    s_barrier
    ds_read_b64_tr_b16 a[240:241], v18 offset:49152
    ds_read_b64_tr_b16 a[242:243], v18 offset:50176
    ds_read_b64_tr_b16 a[244:245], v18 offset:53248
    ds_read_b64_tr_b16 a[246:247], v18 offset:54272
    ds_read_b64_tr_b16 a[248:249], v18 offset:57344
    ds_read_b64_tr_b16 a[250:251], v18 offset:58368
    ds_read_b64_tr_b16 a[252:253], v18 offset:61440
    ds_read_b64_tr_b16 a[254:255], v18 offset:62464
    s_waitcnt lgkmcnt(0)
    s_waitcnt vmcnt(4)
    s_barrier
    ds_read_b64_tr_b16 v[152:153], v17 offset:0
    ds_read_b64_tr_b16 v[154:155], v17 offset:1024
    ds_read_b64_tr_b16 v[156:157], v17 offset:4096
    ds_read_b64_tr_b16 v[158:159], v17 offset:5120
    ds_read_b64_tr_b16 v[160:161], v17 offset:8192
    ds_read_b64_tr_b16 v[162:163], v17 offset:9216
    ds_read_b64_tr_b16 v[164:165], v17 offset:12288
    ds_read_b64_tr_b16 v[166:167], v17 offset:13312
    s_waitcnt lgkmcnt(0)
    s_waitcnt vmcnt(0)
    s_barrier
    ds_read_b64_tr_b16 v[168:169], v17 offset:16384
    ds_read_b64_tr_b16 v[170:171], v17 offset:17408
    ds_read_b64_tr_b16 v[172:173], v17 offset:20480
    ds_read_b64_tr_b16 v[174:175], v17 offset:21504
    ds_read_b64_tr_b16 v[176:177], v17 offset:24576
    ds_read_b64_tr_b16 v[178:179], v17 offset:25600
    ds_read_b64_tr_b16 v[180:181], v17 offset:28672
    ds_read_b64_tr_b16 v[182:183], v17 offset:29696
    s_waitcnt lgkmcnt(0)
    s_barrier
    v_bfe_u32 v10, v0, 4, 5
    v_lshrrev_b32 v5, 9, v0
    v_lshlrev_b32 v10, 4, v10
    v_mul_u32_u24 v6, 2560, v5
    v_add_u32 v10, v10, v6
    v_add_u32 v10, 114688, v10
    s_lshl_b32 s67, s14, 10
    v_bfe_u32 v6, v0, 8, 1
    v_lshlrev_b32 v14, 10, v6
    v_lshl_add_u32 v14, v7, 4, v14
    v_lshl_add_u32 v14, v5, 8, v14
    s_lshl_b32 s17, s51, 13
    s_lshl_b32 s18, s14, 11
    s_add_u32 s52, s17, s18
    s_add_u32 s52, s52, 44040192
    s_lshl_b32 s49, s51, 9
    s_lshl_b32 s17, s14, 2
    s_add_u32 s49, s49, s17
    s_add_u32 s49, s49, 5376
    s_cmp_eq_u32 s50, 1
    s_cselect_b32 s17, 16777216, 0
    s_cselect_b32 s18, 128, 0
    s_add_u32 s52, s52, s17
    s_add_u32 s49, s49, s18
    s_cmp_eq_u32 s50, 1
    s_cselect_b32 s17, 0, 384
    s_add_u32 s17, s17, 128
    v_lshrrev_b32 v185, 4, v0
    v_mul_lo_u32 v185, v185, s17
    v_mov_b32 v48, 0x3f803f80
    v_mov_b32 v49, 0x3f803f80
    v_mov_b32 v50, 0x3f803f80
    v_mov_b32 v51, 0x3f803f80
    s_lshl_b32 s17, s14, 8
    s_add_u32 s17, s17, 110592
    v_bfe_u32 v5, v0, 4, 5
    v_lshl_add_u32 v12, v5, 2, s17
    v_lshrrev_b32 v5, 9, v0
    v_lshl_add_u32 v13, v5, 4, s17
    s_cmp_eq_u32 s50, 1
    s_cbranch_scc1 Lp2_kv
    v_mfma_f32_32x32x16_bf16 v[84:99], a[0:3], v[48:51], 0
    v_mfma_f32_32x32x16_bf16 v[116:131], a[144:147], v[48:51], 0
    v_mfma_f32_32x32x16_bf16 v[84:99], a[4:7], v[48:51], v[84:99]
    v_mfma_f32_32x32x16_bf16 v[116:131], a[148:151], v[48:51], v[116:131]
    v_mfma_f32_32x32x16_bf16 v[84:99], a[8:11], v[48:51], v[84:99]
    v_mfma_f32_32x32x16_bf16 v[116:131], a[152:155], v[48:51], v[116:131]
    v_mfma_f32_32x32x16_bf16 v[84:99], a[12:15], v[48:51], v[84:99]
    v_mfma_f32_32x32x16_bf16 v[116:131], a[156:159], v[48:51], v[116:131]
    v_mfma_f32_32x32x16_bf16 v[84:99], a[16:19], v[48:51], v[84:99]
    v_mfma_f32_32x32x16_bf16 v[116:131], a[160:163], v[48:51], v[116:131]
    v_mfma_f32_32x32x16_bf16 v[84:99], a[20:23], v[48:51], v[84:99]
    v_mfma_f32_32x32x16_bf16 v[116:131], a[164:167], v[48:51], v[116:131]
    v_mfma_f32_32x32x16_bf16 v[84:99], a[24:27], v[48:51], v[84:99]
    v_mfma_f32_32x32x16_bf16 v[116:131], a[168:171], v[48:51], v[116:131]
    v_mfma_f32_32x32x16_bf16 v[84:99], a[28:31], v[48:51], v[84:99]
    v_mfma_f32_32x32x16_bf16 v[116:131], a[172:175], v[48:51], v[116:131]
    v_mfma_f32_32x32x16_bf16 v[84:99], a[32:35], v[48:51], v[84:99]
    v_mfma_f32_32x32x16_bf16 v[116:131], a[176:179], v[48:51], v[116:131]
    v_mfma_f32_32x32x16_bf16 v[84:99], a[36:39], v[48:51], v[84:99]
    v_mfma_f32_32x32x16_bf16 v[116:131], a[180:183], v[48:51], v[116:131]
    v_mfma_f32_32x32x16_bf16 v[84:99], a[40:43], v[48:51], v[84:99]
    v_mfma_f32_32x32x16_bf16 v[116:131], a[184:187], v[48:51], v[116:131]
    v_mfma_f32_32x32x16_bf16 v[84:99], a[44:47], v[48:51], v[84:99]
    v_mfma_f32_32x32x16_bf16 v[116:131], a[188:191], v[48:51], v[116:131]
    v_mfma_f32_32x32x16_bf16 v[84:99], a[48:51], v[48:51], v[84:99]
    v_mfma_f32_32x32x16_bf16 v[116:131], a[192:195], v[48:51], v[116:131]
    v_mfma_f32_32x32x16_bf16 v[84:99], a[52:55], v[48:51], v[84:99]
    v_mfma_f32_32x32x16_bf16 v[116:131], a[196:199], v[48:51], v[116:131]
    v_mfma_f32_32x32x16_bf16 v[84:99], a[56:59], v[48:51], v[84:99]
    v_mfma_f32_32x32x16_bf16 v[116:131], a[200:203], v[48:51], v[116:131]
    v_mfma_f32_32x32x16_bf16 v[84:99], a[60:63], v[48:51], v[84:99]
    v_mfma_f32_32x32x16_bf16 v[116:131], a[204:207], v[48:51], v[116:131]
    v_mfma_f32_32x32x16_bf16 v[84:99], a[64:67], v[48:51], v[84:99]
    v_mfma_f32_32x32x16_bf16 v[116:131], a[208:211], v[48:51], v[116:131]
    v_mfma_f32_32x32x16_bf16 v[84:99], a[68:71], v[48:51], v[84:99]
    v_mfma_f32_32x32x16_bf16 v[116:131], a[212:215], v[48:51], v[116:131]
    v_mfma_f32_32x32x16_bf16 v[84:99], a[72:75], v[48:51], v[84:99]
    v_mfma_f32_32x32x16_bf16 v[116:131], a[216:219], v[48:51], v[116:131]
    v_mfma_f32_32x32x16_bf16 v[84:99], a[76:79], v[48:51], v[84:99]
    v_mfma_f32_32x32x16_bf16 v[116:131], a[220:223], v[48:51], v[116:131]
    v_mfma_f32_32x32x16_bf16 v[84:99], a[80:83], v[48:51], v[84:99]
    v_mfma_f32_32x32x16_bf16 v[116:131], a[224:227], v[48:51], v[116:131]
    v_mfma_f32_32x32x16_bf16 v[84:99], a[84:87], v[48:51], v[84:99]
    v_mfma_f32_32x32x16_bf16 v[116:131], a[228:231], v[48:51], v[116:131]
    v_mfma_f32_32x32x16_bf16 v[84:99], a[88:91], v[48:51], v[84:99]
    v_mfma_f32_32x32x16_bf16 v[116:131], a[232:235], v[48:51], v[116:131]
    v_mfma_f32_32x32x16_bf16 v[84:99], a[92:95], v[48:51], v[84:99]
    v_mfma_f32_32x32x16_bf16 v[116:131], a[236:239], v[48:51], v[116:131]
    v_mfma_f32_32x32x16_bf16 v[84:99], a[96:99], v[48:51], v[84:99]
    v_mfma_f32_32x32x16_bf16 v[116:131], a[240:243], v[48:51], v[116:131]
    v_mfma_f32_32x32x16_bf16 v[84:99], a[100:103], v[48:51], v[84:99]
    v_mfma_f32_32x32x16_bf16 v[116:131], a[244:247], v[48:51], v[116:131]
    v_mfma_f32_32x32x16_bf16 v[84:99], a[104:107], v[48:51], v[84:99]
    v_mfma_f32_32x32x16_bf16 v[116:131], a[248:251], v[48:51], v[116:131]
    v_mfma_f32_32x32x16_bf16 v[84:99], a[108:111], v[48:51], v[84:99]
    v_mfma_f32_32x32x16_bf16 v[116:131], a[252:255], v[48:51], v[116:131]
    v_mfma_f32_32x32x16_bf16 v[84:99], a[112:115], v[48:51], v[84:99]
    v_mfma_f32_32x32x16_bf16 v[116:131], v[152:155], v[48:51], v[116:131]
    v_mfma_f32_32x32x16_bf16 v[84:99], a[116:119], v[48:51], v[84:99]
    v_mfma_f32_32x32x16_bf16 v[116:131], v[156:159], v[48:51], v[116:131]
    v_mfma_f32_32x32x16_bf16 v[84:99], a[120:123], v[48:51], v[84:99]
    v_mfma_f32_32x32x16_bf16 v[116:131], v[160:163], v[48:51], v[116:131]
    v_mfma_f32_32x32x16_bf16 v[84:99], a[124:127], v[48:51], v[84:99]
    v_mfma_f32_32x32x16_bf16 v[116:131], v[164:167], v[48:51], v[116:131]
    v_mfma_f32_32x32x16_bf16 v[84:99], a[128:131], v[48:51], v[84:99]
    v_mfma_f32_32x32x16_bf16 v[116:131], v[168:171], v[48:51], v[116:131]
    v_mfma_f32_32x32x16_bf16 v[84:99], a[132:135], v[48:51], v[84:99]
    v_mfma_f32_32x32x16_bf16 v[116:131], v[172:175], v[48:51], v[116:131]
    v_mfma_f32_32x32x16_bf16 v[84:99], a[136:139], v[48:51], v[84:99]
    v_mfma_f32_32x32x16_bf16 v[116:131], v[176:179], v[48:51], v[116:131]
    v_mfma_f32_32x32x16_bf16 v[84:99], a[140:143], v[48:51], v[84:99]
    v_mfma_f32_32x32x16_bf16 v[116:131], v[180:183], v[48:51], v[116:131]
    s_mov_b32 s66, 114688
    s_mov_b32 s71, 0x2000
    s_mov_b32 s36, s63
    s_mov_b32 s34, s63
    s_mul_i32 s58, s14, 9216
    s_mul_i32 s64, s63, 4718592
    s_add_u32 s64, s64, s58
    s_add_u32 s64, s64, 8650752
    s_mul_i32 s61, s63, 1441792
    s_add_u32 s61, s61, 3584
    s_mov_b32 s37, 0
    s_mov_b32 s40, 36864
    s_mov_b32 s59, s58
    s_mov_b32 s43, 0
    s_mov_b32 s62, 1
    s_mov_b32 s28, s8
    s_mov_b32 s29, s9
    s_mov_b32 s30, 0
    s_mov_b32 s31, 0x00020000
    v_mov_b32 v184, 74752
    v_mov_b32 v5, -1
    ds_write_b32 v184, v5
    s_waitcnt lgkmcnt(0)
    s_cmp_lg_u32 s14, 0
    s_cbranch_scc1 LpQQ_inia_d
    v_mov_b32 v5, 40
    s_mov_b32 s16, 0
LpQQ_inia:
    global_load_dword v6, v5, s[12:13] sc1
    s_add_u32 s16, s16, 1
    s_cmp_gt_u32 s16, 100000
    s_cbranch_scc1 L_role_p_abort
    s_waitcnt vmcnt(0)
    v_cmp_gt_u32 vcc, 128, v6
    s_nop 0
    s_cbranch_vccz LpQQ_inia_d
    s_sleep 8
    s_branch LpQQ_inia
LpQQ_inia_d:
    s_barrier
    s_cmp_eq_u32 s63, 0
    s_cbranch_scc1 LpQQ_ini_sk
    s_cmp_lg_u32 s14, 0
    s_cbranch_scc1 LpQQ_inib_d
    v_mov_b32 v5, 160
    s_mov_b32 s16, 0
LpQQ_inib:
    global_load_dword v6, v5, s[12:13] sc1
    s_add_u32 s16, s16, 1
    s_cmp_gt_u32 s16, 100000
    s_cbranch_scc1 L_role_p_abort
    s_waitcnt vmcnt(0)
    v_cmp_gt_u32 vcc, 64, v6
    s_nop 0
    s_cbranch_vccz LpQQ_inib_d
    s_sleep 8
    s_branch LpQQ_inib
LpQQ_inib_d:
    s_barrier
LpQQ_ini_sk:
    s_mul_i32 s41, s37, 36864
    s_add_u32 s41, s41, s64
    s_mul_i32 s60, s37, 22528
    s_add_u32 s60, s60, s61
    s_cmp_lt_u32 s37, 64
    s_cselect_b32 s60, s60, 2883584
    s_branch LpQQ_wait
LpQQ_head:
    s_waitcnt vmcnt(4)
LpQQ_head2:
    s_barrier
    ds_read_b32 v15, v184
    s_xor_b32 s40, s40, 36864
    s_xor_b32 s59, s59, 36864
    s_mov_b32 s35, s37
    s_lshl_b32 s57, s34, 6
    s_add_u32 s57, s57, s35
    s_add_u32 s37, s37, 1
    s_mov_b32 s39, 0
    s_mov_b32 s54, 0
    s_xor_b32 s66, s66, 8192
    s_xor_b32 s71, s71, 8192
    s_mul_i32 s41, s37, 36864
    s_add_u32 s41, s41, s64
    s_mul_i32 s60, s37, 22528
    s_add_u32 s60, s60, s61
    s_cmp_lt_u32 s37, 64
    s_cselect_b32 s60, s60, 2883584
    v_add_u32 v9, s40, v0
    v_add_u32 v5, s71, v10
    ds_read_b128 v[48:51], v9 offset:0
    ds_read_b128 v[52:55], v9 offset:1024
    ds_read_b128 v[56:59], v9 offset:2048
    ds_read_b128 v[64:67], v5 offset:0
    ds_read_b128 v[68:71], v5 offset:512
    ds_read_b128 v[72:75], v5 offset:1024
    ds_read_b128 v[76:79], v5 offset:1536
    ds_read_b128 v[80:83], v5 offset:2048
    s_waitcnt lgkmcnt(7)
    v_mfma_f32_32x32x16_bf16 v[16:31], a[0:3], v[48:51], 0
    ds_read_b128 v[60:63], v9 offset:3072
    v_mfma_f32_32x32x16_bf16 v[32:47], a[144:147], v[48:51], 0
    s_waitcnt lgkmcnt(4)
    v_add_f32 v64, v64, v68
    v_add_f32 v65, v65, v69
    v_add_f32 v66, v66, v70
    v_add_f32 v67, v67, v71
    v_mfma_f32_32x32x16_bf16 v[16:31], a[4:7], v[52:55], v[16:31]
    ds_read_b128 v[48:51], v9 offset:4096
    s_waitcnt lgkmcnt(4)
    v_add_f32 v64, v64, v72
    v_add_f32 v65, v65, v73
    v_add_f32 v66, v66, v74
    v_mfma_f32_32x32x16_bf16 v[32:47], a[148:151], v[52:55], v[32:47]
    v_add_f32 v67, v67, v75
    s_waitcnt lgkmcnt(3)
    v_add_f32 v64, v64, v76
    v_add_f32 v65, v65, v77
    v_add_f32 v66, v66, v78
    v_readfirstlane_b32 s17, v15
    s_nop 0
    s_add_u32 s18, s17, 1
    s_max_i32 s32, s18, s37
    s_add_u32 s39, s37, 1
    s_min_u32 s39, s39, 63
    s_mul_i32 s33, s32, 22528
    s_add_u32 s33, s33, s61
    s_cmp_eq_u32 s14, 0
    s_cselect_b32 s18, s32, 0x7fff
    v_mov_b32 v2, 2
    s_cmp_le_u32 s18, s39
    s_cselect_b64 exec, -1, 0
    buffer_load_dword v2, v1, s[8:11], s33 offen sc1
    s_mov_b64 exec, -1
    s_cmp_ge_i32 s17, s37
    s_cbranch_scc1 LpQQ_f_1
    v_mfma_f32_32x32x16_bf16 v[16:31], a[8:11], v[56:59], v[16:31]
    ds_read_b128 v[52:55], v9 offset:5120
    v_add_f32 v67, v67, v79
    s_waitcnt lgkmcnt(3)
    v_add_f32 v64, v64, v80
    v_add_f32 v65, v65, v81
    v_mfma_f32_32x32x16_bf16 v[32:47], a[152:155], v[56:59], v[32:47]
    v_add_f32 v66, v66, v82
    v_add_f32 v67, v67, v83
    v_add_f32 v64, v64, v66
    v_add_f32 v65, v65, v67
    s_waitcnt lgkmcnt(2)
    v_mfma_f32_32x32x16_bf16 v[16:31], a[12:15], v[60:63], v[16:31]
    ds_read_b128 v[56:59], v9 offset:6144
    v_mov_b32 v66, v64
    v_mov_b32 v67, v65
    s_nop 0
    v_permlane32_swap_b32 v64, v66
    v_mfma_f32_32x32x16_bf16 v[32:47], a[156:159], v[60:63], v[32:47]
    v_permlane32_swap_b32 v65, v67
    v_add_f32 v64, v64, v66
    v_add_f32 v65, v65, v67
    v_mul_f32 v64, 0x3ae38e39, v64
    s_waitcnt lgkmcnt(2)
    v_mfma_f32_32x32x16_bf16 v[16:31], a[16:19], v[48:51], v[16:31]
    ds_read_b128 v[60:63], v9 offset:7168
    v_mul_f32 v65, 0x3ae38e39, v65
    v_fma_f32 v65, -v64, v64, v65
    v_max_f32 v65, 0, v65
    v_mfma_f32_32x32x16_bf16 v[32:47], a[160:163], v[48:51], v[32:47]
    v_add_f32 v65, 0x3727c5ac, v65
    v_rsq_f32 v148, v65
    s_nop 0
    v_mul_f32 v149, v64, v148
    v_mul_f32 v100, v149, v84
    s_waitcnt lgkmcnt(2)
    v_mfma_f32_32x32x16_bf16 v[16:31], a[20:23], v[52:55], v[16:31]
    ds_read_b128 v[48:51], v9 offset:8192
    v_mul_f32 v101, v149, v85
    v_mul_f32 v102, v149, v86
    v_mul_f32 v103, v149, v87
    v_mfma_f32_32x32x16_bf16 v[32:47], a[164:167], v[52:55], v[32:47]
    v_mul_f32 v104, v149, v88
    v_mul_f32 v105, v149, v89
    v_mul_f32 v106, v149, v90
    v_mul_f32 v107, v149, v91
    s_waitcnt lgkmcnt(2)
    v_mfma_f32_32x32x16_bf16 v[16:31], a[24:27], v[56:59], v[16:31]
    ds_read_b128 v[52:55], v9 offset:9216
    v_mul_f32 v108, v149, v92
    v_mul_f32 v109, v149, v93
    v_mul_f32 v110, v149, v94
    v_mfma_f32_32x32x16_bf16 v[32:47], a[168:171], v[56:59], v[32:47]
    v_mul_f32 v111, v149, v95
    v_mul_f32 v112, v149, v96
    v_mul_f32 v113, v149, v97
    v_mul_f32 v114, v149, v98
    s_waitcnt lgkmcnt(2)
    v_mfma_f32_32x32x16_bf16 v[16:31], a[28:31], v[60:63], v[16:31]
    ds_read_b128 v[56:59], v9 offset:10240
    v_mul_f32 v115, v149, v99
    v_mul_f32 v132, v149, v116
    v_mul_f32 v133, v149, v117
    v_mfma_f32_32x32x16_bf16 v[32:47], a[172:175], v[60:63], v[32:47]
    v_mul_f32 v134, v149, v118
    v_mul_f32 v135, v149, v119
    v_mul_f32 v136, v149, v120
    v_mul_f32 v137, v149, v121
    s_waitcnt lgkmcnt(2)
    v_mfma_f32_32x32x16_bf16 v[16:31], a[32:35], v[48:51], v[16:31]
    ds_read_b128 v[60:63], v9 offset:11264
    v_mul_f32 v138, v149, v122
    v_mul_f32 v139, v149, v123
    v_mul_f32 v140, v149, v124
    v_mfma_f32_32x32x16_bf16 v[32:47], a[176:179], v[48:51], v[32:47]
    v_mul_f32 v141, v149, v125
    v_mul_f32 v142, v149, v126
    v_mul_f32 v143, v149, v127
    v_mul_f32 v144, v149, v128
    s_waitcnt lgkmcnt(2)
    v_mfma_f32_32x32x16_bf16 v[16:31], a[36:39], v[52:55], v[16:31]
    ds_read_b128 v[48:51], v9 offset:12288
    v_mul_f32 v145, v149, v129
    v_mul_f32 v146, v149, v130
    v_mul_f32 v147, v149, v131
    v_mfma_f32_32x32x16_bf16 v[32:47], a[180:183], v[52:55], v[32:47]
    s_mul_i32 s46, s34, 50331648
    s_lshl_b32 s51, s35, 18
    s_add_u32 s46, s46, s51
    s_add_u32 s46, s46, s52
    s_waitcnt lgkmcnt(2)
    v_mfma_f32_32x32x16_bf16 v[16:31], a[40:43], v[56:59], v[16:31]
    ds_read_b128 v[52:55], v9 offset:13312
    v_mfma_f32_32x32x16_bf16 v[32:47], a[184:187], v[56:59], v[32:47]
    s_waitcnt lgkmcnt(2)
    v_mfma_f32_32x32x16_bf16 v[16:31], a[44:47], v[60:63], v[16:31]
    ds_read_b128 v[56:59], v9 offset:14336
    v_mfma_f32_32x32x16_bf16 v[32:47], a[188:191], v[60:63], v[32:47]
    s_waitcnt lgkmcnt(2)
    v_mfma_f32_32x32x16_bf16 v[16:31], a[48:51], v[48:51], v[16:31]
    ds_read_b128 v[60:63], v9 offset:15360
    v_mfma_f32_32x32x16_bf16 v[32:47], a[192:195], v[48:51], v[32:47]
    s_waitcnt vmcnt(1)
    s_cmp_lg_u32 s43, 0
    s_cselect_b64 exec, 3, 0
    buffer_store_dword v3, v185, s[8:11], s43 offen sc1
    s_mov_b64 exec, -1
    s_mov_b32 s43, 0
    s_waitcnt lgkmcnt(2)
    v_mfma_f32_32x32x16_bf16 v[16:31], a[52:55], v[52:55], v[16:31]
    ds_read_b128 v[48:51], v9 offset:16384
    v_mfma_f32_32x32x16_bf16 v[32:47], a[196:199], v[52:55], v[32:47]
    s_waitcnt lgkmcnt(2)
    v_mfma_f32_32x32x16_bf16 v[16:31], a[56:59], v[56:59], v[16:31]
    v_cmp_eq_u32 s[76:77], 1, v2
    v_cmp_eq_u32 vcc, 2, v2
    s_cmp_eq_u64 s[76:77], -1
    s_cselect_b32 s38, 1, 0
    ds_read_b128 v[52:55], v9 offset:17408
    v_mfma_f32_32x32x16_bf16 v[32:47], a[200:203], v[56:59], v[32:47]
    s_cmp_lg_u32 s38, 0
    s_cselect_b64 exec, 1, 0
    v_mov_b32 v15, s32
    ds_write_b32 v184, v15
    v_mov_b32 v2, 2
    s_mov_b64 exec, -1
    s_waitcnt lgkmcnt(3)
    v_mfma_f32_32x32x16_bf16 v[16:31], a[60:63], v[60:63], v[16:31]
    s_add_u32 s32, s32, s38
    s_mul_i32 s38, s38, 22528
    s_add_u32 s33, s33, s38
    ds_read_b128 v[56:59], v9 offset:18432
    v_mfma_f32_32x32x16_bf16 v[32:47], a[204:207], v[60:63], v[32:47]
    s_cmp_eq_u64 vcc, 0
    s_cselect_b32 s38, s32, 0x7fff
    s_waitcnt lgkmcnt(3)
    v_mfma_f32_32x32x16_bf16 v[16:31], a[64:67], v[48:51], v[16:31]
    ds_read_b128 v[60:63], v9 offset:19456
    v_mfma_f32_32x32x16_bf16 v[32:47], a[208:211], v[48:51], v[32:47]
    s_cmp_le_u32 s38, s39
    s_cselect_b64 exec, -1, 0
    v_mov_b32 v2, 2
    buffer_load_dword v2, v1, s[8:11], s33 offen sc1
    s_mov_b64 exec, -1
    ds_read_b32 v15, v184
    s_waitcnt lgkmcnt(4)
    v_mfma_f32_32x32x16_bf16 v[16:31], a[68:71], v[52:55], v[16:31]
    ds_read_b128 v[48:51], v9 offset:20480
    v_mfma_f32_32x32x16_bf16 v[32:47], a[212:215], v[52:55], v[32:47]
    s_waitcnt lgkmcnt(3)
    v_mfma_f32_32x32x16_bf16 v[16:31], a[72:75], v[56:59], v[16:31]
    ds_read_b128 v[52:55], v9 offset:21504
    v_mfma_f32_32x32x16_bf16 v[32:47], a[216:219], v[56:59], v[32:47]
    s_waitcnt lgkmcnt(2)
    v_readfirstlane_b32 s17, v15
    s_nop 0
    s_cmp_ge_i32 s17, s37
    s_cbranch_scc1 LpQQ_f_2
    v_mfma_f32_32x32x16_bf16 v[16:31], a[76:79], v[60:63], v[16:31]
    ds_read_b128 v[56:59], v9 offset:22528
    v_mfma_f32_32x32x16_bf16 v[32:47], a[220:223], v[60:63], v[32:47]
    s_waitcnt lgkmcnt(2)
    v_mfma_f32_32x32x16_bf16 v[16:31], a[80:83], v[48:51], v[16:31]
    ds_read_b128 v[60:63], v9 offset:23552
    v_mfma_f32_32x32x16_bf16 v[32:47], a[224:227], v[48:51], v[32:47]
    s_waitcnt lgkmcnt(2)
    v_mfma_f32_32x32x16_bf16 v[16:31], a[84:87], v[52:55], v[16:31]
    ds_read_b128 v[48:51], v9 offset:24576
    v_mfma_f32_32x32x16_bf16 v[32:47], a[228:231], v[52:55], v[32:47]
    s_waitcnt lgkmcnt(2)
    v_mfma_f32_32x32x16_bf16 v[16:31], a[88:91], v[56:59], v[16:31]
    ds_read_b128 v[52:55], v9 offset:25600
    v_mfma_f32_32x32x16_bf16 v[32:47], a[232:235], v[56:59], v[32:47]
    s_waitcnt lgkmcnt(2)
    v_mfma_f32_32x32x16_bf16 v[16:31], a[92:95], v[60:63], v[16:31]
    ds_read_b128 v[56:59], v9 offset:26624
    v_mfma_f32_32x32x16_bf16 v[32:47], a[236:239], v[60:63], v[32:47]
    s_waitcnt lgkmcnt(2)
    v_mfma_f32_32x32x16_bf16 v[16:31], a[96:99], v[48:51], v[16:31]
    ds_read_b128 v[60:63], v9 offset:27648
    v_mfma_f32_32x32x16_bf16 v[32:47], a[240:243], v[48:51], v[32:47]
    s_waitcnt lgkmcnt(2)
    v_mfma_f32_32x32x16_bf16 v[16:31], a[100:103], v[52:55], v[16:31]
    ds_read_b128 v[48:51], v9 offset:28672
    v_mfma_f32_32x32x16_bf16 v[32:47], a[244:247], v[52:55], v[32:47]
    s_waitcnt lgkmcnt(2)
    v_mfma_f32_32x32x16_bf16 v[16:31], a[104:107], v[56:59], v[16:31]
    ds_read_b128 v[52:55], v9 offset:29696
    v_mfma_f32_32x32x16_bf16 v[32:47], a[248:251], v[56:59], v[32:47]
    s_waitcnt lgkmcnt(2)
    v_mfma_f32_32x32x16_bf16 v[16:31], a[108:111], v[60:63], v[16:31]
    ds_read_b128 v[56:59], v9 offset:30720
    v_mfma_f32_32x32x16_bf16 v[32:47], a[252:255], v[60:63], v[32:47]
    s_waitcnt lgkmcnt(2)
    v_mfma_f32_32x32x16_bf16 v[16:31], a[112:115], v[48:51], v[16:31]
    ds_read_b128 v[60:63], v9 offset:31744
    v_mfma_f32_32x32x16_bf16 v[32:47], v[152:155], v[48:51], v[32:47]
    s_waitcnt lgkmcnt(2)
    v_mfma_f32_32x32x16_bf16 v[16:31], a[116:119], v[52:55], v[16:31]
    ds_read_b128 v[48:51], v9 offset:32768
    v_mfma_f32_32x32x16_bf16 v[32:47], v[156:159], v[52:55], v[32:47]
    s_waitcnt lgkmcnt(2)
    v_mfma_f32_32x32x16_bf16 v[16:31], a[120:123], v[56:59], v[16:31]
    ds_read_b128 v[52:55], v9 offset:33792
    v_mfma_f32_32x32x16_bf16 v[32:47], v[160:163], v[56:59], v[32:47]
    s_waitcnt lgkmcnt(2)
    v_mfma_f32_32x32x16_bf16 v[16:31], a[124:127], v[60:63], v[16:31]
    v_cmp_eq_u32 s[76:77], 1, v2
    v_cmp_eq_u32 vcc, 2, v2
    s_cmp_eq_u64 s[76:77], -1
    s_cselect_b32 s38, 1, 0
    ds_read_b128 v[56:59], v9 offset:34816
    v_mfma_f32_32x32x16_bf16 v[32:47], v[164:167], v[60:63], v[32:47]
    s_cmp_lg_u32 s38, 0
    s_cselect_b64 exec, 1, 0
    v_mov_b32 v15, s32
    ds_write_b32 v184, v15
    v_mov_b32 v2, 2
    s_mov_b64 exec, -1
    s_waitcnt lgkmcnt(3)
    v_mfma_f32_32x32x16_bf16 v[16:31], a[128:131], v[48:51], v[16:31]
    s_add_u32 s32, s32, s38
    s_mul_i32 s38, s38, 22528
    s_add_u32 s33, s33, s38
    ds_read_b128 v[60:63], v9 offset:35840
    v_mfma_f32_32x32x16_bf16 v[32:47], v[168:171], v[48:51], v[32:47]
    s_cmp_eq_u64 vcc, 0
    s_cselect_b32 s38, s32, 0x7fff
    s_waitcnt lgkmcnt(3)
    v_mfma_f32_32x32x16_bf16 v[16:31], a[132:135], v[52:55], v[16:31]
    s_cmp_le_u32 s38, s39
    s_cselect_b64 exec, -1, 0
    v_mov_b32 v2, 2
    buffer_load_dword v2, v1, s[8:11], s33 offen sc1
    s_mov_b64 exec, -1
    v_mfma_f32_32x32x16_bf16 v[32:47], v[172:175], v[52:55], v[32:47]
    s_waitcnt lgkmcnt(2)
    v_mfma_f32_32x32x16_bf16 v[16:31], a[136:139], v[56:59], v[16:31]
    v_mfma_f32_32x32x16_bf16 v[32:47], v[176:179], v[56:59], v[32:47]
    s_waitcnt lgkmcnt(0)
    v_mfma_f32_32x32x16_bf16 v[16:31], a[140:143], v[60:63], v[16:31]
    v_mfma_f32_32x32x16_bf16 v[32:47], v[180:183], v[60:63], v[32:47]
    s_add_u32 s51, s46, 8192
    s_nop 2
    v_pk_fma_f32 v[16:17], v[16:17], v[148:149], v[100:101] op_sel_hi:[1,0,1] neg_lo:[0,0,1] neg_hi:[0,0,1]
    v_pk_fma_f32 v[18:19], v[18:19], v[148:149], v[102:103] op_sel_hi:[1,0,1] neg_lo:[0,0,1] neg_hi:[0,0,1]
    v_pk_fma_f32 v[20:21], v[20:21], v[148:149], v[104:105] op_sel_hi:[1,0,1] neg_lo:[0,0,1] neg_hi:[0,0,1]
    v_pk_fma_f32 v[22:23], v[22:23], v[148:149], v[106:107] op_sel_hi:[1,0,1] neg_lo:[0,0,1] neg_hi:[0,0,1]
    v_pk_fma_f32 v[24:25], v[24:25], v[148:149], v[108:109] op_sel_hi:[1,0,1] neg_lo:[0,0,1] neg_hi:[0,0,1]
    v_pk_fma_f32 v[26:27], v[26:27], v[148:149], v[110:111] op_sel_hi:[1,0,1] neg_lo:[0,0,1] neg_hi:[0,0,1]
    v_pk_fma_f32 v[28:29], v[28:29], v[148:149], v[112:113] op_sel_hi:[1,0,1] neg_lo:[0,0,1] neg_hi:[0,0,1]
    v_pk_fma_f32 v[30:31], v[30:31], v[148:149], v[114:115] op_sel_hi:[1,0,1] neg_lo:[0,0,1] neg_hi:[0,0,1]
    v_cvt_pk_bf16_f32 v188, v16, v24
    v_cvt_pk_bf16_f32 v189, v17, v25
    v_cvt_pk_bf16_f32 v190, v18, v26
    v_cvt_pk_bf16_f32 v191, v19, v27
    buffer_store_dwordx4 v[188:191], v14, s[8:11], s46 offen offset:0 sc1
    v_cvt_pk_bf16_f32 v192, v20, v28
    v_cvt_pk_bf16_f32 v193, v21, v29
    v_cvt_pk_bf16_f32 v194, v22, v30
    v_cvt_pk_bf16_f32 v195, v23, v31
    buffer_store_dwordx4 v[192:195], v14, s[8:11], s46 offen offset:512 sc1
    v_pk_fma_f32 v[32:33], v[32:33], v[148:149], v[132:133] op_sel_hi:[1,0,1] neg_lo:[0,0,1] neg_hi:[0,0,1]
    v_pk_fma_f32 v[34:35], v[34:35], v[148:149], v[134:135] op_sel_hi:[1,0,1] neg_lo:[0,0,1] neg_hi:[0,0,1]
    v_pk_fma_f32 v[36:37], v[36:37], v[148:149], v[136:137] op_sel_hi:[1,0,1] neg_lo:[0,0,1] neg_hi:[0,0,1]
    v_pk_fma_f32 v[38:39], v[38:39], v[148:149], v[138:139] op_sel_hi:[1,0,1] neg_lo:[0,0,1] neg_hi:[0,0,1]
    v_pk_fma_f32 v[40:41], v[40:41], v[148:149], v[140:141] op_sel_hi:[1,0,1] neg_lo:[0,0,1] neg_hi:[0,0,1]
    v_pk_fma_f32 v[42:43], v[42:43], v[148:149], v[142:143] op_sel_hi:[1,0,1] neg_lo:[0,0,1] neg_hi:[0,0,1]
    v_pk_fma_f32 v[44:45], v[44:45], v[148:149], v[144:145] op_sel_hi:[1,0,1] neg_lo:[0,0,1] neg_hi:[0,0,1]
    v_pk_fma_f32 v[46:47], v[46:47], v[148:149], v[146:147] op_sel_hi:[1,0,1] neg_lo:[0,0,1] neg_hi:[0,0,1]
    v_cvt_pk_bf16_f32 v196, v32, v40
    v_cvt_pk_bf16_f32 v197, v33, v41
    v_cvt_pk_bf16_f32 v198, v34, v42
    v_cvt_pk_bf16_f32 v199, v35, v43
    buffer_store_dwordx4 v[196:199], v14, s[8:11], s51 offen offset:0 sc1
    v_cvt_pk_bf16_f32 v200, v36, v44
    v_cvt_pk_bf16_f32 v201, v37, v45
    v_cvt_pk_bf16_f32 v202, v38, v46
    v_cvt_pk_bf16_f32 v203, v39, v47
    buffer_store_dwordx4 v[200:203], v14, s[8:11], s51 offen offset:512 sc1
    s_mul_i32 s43, s57, 22528
    s_add_u32 s43, s43, s49
    s_branch LpQQ_none
LpQQ_f_1:
    v_mfma_f32_32x32x16_bf16 v[16:31], a[8:11], v[56:59], v[16:31]
    ds_read_b128 v[52:55], v9 offset:5120
    v_add_f32 v67, v67, v79
    s_waitcnt lgkmcnt(3)
    v_add_f32 v64, v64, v80
    v_add_f32 v65, v65, v81
    v_mfma_f32_32x32x16_bf16 v[32:47], a[152:155], v[56:59], v[32:47]
    v_add_f32 v66, v66, v82
    v_add_f32 v67, v67, v83
    v_add_f32 v64, v64, v66
    v_add_f32 v65, v65, v67
    s_waitcnt lgkmcnt(2)
    v_mfma_f32_32x32x16_bf16 v[16:31], a[12:15], v[60:63], v[16:31]
    ds_read_b128 v[56:59], v9 offset:6144
    v_mov_b32 v66, v64
    v_mov_b32 v67, v65
    s_nop 0
    v_permlane32_swap_b32 v64, v66
    v_mfma_f32_32x32x16_bf16 v[32:47], a[156:159], v[60:63], v[32:47]
    v_permlane32_swap_b32 v65, v67
    v_add_f32 v64, v64, v66
    v_add_f32 v65, v65, v67
    v_mul_f32 v64, 0x3ae38e39, v64
    s_waitcnt lgkmcnt(2)
    v_mfma_f32_32x32x16_bf16 v[16:31], a[16:19], v[48:51], v[16:31]
    ds_read_b128 v[60:63], v9 offset:7168
    v_mul_f32 v65, 0x3ae38e39, v65
    v_fma_f32 v65, -v64, v64, v65
    v_max_f32 v65, 0, v65
    v_mfma_f32_32x32x16_bf16 v[32:47], a[160:163], v[48:51], v[32:47]
    v_add_f32 v65, 0x3727c5ac, v65
    v_rsq_f32 v148, v65
    s_nop 0
    v_mul_f32 v149, v64, v148
    v_mul_f32 v100, v149, v84
    s_waitcnt lgkmcnt(2)
    v_mfma_f32_32x32x16_bf16 v[16:31], a[20:23], v[52:55], v[16:31]
    ds_read_b128 v[48:51], v9 offset:8192
    v_mul_f32 v101, v149, v85
    v_mul_f32 v102, v149, v86
    v_mul_f32 v103, v149, v87
    v_mfma_f32_32x32x16_bf16 v[32:47], a[164:167], v[52:55], v[32:47]
    v_mul_f32 v104, v149, v88
    v_mul_f32 v105, v149, v89
    v_mul_f32 v106, v149, v90
    v_mul_f32 v107, v149, v91
    s_waitcnt lgkmcnt(2)
    v_mfma_f32_32x32x16_bf16 v[16:31], a[24:27], v[56:59], v[16:31]
    ds_read_b128 v[52:55], v9 offset:9216
    v_mul_f32 v108, v149, v92
    v_mul_f32 v109, v149, v93
    v_mul_f32 v110, v149, v94
    v_mfma_f32_32x32x16_bf16 v[32:47], a[168:171], v[56:59], v[32:47]
    v_mul_f32 v111, v149, v95
    v_mul_f32 v112, v149, v96
    v_mul_f32 v113, v149, v97
    v_mul_f32 v114, v149, v98
    s_waitcnt lgkmcnt(2)
    v_mfma_f32_32x32x16_bf16 v[16:31], a[28:31], v[60:63], v[16:31]
    ds_read_b128 v[56:59], v9 offset:10240
    v_mul_f32 v115, v149, v99
    v_mul_f32 v132, v149, v116
    v_mul_f32 v133, v149, v117
    v_mfma_f32_32x32x16_bf16 v[32:47], a[172:175], v[60:63], v[32:47]
    v_mul_f32 v134, v149, v118
    v_mul_f32 v135, v149, v119
    v_mul_f32 v136, v149, v120
    v_mul_f32 v137, v149, v121
    s_waitcnt lgkmcnt(2)
    v_mfma_f32_32x32x16_bf16 v[16:31], a[32:35], v[48:51], v[16:31]
    ds_read_b128 v[60:63], v9 offset:11264
    v_mul_f32 v138, v149, v122
    v_mul_f32 v139, v149, v123
    v_mul_f32 v140, v149, v124
    v_mfma_f32_32x32x16_bf16 v[32:47], a[176:179], v[48:51], v[32:47]
    v_mul_f32 v141, v149, v125
    v_mul_f32 v142, v149, v126
    v_mul_f32 v143, v149, v127
    v_mul_f32 v144, v149, v128
    s_waitcnt lgkmcnt(2)
    v_mfma_f32_32x32x16_bf16 v[16:31], a[36:39], v[52:55], v[16:31]
    ds_read_b128 v[48:51], v9 offset:12288
    v_mul_f32 v145, v149, v129
    v_mul_f32 v146, v149, v130
    v_mul_f32 v147, v149, v131
    v_mfma_f32_32x32x16_bf16 v[32:47], a[180:183], v[52:55], v[32:47]
    s_mul_i32 s46, s34, 50331648
    s_lshl_b32 s51, s35, 18
    s_add_u32 s46, s46, s51
    s_add_u32 s46, s46, s52
    s_waitcnt lgkmcnt(2)
    v_mfma_f32_32x32x16_bf16 v[16:31], a[40:43], v[56:59], v[16:31]
    s_add_u32 m0, s59, 0
    s_add_u32 s47, s41, 0
    buffer_load_dwordx4 v0, s[8:11], s47 offen offset:0 lds
    buffer_load_dwordx4 v0, s[8:11], s47 offen offset:1024 lds
    ds_read_b128 v[52:55], v9 offset:13312
    v_mfma_f32_32x32x16_bf16 v[32:47], a[184:187], v[56:59], v[32:47]
    buffer_load_dwordx4 v0, s[8:11], s47 offen offset:2048 lds
    buffer_load_dwordx4 v0, s[8:11], s47 offen offset:3072 lds
    s_add_u32 m0, s59, 4096
    s_add_u32 s47, s41, 4096
    buffer_load_dwordx4 v0, s[8:11], s47 offen offset:0 lds
    s_waitcnt lgkmcnt(2)
    v_mfma_f32_32x32x16_bf16 v[16:31], a[44:47], v[60:63], v[16:31]
    buffer_load_dwordx4 v0, s[8:11], s47 offen offset:1024 lds
    buffer_load_dwordx4 v0, s[8:11], s47 offen offset:2048 lds
    buffer_load_dwordx4 v0, s[8:11], s47 offen offset:3072 lds
    ds_read_b128 v[56:59], v9 offset:14336
    v_mfma_f32_32x32x16_bf16 v[32:47], a[188:191], v[60:63], v[32:47]
    s_add_u32 m0, s59, 8192
    s_add_u32 s47, s41, 8192
    buffer_load_dwordx4 v0, s[8:11], s47 offen offset:0 lds
    s_waitcnt lgkmcnt(2)
    v_mfma_f32_32x32x16_bf16 v[16:31], a[48:51], v[48:51], v[16:31]
    s_mul_i32 s48, s36, 786432
    s_mul_i32 s18, s37, 6144
    s_add_u32 s48, s48, s18
    s_add_u32 s48, s48, 16125952
    s_add_u32 m0, s66, 4096
    s_nop 0
    buffer_load_dwordx4 v0, s[8:11], s48 offen lds
    ds_read_b128 v[60:63], v9 offset:15360
    v_mfma_f32_32x32x16_bf16 v[32:47], a[192:195], v[48:51], v[32:47]
    s_add_u32 m0, s66, s67
    s_sub_u32 s48, s48, 4096
    s_add_u32 s48, s48, s67
    buffer_load_dwordx4 v0, s[8:11], s48 offen lds
    s_waitcnt vmcnt(12)
    s_cmp_lg_u32 s43, 0
    s_cselect_b64 exec, 3, 0
    buffer_store_dword v3, v185, s[8:11], s43 offen sc1
    s_mov_b64 exec, -1
    s_mov_b32 s43, 0
    s_waitcnt lgkmcnt(2)
    v_mfma_f32_32x32x16_bf16 v[16:31], a[52:55], v[52:55], v[16:31]
    ds_read_b128 v[48:51], v9 offset:16384
    v_mfma_f32_32x32x16_bf16 v[32:47], a[196:199], v[52:55], v[32:47]
    s_waitcnt lgkmcnt(2)
    v_mfma_f32_32x32x16_bf16 v[16:31], a[56:59], v[56:59], v[16:31]
    v_cmp_eq_u32 s[76:77], 1, v2
    v_cmp_eq_u32 vcc, 2, v2
    s_cmp_eq_u64 s[76:77], -1
    s_cselect_b32 s38, 1, 0
    ds_read_b128 v[52:55], v9 offset:17408
    v_mfma_f32_32x32x16_bf16 v[32:47], a[200:203], v[56:59], v[32:47]
    s_cmp_lg_u32 s38, 0
    s_cselect_b64 exec, 1, 0
    v_mov_b32 v15, s32
    ds_write_b32 v184, v15
    v_mov_b32 v2, 2
    s_mov_b64 exec, -1
    s_waitcnt lgkmcnt(3)
    v_mfma_f32_32x32x16_bf16 v[16:31], a[60:63], v[60:63], v[16:31]
    s_add_u32 s32, s32, s38
    s_mul_i32 s38, s38, 22528
    s_add_u32 s33, s33, s38
    ds_read_b128 v[56:59], v9 offset:18432
    v_mfma_f32_32x32x16_bf16 v[32:47], a[204:207], v[60:63], v[32:47]
    s_cmp_eq_u64 vcc, 0
    s_cselect_b32 s38, s32, 0x7fff
    s_waitcnt lgkmcnt(3)
    v_mfma_f32_32x32x16_bf16 v[16:31], a[64:67], v[48:51], v[16:31]
    ds_read_b128 v[60:63], v9 offset:19456
    v_mfma_f32_32x32x16_bf16 v[32:47], a[208:211], v[48:51], v[32:47]
    s_cmp_le_u32 s38, s39
    s_cselect_b64 exec, -1, 0
    v_mov_b32 v2, 2
    buffer_load_dword v2, v1, s[8:11], s33 offen sc1
    s_mov_b64 exec, -1
    s_waitcnt lgkmcnt(3)
    v_mfma_f32_32x32x16_bf16 v[16:31], a[68:71], v[52:55], v[16:31]
    ds_read_b128 v[48:51], v9 offset:20480
    v_mfma_f32_32x32x16_bf16 v[32:47], a[212:215], v[52:55], v[32:47]
    s_waitcnt lgkmcnt(2)
    v_mfma_f32_32x32x16_bf16 v[16:31], a[72:75], v[56:59], v[16:31]
    ds_read_b128 v[52:55], v9 offset:21504
    v_mfma_f32_32x32x16_bf16 v[32:47], a[216:219], v[56:59], v[32:47]
    s_waitcnt lgkmcnt(2)
    v_mfma_f32_32x32x16_bf16 v[16:31], a[76:79], v[60:63], v[16:31]
    ds_read_b128 v[56:59], v9 offset:22528
    v_mfma_f32_32x32x16_bf16 v[32:47], a[220:223], v[60:63], v[32:47]
    s_waitcnt lgkmcnt(2)
    v_mfma_f32_32x32x16_bf16 v[16:31], a[80:83], v[48:51], v[16:31]
    ds_read_b128 v[60:63], v9 offset:23552
    v_mfma_f32_32x32x16_bf16 v[32:47], a[224:227], v[48:51], v[32:47]
    s_waitcnt lgkmcnt(2)
    v_mfma_f32_32x32x16_bf16 v[16:31], a[84:87], v[52:55], v[16:31]
    ds_read_b128 v[48:51], v9 offset:24576
    v_mfma_f32_32x32x16_bf16 v[32:47], a[228:231], v[52:55], v[32:47]
    s_waitcnt lgkmcnt(2)
    v_mfma_f32_32x32x16_bf16 v[16:31], a[88:91], v[56:59], v[16:31]
    ds_read_b128 v[52:55], v9 offset:25600
    v_mfma_f32_32x32x16_bf16 v[32:47], a[232:235], v[56:59], v[32:47]
    s_waitcnt lgkmcnt(2)
    v_mfma_f32_32x32x16_bf16 v[16:31], a[92:95], v[60:63], v[16:31]
    ds_read_b128 v[56:59], v9 offset:26624
    v_mfma_f32_32x32x16_bf16 v[32:47], a[236:239], v[60:63], v[32:47]
    s_waitcnt lgkmcnt(2)
    v_mfma_f32_32x32x16_bf16 v[16:31], a[96:99], v[48:51], v[16:31]
    ds_read_b128 v[60:63], v9 offset:27648
    v_mfma_f32_32x32x16_bf16 v[32:47], a[240:243], v[48:51], v[32:47]
    s_waitcnt lgkmcnt(2)
    v_mfma_f32_32x32x16_bf16 v[16:31], a[100:103], v[52:55], v[16:31]
    ds_read_b128 v[48:51], v9 offset:28672
    v_mfma_f32_32x32x16_bf16 v[32:47], a[244:247], v[52:55], v[32:47]
    s_waitcnt lgkmcnt(2)
    v_mfma_f32_32x32x16_bf16 v[16:31], a[104:107], v[56:59], v[16:31]
    ds_read_b128 v[52:55], v9 offset:29696
    v_mfma_f32_32x32x16_bf16 v[32:47], a[248:251], v[56:59], v[32:47]
    s_waitcnt lgkmcnt(2)
    v_mfma_f32_32x32x16_bf16 v[16:31], a[108:111], v[60:63], v[16:31]
    ds_read_b128 v[56:59], v9 offset:30720
    v_mfma_f32_32x32x16_bf16 v[32:47], a[252:255], v[60:63], v[32:47]
    s_waitcnt lgkmcnt(2)
    v_mfma_f32_32x32x16_bf16 v[16:31], a[112:115], v[48:51], v[16:31]
    ds_read_b128 v[60:63], v9 offset:31744
    v_mfma_f32_32x32x16_bf16 v[32:47], v[152:155], v[48:51], v[32:47]
    s_waitcnt lgkmcnt(2)
    v_mfma_f32_32x32x16_bf16 v[16:31], a[116:119], v[52:55], v[16:31]
    ds_read_b128 v[48:51], v9 offset:32768
    v_mfma_f32_32x32x16_bf16 v[32:47], v[156:159], v[52:55], v[32:47]
    s_waitcnt lgkmcnt(2)
    v_mfma_f32_32x32x16_bf16 v[16:31], a[120:123], v[56:59], v[16:31]
    ds_read_b128 v[52:55], v9 offset:33792
    v_mfma_f32_32x32x16_bf16 v[32:47], v[160:163], v[56:59], v[32:47]
    s_waitcnt lgkmcnt(2)
    v_mfma_f32_32x32x16_bf16 v[16:31], a[124:127], v[60:63], v[16:31]
    v_cmp_eq_u32 s[76:77], 1, v2
    v_cmp_eq_u32 vcc, 2, v2
    s_cmp_eq_u64 s[76:77], -1
    s_cselect_b32 s38, 1, 0
    ds_read_b128 v[56:59], v9 offset:34816
    v_mfma_f32_32x32x16_bf16 v[32:47], v[164:167], v[60:63], v[32:47]
    s_cmp_lg_u32 s38, 0
    s_cselect_b64 exec, 1, 0
    v_mov_b32 v15, s32
    ds_write_b32 v184, v15
    v_mov_b32 v2, 2
    s_mov_b64 exec, -1
    s_waitcnt lgkmcnt(3)
    v_mfma_f32_32x32x16_bf16 v[16:31], a[128:131], v[48:51], v[16:31]
    s_add_u32 s32, s32, s38
    s_mul_i32 s38, s38, 22528
    s_add_u32 s33, s33, s38
    ds_read_b128 v[60:63], v9 offset:35840
    v_mfma_f32_32x32x16_bf16 v[32:47], v[168:171], v[48:51], v[32:47]
    s_cmp_eq_u64 vcc, 0
    s_cselect_b32 s38, s32, 0x7fff
    s_waitcnt lgkmcnt(3)
    v_mfma_f32_32x32x16_bf16 v[16:31], a[132:135], v[52:55], v[16:31]
    s_cmp_le_u32 s38, s39
    s_cselect_b64 exec, -1, 0
    v_mov_b32 v2, 2
    buffer_load_dword v2, v1, s[8:11], s33 offen sc1
    s_mov_b64 exec, -1
    v_mfma_f32_32x32x16_bf16 v[32:47], v[172:175], v[52:55], v[32:47]
    s_waitcnt lgkmcnt(2)
    v_mfma_f32_32x32x16_bf16 v[16:31], a[136:139], v[56:59], v[16:31]
    v_mfma_f32_32x32x16_bf16 v[32:47], v[176:179], v[56:59], v[32:47]
    s_waitcnt lgkmcnt(0)
    v_mfma_f32_32x32x16_bf16 v[16:31], a[140:143], v[60:63], v[16:31]
    v_mfma_f32_32x32x16_bf16 v[32:47], v[180:183], v[60:63], v[32:47]
    s_add_u32 s51, s46, 8192
    s_nop 2
    v_pk_fma_f32 v[16:17], v[16:17], v[148:149], v[100:101] op_sel_hi:[1,0,1] neg_lo:[0,0,1] neg_hi:[0,0,1]
    v_pk_fma_f32 v[18:19], v[18:19], v[148:149], v[102:103] op_sel_hi:[1,0,1] neg_lo:[0,0,1] neg_hi:[0,0,1]
    v_pk_fma_f32 v[20:21], v[20:21], v[148:149], v[104:105] op_sel_hi:[1,0,1] neg_lo:[0,0,1] neg_hi:[0,0,1]
    v_pk_fma_f32 v[22:23], v[22:23], v[148:149], v[106:107] op_sel_hi:[1,0,1] neg_lo:[0,0,1] neg_hi:[0,0,1]
    v_pk_fma_f32 v[24:25], v[24:25], v[148:149], v[108:109] op_sel_hi:[1,0,1] neg_lo:[0,0,1] neg_hi:[0,0,1]
    v_pk_fma_f32 v[26:27], v[26:27], v[148:149], v[110:111] op_sel_hi:[1,0,1] neg_lo:[0,0,1] neg_hi:[0,0,1]
    v_pk_fma_f32 v[28:29], v[28:29], v[148:149], v[112:113] op_sel_hi:[1,0,1] neg_lo:[0,0,1] neg_hi:[0,0,1]
    v_pk_fma_f32 v[30:31], v[30:31], v[148:149], v[114:115] op_sel_hi:[1,0,1] neg_lo:[0,0,1] neg_hi:[0,0,1]
    v_cvt_pk_bf16_f32 v188, v16, v24
    v_cvt_pk_bf16_f32 v189, v17, v25
    v_cvt_pk_bf16_f32 v190, v18, v26
    v_cvt_pk_bf16_f32 v191, v19, v27
    buffer_store_dwordx4 v[188:191], v14, s[8:11], s46 offen offset:0 sc1
    v_cvt_pk_bf16_f32 v192, v20, v28
    v_cvt_pk_bf16_f32 v193, v21, v29
    v_cvt_pk_bf16_f32 v194, v22, v30
    v_cvt_pk_bf16_f32 v195, v23, v31
    buffer_store_dwordx4 v[192:195], v14, s[8:11], s46 offen offset:512 sc1
    v_pk_fma_f32 v[32:33], v[32:33], v[148:149], v[132:133] op_sel_hi:[1,0,1] neg_lo:[0,0,1] neg_hi:[0,0,1]
    v_pk_fma_f32 v[34:35], v[34:35], v[148:149], v[134:135] op_sel_hi:[1,0,1] neg_lo:[0,0,1] neg_hi:[0,0,1]
    v_pk_fma_f32 v[36:37], v[36:37], v[148:149], v[136:137] op_sel_hi:[1,0,1] neg_lo:[0,0,1] neg_hi:[0,0,1]
    v_pk_fma_f32 v[38:39], v[38:39], v[148:149], v[138:139] op_sel_hi:[1,0,1] neg_lo:[0,0,1] neg_hi:[0,0,1]
    v_pk_fma_f32 v[40:41], v[40:41], v[148:149], v[140:141] op_sel_hi:[1,0,1] neg_lo:[0,0,1] neg_hi:[0,0,1]
    v_pk_fma_f32 v[42:43], v[42:43], v[148:149], v[142:143] op_sel_hi:[1,0,1] neg_lo:[0,0,1] neg_hi:[0,0,1]
    v_pk_fma_f32 v[44:45], v[44:45], v[148:149], v[144:145] op_sel_hi:[1,0,1] neg_lo:[0,0,1] neg_hi:[0,0,1]
    v_pk_fma_f32 v[46:47], v[46:47], v[148:149], v[146:147] op_sel_hi:[1,0,1] neg_lo:[0,0,1] neg_hi:[0,0,1]
    v_cvt_pk_bf16_f32 v196, v32, v40
    v_cvt_pk_bf16_f32 v197, v33, v41
    v_cvt_pk_bf16_f32 v198, v34, v42
    v_cvt_pk_bf16_f32 v199, v35, v43
    buffer_store_dwordx4 v[196:199], v14, s[8:11], s51 offen offset:0 sc1
    v_cvt_pk_bf16_f32 v200, v36, v44
    v_cvt_pk_bf16_f32 v201, v37, v45
    v_cvt_pk_bf16_f32 v202, v38, v46
    v_cvt_pk_bf16_f32 v203, v39, v47
    buffer_store_dwordx4 v[200:203], v14, s[8:11], s51 offen offset:512 sc1
    s_mul_i32 s43, s57, 22528
    s_add_u32 s43, s43, s49
    s_branch LpQQ_head
LpQQ_f_2:
    v_mfma_f32_32x32x16_bf16 v[16:31], a[76:79], v[60:63], v[16:31]
    s_add_u32 m0, s59, 0
    s_add_u32 s47, s41, 0
    buffer_load_dwordx4 v0, s[8:11], s47 offen offset:0 lds
    ds_read_b128 v[56:59], v9 offset:22528
    v_mfma_f32_32x32x16_bf16 v[32:47], a[220:223], v[60:63], v[32:47]
    s_waitcnt lgkmcnt(2)
    v_mfma_f32_32x32x16_bf16 v[16:31], a[80:83], v[48:51], v[16:31]
    buffer_load_dwordx4 v0, s[8:11], s47 offen offset:1024 lds
    ds_read_b128 v[60:63], v9 offset:23552
    v_mfma_f32_32x32x16_bf16 v[32:47], a[224:227], v[48:51], v[32:47]
    s_waitcnt lgkmcnt(2)
    v_mfma_f32_32x32x16_bf16 v[16:31], a[84:87], v[52:55], v[16:31]
    buffer_load_dwordx4 v0, s[8:11], s47 offen offset:2048 lds
    ds_read_b128 v[48:51], v9 offset:24576
    v_mfma_f32_32x32x16_bf16 v[32:47], a[228:231], v[52:55], v[32:47]
    s_waitcnt lgkmcnt(2)
    v_mfma_f32_32x32x16_bf16 v[16:31], a[88:91], v[56:59], v[16:31]
    buffer_load_dwordx4 v0, s[8:11], s47 offen offset:3072 lds
    ds_read_b128 v[52:55], v9 offset:25600
    v_mfma_f32_32x32x16_bf16 v[32:47], a[232:235], v[56:59], v[32:47]
    s_waitcnt lgkmcnt(2)
    v_mfma_f32_32x32x16_bf16 v[16:31], a[92:95], v[60:63], v[16:31]
    s_add_u32 m0, s59, 4096
    s_add_u32 s47, s41, 4096
    buffer_load_dwordx4 v0, s[8:11], s47 offen offset:0 lds
    ds_read_b128 v[56:59], v9 offset:26624
    v_mfma_f32_32x32x16_bf16 v[32:47], a[236:239], v[60:63], v[32:47]
    s_waitcnt lgkmcnt(2)
    v_mfma_f32_32x32x16_bf16 v[16:31], a[96:99], v[48:51], v[16:31]
    buffer_load_dwordx4 v0, s[8:11], s47 offen offset:1024 lds
    ds_read_b128 v[60:63], v9 offset:27648
    v_mfma_f32_32x32x16_bf16 v[32:47], a[240:243], v[48:51], v[32:47]
    s_waitcnt lgkmcnt(2)
    v_mfma_f32_32x32x16_bf16 v[16:31], a[100:103], v[52:55], v[16:31]
    buffer_load_dwordx4 v0, s[8:11], s47 offen offset:2048 lds
    ds_read_b128 v[48:51], v9 offset:28672
    v_mfma_f32_32x32x16_bf16 v[32:47], a[244:247], v[52:55], v[32:47]
    s_waitcnt lgkmcnt(2)
    v_mfma_f32_32x32x16_bf16 v[16:31], a[104:107], v[56:59], v[16:31]
    buffer_load_dwordx4 v0, s[8:11], s47 offen offset:3072 lds
    ds_read_b128 v[52:55], v9 offset:29696
    v_mfma_f32_32x32x16_bf16 v[32:47], a[248:251], v[56:59], v[32:47]
    s_waitcnt lgkmcnt(2)
    v_mfma_f32_32x32x16_bf16 v[16:31], a[108:111], v[60:63], v[16:31]
    s_add_u32 m0, s59, 8192
    s_add_u32 s47, s41, 8192
    buffer_load_dwordx4 v0, s[8:11], s47 offen offset:0 lds
    ds_read_b128 v[56:59], v9 offset:30720
    v_mfma_f32_32x32x16_bf16 v[32:47], a[252:255], v[60:63], v[32:47]
    s_waitcnt lgkmcnt(2)
    v_mfma_f32_32x32x16_bf16 v[16:31], a[112:115], v[48:51], v[16:31]
    s_mul_i32 s48, s36, 786432
    s_mul_i32 s18, s37, 6144
    s_add_u32 s48, s48, s18
    s_add_u32 s48, s48, 16125952
    s_add_u32 m0, s66, 4096
    s_nop 0
    buffer_load_dwordx4 v0, s[8:11], s48 offen lds
    ds_read_b128 v[60:63], v9 offset:31744
    v_mfma_f32_32x32x16_bf16 v[32:47], v[152:155], v[48:51], v[32:47]
    s_waitcnt lgkmcnt(2)
    v_mfma_f32_32x32x16_bf16 v[16:31], a[116:119], v[52:55], v[16:31]
    s_add_u32 m0, s66, s67
    s_sub_u32 s48, s48, 4096
    s_add_u32 s48, s48, s67
    buffer_load_dwordx4 v0, s[8:11], s48 offen lds
    ds_read_b128 v[48:51], v9 offset:32768
    v_mfma_f32_32x32x16_bf16 v[32:47], v[156:159], v[52:55], v[32:47]
    s_waitcnt lgkmcnt(2)
    v_mfma_f32_32x32x16_bf16 v[16:31], a[120:123], v[56:59], v[16:31]
    ds_read_b128 v[52:55], v9 offset:33792
    v_mfma_f32_32x32x16_bf16 v[32:47], v[160:163], v[56:59], v[32:47]
    s_waitcnt lgkmcnt(2)
    v_mfma_f32_32x32x16_bf16 v[16:31], a[124:127], v[60:63], v[16:31]
    v_cmp_eq_u32 s[76:77], 1, v2
    v_cmp_eq_u32 vcc, 2, v2
    s_cmp_eq_u64 s[76:77], -1
    s_cselect_b32 s38, 1, 0
    ds_read_b128 v[56:59], v9 offset:34816
    v_mfma_f32_32x32x16_bf16 v[32:47], v[164:167], v[60:63], v[32:47]
    s_cmp_lg_u32 s38, 0
    s_cselect_b64 exec, 1, 0
    v_mov_b32 v15, s32
    ds_write_b32 v184, v15
    v_mov_b32 v2, 2
    s_mov_b64 exec, -1
    s_waitcnt lgkmcnt(3)
    v_mfma_f32_32x32x16_bf16 v[16:31], a[128:131], v[48:51], v[16:31]
    s_add_u32 s32, s32, s38
    s_mul_i32 s38, s38, 22528
    s_add_u32 s33, s33, s38
    ds_read_b128 v[60:63], v9 offset:35840
    v_mfma_f32_32x32x16_bf16 v[32:47], v[168:171], v[48:51], v[32:47]
    s_cmp_eq_u64 vcc, 0
    s_cselect_b32 s38, s32, 0x7fff
    s_waitcnt lgkmcnt(3)
    v_mfma_f32_32x32x16_bf16 v[16:31], a[132:135], v[52:55], v[16:31]
    s_cmp_le_u32 s38, s39
    s_cselect_b64 exec, -1, 0
    v_mov_b32 v2, 2
    buffer_load_dword v2, v1, s[8:11], s33 offen sc1
    s_mov_b64 exec, -1
    v_mfma_f32_32x32x16_bf16 v[32:47], v[172:175], v[52:55], v[32:47]
    s_waitcnt lgkmcnt(2)
    v_mfma_f32_32x32x16_bf16 v[16:31], a[136:139], v[56:59], v[16:31]
    v_mfma_f32_32x32x16_bf16 v[32:47], v[176:179], v[56:59], v[32:47]
    s_waitcnt lgkmcnt(0)
    v_mfma_f32_32x32x16_bf16 v[16:31], a[140:143], v[60:63], v[16:31]
    v_mfma_f32_32x32x16_bf16 v[32:47], v[180:183], v[60:63], v[32:47]
    s_add_u32 s51, s46, 8192
    s_nop 2
    v_pk_fma_f32 v[16:17], v[16:17], v[148:149], v[100:101] op_sel_hi:[1,0,1] neg_lo:[0,0,1] neg_hi:[0,0,1]
    v_pk_fma_f32 v[18:19], v[18:19], v[148:149], v[102:103] op_sel_hi:[1,0,1] neg_lo:[0,0,1] neg_hi:[0,0,1]
    v_pk_fma_f32 v[20:21], v[20:21], v[148:149], v[104:105] op_sel_hi:[1,0,1] neg_lo:[0,0,1] neg_hi:[0,0,1]
    v_pk_fma_f32 v[22:23], v[22:23], v[148:149], v[106:107] op_sel_hi:[1,0,1] neg_lo:[0,0,1] neg_hi:[0,0,1]
    v_pk_fma_f32 v[24:25], v[24:25], v[148:149], v[108:109] op_sel_hi:[1,0,1] neg_lo:[0,0,1] neg_hi:[0,0,1]
    v_pk_fma_f32 v[26:27], v[26:27], v[148:149], v[110:111] op_sel_hi:[1,0,1] neg_lo:[0,0,1] neg_hi:[0,0,1]
    v_pk_fma_f32 v[28:29], v[28:29], v[148:149], v[112:113] op_sel_hi:[1,0,1] neg_lo:[0,0,1] neg_hi:[0,0,1]
    v_pk_fma_f32 v[30:31], v[30:31], v[148:149], v[114:115] op_sel_hi:[1,0,1] neg_lo:[0,0,1] neg_hi:[0,0,1]
    v_cvt_pk_bf16_f32 v188, v16, v24
    v_cvt_pk_bf16_f32 v189, v17, v25
    v_cvt_pk_bf16_f32 v190, v18, v26
    v_cvt_pk_bf16_f32 v191, v19, v27
    buffer_store_dwordx4 v[188:191], v14, s[8:11], s46 offen offset:0 sc1
    v_cvt_pk_bf16_f32 v192, v20, v28
    v_cvt_pk_bf16_f32 v193, v21, v29
    v_cvt_pk_bf16_f32 v194, v22, v30
    v_cvt_pk_bf16_f32 v195, v23, v31
    buffer_store_dwordx4 v[192:195], v14, s[8:11], s46 offen offset:512 sc1
    v_pk_fma_f32 v[32:33], v[32:33], v[148:149], v[132:133] op_sel_hi:[1,0,1] neg_lo:[0,0,1] neg_hi:[0,0,1]
    v_pk_fma_f32 v[34:35], v[34:35], v[148:149], v[134:135] op_sel_hi:[1,0,1] neg_lo:[0,0,1] neg_hi:[0,0,1]
    v_pk_fma_f32 v[36:37], v[36:37], v[148:149], v[136:137] op_sel_hi:[1,0,1] neg_lo:[0,0,1] neg_hi:[0,0,1]
    v_pk_fma_f32 v[38:39], v[38:39], v[148:149], v[138:139] op_sel_hi:[1,0,1] neg_lo:[0,0,1] neg_hi:[0,0,1]
    v_pk_fma_f32 v[40:41], v[40:41], v[148:149], v[140:141] op_sel_hi:[1,0,1] neg_lo:[0,0,1] neg_hi:[0,0,1]
    v_pk_fma_f32 v[42:43], v[42:43], v[148:149], v[142:143] op_sel_hi:[1,0,1] neg_lo:[0,0,1] neg_hi:[0,0,1]
    v_pk_fma_f32 v[44:45], v[44:45], v[148:149], v[144:145] op_sel_hi:[1,0,1] neg_lo:[0,0,1] neg_hi:[0,0,1]
    v_pk_fma_f32 v[46:47], v[46:47], v[148:149], v[146:147] op_sel_hi:[1,0,1] neg_lo:[0,0,1] neg_hi:[0,0,1]
    v_cvt_pk_bf16_f32 v196, v32, v40
    v_cvt_pk_bf16_f32 v197, v33, v41
    v_cvt_pk_bf16_f32 v198, v34, v42
    v_cvt_pk_bf16_f32 v199, v35, v43
    buffer_store_dwordx4 v[196:199], v14, s[8:11], s51 offen offset:0 sc1
    v_cvt_pk_bf16_f32 v200, v36, v44
    v_cvt_pk_bf16_f32 v201, v37, v45
    v_cvt_pk_bf16_f32 v202, v38, v46
    v_cvt_pk_bf16_f32 v203, v39, v47
    buffer_store_dwordx4 v[200:203], v14, s[8:11], s51 offen offset:512 sc1
    s_mul_i32 s43, s57, 22528
    s_add_u32 s43, s43, s49
    s_branch LpQQ_head
LpQQ_none:
    ds_read_b32 v15, v184
    s_waitcnt lgkmcnt(0)
    v_readfirstlane_b32 s17, v15
    s_nop 0
    s_cmp_lt_i32 s17, s37
    s_cbranch_scc1 LpQQ_nopost
    s_add_u32 m0, s59, 0
    s_add_u32 s47, s41, 0
    buffer_load_dwordx4 v0, s[8:11], s47 offen offset:0 lds
    buffer_load_dwordx4 v0, s[8:11], s47 offen offset:1024 lds
    buffer_load_dwordx4 v0, s[8:11], s47 offen offset:2048 lds
    buffer_load_dwordx4 v0, s[8:11], s47 offen offset:3072 lds
    s_add_u32 m0, s59, 4096
    s_add_u32 s47, s41, 4096
    buffer_load_dwordx4 v0, s[8:11], s47 offen offset:0 lds
    buffer_load_dwordx4 v0, s[8:11], s47 offen offset:1024 lds
    buffer_load_dwordx4 v0, s[8:11], s47 offen offset:2048 lds
    buffer_load_dwordx4 v0, s[8:11], s47 offen offset:3072 lds
    s_add_u32 m0, s59, 8192
    s_add_u32 s47, s41, 8192
    buffer_load_dwordx4 v0, s[8:11], s47 offen offset:0 lds
    s_mul_i32 s48, s36, 786432
    s_mul_i32 s18, s37, 6144
    s_add_u32 s48, s48, s18
    s_add_u32 s48, s48, 16125952
    s_add_u32 m0, s66, 4096
    s_nop 0
    buffer_load_dwordx4 v0, s[8:11], s48 offen lds
    s_add_u32 m0, s66, s67
    s_sub_u32 s48, s48, 4096
    s_add_u32 s48, s48, s67
    buffer_load_dwordx4 v0, s[8:11], s48 offen lds
    s_waitcnt vmcnt(11)
    s_cmp_lg_u32 s43, 0
    s_cselect_b64 exec, 3, 0
    buffer_store_dword v3, v185, s[8:11], s43 offen sc1
    s_mov_b64 exec, -1
    s_mov_b32 s43, 0
    s_waitcnt vmcnt(1) lgkmcnt(0)
    s_branch LpQQ_head2
LpQQ_nopost:
    s_waitcnt vmcnt(0)
    s_cmp_lg_u32 s43, 0
    s_cselect_b64 exec, 3, 0
    buffer_store_dword v3, v185, s[8:11], s43 offen sc1
    s_mov_b64 exec, -1
    s_mov_b32 s43, 0
    s_cmp_ge_u32 s37, 64
    s_cbranch_scc1 LpQQ_end
LpQQ_wait:
    s_mov_b32 s16, 0
    s_cmp_lg_u32 s14, 0
    s_cbranch_scc1 LpQQ_wl
LpQQ_wp:
    buffer_load_dword v2, v1, s[8:11], s60 offen sc1
    s_add_u32 s16, s16, 1
    s_cmp_gt_u32 s16, 100000
    s_cbranch_scc1 LpQQ_giveup
    s_waitcnt vmcnt(0)
    v_cmp_eq_u32 vcc, 0, v2
    s_nop 0
    s_cbranch_vccz LpQQ_wok
    s_sleep 4
    s_branch LpQQ_wp
LpQQ_giveup:
    v_mov_b32 v5, -2
    ds_write_b32 v184, v5
    s_waitcnt lgkmcnt(0)
    s_branch L_role_p_abort
LpQQ_wok:
    v_mov_b32 v5, s37
    ds_write_b32 v184, v5
    s_branch LpQQ_go
LpQQ_wl:
    ds_read_b32 v15, v184
    s_add_u32 s16, s16, 1
    s_cmp_gt_u32 s16, 1600000
    s_cbranch_scc1 L_role_p_abort
    s_waitcnt lgkmcnt(0)
    v_readfirstlane_b32 s17, v15
    s_nop 0
    s_cmp_eq_u32 s17, -2
    s_cbranch_scc1 L_role_p_abort
    s_cmp_ge_i32 s17, s37
    s_cbranch_scc1 LpQQ_go
    s_sleep 1
    s_branch LpQQ_wl
LpQQ_go:
    s_add_u32 m0, s59, 0
    s_add_u32 s47, s41, 0
    buffer_load_dwordx4 v0, s[8:11], s47 offen offset:0 lds
    buffer_load_dwordx4 v0, s[8:11], s47 offen offset:1024 lds
    buffer_load_dwordx4 v0, s[8:11], s47 offen offset:2048 lds
    buffer_load_dwordx4 v0, s[8:11], s47 offen offset:3072 lds
    s_add_u32 m0, s59, 4096
    s_add_u32 s47, s41, 4096
    buffer_load_dwordx4 v0, s[8:11], s47 offen offset:0 lds
    buffer_load_dwordx4 v0, s[8:11], s47 offen offset:1024 lds
    buffer_load_dwordx4 v0, s[8:11], s47 offen offset:2048 lds
    buffer_load_dwordx4 v0, s[8:11], s47 offen offset:3072 lds
    s_add_u32 m0, s59, 8192
    s_add_u32 s47, s41, 8192
    buffer_load_dwordx4 v0, s[8:11], s47 offen offset:0 lds
    s_mul_i32 s48, s36, 786432
    s_mul_i32 s18, s37, 6144
    s_add_u32 s48, s48, s18
    s_add_u32 s48, s48, 16125952
    s_add_u32 m0, s66, 4096
    s_nop 0
    buffer_load_dwordx4 v0, s[8:11], s48 offen lds
    s_add_u32 m0, s66, s67
    s_sub_u32 s48, s48, 4096
    s_add_u32 s48, s48, s67
    buffer_load_dwordx4 v0, s[8:11], s48 offen lds
    s_waitcnt vmcnt(0) lgkmcnt(0)
    s_branch LpQQ_head2
LpQQ_end:
    s_branch L_role_p_exit
Lp2_kv:
    v_mfma_f32_32x32x16_bf16 v[84:99], a[0:3], v[48:51], 0
    v_mfma_f32_32x32x16_bf16 v[32:47], v[48:51], a[144:147], 0
    v_mfma_f32_32x32x16_bf16 v[84:99], a[4:7], v[48:51], v[84:99]
    v_mfma_f32_32x32x16_bf16 v[32:47], v[48:51], a[148:151], v[32:47]
    v_mfma_f32_32x32x16_bf16 v[84:99], a[8:11], v[48:51], v[84:99]
    v_mfma_f32_32x32x16_bf16 v[32:47], v[48:51], a[152:155], v[32:47]
    v_mfma_f32_32x32x16_bf16 v[84:99], a[12:15], v[48:51], v[84:99]
    v_mfma_f32_32x32x16_bf16 v[32:47], v[48:51], a[156:159], v[32:47]
    v_mfma_f32_32x32x16_bf16 v[84:99], a[16:19], v[48:51], v[84:99]
    v_mfma_f32_32x32x16_bf16 v[32:47], v[48:51], a[160:163], v[32:47]
    v_mfma_f32_32x32x16_bf16 v[84:99], a[20:23], v[48:51], v[84:99]
    v_mfma_f32_32x32x16_bf16 v[32:47], v[48:51], a[164:167], v[32:47]
    v_mfma_f32_32x32x16_bf16 v[84:99], a[24:27], v[48:51], v[84:99]
    v_mfma_f32_32x32x16_bf16 v[32:47], v[48:51], a[168:171], v[32:47]
    v_mfma_f32_32x32x16_bf16 v[84:99], a[28:31], v[48:51], v[84:99]
    v_mfma_f32_32x32x16_bf16 v[32:47], v[48:51], a[172:175], v[32:47]
    v_mfma_f32_32x32x16_bf16 v[84:99], a[32:35], v[48:51], v[84:99]
    v_mfma_f32_32x32x16_bf16 v[32:47], v[48:51], a[176:179], v[32:47]
    v_mfma_f32_32x32x16_bf16 v[84:99], a[36:39], v[48:51], v[84:99]
    v_mfma_f32_32x32x16_bf16 v[32:47], v[48:51], a[180:183], v[32:47]
    v_mfma_f32_32x32x16_bf16 v[84:99], a[40:43], v[48:51], v[84:99]
    v_mfma_f32_32x32x16_bf16 v[32:47], v[48:51], a[184:187], v[32:47]
    v_mfma_f32_32x32x16_bf16 v[84:99], a[44:47], v[48:51], v[84:99]
    v_mfma_f32_32x32x16_bf16 v[32:47], v[48:51], a[188:191], v[32:47]
    v_mfma_f32_32x32x16_bf16 v[84:99], a[48:51], v[48:51], v[84:99]
    v_mfma_f32_32x32x16_bf16 v[32:47], v[48:51], a[192:195], v[32:47]
    v_mfma_f32_32x32x16_bf16 v[84:99], a[52:55], v[48:51], v[84:99]
    v_mfma_f32_32x32x16_bf16 v[32:47], v[48:51], a[196:199], v[32:47]
    v_mfma_f32_32x32x16_bf16 v[84:99], a[56:59], v[48:51], v[84:99]
    v_mfma_f32_32x32x16_bf16 v[32:47], v[48:51], a[200:203], v[32:47]
    v_mfma_f32_32x32x16_bf16 v[84:99], a[60:63], v[48:51], v[84:99]
    v_mfma_f32_32x32x16_bf16 v[32:47], v[48:51], a[204:207], v[32:47]
    v_mfma_f32_32x32x16_bf16 v[84:99], a[64:67], v[48:51], v[84:99]
    v_mfma_f32_32x32x16_bf16 v[32:47], v[48:51], a[208:211], v[32:47]
    v_mfma_f32_32x32x16_bf16 v[84:99], a[68:71], v[48:51], v[84:99]
    v_mfma_f32_32x32x16_bf16 v[32:47], v[48:51], a[212:215], v[32:47]
    v_mfma_f32_32x32x16_bf16 v[84:99], a[72:75], v[48:51], v[84:99]
    v_mfma_f32_32x32x16_bf16 v[32:47], v[48:51], a[216:219], v[32:47]
    v_mfma_f32_32x32x16_bf16 v[84:99], a[76:79], v[48:51], v[84:99]
    v_mfma_f32_32x32x16_bf16 v[32:47], v[48:51], a[220:223], v[32:47]
    v_mfma_f32_32x32x16_bf16 v[84:99], a[80:83], v[48:51], v[84:99]
    v_mfma_f32_32x32x16_bf16 v[32:47], v[48:51], a[224:227], v[32:47]
    v_mfma_f32_32x32x16_bf16 v[84:99], a[84:87], v[48:51], v[84:99]
    v_mfma_f32_32x32x16_bf16 v[32:47], v[48:51], a[228:231], v[32:47]
    v_mfma_f32_32x32x16_bf16 v[84:99], a[88:91], v[48:51], v[84:99]
    v_mfma_f32_32x32x16_bf16 v[32:47], v[48:51], a[232:235], v[32:47]
    v_mfma_f32_32x32x16_bf16 v[84:99], a[92:95], v[48:51], v[84:99]
    v_mfma_f32_32x32x16_bf16 v[32:47], v[48:51], a[236:239], v[32:47]
    v_mfma_f32_32x32x16_bf16 v[84:99], a[96:99], v[48:51], v[84:99]
    v_mfma_f32_32x32x16_bf16 v[32:47], v[48:51], a[240:243], v[32:47]
    v_mfma_f32_32x32x16_bf16 v[84:99], a[100:103], v[48:51], v[84:99]
    v_mfma_f32_32x32x16_bf16 v[32:47], v[48:51], a[244:247], v[32:47]
    v_mfma_f32_32x32x16_bf16 v[84:99], a[104:107], v[48:51], v[84:99]
    v_mfma_f32_32x32x16_bf16 v[32:47], v[48:51], a[248:251], v[32:47]
    v_mfma_f32_32x32x16_bf16 v[84:99], a[108:111], v[48:51], v[84:99]
    v_mfma_f32_32x32x16_bf16 v[32:47], v[48:51], a[252:255], v[32:47]
    v_mfma_f32_32x32x16_bf16 v[84:99], a[112:115], v[48:51], v[84:99]
    v_mfma_f32_32x32x16_bf16 v[32:47], v[48:51], v[152:155], v[32:47]
    v_mfma_f32_32x32x16_bf16 v[84:99], a[116:119], v[48:51], v[84:99]
    v_mfma_f32_32x32x16_bf16 v[32:47], v[48:51], v[156:159], v[32:47]
    v_mfma_f32_32x32x16_bf16 v[84:99], a[120:123], v[48:51], v[84:99]
    v_mfma_f32_32x32x16_bf16 v[32:47], v[48:51], v[160:163], v[32:47]
    v_mfma_f32_32x32x16_bf16 v[84:99], a[124:127], v[48:51], v[84:99]
    v_mfma_f32_32x32x16_bf16 v[32:47], v[48:51], v[164:167], v[32:47]
    v_mfma_f32_32x32x16_bf16 v[84:99], a[128:131], v[48:51], v[84:99]
    v_mfma_f32_32x32x16_bf16 v[32:47], v[48:51], v[168:171], v[32:47]
    v_mfma_f32_32x32x16_bf16 v[84:99], a[132:135], v[48:51], v[84:99]
    v_mfma_f32_32x32x16_bf16 v[32:47], v[48:51], v[172:175], v[32:47]
    v_mfma_f32_32x32x16_bf16 v[84:99], a[136:139], v[48:51], v[84:99]
    v_mfma_f32_32x32x16_bf16 v[32:47], v[48:51], v[176:179], v[32:47]
    v_mfma_f32_32x32x16_bf16 v[84:99], a[140:143], v[48:51], v[84:99]
    v_mfma_f32_32x32x16_bf16 v[32:47], v[48:51], v[180:183], v[32:47]
    s_nop 11
    v_mov_b32 v11, v32
    s_mov_b32 s66, 114688
    s_mov_b32 s71, 0x2000
    s_mov_b32 s36, s63
    s_mov_b32 s34, s63
    s_mul_i32 s58, s14, 9216
    s_mul_i32 s64, s63, 4718592
    s_add_u32 s64, s64, s58
    s_add_u32 s64, s64, 8650752
    s_mul_i32 s61, s63, 1441792
    s_add_u32 s61, s61, 3584
    s_mov_b32 s37, 0
    s_mov_b32 s40, 36864
    s_mov_b32 s59, s58
    s_mov_b32 s43, 0
    s_mov_b32 s62, 1
    s_mov_b32 s28, s8
    s_mov_b32 s29, s9
    s_mov_b32 s30, 0
    s_mov_b32 s31, 0x00020000
    v_mov_b32 v184, 74752
    v_mov_b32 v5, -1
    ds_write_b32 v184, v5
    s_waitcnt lgkmcnt(0)
    s_cmp_lg_u32 s14, 0
    s_cbranch_scc1 LpKV_inia_d
    v_mov_b32 v5, 40
    s_mov_b32 s16, 0
LpKV_inia:
    global_load_dword v6, v5, s[12:13] sc1
    s_add_u32 s16, s16, 1
    s_cmp_gt_u32 s16, 100000
    s_cbranch_scc1 L_role_p_abort
    s_waitcnt vmcnt(0)
    v_cmp_gt_u32 vcc, 128, v6
    s_nop 0
    s_cbranch_vccz LpKV_inia_d
    s_sleep 8
    s_branch LpKV_inia
LpKV_inia_d:
    s_barrier
    s_cmp_eq_u32 s63, 0
    s_cbranch_scc1 LpKV_ini_sk
    s_cmp_lg_u32 s14, 0
    s_cbranch_scc1 LpKV_inib_d
    v_mov_b32 v5, 160
    s_mov_b32 s16, 0
LpKV_inib:
    global_load_dword v6, v5, s[12:13] sc1
    s_add_u32 s16, s16, 1
    s_cmp_gt_u32 s16, 100000
    s_cbranch_scc1 L_role_p_abort
    s_waitcnt vmcnt(0)
    v_cmp_gt_u32 vcc, 64, v6
    s_nop 0
    s_cbranch_vccz LpKV_inib_d
    s_sleep 8
    s_branch LpKV_inib
LpKV_inib_d:
    s_barrier
LpKV_ini_sk:
    s_mul_i32 s41, s37, 36864
    s_add_u32 s41, s41, s64
    s_mul_i32 s60, s37, 22528
    s_add_u32 s60, s60, s61
    s_cmp_lt_u32 s37, 64
    s_cselect_b32 s60, s60, 2883584
    s_branch LpKV_wait
LpKV_head:
    s_waitcnt vmcnt(4)
LpKV_head2:
    s_barrier
    ds_read_b32 v15, v184
    s_xor_b32 s40, s40, 36864
    s_xor_b32 s59, s59, 36864
    s_mov_b32 s35, s37
    s_lshl_b32 s57, s34, 6
    s_add_u32 s57, s57, s35
    s_add_u32 s37, s37, 1
    s_mov_b32 s39, 0
    s_mov_b32 s54, 0
    s_xor_b32 s66, s66, 8192
    s_xor_b32 s71, s71, 8192
    s_mul_i32 s41, s37, 36864
    s_add_u32 s41, s41, s64
    s_mul_i32 s60, s37, 22528
    s_add_u32 s60, s60, s61
    s_cmp_lt_u32 s37, 64
    s_cselect_b32 s60, s60, 2883584
    v_add_u32 v9, s40, v0
    v_add_u32 v5, s71, v10
    ds_read_b128 v[48:51], v9 offset:0
    ds_read_b128 v[52:55], v9 offset:1024
    ds_read_b128 v[56:59], v9 offset:2048
    ds_read_b128 v[64:67], v5 offset:0
    ds_read_b128 v[68:71], v5 offset:512
    ds_read_b128 v[72:75], v5 offset:1024
    ds_read_b128 v[76:79], v5 offset:1536
    ds_read_b128 v[80:83], v5 offset:2048
    s_waitcnt lgkmcnt(7)
    v_mfma_f32_32x32x16_bf16 v[16:31], a[0:3], v[48:51], 0
    ds_read_b128 v[60:63], v9 offset:3072
    v_mfma_f32_32x32x16_bf16 v[32:47], v[48:51], a[144:147], 0
    s_waitcnt lgkmcnt(4)
    v_add_f32 v64, v64, v68
    v_add_f32 v65, v65, v69
    v_add_f32 v66, v66, v70
    v_add_f32 v67, v67, v71
    v_mfma_f32_32x32x16_bf16 v[16:31], a[4:7], v[52:55], v[16:31]
    ds_read_b128 v[48:51], v9 offset:4096
    s_waitcnt lgkmcnt(4)
    v_add_f32 v64, v64, v72
    v_add_f32 v65, v65, v73
    v_add_f32 v66, v66, v74
    v_mfma_f32_32x32x16_bf16 v[32:47], v[52:55], a[148:151], v[32:47]
    v_add_f32 v67, v67, v75
    s_waitcnt lgkmcnt(3)
    v_add_f32 v64, v64, v76
    v_add_f32 v65, v65, v77
    v_add_f32 v66, v66, v78
    v_readfirstlane_b32 s17, v15
    s_nop 0
    s_add_u32 s18, s17, 1
    s_max_i32 s32, s18, s37
    s_add_u32 s39, s37, 1
    s_min_u32 s39, s39, 63
    s_mul_i32 s33, s32, 22528
    s_add_u32 s33, s33, s61
    s_cmp_eq_u32 s14, 0
    s_cselect_b32 s18, s32, 0x7fff
    v_mov_b32 v2, 2
    s_cmp_le_u32 s18, s39
    s_cselect_b64 exec, -1, 0
    buffer_load_dword v2, v1, s[8:11], s33 offen sc1
    s_mov_b64 exec, -1
    s_cmp_ge_i32 s17, s37
    s_cbranch_scc1 LpKV_f_3
    v_mfma_f32_32x32x16_bf16 v[16:31], a[8:11], v[56:59], v[16:31]
    ds_read_b128 v[52:55], v9 offset:5120
    v_add_f32 v67, v67, v79
    s_waitcnt lgkmcnt(3)
    v_add_f32 v64, v64, v80
    v_add_f32 v65, v65, v81
    v_mfma_f32_32x32x16_bf16 v[32:47], v[56:59], a[152:155], v[32:47]
    v_add_f32 v66, v66, v82
    v_add_f32 v67, v67, v83
    v_add_f32 v64, v64, v66
    v_add_f32 v65, v65, v67
    s_waitcnt lgkmcnt(2)
    v_mfma_f32_32x32x16_bf16 v[16:31], a[12:15], v[60:63], v[16:31]
    ds_read_b128 v[56:59], v9 offset:6144
    v_mov_b32 v66, v64
    v_mov_b32 v67, v65
    s_nop 0
    v_permlane32_swap_b32 v64, v66
    v_mfma_f32_32x32x16_bf16 v[32:47], v[60:63], a[156:159], v[32:47]
    v_permlane32_swap_b32 v65, v67
    v_add_f32 v64, v64, v66
    v_add_f32 v65, v65, v67
    v_mul_f32 v64, 0x3ae38e39, v64
    s_waitcnt lgkmcnt(2)
    v_mfma_f32_32x32x16_bf16 v[16:31], a[16:19], v[48:51], v[16:31]
    ds_read_b128 v[60:63], v9 offset:7168
    v_mul_f32 v65, 0x3ae38e39, v65
    v_fma_f32 v65, -v64, v64, v65
    v_max_f32 v65, 0, v65
    v_mfma_f32_32x32x16_bf16 v[32:47], v[48:51], a[160:163], v[32:47]
    v_add_f32 v65, 0x3727c5ac, v65
    v_rsq_f32 v148, v65
    s_nop 0
    v_mul_f32 v149, v64, v148
    v_mul_f32 v100, v149, v84
    s_waitcnt lgkmcnt(2)
    v_mfma_f32_32x32x16_bf16 v[16:31], a[20:23], v[52:55], v[16:31]
    ds_read_b128 v[48:51], v9 offset:8192
    v_mul_f32 v101, v149, v85
    v_mul_f32 v102, v149, v86
    v_mul_f32 v103, v149, v87
    v_mfma_f32_32x32x16_bf16 v[32:47], v[52:55], a[164:167], v[32:47]
    v_mul_f32 v104, v149, v88
    v_mul_f32 v105, v149, v89
    v_mul_f32 v106, v149, v90
    v_mul_f32 v107, v149, v91
    s_waitcnt lgkmcnt(2)
    v_mfma_f32_32x32x16_bf16 v[16:31], a[24:27], v[56:59], v[16:31]
    ds_read_b128 v[52:55], v9 offset:9216
    v_mul_f32 v108, v149, v92
    v_mul_f32 v109, v149, v93
    v_mul_f32 v110, v149, v94
    v_mfma_f32_32x32x16_bf16 v[32:47], v[56:59], a[168:171], v[32:47]
    v_mul_f32 v111, v149, v95
    v_mul_f32 v112, v149, v96
    v_mul_f32 v113, v149, v97
    v_mul_f32 v114, v149, v98
    s_waitcnt lgkmcnt(2)
    v_mfma_f32_32x32x16_bf16 v[16:31], a[28:31], v[60:63], v[16:31]
    ds_read_b128 v[56:59], v9 offset:10240
    v_mul_f32 v115, v149, v99
    ds_write2_b32 v12, v148, v149 offset0:0 offset1:32
    ds_read_b128 v[116:119], v13 offset:0
    v_mfma_f32_32x32x16_bf16 v[32:47], v[60:63], a[172:175], v[32:47]
    ds_read_b128 v[120:123], v13 offset:32
    ds_read_b128 v[124:127], v13 offset:64
    ds_read_b128 v[128:131], v13 offset:96
    ds_read_b128 v[132:135], v13 offset:128
    s_waitcnt lgkmcnt(8)
    v_mfma_f32_32x32x16_bf16 v[16:31], a[32:35], v[48:51], v[16:31]
    ds_read_b128 v[60:63], v9 offset:11264
    ds_read_b128 v[136:139], v13 offset:160
    ds_read_b128 v[140:143], v13 offset:192
    ds_read_b128 v[144:147], v13 offset:224
    v_mfma_f32_32x32x16_bf16 v[32:47], v[48:51], a[176:179], v[32:47]
    s_waitcnt lgkmcnt(11)
    v_mfma_f32_32x32x16_bf16 v[16:31], a[36:39], v[52:55], v[16:31]
    ds_read_b128 v[48:51], v9 offset:12288
    v_mfma_f32_32x32x16_bf16 v[32:47], v[52:55], a[180:183], v[32:47]
    s_waitcnt lgkmcnt(5)
    v_mul_f32 v132, v11, v132
    v_mul_f32 v133, v11, v133
    v_mfma_f32_32x32x16_bf16 v[16:31], a[40:43], v[56:59], v[16:31]
    ds_read_b128 v[52:55], v9 offset:13312
    v_mul_f32 v134, v11, v134
    v_mul_f32 v135, v11, v135
    s_waitcnt lgkmcnt(4)
    v_mul_f32 v136, v11, v136
    v_mfma_f32_32x32x16_bf16 v[32:47], v[56:59], a[184:187], v[32:47]
    v_mul_f32 v137, v11, v137
    v_mul_f32 v138, v11, v138
    v_mul_f32 v139, v11, v139
    s_waitcnt lgkmcnt(3)
    v_mul_f32 v140, v11, v140
    v_mfma_f32_32x32x16_bf16 v[16:31], a[44:47], v[60:63], v[16:31]
    ds_read_b128 v[56:59], v9 offset:14336
    v_mul_f32 v141, v11, v141
    v_mul_f32 v142, v11, v142
    v_mul_f32 v143, v11, v143
    v_mfma_f32_32x32x16_bf16 v[32:47], v[60:63], a[188:191], v[32:47]
    s_waitcnt lgkmcnt(3)
    v_mul_f32 v144, v11, v144
    v_mul_f32 v145, v11, v145
    v_mul_f32 v146, v11, v146
    v_mul_f32 v147, v11, v147
    s_waitcnt lgkmcnt(2)
    v_mfma_f32_32x32x16_bf16 v[16:31], a[48:51], v[48:51], v[16:31]
    ds_read_b128 v[60:63], v9 offset:15360
    s_mul_i32 s46, s34, 50331648
    s_lshl_b32 s51, s35, 18
    s_add_u32 s46, s46, s51
    v_mfma_f32_32x32x16_bf16 v[32:47], v[48:51], a[192:195], v[32:47]
    s_add_u32 s46, s46, s52
    s_waitcnt vmcnt(1)
    s_cmp_lg_u32 s43, 0
    s_cselect_b64 exec, 3, 0
    buffer_store_dword v3, v185, s[8:11], s43 offen sc1
    s_mov_b64 exec, -1
    s_mov_b32 s43, 0
    s_waitcnt lgkmcnt(2)
    v_mfma_f32_32x32x16_bf16 v[16:31], a[52:55], v[52:55], v[16:31]
    ds_read_b128 v[48:51], v9 offset:16384
    v_mfma_f32_32x32x16_bf16 v[32:47], v[52:55], a[196:199], v[32:47]
    s_waitcnt lgkmcnt(2)
    v_mfma_f32_32x32x16_bf16 v[16:31], a[56:59], v[56:59], v[16:31]
    v_cmp_eq_u32 s[76:77], 1, v2
    v_cmp_eq_u32 vcc, 2, v2
    s_cmp_eq_u64 s[76:77], -1
    s_cselect_b32 s38, 1, 0
    ds_read_b128 v[52:55], v9 offset:17408
    v_mfma_f32_32x32x16_bf16 v[32:47], v[56:59], a[200:203], v[32:47]
    s_cmp_lg_u32 s38, 0
    s_cselect_b64 exec, 1, 0
    v_mov_b32 v15, s32
    ds_write_b32 v184, v15
    v_mov_b32 v2, 2
    s_mov_b64 exec, -1
    s_waitcnt lgkmcnt(3)
    v_mfma_f32_32x32x16_bf16 v[16:31], a[60:63], v[60:63], v[16:31]
    s_add_u32 s32, s32, s38
    s_mul_i32 s38, s38, 22528
    s_add_u32 s33, s33, s38
    ds_read_b128 v[56:59], v9 offset:18432
    v_mfma_f32_32x32x16_bf16 v[32:47], v[60:63], a[204:207], v[32:47]
    s_cmp_eq_u64 vcc, 0
    s_cselect_b32 s38, s32, 0x7fff
    s_waitcnt lgkmcnt(3)
    v_mfma_f32_32x32x16_bf16 v[16:31], a[64:67], v[48:51], v[16:31]
    ds_read_b128 v[60:63], v9 offset:19456
    v_mfma_f32_32x32x16_bf16 v[32:47], v[48:51], a[208:211], v[32:47]
    s_cmp_le_u32 s38, s39
    s_cselect_b64 exec, -1, 0
    v_mov_b32 v2, 2
    buffer_load_dword v2, v1, s[8:11], s33 offen sc1
    s_mov_b64 exec, -1
    ds_read_b32 v15, v184
    s_waitcnt lgkmcnt(4)
    v_mfma_f32_32x32x16_bf16 v[16:31], a[68:71], v[52:55], v[16:31]
    ds_read_b128 v[48:51], v9 offset:20480
    v_mfma_f32_32x32x16_bf16 v[32:47], v[52:55], a[212:215], v[32:47]
    s_waitcnt lgkmcnt(3)
    v_mfma_f32_32x32x16_bf16 v[16:31], a[72:75], v[56:59], v[16:31]
    ds_read_b128 v[52:55], v9 offset:21504
    v_mfma_f32_32x32x16_bf16 v[32:47], v[56:59], a[216:219], v[32:47]
    s_waitcnt lgkmcnt(2)
    v_readfirstlane_b32 s17, v15
    s_nop 0
    s_cmp_ge_i32 s17, s37
    s_cbranch_scc1 LpKV_f_4
    v_mfma_f32_32x32x16_bf16 v[16:31], a[76:79], v[60:63], v[16:31]
    ds_read_b128 v[56:59], v9 offset:22528
    v_mfma_f32_32x32x16_bf16 v[32:47], v[60:63], a[220:223], v[32:47]
    s_waitcnt lgkmcnt(2)
    v_mfma_f32_32x32x16_bf16 v[16:31], a[80:83], v[48:51], v[16:31]
    ds_read_b128 v[60:63], v9 offset:23552
    v_mfma_f32_32x32x16_bf16 v[32:47], v[48:51], a[224:227], v[32:47]
    s_waitcnt lgkmcnt(2)
    v_mfma_f32_32x32x16_bf16 v[16:31], a[84:87], v[52:55], v[16:31]
    ds_read_b128 v[48:51], v9 offset:24576
    v_mfma_f32_32x32x16_bf16 v[32:47], v[52:55], a[228:231], v[32:47]
    s_waitcnt lgkmcnt(2)
    v_mfma_f32_32x32x16_bf16 v[16:31], a[88:91], v[56:59], v[16:31]
    ds_read_b128 v[52:55], v9 offset:25600
    v_mfma_f32_32x32x16_bf16 v[32:47], v[56:59], a[232:235], v[32:47]
    s_waitcnt lgkmcnt(2)
    v_mfma_f32_32x32x16_bf16 v[16:31], a[92:95], v[60:63], v[16:31]
    ds_read_b128 v[56:59], v9 offset:26624
    v_mfma_f32_32x32x16_bf16 v[32:47], v[60:63], a[236:239], v[32:47]
    s_waitcnt lgkmcnt(2)
    v_mfma_f32_32x32x16_bf16 v[16:31], a[96:99], v[48:51], v[16:31]
    ds_read_b128 v[60:63], v9 offset:27648
    v_mfma_f32_32x32x16_bf16 v[32:47], v[48:51], a[240:243], v[32:47]
    s_waitcnt lgkmcnt(2)
    v_mfma_f32_32x32x16_bf16 v[16:31], a[100:103], v[52:55], v[16:31]
    ds_read_b128 v[48:51], v9 offset:28672
    v_mfma_f32_32x32x16_bf16 v[32:47], v[52:55], a[244:247], v[32:47]
    s_waitcnt lgkmcnt(2)
    v_mfma_f32_32x32x16_bf16 v[16:31], a[104:107], v[56:59], v[16:31]
    ds_read_b128 v[52:55], v9 offset:29696
    v_mfma_f32_32x32x16_bf16 v[32:47], v[56:59], a[248:251], v[32:47]
    s_waitcnt lgkmcnt(2)
    v_mfma_f32_32x32x16_bf16 v[16:31], a[108:111], v[60:63], v[16:31]
    ds_read_b128 v[56:59], v9 offset:30720
    v_mfma_f32_32x32x16_bf16 v[32:47], v[60:63], a[252:255], v[32:47]
    s_waitcnt lgkmcnt(2)
    v_mfma_f32_32x32x16_bf16 v[16:31], a[112:115], v[48:51], v[16:31]
    ds_read_b128 v[60:63], v9 offset:31744
    v_mfma_f32_32x32x16_bf16 v[32:47], v[48:51], v[152:155], v[32:47]
    s_waitcnt lgkmcnt(2)
    v_mfma_f32_32x32x16_bf16 v[16:31], a[116:119], v[52:55], v[16:31]
    ds_read_b128 v[48:51], v9 offset:32768
    v_mfma_f32_32x32x16_bf16 v[32:47], v[52:55], v[156:159], v[32:47]
    s_waitcnt lgkmcnt(2)
    v_mfma_f32_32x32x16_bf16 v[16:31], a[120:123], v[56:59], v[16:31]
    ds_read_b128 v[52:55], v9 offset:33792
    v_mfma_f32_32x32x16_bf16 v[32:47], v[56:59], v[160:163], v[32:47]
    s_waitcnt lgkmcnt(2)
    v_mfma_f32_32x32x16_bf16 v[16:31], a[124:127], v[60:63], v[16:31]
    v_cmp_eq_u32 s[76:77], 1, v2
    v_cmp_eq_u32 vcc, 2, v2
    s_cmp_eq_u64 s[76:77], -1
    s_cselect_b32 s38, 1, 0
    ds_read_b128 v[56:59], v9 offset:34816
    v_mfma_f32_32x32x16_bf16 v[32:47], v[60:63], v[164:167], v[32:47]
    s_cmp_lg_u32 s38, 0
    s_cselect_b64 exec, 1, 0
    v_mov_b32 v15, s32
    ds_write_b32 v184, v15
    v_mov_b32 v2, 2
    s_mov_b64 exec, -1
    s_waitcnt lgkmcnt(3)
    v_mfma_f32_32x32x16_bf16 v[16:31], a[128:131], v[48:51], v[16:31]
    s_add_u32 s32, s32, s38
    s_mul_i32 s38, s38, 22528
    s_add_u32 s33, s33, s38
    ds_read_b128 v[60:63], v9 offset:35840
    v_mfma_f32_32x32x16_bf16 v[32:47], v[48:51], v[168:171], v[32:47]
    s_cmp_eq_u64 vcc, 0
    s_cselect_b32 s38, s32, 0x7fff
    s_waitcnt lgkmcnt(3)
    v_mfma_f32_32x32x16_bf16 v[16:31], a[132:135], v[52:55], v[16:31]
    s_cmp_le_u32 s38, s39
    s_cselect_b64 exec, -1, 0
    v_mov_b32 v2, 2
    buffer_load_dword v2, v1, s[8:11], s33 offen sc1
    s_mov_b64 exec, -1
    v_mfma_f32_32x32x16_bf16 v[32:47], v[52:55], v[172:175], v[32:47]
    s_waitcnt lgkmcnt(2)
    v_mfma_f32_32x32x16_bf16 v[16:31], a[136:139], v[56:59], v[16:31]
    v_mfma_f32_32x32x16_bf16 v[32:47], v[56:59], v[176:179], v[32:47]
    s_waitcnt lgkmcnt(0)
    v_mfma_f32_32x32x16_bf16 v[16:31], a[140:143], v[60:63], v[16:31]
    v_mfma_f32_32x32x16_bf16 v[32:47], v[60:63], v[180:183], v[32:47]
    s_add_u32 s51, s46, 16777216
    s_nop 2
    v_pk_fma_f32 v[16:17], v[16:17], v[148:149], v[100:101] op_sel_hi:[1,0,1] neg_lo:[0,0,1] neg_hi:[0,0,1]
    v_pk_fma_f32 v[18:19], v[18:19], v[148:149], v[102:103] op_sel_hi:[1,0,1] neg_lo:[0,0,1] neg_hi:[0,0,1]
    v_pk_fma_f32 v[20:21], v[20:21], v[148:149], v[104:105] op_sel_hi:[1,0,1] neg_lo:[0,0,1] neg_hi:[0,0,1]
    v_pk_fma_f32 v[22:23], v[22:23], v[148:149], v[106:107] op_sel_hi:[1,0,1] neg_lo:[0,0,1] neg_hi:[0,0,1]
    v_pk_fma_f32 v[24:25], v[24:25], v[148:149], v[108:109] op_sel_hi:[1,0,1] neg_lo:[0,0,1] neg_hi:[0,0,1]
    v_pk_fma_f32 v[26:27], v[26:27], v[148:149], v[110:111] op_sel_hi:[1,0,1] neg_lo:[0,0,1] neg_hi:[0,0,1]
    v_pk_fma_f32 v[28:29], v[28:29], v[148:149], v[112:113] op_sel_hi:[1,0,1] neg_lo:[0,0,1] neg_hi:[0,0,1]
    v_pk_fma_f32 v[30:31], v[30:31], v[148:149], v[114:115] op_sel_hi:[1,0,1] neg_lo:[0,0,1] neg_hi:[0,0,1]
    v_cvt_pk_bf16_f32 v188, v16, v24
    v_cvt_pk_bf16_f32 v189, v17, v25
    v_cvt_pk_bf16_f32 v190, v18, v26
    v_cvt_pk_bf16_f32 v191, v19, v27
    buffer_store_dwordx4 v[188:191], v14, s[8:11], s46 offen offset:0 sc1
    v_cvt_pk_bf16_f32 v192, v20, v28
    v_cvt_pk_bf16_f32 v193, v21, v29
    v_cvt_pk_bf16_f32 v194, v22, v30
    v_cvt_pk_bf16_f32 v195, v23, v31
    buffer_store_dwordx4 v[192:195], v14, s[8:11], s46 offen offset:512 sc1
    v_pk_fma_f32 v[32:33], v[32:33], v[116:117], v[132:133] neg_lo:[0,0,1] neg_hi:[0,0,1]
    v_pk_fma_f32 v[34:35], v[34:35], v[118:119], v[134:135] neg_lo:[0,0,1] neg_hi:[0,0,1]
    v_pk_fma_f32 v[36:37], v[36:37], v[120:121], v[136:137] neg_lo:[0,0,1] neg_hi:[0,0,1]
    v_pk_fma_f32 v[38:39], v[38:39], v[122:123], v[138:139] neg_lo:[0,0,1] neg_hi:[0,0,1]
    v_pk_fma_f32 v[40:41], v[40:41], v[124:125], v[140:141] neg_lo:[0,0,1] neg_hi:[0,0,1]
    v_pk_fma_f32 v[42:43], v[42:43], v[126:127], v[142:143] neg_lo:[0,0,1] neg_hi:[0,0,1]
    v_pk_fma_f32 v[44:45], v[44:45], v[128:129], v[144:145] neg_lo:[0,0,1] neg_hi:[0,0,1]
    v_pk_fma_f32 v[46:47], v[46:47], v[130:131], v[146:147] neg_lo:[0,0,1] neg_hi:[0,0,1]
    v_cvt_pk_bf16_f32 v196, v32, v33
    v_cvt_pk_bf16_f32 v197, v34, v35
    v_cvt_pk_bf16_f32 v198, v40, v41
    v_cvt_pk_bf16_f32 v199, v42, v43
    buffer_store_dwordx4 v[196:199], v14, s[8:11], s51 offen offset:0 sc1
    v_cvt_pk_bf16_f32 v200, v36, v37
    v_cvt_pk_bf16_f32 v201, v38, v39
    v_cvt_pk_bf16_f32 v202, v44, v45
    v_cvt_pk_bf16_f32 v203, v46, v47
    buffer_store_dwordx4 v[200:203], v14, s[8:11], s51 offen offset:512 sc1
    s_mul_i32 s43, s57, 22528
    s_add_u32 s43, s43, s49
    s_branch LpKV_none
LpKV_f_3:
    v_mfma_f32_32x32x16_bf16 v[16:31], a[8:11], v[56:59], v[16:31]
    ds_read_b128 v[52:55], v9 offset:5120
    v_add_f32 v67, v67, v79
    s_waitcnt lgkmcnt(3)
    v_add_f32 v64, v64, v80
    v_add_f32 v65, v65, v81
    v_mfma_f32_32x32x16_bf16 v[32:47], v[56:59], a[152:155], v[32:47]
    v_add_f32 v66, v66, v82
    v_add_f32 v67, v67, v83
    v_add_f32 v64, v64, v66
    v_add_f32 v65, v65, v67
    s_waitcnt lgkmcnt(2)
    v_mfma_f32_32x32x16_bf16 v[16:31], a[12:15], v[60:63], v[16:31]
    ds_read_b128 v[56:59], v9 offset:6144
    v_mov_b32 v66, v64
    v_mov_b32 v67, v65
    s_nop 0
    v_permlane32_swap_b32 v64, v66
    v_mfma_f32_32x32x16_bf16 v[32:47], v[60:63], a[156:159], v[32:47]
    v_permlane32_swap_b32 v65, v67
    v_add_f32 v64, v64, v66
    v_add_f32 v65, v65, v67
    v_mul_f32 v64, 0x3ae38e39, v64
    s_waitcnt lgkmcnt(2)
    v_mfma_f32_32x32x16_bf16 v[16:31], a[16:19], v[48:51], v[16:31]
    ds_read_b128 v[60:63], v9 offset:7168
    v_mul_f32 v65, 0x3ae38e39, v65
    v_fma_f32 v65, -v64, v64, v65
    v_max_f32 v65, 0, v65
    v_mfma_f32_32x32x16_bf16 v[32:47], v[48:51], a[160:163], v[32:47]
    v_add_f32 v65, 0x3727c5ac, v65
    v_rsq_f32 v148, v65
    s_nop 0
    v_mul_f32 v149, v64, v148
    v_mul_f32 v100, v149, v84
    s_waitcnt lgkmcnt(2)
    v_mfma_f32_32x32x16_bf16 v[16:31], a[20:23], v[52:55], v[16:31]
    ds_read_b128 v[48:51], v9 offset:8192
    v_mul_f32 v101, v149, v85
    v_mul_f32 v102, v149, v86
    v_mul_f32 v103, v149, v87
    v_mfma_f32_32x32x16_bf16 v[32:47], v[52:55], a[164:167], v[32:47]
    v_mul_f32 v104, v149, v88
    v_mul_f32 v105, v149, v89
    v_mul_f32 v106, v149, v90
    v_mul_f32 v107, v149, v91
    s_waitcnt lgkmcnt(2)
    v_mfma_f32_32x32x16_bf16 v[16:31], a[24:27], v[56:59], v[16:31]
    ds_read_b128 v[52:55], v9 offset:9216
    v_mul_f32 v108, v149, v92
    v_mul_f32 v109, v149, v93
    v_mul_f32 v110, v149, v94
    v_mfma_f32_32x32x16_bf16 v[32:47], v[56:59], a[168:171], v[32:47]
    v_mul_f32 v111, v149, v95
    v_mul_f32 v112, v149, v96
    v_mul_f32 v113, v149, v97
    v_mul_f32 v114, v149, v98
    s_waitcnt lgkmcnt(2)
    v_mfma_f32_32x32x16_bf16 v[16:31], a[28:31], v[60:63], v[16:31]
    ds_read_b128 v[56:59], v9 offset:10240
    v_mul_f32 v115, v149, v99
    ds_write2_b32 v12, v148, v149 offset0:0 offset1:32
    ds_read_b128 v[116:119], v13 offset:0
    v_mfma_f32_32x32x16_bf16 v[32:47], v[60:63], a[172:175], v[32:47]
    ds_read_b128 v[120:123], v13 offset:32
    ds_read_b128 v[124:127], v13 offset:64
    ds_read_b128 v[128:131], v13 offset:96
    ds_read_b128 v[132:135], v13 offset:128
    s_waitcnt lgkmcnt(8)
    v_mfma_f32_32x32x16_bf16 v[16:31], a[32:35], v[48:51], v[16:31]
    ds_read_b128 v[60:63], v9 offset:11264
    ds_read_b128 v[136:139], v13 offset:160
    ds_read_b128 v[140:143], v13 offset:192
    ds_read_b128 v[144:147], v13 offset:224
    v_mfma_f32_32x32x16_bf16 v[32:47], v[48:51], a[176:179], v[32:47]
    s_add_u32 m0, s59, 0
    s_add_u32 s47, s41, 0
    buffer_load_dwordx4 v0, s[8:11], s47 offen offset:0 lds
    buffer_load_dwordx4 v0, s[8:11], s47 offen offset:1024 lds
    buffer_load_dwordx4 v0, s[8:11], s47 offen offset:2048 lds
    s_waitcnt lgkmcnt(11)
    v_mfma_f32_32x32x16_bf16 v[16:31], a[36:39], v[52:55], v[16:31]
    buffer_load_dwordx4 v0, s[8:11], s47 offen offset:3072 lds
    s_add_u32 m0, s59, 4096
    s_add_u32 s47, s41, 4096
    buffer_load_dwordx4 v0, s[8:11], s47 offen offset:0 lds
    ds_read_b128 v[48:51], v9 offset:12288
    v_mfma_f32_32x32x16_bf16 v[32:47], v[52:55], a[180:183], v[32:47]
    buffer_load_dwordx4 v0, s[8:11], s47 offen offset:1024 lds
    buffer_load_dwordx4 v0, s[8:11], s47 offen offset:2048 lds
    buffer_load_dwordx4 v0, s[8:11], s47 offen offset:3072 lds
    s_waitcnt lgkmcnt(5)
    v_mul_f32 v132, v11, v132
    v_mul_f32 v133, v11, v133
    v_mfma_f32_32x32x16_bf16 v[16:31], a[40:43], v[56:59], v[16:31]
    ds_read_b128 v[52:55], v9 offset:13312
    v_mul_f32 v134, v11, v134
    v_mul_f32 v135, v11, v135
    s_waitcnt lgkmcnt(4)
    v_mul_f32 v136, v11, v136
    v_mfma_f32_32x32x16_bf16 v[32:47], v[56:59], a[184:187], v[32:47]
    v_mul_f32 v137, v11, v137
    v_mul_f32 v138, v11, v138
    v_mul_f32 v139, v11, v139
    s_waitcnt lgkmcnt(3)
    v_mul_f32 v140, v11, v140
    v_mfma_f32_32x32x16_bf16 v[16:31], a[44:47], v[60:63], v[16:31]
    ds_read_b128 v[56:59], v9 offset:14336
    v_mul_f32 v141, v11, v141
    v_mul_f32 v142, v11, v142
    v_mul_f32 v143, v11, v143
    v_mfma_f32_32x32x16_bf16 v[32:47], v[60:63], a[188:191], v[32:47]
    s_waitcnt lgkmcnt(3)
    v_mul_f32 v144, v11, v144
    v_mul_f32 v145, v11, v145
    v_mul_f32 v146, v11, v146
    v_mul_f32 v147, v11, v147
    s_waitcnt lgkmcnt(2)
    v_mfma_f32_32x32x16_bf16 v[16:31], a[48:51], v[48:51], v[16:31]
    ds_read_b128 v[60:63], v9 offset:15360
    s_mul_i32 s46, s34, 50331648
    s_lshl_b32 s51, s35, 18
    s_add_u32 s46, s46, s51
    v_mfma_f32_32x32x16_bf16 v[32:47], v[48:51], a[192:195], v[32:47]
    s_add_u32 m0, s59, 8192
    s_add_u32 s47, s41, 8192
    buffer_load_dwordx4 v0, s[8:11], s47 offen offset:0 lds
    s_add_u32 s46, s46, s52
    s_waitcnt vmcnt(10)
    s_cmp_lg_u32 s43, 0
    s_cselect_b64 exec, 3, 0
    buffer_store_dword v3, v185, s[8:11], s43 offen sc1
    s_mov_b64 exec, -1
    s_mov_b32 s43, 0
    s_waitcnt lgkmcnt(2)
    v_mfma_f32_32x32x16_bf16 v[16:31], a[52:55], v[52:55], v[16:31]
    s_mul_i32 s48, s36, 786432
    s_mul_i32 s18, s37, 6144
    s_add_u32 s48, s48, s18
    s_add_u32 s48, s48, 16125952
    s_add_u32 m0, s66, 4096
    s_nop 0
    buffer_load_dwordx4 v0, s[8:11], s48 offen lds
    ds_read_b128 v[48:51], v9 offset:16384
    v_mfma_f32_32x32x16_bf16 v[32:47], v[52:55], a[196:199], v[32:47]
    s_add_u32 m0, s66, s67
    s_sub_u32 s48, s48, 4096
    s_add_u32 s48, s48, s67
    buffer_load_dwordx4 v0, s[8:11], s48 offen lds
    s_waitcnt lgkmcnt(2)
    v_mfma_f32_32x32x16_bf16 v[16:31], a[56:59], v[56:59], v[16:31]
    v_cmp_eq_u32 s[76:77], 1, v2
    v_cmp_eq_u32 vcc, 2, v2
    s_cmp_eq_u64 s[76:77], -1
    s_cselect_b32 s38, 1, 0
    ds_read_b128 v[52:55], v9 offset:17408
    v_mfma_f32_32x32x16_bf16 v[32:47], v[56:59], a[200:203], v[32:47]
    s_cmp_lg_u32 s38, 0
    s_cselect_b64 exec, 1, 0
    v_mov_b32 v15, s32
    ds_write_b32 v184, v15
    v_mov_b32 v2, 2
    s_mov_b64 exec, -1
    s_waitcnt lgkmcnt(3)
    v_mfma_f32_32x32x16_bf16 v[16:31], a[60:63], v[60:63], v[16:31]
    s_add_u32 s32, s32, s38
    s_mul_i32 s38, s38, 22528
    s_add_u32 s33, s33, s38
    ds_read_b128 v[56:59], v9 offset:18432
    v_mfma_f32_32x32x16_bf16 v[32:47], v[60:63], a[204:207], v[32:47]
    s_cmp_eq_u64 vcc, 0
    s_cselect_b32 s38, s32, 0x7fff
    s_waitcnt lgkmcnt(3)
    v_mfma_f32_32x32x16_bf16 v[16:31], a[64:67], v[48:51], v[16:31]
    ds_read_b128 v[60:63], v9 offset:19456
    v_mfma_f32_32x32x16_bf16 v[32:47], v[48:51], a[208:211], v[32:47]
    s_cmp_le_u32 s38, s39
    s_cselect_b64 exec, -1, 0
    v_mov_b32 v2, 2
    buffer_load_dword v2, v1, s[8:11], s33 offen sc1
    s_mov_b64 exec, -1
    s_waitcnt lgkmcnt(3)
    v_mfma_f32_32x32x16_bf16 v[16:31], a[68:71], v[52:55], v[16:31]
    ds_read_b128 v[48:51], v9 offset:20480
    v_mfma_f32_32x32x16_bf16 v[32:47], v[52:55], a[212:215], v[32:47]
    s_waitcnt lgkmcnt(2)
    v_mfma_f32_32x32x16_bf16 v[16:31], a[72:75], v[56:59], v[16:31]
    ds_read_b128 v[52:55], v9 offset:21504
    v_mfma_f32_32x32x16_bf16 v[32:47], v[56:59], a[216:219], v[32:47]
    s_waitcnt lgkmcnt(2)
    v_mfma_f32_32x32x16_bf16 v[16:31], a[76:79], v[60:63], v[16:31]
    ds_read_b128 v[56:59], v9 offset:22528
    v_mfma_f32_32x32x16_bf16 v[32:47], v[60:63], a[220:223], v[32:47]
    s_waitcnt lgkmcnt(2)
    v_mfma_f32_32x32x16_bf16 v[16:31], a[80:83], v[48:51], v[16:31]
    ds_read_b128 v[60:63], v9 offset:23552
    v_mfma_f32_32x32x16_bf16 v[32:47], v[48:51], a[224:227], v[32:47]
    s_waitcnt lgkmcnt(2)
    v_mfma_f32_32x32x16_bf16 v[16:31], a[84:87], v[52:55], v[16:31]
    ds_read_b128 v[48:51], v9 offset:24576
    v_mfma_f32_32x32x16_bf16 v[32:47], v[52:55], a[228:231], v[32:47]
    s_waitcnt lgkmcnt(2)
    v_mfma_f32_32x32x16_bf16 v[16:31], a[88:91], v[56:59], v[16:31]
    ds_read_b128 v[52:55], v9 offset:25600
    v_mfma_f32_32x32x16_bf16 v[32:47], v[56:59], a[232:235], v[32:47]
    s_waitcnt lgkmcnt(2)
    v_mfma_f32_32x32x16_bf16 v[16:31], a[92:95], v[60:63], v[16:31]
    ds_read_b128 v[56:59], v9 offset:26624
    v_mfma_f32_32x32x16_bf16 v[32:47], v[60:63], a[236:239], v[32:47]
    s_waitcnt lgkmcnt(2)
    v_mfma_f32_32x32x16_bf16 v[16:31], a[96:99], v[48:51], v[16:31]
    ds_read_b128 v[60:63], v9 offset:27648
    v_mfma_f32_32x32x16_bf16 v[32:47], v[48:51], a[240:243], v[32:47]
    s_waitcnt lgkmcnt(2)
    v_mfma_f32_32x32x16_bf16 v[16:31], a[100:103], v[52:55], v[16:31]
    ds_read_b128 v[48:51], v9 offset:28672
    v_mfma_f32_32x32x16_bf16 v[32:47], v[52:55], a[244:247], v[32:47]
    s_waitcnt lgkmcnt(2)
    v_mfma_f32_32x32x16_bf16 v[16:31], a[104:107], v[56:59], v[16:31]
    ds_read_b128 v[52:55], v9 offset:29696
    v_mfma_f32_32x32x16_bf16 v[32:47], v[56:59], a[248:251], v[32:47]
    s_waitcnt lgkmcnt(2)
    v_mfma_f32_32x32x16_bf16 v[16:31], a[108:111], v[60:63], v[16:31]
    ds_read_b128 v[56:59], v9 offset:30720
    v_mfma_f32_32x32x16_bf16 v[32:47], v[60:63], a[252:255], v[32:47]
    s_waitcnt lgkmcnt(2)
    v_mfma_f32_32x32x16_bf16 v[16:31], a[112:115], v[48:51], v[16:31]
    ds_read_b128 v[60:63], v9 offset:31744
    v_mfma_f32_32x32x16_bf16 v[32:47], v[48:51], v[152:155], v[32:47]
    s_waitcnt lgkmcnt(2)
    v_mfma_f32_32x32x16_bf16 v[16:31], a[116:119], v[52:55], v[16:31]
    ds_read_b128 v[48:51], v9 offset:32768
    v_mfma_f32_32x32x16_bf16 v[32:47], v[52:55], v[156:159], v[32:47]
    s_waitcnt lgkmcnt(2)
    v_mfma_f32_32x32x16_bf16 v[16:31], a[120:123], v[56:59], v[16:31]
    ds_read_b128 v[52:55], v9 offset:33792
    v_mfma_f32_32x32x16_bf16 v[32:47], v[56:59], v[160:163], v[32:47]
    s_waitcnt lgkmcnt(2)
    v_mfma_f32_32x32x16_bf16 v[16:31], a[124:127], v[60:63], v[16:31]
    v_cmp_eq_u32 s[76:77], 1, v2
    v_cmp_eq_u32 vcc, 2, v2
    s_cmp_eq_u64 s[76:77], -1
    s_cselect_b32 s38, 1, 0
    ds_read_b128 v[56:59], v9 offset:34816
    v_mfma_f32_32x32x16_bf16 v[32:47], v[60:63], v[164:167], v[32:47]
    s_cmp_lg_u32 s38, 0
    s_cselect_b64 exec, 1, 0
    v_mov_b32 v15, s32
    ds_write_b32 v184, v15
    v_mov_b32 v2, 2
    s_mov_b64 exec, -1
    s_waitcnt lgkmcnt(3)
    v_mfma_f32_32x32x16_bf16 v[16:31], a[128:131], v[48:51], v[16:31]
    s_add_u32 s32, s32, s38
    s_mul_i32 s38, s38, 22528
    s_add_u32 s33, s33, s38
    ds_read_b128 v[60:63], v9 offset:35840
    v_mfma_f32_32x32x16_bf16 v[32:47], v[48:51], v[168:171], v[32:47]
    s_cmp_eq_u64 vcc, 0
    s_cselect_b32 s38, s32, 0x7fff
    s_waitcnt lgkmcnt(3)
    v_mfma_f32_32x32x16_bf16 v[16:31], a[132:135], v[52:55], v[16:31]
    s_cmp_le_u32 s38, s39
    s_cselect_b64 exec, -1, 0
    v_mov_b32 v2, 2
    buffer_load_dword v2, v1, s[8:11], s33 offen sc1
    s_mov_b64 exec, -1
    v_mfma_f32_32x32x16_bf16 v[32:47], v[52:55], v[172:175], v[32:47]
    s_waitcnt lgkmcnt(2)
    v_mfma_f32_32x32x16_bf16 v[16:31], a[136:139], v[56:59], v[16:31]
    v_mfma_f32_32x32x16_bf16 v[32:47], v[56:59], v[176:179], v[32:47]
    s_waitcnt lgkmcnt(0)
    v_mfma_f32_32x32x16_bf16 v[16:31], a[140:143], v[60:63], v[16:31]
    v_mfma_f32_32x32x16_bf16 v[32:47], v[60:63], v[180:183], v[32:47]
    s_add_u32 s51, s46, 16777216
    s_nop 2
    v_pk_fma_f32 v[16:17], v[16:17], v[148:149], v[100:101] op_sel_hi:[1,0,1] neg_lo:[0,0,1] neg_hi:[0,0,1]
    v_pk_fma_f32 v[18:19], v[18:19], v[148:149], v[102:103] op_sel_hi:[1,0,1] neg_lo:[0,0,1] neg_hi:[0,0,1]
    v_pk_fma_f32 v[20:21], v[20:21], v[148:149], v[104:105] op_sel_hi:[1,0,1] neg_lo:[0,0,1] neg_hi:[0,0,1]
    v_pk_fma_f32 v[22:23], v[22:23], v[148:149], v[106:107] op_sel_hi:[1,0,1] neg_lo:[0,0,1] neg_hi:[0,0,1]
    v_pk_fma_f32 v[24:25], v[24:25], v[148:149], v[108:109] op_sel_hi:[1,0,1] neg_lo:[0,0,1] neg_hi:[0,0,1]
    v_pk_fma_f32 v[26:27], v[26:27], v[148:149], v[110:111] op_sel_hi:[1,0,1] neg_lo:[0,0,1] neg_hi:[0,0,1]
    v_pk_fma_f32 v[28:29], v[28:29], v[148:149], v[112:113] op_sel_hi:[1,0,1] neg_lo:[0,0,1] neg_hi:[0,0,1]
    v_pk_fma_f32 v[30:31], v[30:31], v[148:149], v[114:115] op_sel_hi:[1,0,1] neg_lo:[0,0,1] neg_hi:[0,0,1]
    v_cvt_pk_bf16_f32 v188, v16, v24
    v_cvt_pk_bf16_f32 v189, v17, v25
    v_cvt_pk_bf16_f32 v190, v18, v26
    v_cvt_pk_bf16_f32 v191, v19, v27
    buffer_store_dwordx4 v[188:191], v14, s[8:11], s46 offen offset:0 sc1
    v_cvt_pk_bf16_f32 v192, v20, v28
    v_cvt_pk_bf16_f32 v193, v21, v29
    v_cvt_pk_bf16_f32 v194, v22, v30
    v_cvt_pk_bf16_f32 v195, v23, v31
    buffer_store_dwordx4 v[192:195], v14, s[8:11], s46 offen offset:512 sc1
    v_pk_fma_f32 v[32:33], v[32:33], v[116:117], v[132:133] neg_lo:[0,0,1] neg_hi:[0,0,1]
    v_pk_fma_f32 v[34:35], v[34:35], v[118:119], v[134:135] neg_lo:[0,0,1] neg_hi:[0,0,1]
    v_pk_fma_f32 v[36:37], v[36:37], v[120:121], v[136:137] neg_lo:[0,0,1] neg_hi:[0,0,1]
    v_pk_fma_f32 v[38:39], v[38:39], v[122:123], v[138:139] neg_lo:[0,0,1] neg_hi:[0,0,1]
    v_pk_fma_f32 v[40:41], v[40:41], v[124:125], v[140:141] neg_lo:[0,0,1] neg_hi:[0,0,1]
    v_pk_fma_f32 v[42:43], v[42:43], v[126:127], v[142:143] neg_lo:[0,0,1] neg_hi:[0,0,1]
    v_pk_fma_f32 v[44:45], v[44:45], v[128:129], v[144:145] neg_lo:[0,0,1] neg_hi:[0,0,1]
    v_pk_fma_f32 v[46:47], v[46:47], v[130:131], v[146:147] neg_lo:[0,0,1] neg_hi:[0,0,1]
    v_cvt_pk_bf16_f32 v196, v32, v33
    v_cvt_pk_bf16_f32 v197, v34, v35
    v_cvt_pk_bf16_f32 v198, v40, v41
    v_cvt_pk_bf16_f32 v199, v42, v43
    buffer_store_dwordx4 v[196:199], v14, s[8:11], s51 offen offset:0 sc1
    v_cvt_pk_bf16_f32 v200, v36, v37
    v_cvt_pk_bf16_f32 v201, v38, v39
    v_cvt_pk_bf16_f32 v202, v44, v45
    v_cvt_pk_bf16_f32 v203, v46, v47
    buffer_store_dwordx4 v[200:203], v14, s[8:11], s51 offen offset:512 sc1
    s_mul_i32 s43, s57, 22528
    s_add_u32 s43, s43, s49
    s_branch LpKV_head
LpKV_f_4:
    v_mfma_f32_32x32x16_bf16 v[16:31], a[76:79], v[60:63], v[16:31]
    s_add_u32 m0, s59, 0
    s_add_u32 s47, s41, 0
    buffer_load_dwordx4 v0, s[8:11], s47 offen offset:0 lds
    ds_read_b128 v[56:59], v9 offset:22528
    v_mfma_f32_32x32x16_bf16 v[32:47], v[60:63], a[220:223], v[32:47]
    s_waitcnt lgkmcnt(2)
    v_mfma_f32_32x32x16_bf16 v[16:31], a[80:83], v[48:51], v[16:31]
    buffer_load_dwordx4 v0, s[8:11], s47 offen offset:1024 lds
    ds_read_b128 v[60:63], v9 offset:23552
    v_mfma_f32_32x32x16_bf16 v[32:47], v[48:51], a[224:227], v[32:47]
    s_waitcnt lgkmcnt(2)
    v_mfma_f32_32x32x16_bf16 v[16:31], a[84:87], v[52:55], v[16:31]
    buffer_load_dwordx4 v0, s[8:11], s47 offen offset:2048 lds
    ds_read_b128 v[48:51], v9 offset:24576
    v_mfma_f32_32x32x16_bf16 v[32:47], v[52:55], a[228:231], v[32:47]
    s_waitcnt lgkmcnt(2)
    v_mfma_f32_32x32x16_bf16 v[16:31], a[88:91], v[56:59], v[16:31]
    buffer_load_dwordx4 v0, s[8:11], s47 offen offset:3072 lds
    ds_read_b128 v[52:55], v9 offset:25600
    v_mfma_f32_32x32x16_bf16 v[32:47], v[56:59], a[232:235], v[32:47]
    s_waitcnt lgkmcnt(2)
    v_mfma_f32_32x32x16_bf16 v[16:31], a[92:95], v[60:63], v[16:31]
    s_add_u32 m0, s59, 4096
    s_add_u32 s47, s41, 4096
    buffer_load_dwordx4 v0, s[8:11], s47 offen offset:0 lds
    ds_read_b128 v[56:59], v9 offset:26624
    v_mfma_f32_32x32x16_bf16 v[32:47], v[60:63], a[236:239], v[32:47]
    s_waitcnt lgkmcnt(2)
    v_mfma_f32_32x32x16_bf16 v[16:31], a[96:99], v[48:51], v[16:31]
    buffer_load_dwordx4 v0, s[8:11], s47 offen offset:1024 lds
    ds_read_b128 v[60:63], v9 offset:27648
    v_mfma_f32_32x32x16_bf16 v[32:47], v[48:51], a[240:243], v[32:47]
    s_waitcnt lgkmcnt(2)
    v_mfma_f32_32x32x16_bf16 v[16:31], a[100:103], v[52:55], v[16:31]
    buffer_load_dwordx4 v0, s[8:11], s47 offen offset:2048 lds
    ds_read_b128 v[48:51], v9 offset:28672
    v_mfma_f32_32x32x16_bf16 v[32:47], v[52:55], a[244:247], v[32:47]
    s_waitcnt lgkmcnt(2)
    v_mfma_f32_32x32x16_bf16 v[16:31], a[104:107], v[56:59], v[16:31]
    buffer_load_dwordx4 v0, s[8:11], s47 offen offset:3072 lds
    ds_read_b128 v[52:55], v9 offset:29696
    v_mfma_f32_32x32x16_bf16 v[32:47], v[56:59], a[248:251], v[32:47]
    s_waitcnt lgkmcnt(2)
    v_mfma_f32_32x32x16_bf16 v[16:31], a[108:111], v[60:63], v[16:31]
    s_add_u32 m0, s59, 8192
    s_add_u32 s47, s41, 8192
    buffer_load_dwordx4 v0, s[8:11], s47 offen offset:0 lds
    ds_read_b128 v[56:59], v9 offset:30720
    v_mfma_f32_32x32x16_bf16 v[32:47], v[60:63], a[252:255], v[32:47]
    s_waitcnt lgkmcnt(2)
    v_mfma_f32_32x32x16_bf16 v[16:31], a[112:115], v[48:51], v[16:31]
    s_mul_i32 s48, s36, 786432
    s_mul_i32 s18, s37, 6144
    s_add_u32 s48, s48, s18
    s_add_u32 s48, s48, 16125952
    s_add_u32 m0, s66, 4096
    s_nop 0
    buffer_load_dwordx4 v0, s[8:11], s48 offen lds
    ds_read_b128 v[60:63], v9 offset:31744
    v_mfma_f32_32x32x16_bf16 v[32:47], v[48:51], v[152:155], v[32:47]
    s_waitcnt lgkmcnt(2)
    v_mfma_f32_32x32x16_bf16 v[16:31], a[116:119], v[52:55], v[16:31]
    s_add_u32 m0, s66, s67
    s_sub_u32 s48, s48, 4096
    s_add_u32 s48, s48, s67
    buffer_load_dwordx4 v0, s[8:11], s48 offen lds
    ds_read_b128 v[48:51], v9 offset:32768
    v_mfma_f32_32x32x16_bf16 v[32:47], v[52:55], v[156:159], v[32:47]
    s_waitcnt lgkmcnt(2)
    v_mfma_f32_32x32x16_bf16 v[16:31], a[120:123], v[56:59], v[16:31]
    ds_read_b128 v[52:55], v9 offset:33792
    v_mfma_f32_32x32x16_bf16 v[32:47], v[56:59], v[160:163], v[32:47]
    s_waitcnt lgkmcnt(2)
    v_mfma_f32_32x32x16_bf16 v[16:31], a[124:127], v[60:63], v[16:31]
    v_cmp_eq_u32 s[76:77], 1, v2
    v_cmp_eq_u32 vcc, 2, v2
    s_cmp_eq_u64 s[76:77], -1
    s_cselect_b32 s38, 1, 0
    ds_read_b128 v[56:59], v9 offset:34816
    v_mfma_f32_32x32x16_bf16 v[32:47], v[60:63], v[164:167], v[32:47]
    s_cmp_lg_u32 s38, 0
    s_cselect_b64 exec, 1, 0
    v_mov_b32 v15, s32
    ds_write_b32 v184, v15
    v_mov_b32 v2, 2
    s_mov_b64 exec, -1
    s_waitcnt lgkmcnt(3)
    v_mfma_f32_32x32x16_bf16 v[16:31], a[128:131], v[48:51], v[16:31]
    s_add_u32 s32, s32, s38
    s_mul_i32 s38, s38, 22528
    s_add_u32 s33, s33, s38
    ds_read_b128 v[60:63], v9 offset:35840
    v_mfma_f32_32x32x16_bf16 v[32:47], v[48:51], v[168:171], v[32:47]
    s_cmp_eq_u64 vcc, 0
    s_cselect_b32 s38, s32, 0x7fff
    s_waitcnt lgkmcnt(3)
    v_mfma_f32_32x32x16_bf16 v[16:31], a[132:135], v[52:55], v[16:31]
    s_cmp_le_u32 s38, s39
    s_cselect_b64 exec, -1, 0
    v_mov_b32 v2, 2
    buffer_load_dword v2, v1, s[8:11], s33 offen sc1
    s_mov_b64 exec, -1
    v_mfma_f32_32x32x16_bf16 v[32:47], v[52:55], v[172:175], v[32:47]
    s_waitcnt lgkmcnt(2)
    v_mfma_f32_32x32x16_bf16 v[16:31], a[136:139], v[56:59], v[16:31]
    v_mfma_f32_32x32x16_bf16 v[32:47], v[56:59], v[176:179], v[32:47]
    s_waitcnt lgkmcnt(0)
    v_mfma_f32_32x32x16_bf16 v[16:31], a[140:143], v[60:63], v[16:31]
    v_mfma_f32_32x32x16_bf16 v[32:47], v[60:63], v[180:183], v[32:47]
    s_add_u32 s51, s46, 16777216
    s_nop 2
    v_pk_fma_f32 v[16:17], v[16:17], v[148:149], v[100:101] op_sel_hi:[1,0,1] neg_lo:[0,0,1] neg_hi:[0,0,1]
    v_pk_fma_f32 v[18:19], v[18:19], v[148:149], v[102:103] op_sel_hi:[1,0,1] neg_lo:[0,0,1] neg_hi:[0,0,1]
    v_pk_fma_f32 v[20:21], v[20:21], v[148:149], v[104:105] op_sel_hi:[1,0,1] neg_lo:[0,0,1] neg_hi:[0,0,1]
    v_pk_fma_f32 v[22:23], v[22:23], v[148:149], v[106:107] op_sel_hi:[1,0,1] neg_lo:[0,0,1] neg_hi:[0,0,1]
    v_pk_fma_f32 v[24:25], v[24:25], v[148:149], v[108:109] op_sel_hi:[1,0,1] neg_lo:[0,0,1] neg_hi:[0,0,1]
    v_pk_fma_f32 v[26:27], v[26:27], v[148:149], v[110:111] op_sel_hi:[1,0,1] neg_lo:[0,0,1] neg_hi:[0,0,1]
    v_pk_fma_f32 v[28:29], v[28:29], v[148:149], v[112:113] op_sel_hi:[1,0,1] neg_lo:[0,0,1] neg_hi:[0,0,1]
    v_pk_fma_f32 v[30:31], v[30:31], v[148:149], v[114:115] op_sel_hi:[1,0,1] neg_lo:[0,0,1] neg_hi:[0,0,1]
    v_cvt_pk_bf16_f32 v188, v16, v24
    v_cvt_pk_bf16_f32 v189, v17, v25
    v_cvt_pk_bf16_f32 v190, v18, v26
    v_cvt_pk_bf16_f32 v191, v19, v27
    buffer_store_dwordx4 v[188:191], v14, s[8:11], s46 offen offset:0 sc1
    v_cvt_pk_bf16_f32 v192, v20, v28
    v_cvt_pk_bf16_f32 v193, v21, v29
    v_cvt_pk_bf16_f32 v194, v22, v30
    v_cvt_pk_bf16_f32 v195, v23, v31
    buffer_store_dwordx4 v[192:195], v14, s[8:11], s46 offen offset:512 sc1
    v_pk_fma_f32 v[32:33], v[32:33], v[116:117], v[132:133] neg_lo:[0,0,1] neg_hi:[0,0,1]
    v_pk_fma_f32 v[34:35], v[34:35], v[118:119], v[134:135] neg_lo:[0,0,1] neg_hi:[0,0,1]
    v_pk_fma_f32 v[36:37], v[36:37], v[120:121], v[136:137] neg_lo:[0,0,1] neg_hi:[0,0,1]
    v_pk_fma_f32 v[38:39], v[38:39], v[122:123], v[138:139] neg_lo:[0,0,1] neg_hi:[0,0,1]
    v_pk_fma_f32 v[40:41], v[40:41], v[124:125], v[140:141] neg_lo:[0,0,1] neg_hi:[0,0,1]
    v_pk_fma_f32 v[42:43], v[42:43], v[126:127], v[142:143] neg_lo:[0,0,1] neg_hi:[0,0,1]
    v_pk_fma_f32 v[44:45], v[44:45], v[128:129], v[144:145] neg_lo:[0,0,1] neg_hi:[0,0,1]
    v_pk_fma_f32 v[46:47], v[46:47], v[130:131], v[146:147] neg_lo:[0,0,1] neg_hi:[0,0,1]
    v_cvt_pk_bf16_f32 v196, v32, v33
    v_cvt_pk_bf16_f32 v197, v34, v35
    v_cvt_pk_bf16_f32 v198, v40, v41
    v_cvt_pk_bf16_f32 v199, v42, v43
    buffer_store_dwordx4 v[196:199], v14, s[8:11], s51 offen offset:0 sc1
    v_cvt_pk_bf16_f32 v200, v36, v37
    v_cvt_pk_bf16_f32 v201, v38, v39
    v_cvt_pk_bf16_f32 v202, v44, v45
    v_cvt_pk_bf16_f32 v203, v46, v47
    buffer_store_dwordx4 v[200:203], v14, s[8:11], s51 offen offset:512 sc1
    s_mul_i32 s43, s57, 22528
    s_add_u32 s43, s43, s49
    s_branch LpKV_head
LpKV_none:
    ds_read_b32 v15, v184
    s_waitcnt lgkmcnt(0)
    v_readfirstlane_b32 s17, v15
    s_nop 0
    s_cmp_lt_i32 s17, s37
    s_cbranch_scc1 LpKV_nopost
    s_add_u32 m0, s59, 0
    s_add_u32 s47, s41, 0
    buffer_load_dwordx4 v0, s[8:11], s47 offen offset:0 lds
    buffer_load_dwordx4 v0, s[8:11], s47 offen offset:1024 lds
    buffer_load_dwordx4 v0, s[8:11], s47 offen offset:2048 lds
    buffer_load_dwordx4 v0, s[8:11], s47 offen offset:3072 lds
    s_add_u32 m0, s59, 4096
    s_add_u32 s47, s41, 4096
    buffer_load_dwordx4 v0, s[8:11], s47 offen offset:0 lds
    buffer_load_dwordx4 v0, s[8:11], s47 offen offset:1024 lds
    buffer_load_dwordx4 v0, s[8:11], s47 offen offset:2048 lds
    buffer_load_dwordx4 v0, s[8:11], s47 offen offset:3072 lds
    s_add_u32 m0, s59, 8192
    s_add_u32 s47, s41, 8192
    buffer_load_dwordx4 v0, s[8:11], s47 offen offset:0 lds
    s_mul_i32 s48, s36, 786432
    s_mul_i32 s18, s37, 6144
    s_add_u32 s48, s48, s18
    s_add_u32 s48, s48, 16125952
    s_add_u32 m0, s66, 4096
    s_nop 0
    buffer_load_dwordx4 v0, s[8:11], s48 offen lds
    s_add_u32 m0, s66, s67
    s_sub_u32 s48, s48, 4096
    s_add_u32 s48, s48, s67
    buffer_load_dwordx4 v0, s[8:11], s48 offen lds
    s_waitcnt vmcnt(11)
    s_cmp_lg_u32 s43, 0
    s_cselect_b64 exec, 3, 0
    buffer_store_dword v3, v185, s[8:11], s43 offen sc1
    s_mov_b64 exec, -1
    s_mov_b32 s43, 0
    s_waitcnt vmcnt(1) lgkmcnt(0)
    s_branch LpKV_head2
LpKV_nopost:
    s_waitcnt vmcnt(0)
    s_cmp_lg_u32 s43, 0
    s_cselect_b64 exec, 3, 0
    buffer_store_dword v3, v185, s[8:11], s43 offen sc1
    s_mov_b64 exec, -1
    s_mov_b32 s43, 0
    s_cmp_ge_u32 s37, 64
    s_cbranch_scc1 LpKV_end
LpKV_wait:
    s_mov_b32 s16, 0
    s_cmp_lg_u32 s14, 0
    s_cbranch_scc1 LpKV_wl
LpKV_wp:
    buffer_load_dword v2, v1, s[8:11], s60 offen sc1
    s_add_u32 s16, s16, 1
    s_cmp_gt_u32 s16, 100000
    s_cbranch_scc1 LpKV_giveup
    s_waitcnt vmcnt(0)
    v_cmp_eq_u32 vcc, 0, v2
    s_nop 0
    s_cbranch_vccz LpKV_wok
    s_sleep 4
    s_branch LpKV_wp
LpKV_giveup:
    v_mov_b32 v5, -2
    ds_write_b32 v184, v5
    s_waitcnt lgkmcnt(0)
    s_branch L_role_p_abort
LpKV_wok:
    v_mov_b32 v5, s37
    ds_write_b32 v184, v5
    s_branch LpKV_go
LpKV_wl:
    ds_read_b32 v15, v184
    s_add_u32 s16, s16, 1
    s_cmp_gt_u32 s16, 1600000
    s_cbranch_scc1 L_role_p_abort
    s_waitcnt lgkmcnt(0)
    v_readfirstlane_b32 s17, v15
    s_nop 0
    s_cmp_eq_u32 s17, -2
    s_cbranch_scc1 L_role_p_abort
    s_cmp_ge_i32 s17, s37
    s_cbranch_scc1 LpKV_go
    s_sleep 1
    s_branch LpKV_wl
LpKV_go:
    s_add_u32 m0, s59, 0
    s_add_u32 s47, s41, 0
    buffer_load_dwordx4 v0, s[8:11], s47 offen offset:0 lds
    buffer_load_dwordx4 v0, s[8:11], s47 offen offset:1024 lds
    buffer_load_dwordx4 v0, s[8:11], s47 offen offset:2048 lds
    buffer_load_dwordx4 v0, s[8:11], s47 offen offset:3072 lds
    s_add_u32 m0, s59, 4096
    s_add_u32 s47, s41, 4096
    buffer_load_dwordx4 v0, s[8:11], s47 offen offset:0 lds
    buffer_load_dwordx4 v0, s[8:11], s47 offen offset:1024 lds
    buffer_load_dwordx4 v0, s[8:11], s47 offen offset:2048 lds
    buffer_load_dwordx4 v0, s[8:11], s47 offen offset:3072 lds
    s_add_u32 m0, s59, 8192
    s_add_u32 s47, s41, 8192
    buffer_load_dwordx4 v0, s[8:11], s47 offen offset:0 lds
    s_mul_i32 s48, s36, 786432
    s_mul_i32 s18, s37, 6144
    s_add_u32 s48, s48, s18
    s_add_u32 s48, s48, 16125952
    s_add_u32 m0, s66, 4096
    s_nop 0
    buffer_load_dwordx4 v0, s[8:11], s48 offen lds
    s_add_u32 m0, s66, s67
    s_sub_u32 s48, s48, 4096
    s_add_u32 s48, s48, s67
    buffer_load_dwordx4 v0, s[8:11], s48 offen lds
    s_waitcnt vmcnt(0) lgkmcnt(0)
    s_branch LpKV_head2
LpKV_end:
    s_branch L_role_p_exit
L_role_p_abort:
    s_waitcnt lgkmcnt(0)
    s_mov_b64 exec, -1
    v_mov_b32 v0, 60
    s_lshl_b32 s5, s3, 8
    s_or_b32 s5, s5, s4
    s_or_b32 s5, s5, 0x10000
    v_mov_b32 v1, s5
    global_store_dword v0, v1, s[12:13]
    s_endpgm
L_role_p_exit:
    s_endpgm
.p2align 6
L_role_awo:
    v_and_b32 v5, 63, v0
    v_lshlrev_b32 v0, 4, v5
    v_and_b32 v7, 15, v5
    v_lshrrev_b32 v8, 4, v5
    v_min_u32 v1, 63, v5
    v_lshrrev_b32 v6, 2, v1
    v_and_b32 v1, 3, v1
    v_lshlrev_b32 v1, 2, v1
    v_lshl_add_u32 v1, v6, 7, v1
    v_mov_b32 v3, 1
    v_mov_b32 v4, 0
    s_mov_b32 s44, 0x05040100
    s_mov_b32 s45, 0x07060302
    s_load_dwordx2 s[20:21], s[0:1], 16
    s_mov_b32 s22, 663552
    s_mov_b32 s23, 0x00020000
    s_waitcnt lgkmcnt(0)
    s_and_b32 s21, s21, 0xffff
    s_cmp_ge_u32 s15, 3
    s_cselect_b32 s63, 1, 0
    s_cselect_b32 s17, 3, 0
    s_sub_u32 s15, s15, s17
    s_lshl_b32 s50, s15, 2
    s_add_u32 s50, s50, s14
    s_cmp_eq_u32 s63, 0
    s_cbranch_scc1 Lao_gate_ng
    s_cmp_lg_u32 s14, 0
    s_cbranch_scc1 Lao_gate_d
    v_mov_b32 v5, 48
    s_mov_b32 s16, 0
Lao_gate:
    global_load_dword v6, v5, s[12:13] sc1
    s_add_u32 s16, s16, 1
    s_cmp_gt_u32 s16, 100000
    s_cbranch_scc1 L_role_awo_abort
    s_waitcnt vmcnt(0)
    v_cmp_gt_u32 vcc, 32, v6
    s_nop 0
    s_cbranch_vccz Lao_gate_d
    s_sleep 100
    s_branch Lao_gate
Lao_gate_d:
    s_barrier
Lao_gate_ng:
    v_lshrrev_b32 v5, 7, v0
    v_and_b32 v6, 0x70, v0
    v_mul_u32_u24 v16, 1152, v5
    v_add_u32 v16, v16, v6
    v_lshrrev_b32 v17, 1, v5
    v_mul_u32_u24 v17, 18, v17
    v_and_b32 v5, 1, v5
    v_add_u32 v17, v17, v5
    v_add_u32 v17, 16, v17
    v_mul_u32_u24 v17, 1152, v17
    v_add_u32 v17, v17, v6
    v_lshrrev_b32 v5, 2, v7
    v_lshl_add_u32 v5, v8, 3, v5
    v_lshlrev_b32 v18, 7, v5
    v_and_b32 v5, 3, v7
    v_lshl_add_u32 v19, v5, 3, v18
    v_lshl_add_u32 v18, v5, 4, v18
    s_lshl_b32 s46, s14, 15
    v_add_u32 v18, s46, v18
    v_add_u32 v19, s46, v19
    s_mul_i32 s49, s50, 96
    s_add_u32 m0, s46, 0
    s_add_u32 s17, s49, 0
    buffer_load_dwordx4 v16, s[20:23], s17 offen lds
    s_add_u32 m0, s46, 1024
    s_add_u32 s17, s49, 9216
    buffer_load_dwordx4 v16, s[20:23], s17 offen lds
    s_add_u32 m0, s46, 2048
    s_add_u32 s17, s49, 20736
    buffer_load_dwordx4 v16, s[20:23], s17 offen lds
    s_add_u32 m0, s46, 3072
    s_add_u32 s17, s49, 29952
    buffer_load_dwordx4 v16, s[20:23], s17 offen lds
    s_add_u32 m0, s46, 4096
    s_add_u32 s17, s49, 41472
    buffer_load_dwordx4 v16, s[20:23], s17 offen lds
    s_add_u32 m0, s46, 5120
    s_add_u32 s17, s49, 50688
    buffer_load_dwordx4 v16, s[20:23], s17 offen lds
    s_add_u32 m0, s46, 6144
    s_add_u32 s17, s49, 62208
    buffer_load_dwordx4 v16, s[20:23], s17 offen lds
    s_add_u32 m0, s46, 7168
    s_add_u32 s17, s49, 71424
    buffer_load_dwordx4 v16, s[20:23], s17 offen lds
    s_add_u32 m0, s46, 8192
    s_add_u32 s17, s49, 82944
    buffer_load_dwordx4 v16, s[20:23], s17 offen lds
    s_add_u32 m0, s46, 9216
    s_add_u32 s17, s49, 92160
    buffer_load_dwordx4 v16, s[20:23], s17 offen lds
    s_add_u32 m0, s46, 10240
    s_add_u32 s17, s49, 103680
    buffer_load_dwordx4 v16, s[20:23], s17 offen lds
    s_add_u32 m0, s46, 11264
    s_add_u32 s17, s49, 112896
    buffer_load_dwordx4 v16, s[20:23], s17 offen lds
    s_add_u32 m0, s46, 12288
    s_add_u32 s17, s49, 124416
    buffer_load_dwordx4 v16, s[20:23], s17 offen lds
    s_add_u32 m0, s46, 13312
    s_add_u32 s17, s49, 133632
    buffer_load_dwordx4 v16, s[20:23], s17 offen lds
    s_add_u32 m0, s46, 14336
    s_add_u32 s17, s49, 145152
    buffer_load_dwordx4 v16, s[20:23], s17 offen lds
    s_add_u32 m0, s46, 15360
    s_add_u32 s17, s49, 154368
    buffer_load_dwordx4 v16, s[20:23], s17 offen lds
    s_add_u32 m0, s46, 16384
    s_add_u32 s17, s49, 165888
    buffer_load_dwordx4 v16, s[20:23], s17 offen lds
    s_add_u32 m0, s46, 17408
    s_add_u32 s17, s49, 175104
    buffer_load_dwordx4 v16, s[20:23], s17 offen lds
    s_add_u32 m0, s46, 18432
    s_add_u32 s17, s49, 186624
    buffer_load_dwordx4 v16, s[20:23], s17 offen lds
    s_add_u32 m0, s46, 19456
    s_add_u32 s17, s49, 195840
    buffer_load_dwordx4 v16, s[20:23], s17 offen lds
    s_add_u32 m0, s46, 20480
    s_add_u32 s17, s49, 207360
    buffer_load_dwordx4 v16, s[20:23], s17 offen lds
    s_add_u32 m0, s46, 21504
    s_add_u32 s17, s49, 216576
    buffer_load_dwordx4 v16, s[20:23], s17 offen lds
    s_add_u32 m0, s46, 22528
    s_add_u32 s17, s49, 228096
    buffer_load_dwordx4 v16, s[20:23], s17 offen lds
    s_add_u32 m0, s46, 23552
    s_add_u32 s17, s49, 237312
    buffer_load_dwordx4 v16, s[20:23], s17 offen lds
    s_add_u32 m0, s46, 24576
    s_add_u32 s17, s49, 248832
    buffer_load_dwordx4 v16, s[20:23], s17 offen lds
    s_add_u32 m0, s46, 25600
    s_add_u32 s17, s49, 258048
    buffer_load_dwordx4 v16, s[20:23], s17 offen lds
    s_add_u32 m0, s46, 26624
    s_add_u32 s17, s49, 269568
    buffer_load_dwordx4 v16, s[20:23], s17 offen lds
    s_add_u32 m0, s46, 27648
    s_add_u32 s17, s49, 278784
    buffer_load_dwordx4 v16, s[20:23], s17 offen lds
    s_add_u32 m0, s46, 28672
    s_add_u32 s17, s49, 290304
    buffer_load_dwordx4 v16, s[20:23], s17 offen lds
    s_add_u32 m0, s46, 29696
    s_add_u32 s17, s49, 299520
    buffer_load_dwordx4 v16, s[20:23], s17 offen lds
    s_add_u32 m0, s46, 30720
    s_add_u32 s17, s49, 311040
    buffer_load_dwordx4 v16, s[20:23], s17 offen lds
    s_add_u32 m0, s46, 31744
    s_add_u32 s17, s49, 320256
    buffer_load_dwordx4 v16, s[20:23], s17 offen lds
    s_waitcnt vmcnt(28)
    ds_read_b64_tr_b16 a[0:1], v18 offset:0
    ds_read_b64_tr_b16 a[2:3], v18 offset:512
    ds_read_b64_tr_b16 a[4:5], v18 offset:8
    ds_read_b64_tr_b16 a[6:7], v18 offset:520
    ds_read_b64_tr_b16 a[8:9], v19 offset:64
    ds_read_b64_tr_b16 a[10:11], v19 offset:576
    s_waitcnt lgkmcnt(0)
    s_add_u32 m0, s46, 0
    s_add_u32 s17, s49, 331776
    buffer_load_dwordx4 v16, s[20:23], s17 offen lds
    s_add_u32 m0, s46, 1024
    s_add_u32 s17, s49, 340992
    buffer_load_dwordx4 v16, s[20:23], s17 offen lds
    s_add_u32 m0, s46, 2048
    s_add_u32 s17, s49, 352512
    buffer_load_dwordx4 v16, s[20:23], s17 offen lds
    s_add_u32 m0, s46, 3072
    s_add_u32 s17, s49, 361728
    buffer_load_dwordx4 v16, s[20:23], s17 offen lds
    s_waitcnt vmcnt(28)
    ds_read_b64_tr_b16 a[12:13], v18 offset:4096
    ds_read_b64_tr_b16 a[14:15], v18 offset:4608
    ds_read_b64_tr_b16 a[16:17], v18 offset:4104
    ds_read_b64_tr_b16 a[18:19], v18 offset:4616
    ds_read_b64_tr_b16 a[20:21], v19 offset:4160
    ds_read_b64_tr_b16 a[22:23], v19 offset:4672
    s_waitcnt lgkmcnt(0)
    s_add_u32 m0, s46, 4096
    s_add_u32 s17, s49, 373248
    buffer_load_dwordx4 v16, s[20:23], s17 offen lds
    s_add_u32 m0, s46, 5120
    s_add_u32 s17, s49, 382464
    buffer_load_dwordx4 v16, s[20:23], s17 offen lds
    s_add_u32 m0, s46, 6144
    s_add_u32 s17, s49, 393984
    buffer_load_dwordx4 v16, s[20:23], s17 offen lds
    s_add_u32 m0, s46, 7168
    s_add_u32 s17, s49, 403200
    buffer_load_dwordx4 v16, s[20:23], s17 offen lds
    s_waitcnt vmcnt(28)
    ds_read_b64_tr_b16 a[24:25], v18 offset:8192
    ds_read_b64_tr_b16 a[26:27], v18 offset:8704
    ds_read_b64_tr_b16 a[28:29], v18 offset:8200
    ds_read_b64_tr_b16 a[30:31], v18 offset:8712
    ds_read_b64_tr_b16 a[32:33], v19 offset:8256
    ds_read_b64_tr_b16 a[34:35], v19 offset:8768
    s_waitcnt lgkmcnt(0)
    s_add_u32 m0, s46, 8192
    s_add_u32 s17, s49, 414720
    buffer_load_dwordx4 v16, s[20:23], s17 offen lds
    s_add_u32 m0, s46, 9216
    s_add_u32 s17, s49, 423936
    buffer_load_dwordx4 v16, s[20:23], s17 offen lds
    s_add_u32 m0, s46, 10240
    s_add_u32 s17, s49, 435456
    buffer_load_dwordx4 v16, s[20:23], s17 offen lds
    s_add_u32 m0, s46, 11264
    s_add_u32 s17, s49, 444672
    buffer_load_dwordx4 v16, s[20:23], s17 offen lds
    s_waitcnt vmcnt(28)
    ds_read_b64_tr_b16 a[36:37], v18 offset:12288
    ds_read_b64_tr_b16 a[38:39], v18 offset:12800
    ds_read_b64_tr_b16 a[40:41], v18 offset:12296
    ds_read_b64_tr_b16 a[42:43], v18 offset:12808
    ds_read_b64_tr_b16 a[44:45], v19 offset:12352
    ds_read_b64_tr_b16 a[46:47], v19 offset:12864
    s_waitcnt lgkmcnt(0)
    s_add_u32 m0, s46, 12288
    s_add_u32 s17, s49, 456192
    buffer_load_dwordx4 v16, s[20:23], s17 offen lds
    s_add_u32 m0, s46, 13312
    s_add_u32 s17, s49, 465408
    buffer_load_dwordx4 v16, s[20:23], s17 offen lds
    s_add_u32 m0, s46, 14336
    s_add_u32 s17, s49, 476928
    buffer_load_dwordx4 v16, s[20:23], s17 offen lds
    s_add_u32 m0, s46, 15360
    s_add_u32 s17, s49, 486144
    buffer_load_dwordx4 v16, s[20:23], s17 offen lds
    s_waitcnt vmcnt(28)
    ds_read_b64_tr_b16 a[48:49], v18 offset:16384
    ds_read_b64_tr_b16 a[50:51], v18 offset:16896
    ds_read_b64_tr_b16 a[52:53], v18 offset:16392
    ds_read_b64_tr_b16 a[54:55], v18 offset:16904
    ds_read_b64_tr_b16 a[56:57], v19 offset:16448
    ds_read_b64_tr_b16 a[58:59], v19 offset:16960
    s_waitcnt lgkmcnt(0)
    s_add_u32 m0, s46, 16384
    s_add_u32 s17, s49, 497664
    buffer_load_dwordx4 v16, s[20:23], s17 offen lds
    s_add_u32 m0, s46, 17408
    s_add_u32 s17, s49, 506880
    buffer_load_dwordx4 v16, s[20:23], s17 offen lds
    s_add_u32 m0, s46, 18432
    s_add_u32 s17, s49, 518400
    buffer_load_dwordx4 v16, s[20:23], s17 offen lds
    s_add_u32 m0, s46, 19456
    s_add_u32 s17, s49, 527616
    buffer_load_dwordx4 v16, s[20:23], s17 offen lds
    s_waitcnt vmcnt(28)
    ds_read_b64_tr_b16 a[60:61], v18 offset:20480
    ds_read_b64_tr_b16 a[62:63], v18 offset:20992
    ds_read_b64_tr_b16 a[64:65], v18 offset:20488
    ds_read_b64_tr_b16 a[66:67], v18 offset:21000
    ds_read_b64_tr_b16 a[68:69], v19 offset:20544
    ds_read_b64_tr_b16 a[70:71], v19 offset:21056
    s_waitcnt lgkmcnt(0)
    s_add_u32 m0, s46, 20480
    s_add_u32 s17, s49, 539136
    buffer_load_dwordx4 v16, s[20:23], s17 offen lds
    s_add_u32 m0, s46, 21504
    s_add_u32 s17, s49, 548352
    buffer_load_dwordx4 v16, s[20:23], s17 offen lds
    s_add_u32 m0, s46, 22528
    s_add_u32 s17, s49, 559872
    buffer_load_dwordx4 v16, s[20:23], s17 offen lds
    s_add_u32 m0, s46, 23552
    s_add_u32 s17, s49, 569088
    buffer_load_dwordx4 v16, s[20:23], s17 offen lds
    s_waitcnt vmcnt(28)
    ds_read_b64_tr_b16 a[72:73], v18 offset:24576
    ds_read_b64_tr_b16 a[74:75], v18 offset:25088
    ds_read_b64_tr_b16 a[76:77], v18 offset:24584
    ds_read_b64_tr_b16 a[78:79], v18 offset:25096
    ds_read_b64_tr_b16 a[80:81], v19 offset:24640
    ds_read_b64_tr_b16 a[82:83], v19 offset:25152
    s_waitcnt lgkmcnt(0)
    s_add_u32 m0, s46, 24576
    s_add_u32 s17, s49, 580608
    buffer_load_dwordx4 v16, s[20:23], s17 offen lds
    s_add_u32 m0, s46, 25600
    s_add_u32 s17, s49, 589824
    buffer_load_dwordx4 v16, s[20:23], s17 offen lds
    s_add_u32 m0, s46, 26624
    s_add_u32 s17, s49, 601344
    buffer_load_dwordx4 v16, s[20:23], s17 offen lds
    s_add_u32 m0, s46, 27648
    s_add_u32 s17, s49, 610560
    buffer_load_dwordx4 v16, s[20:23], s17 offen lds
    s_waitcnt vmcnt(28)
    ds_read_b64_tr_b16 a[84:85], v18 offset:28672
    ds_read_b64_tr_b16 a[86:87], v18 offset:29184
    ds_read_b64_tr_b16 a[88:89], v18 offset:28680
    ds_read_b64_tr_b16 a[90:91], v18 offset:29192
    ds_read_b64_tr_b16 a[92:93], v19 offset:28736
    ds_read_b64_tr_b16 a[94:95], v19 offset:29248
    s_waitcnt lgkmcnt(0)
    s_add_u32 m0, s46, 28672
    s_add_u32 s17, s49, 622080
    buffer_load_dwordx4 v16, s[20:23], s17 offen lds
    s_add_u32 m0, s46, 29696
    s_add_u32 s17, s49, 631296
    buffer_load_dwordx4 v16, s[20:23], s17 offen lds
    s_add_u32 m0, s46, 30720
    s_add_u32 s17, s49, 642816
    buffer_load_dwordx4 v16, s[20:23], s17 offen lds
    s_add_u32 m0, s46, 31744
    s_add_u32 s17, s49, 652032
    buffer_load_dwordx4 v16, s[20:23], s17 offen lds
    s_waitcnt vmcnt(28)
    ds_read_b64_tr_b16 a[96:97], v18 offset:0
    ds_read_b64_tr_b16 a[98:99], v18 offset:512
    ds_read_b64_tr_b16 a[100:101], v18 offset:8
    ds_read_b64_tr_b16 a[102:103], v18 offset:520
    ds_read_b64_tr_b16 a[104:105], v19 offset:64
    ds_read_b64_tr_b16 a[106:107], v19 offset:576
    s_waitcnt lgkmcnt(0)
    s_add_u32 m0, s46, 0
    s_add_u32 s17, s49, 0
    buffer_load_dwordx4 v17, s[20:23], s17 offen lds
    s_add_u32 m0, s46, 1024
    s_add_u32 s17, s49, 82944
    buffer_load_dwordx4 v17, s[20:23], s17 offen lds
    s_add_u32 m0, s46, 2048
    s_add_u32 s17, s49, 165888
    buffer_load_dwordx4 v17, s[20:23], s17 offen lds
    s_add_u32 m0, s46, 3072
    s_add_u32 s17, s49, 248832
    buffer_load_dwordx4 v17, s[20:23], s17 offen lds
    s_waitcnt vmcnt(28)
    ds_read_b64_tr_b16 a[108:109], v18 offset:4096
    ds_read_b64_tr_b16 a[110:111], v18 offset:4608
    ds_read_b64_tr_b16 a[112:113], v18 offset:4104
    ds_read_b64_tr_b16 a[114:115], v18 offset:4616
    ds_read_b64_tr_b16 a[116:117], v19 offset:4160
    ds_read_b64_tr_b16 a[118:119], v19 offset:4672
    s_waitcnt lgkmcnt(0)
    s_add_u32 m0, s46, 4096
    s_add_u32 s17, s49, 331776
    buffer_load_dwordx4 v17, s[20:23], s17 offen lds
    s_add_u32 m0, s46, 5120
    s_add_u32 s17, s49, 414720
    buffer_load_dwordx4 v17, s[20:23], s17 offen lds
    s_add_u32 m0, s46, 6144
    s_add_u32 s17, s49, 497664
    buffer_load_dwordx4 v17, s[20:23], s17 offen lds
    s_add_u32 m0, s46, 7168
    s_add_u32 s17, s49, 580608
    buffer_load_dwordx4 v17, s[20:23], s17 offen lds
    s_waitcnt vmcnt(28)
    ds_read_b64_tr_b16 a[120:121], v18 offset:8192
    ds_read_b64_tr_b16 a[122:123], v18 offset:8704
    ds_read_b64_tr_b16 a[124:125], v18 offset:8200
    ds_read_b64_tr_b16 a[126:127], v18 offset:8712
    ds_read_b64_tr_b16 a[128:129], v19 offset:8256
    ds_read_b64_tr_b16 a[130:131], v19 offset:8768
    s_waitcnt lgkmcnt(0)
    s_waitcnt vmcnt(24)
    ds_read_b64_tr_b16 a[132:133], v18 offset:12288
    ds_read_b64_tr_b16 a[134:135], v18 offset:12800
    ds_read_b64_tr_b16 a[136:137], v18 offset:12296
    ds_read_b64_tr_b16 a[138:139], v18 offset:12808
    ds_read_b64_tr_b16 a[140:141], v19 offset:12352
    ds_read_b64_tr_b16 a[142:143], v19 offset:12864
    s_waitcnt lgkmcnt(0)
    s_waitcnt vmcnt(20)
    ds_read_b64_tr_b16 a[144:145], v18 offset:16384
    ds_read_b64_tr_b16 a[146:147], v18 offset:16896
    ds_read_b64_tr_b16 a[148:149], v18 offset:16392
    ds_read_b64_tr_b16 a[150:151], v18 offset:16904
    ds_read_b64_tr_b16 a[152:153], v19 offset:16448
    ds_read_b64_tr_b16 a[154:155], v19 offset:16960
    s_waitcnt lgkmcnt(0)
    s_waitcnt vmcnt(16)
    ds_read_b64_tr_b16 a[156:157], v18 offset:20480
    ds_read_b64_tr_b16 a[158:159], v18 offset:20992
    ds_read_b64_tr_b16 a[160:161], v18 offset:20488
    ds_read_b64_tr_b16 a[162:163], v18 offset:21000
    ds_read_b64_tr_b16 a[164:165], v19 offset:20544
    ds_read_b64_tr_b16 a[166:167], v19 offset:21056
    s_waitcnt lgkmcnt(0)
    s_waitcnt vmcnt(12)
    ds_read_b64_tr_b16 a[168:169], v18 offset:24576
    ds_read_b64_tr_b16 a[170:171], v18 offset:25088
    ds_read_b64_tr_b16 a[172:173], v18 offset:24584
    ds_read_b64_tr_b16 a[174:175], v18 offset:25096
    ds_read_b64_tr_b16 a[176:177], v19 offset:24640
    ds_read_b64_tr_b16 a[178:179], v19 offset:25152
    s_waitcnt lgkmcnt(0)
    s_waitcnt vmcnt(8)
    ds_read_b64_tr_b16 a[180:181], v18 offset:28672
    ds_read_b64_tr_b16 a[182:183], v18 offset:29184
    ds_read_b64_tr_b16 a[184:185], v18 offset:28680
    ds_read_b64_tr_b16 a[186:187], v18 offset:29192
    ds_read_b64_tr_b16 a[188:189], v19 offset:28736
    ds_read_b64_tr_b16 a[190:191], v19 offset:29248
    s_waitcnt lgkmcnt(0)
    s_waitcnt vmcnt(4)
    ds_read_b64_tr_b16 a[192:193], v18 offset:0
    ds_read_b64_tr_b16 a[194:195], v18 offset:512
    ds_read_b64_tr_b16 a[196:197], v18 offset:8
    ds_read_b64_tr_b16 a[198:199], v18 offset:520
    ds_read_b64_tr_b16 a[200:201], v19 offset:64
    ds_read_b64_tr_b16 a[202:203], v19 offset:576
    s_waitcnt lgkmcnt(0)
    s_waitcnt vmcnt(0)
    ds_read_b64_tr_b16 a[204:205], v18 offset:4096
    ds_read_b64_tr_b16 a[206:207], v18 offset:4608
    ds_read_b64_tr_b16 a[208:209], v18 offset:4104
    ds_read_b64_tr_b16 a[210:211], v18 offset:4616
    ds_read_b64_tr_b16 a[212:213], v19 offset:4160
    ds_read_b64_tr_b16 a[214:215], v19 offset:4672
    s_waitcnt lgkmcnt(0)
    s_barrier
    v_lshlrev_b32 v5, 4, v7
    v_lshl_add_u32 v10, v8, 9, v5
    s_mul_i32 s17, s50, 3072
    v_add_u32 v10, s17, v10
    v_lshrrev_b32 v6, 1, v8
    v_lshl_add_u32 v12, v6, 9, v5
    v_and_b32 v6, 1, v8
    v_lshl_add_u32 v12, v6, 3, v12
    s_add_u32 s17, s17, 2048
    v_add_u32 v12, s17, v12
    s_lshr_b32 s17, s50, 1
    s_lshl_b32 s17, s17, 9
    s_and_b32 s18, s50, 1
    s_lshl_b32 s18, s18, 3
    s_add_u32 s17, s17, s18
    v_add_u32 v11, s17, v5
    s_lshl_b32 s49, s15, 7
    s_lshl_b32 s17, s14, 2
    s_add_u32 s49, s49, s17
    s_add_u32 s49, s49, 3584
    s_mov_b32 s36, s63
    s_mov_b32 s34, s63
    s_mul_i32 s58, s14, 9216
    s_mul_i32 s64, s63, 2359296
    s_add_u32 s64, s64, s58
    s_add_u32 s64, s64, 17301504
    s_mul_i32 s61, s63, 1441792
    s_add_u32 s61, s61, 1536
    s_mov_b32 s37, 0
    s_mov_b32 s40, 36864
    s_mov_b32 s59, s58
    s_mov_b32 s43, 0
    s_mov_b32 s62, 1
    s_mov_b32 s28, s8
    s_mov_b32 s29, s9
    s_mov_b32 s30, 0
    s_mov_b32 s31, 0x00020000
    v_mov_b32 v184, 74752
    v_mov_b32 v5, -1
    ds_write_b32 v184, v5
    s_waitcnt lgkmcnt(0)
    s_cmp_lg_u32 s14, 0
    s_cbranch_scc1 Lawo_inia_d
    v_mov_b32 v5, 40
    s_mov_b32 s16, 0
Lawo_inia:
    global_load_dword v6, v5, s[12:13] sc1
    s_add_u32 s16, s16, 1
    s_cmp_gt_u32 s16, 100000
    s_cbranch_scc1 L_role_awo_abort
    s_waitcnt vmcnt(0)
    v_cmp_gt_u32 vcc, 128, v6
    s_nop 0
    s_cbranch_vccz Lawo_inia_d
    s_sleep 8
    s_branch Lawo_inia
Lawo_inia_d:
    s_barrier
    s_cmp_eq_u32 s63, 0
    s_cbranch_scc1 Lawo_ini_sk
    s_cmp_lg_u32 s14, 0
    s_cbranch_scc1 Lawo_inib_d
    v_mov_b32 v5, 160
    s_mov_b32 s16, 0
Lawo_inib:
    global_load_dword v6, v5, s[12:13] sc1
    s_add_u32 s16, s16, 1
    s_cmp_gt_u32 s16, 100000
    s_cbranch_scc1 L_role_awo_abort
    s_waitcnt vmcnt(0)
    v_cmp_gt_u32 vcc, 64, v6
    s_nop 0
    s_cbranch_vccz Lawo_inib_d
    s_sleep 8
    s_branch Lawo_inib
Lawo_inib_d:
    s_barrier
Lawo_ini_sk:
    s_mul_i32 s41, s37, 36864
    s_add_u32 s41, s41, s64
    s_mul_i32 s60, s37, 22528
    s_add_u32 s60, s60, s61
    s_cmp_lt_u32 s37, 64
    s_cselect_b32 s60, s60, 2883584
    s_branch Lawo_wait
Lawo_head:
    s_waitcnt vmcnt(6)
Lawo_head2:
    s_barrier
    ds_read_b32 v15, v184
    s_xor_b32 s40, s40, 36864
    s_xor_b32 s59, s59, 36864
    s_mov_b32 s35, s37
    s_lshl_b32 s57, s34, 6
    s_add_u32 s57, s57, s35
    s_add_u32 s37, s37, 1
    s_mov_b32 s39, 0
    s_mov_b32 s54, 0
    s_mul_i32 s41, s37, 36864
    s_add_u32 s41, s41, s64
    s_mul_i32 s60, s37, 22528
    s_add_u32 s60, s60, s61
    s_cmp_lt_u32 s37, 64
    s_cselect_b32 s60, s60, 2883584
    v_lshlrev_b32 v9, 9, v8
    v_lshl_add_u32 v9, v7, 4, v9
    v_add_u32 v9, s40, v9
    ds_read_b128 v[40:43], v9 offset:0
    ds_read_b128 v[44:47], v9 offset:256
    ds_read_b128 v[48:51], v9 offset:2048
    ds_read_b128 v[52:55], v9 offset:2304
    ds_read_b128 v[56:59], v9 offset:4096
    v_lshlrev_b32 v16, 16, v64
    v_and_b32 v17, 0xffff0000, v64
    v_lshlrev_b32 v18, 16, v65
    v_and_b32 v19, 0xffff0000, v65
    v_lshlrev_b32 v20, 16, v66
    v_and_b32 v21, 0xffff0000, v66
    v_lshlrev_b32 v22, 16, v67
    v_and_b32 v23, 0xffff0000, v67
    v_lshlrev_b32 v24, 16, v68
    v_and_b32 v25, 0xffff0000, v68
    v_lshlrev_b32 v26, 16, v69
    v_and_b32 v27, 0xffff0000, v69
    v_lshlrev_b32 v28, 16, v72
    v_and_b32 v29, 0xffff0000, v72
    v_lshlrev_b32 v30, 16, v73
    v_and_b32 v31, 0xffff0000, v73
    v_lshlrev_b32 v32, 16, v74
    v_and_b32 v33, 0xffff0000, v74
    v_lshlrev_b32 v34, 16, v75
    v_and_b32 v35, 0xffff0000, v75
    v_lshlrev_b32 v36, 16, v76
    v_and_b32 v37, 0xffff0000, v76
    v_lshlrev_b32 v38, 16, v77
    v_and_b32 v39, 0xffff0000, v77
    s_waitcnt lgkmcnt(4)
    v_mfma_f32_16x16x32_bf16 v[16:19], a[0:3], v[40:43], v[16:19]
    ds_read_b128 v[60:63], v9 offset:4352
    v_mfma_f32_16x16x32_bf16 v[20:23], a[4:7], v[40:43], v[20:23]
    s_mul_i32 s46, s34, 4718592
    v_mfma_f32_16x16x32_bf16 v[24:27], a[8:11], v[40:43], v[24:27]
    s_waitcnt lgkmcnt(4)
    v_mfma_f32_16x16x32_bf16 v[28:31], a[0:3], v[44:47], v[28:31]
    ds_read_b128 v[40:43], v9 offset:6144
    v_mfma_f32_16x16x32_bf16 v[32:35], a[4:7], v[44:47], v[32:35]
    s_mul_i32 s51, s35, 36864
    v_mfma_f32_16x16x32_bf16 v[36:39], a[8:11], v[44:47], v[36:39]
    v_readfirstlane_b32 s17, v15
    s_nop 0
    s_add_u32 s18, s17, 1
    s_max_i32 s32, s18, s37
    s_add_u32 s39, s37, 1
    s_min_u32 s39, s39, 63
    s_mul_i32 s33, s32, 22528
    s_add_u32 s33, s33, s61
    s_cmp_eq_u32 s14, 0
    s_cselect_b32 s18, s32, 0x7fff
    v_mov_b32 v2, 2
    s_cmp_le_u32 s18, s39
    s_cselect_b64 exec, -1, 0
    buffer_load_dword v2, v1, s[8:11], s33 offen sc1
    s_mov_b64 exec, -1
    s_cmp_ge_i32 s17, s37
    s_cbranch_scc1 Lawo_f_5
    s_waitcnt lgkmcnt(4)
    v_mfma_f32_16x16x32_bf16 v[16:19], a[12:15], v[48:51], v[16:19]
    ds_read_b128 v[44:47], v9 offset:6400
    v_mfma_f32_16x16x32_bf16 v[20:23], a[16:19], v[48:51], v[20:23]
    s_add_u32 s46, s46, s51
    v_mfma_f32_16x16x32_bf16 v[24:27], a[20:23], v[48:51], v[24:27]
    s_waitcnt lgkmcnt(4)
    v_mfma_f32_16x16x32_bf16 v[28:31], a[12:15], v[52:55], v[28:31]
    ds_read_b128 v[48:51], v9 offset:8192
    v_mfma_f32_16x16x32_bf16 v[32:35], a[16:19], v[52:55], v[32:35]
    s_add_u32 s46, s46, 8650752
    v_mfma_f32_16x16x32_bf16 v[36:39], a[20:23], v[52:55], v[36:39]
    s_waitcnt lgkmcnt(4)
    v_mfma_f32_16x16x32_bf16 v[16:19], a[24:27], v[56:59], v[16:19]
    ds_read_b128 v[52:55], v9 offset:8448
    v_mfma_f32_16x16x32_bf16 v[20:23], a[28:31], v[56:59], v[20:23]
    s_mul_i32 s52, s34, 786432
    v_mfma_f32_16x16x32_bf16 v[24:27], a[32:35], v[56:59], v[24:27]
    s_waitcnt lgkmcnt(4)
    v_mfma_f32_16x16x32_bf16 v[28:31], a[24:27], v[60:63], v[28:31]
    ds_read_b128 v[56:59], v9 offset:10240
    v_mfma_f32_16x16x32_bf16 v[32:35], a[28:31], v[60:63], v[32:35]
    s_mul_i32 s51, s35, 6144
    v_mfma_f32_16x16x32_bf16 v[36:39], a[32:35], v[60:63], v[36:39]
    s_waitcnt lgkmcnt(4)
    v_mfma_f32_16x16x32_bf16 v[16:19], a[36:39], v[40:43], v[16:19]
    ds_read_b128 v[60:63], v9 offset:10496
    v_mfma_f32_16x16x32_bf16 v[20:23], a[40:43], v[40:43], v[20:23]
    s_add_u32 s52, s52, s51
    v_mfma_f32_16x16x32_bf16 v[24:27], a[44:47], v[40:43], v[24:27]
    s_waitcnt lgkmcnt(4)
    v_mfma_f32_16x16x32_bf16 v[28:31], a[36:39], v[44:47], v[28:31]
    ds_read_b128 v[40:43], v9 offset:12288
    v_mfma_f32_16x16x32_bf16 v[32:35], a[40:43], v[44:47], v[32:35]
    s_add_u32 s52, s52, 16121856
    v_mfma_f32_16x16x32_bf16 v[36:39], a[44:47], v[44:47], v[36:39]
    s_waitcnt lgkmcnt(4)
    v_mfma_f32_16x16x32_bf16 v[16:19], a[48:51], v[48:51], v[16:19]
    ds_read_b128 v[44:47], v9 offset:12544
    v_mfma_f32_16x16x32_bf16 v[20:23], a[52:55], v[48:51], v[20:23]
    v_mfma_f32_16x16x32_bf16 v[24:27], a[56:59], v[48:51], v[24:27]
    s_waitcnt lgkmcnt(4)
    v_mfma_f32_16x16x32_bf16 v[28:31], a[48:51], v[52:55], v[28:31]
    ds_read_b128 v[48:51], v9 offset:14336
    v_mfma_f32_16x16x32_bf16 v[32:35], a[52:55], v[52:55], v[32:35]
    v_mfma_f32_16x16x32_bf16 v[36:39], a[56:59], v[52:55], v[36:39]
    s_waitcnt lgkmcnt(4)
    v_mfma_f32_16x16x32_bf16 v[16:19], a[60:63], v[56:59], v[16:19]
    ds_read_b128 v[52:55], v9 offset:14592
    v_mfma_f32_16x16x32_bf16 v[20:23], a[64:67], v[56:59], v[20:23]
    v_mfma_f32_16x16x32_bf16 v[24:27], a[68:71], v[56:59], v[24:27]
    s_waitcnt lgkmcnt(4)
    v_mfma_f32_16x16x32_bf16 v[28:31], a[60:63], v[60:63], v[28:31]
    v_cmp_eq_u32 s[76:77], 1, v2
    v_cmp_eq_u32 vcc, 2, v2
    ds_read_b128 v[56:59], v9 offset:16384
    v_mfma_f32_16x16x32_bf16 v[32:35], a[64:67], v[60:63], v[32:35]
    s_cmp_eq_u64 s[76:77], -1
    s_cselect_b32 s38, 1, 0
    v_mfma_f32_16x16x32_bf16 v[36:39], a[68:71], v[60:63], v[36:39]
    s_cmp_lg_u32 s38, 0
    s_cselect_b64 exec, 1, 0
    v_mov_b32 v15, s32
    ds_write_b32 v184, v15
    v_mov_b32 v2, 2
    s_mov_b64 exec, -1
    s_waitcnt lgkmcnt(5)
    v_mfma_f32_16x16x32_bf16 v[16:19], a[72:75], v[40:43], v[16:19]
    ds_read_b128 v[60:63], v9 offset:16640
    v_mfma_f32_16x16x32_bf16 v[20:23], a[76:79], v[40:43], v[20:23]
    s_add_u32 s32, s32, s38
    s_mul_i32 s38, s38, 22528
    s_add_u32 s33, s33, s38
    v_mfma_f32_16x16x32_bf16 v[24:27], a[80:83], v[40:43], v[24:27]
    s_cmp_eq_u64 vcc, 0
    s_cselect_b32 s38, s32, 0x7fff
    s_waitcnt lgkmcnt(5)
    v_mfma_f32_16x16x32_bf16 v[28:31], a[72:75], v[44:47], v[28:31]
    s_cmp_le_u32 s38, s39
    s_cselect_b64 exec, -1, 0
    v_mov_b32 v2, 2
    buffer_load_dword v2, v1, s[8:11], s33 offen sc1
    s_mov_b64 exec, -1
    ds_read_b128 v[40:43], v9 offset:18432
    v_mfma_f32_16x16x32_bf16 v[32:35], a[76:79], v[44:47], v[32:35]
    v_mfma_f32_16x16x32_bf16 v[36:39], a[80:83], v[44:47], v[36:39]
    ds_read_b32 v15, v184
    s_waitcnt lgkmcnt(6)
    v_mfma_f32_16x16x32_bf16 v[16:19], a[84:87], v[48:51], v[16:19]
    ds_read_b128 v[44:47], v9 offset:18688
    v_mfma_f32_16x16x32_bf16 v[20:23], a[88:91], v[48:51], v[20:23]
    v_mfma_f32_16x16x32_bf16 v[24:27], a[92:95], v[48:51], v[24:27]
    s_waitcnt lgkmcnt(6)
    v_mfma_f32_16x16x32_bf16 v[28:31], a[84:87], v[52:55], v[28:31]
    ds_read_b128 v[48:51], v9 offset:20480
    v_mfma_f32_16x16x32_bf16 v[32:35], a[88:91], v[52:55], v[32:35]
    v_mfma_f32_16x16x32_bf16 v[36:39], a[92:95], v[52:55], v[36:39]
    s_waitcnt lgkmcnt(2)
    v_readfirstlane_b32 s17, v15
    s_nop 0
    s_cmp_ge_i32 s17, s37
    s_cbranch_scc1 Lawo_f_6
    v_mfma_f32_16x16x32_bf16 v[16:19], a[96:99], v[56:59], v[16:19]
    ds_read_b128 v[52:55], v9 offset:20736
    v_mfma_f32_16x16x32_bf16 v[20:23], a[100:103], v[56:59], v[20:23]
    v_mfma_f32_16x16x32_bf16 v[24:27], a[104:107], v[56:59], v[24:27]
    v_mfma_f32_16x16x32_bf16 v[28:31], a[96:99], v[60:63], v[28:31]
    ds_read_b128 v[56:59], v9 offset:22528
    v_mfma_f32_16x16x32_bf16 v[32:35], a[100:103], v[60:63], v[32:35]
    v_mfma_f32_16x16x32_bf16 v[36:39], a[104:107], v[60:63], v[36:39]
    s_waitcnt vmcnt(2)
    s_cmp_lg_u32 s43, 0
    s_cselect_b64 exec, 1, 0
    buffer_store_dword v3, v4, s[8:11], s43 offen sc1
    s_mov_b64 exec, -1
    s_mov_b32 s43, 0
    v_mfma_f32_16x16x32_bf16 v[16:19], a[108:111], v[40:43], v[16:19]
    ds_read_b128 v[60:63], v9 offset:22784
    v_mfma_f32_16x16x32_bf16 v[20:23], a[112:115], v[40:43], v[20:23]
    v_mfma_f32_16x16x32_bf16 v[24:27], a[116:119], v[40:43], v[24:27]
    s_waitcnt lgkmcnt(4)
    v_mfma_f32_16x16x32_bf16 v[28:31], a[108:111], v[44:47], v[28:31]
    ds_read_b128 v[40:43], v9 offset:24576
    v_mfma_f32_16x16x32_bf16 v[32:35], a[112:115], v[44:47], v[32:35]
    v_mfma_f32_16x16x32_bf16 v[36:39], a[116:119], v[44:47], v[36:39]
    s_waitcnt lgkmcnt(4)
    v_mfma_f32_16x16x32_bf16 v[16:19], a[120:123], v[48:51], v[16:19]
    ds_read_b128 v[44:47], v9 offset:24832
    v_mfma_f32_16x16x32_bf16 v[20:23], a[124:127], v[48:51], v[20:23]
    v_mfma_f32_16x16x32_bf16 v[24:27], a[128:131], v[48:51], v[24:27]
    s_waitcnt lgkmcnt(4)
    v_mfma_f32_16x16x32_bf16 v[28:31], a[120:123], v[52:55], v[28:31]
    ds_read_b128 v[48:51], v9 offset:26624
    v_mfma_f32_16x16x32_bf16 v[32:35], a[124:127], v[52:55], v[32:35]
    v_mfma_f32_16x16x32_bf16 v[36:39], a[128:131], v[52:55], v[36:39]
    s_waitcnt lgkmcnt(4)
    v_mfma_f32_16x16x32_bf16 v[16:19], a[132:135], v[56:59], v[16:19]
    ds_read_b128 v[52:55], v9 offset:26880
    v_mfma_f32_16x16x32_bf16 v[20:23], a[136:139], v[56:59], v[20:23]
    v_mfma_f32_16x16x32_bf16 v[24:27], a[140:143], v[56:59], v[24:27]
    s_waitcnt lgkmcnt(4)
    v_mfma_f32_16x16x32_bf16 v[28:31], a[132:135], v[60:63], v[28:31]
    ds_read_b128 v[56:59], v9 offset:28672
    v_mfma_f32_16x16x32_bf16 v[32:35], a[136:139], v[60:63], v[32:35]
    v_mfma_f32_16x16x32_bf16 v[36:39], a[140:143], v[60:63], v[36:39]
    s_waitcnt lgkmcnt(4)
    v_mfma_f32_16x16x32_bf16 v[16:19], a[144:147], v[40:43], v[16:19]
    ds_read_b128 v[60:63], v9 offset:28928
    v_mfma_f32_16x16x32_bf16 v[20:23], a[148:151], v[40:43], v[20:23]
    v_mfma_f32_16x16x32_bf16 v[24:27], a[152:155], v[40:43], v[24:27]
    s_waitcnt lgkmcnt(4)
    v_mfma_f32_16x16x32_bf16 v[28:31], a[144:147], v[44:47], v[28:31]
    ds_read_b128 v[40:43], v9 offset:30720
    v_mfma_f32_16x16x32_bf16 v[32:35], a[148:151], v[44:47], v[32:35]
    v_mfma_f32_16x16x32_bf16 v[36:39], a[152:155], v[44:47], v[36:39]
    s_waitcnt lgkmcnt(4)
    v_mfma_f32_16x16x32_bf16 v[16:19], a[156:159], v[48:51], v[16:19]
    ds_read_b128 v[44:47], v9 offset:30976
    v_mfma_f32_16x16x32_bf16 v[20:23], a[160:163], v[48:51], v[20:23]
    v_mfma_f32_16x16x32_bf16 v[24:27], a[164:167], v[48:51], v[24:27]
    s_waitcnt lgkmcnt(4)
    v_mfma_f32_16x16x32_bf16 v[28:31], a[156:159], v[52:55], v[28:31]
    ds_read_b128 v[48:51], v9 offset:32768
    v_mfma_f32_16x16x32_bf16 v[32:35], a[160:163], v[52:55], v[32:35]
    v_mfma_f32_16x16x32_bf16 v[36:39], a[164:167], v[52:55], v[36:39]
    s_waitcnt lgkmcnt(4)
    v_mfma_f32_16x16x32_bf16 v[16:19], a[168:171], v[56:59], v[16:19]
    ds_read_b128 v[52:55], v9 offset:33024
    v_mfma_f32_16x16x32_bf16 v[20:23], a[172:175], v[56:59], v[20:23]
    v_mfma_f32_16x16x32_bf16 v[24:27], a[176:179], v[56:59], v[24:27]
    s_waitcnt lgkmcnt(4)
    v_mfma_f32_16x16x32_bf16 v[28:31], a[168:171], v[60:63], v[28:31]
    v_cmp_eq_u32 s[76:77], 1, v2
    v_cmp_eq_u32 vcc, 2, v2
    ds_read_b128 v[56:59], v9 offset:34816
    v_mfma_f32_16x16x32_bf16 v[32:35], a[172:175], v[60:63], v[32:35]
    s_cmp_eq_u64 s[76:77], -1
    s_cselect_b32 s38, 1, 0
    v_mfma_f32_16x16x32_bf16 v[36:39], a[176:179], v[60:63], v[36:39]
    s_cmp_lg_u32 s38, 0
    s_cselect_b64 exec, 1, 0
    v_mov_b32 v15, s32
    ds_write_b32 v184, v15
    v_mov_b32 v2, 2
    s_mov_b64 exec, -1
    s_waitcnt lgkmcnt(5)
    v_mfma_f32_16x16x32_bf16 v[16:19], a[180:183], v[40:43], v[16:19]
    ds_read_b128 v[60:63], v9 offset:35072
    v_mfma_f32_16x16x32_bf16 v[20:23], a[184:187], v[40:43], v[20:23]
    s_add_u32 s32, s32, s38
    s_mul_i32 s38, s38, 22528
    s_add_u32 s33, s33, s38
    v_mfma_f32_16x16x32_bf16 v[24:27], a[188:191], v[40:43], v[24:27]
    s_cmp_eq_u64 vcc, 0
    s_cselect_b32 s38, s32, 0x7fff
    s_waitcnt lgkmcnt(5)
    v_mfma_f32_16x16x32_bf16 v[28:31], a[180:183], v[44:47], v[28:31]
    s_cmp_le_u32 s38, s39
    s_cselect_b64 exec, -1, 0
    v_mov_b32 v2, 2
    buffer_load_dword v2, v1, s[8:11], s33 offen sc1
    s_mov_b64 exec, -1
    v_mfma_f32_16x16x32_bf16 v[32:35], a[184:187], v[44:47], v[32:35]
    v_mfma_f32_16x16x32_bf16 v[36:39], a[188:191], v[44:47], v[36:39]
    s_waitcnt lgkmcnt(4)
    v_mfma_f32_16x16x32_bf16 v[16:19], a[192:195], v[48:51], v[16:19]
    v_mfma_f32_16x16x32_bf16 v[20:23], a[196:199], v[48:51], v[20:23]
    v_mfma_f32_16x16x32_bf16 v[24:27], a[200:203], v[48:51], v[24:27]
    s_waitcnt lgkmcnt(3)
    v_mfma_f32_16x16x32_bf16 v[28:31], a[192:195], v[52:55], v[28:31]
    v_mfma_f32_16x16x32_bf16 v[32:35], a[196:199], v[52:55], v[32:35]
    v_mfma_f32_16x16x32_bf16 v[36:39], a[200:203], v[52:55], v[36:39]
    s_waitcnt lgkmcnt(2)
    v_mfma_f32_16x16x32_bf16 v[16:19], a[204:207], v[56:59], v[16:19]
    v_mfma_f32_16x16x32_bf16 v[20:23], a[208:211], v[56:59], v[20:23]
    v_mfma_f32_16x16x32_bf16 v[24:27], a[212:215], v[56:59], v[24:27]
    s_waitcnt lgkmcnt(0)
    v_mfma_f32_16x16x32_bf16 v[28:31], a[204:207], v[60:63], v[28:31]
    v_mfma_f32_16x16x32_bf16 v[32:35], a[208:211], v[60:63], v[32:35]
    v_mfma_f32_16x16x32_bf16 v[36:39], a[212:215], v[60:63], v[36:39]
    v_mov_b32 v88, 0x3f803f80
    v_cvt_pk_bf16_f32 v96, v16, v17
    v_cvt_pk_bf16_f32 v97, v18, v19
    v_cvt_pk_bf16_f32 v98, v20, v21
    v_cvt_pk_bf16_f32 v99, v22, v23
    v_cvt_pk_bf16_f32 v100, v24, v25
    v_cvt_pk_bf16_f32 v101, v26, v27
    buffer_store_dwordx4 v[96:99], v10, s[8:11], s46 offen offset:0 sc1
    buffer_store_dwordx2 v[100:101], v12, s[8:11], s46 offen offset:0 sc1
    v_cvt_pk_bf16_f32 v104, v28, v29
    v_cvt_pk_bf16_f32 v105, v30, v31
    v_cvt_pk_bf16_f32 v106, v32, v33
    v_cvt_pk_bf16_f32 v107, v34, v35
    v_cvt_pk_bf16_f32 v108, v36, v37
    v_cvt_pk_bf16_f32 v109, v38, v39
    buffer_store_dwordx4 v[104:107], v10, s[8:11], s46 offen offset:256 sc1
    buffer_store_dwordx2 v[108:109], v12, s[8:11], s46 offen offset:256 sc1
    v_mov_b32 v80, 0
    v_mov_b32 v81, 0
    v_mov_b32 v84, 0
    v_mov_b32 v85, 0
    v_dot2c_f32_bf16 v80, v96, v88
    v_dot2c_f32_bf16 v81, v96, v96
    v_dot2c_f32_bf16 v84, v104, v88
    v_dot2c_f32_bf16 v85, v104, v104
    v_dot2c_f32_bf16 v80, v97, v88
    v_dot2c_f32_bf16 v81, v97, v97
    v_dot2c_f32_bf16 v84, v105, v88
    v_dot2c_f32_bf16 v85, v105, v105
    v_dot2c_f32_bf16 v80, v98, v88
    v_dot2c_f32_bf16 v81, v98, v98
    v_dot2c_f32_bf16 v84, v106, v88
    v_dot2c_f32_bf16 v85, v106, v106
    v_dot2c_f32_bf16 v80, v99, v88
    v_dot2c_f32_bf16 v81, v99, v99
    v_dot2c_f32_bf16 v84, v107, v88
    v_dot2c_f32_bf16 v85, v107, v107
    v_dot2c_f32_bf16 v80, v100, v88
    v_dot2c_f32_bf16 v81, v100, v100
    v_dot2c_f32_bf16 v84, v108, v88
    v_dot2c_f32_bf16 v85, v108, v108
    v_dot2c_f32_bf16 v80, v101, v88
    v_dot2c_f32_bf16 v81, v101, v101
    v_dot2c_f32_bf16 v84, v109, v88
    v_dot2c_f32_bf16 v85, v109, v109
    s_nop 2
    v_mov_b32 v82, v80
    v_mov_b32 v83, v81
    v_mov_b32 v86, v84
    v_mov_b32 v87, v85
    v_permlane32_swap_b32 v80, v82
    v_permlane32_swap_b32 v81, v83
    v_permlane32_swap_b32 v84, v86
    v_permlane32_swap_b32 v85, v87
    v_add_f32 v80, v80, v82
    v_add_f32 v81, v81, v83
    v_add_f32 v84, v84, v86
    v_add_f32 v85, v85, v87
    v_mov_b32 v82, v80
    v_mov_b32 v83, v81
    v_mov_b32 v86, v84
    v_mov_b32 v87, v85
    v_permlane16_swap_b32 v80, v82
    v_permlane16_swap_b32 v81, v83
    v_permlane16_swap_b32 v84, v86
    v_permlane16_swap_b32 v85, v87
    v_add_f32 v80, v80, v82
    v_add_f32 v81, v81, v83
    v_add_f32 v84, v84, v86
    v_add_f32 v85, v85, v87
    s_mov_b64 exec, 0xffff
    buffer_store_dwordx2 v[80:81], v11, s[8:11], s52 offen offset:0 sc1
    buffer_store_dwordx2 v[84:85], v11, s[8:11], s52 offen offset:256 sc1
    s_mov_b64 exec, -1
    s_mul_i32 s43, s57, 22528
    s_add_u32 s43, s43, s49
    s_branch Lawo_none
Lawo_f_5:
    s_waitcnt lgkmcnt(4)
    v_mfma_f32_16x16x32_bf16 v[16:19], a[12:15], v[48:51], v[16:19]
    ds_read_b128 v[44:47], v9 offset:6400
    v_mfma_f32_16x16x32_bf16 v[20:23], a[16:19], v[48:51], v[20:23]
    s_add_u32 s46, s46, s51
    v_mfma_f32_16x16x32_bf16 v[24:27], a[20:23], v[48:51], v[24:27]
    s_add_u32 m0, s59, 0
    s_add_u32 s47, s41, 0
    buffer_load_dwordx4 v0, s[8:11], s47 offen offset:0 lds
    s_waitcnt lgkmcnt(4)
    v_mfma_f32_16x16x32_bf16 v[28:31], a[12:15], v[52:55], v[28:31]
    buffer_load_dwordx4 v0, s[8:11], s47 offen offset:1024 lds
    ds_read_b128 v[48:51], v9 offset:8192
    v_mfma_f32_16x16x32_bf16 v[32:35], a[16:19], v[52:55], v[32:35]
    s_add_u32 s46, s46, 8650752
    v_mfma_f32_16x16x32_bf16 v[36:39], a[20:23], v[52:55], v[36:39]
    s_waitcnt lgkmcnt(4)
    v_mfma_f32_16x16x32_bf16 v[16:19], a[24:27], v[56:59], v[16:19]
    buffer_load_dwordx4 v0, s[8:11], s47 offen offset:2048 lds
    ds_read_b128 v[52:55], v9 offset:8448
    v_mfma_f32_16x16x32_bf16 v[20:23], a[28:31], v[56:59], v[20:23]
    s_mul_i32 s52, s34, 786432
    v_mfma_f32_16x16x32_bf16 v[24:27], a[32:35], v[56:59], v[24:27]
    s_waitcnt lgkmcnt(4)
    v_mfma_f32_16x16x32_bf16 v[28:31], a[24:27], v[60:63], v[28:31]
    buffer_load_dwordx4 v0, s[8:11], s47 offen offset:3072 lds
    ds_read_b128 v[56:59], v9 offset:10240
    v_mfma_f32_16x16x32_bf16 v[32:35], a[28:31], v[60:63], v[32:35]
    s_mul_i32 s51, s35, 6144
    v_mfma_f32_16x16x32_bf16 v[36:39], a[32:35], v[60:63], v[36:39]
    s_waitcnt lgkmcnt(4)
    v_mfma_f32_16x16x32_bf16 v[16:19], a[36:39], v[40:43], v[16:19]
    ds_read_b128 v[60:63], v9 offset:10496
    v_mfma_f32_16x16x32_bf16 v[20:23], a[40:43], v[40:43], v[20:23]
    s_add_u32 s52, s52, s51
    v_mfma_f32_16x16x32_bf16 v[24:27], a[44:47], v[40:43], v[24:27]
    s_add_u32 m0, s59, 4096
    s_add_u32 s47, s41, 4096
    buffer_load_dwordx4 v0, s[8:11], s47 offen offset:0 lds
    s_waitcnt lgkmcnt(4)
    v_mfma_f32_16x16x32_bf16 v[28:31], a[36:39], v[44:47], v[28:31]
    buffer_load_dwordx4 v0, s[8:11], s47 offen offset:1024 lds
    ds_read_b128 v[40:43], v9 offset:12288
    v_mfma_f32_16x16x32_bf16 v[32:35], a[40:43], v[44:47], v[32:35]
    s_add_u32 s52, s52, 16121856
    v_mfma_f32_16x16x32_bf16 v[36:39], a[44:47], v[44:47], v[36:39]
    s_waitcnt lgkmcnt(4)
    v_mfma_f32_16x16x32_bf16 v[16:19], a[48:51], v[48:51], v[16:19]
    buffer_load_dwordx4 v0, s[8:11], s47 offen offset:2048 lds
    ds_read_b128 v[44:47], v9 offset:12544
    v_mfma_f32_16x16x32_bf16 v[20:23], a[52:55], v[48:51], v[20:23]
    v_mfma_f32_16x16x32_bf16 v[24:27], a[56:59], v[48:51], v[24:27]
    s_waitcnt lgkmcnt(4)
    v_mfma_f32_16x16x32_bf16 v[28:31], a[48:51], v[52:55], v[28:31]
    buffer_load_dwordx4 v0, s[8:11], s47 offen offset:3072 lds
    ds_read_b128 v[48:51], v9 offset:14336
    v_mfma_f32_16x16x32_bf16 v[32:35], a[52:55], v[52:55], v[32:35]
    v_mfma_f32_16x16x32_bf16 v[36:39], a[56:59], v[52:55], v[36:39]
    s_waitcnt lgkmcnt(4)
    v_mfma_f32_16x16x32_bf16 v[16:19], a[60:63], v[56:59], v[16:19]
    ds_read_b128 v[52:55], v9 offset:14592
    v_mfma_f32_16x16x32_bf16 v[20:23], a[64:67], v[56:59], v[20:23]
    s_add_u32 m0, s59, 8192
    s_add_u32 s47, s41, 8192
    buffer_load_dwordx4 v0, s[8:11], s47 offen offset:0 lds
    v_mfma_f32_16x16x32_bf16 v[24:27], a[68:71], v[56:59], v[24:27]
    s_waitcnt lgkmcnt(4)
    v_mfma_f32_16x16x32_bf16 v[28:31], a[60:63], v[60:63], v[28:31]
    s_mul_i32 s48, s36, 4718592
    s_mul_i32 s18, s37, 36864
    s_add_u32 s48, s48, s18
    s_add_u32 s48, s48, 6291456
    buffer_load_dwordx4 v[64:67], v10, s[8:11], s48 offen offset:0
    ds_read_b128 v[56:59], v9 offset:16384
    v_mfma_f32_16x16x32_bf16 v[32:35], a[64:67], v[60:63], v[32:35]
    v_cmp_eq_u32 s[76:77], 1, v2
    v_cmp_eq_u32 vcc, 2, v2
    v_mfma_f32_16x16x32_bf16 v[36:39], a[68:71], v[60:63], v[36:39]
    s_cmp_eq_u64 s[76:77], -1
    s_cselect_b32 s38, 1, 0
    s_waitcnt lgkmcnt(4)
    v_mfma_f32_16x16x32_bf16 v[16:19], a[72:75], v[40:43], v[16:19]
    s_cmp_lg_u32 s38, 0
    s_cselect_b64 exec, 1, 0
    v_mov_b32 v15, s32
    ds_write_b32 v184, v15
    v_mov_b32 v2, 2
    s_mov_b64 exec, -1
    ds_read_b128 v[60:63], v9 offset:16640
    v_mfma_f32_16x16x32_bf16 v[20:23], a[76:79], v[40:43], v[20:23]
    s_add_u32 s32, s32, s38
    s_mul_i32 s38, s38, 22528
    s_add_u32 s33, s33, s38
    v_mfma_f32_16x16x32_bf16 v[24:27], a[80:83], v[40:43], v[24:27]
    s_cmp_eq_u64 vcc, 0
    s_cselect_b32 s38, s32, 0x7fff
    s_waitcnt lgkmcnt(5)
    v_mfma_f32_16x16x32_bf16 v[28:31], a[72:75], v[44:47], v[28:31]
    s_cmp_le_u32 s38, s39
    s_cselect_b64 exec, -1, 0
    v_mov_b32 v2, 2
    buffer_load_dword v2, v1, s[8:11], s33 offen sc1
    s_mov_b64 exec, -1
    ds_read_b128 v[40:43], v9 offset:18432
    v_mfma_f32_16x16x32_bf16 v[32:35], a[76:79], v[44:47], v[32:35]
    buffer_load_dwordx2 v[68:69], v12, s[8:11], s48 offen offset:0
    buffer_load_dwordx4 v[72:75], v10, s[8:11], s48 offen offset:256
    v_mfma_f32_16x16x32_bf16 v[36:39], a[80:83], v[44:47], v[36:39]
    s_waitcnt lgkmcnt(5)
    v_mfma_f32_16x16x32_bf16 v[16:19], a[84:87], v[48:51], v[16:19]
    buffer_load_dwordx2 v[76:77], v12, s[8:11], s48 offen offset:256
    ds_read_b128 v[44:47], v9 offset:18688
    v_mfma_f32_16x16x32_bf16 v[20:23], a[88:91], v[48:51], v[20:23]
    v_mfma_f32_16x16x32_bf16 v[24:27], a[92:95], v[48:51], v[24:27]
    s_waitcnt lgkmcnt(5)
    v_mfma_f32_16x16x32_bf16 v[28:31], a[84:87], v[52:55], v[28:31]
    ds_read_b128 v[48:51], v9 offset:20480
    v_mfma_f32_16x16x32_bf16 v[32:35], a[88:91], v[52:55], v[32:35]
    v_mfma_f32_16x16x32_bf16 v[36:39], a[92:95], v[52:55], v[36:39]
    s_waitcnt lgkmcnt(5)
    v_mfma_f32_16x16x32_bf16 v[16:19], a[96:99], v[56:59], v[16:19]
    ds_read_b128 v[52:55], v9 offset:20736
    v_mfma_f32_16x16x32_bf16 v[20:23], a[100:103], v[56:59], v[20:23]
    v_mfma_f32_16x16x32_bf16 v[24:27], a[104:107], v[56:59], v[24:27]
    s_waitcnt lgkmcnt(4)
    v_mfma_f32_16x16x32_bf16 v[28:31], a[96:99], v[60:63], v[28:31]
    ds_read_b128 v[56:59], v9 offset:22528
    v_mfma_f32_16x16x32_bf16 v[32:35], a[100:103], v[60:63], v[32:35]
    v_mfma_f32_16x16x32_bf16 v[36:39], a[104:107], v[60:63], v[36:39]
    s_waitcnt vmcnt(15)
    s_cmp_lg_u32 s43, 0
    s_cselect_b64 exec, 1, 0
    buffer_store_dword v3, v4, s[8:11], s43 offen sc1
    s_mov_b64 exec, -1
    s_mov_b32 s43, 0
    s_waitcnt lgkmcnt(4)
    v_mfma_f32_16x16x32_bf16 v[16:19], a[108:111], v[40:43], v[16:19]
    ds_read_b128 v[60:63], v9 offset:22784
    v_mfma_f32_16x16x32_bf16 v[20:23], a[112:115], v[40:43], v[20:23]
    v_mfma_f32_16x16x32_bf16 v[24:27], a[116:119], v[40:43], v[24:27]
    s_waitcnt lgkmcnt(4)
    v_mfma_f32_16x16x32_bf16 v[28:31], a[108:111], v[44:47], v[28:31]
    ds_read_b128 v[40:43], v9 offset:24576
    v_mfma_f32_16x16x32_bf16 v[32:35], a[112:115], v[44:47], v[32:35]
    v_mfma_f32_16x16x32_bf16 v[36:39], a[116:119], v[44:47], v[36:39]
    s_waitcnt lgkmcnt(4)
    v_mfma_f32_16x16x32_bf16 v[16:19], a[120:123], v[48:51], v[16:19]
    ds_read_b128 v[44:47], v9 offset:24832
    v_mfma_f32_16x16x32_bf16 v[20:23], a[124:127], v[48:51], v[20:23]
    v_mfma_f32_16x16x32_bf16 v[24:27], a[128:131], v[48:51], v[24:27]
    s_waitcnt lgkmcnt(4)
    v_mfma_f32_16x16x32_bf16 v[28:31], a[120:123], v[52:55], v[28:31]
    ds_read_b128 v[48:51], v9 offset:26624
    v_mfma_f32_16x16x32_bf16 v[32:35], a[124:127], v[52:55], v[32:35]
    v_mfma_f32_16x16x32_bf16 v[36:39], a[128:131], v[52:55], v[36:39]
    s_waitcnt lgkmcnt(4)
    v_mfma_f32_16x16x32_bf16 v[16:19], a[132:135], v[56:59], v[16:19]
    ds_read_b128 v[52:55], v9 offset:26880
    v_mfma_f32_16x16x32_bf16 v[20:23], a[136:139], v[56:59], v[20:23]
    v_mfma_f32_16x16x32_bf16 v[24:27], a[140:143], v[56:59], v[24:27]
    s_waitcnt lgkmcnt(4)
    v_mfma_f32_16x16x32_bf16 v[28:31], a[132:135], v[60:63], v[28:31]
    ds_read_b128 v[56:59], v9 offset:28672
    v_mfma_f32_16x16x32_bf16 v[32:35], a[136:139], v[60:63], v[32:35]
    v_mfma_f32_16x16x32_bf16 v[36:39], a[140:143], v[60:63], v[36:39]
    s_waitcnt lgkmcnt(4)
    v_mfma_f32_16x16x32_bf16 v[16:19], a[144:147], v[40:43], v[16:19]
    ds_read_b128 v[60:63], v9 offset:28928
    v_mfma_f32_16x16x32_bf16 v[20:23], a[148:151], v[40:43], v[20:23]
    v_mfma_f32_16x16x32_bf16 v[24:27], a[152:155], v[40:43], v[24:27]
    s_waitcnt lgkmcnt(4)
    v_mfma_f32_16x16x32_bf16 v[28:31], a[144:147], v[44:47], v[28:31]
    ds_read_b128 v[40:43], v9 offset:30720
    v_mfma_f32_16x16x32_bf16 v[32:35], a[148:151], v[44:47], v[32:35]
    v_mfma_f32_16x16x32_bf16 v[36:39], a[152:155], v[44:47], v[36:39]
    s_waitcnt lgkmcnt(4)
    v_mfma_f32_16x16x32_bf16 v[16:19], a[156:159], v[48:51], v[16:19]
    ds_read_b128 v[44:47], v9 offset:30976
    v_mfma_f32_16x16x32_bf16 v[20:23], a[160:163], v[48:51], v[20:23]
    v_mfma_f32_16x16x32_bf16 v[24:27], a[164:167], v[48:51], v[24:27]
    s_waitcnt lgkmcnt(4)
    v_mfma_f32_16x16x32_bf16 v[28:31], a[156:159], v[52:55], v[28:31]
    ds_read_b128 v[48:51], v9 offset:32768
    v_mfma_f32_16x16x32_bf16 v[32:35], a[160:163], v[52:55], v[32:35]
    v_mfma_f32_16x16x32_bf16 v[36:39], a[164:167], v[52:55], v[36:39]
    s_waitcnt lgkmcnt(4)
    v_mfma_f32_16x16x32_bf16 v[16:19], a[168:171], v[56:59], v[16:19]
    ds_read_b128 v[52:55], v9 offset:33024
    v_mfma_f32_16x16x32_bf16 v[20:23], a[172:175], v[56:59], v[20:23]
    v_mfma_f32_16x16x32_bf16 v[24:27], a[176:179], v[56:59], v[24:27]
    s_waitcnt lgkmcnt(4)
    v_mfma_f32_16x16x32_bf16 v[28:31], a[168:171], v[60:63], v[28:31]
    v_cmp_eq_u32 s[76:77], 1, v2
    v_cmp_eq_u32 vcc, 2, v2
    ds_read_b128 v[56:59], v9 offset:34816
    v_mfma_f32_16x16x32_bf16 v[32:35], a[172:175], v[60:63], v[32:35]
    s_cmp_eq_u64 s[76:77], -1
    s_cselect_b32 s38, 1, 0
    v_mfma_f32_16x16x32_bf16 v[36:39], a[176:179], v[60:63], v[36:39]
    s_cmp_lg_u32 s38, 0
    s_cselect_b64 exec, 1, 0
    v_mov_b32 v15, s32
    ds_write_b32 v184, v15
    v_mov_b32 v2, 2
    s_mov_b64 exec, -1
    s_waitcnt lgkmcnt(5)
    v_mfma_f32_16x16x32_bf16 v[16:19], a[180:183], v[40:43], v[16:19]
    ds_read_b128 v[60:63], v9 offset:35072
    v_mfma_f32_16x16x32_bf16 v[20:23], a[184:187], v[40:43], v[20:23]
    s_add_u32 s32, s32, s38
    s_mul_i32 s38, s38, 22528
    s_add_u32 s33, s33, s38
    v_mfma_f32_16x16x32_bf16 v[24:27], a[188:191], v[40:43], v[24:27]
    s_cmp_eq_u64 vcc, 0
    s_cselect_b32 s38, s32, 0x7fff
    s_waitcnt lgkmcnt(5)
    v_mfma_f32_16x16x32_bf16 v[28:31], a[180:183], v[44:47], v[28:31]
    s_cmp_le_u32 s38, s39
    s_cselect_b64 exec, -1, 0
    v_mov_b32 v2, 2
    buffer_load_dword v2, v1, s[8:11], s33 offen sc1
    s_mov_b64 exec, -1
    v_mfma_f32_16x16x32_bf16 v[32:35], a[184:187], v[44:47], v[32:35]
    v_mfma_f32_16x16x32_bf16 v[36:39], a[188:191], v[44:47], v[36:39]
    s_waitcnt lgkmcnt(4)
    v_mfma_f32_16x16x32_bf16 v[16:19], a[192:195], v[48:51], v[16:19]
    v_mfma_f32_16x16x32_bf16 v[20:23], a[196:199], v[48:51], v[20:23]
    v_mfma_f32_16x16x32_bf16 v[24:27], a[200:203], v[48:51], v[24:27]
    s_waitcnt lgkmcnt(3)
    v_mfma_f32_16x16x32_bf16 v[28:31], a[192:195], v[52:55], v[28:31]
    v_mfma_f32_16x16x32_bf16 v[32:35], a[196:199], v[52:55], v[32:35]
    v_mfma_f32_16x16x32_bf16 v[36:39], a[200:203], v[52:55], v[36:39]
    s_waitcnt lgkmcnt(2)
    v_mfma_f32_16x16x32_bf16 v[16:19], a[204:207], v[56:59], v[16:19]
    v_mfma_f32_16x16x32_bf16 v[20:23], a[208:211], v[56:59], v[20:23]
    v_mfma_f32_16x16x32_bf16 v[24:27], a[212:215], v[56:59], v[24:27]
    s_waitcnt lgkmcnt(0)
    v_mfma_f32_16x16x32_bf16 v[28:31], a[204:207], v[60:63], v[28:31]
    v_mfma_f32_16x16x32_bf16 v[32:35], a[208:211], v[60:63], v[32:35]
    v_mfma_f32_16x16x32_bf16 v[36:39], a[212:215], v[60:63], v[36:39]
    v_mov_b32 v88, 0x3f803f80
    v_cvt_pk_bf16_f32 v96, v16, v17
    v_cvt_pk_bf16_f32 v97, v18, v19
    v_cvt_pk_bf16_f32 v98, v20, v21
    v_cvt_pk_bf16_f32 v99, v22, v23
    v_cvt_pk_bf16_f32 v100, v24, v25
    v_cvt_pk_bf16_f32 v101, v26, v27
    buffer_store_dwordx4 v[96:99], v10, s[8:11], s46 offen offset:0 sc1
    buffer_store_dwordx2 v[100:101], v12, s[8:11], s46 offen offset:0 sc1
    v_cvt_pk_bf16_f32 v104, v28, v29
    v_cvt_pk_bf16_f32 v105, v30, v31
    v_cvt_pk_bf16_f32 v106, v32, v33
    v_cvt_pk_bf16_f32 v107, v34, v35
    v_cvt_pk_bf16_f32 v108, v36, v37
    v_cvt_pk_bf16_f32 v109, v38, v39
    buffer_store_dwordx4 v[104:107], v10, s[8:11], s46 offen offset:256 sc1
    buffer_store_dwordx2 v[108:109], v12, s[8:11], s46 offen offset:256 sc1
    v_mov_b32 v80, 0
    v_mov_b32 v81, 0
    v_mov_b32 v84, 0
    v_mov_b32 v85, 0
    v_dot2c_f32_bf16 v80, v96, v88
    v_dot2c_f32_bf16 v81, v96, v96
    v_dot2c_f32_bf16 v84, v104, v88
    v_dot2c_f32_bf16 v85, v104, v104
    v_dot2c_f32_bf16 v80, v97, v88
    v_dot2c_f32_bf16 v81, v97, v97
    v_dot2c_f32_bf16 v84, v105, v88
    v_dot2c_f32_bf16 v85, v105, v105
    v_dot2c_f32_bf16 v80, v98, v88
    v_dot2c_f32_bf16 v81, v98, v98
    v_dot2c_f32_bf16 v84, v106, v88
    v_dot2c_f32_bf16 v85, v106, v106
    v_dot2c_f32_bf16 v80, v99, v88
    v_dot2c_f32_bf16 v81, v99, v99
    v_dot2c_f32_bf16 v84, v107, v88
    v_dot2c_f32_bf16 v85, v107, v107
    v_dot2c_f32_bf16 v80, v100, v88
    v_dot2c_f32_bf16 v81, v100, v100
    v_dot2c_f32_bf16 v84, v108, v88
    v_dot2c_f32_bf16 v85, v108, v108
    v_dot2c_f32_bf16 v80, v101, v88
    v_dot2c_f32_bf16 v81, v101, v101
    v_dot2c_f32_bf16 v84, v109, v88
    v_dot2c_f32_bf16 v85, v109, v109
    s_nop 2
    v_mov_b32 v82, v80
    v_mov_b32 v83, v81
    v_mov_b32 v86, v84
    v_mov_b32 v87, v85
    v_permlane32_swap_b32 v80, v82
    v_permlane32_swap_b32 v81, v83
    v_permlane32_swap_b32 v84, v86
    v_permlane32_swap_b32 v85, v87
    v_add_f32 v80, v80, v82
    v_add_f32 v81, v81, v83
    v_add_f32 v84, v84, v86
    v_add_f32 v85, v85, v87
    v_mov_b32 v82, v80
    v_mov_b32 v83, v81
    v_mov_b32 v86, v84
    v_mov_b32 v87, v85
    v_permlane16_swap_b32 v80, v82
    v_permlane16_swap_b32 v81, v83
    v_permlane16_swap_b32 v84, v86
    v_permlane16_swap_b32 v85, v87
    v_add_f32 v80, v80, v82
    v_add_f32 v81, v81, v83
    v_add_f32 v84, v84, v86
    v_add_f32 v85, v85, v87
    s_mov_b64 exec, 0xffff
    buffer_store_dwordx2 v[80:81], v11, s[8:11], s52 offen offset:0 sc1
    buffer_store_dwordx2 v[84:85], v11, s[8:11], s52 offen offset:256 sc1
    s_mov_b64 exec, -1
    s_mul_i32 s43, s57, 22528
    s_add_u32 s43, s43, s49
    s_branch Lawo_head
Lawo_f_6:
    v_mfma_f32_16x16x32_bf16 v[16:19], a[96:99], v[56:59], v[16:19]
    ds_read_b128 v[52:55], v9 offset:20736
    v_mfma_f32_16x16x32_bf16 v[20:23], a[100:103], v[56:59], v[20:23]
    s_add_u32 m0, s59, 0
    s_add_u32 s47, s41, 0
    buffer_load_dwordx4 v0, s[8:11], s47 offen offset:0 lds
    v_mfma_f32_16x16x32_bf16 v[24:27], a[104:107], v[56:59], v[24:27]
    v_mfma_f32_16x16x32_bf16 v[28:31], a[96:99], v[60:63], v[28:31]
    buffer_load_dwordx4 v0, s[8:11], s47 offen offset:1024 lds
    ds_read_b128 v[56:59], v9 offset:22528
    v_mfma_f32_16x16x32_bf16 v[32:35], a[100:103], v[60:63], v[32:35]
    v_mfma_f32_16x16x32_bf16 v[36:39], a[104:107], v[60:63], v[36:39]
    s_waitcnt vmcnt(4)
    s_cmp_lg_u32 s43, 0
    s_cselect_b64 exec, 1, 0
    buffer_store_dword v3, v4, s[8:11], s43 offen sc1
    s_mov_b64 exec, -1
    s_mov_b32 s43, 0
    v_mfma_f32_16x16x32_bf16 v[16:19], a[108:111], v[40:43], v[16:19]
    buffer_load_dwordx4 v0, s[8:11], s47 offen offset:2048 lds
    ds_read_b128 v[60:63], v9 offset:22784
    v_mfma_f32_16x16x32_bf16 v[20:23], a[112:115], v[40:43], v[20:23]
    v_mfma_f32_16x16x32_bf16 v[24:27], a[116:119], v[40:43], v[24:27]
    s_waitcnt lgkmcnt(4)
    v_mfma_f32_16x16x32_bf16 v[28:31], a[108:111], v[44:47], v[28:31]
    buffer_load_dwordx4 v0, s[8:11], s47 offen offset:3072 lds
    ds_read_b128 v[40:43], v9 offset:24576
    v_mfma_f32_16x16x32_bf16 v[32:35], a[112:115], v[44:47], v[32:35]
    v_mfma_f32_16x16x32_bf16 v[36:39], a[116:119], v[44:47], v[36:39]
    s_waitcnt lgkmcnt(4)
    v_mfma_f32_16x16x32_bf16 v[16:19], a[120:123], v[48:51], v[16:19]
    ds_read_b128 v[44:47], v9 offset:24832
    v_mfma_f32_16x16x32_bf16 v[20:23], a[124:127], v[48:51], v[20:23]
    s_add_u32 m0, s59, 4096
    s_add_u32 s47, s41, 4096
    buffer_load_dwordx4 v0, s[8:11], s47 offen offset:0 lds
    v_mfma_f32_16x16x32_bf16 v[24:27], a[128:131], v[48:51], v[24:27]
    s_waitcnt lgkmcnt(4)
    v_mfma_f32_16x16x32_bf16 v[28:31], a[120:123], v[52:55], v[28:31]
    buffer_load_dwordx4 v0, s[8:11], s47 offen offset:1024 lds
    ds_read_b128 v[48:51], v9 offset:26624
    v_mfma_f32_16x16x32_bf16 v[32:35], a[124:127], v[52:55], v[32:35]
    v_mfma_f32_16x16x32_bf16 v[36:39], a[128:131], v[52:55], v[36:39]
    s_waitcnt lgkmcnt(4)
    v_mfma_f32_16x16x32_bf16 v[16:19], a[132:135], v[56:59], v[16:19]
    buffer_load_dwordx4 v0, s[8:11], s47 offen offset:2048 lds
    ds_read_b128 v[52:55], v9 offset:26880
    v_mfma_f32_16x16x32_bf16 v[20:23], a[136:139], v[56:59], v[20:23]
    v_mfma_f32_16x16x32_bf16 v[24:27], a[140:143], v[56:59], v[24:27]
    s_waitcnt lgkmcnt(4)
    v_mfma_f32_16x16x32_bf16 v[28:31], a[132:135], v[60:63], v[28:31]
    buffer_load_dwordx4 v0, s[8:11], s47 offen offset:3072 lds
    ds_read_b128 v[56:59], v9 offset:28672
    v_mfma_f32_16x16x32_bf16 v[32:35], a[136:139], v[60:63], v[32:35]
    v_mfma_f32_16x16x32_bf16 v[36:39], a[140:143], v[60:63], v[36:39]
    s_waitcnt lgkmcnt(4)
    v_mfma_f32_16x16x32_bf16 v[16:19], a[144:147], v[40:43], v[16:19]
    ds_read_b128 v[60:63], v9 offset:28928
    v_mfma_f32_16x16x32_bf16 v[20:23], a[148:151], v[40:43], v[20:23]
    s_add_u32 m0, s59, 8192
    s_add_u32 s47, s41, 8192
    buffer_load_dwordx4 v0, s[8:11], s47 offen offset:0 lds
    v_mfma_f32_16x16x32_bf16 v[24:27], a[152:155], v[40:43], v[24:27]
    s_waitcnt lgkmcnt(4)
    v_mfma_f32_16x16x32_bf16 v[28:31], a[144:147], v[44:47], v[28:31]
    s_mul_i32 s48, s36, 4718592
    s_mul_i32 s18, s37, 36864
    s_add_u32 s48, s48, s18
    s_add_u32 s48, s48, 6291456
    buffer_load_dwordx4 v[64:67], v10, s[8:11], s48 offen offset:0
    ds_read_b128 v[40:43], v9 offset:30720
    v_mfma_f32_16x16x32_bf16 v[32:35], a[148:151], v[44:47], v[32:35]
    v_mfma_f32_16x16x32_bf16 v[36:39], a[152:155], v[44:47], v[36:39]
    s_waitcnt lgkmcnt(4)
    v_mfma_f32_16x16x32_bf16 v[16:19], a[156:159], v[48:51], v[16:19]
    buffer_load_dwordx2 v[68:69], v12, s[8:11], s48 offen offset:0
    ds_read_b128 v[44:47], v9 offset:30976
    v_mfma_f32_16x16x32_bf16 v[20:23], a[160:163], v[48:51], v[20:23]
    v_mfma_f32_16x16x32_bf16 v[24:27], a[164:167], v[48:51], v[24:27]
    s_waitcnt lgkmcnt(4)
    v_mfma_f32_16x16x32_bf16 v[28:31], a[156:159], v[52:55], v[28:31]
    buffer_load_dwordx4 v[72:75], v10, s[8:11], s48 offen offset:256
    ds_read_b128 v[48:51], v9 offset:32768
    v_mfma_f32_16x16x32_bf16 v[32:35], a[160:163], v[52:55], v[32:35]
    v_mfma_f32_16x16x32_bf16 v[36:39], a[164:167], v[52:55], v[36:39]
    s_waitcnt lgkmcnt(4)
    v_mfma_f32_16x16x32_bf16 v[16:19], a[168:171], v[56:59], v[16:19]
    buffer_load_dwordx2 v[76:77], v12, s[8:11], s48 offen offset:256
    ds_read_b128 v[52:55], v9 offset:33024
    v_mfma_f32_16x16x32_bf16 v[20:23], a[172:175], v[56:59], v[20:23]
    v_mfma_f32_16x16x32_bf16 v[24:27], a[176:179], v[56:59], v[24:27]
    s_waitcnt lgkmcnt(4)
    v_mfma_f32_16x16x32_bf16 v[28:31], a[168:171], v[60:63], v[28:31]
    v_cmp_eq_u32 s[76:77], 1, v2
    v_cmp_eq_u32 vcc, 2, v2
    ds_read_b128 v[56:59], v9 offset:34816
    v_mfma_f32_16x16x32_bf16 v[32:35], a[172:175], v[60:63], v[32:35]
    s_cmp_eq_u64 s[76:77], -1
    s_cselect_b32 s38, 1, 0
    v_mfma_f32_16x16x32_bf16 v[36:39], a[176:179], v[60:63], v[36:39]
    s_cmp_lg_u32 s38, 0
    s_cselect_b64 exec, 1, 0
    v_mov_b32 v15, s32
    ds_write_b32 v184, v15
    v_mov_b32 v2, 2
    s_mov_b64 exec, -1
    s_waitcnt lgkmcnt(5)
    v_mfma_f32_16x16x32_bf16 v[16:19], a[180:183], v[40:43], v[16:19]
    ds_read_b128 v[60:63], v9 offset:35072
    v_mfma_f32_16x16x32_bf16 v[20:23], a[184:187], v[40:43], v[20:23]
    s_add_u32 s32, s32, s38
    s_mul_i32 s38, s38, 22528
    s_add_u32 s33, s33, s38
    v_mfma_f32_16x16x32_bf16 v[24:27], a[188:191], v[40:43], v[24:27]
    s_cmp_eq_u64 vcc, 0
    s_cselect_b32 s38, s32, 0x7fff
    s_waitcnt lgkmcnt(5)
    v_mfma_f32_16x16x32_bf16 v[28:31], a[180:183], v[44:47], v[28:31]
    s_cmp_le_u32 s38, s39
    s_cselect_b64 exec, -1, 0
    v_mov_b32 v2, 2
    buffer_load_dword v2, v1, s[8:11], s33 offen sc1
    s_mov_b64 exec, -1
    v_mfma_f32_16x16x32_bf16 v[32:35], a[184:187], v[44:47], v[32:35]
    v_mfma_f32_16x16x32_bf16 v[36:39], a[188:191], v[44:47], v[36:39]
    s_waitcnt lgkmcnt(4)
    v_mfma_f32_16x16x32_bf16 v[16:19], a[192:195], v[48:51], v[16:19]
    v_mfma_f32_16x16x32_bf16 v[20:23], a[196:199], v[48:51], v[20:23]
    v_mfma_f32_16x16x32_bf16 v[24:27], a[200:203], v[48:51], v[24:27]
    s_waitcnt lgkmcnt(3)
    v_mfma_f32_16x16x32_bf16 v[28:31], a[192:195], v[52:55], v[28:31]
    v_mfma_f32_16x16x32_bf16 v[32:35], a[196:199], v[52:55], v[32:35]
    v_mfma_f32_16x16x32_bf16 v[36:39], a[200:203], v[52:55], v[36:39]
    s_waitcnt lgkmcnt(2)
    v_mfma_f32_16x16x32_bf16 v[16:19], a[204:207], v[56:59], v[16:19]
    v_mfma_f32_16x16x32_bf16 v[20:23], a[208:211], v[56:59], v[20:23]
    v_mfma_f32_16x16x32_bf16 v[24:27], a[212:215], v[56:59], v[24:27]
    s_waitcnt lgkmcnt(0)
    v_mfma_f32_16x16x32_bf16 v[28:31], a[204:207], v[60:63], v[28:31]
    v_mfma_f32_16x16x32_bf16 v[32:35], a[208:211], v[60:63], v[32:35]
    v_mfma_f32_16x16x32_bf16 v[36:39], a[212:215], v[60:63], v[36:39]
    v_mov_b32 v88, 0x3f803f80
    v_cvt_pk_bf16_f32 v96, v16, v17
    v_cvt_pk_bf16_f32 v97, v18, v19
    v_cvt_pk_bf16_f32 v98, v20, v21
    v_cvt_pk_bf16_f32 v99, v22, v23
    v_cvt_pk_bf16_f32 v100, v24, v25
    v_cvt_pk_bf16_f32 v101, v26, v27
    buffer_store_dwordx4 v[96:99], v10, s[8:11], s46 offen offset:0 sc1
    buffer_store_dwordx2 v[100:101], v12, s[8:11], s46 offen offset:0 sc1
    v_cvt_pk_bf16_f32 v104, v28, v29
    v_cvt_pk_bf16_f32 v105, v30, v31
    v_cvt_pk_bf16_f32 v106, v32, v33
    v_cvt_pk_bf16_f32 v107, v34, v35
    v_cvt_pk_bf16_f32 v108, v36, v37
    v_cvt_pk_bf16_f32 v109, v38, v39
    buffer_store_dwordx4 v[104:107], v10, s[8:11], s46 offen offset:256 sc1
    buffer_store_dwordx2 v[108:109], v12, s[8:11], s46 offen offset:256 sc1
    v_mov_b32 v80, 0
    v_mov_b32 v81, 0
    v_mov_b32 v84, 0
    v_mov_b32 v85, 0
    v_dot2c_f32_bf16 v80, v96, v88
    v_dot2c_f32_bf16 v81, v96, v96
    v_dot2c_f32_bf16 v84, v104, v88
    v_dot2c_f32_bf16 v85, v104, v104
    v_dot2c_f32_bf16 v80, v97, v88
    v_dot2c_f32_bf16 v81, v97, v97
    v_dot2c_f32_bf16 v84, v105, v88
    v_dot2c_f32_bf16 v85, v105, v105
    v_dot2c_f32_bf16 v80, v98, v88
    v_dot2c_f32_bf16 v81, v98, v98
    v_dot2c_f32_bf16 v84, v106, v88
    v_dot2c_f32_bf16 v85, v106, v106
    v_dot2c_f32_bf16 v80, v99, v88
    v_dot2c_f32_bf16 v81, v99, v99
    v_dot2c_f32_bf16 v84, v107, v88
    v_dot2c_f32_bf16 v85, v107, v107
    v_dot2c_f32_bf16 v80, v100, v88
    v_dot2c_f32_bf16 v81, v100, v100
    v_dot2c_f32_bf16 v84, v108, v88
    v_dot2c_f32_bf16 v85, v108, v108
    v_dot2c_f32_bf16 v80, v101, v88
    v_dot2c_f32_bf16 v81, v101, v101
    v_dot2c_f32_bf16 v84, v109, v88
    v_dot2c_f32_bf16 v85, v109, v109
    s_nop 2
    v_mov_b32 v82, v80
    v_mov_b32 v83, v81
    v_mov_b32 v86, v84
    v_mov_b32 v87, v85
    v_permlane32_swap_b32 v80, v82
    v_permlane32_swap_b32 v81, v83
    v_permlane32_swap_b32 v84, v86
    v_permlane32_swap_b32 v85, v87
    v_add_f32 v80, v80, v82
    v_add_f32 v81, v81, v83
    v_add_f32 v84, v84, v86
    v_add_f32 v85, v85, v87
    v_mov_b32 v82, v80
    v_mov_b32 v83, v81
    v_mov_b32 v86, v84
    v_mov_b32 v87, v85
    v_permlane16_swap_b32 v80, v82
    v_permlane16_swap_b32 v81, v83
    v_permlane16_swap_b32 v84, v86
    v_permlane16_swap_b32 v85, v87
    v_add_f32 v80, v80, v82
    v_add_f32 v81, v81, v83
    v_add_f32 v84, v84, v86
    v_add_f32 v85, v85, v87
    s_mov_b64 exec, 0xffff
    buffer_store_dwordx2 v[80:81], v11, s[8:11], s52 offen offset:0 sc1
    buffer_store_dwordx2 v[84:85], v11, s[8:11], s52 offen offset:256 sc1
    s_mov_b64 exec, -1
    s_mul_i32 s43, s57, 22528
    s_add_u32 s43, s43, s49
    s_branch Lawo_head
Lawo_none:
    ds_read_b32 v15, v184
    s_waitcnt lgkmcnt(0)
    v_readfirstlane_b32 s17, v15
    s_nop 0
    s_cmp_lt_i32 s17, s37
    s_cbranch_scc1 Lawo_nopost
    s_add_u32 m0, s59, 0
    s_add_u32 s47, s41, 0
    buffer_load_dwordx4 v0, s[8:11], s47 offen offset:0 lds
    buffer_load_dwordx4 v0, s[8:11], s47 offen offset:1024 lds
    buffer_load_dwordx4 v0, s[8:11], s47 offen offset:2048 lds
    buffer_load_dwordx4 v0, s[8:11], s47 offen offset:3072 lds
    s_add_u32 m0, s59, 4096
    s_add_u32 s47, s41, 4096
    buffer_load_dwordx4 v0, s[8:11], s47 offen offset:0 lds
    buffer_load_dwordx4 v0, s[8:11], s47 offen offset:1024 lds
    buffer_load_dwordx4 v0, s[8:11], s47 offen offset:2048 lds
    buffer_load_dwordx4 v0, s[8:11], s47 offen offset:3072 lds
    s_add_u32 m0, s59, 8192
    s_add_u32 s47, s41, 8192
    buffer_load_dwordx4 v0, s[8:11], s47 offen offset:0 lds
    s_mul_i32 s48, s36, 4718592
    s_mul_i32 s18, s37, 36864
    s_add_u32 s48, s48, s18
    s_add_u32 s48, s48, 6291456
    buffer_load_dwordx4 v[64:67], v10, s[8:11], s48 offen offset:0
    buffer_load_dwordx2 v[68:69], v12, s[8:11], s48 offen offset:0
    buffer_load_dwordx4 v[72:75], v10, s[8:11], s48 offen offset:256
    buffer_load_dwordx2 v[76:77], v12, s[8:11], s48 offen offset:256
    s_waitcnt vmcnt(13)
    s_cmp_lg_u32 s43, 0
    s_cselect_b64 exec, 1, 0
    buffer_store_dword v3, v4, s[8:11], s43 offen sc1
    s_mov_b64 exec, -1
    s_mov_b32 s43, 0
    s_waitcnt vmcnt(1) lgkmcnt(0)
    s_branch Lawo_head2
Lawo_nopost:
    s_waitcnt vmcnt(0)
    s_cmp_lg_u32 s43, 0
    s_cselect_b64 exec, 1, 0
    buffer_store_dword v3, v4, s[8:11], s43 offen sc1
    s_mov_b64 exec, -1
    s_mov_b32 s43, 0
    s_cmp_ge_u32 s37, 64
    s_cbranch_scc1 Lawo_end
Lawo_wait:
    s_mov_b32 s16, 0
    s_cmp_lg_u32 s14, 0
    s_cbranch_scc1 Lawo_wl
Lawo_wp:
    buffer_load_dword v2, v1, s[8:11], s60 offen sc1
    s_add_u32 s16, s16, 1
    s_cmp_gt_u32 s16, 100000
    s_cbranch_scc1 Lawo_giveup
    s_waitcnt vmcnt(0)
    v_cmp_eq_u32 vcc, 0, v2
    s_nop 0
    s_cbranch_vccz Lawo_wok
    s_sleep 4
    s_branch Lawo_wp
Lawo_giveup:
    v_mov_b32 v5, -2
    ds_write_b32 v184, v5
    s_waitcnt lgkmcnt(0)
    s_branch L_role_awo_abort
Lawo_wok:
    v_mov_b32 v5, s37
    ds_write_b32 v184, v5
    s_branch Lawo_go
Lawo_wl:
    ds_read_b32 v15, v184
    s_add_u32 s16, s16, 1
    s_cmp_gt_u32 s16, 1600000
    s_cbranch_scc1 L_role_awo_abort
    s_waitcnt lgkmcnt(0)
    v_readfirstlane_b32 s17, v15
    s_nop 0
    s_cmp_eq_u32 s17, -2
    s_cbranch_scc1 L_role_awo_abort
    s_cmp_ge_i32 s17, s37
    s_cbranch_scc1 Lawo_go
    s_sleep 1
    s_branch Lawo_wl
Lawo_go:
    s_add_u32 m0, s59, 0
    s_add_u32 s47, s41, 0
    buffer_load_dwordx4 v0, s[8:11], s47 offen offset:0 lds
    buffer_load_dwordx4 v0, s[8:11], s47 offen offset:1024 lds
    buffer_load_dwordx4 v0, s[8:11], s47 offen offset:2048 lds
    buffer_load_dwordx4 v0, s[8:11], s47 offen offset:3072 lds
    s_add_u32 m0, s59, 4096
    s_add_u32 s47, s41, 4096
    buffer_load_dwordx4 v0, s[8:11], s47 offen offset:0 lds
    buffer_load_dwordx4 v0, s[8:11], s47 offen offset:1024 lds
    buffer_load_dwordx4 v0, s[8:11], s47 offen offset:2048 lds
    buffer_load_dwordx4 v0, s[8:11], s47 offen offset:3072 lds
    s_add_u32 m0, s59, 8192
    s_add_u32 s47, s41, 8192
    buffer_load_dwordx4 v0, s[8:11], s47 offen offset:0 lds
    s_mul_i32 s48, s36, 4718592
    s_mul_i32 s18, s37, 36864
    s_add_u32 s48, s48, s18
    s_add_u32 s48, s48, 6291456
    buffer_load_dwordx4 v[64:67], v10, s[8:11], s48 offen offset:0
    buffer_load_dwordx2 v[68:69], v12, s[8:11], s48 offen offset:0
    buffer_load_dwordx4 v[72:75], v10, s[8:11], s48 offen offset:256
    buffer_load_dwordx2 v[76:77], v12, s[8:11], s48 offen offset:256
    s_waitcnt vmcnt(0) lgkmcnt(0)
    s_branch Lawo_head2
Lawo_end:
    s_branch L_role_awo_exit
L_role_awo_abort:
    s_waitcnt lgkmcnt(0)
    s_mov_b64 exec, -1
    v_mov_b32 v0, 60
    s_lshl_b32 s5, s3, 8
    s_or_b32 s5, s5, s4
    s_or_b32 s5, s5, 0x10000
    v_mov_b32 v1, s5
    global_store_dword v0, v1, s[12:13]
    s_endpgm
L_role_awo_exit:
    s_endpgm
.p2align 6
L_role_aq:
    v_and_b32 v5, 63, v0
    v_lshlrev_b32 v0, 4, v5
    v_and_b32 v7, 15, v5
    v_lshrrev_b32 v8, 4, v5
    v_min_u32 v1, 47, v5
    v_lshrrev_b32 v6, 2, v1
    v_and_b32 v1, 3, v1
    v_lshlrev_b32 v1, 2, v1
    v_lshl_add_u32 v1, v6, 7, v1
    v_mov_b32 v3, 1
    v_mov_b32 v4, 0
    s_mov_b32 s44, 0x05040100
    s_mov_b32 s45, 0x07060302
    s_lshr_b32 s63, s15, 4
    s_and_b32 s15, s15, 15
    s_lshr_b32 s50, s15, 1
    s_lshl_b32 s50, s50, 2
    s_and_b32 s17, s15, 1
    s_add_u32 s50, s50, s17
    s_and_b32 s17, s14, 2
    s_add_u32 s50, s50, s17
    s_and_b32 s51, s14, 1
    s_cmp_eq_u32 s63, 0
    s_cbranch_scc1 Laq_gate_ng
    s_cmp_lg_u32 s14, 0
    s_cbranch_scc1 Laq_gate_d
    v_mov_b32 v5, 48
    s_mov_b32 s16, 0
Laq_gate:
    global_load_dword v6, v5, s[12:13] sc1
    s_add_u32 s16, s16, 1
    s_cmp_gt_u32 s16, 100000
    s_cbranch_scc1 L_role_aq_abort
    s_waitcnt vmcnt(0)
    v_cmp_gt_u32 vcc, 32, v6
    s_nop 0
    s_cbranch_vccz Laq_gate_d
    s_sleep 100
    s_branch Laq_gate
Laq_gate_d:
    s_barrier
Laq_gate_ng:
    s_load_dwordx2 s[20:21], s[0:1], 8
    s_mov_b32 s22, 1990656
    s_mov_b32 s23, 0x00020000
    s_waitcnt lgkmcnt(0)
    s_and_b32 s21, s21, 0xffff
    v_lshrrev_b32 v5, 7, v0
    v_mul_u32_u24 v16, 3456, v5
    v_and_b32 v5, 0x70, v0
    v_add_u32 v16, v16, v5
    s_lshr_b32 s17, s14, 1
    s_mul_i32 s46, s17, 72
    v_lshrrev_b32 v5, 2, v7
    v_lshl_add_u32 v5, v8, 3, v5
    v_and_b32 v6, 3, v7
    v_lshlrev_b32 v17, 7, v5
    v_lshl_add_u32 v17, v6, 3, v17
    v_add_u32 v17, s46, v17
    v_lshlrev_b32 v18, 5, v5
    v_min_u32 v6, 1, v6
    v_lshl_add_u32 v18, v6, 4, v18
    s_mul_i32 s17, s17, 3072
    s_add_u32 s17, s17, 36864
    v_add_u32 v18, s17, v18
    s_sub_u32 s17, s50, s14
    s_lshr_b32 s17, s14, 1
    s_lshl_b32 s17, s17, 1
    s_sub_u32 s17, s50, s17
    s_mul_i32 s49, s17, 36
    s_mul_i32 s17, s14, 82944
    s_add_u32 s49, s49, s17
    s_mul_i32 s47, s14, 3072
    v_lshrrev_b32 v21, 4, v0
    s_lshl_b32 s17, s14, 6
    v_add_u32 v21, s17, v21
    v_cmp_le_u32 vcc, 96, v21
    s_nop 1
    v_cndmask_b32 v5, 0, 1, vcc
    v_mul_u32_u24 v6, 96, v5
    v_sub_u32 v6, v21, v6
    v_lshlrev_b32 v19, 7, v6
    v_mul_u32_u24 v20, 72, v5
    v_add_u32 v19, v19, v20
    v_add_u32 v19, 32, v19
    v_lshlrev_b32 v20, 5, v21
    v_add_u32 v20, 36864, v20
    v_mov_b32 v24, 0
    v_mov_b32 v25, 0
    v_mov_b32 v26, 0
    v_mov_b32 v27, 0
    v_mov_b32 v31, 0
    s_cmp_eq_u32 s14, 3
    s_cselect_b64 s[76:77], 0, -1
    s_mov_b64 exec, s[76:77]
    v_add_u32 v22, 0, v20
    ds_write_b128 v22, v[24:27] offset:16
    v_add_u32 v22, 43008, v20
    ds_write_b128 v22, v[24:27] offset:16
    v_add_u32 v22, 86016, v20
    ds_write_b128 v22, v[24:27] offset:16
    s_mov_b64 exec, -1
    s_add_u32 m0, s47, 0
    s_add_u32 s17, s49, 0
    buffer_load_dwordx4 v16, s[20:23], s17 offen lds
    s_add_u32 m0, s47, 1024
    s_add_u32 s17, s49, 27648
    buffer_load_dwordx4 v16, s[20:23], s17 offen lds
    s_add_u32 m0, s47, 2048
    s_add_u32 s17, s49, 55296
    buffer_load_dwordx4 v16, s[20:23], s17 offen lds
    s_add_u32 m0, s47, 12288
    s_add_u32 s17, s49, 1152
    buffer_load_dwordx4 v16, s[20:23], s17 offen lds
    s_add_u32 m0, s47, 13312
    s_add_u32 s17, s49, 28800
    buffer_load_dwordx4 v16, s[20:23], s17 offen lds
    s_add_u32 m0, s47, 14336
    s_add_u32 s17, s49, 56448
    buffer_load_dwordx4 v16, s[20:23], s17 offen lds
    s_add_u32 m0, s47, 24576
    s_add_u32 s17, s49, 2304
    buffer_load_dwordx4 v16, s[20:23], s17 offen lds
    s_add_u32 m0, s47, 25600
    s_add_u32 s17, s49, 29952
    buffer_load_dwordx4 v16, s[20:23], s17 offen lds
    s_add_u32 m0, s47, 26624
    s_add_u32 s17, s49, 57600
    buffer_load_dwordx4 v16, s[20:23], s17 offen lds
    s_add_u32 m0, s47, 43008
    s_add_u32 s17, s49, 331776
    buffer_load_dwordx4 v16, s[20:23], s17 offen lds
    s_add_u32 m0, s47, 44032
    s_add_u32 s17, s49, 359424
    buffer_load_dwordx4 v16, s[20:23], s17 offen lds
    s_add_u32 m0, s47, 45056
    s_add_u32 s17, s49, 387072
    buffer_load_dwordx4 v16, s[20:23], s17 offen lds
    s_add_u32 m0, s47, 55296
    s_add_u32 s17, s49, 332928
    buffer_load_dwordx4 v16, s[20:23], s17 offen lds
    s_add_u32 m0, s47, 56320
    s_add_u32 s17, s49, 360576
    buffer_load_dwordx4 v16, s[20:23], s17 offen lds
    s_add_u32 m0, s47, 57344
    s_add_u32 s17, s49, 388224
    buffer_load_dwordx4 v16, s[20:23], s17 offen lds
    s_add_u32 m0, s47, 67584
    s_add_u32 s17, s49, 334080
    buffer_load_dwordx4 v16, s[20:23], s17 offen lds
    s_add_u32 m0, s47, 68608
    s_add_u32 s17, s49, 361728
    buffer_load_dwordx4 v16, s[20:23], s17 offen lds
    s_add_u32 m0, s47, 69632
    s_add_u32 s17, s49, 389376
    buffer_load_dwordx4 v16, s[20:23], s17 offen lds
    s_add_u32 m0, s47, 86016
    s_add_u32 s17, s49, 663552
    buffer_load_dwordx4 v16, s[20:23], s17 offen lds
    s_add_u32 m0, s47, 87040
    s_add_u32 s17, s49, 691200
    buffer_load_dwordx4 v16, s[20:23], s17 offen lds
    s_add_u32 m0, s47, 88064
    s_add_u32 s17, s49, 718848
    buffer_load_dwordx4 v16, s[20:23], s17 offen lds
    s_add_u32 m0, s47, 98304
    s_add_u32 s17, s49, 664704
    buffer_load_dwordx4 v16, s[20:23], s17 offen lds
    s_add_u32 m0, s47, 99328
    s_add_u32 s17, s49, 692352
    buffer_load_dwordx4 v16, s[20:23], s17 offen lds
    s_add_u32 m0, s47, 100352
    s_add_u32 s17, s49, 720000
    buffer_load_dwordx4 v16, s[20:23], s17 offen lds
    s_add_u32 m0, s47, 110592
    s_add_u32 s17, s49, 665856
    buffer_load_dwordx4 v16, s[20:23], s17 offen lds
    s_add_u32 m0, s47, 111616
    s_add_u32 s17, s49, 693504
    buffer_load_dwordx4 v16, s[20:23], s17 offen lds
    s_add_u32 m0, s47, 112640
    s_add_u32 s17, s49, 721152
    buffer_load_dwordx4 v16, s[20:23], s17 offen lds
    s_waitcnt vmcnt(18) lgkmcnt(0)
    s_barrier
    s_mov_b64 exec, s[76:77]
    v_add_u32 v22, 0, v19
    ds_read_b32 v28, v22 offset:0
    ds_read_b32 v29, v22 offset:12288
    ds_read_b32 v30, v22 offset:24576
    s_waitcnt lgkmcnt(0)
    v_add_u32 v22, 0, v20
    ds_write_b128 v22, v[28:31]
    s_mov_b64 exec, -1
    v_add_u32 v22, 0, v17
    v_add_u32 v23, 0, v18
    ds_read_b64_tr_b16 v[152:153], v22 offset:0
    ds_read_b64_tr_b16 v[154:155], v22 offset:512
    ds_read_b64_tr_b16 v[224:225], v22 offset:12288
    ds_read_b64_tr_b16 v[226:227], v22 offset:12800
    ds_read_b64_tr_b16 a[112:113], v22 offset:24576
    ds_read_b64_tr_b16 a[114:115], v22 offset:25088
    ds_read_b64_tr_b16 v[156:157], v22 offset:4096
    ds_read_b64_tr_b16 v[158:159], v22 offset:4608
    ds_read_b64_tr_b16 v[228:229], v22 offset:16384
    ds_read_b64_tr_b16 v[230:231], v22 offset:16896
    ds_read_b64_tr_b16 a[116:117], v22 offset:28672
    ds_read_b64_tr_b16 a[118:119], v22 offset:29184
    ds_read_b64_tr_b16 v[160:161], v22 offset:8192
    ds_read_b64_tr_b16 v[162:163], v22 offset:8704
    ds_read_b64_tr_b16 v[232:233], v22 offset:20480
    ds_read_b64_tr_b16 v[234:235], v22 offset:20992
    ds_read_b64_tr_b16 a[120:121], v22 offset:32768
    ds_read_b64_tr_b16 a[122:123], v22 offset:33280
    s_waitcnt lgkmcnt(0)
    s_barrier
    ds_read_b64_tr_b16 a[40:41], v23 offset:0
    ds_read_b64_tr_b16 a[42:43], v23 offset:128
    ds_read_b64_tr_b16 a[184:185], v23 offset:8
    ds_read_b64_tr_b16 a[186:187], v23 offset:136
    ds_read_b64_tr_b16 a[44:45], v23 offset:1024
    ds_read_b64_tr_b16 a[46:47], v23 offset:1152
    ds_read_b64_tr_b16 a[188:189], v23 offset:1032
    ds_read_b64_tr_b16 a[190:191], v23 offset:1160
    ds_read_b64_tr_b16 a[48:49], v23 offset:2048
    ds_read_b64_tr_b16 a[50:51], v23 offset:2176
    ds_read_b64_tr_b16 a[192:193], v23 offset:2056
    ds_read_b64_tr_b16 a[194:195], v23 offset:2184
    s_waitcnt vmcnt(9) lgkmcnt(0)
    s_barrier
    s_add_u32 m0, s47, 0
    s_add_u32 s17, s49, 995328
    buffer_load_dwordx4 v16, s[20:23], s17 offen lds
    s_add_u32 m0, s47, 1024
    s_add_u32 s17, s49, 1022976
    buffer_load_dwordx4 v16, s[20:23], s17 offen lds
    s_add_u32 m0, s47, 2048
    s_add_u32 s17, s49, 1050624
    buffer_load_dwordx4 v16, s[20:23], s17 offen lds
    s_add_u32 m0, s47, 12288
    s_add_u32 s17, s49, 996480
    buffer_load_dwordx4 v16, s[20:23], s17 offen lds
    s_add_u32 m0, s47, 13312
    s_add_u32 s17, s49, 1024128
    buffer_load_dwordx4 v16, s[20:23], s17 offen lds
    s_add_u32 m0, s47, 14336
    s_add_u32 s17, s49, 1051776
    buffer_load_dwordx4 v16, s[20:23], s17 offen lds
    s_add_u32 m0, s47, 24576
    s_add_u32 s17, s49, 997632
    buffer_load_dwordx4 v16, s[20:23], s17 offen lds
    s_add_u32 m0, s47, 25600
    s_add_u32 s17, s49, 1025280
    buffer_load_dwordx4 v16, s[20:23], s17 offen lds
    s_add_u32 m0, s47, 26624
    s_add_u32 s17, s49, 1052928
    buffer_load_dwordx4 v16, s[20:23], s17 offen lds
    s_mov_b64 exec, s[76:77]
    v_add_u32 v22, 43008, v19
    ds_read_b32 v28, v22 offset:0
    ds_read_b32 v29, v22 offset:12288
    ds_read_b32 v30, v22 offset:24576
    s_waitcnt lgkmcnt(0)
    v_add_u32 v22, 43008, v20
    ds_write_b128 v22, v[28:31]
    s_mov_b64 exec, -1
    v_add_u32 v22, 43008, v17
    v_add_u32 v23, 43008, v18
    ds_read_b64_tr_b16 v[164:165], v22 offset:0
    ds_read_b64_tr_b16 v[166:167], v22 offset:512
    ds_read_b64_tr_b16 v[236:237], v22 offset:12288
    ds_read_b64_tr_b16 v[238:239], v22 offset:12800
    ds_read_b64_tr_b16 a[124:125], v22 offset:24576
    ds_read_b64_tr_b16 a[126:127], v22 offset:25088
    ds_read_b64_tr_b16 v[168:169], v22 offset:4096
    ds_read_b64_tr_b16 v[170:171], v22 offset:4608
    ds_read_b64_tr_b16 v[240:241], v22 offset:16384
    ds_read_b64_tr_b16 v[242:243], v22 offset:16896
    ds_read_b64_tr_b16 a[128:129], v22 offset:28672
    ds_read_b64_tr_b16 a[130:131], v22 offset:29184
    ds_read_b64_tr_b16 v[172:173], v22 offset:8192
    ds_read_b64_tr_b16 v[174:175], v22 offset:8704
    ds_read_b64_tr_b16 v[244:245], v22 offset:20480
    ds_read_b64_tr_b16 v[246:247], v22 offset:20992
    ds_read_b64_tr_b16 a[132:133], v22 offset:32768
    ds_read_b64_tr_b16 a[134:135], v22 offset:33280
    s_waitcnt lgkmcnt(0)
    s_barrier
    ds_read_b64_tr_b16 a[52:53], v23 offset:0
    ds_read_b64_tr_b16 a[54:55], v23 offset:128
    ds_read_b64_tr_b16 a[196:197], v23 offset:8
    ds_read_b64_tr_b16 a[198:199], v23 offset:136
    ds_read_b64_tr_b16 a[56:57], v23 offset:1024
    ds_read_b64_tr_b16 a[58:59], v23 offset:1152
    ds_read_b64_tr_b16 a[200:201], v23 offset:1032
    ds_read_b64_tr_b16 a[202:203], v23 offset:1160
    ds_read_b64_tr_b16 a[60:61], v23 offset:2048
    ds_read_b64_tr_b16 a[62:63], v23 offset:2176
    ds_read_b64_tr_b16 a[204:205], v23 offset:2056
    ds_read_b64_tr_b16 a[206:207], v23 offset:2184
    s_waitcnt vmcnt(9) lgkmcnt(0)
    s_barrier
    s_add_u32 m0, s47, 43008
    s_add_u32 s17, s49, 1327104
    buffer_load_dwordx4 v16, s[20:23], s17 offen lds
    s_add_u32 m0, s47, 44032
    s_add_u32 s17, s49, 1354752
    buffer_load_dwordx4 v16, s[20:23], s17 offen lds
    s_add_u32 m0, s47, 45056
    s_add_u32 s17, s49, 1382400
    buffer_load_dwordx4 v16, s[20:23], s17 offen lds
    s_add_u32 m0, s47, 55296
    s_add_u32 s17, s49, 1328256
    buffer_load_dwordx4 v16, s[20:23], s17 offen lds
    s_add_u32 m0, s47, 56320
    s_add_u32 s17, s49, 1355904
    buffer_load_dwordx4 v16, s[20:23], s17 offen lds
    s_add_u32 m0, s47, 57344
    s_add_u32 s17, s49, 1383552
    buffer_load_dwordx4 v16, s[20:23], s17 offen lds
    s_add_u32 m0, s47, 67584
    s_add_u32 s17, s49, 1329408
    buffer_load_dwordx4 v16, s[20:23], s17 offen lds
    s_add_u32 m0, s47, 68608
    s_add_u32 s17, s49, 1357056
    buffer_load_dwordx4 v16, s[20:23], s17 offen lds
    s_add_u32 m0, s47, 69632
    s_add_u32 s17, s49, 1384704
    buffer_load_dwordx4 v16, s[20:23], s17 offen lds
    s_mov_b64 exec, s[76:77]
    v_add_u32 v22, 86016, v19
    ds_read_b32 v28, v22 offset:0
    ds_read_b32 v29, v22 offset:12288
    ds_read_b32 v30, v22 offset:24576
    s_waitcnt lgkmcnt(0)
    v_add_u32 v22, 86016, v20
    ds_write_b128 v22, v[28:31]
    s_mov_b64 exec, -1
    v_add_u32 v22, 86016, v17
    v_add_u32 v23, 86016, v18
    ds_read_b64_tr_b16 v[176:177], v22 offset:0
    ds_read_b64_tr_b16 v[178:179], v22 offset:512
    ds_read_b64_tr_b16 v[248:249], v22 offset:12288
    ds_read_b64_tr_b16 v[250:251], v22 offset:12800
    ds_read_b64_tr_b16 a[136:137], v22 offset:24576
    ds_read_b64_tr_b16 a[138:139], v22 offset:25088
    ds_read_b64_tr_b16 v[180:181], v22 offset:4096
    ds_read_b64_tr_b16 v[182:183], v22 offset:4608
    ds_read_b64_tr_b16 v[252:253], v22 offset:16384
    ds_read_b64_tr_b16 v[254:255], v22 offset:16896
    ds_read_b64_tr_b16 a[140:141], v22 offset:28672
    ds_read_b64_tr_b16 a[142:143], v22 offset:29184
    ds_read_b64_tr_b16 v[184:185], v22 offset:8192
    ds_read_b64_tr_b16 v[186:187], v22 offset:8704
    ds_read_b64_tr_b16 a[0:1], v22 offset:20480
    ds_read_b64_tr_b16 a[2:3], v22 offset:20992
    ds_read_b64_tr_b16 a[144:145], v22 offset:32768
    ds_read_b64_tr_b16 a[146:147], v22 offset:33280
    s_waitcnt lgkmcnt(0)
    s_barrier
    ds_read_b64_tr_b16 a[64:65], v23 offset:0
    ds_read_b64_tr_b16 a[66:67], v23 offset:128
    ds_read_b64_tr_b16 a[208:209], v23 offset:8
    ds_read_b64_tr_b16 a[210:211], v23 offset:136
    ds_read_b64_tr_b16 a[68:69], v23 offset:1024
    ds_read_b64_tr_b16 a[70:71], v23 offset:1152
    ds_read_b64_tr_b16 a[212:213], v23 offset:1032
    ds_read_b64_tr_b16 a[214:215], v23 offset:1160
    ds_read_b64_tr_b16 a[72:73], v23 offset:2048
    ds_read_b64_tr_b16 a[74:75], v23 offset:2176
    ds_read_b64_tr_b16 a[216:217], v23 offset:2056
    ds_read_b64_tr_b16 a[218:219], v23 offset:2184
    s_waitcnt vmcnt(9) lgkmcnt(0)
    s_barrier
    s_add_u32 m0, s47, 86016
    s_add_u32 s17, s49, 1658880
    buffer_load_dwordx4 v16, s[20:23], s17 offen lds
    s_add_u32 m0, s47, 87040
    s_add_u32 s17, s49, 1686528
    buffer_load_dwordx4 v16, s[20:23], s17 offen lds
    s_add_u32 m0, s47, 88064
    s_add_u32 s17, s49, 1714176
    buffer_load_dwordx4 v16, s[20:23], s17 offen lds
    s_add_u32 m0, s47, 98304
    s_add_u32 s17, s49, 1660032
    buffer_load_dwordx4 v16, s[20:23], s17 offen lds
    s_add_u32 m0, s47, 99328
    s_add_u32 s17, s49, 1687680
    buffer_load_dwordx4 v16, s[20:23], s17 offen lds
    s_add_u32 m0, s47, 100352
    s_add_u32 s17, s49, 1715328
    buffer_load_dwordx4 v16, s[20:23], s17 offen lds
    s_add_u32 m0, s47, 110592
    s_add_u32 s17, s49, 1661184
    buffer_load_dwordx4 v16, s[20:23], s17 offen lds
    s_add_u32 m0, s47, 111616
    s_add_u32 s17, s49, 1688832
    buffer_load_dwordx4 v16, s[20:23], s17 offen lds
    s_add_u32 m0, s47, 112640
    s_add_u32 s17, s49, 1716480
    buffer_load_dwordx4 v16, s[20:23], s17 offen lds
    s_mov_b64 exec, s[76:77]
    v_add_u32 v22, 0, v19
    ds_read_b32 v28, v22 offset:0
    ds_read_b32 v29, v22 offset:12288
    ds_read_b32 v30, v22 offset:24576
    s_waitcnt lgkmcnt(0)
    v_add_u32 v22, 0, v20
    ds_write_b128 v22, v[28:31]
    s_mov_b64 exec, -1
    v_add_u32 v22, 0, v17
    v_add_u32 v23, 0, v18
    ds_read_b64_tr_b16 v[188:189], v22 offset:0
    ds_read_b64_tr_b16 v[190:191], v22 offset:512
    ds_read_b64_tr_b16 a[4:5], v22 offset:12288
    ds_read_b64_tr_b16 a[6:7], v22 offset:12800
    ds_read_b64_tr_b16 a[148:149], v22 offset:24576
    ds_read_b64_tr_b16 a[150:151], v22 offset:25088
    ds_read_b64_tr_b16 v[192:193], v22 offset:4096
    ds_read_b64_tr_b16 v[194:195], v22 offset:4608
    ds_read_b64_tr_b16 a[8:9], v22 offset:16384
    ds_read_b64_tr_b16 a[10:11], v22 offset:16896
    ds_read_b64_tr_b16 a[152:153], v22 offset:28672
    ds_read_b64_tr_b16 a[154:155], v22 offset:29184
    ds_read_b64_tr_b16 v[196:197], v22 offset:8192
    ds_read_b64_tr_b16 v[198:199], v22 offset:8704
    ds_read_b64_tr_b16 a[12:13], v22 offset:20480
    ds_read_b64_tr_b16 a[14:15], v22 offset:20992
    ds_read_b64_tr_b16 a[156:157], v22 offset:32768
    ds_read_b64_tr_b16 a[158:159], v22 offset:33280
    s_waitcnt lgkmcnt(0)
    s_barrier
    ds_read_b64_tr_b16 a[76:77], v23 offset:0
    ds_read_b64_tr_b16 a[78:79], v23 offset:128
    ds_read_b64_tr_b16 a[220:221], v23 offset:8
    ds_read_b64_tr_b16 a[222:223], v23 offset:136
    ds_read_b64_tr_b16 a[80:81], v23 offset:1024
    ds_read_b64_tr_b16 a[82:83], v23 offset:1152
    ds_read_b64_tr_b16 a[224:225], v23 offset:1032
    ds_read_b64_tr_b16 a[226:227], v23 offset:1160
    ds_read_b64_tr_b16 a[84:85], v23 offset:2048
    ds_read_b64_tr_b16 a[86:87], v23 offset:2176
    ds_read_b64_tr_b16 a[228:229], v23 offset:2056
    ds_read_b64_tr_b16 a[230:231], v23 offset:2184
    s_waitcnt vmcnt(9) lgkmcnt(0)
    s_barrier
    s_mov_b64 exec, s[76:77]
    v_add_u32 v22, 43008, v19
    ds_read_b32 v28, v22 offset:0
    ds_read_b32 v29, v22 offset:12288
    ds_read_b32 v30, v22 offset:24576
    s_waitcnt lgkmcnt(0)
    v_add_u32 v22, 43008, v20
    ds_write_b128 v22, v[28:31]
    s_mov_b64 exec, -1
    v_add_u32 v22, 43008, v17
    v_add_u32 v23, 43008, v18
    ds_read_b64_tr_b16 v[200:201], v22 offset:0
    ds_read_b64_tr_b16 v[202:203], v22 offset:512
    ds_read_b64_tr_b16 a[16:17], v22 offset:12288
    ds_read_b64_tr_b16 a[18:19], v22 offset:12800
    ds_read_b64_tr_b16 a[160:161], v22 offset:24576
    ds_read_b64_tr_b16 a[162:163], v22 offset:25088
    ds_read_b64_tr_b16 v[204:205], v22 offset:4096
    ds_read_b64_tr_b16 v[206:207], v22 offset:4608
    ds_read_b64_tr_b16 a[20:21], v22 offset:16384
    ds_read_b64_tr_b16 a[22:23], v22 offset:16896
    ds_read_b64_tr_b16 a[164:165], v22 offset:28672
    ds_read_b64_tr_b16 a[166:167], v22 offset:29184
    ds_read_b64_tr_b16 v[208:209], v22 offset:8192
    ds_read_b64_tr_b16 v[210:211], v22 offset:8704
    ds_read_b64_tr_b16 a[24:25], v22 offset:20480
    ds_read_b64_tr_b16 a[26:27], v22 offset:20992
    ds_read_b64_tr_b16 a[168:169], v22 offset:32768
    ds_read_b64_tr_b16 a[170:171], v22 offset:33280
    s_waitcnt lgkmcnt(0)
    s_barrier
    ds_read_b64_tr_b16 a[88:89], v23 offset:0
    ds_read_b64_tr_b16 a[90:91], v23 offset:128
    ds_read_b64_tr_b16 a[232:233], v23 offset:8
    ds_read_b64_tr_b16 a[234:235], v23 offset:136
    ds_read_b64_tr_b16 a[92:93], v23 offset:1024
    ds_read_b64_tr_b16 a[94:95], v23 offset:1152
    ds_read_b64_tr_b16 a[236:237], v23 offset:1032
    ds_read_b64_tr_b16 a[238:239], v23 offset:1160
    ds_read_b64_tr_b16 a[96:97], v23 offset:2048
    ds_read_b64_tr_b16 a[98:99], v23 offset:2176
    ds_read_b64_tr_b16 a[240:241], v23 offset:2056
    ds_read_b64_tr_b16 a[242:243], v23 offset:2184
    s_waitcnt vmcnt(0) lgkmcnt(0)
    s_barrier
    s_mov_b64 exec, s[76:77]
    v_add_u32 v22, 86016, v19
    ds_read_b32 v28, v22 offset:0
    ds_read_b32 v29, v22 offset:12288
    ds_read_b32 v30, v22 offset:24576
    s_waitcnt lgkmcnt(0)
    v_add_u32 v22, 86016, v20
    ds_write_b128 v22, v[28:31]
    s_mov_b64 exec, -1
    v_add_u32 v22, 86016, v17
    v_add_u32 v23, 86016, v18
    ds_read_b64_tr_b16 v[212:213], v22 offset:0
    ds_read_b64_tr_b16 v[214:215], v22 offset:512
    ds_read_b64_tr_b16 a[28:29], v22 offset:12288
    ds_read_b64_tr_b16 a[30:31], v22 offset:12800
    ds_read_b64_tr_b16 a[172:173], v22 offset:24576
    ds_read_b64_tr_b16 a[174:175], v22 offset:25088
    ds_read_b64_tr_b16 v[216:217], v22 offset:4096
    ds_read_b64_tr_b16 v[218:219], v22 offset:4608
    ds_read_b64_tr_b16 a[32:33], v22 offset:16384
    ds_read_b64_tr_b16 a[34:35], v22 offset:16896
    ds_read_b64_tr_b16 a[176:177], v22 offset:28672
    ds_read_b64_tr_b16 a[178:179], v22 offset:29184
    ds_read_b64_tr_b16 v[220:221], v22 offset:8192
    ds_read_b64_tr_b16 v[222:223], v22 offset:8704
    ds_read_b64_tr_b16 a[36:37], v22 offset:20480
    ds_read_b64_tr_b16 a[38:39], v22 offset:20992
    ds_read_b64_tr_b16 a[180:181], v22 offset:32768
    ds_read_b64_tr_b16 a[182:183], v22 offset:33280
    s_waitcnt lgkmcnt(0)
    s_barrier
    ds_read_b64_tr_b16 a[100:101], v23 offset:0
    ds_read_b64_tr_b16 a[102:103], v23 offset:128
    ds_read_b64_tr_b16 a[244:245], v23 offset:8
    ds_read_b64_tr_b16 a[246:247], v23 offset:136
    ds_read_b64_tr_b16 a[104:105], v23 offset:1024
    ds_read_b64_tr_b16 a[106:107], v23 offset:1152
    ds_read_b64_tr_b16 a[248:249], v23 offset:1032
    ds_read_b64_tr_b16 a[250:251], v23 offset:1160
    ds_read_b64_tr_b16 a[108:109], v23 offset:2048
    ds_read_b64_tr_b16 a[110:111], v23 offset:2176
    ds_read_b64_tr_b16 a[252:253], v23 offset:2056
    ds_read_b64_tr_b16 a[254:255], v23 offset:2184
    s_waitcnt lgkmcnt(0)
    s_barrier
    v_mov_b32 v56, 0x3f803f80
    v_mov_b32 v57, 0x3f803f80
    v_mov_b32 v58, 0x3f803f80
    v_mov_b32 v59, 0x3f803f80
    s_nop 1
    v_mfma_f32_16x16x32_bf16 v[36:39], v[152:155], v[56:59], 0
    v_mfma_f32_16x16x32_bf16 v[40:43], v[224:227], v[56:59], 0
    v_mfma_f32_16x16x32_bf16 v[44:47], a[40:43], v[56:59], 0
    v_mfma_f32_16x16x32_bf16 v[48:51], v[56:59], a[112:115], 0
    v_mfma_f32_16x16x32_bf16 v[52:55], v[56:59], a[184:187], 0
    v_mfma_f32_16x16x32_bf16 v[36:39], v[156:159], v[56:59], v[36:39]
    v_mfma_f32_16x16x32_bf16 v[40:43], v[228:231], v[56:59], v[40:43]
    v_mfma_f32_16x16x32_bf16 v[44:47], a[44:47], v[56:59], v[44:47]
    v_mfma_f32_16x16x32_bf16 v[48:51], v[56:59], a[116:119], v[48:51]
    v_mfma_f32_16x16x32_bf16 v[52:55], v[56:59], a[188:191], v[52:55]
    v_mfma_f32_16x16x32_bf16 v[36:39], v[160:163], v[56:59], v[36:39]
    v_mfma_f32_16x16x32_bf16 v[40:43], v[232:235], v[56:59], v[40:43]
    v_mfma_f32_16x16x32_bf16 v[44:47], a[48:51], v[56:59], v[44:47]
    v_mfma_f32_16x16x32_bf16 v[48:51], v[56:59], a[120:123], v[48:51]
    v_mfma_f32_16x16x32_bf16 v[52:55], v[56:59], a[192:195], v[52:55]
    v_mfma_f32_16x16x32_bf16 v[36:39], v[164:167], v[56:59], v[36:39]
    v_mfma_f32_16x16x32_bf16 v[40:43], v[236:239], v[56:59], v[40:43]
    v_mfma_f32_16x16x32_bf16 v[44:47], a[52:55], v[56:59], v[44:47]
    v_mfma_f32_16x16x32_bf16 v[48:51], v[56:59], a[124:127], v[48:51]
    v_mfma_f32_16x16x32_bf16 v[52:55], v[56:59], a[196:199], v[52:55]
    v_mfma_f32_16x16x32_bf16 v[36:39], v[168:171], v[56:59], v[36:39]
    v_mfma_f32_16x16x32_bf16 v[40:43], v[240:243], v[56:59], v[40:43]
    v_mfma_f32_16x16x32_bf16 v[44:47], a[56:59], v[56:59], v[44:47]
    v_mfma_f32_16x16x32_bf16 v[48:51], v[56:59], a[128:131], v[48:51]
    v_mfma_f32_16x16x32_bf16 v[52:55], v[56:59], a[200:203], v[52:55]
    v_mfma_f32_16x16x32_bf16 v[36:39], v[172:175], v[56:59], v[36:39]
    v_mfma_f32_16x16x32_bf16 v[40:43], v[244:247], v[56:59], v[40:43]
    v_mfma_f32_16x16x32_bf16 v[44:47], a[60:63], v[56:59], v[44:47]
    v_mfma_f32_16x16x32_bf16 v[48:51], v[56:59], a[132:135], v[48:51]
    v_mfma_f32_16x16x32_bf16 v[52:55], v[56:59], a[204:207], v[52:55]
    v_mfma_f32_16x16x32_bf16 v[36:39], v[176:179], v[56:59], v[36:39]
    v_mfma_f32_16x16x32_bf16 v[40:43], v[248:251], v[56:59], v[40:43]
    v_mfma_f32_16x16x32_bf16 v[44:47], a[64:67], v[56:59], v[44:47]
    v_mfma_f32_16x16x32_bf16 v[48:51], v[56:59], a[136:139], v[48:51]
    v_mfma_f32_16x16x32_bf16 v[52:55], v[56:59], a[208:211], v[52:55]
    v_mfma_f32_16x16x32_bf16 v[36:39], v[180:183], v[56:59], v[36:39]
    v_mfma_f32_16x16x32_bf16 v[40:43], v[252:255], v[56:59], v[40:43]
    v_mfma_f32_16x16x32_bf16 v[44:47], a[68:71], v[56:59], v[44:47]
    v_mfma_f32_16x16x32_bf16 v[48:51], v[56:59], a[140:143], v[48:51]
    v_mfma_f32_16x16x32_bf16 v[52:55], v[56:59], a[212:215], v[52:55]
    v_mfma_f32_16x16x32_bf16 v[36:39], v[184:187], v[56:59], v[36:39]
    v_mfma_f32_16x16x32_bf16 v[40:43], a[0:3], v[56:59], v[40:43]
    v_mfma_f32_16x16x32_bf16 v[44:47], a[72:75], v[56:59], v[44:47]
    v_mfma_f32_16x16x32_bf16 v[48:51], v[56:59], a[144:147], v[48:51]
    v_mfma_f32_16x16x32_bf16 v[52:55], v[56:59], a[216:219], v[52:55]
    v_mfma_f32_16x16x32_bf16 v[36:39], v[188:191], v[56:59], v[36:39]
    v_mfma_f32_16x16x32_bf16 v[40:43], a[4:7], v[56:59], v[40:43]
    v_mfma_f32_16x16x32_bf16 v[44:47], a[76:79], v[56:59], v[44:47]
    v_mfma_f32_16x16x32_bf16 v[48:51], v[56:59], a[148:151], v[48:51]
    v_mfma_f32_16x16x32_bf16 v[52:55], v[56:59], a[220:223], v[52:55]
    v_mfma_f32_16x16x32_bf16 v[36:39], v[192:195], v[56:59], v[36:39]
    v_mfma_f32_16x16x32_bf16 v[40:43], a[8:11], v[56:59], v[40:43]
    v_mfma_f32_16x16x32_bf16 v[44:47], a[80:83], v[56:59], v[44:47]
    v_mfma_f32_16x16x32_bf16 v[48:51], v[56:59], a[152:155], v[48:51]
    v_mfma_f32_16x16x32_bf16 v[52:55], v[56:59], a[224:227], v[52:55]
    v_mfma_f32_16x16x32_bf16 v[36:39], v[196:199], v[56:59], v[36:39]
    v_mfma_f32_16x16x32_bf16 v[40:43], a[12:15], v[56:59], v[40:43]
    v_mfma_f32_16x16x32_bf16 v[44:47], a[84:87], v[56:59], v[44:47]
    v_mfma_f32_16x16x32_bf16 v[48:51], v[56:59], a[156:159], v[48:51]
    v_mfma_f32_16x16x32_bf16 v[52:55], v[56:59], a[228:231], v[52:55]
    v_mfma_f32_16x16x32_bf16 v[36:39], v[200:203], v[56:59], v[36:39]
    v_mfma_f32_16x16x32_bf16 v[40:43], a[16:19], v[56:59], v[40:43]
    v_mfma_f32_16x16x32_bf16 v[44:47], a[88:91], v[56:59], v[44:47]
    v_mfma_f32_16x16x32_bf16 v[48:51], v[56:59], a[160:163], v[48:51]
    v_mfma_f32_16x16x32_bf16 v[52:55], v[56:59], a[232:235], v[52:55]
    v_mfma_f32_16x16x32_bf16 v[36:39], v[204:207], v[56:59], v[36:39]
    v_mfma_f32_16x16x32_bf16 v[40:43], a[20:23], v[56:59], v[40:43]
    v_mfma_f32_16x16x32_bf16 v[44:47], a[92:95], v[56:59], v[44:47]
    v_mfma_f32_16x16x32_bf16 v[48:51], v[56:59], a[164:167], v[48:51]
    v_mfma_f32_16x16x32_bf16 v[52:55], v[56:59], a[236:239], v[52:55]
    v_mfma_f32_16x16x32_bf16 v[36:39], v[208:211], v[56:59], v[36:39]
    v_mfma_f32_16x16x32_bf16 v[40:43], a[24:27], v[56:59], v[40:43]
    v_mfma_f32_16x16x32_bf16 v[44:47], a[96:99], v[56:59], v[44:47]
    v_mfma_f32_16x16x32_bf16 v[48:51], v[56:59], a[168:171], v[48:51]
    v_mfma_f32_16x16x32_bf16 v[52:55], v[56:59], a[240:243], v[52:55]
    v_mfma_f32_16x16x32_bf16 v[36:39], v[212:215], v[56:59], v[36:39]
    v_mfma_f32_16x16x32_bf16 v[40:43], a[28:31], v[56:59], v[40:43]
    v_mfma_f32_16x16x32_bf16 v[44:47], a[100:103], v[56:59], v[44:47]
    v_mfma_f32_16x16x32_bf16 v[48:51], v[56:59], a[172:175], v[48:51]
    v_mfma_f32_16x16x32_bf16 v[52:55], v[56:59], a[244:247], v[52:55]
    v_mfma_f32_16x16x32_bf16 v[36:39], v[216:219], v[56:59], v[36:39]
    v_mfma_f32_16x16x32_bf16 v[40:43], a[32:35], v[56:59], v[40:43]
    v_mfma_f32_16x16x32_bf16 v[44:47], a[104:107], v[56:59], v[44:47]
    v_mfma_f32_16x16x32_bf16 v[48:51], v[56:59], a[176:179], v[48:51]
    v_mfma_f32_16x16x32_bf16 v[52:55], v[56:59], a[248:251], v[52:55]
    v_mfma_f32_16x16x32_bf16 v[36:39], v[220:223], v[56:59], v[36:39]
    v_mfma_f32_16x16x32_bf16 v[40:43], a[36:39], v[56:59], v[40:43]
    v_mfma_f32_16x16x32_bf16 v[44:47], a[108:111], v[56:59], v[44:47]
    v_mfma_f32_16x16x32_bf16 v[48:51], v[56:59], a[180:183], v[48:51]
    v_mfma_f32_16x16x32_bf16 v[52:55], v[56:59], a[252:255], v[52:55]
    v_lshlrev_b32 v10, 5, v7
    s_lshl_b32 s17, s51, 4
    v_add_u32 v10, s17, v10
    v_mul_u32_u24 v6, 1536, v8
    v_add_u32 v10, v10, v6
    s_lshl_b32 s17, s14, 7
    s_add_u32 s17, s17, 73728
    v_lshl_add_u32 v11, v7, 3, s17
    v_lshl_add_u32 v12, v8, 5, s17
    v_lshlrev_b32 v13, 5, v7
    s_lshl_b32 s17, s51, 4
    v_add_u32 v13, s17, v13
    s_lshr_b32 s17, s50, 2
    s_add_u32 s17, s17, 64
    s_lshl_b32 s17, s17, 9
    s_and_b32 s18, s50, 3
    s_lshl_b32 s18, s18, 2
    s_add_u32 s17, s17, s18
    v_add_u32 v14, s17, v13
    v_lshrrev_b32 v5, 1, v8
    v_lshl_add_u32 v13, v5, 9, v13
    v_and_b32 v5, 1, v8
    v_lshl_add_u32 v13, v5, 3, v13
    s_lshl_b32 s17, s50, 10
    v_add_u32 v13, s17, v13
    s_lshl_b32 s49, s15, 7
    s_lshl_b32 s17, s14, 2
    s_add_u32 s49, s49, s17
    s_add_u32 s49, s49, 1536
    s_mov_b32 s52, 0x3eae1a93
    v_mov_b32 v6, 0xf149f2ca
    v_lshl_add_u32 v5, v8, 2, 0
    v_sub_u32 v5, v5, v7
    v_cmp_le_i32 vcc, 9, v5
    s_nop 1
    v_cndmask_b32 v72, v6, v4, vcc
    v_add_u32 v5, 7, v5
    v_cmp_ge_u32 vcc, 7, v5
    s_nop 1
    v_cndmask_b32 v76, v6, v4, vcc
    v_lshl_add_u32 v5, v8, 2, 1
    v_sub_u32 v5, v5, v7
    v_cmp_le_i32 vcc, 9, v5
    s_nop 1
    v_cndmask_b32 v73, v6, v4, vcc
    v_add_u32 v5, 7, v5
    v_cmp_ge_u32 vcc, 7, v5
    s_nop 1
    v_cndmask_b32 v77, v6, v4, vcc
    v_lshl_add_u32 v5, v8, 2, 2
    v_sub_u32 v5, v5, v7
    v_cmp_le_i32 vcc, 9, v5
    s_nop 1
    v_cndmask_b32 v74, v6, v4, vcc
    v_add_u32 v5, 7, v5
    v_cmp_ge_u32 vcc, 7, v5
    s_nop 1
    v_cndmask_b32 v78, v6, v4, vcc
    v_lshl_add_u32 v5, v8, 2, 3
    v_sub_u32 v5, v5, v7
    v_cmp_le_i32 vcc, 9, v5
    s_nop 1
    v_cndmask_b32 v75, v6, v4, vcc
    v_add_u32 v5, 7, v5
    v_cmp_ge_u32 vcc, 7, v5
    s_nop 1
    v_cndmask_b32 v79, v6, v4, vcc
    v_mov_b32 v112, 0
    v_mov_b32 v113, 0
    v_mov_b32 v114, 0
    v_mov_b32 v115, 0
    v_mov_b32 v136, 0
    v_mov_b32 v137, 0
    v_mov_b32 v138, 0
    v_mov_b32 v139, 0
    v_mov_b32 v140, 0
    v_mov_b32 v141, 0
    v_mov_b32 v142, 0
    v_mov_b32 v143, 0
    v_mov_b32 v116, 0x3f803f80
    v_mov_b32 v117, 0x3f803f80
    v_mov_b32 v118, 0x3f803f80
    v_mov_b32 v119, 0x3f803f80
    v_mov_b32 v131, 0
    v_mov_b32 v135, 0
    s_mov_b64 exec, 0xff
    v_lshrrev_b32 v6, 2, v0
    v_lshlrev_b32 v5, 5, v6
    v_and_b32 v5, 128, v5
    v_lshrrev_b32 v6, 1, v6
    v_and_or_b32 v5, v6, 12, v5
    s_mov_b32 s16, 0
Laq_pure:
    global_load_dword v6, v5, s[12:13] sc1
    s_add_u32 s16, s16, 1
    s_cmp_gt_u32 s16, 100000
    s_cbranch_scc1 L_role_aq_abort
    s_mov_b32 s6, 0
    s_waitcnt vmcnt(0)
    v_readlane_b32 s7, v6, 0
    s_nop 0
    s_add_u32 s6, s6, s7
    v_readlane_b32 s7, v6, 1
    s_nop 0
    s_add_u32 s6, s6, s7
    v_readlane_b32 s7, v6, 2
    s_nop 0
    s_add_u32 s6, s6, s7
    v_readlane_b32 s7, v6, 3
    s_nop 0
    s_add_u32 s6, s6, s7
    v_readlane_b32 s7, v6, 4
    s_nop 0
    s_add_u32 s6, s6, s7
    v_readlane_b32 s7, v6, 5
    s_nop 0
    s_add_u32 s6, s6, s7
    v_readlane_b32 s7, v6, 6
    s_nop 0
    s_add_u32 s6, s6, s7
    v_readlane_b32 s7, v6, 7
    s_nop 0
    s_add_u32 s6, s6, s7
    v_readlane_b32 s7, v6, s3
    s_nop 0
    s_cmp_ge_u32 s7, 32
    s_cselect_b32 s78, 0, -1
    s_cselect_b32 s6, 256, s6
    s_cmp_lt_u32 s6, 256
    s_cbranch_scc1 Laq_pure
    s_mov_b32 s79, s78
    s_mov_b64 exec, -1
    s_mov_b32 s36, s63
    s_mov_b32 s34, s63
    s_mul_i32 s58, s14, 9216
    s_mul_i32 s64, s63, 4718592
    s_add_u32 s64, s64, s58
    s_add_u32 s64, s64, 6291456
    s_mul_i32 s61, s63, 1441792
    s_add_u32 s61, s61, 0
    s_mov_b32 s37, 0
    s_mov_b32 s40, 36864
    s_mov_b32 s59, s58
    s_mov_b32 s43, 0
    s_mov_b32 s62, 1
    s_mov_b32 s28, s8
    s_mov_b32 s29, s9
    s_mov_b32 s30, 0
    s_mov_b32 s31, 0x00020000
    v_mov_b32 v110, 74752
    v_mov_b32 v5, -1
    ds_write_b32 v110, v5
    s_waitcnt lgkmcnt(0)
    s_cmp_lg_u32 s14, 0
    s_cbranch_scc1 Laq_inia_d
    v_mov_b32 v5, 40
    s_mov_b32 s16, 0
Laq_inia:
    global_load_dword v6, v5, s[12:13] sc1
    s_add_u32 s16, s16, 1
    s_cmp_gt_u32 s16, 100000
    s_cbranch_scc1 L_role_aq_abort
    s_waitcnt vmcnt(0)
    v_cmp_gt_u32 vcc, 128, v6
    s_nop 0
    s_cbranch_vccz Laq_inia_d
    s_sleep 8
    s_branch Laq_inia
Laq_inia_d:
    s_barrier
    s_cmp_eq_u32 s63, 0
    s_cbranch_scc1 Laq_ini_sk
    s_cmp_lg_u32 s14, 0
    s_cbranch_scc1 Laq_inib_d
    v_mov_b32 v5, 160
    s_mov_b32 s16, 0
Laq_inib:
    global_load_dword v6, v5, s[12:13] sc1
    s_add_u32 s16, s16, 1
    s_cmp_gt_u32 s16, 100000
    s_cbranch_scc1 L_role_aq_abort
    s_waitcnt vmcnt(0)
    v_cmp_gt_u32 vcc, 64, v6
    s_nop 0
    s_cbranch_vccz Laq_inib_d
    s_sleep 8
    s_branch Laq_inib
Laq_inib_d:
    s_barrier
Laq_ini_sk:
    s_mul_i32 s41, s37, 36864
    s_add_u32 s41, s41, s64
    s_mul_i32 s60, s37, 22528
    s_add_u32 s60, s60, s61
    s_cmp_lt_u32 s37, 64
    s_cselect_b32 s60, s60, 2883584
    s_branch Laq_wait
Laq_head:
    s_waitcnt vmcnt(4)
Laq_head2:
    s_barrier
    ds_read_b32 v15, v110
    s_xor_b32 s40, s40, 36864
    s_xor_b32 s59, s59, 36864
    s_mov_b32 s35, s37
    s_lshl_b32 s57, s34, 6
    s_add_u32 s57, s57, s35
    s_add_u32 s37, s37, 1
    s_mov_b32 s39, 0
    s_mov_b32 s54, 0
    s_mul_i32 s41, s37, 36864
    s_add_u32 s41, s41, s64
    s_mul_i32 s60, s37, 22528
    s_add_u32 s60, s60, s61
    s_cmp_lt_u32 s37, 64
    s_cselect_b32 s60, s60, 2883584
    v_lshlrev_b32 v9, 9, v8
    v_lshl_add_u32 v9, v7, 5, v9
    s_lshl_b32 s17, s51, 4
    s_add_u32 s17, s17, s40
    v_add_u32 v9, s17, v9
    ds_read_b128 v[56:59], v9 offset:0
    ds_read_b128 v[60:63], v9 offset:2048
    ds_read_b128 v[64:67], v9 offset:4096
    s_waitcnt lgkmcnt(2)
    v_mfma_f32_16x16x32_bf16 v[16:19], v[152:155], v[56:59], 0
    v_add_f32 v80, v80, v84
    v_mfma_f32_16x16x32_bf16 v[20:23], v[224:227], v[56:59], 0
    v_add_f32 v81, v81, v85
    v_mfma_f32_16x16x32_bf16 v[24:27], a[40:43], v[56:59], 0
    v_add_f32 v82, v82, v86
    ds_read_b128 v[56:59], v9 offset:6144
    s_waitcnt lgkmcnt(2)
    v_mfma_f32_16x16x32_bf16 v[16:19], v[156:159], v[60:63], v[16:19]
    v_add_f32 v83, v83, v87
    v_mfma_f32_16x16x32_bf16 v[20:23], v[228:231], v[60:63], v[20:23]
    v_add_f32 v80, v80, v88
    v_mfma_f32_16x16x32_bf16 v[24:27], a[44:47], v[60:63], v[24:27]
    v_add_f32 v81, v81, v89
    v_readfirstlane_b32 s17, v15
    s_nop 0
    s_add_u32 s18, s17, 1
    s_max_i32 s32, s18, s37
    s_add_u32 s39, s37, 1
    s_min_u32 s39, s39, 63
    s_mul_i32 s33, s32, 22528
    s_add_u32 s33, s33, s61
    s_cmp_eq_u32 s14, 0
    s_cselect_b32 s18, s32, 0x7fff
    v_mov_b32 v2, 2
    s_cmp_le_u32 s18, s39
    s_cselect_b64 exec, -1, 0
    buffer_load_dword v2, v1, s[8:11], s33 offen sc1
    s_mov_b64 exec, -1
    s_cmp_ge_i32 s17, s37
    s_cbranch_scc1 Laq_f_7
    ds_read_b128 v[60:63], v9 offset:8192
    s_waitcnt lgkmcnt(2)
    v_mfma_f32_16x16x32_bf16 v[16:19], v[160:163], v[64:67], v[16:19]
    v_add_f32 v82, v82, v90
    v_mfma_f32_16x16x32_bf16 v[20:23], v[232:235], v[64:67], v[20:23]
    v_add_f32 v83, v83, v91
    v_mfma_f32_16x16x32_bf16 v[24:27], a[48:51], v[64:67], v[24:27]
    v_add_f32 v80, v80, v82
    ds_read_b128 v[64:67], v9 offset:10240
    s_waitcnt lgkmcnt(2)
    v_mfma_f32_16x16x32_bf16 v[16:19], v[164:167], v[56:59], v[16:19]
    v_add_f32 v81, v81, v83
    v_mfma_f32_16x16x32_bf16 v[20:23], v[236:239], v[56:59], v[20:23]
    v_mov_b32 v82, v80
    v_mfma_f32_16x16x32_bf16 v[24:27], a[52:55], v[56:59], v[24:27]
    v_mov_b32 v83, v81
    ds_read_b128 v[56:59], v9 offset:12288
    s_waitcnt lgkmcnt(2)
    v_mfma_f32_16x16x32_bf16 v[16:19], v[168:171], v[60:63], v[16:19]
    v_permlane32_swap_b32 v80, v82
    v_mfma_f32_16x16x32_bf16 v[20:23], v[240:243], v[60:63], v[20:23]
    v_permlane32_swap_b32 v81, v83
    v_mfma_f32_16x16x32_bf16 v[24:27], a[56:59], v[60:63], v[24:27]
    v_add_f32 v80, v80, v82
    ds_read_b128 v[60:63], v9 offset:14336
    s_waitcnt lgkmcnt(2)
    v_mfma_f32_16x16x32_bf16 v[16:19], v[172:175], v[64:67], v[16:19]
    v_add_f32 v81, v81, v83
    v_mfma_f32_16x16x32_bf16 v[20:23], v[244:247], v[64:67], v[20:23]
    v_mov_b32 v82, v80
    v_mfma_f32_16x16x32_bf16 v[24:27], a[60:63], v[64:67], v[24:27]
    v_mov_b32 v83, v81
    s_waitcnt vmcnt(1)
    s_cmp_lg_u32 s43, 0
    s_cselect_b64 exec, 1, 0
    buffer_store_dword v3, v4, s[8:11], s43 offen
    s_and_b64 exec, exec, s[78:79]
    buffer_store_dword v3, v4, s[8:11], s43 offen sc1
    s_mov_b64 exec, -1
    s_mov_b32 s43, 0
    ds_read_b128 v[64:67], v9 offset:16384
    s_waitcnt lgkmcnt(2)
    v_mfma_f32_16x16x32_bf16 v[16:19], v[176:179], v[56:59], v[16:19]
    v_permlane16_swap_b32 v80, v82
    v_mfma_f32_16x16x32_bf16 v[20:23], v[248:251], v[56:59], v[20:23]
    v_permlane16_swap_b32 v81, v83
    v_mfma_f32_16x16x32_bf16 v[24:27], a[64:67], v[56:59], v[24:27]
    v_add_f32 v80, v80, v82
    ds_read_b128 v[56:59], v9 offset:18432
    s_waitcnt lgkmcnt(2)
    v_mfma_f32_16x16x32_bf16 v[16:19], v[180:183], v[60:63], v[16:19]
    v_add_f32 v81, v81, v83
    v_mfma_f32_16x16x32_bf16 v[20:23], v[252:255], v[60:63], v[20:23]
    v_mul_f32 v80, 0x3ae38e39, v80
    v_mfma_f32_16x16x32_bf16 v[24:27], a[68:71], v[60:63], v[24:27]
    v_mul_f32 v81, 0x3ae38e39, v81
    ds_read_b128 v[60:63], v9 offset:20480
    s_waitcnt lgkmcnt(2)
    v_mfma_f32_16x16x32_bf16 v[16:19], v[184:187], v[64:67], v[16:19]
    v_fma_f32 v81, -v80, v80, v81
    v_mfma_f32_16x16x32_bf16 v[20:23], a[0:3], v[64:67], v[20:23]
    v_max_f32 v81, 0, v81
    v_mfma_f32_16x16x32_bf16 v[24:27], a[72:75], v[64:67], v[24:27]
    v_add_f32 v81, 0x3727c5ac, v81
    ds_read_b128 v[64:67], v9 offset:22528
    s_waitcnt lgkmcnt(2)
    v_mfma_f32_16x16x32_bf16 v[16:19], v[188:191], v[56:59], v[16:19]
    v_rsq_f32 v92, v81
    v_mfma_f32_16x16x32_bf16 v[20:23], a[4:7], v[56:59], v[20:23]
    v_mul_f32 v93, v80, v92
    v_mfma_f32_16x16x32_bf16 v[24:27], a[76:79], v[56:59], v[24:27]
    ds_write_b64 v11, v[92:93]
    ds_read_b128 v[56:59], v9 offset:24576
    s_waitcnt lgkmcnt(3)
    v_mfma_f32_16x16x32_bf16 v[16:19], v[192:195], v[60:63], v[16:19]
    ds_read_b128 v[96:99], v12
    v_mfma_f32_16x16x32_bf16 v[20:23], a[8:11], v[60:63], v[20:23]
    ds_read_b128 v[100:103], v12 offset:16
    v_mfma_f32_16x16x32_bf16 v[24:27], a[80:83], v[60:63], v[24:27]
    ds_read_b128 v[60:63], v9 offset:26624
    s_waitcnt lgkmcnt(5)
    v_mfma_f32_16x16x32_bf16 v[16:19], v[196:199], v[64:67], v[16:19]
    v_mfma_f32_16x16x32_bf16 v[20:23], a[12:15], v[64:67], v[20:23]
    v_mfma_f32_16x16x32_bf16 v[24:27], a[84:87], v[64:67], v[24:27]
    ds_read_b128 v[64:67], v9 offset:28672
    s_waitcnt lgkmcnt(4)
    v_mfma_f32_16x16x32_bf16 v[16:19], v[200:203], v[56:59], v[16:19]
    v_mfma_f32_16x16x32_bf16 v[20:23], a[16:19], v[56:59], v[20:23]
    v_mfma_f32_16x16x32_bf16 v[24:27], a[88:91], v[56:59], v[24:27]
    ds_read_b128 v[56:59], v9 offset:30720
    s_waitcnt lgkmcnt(2)
    v_mfma_f32_16x16x32_bf16 v[16:19], v[204:207], v[60:63], v[16:19]
    v_mfma_f32_16x16x32_bf16 v[20:23], a[20:23], v[60:63], v[20:23]
    v_mfma_f32_16x16x32_bf16 v[24:27], a[92:95], v[60:63], v[24:27]
    ds_read_b128 v[60:63], v9 offset:32768
    s_waitcnt lgkmcnt(2)
    v_mfma_f32_16x16x32_bf16 v[16:19], v[208:211], v[64:67], v[16:19]
    v_mfma_f32_16x16x32_bf16 v[20:23], a[24:27], v[64:67], v[20:23]
    v_mfma_f32_16x16x32_bf16 v[24:27], a[96:99], v[64:67], v[24:27]
    ds_read_b128 v[64:67], v9 offset:34816
    s_waitcnt lgkmcnt(2)
    v_mfma_f32_16x16x32_bf16 v[16:19], v[212:215], v[56:59], v[16:19]
    v_cmp_eq_u32 s[76:77], 1, v2
    v_cmp_eq_u32 vcc, 2, v2
    v_mfma_f32_16x16x32_bf16 v[20:23], a[28:31], v[56:59], v[20:23]
    s_cmp_eq_u64 s[76:77], -1
    s_cselect_b32 s38, 1, 0
    v_mfma_f32_16x16x32_bf16 v[24:27], a[100:103], v[56:59], v[24:27]
    s_cmp_lg_u32 s38, 0
    s_cselect_b64 exec, 1, 0
    v_mov_b32 v15, s32
    ds_write_b32 v110, v15
    v_mov_b32 v2, 2
    s_mov_b64 exec, -1
    ds_read_b128 v[56:59], v9 offset:0
    s_waitcnt lgkmcnt(3)
    v_mfma_f32_16x16x32_bf16 v[16:19], v[216:219], v[60:63], v[16:19]
    s_add_u32 s32, s32, s38
    s_mul_i32 s38, s38, 22528
    s_add_u32 s33, s33, s38
    v_mfma_f32_16x16x32_bf16 v[20:23], a[32:35], v[60:63], v[20:23]
    s_cmp_eq_u64 vcc, 0
    s_cselect_b32 s38, s32, 0x7fff
    v_mfma_f32_16x16x32_bf16 v[24:27], a[104:107], v[60:63], v[24:27]
    s_cmp_le_u32 s38, s39
    s_cselect_b64 exec, -1, 0
    v_mov_b32 v2, 2
    buffer_load_dword v2, v1, s[8:11], s33 offen sc1
    s_mov_b64 exec, -1
    ds_read_b128 v[60:63], v9 offset:2048
    s_waitcnt lgkmcnt(3)
    v_mfma_f32_16x16x32_bf16 v[16:19], v[220:223], v[64:67], v[16:19]
    v_mfma_f32_16x16x32_bf16 v[20:23], a[36:39], v[64:67], v[20:23]
    v_mfma_f32_16x16x32_bf16 v[24:27], a[108:111], v[64:67], v[24:27]
    ds_read_b32 v15, v110
    ds_read_b128 v[64:67], v9 offset:4096
    s_waitcnt lgkmcnt(3)
    v_mfma_f32_16x16x32_bf16 v[28:31], v[56:59], a[112:115], 0
    v_mfma_f32_16x16x32_bf16 v[32:35], v[56:59], a[184:187], 0
    ds_read_b128 v[56:59], v9 offset:6144
    s_waitcnt lgkmcnt(3)
    v_mfma_f32_16x16x32_bf16 v[28:31], v[60:63], a[116:119], v[28:31]
    v_mul_f32 v94, v93, v36
    v_fma_f32 v16, v16, v92, -v94
    v_mfma_f32_16x16x32_bf16 v[32:35], v[60:63], a[188:191], v[32:35]
    v_mul_f32 v94, v93, v37
    v_fma_f32 v17, v17, v92, -v94
    s_waitcnt lgkmcnt(2)
    v_readfirstlane_b32 s17, v15
    s_nop 0
    s_cmp_ge_i32 s17, s37
    s_cbranch_scc1 Laq_f_8
    ds_read_b128 v[60:63], v9 offset:8192
    s_waitcnt lgkmcnt(2)
    v_mfma_f32_16x16x32_bf16 v[28:31], v[64:67], a[120:123], v[28:31]
    v_mul_f32 v94, v93, v38
    v_fma_f32 v18, v18, v92, -v94
    v_mfma_f32_16x16x32_bf16 v[32:35], v[64:67], a[192:195], v[32:35]
    v_mul_f32 v94, v93, v39
    v_fma_f32 v19, v19, v92, -v94
    ds_read_b128 v[64:67], v9 offset:10240
    s_waitcnt lgkmcnt(2)
    v_mfma_f32_16x16x32_bf16 v[28:31], v[56:59], a[124:127], v[28:31]
    v_mul_f32 v94, v93, v44
    v_fma_f32 v24, v24, v92, -v94
    v_mfma_f32_16x16x32_bf16 v[32:35], v[56:59], a[196:199], v[32:35]
    v_mul_f32 v94, v93, v45
    v_fma_f32 v25, v25, v92, -v94
    ds_read_b128 v[56:59], v9 offset:12288
    s_waitcnt lgkmcnt(2)
    v_mfma_f32_16x16x32_bf16 v[28:31], v[60:63], a[128:131], v[28:31]
    v_mul_f32 v94, v93, v46
    v_fma_f32 v26, v26, v92, -v94
    v_mfma_f32_16x16x32_bf16 v[32:35], v[60:63], a[200:203], v[32:35]
    v_mul_f32 v94, v93, v47
    v_fma_f32 v27, v27, v92, -v94
    ds_read_b128 v[60:63], v9 offset:14336
    s_waitcnt lgkmcnt(2)
    v_mfma_f32_16x16x32_bf16 v[28:31], v[64:67], a[132:135], v[28:31]
    v_mul_f32 v94, v93, v40
    v_fma_f32 v20, v20, v92, -v94
    v_mfma_f32_16x16x32_bf16 v[32:35], v[64:67], a[204:207], v[32:35]
    v_mul_f32 v94, v93, v41
    v_fma_f32 v21, v21, v92, -v94
    ds_read_b128 v[64:67], v9 offset:16384
    s_waitcnt lgkmcnt(2)
    v_mfma_f32_16x16x32_bf16 v[28:31], v[56:59], a[136:139], v[28:31]
    v_mul_f32 v94, v93, v42
    v_fma_f32 v22, v22, v92, -v94
    v_mfma_f32_16x16x32_bf16 v[32:35], v[56:59], a[208:211], v[32:35]
    v_mul_f32 v94, v93, v43
    v_fma_f32 v23, v23, v92, -v94
    ds_read_b128 v[56:59], v9 offset:18432
    s_waitcnt lgkmcnt(2)
    v_mfma_f32_16x16x32_bf16 v[28:31], v[60:63], a[140:143], v[28:31]
    v_cvt_pk_bf16_f32 v128, v16, v17
    v_cvt_pk_bf16_f32 v129, v18, v19
    v_mfma_f32_16x16x32_bf16 v[32:35], v[60:63], a[212:215], v[32:35]
    v_cvt_pk_bf16_f32 v130, v24, v25
    v_cvt_pk_bf16_f32 v132, v20, v21
    ds_read_b128 v[60:63], v9 offset:20480
    s_waitcnt lgkmcnt(2)
    v_mfma_f32_16x16x32_bf16 v[28:31], v[64:67], a[144:147], v[28:31]
    v_cvt_pk_bf16_f32 v133, v22, v23
    v_cvt_pk_bf16_f32 v134, v26, v27
    v_mfma_f32_16x16x32_bf16 v[32:35], v[64:67], a[216:219], v[32:35]
    s_cmp_eq_u32 s35, 0
    s_cselect_b32 s46, 0xf149f2ca, 0
    ds_read_b128 v[64:67], v9 offset:22528
    s_waitcnt lgkmcnt(2)
    v_mfma_f32_16x16x32_bf16 v[28:31], v[56:59], a[148:151], v[28:31]
    v_mfma_f32_16x16x32_bf16 v[144:147], v[112:115], v[128:131], 0
    v_mfma_f32_16x16x32_bf16 v[32:35], v[56:59], a[220:223], v[32:35]
    v_mfma_f32_16x16x32_bf16 v[148:151], v[132:135], v[128:131], 0
    ds_read_b128 v[56:59], v9 offset:24576
    s_waitcnt lgkmcnt(2)
    v_mfma_f32_16x16x32_bf16 v[28:31], v[60:63], a[152:155], v[28:31]
    v_mov_b32 v112, v132
    v_mfma_f32_16x16x32_bf16 v[32:35], v[60:63], a[224:227], v[32:35]
    v_mov_b32 v113, v133
    v_mov_b32 v114, v134
    ds_read_b128 v[60:63], v9 offset:26624
    s_waitcnt lgkmcnt(2)
    v_mfma_f32_16x16x32_bf16 v[28:31], v[64:67], a[156:159], v[28:31]
    v_mfma_f32_16x16x32_bf16 v[32:35], v[64:67], a[228:231], v[32:35]
    v_fma_f32 v144, v144, s52, v72
    ds_read_b128 v[64:67], v9 offset:28672
    s_waitcnt lgkmcnt(2)
    v_mfma_f32_16x16x32_bf16 v[28:31], v[56:59], a[160:163], v[28:31]
    v_fma_f32 v145, v145, s52, v73
    v_fma_f32 v146, v146, s52, v74
    v_fma_f32 v147, v147, s52, v75
    v_mfma_f32_16x16x32_bf16 v[32:35], v[56:59], a[232:235], v[32:35]
    v_fma_f32 v148, v148, s52, v76
    v_fma_f32 v149, v149, s52, v77
    v_fma_f32 v150, v150, s52, v78
    ds_read_b128 v[56:59], v9 offset:30720
    s_waitcnt lgkmcnt(2)
    v_mfma_f32_16x16x32_bf16 v[28:31], v[60:63], a[164:167], v[28:31]
    v_fma_f32 v151, v151, s52, v79
    v_add_f32 v144, s46, v144
    v_add_f32 v145, s46, v145
    v_mfma_f32_16x16x32_bf16 v[32:35], v[60:63], a[236:239], v[32:35]
    v_add_f32 v146, s46, v146
    v_add_f32 v147, s46, v147
    v_max3_f32 v5, v144, v145, v146
    ds_read_b128 v[60:63], v9 offset:32768
    s_waitcnt lgkmcnt(2)
    v_mfma_f32_16x16x32_bf16 v[28:31], v[64:67], a[168:171], v[28:31]
    v_max3_f32 v5, v5, v147, v148
    v_max3_f32 v5, v5, v149, v150
    v_max_f32 v5, v5, v151
    v_mfma_f32_16x16x32_bf16 v[32:35], v[64:67], a[240:243], v[32:35]
    v_mov_b32 v6, v5
    s_nop 1
    v_permlane32_swap_b32 v5, v6
    ds_read_b128 v[64:67], v9 offset:34816
    s_waitcnt lgkmcnt(2)
    v_mfma_f32_16x16x32_bf16 v[28:31], v[56:59], a[172:175], v[28:31]
    v_max_f32 v5, v5, v6
    v_mov_b32 v6, v5
    v_mfma_f32_16x16x32_bf16 v[32:35], v[56:59], a[244:247], v[32:35]
    s_nop 0
    v_permlane16_swap_b32 v5, v6
    v_max_f32 v5, v5, v6
    v_sub_f32 v144, v144, v5
    s_waitcnt lgkmcnt(1)
    v_mfma_f32_16x16x32_bf16 v[28:31], v[60:63], a[176:179], v[28:31]
    v_sub_f32 v145, v145, v5
    v_sub_f32 v146, v146, v5
    v_sub_f32 v147, v147, v5
    v_mfma_f32_16x16x32_bf16 v[32:35], v[60:63], a[248:251], v[32:35]
    v_sub_f32 v148, v148, v5
    v_sub_f32 v149, v149, v5
    v_sub_f32 v150, v150, v5
    s_waitcnt lgkmcnt(0)
    v_mfma_f32_16x16x32_bf16 v[28:31], v[64:67], a[180:183], v[28:31]
    v_sub_f32 v151, v151, v5
    v_exp_f32 v144, v144
    v_exp_f32 v145, v145
    v_mfma_f32_16x16x32_bf16 v[32:35], v[64:67], a[252:255], v[32:35]
    v_exp_f32 v146, v146
    v_exp_f32 v147, v147
    v_exp_f32 v148, v148
    v_cmp_eq_u32 s[76:77], 1, v2
    v_cmp_eq_u32 vcc, 2, v2
    s_cmp_eq_u64 s[76:77], -1
    s_cselect_b32 s38, 1, 0
    s_cmp_lg_u32 s38, 0
    s_cselect_b64 exec, 1, 0
    v_mov_b32 v15, s32
    ds_write_b32 v110, v15
    v_mov_b32 v2, 2
    s_mov_b64 exec, -1
    s_add_u32 s32, s32, s38
    s_mul_i32 s38, s38, 22528
    s_add_u32 s33, s33, s38
    s_cmp_eq_u64 vcc, 0
    s_cselect_b32 s38, s32, 0x7fff
    s_cmp_le_u32 s38, s39
    s_cselect_b64 exec, -1, 0
    v_mov_b32 v2, 2
    buffer_load_dword v2, v1, s[8:11], s33 offen sc1
    s_mov_b64 exec, -1
    v_exp_f32 v149, v149
    v_exp_f32 v150, v150
    v_exp_f32 v151, v151
    v_cvt_pk_bf16_f32 v68, v144, v145
    v_cvt_pk_bf16_f32 v69, v146, v147
    v_cvt_pk_bf16_f32 v70, v148, v149
    v_cvt_pk_bf16_f32 v71, v150, v151
    s_nop 1
    v_mfma_f32_16x16x32_bf16 v[16:19], v[116:119], v[68:71], 0
    s_mul_i32 s46, s57, 36864
    s_add_u32 s46, s46, 17301504
    s_nop 5
    v_rcp_f32 v6, v16
    v_mul_f32 v94, v97, v48
    v_fma_f32 v28, v28, v96, -v94
    v_mul_f32 v94, v99, v49
    v_fma_f32 v29, v29, v98, -v94
    v_mul_f32 v94, v101, v50
    v_fma_f32 v30, v30, v100, -v94
    v_mul_f32 v94, v103, v51
    v_fma_f32 v31, v31, v102, -v94
    v_cvt_pk_bf16_f32 v138, v28, v29
    v_cvt_pk_bf16_f32 v139, v30, v31
    v_mul_f32 v94, v97, v52
    v_fma_f32 v32, v32, v96, -v94
    v_mfma_f32_16x16x32_bf16 v[20:23], v[136:139], v[68:71], 0
    v_mul_f32 v94, v99, v53
    v_fma_f32 v33, v33, v98, -v94
    v_mul_f32 v94, v101, v54
    v_fma_f32 v34, v34, v100, -v94
    v_mul_f32 v94, v103, v55
    v_fma_f32 v35, v35, v102, -v94
    v_cvt_pk_bf16_f32 v142, v32, v33
    v_cvt_pk_bf16_f32 v143, v34, v35
    v_mov_b32 v136, v138
    v_mov_b32 v137, v139
    v_mfma_f32_16x16x32_bf16 v[24:27], v[140:143], v[68:71], 0
    v_mul_f32 v20, v6, v20
    v_mul_f32 v21, v6, v21
    v_mul_f32 v22, v6, v22
    v_mul_f32 v23, v6, v23
    v_cvt_pk_bf16_f32 v20, v20, v21
    v_cvt_pk_bf16_f32 v21, v22, v23
    s_mov_b64 exec, -1
    buffer_store_dwordx2 v[20:21], v13, s[8:11], s46 offen
    s_and_b64 exec, exec, s[78:79]
    buffer_store_dwordx2 v[20:21], v13, s[8:11], s46 offen sc1
    s_mov_b64 exec, -1
    v_mov_b32 v140, v142
    v_mov_b32 v141, v143
    v_mul_f32 v24, v6, v24
    v_mul_f32 v25, v6, v25
    v_cvt_pk_bf16_f32 v24, v24, v25
    s_mov_b64 exec, 0xffff
    buffer_store_dword v24, v14, s[8:11], s46 offen
    s_and_b64 exec, exec, s[78:79]
    buffer_store_dword v24, v14, s[8:11], s46 offen sc1
    s_mov_b64 exec, -1
    s_mul_i32 s43, s57, 22528
    s_add_u32 s43, s43, s49
    s_branch Laq_none
Laq_f_7:
    ds_read_b128 v[60:63], v9 offset:8192
    s_waitcnt lgkmcnt(2)
    v_mfma_f32_16x16x32_bf16 v[16:19], v[160:163], v[64:67], v[16:19]
    v_add_f32 v82, v82, v90
    v_mfma_f32_16x16x32_bf16 v[20:23], v[232:235], v[64:67], v[20:23]
    v_add_f32 v83, v83, v91
    v_mfma_f32_16x16x32_bf16 v[24:27], a[48:51], v[64:67], v[24:27]
    v_add_f32 v80, v80, v82
    ds_read_b128 v[64:67], v9 offset:10240
    s_waitcnt lgkmcnt(2)
    v_mfma_f32_16x16x32_bf16 v[16:19], v[164:167], v[56:59], v[16:19]
    v_add_f32 v81, v81, v83
    v_mfma_f32_16x16x32_bf16 v[20:23], v[236:239], v[56:59], v[20:23]
    v_mov_b32 v82, v80
    v_mfma_f32_16x16x32_bf16 v[24:27], a[52:55], v[56:59], v[24:27]
    v_mov_b32 v83, v81
    ds_read_b128 v[56:59], v9 offset:12288
    s_waitcnt lgkmcnt(2)
    v_mfma_f32_16x16x32_bf16 v[16:19], v[168:171], v[60:63], v[16:19]
    v_permlane32_swap_b32 v80, v82
    v_mfma_f32_16x16x32_bf16 v[20:23], v[240:243], v[60:63], v[20:23]
    v_permlane32_swap_b32 v81, v83
    v_mfma_f32_16x16x32_bf16 v[24:27], a[56:59], v[60:63], v[24:27]
    v_add_f32 v80, v80, v82
    ds_read_b128 v[60:63], v9 offset:14336
    s_waitcnt lgkmcnt(2)
    v_mfma_f32_16x16x32_bf16 v[16:19], v[172:175], v[64:67], v[16:19]
    v_add_f32 v81, v81, v83
    v_mfma_f32_16x16x32_bf16 v[20:23], v[244:247], v[64:67], v[20:23]
    v_mov_b32 v82, v80
    v_mfma_f32_16x16x32_bf16 v[24:27], a[60:63], v[64:67], v[24:27]
    v_mov_b32 v83, v81
    s_waitcnt vmcnt(1)
    s_cmp_lg_u32 s43, 0
    s_cselect_b64 exec, 1, 0
    buffer_store_dword v3, v4, s[8:11], s43 offen
    s_and_b64 exec, exec, s[78:79]
    buffer_store_dword v3, v4, s[8:11], s43 offen sc1
    s_mov_b64 exec, -1
    s_mov_b32 s43, 0
    ds_read_b128 v[64:67], v9 offset:16384
    s_waitcnt lgkmcnt(2)
    v_mfma_f32_16x16x32_bf16 v[16:19], v[176:179], v[56:59], v[16:19]
    v_permlane16_swap_b32 v80, v82
    v_mfma_f32_16x16x32_bf16 v[20:23], v[248:251], v[56:59], v[20:23]
    v_permlane16_swap_b32 v81, v83
    v_mfma_f32_16x16x32_bf16 v[24:27], a[64:67], v[56:59], v[24:27]
    v_add_f32 v80, v80, v82
    ds_read_b128 v[56:59], v9 offset:18432
    s_waitcnt lgkmcnt(2)
    v_mfma_f32_16x16x32_bf16 v[16:19], v[180:183], v[60:63], v[16:19]
    v_add_f32 v81, v81, v83
    v_mfma_f32_16x16x32_bf16 v[20:23], v[252:255], v[60:63], v[20:23]
    v_mul_f32 v80, 0x3ae38e39, v80
    v_mfma_f32_16x16x32_bf16 v[24:27], a[68:71], v[60:63], v[24:27]
    v_mul_f32 v81, 0x3ae38e39, v81
    ds_read_b128 v[60:63], v9 offset:20480
    s_waitcnt lgkmcnt(2)
    v_mfma_f32_16x16x32_bf16 v[16:19], v[184:187], v[64:67], v[16:19]
    v_fma_f32 v81, -v80, v80, v81
    v_mfma_f32_16x16x32_bf16 v[20:23], a[0:3], v[64:67], v[20:23]
    v_max_f32 v81, 0, v81
    v_mfma_f32_16x16x32_bf16 v[24:27], a[72:75], v[64:67], v[24:27]
    v_add_f32 v81, 0x3727c5ac, v81
    ds_read_b128 v[64:67], v9 offset:22528
    s_waitcnt lgkmcnt(2)
    v_mfma_f32_16x16x32_bf16 v[16:19], v[188:191], v[56:59], v[16:19]
    v_rsq_f32 v92, v81
    v_mfma_f32_16x16x32_bf16 v[20:23], a[4:7], v[56:59], v[20:23]
    v_mul_f32 v93, v80, v92
    v_mfma_f32_16x16x32_bf16 v[24:27], a[76:79], v[56:59], v[24:27]
    ds_write_b64 v11, v[92:93]
    ds_read_b128 v[56:59], v9 offset:24576
    s_waitcnt lgkmcnt(3)
    v_mfma_f32_16x16x32_bf16 v[16:19], v[192:195], v[60:63], v[16:19]
    ds_read_b128 v[96:99], v12
    v_mfma_f32_16x16x32_bf16 v[20:23], a[8:11], v[60:63], v[20:23]
    ds_read_b128 v[100:103], v12 offset:16
    v_mfma_f32_16x16x32_bf16 v[24:27], a[80:83], v[60:63], v[24:27]
    s_add_u32 m0, s59, 0
    s_add_u32 s47, s41, 0
    buffer_load_dwordx4 v0, s[8:11], s47 offen offset:0 lds
    ds_read_b128 v[60:63], v9 offset:26624
    s_waitcnt lgkmcnt(5)
    v_mfma_f32_16x16x32_bf16 v[16:19], v[196:199], v[64:67], v[16:19]
    buffer_load_dwordx4 v0, s[8:11], s47 offen offset:1024 lds
    buffer_load_dwordx4 v0, s[8:11], s47 offen offset:2048 lds
    buffer_load_dwordx4 v0, s[8:11], s47 offen offset:3072 lds
    v_mfma_f32_16x16x32_bf16 v[20:23], a[12:15], v[64:67], v[20:23]
    s_add_u32 m0, s59, 4096
    s_add_u32 s47, s41, 4096
    buffer_load_dwordx4 v0, s[8:11], s47 offen offset:0 lds
    v_mfma_f32_16x16x32_bf16 v[24:27], a[84:87], v[64:67], v[24:27]
    buffer_load_dwordx4 v0, s[8:11], s47 offen offset:1024 lds
    buffer_load_dwordx4 v0, s[8:11], s47 offen offset:2048 lds
    buffer_load_dwordx4 v0, s[8:11], s47 offen offset:3072 lds
    ds_read_b128 v[64:67], v9 offset:28672
    s_waitcnt lgkmcnt(4)
    v_mfma_f32_16x16x32_bf16 v[16:19], v[200:203], v[56:59], v[16:19]
    s_add_u32 m0, s59, 8192
    s_add_u32 s47, s41, 8192
    buffer_load_dwordx4 v0, s[8:11], s47 offen offset:0 lds
    v_mfma_f32_16x16x32_bf16 v[20:23], a[16:19], v[56:59], v[20:23]
    v_mfma_f32_16x16x32_bf16 v[24:27], a[88:91], v[56:59], v[24:27]
    ds_read_b128 v[56:59], v9 offset:30720
    s_waitcnt lgkmcnt(2)
    v_mfma_f32_16x16x32_bf16 v[16:19], v[204:207], v[60:63], v[16:19]
    v_mfma_f32_16x16x32_bf16 v[20:23], a[20:23], v[60:63], v[20:23]
    v_mfma_f32_16x16x32_bf16 v[24:27], a[92:95], v[60:63], v[24:27]
    ds_read_b128 v[60:63], v9 offset:32768
    s_waitcnt lgkmcnt(2)
    v_mfma_f32_16x16x32_bf16 v[16:19], v[208:211], v[64:67], v[16:19]
    v_mfma_f32_16x16x32_bf16 v[20:23], a[24:27], v[64:67], v[20:23]
    v_mfma_f32_16x16x32_bf16 v[24:27], a[96:99], v[64:67], v[24:27]
    ds_read_b128 v[64:67], v9 offset:34816
    s_waitcnt lgkmcnt(2)
    v_mfma_f32_16x16x32_bf16 v[16:19], v[212:215], v[56:59], v[16:19]
    v_cmp_eq_u32 s[76:77], 1, v2
    v_cmp_eq_u32 vcc, 2, v2
    v_mfma_f32_16x16x32_bf16 v[20:23], a[28:31], v[56:59], v[20:23]
    s_cmp_eq_u64 s[76:77], -1
    s_cselect_b32 s38, 1, 0
    v_mfma_f32_16x16x32_bf16 v[24:27], a[100:103], v[56:59], v[24:27]
    s_cmp_lg_u32 s38, 0
    s_cselect_b64 exec, 1, 0
    v_mov_b32 v15, s32
    ds_write_b32 v110, v15
    v_mov_b32 v2, 2
    s_mov_b64 exec, -1
    ds_read_b128 v[56:59], v9 offset:0
    s_waitcnt lgkmcnt(3)
    v_mfma_f32_16x16x32_bf16 v[16:19], v[216:219], v[60:63], v[16:19]
    s_add_u32 s32, s32, s38
    s_mul_i32 s38, s38, 22528
    s_add_u32 s33, s33, s38
    v_mfma_f32_16x16x32_bf16 v[20:23], a[32:35], v[60:63], v[20:23]
    s_cmp_eq_u64 vcc, 0
    s_cselect_b32 s38, s32, 0x7fff
    v_mfma_f32_16x16x32_bf16 v[24:27], a[104:107], v[60:63], v[24:27]
    s_cmp_le_u32 s38, s39
    s_cselect_b64 exec, -1, 0
    v_mov_b32 v2, 2
    buffer_load_dword v2, v1, s[8:11], s33 offen sc1
    s_mov_b64 exec, -1
    ds_read_b128 v[60:63], v9 offset:2048
    s_waitcnt lgkmcnt(3)
    v_mfma_f32_16x16x32_bf16 v[16:19], v[220:223], v[64:67], v[16:19]
    s_mul_i32 s48, s36, 786432
    s_mul_i32 s18, s37, 6144
    s_add_u32 s48, s48, s18
    s_add_u32 s48, s48, 15728640
    buffer_load_dwordx4 v[80:83], v10, s[8:11], s48 offen offset:0
    v_mfma_f32_16x16x32_bf16 v[20:23], a[36:39], v[64:67], v[20:23]
    v_mfma_f32_16x16x32_bf16 v[24:27], a[108:111], v[64:67], v[24:27]
    ds_read_b128 v[64:67], v9 offset:4096
    s_waitcnt lgkmcnt(2)
    v_mfma_f32_16x16x32_bf16 v[28:31], v[56:59], a[112:115], 0
    buffer_load_dwordx4 v[84:87], v10, s[8:11], s48 offen offset:512
    v_mfma_f32_16x16x32_bf16 v[32:35], v[56:59], a[184:187], 0
    ds_read_b128 v[56:59], v9 offset:6144
    s_waitcnt lgkmcnt(2)
    v_mfma_f32_16x16x32_bf16 v[28:31], v[60:63], a[116:119], v[28:31]
    buffer_load_dwordx4 v[88:91], v10, s[8:11], s48 offen offset:1024
    v_mul_f32 v94, v93, v36
    v_fma_f32 v16, v16, v92, -v94
    v_mfma_f32_16x16x32_bf16 v[32:35], v[60:63], a[188:191], v[32:35]
    v_mul_f32 v94, v93, v37
    v_fma_f32 v17, v17, v92, -v94
    ds_read_b128 v[60:63], v9 offset:8192
    s_waitcnt lgkmcnt(2)
    v_mfma_f32_16x16x32_bf16 v[28:31], v[64:67], a[120:123], v[28:31]
    v_mul_f32 v94, v93, v38
    v_fma_f32 v18, v18, v92, -v94
    v_mfma_f32_16x16x32_bf16 v[32:35], v[64:67], a[192:195], v[32:35]
    v_mul_f32 v94, v93, v39
    v_fma_f32 v19, v19, v92, -v94
    ds_read_b128 v[64:67], v9 offset:10240
    s_waitcnt lgkmcnt(2)
    v_mfma_f32_16x16x32_bf16 v[28:31], v[56:59], a[124:127], v[28:31]
    v_mul_f32 v94, v93, v44
    v_fma_f32 v24, v24, v92, -v94
    v_mfma_f32_16x16x32_bf16 v[32:35], v[56:59], a[196:199], v[32:35]
    v_mul_f32 v94, v93, v45
    v_fma_f32 v25, v25, v92, -v94
    ds_read_b128 v[56:59], v9 offset:12288
    s_waitcnt lgkmcnt(2)
    v_mfma_f32_16x16x32_bf16 v[28:31], v[60:63], a[128:131], v[28:31]
    v_mul_f32 v94, v93, v46
    v_fma_f32 v26, v26, v92, -v94
    v_mfma_f32_16x16x32_bf16 v[32:35], v[60:63], a[200:203], v[32:35]
    v_mul_f32 v94, v93, v47
    v_fma_f32 v27, v27, v92, -v94
    ds_read_b128 v[60:63], v9 offset:14336
    s_waitcnt lgkmcnt(2)
    v_mfma_f32_16x16x32_bf16 v[28:31], v[64:67], a[132:135], v[28:31]
    v_mul_f32 v94, v93, v40
    v_fma_f32 v20, v20, v92, -v94
    v_mfma_f32_16x16x32_bf16 v[32:35], v[64:67], a[204:207], v[32:35]
    v_mul_f32 v94, v93, v41
    v_fma_f32 v21, v21, v92, -v94
    ds_read_b128 v[64:67], v9 offset:16384
    s_waitcnt lgkmcnt(2)
    v_mfma_f32_16x16x32_bf16 v[28:31], v[56:59], a[136:139], v[28:31]
    v_mul_f32 v94, v93, v42
    v_fma_f32 v22, v22, v92, -v94
    v_mfma_f32_16x16x32_bf16 v[32:35], v[56:59], a[208:211], v[32:35]
    v_mul_f32 v94, v93, v43
    v_fma_f32 v23, v23, v92, -v94
    ds_read_b128 v[56:59], v9 offset:18432
    s_waitcnt lgkmcnt(2)
    v_mfma_f32_16x16x32_bf16 v[28:31], v[60:63], a[140:143], v[28:31]
    v_cvt_pk_bf16_f32 v128, v16, v17
    v_cvt_pk_bf16_f32 v129, v18, v19
    v_mfma_f32_16x16x32_bf16 v[32:35], v[60:63], a[212:215], v[32:35]
    v_cvt_pk_bf16_f32 v130, v24, v25
    v_cvt_pk_bf16_f32 v132, v20, v21
    ds_read_b128 v[60:63], v9 offset:20480
    s_waitcnt lgkmcnt(2)
    v_mfma_f32_16x16x32_bf16 v[28:31], v[64:67], a[144:147], v[28:31]
    v_cvt_pk_bf16_f32 v133, v22, v23
    v_cvt_pk_bf16_f32 v134, v26, v27
    v_mfma_f32_16x16x32_bf16 v[32:35], v[64:67], a[216:219], v[32:35]
    s_cmp_eq_u32 s35, 0
    s_cselect_b32 s46, 0xf149f2ca, 0
    ds_read_b128 v[64:67], v9 offset:22528
    s_waitcnt lgkmcnt(2)
    v_mfma_f32_16x16x32_bf16 v[28:31], v[56:59], a[148:151], v[28:31]
    v_mfma_f32_16x16x32_bf16 v[144:147], v[112:115], v[128:131], 0
    v_mfma_f32_16x16x32_bf16 v[32:35], v[56:59], a[220:223], v[32:35]
    v_mfma_f32_16x16x32_bf16 v[148:151], v[132:135], v[128:131], 0
    ds_read_b128 v[56:59], v9 offset:24576
    s_waitcnt lgkmcnt(2)
    v_mfma_f32_16x16x32_bf16 v[28:31], v[60:63], a[152:155], v[28:31]
    v_mov_b32 v112, v132
    v_mfma_f32_16x16x32_bf16 v[32:35], v[60:63], a[224:227], v[32:35]
    v_mov_b32 v113, v133
    v_mov_b32 v114, v134
    ds_read_b128 v[60:63], v9 offset:26624
    s_waitcnt lgkmcnt(2)
    v_mfma_f32_16x16x32_bf16 v[28:31], v[64:67], a[156:159], v[28:31]
    v_mfma_f32_16x16x32_bf16 v[32:35], v[64:67], a[228:231], v[32:35]
    v_fma_f32 v144, v144, s52, v72
    ds_read_b128 v[64:67], v9 offset:28672
    s_waitcnt lgkmcnt(2)
    v_mfma_f32_16x16x32_bf16 v[28:31], v[56:59], a[160:163], v[28:31]
    v_fma_f32 v145, v145, s52, v73
    v_fma_f32 v146, v146, s52, v74
    v_fma_f32 v147, v147, s52, v75
    v_mfma_f32_16x16x32_bf16 v[32:35], v[56:59], a[232:235], v[32:35]
    v_fma_f32 v148, v148, s52, v76
    v_fma_f32 v149, v149, s52, v77
    v_fma_f32 v150, v150, s52, v78
    ds_read_b128 v[56:59], v9 offset:30720
    s_waitcnt lgkmcnt(2)
    v_mfma_f32_16x16x32_bf16 v[28:31], v[60:63], a[164:167], v[28:31]
    v_fma_f32 v151, v151, s52, v79
    v_add_f32 v144, s46, v144
    v_add_f32 v145, s46, v145
    v_mfma_f32_16x16x32_bf16 v[32:35], v[60:63], a[236:239], v[32:35]
    v_add_f32 v146, s46, v146
    v_add_f32 v147, s46, v147
    v_max3_f32 v5, v144, v145, v146
    ds_read_b128 v[60:63], v9 offset:32768
    s_waitcnt lgkmcnt(2)
    v_mfma_f32_16x16x32_bf16 v[28:31], v[64:67], a[168:171], v[28:31]
    v_max3_f32 v5, v5, v147, v148
    v_max3_f32 v5, v5, v149, v150
    v_max_f32 v5, v5, v151
    v_mfma_f32_16x16x32_bf16 v[32:35], v[64:67], a[240:243], v[32:35]
    v_mov_b32 v6, v5
    s_nop 1
    v_permlane32_swap_b32 v5, v6
    ds_read_b128 v[64:67], v9 offset:34816
    s_waitcnt lgkmcnt(2)
    v_mfma_f32_16x16x32_bf16 v[28:31], v[56:59], a[172:175], v[28:31]
    v_max_f32 v5, v5, v6
    v_mov_b32 v6, v5
    v_mfma_f32_16x16x32_bf16 v[32:35], v[56:59], a[244:247], v[32:35]
    s_nop 0
    v_permlane16_swap_b32 v5, v6
    v_max_f32 v5, v5, v6
    v_sub_f32 v144, v144, v5
    s_waitcnt lgkmcnt(1)
    v_mfma_f32_16x16x32_bf16 v[28:31], v[60:63], a[176:179], v[28:31]
    v_sub_f32 v145, v145, v5
    v_sub_f32 v146, v146, v5
    v_sub_f32 v147, v147, v5
    v_mfma_f32_16x16x32_bf16 v[32:35], v[60:63], a[248:251], v[32:35]
    v_sub_f32 v148, v148, v5
    v_sub_f32 v149, v149, v5
    v_sub_f32 v150, v150, v5
    s_waitcnt lgkmcnt(0)
    v_mfma_f32_16x16x32_bf16 v[28:31], v[64:67], a[180:183], v[28:31]
    v_sub_f32 v151, v151, v5
    v_exp_f32 v144, v144
    v_exp_f32 v145, v145
    v_mfma_f32_16x16x32_bf16 v[32:35], v[64:67], a[252:255], v[32:35]
    v_exp_f32 v146, v146
    v_exp_f32 v147, v147
    v_exp_f32 v148, v148
    v_cmp_eq_u32 s[76:77], 1, v2
    v_cmp_eq_u32 vcc, 2, v2
    s_cmp_eq_u64 s[76:77], -1
    s_cselect_b32 s38, 1, 0
    s_cmp_lg_u32 s38, 0
    s_cselect_b64 exec, 1, 0
    v_mov_b32 v15, s32
    ds_write_b32 v110, v15
    v_mov_b32 v2, 2
    s_mov_b64 exec, -1
    s_add_u32 s32, s32, s38
    s_mul_i32 s38, s38, 22528
    s_add_u32 s33, s33, s38
    s_cmp_eq_u64 vcc, 0
    s_cselect_b32 s38, s32, 0x7fff
    s_cmp_le_u32 s38, s39
    s_cselect_b64 exec, -1, 0
    v_mov_b32 v2, 2
    buffer_load_dword v2, v1, s[8:11], s33 offen sc1
    s_mov_b64 exec, -1
    v_exp_f32 v149, v149
    v_exp_f32 v150, v150
    v_exp_f32 v151, v151
    v_cvt_pk_bf16_f32 v68, v144, v145
    v_cvt_pk_bf16_f32 v69, v146, v147
    v_cvt_pk_bf16_f32 v70, v148, v149
    v_cvt_pk_bf16_f32 v71, v150, v151
    s_nop 1
    v_mfma_f32_16x16x32_bf16 v[16:19], v[116:119], v[68:71], 0
    s_mul_i32 s46, s57, 36864
    s_add_u32 s46, s46, 17301504
    s_nop 5
    v_rcp_f32 v6, v16
    v_mul_f32 v94, v97, v48
    v_fma_f32 v28, v28, v96, -v94
    v_mul_f32 v94, v99, v49
    v_fma_f32 v29, v29, v98, -v94
    v_mul_f32 v94, v101, v50
    v_fma_f32 v30, v30, v100, -v94
    v_mul_f32 v94, v103, v51
    v_fma_f32 v31, v31, v102, -v94
    v_cvt_pk_bf16_f32 v138, v28, v29
    v_cvt_pk_bf16_f32 v139, v30, v31
    v_mul_f32 v94, v97, v52
    v_fma_f32 v32, v32, v96, -v94
    v_mfma_f32_16x16x32_bf16 v[20:23], v[136:139], v[68:71], 0
    v_mul_f32 v94, v99, v53
    v_fma_f32 v33, v33, v98, -v94
    v_mul_f32 v94, v101, v54
    v_fma_f32 v34, v34, v100, -v94
    v_mul_f32 v94, v103, v55
    v_fma_f32 v35, v35, v102, -v94
    v_cvt_pk_bf16_f32 v142, v32, v33
    v_cvt_pk_bf16_f32 v143, v34, v35
    v_mov_b32 v136, v138
    v_mov_b32 v137, v139
    v_mfma_f32_16x16x32_bf16 v[24:27], v[140:143], v[68:71], 0
    v_mul_f32 v20, v6, v20
    v_mul_f32 v21, v6, v21
    v_mul_f32 v22, v6, v22
    v_mul_f32 v23, v6, v23
    v_cvt_pk_bf16_f32 v20, v20, v21
    v_cvt_pk_bf16_f32 v21, v22, v23
    s_mov_b64 exec, -1
    buffer_store_dwordx2 v[20:21], v13, s[8:11], s46 offen
    s_and_b64 exec, exec, s[78:79]
    buffer_store_dwordx2 v[20:21], v13, s[8:11], s46 offen sc1
    s_mov_b64 exec, -1
    v_mov_b32 v140, v142
    v_mov_b32 v141, v143
    v_mul_f32 v24, v6, v24
    v_mul_f32 v25, v6, v25
    v_cvt_pk_bf16_f32 v24, v24, v25
    s_mov_b64 exec, 0xffff
    buffer_store_dword v24, v14, s[8:11], s46 offen
    s_and_b64 exec, exec, s[78:79]
    buffer_store_dword v24, v14, s[8:11], s46 offen sc1
    s_mov_b64 exec, -1
    s_mul_i32 s43, s57, 22528
    s_add_u32 s43, s43, s49
    s_branch Laq_head
Laq_f_8:
    ds_read_b128 v[60:63], v9 offset:8192
    s_waitcnt lgkmcnt(2)
    v_mfma_f32_16x16x32_bf16 v[28:31], v[64:67], a[120:123], v[28:31]
    v_mul_f32 v94, v93, v38
    v_fma_f32 v18, v18, v92, -v94
    v_mfma_f32_16x16x32_bf16 v[32:35], v[64:67], a[192:195], v[32:35]
    v_mul_f32 v94, v93, v39
    v_fma_f32 v19, v19, v92, -v94
    ds_read_b128 v[64:67], v9 offset:10240
    s_waitcnt lgkmcnt(2)
    v_mfma_f32_16x16x32_bf16 v[28:31], v[56:59], a[124:127], v[28:31]
    v_mul_f32 v94, v93, v44
    v_fma_f32 v24, v24, v92, -v94
    v_mfma_f32_16x16x32_bf16 v[32:35], v[56:59], a[196:199], v[32:35]
    v_mul_f32 v94, v93, v45
    v_fma_f32 v25, v25, v92, -v94
    ds_read_b128 v[56:59], v9 offset:12288
    s_waitcnt lgkmcnt(2)
    v_mfma_f32_16x16x32_bf16 v[28:31], v[60:63], a[128:131], v[28:31]
    v_mul_f32 v94, v93, v46
    v_fma_f32 v26, v26, v92, -v94
    v_mfma_f32_16x16x32_bf16 v[32:35], v[60:63], a[200:203], v[32:35]
    v_mul_f32 v94, v93, v47
    v_fma_f32 v27, v27, v92, -v94
    ds_read_b128 v[60:63], v9 offset:14336
    s_waitcnt lgkmcnt(2)
    v_mfma_f32_16x16x32_bf16 v[28:31], v[64:67], a[132:135], v[28:31]
    v_mul_f32 v94, v93, v40
    v_fma_f32 v20, v20, v92, -v94
    v_mfma_f32_16x16x32_bf16 v[32:35], v[64:67], a[204:207], v[32:35]
    v_mul_f32 v94, v93, v41
    v_fma_f32 v21, v21, v92, -v94
    ds_read_b128 v[64:67], v9 offset:16384
    s_waitcnt lgkmcnt(2)
    v_mfma_f32_16x16x32_bf16 v[28:31], v[56:59], a[136:139], v[28:31]
    v_mul_f32 v94, v93, v42
    v_fma_f32 v22, v22, v92, -v94
    v_mfma_f32_16x16x32_bf16 v[32:35], v[56:59], a[208:211], v[32:35]
    v_mul_f32 v94, v93, v43
    v_fma_f32 v23, v23, v92, -v94
    ds_read_b128 v[56:59], v9 offset:18432
    s_waitcnt lgkmcnt(2)
    v_mfma_f32_16x16x32_bf16 v[28:31], v[60:63], a[140:143], v[28:31]
    v_cvt_pk_bf16_f32 v128, v16, v17
    v_cvt_pk_bf16_f32 v129, v18, v19
    v_mfma_f32_16x16x32_bf16 v[32:35], v[60:63], a[212:215], v[32:35]
    v_cvt_pk_bf16_f32 v130, v24, v25
    v_cvt_pk_bf16_f32 v132, v20, v21
    ds_read_b128 v[60:63], v9 offset:20480
    s_waitcnt lgkmcnt(2)
    v_mfma_f32_16x16x32_bf16 v[28:31], v[64:67], a[144:147], v[28:31]
    v_cvt_pk_bf16_f32 v133, v22, v23
    v_cvt_pk_bf16_f32 v134, v26, v27
    v_mfma_f32_16x16x32_bf16 v[32:35], v[64:67], a[216:219], v[32:35]
    s_cmp_eq_u32 s35, 0
    s_cselect_b32 s46, 0xf149f2ca, 0
    ds_read_b128 v[64:67], v9 offset:22528
    s_waitcnt lgkmcnt(2)
    v_mfma_f32_16x16x32_bf16 v[28:31], v[56:59], a[148:151], v[28:31]
    s_add_u32 m0, s59, 0
    s_add_u32 s47, s41, 0
    buffer_load_dwordx4 v0, s[8:11], s47 offen offset:0 lds
    v_mfma_f32_16x16x32_bf16 v[144:147], v[112:115], v[128:131], 0
    buffer_load_dwordx4 v0, s[8:11], s47 offen offset:1024 lds
    buffer_load_dwordx4 v0, s[8:11], s47 offen offset:2048 lds
    buffer_load_dwordx4 v0, s[8:11], s47 offen offset:3072 lds
    v_mfma_f32_16x16x32_bf16 v[32:35], v[56:59], a[220:223], v[32:35]
    s_add_u32 m0, s59, 4096
    s_add_u32 s47, s41, 4096
    buffer_load_dwordx4 v0, s[8:11], s47 offen offset:0 lds
    v_mfma_f32_16x16x32_bf16 v[148:151], v[132:135], v[128:131], 0
    buffer_load_dwordx4 v0, s[8:11], s47 offen offset:1024 lds
    buffer_load_dwordx4 v0, s[8:11], s47 offen offset:2048 lds
    buffer_load_dwordx4 v0, s[8:11], s47 offen offset:3072 lds
    ds_read_b128 v[56:59], v9 offset:24576
    s_waitcnt lgkmcnt(2)
    v_mfma_f32_16x16x32_bf16 v[28:31], v[60:63], a[152:155], v[28:31]
    v_mov_b32 v112, v132
    v_mfma_f32_16x16x32_bf16 v[32:35], v[60:63], a[224:227], v[32:35]
    v_mov_b32 v113, v133
    v_mov_b32 v114, v134
    ds_read_b128 v[60:63], v9 offset:26624
    s_waitcnt lgkmcnt(2)
    v_mfma_f32_16x16x32_bf16 v[28:31], v[64:67], a[156:159], v[28:31]
    s_add_u32 m0, s59, 8192
    s_add_u32 s47, s41, 8192
    buffer_load_dwordx4 v0, s[8:11], s47 offen offset:0 lds
    v_mfma_f32_16x16x32_bf16 v[32:35], v[64:67], a[228:231], v[32:35]
    s_mul_i32 s48, s36, 786432
    s_mul_i32 s18, s37, 6144
    s_add_u32 s48, s48, s18
    s_add_u32 s48, s48, 15728640
    buffer_load_dwordx4 v[80:83], v10, s[8:11], s48 offen offset:0
    v_fma_f32 v144, v144, s52, v72
    ds_read_b128 v[64:67], v9 offset:28672
    s_waitcnt lgkmcnt(2)
    v_mfma_f32_16x16x32_bf16 v[28:31], v[56:59], a[160:163], v[28:31]
    v_fma_f32 v145, v145, s52, v73
    v_fma_f32 v146, v146, s52, v74
    v_fma_f32 v147, v147, s52, v75
    v_mfma_f32_16x16x32_bf16 v[32:35], v[56:59], a[232:235], v[32:35]
    v_fma_f32 v148, v148, s52, v76
    v_fma_f32 v149, v149, s52, v77
    v_fma_f32 v150, v150, s52, v78
    ds_read_b128 v[56:59], v9 offset:30720
    s_waitcnt lgkmcnt(2)
    v_mfma_f32_16x16x32_bf16 v[28:31], v[60:63], a[164:167], v[28:31]
    v_fma_f32 v151, v151, s52, v79
    v_add_f32 v144, s46, v144
    v_add_f32 v145, s46, v145
    v_mfma_f32_16x16x32_bf16 v[32:35], v[60:63], a[236:239], v[32:35]
    v_add_f32 v146, s46, v146
    v_add_f32 v147, s46, v147
    v_max3_f32 v5, v144, v145, v146
    ds_read_b128 v[60:63], v9 offset:32768
    s_waitcnt lgkmcnt(2)
    v_mfma_f32_16x16x32_bf16 v[28:31], v[64:67], a[168:171], v[28:31]
    v_max3_f32 v5, v5, v147, v148
    v_max3_f32 v5, v5, v149, v150
    v_max_f32 v5, v5, v151
    v_mfma_f32_16x16x32_bf16 v[32:35], v[64:67], a[240:243], v[32:35]
    buffer_load_dwordx4 v[84:87], v10, s[8:11], s48 offen offset:512
    v_mov_b32 v6, v5
    s_nop 1
    v_permlane32_swap_b32 v5, v6
    ds_read_b128 v[64:67], v9 offset:34816
    s_waitcnt lgkmcnt(2)
    v_mfma_f32_16x16x32_bf16 v[28:31], v[56:59], a[172:175], v[28:31]
    buffer_load_dwordx4 v[88:91], v10, s[8:11], s48 offen offset:1024
    v_max_f32 v5, v5, v6
    v_mov_b32 v6, v5
    v_mfma_f32_16x16x32_bf16 v[32:35], v[56:59], a[244:247], v[32:35]
    s_nop 0
    v_permlane16_swap_b32 v5, v6
    v_max_f32 v5, v5, v6
    v_sub_f32 v144, v144, v5
    s_waitcnt lgkmcnt(1)
    v_mfma_f32_16x16x32_bf16 v[28:31], v[60:63], a[176:179], v[28:31]
    v_sub_f32 v145, v145, v5
    v_sub_f32 v146, v146, v5
    v_sub_f32 v147, v147, v5
    v_mfma_f32_16x16x32_bf16 v[32:35], v[60:63], a[248:251], v[32:35]
    v_sub_f32 v148, v148, v5
    v_sub_f32 v149, v149, v5
    v_sub_f32 v150, v150, v5
    s_waitcnt lgkmcnt(0)
    v_mfma_f32_16x16x32_bf16 v[28:31], v[64:67], a[180:183], v[28:31]
    v_sub_f32 v151, v151, v5
    v_exp_f32 v144, v144
    v_exp_f32 v145, v145
    v_mfma_f32_16x16x32_bf16 v[32:35], v[64:67], a[252:255], v[32:35]
    v_exp_f32 v146, v146
    v_exp_f32 v147, v147
    v_exp_f32 v148, v148
    v_cmp_eq_u32 s[76:77], 1, v2
    v_cmp_eq_u32 vcc, 2, v2
    s_cmp_eq_u64 s[76:77], -1
    s_cselect_b32 s38, 1, 0
    s_cmp_lg_u32 s38, 0
    s_cselect_b64 exec, 1, 0
    v_mov_b32 v15, s32
    ds_write_b32 v110, v15
    v_mov_b32 v2, 2
    s_mov_b64 exec, -1
    s_add_u32 s32, s32, s38
    s_mul_i32 s38, s38, 22528
    s_add_u32 s33, s33, s38
    s_cmp_eq_u64 vcc, 0
    s_cselect_b32 s38, s32, 0x7fff
    s_cmp_le_u32 s38, s39
    s_cselect_b64 exec, -1, 0
    v_mov_b32 v2, 2
    buffer_load_dword v2, v1, s[8:11], s33 offen sc1
    s_mov_b64 exec, -1
    v_exp_f32 v149, v149
    v_exp_f32 v150, v150
    v_exp_f32 v151, v151
    v_cvt_pk_bf16_f32 v68, v144, v145
    v_cvt_pk_bf16_f32 v69, v146, v147
    v_cvt_pk_bf16_f32 v70, v148, v149
    v_cvt_pk_bf16_f32 v71, v150, v151
    s_nop 1
    v_mfma_f32_16x16x32_bf16 v[16:19], v[116:119], v[68:71], 0
    s_mul_i32 s46, s57, 36864
    s_add_u32 s46, s46, 17301504
    s_nop 5
    v_rcp_f32 v6, v16
    v_mul_f32 v94, v97, v48
    v_fma_f32 v28, v28, v96, -v94
    v_mul_f32 v94, v99, v49
    v_fma_f32 v29, v29, v98, -v94
    v_mul_f32 v94, v101, v50
    v_fma_f32 v30, v30, v100, -v94
    v_mul_f32 v94, v103, v51
    v_fma_f32 v31, v31, v102, -v94
    v_cvt_pk_bf16_f32 v138, v28, v29
    v_cvt_pk_bf16_f32 v139, v30, v31
    v_mul_f32 v94, v97, v52
    v_fma_f32 v32, v32, v96, -v94
    v_mfma_f32_16x16x32_bf16 v[20:23], v[136:139], v[68:71], 0
    v_mul_f32 v94, v99, v53
    v_fma_f32 v33, v33, v98, -v94
    v_mul_f32 v94, v101, v54
    v_fma_f32 v34, v34, v100, -v94
    v_mul_f32 v94, v103, v55
    v_fma_f32 v35, v35, v102, -v94
    v_cvt_pk_bf16_f32 v142, v32, v33
    v_cvt_pk_bf16_f32 v143, v34, v35
    v_mov_b32 v136, v138
    v_mov_b32 v137, v139
    v_mfma_f32_16x16x32_bf16 v[24:27], v[140:143], v[68:71], 0
    v_mul_f32 v20, v6, v20
    v_mul_f32 v21, v6, v21
    v_mul_f32 v22, v6, v22
    v_mul_f32 v23, v6, v23
    v_cvt_pk_bf16_f32 v20, v20, v21
    v_cvt_pk_bf16_f32 v21, v22, v23
    s_mov_b64 exec, -1
    buffer_store_dwordx2 v[20:21], v13, s[8:11], s46 offen
    s_and_b64 exec, exec, s[78:79]
    buffer_store_dwordx2 v[20:21], v13, s[8:11], s46 offen sc1
    s_mov_b64 exec, -1
    v_mov_b32 v140, v142
    v_mov_b32 v141, v143
    v_mul_f32 v24, v6, v24
    v_mul_f32 v25, v6, v25
    v_cvt_pk_bf16_f32 v24, v24, v25
    s_mov_b64 exec, 0xffff
    buffer_store_dword v24, v14, s[8:11], s46 offen
    s_and_b64 exec, exec, s[78:79]
    buffer_store_dword v24, v14, s[8:11], s46 offen sc1
    s_mov_b64 exec, -1
    s_mul_i32 s43, s57, 22528
    s_add_u32 s43, s43, s49
    s_branch Laq_head
Laq_none:
    ds_read_b32 v15, v110
    s_waitcnt lgkmcnt(0)
    v_readfirstlane_b32 s17, v15
    s_nop 0
    s_cmp_lt_i32 s17, s37
    s_cbranch_scc1 Laq_nopost
    s_add_u32 m0, s59, 0
    s_add_u32 s47, s41, 0
    buffer_load_dwordx4 v0, s[8:11], s47 offen offset:0 lds
    buffer_load_dwordx4 v0, s[8:11], s47 offen offset:1024 lds
    buffer_load_dwordx4 v0, s[8:11], s47 offen offset:2048 lds
    buffer_load_dwordx4 v0, s[8:11], s47 offen offset:3072 lds
    s_add_u32 m0, s59, 4096
    s_add_u32 s47, s41, 4096
    buffer_load_dwordx4 v0, s[8:11], s47 offen offset:0 lds
    buffer_load_dwordx4 v0, s[8:11], s47 offen offset:1024 lds
    buffer_load_dwordx4 v0, s[8:11], s47 offen offset:2048 lds
    buffer_load_dwordx4 v0, s[8:11], s47 offen offset:3072 lds
    s_add_u32 m0, s59, 8192
    s_add_u32 s47, s41, 8192
    buffer_load_dwordx4 v0, s[8:11], s47 offen offset:0 lds
    s_mul_i32 s48, s36, 786432
    s_mul_i32 s18, s37, 6144
    s_add_u32 s48, s48, s18
    s_add_u32 s48, s48, 15728640
    buffer_load_dwordx4 v[80:83], v10, s[8:11], s48 offen offset:0
    buffer_load_dwordx4 v[84:87], v10, s[8:11], s48 offen offset:512
    buffer_load_dwordx4 v[88:91], v10, s[8:11], s48 offen offset:1024
    s_waitcnt vmcnt(12)
    s_cmp_lg_u32 s43, 0
    s_cselect_b64 exec, 1, 0
    buffer_store_dword v3, v4, s[8:11], s43 offen
    s_and_b64 exec, exec, s[78:79]
    buffer_store_dword v3, v4, s[8:11], s43 offen sc1
    s_mov_b64 exec, -1
    s_mov_b32 s43, 0
    s_waitcnt vmcnt(2) lgkmcnt(0)
    s_branch Laq_head2
Laq_nopost:
    s_waitcnt vmcnt(0)
    s_cmp_lg_u32 s43, 0
    s_cselect_b64 exec, 1, 0
    buffer_store_dword v3, v4, s[8:11], s43 offen
    s_and_b64 exec, exec, s[78:79]
    buffer_store_dword v3, v4, s[8:11], s43 offen sc1
    s_mov_b64 exec, -1
    s_mov_b32 s43, 0
    s_cmp_ge_u32 s37, 64
    s_cbranch_scc1 Laq_end
Laq_wait:
    s_mov_b32 s16, 0
    s_cmp_lg_u32 s14, 0
    s_cbranch_scc1 Laq_wl
Laq_wp:
    buffer_load_dword v2, v1, s[8:11], s60 offen sc1
    s_add_u32 s16, s16, 1
    s_cmp_gt_u32 s16, 100000
    s_cbranch_scc1 Laq_giveup
    s_waitcnt vmcnt(0)
    v_cmp_eq_u32 vcc, 0, v2
    s_nop 0
    s_cbranch_vccz Laq_wok
    s_sleep 4
    s_branch Laq_wp
Laq_giveup:
    v_mov_b32 v5, -2
    ds_write_b32 v110, v5
    s_waitcnt lgkmcnt(0)
    s_branch L_role_aq_abort
Laq_wok:
    v_mov_b32 v5, s37
    ds_write_b32 v110, v5
    s_branch Laq_go
Laq_wl:
    ds_read_b32 v15, v110
    s_add_u32 s16, s16, 1
    s_cmp_gt_u32 s16, 1600000
    s_cbranch_scc1 L_role_aq_abort
    s_waitcnt lgkmcnt(0)
    v_readfirstlane_b32 s17, v15
    s_nop 0
    s_cmp_eq_u32 s17, -2
    s_cbranch_scc1 L_role_aq_abort
    s_cmp_ge_i32 s17, s37
    s_cbranch_scc1 Laq_go
    s_sleep 1
    s_branch Laq_wl
Laq_go:
    s_add_u32 m0, s59, 0
    s_add_u32 s47, s41, 0
    buffer_load_dwordx4 v0, s[8:11], s47 offen offset:0 lds
    buffer_load_dwordx4 v0, s[8:11], s47 offen offset:1024 lds
    buffer_load_dwordx4 v0, s[8:11], s47 offen offset:2048 lds
    buffer_load_dwordx4 v0, s[8:11], s47 offen offset:3072 lds
    s_add_u32 m0, s59, 4096
    s_add_u32 s47, s41, 4096
    buffer_load_dwordx4 v0, s[8:11], s47 offen offset:0 lds
    buffer_load_dwordx4 v0, s[8:11], s47 offen offset:1024 lds
    buffer_load_dwordx4 v0, s[8:11], s47 offen offset:2048 lds
    buffer_load_dwordx4 v0, s[8:11], s47 offen offset:3072 lds
    s_add_u32 m0, s59, 8192
    s_add_u32 s47, s41, 8192
    buffer_load_dwordx4 v0, s[8:11], s47 offen offset:0 lds
    s_mul_i32 s48, s36, 786432
    s_mul_i32 s18, s37, 6144
    s_add_u32 s48, s48, s18
    s_add_u32 s48, s48, 15728640
    buffer_load_dwordx4 v[80:83], v10, s[8:11], s48 offen offset:0
    buffer_load_dwordx4 v[84:87], v10, s[8:11], s48 offen offset:512
    buffer_load_dwordx4 v[88:91], v10, s[8:11], s48 offen offset:1024
    s_waitcnt vmcnt(0) lgkmcnt(0)
    s_branch Laq_head2
Laq_end:
    s_branch L_role_aq_exit
L_role_aq_abort:
    s_waitcnt lgkmcnt(0)
    s_mov_b64 exec, -1
    v_mov_b32 v0, 60
    s_lshl_b32 s5, s3, 8
    s_or_b32 s5, s5, s4
    s_or_b32 s5, s5, 0x10000
    v_mov_b32 v1, s5
    global_store_dword v0, v1, s[12:13]
    s_endpgm
L_role_aq_exit:
    s_endpgm
.p2align 6
L_role_ta:
    v_and_b32 v5, 63, v0
    v_lshlrev_b32 v0, 4, v5
    v_and_b32 v7, 15, v5
    v_lshrrev_b32 v8, 4, v5
    v_min_u32 v1, 12, v5
    v_lshrrev_b32 v6, 2, v1
    v_and_b32 v1, 3, v1
    v_lshlrev_b32 v1, 2, v1
    v_lshl_add_u32 v1, v6, 7, v1
    v_mov_b32 v3, 1
    v_mov_b32 v4, 0
    s_mov_b32 s44, 0x05040100
    s_mov_b32 s45, 0x07060302
    s_cmp_ge_u32 s15, 11
    s_cselect_b32 s36, 1, 0
    s_cselect_b32 s17, 11, 0
    s_sub_u32 s17, s15, s17
    s_mul_i32 s50, s17, 3
    s_add_u32 s50, s50, s14
    s_cmp_eq_u32 s14, 3
    s_cselect_b32 s50, 32, s50
    s_mov_b32 s40, s50
    s_mov_b32 s37, 0
    s_mov_b32 s52, 0x3e0293ee
    v_lshrrev_b32 v5, 2, v7
    v_and_b32 v6, 1, v7
    v_lshl_add_u32 v5, v5, 1, v6
    v_lshlrev_b32 v9, 8, v5
    v_lshl_add_u32 v9, v8, 4, v9
    v_lshrrev_b32 v10, 1, v0
    v_mov_b32 v11, 384
    v_mov_b32 v6, 0xf149f2ca
    v_mov_b32 v21, 0
    v_mov_b32 v22, 0
    s_mul_i32 s42, s36, 1441792
    s_lshl_b32 s17, s50, 9
    s_add_u32 s42, s42, s17
    s_add_u32 s42, s42, 5376
    s_mul_i32 s51, s36, 50331648
    s_lshl_b32 s17, s50, 13
    s_add_u32 s51, s51, s17
    s_add_u32 s51, s51, 44040192
    s_lshl_b32 s47, s36, 11
    s_add_u32 s47, s47, s50
    s_lshl_b32 s48, s47, 13
    s_add_u32 s48, s48, 144703488
    s_lshl_b32 s47, s47, 12
    s_add_u32 s47, s47, 27262976
    s_mul_i32 s43, s36, 1441792
    s_lshr_b32 s17, s50, 2
    s_lshl_b32 s17, s17, 7
    s_add_u32 s43, s43, s17
    s_and_b32 s17, s50, 3
    s_lshl_b32 s17, s17, 2
    s_add_u32 s43, s43, s17
    s_add_u32 s43, s43, 4224
    s_mov_b32 s28, s8
    s_mov_b32 s29, s9
    s_mov_b32 s30, 0
    s_mov_b32 s31, 0x00020000
    s_mov_b32 s39, 0
    s_mov_b32 s38, 0
    s_mov_b32 s49, 0
    s_mov_b32 s20, s8
    s_mov_b32 s21, s9
    s_mov_b32 s22, 0
    s_mov_b32 s23, 0x00020000
    v_mov_b32 v16, 0x3f803f80
    v_lshl_add_u32 v5, v8, 2, 0
    v_cmp_le_u32 vcc, v5, v7
    s_nop 1
    v_cndmask_b32 v236, v6, v4, vcc
    v_mov_b32 v17, 0x3f803f80
    v_lshl_add_u32 v5, v8, 2, 1
    v_cmp_le_u32 vcc, v5, v7
    s_nop 1
    v_cndmask_b32 v237, v6, v4, vcc
    v_mov_b32 v18, 0x3f803f80
    v_lshl_add_u32 v5, v8, 2, 2
    v_cmp_le_u32 vcc, v5, v7
    s_nop 1
    v_cndmask_b32 v238, v6, v4, vcc
    v_mov_b32 v19, 0x3f803f80
    v_lshl_add_u32 v5, v8, 2, 3
    v_cmp_le_u32 vcc, v5, v7
    s_nop 1
    v_cndmask_b32 v239, v6, v4, vcc
    v_mov_b32 v15, 0
    s_cmp_lg_u32 s14, 0
    s_cbranch_scc1 Lta_inia_d
    v_mov_b32 v5, 40
    s_mov_b32 s16, 0
Lta_inia:
    global_load_dword v6, v5, s[12:13] sc1
    s_add_u32 s16, s16, 1
    s_cmp_gt_u32 s16, 100000
    s_cbranch_scc1 L_role_ta_abort
    s_waitcnt vmcnt(0)
    v_cmp_gt_u32 vcc, 128, v6
    s_nop 0
    s_cbranch_vccz Lta_inia_d
    s_sleep 8
    s_branch Lta_inia
Lta_inia_d:
    s_barrier
    s_cmp_eq_u32 s36, 0
    s_cbranch_scc1 Lta_ini_sk
    s_cmp_lg_u32 s14, 0
    s_cbranch_scc1 Lta_inib_d
    v_mov_b32 v5, 160
    s_mov_b32 s16, 0
Lta_inib:
    global_load_dword v6, v5, s[12:13] sc1
    s_add_u32 s16, s16, 1
    s_cmp_gt_u32 s16, 100000
    s_cbranch_scc1 L_role_ta_abort
    s_waitcnt vmcnt(0)
    v_cmp_gt_u32 vcc, 64, v6
    s_nop 0
    s_cbranch_vccz Lta_inib_d
    s_sleep 8
    s_branch Lta_inib
Lta_inib_d:
    s_barrier
Lta_ini_sk:
    s_cmp_ge_u32 s40, 32
    s_cbranch_scc1 L_role_ta_exit
Lta0:
    s_cmp_eq_u32 s39, 1
    s_cbranch_scc1 Lta0_have
    s_waitcnt vmcnt(0)
    s_cmp_lg_u32 s49, 0
    s_cselect_b64 exec, 1, 0
    buffer_store_dword v3, v4, s[8:11], s43 offen sc1
    s_mov_b64 exec, -1
    s_add_u32 s43, s43, s49
    s_mov_b32 s49, 0
    s_mov_b32 s16, 0
Lta0_f:
    buffer_load_dword v2, v1, s[8:11], s42 offen sc1
    s_add_u32 s16, s16, 1
    s_cmp_gt_u32 s16, 100000
    s_cbranch_scc1 L_role_ta_abort
    s_waitcnt vmcnt(0)
    v_cmp_eq_u32 vcc, 0, v2
    s_nop 0
    s_and_b32 s17, vcc_lo, 0xfff
    s_cbranch_scc0 Lta0_fd
    s_sleep 4
    s_branch Lta0_f
Lta0_fd:
    s_add_u32 s46, s51, 0
    buffer_load_dwordx4 v[140:143], v0, s[8:11], s46 offen offset:0
    buffer_load_dwordx4 v[144:147], v0, s[8:11], s46 offen offset:1024
    buffer_load_dwordx4 v[148:151], v0, s[8:11], s46 offen offset:2048
    buffer_load_dwordx4 v[152:155], v0, s[8:11], s46 offen offset:3072
    s_add_u32 s46, s51, 4096
    buffer_load_dwordx4 v[156:159], v0, s[8:11], s46 offen offset:0
    buffer_load_dwordx4 v[160:163], v0, s[8:11], s46 offen offset:1024
    buffer_load_dwordx4 v[164:167], v0, s[8:11], s46 offen offset:2048
    buffer_load_dwordx4 v[168:171], v0, s[8:11], s46 offen offset:3072
    s_add_u32 s46, s51, 16777216
    buffer_load_dwordx4 v[172:175], v0, s[8:11], s46 offen offset:0
    buffer_load_dwordx4 v[176:179], v0, s[8:11], s46 offen offset:1024
    buffer_load_dwordx4 v[180:183], v0, s[8:11], s46 offen offset:2048
    buffer_load_dwordx4 v[184:187], v0, s[8:11], s46 offen offset:3072
    s_add_u32 s46, s51, 16781312
    buffer_load_dwordx4 v[188:191], v0, s[8:11], s46 offen offset:0
    buffer_load_dwordx4 v[192:195], v0, s[8:11], s46 offen offset:1024
    buffer_load_dwordx4 v[196:199], v0, s[8:11], s46 offen offset:2048
    buffer_load_dwordx4 v[200:203], v0, s[8:11], s46 offen offset:3072
    s_add_u32 s46, s51, 33554432
    buffer_load_dwordx4 v[204:207], v0, s[8:11], s46 offen offset:0
    buffer_load_dwordx4 v[208:211], v0, s[8:11], s46 offen offset:1024
    buffer_load_dwordx4 v[212:215], v0, s[8:11], s46 offen offset:2048
    buffer_load_dwordx4 v[216:219], v0, s[8:11], s46 offen offset:3072
    s_add_u32 s46, s51, 33558528
    buffer_load_dwordx4 v[220:223], v0, s[8:11], s46 offen offset:0
    buffer_load_dwordx4 v[224:227], v0, s[8:11], s46 offen offset:1024
    buffer_load_dwordx4 v[228:231], v0, s[8:11], s46 offen offset:2048
    buffer_load_dwordx4 v[232:235], v0, s[8:11], s46 offen offset:3072
    s_waitcnt vmcnt(0)
Lta0_have:
    buffer_load_dword v2, v11, s[8:11], s42 offen sc1
    s_waitcnt vmcnt(5)
    v_cmp_eq_u32 vcc, 0, v15
    s_add_u32 s51, s51, 262144
    s_add_u32 s37, s37, 1
    s_mov_b32 s62, s38
    s_and_b32 s17, vcc_lo, 0xfff
    s_cselect_b32 s39, 0, 1
    s_cmp_eq_u64 vcc, 0
    s_cselect_b32 s38, 1, 0
    s_cmp_lt_u32 s37, 64
    s_cselect_b32 s39, s39, 0
    s_cselect_b32 s38, s38, 0
    s_cmp_eq_u32 s39, 1
    s_cselect_b32 s30, 268435456, 0
    s_cmp_eq_u32 s38, 1
    s_cselect_b32 s22, 268435456, 0
    v_mfma_f32_16x16x32_bf16 v[32:35], v[172:175], v[140:143], 0
    s_add_u32 s46, s51, 0
    buffer_load_dwordx4 a[0:3], v0, s[28:31], s46 offen offset:0
    v_mfma_f32_16x16x32_bf16 v[36:39], v[172:175], v[144:147], 0
    buffer_load_dwordx4 a[4:7], v0, s[28:31], s46 offen offset:1024
    v_mfma_f32_16x16x32_bf16 v[40:43], v[176:179], v[144:147], 0
    buffer_load_dwordx4 a[8:11], v0, s[28:31], s46 offen offset:2048
    v_mfma_f32_16x16x32_bf16 v[32:35], v[180:183], v[148:151], v[32:35]
    buffer_load_dwordx4 a[12:15], v0, s[28:31], s46 offen offset:3072
    v_mfma_f32_16x16x32_bf16 v[36:39], v[180:183], v[152:155], v[36:39]
    s_add_u32 s46, s51, 4096
    buffer_load_dwordx4 a[16:19], v0, s[28:31], s46 offen offset:0
    v_mfma_f32_16x16x32_bf16 v[40:43], v[184:187], v[152:155], v[40:43]
    buffer_load_dwordx4 a[20:23], v0, s[28:31], s46 offen offset:1024
    v_mfma_f32_16x16x32_bf16 v[32:35], v[188:191], v[156:159], v[32:35]
    v_mfma_f32_16x16x32_bf16 v[36:39], v[188:191], v[160:163], v[36:39]
    v_mfma_f32_16x16x32_bf16 v[40:43], v[192:195], v[160:163], v[40:43]
    v_mfma_f32_16x16x32_bf16 v[32:35], v[196:199], v[164:167], v[32:35]
    v_mfma_f32_16x16x32_bf16 v[36:39], v[196:199], v[168:171], v[36:39]
    v_mfma_f32_16x16x32_bf16 v[40:43], v[200:203], v[168:171], v[40:43]
    s_waitcnt vmcnt(7)
    s_cmp_lg_u32 s49, 0
    s_cselect_b64 exec, 1, 0
    buffer_store_dword v3, v4, s[8:11], s43 offen sc1
    s_mov_b64 exec, -1
    s_add_u32 s43, s43, s49
    s_mov_b32 s49, 0
    s_cmp_eq_u32 s62, 1
    s_cbranch_scc1 Lta0_km
    s_waitcnt vmcnt(6)
    v_cmp_eq_u32 vcc, 0, v2
    s_nop 0
    s_cbranch_vccz Lta0_r
    s_mov_b32 s16, 0
Lta0_rp:
    buffer_load_dword v2, v11, s[8:11], s42 offen sc1
    s_add_u32 s16, s16, 1
    s_cmp_gt_u32 s16, 100000
    s_cbranch_scc1 L_role_ta_abort
    s_waitcnt vmcnt(0)
    v_cmp_eq_u32 vcc, 0, v2
    s_nop 0
    s_cbranch_vccnz Lta0_rp
Lta0_r:
    buffer_load_dwordx4 a[96:99], v9, s[8:11], s47 offen offset:0
    buffer_load_dwordx4 a[100:103], v9, s[8:11], s47 offen offset:64
    buffer_load_dwordx4 a[104:107], v9, s[8:11], s47 offen offset:128
    buffer_load_dwordx4 a[108:111], v9, s[8:11], s47 offen offset:192
    buffer_load_dwordx2 a[112:113], v10, s[8:11], s47 offen offset:2048
    buffer_load_dwordx2 a[114:115], v10, s[8:11], s47 offen offset:2560
    buffer_load_dwordx2 a[116:117], v10, s[8:11], s47 offen offset:3072
    buffer_load_dwordx2 a[118:119], v10, s[8:11], s47 offen offset:3584
Lta0_km:
    s_add_u32 s42, s42, 22528
    s_add_u32 s47, s47, 131072
    v_fma_f32 v32, v32, s52, v236
    v_fma_f32 v33, v33, s52, v237
    v_fma_f32 v34, v34, s52, v238
    v_fma_f32 v35, v35, s52, v239
    buffer_load_dwordx4 a[24:27], v0, s[28:31], s46 offen offset:2048
    buffer_load_dwordx4 a[28:31], v0, s[28:31], s46 offen offset:3072
    v_mul_f32 v36, s52, v36
    v_mul_f32 v37, s52, v37
    v_mul_f32 v38, s52, v38
    v_mul_f32 v39, s52, v39
    s_add_u32 s46, s51, 16777216
    buffer_load_dwordx4 a[32:35], v0, s[28:31], s46 offen offset:0
    buffer_load_dwordx4 a[36:39], v0, s[28:31], s46 offen offset:1024
    v_fma_f32 v40, v40, s52, v236
    v_fma_f32 v41, v41, s52, v237
    v_fma_f32 v42, v42, s52, v238
    v_fma_f32 v43, v43, s52, v239
    buffer_load_dwordx4 a[40:43], v0, s[28:31], s46 offen offset:2048
    buffer_load_dwordx4 a[44:47], v0, s[28:31], s46 offen offset:3072
    s_waitcnt vmcnt(13)
    v_mfma_f32_16x16x32_bf16 v[44:47], a[96:99], v[140:143], 0
    v_mfma_f32_16x16x32_bf16 v[48:51], a[96:99], v[144:147], 0
    s_add_u32 s46, s51, 16781312
    buffer_load_dwordx4 a[48:51], v0, s[28:31], s46 offen offset:0
    s_waitcnt vmcnt(13)
    v_mfma_f32_16x16x32_bf16 v[44:47], a[100:103], v[148:151], v[44:47]
    v_mfma_f32_16x16x32_bf16 v[48:51], a[100:103], v[152:155], v[48:51]
    buffer_load_dwordx4 a[52:55], v0, s[28:31], s46 offen offset:1024
    s_waitcnt vmcnt(13)
    v_mfma_f32_16x16x32_bf16 v[44:47], a[104:107], v[156:159], v[44:47]
    v_mfma_f32_16x16x32_bf16 v[48:51], a[104:107], v[160:163], v[48:51]
    buffer_load_dwordx4 a[56:59], v0, s[28:31], s46 offen offset:2048
    s_waitcnt vmcnt(13)
    v_mfma_f32_16x16x32_bf16 v[44:47], a[108:111], v[164:167], v[44:47]
    v_mfma_f32_16x16x32_bf16 v[48:51], a[108:111], v[168:171], v[48:51]
    buffer_load_dwordx4 a[60:63], v0, s[28:31], s46 offen offset:3072
    v_max3_f32 v5, v32, v33, v34
    v_max_f32 v5, v5, v35
    s_nop 0
    v_mul_f32 v44, s52, v44
    v_mul_f32 v45, s52, v45
    v_max3_f32 v5, v5, v44, v45
    v_mov_b32 v6, v5
    s_add_u32 s46, s51, 33554432
    buffer_load_dwordx4 a[64:67], v0, s[28:31], s46 offen offset:0
    v_permlane32_swap_b32 v5, v6
    v_max_f32 v5, v5, v6
    v_mov_b32 v6, v5
    buffer_load_dwordx4 a[68:71], v0, s[28:31], s46 offen offset:1024
    s_nop 0
    v_permlane16_swap_b32 v5, v6
    v_max_f32 v5, v5, v6
    v_sub_f32 v32, v32, v5
    v_sub_f32 v33, v33, v5
    v_sub_f32 v34, v34, v5
    v_sub_f32 v35, v35, v5
    v_sub_f32 v44, v44, v5
    v_sub_f32 v45, v45, v5
    v_exp_f32 v32, v32
    v_exp_f32 v33, v33
    v_exp_f32 v34, v34
    v_exp_f32 v35, v35
    v_exp_f32 v44, v44
    v_exp_f32 v45, v45
    v_cvt_pk_bf16_f32 v24, v32, v33
    v_cvt_pk_bf16_f32 v25, v34, v35
    v_mov_b32 v26, 0
    v_mov_b32 v27, 0
    v_cvt_pk_bf16_f32 v20, v44, v45
    v_cvt_pk_bf16_f32 v23, v44, v45
    v_mfma_f32_16x16x32_bf16 v[28:31], v[16:19], v[24:27], 0
    v_mfma_f32_16x16x32_bf16 v[76:79], v[204:207], v[24:27], 0
    v_mfma_f32_16x16x32_bf16 v[80:83], v[208:211], v[24:27], 0
    s_add_u32 s17, s42, 22528
    buffer_load_dword v15, v1, s[8:11], s17 offen sc1
    v_mfma_f32_16x16x32_bf16 v[84:87], v[212:215], v[24:27], 0
    v_mfma_f32_16x16x32_bf16 v[88:91], v[216:219], v[24:27], 0
    buffer_load_dwordx4 a[72:75], v0, s[28:31], s46 offen offset:2048
    v_mfma_f32_16x16x32_bf16 v[92:95], v[220:223], v[24:27], 0
    v_mfma_f32_16x16x32_bf16 v[96:99], v[224:227], v[24:27], 0
    buffer_load_dwordx4 a[76:79], v0, s[28:31], s46 offen offset:3072
    v_mfma_f32_16x16x16_bf16 v[28:31], v[16:17], v[20:21], v[28:31]
    v_mfma_f32_16x16x32_bf16 v[100:103], v[228:231], v[24:27], 0
    v_mfma_f32_16x16x32_bf16 v[104:107], v[232:235], v[24:27], 0
    s_add_u32 s46, s51, 33558528
    buffer_load_dwordx4 a[80:83], v0, s[28:31], s46 offen offset:0
    s_waitcnt vmcnt(19)
    v_mfma_f32_16x16x16_bf16 v[76:79], a[112:113], v[20:21], v[76:79]
    v_mfma_f32_16x16x16_bf16 v[80:83], a[112:113], v[22:23], v[80:83]
    v_rcp_f32 v6, v28
    s_waitcnt vmcnt(18)
    v_mfma_f32_16x16x16_bf16 v[84:87], a[114:115], v[20:21], v[84:87]
    v_mfma_f32_16x16x16_bf16 v[88:91], a[114:115], v[22:23], v[88:91]
    v_mul_f32 v76, v6, v76
    v_mul_f32 v80, v6, v80
    v_cvt_pk_bf16_f32 v108, v76, v80
    v_mul_f32 v77, v6, v77
    v_mul_f32 v81, v6, v81
    v_cvt_pk_bf16_f32 v109, v77, v81
    v_mul_f32 v78, v6, v78
    v_mul_f32 v82, v6, v82
    v_cvt_pk_bf16_f32 v110, v78, v82
    v_mul_f32 v79, v6, v79
    v_mul_f32 v83, v6, v83
    v_cvt_pk_bf16_f32 v111, v79, v83
    s_add_u32 s17, s48, 0
    buffer_store_dwordx4 v[108:111], v0, s[8:11], s17 offen offset:0 sc1
    buffer_load_dwordx4 a[84:87], v0, s[28:31], s46 offen offset:1024
    s_waitcnt vmcnt(19)
    v_mfma_f32_16x16x16_bf16 v[92:95], a[116:117], v[20:21], v[92:95]
    v_mfma_f32_16x16x16_bf16 v[96:99], a[116:117], v[22:23], v[96:99]
    v_mul_f32 v84, v6, v84
    v_mul_f32 v88, v6, v88
    v_cvt_pk_bf16_f32 v112, v84, v88
    v_mul_f32 v85, v6, v85
    v_mul_f32 v89, v6, v89
    v_cvt_pk_bf16_f32 v113, v85, v89
    v_mul_f32 v86, v6, v86
    v_mul_f32 v90, v6, v90
    v_cvt_pk_bf16_f32 v114, v86, v90
    v_mul_f32 v87, v6, v87
    v_mul_f32 v91, v6, v91
    v_cvt_pk_bf16_f32 v115, v87, v91
    buffer_store_dwordx4 v[112:115], v0, s[8:11], s17 offen offset:2048 sc1
    buffer_load_dwordx4 a[88:91], v0, s[28:31], s46 offen offset:2048
    s_waitcnt vmcnt(20)
    v_mfma_f32_16x16x16_bf16 v[100:103], a[118:119], v[20:21], v[100:103]
    v_mfma_f32_16x16x16_bf16 v[104:107], a[118:119], v[22:23], v[104:107]
    v_mul_f32 v92, v6, v92
    v_mul_f32 v96, v6, v96
    v_cvt_pk_bf16_f32 v116, v92, v96
    v_mul_f32 v93, v6, v93
    v_mul_f32 v97, v6, v97
    v_cvt_pk_bf16_f32 v117, v93, v97
    v_mul_f32 v94, v6, v94
    v_mul_f32 v98, v6, v98
    v_cvt_pk_bf16_f32 v118, v94, v98
    v_mul_f32 v95, v6, v95
    v_mul_f32 v99, v6, v99
    v_cvt_pk_bf16_f32 v119, v95, v99
    s_add_u32 s17, s48, 4096
    buffer_store_dwordx4 v[116:119], v0, s[8:11], s17 offen offset:0 sc1
    buffer_load_dwordx4 a[92:95], v0, s[28:31], s46 offen offset:3072
    v_mul_f32 v100, v6, v100
    v_mul_f32 v104, v6, v104
    v_cvt_pk_bf16_f32 v120, v100, v104
    v_mul_f32 v101, v6, v101
    v_mul_f32 v105, v6, v105
    v_cvt_pk_bf16_f32 v121, v101, v105
    v_mul_f32 v102, v6, v102
    v_mul_f32 v106, v6, v106
    v_cvt_pk_bf16_f32 v122, v102, v106
    v_mul_f32 v103, v6, v103
    v_mul_f32 v107, v6, v107
    v_cvt_pk_bf16_f32 v123, v103, v107
    buffer_store_dwordx4 v[120:123], v0, s[8:11], s17 offen offset:2048 sc1
    buffer_load_dwordx4 a[120:123], v9, s[20:23], s47 offen offset:0
    v_max3_f32 v5, v36, v37, v38
    v_max_f32 v5, v5, v39
    v_max3_f32 v5, v5, v40, v41
    v_max3_f32 v5, v5, v42, v43
    v_mul_f32 v48, s52, v48
    v_mul_f32 v49, s52, v49
    v_max3_f32 v5, v5, v48, v49
    v_mov_b32 v6, v5
    buffer_load_dwordx4 a[124:127], v9, s[20:23], s47 offen offset:64
    s_nop 0
    v_permlane32_swap_b32 v5, v6
    v_max_f32 v5, v5, v6
    v_mov_b32 v6, v5
    buffer_load_dwordx4 a[128:131], v9, s[20:23], s47 offen offset:128
    s_nop 0
    v_permlane16_swap_b32 v5, v6
    v_max_f32 v5, v5, v6
    v_sub_f32 v36, v36, v5
    v_sub_f32 v37, v37, v5
    v_sub_f32 v38, v38, v5
    v_sub_f32 v39, v39, v5
    v_sub_f32 v40, v40, v5
    v_sub_f32 v41, v41, v5
    v_sub_f32 v42, v42, v5
    v_sub_f32 v43, v43, v5
    v_sub_f32 v48, v48, v5
    v_sub_f32 v49, v49, v5
    v_exp_f32 v36, v36
    v_exp_f32 v37, v37
    v_exp_f32 v38, v38
    v_exp_f32 v39, v39
    v_exp_f32 v40, v40
    v_exp_f32 v41, v41
    v_exp_f32 v42, v42
    v_exp_f32 v43, v43
    v_exp_f32 v48, v48
    v_exp_f32 v49, v49
    v_cvt_pk_bf16_f32 v24, v36, v37
    v_cvt_pk_bf16_f32 v25, v38, v39
    v_cvt_pk_bf16_f32 v26, v40, v41
    v_cvt_pk_bf16_f32 v27, v42, v43
    v_cvt_pk_bf16_f32 v20, v48, v49
    v_cvt_pk_bf16_f32 v23, v48, v49
    v_mfma_f32_16x16x32_bf16 v[28:31], v[16:19], v[24:27], 0
    v_mfma_f32_16x16x32_bf16 v[76:79], v[204:207], v[24:27], 0
    v_mfma_f32_16x16x32_bf16 v[80:83], v[208:211], v[24:27], 0
    buffer_load_dwordx4 a[132:135], v9, s[20:23], s47 offen offset:192
    v_mfma_f32_16x16x32_bf16 v[84:87], v[212:215], v[24:27], 0
    v_mfma_f32_16x16x32_bf16 v[88:91], v[216:219], v[24:27], 0
    buffer_load_dwordx2 a[136:137], v10, s[20:23], s47 offen offset:2048
    v_mfma_f32_16x16x32_bf16 v[92:95], v[220:223], v[24:27], 0
    v_mfma_f32_16x16x32_bf16 v[96:99], v[224:227], v[24:27], 0
    buffer_load_dwordx2 a[138:139], v10, s[20:23], s47 offen offset:2560
    v_mfma_f32_16x16x16_bf16 v[28:31], v[16:17], v[20:21], v[28:31]
    v_mfma_f32_16x16x32_bf16 v[100:103], v[228:231], v[24:27], 0
    v_mfma_f32_16x16x32_bf16 v[104:107], v[232:235], v[24:27], 0
    buffer_load_dwordx2 a[140:141], v10, s[20:23], s47 offen offset:3072
    buffer_load_dwordx2 a[142:143], v10, s[20:23], s47 offen offset:3584
    v_mfma_f32_16x16x16_bf16 v[76:79], a[112:113], v[20:21], v[76:79]
    v_mfma_f32_16x16x16_bf16 v[80:83], a[112:113], v[22:23], v[80:83]
    v_rcp_f32 v6, v28
    v_mfma_f32_16x16x16_bf16 v[84:87], a[114:115], v[20:21], v[84:87]
    v_mfma_f32_16x16x16_bf16 v[88:91], a[114:115], v[22:23], v[88:91]
    v_mul_f32 v76, v6, v76
    v_mul_f32 v80, v6, v80
    v_cvt_pk_bf16_f32 v124, v76, v80
    v_mul_f32 v77, v6, v77
    v_mul_f32 v81, v6, v81
    v_cvt_pk_bf16_f32 v125, v77, v81
    v_mul_f32 v78, v6, v78
    v_mul_f32 v82, v6, v82
    v_cvt_pk_bf16_f32 v126, v78, v82
    v_mul_f32 v79, v6, v79
    v_mul_f32 v83, v6, v83
    v_cvt_pk_bf16_f32 v127, v79, v83
    s_add_u32 s17, s48, 0
    buffer_store_dwordx4 v[124:127], v0, s[8:11], s17 offen offset:1024 sc1
    v_mfma_f32_16x16x16_bf16 v[92:95], a[116:117], v[20:21], v[92:95]
    v_mfma_f32_16x16x16_bf16 v[96:99], a[116:117], v[22:23], v[96:99]
    v_mul_f32 v84, v6, v84
    v_mul_f32 v88, v6, v88
    v_cvt_pk_bf16_f32 v128, v84, v88
    v_mul_f32 v85, v6, v85
    v_mul_f32 v89, v6, v89
    v_cvt_pk_bf16_f32 v129, v85, v89
    v_mul_f32 v86, v6, v86
    v_mul_f32 v90, v6, v90
    v_cvt_pk_bf16_f32 v130, v86, v90
    v_mul_f32 v87, v6, v87
    v_mul_f32 v91, v6, v91
    v_cvt_pk_bf16_f32 v131, v87, v91
    buffer_store_dwordx4 v[128:131], v0, s[8:11], s17 offen offset:3072 sc1
    v_mfma_f32_16x16x16_bf16 v[100:103], a[118:119], v[20:21], v[100:103]
    v_mfma_f32_16x16x16_bf16 v[104:107], a[118:119], v[22:23], v[104:107]
    v_mul_f32 v92, v6, v92
    v_mul_f32 v96, v6, v96
    v_cvt_pk_bf16_f32 v132, v92, v96
    v_mul_f32 v93, v6, v93
    v_mul_f32 v97, v6, v97
    v_cvt_pk_bf16_f32 v133, v93, v97
    v_mul_f32 v94, v6, v94
    v_mul_f32 v98, v6, v98
    v_cvt_pk_bf16_f32 v134, v94, v98
    v_mul_f32 v95, v6, v95
    v_mul_f32 v99, v6, v99
    v_cvt_pk_bf16_f32 v135, v95, v99
    s_add_u32 s17, s48, 4096
    buffer_store_dwordx4 v[132:135], v0, s[8:11], s17 offen offset:1024 sc1
    v_mul_f32 v100, v6, v100
    v_mul_f32 v104, v6, v104
    v_cvt_pk_bf16_f32 v136, v100, v104
    v_mul_f32 v101, v6, v101
    v_mul_f32 v105, v6, v105
    v_cvt_pk_bf16_f32 v137, v101, v105
    v_mul_f32 v102, v6, v102
    v_mul_f32 v106, v6, v106
    v_cvt_pk_bf16_f32 v138, v102, v106
    v_mul_f32 v103, v6, v103
    v_mul_f32 v107, v6, v107
    v_cvt_pk_bf16_f32 v139, v103, v107
    buffer_store_dwordx4 v[136:139], v0, s[8:11], s17 offen offset:3072 sc1
    s_add_u32 s48, s48, 262144
    s_mov_b32 s49, 22528
    s_cmp_ge_u32 s37, 64
    s_cbranch_scc1 Lta_end
Lta1:
    s_cmp_eq_u32 s39, 1
    s_cbranch_scc1 Lta1_have
    s_waitcnt vmcnt(0)
    s_cmp_lg_u32 s49, 0
    s_cselect_b64 exec, 1, 0
    buffer_store_dword v3, v4, s[8:11], s43 offen sc1
    s_mov_b64 exec, -1
    s_add_u32 s43, s43, s49
    s_mov_b32 s49, 0
    s_mov_b32 s16, 0
Lta1_f:
    buffer_load_dword v2, v1, s[8:11], s42 offen sc1
    s_add_u32 s16, s16, 1
    s_cmp_gt_u32 s16, 100000
    s_cbranch_scc1 L_role_ta_abort
    s_waitcnt vmcnt(0)
    v_cmp_eq_u32 vcc, 0, v2
    s_nop 0
    s_and_b32 s17, vcc_lo, 0xfff
    s_cbranch_scc0 Lta1_fd
    s_sleep 4
    s_branch Lta1_f
Lta1_fd:
    s_add_u32 s46, s51, 0
    buffer_load_dwordx4 a[0:3], v0, s[8:11], s46 offen offset:0
    buffer_load_dwordx4 a[4:7], v0, s[8:11], s46 offen offset:1024
    buffer_load_dwordx4 a[8:11], v0, s[8:11], s46 offen offset:2048
    buffer_load_dwordx4 a[12:15], v0, s[8:11], s46 offen offset:3072
    s_add_u32 s46, s51, 4096
    buffer_load_dwordx4 a[16:19], v0, s[8:11], s46 offen offset:0
    buffer_load_dwordx4 a[20:23], v0, s[8:11], s46 offen offset:1024
    buffer_load_dwordx4 a[24:27], v0, s[8:11], s46 offen offset:2048
    buffer_load_dwordx4 a[28:31], v0, s[8:11], s46 offen offset:3072
    s_add_u32 s46, s51, 16777216
    buffer_load_dwordx4 a[32:35], v0, s[8:11], s46 offen offset:0
    buffer_load_dwordx4 a[36:39], v0, s[8:11], s46 offen offset:1024
    buffer_load_dwordx4 a[40:43], v0, s[8:11], s46 offen offset:2048
    buffer_load_dwordx4 a[44:47], v0, s[8:11], s46 offen offset:3072
    s_add_u32 s46, s51, 16781312
    buffer_load_dwordx4 a[48:51], v0, s[8:11], s46 offen offset:0
    buffer_load_dwordx4 a[52:55], v0, s[8:11], s46 offen offset:1024
    buffer_load_dwordx4 a[56:59], v0, s[8:11], s46 offen offset:2048
    buffer_load_dwordx4 a[60:63], v0, s[8:11], s46 offen offset:3072
    s_add_u32 s46, s51, 33554432
    buffer_load_dwordx4 a[64:67], v0, s[8:11], s46 offen offset:0
    buffer_load_dwordx4 a[68:71], v0, s[8:11], s46 offen offset:1024
    buffer_load_dwordx4 a[72:75], v0, s[8:11], s46 offen offset:2048
    buffer_load_dwordx4 a[76:79], v0, s[8:11], s46 offen offset:3072
    s_add_u32 s46, s51, 33558528
    buffer_load_dwordx4 a[80:83], v0, s[8:11], s46 offen offset:0
    buffer_load_dwordx4 a[84:87], v0, s[8:11], s46 offen offset:1024
    buffer_load_dwordx4 a[88:91], v0, s[8:11], s46 offen offset:2048
    buffer_load_dwordx4 a[92:95], v0, s[8:11], s46 offen offset:3072
    s_waitcnt vmcnt(0)
Lta1_have:
    buffer_load_dword v2, v11, s[8:11], s42 offen sc1
    s_waitcnt vmcnt(5)
    v_cmp_eq_u32 vcc, 0, v15
    s_add_u32 s51, s51, 262144
    s_add_u32 s37, s37, 1
    s_mov_b32 s62, s38
    s_and_b32 s17, vcc_lo, 0xfff
    s_cselect_b32 s39, 0, 1
    s_cmp_eq_u64 vcc, 0
    s_cselect_b32 s38, 1, 0
    s_cmp_lt_u32 s37, 64
    s_cselect_b32 s39, s39, 0
    s_cselect_b32 s38, s38, 0
    s_cmp_eq_u32 s39, 1
    s_cselect_b32 s30, 268435456, 0
    s_cmp_eq_u32 s38, 1
    s_cselect_b32 s22, 268435456, 0
    v_mfma_f32_16x16x32_bf16 v[32:35], a[32:35], a[0:3], 0
    s_add_u32 s46, s51, 0
    buffer_load_dwordx4 v[140:143], v0, s[28:31], s46 offen offset:0
    v_mfma_f32_16x16x32_bf16 v[36:39], a[32:35], a[4:7], 0
    buffer_load_dwordx4 v[144:147], v0, s[28:31], s46 offen offset:1024
    v_mfma_f32_16x16x32_bf16 v[40:43], a[36:39], a[4:7], 0
    buffer_load_dwordx4 v[148:151], v0, s[28:31], s46 offen offset:2048
    v_mfma_f32_16x16x32_bf16 v[32:35], a[40:43], a[8:11], v[32:35]
    buffer_load_dwordx4 v[152:155], v0, s[28:31], s46 offen offset:3072
    v_mfma_f32_16x16x32_bf16 v[36:39], a[40:43], a[12:15], v[36:39]
    s_add_u32 s46, s51, 4096
    buffer_load_dwordx4 v[156:159], v0, s[28:31], s46 offen offset:0
    v_mfma_f32_16x16x32_bf16 v[40:43], a[44:47], a[12:15], v[40:43]
    buffer_load_dwordx4 v[160:163], v0, s[28:31], s46 offen offset:1024
    v_mfma_f32_16x16x32_bf16 v[32:35], a[48:51], a[16:19], v[32:35]
    v_mfma_f32_16x16x32_bf16 v[36:39], a[48:51], a[20:23], v[36:39]
    v_mfma_f32_16x16x32_bf16 v[40:43], a[52:55], a[20:23], v[40:43]
    v_mfma_f32_16x16x32_bf16 v[32:35], a[56:59], a[24:27], v[32:35]
    v_mfma_f32_16x16x32_bf16 v[36:39], a[56:59], a[28:31], v[36:39]
    v_mfma_f32_16x16x32_bf16 v[40:43], a[60:63], a[28:31], v[40:43]
    s_waitcnt vmcnt(7)
    s_cmp_lg_u32 s49, 0
    s_cselect_b64 exec, 1, 0
    buffer_store_dword v3, v4, s[8:11], s43 offen sc1
    s_mov_b64 exec, -1
    s_add_u32 s43, s43, s49
    s_mov_b32 s49, 0
    s_cmp_eq_u32 s62, 1
    s_cbranch_scc1 Lta1_km
    s_waitcnt vmcnt(6)
    v_cmp_eq_u32 vcc, 0, v2
    s_nop 0
    s_cbranch_vccz Lta1_r
    s_mov_b32 s16, 0
Lta1_rp:
    buffer_load_dword v2, v11, s[8:11], s42 offen sc1
    s_add_u32 s16, s16, 1
    s_cmp_gt_u32 s16, 100000
    s_cbranch_scc1 L_role_ta_abort
    s_waitcnt vmcnt(0)
    v_cmp_eq_u32 vcc, 0, v2
    s_nop 0
    s_cbranch_vccnz Lta1_rp
Lta1_r:
    buffer_load_dwordx4 a[120:123], v9, s[8:11], s47 offen offset:0
    buffer_load_dwordx4 a[124:127], v9, s[8:11], s47 offen offset:64
    buffer_load_dwordx4 a[128:131], v9, s[8:11], s47 offen offset:128
    buffer_load_dwordx4 a[132:135], v9, s[8:11], s47 offen offset:192
    buffer_load_dwordx2 a[136:137], v10, s[8:11], s47 offen offset:2048
    buffer_load_dwordx2 a[138:139], v10, s[8:11], s47 offen offset:2560
    buffer_load_dwordx2 a[140:141], v10, s[8:11], s47 offen offset:3072
    buffer_load_dwordx2 a[142:143], v10, s[8:11], s47 offen offset:3584
Lta1_km:
    s_add_u32 s42, s42, 22528
    s_add_u32 s47, s47, 131072
    v_fma_f32 v32, v32, s52, v236
    v_fma_f32 v33, v33, s52, v237
    v_fma_f32 v34, v34, s52, v238
    v_fma_f32 v35, v35, s52, v239
    buffer_load_dwordx4 v[164:167], v0, s[28:31], s46 offen offset:2048
    buffer_load_dwordx4 v[168:171], v0, s[28:31], s46 offen offset:3072
    v_mul_f32 v36, s52, v36
    v_mul_f32 v37, s52, v37
    v_mul_f32 v38, s52, v38
    v_mul_f32 v39, s52, v39
    s_add_u32 s46, s51, 16777216
    buffer_load_dwordx4 v[172:175], v0, s[28:31], s46 offen offset:0
    buffer_load_dwordx4 v[176:179], v0, s[28:31], s46 offen offset:1024
    v_fma_f32 v40, v40, s52, v236
    v_fma_f32 v41, v41, s52, v237
    v_fma_f32 v42, v42, s52, v238
    v_fma_f32 v43, v43, s52, v239
    buffer_load_dwordx4 v[180:183], v0, s[28:31], s46 offen offset:2048
    buffer_load_dwordx4 v[184:187], v0, s[28:31], s46 offen offset:3072
    s_waitcnt vmcnt(13)
    v_mfma_f32_16x16x32_bf16 v[44:47], a[120:123], a[0:3], 0
    v_mfma_f32_16x16x32_bf16 v[48:51], a[120:123], a[4:7], 0
    s_add_u32 s46, s51, 16781312
    buffer_load_dwordx4 v[188:191], v0, s[28:31], s46 offen offset:0
    s_waitcnt vmcnt(13)
    v_mfma_f32_16x16x32_bf16 v[44:47], a[124:127], a[8:11], v[44:47]
    v_mfma_f32_16x16x32_bf16 v[48:51], a[124:127], a[12:15], v[48:51]
    buffer_load_dwordx4 v[192:195], v0, s[28:31], s46 offen offset:1024
    s_waitcnt vmcnt(13)
    v_mfma_f32_16x16x32_bf16 v[44:47], a[128:131], a[16:19], v[44:47]
    v_mfma_f32_16x16x32_bf16 v[48:51], a[128:131], a[20:23], v[48:51]
    buffer_load_dwordx4 v[196:199], v0, s[28:31], s46 offen offset:2048
    s_waitcnt vmcnt(13)
    v_mfma_f32_16x16x32_bf16 v[44:47], a[132:135], a[24:27], v[44:47]
    v_mfma_f32_16x16x32_bf16 v[48:51], a[132:135], a[28:31], v[48:51]
    buffer_load_dwordx4 v[200:203], v0, s[28:31], s46 offen offset:3072
    v_max3_f32 v5, v32, v33, v34
    v_max_f32 v5, v5, v35
    s_nop 0
    v_mul_f32 v44, s52, v44
    v_mul_f32 v45, s52, v45
    v_max3_f32 v5, v5, v44, v45
    v_mov_b32 v6, v5
    s_add_u32 s46, s51, 33554432
    buffer_load_dwordx4 v[204:207], v0, s[28:31], s46 offen offset:0
    v_permlane32_swap_b32 v5, v6
    v_max_f32 v5, v5, v6
    v_mov_b32 v6, v5
    buffer_load_dwordx4 v[208:211], v0, s[28:31], s46 offen offset:1024
    s_nop 0
    v_permlane16_swap_b32 v5, v6
    v_max_f32 v5, v5, v6
    v_sub_f32 v32, v32, v5
    v_sub_f32 v33, v33, v5
    v_sub_f32 v34, v34, v5
    v_sub_f32 v35, v35, v5
    v_sub_f32 v44, v44, v5
    v_sub_f32 v45, v45, v5
    v_exp_f32 v32, v32
    v_exp_f32 v33, v33
    v_exp_f32 v34, v34
    v_exp_f32 v35, v35
    v_exp_f32 v44, v44
    v_exp_f32 v45, v45
    v_cvt_pk_bf16_f32 v24, v32, v33
    v_cvt_pk_bf16_f32 v25, v34, v35
    v_mov_b32 v26, 0
    v_mov_b32 v27, 0
    v_cvt_pk_bf16_f32 v20, v44, v45
    v_cvt_pk_bf16_f32 v23, v44, v45
    v_mfma_f32_16x16x32_bf16 v[28:31], v[16:19], v[24:27], 0
    v_mfma_f32_16x16x32_bf16 v[76:79], a[64:67], v[24:27], 0
    v_mfma_f32_16x16x32_bf16 v[80:83], a[68:71], v[24:27], 0
    s_add_u32 s17, s42, 22528
    buffer_load_dword v15, v1, s[8:11], s17 offen sc1
    v_mfma_f32_16x16x32_bf16 v[84:87], a[72:75], v[24:27], 0
    v_mfma_f32_16x16x32_bf16 v[88:91], a[76:79], v[24:27], 0
    buffer_load_dwordx4 v[212:215], v0, s[28:31], s46 offen offset:2048
    v_mfma_f32_16x16x32_bf16 v[92:95], a[80:83], v[24:27], 0
    v_mfma_f32_16x16x32_bf16 v[96:99], a[84:87], v[24:27], 0
    buffer_load_dwordx4 v[216:219], v0, s[28:31], s46 offen offset:3072
    v_mfma_f32_16x16x16_bf16 v[28:31], v[16:17], v[20:21], v[28:31]
    v_mfma_f32_16x16x32_bf16 v[100:103], a[88:91], v[24:27], 0
    v_mfma_f32_16x16x32_bf16 v[104:107], a[92:95], v[24:27], 0
    s_add_u32 s46, s51, 33558528
    buffer_load_dwordx4 v[220:223], v0, s[28:31], s46 offen offset:0
    s_waitcnt vmcnt(19)
    v_mfma_f32_16x16x16_bf16 v[76:79], a[136:137], v[20:21], v[76:79]
    v_mfma_f32_16x16x16_bf16 v[80:83], a[136:137], v[22:23], v[80:83]
    v_rcp_f32 v6, v28
    s_waitcnt vmcnt(18)
    v_mfma_f32_16x16x16_bf16 v[84:87], a[138:139], v[20:21], v[84:87]
    v_mfma_f32_16x16x16_bf16 v[88:91], a[138:139], v[22:23], v[88:91]
    v_mul_f32 v76, v6, v76
    v_mul_f32 v80, v6, v80
    v_cvt_pk_bf16_f32 v108, v76, v80
    v_mul_f32 v77, v6, v77
    v_mul_f32 v81, v6, v81
    v_cvt_pk_bf16_f32 v109, v77, v81
    v_mul_f32 v78, v6, v78
    v_mul_f32 v82, v6, v82
    v_cvt_pk_bf16_f32 v110, v78, v82
    v_mul_f32 v79, v6, v79
    v_mul_f32 v83, v6, v83
    v_cvt_pk_bf16_f32 v111, v79, v83
    s_add_u32 s17, s48, 0
    buffer_store_dwordx4 v[108:111], v0, s[8:11], s17 offen offset:0 sc1
    buffer_load_dwordx4 v[224:227], v0, s[28:31], s46 offen offset:1024
    s_waitcnt vmcnt(19)
    v_mfma_f32_16x16x16_bf16 v[92:95], a[140:141], v[20:21], v[92:95]
    v_mfma_f32_16x16x16_bf16 v[96:99], a[140:141], v[22:23], v[96:99]
    v_mul_f32 v84, v6, v84
    v_mul_f32 v88, v6, v88
    v_cvt_pk_bf16_f32 v112, v84, v88
    v_mul_f32 v85, v6, v85
    v_mul_f32 v89, v6, v89
    v_cvt_pk_bf16_f32 v113, v85, v89
    v_mul_f32 v86, v6, v86
    v_mul_f32 v90, v6, v90
    v_cvt_pk_bf16_f32 v114, v86, v90
    v_mul_f32 v87, v6, v87
    v_mul_f32 v91, v6, v91
    v_cvt_pk_bf16_f32 v115, v87, v91
    buffer_store_dwordx4 v[112:115], v0, s[8:11], s17 offen offset:2048 sc1
    buffer_load_dwordx4 v[228:231], v0, s[28:31], s46 offen offset:2048
    s_waitcnt vmcnt(20)
    v_mfma_f32_16x16x16_bf16 v[100:103], a[142:143], v[20:21], v[100:103]
    v_mfma_f32_16x16x16_bf16 v[104:107], a[142:143], v[22:23], v[104:107]
    v_mul_f32 v92, v6, v92
    v_mul_f32 v96, v6, v96
    v_cvt_pk_bf16_f32 v116, v92, v96
    v_mul_f32 v93, v6, v93
    v_mul_f32 v97, v6, v97
    v_cvt_pk_bf16_f32 v117, v93, v97
    v_mul_f32 v94, v6, v94
    v_mul_f32 v98, v6, v98
    v_cvt_pk_bf16_f32 v118, v94, v98
    v_mul_f32 v95, v6, v95
    v_mul_f32 v99, v6, v99
    v_cvt_pk_bf16_f32 v119, v95, v99
    s_add_u32 s17, s48, 4096
    buffer_store_dwordx4 v[116:119], v0, s[8:11], s17 offen offset:0 sc1
    buffer_load_dwordx4 v[232:235], v0, s[28:31], s46 offen offset:3072
    v_mul_f32 v100, v6, v100
    v_mul_f32 v104, v6, v104
    v_cvt_pk_bf16_f32 v120, v100, v104
    v_mul_f32 v101, v6, v101
    v_mul_f32 v105, v6, v105
    v_cvt_pk_bf16_f32 v121, v101, v105
    v_mul_f32 v102, v6, v102
    v_mul_f32 v106, v6, v106
    v_cvt_pk_bf16_f32 v122, v102, v106
    v_mul_f32 v103, v6, v103
    v_mul_f32 v107, v6, v107
    v_cvt_pk_bf16_f32 v123, v103, v107
    buffer_store_dwordx4 v[120:123], v0, s[8:11], s17 offen offset:2048 sc1
    buffer_load_dwordx4 a[96:99], v9, s[20:23], s47 offen offset:0
    v_max3_f32 v5, v36, v37, v38
    v_max_f32 v5, v5, v39
    v_max3_f32 v5, v5, v40, v41
    v_max3_f32 v5, v5, v42, v43
    v_mul_f32 v48, s52, v48
    v_mul_f32 v49, s52, v49
    v_max3_f32 v5, v5, v48, v49
    v_mov_b32 v6, v5
    buffer_load_dwordx4 a[100:103], v9, s[20:23], s47 offen offset:64
    s_nop 0
    v_permlane32_swap_b32 v5, v6
    v_max_f32 v5, v5, v6
    v_mov_b32 v6, v5
    buffer_load_dwordx4 a[104:107], v9, s[20:23], s47 offen offset:128
    s_nop 0
    v_permlane16_swap_b32 v5, v6
    v_max_f32 v5, v5, v6
    v_sub_f32 v36, v36, v5
    v_sub_f32 v37, v37, v5
    v_sub_f32 v38, v38, v5
    v_sub_f32 v39, v39, v5
    v_sub_f32 v40, v40, v5
    v_sub_f32 v41, v41, v5
    v_sub_f32 v42, v42, v5
    v_sub_f32 v43, v43, v5
    v_sub_f32 v48, v48, v5
    v_sub_f32 v49, v49, v5
    v_exp_f32 v36, v36
    v_exp_f32 v37, v37
    v_exp_f32 v38, v38
    v_exp_f32 v39, v39
    v_exp_f32 v40, v40
    v_exp_f32 v41, v41
    v_exp_f32 v42, v42
    v_exp_f32 v43, v43
    v_exp_f32 v48, v48
    v_exp_f32 v49, v49
    v_cvt_pk_bf16_f32 v24, v36, v37
    v_cvt_pk_bf16_f32 v25, v38, v39
    v_cvt_pk_bf16_f32 v26, v40, v41
    v_cvt_pk_bf16_f32 v27, v42, v43
    v_cvt_pk_bf16_f32 v20, v48, v49
    v_cvt_pk_bf16_f32 v23, v48, v49
    v_mfma_f32_16x16x32_bf16 v[28:31], v[16:19], v[24:27], 0
    v_mfma_f32_16x16x32_bf16 v[76:79], a[64:67], v[24:27], 0
    v_mfma_f32_16x16x32_bf16 v[80:83], a[68:71], v[24:27], 0
    buffer_load_dwordx4 a[108:111], v9, s[20:23], s47 offen offset:192
    v_mfma_f32_16x16x32_bf16 v[84:87], a[72:75], v[24:27], 0
    v_mfma_f32_16x16x32_bf16 v[88:91], a[76:79], v[24:27], 0
    buffer_load_dwordx2 a[112:113], v10, s[20:23], s47 offen offset:2048
    v_mfma_f32_16x16x32_bf16 v[92:95], a[80:83], v[24:27], 0
    v_mfma_f32_16x16x32_bf16 v[96:99], a[84:87], v[24:27], 0
    buffer_load_dwordx2 a[114:115], v10, s[20:23], s47 offen offset:2560
    v_mfma_f32_16x16x16_bf16 v[28:31], v[16:17], v[20:21], v[28:31]
    v_mfma_f32_16x16x32_bf16 v[100:103], a[88:91], v[24:27], 0
    v_mfma_f32_16x16x32_bf16 v[104:107], a[92:95], v[24:27], 0
    buffer_load_dwordx2 a[116:117], v10, s[20:23], s47 offen offset:3072
    buffer_load_dwordx2 a[118:119], v10, s[20:23], s47 offen offset:3584
    v_mfma_f32_16x16x16_bf16 v[76:79], a[136:137], v[20:21], v[76:79]
    v_mfma_f32_16x16x16_bf16 v[80:83], a[136:137], v[22:23], v[80:83]
    v_rcp_f32 v6, v28
    v_mfma_f32_16x16x16_bf16 v[84:87], a[138:139], v[20:21], v[84:87]
    v_mfma_f32_16x16x16_bf16 v[88:91], a[138:139], v[22:23], v[88:91]
    v_mul_f32 v76, v6, v76
    v_mul_f32 v80, v6, v80
    v_cvt_pk_bf16_f32 v124, v76, v80
    v_mul_f32 v77, v6, v77
    v_mul_f32 v81, v6, v81
    v_cvt_pk_bf16_f32 v125, v77, v81
    v_mul_f32 v78, v6, v78
    v_mul_f32 v82, v6, v82
    v_cvt_pk_bf16_f32 v126, v78, v82
    v_mul_f32 v79, v6, v79
    v_mul_f32 v83, v6, v83
    v_cvt_pk_bf16_f32 v127, v79, v83
    s_add_u32 s17, s48, 0
    buffer_store_dwordx4 v[124:127], v0, s[8:11], s17 offen offset:1024 sc1
    v_mfma_f32_16x16x16_bf16 v[92:95], a[140:141], v[20:21], v[92:95]
    v_mfma_f32_16x16x16_bf16 v[96:99], a[140:141], v[22:23], v[96:99]
    v_mul_f32 v84, v6, v84
    v_mul_f32 v88, v6, v88
    v_cvt_pk_bf16_f32 v128, v84, v88
    v_mul_f32 v85, v6, v85
    v_mul_f32 v89, v6, v89
    v_cvt_pk_bf16_f32 v129, v85, v89
    v_mul_f32 v86, v6, v86
    v_mul_f32 v90, v6, v90
    v_cvt_pk_bf16_f32 v130, v86, v90
    v_mul_f32 v87, v6, v87
    v_mul_f32 v91, v6, v91
    v_cvt_pk_bf16_f32 v131, v87, v91
    buffer_store_dwordx4 v[128:131], v0, s[8:11], s17 offen offset:3072 sc1
    v_mfma_f32_16x16x16_bf16 v[100:103], a[142:143], v[20:21], v[100:103]
    v_mfma_f32_16x16x16_bf16 v[104:107], a[142:143], v[22:23], v[104:107]
    v_mul_f32 v92, v6, v92
    v_mul_f32 v96, v6, v96
    v_cvt_pk_bf16_f32 v132, v92, v96
    v_mul_f32 v93, v6, v93
    v_mul_f32 v97, v6, v97
    v_cvt_pk_bf16_f32 v133, v93, v97
    v_mul_f32 v94, v6, v94
    v_mul_f32 v98, v6, v98
    v_cvt_pk_bf16_f32 v134, v94, v98
    v_mul_f32 v95, v6, v95
    v_mul_f32 v99, v6, v99
    v_cvt_pk_bf16_f32 v135, v95, v99
    s_add_u32 s17, s48, 4096
    buffer_store_dwordx4 v[132:135], v0, s[8:11], s17 offen offset:1024 sc1
    v_mul_f32 v100, v6, v100
    v_mul_f32 v104, v6, v104
    v_cvt_pk_bf16_f32 v136, v100, v104
    v_mul_f32 v101, v6, v101
    v_mul_f32 v105, v6, v105
    v_cvt_pk_bf16_f32 v137, v101, v105
    v_mul_f32 v102, v6, v102
    v_mul_f32 v106, v6, v106
    v_cvt_pk_bf16_f32 v138, v102, v106
    v_mul_f32 v103, v6, v103
    v_mul_f32 v107, v6, v107
    v_cvt_pk_bf16_f32 v139, v103, v107
    buffer_store_dwordx4 v[136:139], v0, s[8:11], s17 offen offset:3072 sc1
    s_add_u32 s48, s48, 262144
    s_mov_b32 s49, 22528
    s_cmp_ge_u32 s37, 64
    s_cbranch_scc1 Lta_end
    s_branch Lta0
Lta_end:
    s_waitcnt vmcnt(0)
    s_mov_b64 exec, 1
    buffer_store_dword v3, v4, s[8:11], s43 offen sc1
    s_mov_b64 exec, -1
    s_branch L_role_ta_exit
L_role_ta_abort:
    s_waitcnt lgkmcnt(0)
    s_mov_b64 exec, -1
    v_mov_b32 v0, 60
    s_lshl_b32 s5, s3, 8
    s_or_b32 s5, s5, s4
    s_or_b32 s5, s5, 0x10000
    v_mov_b32 v1, s5
    global_store_dword v0, v1, s[12:13]
    s_endpgm
L_role_ta_exit:
    s_endpgm
.p2align 6
L_role_tw:
    v_and_b32 v5, 63, v0
    v_lshlrev_b32 v0, 4, v5
    v_and_b32 v7, 15, v5
    v_lshrrev_b32 v8, 4, v5
    v_min_u32 v1, 31, v5
    v_lshrrev_b32 v6, 2, v1
    v_and_b32 v1, 3, v1
    v_lshlrev_b32 v1, 2, v1
    v_lshl_add_u32 v1, v6, 7, v1
    v_mov_b32 v3, 1
    v_mov_b32 v4, 0
    s_mov_b32 s44, 0x05040100
    s_mov_b32 s45, 0x07060302
    s_cmp_lg_u32 s14, 0
    s_cbranch_scc1 Ltw_gate_d
    v_mov_b32 v5, 48
    s_mov_b32 s16, 0
Ltw_gate:
    global_load_dword v6, v5, s[12:13] sc1
    s_add_u32 s16, s16, 1
    s_cmp_gt_u32 s16, 100000
    s_cbranch_scc1 L_role_tw_abort
    s_waitcnt vmcnt(0)
    v_cmp_gt_u32 vcc, 32, v6
    s_nop 0
    s_cbranch_vccz Ltw_gate_d
    s_sleep 100
    s_branch Ltw_gate
Ltw_gate_d:
    s_barrier
    s_load_dwordx2 s[20:21], s[0:1], 64
    s_mov_b32 s22, 4718592
    s_mov_b32 s23, 0x00020000
    s_waitcnt lgkmcnt(0)
    s_and_b32 s21, s21, 0xffff
    s_load_dwordx2 s[24:25], s[0:1], 80
    s_mov_b32 s26, 2359296
    s_mov_b32 s27, 0x00020000
    s_waitcnt lgkmcnt(0)
    s_and_b32 s25, s25, 0xffff
    s_mul_i32 s17, s15, 43
    s_lshr_b32 s32, s17, 9
    s_mul_i32 s17, s32, 12
    s_sub_u32 s50, s15, s17
    s_add_u32 s33, s32, 30
    s_cmp_eq_u32 s32, 2
    s_cselect_b32 s33, 0, s33
    s_cselect_b32 s32, 64, s32
    s_mul_i32 s49, s50, 96
    s_mul_i32 s17, s14, 1179648
    s_add_u32 s49, s49, s17
    v_mul_u32_u24 v5, 4608, v8
    v_lshl_add_u32 v9, v7, 2, v5
    v_add_u32 v10, 18432, v9
    v_and_b32 v6, 14, v7
    v_lshl_add_u32 v12, v6, 1, v5
    v_add_u32 v12, 64, v12
    v_add_u32 v13, 18432, v12
    v_and_b32 v5, 1, v7
    v_mov_b32 v11, s44
    v_mov_b32 v6, s45
    v_cmp_eq_u32 vcc, 1, v5
    s_nop 1
    v_cndmask_b32 v11, v11, v6, vcc
    s_add_u32 s17, s49, 0
    buffer_load_dword v16, v9, s[20:23], s17 offen
    buffer_load_dword v17, v10, s[20:23], s17 offen
    buffer_load_dword v18, v12, s[20:23], s17 offen
    buffer_load_dword v19, v13, s[20:23], s17 offen
    s_add_u32 s17, s49, 1152
    buffer_load_dword v20, v9, s[20:23], s17 offen
    buffer_load_dword v21, v10, s[20:23], s17 offen
    buffer_load_dword v22, v12, s[20:23], s17 offen
    buffer_load_dword v23, v13, s[20:23], s17 offen
    s_add_u32 s17, s49, 2304
    buffer_load_dword v24, v9, s[20:23], s17 offen
    buffer_load_dword v25, v10, s[20:23], s17 offen
    buffer_load_dword v26, v12, s[20:23], s17 offen
    buffer_load_dword v27, v13, s[20:23], s17 offen
    s_add_u32 s17, s49, 3456
    buffer_load_dword v28, v9, s[20:23], s17 offen
    buffer_load_dword v29, v10, s[20:23], s17 offen
    buffer_load_dword v30, v12, s[20:23], s17 offen
    buffer_load_dword v31, v13, s[20:23], s17 offen
    s_add_u32 s17, s49, 36864
    buffer_load_dword v32, v9, s[20:23], s17 offen
    buffer_load_dword v33, v10, s[20:23], s17 offen
    buffer_load_dword v34, v12, s[20:23], s17 offen
    buffer_load_dword v35, v13, s[20:23], s17 offen
    s_add_u32 s17, s49, 38016
    buffer_load_dword v36, v9, s[20:23], s17 offen
    buffer_load_dword v37, v10, s[20:23], s17 offen
    buffer_load_dword v38, v12, s[20:23], s17 offen
    buffer_load_dword v39, v13, s[20:23], s17 offen
    s_add_u32 s17, s49, 39168
    buffer_load_dword v40, v9, s[20:23], s17 offen
    buffer_load_dword v41, v10, s[20:23], s17 offen
    buffer_load_dword v42, v12, s[20:23], s17 offen
    buffer_load_dword v43, v13, s[20:23], s17 offen
    s_add_u32 s17, s49, 40320
    buffer_load_dword v44, v9, s[20:23], s17 offen
    buffer_load_dword v45, v10, s[20:23], s17 offen
    buffer_load_dword v46, v12, s[20:23], s17 offen
    buffer_load_dword v47, v13, s[20:23], s17 offen
    s_add_u32 s17, s49, 73728
    buffer_load_dword v48, v9, s[20:23], s17 offen
    buffer_load_dword v49, v10, s[20:23], s17 offen
    buffer_load_dword v50, v12, s[20:23], s17 offen
    buffer_load_dword v51, v13, s[20:23], s17 offen
    s_add_u32 s17, s49, 74880
    buffer_load_dword v52, v9, s[20:23], s17 offen
    buffer_load_dword v53, v10, s[20:23], s17 offen
    buffer_load_dword v54, v12, s[20:23], s17 offen
    buffer_load_dword v55, v13, s[20:23], s17 offen
    s_add_u32 s17, s49, 76032
    buffer_load_dword v56, v9, s[20:23], s17 offen
    buffer_load_dword v57, v10, s[20:23], s17 offen
    buffer_load_dword v58, v12, s[20:23], s17 offen
    buffer_load_dword v59, v13, s[20:23], s17 offen
    s_add_u32 s17, s49, 77184
    buffer_load_dword v60, v9, s[20:23], s17 offen
    buffer_load_dword v61, v10, s[20:23], s17 offen
    buffer_load_dword v62, v12, s[20:23], s17 offen
    buffer_load_dword v63, v13, s[20:23], s17 offen
    s_add_u32 s17, s49, 110592
    buffer_load_dword v64, v9, s[20:23], s17 offen
    buffer_load_dword v65, v10, s[20:23], s17 offen
    buffer_load_dword v66, v12, s[20:23], s17 offen
    buffer_load_dword v67, v13, s[20:23], s17 offen
    s_add_u32 s17, s49, 111744
    buffer_load_dword v68, v9, s[20:23], s17 offen
    buffer_load_dword v69, v10, s[20:23], s17 offen
    buffer_load_dword v70, v12, s[20:23], s17 offen
    buffer_load_dword v71, v13, s[20:23], s17 offen
    s_add_u32 s17, s49, 112896
    buffer_load_dword v72, v9, s[20:23], s17 offen
    buffer_load_dword v73, v10, s[20:23], s17 offen
    buffer_load_dword v74, v12, s[20:23], s17 offen
    buffer_load_dword v75, v13, s[20:23], s17 offen
    s_waitcnt vmcnt(58)
    v_perm_b32 v5, v17, v16, s44
    v_perm_b32 v6, v17, v16, s45
    s_waitcnt vmcnt(56)
    v_perm_b32 v128, v19, v18, v11
    v_accvgpr_write_b32 a0, v5
    v_accvgpr_write_b32 a4, v6
    s_add_u32 s17, s49, 114048
    buffer_load_dword v76, v9, s[20:23], s17 offen
    buffer_load_dword v77, v10, s[20:23], s17 offen
    buffer_load_dword v78, v12, s[20:23], s17 offen
    buffer_load_dword v79, v13, s[20:23], s17 offen
    s_waitcnt vmcnt(58)
    v_perm_b32 v5, v21, v20, s44
    v_perm_b32 v6, v21, v20, s45
    s_waitcnt vmcnt(56)
    v_perm_b32 v129, v23, v22, v11
    v_accvgpr_write_b32 a1, v5
    v_accvgpr_write_b32 a5, v6
    s_add_u32 s17, s49, 147456
    buffer_load_dword v80, v9, s[20:23], s17 offen
    buffer_load_dword v81, v10, s[20:23], s17 offen
    buffer_load_dword v82, v12, s[20:23], s17 offen
    buffer_load_dword v83, v13, s[20:23], s17 offen
    s_waitcnt vmcnt(58)
    v_perm_b32 v5, v25, v24, s44
    v_perm_b32 v6, v25, v24, s45
    s_waitcnt vmcnt(56)
    v_perm_b32 v130, v27, v26, v11
    v_accvgpr_write_b32 a2, v5
    v_accvgpr_write_b32 a6, v6
    s_add_u32 s17, s49, 148608
    buffer_load_dword v84, v9, s[20:23], s17 offen
    buffer_load_dword v85, v10, s[20:23], s17 offen
    buffer_load_dword v86, v12, s[20:23], s17 offen
    buffer_load_dword v87, v13, s[20:23], s17 offen
    s_waitcnt vmcnt(58)
    v_perm_b32 v5, v29, v28, s44
    v_perm_b32 v6, v29, v28, s45
    s_waitcnt vmcnt(56)
    v_perm_b32 v131, v31, v30, v11
    v_accvgpr_write_b32 a3, v5
    v_accvgpr_write_b32 a7, v6
    s_add_u32 s17, s49, 149760
    buffer_load_dword v88, v9, s[20:23], s17 offen
    buffer_load_dword v89, v10, s[20:23], s17 offen
    buffer_load_dword v90, v12, s[20:23], s17 offen
    buffer_load_dword v91, v13, s[20:23], s17 offen
    s_waitcnt vmcnt(58)
    v_perm_b32 v5, v33, v32, s44
    v_perm_b32 v6, v33, v32, s45
    s_waitcnt vmcnt(56)
    v_perm_b32 v132, v35, v34, v11
    v_accvgpr_write_b32 a8, v5
    v_accvgpr_write_b32 a12, v6
    s_add_u32 s17, s49, 150912
    buffer_load_dword v92, v9, s[20:23], s17 offen
    buffer_load_dword v93, v10, s[20:23], s17 offen
    buffer_load_dword v94, v12, s[20:23], s17 offen
    buffer_load_dword v95, v13, s[20:23], s17 offen
    s_waitcnt vmcnt(58)
    v_perm_b32 v5, v37, v36, s44
    v_perm_b32 v6, v37, v36, s45
    s_waitcnt vmcnt(56)
    v_perm_b32 v133, v39, v38, v11
    v_accvgpr_write_b32 a9, v5
    v_accvgpr_write_b32 a13, v6
    s_add_u32 s17, s49, 184320
    buffer_load_dword v96, v9, s[20:23], s17 offen
    buffer_load_dword v97, v10, s[20:23], s17 offen
    buffer_load_dword v98, v12, s[20:23], s17 offen
    buffer_load_dword v99, v13, s[20:23], s17 offen
    s_waitcnt vmcnt(58)
    v_perm_b32 v5, v41, v40, s44
    v_perm_b32 v6, v41, v40, s45
    s_waitcnt vmcnt(56)
    v_perm_b32 v134, v43, v42, v11
    v_accvgpr_write_b32 a10, v5
    v_accvgpr_write_b32 a14, v6
    s_add_u32 s17, s49, 185472
    buffer_load_dword v100, v9, s[20:23], s17 offen
    buffer_load_dword v101, v10, s[20:23], s17 offen
    buffer_load_dword v102, v12, s[20:23], s17 offen
    buffer_load_dword v103, v13, s[20:23], s17 offen
    s_waitcnt vmcnt(58)
    v_perm_b32 v5, v45, v44, s44
    v_perm_b32 v6, v45, v44, s45
    s_waitcnt vmcnt(56)
    v_perm_b32 v135, v47, v46, v11
    v_accvgpr_write_b32 a11, v5
    v_accvgpr_write_b32 a15, v6
    s_add_u32 s17, s49, 186624
    buffer_load_dword v104, v9, s[20:23], s17 offen
    buffer_load_dword v105, v10, s[20:23], s17 offen
    buffer_load_dword v106, v12, s[20:23], s17 offen
    buffer_load_dword v107, v13, s[20:23], s17 offen
    s_waitcnt vmcnt(58)
    v_perm_b32 v5, v49, v48, s44
    v_perm_b32 v6, v49, v48, s45
    s_waitcnt vmcnt(56)
    v_perm_b32 v136, v51, v50, v11
    v_accvgpr_write_b32 a16, v5
    v_accvgpr_write_b32 a20, v6
    s_add_u32 s17, s49, 187776
    buffer_load_dword v108, v9, s[20:23], s17 offen
    buffer_load_dword v109, v10, s[20:23], s17 offen
    buffer_load_dword v110, v12, s[20:23], s17 offen
    buffer_load_dword v111, v13, s[20:23], s17 offen
    s_waitcnt vmcnt(58)
    v_perm_b32 v5, v53, v52, s44
    v_perm_b32 v6, v53, v52, s45
    s_waitcnt vmcnt(56)
    v_perm_b32 v137, v55, v54, v11
    v_accvgpr_write_b32 a17, v5
    v_accvgpr_write_b32 a21, v6
    s_add_u32 s17, s49, 221184
    buffer_load_dword v112, v9, s[20:23], s17 offen
    buffer_load_dword v113, v10, s[20:23], s17 offen
    buffer_load_dword v114, v12, s[20:23], s17 offen
    buffer_load_dword v115, v13, s[20:23], s17 offen
    s_waitcnt vmcnt(58)
    v_perm_b32 v5, v57, v56, s44
    v_perm_b32 v6, v57, v56, s45
    s_waitcnt vmcnt(56)
    v_perm_b32 v138, v59, v58, v11
    v_accvgpr_write_b32 a18, v5
    v_accvgpr_write_b32 a22, v6
    s_add_u32 s17, s49, 222336
    buffer_load_dword v116, v9, s[20:23], s17 offen
    buffer_load_dword v117, v10, s[20:23], s17 offen
    buffer_load_dword v118, v12, s[20:23], s17 offen
    buffer_load_dword v119, v13, s[20:23], s17 offen
    s_waitcnt vmcnt(58)
    v_perm_b32 v5, v61, v60, s44
    v_perm_b32 v6, v61, v60, s45
    s_waitcnt vmcnt(56)
    v_perm_b32 v139, v63, v62, v11
    v_accvgpr_write_b32 a19, v5
    v_accvgpr_write_b32 a23, v6
    s_add_u32 s17, s49, 223488
    buffer_load_dword v120, v9, s[20:23], s17 offen
    buffer_load_dword v121, v10, s[20:23], s17 offen
    buffer_load_dword v122, v12, s[20:23], s17 offen
    buffer_load_dword v123, v13, s[20:23], s17 offen
    s_waitcnt vmcnt(58)
    v_perm_b32 v5, v65, v64, s44
    v_perm_b32 v6, v65, v64, s45
    s_waitcnt vmcnt(56)
    v_perm_b32 v140, v67, v66, v11
    v_accvgpr_write_b32 a24, v5
    v_accvgpr_write_b32 a28, v6
    s_add_u32 s17, s49, 224640
    buffer_load_dword v124, v9, s[20:23], s17 offen
    buffer_load_dword v125, v10, s[20:23], s17 offen
    buffer_load_dword v126, v12, s[20:23], s17 offen
    buffer_load_dword v127, v13, s[20:23], s17 offen
    s_waitcnt vmcnt(58)
    v_perm_b32 v5, v69, v68, s44
    v_perm_b32 v6, v69, v68, s45
    s_waitcnt vmcnt(56)
    v_perm_b32 v141, v71, v70, v11
    v_accvgpr_write_b32 a25, v5
    v_accvgpr_write_b32 a29, v6
    s_add_u32 s17, s49, 258048
    buffer_load_dword v16, v9, s[20:23], s17 offen
    buffer_load_dword v17, v10, s[20:23], s17 offen
    buffer_load_dword v18, v12, s[20:23], s17 offen
    buffer_load_dword v19, v13, s[20:23], s17 offen
    s_waitcnt vmcnt(58)
    v_perm_b32 v5, v73, v72, s44
    v_perm_b32 v6, v73, v72, s45
    s_waitcnt vmcnt(56)
    v_perm_b32 v142, v75, v74, v11
    v_accvgpr_write_b32 a26, v5
    v_accvgpr_write_b32 a30, v6
    s_add_u32 s17, s49, 259200
    buffer_load_dword v20, v9, s[20:23], s17 offen
    buffer_load_dword v21, v10, s[20:23], s17 offen
    buffer_load_dword v22, v12, s[20:23], s17 offen
    buffer_load_dword v23, v13, s[20:23], s17 offen
    s_waitcnt vmcnt(58)
    v_perm_b32 v5, v77, v76, s44
    v_perm_b32 v6, v77, v76, s45
    s_waitcnt vmcnt(56)
    v_perm_b32 v143, v79, v78, v11
    v_accvgpr_write_b32 a27, v5
    v_accvgpr_write_b32 a31, v6
    s_add_u32 s17, s49, 260352
    buffer_load_dword v24, v9, s[20:23], s17 offen
    buffer_load_dword v25, v10, s[20:23], s17 offen
    buffer_load_dword v26, v12, s[20:23], s17 offen
    buffer_load_dword v27, v13, s[20:23], s17 offen
    s_waitcnt vmcnt(58)
    v_perm_b32 v5, v81, v80, s44
    v_perm_b32 v6, v81, v80, s45
    s_waitcnt vmcnt(56)
    v_perm_b32 v144, v83, v82, v11
    v_accvgpr_write_b32 a32, v5
    v_accvgpr_write_b32 a36, v6
    s_add_u32 s17, s49, 261504
    buffer_load_dword v28, v9, s[20:23], s17 offen
    buffer_load_dword v29, v10, s[20:23], s17 offen
    buffer_load_dword v30, v12, s[20:23], s17 offen
    buffer_load_dword v31, v13, s[20:23], s17 offen
    s_waitcnt vmcnt(58)
    v_perm_b32 v5, v85, v84, s44
    v_perm_b32 v6, v85, v84, s45
    s_waitcnt vmcnt(56)
    v_perm_b32 v145, v87, v86, v11
    v_accvgpr_write_b32 a33, v5
    v_accvgpr_write_b32 a37, v6
    s_add_u32 s17, s49, 294912
    buffer_load_dword v32, v9, s[20:23], s17 offen
    buffer_load_dword v33, v10, s[20:23], s17 offen
    buffer_load_dword v34, v12, s[20:23], s17 offen
    buffer_load_dword v35, v13, s[20:23], s17 offen
    s_waitcnt vmcnt(58)
    v_perm_b32 v5, v89, v88, s44
    v_perm_b32 v6, v89, v88, s45
    s_waitcnt vmcnt(56)
    v_perm_b32 v146, v91, v90, v11
    v_accvgpr_write_b32 a34, v5
    v_accvgpr_write_b32 a38, v6
    s_add_u32 s17, s49, 296064
    buffer_load_dword v36, v9, s[20:23], s17 offen
    buffer_load_dword v37, v10, s[20:23], s17 offen
    buffer_load_dword v38, v12, s[20:23], s17 offen
    buffer_load_dword v39, v13, s[20:23], s17 offen
    s_waitcnt vmcnt(58)
    v_perm_b32 v5, v93, v92, s44
    v_perm_b32 v6, v93, v92, s45
    s_waitcnt vmcnt(56)
    v_perm_b32 v147, v95, v94, v11
    v_accvgpr_write_b32 a35, v5
    v_accvgpr_write_b32 a39, v6
    s_add_u32 s17, s49, 297216
    buffer_load_dword v40, v9, s[20:23], s17 offen
    buffer_load_dword v41, v10, s[20:23], s17 offen
    buffer_load_dword v42, v12, s[20:23], s17 offen
    buffer_load_dword v43, v13, s[20:23], s17 offen
    s_waitcnt vmcnt(58)
    v_perm_b32 v5, v97, v96, s44
    v_perm_b32 v6, v97, v96, s45
    s_waitcnt vmcnt(56)
    v_perm_b32 v148, v99, v98, v11
    v_accvgpr_write_b32 a40, v5
    v_accvgpr_write_b32 a44, v6
    s_add_u32 s17, s49, 298368
    buffer_load_dword v44, v9, s[20:23], s17 offen
    buffer_load_dword v45, v10, s[20:23], s17 offen
    buffer_load_dword v46, v12, s[20:23], s17 offen
    buffer_load_dword v47, v13, s[20:23], s17 offen
    s_waitcnt vmcnt(58)
    v_perm_b32 v5, v101, v100, s44
    v_perm_b32 v6, v101, v100, s45
    s_waitcnt vmcnt(56)
    v_perm_b32 v149, v103, v102, v11
    v_accvgpr_write_b32 a41, v5
    v_accvgpr_write_b32 a45, v6
    s_add_u32 s17, s49, 331776
    buffer_load_dword v48, v9, s[20:23], s17 offen
    buffer_load_dword v49, v10, s[20:23], s17 offen
    buffer_load_dword v50, v12, s[20:23], s17 offen
    buffer_load_dword v51, v13, s[20:23], s17 offen
    s_waitcnt vmcnt(58)
    v_perm_b32 v5, v105, v104, s44
    v_perm_b32 v6, v105, v104, s45
    s_waitcnt vmcnt(56)
    v_perm_b32 v150, v107, v106, v11
    v_accvgpr_write_b32 a42, v5
    v_accvgpr_write_b32 a46, v6
    s_add_u32 s17, s49, 332928
    buffer_load_dword v52, v9, s[20:23], s17 offen
    buffer_load_dword v53, v10, s[20:23], s17 offen
    buffer_load_dword v54, v12, s[20:23], s17 offen
    buffer_load_dword v55, v13, s[20:23], s17 offen
    s_waitcnt vmcnt(58)
    v_perm_b32 v5, v109, v108, s44
    v_perm_b32 v6, v109, v108, s45
    s_waitcnt vmcnt(56)
    v_perm_b32 v151, v111, v110, v11
    v_accvgpr_write_b32 a43, v5
    v_accvgpr_write_b32 a47, v6
    s_add_u32 s17, s49, 334080
    buffer_load_dword v56, v9, s[20:23], s17 offen
    buffer_load_dword v57, v10, s[20:23], s17 offen
    buffer_load_dword v58, v12, s[20:23], s17 offen
    buffer_load_dword v59, v13, s[20:23], s17 offen
    s_waitcnt vmcnt(58)
    v_perm_b32 v5, v113, v112, s44
    v_perm_b32 v6, v113, v112, s45
    s_waitcnt vmcnt(56)
    v_perm_b32 v152, v115, v114, v11
    v_accvgpr_write_b32 a48, v5
    v_accvgpr_write_b32 a52, v6
    s_add_u32 s17, s49, 335232
    buffer_load_dword v60, v9, s[20:23], s17 offen
    buffer_load_dword v61, v10, s[20:23], s17 offen
    buffer_load_dword v62, v12, s[20:23], s17 offen
    buffer_load_dword v63, v13, s[20:23], s17 offen
    s_waitcnt vmcnt(58)
    v_perm_b32 v5, v117, v116, s44
    v_perm_b32 v6, v117, v116, s45
    s_waitcnt vmcnt(56)
    v_perm_b32 v153, v119, v118, v11
    v_accvgpr_write_b32 a49, v5
    v_accvgpr_write_b32 a53, v6
    s_add_u32 s17, s49, 368640
    buffer_load_dword v64, v9, s[20:23], s17 offen
    buffer_load_dword v65, v10, s[20:23], s17 offen
    buffer_load_dword v66, v12, s[20:23], s17 offen
    buffer_load_dword v67, v13, s[20:23], s17 offen
    s_waitcnt vmcnt(58)
    v_perm_b32 v5, v121, v120, s44
    v_perm_b32 v6, v121, v120, s45
    s_waitcnt vmcnt(56)
    v_perm_b32 v154, v123, v122, v11
    v_accvgpr_write_b32 a50, v5
    v_accvgpr_write_b32 a54, v6
    s_add_u32 s17, s49, 369792
    buffer_load_dword v68, v9, s[20:23], s17 offen
    buffer_load_dword v69, v10, s[20:23], s17 offen
    buffer_load_dword v70, v12, s[20:23], s17 offen
    buffer_load_dword v71, v13, s[20:23], s17 offen
    s_waitcnt vmcnt(58)
    v_perm_b32 v5, v125, v124, s44
    v_perm_b32 v6, v125, v124, s45
    s_waitcnt vmcnt(56)
    v_perm_b32 v155, v127, v126, v11
    v_accvgpr_write_b32 a51, v5
    v_accvgpr_write_b32 a55, v6
    s_add_u32 s17, s49, 370944
    buffer_load_dword v72, v9, s[20:23], s17 offen
    buffer_load_dword v73, v10, s[20:23], s17 offen
    buffer_load_dword v74, v12, s[20:23], s17 offen
    buffer_load_dword v75, v13, s[20:23], s17 offen
    s_waitcnt vmcnt(58)
    v_perm_b32 v5, v17, v16, s44
    v_perm_b32 v6, v17, v16, s45
    s_waitcnt vmcnt(56)
    v_perm_b32 v156, v19, v18, v11
    v_accvgpr_write_b32 a56, v5
    v_accvgpr_write_b32 a60, v6
    s_add_u32 s17, s49, 372096
    buffer_load_dword v76, v9, s[20:23], s17 offen
    buffer_load_dword v77, v10, s[20:23], s17 offen
    buffer_load_dword v78, v12, s[20:23], s17 offen
    buffer_load_dword v79, v13, s[20:23], s17 offen
    s_waitcnt vmcnt(58)
    v_perm_b32 v5, v21, v20, s44
    v_perm_b32 v6, v21, v20, s45
    s_waitcnt vmcnt(56)
    v_perm_b32 v157, v23, v22, v11
    v_accvgpr_write_b32 a57, v5
    v_accvgpr_write_b32 a61, v6
    s_add_u32 s17, s49, 405504
    buffer_load_dword v80, v9, s[20:23], s17 offen
    buffer_load_dword v81, v10, s[20:23], s17 offen
    buffer_load_dword v82, v12, s[20:23], s17 offen
    buffer_load_dword v83, v13, s[20:23], s17 offen
    s_waitcnt vmcnt(58)
    v_perm_b32 v5, v25, v24, s44
    v_perm_b32 v6, v25, v24, s45
    s_waitcnt vmcnt(56)
    v_perm_b32 v158, v27, v26, v11
    v_accvgpr_write_b32 a58, v5
    v_accvgpr_write_b32 a62, v6
    s_add_u32 s17, s49, 406656
    buffer_load_dword v84, v9, s[20:23], s17 offen
    buffer_load_dword v85, v10, s[20:23], s17 offen
    buffer_load_dword v86, v12, s[20:23], s17 offen
    buffer_load_dword v87, v13, s[20:23], s17 offen
    s_waitcnt vmcnt(58)
    v_perm_b32 v5, v29, v28, s44
    v_perm_b32 v6, v29, v28, s45
    s_waitcnt vmcnt(56)
    v_perm_b32 v159, v31, v30, v11
    v_accvgpr_write_b32 a59, v5
    v_accvgpr_write_b32 a63, v6
    s_add_u32 s17, s49, 407808
    buffer_load_dword v88, v9, s[20:23], s17 offen
    buffer_load_dword v89, v10, s[20:23], s17 offen
    buffer_load_dword v90, v12, s[20:23], s17 offen
    buffer_load_dword v91, v13, s[20:23], s17 offen
    s_waitcnt vmcnt(58)
    v_perm_b32 v5, v33, v32, s44
    v_perm_b32 v6, v33, v32, s45
    s_waitcnt vmcnt(56)
    v_perm_b32 v160, v35, v34, v11
    v_accvgpr_write_b32 a64, v5
    v_accvgpr_write_b32 a68, v6
    s_add_u32 s17, s49, 408960
    buffer_load_dword v92, v9, s[20:23], s17 offen
    buffer_load_dword v93, v10, s[20:23], s17 offen
    buffer_load_dword v94, v12, s[20:23], s17 offen
    buffer_load_dword v95, v13, s[20:23], s17 offen
    s_waitcnt vmcnt(58)
    v_perm_b32 v5, v37, v36, s44
    v_perm_b32 v6, v37, v36, s45
    s_waitcnt vmcnt(56)
    v_perm_b32 v161, v39, v38, v11
    v_accvgpr_write_b32 a65, v5
    v_accvgpr_write_b32 a69, v6
    s_add_u32 s17, s49, 442368
    buffer_load_dword v96, v9, s[20:23], s17 offen
    buffer_load_dword v97, v10, s[20:23], s17 offen
    buffer_load_dword v98, v12, s[20:23], s17 offen
    buffer_load_dword v99, v13, s[20:23], s17 offen
    s_waitcnt vmcnt(58)
    v_perm_b32 v5, v41, v40, s44
    v_perm_b32 v6, v41, v40, s45
    s_waitcnt vmcnt(56)
    v_perm_b32 v162, v43, v42, v11
    v_accvgpr_write_b32 a66, v5
    v_accvgpr_write_b32 a70, v6
    s_add_u32 s17, s49, 443520
    buffer_load_dword v100, v9, s[20:23], s17 offen
    buffer_load_dword v101, v10, s[20:23], s17 offen
    buffer_load_dword v102, v12, s[20:23], s17 offen
    buffer_load_dword v103, v13, s[20:23], s17 offen
    s_waitcnt vmcnt(58)
    v_perm_b32 v5, v45, v44, s44
    v_perm_b32 v6, v45, v44, s45
    s_waitcnt vmcnt(56)
    v_perm_b32 v163, v47, v46, v11
    v_accvgpr_write_b32 a67, v5
    v_accvgpr_write_b32 a71, v6
    s_add_u32 s17, s49, 444672
    buffer_load_dword v104, v9, s[20:23], s17 offen
    buffer_load_dword v105, v10, s[20:23], s17 offen
    buffer_load_dword v106, v12, s[20:23], s17 offen
    buffer_load_dword v107, v13, s[20:23], s17 offen
    s_waitcnt vmcnt(58)
    v_perm_b32 v5, v49, v48, s44
    v_perm_b32 v6, v49, v48, s45
    s_waitcnt vmcnt(56)
    v_perm_b32 v164, v51, v50, v11
    v_accvgpr_write_b32 a72, v5
    v_accvgpr_write_b32 a76, v6
    s_add_u32 s17, s49, 445824
    buffer_load_dword v108, v9, s[20:23], s17 offen
    buffer_load_dword v109, v10, s[20:23], s17 offen
    buffer_load_dword v110, v12, s[20:23], s17 offen
    buffer_load_dword v111, v13, s[20:23], s17 offen
    s_waitcnt vmcnt(58)
    v_perm_b32 v5, v53, v52, s44
    v_perm_b32 v6, v53, v52, s45
    s_waitcnt vmcnt(56)
    v_perm_b32 v165, v55, v54, v11
    v_accvgpr_write_b32 a73, v5
    v_accvgpr_write_b32 a77, v6
    s_add_u32 s17, s49, 479232
    buffer_load_dword v112, v9, s[20:23], s17 offen
    buffer_load_dword v113, v10, s[20:23], s17 offen
    buffer_load_dword v114, v12, s[20:23], s17 offen
    buffer_load_dword v115, v13, s[20:23], s17 offen
    s_waitcnt vmcnt(58)
    v_perm_b32 v5, v57, v56, s44
    v_perm_b32 v6, v57, v56, s45
    s_waitcnt vmcnt(56)
    v_perm_b32 v166, v59, v58, v11
    v_accvgpr_write_b32 a74, v5
    v_accvgpr_write_b32 a78, v6
    s_add_u32 s17, s49, 480384
    buffer_load_dword v116, v9, s[20:23], s17 offen
    buffer_load_dword v117, v10, s[20:23], s17 offen
    buffer_load_dword v118, v12, s[20:23], s17 offen
    buffer_load_dword v119, v13, s[20:23], s17 offen
    s_waitcnt vmcnt(58)
    v_perm_b32 v5, v61, v60, s44
    v_perm_b32 v6, v61, v60, s45
    s_waitcnt vmcnt(56)
    v_perm_b32 v167, v63, v62, v11
    v_accvgpr_write_b32 a75, v5
    v_accvgpr_write_b32 a79, v6
    s_add_u32 s17, s49, 481536
    buffer_load_dword v120, v9, s[20:23], s17 offen
    buffer_load_dword v121, v10, s[20:23], s17 offen
    buffer_load_dword v122, v12, s[20:23], s17 offen
    buffer_load_dword v123, v13, s[20:23], s17 offen
    s_waitcnt vmcnt(58)
    v_perm_b32 v5, v65, v64, s44
    v_perm_b32 v6, v65, v64, s45
    s_waitcnt vmcnt(56)
    v_perm_b32 v168, v67, v66, v11
    v_accvgpr_write_b32 a80, v5
    v_accvgpr_write_b32 a84, v6
    s_add_u32 s17, s49, 482688
    buffer_load_dword v124, v9, s[20:23], s17 offen
    buffer_load_dword v125, v10, s[20:23], s17 offen
    buffer_load_dword v126, v12, s[20:23], s17 offen
    buffer_load_dword v127, v13, s[20:23], s17 offen
    s_waitcnt vmcnt(58)
    v_perm_b32 v5, v69, v68, s44
    v_perm_b32 v6, v69, v68, s45
    s_waitcnt vmcnt(56)
    v_perm_b32 v169, v71, v70, v11
    v_accvgpr_write_b32 a81, v5
    v_accvgpr_write_b32 a85, v6
    s_add_u32 s17, s49, 516096
    buffer_load_dword v16, v9, s[20:23], s17 offen
    buffer_load_dword v17, v10, s[20:23], s17 offen
    buffer_load_dword v18, v12, s[20:23], s17 offen
    buffer_load_dword v19, v13, s[20:23], s17 offen
    s_waitcnt vmcnt(58)
    v_perm_b32 v5, v73, v72, s44
    v_perm_b32 v6, v73, v72, s45
    s_waitcnt vmcnt(56)
    v_perm_b32 v170, v75, v74, v11
    v_accvgpr_write_b32 a82, v5
    v_accvgpr_write_b32 a86, v6
    s_add_u32 s17, s49, 517248
    buffer_load_dword v20, v9, s[20:23], s17 offen
    buffer_load_dword v21, v10, s[20:23], s17 offen
    buffer_load_dword v22, v12, s[20:23], s17 offen
    buffer_load_dword v23, v13, s[20:23], s17 offen
    s_waitcnt vmcnt(58)
    v_perm_b32 v5, v77, v76, s44
    v_perm_b32 v6, v77, v76, s45
    s_waitcnt vmcnt(56)
    v_perm_b32 v171, v79, v78, v11
    v_accvgpr_write_b32 a83, v5
    v_accvgpr_write_b32 a87, v6
    s_add_u32 s17, s49, 518400
    buffer_load_dword v24, v9, s[20:23], s17 offen
    buffer_load_dword v25, v10, s[20:23], s17 offen
    buffer_load_dword v26, v12, s[20:23], s17 offen
    buffer_load_dword v27, v13, s[20:23], s17 offen
    s_waitcnt vmcnt(58)
    v_perm_b32 v5, v81, v80, s44
    v_perm_b32 v6, v81, v80, s45
    s_waitcnt vmcnt(56)
    v_perm_b32 v172, v83, v82, v11
    v_accvgpr_write_b32 a88, v5
    v_accvgpr_write_b32 a92, v6
    s_add_u32 s17, s49, 519552
    buffer_load_dword v28, v9, s[20:23], s17 offen
    buffer_load_dword v29, v10, s[20:23], s17 offen
    buffer_load_dword v30, v12, s[20:23], s17 offen
    buffer_load_dword v31, v13, s[20:23], s17 offen
    s_waitcnt vmcnt(58)
    v_perm_b32 v5, v85, v84, s44
    v_perm_b32 v6, v85, v84, s45
    s_waitcnt vmcnt(56)
    v_perm_b32 v173, v87, v86, v11
    v_accvgpr_write_b32 a89, v5
    v_accvgpr_write_b32 a93, v6
    s_add_u32 s17, s49, 552960
    buffer_load_dword v32, v9, s[20:23], s17 offen
    buffer_load_dword v33, v10, s[20:23], s17 offen
    buffer_load_dword v34, v12, s[20:23], s17 offen
    buffer_load_dword v35, v13, s[20:23], s17 offen
    s_waitcnt vmcnt(58)
    v_perm_b32 v5, v89, v88, s44
    v_perm_b32 v6, v89, v88, s45
    s_waitcnt vmcnt(56)
    v_perm_b32 v174, v91, v90, v11
    v_accvgpr_write_b32 a90, v5
    v_accvgpr_write_b32 a94, v6
    s_add_u32 s17, s49, 554112
    buffer_load_dword v36, v9, s[20:23], s17 offen
    buffer_load_dword v37, v10, s[20:23], s17 offen
    buffer_load_dword v38, v12, s[20:23], s17 offen
    buffer_load_dword v39, v13, s[20:23], s17 offen
    s_waitcnt vmcnt(58)
    v_perm_b32 v5, v93, v92, s44
    v_perm_b32 v6, v93, v92, s45
    s_waitcnt vmcnt(56)
    v_perm_b32 v175, v95, v94, v11
    v_accvgpr_write_b32 a91, v5
    v_accvgpr_write_b32 a95, v6
    s_add_u32 s17, s49, 555264
    buffer_load_dword v40, v9, s[20:23], s17 offen
    buffer_load_dword v41, v10, s[20:23], s17 offen
    buffer_load_dword v42, v12, s[20:23], s17 offen
    buffer_load_dword v43, v13, s[20:23], s17 offen
    s_waitcnt vmcnt(58)
    v_perm_b32 v5, v97, v96, s44
    v_perm_b32 v6, v97, v96, s45
    s_waitcnt vmcnt(56)
    v_perm_b32 v176, v99, v98, v11
    v_accvgpr_write_b32 a96, v5
    v_accvgpr_write_b32 a100, v6
    s_add_u32 s17, s49, 556416
    buffer_load_dword v44, v9, s[20:23], s17 offen
    buffer_load_dword v45, v10, s[20:23], s17 offen
    buffer_load_dword v46, v12, s[20:23], s17 offen
    buffer_load_dword v47, v13, s[20:23], s17 offen
    s_waitcnt vmcnt(58)
    v_perm_b32 v5, v101, v100, s44
    v_perm_b32 v6, v101, v100, s45
    s_waitcnt vmcnt(56)
    v_perm_b32 v177, v103, v102, v11
    v_accvgpr_write_b32 a97, v5
    v_accvgpr_write_b32 a101, v6
    s_add_u32 s17, s49, 589824
    buffer_load_dword v48, v9, s[20:23], s17 offen
    buffer_load_dword v49, v10, s[20:23], s17 offen
    buffer_load_dword v50, v12, s[20:23], s17 offen
    buffer_load_dword v51, v13, s[20:23], s17 offen
    s_waitcnt vmcnt(58)
    v_perm_b32 v5, v105, v104, s44
    v_perm_b32 v6, v105, v104, s45
    s_waitcnt vmcnt(56)
    v_perm_b32 v178, v107, v106, v11
    v_accvgpr_write_b32 a98, v5
    v_accvgpr_write_b32 a102, v6
    s_add_u32 s17, s49, 590976
    buffer_load_dword v52, v9, s[20:23], s17 offen
    buffer_load_dword v53, v10, s[20:23], s17 offen
    buffer_load_dword v54, v12, s[20:23], s17 offen
    buffer_load_dword v55, v13, s[20:23], s17 offen
    s_waitcnt vmcnt(58)
    v_perm_b32 v5, v109, v108, s44
    v_perm_b32 v6, v109, v108, s45
    s_waitcnt vmcnt(56)
    v_perm_b32 v179, v111, v110, v11
    v_accvgpr_write_b32 a99, v5
    v_accvgpr_write_b32 a103, v6
    s_add_u32 s17, s49, 592128
    buffer_load_dword v56, v9, s[20:23], s17 offen
    buffer_load_dword v57, v10, s[20:23], s17 offen
    buffer_load_dword v58, v12, s[20:23], s17 offen
    buffer_load_dword v59, v13, s[20:23], s17 offen
    s_waitcnt vmcnt(58)
    v_perm_b32 v5, v113, v112, s44
    v_perm_b32 v6, v113, v112, s45
    s_waitcnt vmcnt(56)
    v_perm_b32 v180, v115, v114, v11
    v_accvgpr_write_b32 a104, v5
    v_accvgpr_write_b32 a108, v6
    s_add_u32 s17, s49, 593280
    buffer_load_dword v60, v9, s[20:23], s17 offen
    buffer_load_dword v61, v10, s[20:23], s17 offen
    buffer_load_dword v62, v12, s[20:23], s17 offen
    buffer_load_dword v63, v13, s[20:23], s17 offen
    s_waitcnt vmcnt(58)
    v_perm_b32 v5, v117, v116, s44
    v_perm_b32 v6, v117, v116, s45
    s_waitcnt vmcnt(56)
    v_perm_b32 v181, v119, v118, v11
    v_accvgpr_write_b32 a105, v5
    v_accvgpr_write_b32 a109, v6
    s_add_u32 s17, s49, 626688
    buffer_load_dword v64, v9, s[20:23], s17 offen
    buffer_load_dword v65, v10, s[20:23], s17 offen
    buffer_load_dword v66, v12, s[20:23], s17 offen
    buffer_load_dword v67, v13, s[20:23], s17 offen
    s_waitcnt vmcnt(58)
    v_perm_b32 v5, v121, v120, s44
    v_perm_b32 v6, v121, v120, s45
    s_waitcnt vmcnt(56)
    v_perm_b32 v182, v123, v122, v11
    v_accvgpr_write_b32 a106, v5
    v_accvgpr_write_b32 a110, v6
    s_add_u32 s17, s49, 627840
    buffer_load_dword v68, v9, s[20:23], s17 offen
    buffer_load_dword v69, v10, s[20:23], s17 offen
    buffer_load_dword v70, v12, s[20:23], s17 offen
    buffer_load_dword v71, v13, s[20:23], s17 offen
    s_waitcnt vmcnt(58)
    v_perm_b32 v5, v125, v124, s44
    v_perm_b32 v6, v125, v124, s45
    s_waitcnt vmcnt(56)
    v_perm_b32 v183, v127, v126, v11
    v_accvgpr_write_b32 a107, v5
    v_accvgpr_write_b32 a111, v6
    s_add_u32 s17, s49, 628992
    buffer_load_dword v72, v9, s[20:23], s17 offen
    buffer_load_dword v73, v10, s[20:23], s17 offen
    buffer_load_dword v74, v12, s[20:23], s17 offen
    buffer_load_dword v75, v13, s[20:23], s17 offen
    s_waitcnt vmcnt(58)
    v_perm_b32 v5, v17, v16, s44
    v_perm_b32 v6, v17, v16, s45
    s_waitcnt vmcnt(56)
    v_perm_b32 v184, v19, v18, v11
    v_accvgpr_write_b32 a112, v5
    v_accvgpr_write_b32 a116, v6
    s_add_u32 s17, s49, 630144
    buffer_load_dword v76, v9, s[20:23], s17 offen
    buffer_load_dword v77, v10, s[20:23], s17 offen
    buffer_load_dword v78, v12, s[20:23], s17 offen
    buffer_load_dword v79, v13, s[20:23], s17 offen
    s_waitcnt vmcnt(58)
    v_perm_b32 v5, v21, v20, s44
    v_perm_b32 v6, v21, v20, s45
    s_waitcnt vmcnt(56)
    v_perm_b32 v185, v23, v22, v11
    v_accvgpr_write_b32 a113, v5
    v_accvgpr_write_b32 a117, v6
    s_add_u32 s17, s49, 663552
    buffer_load_dword v80, v9, s[20:23], s17 offen
    buffer_load_dword v81, v10, s[20:23], s17 offen
    buffer_load_dword v82, v12, s[20:23], s17 offen
    buffer_load_dword v83, v13, s[20:23], s17 offen
    s_waitcnt vmcnt(58)
    v_perm_b32 v5, v25, v24, s44
    v_perm_b32 v6, v25, v24, s45
    s_waitcnt vmcnt(56)
    v_perm_b32 v186, v27, v26, v11
    v_accvgpr_write_b32 a114, v5
    v_accvgpr_write_b32 a118, v6
    s_add_u32 s17, s49, 664704
    buffer_load_dword v84, v9, s[20:23], s17 offen
    buffer_load_dword v85, v10, s[20:23], s17 offen
    buffer_load_dword v86, v12, s[20:23], s17 offen
    buffer_load_dword v87, v13, s[20:23], s17 offen
    s_waitcnt vmcnt(58)
    v_perm_b32 v5, v29, v28, s44
    v_perm_b32 v6, v29, v28, s45
    s_waitcnt vmcnt(56)
    v_perm_b32 v187, v31, v30, v11
    v_accvgpr_write_b32 a115, v5
    v_accvgpr_write_b32 a119, v6
    s_add_u32 s17, s49, 665856
    buffer_load_dword v88, v9, s[20:23], s17 offen
    buffer_load_dword v89, v10, s[20:23], s17 offen
    buffer_load_dword v90, v12, s[20:23], s17 offen
    buffer_load_dword v91, v13, s[20:23], s17 offen
    s_waitcnt vmcnt(58)
    v_perm_b32 v5, v33, v32, s44
    v_perm_b32 v6, v33, v32, s45
    s_waitcnt vmcnt(56)
    v_perm_b32 v188, v35, v34, v11
    v_accvgpr_write_b32 a120, v5
    v_accvgpr_write_b32 a124, v6
    s_add_u32 s17, s49, 667008
    buffer_load_dword v92, v9, s[20:23], s17 offen
    buffer_load_dword v93, v10, s[20:23], s17 offen
    buffer_load_dword v94, v12, s[20:23], s17 offen
    buffer_load_dword v95, v13, s[20:23], s17 offen
    s_waitcnt vmcnt(58)
    v_perm_b32 v5, v37, v36, s44
    v_perm_b32 v6, v37, v36, s45
    s_waitcnt vmcnt(56)
    v_perm_b32 v189, v39, v38, v11
    v_accvgpr_write_b32 a121, v5
    v_accvgpr_write_b32 a125, v6
    s_add_u32 s17, s49, 700416
    buffer_load_dword v96, v9, s[20:23], s17 offen
    buffer_load_dword v97, v10, s[20:23], s17 offen
    buffer_load_dword v98, v12, s[20:23], s17 offen
    buffer_load_dword v99, v13, s[20:23], s17 offen
    s_waitcnt vmcnt(58)
    v_perm_b32 v5, v41, v40, s44
    v_perm_b32 v6, v41, v40, s45
    s_waitcnt vmcnt(56)
    v_perm_b32 v190, v43, v42, v11
    v_accvgpr_write_b32 a122, v5
    v_accvgpr_write_b32 a126, v6
    s_add_u32 s17, s49, 701568
    buffer_load_dword v100, v9, s[20:23], s17 offen
    buffer_load_dword v101, v10, s[20:23], s17 offen
    buffer_load_dword v102, v12, s[20:23], s17 offen
    buffer_load_dword v103, v13, s[20:23], s17 offen
    s_waitcnt vmcnt(58)
    v_perm_b32 v5, v45, v44, s44
    v_perm_b32 v6, v45, v44, s45
    s_waitcnt vmcnt(56)
    v_perm_b32 v191, v47, v46, v11
    v_accvgpr_write_b32 a123, v5
    v_accvgpr_write_b32 a127, v6
    s_add_u32 s17, s49, 702720
    buffer_load_dword v104, v9, s[20:23], s17 offen
    buffer_load_dword v105, v10, s[20:23], s17 offen
    buffer_load_dword v106, v12, s[20:23], s17 offen
    buffer_load_dword v107, v13, s[20:23], s17 offen
    s_waitcnt vmcnt(58)
    v_perm_b32 v5, v49, v48, s44
    v_perm_b32 v6, v49, v48, s45
    s_waitcnt vmcnt(56)
    v_perm_b32 v192, v51, v50, v11
    v_accvgpr_write_b32 a128, v5
    v_accvgpr_write_b32 a132, v6
    s_add_u32 s17, s49, 703872
    buffer_load_dword v108, v9, s[20:23], s17 offen
    buffer_load_dword v109, v10, s[20:23], s17 offen
    buffer_load_dword v110, v12, s[20:23], s17 offen
    buffer_load_dword v111, v13, s[20:23], s17 offen
    s_waitcnt vmcnt(58)
    v_perm_b32 v5, v53, v52, s44
    v_perm_b32 v6, v53, v52, s45
    s_waitcnt vmcnt(56)
    v_perm_b32 v193, v55, v54, v11
    v_accvgpr_write_b32 a129, v5
    v_accvgpr_write_b32 a133, v6
    s_add_u32 s17, s49, 737280
    buffer_load_dword v112, v9, s[20:23], s17 offen
    buffer_load_dword v113, v10, s[20:23], s17 offen
    buffer_load_dword v114, v12, s[20:23], s17 offen
    buffer_load_dword v115, v13, s[20:23], s17 offen
    s_waitcnt vmcnt(58)
    v_perm_b32 v5, v57, v56, s44
    v_perm_b32 v6, v57, v56, s45
    s_waitcnt vmcnt(56)
    v_perm_b32 v194, v59, v58, v11
    v_accvgpr_write_b32 a130, v5
    v_accvgpr_write_b32 a134, v6
    s_add_u32 s17, s49, 738432
    buffer_load_dword v116, v9, s[20:23], s17 offen
    buffer_load_dword v117, v10, s[20:23], s17 offen
    buffer_load_dword v118, v12, s[20:23], s17 offen
    buffer_load_dword v119, v13, s[20:23], s17 offen
    s_waitcnt vmcnt(58)
    v_perm_b32 v5, v61, v60, s44
    v_perm_b32 v6, v61, v60, s45
    s_waitcnt vmcnt(56)
    v_perm_b32 v195, v63, v62, v11
    v_accvgpr_write_b32 a131, v5
    v_accvgpr_write_b32 a135, v6
    s_add_u32 s17, s49, 739584
    buffer_load_dword v120, v9, s[20:23], s17 offen
    buffer_load_dword v121, v10, s[20:23], s17 offen
    buffer_load_dword v122, v12, s[20:23], s17 offen
    buffer_load_dword v123, v13, s[20:23], s17 offen
    s_waitcnt vmcnt(58)
    v_perm_b32 v5, v65, v64, s44
    v_perm_b32 v6, v65, v64, s45
    s_waitcnt vmcnt(56)
    v_perm_b32 v196, v67, v66, v11
    v_accvgpr_write_b32 a136, v5
    v_accvgpr_write_b32 a140, v6
    s_add_u32 s17, s49, 740736
    buffer_load_dword v124, v9, s[20:23], s17 offen
    buffer_load_dword v125, v10, s[20:23], s17 offen
    buffer_load_dword v126, v12, s[20:23], s17 offen
    buffer_load_dword v127, v13, s[20:23], s17 offen
    s_waitcnt vmcnt(58)
    v_perm_b32 v5, v69, v68, s44
    v_perm_b32 v6, v69, v68, s45
    s_waitcnt vmcnt(56)
    v_perm_b32 v197, v71, v70, v11
    v_accvgpr_write_b32 a137, v5
    v_accvgpr_write_b32 a141, v6
    s_add_u32 s17, s49, 774144
    buffer_load_dword v16, v9, s[20:23], s17 offen
    buffer_load_dword v17, v10, s[20:23], s17 offen
    buffer_load_dword v18, v12, s[20:23], s17 offen
    buffer_load_dword v19, v13, s[20:23], s17 offen
    s_waitcnt vmcnt(58)
    v_perm_b32 v5, v73, v72, s44
    v_perm_b32 v6, v73, v72, s45
    s_waitcnt vmcnt(56)
    v_perm_b32 v198, v75, v74, v11
    v_accvgpr_write_b32 a138, v5
    v_accvgpr_write_b32 a142, v6
    s_add_u32 s17, s49, 775296
    buffer_load_dword v20, v9, s[20:23], s17 offen
    buffer_load_dword v21, v10, s[20:23], s17 offen
    buffer_load_dword v22, v12, s[20:23], s17 offen
    buffer_load_dword v23, v13, s[20:23], s17 offen
    s_waitcnt vmcnt(58)
    v_perm_b32 v5, v77, v76, s44
    v_perm_b32 v6, v77, v76, s45
    s_waitcnt vmcnt(56)
    v_perm_b32 v199, v79, v78, v11
    v_accvgpr_write_b32 a139, v5
    v_accvgpr_write_b32 a143, v6
    s_add_u32 s17, s49, 776448
    buffer_load_dword v24, v9, s[20:23], s17 offen
    buffer_load_dword v25, v10, s[20:23], s17 offen
    buffer_load_dword v26, v12, s[20:23], s17 offen
    buffer_load_dword v27, v13, s[20:23], s17 offen
    s_waitcnt vmcnt(58)
    v_perm_b32 v5, v81, v80, s44
    v_perm_b32 v6, v81, v80, s45
    s_waitcnt vmcnt(56)
    v_perm_b32 v200, v83, v82, v11
    v_accvgpr_write_b32 a144, v5
    v_accvgpr_write_b32 a148, v6
    s_add_u32 s17, s49, 777600
    buffer_load_dword v28, v9, s[20:23], s17 offen
    buffer_load_dword v29, v10, s[20:23], s17 offen
    buffer_load_dword v30, v12, s[20:23], s17 offen
    buffer_load_dword v31, v13, s[20:23], s17 offen
    s_waitcnt vmcnt(58)
    v_perm_b32 v5, v85, v84, s44
    v_perm_b32 v6, v85, v84, s45
    s_waitcnt vmcnt(56)
    v_perm_b32 v201, v87, v86, v11
    v_accvgpr_write_b32 a145, v5
    v_accvgpr_write_b32 a149, v6
    s_add_u32 s17, s49, 811008
    buffer_load_dword v32, v9, s[20:23], s17 offen
    buffer_load_dword v33, v10, s[20:23], s17 offen
    buffer_load_dword v34, v12, s[20:23], s17 offen
    buffer_load_dword v35, v13, s[20:23], s17 offen
    s_waitcnt vmcnt(58)
    v_perm_b32 v5, v89, v88, s44
    v_perm_b32 v6, v89, v88, s45
    s_waitcnt vmcnt(56)
    v_perm_b32 v202, v91, v90, v11
    v_accvgpr_write_b32 a146, v5
    v_accvgpr_write_b32 a150, v6
    s_add_u32 s17, s49, 812160
    buffer_load_dword v36, v9, s[20:23], s17 offen
    buffer_load_dword v37, v10, s[20:23], s17 offen
    buffer_load_dword v38, v12, s[20:23], s17 offen
    buffer_load_dword v39, v13, s[20:23], s17 offen
    s_waitcnt vmcnt(58)
    v_perm_b32 v5, v93, v92, s44
    v_perm_b32 v6, v93, v92, s45
    s_waitcnt vmcnt(56)
    v_perm_b32 v203, v95, v94, v11
    v_accvgpr_write_b32 a147, v5
    v_accvgpr_write_b32 a151, v6
    s_add_u32 s17, s49, 813312
    buffer_load_dword v40, v9, s[20:23], s17 offen
    buffer_load_dword v41, v10, s[20:23], s17 offen
    buffer_load_dword v42, v12, s[20:23], s17 offen
    buffer_load_dword v43, v13, s[20:23], s17 offen
    s_waitcnt vmcnt(58)
    v_perm_b32 v5, v97, v96, s44
    v_perm_b32 v6, v97, v96, s45
    s_waitcnt vmcnt(56)
    v_perm_b32 v204, v99, v98, v11
    v_accvgpr_write_b32 a152, v5
    v_accvgpr_write_b32 a156, v6
    s_add_u32 s17, s49, 814464
    buffer_load_dword v44, v9, s[20:23], s17 offen
    buffer_load_dword v45, v10, s[20:23], s17 offen
    buffer_load_dword v46, v12, s[20:23], s17 offen
    buffer_load_dword v47, v13, s[20:23], s17 offen
    s_waitcnt vmcnt(58)
    v_perm_b32 v5, v101, v100, s44
    v_perm_b32 v6, v101, v100, s45
    s_waitcnt vmcnt(56)
    v_perm_b32 v205, v103, v102, v11
    v_accvgpr_write_b32 a153, v5
    v_accvgpr_write_b32 a157, v6
    s_add_u32 s17, s49, 847872
    buffer_load_dword v48, v9, s[20:23], s17 offen
    buffer_load_dword v49, v10, s[20:23], s17 offen
    buffer_load_dword v50, v12, s[20:23], s17 offen
    buffer_load_dword v51, v13, s[20:23], s17 offen
    s_waitcnt vmcnt(58)
    v_perm_b32 v5, v105, v104, s44
    v_perm_b32 v6, v105, v104, s45
    s_waitcnt vmcnt(56)
    v_perm_b32 v206, v107, v106, v11
    v_accvgpr_write_b32 a154, v5
    v_accvgpr_write_b32 a158, v6
    s_add_u32 s17, s49, 849024
    buffer_load_dword v52, v9, s[20:23], s17 offen
    buffer_load_dword v53, v10, s[20:23], s17 offen
    buffer_load_dword v54, v12, s[20:23], s17 offen
    buffer_load_dword v55, v13, s[20:23], s17 offen
    s_waitcnt vmcnt(58)
    v_perm_b32 v5, v109, v108, s44
    v_perm_b32 v6, v109, v108, s45
    s_waitcnt vmcnt(56)
    v_perm_b32 v207, v111, v110, v11
    v_accvgpr_write_b32 a155, v5
    v_accvgpr_write_b32 a159, v6
    s_add_u32 s17, s49, 850176
    buffer_load_dword v56, v9, s[20:23], s17 offen
    buffer_load_dword v57, v10, s[20:23], s17 offen
    buffer_load_dword v58, v12, s[20:23], s17 offen
    buffer_load_dword v59, v13, s[20:23], s17 offen
    s_waitcnt vmcnt(58)
    v_perm_b32 v5, v113, v112, s44
    v_perm_b32 v6, v113, v112, s45
    s_waitcnt vmcnt(56)
    v_perm_b32 v208, v115, v114, v11
    v_accvgpr_write_b32 a160, v5
    v_accvgpr_write_b32 a164, v6
    s_add_u32 s17, s49, 851328
    buffer_load_dword v60, v9, s[20:23], s17 offen
    buffer_load_dword v61, v10, s[20:23], s17 offen
    buffer_load_dword v62, v12, s[20:23], s17 offen
    buffer_load_dword v63, v13, s[20:23], s17 offen
    s_waitcnt vmcnt(58)
    v_perm_b32 v5, v117, v116, s44
    v_perm_b32 v6, v117, v116, s45
    s_waitcnt vmcnt(56)
    v_perm_b32 v209, v119, v118, v11
    v_accvgpr_write_b32 a161, v5
    v_accvgpr_write_b32 a165, v6
    s_add_u32 s17, s49, 884736
    buffer_load_dword v64, v9, s[20:23], s17 offen
    buffer_load_dword v65, v10, s[20:23], s17 offen
    buffer_load_dword v66, v12, s[20:23], s17 offen
    buffer_load_dword v67, v13, s[20:23], s17 offen
    s_waitcnt vmcnt(58)
    v_perm_b32 v5, v121, v120, s44
    v_perm_b32 v6, v121, v120, s45
    s_waitcnt vmcnt(56)
    v_perm_b32 v210, v123, v122, v11
    v_accvgpr_write_b32 a162, v5
    v_accvgpr_write_b32 a166, v6
    s_add_u32 s17, s49, 885888
    buffer_load_dword v68, v9, s[20:23], s17 offen
    buffer_load_dword v69, v10, s[20:23], s17 offen
    buffer_load_dword v70, v12, s[20:23], s17 offen
    buffer_load_dword v71, v13, s[20:23], s17 offen
    s_waitcnt vmcnt(58)
    v_perm_b32 v5, v125, v124, s44
    v_perm_b32 v6, v125, v124, s45
    s_waitcnt vmcnt(56)
    v_perm_b32 v211, v127, v126, v11
    v_accvgpr_write_b32 a163, v5
    v_accvgpr_write_b32 a167, v6
    s_add_u32 s17, s49, 887040
    buffer_load_dword v72, v9, s[20:23], s17 offen
    buffer_load_dword v73, v10, s[20:23], s17 offen
    buffer_load_dword v74, v12, s[20:23], s17 offen
    buffer_load_dword v75, v13, s[20:23], s17 offen
    s_waitcnt vmcnt(58)
    v_perm_b32 v5, v17, v16, s44
    v_perm_b32 v6, v17, v16, s45
    s_waitcnt vmcnt(56)
    v_perm_b32 v212, v19, v18, v11
    v_accvgpr_write_b32 a168, v5
    v_accvgpr_write_b32 a172, v6
    s_add_u32 s17, s49, 888192
    buffer_load_dword v76, v9, s[20:23], s17 offen
    buffer_load_dword v77, v10, s[20:23], s17 offen
    buffer_load_dword v78, v12, s[20:23], s17 offen
    buffer_load_dword v79, v13, s[20:23], s17 offen
    s_waitcnt vmcnt(58)
    v_perm_b32 v5, v21, v20, s44
    v_perm_b32 v6, v21, v20, s45
    s_waitcnt vmcnt(56)
    v_perm_b32 v213, v23, v22, v11
    v_accvgpr_write_b32 a169, v5
    v_accvgpr_write_b32 a173, v6
    s_add_u32 s17, s49, 921600
    buffer_load_dword v80, v9, s[20:23], s17 offen
    buffer_load_dword v81, v10, s[20:23], s17 offen
    buffer_load_dword v82, v12, s[20:23], s17 offen
    buffer_load_dword v83, v13, s[20:23], s17 offen
    s_waitcnt vmcnt(58)
    v_perm_b32 v5, v25, v24, s44
    v_perm_b32 v6, v25, v24, s45
    s_waitcnt vmcnt(56)
    v_perm_b32 v214, v27, v26, v11
    v_accvgpr_write_b32 a170, v5
    v_accvgpr_write_b32 a174, v6
    s_add_u32 s17, s49, 922752
    buffer_load_dword v84, v9, s[20:23], s17 offen
    buffer_load_dword v85, v10, s[20:23], s17 offen
    buffer_load_dword v86, v12, s[20:23], s17 offen
    buffer_load_dword v87, v13, s[20:23], s17 offen
    s_waitcnt vmcnt(58)
    v_perm_b32 v5, v29, v28, s44
    v_perm_b32 v6, v29, v28, s45
    s_waitcnt vmcnt(56)
    v_perm_b32 v215, v31, v30, v11
    v_accvgpr_write_b32 a171, v5
    v_accvgpr_write_b32 a175, v6
    s_add_u32 s17, s49, 923904
    buffer_load_dword v88, v9, s[20:23], s17 offen
    buffer_load_dword v89, v10, s[20:23], s17 offen
    buffer_load_dword v90, v12, s[20:23], s17 offen
    buffer_load_dword v91, v13, s[20:23], s17 offen
    s_waitcnt vmcnt(58)
    v_perm_b32 v5, v33, v32, s44
    v_perm_b32 v6, v33, v32, s45
    s_waitcnt vmcnt(56)
    v_perm_b32 v216, v35, v34, v11
    v_accvgpr_write_b32 a176, v5
    v_accvgpr_write_b32 a180, v6
    s_add_u32 s17, s49, 925056
    buffer_load_dword v92, v9, s[20:23], s17 offen
    buffer_load_dword v93, v10, s[20:23], s17 offen
    buffer_load_dword v94, v12, s[20:23], s17 offen
    buffer_load_dword v95, v13, s[20:23], s17 offen
    s_waitcnt vmcnt(58)
    v_perm_b32 v5, v37, v36, s44
    v_perm_b32 v6, v37, v36, s45
    s_waitcnt vmcnt(56)
    v_perm_b32 v217, v39, v38, v11
    v_accvgpr_write_b32 a177, v5
    v_accvgpr_write_b32 a181, v6
    s_add_u32 s17, s49, 958464
    buffer_load_dword v96, v9, s[20:23], s17 offen
    buffer_load_dword v97, v10, s[20:23], s17 offen
    buffer_load_dword v98, v12, s[20:23], s17 offen
    buffer_load_dword v99, v13, s[20:23], s17 offen
    s_waitcnt vmcnt(58)
    v_perm_b32 v5, v41, v40, s44
    v_perm_b32 v6, v41, v40, s45
    s_waitcnt vmcnt(56)
    v_perm_b32 v218, v43, v42, v11
    v_accvgpr_write_b32 a178, v5
    v_accvgpr_write_b32 a182, v6
    s_add_u32 s17, s49, 959616
    buffer_load_dword v100, v9, s[20:23], s17 offen
    buffer_load_dword v101, v10, s[20:23], s17 offen
    buffer_load_dword v102, v12, s[20:23], s17 offen
    buffer_load_dword v103, v13, s[20:23], s17 offen
    s_waitcnt vmcnt(58)
    v_perm_b32 v5, v45, v44, s44
    v_perm_b32 v6, v45, v44, s45
    s_waitcnt vmcnt(56)
    v_perm_b32 v219, v47, v46, v11
    v_accvgpr_write_b32 a179, v5
    v_accvgpr_write_b32 a183, v6
    s_add_u32 s17, s49, 960768
    buffer_load_dword v104, v9, s[20:23], s17 offen
    buffer_load_dword v105, v10, s[20:23], s17 offen
    buffer_load_dword v106, v12, s[20:23], s17 offen
    buffer_load_dword v107, v13, s[20:23], s17 offen
    s_waitcnt vmcnt(58)
    v_perm_b32 v5, v49, v48, s44
    v_perm_b32 v6, v49, v48, s45
    s_waitcnt vmcnt(56)
    v_perm_b32 v220, v51, v50, v11
    v_accvgpr_write_b32 a184, v5
    v_accvgpr_write_b32 a188, v6
    s_add_u32 s17, s49, 961920
    buffer_load_dword v108, v9, s[20:23], s17 offen
    buffer_load_dword v109, v10, s[20:23], s17 offen
    buffer_load_dword v110, v12, s[20:23], s17 offen
    buffer_load_dword v111, v13, s[20:23], s17 offen
    s_waitcnt vmcnt(58)
    v_perm_b32 v5, v53, v52, s44
    v_perm_b32 v6, v53, v52, s45
    s_waitcnt vmcnt(56)
    v_perm_b32 v221, v55, v54, v11
    v_accvgpr_write_b32 a185, v5
    v_accvgpr_write_b32 a189, v6
    s_add_u32 s17, s49, 995328
    buffer_load_dword v112, v9, s[20:23], s17 offen
    buffer_load_dword v113, v10, s[20:23], s17 offen
    buffer_load_dword v114, v12, s[20:23], s17 offen
    buffer_load_dword v115, v13, s[20:23], s17 offen
    s_waitcnt vmcnt(58)
    v_perm_b32 v5, v57, v56, s44
    v_perm_b32 v6, v57, v56, s45
    s_waitcnt vmcnt(56)
    v_perm_b32 v222, v59, v58, v11
    v_accvgpr_write_b32 a186, v5
    v_accvgpr_write_b32 a190, v6
    s_add_u32 s17, s49, 996480
    buffer_load_dword v116, v9, s[20:23], s17 offen
    buffer_load_dword v117, v10, s[20:23], s17 offen
    buffer_load_dword v118, v12, s[20:23], s17 offen
    buffer_load_dword v119, v13, s[20:23], s17 offen
    s_waitcnt vmcnt(58)
    v_perm_b32 v5, v61, v60, s44
    v_perm_b32 v6, v61, v60, s45
    s_waitcnt vmcnt(56)
    v_perm_b32 v223, v63, v62, v11
    v_accvgpr_write_b32 a187, v5
    v_accvgpr_write_b32 a191, v6
    s_add_u32 s17, s49, 997632
    buffer_load_dword v120, v9, s[20:23], s17 offen
    buffer_load_dword v121, v10, s[20:23], s17 offen
    buffer_load_dword v122, v12, s[20:23], s17 offen
    buffer_load_dword v123, v13, s[20:23], s17 offen
    s_waitcnt vmcnt(58)
    v_perm_b32 v5, v65, v64, s44
    v_perm_b32 v6, v65, v64, s45
    s_waitcnt vmcnt(56)
    v_perm_b32 v224, v67, v66, v11
    v_accvgpr_write_b32 a192, v5
    v_accvgpr_write_b32 a196, v6
    s_add_u32 s17, s49, 998784
    buffer_load_dword v124, v9, s[20:23], s17 offen
    buffer_load_dword v125, v10, s[20:23], s17 offen
    buffer_load_dword v126, v12, s[20:23], s17 offen
    buffer_load_dword v127, v13, s[20:23], s17 offen
    s_waitcnt vmcnt(58)
    v_perm_b32 v5, v69, v68, s44
    v_perm_b32 v6, v69, v68, s45
    s_waitcnt vmcnt(56)
    v_perm_b32 v225, v71, v70, v11
    v_accvgpr_write_b32 a193, v5
    v_accvgpr_write_b32 a197, v6
    s_add_u32 s17, s49, 1032192
    buffer_load_dword v16, v9, s[20:23], s17 offen
    buffer_load_dword v17, v10, s[20:23], s17 offen
    buffer_load_dword v18, v12, s[20:23], s17 offen
    buffer_load_dword v19, v13, s[20:23], s17 offen
    s_waitcnt vmcnt(58)
    v_perm_b32 v5, v73, v72, s44
    v_perm_b32 v6, v73, v72, s45
    s_waitcnt vmcnt(56)
    v_perm_b32 v226, v75, v74, v11
    v_accvgpr_write_b32 a194, v5
    v_accvgpr_write_b32 a198, v6
    s_add_u32 s17, s49, 1033344
    buffer_load_dword v20, v9, s[20:23], s17 offen
    buffer_load_dword v21, v10, s[20:23], s17 offen
    buffer_load_dword v22, v12, s[20:23], s17 offen
    buffer_load_dword v23, v13, s[20:23], s17 offen
    s_waitcnt vmcnt(58)
    v_perm_b32 v5, v77, v76, s44
    v_perm_b32 v6, v77, v76, s45
    s_waitcnt vmcnt(56)
    v_perm_b32 v227, v79, v78, v11
    v_accvgpr_write_b32 a195, v5
    v_accvgpr_write_b32 a199, v6
    s_add_u32 s17, s49, 1034496
    buffer_load_dword v24, v9, s[20:23], s17 offen
    buffer_load_dword v25, v10, s[20:23], s17 offen
    buffer_load_dword v26, v12, s[20:23], s17 offen
    buffer_load_dword v27, v13, s[20:23], s17 offen
    s_waitcnt vmcnt(58)
    v_perm_b32 v5, v81, v80, s44
    v_perm_b32 v6, v81, v80, s45
    s_waitcnt vmcnt(56)
    v_perm_b32 v228, v83, v82, v11
    v_accvgpr_write_b32 a200, v5
    v_accvgpr_write_b32 a204, v6
    s_add_u32 s17, s49, 1035648
    buffer_load_dword v28, v9, s[20:23], s17 offen
    buffer_load_dword v29, v10, s[20:23], s17 offen
    buffer_load_dword v30, v12, s[20:23], s17 offen
    buffer_load_dword v31, v13, s[20:23], s17 offen
    s_waitcnt vmcnt(58)
    v_perm_b32 v5, v85, v84, s44
    v_perm_b32 v6, v85, v84, s45
    s_waitcnt vmcnt(56)
    v_perm_b32 v229, v87, v86, v11
    v_accvgpr_write_b32 a201, v5
    v_accvgpr_write_b32 a205, v6
    s_add_u32 s17, s49, 1069056
    buffer_load_dword v32, v9, s[20:23], s17 offen
    buffer_load_dword v33, v10, s[20:23], s17 offen
    buffer_load_dword v34, v12, s[20:23], s17 offen
    buffer_load_dword v35, v13, s[20:23], s17 offen
    s_waitcnt vmcnt(58)
    v_perm_b32 v5, v89, v88, s44
    v_perm_b32 v6, v89, v88, s45
    s_waitcnt vmcnt(56)
    v_perm_b32 v230, v91, v90, v11
    v_accvgpr_write_b32 a202, v5
    v_accvgpr_write_b32 a206, v6
    s_add_u32 s17, s49, 1070208
    buffer_load_dword v36, v9, s[20:23], s17 offen
    buffer_load_dword v37, v10, s[20:23], s17 offen
    buffer_load_dword v38, v12, s[20:23], s17 offen
    buffer_load_dword v39, v13, s[20:23], s17 offen
    s_waitcnt vmcnt(58)
    v_perm_b32 v5, v93, v92, s44
    v_perm_b32 v6, v93, v92, s45
    s_waitcnt vmcnt(56)
    v_perm_b32 v231, v95, v94, v11
    v_accvgpr_write_b32 a203, v5
    v_accvgpr_write_b32 a207, v6
    s_add_u32 s17, s49, 1071360
    buffer_load_dword v40, v9, s[20:23], s17 offen
    buffer_load_dword v41, v10, s[20:23], s17 offen
    buffer_load_dword v42, v12, s[20:23], s17 offen
    buffer_load_dword v43, v13, s[20:23], s17 offen
    s_waitcnt vmcnt(58)
    v_perm_b32 v5, v97, v96, s44
    v_perm_b32 v6, v97, v96, s45
    s_waitcnt vmcnt(56)
    v_perm_b32 v232, v99, v98, v11
    v_accvgpr_write_b32 a208, v5
    v_accvgpr_write_b32 a212, v6
    s_add_u32 s17, s49, 1072512
    buffer_load_dword v44, v9, s[20:23], s17 offen
    buffer_load_dword v45, v10, s[20:23], s17 offen
    buffer_load_dword v46, v12, s[20:23], s17 offen
    buffer_load_dword v47, v13, s[20:23], s17 offen
    s_waitcnt vmcnt(58)
    v_perm_b32 v5, v101, v100, s44
    v_perm_b32 v6, v101, v100, s45
    s_waitcnt vmcnt(56)
    v_perm_b32 v233, v103, v102, v11
    v_accvgpr_write_b32 a209, v5
    v_accvgpr_write_b32 a213, v6
    s_add_u32 s17, s49, 1105920
    buffer_load_dword v48, v9, s[20:23], s17 offen
    buffer_load_dword v49, v10, s[20:23], s17 offen
    buffer_load_dword v50, v12, s[20:23], s17 offen
    buffer_load_dword v51, v13, s[20:23], s17 offen
    s_waitcnt vmcnt(58)
    v_perm_b32 v5, v105, v104, s44
    v_perm_b32 v6, v105, v104, s45
    s_waitcnt vmcnt(56)
    v_perm_b32 v234, v107, v106, v11
    v_accvgpr_write_b32 a210, v5
    v_accvgpr_write_b32 a214, v6
    s_add_u32 s17, s49, 1107072
    buffer_load_dword v52, v9, s[20:23], s17 offen
    buffer_load_dword v53, v10, s[20:23], s17 offen
    buffer_load_dword v54, v12, s[20:23], s17 offen
    buffer_load_dword v55, v13, s[20:23], s17 offen
    s_waitcnt vmcnt(58)
    v_perm_b32 v5, v109, v108, s44
    v_perm_b32 v6, v109, v108, s45
    s_waitcnt vmcnt(56)
    v_perm_b32 v235, v111, v110, v11
    v_accvgpr_write_b32 a211, v5
    v_accvgpr_write_b32 a215, v6
    s_add_u32 s17, s49, 1108224
    buffer_load_dword v56, v9, s[20:23], s17 offen
    buffer_load_dword v57, v10, s[20:23], s17 offen
    buffer_load_dword v58, v12, s[20:23], s17 offen
    buffer_load_dword v59, v13, s[20:23], s17 offen
    s_waitcnt vmcnt(58)
    v_perm_b32 v5, v113, v112, s44
    v_perm_b32 v6, v113, v112, s45
    s_waitcnt vmcnt(56)
    v_perm_b32 v236, v115, v114, v11
    v_accvgpr_write_b32 a216, v5
    v_accvgpr_write_b32 a220, v6
    s_add_u32 s17, s49, 1109376
    buffer_load_dword v60, v9, s[20:23], s17 offen
    buffer_load_dword v61, v10, s[20:23], s17 offen
    buffer_load_dword v62, v12, s[20:23], s17 offen
    buffer_load_dword v63, v13, s[20:23], s17 offen
    s_waitcnt vmcnt(58)
    v_perm_b32 v5, v117, v116, s44
    v_perm_b32 v6, v117, v116, s45
    s_waitcnt vmcnt(56)
    v_perm_b32 v237, v119, v118, v11
    v_accvgpr_write_b32 a217, v5
    v_accvgpr_write_b32 a221, v6
    s_add_u32 s17, s49, 1142784
    buffer_load_dword v64, v9, s[20:23], s17 offen
    buffer_load_dword v65, v10, s[20:23], s17 offen
    buffer_load_dword v66, v12, s[20:23], s17 offen
    buffer_load_dword v67, v13, s[20:23], s17 offen
    s_waitcnt vmcnt(58)
    v_perm_b32 v5, v121, v120, s44
    v_perm_b32 v6, v121, v120, s45
    s_waitcnt vmcnt(56)
    v_perm_b32 v238, v123, v122, v11
    v_accvgpr_write_b32 a218, v5
    v_accvgpr_write_b32 a222, v6
    s_add_u32 s17, s49, 1143936
    buffer_load_dword v68, v9, s[20:23], s17 offen
    buffer_load_dword v69, v10, s[20:23], s17 offen
    buffer_load_dword v70, v12, s[20:23], s17 offen
    buffer_load_dword v71, v13, s[20:23], s17 offen
    s_waitcnt vmcnt(58)
    v_perm_b32 v5, v125, v124, s44
    v_perm_b32 v6, v125, v124, s45
    s_waitcnt vmcnt(56)
    v_perm_b32 v239, v127, v126, v11
    v_accvgpr_write_b32 a219, v5
    v_accvgpr_write_b32 a223, v6
    s_add_u32 s17, s49, 1145088
    buffer_load_dword v72, v9, s[20:23], s17 offen
    buffer_load_dword v73, v10, s[20:23], s17 offen
    buffer_load_dword v74, v12, s[20:23], s17 offen
    buffer_load_dword v75, v13, s[20:23], s17 offen
    s_waitcnt vmcnt(58)
    v_perm_b32 v5, v17, v16, s44
    v_perm_b32 v6, v17, v16, s45
    s_waitcnt vmcnt(56)
    v_perm_b32 v240, v19, v18, v11
    v_accvgpr_write_b32 a224, v5
    v_accvgpr_write_b32 a228, v6
    s_add_u32 s17, s49, 1146240
    buffer_load_dword v76, v9, s[20:23], s17 offen
    buffer_load_dword v77, v10, s[20:23], s17 offen
    buffer_load_dword v78, v12, s[20:23], s17 offen
    buffer_load_dword v79, v13, s[20:23], s17 offen
    s_waitcnt vmcnt(58)
    v_perm_b32 v5, v21, v20, s44
    v_perm_b32 v6, v21, v20, s45
    s_waitcnt vmcnt(56)
    v_perm_b32 v241, v23, v22, v11
    v_accvgpr_write_b32 a225, v5
    v_accvgpr_write_b32 a229, v6
    s_waitcnt vmcnt(54)
    v_perm_b32 v5, v25, v24, s44
    v_perm_b32 v6, v25, v24, s45
    s_waitcnt vmcnt(52)
    v_perm_b32 v242, v27, v26, v11
    v_accvgpr_write_b32 a226, v5
    v_accvgpr_write_b32 a230, v6
    s_waitcnt vmcnt(50)
    v_perm_b32 v5, v29, v28, s44
    v_perm_b32 v6, v29, v28, s45
    s_waitcnt vmcnt(48)
    v_perm_b32 v243, v31, v30, v11
    v_accvgpr_write_b32 a227, v5
    v_accvgpr_write_b32 a231, v6
    s_waitcnt vmcnt(46)
    v_perm_b32 v5, v33, v32, s44
    v_perm_b32 v6, v33, v32, s45
    s_waitcnt vmcnt(44)
    v_perm_b32 v244, v35, v34, v11
    v_accvgpr_write_b32 a232, v5
    v_accvgpr_write_b32 a236, v6
    s_waitcnt vmcnt(42)
    v_perm_b32 v5, v37, v36, s44
    v_perm_b32 v6, v37, v36, s45
    s_waitcnt vmcnt(40)
    v_perm_b32 v245, v39, v38, v11
    v_accvgpr_write_b32 a233, v5
    v_accvgpr_write_b32 a237, v6
    s_waitcnt vmcnt(38)
    v_perm_b32 v5, v41, v40, s44
    v_perm_b32 v6, v41, v40, s45
    s_waitcnt vmcnt(36)
    v_perm_b32 v246, v43, v42, v11
    v_accvgpr_write_b32 a234, v5
    v_accvgpr_write_b32 a238, v6
    s_waitcnt vmcnt(34)
    v_perm_b32 v5, v45, v44, s44
    v_perm_b32 v6, v45, v44, s45
    s_waitcnt vmcnt(32)
    v_perm_b32 v247, v47, v46, v11
    v_accvgpr_write_b32 a235, v5
    v_accvgpr_write_b32 a239, v6
    s_waitcnt vmcnt(30)
    v_perm_b32 v5, v49, v48, s44
    v_perm_b32 v6, v49, v48, s45
    s_waitcnt vmcnt(28)
    v_perm_b32 v248, v51, v50, v11
    v_accvgpr_write_b32 a240, v5
    v_accvgpr_write_b32 a244, v6
    s_waitcnt vmcnt(26)
    v_perm_b32 v5, v53, v52, s44
    v_perm_b32 v6, v53, v52, s45
    s_waitcnt vmcnt(24)
    v_perm_b32 v249, v55, v54, v11
    v_accvgpr_write_b32 a241, v5
    v_accvgpr_write_b32 a245, v6
    s_waitcnt vmcnt(22)
    v_perm_b32 v5, v57, v56, s44
    v_perm_b32 v6, v57, v56, s45
    s_waitcnt vmcnt(20)
    v_perm_b32 v250, v59, v58, v11
    v_accvgpr_write_b32 a242, v5
    v_accvgpr_write_b32 a246, v6
    s_waitcnt vmcnt(18)
    v_perm_b32 v5, v61, v60, s44
    v_perm_b32 v6, v61, v60, s45
    s_waitcnt vmcnt(16)
    v_perm_b32 v251, v63, v62, v11
    v_accvgpr_write_b32 a243, v5
    v_accvgpr_write_b32 a247, v6
    s_waitcnt vmcnt(14)
    v_perm_b32 v5, v65, v64, s44
    v_perm_b32 v6, v65, v64, s45
    s_waitcnt vmcnt(12)
    v_perm_b32 v252, v67, v66, v11
    v_accvgpr_write_b32 a248, v5
    v_accvgpr_write_b32 a252, v6
    s_waitcnt vmcnt(10)
    v_perm_b32 v5, v69, v68, s44
    v_perm_b32 v6, v69, v68, s45
    s_waitcnt vmcnt(8)
    v_perm_b32 v253, v71, v70, v11
    v_accvgpr_write_b32 a249, v5
    v_accvgpr_write_b32 a253, v6
    s_waitcnt vmcnt(6)
    v_perm_b32 v5, v73, v72, s44
    v_perm_b32 v6, v73, v72, s45
    s_waitcnt vmcnt(4)
    v_perm_b32 v254, v75, v74, v11
    v_accvgpr_write_b32 a250, v5
    v_accvgpr_write_b32 a254, v6
    s_waitcnt vmcnt(2)
    v_perm_b32 v5, v77, v76, s44
    v_perm_b32 v6, v77, v76, s45
    s_waitcnt vmcnt(0)
    v_perm_b32 v255, v79, v78, v11
    v_accvgpr_write_b32 a251, v5
    v_accvgpr_write_b32 a255, v6
    s_and_b32 s51, s14, 1
    s_lshl_b32 s17, s51, 4
    v_add_u32 v5, s17, v7
    v_lshlrev_b32 v14, 4, v5
    v_mul_u32_u24 v13, 1152, v5
    s_mul_i32 s17, s50, 96
    v_add_u32 v13, s17, v13
    s_mul_i32 s17, s50, 3072
    v_add_u32 v12, s17, v14
    s_lshl_b32 s17, s50, 9
    v_add_u32 v14, s17, v14
    s_lshl_b32 s49, s50, 7
    s_lshl_b32 s17, s14, 2
    s_add_u32 s49, s49, s17
    s_add_u32 s49, s49, 1441792
    s_mul_i32 s17, s14, 6144
    v_add_u32 v48, s17, v0
    v_mov_b32 v49, 0x10000
    s_mul_i32 s17, s50, 43
    v_lshrrev_b32 v10, 4, v0
    v_add_u32 v10, s17, v10
    v_min_u32 v10, 511, v10
    v_lshlrev_b32 v10, 7, v10
    s_cmp_gt_u32 s14, 1
    s_cbranch_scc1 Ltw_z
    v_lshl_add_u32 v12, v8, 9, v12
    v_lshl_add_u32 v13, v8, 4, v13
    s_lshl_b32 s58, s14, 16
    s_add_u32 s58, s58, 144703488
    s_mov_b32 s43, 0
    s_mov_b32 s28, s8
    s_mov_b32 s29, s9
    s_mov_b32 s30, 0
    s_mov_b32 s31, 0x00020000
    s_mul_i32 s17, s51, 3072
    v_add_u32 v50, s17, v0
    ds_write2_b32 v49, v4, v4 offset0:0 offset1:1
    s_waitcnt lgkmcnt(0)
    s_cmp_lg_u32 s14, 0
    s_cbranch_scc1 LtwX_inia_d
    v_mov_b32 v5, 40
    s_mov_b32 s16, 0
LtwX_inia:
    global_load_dword v6, v5, s[12:13] sc1
    s_add_u32 s16, s16, 1
    s_cmp_gt_u32 s16, 100000
    s_cbranch_scc1 L_role_tw_abort
    s_waitcnt vmcnt(0)
    v_cmp_gt_u32 vcc, 128, v6
    s_nop 0
    s_cbranch_vccz LtwX_inia_d
    s_sleep 8
    s_branch LtwX_inia
LtwX_inia_d:
    s_barrier
    s_cmp_lg_u32 s14, 0
    s_cbranch_scc1 LtwX_inib_d
    v_mov_b32 v5, 160
    s_mov_b32 s16, 0
LtwX_inib:
    global_load_dword v6, v5, s[12:13] sc1
    s_add_u32 s16, s16, 1
    s_cmp_gt_u32 s16, 100000
    s_cbranch_scc1 L_role_tw_abort
    s_waitcnt vmcnt(0)
    v_cmp_gt_u32 vcc, 64, v6
    s_nop 0
    s_cbranch_vccz LtwX_inib_d
    s_sleep 8
    s_branch LtwX_inib
LtwX_inib_d:
    s_barrier
LtwX_idle:
    s_cmp_lg_u32 s14, 0
    s_cbranch_scc1 LtwX_nw0
    s_mul_i32 s60, s32, 22528
    s_add_u32 s60, s60, 4224
    s_cmp_lt_u32 s32, 64
    s_cselect_b32 s60, s60, 2883584
    s_mul_i32 s61, s33, 22528
    s_add_u32 s61, s61, 1446016
    s_cmp_lt_u32 s33, 64
    s_cselect_b32 s61, s61, 2883584
    s_mov_b32 s16, 0
LtwX_p_9:
    buffer_load_dword v2, v1, s[8:11], s60 offen sc1
    buffer_load_dword v15, v1, s[8:11], s61 offen sc1
    s_add_u32 s16, s16, 1
    s_cmp_gt_u32 s16, 100000
    s_cbranch_scc1 L_role_tw_abort
    s_waitcnt vmcnt(1)
    v_cmp_eq_u32 vcc, 0, v2
    s_waitcnt vmcnt(0)
    v_cmp_eq_u32 s[54:55], 0, v15
    s_nop 0
    s_cmp_eq_u64 s[54:55], 0
    s_cselect_b32 s62, 2, 0
    s_cmp_eq_u64 vcc, 0
    s_cselect_b32 s62, 1, s62
    s_cmp_lg_u32 s62, 0
    s_cbranch_scc1 LtwX_p_9d
    s_sleep 4
    s_branch LtwX_p_9
LtwX_p_9d:
    v_mov_b32 v5, s62
    ds_write_b32 v49, v5
    s_waitcnt lgkmcnt(0)
LtwX_nw0:
    s_barrier
    ds_read_b32 v6, v49
    v_xor_b32 v49, 4, v49
    s_waitcnt lgkmcnt(0)
    v_readfirstlane_b32 s62, v6
    s_nop 0
    s_cmp_eq_u32 s62, 0
    s_cbranch_scc1 L_role_tw_abort
    s_cmp_lt_u32 s33, 29
    s_cselect_b32 s38, 1, 3
    s_cmp_eq_u32 s62, 2
    s_cselect_b32 s36, 1, 0
    s_cselect_b32 s37, s33, s32
    s_cselect_b32 s17, s38, 0
    s_add_u32 s33, s33, s17
    s_cmp_eq_u32 s62, 1
    s_cselect_b32 s17, 2, 0
    s_add_u32 s32, s32, s17
    s_lshl_b32 s56, s36, 6
    s_add_u32 s56, s56, s37
    s_lshl_b32 s46, s56, 18
    s_add_u32 s46, s46, s58
    s_mul_i32 s41, s36, 4718592
    s_mul_i32 s17, s37, 36864
    s_add_u32 s41, s41, s17
    s_add_u32 s41, s41, 8650752
    s_cmp_ge_u32 s37, 64
    s_cbranch_scc1 L_role_tw_abort
    s_add_u32 s48, s46, 0
    buffer_load_dwordx4 v[64:67], v0, s[8:11], s48 offen offset:0
    buffer_load_dwordx4 v[68:71], v0, s[8:11], s48 offen offset:1024
    buffer_load_dwordx4 v[72:75], v0, s[8:11], s48 offen offset:2048
    buffer_load_dwordx4 v[76:79], v0, s[8:11], s48 offen offset:3072
    s_add_u32 s48, s46, 4096
    buffer_load_dwordx4 v[80:83], v0, s[8:11], s48 offen offset:0
    buffer_load_dwordx4 v[84:87], v0, s[8:11], s48 offen offset:1024
    buffer_load_dwordx4 v[88:91], v0, s[8:11], s48 offen offset:2048
    buffer_load_dwordx4 v[92:95], v0, s[8:11], s48 offen offset:3072
    s_add_u32 s48, s46, 8192
    buffer_load_dwordx4 v[96:99], v0, s[8:11], s48 offen offset:0
    buffer_load_dwordx4 v[100:103], v0, s[8:11], s48 offen offset:1024
    buffer_load_dwordx4 v[104:107], v0, s[8:11], s48 offen offset:2048
    buffer_load_dwordx4 v[108:111], v0, s[8:11], s48 offen offset:3072
    s_add_u32 s48, s46, 12288
    buffer_load_dwordx4 v[112:115], v0, s[8:11], s48 offen offset:0
    buffer_load_dwordx4 v[116:119], v0, s[8:11], s48 offen offset:1024
    buffer_load_dwordx4 v[120:123], v0, s[8:11], s48 offen offset:2048
    buffer_load_dwordx4 v[40:43], v12, s[8:11], s41 offen
LtwX_item:
    s_mov_b32 s34, s36
    s_mov_b32 s35, s37
    s_mov_b32 s47, s41
    buffer_load_dwordx4 v[124:127], v0, s[8:11], s48 offen offset:3072
    s_waitcnt vmcnt(16)
    v_mfma_f32_16x16x32_bf16 v[16:19], a[0:3], v[64:67], 0
    v_mfma_f32_16x16x32_bf16 v[20:23], a[4:7], v[64:67], 0
    v_mfma_f32_16x16x32_bf16 v[24:27], v[128:131], v[64:67], 0
    s_add_u32 s48, s46, 16384
    buffer_load_dwordx4 v[64:67], v0, s[8:11], s48 offen offset:0
    s_waitcnt vmcnt(16)
    v_mfma_f32_16x16x32_bf16 v[28:31], a[0:3], v[68:71], 0
    v_mfma_f32_16x16x32_bf16 v[32:35], a[4:7], v[68:71], 0
    v_mfma_f32_16x16x32_bf16 v[36:39], v[128:131], v[68:71], 0
    buffer_load_dwordx4 v[68:71], v0, s[8:11], s48 offen offset:1024
    s_waitcnt vmcnt(16)
    v_mfma_f32_16x16x32_bf16 v[16:19], a[8:11], v[72:75], v[16:19]
    v_mfma_f32_16x16x32_bf16 v[20:23], a[12:15], v[72:75], v[20:23]
    v_mfma_f32_16x16x32_bf16 v[24:27], v[132:135], v[72:75], v[24:27]
    buffer_load_dwordx4 v[72:75], v0, s[8:11], s48 offen offset:2048
    s_waitcnt vmcnt(16)
    v_mfma_f32_16x16x32_bf16 v[28:31], a[8:11], v[76:79], v[28:31]
    v_mfma_f32_16x16x32_bf16 v[32:35], a[12:15], v[76:79], v[32:35]
    v_mfma_f32_16x16x32_bf16 v[36:39], v[132:135], v[76:79], v[36:39]
    buffer_load_dwordx4 v[76:79], v0, s[8:11], s48 offen offset:3072
    s_waitcnt vmcnt(16)
    v_mfma_f32_16x16x32_bf16 v[16:19], a[16:19], v[80:83], v[16:19]
    v_mfma_f32_16x16x32_bf16 v[20:23], a[20:23], v[80:83], v[20:23]
    v_mfma_f32_16x16x32_bf16 v[24:27], v[136:139], v[80:83], v[24:27]
    s_add_u32 s48, s46, 20480
    buffer_load_dwordx4 v[80:83], v0, s[8:11], s48 offen offset:0
    s_waitcnt vmcnt(16)
    v_mfma_f32_16x16x32_bf16 v[28:31], a[16:19], v[84:87], v[28:31]
    v_mfma_f32_16x16x32_bf16 v[32:35], a[20:23], v[84:87], v[32:35]
    v_mfma_f32_16x16x32_bf16 v[36:39], v[136:139], v[84:87], v[36:39]
    buffer_load_dwordx4 v[84:87], v0, s[8:11], s48 offen offset:1024
    s_waitcnt vmcnt(16)
    v_mfma_f32_16x16x32_bf16 v[16:19], a[24:27], v[88:91], v[16:19]
    v_mfma_f32_16x16x32_bf16 v[20:23], a[28:31], v[88:91], v[20:23]
    v_mfma_f32_16x16x32_bf16 v[24:27], v[140:143], v[88:91], v[24:27]
    buffer_load_dwordx4 v[88:91], v0, s[8:11], s48 offen offset:2048
    s_waitcnt vmcnt(16)
    v_mfma_f32_16x16x32_bf16 v[28:31], a[24:27], v[92:95], v[28:31]
    v_mfma_f32_16x16x32_bf16 v[32:35], a[28:31], v[92:95], v[32:35]
    v_mfma_f32_16x16x32_bf16 v[36:39], v[140:143], v[92:95], v[36:39]
    buffer_load_dwordx4 v[92:95], v0, s[8:11], s48 offen offset:3072
    s_waitcnt vmcnt(16)
    v_mfma_f32_16x16x32_bf16 v[16:19], a[32:35], v[96:99], v[16:19]
    v_mfma_f32_16x16x32_bf16 v[20:23], a[36:39], v[96:99], v[20:23]
    v_mfma_f32_16x16x32_bf16 v[24:27], v[144:147], v[96:99], v[24:27]
    s_add_u32 s48, s46, 24576
    buffer_load_dwordx4 v[96:99], v0, s[8:11], s48 offen offset:0
    s_waitcnt vmcnt(16)
    v_mfma_f32_16x16x32_bf16 v[28:31], a[32:35], v[100:103], v[28:31]
    v_mfma_f32_16x16x32_bf16 v[32:35], a[36:39], v[100:103], v[32:35]
    v_mfma_f32_16x16x32_bf16 v[36:39], v[144:147], v[100:103], v[36:39]
    buffer_load_dwordx4 v[100:103], v0, s[8:11], s48 offen offset:1024
    s_waitcnt vmcnt(16)
    v_mfma_f32_16x16x32_bf16 v[16:19], a[40:43], v[104:107], v[16:19]
    v_mfma_f32_16x16x32_bf16 v[20:23], a[44:47], v[104:107], v[20:23]
    v_mfma_f32_16x16x32_bf16 v[24:27], v[148:151], v[104:107], v[24:27]
    buffer_load_dwordx4 v[104:107], v0, s[8:11], s48 offen offset:2048
    s_waitcnt vmcnt(16)
    v_mfma_f32_16x16x32_bf16 v[28:31], a[40:43], v[108:111], v[28:31]
    v_mfma_f32_16x16x32_bf16 v[32:35], a[44:47], v[108:111], v[32:35]
    v_mfma_f32_16x16x32_bf16 v[36:39], v[148:151], v[108:111], v[36:39]
    buffer_load_dwordx4 v[108:111], v0, s[8:11], s48 offen offset:3072
    s_waitcnt vmcnt(16)
    v_mfma_f32_16x16x32_bf16 v[16:19], a[48:51], v[112:115], v[16:19]
    v_mfma_f32_16x16x32_bf16 v[20:23], a[52:55], v[112:115], v[20:23]
    v_mfma_f32_16x16x32_bf16 v[24:27], v[152:155], v[112:115], v[24:27]
    s_add_u32 s48, s46, 28672
    buffer_load_dwordx4 v[112:115], v0, s[8:11], s48 offen offset:0
    s_waitcnt vmcnt(16)
    v_mfma_f32_16x16x32_bf16 v[28:31], a[48:51], v[116:119], v[28:31]
    v_mfma_f32_16x16x32_bf16 v[32:35], a[52:55], v[116:119], v[32:35]
    v_mfma_f32_16x16x32_bf16 v[36:39], v[152:155], v[116:119], v[36:39]
    buffer_load_dwordx4 v[116:119], v0, s[8:11], s48 offen offset:1024
    s_waitcnt vmcnt(16)
    v_mfma_f32_16x16x32_bf16 v[16:19], a[56:59], v[120:123], v[16:19]
    v_mfma_f32_16x16x32_bf16 v[20:23], a[60:63], v[120:123], v[20:23]
    v_mfma_f32_16x16x32_bf16 v[24:27], v[156:159], v[120:123], v[24:27]
    buffer_load_dwordx4 v[120:123], v0, s[8:11], s48 offen offset:2048
    s_waitcnt vmcnt(15)
    v_mfma_f32_16x16x32_bf16 v[28:31], a[56:59], v[124:127], v[28:31]
    v_mfma_f32_16x16x32_bf16 v[32:35], a[60:63], v[124:127], v[32:35]
    v_mfma_f32_16x16x32_bf16 v[36:39], v[156:159], v[124:127], v[36:39]
    buffer_load_dwordx4 v[124:127], v0, s[8:11], s48 offen offset:3072
    s_waitcnt vmcnt(15)
    v_mfma_f32_16x16x32_bf16 v[16:19], a[64:67], v[64:67], v[16:19]
    v_mfma_f32_16x16x32_bf16 v[20:23], a[68:71], v[64:67], v[20:23]
    v_mfma_f32_16x16x32_bf16 v[24:27], v[160:163], v[64:67], v[24:27]
    s_add_u32 s48, s46, 32768
    buffer_load_dwordx4 v[64:67], v0, s[8:11], s48 offen offset:0
    s_waitcnt vmcnt(15)
    v_mfma_f32_16x16x32_bf16 v[28:31], a[64:67], v[68:71], v[28:31]
    v_mfma_f32_16x16x32_bf16 v[32:35], a[68:71], v[68:71], v[32:35]
    v_mfma_f32_16x16x32_bf16 v[36:39], v[160:163], v[68:71], v[36:39]
    s_cmp_lg_u32 s43, 0
    s_cselect_b64 exec, 1, 0
    buffer_store_dword v3, v4, s[8:11], s43 offen sc1
    s_mov_b64 exec, -1
    s_mov_b32 s43, 0
    buffer_load_dwordx4 v[68:71], v0, s[8:11], s48 offen offset:1024
    s_waitcnt vmcnt(16)
    v_mfma_f32_16x16x32_bf16 v[16:19], a[72:75], v[72:75], v[16:19]
    v_mfma_f32_16x16x32_bf16 v[20:23], a[76:79], v[72:75], v[20:23]
    v_mfma_f32_16x16x32_bf16 v[24:27], v[164:167], v[72:75], v[24:27]
    buffer_load_dwordx4 v[72:75], v0, s[8:11], s48 offen offset:2048
    s_waitcnt vmcnt(16)
    v_mfma_f32_16x16x32_bf16 v[28:31], a[72:75], v[76:79], v[28:31]
    v_mfma_f32_16x16x32_bf16 v[32:35], a[76:79], v[76:79], v[32:35]
    v_mfma_f32_16x16x32_bf16 v[36:39], v[164:167], v[76:79], v[36:39]
    buffer_load_dwordx4 v[76:79], v0, s[8:11], s48 offen offset:3072
    s_waitcnt vmcnt(16)
    v_mfma_f32_16x16x32_bf16 v[16:19], a[80:83], v[80:83], v[16:19]
    v_mfma_f32_16x16x32_bf16 v[20:23], a[84:87], v[80:83], v[20:23]
    v_mfma_f32_16x16x32_bf16 v[24:27], v[168:171], v[80:83], v[24:27]
    s_add_u32 s48, s46, 36864
    buffer_load_dwordx4 v[80:83], v0, s[8:11], s48 offen offset:0
    s_waitcnt vmcnt(16)
    v_mfma_f32_16x16x32_bf16 v[28:31], a[80:83], v[84:87], v[28:31]
    v_mfma_f32_16x16x32_bf16 v[32:35], a[84:87], v[84:87], v[32:35]
    v_mfma_f32_16x16x32_bf16 v[36:39], v[168:171], v[84:87], v[36:39]
    buffer_load_dwordx4 v[84:87], v0, s[8:11], s48 offen offset:1024
    s_waitcnt vmcnt(16)
    v_mfma_f32_16x16x32_bf16 v[16:19], a[88:91], v[88:91], v[16:19]
    v_mfma_f32_16x16x32_bf16 v[20:23], a[92:95], v[88:91], v[20:23]
    v_mfma_f32_16x16x32_bf16 v[24:27], v[172:175], v[88:91], v[24:27]
    buffer_load_dwordx4 v[88:91], v0, s[8:11], s48 offen offset:2048
    s_waitcnt vmcnt(16)
    v_mfma_f32_16x16x32_bf16 v[28:31], a[88:91], v[92:95], v[28:31]
    v_mfma_f32_16x16x32_bf16 v[32:35], a[92:95], v[92:95], v[32:35]
    v_mfma_f32_16x16x32_bf16 v[36:39], v[172:175], v[92:95], v[36:39]
    buffer_load_dwordx4 v[92:95], v0, s[8:11], s48 offen offset:3072
    s_waitcnt vmcnt(16)
    v_mfma_f32_16x16x32_bf16 v[16:19], a[96:99], v[96:99], v[16:19]
    v_mfma_f32_16x16x32_bf16 v[20:23], a[100:103], v[96:99], v[20:23]
    v_mfma_f32_16x16x32_bf16 v[24:27], v[176:179], v[96:99], v[24:27]
    s_add_u32 s48, s46, 40960
    buffer_load_dwordx4 v[96:99], v0, s[8:11], s48 offen offset:0
    s_waitcnt vmcnt(16)
    v_mfma_f32_16x16x32_bf16 v[28:31], a[96:99], v[100:103], v[28:31]
    v_mfma_f32_16x16x32_bf16 v[32:35], a[100:103], v[100:103], v[32:35]
    v_mfma_f32_16x16x32_bf16 v[36:39], v[176:179], v[100:103], v[36:39]
    buffer_load_dwordx4 v[100:103], v0, s[8:11], s48 offen offset:1024
    s_waitcnt vmcnt(16)
    v_mfma_f32_16x16x32_bf16 v[16:19], a[104:107], v[104:107], v[16:19]
    v_mfma_f32_16x16x32_bf16 v[20:23], a[108:111], v[104:107], v[20:23]
    v_mfma_f32_16x16x32_bf16 v[24:27], v[180:183], v[104:107], v[24:27]
    s_cmp_lg_u32 s14, 0
    s_cbranch_scc1 LtwX_nw1
    s_mul_i32 s60, s32, 22528
    s_add_u32 s60, s60, 4224
    s_cmp_lt_u32 s32, 64
    s_cselect_b32 s60, s60, 2883584
    s_mul_i32 s61, s33, 22528
    s_add_u32 s61, s61, 1446016
    s_cmp_lt_u32 s33, 64
    s_cselect_b32 s61, s61, 2883584
    buffer_load_dword v2, v1, s[8:11], s60 offen sc1
    buffer_load_dword v15, v1, s[8:11], s61 offen sc1
LtwX_nw1:
    buffer_load_dwordx4 v[104:107], v0, s[8:11], s48 offen offset:2048
    s_waitcnt vmcnt(16)
    v_mfma_f32_16x16x32_bf16 v[28:31], a[104:107], v[108:111], v[28:31]
    v_mfma_f32_16x16x32_bf16 v[32:35], a[108:111], v[108:111], v[32:35]
    v_mfma_f32_16x16x32_bf16 v[36:39], v[180:183], v[108:111], v[36:39]
    buffer_load_dwordx4 v[108:111], v0, s[8:11], s48 offen offset:3072
    s_waitcnt vmcnt(16)
    v_mfma_f32_16x16x32_bf16 v[16:19], a[112:115], v[112:115], v[16:19]
    v_mfma_f32_16x16x32_bf16 v[20:23], a[116:119], v[112:115], v[20:23]
    v_mfma_f32_16x16x32_bf16 v[24:27], v[184:187], v[112:115], v[24:27]
    s_add_u32 s48, s46, 45056
    buffer_load_dwordx4 v[112:115], v0, s[8:11], s48 offen offset:0
    s_waitcnt vmcnt(16)
    v_mfma_f32_16x16x32_bf16 v[28:31], a[112:115], v[116:119], v[28:31]
    v_mfma_f32_16x16x32_bf16 v[32:35], a[116:119], v[116:119], v[32:35]
    v_mfma_f32_16x16x32_bf16 v[36:39], v[184:187], v[116:119], v[36:39]
    buffer_load_dwordx4 v[116:119], v0, s[8:11], s48 offen offset:1024
    s_waitcnt vmcnt(16)
    v_mfma_f32_16x16x32_bf16 v[16:19], a[120:123], v[120:123], v[16:19]
    v_mfma_f32_16x16x32_bf16 v[20:23], a[124:127], v[120:123], v[20:23]
    v_mfma_f32_16x16x32_bf16 v[24:27], v[188:191], v[120:123], v[24:27]
    buffer_load_dwordx4 v[120:123], v0, s[8:11], s48 offen offset:2048
    s_waitcnt vmcnt(16)
    v_mfma_f32_16x16x32_bf16 v[28:31], a[120:123], v[124:127], v[28:31]
    v_mfma_f32_16x16x32_bf16 v[32:35], a[124:127], v[124:127], v[32:35]
    v_mfma_f32_16x16x32_bf16 v[36:39], v[188:191], v[124:127], v[36:39]
    buffer_load_dwordx4 v[124:127], v0, s[8:11], s48 offen offset:3072
    s_waitcnt vmcnt(16)
    v_mfma_f32_16x16x32_bf16 v[16:19], a[128:131], v[64:67], v[16:19]
    v_mfma_f32_16x16x32_bf16 v[20:23], a[132:135], v[64:67], v[20:23]
    v_mfma_f32_16x16x32_bf16 v[24:27], v[192:195], v[64:67], v[24:27]
    s_add_u32 s48, s46, 49152
    buffer_load_dwordx4 v[64:67], v0, s[8:11], s48 offen offset:0
    s_waitcnt vmcnt(15)
    v_mfma_f32_16x16x32_bf16 v[28:31], a[128:131], v[68:71], v[28:31]
    v_mfma_f32_16x16x32_bf16 v[32:35], a[132:135], v[68:71], v[32:35]
    v_mfma_f32_16x16x32_bf16 v[36:39], v[192:195], v[68:71], v[36:39]
    buffer_load_dwordx4 v[68:71], v0, s[8:11], s48 offen offset:1024
    s_waitcnt vmcnt(15)
    v_mfma_f32_16x16x32_bf16 v[16:19], a[136:139], v[72:75], v[16:19]
    v_mfma_f32_16x16x32_bf16 v[20:23], a[140:143], v[72:75], v[20:23]
    v_mfma_f32_16x16x32_bf16 v[24:27], v[196:199], v[72:75], v[24:27]
    buffer_load_dwordx4 v[72:75], v0, s[8:11], s48 offen offset:2048
    s_waitcnt vmcnt(15)
    v_mfma_f32_16x16x32_bf16 v[28:31], a[136:139], v[76:79], v[28:31]
    v_mfma_f32_16x16x32_bf16 v[32:35], a[140:143], v[76:79], v[32:35]
    v_mfma_f32_16x16x32_bf16 v[36:39], v[196:199], v[76:79], v[36:39]
    buffer_load_dwordx4 v[76:79], v0, s[8:11], s48 offen offset:3072
    s_waitcnt vmcnt(15)
    v_mfma_f32_16x16x32_bf16 v[16:19], a[144:147], v[80:83], v[16:19]
    v_mfma_f32_16x16x32_bf16 v[20:23], a[148:151], v[80:83], v[20:23]
    v_mfma_f32_16x16x32_bf16 v[24:27], v[200:203], v[80:83], v[24:27]
    s_add_u32 s48, s46, 53248
    buffer_load_dwordx4 v[80:83], v0, s[8:11], s48 offen offset:0
    s_waitcnt vmcnt(15)
    v_mfma_f32_16x16x32_bf16 v[28:31], a[144:147], v[84:87], v[28:31]
    v_mfma_f32_16x16x32_bf16 v[32:35], a[148:151], v[84:87], v[32:35]
    v_mfma_f32_16x16x32_bf16 v[36:39], v[200:203], v[84:87], v[36:39]
    buffer_load_dwordx4 v[84:87], v0, s[8:11], s48 offen offset:1024
    s_waitcnt vmcnt(15)
    v_mfma_f32_16x16x32_bf16 v[16:19], a[152:155], v[88:91], v[16:19]
    v_mfma_f32_16x16x32_bf16 v[20:23], a[156:159], v[88:91], v[20:23]
    v_mfma_f32_16x16x32_bf16 v[24:27], v[204:207], v[88:91], v[24:27]
    buffer_load_dwordx4 v[88:91], v0, s[8:11], s48 offen offset:2048
    s_waitcnt vmcnt(15)
    v_mfma_f32_16x16x32_bf16 v[28:31], a[152:155], v[92:95], v[28:31]
    v_mfma_f32_16x16x32_bf16 v[32:35], a[156:159], v[92:95], v[32:35]
    v_mfma_f32_16x16x32_bf16 v[36:39], v[204:207], v[92:95], v[36:39]
    buffer_load_dwordx4 v[92:95], v0, s[8:11], s48 offen offset:3072
    s_waitcnt vmcnt(15)
    v_mfma_f32_16x16x32_bf16 v[16:19], a[160:163], v[96:99], v[16:19]
    v_mfma_f32_16x16x32_bf16 v[20:23], a[164:167], v[96:99], v[20:23]
    v_mfma_f32_16x16x32_bf16 v[24:27], v[208:211], v[96:99], v[24:27]
    s_add_u32 s48, s46, 57344
    buffer_load_dwordx4 v[96:99], v0, s[8:11], s48 offen offset:0
    s_waitcnt vmcnt(15)
    v_mfma_f32_16x16x32_bf16 v[28:31], a[160:163], v[100:103], v[28:31]
    v_mfma_f32_16x16x32_bf16 v[32:35], a[164:167], v[100:103], v[32:35]
    v_mfma_f32_16x16x32_bf16 v[36:39], v[208:211], v[100:103], v[36:39]
    buffer_load_dwordx4 v[100:103], v0, s[8:11], s48 offen offset:1024
    s_waitcnt vmcnt(15)
    v_mfma_f32_16x16x32_bf16 v[16:19], a[168:171], v[104:107], v[16:19]
    v_mfma_f32_16x16x32_bf16 v[20:23], a[172:175], v[104:107], v[20:23]
    v_mfma_f32_16x16x32_bf16 v[24:27], v[212:215], v[104:107], v[24:27]
    buffer_load_dwordx4 v[104:107], v0, s[8:11], s48 offen offset:2048
    s_waitcnt vmcnt(15)
    v_mfma_f32_16x16x32_bf16 v[28:31], a[168:171], v[108:111], v[28:31]
    v_mfma_f32_16x16x32_bf16 v[32:35], a[172:175], v[108:111], v[32:35]
    v_mfma_f32_16x16x32_bf16 v[36:39], v[212:215], v[108:111], v[36:39]
    buffer_load_dwordx4 v[108:111], v0, s[8:11], s48 offen offset:3072
    s_waitcnt vmcnt(15)
    v_mfma_f32_16x16x32_bf16 v[16:19], a[176:179], v[112:115], v[16:19]
    v_mfma_f32_16x16x32_bf16 v[20:23], a[180:183], v[112:115], v[20:23]
    v_mfma_f32_16x16x32_bf16 v[24:27], v[216:219], v[112:115], v[24:27]
    s_cmp_lg_u32 s14, 0
    s_cbranch_scc1 LtwX_nw2
    v_cmp_eq_u32 vcc, 0, v2
    v_cmp_eq_u32 s[54:55], 0, v15
    s_nop 0
    s_cmp_eq_u64 s[54:55], 0
    s_cselect_b32 s62, 2, 0
    s_cmp_eq_u64 vcc, 0
    s_cselect_b32 s62, 1, s62
    v_mov_b32 v5, s62
    ds_write_b32 v49, v5
    s_waitcnt lgkmcnt(0)
LtwX_nw2:
    s_barrier
    ds_read_b32 v6, v49
    v_xor_b32 v49, 4, v49
    s_add_u32 s48, s46, 61440
    buffer_load_dwordx4 v[112:115], v0, s[8:11], s48 offen offset:0
    s_waitcnt vmcnt(15)
    v_mfma_f32_16x16x32_bf16 v[28:31], a[176:179], v[116:119], v[28:31]
    v_mfma_f32_16x16x32_bf16 v[32:35], a[180:183], v[116:119], v[32:35]
    v_mfma_f32_16x16x32_bf16 v[36:39], v[216:219], v[116:119], v[36:39]
    buffer_load_dwordx4 v[116:119], v0, s[8:11], s48 offen offset:1024
    s_waitcnt vmcnt(15)
    v_mfma_f32_16x16x32_bf16 v[16:19], a[184:187], v[120:123], v[16:19]
    v_mfma_f32_16x16x32_bf16 v[20:23], a[188:191], v[120:123], v[20:23]
    v_mfma_f32_16x16x32_bf16 v[24:27], v[220:223], v[120:123], v[24:27]
    buffer_load_dwordx4 v[120:123], v0, s[8:11], s48 offen offset:2048
    s_waitcnt vmcnt(15)
    v_mfma_f32_16x16x32_bf16 v[28:31], a[184:187], v[124:127], v[28:31]
    v_mfma_f32_16x16x32_bf16 v[32:35], a[188:191], v[124:127], v[32:35]
    v_mfma_f32_16x16x32_bf16 v[36:39], v[220:223], v[124:127], v[36:39]
    s_waitcnt lgkmcnt(0)
    v_readfirstlane_b32 s62, v6
    s_cmp_lt_u32 s33, 29
    s_cselect_b32 s38, 1, 3
    s_cmp_eq_u32 s62, 2
    s_cselect_b32 s36, 1, 0
    s_cselect_b32 s37, s33, s32
    s_cselect_b32 s17, s38, 0
    s_add_u32 s33, s33, s17
    s_cmp_eq_u32 s62, 1
    s_cselect_b32 s17, 2, 0
    s_add_u32 s32, s32, s17
    s_lshl_b32 s56, s36, 6
    s_add_u32 s56, s56, s37
    buffer_load_dwordx4 v[124:127], v0, s[8:11], s48 offen offset:3072
    s_waitcnt vmcnt(15)
    v_mfma_f32_16x16x32_bf16 v[16:19], a[192:195], v[64:67], v[16:19]
    v_mfma_f32_16x16x32_bf16 v[20:23], a[196:199], v[64:67], v[20:23]
    v_mfma_f32_16x16x32_bf16 v[24:27], v[224:227], v[64:67], v[24:27]
    s_cmp_lt_u32 s37, 64
    s_cselect_b32 s62, s62, 0
    s_lshl_b32 s46, s56, 18
    s_add_u32 s46, s46, s58
    s_mul_i32 s41, s36, 4718592
    s_mul_i32 s17, s37, 36864
    s_add_u32 s41, s41, s17
    s_add_u32 s41, s41, 8650752
    s_cmp_lg_u32 s62, 0
    s_cselect_b32 s30, 268435456, 0
    s_add_u32 s48, s46, 0
    buffer_load_dwordx4 v[64:67], v0, s[28:31], s48 offen offset:0
    s_waitcnt vmcnt(15)
    v_mfma_f32_16x16x32_bf16 v[28:31], a[192:195], v[68:71], v[28:31]
    v_mfma_f32_16x16x32_bf16 v[32:35], a[196:199], v[68:71], v[32:35]
    v_mfma_f32_16x16x32_bf16 v[36:39], v[224:227], v[68:71], v[36:39]
    buffer_load_dwordx4 v[68:71], v0, s[28:31], s48 offen offset:1024
    s_waitcnt vmcnt(15)
    v_mfma_f32_16x16x32_bf16 v[16:19], a[200:203], v[72:75], v[16:19]
    v_mfma_f32_16x16x32_bf16 v[20:23], a[204:207], v[72:75], v[20:23]
    v_mfma_f32_16x16x32_bf16 v[24:27], v[228:231], v[72:75], v[24:27]
    buffer_load_dwordx4 v[72:75], v0, s[28:31], s48 offen offset:2048
    s_waitcnt vmcnt(15)
    v_mfma_f32_16x16x32_bf16 v[28:31], a[200:203], v[76:79], v[28:31]
    v_mfma_f32_16x16x32_bf16 v[32:35], a[204:207], v[76:79], v[32:35]
    v_mfma_f32_16x16x32_bf16 v[36:39], v[228:231], v[76:79], v[36:39]
    buffer_load_dwordx4 v[76:79], v0, s[28:31], s48 offen offset:3072
    s_waitcnt vmcnt(15)
    v_mfma_f32_16x16x32_bf16 v[16:19], a[208:211], v[80:83], v[16:19]
    v_mfma_f32_16x16x32_bf16 v[20:23], a[212:215], v[80:83], v[20:23]
    v_mfma_f32_16x16x32_bf16 v[24:27], v[232:235], v[80:83], v[24:27]
    s_add_u32 s48, s46, 4096
    buffer_load_dwordx4 v[80:83], v0, s[28:31], s48 offen offset:0
    s_waitcnt vmcnt(15)
    v_mfma_f32_16x16x32_bf16 v[28:31], a[208:211], v[84:87], v[28:31]
    v_mfma_f32_16x16x32_bf16 v[32:35], a[212:215], v[84:87], v[32:35]
    v_mfma_f32_16x16x32_bf16 v[36:39], v[232:235], v[84:87], v[36:39]
    buffer_load_dwordx4 v[84:87], v0, s[28:31], s48 offen offset:1024
    s_waitcnt vmcnt(15)
    v_mfma_f32_16x16x32_bf16 v[16:19], a[216:219], v[88:91], v[16:19]
    v_mfma_f32_16x16x32_bf16 v[20:23], a[220:223], v[88:91], v[20:23]
    v_mfma_f32_16x16x32_bf16 v[24:27], v[236:239], v[88:91], v[24:27]
    buffer_load_dwordx4 v[88:91], v0, s[28:31], s48 offen offset:2048
    s_waitcnt vmcnt(15)
    v_mfma_f32_16x16x32_bf16 v[28:31], a[216:219], v[92:95], v[28:31]
    v_mfma_f32_16x16x32_bf16 v[32:35], a[220:223], v[92:95], v[32:35]
    v_mfma_f32_16x16x32_bf16 v[36:39], v[236:239], v[92:95], v[36:39]
    buffer_load_dwordx4 v[92:95], v0, s[28:31], s48 offen offset:3072
    s_waitcnt vmcnt(15)
    v_mfma_f32_16x16x32_bf16 v[16:19], a[224:227], v[96:99], v[16:19]
    v_mfma_f32_16x16x32_bf16 v[20:23], a[228:231], v[96:99], v[20:23]
    v_mfma_f32_16x16x32_bf16 v[24:27], v[240:243], v[96:99], v[24:27]
    s_add_u32 s48, s46, 8192
    buffer_load_dwordx4 v[96:99], v0, s[28:31], s48 offen offset:0
    s_waitcnt vmcnt(15)
    v_mfma_f32_16x16x32_bf16 v[28:31], a[224:227], v[100:103], v[28:31]
    v_mfma_f32_16x16x32_bf16 v[32:35], a[228:231], v[100:103], v[32:35]
    v_mfma_f32_16x16x32_bf16 v[36:39], v[240:243], v[100:103], v[36:39]
    buffer_load_dwordx4 v[100:103], v0, s[28:31], s48 offen offset:1024
    s_waitcnt vmcnt(15)
    v_mfma_f32_16x16x32_bf16 v[16:19], a[232:235], v[104:107], v[16:19]
    v_mfma_f32_16x16x32_bf16 v[20:23], a[236:239], v[104:107], v[20:23]
    v_mfma_f32_16x16x32_bf16 v[24:27], v[244:247], v[104:107], v[24:27]
    buffer_load_dwordx4 v[104:107], v0, s[28:31], s48 offen offset:2048
    s_waitcnt vmcnt(15)
    v_mfma_f32_16x16x32_bf16 v[28:31], a[232:235], v[108:111], v[28:31]
    v_mfma_f32_16x16x32_bf16 v[32:35], a[236:239], v[108:111], v[32:35]
    v_mfma_f32_16x16x32_bf16 v[36:39], v[244:247], v[108:111], v[36:39]
    buffer_load_dwordx4 v[108:111], v0, s[28:31], s48 offen offset:3072
    s_waitcnt vmcnt(15)
    v_mfma_f32_16x16x32_bf16 v[16:19], a[240:243], v[112:115], v[16:19]
    v_mfma_f32_16x16x32_bf16 v[20:23], a[244:247], v[112:115], v[20:23]
    v_mfma_f32_16x16x32_bf16 v[24:27], v[248:251], v[112:115], v[24:27]
    s_add_u32 s48, s46, 12288
    buffer_load_dwordx4 v[112:115], v0, s[28:31], s48 offen offset:0
    s_waitcnt vmcnt(15)
    v_mfma_f32_16x16x32_bf16 v[28:31], a[240:243], v[116:119], v[28:31]
    v_mfma_f32_16x16x32_bf16 v[32:35], a[244:247], v[116:119], v[32:35]
    v_mfma_f32_16x16x32_bf16 v[36:39], v[248:251], v[116:119], v[36:39]
    buffer_load_dwordx4 v[116:119], v0, s[28:31], s48 offen offset:1024
    s_waitcnt vmcnt(15)
    v_mfma_f32_16x16x32_bf16 v[16:19], a[248:251], v[120:123], v[16:19]
    v_mfma_f32_16x16x32_bf16 v[20:23], a[252:255], v[120:123], v[20:23]
    v_mfma_f32_16x16x32_bf16 v[24:27], v[252:255], v[120:123], v[24:27]
    buffer_load_dwordx4 v[120:123], v0, s[28:31], s48 offen offset:2048
    s_waitcnt vmcnt(15)
    v_mfma_f32_16x16x32_bf16 v[28:31], a[248:251], v[124:127], v[28:31]
    v_mfma_f32_16x16x32_bf16 v[32:35], a[252:255], v[124:127], v[32:35]
    v_mfma_f32_16x16x32_bf16 v[36:39], v[252:255], v[124:127], v[36:39]
    s_nop 5
    ds_write_b128 v48, v[16:19] offset:0
    ds_write_b128 v48, v[20:23] offset:1024
    ds_write_b128 v48, v[24:27] offset:2048
    ds_write_b128 v48, v[28:31] offset:3072
    ds_write_b128 v48, v[32:35] offset:4096
    ds_write_b128 v48, v[36:39] offset:5120
    s_waitcnt lgkmcnt(0)
    s_barrier
    ds_read_b128 v[24:27], v50 offset:0
    ds_read_b128 v[28:31], v50 offset:1024
    ds_read_b128 v[32:35], v50 offset:6144
    ds_read_b128 v[36:39], v50 offset:7168
    ds_read_b128 v[56:59], v50 offset:12288
    ds_read_b128 v[60:63], v50 offset:13312
    ds_read_b128 v[124:127], v50 offset:18432
    ds_read_b128 v[52:55], v50 offset:19456
    v_xor_b32 v48, 0x8000, v48
    v_xor_b32 v50, 0x8000, v50
    v_lshlrev_b32 v16, 16, v40
    v_and_b32 v20, 0xffff0000, v40
    v_lshlrev_b32 v17, 16, v41
    v_and_b32 v21, 0xffff0000, v41
    v_lshlrev_b32 v18, 16, v42
    v_and_b32 v22, 0xffff0000, v42
    v_lshlrev_b32 v19, 16, v43
    v_and_b32 v23, 0xffff0000, v43
    buffer_load_dwordx4 v[40:43], v12, s[28:31], s41 offen
    s_waitcnt lgkmcnt(7)
    v_add_f32 v16, v16, v24
    v_add_f32 v17, v17, v25
    v_add_f32 v18, v18, v26
    v_add_f32 v19, v19, v27
    s_waitcnt lgkmcnt(6)
    v_add_f32 v20, v20, v28
    v_add_f32 v21, v21, v29
    v_add_f32 v22, v22, v30
    v_add_f32 v23, v23, v31
    s_waitcnt lgkmcnt(5)
    v_add_f32 v16, v16, v32
    v_add_f32 v17, v17, v33
    v_add_f32 v18, v18, v34
    v_add_f32 v19, v19, v35
    s_waitcnt lgkmcnt(4)
    v_add_f32 v20, v20, v36
    v_add_f32 v21, v21, v37
    v_add_f32 v22, v22, v38
    v_add_f32 v23, v23, v39
    s_waitcnt lgkmcnt(3)
    v_add_f32 v16, v16, v56
    v_add_f32 v17, v17, v57
    v_add_f32 v18, v18, v58
    v_add_f32 v19, v19, v59
    s_waitcnt lgkmcnt(2)
    v_add_f32 v20, v20, v60
    v_add_f32 v21, v21, v61
    v_add_f32 v22, v22, v62
    v_add_f32 v23, v23, v63
    s_waitcnt lgkmcnt(1)
    v_add_f32 v16, v16, v124
    v_add_f32 v17, v17, v125
    v_add_f32 v18, v18, v126
    v_add_f32 v19, v19, v127
    s_waitcnt lgkmcnt(0)
    v_add_f32 v20, v20, v52
    v_add_f32 v21, v21, v53
    v_add_f32 v22, v22, v54
    v_add_f32 v23, v23, v55
    v_cvt_pk_bf16_f32 v52, v16, v20
    v_cvt_pk_bf16_f32 v53, v17, v21
    v_cvt_pk_bf16_f32 v54, v18, v22
    v_cvt_pk_bf16_f32 v55, v19, v23
    s_cmp_eq_u32 s34, 0
    s_cbranch_scc1 LtwX_l0
    s_mul_i32 s17, s35, 36864
    buffer_store_dwordx4 v[52:55], v13, s[24:27], s17 offen sc1
    s_cmp_lg_u32 s62, 0
    s_cbranch_scc1 LtwX_item
LtwX_chk:
    s_min_u32 s17, s32, s33
    s_cmp_lt_u32 s17, 64
    s_cbranch_scc1 LtwX_idle
    s_branch L_role_tw_exit
LtwX_l0:
    s_add_u32 s47, s47, 2359296
    buffer_store_dwordx4 v[52:55], v12, s[8:11], s47 offen sc1
    v_add_f32 v44, v16, v17
    v_mul_f32 v45, v16, v16
    v_fmac_f32 v45, v17, v17
    v_add_f32 v44, v44, v18
    v_fmac_f32 v45, v18, v18
    v_add_f32 v44, v44, v19
    v_fmac_f32 v45, v19, v19
    v_add_f32 v44, v44, v20
    v_fmac_f32 v45, v20, v20
    v_add_f32 v44, v44, v21
    v_fmac_f32 v45, v21, v21
    v_add_f32 v44, v44, v22
    v_fmac_f32 v45, v22, v22
    v_add_f32 v44, v44, v23
    v_fmac_f32 v45, v23, v23
    v_mov_b32 v46, v44
    v_mov_b32 v47, v45
    s_nop 0
    v_permlane32_swap_b32 v44, v46
    v_permlane32_swap_b32 v45, v47
    v_add_f32 v44, v44, v46
    v_add_f32 v45, v45, v47
    v_mov_b32 v46, v44
    v_mov_b32 v47, v45
    s_nop 0
    v_permlane16_swap_b32 v44, v46
    v_permlane16_swap_b32 v45, v47
    v_add_f32 v44, v44, v46
    v_add_f32 v45, v45, v47
    s_mul_i32 s17, s35, 6144
    s_add_u32 s17, s17, 16515072
    s_mov_b64 exec, 0xffff
    buffer_store_dwordx2 v[44:45], v14, s[8:11], s17 offen sc1
    s_mov_b64 exec, -1
    s_mul_i32 s43, s35, 22528
    s_add_u32 s43, s43, s49
    s_cmp_lg_u32 s62, 0
    s_cbranch_scc1 LtwX_item
    s_waitcnt vmcnt(0)
    s_mov_b64 exec, 1
    buffer_store_dword v3, v4, s[8:11], s43 offen sc1
    s_mov_b64 exec, -1
    s_mov_b32 s43, 0
    s_branch LtwX_chk
Ltw_z:
    v_lshrrev_b32 v5, 1, v8
    v_lshl_add_u32 v12, v5, 9, v12
    v_and_b32 v5, 1, v8
    v_lshl_add_u32 v12, v5, 3, v12
    v_add_u32 v12, 2048, v12
    v_lshl_add_u32 v13, v8, 3, v13
    v_add_u32 v13, 64, v13
    v_add_u32 v14, 8, v14
    s_lshl_b32 s58, s14, 16
    s_add_u32 s58, s58, 144703488
    s_mov_b32 s43, 0
    s_mov_b32 s28, s8
    s_mov_b32 s29, s9
    s_mov_b32 s30, 0
    s_mov_b32 s31, 0x00020000
    s_mul_i32 s17, s51, 3072
    v_add_u32 v50, s17, v0
    ds_write2_b32 v49, v4, v4 offset0:0 offset1:1
    s_waitcnt lgkmcnt(0)
    s_cmp_lg_u32 s14, 0
    s_cbranch_scc1 LtwZ_inia_d
    v_mov_b32 v5, 40
    s_mov_b32 s16, 0
LtwZ_inia:
    global_load_dword v6, v5, s[12:13] sc1
    s_add_u32 s16, s16, 1
    s_cmp_gt_u32 s16, 100000
    s_cbranch_scc1 L_role_tw_abort
    s_waitcnt vmcnt(0)
    v_cmp_gt_u32 vcc, 128, v6
    s_nop 0
    s_cbranch_vccz LtwZ_inia_d
    s_sleep 8
    s_branch LtwZ_inia
LtwZ_inia_d:
    s_barrier
    s_cmp_lg_u32 s14, 0
    s_cbranch_scc1 LtwZ_inib_d
    v_mov_b32 v5, 160
    s_mov_b32 s16, 0
LtwZ_inib:
    global_load_dword v6, v5, s[12:13] sc1
    s_add_u32 s16, s16, 1
    s_cmp_gt_u32 s16, 100000
    s_cbranch_scc1 L_role_tw_abort
    s_waitcnt vmcnt(0)
    v_cmp_gt_u32 vcc, 64, v6
    s_nop 0
    s_cbranch_vccz LtwZ_inib_d
    s_sleep 8
    s_branch LtwZ_inib
LtwZ_inib_d:
    s_barrier
LtwZ_idle:
    s_barrier
    ds_read_b32 v6, v49
    v_xor_b32 v49, 4, v49
    s_waitcnt lgkmcnt(0)
    v_readfirstlane_b32 s62, v6
    s_nop 0
    s_cmp_eq_u32 s62, 0
    s_cbranch_scc1 L_role_tw_abort
    s_cmp_lt_u32 s33, 29
    s_cselect_b32 s38, 1, 3
    s_cmp_eq_u32 s62, 2
    s_cselect_b32 s36, 1, 0
    s_cselect_b32 s37, s33, s32
    s_cselect_b32 s17, s38, 0
    s_add_u32 s33, s33, s17
    s_cmp_eq_u32 s62, 1
    s_cselect_b32 s17, 2, 0
    s_add_u32 s32, s32, s17
    s_lshl_b32 s56, s36, 6
    s_add_u32 s56, s56, s37
    s_lshl_b32 s46, s56, 18
    s_add_u32 s46, s46, s58
    s_mul_i32 s41, s36, 4718592
    s_mul_i32 s17, s37, 36864
    s_add_u32 s41, s41, s17
    s_add_u32 s41, s41, 8650752
    s_cmp_ge_u32 s37, 64
    s_cbranch_scc1 L_role_tw_abort
    s_add_u32 s48, s46, 0
    buffer_load_dwordx4 v[64:67], v0, s[8:11], s48 offen offset:0
    buffer_load_dwordx4 v[68:71], v0, s[8:11], s48 offen offset:1024
    buffer_load_dwordx4 v[72:75], v0, s[8:11], s48 offen offset:2048
    buffer_load_dwordx4 v[76:79], v0, s[8:11], s48 offen offset:3072
    s_add_u32 s48, s46, 4096
    buffer_load_dwordx4 v[80:83], v0, s[8:11], s48 offen offset:0
    buffer_load_dwordx4 v[84:87], v0, s[8:11], s48 offen offset:1024
    buffer_load_dwordx4 v[88:91], v0, s[8:11], s48 offen offset:2048
    buffer_load_dwordx4 v[92:95], v0, s[8:11], s48 offen offset:3072
    s_add_u32 s48, s46, 8192
    buffer_load_dwordx4 v[96:99], v0, s[8:11], s48 offen offset:0
    buffer_load_dwordx4 v[100:103], v0, s[8:11], s48 offen offset:1024
    buffer_load_dwordx4 v[104:107], v0, s[8:11], s48 offen offset:2048
    buffer_load_dwordx4 v[108:111], v0, s[8:11], s48 offen offset:3072
    s_add_u32 s48, s46, 12288
    buffer_load_dwordx4 v[112:115], v0, s[8:11], s48 offen offset:0
    buffer_load_dwordx4 v[116:119], v0, s[8:11], s48 offen offset:1024
    buffer_load_dwordx4 v[120:123], v0, s[8:11], s48 offen offset:2048
    buffer_load_dwordx2 v[40:41], v12, s[8:11], s41 offen
LtwZ_item:
    s_mov_b32 s34, s36
    s_mov_b32 s35, s37
    s_mov_b32 s47, s41
    buffer_load_dwordx4 v[124:127], v0, s[8:11], s48 offen offset:3072
    s_waitcnt vmcnt(16)
    v_mfma_f32_16x16x32_bf16 v[16:19], a[0:3], v[64:67], 0
    v_mfma_f32_16x16x32_bf16 v[20:23], a[4:7], v[64:67], 0
    v_mfma_f32_16x16x32_bf16 v[24:27], v[128:131], v[64:67], 0
    s_add_u32 s48, s46, 16384
    buffer_load_dwordx4 v[64:67], v0, s[8:11], s48 offen offset:0
    s_waitcnt vmcnt(16)
    v_mfma_f32_16x16x32_bf16 v[28:31], a[0:3], v[68:71], 0
    v_mfma_f32_16x16x32_bf16 v[32:35], a[4:7], v[68:71], 0
    v_mfma_f32_16x16x32_bf16 v[36:39], v[128:131], v[68:71], 0
    buffer_load_dwordx4 v[68:71], v0, s[8:11], s48 offen offset:1024
    s_waitcnt vmcnt(16)
    v_mfma_f32_16x16x32_bf16 v[16:19], a[8:11], v[72:75], v[16:19]
    v_mfma_f32_16x16x32_bf16 v[20:23], a[12:15], v[72:75], v[20:23]
    v_mfma_f32_16x16x32_bf16 v[24:27], v[132:135], v[72:75], v[24:27]
    buffer_load_dwordx4 v[72:75], v0, s[8:11], s48 offen offset:2048
    s_waitcnt vmcnt(16)
    v_mfma_f32_16x16x32_bf16 v[28:31], a[8:11], v[76:79], v[28:31]
    v_mfma_f32_16x16x32_bf16 v[32:35], a[12:15], v[76:79], v[32:35]
    v_mfma_f32_16x16x32_bf16 v[36:39], v[132:135], v[76:79], v[36:39]
    buffer_load_dwordx4 v[76:79], v0, s[8:11], s48 offen offset:3072
    s_waitcnt vmcnt(16)
    v_mfma_f32_16x16x32_bf16 v[16:19], a[16:19], v[80:83], v[16:19]
    v_mfma_f32_16x16x32_bf16 v[20:23], a[20:23], v[80:83], v[20:23]
    v_mfma_f32_16x16x32_bf16 v[24:27], v[136:139], v[80:83], v[24:27]
    s_add_u32 s48, s46, 20480
    buffer_load_dwordx4 v[80:83], v0, s[8:11], s48 offen offset:0
    s_waitcnt vmcnt(16)
    v_mfma_f32_16x16x32_bf16 v[28:31], a[16:19], v[84:87], v[28:31]
    v_mfma_f32_16x16x32_bf16 v[32:35], a[20:23], v[84:87], v[32:35]
    v_mfma_f32_16x16x32_bf16 v[36:39], v[136:139], v[84:87], v[36:39]
    buffer_load_dwordx4 v[84:87], v0, s[8:11], s48 offen offset:1024
    s_waitcnt vmcnt(16)
    v_mfma_f32_16x16x32_bf16 v[16:19], a[24:27], v[88:91], v[16:19]
    v_mfma_f32_16x16x32_bf16 v[20:23], a[28:31], v[88:91], v[20:23]
    v_mfma_f32_16x16x32_bf16 v[24:27], v[140:143], v[88:91], v[24:27]
    buffer_load_dwordx4 v[88:91], v0, s[8:11], s48 offen offset:2048
    s_waitcnt vmcnt(16)
    v_mfma_f32_16x16x32_bf16 v[28:31], a[24:27], v[92:95], v[28:31]
    v_mfma_f32_16x16x32_bf16 v[32:35], a[28:31], v[92:95], v[32:35]
    v_mfma_f32_16x16x32_bf16 v[36:39], v[140:143], v[92:95], v[36:39]
    buffer_load_dwordx4 v[92:95], v0, s[8:11], s48 offen offset:3072
    s_waitcnt vmcnt(16)
    v_mfma_f32_16x16x32_bf16 v[16:19], a[32:35], v[96:99], v[16:19]
    v_mfma_f32_16x16x32_bf16 v[20:23], a[36:39], v[96:99], v[20:23]
    v_mfma_f32_16x16x32_bf16 v[24:27], v[144:147], v[96:99], v[24:27]
    s_add_u32 s48, s46, 24576
    buffer_load_dwordx4 v[96:99], v0, s[8:11], s48 offen offset:0
    s_waitcnt vmcnt(16)
    v_mfma_f32_16x16x32_bf16 v[28:31], a[32:35], v[100:103], v[28:31]
    v_mfma_f32_16x16x32_bf16 v[32:35], a[36:39], v[100:103], v[32:35]
    v_mfma_f32_16x16x32_bf16 v[36:39], v[144:147], v[100:103], v[36:39]
    buffer_load_dwordx4 v[100:103], v0, s[8:11], s48 offen offset:1024
    s_waitcnt vmcnt(16)
    v_mfma_f32_16x16x32_bf16 v[16:19], a[40:43], v[104:107], v[16:19]
    v_mfma_f32_16x16x32_bf16 v[20:23], a[44:47], v[104:107], v[20:23]
    v_mfma_f32_16x16x32_bf16 v[24:27], v[148:151], v[104:107], v[24:27]
    buffer_load_dwordx4 v[104:107], v0, s[8:11], s48 offen offset:2048
    s_waitcnt vmcnt(16)
    v_mfma_f32_16x16x32_bf16 v[28:31], a[40:43], v[108:111], v[28:31]
    v_mfma_f32_16x16x32_bf16 v[32:35], a[44:47], v[108:111], v[32:35]
    v_mfma_f32_16x16x32_bf16 v[36:39], v[148:151], v[108:111], v[36:39]
    buffer_load_dwordx4 v[108:111], v0, s[8:11], s48 offen offset:3072
    s_waitcnt vmcnt(16)
    v_mfma_f32_16x16x32_bf16 v[16:19], a[48:51], v[112:115], v[16:19]
    v_mfma_f32_16x16x32_bf16 v[20:23], a[52:55], v[112:115], v[20:23]
    v_mfma_f32_16x16x32_bf16 v[24:27], v[152:155], v[112:115], v[24:27]
    s_add_u32 s48, s46, 28672
    buffer_load_dwordx4 v[112:115], v0, s[8:11], s48 offen offset:0
    s_waitcnt vmcnt(16)
    v_mfma_f32_16x16x32_bf16 v[28:31], a[48:51], v[116:119], v[28:31]
    v_mfma_f32_16x16x32_bf16 v[32:35], a[52:55], v[116:119], v[32:35]
    v_mfma_f32_16x16x32_bf16 v[36:39], v[152:155], v[116:119], v[36:39]
    buffer_load_dwordx4 v[116:119], v0, s[8:11], s48 offen offset:1024
    s_waitcnt vmcnt(16)
    v_mfma_f32_16x16x32_bf16 v[16:19], a[56:59], v[120:123], v[16:19]
    v_mfma_f32_16x16x32_bf16 v[20:23], a[60:63], v[120:123], v[20:23]
    v_mfma_f32_16x16x32_bf16 v[24:27], v[156:159], v[120:123], v[24:27]
    buffer_load_dwordx4 v[120:123], v0, s[8:11], s48 offen offset:2048
    s_waitcnt vmcnt(15)
    v_mfma_f32_16x16x32_bf16 v[28:31], a[56:59], v[124:127], v[28:31]
    v_mfma_f32_16x16x32_bf16 v[32:35], a[60:63], v[124:127], v[32:35]
    v_mfma_f32_16x16x32_bf16 v[36:39], v[156:159], v[124:127], v[36:39]
    buffer_load_dwordx4 v[124:127], v0, s[8:11], s48 offen offset:3072
    s_waitcnt vmcnt(15)
    v_mfma_f32_16x16x32_bf16 v[16:19], a[64:67], v[64:67], v[16:19]
    v_mfma_f32_16x16x32_bf16 v[20:23], a[68:71], v[64:67], v[20:23]
    v_mfma_f32_16x16x32_bf16 v[24:27], v[160:163], v[64:67], v[24:27]
    s_add_u32 s48, s46, 32768
    buffer_load_dwordx4 v[64:67], v0, s[8:11], s48 offen offset:0
    s_waitcnt vmcnt(15)
    v_mfma_f32_16x16x32_bf16 v[28:31], a[64:67], v[68:71], v[28:31]
    v_mfma_f32_16x16x32_bf16 v[32:35], a[68:71], v[68:71], v[32:35]
    v_mfma_f32_16x16x32_bf16 v[36:39], v[160:163], v[68:71], v[36:39]
    s_cmp_lg_u32 s43, 0
    s_cselect_b64 exec, 1, 0
    buffer_store_dword v3, v4, s[8:11], s43 offen sc1
    s_mov_b64 exec, -1
    s_mov_b32 s43, 0
    buffer_load_dwordx4 v[68:71], v0, s[8:11], s48 offen offset:1024
    s_waitcnt vmcnt(16)
    v_mfma_f32_16x16x32_bf16 v[16:19], a[72:75], v[72:75], v[16:19]
    v_mfma_f32_16x16x32_bf16 v[20:23], a[76:79], v[72:75], v[20:23]
    v_mfma_f32_16x16x32_bf16 v[24:27], v[164:167], v[72:75], v[24:27]
    buffer_load_dwordx4 v[72:75], v0, s[8:11], s48 offen offset:2048
    s_waitcnt vmcnt(16)
    v_mfma_f32_16x16x32_bf16 v[28:31], a[72:75], v[76:79], v[28:31]
    v_mfma_f32_16x16x32_bf16 v[32:35], a[76:79], v[76:79], v[32:35]
    v_mfma_f32_16x16x32_bf16 v[36:39], v[164:167], v[76:79], v[36:39]
    buffer_load_dwordx4 v[76:79], v0, s[8:11], s48 offen offset:3072
    s_waitcnt vmcnt(16)
    v_mfma_f32_16x16x32_bf16 v[16:19], a[80:83], v[80:83], v[16:19]
    v_mfma_f32_16x16x32_bf16 v[20:23], a[84:87], v[80:83], v[20:23]
    v_mfma_f32_16x16x32_bf16 v[24:27], v[168:171], v[80:83], v[24:27]
    s_add_u32 s48, s46, 36864
    buffer_load_dwordx4 v[80:83], v0, s[8:11], s48 offen offset:0
    s_waitcnt vmcnt(16)
    v_mfma_f32_16x16x32_bf16 v[28:31], a[80:83], v[84:87], v[28:31]
    v_mfma_f32_16x16x32_bf16 v[32:35], a[84:87], v[84:87], v[32:35]
    v_mfma_f32_16x16x32_bf16 v[36:39], v[168:171], v[84:87], v[36:39]
    buffer_load_dwordx4 v[84:87], v0, s[8:11], s48 offen offset:1024
    s_waitcnt vmcnt(16)
    v_mfma_f32_16x16x32_bf16 v[16:19], a[88:91], v[88:91], v[16:19]
    v_mfma_f32_16x16x32_bf16 v[20:23], a[92:95], v[88:91], v[20:23]
    v_mfma_f32_16x16x32_bf16 v[24:27], v[172:175], v[88:91], v[24:27]
    buffer_load_dwordx4 v[88:91], v0, s[8:11], s48 offen offset:2048
    s_waitcnt vmcnt(16)
    v_mfma_f32_16x16x32_bf16 v[28:31], a[88:91], v[92:95], v[28:31]
    v_mfma_f32_16x16x32_bf16 v[32:35], a[92:95], v[92:95], v[32:35]
    v_mfma_f32_16x16x32_bf16 v[36:39], v[172:175], v[92:95], v[36:39]
    buffer_load_dwordx4 v[92:95], v0, s[8:11], s48 offen offset:3072
    s_waitcnt vmcnt(16)
    v_mfma_f32_16x16x32_bf16 v[16:19], a[96:99], v[96:99], v[16:19]
    v_mfma_f32_16x16x32_bf16 v[20:23], a[100:103], v[96:99], v[20:23]
    v_mfma_f32_16x16x32_bf16 v[24:27], v[176:179], v[96:99], v[24:27]
    s_add_u32 s48, s46, 40960
    buffer_load_dwordx4 v[96:99], v0, s[8:11], s48 offen offset:0
    s_waitcnt vmcnt(16)
    v_mfma_f32_16x16x32_bf16 v[28:31], a[96:99], v[100:103], v[28:31]
    v_mfma_f32_16x16x32_bf16 v[32:35], a[100:103], v[100:103], v[32:35]
    v_mfma_f32_16x16x32_bf16 v[36:39], v[176:179], v[100:103], v[36:39]
    buffer_load_dwordx4 v[100:103], v0, s[8:11], s48 offen offset:1024
    s_waitcnt vmcnt(16)
    v_mfma_f32_16x16x32_bf16 v[16:19], a[104:107], v[104:107], v[16:19]
    v_mfma_f32_16x16x32_bf16 v[20:23], a[108:111], v[104:107], v[20:23]
    v_mfma_f32_16x16x32_bf16 v[24:27], v[180:183], v[104:107], v[24:27]
    buffer_load_dwordx4 v[104:107], v0, s[8:11], s48 offen offset:2048
    s_waitcnt vmcnt(16)
    v_mfma_f32_16x16x32_bf16 v[28:31], a[104:107], v[108:111], v[28:31]
    v_mfma_f32_16x16x32_bf16 v[32:35], a[108:111], v[108:111], v[32:35]
    v_mfma_f32_16x16x32_bf16 v[36:39], v[180:183], v[108:111], v[36:39]
    buffer_load_dwordx4 v[108:111], v0, s[8:11], s48 offen offset:3072
    s_waitcnt vmcnt(16)
    v_mfma_f32_16x16x32_bf16 v[16:19], a[112:115], v[112:115], v[16:19]
    v_mfma_f32_16x16x32_bf16 v[20:23], a[116:119], v[112:115], v[20:23]
    v_mfma_f32_16x16x32_bf16 v[24:27], v[184:187], v[112:115], v[24:27]
    s_add_u32 s48, s46, 45056
    buffer_load_dwordx4 v[112:115], v0, s[8:11], s48 offen offset:0
    s_waitcnt vmcnt(16)
    v_mfma_f32_16x16x32_bf16 v[28:31], a[112:115], v[116:119], v[28:31]
    v_mfma_f32_16x16x32_bf16 v[32:35], a[116:119], v[116:119], v[32:35]
    v_mfma_f32_16x16x32_bf16 v[36:39], v[184:187], v[116:119], v[36:39]
    buffer_load_dwordx4 v[116:119], v0, s[8:11], s48 offen offset:1024
    s_waitcnt vmcnt(16)
    v_mfma_f32_16x16x32_bf16 v[16:19], a[120:123], v[120:123], v[16:19]
    v_mfma_f32_16x16x32_bf16 v[20:23], a[124:127], v[120:123], v[20:23]
    v_mfma_f32_16x16x32_bf16 v[24:27], v[188:191], v[120:123], v[24:27]
    buffer_load_dwordx4 v[120:123], v0, s[8:11], s48 offen offset:2048
    s_waitcnt vmcnt(16)
    v_mfma_f32_16x16x32_bf16 v[28:31], a[120:123], v[124:127], v[28:31]
    v_mfma_f32_16x16x32_bf16 v[32:35], a[124:127], v[124:127], v[32:35]
    v_mfma_f32_16x16x32_bf16 v[36:39], v[188:191], v[124:127], v[36:39]
    buffer_load_dwordx4 v[124:127], v0, s[8:11], s48 offen offset:3072
    s_waitcnt vmcnt(16)
    v_mfma_f32_16x16x32_bf16 v[16:19], a[128:131], v[64:67], v[16:19]
    v_mfma_f32_16x16x32_bf16 v[20:23], a[132:135], v[64:67], v[20:23]
    v_mfma_f32_16x16x32_bf16 v[24:27], v[192:195], v[64:67], v[24:27]
    s_add_u32 s48, s46, 49152
    buffer_load_dwordx4 v[64:67], v0, s[8:11], s48 offen offset:0
    s_waitcnt vmcnt(15)
    v_mfma_f32_16x16x32_bf16 v[28:31], a[128:131], v[68:71], v[28:31]
    v_mfma_f32_16x16x32_bf16 v[32:35], a[132:135], v[68:71], v[32:35]
    v_mfma_f32_16x16x32_bf16 v[36:39], v[192:195], v[68:71], v[36:39]
    buffer_load_dwordx4 v[68:71], v0, s[8:11], s48 offen offset:1024
    s_waitcnt vmcnt(15)
    v_mfma_f32_16x16x32_bf16 v[16:19], a[136:139], v[72:75], v[16:19]
    v_mfma_f32_16x16x32_bf16 v[20:23], a[140:143], v[72:75], v[20:23]
    v_mfma_f32_16x16x32_bf16 v[24:27], v[196:199], v[72:75], v[24:27]
    buffer_load_dwordx4 v[72:75], v0, s[8:11], s48 offen offset:2048
    s_waitcnt vmcnt(15)
    v_mfma_f32_16x16x32_bf16 v[28:31], a[136:139], v[76:79], v[28:31]
    v_mfma_f32_16x16x32_bf16 v[32:35], a[140:143], v[76:79], v[32:35]
    v_mfma_f32_16x16x32_bf16 v[36:39], v[196:199], v[76:79], v[36:39]
    buffer_load_dwordx4 v[76:79], v0, s[8:11], s48 offen offset:3072
    s_waitcnt vmcnt(15)
    v_mfma_f32_16x16x32_bf16 v[16:19], a[144:147], v[80:83], v[16:19]
    v_mfma_f32_16x16x32_bf16 v[20:23], a[148:151], v[80:83], v[20:23]
    v_mfma_f32_16x16x32_bf16 v[24:27], v[200:203], v[80:83], v[24:27]
    s_add_u32 s48, s46, 53248
    buffer_load_dwordx4 v[80:83], v0, s[8:11], s48 offen offset:0
    s_waitcnt vmcnt(15)
    v_mfma_f32_16x16x32_bf16 v[28:31], a[144:147], v[84:87], v[28:31]
    v_mfma_f32_16x16x32_bf16 v[32:35], a[148:151], v[84:87], v[32:35]
    v_mfma_f32_16x16x32_bf16 v[36:39], v[200:203], v[84:87], v[36:39]
    buffer_load_dwordx4 v[84:87], v0, s[8:11], s48 offen offset:1024
    s_waitcnt vmcnt(15)
    v_mfma_f32_16x16x32_bf16 v[16:19], a[152:155], v[88:91], v[16:19]
    v_mfma_f32_16x16x32_bf16 v[20:23], a[156:159], v[88:91], v[20:23]
    v_mfma_f32_16x16x32_bf16 v[24:27], v[204:207], v[88:91], v[24:27]
    buffer_load_dwordx4 v[88:91], v0, s[8:11], s48 offen offset:2048
    s_waitcnt vmcnt(15)
    v_mfma_f32_16x16x32_bf16 v[28:31], a[152:155], v[92:95], v[28:31]
    v_mfma_f32_16x16x32_bf16 v[32:35], a[156:159], v[92:95], v[32:35]
    v_mfma_f32_16x16x32_bf16 v[36:39], v[204:207], v[92:95], v[36:39]
    buffer_load_dwordx4 v[92:95], v0, s[8:11], s48 offen offset:3072
    s_waitcnt vmcnt(15)
    v_mfma_f32_16x16x32_bf16 v[16:19], a[160:163], v[96:99], v[16:19]
    v_mfma_f32_16x16x32_bf16 v[20:23], a[164:167], v[96:99], v[20:23]
    v_mfma_f32_16x16x32_bf16 v[24:27], v[208:211], v[96:99], v[24:27]
    s_add_u32 s48, s46, 57344
    buffer_load_dwordx4 v[96:99], v0, s[8:11], s48 offen offset:0
    s_waitcnt vmcnt(15)
    v_mfma_f32_16x16x32_bf16 v[28:31], a[160:163], v[100:103], v[28:31]
    v_mfma_f32_16x16x32_bf16 v[32:35], a[164:167], v[100:103], v[32:35]
    v_mfma_f32_16x16x32_bf16 v[36:39], v[208:211], v[100:103], v[36:39]
    buffer_load_dwordx4 v[100:103], v0, s[8:11], s48 offen offset:1024
    s_waitcnt vmcnt(15)
    v_mfma_f32_16x16x32_bf16 v[16:19], a[168:171], v[104:107], v[16:19]
    v_mfma_f32_16x16x32_bf16 v[20:23], a[172:175], v[104:107], v[20:23]
    v_mfma_f32_16x16x32_bf16 v[24:27], v[212:215], v[104:107], v[24:27]
    buffer_load_dwordx4 v[104:107], v0, s[8:11], s48 offen offset:2048
    s_waitcnt vmcnt(15)
    v_mfma_f32_16x16x32_bf16 v[28:31], a[168:171], v[108:111], v[28:31]
    v_mfma_f32_16x16x32_bf16 v[32:35], a[172:175], v[108:111], v[32:35]
    v_mfma_f32_16x16x32_bf16 v[36:39], v[212:215], v[108:111], v[36:39]
    buffer_load_dwordx4 v[108:111], v0, s[8:11], s48 offen offset:3072
    s_waitcnt vmcnt(15)
    v_mfma_f32_16x16x32_bf16 v[16:19], a[176:179], v[112:115], v[16:19]
    v_mfma_f32_16x16x32_bf16 v[20:23], a[180:183], v[112:115], v[20:23]
    v_mfma_f32_16x16x32_bf16 v[24:27], v[216:219], v[112:115], v[24:27]
    s_barrier
    ds_read_b32 v6, v49
    v_xor_b32 v49, 4, v49
    s_add_u32 s48, s46, 61440
    buffer_load_dwordx4 v[112:115], v0, s[8:11], s48 offen offset:0
    s_waitcnt vmcnt(15)
    v_mfma_f32_16x16x32_bf16 v[28:31], a[176:179], v[116:119], v[28:31]
    v_mfma_f32_16x16x32_bf16 v[32:35], a[180:183], v[116:119], v[32:35]
    v_mfma_f32_16x16x32_bf16 v[36:39], v[216:219], v[116:119], v[36:39]
    buffer_load_dwordx4 v[116:119], v0, s[8:11], s48 offen offset:1024
    s_waitcnt vmcnt(15)
    v_mfma_f32_16x16x32_bf16 v[16:19], a[184:187], v[120:123], v[16:19]
    v_mfma_f32_16x16x32_bf16 v[20:23], a[188:191], v[120:123], v[20:23]
    v_mfma_f32_16x16x32_bf16 v[24:27], v[220:223], v[120:123], v[24:27]
    buffer_load_dwordx4 v[120:123], v0, s[8:11], s48 offen offset:2048
    s_waitcnt vmcnt(15)
    v_mfma_f32_16x16x32_bf16 v[28:31], a[184:187], v[124:127], v[28:31]
    v_mfma_f32_16x16x32_bf16 v[32:35], a[188:191], v[124:127], v[32:35]
    v_mfma_f32_16x16x32_bf16 v[36:39], v[220:223], v[124:127], v[36:39]
    s_waitcnt lgkmcnt(0)
    v_readfirstlane_b32 s62, v6
    s_cmp_lt_u32 s33, 29
    s_cselect_b32 s38, 1, 3
    s_cmp_eq_u32 s62, 2
    s_cselect_b32 s36, 1, 0
    s_cselect_b32 s37, s33, s32
    s_cselect_b32 s17, s38, 0
    s_add_u32 s33, s33, s17
    s_cmp_eq_u32 s62, 1
    s_cselect_b32 s17, 2, 0
    s_add_u32 s32, s32, s17
    s_lshl_b32 s56, s36, 6
    s_add_u32 s56, s56, s37
    buffer_load_dwordx4 v[124:127], v0, s[8:11], s48 offen offset:3072
    s_waitcnt vmcnt(15)
    v_mfma_f32_16x16x32_bf16 v[16:19], a[192:195], v[64:67], v[16:19]
    v_mfma_f32_16x16x32_bf16 v[20:23], a[196:199], v[64:67], v[20:23]
    v_mfma_f32_16x16x32_bf16 v[24:27], v[224:227], v[64:67], v[24:27]
    s_cmp_lt_u32 s37, 64
    s_cselect_b32 s62, s62, 0
    s_lshl_b32 s46, s56, 18
    s_add_u32 s46, s46, s58
    s_mul_i32 s41, s36, 4718592
    s_mul_i32 s17, s37, 36864
    s_add_u32 s41, s41, s17
    s_add_u32 s41, s41, 8650752
    s_cmp_lg_u32 s62, 0
    s_cselect_b32 s30, 268435456, 0
    s_add_u32 s48, s46, 0
    buffer_load_dwordx4 v[64:67], v0, s[28:31], s48 offen offset:0
    s_waitcnt vmcnt(15)
    v_mfma_f32_16x16x32_bf16 v[28:31], a[192:195], v[68:71], v[28:31]
    v_mfma_f32_16x16x32_bf16 v[32:35], a[196:199], v[68:71], v[32:35]
    v_mfma_f32_16x16x32_bf16 v[36:39], v[224:227], v[68:71], v[36:39]
    buffer_load_dwordx4 v[68:71], v0, s[28:31], s48 offen offset:1024
    s_waitcnt vmcnt(15)
    v_mfma_f32_16x16x32_bf16 v[16:19], a[200:203], v[72:75], v[16:19]
    v_mfma_f32_16x16x32_bf16 v[20:23], a[204:207], v[72:75], v[20:23]
    v_mfma_f32_16x16x32_bf16 v[24:27], v[228:231], v[72:75], v[24:27]
    buffer_load_dwordx4 v[72:75], v0, s[28:31], s48 offen offset:2048
    s_waitcnt vmcnt(15)
    v_mfma_f32_16x16x32_bf16 v[28:31], a[200:203], v[76:79], v[28:31]
    v_mfma_f32_16x16x32_bf16 v[32:35], a[204:207], v[76:79], v[32:35]
    v_mfma_f32_16x16x32_bf16 v[36:39], v[228:231], v[76:79], v[36:39]
    buffer_load_dwordx4 v[76:79], v0, s[28:31], s48 offen offset:3072
    s_waitcnt vmcnt(15)
    v_mfma_f32_16x16x32_bf16 v[16:19], a[208:211], v[80:83], v[16:19]
    v_mfma_f32_16x16x32_bf16 v[20:23], a[212:215], v[80:83], v[20:23]
    v_mfma_f32_16x16x32_bf16 v[24:27], v[232:235], v[80:83], v[24:27]
    s_add_u32 s48, s46, 4096
    buffer_load_dwordx4 v[80:83], v0, s[28:31], s48 offen offset:0
    s_waitcnt vmcnt(15)
    v_mfma_f32_16x16x32_bf16 v[28:31], a[208:211], v[84:87], v[28:31]
    v_mfma_f32_16x16x32_bf16 v[32:35], a[212:215], v[84:87], v[32:35]
    v_mfma_f32_16x16x32_bf16 v[36:39], v[232:235], v[84:87], v[36:39]
    buffer_load_dwordx4 v[84:87], v0, s[28:31], s48 offen offset:1024
    s_waitcnt vmcnt(15)
    v_mfma_f32_16x16x32_bf16 v[16:19], a[216:219], v[88:91], v[16:19]
    v_mfma_f32_16x16x32_bf16 v[20:23], a[220:223], v[88:91], v[20:23]
    v_mfma_f32_16x16x32_bf16 v[24:27], v[236:239], v[88:91], v[24:27]
    buffer_load_dwordx4 v[88:91], v0, s[28:31], s48 offen offset:2048
    s_waitcnt vmcnt(15)
    v_mfma_f32_16x16x32_bf16 v[28:31], a[216:219], v[92:95], v[28:31]
    v_mfma_f32_16x16x32_bf16 v[32:35], a[220:223], v[92:95], v[32:35]
    v_mfma_f32_16x16x32_bf16 v[36:39], v[236:239], v[92:95], v[36:39]
    buffer_load_dwordx4 v[92:95], v0, s[28:31], s48 offen offset:3072
    s_waitcnt vmcnt(15)
    v_mfma_f32_16x16x32_bf16 v[16:19], a[224:227], v[96:99], v[16:19]
    v_mfma_f32_16x16x32_bf16 v[20:23], a[228:231], v[96:99], v[20:23]
    v_mfma_f32_16x16x32_bf16 v[24:27], v[240:243], v[96:99], v[24:27]
    s_add_u32 s48, s46, 8192
    buffer_load_dwordx4 v[96:99], v0, s[28:31], s48 offen offset:0
    s_waitcnt vmcnt(15)
    v_mfma_f32_16x16x32_bf16 v[28:31], a[224:227], v[100:103], v[28:31]
    v_mfma_f32_16x16x32_bf16 v[32:35], a[228:231], v[100:103], v[32:35]
    v_mfma_f32_16x16x32_bf16 v[36:39], v[240:243], v[100:103], v[36:39]
    buffer_load_dwordx4 v[100:103], v0, s[28:31], s48 offen offset:1024
    s_waitcnt vmcnt(15)
    v_mfma_f32_16x16x32_bf16 v[16:19], a[232:235], v[104:107], v[16:19]
    v_mfma_f32_16x16x32_bf16 v[20:23], a[236:239], v[104:107], v[20:23]
    v_mfma_f32_16x16x32_bf16 v[24:27], v[244:247], v[104:107], v[24:27]
    buffer_load_dwordx4 v[104:107], v0, s[28:31], s48 offen offset:2048
    s_waitcnt vmcnt(15)
    v_mfma_f32_16x16x32_bf16 v[28:31], a[232:235], v[108:111], v[28:31]
    v_mfma_f32_16x16x32_bf16 v[32:35], a[236:239], v[108:111], v[32:35]
    v_mfma_f32_16x16x32_bf16 v[36:39], v[244:247], v[108:111], v[36:39]
    buffer_load_dwordx4 v[108:111], v0, s[28:31], s48 offen offset:3072
    s_waitcnt vmcnt(15)
    v_mfma_f32_16x16x32_bf16 v[16:19], a[240:243], v[112:115], v[16:19]
    v_mfma_f32_16x16x32_bf16 v[20:23], a[244:247], v[112:115], v[20:23]
    v_mfma_f32_16x16x32_bf16 v[24:27], v[248:251], v[112:115], v[24:27]
    s_add_u32 s48, s46, 12288
    buffer_load_dwordx4 v[112:115], v0, s[28:31], s48 offen offset:0
    s_waitcnt vmcnt(15)
    v_mfma_f32_16x16x32_bf16 v[28:31], a[240:243], v[116:119], v[28:31]
    v_mfma_f32_16x16x32_bf16 v[32:35], a[244:247], v[116:119], v[32:35]
    v_mfma_f32_16x16x32_bf16 v[36:39], v[248:251], v[116:119], v[36:39]
    buffer_load_dwordx4 v[116:119], v0, s[28:31], s48 offen offset:1024
    s_waitcnt vmcnt(15)
    v_mfma_f32_16x16x32_bf16 v[16:19], a[248:251], v[120:123], v[16:19]
    v_mfma_f32_16x16x32_bf16 v[20:23], a[252:255], v[120:123], v[20:23]
    v_mfma_f32_16x16x32_bf16 v[24:27], v[252:255], v[120:123], v[24:27]
    buffer_load_dwordx4 v[120:123], v0, s[28:31], s48 offen offset:2048
    s_waitcnt vmcnt(15)
    v_mfma_f32_16x16x32_bf16 v[28:31], a[248:251], v[124:127], v[28:31]
    v_mfma_f32_16x16x32_bf16 v[32:35], a[252:255], v[124:127], v[32:35]
    v_mfma_f32_16x16x32_bf16 v[36:39], v[252:255], v[124:127], v[36:39]
    s_nop 5
    ds_write_b128 v48, v[16:19] offset:0
    ds_write_b128 v48, v[20:23] offset:1024
    ds_write_b128 v48, v[24:27] offset:2048
    ds_write_b128 v48, v[28:31] offset:3072
    ds_write_b128 v48, v[32:35] offset:4096
    ds_write_b128 v48, v[36:39] offset:5120
    s_waitcnt lgkmcnt(0)
    s_barrier
    ds_read_b128 v[24:27], v50 offset:2048
    ds_read_b128 v[28:31], v50 offset:8192
    ds_read_b128 v[32:35], v50 offset:14336
    ds_read_b128 v[36:39], v50 offset:20480
    v_xor_b32 v48, 0x8000, v48
    v_xor_b32 v50, 0x8000, v50
    v_lshlrev_b32 v16, 16, v40
    v_and_b32 v17, 0xffff0000, v40
    v_lshlrev_b32 v18, 16, v41
    v_and_b32 v19, 0xffff0000, v41
    buffer_load_dwordx2 v[40:41], v12, s[28:31], s41 offen
    s_waitcnt lgkmcnt(3)
    v_add_f32 v16, v16, v24
    v_add_f32 v17, v17, v25
    v_add_f32 v18, v18, v26
    v_add_f32 v19, v19, v27
    s_waitcnt lgkmcnt(2)
    v_add_f32 v16, v16, v28
    v_add_f32 v17, v17, v29
    v_add_f32 v18, v18, v30
    v_add_f32 v19, v19, v31
    s_waitcnt lgkmcnt(1)
    v_add_f32 v16, v16, v32
    v_add_f32 v17, v17, v33
    v_add_f32 v18, v18, v34
    v_add_f32 v19, v19, v35
    s_waitcnt lgkmcnt(0)
    v_add_f32 v16, v16, v36
    v_add_f32 v17, v17, v37
    v_add_f32 v18, v18, v38
    v_add_f32 v19, v19, v39
    v_cvt_pk_bf16_f32 v52, v16, v17
    v_cvt_pk_bf16_f32 v53, v18, v19
    s_cmp_eq_u32 s34, 0
    s_cbranch_scc1 LtwZ_l0
    s_mul_i32 s17, s35, 36864
    buffer_store_dwordx2 v[52:53], v13, s[24:27], s17 offen sc1
    s_cmp_lg_u32 s62, 0
    s_cbranch_scc1 LtwZ_item
LtwZ_chk:
    s_min_u32 s17, s32, s33
    s_cmp_lt_u32 s17, 64
    s_cbranch_scc1 LtwZ_idle
    s_branch L_role_tw_exit
LtwZ_l0:
    s_add_u32 s47, s47, 2359296
    buffer_store_dwordx2 v[52:53], v12, s[8:11], s47 offen sc1
    v_add_f32 v44, v16, v17
    v_mul_f32 v45, v16, v16
    v_fmac_f32 v45, v17, v17
    v_add_f32 v44, v44, v18
    v_fmac_f32 v45, v18, v18
    v_add_f32 v44, v44, v19
    v_fmac_f32 v45, v19, v19
    v_mov_b32 v46, v44
    v_mov_b32 v47, v45
    s_nop 0
    v_permlane32_swap_b32 v44, v46
    v_permlane32_swap_b32 v45, v47
    v_add_f32 v44, v44, v46
    v_add_f32 v45, v45, v47
    v_mov_b32 v46, v44
    v_mov_b32 v47, v45
    s_nop 0
    v_permlane16_swap_b32 v44, v46
    v_permlane16_swap_b32 v45, v47
    v_add_f32 v44, v44, v46
    v_add_f32 v45, v45, v47
    s_mul_i32 s17, s35, 6144
    s_add_u32 s17, s17, 16515072
    s_mov_b64 exec, 0xffff
    buffer_store_dwordx2 v[44:45], v14, s[8:11], s17 offen sc1
    s_mov_b64 exec, -1
    s_mul_i32 s43, s35, 22528
    s_add_u32 s43, s43, s49
    s_cmp_lg_u32 s62, 0
    s_cbranch_scc1 LtwZ_item
    s_waitcnt vmcnt(0)
    s_mov_b64 exec, 1
    buffer_store_dword v3, v4, s[8:11], s43 offen sc1
    s_mov_b64 exec, -1
    s_mov_b32 s43, 0
    s_branch LtwZ_chk
L_role_tw_abort:
    s_waitcnt lgkmcnt(0)
    s_mov_b64 exec, -1
    v_mov_b32 v0, 60
    s_lshl_b32 s5, s3, 8
    s_or_b32 s5, s5, s4
    s_or_b32 s5, s5, 0x10000
    v_mov_b32 v1, s5
    global_store_dword v0, v1, s[12:13]
    s_endpgm
L_role_tw_exit:
    s_endpgm
.p2align 6
L_role_r:
    s_mov_b32 s32, s3
    s_mov_b32 s15, s4
    v_and_b32 v60, 63, v0
    v_and_b32 v61, 15, v60
    v_lshrrev_b32 v62, 4, v60
    v_lshlrev_b32 v0, 4, v60
    s_mul_i32 s17, s14, 34816
    s_add_u32 s17, s17, 23296
    v_add_u32 v8, s17, v0
    s_mov_b32 s50, 0xfffffffe
    s_mov_b32 s44, 0x3e0293ee
    s_mov_b32 s45, 0x3e0293ee
    s_mov_b32 s52, 0x3f803f80
    s_mov_b32 s53, 0x3f803f80
    s_mov_b32 s40, 1
    s_mov_b32 s46, 0x00ff00ff
    s_cmp_eq_u32 s14, 2
    s_cselect_b32 s46, 0x00030003, s46
    s_mov_b32 s47, s46
    v_bfe_u32 v63, v61, 1, 1
    v_mov_b32 v1, 0x4444
    v_mov_b32 v64, 0xeeee
    v_cmp_eq_u32 vcc, 0, v63
    s_nop 1
    v_cndmask_b32 v1, v64, v1, vcc
    v_mul_u32_u24 v64, 1152, v62
    v_lshl_add_u32 v2, v61, 2, v64
    s_lshl_b32 s17, s14, 6
    s_add_u32 s18, s17, 0
    v_add_u32 v2, s18, v2
    v_mul_u32_u24 v64, 288, v61
    v_lshl_add_u32 v3, v62, 4, v64
    v_add_u32 v3, 0, v3
    v_lshrrev_b32 v64, 2, v61
    v_and_b32 v65, 1, v61
    v_lshl_add_u32 v64, v64, 1, v65
    v_mul_u32_u24 v65, 288, v64
    v_lshl_add_u32 v4, v62, 5, v65
    v_lshl_add_u32 v4, v63, 4, v4
    v_add_u32 v4, 4608, v4
    v_xor_b32 v63, 1, v63
    v_mul_u32_u24 v63, 2304, v63
    v_add_u32 v5, v65, v63
    v_lshl_add_u32 v5, v62, 4, v5
    s_add_u32 s18, s17, 4608
    v_add_u32 v5, s18, v5
    s_lshr_b32 s70, s15, 3
    s_bfe_u32 s71, s15, 0x20001
    s_and_b32 s72, s15, 1
    v_bfe_u32 v64, v61, 2, 1
    v_lshl_add_u32 v63, v64, 2, v62
    v_mul_u32_u24 v63, 9216, v63
    v_lshrrev_b32 v65, 3, v61
    v_lshlrev_b32 v65, 2, v65
    v_and_b32 v64, 3, v61
    v_add_u32 v65, v65, v64
    s_lshl_b32 s73, s71, 4
    s_lshl_b32 s17, s72, 3
    s_add_u32 s73, s73, s17
    v_add_u32 v65, s73, v65
    s_lshl_b32 s17, s70, 6
    v_add_u32 v65, s17, v65
    s_cmp_eq_u32 s14, 2
    s_cselect_b32 s17, 2, 4
    v_lshlrev_b32 v65, s17, v65
    v_add_u32 v6, v63, v65
    s_lshl_b32 s17, s14, 12
    v_add_u32 v6, s17, v6
    v_lshrrev_b32 v66, 1, v61
    s_lshl_b32 s17, s14, 2
    v_add_u32 v66, s17, v66
    v_and_b32 v64, 1, v61
    s_lshl_b32 s17, s70, 4
    s_lshl_b32 s18, s71, 2
    s_add_u32 s17, s17, s18
    s_lshl_b32 s18, s72, 1
    s_add_u32 s17, s17, s18
    v_add_u32 v65, s17, v64
    v_lshl_add_u32 v65, v66, 6, v65
    v_lshlrev_b32 v65, 4, v65
    v_lshl_add_u32 v7, v62, 2, v65
    s_lshl_b32 s17, s71, 1
    v_add_u32 v64, s17, v64
    v_mul_u32_u24 v64, 576, v64
    v_lshl_add_u32 v64, v66, 4, v64
    v_lshl_add_u32 v64, v62, 1, v64
    s_mul_i32 s17, s70, 144
    s_lshl_b32 s18, s72, 3
    s_add_u32 s17, s17, s18
    v_add_u32 v64, s17, v64
    v_lshlrev_b32 v67, 1, v64
    s_mul_i32 s48, s32, 1048576
    s_add_u32 s48, s48, 4194304
    s_mul_i32 s17, s15, 9216
    s_add_u32 s17, s17, s48
    s_lshl_b32 s18, s14, 10
    s_add_u32 s38, s17, s18
    s_lshl_b32 s19, s14, 8
    s_add_u32 s39, s17, s19
    s_add_u32 s39, s39, 8192
    s_add_u32 s37, s48, 983040
    s_xor_b32 s36, s37, 16384
    s_add_u32 s34, s37, s18
    s_add_u32 s35, s37, 8192
    s_mul_i32 s17, s32, 50331648
    s_lshl_b32 s19, s15, 13
    s_add_u32 s17, s17, s19
    s_add_u32 s68, s17, 77594624
    s_lshl_b32 s18, s14, 11
    s_add_u32 s17, s17, s18
    s_add_u32 s41, s17, 60817408
    s_add_u32 s42, s17, 77594624
    s_mul_i32 s17, s32, 8388608
    s_lshl_b32 s19, s15, 12
    s_add_u32 s17, s17, s19
    s_add_u32 s43, s17, 27262976
    s_mul_i32 s17, s32, 1441792
    s_lshl_b32 s19, s15, 9
    s_add_u32 s17, s17, s19
    s_add_u32 s66, s17, 5376
    s_mov_b32 s33, 0
    s_add_u32 s62, s48, 0
    s_add_u32 s63, s48, 73728
    s_add_u32 s64, s48, 147456
    s_add_u32 s65, s48, 221184
    s_load_dwordx2 s[20:21], s[0:1], 32
    s_mov_b32 s22, 9216
    s_mov_b32 s23, 0x00020000
    s_waitcnt lgkmcnt(0)
    s_and_b32 s21, s21, 0xffff
    s_cmp_gt_u32 s14, 2
    s_cbranch_scc1 Lr_mem0_done
    s_mov_b64 exec, s[46:47]
    buffer_load_dword v64, v67, s[20:23], 0 offen
    s_waitcnt vmcnt(0)
    v_min_u32 v64, s50, v64
    buffer_store_dword v64, v7, s[8:11], s37 offen sc1
    v_mov_b32 v64, -1
    buffer_store_dword v64, v7, s[8:11], s36 offen sc1
    s_mov_b64 exec, -1
Lr_mem0_done:
    v_mov_b32 v64, 0
    v_mov_b32 v65, 0
    v_mov_b32 v66, 0
    v_mov_b32 v67, 0
    v_lshrrev_b32 v63, 2, v0
    buffer_store_dwordx4 v[64:67], v0, s[8:11], s38 offen sc1
    s_add_u32 s17, s38, 4096
    buffer_store_dwordx4 v[64:67], v0, s[8:11], s17 offen sc1
    buffer_store_dword v64, v63, s[8:11], s39 offen sc1
    s_waitcnt vmcnt(0)
    s_barrier
    s_cmp_lg_u32 s14, 0
    s_cbranch_scc1 Lr_noadd
    s_lshl_b32 s17, s32, 2
    s_add_u32 s17, s17, 192
    v_mov_b32 v63, s17
    v_mov_b32 v64, 1
    s_mov_b64 exec, 1
    global_atomic_add v63, v64, s[12:13]
    s_mov_b64 exec, -1
Lr_noadd:
    s_cmp_lt_u32 s14, 3
    s_cbranch_scc1 Lr_not_w3
    v_lshlrev_b32 v6, 3, v0
    v_lshrrev_b32 v63, 2, v0
    v_and_b32 v7, 12, v63
    v_and_b32 v63, 16, v63
    v_lshl_add_u32 v7, v63, 3, v7
Lr_not_w3:
    s_cmp_eq_u32 s32, 0
    s_cbranch_scc1 Lr_gate_ng
    s_cmp_lg_u32 s14, 0
    s_cbranch_scc1 Lr_gate_d
    v_mov_b32 v63, 48
    s_mov_b32 s16, 0
Lr_gate:
    global_load_dword v64, v63, s[12:13] sc1
    s_add_u32 s16, s16, 1
    s_cmp_gt_u32 s16, 100000
    s_cbranch_scc1 Lr_abort
    s_waitcnt vmcnt(0)
    v_cmp_gt_u32 vcc, 32, v64
    s_nop 0
    s_cbranch_vccz Lr_gate_d
    s_sleep 100
    s_branch Lr_gate
Lr_gate_d:
    s_barrier
Lr_gate_ng:
    s_load_dwordx2 s[20:21], s[0:1], 40
    s_mov_b32 s22, 4718592
    s_mov_b32 s23, 0x00020000
    s_waitcnt lgkmcnt(0)
    s_and_b32 s21, s21, 0xffff
    s_load_dwordx2 s[24:25], s[0:1], 48
    s_mov_b32 s26, 4718592
    s_mov_b32 s27, 0x00020000
    s_waitcnt lgkmcnt(0)
    s_and_b32 s25, s25, 0xffff
    s_load_dwordx2 s[28:29], s[0:1], 56
    s_mov_b32 s30, 4718592
    s_mov_b32 s31, 0x00020000
    s_waitcnt lgkmcnt(0)
    s_and_b32 s29, s29, 0xffff
    s_load_dwordx2 s[76:77], s[0:1], 64
    s_mov_b32 s78, 4718592
    s_mov_b32 s79, 0x00020000
    s_waitcnt lgkmcnt(0)
    s_and_b32 s77, s77, 0xffff
    v_lshrrev_b32 v60, 4, v0
    v_and_b32 v61, 15, v60
    v_lshrrev_b32 v62, 4, v60
    s_mul_i32 s72, s14, 34816
    s_add_u32 s72, s72, 23296
    s_mul_i32 s70, s14, 1179648
    s_lshl_b32 s17, s15, 8
    s_add_u32 s70, s70, s17
    s_mul_i32 s71, s15, 147456
    s_mul_i32 s17, s14, 288
    s_add_u32 s71, s71, s17
    v_and_b32 v63, 1, v62
    v_lshrrev_b32 v64, 1, v61
    v_xor_b32 v64, v64, v63
    v_lshlrev_b32 v64, 5, v64
    v_and_b32 v65, 1, v61
    v_lshl_add_u32 v64, v65, 4, v64
    v_lshl_add_u32 v12, v62, 13, v64
    v_xor_b32 v13, 128, v12
    v_xor_b32 v14, 64, v12
    v_xor_b32 v15, 192, v12
    v_lshrrev_b32 v63, 2, v60
    v_mul_u32_u24 v63, 1152, v63
    v_and_b32 v64, 3, v60
    v_lshl_add_u32 v16, v64, 4, v63
    v_lshrrev_b32 v63, 1, v60
    v_mul_u32_u24 v63, 1152, v63
    v_and_b32 v64, 1, v60
    v_lshl_add_u32 v17, v64, 4, v63
    v_lshrrev_b32 v40, 2, v61
    v_and_b32 v41, 3, v61
    v_and_b32 v63, 1, v62
    v_lshl_add_u32 v42, v63, 2, v40
    v_and_b32 v64, 1, v40
    v_lshl_add_u32 v64, v63, 2, v64
    v_lshrrev_b32 v65, 1, v40
    v_lshl_add_u32 v64, v65, 3, v64
    v_lshlrev_b32 v64, 8, v64
    v_lshl_add_u32 v64, v41, 3, v64
    v_lshrrev_b32 v65, 1, v62
    v_mul_u32_u24 v65, 34816, v65
    v_add_u32 v64, v64, v65
    v_add_u32 v64, 23296, v64
    s_lshl_b32 s17, s14, 1
    s_add_u32 s18, s17, 0
    v_xor_b32 v65, s18, v42
    v_lshl_add_u32 v18, v65, 5, v64
    v_add_u32 v19, 69632, v18
    s_add_u32 s18, s17, 1
    v_xor_b32 v65, s18, v42
    v_lshl_add_u32 v20, v65, 5, v64
    v_add_u32 v21, 69632, v20
    v_lshrrev_b32 v63, 1, v62
    v_lshlrev_b32 v63, 3, v63
    v_and_b32 v64, 1, v62
    v_lshl_add_u32 v63, v64, 1, v63
    v_and_b32 v64, 1, v40
    v_lshl_add_u32 v63, v64, 4, v63
    v_lshrrev_b32 v64, 1, v40
    v_lshl_add_u32 v63, v64, 2, v63
    v_lshlrev_b32 v64, 3, v41
    v_lshl_add_u32 v22, v63, 6, v64
    v_add_u32 v22, s72, v22
    v_lshl_add_u32 v23, v63, 5, v64
    v_add_u32 v23, s72, v23
    s_add_u32 m0, s72, 0
    s_add_u32 s17, s70, 0
    buffer_load_dwordx4 v12, s[20:23], s17 offen  lds
    s_add_u32 m0, m0, 1024
    s_add_u32 s17, s70, 32768
    buffer_load_dwordx4 v13, s[20:23], s17 offen  lds
    s_add_u32 m0, m0, 1024
    s_add_u32 s17, s70, 65536
    buffer_load_dwordx4 v14, s[20:23], s17 offen  lds
    s_add_u32 m0, m0, 1024
    s_add_u32 s17, s70, 98304
    buffer_load_dwordx4 v15, s[20:23], s17 offen  lds
    s_add_u32 m0, s72, 4096
    s_add_u32 s17, s70, 0
    buffer_load_dwordx4 v12, s[24:27], s17 offen  lds
    s_add_u32 m0, m0, 1024
    s_add_u32 s17, s70, 32768
    buffer_load_dwordx4 v13, s[24:27], s17 offen  lds
    s_add_u32 m0, m0, 1024
    s_add_u32 s17, s70, 65536
    buffer_load_dwordx4 v14, s[24:27], s17 offen  lds
    s_add_u32 m0, m0, 1024
    s_add_u32 s17, s70, 98304
    buffer_load_dwordx4 v15, s[24:27], s17 offen  lds
    s_add_u32 m0, s72, 8192
    s_add_u32 s17, s70, 131072
    buffer_load_dwordx4 v12, s[20:23], s17 offen  lds
    s_add_u32 m0, m0, 1024
    s_add_u32 s17, s70, 163840
    buffer_load_dwordx4 v13, s[20:23], s17 offen  lds
    s_add_u32 m0, m0, 1024
    s_add_u32 s17, s70, 196608
    buffer_load_dwordx4 v14, s[20:23], s17 offen  lds
    s_add_u32 m0, m0, 1024
    s_add_u32 s17, s70, 229376
    buffer_load_dwordx4 v15, s[20:23], s17 offen  lds
    s_add_u32 m0, s72, 12288
    s_add_u32 s17, s70, 131072
    buffer_load_dwordx4 v12, s[24:27], s17 offen  lds
    s_add_u32 m0, m0, 1024
    s_add_u32 s17, s70, 163840
    buffer_load_dwordx4 v13, s[24:27], s17 offen  lds
    s_add_u32 m0, m0, 1024
    s_add_u32 s17, s70, 196608
    buffer_load_dwordx4 v14, s[24:27], s17 offen  lds
    s_add_u32 m0, m0, 1024
    s_add_u32 s17, s70, 229376
    buffer_load_dwordx4 v15, s[24:27], s17 offen  lds
    s_add_u32 m0, s72, 16384
    s_add_u32 s17, s70, 131072
    buffer_load_dwordx4 v12, s[28:31], s17 offen  lds
    s_add_u32 m0, m0, 1024
    s_add_u32 s17, s70, 163840
    buffer_load_dwordx4 v13, s[28:31], s17 offen  lds
    s_add_u32 m0, m0, 1024
    s_add_u32 s17, s70, 196608
    buffer_load_dwordx4 v14, s[28:31], s17 offen  lds
    s_add_u32 m0, m0, 1024
    s_add_u32 s17, s70, 229376
    buffer_load_dwordx4 v15, s[28:31], s17 offen  lds
    s_add_u32 m0, s72, 20480
    s_add_u32 s17, s70, 262144
    buffer_load_dwordx4 v12, s[20:23], s17 offen  lds
    s_add_u32 m0, m0, 1024
    s_add_u32 s17, s70, 294912
    buffer_load_dwordx4 v13, s[20:23], s17 offen  lds
    s_add_u32 m0, m0, 1024
    s_add_u32 s17, s70, 327680
    buffer_load_dwordx4 v14, s[20:23], s17 offen  lds
    s_add_u32 m0, m0, 1024
    s_add_u32 s17, s70, 360448
    buffer_load_dwordx4 v15, s[20:23], s17 offen  lds
    s_add_u32 m0, s72, 24576
    s_add_u32 s17, s70, 262144
    buffer_load_dwordx4 v12, s[24:27], s17 offen  lds
    s_add_u32 m0, m0, 1024
    s_add_u32 s17, s70, 294912
    buffer_load_dwordx4 v13, s[24:27], s17 offen  lds
    s_add_u32 m0, m0, 1024
    s_add_u32 s17, s70, 327680
    buffer_load_dwordx4 v14, s[24:27], s17 offen  lds
    s_add_u32 m0, m0, 1024
    s_add_u32 s17, s70, 360448
    buffer_load_dwordx4 v15, s[24:27], s17 offen  lds
    s_add_u32 m0, s72, 28672
    s_add_u32 s17, s70, 393216
    buffer_load_dwordx4 v12, s[20:23], s17 offen  lds
    s_add_u32 m0, m0, 1024
    s_add_u32 s17, s70, 425984
    buffer_load_dwordx4 v13, s[20:23], s17 offen  lds
    s_add_u32 m0, m0, 1024
    s_add_u32 s17, s70, 458752
    buffer_load_dwordx4 v14, s[20:23], s17 offen  lds
    s_add_u32 m0, m0, 1024
    s_add_u32 s17, s70, 491520
    buffer_load_dwordx4 v15, s[20:23], s17 offen  lds
    s_add_u32 m0, s72, 32768
    s_add_u32 s17, s71, 256
    buffer_load_dwordx4 v17, s[76:79], s17 offen lds
    s_add_u32 m0, m0, 1024
    s_add_u32 s17, s71, 37120
    buffer_load_dwordx4 v17, s[76:79], s17 offen lds
    s_waitcnt vmcnt(30)
    s_barrier
    ds_read_b64_tr_b16 v[72:73], v18 offset:0
    ds_read_b64_tr_b16 v[74:75], v18 offset:512
    ds_read_b64_tr_b16 v[76:77], v19 offset:0
    ds_read_b64_tr_b16 v[78:79], v19 offset:512
    ds_read_b64_tr_b16 v[80:81], v20 offset:0
    ds_read_b64_tr_b16 v[82:83], v20 offset:512
    ds_read_b64_tr_b16 v[84:85], v21 offset:0
    ds_read_b64_tr_b16 v[86:87], v21 offset:512
    s_waitcnt lgkmcnt(0)
    s_waitcnt vmcnt(26)
    s_barrier
    s_add_u32 m0, s72, 0
    s_add_u32 s17, s70, 393216
    buffer_load_dwordx4 v12, s[24:27], s17 offen  lds
    s_add_u32 m0, m0, 1024
    s_add_u32 s17, s70, 425984
    buffer_load_dwordx4 v13, s[24:27], s17 offen  lds
    s_add_u32 m0, m0, 1024
    s_add_u32 s17, s70, 458752
    buffer_load_dwordx4 v14, s[24:27], s17 offen  lds
    s_add_u32 m0, m0, 1024
    s_add_u32 s17, s70, 491520
    buffer_load_dwordx4 v15, s[24:27], s17 offen  lds
    ds_read_b64_tr_b16 v[184:185], v18 offset:4096
    ds_read_b64_tr_b16 v[186:187], v18 offset:4608
    ds_read_b64_tr_b16 v[188:189], v19 offset:4096
    ds_read_b64_tr_b16 v[190:191], v19 offset:4608
    ds_read_b64_tr_b16 v[192:193], v20 offset:4096
    ds_read_b64_tr_b16 v[194:195], v20 offset:4608
    ds_read_b64_tr_b16 v[196:197], v21 offset:4096
    ds_read_b64_tr_b16 v[198:199], v21 offset:4608
    s_waitcnt lgkmcnt(0)
    s_waitcnt vmcnt(26)
    s_barrier
    s_add_u32 m0, s72, 4096
    s_add_u32 s17, s70, 393216
    buffer_load_dwordx4 v12, s[28:31], s17 offen  lds
    s_add_u32 m0, m0, 1024
    s_add_u32 s17, s70, 425984
    buffer_load_dwordx4 v13, s[28:31], s17 offen  lds
    s_add_u32 m0, m0, 1024
    s_add_u32 s17, s70, 458752
    buffer_load_dwordx4 v14, s[28:31], s17 offen  lds
    s_add_u32 m0, m0, 1024
    s_add_u32 s17, s70, 491520
    buffer_load_dwordx4 v15, s[28:31], s17 offen  lds
    ds_read_b64_tr_b16 v[88:89], v18 offset:8192
    ds_read_b64_tr_b16 v[90:91], v18 offset:8704
    ds_read_b64_tr_b16 v[92:93], v19 offset:8192
    ds_read_b64_tr_b16 v[94:95], v19 offset:8704
    ds_read_b64_tr_b16 v[96:97], v20 offset:8192
    ds_read_b64_tr_b16 v[98:99], v20 offset:8704
    ds_read_b64_tr_b16 v[100:101], v21 offset:8192
    ds_read_b64_tr_b16 v[102:103], v21 offset:8704
    s_waitcnt lgkmcnt(0)
    s_waitcnt vmcnt(26)
    s_barrier
    s_add_u32 m0, s72, 8192
    s_add_u32 s17, s70, 524288
    buffer_load_dwordx4 v12, s[24:27], s17 offen  lds
    s_add_u32 m0, m0, 1024
    s_add_u32 s17, s70, 557056
    buffer_load_dwordx4 v13, s[24:27], s17 offen  lds
    s_add_u32 m0, m0, 1024
    s_add_u32 s17, s70, 589824
    buffer_load_dwordx4 v14, s[24:27], s17 offen  lds
    s_add_u32 m0, m0, 1024
    s_add_u32 s17, s70, 622592
    buffer_load_dwordx4 v15, s[24:27], s17 offen  lds
    ds_read_b64_tr_b16 v[200:201], v18 offset:12288
    ds_read_b64_tr_b16 v[202:203], v18 offset:12800
    ds_read_b64_tr_b16 v[204:205], v19 offset:12288
    ds_read_b64_tr_b16 v[206:207], v19 offset:12800
    ds_read_b64_tr_b16 v[208:209], v20 offset:12288
    ds_read_b64_tr_b16 v[210:211], v20 offset:12800
    ds_read_b64_tr_b16 v[212:213], v21 offset:12288
    ds_read_b64_tr_b16 v[214:215], v21 offset:12800
    s_waitcnt lgkmcnt(0)
    s_waitcnt vmcnt(26)
    s_barrier
    s_add_u32 m0, s72, 12288
    s_add_u32 s17, s70, 524288
    buffer_load_dwordx4 v12, s[28:31], s17 offen  lds
    s_add_u32 m0, m0, 1024
    s_add_u32 s17, s70, 557056
    buffer_load_dwordx4 v13, s[28:31], s17 offen  lds
    s_add_u32 m0, m0, 1024
    s_add_u32 s17, s70, 589824
    buffer_load_dwordx4 v14, s[28:31], s17 offen  lds
    s_add_u32 m0, m0, 1024
    s_add_u32 s17, s70, 622592
    buffer_load_dwordx4 v15, s[28:31], s17 offen  lds
    ds_read_b64_tr_b16 a[72:73], v18 offset:16384
    ds_read_b64_tr_b16 a[74:75], v18 offset:16896
    ds_read_b64_tr_b16 a[76:77], v19 offset:16384
    ds_read_b64_tr_b16 a[78:79], v19 offset:16896
    ds_read_b64_tr_b16 a[80:81], v20 offset:16384
    ds_read_b64_tr_b16 a[82:83], v20 offset:16896
    ds_read_b64_tr_b16 a[84:85], v21 offset:16384
    ds_read_b64_tr_b16 a[86:87], v21 offset:16896
    s_waitcnt lgkmcnt(0)
    s_waitcnt vmcnt(26)
    s_barrier
    s_add_u32 m0, s72, 16384
    s_add_u32 s17, s70, 655360
    buffer_load_dwordx4 v12, s[20:23], s17 offen  lds
    s_add_u32 m0, m0, 1024
    s_add_u32 s17, s70, 688128
    buffer_load_dwordx4 v13, s[20:23], s17 offen  lds
    s_add_u32 m0, m0, 1024
    s_add_u32 s17, s70, 720896
    buffer_load_dwordx4 v14, s[20:23], s17 offen  lds
    s_add_u32 m0, m0, 1024
    s_add_u32 s17, s70, 753664
    buffer_load_dwordx4 v15, s[20:23], s17 offen  lds
    ds_read_b64_tr_b16 v[104:105], v18 offset:20480
    ds_read_b64_tr_b16 v[106:107], v18 offset:20992
    ds_read_b64_tr_b16 v[108:109], v19 offset:20480
    ds_read_b64_tr_b16 v[110:111], v19 offset:20992
    ds_read_b64_tr_b16 v[112:113], v20 offset:20480
    ds_read_b64_tr_b16 v[114:115], v20 offset:20992
    ds_read_b64_tr_b16 v[116:117], v21 offset:20480
    ds_read_b64_tr_b16 v[118:119], v21 offset:20992
    s_waitcnt lgkmcnt(0)
    s_waitcnt vmcnt(26)
    s_barrier
    s_add_u32 m0, s72, 20480
    s_add_u32 s17, s70, 655360
    buffer_load_dwordx4 v12, s[24:27], s17 offen  lds
    s_add_u32 m0, m0, 1024
    s_add_u32 s17, s70, 688128
    buffer_load_dwordx4 v13, s[24:27], s17 offen  lds
    s_add_u32 m0, m0, 1024
    s_add_u32 s17, s70, 720896
    buffer_load_dwordx4 v14, s[24:27], s17 offen  lds
    s_add_u32 m0, m0, 1024
    s_add_u32 s17, s70, 753664
    buffer_load_dwordx4 v15, s[24:27], s17 offen  lds
    ds_read_b64_tr_b16 v[216:217], v18 offset:24576
    ds_read_b64_tr_b16 v[218:219], v18 offset:25088
    ds_read_b64_tr_b16 v[220:221], v19 offset:24576
    ds_read_b64_tr_b16 v[222:223], v19 offset:25088
    ds_read_b64_tr_b16 v[224:225], v20 offset:24576
    ds_read_b64_tr_b16 v[226:227], v20 offset:25088
    ds_read_b64_tr_b16 v[228:229], v21 offset:24576
    ds_read_b64_tr_b16 v[230:231], v21 offset:25088
    s_waitcnt lgkmcnt(0)
    s_waitcnt vmcnt(26)
    s_barrier
    s_add_u32 m0, s72, 24576
    s_add_u32 s17, s70, 655360
    buffer_load_dwordx4 v12, s[28:31], s17 offen  lds
    s_add_u32 m0, m0, 1024
    s_add_u32 s17, s70, 688128
    buffer_load_dwordx4 v13, s[28:31], s17 offen  lds
    s_add_u32 m0, m0, 1024
    s_add_u32 s17, s70, 720896
    buffer_load_dwordx4 v14, s[28:31], s17 offen  lds
    s_add_u32 m0, m0, 1024
    s_add_u32 s17, s70, 753664
    buffer_load_dwordx4 v15, s[28:31], s17 offen  lds
    ds_read_b64_tr_b16 v[120:121], v18 offset:28672
    ds_read_b64_tr_b16 v[122:123], v18 offset:29184
    ds_read_b64_tr_b16 v[124:125], v19 offset:28672
    ds_read_b64_tr_b16 v[126:127], v19 offset:29184
    ds_read_b64_tr_b16 v[128:129], v20 offset:28672
    ds_read_b64_tr_b16 v[130:131], v20 offset:29184
    ds_read_b64_tr_b16 v[132:133], v21 offset:28672
    ds_read_b64_tr_b16 v[134:135], v21 offset:29184
    s_waitcnt lgkmcnt(0)
    s_waitcnt vmcnt(24)
    s_barrier
    s_add_u32 m0, s72, 28672
    s_add_u32 s17, s70, 786432
    buffer_load_dwordx4 v12, s[24:27], s17 offen  lds
    s_add_u32 m0, m0, 1024
    s_add_u32 s17, s70, 819200
    buffer_load_dwordx4 v13, s[24:27], s17 offen  lds
    s_add_u32 m0, m0, 1024
    s_add_u32 s17, s70, 851968
    buffer_load_dwordx4 v14, s[24:27], s17 offen  lds
    s_add_u32 m0, m0, 1024
    s_add_u32 s17, s70, 884736
    buffer_load_dwordx4 v15, s[24:27], s17 offen  lds
    ds_read_b64_tr_b16 v[232:233], v18 offset:0
    ds_read_b64_tr_b16 v[234:235], v18 offset:512
    ds_read_b64_tr_b16 v[236:237], v19 offset:0
    ds_read_b64_tr_b16 v[238:239], v19 offset:512
    ds_read_b64_tr_b16 v[240:241], v20 offset:0
    ds_read_b64_tr_b16 v[242:243], v20 offset:512
    ds_read_b64_tr_b16 v[244:245], v21 offset:0
    ds_read_b64_tr_b16 v[246:247], v21 offset:512
    s_waitcnt lgkmcnt(0)
    s_waitcnt vmcnt(24)
    s_barrier
    s_add_u32 m0, s72, 0
    s_add_u32 s17, s70, 786432
    buffer_load_dwordx4 v12, s[28:31], s17 offen  lds
    s_add_u32 m0, m0, 1024
    s_add_u32 s17, s70, 819200
    buffer_load_dwordx4 v13, s[28:31], s17 offen  lds
    s_add_u32 m0, m0, 1024
    s_add_u32 s17, s70, 851968
    buffer_load_dwordx4 v14, s[28:31], s17 offen  lds
    s_add_u32 m0, m0, 1024
    s_add_u32 s17, s70, 884736
    buffer_load_dwordx4 v15, s[28:31], s17 offen  lds
    ds_read_b64_tr_b16 a[88:89], v18 offset:4096
    ds_read_b64_tr_b16 a[90:91], v18 offset:4608
    ds_read_b64_tr_b16 a[92:93], v19 offset:4096
    ds_read_b64_tr_b16 a[94:95], v19 offset:4608
    ds_read_b64_tr_b16 a[96:97], v20 offset:4096
    ds_read_b64_tr_b16 a[98:99], v20 offset:4608
    ds_read_b64_tr_b16 a[100:101], v21 offset:4096
    ds_read_b64_tr_b16 a[102:103], v21 offset:4608
    s_waitcnt lgkmcnt(0)
    s_waitcnt vmcnt(24)
    s_barrier
    s_add_u32 m0, s72, 4096
    s_add_u32 s17, s70, 917504
    buffer_load_dwordx4 v12, s[20:23], s17 offen  lds
    s_add_u32 m0, m0, 1024
    s_add_u32 s17, s70, 950272
    buffer_load_dwordx4 v13, s[20:23], s17 offen  lds
    s_add_u32 m0, m0, 1024
    s_add_u32 s17, s70, 983040
    buffer_load_dwordx4 v14, s[20:23], s17 offen  lds
    s_add_u32 m0, m0, 1024
    s_add_u32 s17, s70, 1015808
    buffer_load_dwordx4 v15, s[20:23], s17 offen  lds
    ds_read_b64_tr_b16 v[248:249], v18 offset:8192
    ds_read_b64_tr_b16 v[250:251], v18 offset:8704
    ds_read_b64_tr_b16 v[252:253], v19 offset:8192
    ds_read_b64_tr_b16 v[254:255], v19 offset:8704
    ds_read_b64_tr_b16 a[0:1], v20 offset:8192
    ds_read_b64_tr_b16 a[2:3], v20 offset:8704
    ds_read_b64_tr_b16 a[4:5], v21 offset:8192
    ds_read_b64_tr_b16 a[6:7], v21 offset:8704
    s_waitcnt lgkmcnt(0)
    s_waitcnt vmcnt(24)
    s_barrier
    s_add_u32 m0, s72, 8192
    s_add_u32 s17, s70, 917504
    buffer_load_dwordx4 v12, s[24:27], s17 offen  lds
    s_add_u32 m0, m0, 1024
    s_add_u32 s17, s70, 950272
    buffer_load_dwordx4 v13, s[24:27], s17 offen  lds
    s_add_u32 m0, m0, 1024
    s_add_u32 s17, s70, 983040
    buffer_load_dwordx4 v14, s[24:27], s17 offen  lds
    s_add_u32 m0, m0, 1024
    s_add_u32 s17, s70, 1015808
    buffer_load_dwordx4 v15, s[24:27], s17 offen  lds
    ds_read_b64_tr_b16 a[104:105], v18 offset:12288
    ds_read_b64_tr_b16 a[106:107], v18 offset:12800
    ds_read_b64_tr_b16 a[108:109], v19 offset:12288
    ds_read_b64_tr_b16 a[110:111], v19 offset:12800
    ds_read_b64_tr_b16 a[112:113], v20 offset:12288
    ds_read_b64_tr_b16 a[114:115], v20 offset:12800
    ds_read_b64_tr_b16 a[116:117], v21 offset:12288
    ds_read_b64_tr_b16 a[118:119], v21 offset:12800
    s_waitcnt lgkmcnt(0)
    s_waitcnt vmcnt(24)
    s_barrier
    s_add_u32 m0, s72, 12288
    s_add_u32 s17, s70, 917504
    buffer_load_dwordx4 v12, s[28:31], s17 offen  lds
    s_add_u32 m0, m0, 1024
    s_add_u32 s17, s70, 950272
    buffer_load_dwordx4 v13, s[28:31], s17 offen  lds
    s_add_u32 m0, m0, 1024
    s_add_u32 s17, s70, 983040
    buffer_load_dwordx4 v14, s[28:31], s17 offen  lds
    s_add_u32 m0, m0, 1024
    s_add_u32 s17, s70, 1015808
    buffer_load_dwordx4 v15, s[28:31], s17 offen  lds
    ds_read_b64_tr_b16 v[136:137], v18 offset:16384
    ds_read_b64_tr_b16 v[138:139], v18 offset:16896
    ds_read_b64_tr_b16 v[140:141], v19 offset:16384
    ds_read_b64_tr_b16 v[142:143], v19 offset:16896
    ds_read_b64_tr_b16 v[144:145], v20 offset:16384
    ds_read_b64_tr_b16 v[146:147], v20 offset:16896
    ds_read_b64_tr_b16 v[148:149], v21 offset:16384
    ds_read_b64_tr_b16 v[150:151], v21 offset:16896
    s_waitcnt lgkmcnt(0)
    s_add_u32 s17, s32, s14
    s_cmp_lg_u32 s17, 0
    s_cbranch_scc1 Lr_nold
    v_mov_b32 v63, 48
    v_mov_b32 v64, 1
    s_mov_b64 exec, 1
    global_atomic_add v63, v64, s[12:13]
    s_mov_b64 exec, -1
Lr_nold:
    s_waitcnt vmcnt(24)
    s_barrier
    s_add_u32 m0, s72, 16384
    s_add_u32 s17, s70, 1048576
    buffer_load_dwordx4 v12, s[20:23], s17 offen  lds
    s_add_u32 m0, m0, 1024
    s_add_u32 s17, s70, 1081344
    buffer_load_dwordx4 v13, s[20:23], s17 offen  lds
    s_add_u32 m0, m0, 1024
    s_add_u32 s17, s70, 1114112
    buffer_load_dwordx4 v14, s[20:23], s17 offen  lds
    s_add_u32 m0, m0, 1024
    s_add_u32 s17, s70, 1146880
    buffer_load_dwordx4 v15, s[20:23], s17 offen  lds
    ds_read_b64_tr_b16 a[8:9], v18 offset:20480
    ds_read_b64_tr_b16 a[10:11], v18 offset:20992
    ds_read_b64_tr_b16 a[12:13], v19 offset:20480
    ds_read_b64_tr_b16 a[14:15], v19 offset:20992
    ds_read_b64_tr_b16 a[16:17], v20 offset:20480
    ds_read_b64_tr_b16 a[18:19], v20 offset:20992
    ds_read_b64_tr_b16 a[20:21], v21 offset:20480
    ds_read_b64_tr_b16 a[22:23], v21 offset:20992
    s_waitcnt lgkmcnt(0)
    s_waitcnt vmcnt(24)
    s_barrier
    s_add_u32 m0, s72, 20480
    s_add_u32 s17, s70, 1048576
    buffer_load_dwordx4 v12, s[24:27], s17 offen  lds
    s_add_u32 m0, m0, 1024
    s_add_u32 s17, s70, 1081344
    buffer_load_dwordx4 v13, s[24:27], s17 offen  lds
    s_add_u32 m0, m0, 1024
    s_add_u32 s17, s70, 1114112
    buffer_load_dwordx4 v14, s[24:27], s17 offen  lds
    s_add_u32 m0, m0, 1024
    s_add_u32 s17, s70, 1146880
    buffer_load_dwordx4 v15, s[24:27], s17 offen  lds
    ds_read_b64_tr_b16 a[120:121], v18 offset:24576
    ds_read_b64_tr_b16 a[122:123], v18 offset:25088
    ds_read_b64_tr_b16 a[124:125], v19 offset:24576
    ds_read_b64_tr_b16 a[126:127], v19 offset:25088
    ds_read_b64_tr_b16 a[128:129], v20 offset:24576
    ds_read_b64_tr_b16 a[130:131], v20 offset:25088
    ds_read_b64_tr_b16 a[132:133], v21 offset:24576
    ds_read_b64_tr_b16 a[134:135], v21 offset:25088
    s_waitcnt lgkmcnt(0)
    s_waitcnt vmcnt(24)
    s_barrier
    s_add_u32 m0, s72, 24576
    s_add_u32 s17, s70, 1048576
    buffer_load_dwordx4 v12, s[28:31], s17 offen  lds
    s_add_u32 m0, m0, 1024
    s_add_u32 s17, s70, 1081344
    buffer_load_dwordx4 v13, s[28:31], s17 offen  lds
    s_add_u32 m0, m0, 1024
    s_add_u32 s17, s70, 1114112
    buffer_load_dwordx4 v14, s[28:31], s17 offen  lds
    s_add_u32 m0, m0, 1024
    s_add_u32 s17, s70, 1146880
    buffer_load_dwordx4 v15, s[28:31], s17 offen  lds
    ds_read_b64_tr_b16 a[24:25], v18 offset:28672
    ds_read_b64_tr_b16 a[26:27], v18 offset:29184
    ds_read_b64_tr_b16 a[28:29], v19 offset:28672
    ds_read_b64_tr_b16 a[30:31], v19 offset:29184
    ds_read_b64_tr_b16 a[32:33], v20 offset:28672
    ds_read_b64_tr_b16 a[34:35], v20 offset:29184
    ds_read_b64_tr_b16 a[36:37], v21 offset:28672
    ds_read_b64_tr_b16 a[38:39], v21 offset:29184
    s_waitcnt lgkmcnt(0)
    s_waitcnt vmcnt(24)
    s_barrier
    ds_read_b64_tr_b16 a[136:137], v18 offset:0
    ds_read_b64_tr_b16 a[138:139], v18 offset:512
    ds_read_b64_tr_b16 a[140:141], v19 offset:0
    ds_read_b64_tr_b16 a[142:143], v19 offset:512
    ds_read_b64_tr_b16 a[144:145], v20 offset:0
    ds_read_b64_tr_b16 a[146:147], v20 offset:512
    ds_read_b64_tr_b16 a[148:149], v21 offset:0
    ds_read_b64_tr_b16 a[150:151], v21 offset:512
    s_waitcnt lgkmcnt(0)
    s_waitcnt vmcnt(20)
    s_barrier
    s_add_u32 m0, s72, 0
    s_add_u32 s17, s70, 0
    buffer_load_dwordx4 v12, s[28:31], s17 offen  lds
    s_add_u32 m0, m0, 1024
    s_add_u32 s17, s70, 32768
    buffer_load_dwordx4 v13, s[28:31], s17 offen  lds
    s_add_u32 m0, m0, 1024
    s_add_u32 s17, s70, 65536
    buffer_load_dwordx4 v14, s[28:31], s17 offen  lds
    s_add_u32 m0, m0, 1024
    s_add_u32 s17, s70, 98304
    buffer_load_dwordx4 v15, s[28:31], s17 offen  lds
    ds_read_b64_tr_b16 v[152:153], v18 offset:4096
    ds_read_b64_tr_b16 v[154:155], v18 offset:4608
    ds_read_b64_tr_b16 v[156:157], v19 offset:4096
    ds_read_b64_tr_b16 v[158:159], v19 offset:4608
    ds_read_b64_tr_b16 v[160:161], v20 offset:4096
    ds_read_b64_tr_b16 v[162:163], v20 offset:4608
    ds_read_b64_tr_b16 v[164:165], v21 offset:4096
    ds_read_b64_tr_b16 v[166:167], v21 offset:4608
    s_waitcnt lgkmcnt(0)
    s_waitcnt vmcnt(20)
    s_barrier
    s_add_u32 m0, s72, 4096
    s_add_u32 s17, s70, 262144
    buffer_load_dwordx4 v12, s[28:31], s17 offen  lds
    s_add_u32 m0, m0, 1024
    s_add_u32 s17, s70, 294912
    buffer_load_dwordx4 v13, s[28:31], s17 offen  lds
    s_add_u32 m0, m0, 1024
    s_add_u32 s17, s70, 327680
    buffer_load_dwordx4 v14, s[28:31], s17 offen  lds
    s_add_u32 m0, m0, 1024
    s_add_u32 s17, s70, 360448
    buffer_load_dwordx4 v15, s[28:31], s17 offen  lds
    ds_read_b64_tr_b16 a[40:41], v18 offset:8192
    ds_read_b64_tr_b16 a[42:43], v18 offset:8704
    ds_read_b64_tr_b16 a[44:45], v19 offset:8192
    ds_read_b64_tr_b16 a[46:47], v19 offset:8704
    ds_read_b64_tr_b16 a[48:49], v20 offset:8192
    ds_read_b64_tr_b16 a[50:51], v20 offset:8704
    ds_read_b64_tr_b16 a[52:53], v21 offset:8192
    ds_read_b64_tr_b16 a[54:55], v21 offset:8704
    s_waitcnt lgkmcnt(0)
    s_waitcnt vmcnt(20)
    s_barrier
    s_add_u32 m0, s72, 8192
    s_add_u32 s17, s70, 524288
    buffer_load_dwordx4 v12, s[20:23], s17 offen  lds
    s_add_u32 m0, m0, 1024
    s_add_u32 s17, s70, 557056
    buffer_load_dwordx4 v13, s[20:23], s17 offen  lds
    s_add_u32 m0, m0, 1024
    s_add_u32 s17, s70, 589824
    buffer_load_dwordx4 v14, s[20:23], s17 offen  lds
    s_add_u32 m0, m0, 1024
    s_add_u32 s17, s70, 622592
    buffer_load_dwordx4 v15, s[20:23], s17 offen  lds
    ds_read_b64_tr_b16 a[152:153], v18 offset:12288
    ds_read_b64_tr_b16 a[154:155], v18 offset:12800
    ds_read_b64_tr_b16 a[156:157], v19 offset:12288
    ds_read_b64_tr_b16 a[158:159], v19 offset:12800
    ds_read_b64_tr_b16 a[160:161], v20 offset:12288
    ds_read_b64_tr_b16 a[162:163], v20 offset:12800
    ds_read_b64_tr_b16 a[164:165], v21 offset:12288
    ds_read_b64_tr_b16 a[166:167], v21 offset:12800
    s_waitcnt lgkmcnt(0)
    s_waitcnt vmcnt(20)
    s_barrier
    s_add_u32 m0, s72, 12288
    s_add_u32 s17, s70, 786432
    buffer_load_dwordx4 v12, s[20:23], s17 offen  lds
    s_add_u32 m0, m0, 1024
    s_add_u32 s17, s70, 819200
    buffer_load_dwordx4 v13, s[20:23], s17 offen  lds
    s_add_u32 m0, m0, 1024
    s_add_u32 s17, s70, 851968
    buffer_load_dwordx4 v14, s[20:23], s17 offen  lds
    s_add_u32 m0, m0, 1024
    s_add_u32 s17, s70, 884736
    buffer_load_dwordx4 v15, s[20:23], s17 offen  lds
    ds_read_b64_tr_b16 v[168:169], v18 offset:16384
    ds_read_b64_tr_b16 v[170:171], v18 offset:16896
    ds_read_b64_tr_b16 v[172:173], v19 offset:16384
    ds_read_b64_tr_b16 v[174:175], v19 offset:16896
    ds_read_b64_tr_b16 v[176:177], v20 offset:16384
    ds_read_b64_tr_b16 v[178:179], v20 offset:16896
    ds_read_b64_tr_b16 v[180:181], v21 offset:16384
    ds_read_b64_tr_b16 v[182:183], v21 offset:16896
    s_waitcnt lgkmcnt(0)
    s_waitcnt vmcnt(20)
    s_barrier
    s_add_u32 m0, s72, 16384
    s_add_u32 s17, s71, 0
    buffer_load_dwordx4 v16, s[76:79], s17 offen  lds
    s_add_u32 m0, m0, 1024
    s_add_u32 s17, s71, 18432
    buffer_load_dwordx4 v16, s[76:79], s17 offen  lds
    s_add_u32 m0, m0, 1024
    s_add_u32 s17, s71, 36864
    buffer_load_dwordx4 v16, s[76:79], s17 offen  lds
    s_add_u32 m0, m0, 1024
    s_add_u32 s17, s71, 55296
    buffer_load_dwordx4 v16, s[76:79], s17 offen  lds
    ds_read_b64_tr_b16 a[56:57], v18 offset:20480
    ds_read_b64_tr_b16 a[58:59], v18 offset:20992
    ds_read_b64_tr_b16 a[60:61], v19 offset:20480
    ds_read_b64_tr_b16 a[62:63], v19 offset:20992
    ds_read_b64_tr_b16 a[64:65], v20 offset:20480
    ds_read_b64_tr_b16 a[66:67], v20 offset:20992
    ds_read_b64_tr_b16 a[68:69], v21 offset:20480
    ds_read_b64_tr_b16 a[70:71], v21 offset:20992
    s_waitcnt lgkmcnt(0)
    s_waitcnt vmcnt(20)
    s_barrier
    s_add_u32 m0, s72, 20480
    s_add_u32 s17, s71, 73728
    buffer_load_dwordx4 v16, s[76:79], s17 offen  lds
    s_add_u32 m0, m0, 1024
    s_add_u32 s17, s71, 92160
    buffer_load_dwordx4 v16, s[76:79], s17 offen  lds
    s_add_u32 m0, m0, 1024
    s_add_u32 s17, s71, 110592
    buffer_load_dwordx4 v16, s[76:79], s17 offen  lds
    s_add_u32 m0, m0, 1024
    s_add_u32 s17, s71, 129024
    buffer_load_dwordx4 v16, s[76:79], s17 offen  lds
    ds_read_b64_tr_b16 a[168:169], v18 offset:24576
    ds_read_b64_tr_b16 a[170:171], v18 offset:25088
    ds_read_b64_tr_b16 a[172:173], v19 offset:24576
    ds_read_b64_tr_b16 a[174:175], v19 offset:25088
    ds_read_b64_tr_b16 a[176:177], v20 offset:24576
    ds_read_b64_tr_b16 a[178:179], v20 offset:25088
    ds_read_b64_tr_b16 a[180:181], v21 offset:24576
    ds_read_b64_tr_b16 a[182:183], v21 offset:25088
    s_waitcnt lgkmcnt(0)
    s_waitcnt vmcnt(20)
    s_barrier
    s_add_u32 m0, s72, 24576
    s_add_u32 s17, s71, 64
    buffer_load_dwordx4 v16, s[76:79], s17 offen  lds
    s_add_u32 m0, m0, 1024
    s_add_u32 s17, s71, 18496
    buffer_load_dwordx4 v16, s[76:79], s17 offen  lds
    s_add_u32 m0, m0, 1024
    s_add_u32 s17, s71, 36928
    buffer_load_dwordx4 v16, s[76:79], s17 offen  lds
    s_add_u32 m0, m0, 1024
    s_add_u32 s17, s71, 55360
    buffer_load_dwordx4 v16, s[76:79], s17 offen  lds
    s_add_u32 m0, s72, 28672
    s_add_u32 s17, s71, 73792
    buffer_load_dwordx4 v16, s[76:79], s17 offen  lds
    s_add_u32 m0, m0, 1024
    s_add_u32 s17, s71, 92224
    buffer_load_dwordx4 v16, s[76:79], s17 offen  lds
    s_add_u32 m0, m0, 1024
    s_add_u32 s17, s71, 110656
    buffer_load_dwordx4 v16, s[76:79], s17 offen  lds
    s_add_u32 m0, m0, 1024
    s_add_u32 s17, s71, 129088
    buffer_load_dwordx4 v16, s[76:79], s17 offen  lds
    ds_read_b64_tr_b16 v[24:25], v18 offset:0
    ds_read_b64_tr_b16 v[26:27], v18 offset:512
    ds_read_b64_tr_b16 v[28:29], v19 offset:0
    ds_read_b64_tr_b16 v[30:31], v19 offset:512
    ds_read_b64_tr_b16 v[32:33], v20 offset:0
    ds_read_b64_tr_b16 v[34:35], v20 offset:512
    ds_read_b64_tr_b16 v[36:37], v21 offset:0
    ds_read_b64_tr_b16 v[38:39], v21 offset:512
    s_waitcnt lgkmcnt(0)
    s_barrier
    ds_write_b128 v8, v[24:27] offset:0
    ds_write_b128 v8, v[28:31] offset:1024
    ds_write_b128 v8, v[32:35] offset:2048
    ds_write_b128 v8, v[36:39] offset:3072
    s_waitcnt lgkmcnt(0)
    s_waitcnt vmcnt(24)
    s_barrier
    ds_read_b64_tr_b16 v[24:25], v18 offset:4096
    ds_read_b64_tr_b16 v[26:27], v18 offset:4608
    ds_read_b64_tr_b16 v[28:29], v19 offset:4096
    ds_read_b64_tr_b16 v[30:31], v19 offset:4608
    ds_read_b64_tr_b16 v[32:33], v20 offset:4096
    ds_read_b64_tr_b16 v[34:35], v20 offset:4608
    ds_read_b64_tr_b16 v[36:37], v21 offset:4096
    ds_read_b64_tr_b16 v[38:39], v21 offset:4608
    s_waitcnt lgkmcnt(0)
    s_barrier
    ds_write_b128 v8, v[24:27] offset:4096
    ds_write_b128 v8, v[28:31] offset:5120
    ds_write_b128 v8, v[32:35] offset:6144
    ds_write_b128 v8, v[36:39] offset:7168
    s_waitcnt lgkmcnt(0)
    s_waitcnt vmcnt(20)
    s_barrier
    ds_read_b64_tr_b16 v[24:25], v18 offset:8192
    ds_read_b64_tr_b16 v[26:27], v18 offset:8704
    ds_read_b64_tr_b16 v[28:29], v19 offset:8192
    ds_read_b64_tr_b16 v[30:31], v19 offset:8704
    ds_read_b64_tr_b16 v[32:33], v20 offset:8192
    ds_read_b64_tr_b16 v[34:35], v20 offset:8704
    ds_read_b64_tr_b16 v[36:37], v21 offset:8192
    ds_read_b64_tr_b16 v[38:39], v21 offset:8704
    s_waitcnt lgkmcnt(0)
    s_barrier
    ds_write_b128 v8, v[24:27] offset:8192
    ds_write_b128 v8, v[28:31] offset:9216
    ds_write_b128 v8, v[32:35] offset:10240
    ds_write_b128 v8, v[36:39] offset:11264
    s_waitcnt lgkmcnt(0)
    s_waitcnt vmcnt(16)
    s_barrier
    ds_read_b64_tr_b16 v[24:25], v18 offset:12288
    ds_read_b64_tr_b16 v[26:27], v18 offset:12800
    ds_read_b64_tr_b16 v[28:29], v19 offset:12288
    ds_read_b64_tr_b16 v[30:31], v19 offset:12800
    ds_read_b64_tr_b16 v[32:33], v20 offset:12288
    ds_read_b64_tr_b16 v[34:35], v20 offset:12800
    ds_read_b64_tr_b16 v[36:37], v21 offset:12288
    ds_read_b64_tr_b16 v[38:39], v21 offset:12800
    s_waitcnt lgkmcnt(0)
    s_barrier
    ds_write_b128 v8, v[24:27] offset:12288
    ds_write_b128 v8, v[28:31] offset:13312
    ds_write_b128 v8, v[32:35] offset:14336
    ds_write_b128 v8, v[36:39] offset:15360
    s_waitcnt lgkmcnt(0)
    s_barrier
    s_waitcnt vmcnt(12)
    ds_read_b64_tr_b16 a[184:185], v22 offset:16384
    ds_read_b64_tr_b16 a[186:187], v22 offset:16448
    ds_read_b64_tr_b16 a[188:189], v22 offset:18432
    ds_read_b64_tr_b16 a[190:191], v22 offset:18496
    ds_read_b64_tr_b16 a[200:201], v22 offset:16416
    ds_read_b64_tr_b16 a[202:203], v22 offset:16480
    ds_read_b64_tr_b16 a[204:205], v22 offset:18464
    ds_read_b64_tr_b16 a[206:207], v22 offset:18528
    s_waitcnt lgkmcnt(0)
    s_add_u32 m0, s72, 16384
    s_add_u32 s17, s71, 128
    buffer_load_dwordx4 v16, s[76:79], s17 offen  lds
    s_add_u32 m0, m0, 1024
    s_add_u32 s17, s71, 18560
    buffer_load_dwordx4 v16, s[76:79], s17 offen  lds
    s_add_u32 m0, m0, 1024
    s_add_u32 s17, s71, 36992
    buffer_load_dwordx4 v16, s[76:79], s17 offen  lds
    s_add_u32 m0, m0, 1024
    s_add_u32 s17, s71, 55424
    buffer_load_dwordx4 v16, s[76:79], s17 offen  lds
    s_waitcnt vmcnt(12)
    ds_read_b64_tr_b16 a[192:193], v22 offset:20480
    ds_read_b64_tr_b16 a[194:195], v22 offset:20544
    ds_read_b64_tr_b16 a[196:197], v22 offset:22528
    ds_read_b64_tr_b16 a[198:199], v22 offset:22592
    ds_read_b64_tr_b16 a[208:209], v22 offset:20512
    ds_read_b64_tr_b16 a[210:211], v22 offset:20576
    ds_read_b64_tr_b16 a[212:213], v22 offset:22560
    ds_read_b64_tr_b16 a[214:215], v22 offset:22624
    s_waitcnt lgkmcnt(0)
    s_add_u32 m0, s72, 20480
    s_add_u32 s17, s71, 73856
    buffer_load_dwordx4 v16, s[76:79], s17 offen  lds
    s_add_u32 m0, m0, 1024
    s_add_u32 s17, s71, 92288
    buffer_load_dwordx4 v16, s[76:79], s17 offen  lds
    s_add_u32 m0, m0, 1024
    s_add_u32 s17, s71, 110720
    buffer_load_dwordx4 v16, s[76:79], s17 offen  lds
    s_add_u32 m0, m0, 1024
    s_add_u32 s17, s71, 129152
    buffer_load_dwordx4 v16, s[76:79], s17 offen  lds
    s_waitcnt vmcnt(12)
    ds_read_b64_tr_b16 a[216:217], v22 offset:24576
    ds_read_b64_tr_b16 a[218:219], v22 offset:24640
    ds_read_b64_tr_b16 a[220:221], v22 offset:26624
    ds_read_b64_tr_b16 a[222:223], v22 offset:26688
    ds_read_b64_tr_b16 a[232:233], v22 offset:24608
    ds_read_b64_tr_b16 a[234:235], v22 offset:24672
    ds_read_b64_tr_b16 a[236:237], v22 offset:26656
    ds_read_b64_tr_b16 a[238:239], v22 offset:26720
    s_waitcnt lgkmcnt(0)
    s_add_u32 m0, s72, 24576
    s_add_u32 s17, s71, 192
    buffer_load_dwordx4 v16, s[76:79], s17 offen  lds
    s_add_u32 m0, m0, 1024
    s_add_u32 s17, s71, 18624
    buffer_load_dwordx4 v16, s[76:79], s17 offen  lds
    s_add_u32 m0, m0, 1024
    s_add_u32 s17, s71, 37056
    buffer_load_dwordx4 v16, s[76:79], s17 offen  lds
    s_add_u32 m0, m0, 1024
    s_add_u32 s17, s71, 55488
    buffer_load_dwordx4 v16, s[76:79], s17 offen  lds
    s_waitcnt vmcnt(12)
    ds_read_b64_tr_b16 a[224:225], v22 offset:28672
    ds_read_b64_tr_b16 a[226:227], v22 offset:28736
    ds_read_b64_tr_b16 a[228:229], v22 offset:30720
    ds_read_b64_tr_b16 a[230:231], v22 offset:30784
    ds_read_b64_tr_b16 a[240:241], v22 offset:28704
    ds_read_b64_tr_b16 a[242:243], v22 offset:28768
    ds_read_b64_tr_b16 a[244:245], v22 offset:30752
    ds_read_b64_tr_b16 a[246:247], v22 offset:30816
    s_waitcnt lgkmcnt(0)
    s_add_u32 m0, s72, 28672
    s_add_u32 s17, s71, 73920
    buffer_load_dwordx4 v16, s[76:79], s17 offen  lds
    s_add_u32 m0, m0, 1024
    s_add_u32 s17, s71, 92352
    buffer_load_dwordx4 v16, s[76:79], s17 offen  lds
    s_add_u32 m0, m0, 1024
    s_add_u32 s17, s71, 110784
    buffer_load_dwordx4 v16, s[76:79], s17 offen  lds
    s_add_u32 m0, m0, 1024
    s_add_u32 s17, s71, 129216
    buffer_load_dwordx4 v16, s[76:79], s17 offen  lds
    s_waitcnt vmcnt(63)
    ds_read_b64_tr_b16 a[248:249], v23 offset:32768
    ds_read_b64_tr_b16 a[250:251], v23 offset:32800
    ds_read_b64_tr_b16 a[252:253], v23 offset:33792
    ds_read_b64_tr_b16 a[254:255], v23 offset:33824
    s_waitcnt lgkmcnt(0)
    s_add_u32 m0, s72, 32768
    s_add_u32 s17, s71, 73984
    buffer_load_dwordx4 v17, s[76:79], s17 offen lds
    s_add_u32 m0, m0, 1024
    s_add_u32 s17, s71, 110848
    buffer_load_dwordx4 v17, s[76:79], s17 offen lds
    s_waitcnt vmcnt(14)
    ds_read_b64_tr_b16 v[24:25], v22 offset:16384
    ds_read_b64_tr_b16 v[26:27], v22 offset:16448
    ds_read_b64_tr_b16 v[28:29], v22 offset:18432
    ds_read_b64_tr_b16 v[30:31], v22 offset:18496
    ds_read_b64_tr_b16 v[32:33], v22 offset:16416
    ds_read_b64_tr_b16 v[34:35], v22 offset:16480
    ds_read_b64_tr_b16 v[36:37], v22 offset:18464
    ds_read_b64_tr_b16 v[38:39], v22 offset:18528
    s_waitcnt lgkmcnt(0)
    ds_write_b128 v8, v[24:27] offset:16384
    ds_write_b128 v8, v[28:31] offset:17408
    ds_write_b128 v8, v[32:35] offset:18432
    ds_write_b128 v8, v[36:39] offset:19456
    s_waitcnt lgkmcnt(0)
    s_waitcnt vmcnt(10)
    ds_read_b64_tr_b16 v[24:25], v22 offset:20480
    ds_read_b64_tr_b16 v[26:27], v22 offset:20544
    ds_read_b64_tr_b16 v[28:29], v22 offset:22528
    ds_read_b64_tr_b16 v[30:31], v22 offset:22592
    ds_read_b64_tr_b16 v[32:33], v22 offset:20512
    ds_read_b64_tr_b16 v[34:35], v22 offset:20576
    ds_read_b64_tr_b16 v[36:37], v22 offset:22560
    ds_read_b64_tr_b16 v[38:39], v22 offset:22624
    s_waitcnt lgkmcnt(0)
    ds_write_b128 v8, v[24:27] offset:20480
    ds_write_b128 v8, v[28:31] offset:21504
    ds_write_b128 v8, v[32:35] offset:22528
    ds_write_b128 v8, v[36:39] offset:23552
    s_waitcnt lgkmcnt(0)
    s_waitcnt vmcnt(6)
    ds_read_b64_tr_b16 v[24:25], v22 offset:24576
    ds_read_b64_tr_b16 v[26:27], v22 offset:24640
    ds_read_b64_tr_b16 v[28:29], v22 offset:26624
    ds_read_b64_tr_b16 v[30:31], v22 offset:26688
    ds_read_b64_tr_b16 v[32:33], v22 offset:24608
    ds_read_b64_tr_b16 v[34:35], v22 offset:24672
    ds_read_b64_tr_b16 v[36:37], v22 offset:26656
    ds_read_b64_tr_b16 v[38:39], v22 offset:26720
    s_waitcnt lgkmcnt(0)
    ds_write_b128 v8, v[24:27] offset:24576
    ds_write_b128 v8, v[28:31] offset:25600
    ds_write_b128 v8, v[32:35] offset:26624
    ds_write_b128 v8, v[36:39] offset:27648
    s_waitcnt lgkmcnt(0)
    s_waitcnt vmcnt(2)
    ds_read_b64_tr_b16 v[24:25], v22 offset:28672
    ds_read_b64_tr_b16 v[26:27], v22 offset:28736
    ds_read_b64_tr_b16 v[28:29], v22 offset:30720
    ds_read_b64_tr_b16 v[30:31], v22 offset:30784
    ds_read_b64_tr_b16 v[32:33], v22 offset:28704
    ds_read_b64_tr_b16 v[34:35], v22 offset:28768
    ds_read_b64_tr_b16 v[36:37], v22 offset:30752
    ds_read_b64_tr_b16 v[38:39], v22 offset:30816
    s_waitcnt lgkmcnt(0)
    ds_write_b128 v8, v[24:27] offset:28672
    ds_write_b128 v8, v[28:31] offset:29696
    ds_write_b128 v8, v[32:35] offset:30720
    ds_write_b128 v8, v[36:39] offset:31744
    s_waitcnt lgkmcnt(0)
    s_waitcnt vmcnt(0)
    ds_read_b64_tr_b16 v[24:25], v23 offset:32768
    ds_read_b64_tr_b16 v[26:27], v23 offset:32800
    ds_read_b64_tr_b16 v[28:29], v23 offset:33792
    ds_read_b64_tr_b16 v[30:31], v23 offset:33824
    s_waitcnt lgkmcnt(0)
    ds_write_b128 v8, v[24:27] offset:32768
    ds_write_b128 v8, v[28:31] offset:33792
    s_waitcnt lgkmcnt(0)
    v_bfe_u32 v9, v0, 4, 4
    v_mov_b32 v10, 0x3f80
    v_mov_b32 v16, 0x3f800000
    v_cmp_eq_u32 vcc, 0, v9
    v_cmp_eq_u32 s[48:49], 1, v9
    s_nop 0
    v_cndmask_b32 v12, 0, v10, vcc
    v_cndmask_b32 v12, v12, v16, s[48:49]
    v_cmp_eq_u32 vcc, 2, v9
    v_cmp_eq_u32 s[48:49], 3, v9
    s_nop 0
    v_cndmask_b32 v13, 0, v10, vcc
    v_cndmask_b32 v13, v13, v16, s[48:49]
    v_cmp_eq_u32 vcc, 4, v9
    v_cmp_eq_u32 s[48:49], 5, v9
    s_nop 0
    v_cndmask_b32 v14, 0, v10, vcc
    v_cndmask_b32 v14, v14, v16, s[48:49]
    v_cmp_eq_u32 vcc, 6, v9
    v_cmp_eq_u32 s[48:49], 7, v9
    s_nop 0
    v_cndmask_b32 v15, 0, v10, vcc
    v_cndmask_b32 v15, v15, v16, s[48:49]
    v_add_u32 v9, 162560, v0
    ds_write_b128 v9, v[12:15]
    s_waitcnt lgkmcnt(0)
    s_mov_b64 exec, 0x7ff
    v_lshrrev_b32 v14, 2, v0
    v_lshlrev_b32 v12, 5, v14
    v_and_b32 v12, 128, v12
    v_lshrrev_b32 v13, 1, v14
    v_and_or_b32 v12, v13, 12, v12
    s_lshl_b32 s6, s32, 2
    s_add_u32 s6, s6, 192
    v_writelane_b32 v12, s6, 8
    s_mov_b32 s6, 40
    v_writelane_b32 v12, s6, 9
    s_mov_b32 s6, 160
    v_writelane_b32 v12, s6, 10
    s_mov_b32 s16, 0
L_pure:
    global_load_dword v13, v12, s[12:13] sc1
    s_add_u32 s16, s16, 1
    s_cmp_gt_u32 s16, 100000
    s_cbranch_scc1 Lr_abort
    s_mov_b32 s6, 0
    s_waitcnt vmcnt(0)
    v_readlane_b32 s7, v13, 0
    s_nop 0
    s_add_u32 s6, s6, s7
    v_readlane_b32 s7, v13, 1
    s_nop 0
    s_add_u32 s6, s6, s7
    v_readlane_b32 s7, v13, 2
    s_nop 0
    s_add_u32 s6, s6, s7
    v_readlane_b32 s7, v13, 3
    s_nop 0
    s_add_u32 s6, s6, s7
    v_readlane_b32 s7, v13, 4
    s_nop 0
    s_add_u32 s6, s6, s7
    v_readlane_b32 s7, v13, 5
    s_nop 0
    s_add_u32 s6, s6, s7
    v_readlane_b32 s7, v13, 6
    s_nop 0
    s_add_u32 s6, s6, s7
    v_readlane_b32 s7, v13, 7
    s_nop 0
    s_add_u32 s6, s6, s7
    v_readlane_b32 s7, v13, s32
    s_nop 0
    s_cmp_ge_u32 s7, 32
    s_cselect_b32 s51, 1, 0
    s_cselect_b32 s6, 256, s6
    s_cmp_lt_u32 s6, 256
    s_cbranch_scc1 L_pure
    v_readlane_b32 s7, v13, 8
    s_nop 0
    s_cmp_lt_u32 s7, 32
    s_cbranch_scc1 L_pure
    v_readlane_b32 s7, v13, 9
    s_nop 0
    s_cmp_lt_u32 s7, 128
    s_cbranch_scc1 L_pure
    v_readlane_b32 s7, v13, 10
    s_cmp_eq_u32 s32, 0
    s_cselect_b32 s7, 64, s7
    s_cmp_lt_u32 s7, 64
    s_cbranch_scc1 L_pure
    s_mov_b64 exec, -1
    s_barrier
    s_cmp_eq_u32 s51, 0
    s_cbranch_scc1 L_slow
    s_cmp_lg_u32 s14, 0
    s_cbranch_scc1 L_w1_1
    buffer_load_dwordx4 v[36:39], v0, s[8:11], s34 offen sc1
    s_mov_b32 s16, 0
    s_add_u32 s17, s66, 128
    v_lshrrev_b32 v10, 2, v0
    v_and_b32 v9, 16, v10
    v_lshlrev_b32 v9, 3, v9
    v_and_or_b32 v10, v10, 12, v9
Lr0f_fw_10:
    buffer_load_dword v9, v10, s[8:11], s17 offen sc1
    s_add_u32 s16, s16, 1
    s_cmp_gt_u32 s16, 100000
    s_cbranch_scc1 Lr_abort
    s_waitcnt vmcnt(0)
    v_cmp_eq_u32 vcc, 0, v9
    s_nop 0
    s_cbranch_vccnz Lr0f_fw_10
    s_mov_b32 m0, 15104
    s_nop 0
    buffer_load_dwordx4 v0, s[8:11], s41 offen offset:0 lds
    buffer_load_dwordx4 v0, s[8:11], s41 offen offset:1024 lds
    s_add_u32 s41, s41, 262144
    s_add_u32 s68, s68, 4278452224
    ds_read_b128 v[56:59], v8 offset:0
    ds_read_b128 v[60:63], v8 offset:1024
    ds_read_b128 v[64:67], v8 offset:2048
    ds_read_b128 v[68:71], v8 offset:3072
    v_mov_b64 v[12:13], 0
    v_mov_b64 v[14:15], 0
    v_mov_b64 v[16:17], 0
    v_mov_b64 v[18:19], 0
    v_mov_b64 v[20:21], 0
    v_mov_b64 v[22:23], 0
    v_mov_b64 v[24:25], 0
    v_mov_b64 v[26:27], 0
    v_mov_b64 v[28:29], 0
    v_mov_b64 v[30:31], 0
    v_mov_b64 v[32:33], 0
    v_mov_b64 v[34:35], 0
    s_waitcnt vmcnt(0) lgkmcnt(0)
Lr0f_step:
    s_mov_b32 s16, 0
Lr0f_alp:
    s_waitcnt vmcnt(2)
    v_max3_u32 v10, v36, v37, v38
    v_max_u32 v10, v10, v39
    v_cmp_eq_u32 vcc, -1, v10
    s_nop 0
    s_cbranch_vccz Lr0f_aok
    buffer_load_dwordx4 v[36:39], v0, s[8:11], s34 offen sc1
    s_add_u32 s16, s16, 1
    s_cmp_gt_u32 s16, 100000
    s_cbranch_scc1 Lr_abort
    s_branch Lr0f_alp
Lr0f_aok:
    ds_write_b128 v0, v[36:39] offset:6912
    v_smfmac_f32_16x16x64_bf16 v[12:15], v[36:39], v[72:79], v1
    v_smfmac_f32_16x16x64_bf16 v[16:19], v[36:39], v[80:87], v1
    v_smfmac_f32_16x16x64_bf16 v[20:23], v[36:39], v[184:191], v1
    s_waitcnt lgkmcnt(0)
    s_barrier
    ds_read_b128 v[48:51], v0 offset:7936
    ds_read_b128 v[52:55], v0 offset:8960
    v_smfmac_f32_16x16x64_bf16 v[28:31], v[36:39], v[56:63], v1
    ds_read_b128 v[56:59], v8 offset:4096
    ds_read_b128 v[60:63], v8 offset:5120
    s_add_u32 s17, s34, 4096
    buffer_load_dwordx4 v[40:43], v0, s[8:11], s17 offen sc1
    v_smfmac_f32_16x16x64_bf16 v[24:27], v[36:39], v[192:199], v1
    v_smfmac_f32_16x16x64_bf16 v[32:35], v[36:39], v[64:71], v1
    ds_read_b128 v[64:67], v8 offset:6144
    ds_read_b128 v[68:71], v8 offset:7168
    s_waitcnt vmcnt(1)
    ds_read_b128 v[36:39], v0 offset:9984
    s_waitcnt lgkmcnt(6)
    v_smfmac_f32_16x16x64_bf16 v[28:31], v[48:51], a[72:79], v1
    v_smfmac_f32_16x16x64_bf16 v[12:15], v[48:51], v[88:95], v1
    buffer_load_dwordx4 v[44:47], v0, s[8:11], s35 offen sc1
    v_smfmac_f32_16x16x64_bf16 v[16:19], v[48:51], v[96:103], v1
    v_smfmac_f32_16x16x64_bf16 v[32:35], v[48:51], a[80:87], v1
    v_smfmac_f32_16x16x64_bf16 v[20:23], v[48:51], v[200:207], v1
    v_smfmac_f32_16x16x64_bf16 v[24:27], v[48:51], v[208:215], v1
    s_waitcnt lgkmcnt(3)
    v_smfmac_f32_16x16x64_bf16 v[28:31], v[52:55], v[56:63], v1
    ds_read_b128 v[56:59], v8 offset:8192
    ds_read_b128 v[60:63], v8 offset:9216
    v_smfmac_f32_16x16x64_bf16 v[12:15], v[52:55], v[104:111], v1
    v_smfmac_f32_16x16x64_bf16 v[16:19], v[52:55], v[112:119], v1
    s_waitcnt lgkmcnt(3)
    v_smfmac_f32_16x16x64_bf16 v[32:35], v[52:55], v[64:71], v1
    ds_read_b128 v[64:67], v8 offset:10240
    ds_read_b128 v[68:71], v8 offset:11264
    v_smfmac_f32_16x16x64_bf16 v[20:23], v[52:55], v[216:223], v1
    v_smfmac_f32_16x16x64_bf16 v[24:27], v[52:55], v[224:231], v1
    s_waitcnt lgkmcnt(4)
    v_smfmac_f32_16x16x64_bf16 v[28:31], v[36:39], a[88:95], v1
    v_smfmac_f32_16x16x64_bf16 v[12:15], v[36:39], v[120:127], v1
    v_smfmac_f32_16x16x64_bf16 v[16:19], v[36:39], v[128:135], v1
    v_smfmac_f32_16x16x64_bf16 v[32:35], v[36:39], a[96:103], v1
    v_smfmac_f32_16x16x64_bf16 v[20:23], v[36:39], v[232:239], v1
    v_smfmac_f32_16x16x64_bf16 v[24:27], v[36:39], v[240:247], v1
    s_waitcnt vmcnt(1)
    v_max3_u32 v10, v40, v41, v42
    v_max_u32 v10, v10, v43
    v_cmp_eq_u32 vcc, -1, v10
    s_nop 0
    s_cbranch_vccnz Lr0f_pb_re
Lr0f_pb_ok:
    ds_write_b128 v0, v[40:43] offset:11008
    s_waitcnt lgkmcnt(3)
    v_smfmac_f32_16x16x64_bf16 v[12:15], v[40:43], v[56:63], v1
    ds_read_b128 v[56:59], v8 offset:12288
    ds_read_b128 v[60:63], v8 offset:13312
    v_smfmac_f32_16x16x64_bf16 v[20:23], v[40:43], v[248:255], v1
    s_waitcnt lgkmcnt(3)
    v_smfmac_f32_16x16x64_bf16 v[16:19], v[40:43], v[64:71], v1
    ds_read_b128 v[64:67], v8 offset:14336
    ds_read_b128 v[68:71], v8 offset:15360
    v_smfmac_f32_16x16x64_bf16 v[24:27], v[40:43], a[0:7], v1
    s_waitcnt lgkmcnt(4)
    s_barrier
    ds_read_b128 v[48:51], v0 offset:13056
    ds_read_b128 v[52:55], v0 offset:12032
    ds_read_b128 v[36:39], v0 offset:14080
    v_smfmac_f32_16x16x64_bf16 v[28:31], v[40:43], a[104:111], v1
    v_smfmac_f32_16x16x64_bf16 v[32:35], v[40:43], a[112:119], v1
    s_waitcnt lgkmcnt(2)
    v_smfmac_f32_16x16x64_bf16 v[12:15], v[48:51], v[56:63], v1
    v_smfmac_f32_16x16x64_bf16 v[16:19], v[48:51], v[64:71], v1
    s_waitcnt lgkmcnt(1)
    v_smfmac_f32_16x16x64_bf16 v[12:15], v[52:55], v[136:143], v1
    v_smfmac_f32_16x16x64_bf16 v[16:19], v[52:55], v[144:151], v1
    s_waitcnt lgkmcnt(0)
    v_smfmac_f32_16x16x64_bf16 v[12:15], v[36:39], v[152:159], v1
    v_smfmac_f32_16x16x64_bf16 v[16:19], v[36:39], v[160:167], v1
    s_waitcnt vmcnt(0)
    v_max3_u32 v10, v44, v45, v46
    v_max_u32 v10, v10, v47
    v_cmp_eq_u32 vcc, -1, v10
    s_nop 0
    s_cbranch_vccnz Lr0f_pc_re
Lr0f_pc_ok:
    v_smfmac_f32_16x16x64_bf16 v[12:15], v[44:47], v[168:175], v1
    v_smfmac_f32_16x16x64_bf16 v[16:19], v[44:47], v[176:183], v1
    v_smfmac_f32_16x16x64_bf16 v[20:23], v[48:51], a[24:31], v1
    buffer_load_dwordx4 v[64:67], v0, s[8:11], s42 offen
    v_smfmac_f32_16x16x64_bf16 v[24:27], v[48:51], a[32:39], v1
    v_smfmac_f32_16x16x64_bf16 v[20:23], v[52:55], a[8:15], v1
    v_add_f32 v12, v12, v14
    v_smfmac_f32_16x16x64_bf16 v[24:27], v[52:55], a[16:23], v1
    v_add_f32 v16, v16, v18
    v_smfmac_f32_16x16x64_bf16 v[20:23], v[36:39], a[40:47], v1
    v_add_f32 v13, v13, v15
    buffer_load_dwordx4 v[68:71], v0, s[8:11], s42 offen offset:1024
    v_smfmac_f32_16x16x64_bf16 v[24:27], v[36:39], a[48:55], v1
    v_add_f32 v17, v17, v19
    v_smfmac_f32_16x16x64_bf16 v[20:23], v[44:47], a[56:63], v1
    v_cvt_pk_bf16_f32 v14, v12, v16
    ds_read_b128 v[56:59], v0 offset:15104
    v_smfmac_f32_16x16x64_bf16 v[24:27], v[44:47], a[64:71], v1
    v_cvt_pk_bf16_f32 v15, v13, v17
    ds_read_b128 v[60:63], v0 offset:16128
    ds_write_b32 v2, v14 offset:576
    ds_write_b32 v2, v15 offset:864
    v_smfmac_f32_16x16x64_bf16 v[28:31], v[48:51], a[136:143], v1
    v_smfmac_f32_16x16x64_bf16 v[32:35], v[48:51], a[144:151], v1
    v_add_f32 v20, v20, v22
    v_add_f32 v24, v24, v26
    v_add_f32 v21, v21, v23
    v_add_f32 v25, v25, v27
    v_cvt_pk_bf16_f32 v22, v20, v24
    v_cvt_pk_bf16_f32 v23, v21, v25
    ds_write_b32 v2, v22 offset:0
    ds_write_b32 v2, v23 offset:288
    v_smfmac_f32_16x16x64_bf16 v[28:31], v[52:55], a[120:127], v1
    v_smfmac_f32_16x16x64_bf16 v[32:35], v[52:55], a[128:135], v1
    s_waitcnt lgkmcnt(0)
    s_barrier
    ds_read_b128 v[40:43], v3 offset:0
    ds_read_b128 v[48:51], v3 offset:64
    ds_read_b128 v[20:23], v3 offset:128
    ds_read_b128 v[52:55], v3 offset:192
    v_smfmac_f32_16x16x64_bf16 v[28:31], v[36:39], a[152:159], v1
    v_smfmac_f32_16x16x64_bf16 v[32:35], v[36:39], a[160:167], v1
    ds_read_b128 v[36:39], v0 offset:17152
    v_lshlrev_b32 v9, 3, v0
    buffer_load_dword v11, v9, s[8:11], s68 offen
    v_smfmac_f32_16x16x64_bf16 v[28:31], v[44:47], a[168:175], v1
    v_smfmac_f32_16x16x64_bf16 v[32:35], v[44:47], a[176:183], v1
    ds_read_b128 v[44:47], v0 offset:18176
    s_waitcnt lgkmcnt(5)
    v_mfma_f32_16x16x32_bf16 v[12:15], v[56:59], v[40:43], 0
    v_mfma_f32_16x16x32_bf16 v[16:19], v[60:63], v[40:43], 0
    v_mfma_f32_16x16x32_bf16 v[24:27], v[40:43], v[40:43], 0
    ds_read_b128 v[56:59], v0 offset:19200
    ds_read_b128 v[60:63], v0 offset:20224
    s_waitcnt lgkmcnt(3)
    v_mfma_f32_16x16x32_bf16 v[12:15], v[36:39], v[48:51], v[12:15]
    v_lshrrev_b32 v10, 1, v0
    v_lshrrev_b32 v9, 9, v0
    s_waitcnt lgkmcnt(2)
    v_mfma_f32_16x16x32_bf16 v[16:19], v[44:47], v[48:51], v[16:19]
    v_lshl_add_u32 v9, v9, 5, v10
    v_add_f32 v28, v28, v30
    v_mfma_f32_16x16x32_bf16 v[24:27], v[48:51], v[48:51], v[24:27]
    v_add_f32 v32, v32, v34
    v_add_f32 v29, v29, v31
    ds_read_b128 v[36:39], v0 offset:21248
    ds_read_b128 v[44:47], v0 offset:22272
    s_waitcnt lgkmcnt(3)
    v_mfma_f32_16x16x32_bf16 v[12:15], v[56:59], v[20:23], v[12:15]
    v_add_f32 v33, v33, v35
    v_cvt_pk_bf16_f32 v30, v28, v29
    s_waitcnt lgkmcnt(2)
    v_mfma_f32_16x16x32_bf16 v[16:19], v[60:63], v[20:23], v[16:19]
    v_cvt_pk_bf16_f32 v31, v32, v33
    ds_read_b64 v[34:35], v9 offset:0
    v_mfma_f32_16x16x32_bf16 v[24:27], v[20:23], v[20:23], v[24:27]
    s_add_u32 s17, s43, 2048
    buffer_store_dwordx2 v[30:31], v10, s[8:11], s17 offen sc1
    s_waitcnt lgkmcnt(2)
    v_mfma_f32_16x16x32_bf16 v[12:15], v[36:39], v[52:55], v[12:15]
    s_waitcnt lgkmcnt(1)
    v_mfma_f32_16x16x32_bf16 v[16:19], v[44:47], v[52:55], v[16:19]
    v_mfma_f32_16x16x32_bf16 v[24:27], v[52:55], v[52:55], v[24:27]
    s_add_u32 s17, s43, 0
    s_waitcnt lgkmcnt(0)
    buffer_store_dwordx2 v[34:35], v10, s[8:11], s17 offen sc1
    s_cmp_eq_u32 s33, 63
    s_cbranch_scc1 Lr0f_last
    ds_read_b128 v[56:59], v8 offset:16384
    ds_read_b128 v[60:63], v8 offset:17408
    v_mov_b64 v[20:21], s[52:53]
    v_mov_b64 v[22:23], s[52:53]
    v_mov_b32 v41, 0
    v_mov_b32 v42, 0
    v_max3_f32 v9, v12, v13, v14
    v_max3_f32 v9, v9, v15, v16
    v_max3_f32 v9, v9, v17, v18
    v_max3_f32 v9, v9, v19, v24
    v_max_f32 v9, v9, v25
    v_mov_b32 v10, v9
    v_mov_b64 v[32:33], 0
    v_mov_b64 v[34:35], 0
    v_permlane32_swap_b32 v9, v10
    v_max_f32 v9, v9, v10
    v_mov_b32 v10, v9
    s_nop 1
    v_permlane16_swap_b32 v9, v10
    v_max_f32 v9, v9, v10
    v_mul_f32 v28, s44, v9
    v_fma_f32 v12, v12, s44, -v28
    v_fma_f32 v13, v13, s44, -v28
    v_fma_f32 v14, v14, s44, -v28
    v_fma_f32 v15, v15, s44, -v28
    v_exp_f32 v12, v12
    v_exp_f32 v13, v13
    v_fma_f32 v16, v16, s44, -v28
    v_fma_f32 v17, v17, s44, -v28
    v_exp_f32 v14, v14
    v_exp_f32 v15, v15
    v_cvt_pk_bf16_f32 v36, v12, v13
    v_fma_f32 v18, v18, s44, -v28
    v_fma_f32 v19, v19, s44, -v28
    v_exp_f32 v16, v16
    v_exp_f32 v17, v17
    v_cvt_pk_bf16_f32 v37, v14, v15
    v_fma_f32 v24, v24, s44, -v28
    v_fma_f32 v25, v25, s44, -v28
    v_exp_f32 v18, v18
    v_exp_f32 v19, v19
    v_cvt_pk_bf16_f32 v38, v16, v17
    v_exp_f32 v24, v24
    v_exp_f32 v25, v25
    v_cvt_pk_bf16_f32 v39, v18, v19
    v_cvt_pk_bf16_f32 v40, v24, v25
    v_cvt_pk_bf16_f32 v43, v24, v25
    v_mfma_f32_16x16x32_bf16 v[52:55], v[20:23], v[36:39], 0
    v_mov_b64 v[12:13], 0
    v_mov_b64 v[14:15], 0
    s_waitcnt vmcnt(4)
    v_mfma_f32_16x16x32_bf16 v[44:47], v[64:67], v[36:39], 0
    v_mov_b64 v[24:25], 0
    v_mov_b64 v[26:27], 0
    s_waitcnt vmcnt(3)
    v_mfma_f32_16x16x32_bf16 v[48:51], v[68:71], v[36:39], 0
    ds_read_b128 v[64:67], v8 offset:20480
    ds_read_b128 v[68:71], v8 offset:21504
    v_mfma_f32_16x16x16_bf16 v[52:55], v[20:21], v[40:41], v[52:55]
    v_mfma_f32_16x16x16_bf16 v[44:47], v[30:31], v[40:41], v[44:47]
    v_mov_b64 v[20:21], 0
    v_mov_b64 v[22:23], 0
    v_mfma_f32_16x16x16_bf16 v[48:51], v[30:31], v[42:43], v[48:51]
    v_mov_b64 v[36:37], 0
    v_mov_b64 v[38:39], 0
    v_mov_b64 v[40:41], 0
    v_mov_b64 v[42:43], 0
    v_rcp_f32 v9, v52
    v_mov_b64 v[52:53], 0
    v_mov_b64 v[54:55], 0
    v_mul_f32 v44, v9, v44
    v_mul_f32 v48, v9, v48
    v_cvt_pk_bf16_f32 v16, v44, v48
    v_mul_f32 v45, v9, v45
    v_mul_f32 v49, v9, v49
    v_cvt_pk_bf16_f32 v17, v45, v49
    v_mul_f32 v46, v9, v46
    v_mul_f32 v50, v9, v50
    v_cvt_pk_bf16_f32 v18, v46, v50
    v_mul_f32 v47, v9, v47
    v_mul_f32 v51, v9, v51
    v_cvt_pk_bf16_f32 v19, v47, v51
    ds_write_b128 v5, v[16:19]
    v_mov_b64 v[28:29], 0
    v_mov_b64 v[30:31], 0
    s_waitcnt lgkmcnt(0)
    s_barrier
    ds_read_b128 v[44:47], v4 offset:0
    ds_read_b128 v[48:51], v4 offset:128
    v_mov_b64 v[16:17], 0
    v_mov_b64 v[18:19], 0
    buffer_load_dwordx4 v0, s[8:11], s41 offen offset:0 lds
    buffer_load_dwordx4 v0, s[8:11], s41 offen offset:1024 lds
    s_waitcnt lgkmcnt(1)
    v_smfmac_f32_16x16x64_bf16 v[12:15], v[44:47], a[184:191], v1
    s_waitcnt lgkmcnt(0)
    v_smfmac_f32_16x16x64_bf16 v[12:15], v[48:51], a[192:199], v1
    v_smfmac_f32_16x16x64_bf16 v[24:27], v[44:47], a[200:207], v1
    v_smfmac_f32_16x16x64_bf16 v[24:27], v[48:51], a[208:215], v1
    v_add_f32 v12, v12, v14
    v_smfmac_f32_16x16x64_bf16 v[20:23], v[44:47], a[216:223], v1
    v_add_f32 v13, v13, v15
    v_smfmac_f32_16x16x64_bf16 v[20:23], v[48:51], a[224:231], v1
    v_cvt_pk_bf16_f32 v12, v12, v13
    v_smfmac_f32_16x16x64_bf16 v[16:19], v[44:47], a[232:239], v1
    v_add_f32 v24, v24, v26
    v_smfmac_f32_16x16x64_bf16 v[16:19], v[48:51], a[240:247], v1
    v_add_f32 v25, v25, v27
    v_smfmac_f32_16x16x64_bf16 v[36:39], v[44:47], v[56:63], v1
    v_cvt_pk_bf16_f32 v13, v24, v25
    v_smfmac_f32_16x16x64_bf16 v[36:39], v[48:51], v[64:71], v1
    v_add_f32 v20, v20, v22
    v_add_f32 v21, v21, v23
    v_cvt_pk_bf16_f32 v14, v20, v21
    v_add_f32 v16, v16, v18
    v_add_f32 v17, v17, v19
    v_cvt_pk_bf16_f32 v15, v16, v17
    v_and_or_b32 v15, v15, -2, s40
    buffer_store_dwordx4 v[12:15], v0, s[8:11], s38 offen
    s_nop 0
    ds_read_b128 v[12:15], v8 offset:18432
    ds_read_b128 v[16:19], v8 offset:19456
    ds_read_b128 v[20:23], v8 offset:22528
    ds_read_b128 v[24:27], v8 offset:23552
    ds_read_b128 v[56:59], v8 offset:24576
    ds_read_b128 v[60:63], v8 offset:25600
    ds_read_b128 v[64:67], v8 offset:28672
    ds_read_b128 v[68:71], v8 offset:29696
    s_waitcnt lgkmcnt(6)
    v_smfmac_f32_16x16x64_bf16 v[40:43], v[44:47], v[12:19], v1
    ds_read_b128 v[12:15], v8 offset:26624
    ds_read_b128 v[16:19], v8 offset:27648
    s_waitcnt lgkmcnt(6)
    v_smfmac_f32_16x16x64_bf16 v[40:43], v[48:51], v[20:27], v1
    ds_read_b128 v[20:23], v8 offset:30720
    ds_read_b128 v[24:27], v8 offset:31744
    s_waitcnt lgkmcnt(6)
    v_smfmac_f32_16x16x64_bf16 v[52:55], v[44:47], v[56:63], v1
    ds_read_b128 v[56:59], v8 offset:32768
    ds_read_b128 v[60:63], v8 offset:33792
    s_waitcnt lgkmcnt(6)
    v_smfmac_f32_16x16x64_bf16 v[52:55], v[48:51], v[64:71], v1
    s_waitcnt lgkmcnt(4)
    v_smfmac_f32_16x16x64_bf16 v[32:35], v[44:47], v[12:19], v1
    s_waitcnt lgkmcnt(2)
    v_smfmac_f32_16x16x64_bf16 v[32:35], v[48:51], v[20:27], v1
    v_smfmac_f32_16x16x64_bf16 v[28:31], v[44:47], a[248:255], v1
    s_waitcnt lgkmcnt(0)
    v_smfmac_f32_16x16x64_bf16 v[28:31], v[48:51], v[56:63], v1
    buffer_load_dwordx4 v[12:15], v6, s[8:11], s62 offen sc1
    buffer_load_dwordx4 v[16:19], v6, s[8:11], s63 offen sc1
    buffer_load_dwordx4 v[20:23], v6, s[8:11], s64 offen sc1
    buffer_load_dwordx4 v[24:27], v6, s[8:11], s65 offen sc1
    v_add_f32 v36, v36, v38
    v_add_f32 v37, v37, v39
    v_cvt_pk_bf16_f32 v36, v36, v37
    v_add_f32 v40, v40, v42
    v_add_f32 v41, v41, v43
    v_cvt_pk_bf16_f32 v37, v40, v41
    v_add_f32 v52, v52, v54
    v_add_f32 v53, v53, v55
    v_cvt_pk_bf16_f32 v38, v52, v53
    v_add_f32 v32, v32, v34
    v_add_f32 v33, v33, v35
    v_cvt_pk_bf16_f32 v39, v32, v33
    v_and_or_b32 v39, v39, -2, s40
    s_add_u32 s17, s38, 4096
    buffer_store_dwordx4 v[36:39], v0, s[8:11], s17 offen
    v_add_f32 v28, v28, v30
    v_add_f32 v29, v29, v31
    v_cvt_pk_bf16_f32 v28, v28, v29
    v_and_or_b32 v28, v28, -2, s40
    v_lshrrev_b32 v9, 2, v0
    buffer_store_dword v28, v9, s[8:11], s39 offen
    v_add_u32 v10, 162560, v0
    ds_read_b128 v[64:67], v10
    s_nop 9
    buffer_load_dwordx4 v[40:43], v6, s[8:11], s62 offen sc1
    buffer_load_dwordx4 v[44:47], v6, s[8:11], s63 offen sc1
    buffer_load_dwordx4 v[48:51], v6, s[8:11], s64 offen sc1
    buffer_load_dwordx4 v[52:55], v6, s[8:11], s65 offen sc1
    s_add_u32 s33, s33, 1
    s_add_u32 s42, s42, 262144
    s_add_u32 s41, s41, 262144
    s_add_u32 s43, s43, 131072
    s_add_u32 s68, s68, 262144
    s_add_u32 s66, s66, 22528
    ds_read_b128 v[56:59], v8 offset:0
    ds_read_b128 v[60:63], v8 offset:1024
    s_waitcnt lgkmcnt(2)
    s_waitcnt vmcnt(9)
    v_mfma_f32_16x16x32_bf16 v[68:71], v[12:15], v[64:67], 0
    v_and_b32 v10, 1, v15
    v_cmp_ne_u32 s[54:55], s40, v10
    s_waitcnt vmcnt(8)
    v_mfma_f32_16x16x32_bf16 v[68:71], v[16:19], v[64:67], v[68:71]
    v_and_b32 v10, 1, v19
    v_cmp_ne_u32 s[56:57], s40, v10
    s_waitcnt vmcnt(7)
    v_mfma_f32_16x16x32_bf16 v[68:71], v[20:23], v[64:67], v[68:71]
    v_and_b32 v10, 1, v23
    v_cmp_ne_u32 s[58:59], s40, v10
    s_waitcnt vmcnt(6)
    v_mfma_f32_16x16x32_bf16 v[68:71], v[24:27], v[64:67], v[68:71]
    v_and_b32 v10, 1, v27
    v_cmp_ne_u32 s[60:61], s40, v10
    s_or_b64 vcc, s[54:55], s[56:57]
    s_or_b64 vcc, vcc, s[58:59]
    s_or_b64 vcc, vcc, s[60:61]
    s_cbranch_scc0 Lr0f_red
    s_mov_b32 s16, 0
Lr0f_p1:
    buffer_load_dwordx4 v[12:15], v6, s[8:11], s62 offen sc1
    buffer_load_dwordx4 v[16:19], v6, s[8:11], s63 offen sc1
    buffer_load_dwordx4 v[20:23], v6, s[8:11], s64 offen sc1
    buffer_load_dwordx4 v[24:27], v6, s[8:11], s65 offen sc1
    s_waitcnt vmcnt(7)
    v_mfma_f32_16x16x32_bf16 v[68:71], v[40:43], v[64:67], 0
    v_and_b32 v10, 1, v43
    v_cmp_ne_u32 s[54:55], s40, v10
    s_waitcnt vmcnt(6)
    v_mfma_f32_16x16x32_bf16 v[68:71], v[44:47], v[64:67], v[68:71]
    v_and_b32 v10, 1, v47
    v_cmp_ne_u32 s[56:57], s40, v10
    s_waitcnt vmcnt(5)
    v_mfma_f32_16x16x32_bf16 v[68:71], v[48:51], v[64:67], v[68:71]
    v_and_b32 v10, 1, v51
    v_cmp_ne_u32 s[58:59], s40, v10
    s_waitcnt vmcnt(4)
    v_mfma_f32_16x16x32_bf16 v[68:71], v[52:55], v[64:67], v[68:71]
    v_and_b32 v10, 1, v55
    v_cmp_ne_u32 s[60:61], s40, v10
    s_or_b64 vcc, s[54:55], s[56:57]
    s_or_b64 vcc, vcc, s[58:59]
    s_or_b64 vcc, vcc, s[60:61]
    s_cbranch_scc0 Lr0f_red
    buffer_load_dwordx4 v[40:43], v6, s[8:11], s62 offen sc1
    buffer_load_dwordx4 v[44:47], v6, s[8:11], s63 offen sc1
    buffer_load_dwordx4 v[48:51], v6, s[8:11], s64 offen sc1
    buffer_load_dwordx4 v[52:55], v6, s[8:11], s65 offen sc1
    s_add_u32 s16, s16, 1
    s_cmp_gt_u32 s16, 100000
    s_cbranch_scc1 Lr_abort
    s_waitcnt vmcnt(7)
    v_mfma_f32_16x16x32_bf16 v[68:71], v[12:15], v[64:67], 0
    v_and_b32 v10, 1, v15
    v_cmp_ne_u32 s[54:55], s40, v10
    s_waitcnt vmcnt(6)
    v_mfma_f32_16x16x32_bf16 v[68:71], v[16:19], v[64:67], v[68:71]
    v_and_b32 v10, 1, v19
    v_cmp_ne_u32 s[56:57], s40, v10
    s_waitcnt vmcnt(5)
    v_mfma_f32_16x16x32_bf16 v[68:71], v[20:23], v[64:67], v[68:71]
    v_and_b32 v10, 1, v23
    v_cmp_ne_u32 s[58:59], s40, v10
    s_waitcnt vmcnt(4)
    v_mfma_f32_16x16x32_bf16 v[68:71], v[24:27], v[64:67], v[68:71]
    v_and_b32 v10, 1, v27
    v_cmp_ne_u32 s[60:61], s40, v10
    s_or_b64 vcc, s[54:55], s[56:57]
    s_or_b64 vcc, vcc, s[58:59]
    s_or_b64 vcc, vcc, s[60:61]
    s_cbranch_scc1 Lr0f_p1
Lr0f_red:
    s_nop 1
    v_permlane16_swap_b32 v68, v70
    v_permlane16_swap_b32 v69, v71
    s_mov_b64 exec, s[46:47]
    v_add_f32 v68, v68, v70
    v_add_f32 v69, v69, v71
    v_cvt_pk_bf16_f32 v68, v68, v69
    v_min_u32 v68, s50, v68
    buffer_store_dword v68, v7, s[8:11], s36 offen
    v_mov_b32 v69, -1
    buffer_store_dword v69, v7, s[8:11], s37 offen
    s_mov_b64 exec, -1
    s_xor_b32 s34, s34, 16384
    s_xor_b32 s35, s35, 16384
    s_xor_b32 s40, s40, 1
    s_xor_b32 s36, s36, 16384
    s_xor_b32 s37, s37, 16384
    s_nop 15
    s_nop 3
    buffer_load_dwordx4 v[36:39], v0, s[8:11], s34 offen sc1
    s_waitcnt vmcnt(3)
    ds_read_b128 v[64:67], v8 offset:2048
    ds_read_b128 v[68:71], v8 offset:3072
    v_mov_b64 v[12:13], 0
    v_mov_b64 v[14:15], 0
    v_mov_b64 v[16:17], 0
    v_mov_b64 v[18:19], 0
    v_mov_b64 v[20:21], 0
    v_mov_b64 v[22:23], 0
    v_mov_b64 v[24:25], 0
    v_mov_b64 v[26:27], 0
    v_mov_b64 v[28:29], 0
    v_mov_b64 v[30:31], 0
    v_mov_b64 v[32:33], 0
    v_mov_b64 v[34:35], 0
    s_nop 9
    buffer_load_dwordx4 v[36:39], v0, s[8:11], s34 offen sc1
    s_nop 15
    s_nop 8
    buffer_load_dwordx4 v[36:39], v0, s[8:11], s34 offen sc1
    s_waitcnt lgkmcnt(0)
    s_branch Lr0f_step
Lr0f_pb_re:
    s_mov_b32 s16, 0
Lr0f_pb_lp:
    s_add_u32 s17, s34, 4096
    buffer_load_dwordx4 v[40:43], v0, s[8:11], s17 offen sc1
    s_add_u32 s16, s16, 1
    s_cmp_gt_u32 s16, 100000
    s_cbranch_scc1 Lr_abort
    s_waitcnt vmcnt(0)
    v_max3_u32 v10, v40, v41, v42
    v_max_u32 v10, v10, v43
    v_cmp_eq_u32 vcc, -1, v10
    s_nop 0
    s_cbranch_vccnz Lr0f_pb_lp
    s_branch Lr0f_pb_ok
Lr0f_pc_re:
    s_mov_b32 s16, 0
Lr0f_pc_lp:
    buffer_load_dwordx4 v[44:47], v0, s[8:11], s35 offen sc1
    s_add_u32 s16, s16, 1
    s_cmp_gt_u32 s16, 100000
    s_cbranch_scc1 Lr_abort
    s_waitcnt vmcnt(0)
    v_max3_u32 v10, v44, v45, v46
    v_max_u32 v10, v10, v47
    v_cmp_eq_u32 vcc, -1, v10
    s_nop 0
    s_cbranch_vccnz Lr0f_pc_lp
    s_branch Lr0f_pc_ok
Lr0f_last:
    s_waitcnt vmcnt(0) lgkmcnt(0)
    s_barrier
    s_branch Lr_exit
L_w1_1:
    s_cmp_lg_u32 s14, 1
    s_cbranch_scc1 L_w2_1
    buffer_load_dwordx4 v[36:39], v0, s[8:11], s34 offen sc1
    s_mov_b32 s16, 0
    s_add_u32 s17, s66, 128
    v_lshrrev_b32 v10, 2, v0
    v_and_b32 v9, 16, v10
    v_lshlrev_b32 v9, 3, v9
    v_and_or_b32 v10, v10, 12, v9
Lr1f_fw_11:
    buffer_load_dword v9, v10, s[8:11], s17 offen sc1
    s_add_u32 s16, s16, 1
    s_cmp_gt_u32 s16, 100000
    s_cbranch_scc1 Lr_abort
    s_waitcnt vmcnt(0)
    v_cmp_eq_u32 vcc, 0, v9
    s_nop 0
    s_cbranch_vccnz Lr1f_fw_11
    s_lshl_b32 s67, s32, 5
    s_add_u32 s67, s67, s15
    s_lshl_b32 s67, s67, 12
    s_add_u32 s67, s67, 3145728
    s_mov_b32 m0, 17152
    s_nop 0
    buffer_load_dwordx4 v0, s[8:11], s41 offen offset:0 lds
    buffer_load_dwordx4 v0, s[8:11], s41 offen offset:1024 lds
    s_add_u32 s41, s41, 262144
    s_add_u32 s68, s68, 262144
    ds_read_b128 v[56:59], v8 offset:4096
    ds_read_b128 v[60:63], v8 offset:5120
    ds_read_b128 v[64:67], v8 offset:6144
    ds_read_b128 v[68:71], v8 offset:7168
    v_mov_b64 v[12:13], 0
    v_mov_b64 v[14:15], 0
    v_mov_b64 v[16:17], 0
    v_mov_b64 v[18:19], 0
    v_mov_b64 v[20:21], 0
    v_mov_b64 v[22:23], 0
    v_mov_b64 v[24:25], 0
    v_mov_b64 v[26:27], 0
    v_mov_b64 v[28:29], 0
    v_mov_b64 v[30:31], 0
    v_mov_b64 v[32:33], 0
    v_mov_b64 v[34:35], 0
    s_waitcnt vmcnt(0) lgkmcnt(0)
Lr1f_step:
    s_waitcnt vmcnt(3)
    v_max3_u32 v10, v36, v37, v38
    v_max_u32 v10, v10, v39
    v_cmp_eq_u32 vcc, -1, v10
    s_nop 0
    s_cbranch_vccz Lr1f_aok
    buffer_load_dwordx4 v[36:39], v0, s[8:11], s34 offen sc1
    s_nop 15
    s_nop 8
    buffer_load_dwordx4 v[36:39], v0, s[8:11], s34 offen sc1
    s_mov_b32 s16, 0
Lr1f_alp:
    s_waitcnt vmcnt(2)
    v_max3_u32 v10, v36, v37, v38
    v_max_u32 v10, v10, v39
    v_cmp_eq_u32 vcc, -1, v10
    s_nop 0
    s_cbranch_vccz Lr1f_aok
    buffer_load_dwordx4 v[36:39], v0, s[8:11], s34 offen sc1
    s_add_u32 s16, s16, 1
    s_cmp_gt_u32 s16, 100000
    s_cbranch_scc1 Lr_abort
    s_branch Lr1f_alp
Lr1f_aok:
    ds_write_b128 v0, v[36:39] offset:7936
    v_smfmac_f32_16x16x64_bf16 v[12:15], v[36:39], v[88:95], v1
    v_smfmac_f32_16x16x64_bf16 v[16:19], v[36:39], v[96:103], v1
    v_smfmac_f32_16x16x64_bf16 v[20:23], v[36:39], v[200:207], v1
    s_waitcnt lgkmcnt(0)
    s_barrier
    ds_read_b128 v[48:51], v0 offset:8960
    ds_read_b128 v[52:55], v0 offset:9984
    v_smfmac_f32_16x16x64_bf16 v[28:31], v[36:39], a[72:79], v1
    v_smfmac_f32_16x16x64_bf16 v[24:27], v[36:39], v[208:215], v1
    s_add_u32 s17, s34, 4096
    buffer_load_dwordx4 v[40:43], v0, s[8:11], s17 offen sc1
    v_smfmac_f32_16x16x64_bf16 v[32:35], v[36:39], a[80:87], v1
    s_waitcnt vmcnt(1)
    ds_read_b128 v[36:39], v0 offset:6912
    s_waitcnt lgkmcnt(2)
    v_smfmac_f32_16x16x64_bf16 v[28:31], v[48:51], v[56:63], v1
    ds_read_b128 v[56:59], v8 offset:0
    ds_read_b128 v[60:63], v8 offset:1024
    v_smfmac_f32_16x16x64_bf16 v[12:15], v[48:51], v[104:111], v1
    v_smfmac_f32_16x16x64_bf16 v[16:19], v[48:51], v[112:119], v1
    buffer_load_dwordx4 v[44:47], v0, s[8:11], s35 offen sc1
    v_smfmac_f32_16x16x64_bf16 v[32:35], v[48:51], v[64:71], v1
    ds_read_b128 v[64:67], v8 offset:2048
    ds_read_b128 v[68:71], v8 offset:3072
    v_smfmac_f32_16x16x64_bf16 v[20:23], v[48:51], v[216:223], v1
    v_smfmac_f32_16x16x64_bf16 v[24:27], v[48:51], v[224:231], v1
    s_waitcnt lgkmcnt(5)
    v_smfmac_f32_16x16x64_bf16 v[28:31], v[52:55], a[88:95], v1
    v_smfmac_f32_16x16x64_bf16 v[12:15], v[52:55], v[120:127], v1
    v_smfmac_f32_16x16x64_bf16 v[16:19], v[52:55], v[128:135], v1
    v_smfmac_f32_16x16x64_bf16 v[32:35], v[52:55], a[96:103], v1
    v_smfmac_f32_16x16x64_bf16 v[20:23], v[52:55], v[232:239], v1
    v_smfmac_f32_16x16x64_bf16 v[24:27], v[52:55], v[240:247], v1
    s_waitcnt lgkmcnt(2)
    v_smfmac_f32_16x16x64_bf16 v[28:31], v[36:39], v[56:63], v1
    ds_read_b128 v[56:59], v8 offset:12288
    ds_read_b128 v[60:63], v8 offset:13312
    v_smfmac_f32_16x16x64_bf16 v[12:15], v[36:39], v[72:79], v1
    v_smfmac_f32_16x16x64_bf16 v[16:19], v[36:39], v[80:87], v1
    s_waitcnt lgkmcnt(2)
    v_smfmac_f32_16x16x64_bf16 v[32:35], v[36:39], v[64:71], v1
    ds_read_b128 v[64:67], v8 offset:14336
    ds_read_b128 v[68:71], v8 offset:15360
    v_smfmac_f32_16x16x64_bf16 v[20:23], v[36:39], v[184:191], v1
    v_smfmac_f32_16x16x64_bf16 v[24:27], v[36:39], v[192:199], v1
    s_waitcnt vmcnt(1)
    v_max3_u32 v10, v40, v41, v42
    v_max_u32 v10, v10, v43
    v_cmp_eq_u32 vcc, -1, v10
    s_nop 0
    s_cbranch_vccnz Lr1f_pb_re
Lr1f_pb_ok:
    ds_write_b128 v0, v[40:43] offset:12032
    v_mov_b32 v9, 1
    v_mov_b32 v10, 0
    s_mov_b64 exec, 1
    buffer_store_dword v9, v10, s[8:11], s67 offen offset:384 sc1
    s_mov_b64 exec, -1
    v_smfmac_f32_16x16x64_bf16 v[12:15], v[40:43], v[136:143], v1
    v_smfmac_f32_16x16x64_bf16 v[20:23], v[40:43], a[8:15], v1
    v_smfmac_f32_16x16x64_bf16 v[16:19], v[40:43], v[144:151], v1
    v_smfmac_f32_16x16x64_bf16 v[24:27], v[40:43], a[16:23], v1
    s_waitcnt lgkmcnt(0)
    s_barrier
    ds_read_b128 v[48:51], v0 offset:13056
    ds_read_b128 v[52:55], v0 offset:14080
    ds_read_b128 v[36:39], v0 offset:11008
    v_smfmac_f32_16x16x64_bf16 v[28:31], v[40:43], a[120:127], v1
    v_smfmac_f32_16x16x64_bf16 v[32:35], v[40:43], a[128:135], v1
    s_waitcnt lgkmcnt(2)
    v_smfmac_f32_16x16x64_bf16 v[12:15], v[48:51], v[56:63], v1
    ds_read_b128 v[56:59], v8 offset:8192
    ds_read_b128 v[60:63], v8 offset:9216
    v_smfmac_f32_16x16x64_bf16 v[16:19], v[48:51], v[64:71], v1
    ds_read_b128 v[64:67], v8 offset:10240
    ds_read_b128 v[68:71], v8 offset:11264
    s_waitcnt lgkmcnt(5)
    v_smfmac_f32_16x16x64_bf16 v[12:15], v[52:55], v[152:159], v1
    v_smfmac_f32_16x16x64_bf16 v[16:19], v[52:55], v[160:167], v1
    s_waitcnt vmcnt(1)
    v_max3_u32 v10, v44, v45, v46
    v_max_u32 v10, v10, v47
    v_cmp_eq_u32 vcc, -1, v10
    s_nop 0
    s_cbranch_vccnz Lr1f_pc_re
Lr1f_pc_ok:
    v_smfmac_f32_16x16x64_bf16 v[12:15], v[44:47], v[168:175], v1
    v_smfmac_f32_16x16x64_bf16 v[16:19], v[44:47], v[176:183], v1
    s_waitcnt lgkmcnt(2)
    v_smfmac_f32_16x16x64_bf16 v[12:15], v[36:39], v[56:63], v1
    s_waitcnt lgkmcnt(0)
    v_smfmac_f32_16x16x64_bf16 v[16:19], v[36:39], v[64:71], v1
    v_smfmac_f32_16x16x64_bf16 v[20:23], v[48:51], a[24:31], v1
    v_smfmac_f32_16x16x64_bf16 v[24:27], v[48:51], a[32:39], v1
    buffer_load_dwordx4 v[64:67], v0, s[8:11], s42 offen
    v_smfmac_f32_16x16x64_bf16 v[20:23], v[52:55], a[40:47], v1
    v_add_f32 v12, v12, v14
    v_smfmac_f32_16x16x64_bf16 v[24:27], v[52:55], a[48:55], v1
    v_add_f32 v16, v16, v18
    v_smfmac_f32_16x16x64_bf16 v[20:23], v[36:39], v[248:255], v1
    v_add_f32 v13, v13, v15
    v_smfmac_f32_16x16x64_bf16 v[24:27], v[36:39], a[0:7], v1
    v_add_f32 v17, v17, v19
    buffer_load_dwordx4 v[68:71], v0, s[8:11], s42 offen offset:1024
    v_smfmac_f32_16x16x64_bf16 v[20:23], v[44:47], a[56:63], v1
    v_cvt_pk_bf16_f32 v14, v12, v16
    ds_read_b128 v[56:59], v0 offset:15104
    v_smfmac_f32_16x16x64_bf16 v[24:27], v[44:47], a[64:71], v1
    v_cvt_pk_bf16_f32 v15, v13, v17
    ds_read_b128 v[60:63], v0 offset:16128
    ds_write_b32 v2, v14 offset:576
    ds_write_b32 v2, v15 offset:864
    v_smfmac_f32_16x16x64_bf16 v[28:31], v[48:51], a[136:143], v1
    v_smfmac_f32_16x16x64_bf16 v[32:35], v[48:51], a[144:151], v1
    v_add_f32 v20, v20, v22
    v_add_f32 v24, v24, v26
    v_add_f32 v21, v21, v23
    v_add_f32 v25, v25, v27
    v_cvt_pk_bf16_f32 v22, v20, v24
    v_cvt_pk_bf16_f32 v23, v21, v25
    ds_write_b32 v2, v22 offset:0
    ds_write_b32 v2, v23 offset:288
    v_smfmac_f32_16x16x64_bf16 v[28:31], v[52:55], a[152:159], v1
    v_smfmac_f32_16x16x64_bf16 v[32:35], v[52:55], a[160:167], v1
    s_waitcnt lgkmcnt(0)
    s_barrier
    ds_read_b128 v[40:43], v3 offset:0
    ds_read_b128 v[48:51], v3 offset:64
    ds_read_b128 v[20:23], v3 offset:128
    ds_read_b128 v[52:55], v3 offset:192
    v_smfmac_f32_16x16x64_bf16 v[28:31], v[36:39], a[104:111], v1
    v_smfmac_f32_16x16x64_bf16 v[32:35], v[36:39], a[112:119], v1
    ds_read_b128 v[36:39], v0 offset:17152
    v_smfmac_f32_16x16x64_bf16 v[28:31], v[44:47], a[168:175], v1
    v_smfmac_f32_16x16x64_bf16 v[32:35], v[44:47], a[176:183], v1
    ds_read_b128 v[44:47], v0 offset:18176
    s_waitcnt lgkmcnt(5)
    v_mfma_f32_16x16x32_bf16 v[12:15], v[56:59], v[40:43], 0
    v_mfma_f32_16x16x32_bf16 v[16:19], v[60:63], v[40:43], 0
    v_mfma_f32_16x16x32_bf16 v[24:27], v[40:43], v[40:43], 0
    ds_read_b128 v[56:59], v0 offset:19200
    ds_read_b128 v[60:63], v0 offset:20224
    s_waitcnt lgkmcnt(3)
    v_mfma_f32_16x16x32_bf16 v[12:15], v[36:39], v[48:51], v[12:15]
    v_lshrrev_b32 v10, 1, v0
    v_lshrrev_b32 v9, 9, v0
    s_waitcnt lgkmcnt(2)
    v_mfma_f32_16x16x32_bf16 v[16:19], v[44:47], v[48:51], v[16:19]
    v_lshl_add_u32 v9, v9, 5, v10
    v_add_f32 v28, v28, v30
    v_mfma_f32_16x16x32_bf16 v[24:27], v[48:51], v[48:51], v[24:27]
    v_add_f32 v32, v32, v34
    v_add_f32 v29, v29, v31
    ds_read_b128 v[36:39], v0 offset:21248
    ds_read_b128 v[44:47], v0 offset:22272
    s_waitcnt lgkmcnt(3)
    v_mfma_f32_16x16x32_bf16 v[12:15], v[56:59], v[20:23], v[12:15]
    v_add_f32 v33, v33, v35
    v_cvt_pk_bf16_f32 v30, v28, v29
    s_waitcnt lgkmcnt(2)
    v_mfma_f32_16x16x32_bf16 v[16:19], v[60:63], v[20:23], v[16:19]
    v_cvt_pk_bf16_f32 v31, v32, v33
    ds_read_b64 v[34:35], v9 offset:1152
    v_mfma_f32_16x16x32_bf16 v[24:27], v[20:23], v[20:23], v[24:27]
    s_add_u32 s17, s43, 2560
    buffer_store_dwordx2 v[30:31], v10, s[8:11], s17 offen sc1
    s_waitcnt lgkmcnt(2)
    v_mfma_f32_16x16x32_bf16 v[12:15], v[36:39], v[52:55], v[12:15]
    s_waitcnt lgkmcnt(1)
    v_mfma_f32_16x16x32_bf16 v[16:19], v[44:47], v[52:55], v[16:19]
    v_mfma_f32_16x16x32_bf16 v[24:27], v[52:55], v[52:55], v[24:27]
    s_add_u32 s17, s43, 512
    s_waitcnt lgkmcnt(0)
    buffer_store_dwordx2 v[34:35], v10, s[8:11], s17 offen sc1
    s_cmp_eq_u32 s33, 63
    s_cbranch_scc1 Lr1f_last
    ds_read_b128 v[56:59], v8 offset:16384
    ds_read_b128 v[60:63], v8 offset:17408
    v_mov_b64 v[20:21], s[52:53]
    v_mov_b64 v[22:23], s[52:53]
    v_mov_b32 v41, 0
    v_mov_b32 v42, 0
    v_max3_f32 v9, v12, v13, v14
    v_max3_f32 v9, v9, v15, v16
    v_max3_f32 v9, v9, v17, v18
    v_max3_f32 v9, v9, v19, v24
    v_max_f32 v9, v9, v25
    v_mov_b32 v10, v9
    v_mov_b64 v[32:33], 0
    v_mov_b64 v[34:35], 0
    v_permlane32_swap_b32 v9, v10
    v_max_f32 v9, v9, v10
    v_mov_b32 v10, v9
    s_nop 1
    v_permlane16_swap_b32 v9, v10
    v_max_f32 v9, v9, v10
    v_mul_f32 v28, s44, v9
    v_fma_f32 v12, v12, s44, -v28
    v_fma_f32 v13, v13, s44, -v28
    v_fma_f32 v14, v14, s44, -v28
    v_fma_f32 v15, v15, s44, -v28
    v_exp_f32 v12, v12
    v_exp_f32 v13, v13
    v_fma_f32 v16, v16, s44, -v28
    v_fma_f32 v17, v17, s44, -v28
    v_exp_f32 v14, v14
    v_exp_f32 v15, v15
    v_cvt_pk_bf16_f32 v36, v12, v13
    v_fma_f32 v18, v18, s44, -v28
    v_fma_f32 v19, v19, s44, -v28
    v_exp_f32 v16, v16
    v_exp_f32 v17, v17
    v_cvt_pk_bf16_f32 v37, v14, v15
    v_fma_f32 v24, v24, s44, -v28
    v_fma_f32 v25, v25, s44, -v28
    v_exp_f32 v18, v18
    v_exp_f32 v19, v19
    v_cvt_pk_bf16_f32 v38, v16, v17
    v_exp_f32 v24, v24
    v_exp_f32 v25, v25
    v_cvt_pk_bf16_f32 v39, v18, v19
    v_cvt_pk_bf16_f32 v40, v24, v25
    v_cvt_pk_bf16_f32 v43, v24, v25
    v_mfma_f32_16x16x32_bf16 v[52:55], v[20:23], v[36:39], 0
    v_mov_b64 v[12:13], 0
    v_mov_b64 v[14:15], 0
    s_waitcnt vmcnt(3)
    v_mfma_f32_16x16x32_bf16 v[44:47], v[64:67], v[36:39], 0
    v_mov_b64 v[24:25], 0
    v_mov_b64 v[26:27], 0
    s_waitcnt vmcnt(2)
    v_mfma_f32_16x16x32_bf16 v[48:51], v[68:71], v[36:39], 0
    ds_read_b128 v[64:67], v8 offset:20480
    ds_read_b128 v[68:71], v8 offset:21504
    v_mfma_f32_16x16x16_bf16 v[52:55], v[20:21], v[40:41], v[52:55]
    v_mfma_f32_16x16x16_bf16 v[44:47], v[30:31], v[40:41], v[44:47]
    v_mov_b64 v[20:21], 0
    v_mov_b64 v[22:23], 0
    v_mfma_f32_16x16x16_bf16 v[48:51], v[30:31], v[42:43], v[48:51]
    v_mov_b64 v[36:37], 0
    v_mov_b64 v[38:39], 0
    v_mov_b64 v[40:41], 0
    v_mov_b64 v[42:43], 0
    v_rcp_f32 v9, v52
    v_mov_b64 v[52:53], 0
    v_mov_b64 v[54:55], 0
    v_mul_f32 v44, v9, v44
    v_mul_f32 v48, v9, v48
    v_cvt_pk_bf16_f32 v16, v44, v48
    v_mul_f32 v45, v9, v45
    v_mul_f32 v49, v9, v49
    v_cvt_pk_bf16_f32 v17, v45, v49
    v_mul_f32 v46, v9, v46
    v_mul_f32 v50, v9, v50
    v_cvt_pk_bf16_f32 v18, v46, v50
    v_mul_f32 v47, v9, v47
    v_mul_f32 v51, v9, v51
    v_cvt_pk_bf16_f32 v19, v47, v51
    ds_write_b128 v5, v[16:19]
    v_mov_b64 v[28:29], 0
    v_mov_b64 v[30:31], 0
    s_waitcnt lgkmcnt(0)
    s_barrier
    ds_read_b128 v[44:47], v4 offset:0
    ds_read_b128 v[48:51], v4 offset:128
    v_mov_b64 v[16:17], 0
    v_mov_b64 v[18:19], 0
    buffer_load_dwordx4 v0, s[8:11], s41 offen offset:0 lds
    buffer_load_dwordx4 v0, s[8:11], s41 offen offset:1024 lds
    s_waitcnt lgkmcnt(1)
    v_smfmac_f32_16x16x64_bf16 v[12:15], v[44:47], a[184:191], v1
    s_waitcnt lgkmcnt(0)
    v_smfmac_f32_16x16x64_bf16 v[12:15], v[48:51], a[192:199], v1
    v_smfmac_f32_16x16x64_bf16 v[24:27], v[44:47], a[200:207], v1
    v_smfmac_f32_16x16x64_bf16 v[24:27], v[48:51], a[208:215], v1
    v_add_f32 v12, v12, v14
    v_smfmac_f32_16x16x64_bf16 v[20:23], v[44:47], a[216:223], v1
    v_add_f32 v13, v13, v15
    v_smfmac_f32_16x16x64_bf16 v[20:23], v[48:51], a[224:231], v1
    v_cvt_pk_bf16_f32 v12, v12, v13
    v_smfmac_f32_16x16x64_bf16 v[16:19], v[44:47], a[232:239], v1
    v_add_f32 v24, v24, v26
    v_smfmac_f32_16x16x64_bf16 v[16:19], v[48:51], a[240:247], v1
    v_add_f32 v25, v25, v27
    v_smfmac_f32_16x16x64_bf16 v[36:39], v[44:47], v[56:63], v1
    v_cvt_pk_bf16_f32 v13, v24, v25
    v_smfmac_f32_16x16x64_bf16 v[36:39], v[48:51], v[64:71], v1
    v_add_f32 v20, v20, v22
    v_add_f32 v21, v21, v23
    v_cvt_pk_bf16_f32 v14, v20, v21
    v_add_f32 v16, v16, v18
    v_add_f32 v17, v17, v19
    v_cvt_pk_bf16_f32 v15, v16, v17
    v_and_or_b32 v15, v15, -2, s40
    buffer_store_dwordx4 v[12:15], v0, s[8:11], s38 offen
    s_nop 0
    ds_read_b128 v[12:15], v8 offset:18432
    ds_read_b128 v[16:19], v8 offset:19456
    ds_read_b128 v[20:23], v8 offset:22528
    ds_read_b128 v[24:27], v8 offset:23552
    ds_read_b128 v[56:59], v8 offset:24576
    ds_read_b128 v[60:63], v8 offset:25600
    ds_read_b128 v[64:67], v8 offset:28672
    ds_read_b128 v[68:71], v8 offset:29696
    s_waitcnt lgkmcnt(6)
    v_smfmac_f32_16x16x64_bf16 v[40:43], v[44:47], v[12:19], v1
    ds_read_b128 v[12:15], v8 offset:26624
    ds_read_b128 v[16:19], v8 offset:27648
    s_waitcnt lgkmcnt(6)
    v_smfmac_f32_16x16x64_bf16 v[40:43], v[48:51], v[20:27], v1
    ds_read_b128 v[20:23], v8 offset:30720
    ds_read_b128 v[24:27], v8 offset:31744
    s_waitcnt lgkmcnt(6)
    v_smfmac_f32_16x16x64_bf16 v[52:55], v[44:47], v[56:63], v1
    ds_read_b128 v[56:59], v8 offset:32768
    ds_read_b128 v[60:63], v8 offset:33792
    s_waitcnt lgkmcnt(6)
    v_smfmac_f32_16x16x64_bf16 v[52:55], v[48:51], v[64:71], v1
    s_waitcnt lgkmcnt(4)
    v_smfmac_f32_16x16x64_bf16 v[32:35], v[44:47], v[12:19], v1
    s_waitcnt lgkmcnt(2)
    v_smfmac_f32_16x16x64_bf16 v[32:35], v[48:51], v[20:27], v1
    v_smfmac_f32_16x16x64_bf16 v[28:31], v[44:47], a[248:255], v1
    s_waitcnt lgkmcnt(0)
    v_smfmac_f32_16x16x64_bf16 v[28:31], v[48:51], v[56:63], v1
    v_add_f32 v36, v36, v38
    v_add_f32 v37, v37, v39
    v_cvt_pk_bf16_f32 v36, v36, v37
    v_add_f32 v40, v40, v42
    v_add_f32 v41, v41, v43
    v_cvt_pk_bf16_f32 v37, v40, v41
    v_add_f32 v52, v52, v54
    v_add_f32 v53, v53, v55
    v_cvt_pk_bf16_f32 v38, v52, v53
    v_add_f32 v32, v32, v34
    v_add_f32 v33, v33, v35
    v_cvt_pk_bf16_f32 v39, v32, v33
    v_and_or_b32 v39, v39, -2, s40
    s_add_u32 s17, s38, 4096
    buffer_store_dwordx4 v[36:39], v0, s[8:11], s17 offen
    v_add_f32 v28, v28, v30
    v_add_f32 v29, v29, v31
    v_cvt_pk_bf16_f32 v28, v28, v29
    v_and_or_b32 v28, v28, -2, s40
    v_lshrrev_b32 v9, 2, v0
    buffer_store_dword v28, v9, s[8:11], s39 offen
    v_add_u32 v10, 162560, v0
    ds_read_b128 v[64:67], v10
    s_add_u32 s33, s33, 1
    s_add_u32 s42, s42, 262144
    s_add_u32 s41, s41, 262144
    s_add_u32 s43, s43, 131072
    s_mov_b32 s67, s66
    s_add_u32 s68, s68, 262144
    s_add_u32 s66, s66, 22528
    ds_read_b128 v[56:59], v8 offset:4096
    ds_read_b128 v[60:63], v8 offset:5120
    v_mov_b64 v[12:13], 0
    v_mov_b64 v[14:15], 0
    v_mov_b64 v[16:17], 0
    v_mov_b64 v[18:19], 0
    v_mov_b64 v[20:21], 0
    v_mov_b64 v[22:23], 0
    v_mov_b64 v[24:25], 0
    v_mov_b64 v[26:27], 0
    v_mov_b64 v[28:29], 0
    v_mov_b64 v[30:31], 0
    v_mov_b64 v[32:33], 0
    v_mov_b64 v[34:35], 0
    s_nop 15
    s_nop 15
    s_nop 15
    s_nop 11
    buffer_load_dwordx4 v[40:43], v6, s[8:11], s62 offen sc1
    buffer_load_dwordx4 v[44:47], v6, s[8:11], s63 offen sc1
    buffer_load_dwordx4 v[48:51], v6, s[8:11], s64 offen sc1
    buffer_load_dwordx4 v[52:55], v6, s[8:11], s65 offen sc1
    s_waitcnt lgkmcnt(0)
    s_waitcnt vmcnt(3)
    v_mfma_f32_16x16x32_bf16 v[68:71], v[40:43], v[64:67], 0
    v_and_b32 v10, 1, v43
    v_cmp_ne_u32 s[54:55], s40, v10
    s_waitcnt vmcnt(2)
    v_mfma_f32_16x16x32_bf16 v[68:71], v[44:47], v[64:67], v[68:71]
    v_and_b32 v10, 1, v47
    v_cmp_ne_u32 s[56:57], s40, v10
    s_waitcnt vmcnt(1)
    v_mfma_f32_16x16x32_bf16 v[68:71], v[48:51], v[64:67], v[68:71]
    v_and_b32 v10, 1, v51
    v_cmp_ne_u32 s[58:59], s40, v10
    s_waitcnt vmcnt(0)
    v_mfma_f32_16x16x32_bf16 v[68:71], v[52:55], v[64:67], v[68:71]
    v_and_b32 v10, 1, v55
    v_cmp_ne_u32 s[60:61], s40, v10
    s_or_b64 vcc, s[54:55], s[56:57]
    s_or_b64 vcc, vcc, s[58:59]
    s_or_b64 vcc, vcc, s[60:61]
    s_cbranch_scc0 Lr1f_red
    s_mov_b32 s16, 0
Lr1f_p1:
    s_mov_b64 exec, s[54:55]
    buffer_load_dwordx4 v[40:43], v6, s[8:11], s62 offen sc1
    s_mov_b64 exec, s[56:57]
    buffer_load_dwordx4 v[44:47], v6, s[8:11], s63 offen sc1
    s_mov_b64 exec, s[58:59]
    buffer_load_dwordx4 v[48:51], v6, s[8:11], s64 offen sc1
    s_mov_b64 exec, s[60:61]
    buffer_load_dwordx4 v[52:55], v6, s[8:11], s65 offen sc1
    s_mov_b64 exec, -1
    s_add_u32 s16, s16, 1
    s_cmp_gt_u32 s16, 100000
    s_cbranch_scc1 Lr_abort
    s_waitcnt vmcnt(3)
    v_mfma_f32_16x16x32_bf16 v[68:71], v[40:43], v[64:67], 0
    v_and_b32 v10, 1, v43
    v_cmp_ne_u32 s[54:55], s40, v10
    s_waitcnt vmcnt(2)
    v_mfma_f32_16x16x32_bf16 v[68:71], v[44:47], v[64:67], v[68:71]
    v_and_b32 v10, 1, v47
    v_cmp_ne_u32 s[56:57], s40, v10
    s_waitcnt vmcnt(1)
    v_mfma_f32_16x16x32_bf16 v[68:71], v[48:51], v[64:67], v[68:71]
    v_and_b32 v10, 1, v51
    v_cmp_ne_u32 s[58:59], s40, v10
    s_waitcnt vmcnt(0)
    v_mfma_f32_16x16x32_bf16 v[68:71], v[52:55], v[64:67], v[68:71]
    v_and_b32 v10, 1, v55
    v_cmp_ne_u32 s[60:61], s40, v10
    s_or_b64 vcc, s[54:55], s[56:57]
    s_or_b64 vcc, vcc, s[58:59]
    s_or_b64 vcc, vcc, s[60:61]
    s_cbranch_scc1 Lr1f_p1
Lr1f_red:
    s_xor_b32 s34, s34, 16384
    s_xor_b32 s35, s35, 16384
    buffer_load_dwordx4 v[36:39], v0, s[8:11], s34 offen sc1
    v_permlane16_swap_b32 v68, v70
    v_permlane16_swap_b32 v69, v71
    s_mov_b64 exec, s[46:47]
    v_add_f32 v68, v68, v70
    v_add_f32 v69, v69, v71
    v_cvt_pk_bf16_f32 v68, v68, v69
    v_min_u32 v68, s50, v68
    buffer_store_dword v68, v7, s[8:11], s36 offen
    v_mov_b32 v69, -1
    buffer_store_dword v69, v7, s[8:11], s37 offen
    s_mov_b64 exec, -1
    buffer_load_dwordx4 v[36:39], v0, s[8:11], s34 offen sc1
    s_xor_b32 s40, s40, 1
    s_xor_b32 s36, s36, 16384
    s_xor_b32 s37, s37, 16384
    ds_read_b128 v[64:67], v8 offset:6144
    ds_read_b128 v[68:71], v8 offset:7168
    s_waitcnt lgkmcnt(0)
    s_branch Lr1f_step
Lr1f_pb_re:
    s_mov_b32 s16, 0
Lr1f_pb_lp:
    s_add_u32 s17, s34, 4096
    buffer_load_dwordx4 v[40:43], v0, s[8:11], s17 offen sc1
    s_add_u32 s16, s16, 1
    s_cmp_gt_u32 s16, 100000
    s_cbranch_scc1 Lr_abort
    s_waitcnt vmcnt(0)
    v_max3_u32 v10, v40, v41, v42
    v_max_u32 v10, v10, v43
    v_cmp_eq_u32 vcc, -1, v10
    s_nop 0
    s_cbranch_vccnz Lr1f_pb_lp
    s_branch Lr1f_pb_ok
Lr1f_pc_re:
    s_mov_b32 s16, 0
Lr1f_pc_lp:
    buffer_load_dwordx4 v[44:47], v0, s[8:11], s35 offen sc1
    s_add_u32 s16, s16, 1
    s_cmp_gt_u32 s16, 100000
    s_cbranch_scc1 Lr_abort
    s_waitcnt vmcnt(0)
    v_max3_u32 v10, v44, v45, v46
    v_max_u32 v10, v10, v47
    v_cmp_eq_u32 vcc, -1, v10
    s_nop 0
    s_cbranch_vccnz Lr1f_pc_lp
    s_branch Lr1f_pc_ok
Lr1f_last:
    s_waitcnt vmcnt(0) lgkmcnt(0)
    s_barrier
    s_mov_b32 s67, s66
    v_mov_b32 v9, 1
    v_mov_b32 v10, 0
    s_mov_b64 exec, 1
    buffer_store_dword v9, v10, s[8:11], s67 offen offset:384 sc1
    s_mov_b64 exec, -1
    s_branch Lr_exit
L_w2_1:
    s_cmp_lg_u32 s14, 2
    s_cbranch_scc1 L_w3_1
    buffer_load_dwordx4 v[36:39], v0, s[8:11], s34 offen sc1
    s_mov_b32 s16, 0
    s_add_u32 s17, s66, 128
    v_lshrrev_b32 v10, 2, v0
    v_and_b32 v9, 16, v10
    v_lshlrev_b32 v9, 3, v9
    v_and_or_b32 v10, v10, 12, v9
Lr2f_fw_12:
    buffer_load_dword v9, v10, s[8:11], s17 offen sc1
    s_add_u32 s16, s16, 1
    s_cmp_gt_u32 s16, 100000
    s_cbranch_scc1 Lr_abort
    s_waitcnt vmcnt(0)
    v_cmp_eq_u32 vcc, 0, v9
    s_nop 0
    s_cbranch_vccnz Lr2f_fw_12
    s_mov_b32 m0, 19200
    s_nop 0
    buffer_load_dwordx4 v0, s[8:11], s41 offen offset:0 lds
    buffer_load_dwordx4 v0, s[8:11], s41 offen offset:1024 lds
    s_add_u32 s41, s41, 262144
    s_add_u32 s68, s68, 262144
    ds_read_b128 v[56:59], v8 offset:4096
    ds_read_b128 v[60:63], v8 offset:5120
    ds_read_b128 v[64:67], v8 offset:6144
    ds_read_b128 v[68:71], v8 offset:7168
    v_mov_b64 v[12:13], 0
    v_mov_b64 v[14:15], 0
    v_mov_b64 v[16:17], 0
    v_mov_b64 v[18:19], 0
    v_mov_b64 v[20:21], 0
    v_mov_b64 v[22:23], 0
    v_mov_b64 v[24:25], 0
    v_mov_b64 v[26:27], 0
    v_mov_b64 v[28:29], 0
    v_mov_b64 v[30:31], 0
    v_mov_b64 v[32:33], 0
    v_mov_b64 v[34:35], 0
    s_waitcnt vmcnt(0) lgkmcnt(0)
Lr2f_step:
    s_waitcnt vmcnt(3)
    v_max3_u32 v10, v36, v37, v38
    v_max_u32 v10, v10, v39
    v_cmp_eq_u32 vcc, -1, v10
    s_nop 0
    s_cbranch_vccz Lr2f_aok
    buffer_load_dwordx4 v[36:39], v0, s[8:11], s34 offen sc1
    s_nop 15
    s_nop 8
    buffer_load_dwordx4 v[36:39], v0, s[8:11], s34 offen sc1
    s_mov_b32 s16, 0
Lr2f_alp:
    s_waitcnt vmcnt(2)
    v_max3_u32 v10, v36, v37, v38
    v_max_u32 v10, v10, v39
    v_cmp_eq_u32 vcc, -1, v10
    s_nop 0
    s_cbranch_vccz Lr2f_aok
    buffer_load_dwordx4 v[36:39], v0, s[8:11], s34 offen sc1
    s_add_u32 s16, s16, 1
    s_cmp_gt_u32 s16, 100000
    s_cbranch_scc1 Lr_abort
    s_branch Lr2f_alp
Lr2f_aok:
    ds_write_b128 v0, v[36:39] offset:8960
    v_smfmac_f32_16x16x64_bf16 v[12:15], v[36:39], v[104:111], v1
    v_smfmac_f32_16x16x64_bf16 v[16:19], v[36:39], v[112:119], v1
    v_smfmac_f32_16x16x64_bf16 v[20:23], v[36:39], v[216:223], v1
    s_waitcnt lgkmcnt(0)
    s_barrier
    ds_read_b128 v[48:51], v0 offset:9984
    ds_read_b128 v[52:55], v0 offset:6912
    v_smfmac_f32_16x16x64_bf16 v[28:31], v[36:39], v[56:63], v1
    ds_read_b128 v[56:59], v8 offset:0
    ds_read_b128 v[60:63], v8 offset:1024
    v_smfmac_f32_16x16x64_bf16 v[24:27], v[36:39], v[224:231], v1
    v_smfmac_f32_16x16x64_bf16 v[32:35], v[36:39], v[64:71], v1
    ds_read_b128 v[64:67], v8 offset:2048
    ds_read_b128 v[68:71], v8 offset:3072
    s_add_u32 s17, s34, 4096
    buffer_load_dwordx4 v[40:43], v0, s[8:11], s17 offen sc1
    s_waitcnt vmcnt(1)
    ds_read_b128 v[36:39], v0 offset:7936
    s_waitcnt lgkmcnt(6)
    v_smfmac_f32_16x16x64_bf16 v[28:31], v[48:51], a[88:95], v1
    v_smfmac_f32_16x16x64_bf16 v[12:15], v[48:51], v[120:127], v1
    v_smfmac_f32_16x16x64_bf16 v[16:19], v[48:51], v[128:135], v1
    v_smfmac_f32_16x16x64_bf16 v[32:35], v[48:51], a[96:103], v1
    buffer_load_dwordx4 v[44:47], v0, s[8:11], s35 offen sc1
    v_smfmac_f32_16x16x64_bf16 v[20:23], v[48:51], v[232:239], v1
    v_lshrrev_b32 v10, 2, v0
    v_and_b32 v9, 16, v10
    v_lshlrev_b32 v9, 3, v9
    v_and_or_b32 v10, v10, 12, v9
    s_add_u32 s17, s66, 22656
    v_mov_b32 v11, 2
    buffer_load_dword v11, v10, s[8:11], s17 offen sc1
    v_smfmac_f32_16x16x64_bf16 v[24:27], v[48:51], v[240:247], v1
    s_waitcnt lgkmcnt(3)
    v_smfmac_f32_16x16x64_bf16 v[28:31], v[52:55], v[56:63], v1
    ds_read_b128 v[56:59], v8 offset:12288
    ds_read_b128 v[60:63], v8 offset:13312
    v_smfmac_f32_16x16x64_bf16 v[12:15], v[52:55], v[72:79], v1
    v_smfmac_f32_16x16x64_bf16 v[16:19], v[52:55], v[80:87], v1
    s_waitcnt lgkmcnt(3)
    v_smfmac_f32_16x16x64_bf16 v[32:35], v[52:55], v[64:71], v1
    ds_read_b128 v[64:67], v8 offset:14336
    ds_read_b128 v[68:71], v8 offset:15360
    v_smfmac_f32_16x16x64_bf16 v[20:23], v[52:55], v[184:191], v1
    v_smfmac_f32_16x16x64_bf16 v[24:27], v[52:55], v[192:199], v1
    s_waitcnt lgkmcnt(4)
    v_smfmac_f32_16x16x64_bf16 v[28:31], v[36:39], a[72:79], v1
    v_smfmac_f32_16x16x64_bf16 v[12:15], v[36:39], v[88:95], v1
    v_smfmac_f32_16x16x64_bf16 v[16:19], v[36:39], v[96:103], v1
    v_smfmac_f32_16x16x64_bf16 v[32:35], v[36:39], a[80:87], v1
    v_smfmac_f32_16x16x64_bf16 v[20:23], v[36:39], v[200:207], v1
    v_smfmac_f32_16x16x64_bf16 v[24:27], v[36:39], v[208:215], v1
    s_waitcnt vmcnt(2)
    v_max3_u32 v10, v40, v41, v42
    v_max_u32 v10, v10, v43
    v_cmp_eq_u32 vcc, -1, v10
    s_nop 0
    s_cbranch_vccnz Lr2f_pb_re
Lr2f_pb_ok:
    ds_write_b128 v0, v[40:43] offset:13056
    s_waitcnt lgkmcnt(3)
    v_smfmac_f32_16x16x64_bf16 v[12:15], v[40:43], v[56:63], v1
    ds_read_b128 v[56:59], v8 offset:8192
    ds_read_b128 v[60:63], v8 offset:9216
    v_smfmac_f32_16x16x64_bf16 v[20:23], v[40:43], a[24:31], v1
    s_waitcnt lgkmcnt(3)
    v_smfmac_f32_16x16x64_bf16 v[16:19], v[40:43], v[64:71], v1
    ds_read_b128 v[64:67], v8 offset:10240
    ds_read_b128 v[68:71], v8 offset:11264
    v_smfmac_f32_16x16x64_bf16 v[24:27], v[40:43], a[32:39], v1
    s_waitcnt lgkmcnt(4)
    s_barrier
    ds_read_b128 v[48:51], v0 offset:11008
    ds_read_b128 v[52:55], v0 offset:14080
    ds_read_b128 v[36:39], v0 offset:12032
    v_smfmac_f32_16x16x64_bf16 v[28:31], v[40:43], a[136:143], v1
    v_smfmac_f32_16x16x64_bf16 v[32:35], v[40:43], a[144:151], v1
    s_waitcnt lgkmcnt(2)
    v_smfmac_f32_16x16x64_bf16 v[12:15], v[48:51], v[56:63], v1
    v_smfmac_f32_16x16x64_bf16 v[16:19], v[48:51], v[64:71], v1
    s_waitcnt lgkmcnt(1)
    v_smfmac_f32_16x16x64_bf16 v[12:15], v[52:55], v[152:159], v1
    v_smfmac_f32_16x16x64_bf16 v[16:19], v[52:55], v[160:167], v1
    s_waitcnt lgkmcnt(0)
    v_smfmac_f32_16x16x64_bf16 v[12:15], v[36:39], v[136:143], v1
    v_smfmac_f32_16x16x64_bf16 v[16:19], v[36:39], v[144:151], v1
    s_waitcnt vmcnt(1)
    v_max3_u32 v10, v44, v45, v46
    v_max_u32 v10, v10, v47
    v_cmp_eq_u32 vcc, -1, v10
    s_nop 0
    s_cbranch_vccnz Lr2f_pc_re
Lr2f_pc_ok:
    v_smfmac_f32_16x16x64_bf16 v[12:15], v[44:47], v[168:175], v1
    v_smfmac_f32_16x16x64_bf16 v[16:19], v[44:47], v[176:183], v1
    v_smfmac_f32_16x16x64_bf16 v[20:23], v[48:51], v[248:255], v1
    v_smfmac_f32_16x16x64_bf16 v[24:27], v[48:51], a[0:7], v1
    v_smfmac_f32_16x16x64_bf16 v[20:23], v[52:55], a[40:47], v1
    v_add_f32 v12, v12, v14
    buffer_load_dwordx4 v[64:67], v0, s[8:11], s42 offen
    v_smfmac_f32_16x16x64_bf16 v[24:27], v[52:55], a[48:55], v1
    v_add_f32 v16, v16, v18
    v_smfmac_f32_16x16x64_bf16 v[20:23], v[36:39], a[8:15], v1
    v_add_f32 v13, v13, v15
    v_smfmac_f32_16x16x64_bf16 v[24:27], v[36:39], a[16:23], v1
    v_add_f32 v17, v17, v19
    v_smfmac_f32_16x16x64_bf16 v[20:23], v[44:47], a[56:63], v1
    v_cvt_pk_bf16_f32 v14, v12, v16
    ds_read_b128 v[56:59], v0 offset:15104
    buffer_load_dwordx4 v[68:71], v0, s[8:11], s42 offen offset:1024
    v_smfmac_f32_16x16x64_bf16 v[24:27], v[44:47], a[64:71], v1
    v_cvt_pk_bf16_f32 v15, v13, v17
    ds_read_b128 v[60:63], v0 offset:16128
    ds_write_b32 v2, v14 offset:576
    ds_write_b32 v2, v15 offset:864
    v_smfmac_f32_16x16x64_bf16 v[28:31], v[48:51], a[104:111], v1
    v_smfmac_f32_16x16x64_bf16 v[32:35], v[48:51], a[112:119], v1
    v_add_f32 v20, v20, v22
    v_add_f32 v24, v24, v26
    v_add_f32 v21, v21, v23
    v_add_f32 v25, v25, v27
    v_cvt_pk_bf16_f32 v22, v20, v24
    v_cvt_pk_bf16_f32 v23, v21, v25
    ds_write_b32 v2, v22 offset:0
    ds_write_b32 v2, v23 offset:288
    v_smfmac_f32_16x16x64_bf16 v[28:31], v[52:55], a[152:159], v1
    v_smfmac_f32_16x16x64_bf16 v[32:35], v[52:55], a[160:167], v1
    s_waitcnt vmcnt(2)
    v_cmp_eq_u32 vcc, 0, v11
    s_nop 0
    s_cbranch_vccnz Lr2f_flbad
Lr2f_flok:
    s_waitcnt lgkmcnt(0)
    s_barrier
    ds_read_b128 v[40:43], v3 offset:0
    ds_read_b128 v[48:51], v3 offset:64
    ds_read_b128 v[20:23], v3 offset:128
    ds_read_b128 v[52:55], v3 offset:192
    v_smfmac_f32_16x16x64_bf16 v[28:31], v[36:39], a[120:127], v1
    v_smfmac_f32_16x16x64_bf16 v[32:35], v[36:39], a[128:135], v1
    ds_read_b128 v[36:39], v0 offset:17152
    v_smfmac_f32_16x16x64_bf16 v[28:31], v[44:47], a[168:175], v1
    v_smfmac_f32_16x16x64_bf16 v[32:35], v[44:47], a[176:183], v1
    ds_read_b128 v[44:47], v0 offset:18176
    s_waitcnt lgkmcnt(5)
    v_mfma_f32_16x16x32_bf16 v[12:15], v[56:59], v[40:43], 0
    v_mfma_f32_16x16x32_bf16 v[16:19], v[60:63], v[40:43], 0
    v_mfma_f32_16x16x32_bf16 v[24:27], v[40:43], v[40:43], 0
    ds_read_b128 v[56:59], v0 offset:19200
    ds_read_b128 v[60:63], v0 offset:20224
    s_waitcnt lgkmcnt(3)
    v_mfma_f32_16x16x32_bf16 v[12:15], v[36:39], v[48:51], v[12:15]
    v_lshrrev_b32 v10, 1, v0
    v_lshrrev_b32 v9, 9, v0
    s_waitcnt lgkmcnt(2)
    v_mfma_f32_16x16x32_bf16 v[16:19], v[44:47], v[48:51], v[16:19]
    v_lshl_add_u32 v9, v9, 5, v10
    v_add_f32 v28, v28, v30
    v_mfma_f32_16x16x32_bf16 v[24:27], v[48:51], v[48:51], v[24:27]
    v_add_f32 v32, v32, v34
    v_add_f32 v29, v29, v31
    ds_read_b128 v[36:39], v0 offset:21248
    ds_read_b128 v[44:47], v0 offset:22272
    s_waitcnt lgkmcnt(3)
    v_mfma_f32_16x16x32_bf16 v[12:15], v[56:59], v[20:23], v[12:15]
    v_add_f32 v33, v33, v35
    v_cvt_pk_bf16_f32 v30, v28, v29
    s_waitcnt lgkmcnt(2)
    v_mfma_f32_16x16x32_bf16 v[16:19], v[60:63], v[20:23], v[16:19]
    v_cvt_pk_bf16_f32 v31, v32, v33
    ds_read_b64 v[34:35], v9 offset:2304
    v_mfma_f32_16x16x32_bf16 v[24:27], v[20:23], v[20:23], v[24:27]
    s_add_u32 s17, s43, 3072
    buffer_store_dwordx2 v[30:31], v10, s[8:11], s17 offen sc1
    s_waitcnt lgkmcnt(2)
    v_mfma_f32_16x16x32_bf16 v[12:15], v[36:39], v[52:55], v[12:15]
    s_waitcnt lgkmcnt(1)
    v_mfma_f32_16x16x32_bf16 v[16:19], v[44:47], v[52:55], v[16:19]
    v_mfma_f32_16x16x32_bf16 v[24:27], v[52:55], v[52:55], v[24:27]
    s_add_u32 s17, s43, 1024
    s_waitcnt lgkmcnt(0)
    buffer_store_dwordx2 v[34:35], v10, s[8:11], s17 offen sc1
    s_cmp_eq_u32 s33, 63
    s_cbranch_scc1 Lr2f_last
    ds_read_b128 v[56:59], v8 offset:16384
    ds_read_b128 v[60:63], v8 offset:17408
    v_mov_b64 v[20:21], s[52:53]
    v_mov_b64 v[22:23], s[52:53]
    v_mov_b32 v41, 0
    v_mov_b32 v42, 0
    v_max3_f32 v9, v12, v13, v14
    v_max3_f32 v9, v9, v15, v16
    v_max3_f32 v9, v9, v17, v18
    v_max3_f32 v9, v9, v19, v24
    v_max_f32 v9, v9, v25
    v_mov_b32 v10, v9
    v_mov_b64 v[32:33], 0
    v_mov_b64 v[34:35], 0
    v_permlane32_swap_b32 v9, v10
    v_max_f32 v9, v9, v10
    v_mov_b32 v10, v9
    s_nop 1
    v_permlane16_swap_b32 v9, v10
    v_max_f32 v9, v9, v10
    v_mul_f32 v28, s44, v9
    v_fma_f32 v12, v12, s44, -v28
    v_fma_f32 v13, v13, s44, -v28
    v_fma_f32 v14, v14, s44, -v28
    v_fma_f32 v15, v15, s44, -v28
    v_exp_f32 v12, v12
    v_exp_f32 v13, v13
    v_fma_f32 v16, v16, s44, -v28
    v_fma_f32 v17, v17, s44, -v28
    v_exp_f32 v14, v14
    v_exp_f32 v15, v15
    v_cvt_pk_bf16_f32 v36, v12, v13
    v_fma_f32 v18, v18, s44, -v28
    v_fma_f32 v19, v19, s44, -v28
    v_exp_f32 v16, v16
    v_exp_f32 v17, v17
    v_cvt_pk_bf16_f32 v37, v14, v15
    v_fma_f32 v24, v24, s44, -v28
    v_fma_f32 v25, v25, s44, -v28
    v_exp_f32 v18, v18
    v_exp_f32 v19, v19
    v_cvt_pk_bf16_f32 v38, v16, v17
    v_exp_f32 v24, v24
    v_exp_f32 v25, v25
    v_cvt_pk_bf16_f32 v39, v18, v19
    v_cvt_pk_bf16_f32 v40, v24, v25
    v_cvt_pk_bf16_f32 v43, v24, v25
    v_mfma_f32_16x16x32_bf16 v[52:55], v[20:23], v[36:39], 0
    v_mov_b64 v[12:13], 0
    v_mov_b64 v[14:15], 0
    s_waitcnt vmcnt(3)
    v_mfma_f32_16x16x32_bf16 v[44:47], v[64:67], v[36:39], 0
    v_mov_b64 v[24:25], 0
    v_mov_b64 v[26:27], 0
    s_waitcnt vmcnt(2)
    v_mfma_f32_16x16x32_bf16 v[48:51], v[68:71], v[36:39], 0
    ds_read_b128 v[64:67], v8 offset:20480
    ds_read_b128 v[68:71], v8 offset:21504
    v_mfma_f32_16x16x16_bf16 v[52:55], v[20:21], v[40:41], v[52:55]
    v_mfma_f32_16x16x16_bf16 v[44:47], v[30:31], v[40:41], v[44:47]
    v_mov_b64 v[20:21], 0
    v_mov_b64 v[22:23], 0
    v_mfma_f32_16x16x16_bf16 v[48:51], v[30:31], v[42:43], v[48:51]
    v_mov_b64 v[36:37], 0
    v_mov_b64 v[38:39], 0
    v_mov_b64 v[40:41], 0
    v_mov_b64 v[42:43], 0
    v_rcp_f32 v9, v52
    v_mov_b64 v[52:53], 0
    v_mov_b64 v[54:55], 0
    v_mul_f32 v44, v9, v44
    v_mul_f32 v48, v9, v48
    v_cvt_pk_bf16_f32 v16, v44, v48
    v_mul_f32 v45, v9, v45
    v_mul_f32 v49, v9, v49
    v_cvt_pk_bf16_f32 v17, v45, v49
    v_mul_f32 v46, v9, v46
    v_mul_f32 v50, v9, v50
    v_cvt_pk_bf16_f32 v18, v46, v50
    v_mul_f32 v47, v9, v47
    v_mul_f32 v51, v9, v51
    v_cvt_pk_bf16_f32 v19, v47, v51
    ds_write_b128 v5, v[16:19]
    v_mov_b64 v[28:29], 0
    v_mov_b64 v[30:31], 0
    s_waitcnt lgkmcnt(0)
    s_barrier
    ds_read_b128 v[44:47], v4 offset:0
    ds_read_b128 v[48:51], v4 offset:128
    v_mov_b64 v[16:17], 0
    v_mov_b64 v[18:19], 0
    buffer_load_dwordx4 v0, s[8:11], s41 offen offset:0 lds
    buffer_load_dwordx4 v0, s[8:11], s41 offen offset:1024 lds
    s_waitcnt lgkmcnt(1)
    v_smfmac_f32_16x16x64_bf16 v[12:15], v[44:47], a[184:191], v1
    s_waitcnt lgkmcnt(0)
    v_smfmac_f32_16x16x64_bf16 v[12:15], v[48:51], a[192:199], v1
    v_smfmac_f32_16x16x64_bf16 v[24:27], v[44:47], a[200:207], v1
    v_smfmac_f32_16x16x64_bf16 v[24:27], v[48:51], a[208:215], v1
    v_add_f32 v12, v12, v14
    v_smfmac_f32_16x16x64_bf16 v[20:23], v[44:47], a[216:223], v1
    v_add_f32 v13, v13, v15
    v_smfmac_f32_16x16x64_bf16 v[20:23], v[48:51], a[224:231], v1
    v_cvt_pk_bf16_f32 v12, v12, v13
    v_smfmac_f32_16x16x64_bf16 v[16:19], v[44:47], a[232:239], v1
    v_add_f32 v24, v24, v26
    v_smfmac_f32_16x16x64_bf16 v[16:19], v[48:51], a[240:247], v1
    v_add_f32 v25, v25, v27
    v_smfmac_f32_16x16x64_bf16 v[36:39], v[44:47], v[56:63], v1
    v_cvt_pk_bf16_f32 v13, v24, v25
    v_smfmac_f32_16x16x64_bf16 v[36:39], v[48:51], v[64:71], v1
    v_add_f32 v20, v20, v22
    v_add_f32 v21, v21, v23
    v_cvt_pk_bf16_f32 v14, v20, v21
    v_add_f32 v16, v16, v18
    v_add_f32 v17, v17, v19
    v_cvt_pk_bf16_f32 v15, v16, v17
    v_and_or_b32 v15, v15, -2, s40
    buffer_store_dwordx4 v[12:15], v0, s[8:11], s38 offen
    s_nop 0
    ds_read_b128 v[12:15], v8 offset:18432
    ds_read_b128 v[16:19], v8 offset:19456
    ds_read_b128 v[20:23], v8 offset:22528
    ds_read_b128 v[24:27], v8 offset:23552
    ds_read_b128 v[56:59], v8 offset:24576
    ds_read_b128 v[60:63], v8 offset:25600
    ds_read_b128 v[64:67], v8 offset:28672
    ds_read_b128 v[68:71], v8 offset:29696
    s_waitcnt lgkmcnt(6)
    v_smfmac_f32_16x16x64_bf16 v[40:43], v[44:47], v[12:19], v1
    ds_read_b128 v[12:15], v8 offset:26624
    ds_read_b128 v[16:19], v8 offset:27648
    s_waitcnt lgkmcnt(6)
    v_smfmac_f32_16x16x64_bf16 v[40:43], v[48:51], v[20:27], v1
    ds_read_b128 v[20:23], v8 offset:30720
    ds_read_b128 v[24:27], v8 offset:31744
    s_waitcnt lgkmcnt(6)
    v_smfmac_f32_16x16x64_bf16 v[52:55], v[44:47], v[56:63], v1
    ds_read_b128 v[56:59], v8 offset:32768
    ds_read_b128 v[60:63], v8 offset:33792
    s_waitcnt lgkmcnt(6)
    v_smfmac_f32_16x16x64_bf16 v[52:55], v[48:51], v[64:71], v1
    s_waitcnt lgkmcnt(4)
    v_smfmac_f32_16x16x64_bf16 v[32:35], v[44:47], v[12:19], v1
    s_waitcnt lgkmcnt(2)
    v_smfmac_f32_16x16x64_bf16 v[32:35], v[48:51], v[20:27], v1
    v_smfmac_f32_16x16x64_bf16 v[28:31], v[44:47], a[248:255], v1
    s_waitcnt lgkmcnt(0)
    v_smfmac_f32_16x16x64_bf16 v[28:31], v[48:51], v[56:63], v1
    v_add_f32 v36, v36, v38
    v_add_f32 v37, v37, v39
    v_cvt_pk_bf16_f32 v36, v36, v37
    v_add_f32 v40, v40, v42
    v_add_f32 v41, v41, v43
    v_cvt_pk_bf16_f32 v37, v40, v41
    v_add_f32 v52, v52, v54
    v_add_f32 v53, v53, v55
    v_cvt_pk_bf16_f32 v38, v52, v53
    v_add_f32 v32, v32, v34
    v_add_f32 v33, v33, v35
    v_cvt_pk_bf16_f32 v39, v32, v33
    v_and_or_b32 v39, v39, -2, s40
    s_add_u32 s17, s38, 4096
    buffer_store_dwordx4 v[36:39], v0, s[8:11], s17 offen
    v_add_f32 v28, v28, v30
    v_add_f32 v29, v29, v31
    v_cvt_pk_bf16_f32 v28, v28, v29
    v_and_or_b32 v28, v28, -2, s40
    v_lshrrev_b32 v9, 2, v0
    buffer_store_dword v28, v9, s[8:11], s39 offen
    v_add_u32 v10, 162560, v0
    ds_read_b32 v64, v10
    v_mov_b32 v65, 0
    v_mov_b32 v41, 0
    v_mov_b32 v45, 0
    v_mov_b32 v49, 0
    v_mov_b32 v53, 0
    s_add_u32 s33, s33, 1
    s_add_u32 s42, s42, 262144
    s_add_u32 s41, s41, 262144
    s_add_u32 s43, s43, 131072
    s_add_u32 s68, s68, 262144
    s_add_u32 s66, s66, 22528
    ds_read_b128 v[56:59], v8 offset:4096
    ds_read_b128 v[60:63], v8 offset:5120
    v_mov_b64 v[12:13], 0
    v_mov_b64 v[14:15], 0
    v_mov_b64 v[16:17], 0
    v_mov_b64 v[18:19], 0
    v_mov_b64 v[20:21], 0
    v_mov_b64 v[22:23], 0
    v_mov_b64 v[24:25], 0
    v_mov_b64 v[26:27], 0
    v_mov_b64 v[28:29], 0
    v_mov_b64 v[30:31], 0
    v_mov_b64 v[32:33], 0
    v_mov_b64 v[34:35], 0
    s_nop 15
    s_nop 15
    s_nop 15
    s_nop 1
    buffer_load_dword v40, v6, s[8:11], s62 offen sc1
    buffer_load_dword v44, v6, s[8:11], s63 offen sc1
    buffer_load_dword v48, v6, s[8:11], s64 offen sc1
    buffer_load_dword v52, v6, s[8:11], s65 offen sc1
    s_waitcnt lgkmcnt(0)
    s_waitcnt vmcnt(3)
    v_mfma_f32_16x16x16_bf16 v[68:71], v[40:41], v[64:65], 0
    v_and_b32 v10, 1, v40
    v_cmp_ne_u32 s[54:55], s40, v10
    s_waitcnt vmcnt(2)
    v_mfma_f32_16x16x16_bf16 v[68:71], v[44:45], v[64:65], v[68:71]
    v_and_b32 v10, 1, v44
    v_cmp_ne_u32 s[56:57], s40, v10
    s_waitcnt vmcnt(1)
    v_mfma_f32_16x16x16_bf16 v[68:71], v[48:49], v[64:65], v[68:71]
    v_and_b32 v10, 1, v48
    v_cmp_ne_u32 s[58:59], s40, v10
    s_waitcnt vmcnt(0)
    v_mfma_f32_16x16x16_bf16 v[68:71], v[52:53], v[64:65], v[68:71]
    v_and_b32 v10, 1, v52
    v_cmp_ne_u32 s[60:61], s40, v10
    s_or_b64 vcc, s[54:55], s[56:57]
    s_or_b64 vcc, vcc, s[58:59]
    s_or_b64 vcc, vcc, s[60:61]
    s_cbranch_scc0 Lr2f_red
    s_mov_b32 s16, 0
Lr2f_p1:
    s_mov_b64 exec, s[54:55]
    buffer_load_dword v40, v6, s[8:11], s62 offen sc1
    s_mov_b64 exec, s[56:57]
    buffer_load_dword v44, v6, s[8:11], s63 offen sc1
    s_mov_b64 exec, s[58:59]
    buffer_load_dword v48, v6, s[8:11], s64 offen sc1
    s_mov_b64 exec, s[60:61]
    buffer_load_dword v52, v6, s[8:11], s65 offen sc1
    s_mov_b64 exec, -1
    s_add_u32 s16, s16, 1
    s_cmp_gt_u32 s16, 100000
    s_cbranch_scc1 Lr_abort
    s_waitcnt vmcnt(3)
    v_mfma_f32_16x16x16_bf16 v[68:71], v[40:41], v[64:65], 0
    v_and_b32 v10, 1, v40
    v_cmp_ne_u32 s[54:55], s40, v10
    s_waitcnt vmcnt(2)
    v_mfma_f32_16x16x16_bf16 v[68:71], v[44:45], v[64:65], v[68:71]
    v_and_b32 v10, 1, v44
    v_cmp_ne_u32 s[56:57], s40, v10
    s_waitcnt vmcnt(1)
    v_mfma_f32_16x16x16_bf16 v[68:71], v[48:49], v[64:65], v[68:71]
    v_and_b32 v10, 1, v48
    v_cmp_ne_u32 s[58:59], s40, v10
    s_waitcnt vmcnt(0)
    v_mfma_f32_16x16x16_bf16 v[68:71], v[52:53], v[64:65], v[68:71]
    v_and_b32 v10, 1, v52
    v_cmp_ne_u32 s[60:61], s40, v10
    s_or_b64 vcc, s[54:55], s[56:57]
    s_or_b64 vcc, vcc, s[58:59]
    s_or_b64 vcc, vcc, s[60:61]
    s_cbranch_scc1 Lr2f_p1
Lr2f_red:
    s_xor_b32 s34, s34, 16384
    s_xor_b32 s35, s35, 16384
    buffer_load_dwordx4 v[36:39], v0, s[8:11], s34 offen sc1
    v_permlane16_swap_b32 v68, v70
    v_permlane16_swap_b32 v69, v71
    s_mov_b64 exec, s[46:47]
    v_add_f32 v68, v68, v70
    v_add_f32 v69, v69, v71
    v_cvt_pk_bf16_f32 v68, v68, v69
    v_min_u32 v68, s50, v68
    buffer_store_dword v68, v7, s[8:11], s36 offen
    v_mov_b32 v69, -1
    buffer_store_dword v69, v7, s[8:11], s37 offen
    s_mov_b64 exec, -1
    buffer_load_dwordx4 v[36:39], v0, s[8:11], s34 offen sc1
    s_xor_b32 s40, s40, 1
    s_xor_b32 s36, s36, 16384
    s_xor_b32 s37, s37, 16384
    ds_read_b128 v[64:67], v8 offset:6144
    ds_read_b128 v[68:71], v8 offset:7168
    s_waitcnt lgkmcnt(0)
    s_branch Lr2f_step
Lr2f_pb_re:
    s_mov_b32 s16, 0
Lr2f_pb_lp:
    s_add_u32 s17, s34, 4096
    buffer_load_dwordx4 v[40:43], v0, s[8:11], s17 offen sc1
    s_add_u32 s16, s16, 1
    s_cmp_gt_u32 s16, 100000
    s_cbranch_scc1 Lr_abort
    s_waitcnt vmcnt(0)
    v_max3_u32 v10, v40, v41, v42
    v_max_u32 v10, v10, v43
    v_cmp_eq_u32 vcc, -1, v10
    s_nop 0
    s_cbranch_vccnz Lr2f_pb_lp
    s_branch Lr2f_pb_ok
Lr2f_pc_re:
    s_mov_b32 s16, 0
Lr2f_pc_lp:
    buffer_load_dwordx4 v[44:47], v0, s[8:11], s35 offen sc1
    s_add_u32 s16, s16, 1
    s_cmp_gt_u32 s16, 100000
    s_cbranch_scc1 Lr_abort
    s_waitcnt vmcnt(0)
    v_max3_u32 v10, v44, v45, v46
    v_max_u32 v10, v10, v47
    v_cmp_eq_u32 vcc, -1, v10
    s_nop 0
    s_cbranch_vccnz Lr2f_pc_lp
    s_branch Lr2f_pc_ok
Lr2f_flbad:
    s_cmp_eq_u32 s33, 63
    s_cbranch_scc1 Lr2f_flok
    s_mov_b32 s16, 0
    s_add_u32 s17, s66, 22656
    v_lshrrev_b32 v10, 2, v0
    v_and_b32 v9, 16, v10
    v_lshlrev_b32 v9, 3, v9
    v_and_or_b32 v10, v10, 12, v9
Lr2f_fw_13:
    buffer_load_dword v9, v10, s[8:11], s17 offen sc1
    s_add_u32 s16, s16, 1
    s_cmp_gt_u32 s16, 100000
    s_cbranch_scc1 Lr_abort
    s_waitcnt vmcnt(0)
    v_cmp_eq_u32 vcc, 0, v9
    s_nop 0
    s_cbranch_vccnz Lr2f_fw_13
    s_branch Lr2f_flok
Lr2f_last:
    s_waitcnt vmcnt(0) lgkmcnt(0)
    s_barrier
    s_branch Lr_exit
L_w3_1:
    buffer_load_dwordx4 v[36:39], v0, s[8:11], s34 offen sc1
    s_mov_b32 s16, 0
    s_add_u32 s17, s66, 128
    v_lshrrev_b32 v10, 2, v0
    v_and_b32 v9, 16, v10
    v_lshlrev_b32 v9, 3, v9
    v_and_or_b32 v10, v10, 12, v9
Lr3f_fw_14:
    buffer_load_dword v9, v10, s[8:11], s17 offen sc1
    s_add_u32 s16, s16, 1
    s_cmp_gt_u32 s16, 100000
    s_cbranch_scc1 Lr_abort
    s_waitcnt vmcnt(0)
    v_cmp_eq_u32 vcc, 0, v9
    s_nop 0
    s_cbranch_vccnz Lr3f_fw_14
    s_mov_b32 m0, 21248
    s_nop 0
    buffer_load_dwordx4 v0, s[8:11], s41 offen offset:0 lds
    buffer_load_dwordx4 v0, s[8:11], s41 offen offset:1024 lds
    s_add_u32 s41, s41, 262144
    s_add_u32 s68, s68, 262144
    ds_read_b128 v[56:59], v8 offset:0
    ds_read_b128 v[60:63], v8 offset:1024
    ds_read_b128 v[64:67], v8 offset:2048
    ds_read_b128 v[68:71], v8 offset:3072
    v_mov_b64 v[12:13], 0
    v_mov_b64 v[14:15], 0
    v_mov_b64 v[16:17], 0
    v_mov_b64 v[18:19], 0
    v_mov_b64 v[20:21], 0
    v_mov_b64 v[22:23], 0
    v_mov_b64 v[24:25], 0
    v_mov_b64 v[26:27], 0
    v_mov_b64 v[28:29], 0
    v_mov_b64 v[30:31], 0
    v_mov_b64 v[32:33], 0
    v_mov_b64 v[34:35], 0
    s_waitcnt vmcnt(0) lgkmcnt(0)
Lr3f_step:
    s_mov_b32 s16, 0
Lr3f_alp:
    s_waitcnt vmcnt(2)
    v_max3_u32 v10, v36, v37, v38
    v_max_u32 v10, v10, v39
    v_cmp_eq_u32 vcc, -1, v10
    s_nop 0
    s_cbranch_vccz Lr3f_aok
    buffer_load_dwordx4 v[36:39], v0, s[8:11], s34 offen sc1
    s_add_u32 s16, s16, 1
    s_cmp_gt_u32 s16, 100000
    s_cbranch_scc1 Lr_abort
    s_branch Lr3f_alp
Lr3f_aok:
    ds_write_b128 v0, v[36:39] offset:9984
    v_smfmac_f32_16x16x64_bf16 v[12:15], v[36:39], v[120:127], v1
    v_smfmac_f32_16x16x64_bf16 v[16:19], v[36:39], v[128:135], v1
    v_smfmac_f32_16x16x64_bf16 v[20:23], v[36:39], v[232:239], v1
    s_waitcnt lgkmcnt(0)
    s_barrier
    ds_read_b128 v[48:51], v0 offset:6912
    ds_read_b128 v[52:55], v0 offset:7936
    v_smfmac_f32_16x16x64_bf16 v[28:31], v[36:39], a[88:95], v1
    v_smfmac_f32_16x16x64_bf16 v[24:27], v[36:39], v[240:247], v1
    v_smfmac_f32_16x16x64_bf16 v[32:35], v[36:39], a[96:103], v1
    s_waitcnt vmcnt(0)
    ds_read_b128 v[36:39], v0 offset:8960
    s_waitcnt lgkmcnt(2)
    v_smfmac_f32_16x16x64_bf16 v[28:31], v[48:51], v[56:63], v1
    ds_read_b128 v[56:59], v8 offset:4096
    ds_read_b128 v[60:63], v8 offset:5120
    s_add_u32 s17, s34, 4096
    buffer_load_dwordx4 v[40:43], v0, s[8:11], s17 offen sc1
    v_smfmac_f32_16x16x64_bf16 v[12:15], v[48:51], v[72:79], v1
    v_smfmac_f32_16x16x64_bf16 v[16:19], v[48:51], v[80:87], v1
    v_smfmac_f32_16x16x64_bf16 v[32:35], v[48:51], v[64:71], v1
    ds_read_b128 v[64:67], v8 offset:6144
    ds_read_b128 v[68:71], v8 offset:7168
    v_smfmac_f32_16x16x64_bf16 v[20:23], v[48:51], v[184:191], v1
    buffer_load_dwordx4 v[44:47], v0, s[8:11], s35 offen sc1
    v_smfmac_f32_16x16x64_bf16 v[24:27], v[48:51], v[192:199], v1
    s_waitcnt lgkmcnt(5)
    v_smfmac_f32_16x16x64_bf16 v[28:31], v[52:55], a[72:79], v1
    v_smfmac_f32_16x16x64_bf16 v[12:15], v[52:55], v[88:95], v1
    v_smfmac_f32_16x16x64_bf16 v[16:19], v[52:55], v[96:103], v1
    v_smfmac_f32_16x16x64_bf16 v[32:35], v[52:55], a[80:87], v1
    v_smfmac_f32_16x16x64_bf16 v[20:23], v[52:55], v[200:207], v1
    v_smfmac_f32_16x16x64_bf16 v[24:27], v[52:55], v[208:215], v1
    s_waitcnt lgkmcnt(2)
    v_smfmac_f32_16x16x64_bf16 v[28:31], v[36:39], v[56:63], v1
    ds_read_b128 v[56:59], v8 offset:8192
    ds_read_b128 v[60:63], v8 offset:9216
    v_smfmac_f32_16x16x64_bf16 v[12:15], v[36:39], v[104:111], v1
    v_smfmac_f32_16x16x64_bf16 v[16:19], v[36:39], v[112:119], v1
    s_waitcnt lgkmcnt(2)
    v_smfmac_f32_16x16x64_bf16 v[32:35], v[36:39], v[64:71], v1
    ds_read_b128 v[64:67], v8 offset:10240
    ds_read_b128 v[68:71], v8 offset:11264
    v_smfmac_f32_16x16x64_bf16 v[20:23], v[36:39], v[216:223], v1
    v_smfmac_f32_16x16x64_bf16 v[24:27], v[36:39], v[224:231], v1
    s_waitcnt vmcnt(1)
    v_max3_u32 v10, v40, v41, v42
    v_max_u32 v10, v10, v43
    v_cmp_eq_u32 vcc, -1, v10
    s_nop 0
    s_cbranch_vccnz Lr3f_pb_re
Lr3f_pb_ok:
    ds_write_b128 v0, v[40:43] offset:14080
    v_smfmac_f32_16x16x64_bf16 v[12:15], v[40:43], v[152:159], v1
    v_smfmac_f32_16x16x64_bf16 v[20:23], v[40:43], a[40:47], v1
    v_smfmac_f32_16x16x64_bf16 v[16:19], v[40:43], v[160:167], v1
    v_smfmac_f32_16x16x64_bf16 v[24:27], v[40:43], a[48:55], v1
    s_waitcnt lgkmcnt(0)
    s_barrier
    ds_read_b128 v[48:51], v0 offset:11008
    ds_read_b128 v[52:55], v0 offset:12032
    ds_read_b128 v[36:39], v0 offset:13056
    v_smfmac_f32_16x16x64_bf16 v[28:31], v[40:43], a[152:159], v1
    v_smfmac_f32_16x16x64_bf16 v[32:35], v[40:43], a[160:167], v1
    s_waitcnt lgkmcnt(2)
    v_smfmac_f32_16x16x64_bf16 v[12:15], v[48:51], v[56:63], v1
    ds_read_b128 v[56:59], v8 offset:12288
    ds_read_b128 v[60:63], v8 offset:13312
    v_smfmac_f32_16x16x64_bf16 v[16:19], v[48:51], v[64:71], v1
    ds_read_b128 v[64:67], v8 offset:14336
    ds_read_b128 v[68:71], v8 offset:15360
    s_waitcnt lgkmcnt(5)
    v_smfmac_f32_16x16x64_bf16 v[12:15], v[52:55], v[136:143], v1
    v_smfmac_f32_16x16x64_bf16 v[16:19], v[52:55], v[144:151], v1
    s_waitcnt vmcnt(0)
    v_max3_u32 v10, v44, v45, v46
    v_max_u32 v10, v10, v47
    v_cmp_eq_u32 vcc, -1, v10
    s_nop 0
    s_cbranch_vccnz Lr3f_pc_re
Lr3f_pc_ok:
    v_smfmac_f32_16x16x64_bf16 v[12:15], v[44:47], v[168:175], v1
    v_smfmac_f32_16x16x64_bf16 v[16:19], v[44:47], v[176:183], v1
    s_waitcnt lgkmcnt(2)
    v_smfmac_f32_16x16x64_bf16 v[12:15], v[36:39], v[56:63], v1
    s_waitcnt lgkmcnt(0)
    v_smfmac_f32_16x16x64_bf16 v[16:19], v[36:39], v[64:71], v1
    v_smfmac_f32_16x16x64_bf16 v[20:23], v[48:51], v[248:255], v1
    v_smfmac_f32_16x16x64_bf16 v[24:27], v[48:51], a[0:7], v1
    v_smfmac_f32_16x16x64_bf16 v[20:23], v[52:55], a[8:15], v1
    v_add_f32 v12, v12, v14
    v_smfmac_f32_16x16x64_bf16 v[24:27], v[52:55], a[16:23], v1
    v_add_f32 v16, v16, v18
    buffer_load_dwordx4 v[64:67], v0, s[8:11], s42 offen
    v_smfmac_f32_16x16x64_bf16 v[20:23], v[36:39], a[24:31], v1
    v_add_f32 v13, v13, v15
    v_smfmac_f32_16x16x64_bf16 v[24:27], v[36:39], a[32:39], v1
    v_add_f32 v17, v17, v19
    v_smfmac_f32_16x16x64_bf16 v[20:23], v[44:47], a[56:63], v1
    v_cvt_pk_bf16_f32 v14, v12, v16
    ds_read_b128 v[56:59], v0 offset:15104
    v_smfmac_f32_16x16x64_bf16 v[24:27], v[44:47], a[64:71], v1
    v_cvt_pk_bf16_f32 v15, v13, v17
    ds_read_b128 v[60:63], v0 offset:16128
    buffer_load_dwordx4 v[68:71], v0, s[8:11], s42 offen offset:1024
    ds_write_b32 v2, v14 offset:576
    ds_write_b32 v2, v15 offset:864
    v_smfmac_f32_16x16x64_bf16 v[28:31], v[48:51], a[104:111], v1
    v_smfmac_f32_16x16x64_bf16 v[32:35], v[48:51], a[112:119], v1
    v_add_f32 v20, v20, v22
    v_add_f32 v24, v24, v26
    v_add_f32 v21, v21, v23
    v_add_f32 v25, v25, v27
    v_cvt_pk_bf16_f32 v22, v20, v24
    v_cvt_pk_bf16_f32 v23, v21, v25
    ds_write_b32 v2, v22 offset:0
    ds_write_b32 v2, v23 offset:288
    v_smfmac_f32_16x16x64_bf16 v[28:31], v[52:55], a[120:127], v1
    v_smfmac_f32_16x16x64_bf16 v[32:35], v[52:55], a[128:135], v1
    s_waitcnt lgkmcnt(0)
    s_barrier
    ds_read_b128 v[40:43], v3 offset:0
    ds_read_b128 v[48:51], v3 offset:64
    ds_read_b128 v[20:23], v3 offset:128
    ds_read_b128 v[52:55], v3 offset:192
    v_smfmac_f32_16x16x64_bf16 v[28:31], v[36:39], a[136:143], v1
    v_smfmac_f32_16x16x64_bf16 v[32:35], v[36:39], a[144:151], v1
    ds_read_b128 v[36:39], v0 offset:17152
    v_lshlrev_b32 v9, 3, v0
    buffer_load_dword v11, v9, s[8:11], s68 offen
    v_smfmac_f32_16x16x64_bf16 v[28:31], v[44:47], a[168:175], v1
    v_smfmac_f32_16x16x64_bf16 v[32:35], v[44:47], a[176:183], v1
    ds_read_b128 v[44:47], v0 offset:18176
    s_waitcnt lgkmcnt(5)
    v_mfma_f32_16x16x32_bf16 v[12:15], v[56:59], v[40:43], 0
    v_mfma_f32_16x16x32_bf16 v[16:19], v[60:63], v[40:43], 0
    v_mfma_f32_16x16x32_bf16 v[24:27], v[40:43], v[40:43], 0
    ds_read_b128 v[56:59], v0 offset:19200
    ds_read_b128 v[60:63], v0 offset:20224
    s_waitcnt lgkmcnt(3)
    v_mfma_f32_16x16x32_bf16 v[12:15], v[36:39], v[48:51], v[12:15]
    v_lshrrev_b32 v10, 1, v0
    v_lshrrev_b32 v9, 9, v0
    s_waitcnt lgkmcnt(2)
    v_mfma_f32_16x16x32_bf16 v[16:19], v[44:47], v[48:51], v[16:19]
    v_lshl_add_u32 v9, v9, 5, v10
    v_add_f32 v28, v28, v30
    v_mfma_f32_16x16x32_bf16 v[24:27], v[48:51], v[48:51], v[24:27]
    v_add_f32 v32, v32, v34
    v_add_f32 v29, v29, v31
    ds_read_b128 v[36:39], v0 offset:21248
    ds_read_b128 v[44:47], v0 offset:22272
    s_waitcnt lgkmcnt(3)
    v_mfma_f32_16x16x32_bf16 v[12:15], v[56:59], v[20:23], v[12:15]
    v_add_f32 v33, v33, v35
    v_cvt_pk_bf16_f32 v30, v28, v29
    s_waitcnt lgkmcnt(2)
    v_mfma_f32_16x16x32_bf16 v[16:19], v[60:63], v[20:23], v[16:19]
    v_cvt_pk_bf16_f32 v31, v32, v33
    ds_read_b64 v[34:35], v9 offset:3456
    v_mfma_f32_16x16x32_bf16 v[24:27], v[20:23], v[20:23], v[24:27]
    s_add_u32 s17, s43, 3584
    buffer_store_dwordx2 v[30:31], v10, s[8:11], s17 offen sc1
    s_waitcnt lgkmcnt(2)
    v_mfma_f32_16x16x32_bf16 v[12:15], v[36:39], v[52:55], v[12:15]
    s_waitcnt lgkmcnt(1)
    v_mfma_f32_16x16x32_bf16 v[16:19], v[44:47], v[52:55], v[16:19]
    v_mfma_f32_16x16x32_bf16 v[24:27], v[52:55], v[52:55], v[24:27]
    s_add_u32 s17, s43, 1536
    s_waitcnt lgkmcnt(0)
    buffer_store_dwordx2 v[34:35], v10, s[8:11], s17 offen sc1
    s_cmp_eq_u32 s33, 63
    s_cbranch_scc1 Lr3f_last
    ds_read_b128 v[56:59], v8 offset:16384
    ds_read_b128 v[60:63], v8 offset:17408
    v_mov_b64 v[20:21], s[52:53]
    v_mov_b64 v[22:23], s[52:53]
    v_mov_b32 v41, 0
    v_mov_b32 v42, 0
    v_max3_f32 v9, v12, v13, v14
    v_max3_f32 v9, v9, v15, v16
    v_max3_f32 v9, v9, v17, v18
    v_max3_f32 v9, v9, v19, v24
    v_max_f32 v9, v9, v25
    v_mov_b32 v10, v9
    v_mov_b64 v[32:33], 0
    v_mov_b64 v[34:35], 0
    v_permlane32_swap_b32 v9, v10
    v_max_f32 v9, v9, v10
    v_mov_b32 v10, v9
    s_nop 1
    v_permlane16_swap_b32 v9, v10
    v_max_f32 v9, v9, v10
    v_mul_f32 v28, s44, v9
    v_fma_f32 v12, v12, s44, -v28
    v_fma_f32 v13, v13, s44, -v28
    v_fma_f32 v14, v14, s44, -v28
    v_fma_f32 v15, v15, s44, -v28
    v_exp_f32 v12, v12
    v_exp_f32 v13, v13
    v_fma_f32 v16, v16, s44, -v28
    v_fma_f32 v17, v17, s44, -v28
    v_exp_f32 v14, v14
    v_exp_f32 v15, v15
    v_cvt_pk_bf16_f32 v36, v12, v13
    v_fma_f32 v18, v18, s44, -v28
    v_fma_f32 v19, v19, s44, -v28
    v_exp_f32 v16, v16
    v_exp_f32 v17, v17
    v_cvt_pk_bf16_f32 v37, v14, v15
    v_fma_f32 v24, v24, s44, -v28
    v_fma_f32 v25, v25, s44, -v28
    v_exp_f32 v18, v18
    v_exp_f32 v19, v19
    v_cvt_pk_bf16_f32 v38, v16, v17
    v_exp_f32 v24, v24
    v_exp_f32 v25, v25
    v_cvt_pk_bf16_f32 v39, v18, v19
    v_cvt_pk_bf16_f32 v40, v24, v25
    v_cvt_pk_bf16_f32 v43, v24, v25
    v_mfma_f32_16x16x32_bf16 v[52:55], v[20:23], v[36:39], 0
    v_mov_b64 v[12:13], 0
    v_mov_b64 v[14:15], 0
    s_waitcnt vmcnt(4)
    v_mfma_f32_16x16x32_bf16 v[44:47], v[64:67], v[36:39], 0
    v_mov_b64 v[24:25], 0
    v_mov_b64 v[26:27], 0
    s_waitcnt vmcnt(3)
    v_mfma_f32_16x16x32_bf16 v[48:51], v[68:71], v[36:39], 0
    ds_read_b128 v[64:67], v8 offset:20480
    ds_read_b128 v[68:71], v8 offset:21504
    v_mfma_f32_16x16x16_bf16 v[52:55], v[20:21], v[40:41], v[52:55]
    v_mfma_f32_16x16x16_bf16 v[44:47], v[30:31], v[40:41], v[44:47]
    v_mov_b64 v[20:21], 0
    v_mov_b64 v[22:23], 0
    v_mfma_f32_16x16x16_bf16 v[48:51], v[30:31], v[42:43], v[48:51]
    v_mov_b64 v[36:37], 0
    v_mov_b64 v[38:39], 0
    v_mov_b64 v[40:41], 0
    v_mov_b64 v[42:43], 0
    v_rcp_f32 v9, v52
    v_mov_b64 v[52:53], 0
    v_mov_b64 v[54:55], 0
    v_mul_f32 v44, v9, v44
    v_mul_f32 v48, v9, v48
    v_cvt_pk_bf16_f32 v16, v44, v48
    v_mul_f32 v45, v9, v45
    v_mul_f32 v49, v9, v49
    v_cvt_pk_bf16_f32 v17, v45, v49
    v_mul_f32 v46, v9, v46
    v_mul_f32 v50, v9, v50
    v_cvt_pk_bf16_f32 v18, v46, v50
    v_mul_f32 v47, v9, v47
    v_mul_f32 v51, v9, v51
    v_cvt_pk_bf16_f32 v19, v47, v51
    ds_write_b128 v5, v[16:19]
    v_mov_b64 v[28:29], 0
    v_mov_b64 v[30:31], 0
    s_waitcnt lgkmcnt(0)
    s_barrier
    ds_read_b128 v[44:47], v4 offset:0
    ds_read_b128 v[48:51], v4 offset:128
    v_mov_b64 v[16:17], 0
    v_mov_b64 v[18:19], 0
    buffer_load_dwordx4 v0, s[8:11], s41 offen offset:0 lds
    buffer_load_dwordx4 v0, s[8:11], s41 offen offset:1024 lds
    s_waitcnt lgkmcnt(1)
    v_smfmac_f32_16x16x64_bf16 v[12:15], v[44:47], a[184:191], v1
    s_waitcnt lgkmcnt(0)
    v_smfmac_f32_16x16x64_bf16 v[12:15], v[48:51], a[192:199], v1
    v_smfmac_f32_16x16x64_bf16 v[24:27], v[44:47], a[200:207], v1
    v_smfmac_f32_16x16x64_bf16 v[24:27], v[48:51], a[208:215], v1
    v_add_f32 v12, v12, v14
    v_smfmac_f32_16x16x64_bf16 v[20:23], v[44:47], a[216:223], v1
    v_add_f32 v13, v13, v15
    v_smfmac_f32_16x16x64_bf16 v[20:23], v[48:51], a[224:231], v1
    v_cvt_pk_bf16_f32 v12, v12, v13
    v_smfmac_f32_16x16x64_bf16 v[16:19], v[44:47], a[232:239], v1
    v_add_f32 v24, v24, v26
    v_smfmac_f32_16x16x64_bf16 v[16:19], v[48:51], a[240:247], v1
    v_add_f32 v25, v25, v27
    v_smfmac_f32_16x16x64_bf16 v[36:39], v[44:47], v[56:63], v1
    v_cvt_pk_bf16_f32 v13, v24, v25
    v_smfmac_f32_16x16x64_bf16 v[36:39], v[48:51], v[64:71], v1
    v_add_f32 v20, v20, v22
    v_add_f32 v21, v21, v23
    v_cvt_pk_bf16_f32 v14, v20, v21
    v_add_f32 v16, v16, v18
    v_add_f32 v17, v17, v19
    v_cvt_pk_bf16_f32 v15, v16, v17
    v_and_or_b32 v15, v15, -2, s40
    buffer_store_dwordx4 v[12:15], v0, s[8:11], s38 offen
    s_nop 0
    ds_read_b128 v[12:15], v8 offset:18432
    ds_read_b128 v[16:19], v8 offset:19456
    ds_read_b128 v[20:23], v8 offset:22528
    ds_read_b128 v[24:27], v8 offset:23552
    ds_read_b128 v[56:59], v8 offset:24576
    ds_read_b128 v[60:63], v8 offset:25600
    ds_read_b128 v[64:67], v8 offset:28672
    ds_read_b128 v[68:71], v8 offset:29696
    s_waitcnt lgkmcnt(6)
    v_smfmac_f32_16x16x64_bf16 v[40:43], v[44:47], v[12:19], v1
    ds_read_b128 v[12:15], v8 offset:26624
    ds_read_b128 v[16:19], v8 offset:27648
    s_waitcnt lgkmcnt(6)
    v_smfmac_f32_16x16x64_bf16 v[40:43], v[48:51], v[20:27], v1
    ds_read_b128 v[20:23], v8 offset:30720
    ds_read_b128 v[24:27], v8 offset:31744
    s_waitcnt lgkmcnt(6)
    v_smfmac_f32_16x16x64_bf16 v[52:55], v[44:47], v[56:63], v1
    ds_read_b128 v[56:59], v8 offset:32768
    ds_read_b128 v[60:63], v8 offset:33792
    s_waitcnt lgkmcnt(6)
    v_smfmac_f32_16x16x64_bf16 v[52:55], v[48:51], v[64:71], v1
    s_waitcnt lgkmcnt(4)
    v_smfmac_f32_16x16x64_bf16 v[32:35], v[44:47], v[12:19], v1
    s_waitcnt lgkmcnt(2)
    v_smfmac_f32_16x16x64_bf16 v[32:35], v[48:51], v[20:27], v1
    v_smfmac_f32_16x16x64_bf16 v[28:31], v[44:47], a[248:255], v1
    s_waitcnt lgkmcnt(0)
    v_smfmac_f32_16x16x64_bf16 v[28:31], v[48:51], v[56:63], v1
    v_add_f32 v36, v36, v38
    v_add_f32 v37, v37, v39
    v_cvt_pk_bf16_f32 v36, v36, v37
    v_add_f32 v40, v40, v42
    v_add_f32 v41, v41, v43
    v_cvt_pk_bf16_f32 v37, v40, v41
    v_add_f32 v52, v52, v54
    v_add_f32 v53, v53, v55
    v_cvt_pk_bf16_f32 v38, v52, v53
    v_add_f32 v32, v32, v34
    v_add_f32 v33, v33, v35
    v_cvt_pk_bf16_f32 v39, v32, v33
    v_and_or_b32 v39, v39, -2, s40
    s_add_u32 s17, s38, 4096
    buffer_store_dwordx4 v[36:39], v0, s[8:11], s17 offen
    v_add_f32 v28, v28, v30
    v_add_f32 v29, v29, v31
    v_cvt_pk_bf16_f32 v28, v28, v29
    v_and_or_b32 v28, v28, -2, s40
    v_lshrrev_b32 v9, 2, v0
    buffer_store_dword v28, v9, s[8:11], s39 offen
    s_xor_b32 s34, s34, 16384
    s_xor_b32 s35, s35, 16384
    s_add_u32 s33, s33, 1
    s_add_u32 s42, s42, 262144
    s_add_u32 s41, s41, 262144
    s_add_u32 s43, s43, 131072
    s_add_u32 s68, s68, 262144
    s_add_u32 s66, s66, 22528
    s_xor_b32 s40, s40, 1
    ds_read_b128 v[56:59], v8 offset:0
    ds_read_b128 v[60:63], v8 offset:1024
    ds_read_b128 v[64:67], v8 offset:2048
    ds_read_b128 v[68:71], v8 offset:3072
    v_mov_b64 v[12:13], 0
    v_mov_b64 v[14:15], 0
    v_mov_b64 v[16:17], 0
    v_mov_b64 v[18:19], 0
    v_mov_b64 v[20:21], 0
    v_mov_b64 v[22:23], 0
    v_mov_b64 v[24:25], 0
    v_mov_b64 v[26:27], 0
    v_mov_b64 v[28:29], 0
    v_mov_b64 v[30:31], 0
    v_mov_b64 v[32:33], 0
    v_mov_b64 v[34:35], 0
    s_sleep 5
    s_nop 9
    buffer_load_dwordx4 v[36:39], v0, s[8:11], s34 offen sc1
    s_nop 15
    s_nop 8
    buffer_load_dwordx4 v[36:39], v0, s[8:11], s34 offen sc1
    s_nop 15
    s_nop 8
    buffer_load_dwordx4 v[36:39], v0, s[8:11], s34 offen sc1
    s_waitcnt lgkmcnt(0)
    s_branch Lr3f_step
Lr3f_pb_re:
    s_mov_b32 s16, 0
Lr3f_pb_lp:
    s_add_u32 s17, s34, 4096
    buffer_load_dwordx4 v[40:43], v0, s[8:11], s17 offen sc1
    s_add_u32 s16, s16, 1
    s_cmp_gt_u32 s16, 100000
    s_cbranch_scc1 Lr_abort
    s_waitcnt vmcnt(0)
    v_max3_u32 v10, v40, v41, v42
    v_max_u32 v10, v10, v43
    v_cmp_eq_u32 vcc, -1, v10
    s_nop 0
    s_cbranch_vccnz Lr3f_pb_lp
    s_branch Lr3f_pb_ok
Lr3f_pc_re:
    s_mov_b32 s16, 0
Lr3f_pc_lp:
    buffer_load_dwordx4 v[44:47], v0, s[8:11], s35 offen sc1
    s_add_u32 s16, s16, 1
    s_cmp_gt_u32 s16, 100000
    s_cbranch_scc1 Lr_abort
    s_waitcnt vmcnt(0)
    v_max3_u32 v10, v44, v45, v46
    v_max_u32 v10, v10, v47
    v_cmp_eq_u32 vcc, -1, v10
    s_nop 0
    s_cbranch_vccnz Lr3f_pc_lp
    s_branch Lr3f_pc_ok
Lr3f_last:
    s_waitcnt vmcnt(0) lgkmcnt(0)
    s_barrier
    s_branch Lr_exit
L_slow:
    s_cmp_lg_u32 s14, 0
    s_cbranch_scc1 L_w1_0
    buffer_load_dwordx4 v[36:39], v0, s[8:11], s34 offen sc1
    s_mov_b32 s16, 0
    s_add_u32 s17, s66, 128
    v_lshrrev_b32 v10, 2, v0
    v_and_b32 v9, 16, v10
    v_lshlrev_b32 v9, 3, v9
    v_and_or_b32 v10, v10, 12, v9
Lr0s_fw_15:
    buffer_load_dword v9, v10, s[8:11], s17 offen sc1
    s_add_u32 s16, s16, 1
    s_cmp_gt_u32 s16, 100000
    s_cbranch_scc1 Lr_abort
    s_waitcnt vmcnt(0)
    v_cmp_eq_u32 vcc, 0, v9
    s_nop 0
    s_cbranch_vccnz Lr0s_fw_15
    s_mov_b32 m0, 15104
    s_nop 0
    buffer_load_dwordx4 v0, s[8:11], s41 offen offset:0 lds
    buffer_load_dwordx4 v0, s[8:11], s41 offen offset:1024 lds
    s_add_u32 s41, s41, 262144
    s_add_u32 s68, s68, 4278452224
    ds_read_b128 v[56:59], v8 offset:0
    ds_read_b128 v[60:63], v8 offset:1024
    ds_read_b128 v[64:67], v8 offset:2048
    ds_read_b128 v[68:71], v8 offset:3072
    v_mov_b64 v[12:13], 0
    v_mov_b64 v[14:15], 0
    v_mov_b64 v[16:17], 0
    v_mov_b64 v[18:19], 0
    v_mov_b64 v[20:21], 0
    v_mov_b64 v[22:23], 0
    v_mov_b64 v[24:25], 0
    v_mov_b64 v[26:27], 0
    v_mov_b64 v[28:29], 0
    v_mov_b64 v[30:31], 0
    v_mov_b64 v[32:33], 0
    v_mov_b64 v[34:35], 0
    s_waitcnt vmcnt(0) lgkmcnt(0)
Lr0s_step:
    s_mov_b32 s16, 0
Lr0s_alp:
    s_waitcnt vmcnt(2)
    v_max3_u32 v10, v36, v37, v38
    v_max_u32 v10, v10, v39
    v_cmp_eq_u32 vcc, -1, v10
    s_nop 0
    s_cbranch_vccz Lr0s_aok
    buffer_load_dwordx4 v[36:39], v0, s[8:11], s34 offen sc1
    s_add_u32 s16, s16, 1
    s_cmp_gt_u32 s16, 100000
    s_cbranch_scc1 Lr_abort
    s_branch Lr0s_alp
Lr0s_aok:
    ds_write_b128 v0, v[36:39] offset:6912
    v_smfmac_f32_16x16x64_bf16 v[12:15], v[36:39], v[72:79], v1
    v_smfmac_f32_16x16x64_bf16 v[16:19], v[36:39], v[80:87], v1
    v_smfmac_f32_16x16x64_bf16 v[20:23], v[36:39], v[184:191], v1
    s_waitcnt lgkmcnt(0)
    s_barrier
    ds_read_b128 v[48:51], v0 offset:7936
    ds_read_b128 v[52:55], v0 offset:8960
    v_smfmac_f32_16x16x64_bf16 v[28:31], v[36:39], v[56:63], v1
    ds_read_b128 v[56:59], v8 offset:4096
    ds_read_b128 v[60:63], v8 offset:5120
    s_add_u32 s17, s34, 4096
    buffer_load_dwordx4 v[40:43], v0, s[8:11], s17 offen sc1
    v_smfmac_f32_16x16x64_bf16 v[24:27], v[36:39], v[192:199], v1
    v_smfmac_f32_16x16x64_bf16 v[32:35], v[36:39], v[64:71], v1
    ds_read_b128 v[64:67], v8 offset:6144
    ds_read_b128 v[68:71], v8 offset:7168
    s_waitcnt vmcnt(1)
    ds_read_b128 v[36:39], v0 offset:9984
    s_waitcnt lgkmcnt(6)
    v_smfmac_f32_16x16x64_bf16 v[28:31], v[48:51], a[72:79], v1
    v_smfmac_f32_16x16x64_bf16 v[12:15], v[48:51], v[88:95], v1
    buffer_load_dwordx4 v[44:47], v0, s[8:11], s35 offen sc1
    v_smfmac_f32_16x16x64_bf16 v[16:19], v[48:51], v[96:103], v1
    v_smfmac_f32_16x16x64_bf16 v[32:35], v[48:51], a[80:87], v1
    v_smfmac_f32_16x16x64_bf16 v[20:23], v[48:51], v[200:207], v1
    v_smfmac_f32_16x16x64_bf16 v[24:27], v[48:51], v[208:215], v1
    s_waitcnt lgkmcnt(3)
    v_smfmac_f32_16x16x64_bf16 v[28:31], v[52:55], v[56:63], v1
    ds_read_b128 v[56:59], v8 offset:8192
    ds_read_b128 v[60:63], v8 offset:9216
    v_smfmac_f32_16x16x64_bf16 v[12:15], v[52:55], v[104:111], v1
    v_smfmac_f32_16x16x64_bf16 v[16:19], v[52:55], v[112:119], v1
    s_waitcnt lgkmcnt(3)
    v_smfmac_f32_16x16x64_bf16 v[32:35], v[52:55], v[64:71], v1
    ds_read_b128 v[64:67], v8 offset:10240
    ds_read_b128 v[68:71], v8 offset:11264
    v_smfmac_f32_16x16x64_bf16 v[20:23], v[52:55], v[216:223], v1
    v_smfmac_f32_16x16x64_bf16 v[24:27], v[52:55], v[224:231], v1
    s_waitcnt lgkmcnt(4)
    v_smfmac_f32_16x16x64_bf16 v[28:31], v[36:39], a[88:95], v1
    v_smfmac_f32_16x16x64_bf16 v[12:15], v[36:39], v[120:127], v1
    v_smfmac_f32_16x16x64_bf16 v[16:19], v[36:39], v[128:135], v1
    v_smfmac_f32_16x16x64_bf16 v[32:35], v[36:39], a[96:103], v1
    v_smfmac_f32_16x16x64_bf16 v[20:23], v[36:39], v[232:239], v1
    v_smfmac_f32_16x16x64_bf16 v[24:27], v[36:39], v[240:247], v1
    s_waitcnt vmcnt(1)
    v_max3_u32 v10, v40, v41, v42
    v_max_u32 v10, v10, v43
    v_cmp_eq_u32 vcc, -1, v10
    s_nop 0
    s_cbranch_vccnz Lr0s_pb_re
Lr0s_pb_ok:
    ds_write_b128 v0, v[40:43] offset:11008
    s_waitcnt lgkmcnt(3)
    v_smfmac_f32_16x16x64_bf16 v[12:15], v[40:43], v[56:63], v1
    ds_read_b128 v[56:59], v8 offset:12288
    ds_read_b128 v[60:63], v8 offset:13312
    v_smfmac_f32_16x16x64_bf16 v[20:23], v[40:43], v[248:255], v1
    s_waitcnt lgkmcnt(3)
    v_smfmac_f32_16x16x64_bf16 v[16:19], v[40:43], v[64:71], v1
    ds_read_b128 v[64:67], v8 offset:14336
    ds_read_b128 v[68:71], v8 offset:15360
    v_smfmac_f32_16x16x64_bf16 v[24:27], v[40:43], a[0:7], v1
    s_waitcnt lgkmcnt(4)
    s_barrier
    ds_read_b128 v[48:51], v0 offset:13056
    ds_read_b128 v[52:55], v0 offset:12032
    ds_read_b128 v[36:39], v0 offset:14080
    v_smfmac_f32_16x16x64_bf16 v[28:31], v[40:43], a[104:111], v1
    v_smfmac_f32_16x16x64_bf16 v[32:35], v[40:43], a[112:119], v1
    s_waitcnt lgkmcnt(2)
    v_smfmac_f32_16x16x64_bf16 v[12:15], v[48:51], v[56:63], v1
    v_smfmac_f32_16x16x64_bf16 v[16:19], v[48:51], v[64:71], v1
    s_waitcnt lgkmcnt(1)
    v_smfmac_f32_16x16x64_bf16 v[12:15], v[52:55], v[136:143], v1
    v_smfmac_f32_16x16x64_bf16 v[16:19], v[52:55], v[144:151], v1
    s_waitcnt lgkmcnt(0)
    v_smfmac_f32_16x16x64_bf16 v[12:15], v[36:39], v[152:159], v1
    v_smfmac_f32_16x16x64_bf16 v[16:19], v[36:39], v[160:167], v1
    s_waitcnt vmcnt(0)
    v_max3_u32 v10, v44, v45, v46
    v_max_u32 v10, v10, v47
    v_cmp_eq_u32 vcc, -1, v10
    s_nop 0
    s_cbranch_vccnz Lr0s_pc_re
Lr0s_pc_ok:
    v_smfmac_f32_16x16x64_bf16 v[12:15], v[44:47], v[168:175], v1
    v_smfmac_f32_16x16x64_bf16 v[16:19], v[44:47], v[176:183], v1
    v_smfmac_f32_16x16x64_bf16 v[20:23], v[48:51], a[24:31], v1
    buffer_load_dwordx4 v[64:67], v0, s[8:11], s42 offen
    v_smfmac_f32_16x16x64_bf16 v[24:27], v[48:51], a[32:39], v1
    v_smfmac_f32_16x16x64_bf16 v[20:23], v[52:55], a[8:15], v1
    v_add_f32 v12, v12, v14
    v_smfmac_f32_16x16x64_bf16 v[24:27], v[52:55], a[16:23], v1
    v_add_f32 v16, v16, v18
    v_smfmac_f32_16x16x64_bf16 v[20:23], v[36:39], a[40:47], v1
    v_add_f32 v13, v13, v15
    buffer_load_dwordx4 v[68:71], v0, s[8:11], s42 offen offset:1024
    v_smfmac_f32_16x16x64_bf16 v[24:27], v[36:39], a[48:55], v1
    v_add_f32 v17, v17, v19
    v_smfmac_f32_16x16x64_bf16 v[20:23], v[44:47], a[56:63], v1
    v_cvt_pk_bf16_f32 v14, v12, v16
    ds_read_b128 v[56:59], v0 offset:15104
    v_smfmac_f32_16x16x64_bf16 v[24:27], v[44:47], a[64:71], v1
    v_cvt_pk_bf16_f32 v15, v13, v17
    ds_read_b128 v[60:63], v0 offset:16128
    ds_write_b32 v2, v14 offset:576
    ds_write_b32 v2, v15 offset:864
    v_smfmac_f32_16x16x64_bf16 v[28:31], v[48:51], a[136:143], v1
    v_smfmac_f32_16x16x64_bf16 v[32:35], v[48:51], a[144:151], v1
    v_add_f32 v20, v20, v22
    v_add_f32 v24, v24, v26
    v_add_f32 v21, v21, v23
    v_add_f32 v25, v25, v27
    v_cvt_pk_bf16_f32 v22, v20, v24
    v_cvt_pk_bf16_f32 v23, v21, v25
    ds_write_b32 v2, v22 offset:0
    ds_write_b32 v2, v23 offset:288
    v_smfmac_f32_16x16x64_bf16 v[28:31], v[52:55], a[120:127], v1
    v_smfmac_f32_16x16x64_bf16 v[32:35], v[52:55], a[128:135], v1
    s_waitcnt lgkmcnt(0)
    s_barrier
    ds_read_b128 v[40:43], v3 offset:0
    ds_read_b128 v[48:51], v3 offset:64
    ds_read_b128 v[20:23], v3 offset:128
    ds_read_b128 v[52:55], v3 offset:192
    v_smfmac_f32_16x16x64_bf16 v[28:31], v[36:39], a[152:159], v1
    v_smfmac_f32_16x16x64_bf16 v[32:35], v[36:39], a[160:167], v1
    ds_read_b128 v[36:39], v0 offset:17152
    v_lshlrev_b32 v9, 3, v0
    buffer_load_dword v11, v9, s[8:11], s68 offen
    v_smfmac_f32_16x16x64_bf16 v[28:31], v[44:47], a[168:175], v1
    v_smfmac_f32_16x16x64_bf16 v[32:35], v[44:47], a[176:183], v1
    ds_read_b128 v[44:47], v0 offset:18176
    s_waitcnt lgkmcnt(5)
    v_mfma_f32_16x16x32_bf16 v[12:15], v[56:59], v[40:43], 0
    v_mfma_f32_16x16x32_bf16 v[16:19], v[60:63], v[40:43], 0
    v_mfma_f32_16x16x32_bf16 v[24:27], v[40:43], v[40:43], 0
    ds_read_b128 v[56:59], v0 offset:19200
    ds_read_b128 v[60:63], v0 offset:20224
    s_waitcnt lgkmcnt(3)
    v_mfma_f32_16x16x32_bf16 v[12:15], v[36:39], v[48:51], v[12:15]
    v_lshrrev_b32 v10, 1, v0
    v_lshrrev_b32 v9, 9, v0
    s_waitcnt lgkmcnt(2)
    v_mfma_f32_16x16x32_bf16 v[16:19], v[44:47], v[48:51], v[16:19]
    v_lshl_add_u32 v9, v9, 5, v10
    v_add_f32 v28, v28, v30
    v_mfma_f32_16x16x32_bf16 v[24:27], v[48:51], v[48:51], v[24:27]
    v_add_f32 v32, v32, v34
    v_add_f32 v29, v29, v31
    ds_read_b128 v[36:39], v0 offset:21248
    ds_read_b128 v[44:47], v0 offset:22272
    s_waitcnt lgkmcnt(3)
    v_mfma_f32_16x16x32_bf16 v[12:15], v[56:59], v[20:23], v[12:15]
    v_add_f32 v33, v33, v35
    v_cvt_pk_bf16_f32 v30, v28, v29
    s_waitcnt lgkmcnt(2)
    v_mfma_f32_16x16x32_bf16 v[16:19], v[60:63], v[20:23], v[16:19]
    v_cvt_pk_bf16_f32 v31, v32, v33
    ds_read_b64 v[34:35], v9 offset:0
    v_mfma_f32_16x16x32_bf16 v[24:27], v[20:23], v[20:23], v[24:27]
    s_add_u32 s17, s43, 2048
    buffer_store_dwordx2 v[30:31], v10, s[8:11], s17 offen sc1
    s_waitcnt lgkmcnt(2)
    v_mfma_f32_16x16x32_bf16 v[12:15], v[36:39], v[52:55], v[12:15]
    s_waitcnt lgkmcnt(1)
    v_mfma_f32_16x16x32_bf16 v[16:19], v[44:47], v[52:55], v[16:19]
    v_mfma_f32_16x16x32_bf16 v[24:27], v[52:55], v[52:55], v[24:27]
    s_add_u32 s17, s43, 0
    s_waitcnt lgkmcnt(0)
    buffer_store_dwordx2 v[34:35], v10, s[8:11], s17 offen sc1
    s_cmp_eq_u32 s33, 63
    s_cbranch_scc1 Lr0s_last
    ds_read_b128 v[56:59], v8 offset:16384
    ds_read_b128 v[60:63], v8 offset:17408
    v_mov_b64 v[20:21], s[52:53]
    v_mov_b64 v[22:23], s[52:53]
    v_mov_b32 v41, 0
    v_mov_b32 v42, 0
    v_max3_f32 v9, v12, v13, v14
    v_max3_f32 v9, v9, v15, v16
    v_max3_f32 v9, v9, v17, v18
    v_max3_f32 v9, v9, v19, v24
    v_max_f32 v9, v9, v25
    v_mov_b32 v10, v9
    v_mov_b64 v[32:33], 0
    v_mov_b64 v[34:35], 0
    v_permlane32_swap_b32 v9, v10
    v_max_f32 v9, v9, v10
    v_mov_b32 v10, v9
    s_nop 1
    v_permlane16_swap_b32 v9, v10
    v_max_f32 v9, v9, v10
    v_mul_f32 v28, s44, v9
    v_fma_f32 v12, v12, s44, -v28
    v_fma_f32 v13, v13, s44, -v28
    v_fma_f32 v14, v14, s44, -v28
    v_fma_f32 v15, v15, s44, -v28
    v_exp_f32 v12, v12
    v_exp_f32 v13, v13
    v_fma_f32 v16, v16, s44, -v28
    v_fma_f32 v17, v17, s44, -v28
    v_exp_f32 v14, v14
    v_exp_f32 v15, v15
    v_cvt_pk_bf16_f32 v36, v12, v13
    v_fma_f32 v18, v18, s44, -v28
    v_fma_f32 v19, v19, s44, -v28
    v_exp_f32 v16, v16
    v_exp_f32 v17, v17
    v_cvt_pk_bf16_f32 v37, v14, v15
    v_fma_f32 v24, v24, s44, -v28
    v_fma_f32 v25, v25, s44, -v28
    v_exp_f32 v18, v18
    v_exp_f32 v19, v19
    v_cvt_pk_bf16_f32 v38, v16, v17
    v_exp_f32 v24, v24
    v_exp_f32 v25, v25
    v_cvt_pk_bf16_f32 v39, v18, v19
    v_cvt_pk_bf16_f32 v40, v24, v25
    v_cvt_pk_bf16_f32 v43, v24, v25
    v_mfma_f32_16x16x32_bf16 v[52:55], v[20:23], v[36:39], 0
    v_mov_b64 v[12:13], 0
    v_mov_b64 v[14:15], 0
    s_waitcnt vmcnt(4)
    v_mfma_f32_16x16x32_bf16 v[44:47], v[64:67], v[36:39], 0
    v_mov_b64 v[24:25], 0
    v_mov_b64 v[26:27], 0
    s_waitcnt vmcnt(3)
    v_mfma_f32_16x16x32_bf16 v[48:51], v[68:71], v[36:39], 0
    ds_read_b128 v[64:67], v8 offset:20480
    ds_read_b128 v[68:71], v8 offset:21504
    v_mfma_f32_16x16x16_bf16 v[52:55], v[20:21], v[40:41], v[52:55]
    v_mfma_f32_16x16x16_bf16 v[44:47], v[30:31], v[40:41], v[44:47]
    v_mov_b64 v[20:21], 0
    v_mov_b64 v[22:23], 0
    v_mfma_f32_16x16x16_bf16 v[48:51], v[30:31], v[42:43], v[48:51]
    v_mov_b64 v[36:37], 0
    v_mov_b64 v[38:39], 0
    v_mov_b64 v[40:41], 0
    v_mov_b64 v[42:43], 0
    v_rcp_f32 v9, v52
    v_mov_b64 v[52:53], 0
    v_mov_b64 v[54:55], 0
    v_mul_f32 v44, v9, v44
    v_mul_f32 v48, v9, v48
    v_cvt_pk_bf16_f32 v16, v44, v48
    v_mul_f32 v45, v9, v45
    v_mul_f32 v49, v9, v49
    v_cvt_pk_bf16_f32 v17, v45, v49
    v_mul_f32 v46, v9, v46
    v_mul_f32 v50, v9, v50
    v_cvt_pk_bf16_f32 v18, v46, v50
    v_mul_f32 v47, v9, v47
    v_mul_f32 v51, v9, v51
    v_cvt_pk_bf16_f32 v19, v47, v51
    ds_write_b128 v5, v[16:19]
    v_mov_b64 v[28:29], 0
    v_mov_b64 v[30:31], 0
    s_waitcnt lgkmcnt(0)
    s_barrier
    ds_read_b128 v[44:47], v4 offset:0
    ds_read_b128 v[48:51], v4 offset:128
    v_mov_b64 v[16:17], 0
    v_mov_b64 v[18:19], 0
    buffer_load_dwordx4 v0, s[8:11], s41 offen offset:0 lds
    buffer_load_dwordx4 v0, s[8:11], s41 offen offset:1024 lds
    s_waitcnt lgkmcnt(1)
    v_smfmac_f32_16x16x64_bf16 v[12:15], v[44:47], a[184:191], v1
    s_waitcnt lgkmcnt(0)
    v_smfmac_f32_16x16x64_bf16 v[12:15], v[48:51], a[192:199], v1
    v_smfmac_f32_16x16x64_bf16 v[24:27], v[44:47], a[200:207], v1
    v_smfmac_f32_16x16x64_bf16 v[24:27], v[48:51], a[208:215], v1
    v_add_f32 v12, v12, v14
    v_smfmac_f32_16x16x64_bf16 v[20:23], v[44:47], a[216:223], v1
    v_add_f32 v13, v13, v15
    v_smfmac_f32_16x16x64_bf16 v[20:23], v[48:51], a[224:231], v1
    v_cvt_pk_bf16_f32 v12, v12, v13
    v_smfmac_f32_16x16x64_bf16 v[16:19], v[44:47], a[232:239], v1
    v_add_f32 v24, v24, v26
    v_smfmac_f32_16x16x64_bf16 v[16:19], v[48:51], a[240:247], v1
    v_add_f32 v25, v25, v27
    v_smfmac_f32_16x16x64_bf16 v[36:39], v[44:47], v[56:63], v1
    v_cvt_pk_bf16_f32 v13, v24, v25
    v_smfmac_f32_16x16x64_bf16 v[36:39], v[48:51], v[64:71], v1
    v_add_f32 v20, v20, v22
    v_add_f32 v21, v21, v23
    v_cvt_pk_bf16_f32 v14, v20, v21
    v_add_f32 v16, v16, v18
    v_add_f32 v17, v17, v19
    v_cvt_pk_bf16_f32 v15, v16, v17
    v_and_or_b32 v15, v15, -2, s40
    buffer_store_dwordx4 v[12:15], v0, s[8:11], s38 offen sc1
    s_nop 0
    ds_read_b128 v[12:15], v8 offset:18432
    ds_read_b128 v[16:19], v8 offset:19456
    ds_read_b128 v[20:23], v8 offset:22528
    ds_read_b128 v[24:27], v8 offset:23552
    ds_read_b128 v[56:59], v8 offset:24576
    ds_read_b128 v[60:63], v8 offset:25600
    ds_read_b128 v[64:67], v8 offset:28672
    ds_read_b128 v[68:71], v8 offset:29696
    s_waitcnt lgkmcnt(6)
    v_smfmac_f32_16x16x64_bf16 v[40:43], v[44:47], v[12:19], v1
    ds_read_b128 v[12:15], v8 offset:26624
    ds_read_b128 v[16:19], v8 offset:27648
    s_waitcnt lgkmcnt(6)
    v_smfmac_f32_16x16x64_bf16 v[40:43], v[48:51], v[20:27], v1
    ds_read_b128 v[20:23], v8 offset:30720
    ds_read_b128 v[24:27], v8 offset:31744
    s_waitcnt lgkmcnt(6)
    v_smfmac_f32_16x16x64_bf16 v[52:55], v[44:47], v[56:63], v1
    ds_read_b128 v[56:59], v8 offset:32768
    ds_read_b128 v[60:63], v8 offset:33792
    s_waitcnt lgkmcnt(6)
    v_smfmac_f32_16x16x64_bf16 v[52:55], v[48:51], v[64:71], v1
    s_waitcnt lgkmcnt(4)
    v_smfmac_f32_16x16x64_bf16 v[32:35], v[44:47], v[12:19], v1
    s_waitcnt lgkmcnt(2)
    v_smfmac_f32_16x16x64_bf16 v[32:35], v[48:51], v[20:27], v1
    v_smfmac_f32_16x16x64_bf16 v[28:31], v[44:47], a[248:255], v1
    s_waitcnt lgkmcnt(0)
    v_smfmac_f32_16x16x64_bf16 v[28:31], v[48:51], v[56:63], v1
    buffer_load_dwordx4 v[12:15], v6, s[8:11], s62 offen sc1
    buffer_load_dwordx4 v[16:19], v6, s[8:11], s63 offen sc1
    buffer_load_dwordx4 v[20:23], v6, s[8:11], s64 offen sc1
    buffer_load_dwordx4 v[24:27], v6, s[8:11], s65 offen sc1
    v_add_f32 v36, v36, v38
    v_add_f32 v37, v37, v39
    v_cvt_pk_bf16_f32 v36, v36, v37
    v_add_f32 v40, v40, v42
    v_add_f32 v41, v41, v43
    v_cvt_pk_bf16_f32 v37, v40, v41
    v_add_f32 v52, v52, v54
    v_add_f32 v53, v53, v55
    v_cvt_pk_bf16_f32 v38, v52, v53
    v_add_f32 v32, v32, v34
    v_add_f32 v33, v33, v35
    v_cvt_pk_bf16_f32 v39, v32, v33
    v_and_or_b32 v39, v39, -2, s40
    s_add_u32 s17, s38, 4096
    buffer_store_dwordx4 v[36:39], v0, s[8:11], s17 offen sc1
    v_add_f32 v28, v28, v30
    v_add_f32 v29, v29, v31
    v_cvt_pk_bf16_f32 v28, v28, v29
    v_and_or_b32 v28, v28, -2, s40
    v_lshrrev_b32 v9, 2, v0
    buffer_store_dword v28, v9, s[8:11], s39 offen sc1
    v_add_u32 v10, 162560, v0
    ds_read_b128 v[64:67], v10
    s_nop 9
    buffer_load_dwordx4 v[40:43], v6, s[8:11], s62 offen sc1
    buffer_load_dwordx4 v[44:47], v6, s[8:11], s63 offen sc1
    buffer_load_dwordx4 v[48:51], v6, s[8:11], s64 offen sc1
    buffer_load_dwordx4 v[52:55], v6, s[8:11], s65 offen sc1
    s_add_u32 s33, s33, 1
    s_add_u32 s42, s42, 262144
    s_add_u32 s41, s41, 262144
    s_add_u32 s43, s43, 131072
    s_add_u32 s68, s68, 262144
    s_add_u32 s66, s66, 22528
    ds_read_b128 v[56:59], v8 offset:0
    ds_read_b128 v[60:63], v8 offset:1024
    s_waitcnt lgkmcnt(2)
    s_waitcnt vmcnt(9)
    v_mfma_f32_16x16x32_bf16 v[68:71], v[12:15], v[64:67], 0
    v_and_b32 v10, 1, v15
    v_cmp_ne_u32 s[54:55], s40, v10
    s_waitcnt vmcnt(8)
    v_mfma_f32_16x16x32_bf16 v[68:71], v[16:19], v[64:67], v[68:71]
    v_and_b32 v10, 1, v19
    v_cmp_ne_u32 s[56:57], s40, v10
    s_waitcnt vmcnt(7)
    v_mfma_f32_16x16x32_bf16 v[68:71], v[20:23], v[64:67], v[68:71]
    v_and_b32 v10, 1, v23
    v_cmp_ne_u32 s[58:59], s40, v10
    s_waitcnt vmcnt(6)
    v_mfma_f32_16x16x32_bf16 v[68:71], v[24:27], v[64:67], v[68:71]
    v_and_b32 v10, 1, v27
    v_cmp_ne_u32 s[60:61], s40, v10
    s_or_b64 vcc, s[54:55], s[56:57]
    s_or_b64 vcc, vcc, s[58:59]
    s_or_b64 vcc, vcc, s[60:61]
    s_cbranch_scc0 Lr0s_red
    s_mov_b32 s16, 0
Lr0s_p1:
    buffer_load_dwordx4 v[12:15], v6, s[8:11], s62 offen sc1
    buffer_load_dwordx4 v[16:19], v6, s[8:11], s63 offen sc1
    buffer_load_dwordx4 v[20:23], v6, s[8:11], s64 offen sc1
    buffer_load_dwordx4 v[24:27], v6, s[8:11], s65 offen sc1
    s_waitcnt vmcnt(7)
    v_mfma_f32_16x16x32_bf16 v[68:71], v[40:43], v[64:67], 0
    v_and_b32 v10, 1, v43
    v_cmp_ne_u32 s[54:55], s40, v10
    s_waitcnt vmcnt(6)
    v_mfma_f32_16x16x32_bf16 v[68:71], v[44:47], v[64:67], v[68:71]
    v_and_b32 v10, 1, v47
    v_cmp_ne_u32 s[56:57], s40, v10
    s_waitcnt vmcnt(5)
    v_mfma_f32_16x16x32_bf16 v[68:71], v[48:51], v[64:67], v[68:71]
    v_and_b32 v10, 1, v51
    v_cmp_ne_u32 s[58:59], s40, v10
    s_waitcnt vmcnt(4)
    v_mfma_f32_16x16x32_bf16 v[68:71], v[52:55], v[64:67], v[68:71]
    v_and_b32 v10, 1, v55
    v_cmp_ne_u32 s[60:61], s40, v10
    s_or_b64 vcc, s[54:55], s[56:57]
    s_or_b64 vcc, vcc, s[58:59]
    s_or_b64 vcc, vcc, s[60:61]
    s_cbranch_scc0 Lr0s_red
    buffer_load_dwordx4 v[40:43], v6, s[8:11], s62 offen sc1
    buffer_load_dwordx4 v[44:47], v6, s[8:11], s63 offen sc1
    buffer_load_dwordx4 v[48:51], v6, s[8:11], s64 offen sc1
    buffer_load_dwordx4 v[52:55], v6, s[8:11], s65 offen sc1
    s_add_u32 s16, s16, 1
    s_cmp_gt_u32 s16, 100000
    s_cbranch_scc1 Lr_abort
    s_waitcnt vmcnt(7)
    v_mfma_f32_16x16x32_bf16 v[68:71], v[12:15], v[64:67], 0
    v_and_b32 v10, 1, v15
    v_cmp_ne_u32 s[54:55], s40, v10
    s_waitcnt vmcnt(6)
    v_mfma_f32_16x16x32_bf16 v[68:71], v[16:19], v[64:67], v[68:71]
    v_and_b32 v10, 1, v19
    v_cmp_ne_u32 s[56:57], s40, v10
    s_waitcnt vmcnt(5)
    v_mfma_f32_16x16x32_bf16 v[68:71], v[20:23], v[64:67], v[68:71]
    v_and_b32 v10, 1, v23
    v_cmp_ne_u32 s[58:59], s40, v10
    s_waitcnt vmcnt(4)
    v_mfma_f32_16x16x32_bf16 v[68:71], v[24:27], v[64:67], v[68:71]
    v_and_b32 v10, 1, v27
    v_cmp_ne_u32 s[60:61], s40, v10
    s_or_b64 vcc, s[54:55], s[56:57]
    s_or_b64 vcc, vcc, s[58:59]
    s_or_b64 vcc, vcc, s[60:61]
    s_cbranch_scc1 Lr0s_p1
Lr0s_red:
    s_nop 1
    v_permlane16_swap_b32 v68, v70
    v_permlane16_swap_b32 v69, v71
    s_mov_b64 exec, s[46:47]
    v_add_f32 v68, v68, v70
    v_add_f32 v69, v69, v71
    v_cvt_pk_bf16_f32 v68, v68, v69
    v_min_u32 v68, s50, v68
    buffer_store_dword v68, v7, s[8:11], s36 offen sc1
    v_mov_b32 v69, -1
    buffer_store_dword v69, v7, s[8:11], s37 offen sc1
    s_mov_b64 exec, -1
    s_xor_b32 s34, s34, 16384
    s_xor_b32 s35, s35, 16384
    s_xor_b32 s40, s40, 1
    s_xor_b32 s36, s36, 16384
    s_xor_b32 s37, s37, 16384
    s_nop 15
    s_nop 3
    buffer_load_dwordx4 v[36:39], v0, s[8:11], s34 offen sc1
    s_waitcnt vmcnt(3)
    ds_read_b128 v[64:67], v8 offset:2048
    ds_read_b128 v[68:71], v8 offset:3072
    v_mov_b64 v[12:13], 0
    v_mov_b64 v[14:15], 0
    v_mov_b64 v[16:17], 0
    v_mov_b64 v[18:19], 0
    v_mov_b64 v[20:21], 0
    v_mov_b64 v[22:23], 0
    v_mov_b64 v[24:25], 0
    v_mov_b64 v[26:27], 0
    v_mov_b64 v[28:29], 0
    v_mov_b64 v[30:31], 0
    v_mov_b64 v[32:33], 0
    v_mov_b64 v[34:35], 0
    s_nop 9
    buffer_load_dwordx4 v[36:39], v0, s[8:11], s34 offen sc1
    s_nop 15
    s_nop 8
    buffer_load_dwordx4 v[36:39], v0, s[8:11], s34 offen sc1
    s_waitcnt lgkmcnt(0)
    s_branch Lr0s_step
Lr0s_pb_re:
    s_mov_b32 s16, 0
Lr0s_pb_lp:
    s_add_u32 s17, s34, 4096
    buffer_load_dwordx4 v[40:43], v0, s[8:11], s17 offen sc1
    s_add_u32 s16, s16, 1
    s_cmp_gt_u32 s16, 100000
    s_cbranch_scc1 Lr_abort
    s_waitcnt vmcnt(0)
    v_max3_u32 v10, v40, v41, v42
    v_max_u32 v10, v10, v43
    v_cmp_eq_u32 vcc, -1, v10
    s_nop 0
    s_cbranch_vccnz Lr0s_pb_lp
    s_branch Lr0s_pb_ok
Lr0s_pc_re:
    s_mov_b32 s16, 0
Lr0s_pc_lp:
    buffer_load_dwordx4 v[44:47], v0, s[8:11], s35 offen sc1
    s_add_u32 s16, s16, 1
    s_cmp_gt_u32 s16, 100000
    s_cbranch_scc1 Lr_abort
    s_waitcnt vmcnt(0)
    v_max3_u32 v10, v44, v45, v46
    v_max_u32 v10, v10, v47
    v_cmp_eq_u32 vcc, -1, v10
    s_nop 0
    s_cbranch_vccnz Lr0s_pc_lp
    s_branch Lr0s_pc_ok
Lr0s_last:
    s_waitcnt vmcnt(0) lgkmcnt(0)
    s_barrier
    s_branch Lr_exit
L_w1_0:
    s_cmp_lg_u32 s14, 1
    s_cbranch_scc1 L_w2_0
    buffer_load_dwordx4 v[36:39], v0, s[8:11], s34 offen sc1
    s_mov_b32 s16, 0
    s_add_u32 s17, s66, 128
    v_lshrrev_b32 v10, 2, v0
    v_and_b32 v9, 16, v10
    v_lshlrev_b32 v9, 3, v9
    v_and_or_b32 v10, v10, 12, v9
Lr1s_fw_16:
    buffer_load_dword v9, v10, s[8:11], s17 offen sc1
    s_add_u32 s16, s16, 1
    s_cmp_gt_u32 s16, 100000
    s_cbranch_scc1 Lr_abort
    s_waitcnt vmcnt(0)
    v_cmp_eq_u32 vcc, 0, v9
    s_nop 0
    s_cbranch_vccnz Lr1s_fw_16
    s_lshl_b32 s67, s32, 5
    s_add_u32 s67, s67, s15
    s_lshl_b32 s67, s67, 12
    s_add_u32 s67, s67, 3145728
    s_mov_b32 m0, 17152
    s_nop 0
    buffer_load_dwordx4 v0, s[8:11], s41 offen offset:0 lds
    buffer_load_dwordx4 v0, s[8:11], s41 offen offset:1024 lds
    s_add_u32 s41, s41, 262144
    s_add_u32 s68, s68, 262144
    ds_read_b128 v[56:59], v8 offset:4096
    ds_read_b128 v[60:63], v8 offset:5120
    ds_read_b128 v[64:67], v8 offset:6144
    ds_read_b128 v[68:71], v8 offset:7168
    v_mov_b64 v[12:13], 0
    v_mov_b64 v[14:15], 0
    v_mov_b64 v[16:17], 0
    v_mov_b64 v[18:19], 0
    v_mov_b64 v[20:21], 0
    v_mov_b64 v[22:23], 0
    v_mov_b64 v[24:25], 0
    v_mov_b64 v[26:27], 0
    v_mov_b64 v[28:29], 0
    v_mov_b64 v[30:31], 0
    v_mov_b64 v[32:33], 0
    v_mov_b64 v[34:35], 0
    s_waitcnt vmcnt(0) lgkmcnt(0)
Lr1s_step:
    s_waitcnt vmcnt(3)
    v_max3_u32 v10, v36, v37, v38
    v_max_u32 v10, v10, v39
    v_cmp_eq_u32 vcc, -1, v10
    s_nop 0
    s_cbranch_vccz Lr1s_aok
    buffer_load_dwordx4 v[36:39], v0, s[8:11], s34 offen sc1
    s_nop 15
    s_nop 8
    buffer_load_dwordx4 v[36:39], v0, s[8:11], s34 offen sc1
    s_mov_b32 s16, 0
Lr1s_alp:
    s_waitcnt vmcnt(2)
    v_max3_u32 v10, v36, v37, v38
    v_max_u32 v10, v10, v39
    v_cmp_eq_u32 vcc, -1, v10
    s_nop 0
    s_cbranch_vccz Lr1s_aok
    buffer_load_dwordx4 v[36:39], v0, s[8:11], s34 offen sc1
    s_add_u32 s16, s16, 1
    s_cmp_gt_u32 s16, 100000
    s_cbranch_scc1 Lr_abort
    s_branch Lr1s_alp
Lr1s_aok:
    ds_write_b128 v0, v[36:39] offset:7936
    v_smfmac_f32_16x16x64_bf16 v[12:15], v[36:39], v[88:95], v1
    v_smfmac_f32_16x16x64_bf16 v[16:19], v[36:39], v[96:103], v1
    v_smfmac_f32_16x16x64_bf16 v[20:23], v[36:39], v[200:207], v1
    s_waitcnt lgkmcnt(0)
    s_barrier
    ds_read_b128 v[48:51], v0 offset:8960
    ds_read_b128 v[52:55], v0 offset:9984
    v_smfmac_f32_16x16x64_bf16 v[28:31], v[36:39], a[72:79], v1
    v_smfmac_f32_16x16x64_bf16 v[24:27], v[36:39], v[208:215], v1
    s_add_u32 s17, s34, 4096
    buffer_load_dwordx4 v[40:43], v0, s[8:11], s17 offen sc1
    v_smfmac_f32_16x16x64_bf16 v[32:35], v[36:39], a[80:87], v1
    s_waitcnt vmcnt(1)
    ds_read_b128 v[36:39], v0 offset:6912
    s_waitcnt lgkmcnt(2)
    v_smfmac_f32_16x16x64_bf16 v[28:31], v[48:51], v[56:63], v1
    ds_read_b128 v[56:59], v8 offset:0
    ds_read_b128 v[60:63], v8 offset:1024
    v_smfmac_f32_16x16x64_bf16 v[12:15], v[48:51], v[104:111], v1
    v_smfmac_f32_16x16x64_bf16 v[16:19], v[48:51], v[112:119], v1
    buffer_load_dwordx4 v[44:47], v0, s[8:11], s35 offen sc1
    v_smfmac_f32_16x16x64_bf16 v[32:35], v[48:51], v[64:71], v1
    ds_read_b128 v[64:67], v8 offset:2048
    ds_read_b128 v[68:71], v8 offset:3072
    v_smfmac_f32_16x16x64_bf16 v[20:23], v[48:51], v[216:223], v1
    v_smfmac_f32_16x16x64_bf16 v[24:27], v[48:51], v[224:231], v1
    s_waitcnt lgkmcnt(5)
    v_smfmac_f32_16x16x64_bf16 v[28:31], v[52:55], a[88:95], v1
    v_smfmac_f32_16x16x64_bf16 v[12:15], v[52:55], v[120:127], v1
    v_smfmac_f32_16x16x64_bf16 v[16:19], v[52:55], v[128:135], v1
    v_smfmac_f32_16x16x64_bf16 v[32:35], v[52:55], a[96:103], v1
    v_smfmac_f32_16x16x64_bf16 v[20:23], v[52:55], v[232:239], v1
    v_smfmac_f32_16x16x64_bf16 v[24:27], v[52:55], v[240:247], v1
    s_waitcnt lgkmcnt(2)
    v_smfmac_f32_16x16x64_bf16 v[28:31], v[36:39], v[56:63], v1
    ds_read_b128 v[56:59], v8 offset:12288
    ds_read_b128 v[60:63], v8 offset:13312
    v_smfmac_f32_16x16x64_bf16 v[12:15], v[36:39], v[72:79], v1
    v_smfmac_f32_16x16x64_bf16 v[16:19], v[36:39], v[80:87], v1
    s_waitcnt lgkmcnt(2)
    v_smfmac_f32_16x16x64_bf16 v[32:35], v[36:39], v[64:71], v1
    ds_read_b128 v[64:67], v8 offset:14336
    ds_read_b128 v[68:71], v8 offset:15360
    v_smfmac_f32_16x16x64_bf16 v[20:23], v[36:39], v[184:191], v1
    v_smfmac_f32_16x16x64_bf16 v[24:27], v[36:39], v[192:199], v1
    s_waitcnt vmcnt(1)
    v_max3_u32 v10, v40, v41, v42
    v_max_u32 v10, v10, v43
    v_cmp_eq_u32 vcc, -1, v10
    s_nop 0
    s_cbranch_vccnz Lr1s_pb_re
Lr1s_pb_ok:
    ds_write_b128 v0, v[40:43] offset:12032
    v_mov_b32 v9, 1
    v_mov_b32 v10, 0
    s_mov_b64 exec, 1
    buffer_store_dword v9, v10, s[8:11], s67 offen offset:384 sc1
    s_mov_b64 exec, -1
    v_smfmac_f32_16x16x64_bf16 v[12:15], v[40:43], v[136:143], v1
    v_smfmac_f32_16x16x64_bf16 v[20:23], v[40:43], a[8:15], v1
    v_smfmac_f32_16x16x64_bf16 v[16:19], v[40:43], v[144:151], v1
    v_smfmac_f32_16x16x64_bf16 v[24:27], v[40:43], a[16:23], v1
    s_waitcnt lgkmcnt(0)
    s_barrier
    ds_read_b128 v[48:51], v0 offset:13056
    ds_read_b128 v[52:55], v0 offset:14080
    ds_read_b128 v[36:39], v0 offset:11008
    v_smfmac_f32_16x16x64_bf16 v[28:31], v[40:43], a[120:127], v1
    v_smfmac_f32_16x16x64_bf16 v[32:35], v[40:43], a[128:135], v1
    s_waitcnt lgkmcnt(2)
    v_smfmac_f32_16x16x64_bf16 v[12:15], v[48:51], v[56:63], v1
    ds_read_b128 v[56:59], v8 offset:8192
    ds_read_b128 v[60:63], v8 offset:9216
    v_smfmac_f32_16x16x64_bf16 v[16:19], v[48:51], v[64:71], v1
    ds_read_b128 v[64:67], v8 offset:10240
    ds_read_b128 v[68:71], v8 offset:11264
    s_waitcnt lgkmcnt(5)
    v_smfmac_f32_16x16x64_bf16 v[12:15], v[52:55], v[152:159], v1
    v_smfmac_f32_16x16x64_bf16 v[16:19], v[52:55], v[160:167], v1
    s_waitcnt vmcnt(1)
    v_max3_u32 v10, v44, v45, v46
    v_max_u32 v10, v10, v47
    v_cmp_eq_u32 vcc, -1, v10
    s_nop 0
    s_cbranch_vccnz Lr1s_pc_re
Lr1s_pc_ok:
    v_smfmac_f32_16x16x64_bf16 v[12:15], v[44:47], v[168:175], v1
    v_smfmac_f32_16x16x64_bf16 v[16:19], v[44:47], v[176:183], v1
    s_waitcnt lgkmcnt(2)
    v_smfmac_f32_16x16x64_bf16 v[12:15], v[36:39], v[56:63], v1
    s_waitcnt lgkmcnt(0)
    v_smfmac_f32_16x16x64_bf16 v[16:19], v[36:39], v[64:71], v1
    v_smfmac_f32_16x16x64_bf16 v[20:23], v[48:51], a[24:31], v1
    v_smfmac_f32_16x16x64_bf16 v[24:27], v[48:51], a[32:39], v1
    buffer_load_dwordx4 v[64:67], v0, s[8:11], s42 offen
    v_smfmac_f32_16x16x64_bf16 v[20:23], v[52:55], a[40:47], v1
    v_add_f32 v12, v12, v14
    v_smfmac_f32_16x16x64_bf16 v[24:27], v[52:55], a[48:55], v1
    v_add_f32 v16, v16, v18
    v_smfmac_f32_16x16x64_bf16 v[20:23], v[36:39], v[248:255], v1
    v_add_f32 v13, v13, v15
    v_smfmac_f32_16x16x64_bf16 v[24:27], v[36:39], a[0:7], v1
    v_add_f32 v17, v17, v19
    buffer_load_dwordx4 v[68:71], v0, s[8:11], s42 offen offset:1024
    v_smfmac_f32_16x16x64_bf16 v[20:23], v[44:47], a[56:63], v1
    v_cvt_pk_bf16_f32 v14, v12, v16
    ds_read_b128 v[56:59], v0 offset:15104
    v_smfmac_f32_16x16x64_bf16 v[24:27], v[44:47], a[64:71], v1
    v_cvt_pk_bf16_f32 v15, v13, v17
    ds_read_b128 v[60:63], v0 offset:16128
    ds_write_b32 v2, v14 offset:576
    ds_write_b32 v2, v15 offset:864
    v_smfmac_f32_16x16x64_bf16 v[28:31], v[48:51], a[136:143], v1
    v_smfmac_f32_16x16x64_bf16 v[32:35], v[48:51], a[144:151], v1
    v_add_f32 v20, v20, v22
    v_add_f32 v24, v24, v26
    v_add_f32 v21, v21, v23
    v_add_f32 v25, v25, v27
    v_cvt_pk_bf16_f32 v22, v20, v24
    v_cvt_pk_bf16_f32 v23, v21, v25
    ds_write_b32 v2, v22 offset:0
    ds_write_b32 v2, v23 offset:288
    v_smfmac_f32_16x16x64_bf16 v[28:31], v[52:55], a[152:159], v1
    v_smfmac_f32_16x16x64_bf16 v[32:35], v[52:55], a[160:167], v1
    s_waitcnt lgkmcnt(0)
    s_barrier
    ds_read_b128 v[40:43], v3 offset:0
    ds_read_b128 v[48:51], v3 offset:64
    ds_read_b128 v[20:23], v3 offset:128
    ds_read_b128 v[52:55], v3 offset:192
    v_smfmac_f32_16x16x64_bf16 v[28:31], v[36:39], a[104:111], v1
    v_smfmac_f32_16x16x64_bf16 v[32:35], v[36:39], a[112:119], v1
    ds_read_b128 v[36:39], v0 offset:17152
    v_smfmac_f32_16x16x64_bf16 v[28:31], v[44:47], a[168:175], v1
    v_smfmac_f32_16x16x64_bf16 v[32:35], v[44:47], a[176:183], v1
    ds_read_b128 v[44:47], v0 offset:18176
    s_waitcnt lgkmcnt(5)
    v_mfma_f32_16x16x32_bf16 v[12:15], v[56:59], v[40:43], 0
    v_mfma_f32_16x16x32_bf16 v[16:19], v[60:63], v[40:43], 0
    v_mfma_f32_16x16x32_bf16 v[24:27], v[40:43], v[40:43], 0
    ds_read_b128 v[56:59], v0 offset:19200
    ds_read_b128 v[60:63], v0 offset:20224
    s_waitcnt lgkmcnt(3)
    v_mfma_f32_16x16x32_bf16 v[12:15], v[36:39], v[48:51], v[12:15]
    v_lshrrev_b32 v10, 1, v0
    v_lshrrev_b32 v9, 9, v0
    s_waitcnt lgkmcnt(2)
    v_mfma_f32_16x16x32_bf16 v[16:19], v[44:47], v[48:51], v[16:19]
    v_lshl_add_u32 v9, v9, 5, v10
    v_add_f32 v28, v28, v30
    v_mfma_f32_16x16x32_bf16 v[24:27], v[48:51], v[48:51], v[24:27]
    v_add_f32 v32, v32, v34
    v_add_f32 v29, v29, v31
    ds_read_b128 v[36:39], v0 offset:21248
    ds_read_b128 v[44:47], v0 offset:22272
    s_waitcnt lgkmcnt(3)
    v_mfma_f32_16x16x32_bf16 v[12:15], v[56:59], v[20:23], v[12:15]
    v_add_f32 v33, v33, v35
    v_cvt_pk_bf16_f32 v30, v28, v29
    s_waitcnt lgkmcnt(2)
    v_mfma_f32_16x16x32_bf16 v[16:19], v[60:63], v[20:23], v[16:19]
    v_cvt_pk_bf16_f32 v31, v32, v33
    ds_read_b64 v[34:35], v9 offset:1152
    v_mfma_f32_16x16x32_bf16 v[24:27], v[20:23], v[20:23], v[24:27]
    s_add_u32 s17, s43, 2560
    buffer_store_dwordx2 v[30:31], v10, s[8:11], s17 offen sc1
    s_waitcnt lgkmcnt(2)
    v_mfma_f32_16x16x32_bf16 v[12:15], v[36:39], v[52:55], v[12:15]
    s_waitcnt lgkmcnt(1)
    v_mfma_f32_16x16x32_bf16 v[16:19], v[44:47], v[52:55], v[16:19]
    v_mfma_f32_16x16x32_bf16 v[24:27], v[52:55], v[52:55], v[24:27]
    s_add_u32 s17, s43, 512
    s_waitcnt lgkmcnt(0)
    buffer_store_dwordx2 v[34:35], v10, s[8:11], s17 offen sc1
    s_cmp_eq_u32 s33, 63
    s_cbranch_scc1 Lr1s_last
    ds_read_b128 v[56:59], v8 offset:16384
    ds_read_b128 v[60:63], v8 offset:17408
    v_mov_b64 v[20:21], s[52:53]
    v_mov_b64 v[22:23], s[52:53]
    v_mov_b32 v41, 0
    v_mov_b32 v42, 0
    v_max3_f32 v9, v12, v13, v14
    v_max3_f32 v9, v9, v15, v16
    v_max3_f32 v9, v9, v17, v18
    v_max3_f32 v9, v9, v19, v24
    v_max_f32 v9, v9, v25
    v_mov_b32 v10, v9
    v_mov_b64 v[32:33], 0
    v_mov_b64 v[34:35], 0
    v_permlane32_swap_b32 v9, v10
    v_max_f32 v9, v9, v10
    v_mov_b32 v10, v9
    s_nop 1
    v_permlane16_swap_b32 v9, v10
    v_max_f32 v9, v9, v10
    v_mul_f32 v28, s44, v9
    v_fma_f32 v12, v12, s44, -v28
    v_fma_f32 v13, v13, s44, -v28
    v_fma_f32 v14, v14, s44, -v28
    v_fma_f32 v15, v15, s44, -v28
    v_exp_f32 v12, v12
    v_exp_f32 v13, v13
    v_fma_f32 v16, v16, s44, -v28
    v_fma_f32 v17, v17, s44, -v28
    v_exp_f32 v14, v14
    v_exp_f32 v15, v15
    v_cvt_pk_bf16_f32 v36, v12, v13
    v_fma_f32 v18, v18, s44, -v28
    v_fma_f32 v19, v19, s44, -v28
    v_exp_f32 v16, v16
    v_exp_f32 v17, v17
    v_cvt_pk_bf16_f32 v37, v14, v15
    v_fma_f32 v24, v24, s44, -v28
    v_fma_f32 v25, v25, s44, -v28
    v_exp_f32 v18, v18
    v_exp_f32 v19, v19
    v_cvt_pk_bf16_f32 v38, v16, v17
    v_exp_f32 v24, v24
    v_exp_f32 v25, v25
    v_cvt_pk_bf16_f32 v39, v18, v19
    v_cvt_pk_bf16_f32 v40, v24, v25
    v_cvt_pk_bf16_f32 v43, v24, v25
    v_mfma_f32_16x16x32_bf16 v[52:55], v[20:23], v[36:39], 0
    v_mov_b64 v[12:13], 0
    v_mov_b64 v[14:15], 0
    s_waitcnt vmcnt(3)
    v_mfma_f32_16x16x32_bf16 v[44:47], v[64:67], v[36:39], 0
    v_mov_b64 v[24:25], 0
    v_mov_b64 v[26:27], 0
    s_waitcnt vmcnt(2)
    v_mfma_f32_16x16x32_bf16 v[48:51], v[68:71], v[36:39], 0
    ds_read_b128 v[64:67], v8 offset:20480
    ds_read_b128 v[68:71], v8 offset:21504
    v_mfma_f32_16x16x16_bf16 v[52:55], v[20:21], v[40:41], v[52:55]
    v_mfma_f32_16x16x16_bf16 v[44:47], v[30:31], v[40:41], v[44:47]
    v_mov_b64 v[20:21], 0
    v_mov_b64 v[22:23], 0
    v_mfma_f32_16x16x16_bf16 v[48:51], v[30:31], v[42:43], v[48:51]
    v_mov_b64 v[36:37], 0
    v_mov_b64 v[38:39], 0
    v_mov_b64 v[40:41], 0
    v_mov_b64 v[42:43], 0
    v_rcp_f32 v9, v52
    v_mov_b64 v[52:53], 0
    v_mov_b64 v[54:55], 0
    v_mul_f32 v44, v9, v44
    v_mul_f32 v48, v9, v48
    v_cvt_pk_bf16_f32 v16, v44, v48
    v_mul_f32 v45, v9, v45
    v_mul_f32 v49, v9, v49
    v_cvt_pk_bf16_f32 v17, v45, v49
    v_mul_f32 v46, v9, v46
    v_mul_f32 v50, v9, v50
    v_cvt_pk_bf16_f32 v18, v46, v50
    v_mul_f32 v47, v9, v47
    v_mul_f32 v51, v9, v51
    v_cvt_pk_bf16_f32 v19, v47, v51
    ds_write_b128 v5, v[16:19]
    v_mov_b64 v[28:29], 0
    v_mov_b64 v[30:31], 0
    s_waitcnt lgkmcnt(0)
    s_barrier
    ds_read_b128 v[44:47], v4 offset:0
    ds_read_b128 v[48:51], v4 offset:128
    v_mov_b64 v[16:17], 0
    v_mov_b64 v[18:19], 0
    buffer_load_dwordx4 v0, s[8:11], s41 offen offset:0 lds
    buffer_load_dwordx4 v0, s[8:11], s41 offen offset:1024 lds
    s_waitcnt lgkmcnt(1)
    v_smfmac_f32_16x16x64_bf16 v[12:15], v[44:47], a[184:191], v1
    s_waitcnt lgkmcnt(0)
    v_smfmac_f32_16x16x64_bf16 v[12:15], v[48:51], a[192:199], v1
    v_smfmac_f32_16x16x64_bf16 v[24:27], v[44:47], a[200:207], v1
    v_smfmac_f32_16x16x64_bf16 v[24:27], v[48:51], a[208:215], v1
    v_add_f32 v12, v12, v14
    v_smfmac_f32_16x16x64_bf16 v[20:23], v[44:47], a[216:223], v1
    v_add_f32 v13, v13, v15
    v_smfmac_f32_16x16x64_bf16 v[20:23], v[48:51], a[224:231], v1
    v_cvt_pk_bf16_f32 v12, v12, v13
    v_smfmac_f32_16x16x64_bf16 v[16:19], v[44:47], a[232:239], v1
    v_add_f32 v24, v24, v26
    v_smfmac_f32_16x16x64_bf16 v[16:19], v[48:51], a[240:247], v1
    v_add_f32 v25, v25, v27
    v_smfmac_f32_16x16x64_bf16 v[36:39], v[44:47], v[56:63], v1
    v_cvt_pk_bf16_f32 v13, v24, v25
    v_smfmac_f32_16x16x64_bf16 v[36:39], v[48:51], v[64:71], v1
    v_add_f32 v20, v20, v22
    v_add_f32 v21, v21, v23
    v_cvt_pk_bf16_f32 v14, v20, v21
    v_add_f32 v16, v16, v18
    v_add_f32 v17, v17, v19
    v_cvt_pk_bf16_f32 v15, v16, v17
    v_and_or_b32 v15, v15, -2, s40
    buffer_store_dwordx4 v[12:15], v0, s[8:11], s38 offen sc1
    s_nop 0
    ds_read_b128 v[12:15], v8 offset:18432
    ds_read_b128 v[16:19], v8 offset:19456
    ds_read_b128 v[20:23], v8 offset:22528
    ds_read_b128 v[24:27], v8 offset:23552
    ds_read_b128 v[56:59], v8 offset:24576
    ds_read_b128 v[60:63], v8 offset:25600
    ds_read_b128 v[64:67], v8 offset:28672
    ds_read_b128 v[68:71], v8 offset:29696
    s_waitcnt lgkmcnt(6)
    v_smfmac_f32_16x16x64_bf16 v[40:43], v[44:47], v[12:19], v1
    ds_read_b128 v[12:15], v8 offset:26624
    ds_read_b128 v[16:19], v8 offset:27648
    s_waitcnt lgkmcnt(6)
    v_smfmac_f32_16x16x64_bf16 v[40:43], v[48:51], v[20:27], v1
    ds_read_b128 v[20:23], v8 offset:30720
    ds_read_b128 v[24:27], v8 offset:31744
    s_waitcnt lgkmcnt(6)
    v_smfmac_f32_16x16x64_bf16 v[52:55], v[44:47], v[56:63], v1
    ds_read_b128 v[56:59], v8 offset:32768
    ds_read_b128 v[60:63], v8 offset:33792
    s_waitcnt lgkmcnt(6)
    v_smfmac_f32_16x16x64_bf16 v[52:55], v[48:51], v[64:71], v1
    s_waitcnt lgkmcnt(4)
    v_smfmac_f32_16x16x64_bf16 v[32:35], v[44:47], v[12:19], v1
    s_waitcnt lgkmcnt(2)
    v_smfmac_f32_16x16x64_bf16 v[32:35], v[48:51], v[20:27], v1
    v_smfmac_f32_16x16x64_bf16 v[28:31], v[44:47], a[248:255], v1
    s_waitcnt lgkmcnt(0)
    v_smfmac_f32_16x16x64_bf16 v[28:31], v[48:51], v[56:63], v1
    v_add_f32 v36, v36, v38
    v_add_f32 v37, v37, v39
    v_cvt_pk_bf16_f32 v36, v36, v37
    v_add_f32 v40, v40, v42
    v_add_f32 v41, v41, v43
    v_cvt_pk_bf16_f32 v37, v40, v41
    v_add_f32 v52, v52, v54
    v_add_f32 v53, v53, v55
    v_cvt_pk_bf16_f32 v38, v52, v53
    v_add_f32 v32, v32, v34
    v_add_f32 v33, v33, v35
    v_cvt_pk_bf16_f32 v39, v32, v33
    v_and_or_b32 v39, v39, -2, s40
    s_add_u32 s17, s38, 4096
    buffer_store_dwordx4 v[36:39], v0, s[8:11], s17 offen sc1
    v_add_f32 v28, v28, v30
    v_add_f32 v29, v29, v31
    v_cvt_pk_bf16_f32 v28, v28, v29
    v_and_or_b32 v28, v28, -2, s40
    v_lshrrev_b32 v9, 2, v0
    buffer_store_dword v28, v9, s[8:11], s39 offen sc1
    v_add_u32 v10, 162560, v0
    ds_read_b128 v[64:67], v10
    s_add_u32 s33, s33, 1
    s_add_u32 s42, s42, 262144
    s_add_u32 s41, s41, 262144
    s_add_u32 s43, s43, 131072
    s_mov_b32 s67, s66
    s_add_u32 s68, s68, 262144
    s_add_u32 s66, s66, 22528
    ds_read_b128 v[56:59], v8 offset:4096
    ds_read_b128 v[60:63], v8 offset:5120
    v_mov_b64 v[12:13], 0
    v_mov_b64 v[14:15], 0
    v_mov_b64 v[16:17], 0
    v_mov_b64 v[18:19], 0
    v_mov_b64 v[20:21], 0
    v_mov_b64 v[22:23], 0
    v_mov_b64 v[24:25], 0
    v_mov_b64 v[26:27], 0
    v_mov_b64 v[28:29], 0
    v_mov_b64 v[30:31], 0
    v_mov_b64 v[32:33], 0
    v_mov_b64 v[34:35], 0
    s_nop 15
    s_nop 15
    s_nop 15
    s_nop 11
    buffer_load_dwordx4 v[40:43], v6, s[8:11], s62 offen sc1
    buffer_load_dwordx4 v[44:47], v6, s[8:11], s63 offen sc1
    buffer_load_dwordx4 v[48:51], v6, s[8:11], s64 offen sc1
    buffer_load_dwordx4 v[52:55], v6, s[8:11], s65 offen sc1
    s_waitcnt lgkmcnt(0)
    s_waitcnt vmcnt(3)
    v_mfma_f32_16x16x32_bf16 v[68:71], v[40:43], v[64:67], 0
    v_and_b32 v10, 1, v43
    v_cmp_ne_u32 s[54:55], s40, v10
    s_waitcnt vmcnt(2)
    v_mfma_f32_16x16x32_bf16 v[68:71], v[44:47], v[64:67], v[68:71]
    v_and_b32 v10, 1, v47
    v_cmp_ne_u32 s[56:57], s40, v10
    s_waitcnt vmcnt(1)
    v_mfma_f32_16x16x32_bf16 v[68:71], v[48:51], v[64:67], v[68:71]
    v_and_b32 v10, 1, v51
    v_cmp_ne_u32 s[58:59], s40, v10
    s_waitcnt vmcnt(0)
    v_mfma_f32_16x16x32_bf16 v[68:71], v[52:55], v[64:67], v[68:71]
    v_and_b32 v10, 1, v55
    v_cmp_ne_u32 s[60:61], s40, v10
    s_or_b64 vcc, s[54:55], s[56:57]
    s_or_b64 vcc, vcc, s[58:59]
    s_or_b64 vcc, vcc, s[60:61]
    s_cbranch_scc0 Lr1s_red
    s_mov_b32 s16, 0
Lr1s_p1:
    s_mov_b64 exec, s[54:55]
    buffer_load_dwordx4 v[40:43], v6, s[8:11], s62 offen sc1
    s_mov_b64 exec, s[56:57]
    buffer_load_dwordx4 v[44:47], v6, s[8:11], s63 offen sc1
    s_mov_b64 exec, s[58:59]
    buffer_load_dwordx4 v[48:51], v6, s[8:11], s64 offen sc1
    s_mov_b64 exec, s[60:61]
    buffer_load_dwordx4 v[52:55], v6, s[8:11], s65 offen sc1
    s_mov_b64 exec, -1
    s_add_u32 s16, s16, 1
    s_cmp_gt_u32 s16, 100000
    s_cbranch_scc1 Lr_abort
    s_waitcnt vmcnt(3)
    v_mfma_f32_16x16x32_bf16 v[68:71], v[40:43], v[64:67], 0
    v_and_b32 v10, 1, v43
    v_cmp_ne_u32 s[54:55], s40, v10
    s_waitcnt vmcnt(2)
    v_mfma_f32_16x16x32_bf16 v[68:71], v[44:47], v[64:67], v[68:71]
    v_and_b32 v10, 1, v47
    v_cmp_ne_u32 s[56:57], s40, v10
    s_waitcnt vmcnt(1)
    v_mfma_f32_16x16x32_bf16 v[68:71], v[48:51], v[64:67], v[68:71]
    v_and_b32 v10, 1, v51
    v_cmp_ne_u32 s[58:59], s40, v10
    s_waitcnt vmcnt(0)
    v_mfma_f32_16x16x32_bf16 v[68:71], v[52:55], v[64:67], v[68:71]
    v_and_b32 v10, 1, v55
    v_cmp_ne_u32 s[60:61], s40, v10
    s_or_b64 vcc, s[54:55], s[56:57]
    s_or_b64 vcc, vcc, s[58:59]
    s_or_b64 vcc, vcc, s[60:61]
    s_cbranch_scc1 Lr1s_p1
Lr1s_red:
    s_xor_b32 s34, s34, 16384
    s_xor_b32 s35, s35, 16384
    buffer_load_dwordx4 v[36:39], v0, s[8:11], s34 offen sc1
    v_permlane16_swap_b32 v68, v70
    v_permlane16_swap_b32 v69, v71
    s_mov_b64 exec, s[46:47]
    v_add_f32 v68, v68, v70
    v_add_f32 v69, v69, v71
    v_cvt_pk_bf16_f32 v68, v68, v69
    v_min_u32 v68, s50, v68
    buffer_store_dword v68, v7, s[8:11], s36 offen sc1
    v_mov_b32 v69, -1
    buffer_store_dword v69, v7, s[8:11], s37 offen sc1
    s_mov_b64 exec, -1
    buffer_load_dwordx4 v[36:39], v0, s[8:11], s34 offen sc1
    s_xor_b32 s40, s40, 1
    s_xor_b32 s36, s36, 16384
    s_xor_b32 s37, s37, 16384
    ds_read_b128 v[64:67], v8 offset:6144
    ds_read_b128 v[68:71], v8 offset:7168
    s_waitcnt lgkmcnt(0)
    s_branch Lr1s_step
Lr1s_pb_re:
    s_mov_b32 s16, 0
Lr1s_pb_lp:
    s_add_u32 s17, s34, 4096
    buffer_load_dwordx4 v[40:43], v0, s[8:11], s17 offen sc1
    s_add_u32 s16, s16, 1
    s_cmp_gt_u32 s16, 100000
    s_cbranch_scc1 Lr_abort
    s_waitcnt vmcnt(0)
    v_max3_u32 v10, v40, v41, v42
    v_max_u32 v10, v10, v43
    v_cmp_eq_u32 vcc, -1, v10
    s_nop 0
    s_cbranch_vccnz Lr1s_pb_lp
    s_branch Lr1s_pb_ok
Lr1s_pc_re:
    s_mov_b32 s16, 0
Lr1s_pc_lp:
    buffer_load_dwordx4 v[44:47], v0, s[8:11], s35 offen sc1
    s_add_u32 s16, s16, 1
    s_cmp_gt_u32 s16, 100000
    s_cbranch_scc1 Lr_abort
    s_waitcnt vmcnt(0)
    v_max3_u32 v10, v44, v45, v46
    v_max_u32 v10, v10, v47
    v_cmp_eq_u32 vcc, -1, v10
    s_nop 0
    s_cbranch_vccnz Lr1s_pc_lp
    s_branch Lr1s_pc_ok
Lr1s_last:
    s_waitcnt vmcnt(0) lgkmcnt(0)
    s_barrier
    s_mov_b32 s67, s66
    v_mov_b32 v9, 1
    v_mov_b32 v10, 0
    s_mov_b64 exec, 1
    buffer_store_dword v9, v10, s[8:11], s67 offen offset:384 sc1
    s_mov_b64 exec, -1
    s_branch Lr_exit
L_w2_0:
    s_cmp_lg_u32 s14, 2
    s_cbranch_scc1 L_w3_0
    buffer_load_dwordx4 v[36:39], v0, s[8:11], s34 offen sc1
    s_mov_b32 s16, 0
    s_add_u32 s17, s66, 128
    v_lshrrev_b32 v10, 2, v0
    v_and_b32 v9, 16, v10
    v_lshlrev_b32 v9, 3, v9
    v_and_or_b32 v10, v10, 12, v9
Lr2s_fw_17:
    buffer_load_dword v9, v10, s[8:11], s17 offen sc1
    s_add_u32 s16, s16, 1
    s_cmp_gt_u32 s16, 100000
    s_cbranch_scc1 Lr_abort
    s_waitcnt vmcnt(0)
    v_cmp_eq_u32 vcc, 0, v9
    s_nop 0
    s_cbranch_vccnz Lr2s_fw_17
    s_mov_b32 m0, 19200
    s_nop 0
    buffer_load_dwordx4 v0, s[8:11], s41 offen offset:0 lds
    buffer_load_dwordx4 v0, s[8:11], s41 offen offset:1024 lds
    s_add_u32 s41, s41, 262144
    s_add_u32 s68, s68, 262144
    ds_read_b128 v[56:59], v8 offset:4096
    ds_read_b128 v[60:63], v8 offset:5120
    ds_read_b128 v[64:67], v8 offset:6144
    ds_read_b128 v[68:71], v8 offset:7168
    v_mov_b64 v[12:13], 0
    v_mov_b64 v[14:15], 0
    v_mov_b64 v[16:17], 0
    v_mov_b64 v[18:19], 0
    v_mov_b64 v[20:21], 0
    v_mov_b64 v[22:23], 0
    v_mov_b64 v[24:25], 0
    v_mov_b64 v[26:27], 0
    v_mov_b64 v[28:29], 0
    v_mov_b64 v[30:31], 0
    v_mov_b64 v[32:33], 0
    v_mov_b64 v[34:35], 0
    s_waitcnt vmcnt(0) lgkmcnt(0)
Lr2s_step:
    s_waitcnt vmcnt(3)
    v_max3_u32 v10, v36, v37, v38
    v_max_u32 v10, v10, v39
    v_cmp_eq_u32 vcc, -1, v10
    s_nop 0
    s_cbranch_vccz Lr2s_aok
    buffer_load_dwordx4 v[36:39], v0, s[8:11], s34 offen sc1
    s_nop 15
    s_nop 8
    buffer_load_dwordx4 v[36:39], v0, s[8:11], s34 offen sc1
    s_mov_b32 s16, 0
Lr2s_alp:
    s_waitcnt vmcnt(2)
    v_max3_u32 v10, v36, v37, v38
    v_max_u32 v10, v10, v39
    v_cmp_eq_u32 vcc, -1, v10
    s_nop 0
    s_cbranch_vccz Lr2s_aok
    buffer_load_dwordx4 v[36:39], v0, s[8:11], s34 offen sc1
    s_add_u32 s16, s16, 1
    s_cmp_gt_u32 s16, 100000
    s_cbranch_scc1 Lr_abort
    s_branch Lr2s_alp
Lr2s_aok:
    ds_write_b128 v0, v[36:39] offset:8960
    v_smfmac_f32_16x16x64_bf16 v[12:15], v[36:39], v[104:111], v1
    v_smfmac_f32_16x16x64_bf16 v[16:19], v[36:39], v[112:119], v1
    v_smfmac_f32_16x16x64_bf16 v[20:23], v[36:39], v[216:223], v1
    s_waitcnt lgkmcnt(0)
    s_barrier
    ds_read_b128 v[48:51], v0 offset:9984
    ds_read_b128 v[52:55], v0 offset:6912
    v_smfmac_f32_16x16x64_bf16 v[28:31], v[36:39], v[56:63], v1
    ds_read_b128 v[56:59], v8 offset:0
    ds_read_b128 v[60:63], v8 offset:1024
    v_smfmac_f32_16x16x64_bf16 v[24:27], v[36:39], v[224:231], v1
    v_smfmac_f32_16x16x64_bf16 v[32:35], v[36:39], v[64:71], v1
    ds_read_b128 v[64:67], v8 offset:2048
    ds_read_b128 v[68:71], v8 offset:3072
    s_add_u32 s17, s34, 4096
    buffer_load_dwordx4 v[40:43], v0, s[8:11], s17 offen sc1
    s_waitcnt vmcnt(1)
    ds_read_b128 v[36:39], v0 offset:7936
    s_waitcnt lgkmcnt(6)
    v_smfmac_f32_16x16x64_bf16 v[28:31], v[48:51], a[88:95], v1
    v_smfmac_f32_16x16x64_bf16 v[12:15], v[48:51], v[120:127], v1
    v_smfmac_f32_16x16x64_bf16 v[16:19], v[48:51], v[128:135], v1
    v_smfmac_f32_16x16x64_bf16 v[32:35], v[48:51], a[96:103], v1
    buffer_load_dwordx4 v[44:47], v0, s[8:11], s35 offen sc1
    v_smfmac_f32_16x16x64_bf16 v[20:23], v[48:51], v[232:239], v1
    v_lshrrev_b32 v10, 2, v0
    v_and_b32 v9, 16, v10
    v_lshlrev_b32 v9, 3, v9
    v_and_or_b32 v10, v10, 12, v9
    s_add_u32 s17, s66, 22656
    v_mov_b32 v11, 2
    buffer_load_dword v11, v10, s[8:11], s17 offen sc1
    v_smfmac_f32_16x16x64_bf16 v[24:27], v[48:51], v[240:247], v1
    s_waitcnt lgkmcnt(3)
    v_smfmac_f32_16x16x64_bf16 v[28:31], v[52:55], v[56:63], v1
    ds_read_b128 v[56:59], v8 offset:12288
    ds_read_b128 v[60:63], v8 offset:13312
    v_smfmac_f32_16x16x64_bf16 v[12:15], v[52:55], v[72:79], v1
    v_smfmac_f32_16x16x64_bf16 v[16:19], v[52:55], v[80:87], v1
    s_waitcnt lgkmcnt(3)
    v_smfmac_f32_16x16x64_bf16 v[32:35], v[52:55], v[64:71], v1
    ds_read_b128 v[64:67], v8 offset:14336
    ds_read_b128 v[68:71], v8 offset:15360
    v_smfmac_f32_16x16x64_bf16 v[20:23], v[52:55], v[184:191], v1
    v_smfmac_f32_16x16x64_bf16 v[24:27], v[52:55], v[192:199], v1
    s_waitcnt lgkmcnt(4)
    v_smfmac_f32_16x16x64_bf16 v[28:31], v[36:39], a[72:79], v1
    v_smfmac_f32_16x16x64_bf16 v[12:15], v[36:39], v[88:95], v1
    v_smfmac_f32_16x16x64_bf16 v[16:19], v[36:39], v[96:103], v1
    v_smfmac_f32_16x16x64_bf16 v[32:35], v[36:39], a[80:87], v1
    v_smfmac_f32_16x16x64_bf16 v[20:23], v[36:39], v[200:207], v1
    v_smfmac_f32_16x16x64_bf16 v[24:27], v[36:39], v[208:215], v1
    s_waitcnt vmcnt(2)
    v_max3_u32 v10, v40, v41, v42
    v_max_u32 v10, v10, v43
    v_cmp_eq_u32 vcc, -1, v10
    s_nop 0
    s_cbranch_vccnz Lr2s_pb_re
Lr2s_pb_ok:
    ds_write_b128 v0, v[40:43] offset:13056
    s_waitcnt lgkmcnt(3)
    v_smfmac_f32_16x16x64_bf16 v[12:15], v[40:43], v[56:63], v1
    ds_read_b128 v[56:59], v8 offset:8192
    ds_read_b128 v[60:63], v8 offset:9216
    v_smfmac_f32_16x16x64_bf16 v[20:23], v[40:43], a[24:31], v1
    s_waitcnt lgkmcnt(3)
    v_smfmac_f32_16x16x64_bf16 v[16:19], v[40:43], v[64:71], v1
    ds_read_b128 v[64:67], v8 offset:10240
    ds_read_b128 v[68:71], v8 offset:11264
    v_smfmac_f32_16x16x64_bf16 v[24:27], v[40:43], a[32:39], v1
    s_waitcnt lgkmcnt(4)
    s_barrier
    ds_read_b128 v[48:51], v0 offset:11008
    ds_read_b128 v[52:55], v0 offset:14080
    ds_read_b128 v[36:39], v0 offset:12032
    v_smfmac_f32_16x16x64_bf16 v[28:31], v[40:43], a[136:143], v1
    v_smfmac_f32_16x16x64_bf16 v[32:35], v[40:43], a[144:151], v1
    s_waitcnt lgkmcnt(2)
    v_smfmac_f32_16x16x64_bf16 v[12:15], v[48:51], v[56:63], v1
    v_smfmac_f32_16x16x64_bf16 v[16:19], v[48:51], v[64:71], v1
    s_waitcnt lgkmcnt(1)
    v_smfmac_f32_16x16x64_bf16 v[12:15], v[52:55], v[152:159], v1
    v_smfmac_f32_16x16x64_bf16 v[16:19], v[52:55], v[160:167], v1
    s_waitcnt lgkmcnt(0)
    v_smfmac_f32_16x16x64_bf16 v[12:15], v[36:39], v[136:143], v1
    v_smfmac_f32_16x16x64_bf16 v[16:19], v[36:39], v[144:151], v1
    s_waitcnt vmcnt(1)
    v_max3_u32 v10, v44, v45, v46
    v_max_u32 v10, v10, v47
    v_cmp_eq_u32 vcc, -1, v10
    s_nop 0
    s_cbranch_vccnz Lr2s_pc_re
Lr2s_pc_ok:
    v_smfmac_f32_16x16x64_bf16 v[12:15], v[44:47], v[168:175], v1
    v_smfmac_f32_16x16x64_bf16 v[16:19], v[44:47], v[176:183], v1
    v_smfmac_f32_16x16x64_bf16 v[20:23], v[48:51], v[248:255], v1
    v_smfmac_f32_16x16x64_bf16 v[24:27], v[48:51], a[0:7], v1
    v_smfmac_f32_16x16x64_bf16 v[20:23], v[52:55], a[40:47], v1
    v_add_f32 v12, v12, v14
    buffer_load_dwordx4 v[64:67], v0, s[8:11], s42 offen
    v_smfmac_f32_16x16x64_bf16 v[24:27], v[52:55], a[48:55], v1
    v_add_f32 v16, v16, v18
    v_smfmac_f32_16x16x64_bf16 v[20:23], v[36:39], a[8:15], v1
    v_add_f32 v13, v13, v15
    v_smfmac_f32_16x16x64_bf16 v[24:27], v[36:39], a[16:23], v1
    v_add_f32 v17, v17, v19
    v_smfmac_f32_16x16x64_bf16 v[20:23], v[44:47], a[56:63], v1
    v_cvt_pk_bf16_f32 v14, v12, v16
    ds_read_b128 v[56:59], v0 offset:15104
    buffer_load_dwordx4 v[68:71], v0, s[8:11], s42 offen offset:1024
    v_smfmac_f32_16x16x64_bf16 v[24:27], v[44:47], a[64:71], v1
    v_cvt_pk_bf16_f32 v15, v13, v17
    ds_read_b128 v[60:63], v0 offset:16128
    ds_write_b32 v2, v14 offset:576
    ds_write_b32 v2, v15 offset:864
    v_smfmac_f32_16x16x64_bf16 v[28:31], v[48:51], a[104:111], v1
    v_smfmac_f32_16x16x64_bf16 v[32:35], v[48:51], a[112:119], v1
    v_add_f32 v20, v20, v22
    v_add_f32 v24, v24, v26
    v_add_f32 v21, v21, v23
    v_add_f32 v25, v25, v27
    v_cvt_pk_bf16_f32 v22, v20, v24
    v_cvt_pk_bf16_f32 v23, v21, v25
    ds_write_b32 v2, v22 offset:0
    ds_write_b32 v2, v23 offset:288
    v_smfmac_f32_16x16x64_bf16 v[28:31], v[52:55], a[152:159], v1
    v_smfmac_f32_16x16x64_bf16 v[32:35], v[52:55], a[160:167], v1
    s_waitcnt vmcnt(2)
    v_cmp_eq_u32 vcc, 0, v11
    s_nop 0
    s_cbranch_vccnz Lr2s_flbad
Lr2s_flok:
    s_waitcnt lgkmcnt(0)
    s_barrier
    ds_read_b128 v[40:43], v3 offset:0
    ds_read_b128 v[48:51], v3 offset:64
    ds_read_b128 v[20:23], v3 offset:128
    ds_read_b128 v[52:55], v3 offset:192
    v_smfmac_f32_16x16x64_bf16 v[28:31], v[36:39], a[120:127], v1
    v_smfmac_f32_16x16x64_bf16 v[32:35], v[36:39], a[128:135], v1
    ds_read_b128 v[36:39], v0 offset:17152
    v_smfmac_f32_16x16x64_bf16 v[28:31], v[44:47], a[168:175], v1
    v_smfmac_f32_16x16x64_bf16 v[32:35], v[44:47], a[176:183], v1
    ds_read_b128 v[44:47], v0 offset:18176
    s_waitcnt lgkmcnt(5)
    v_mfma_f32_16x16x32_bf16 v[12:15], v[56:59], v[40:43], 0
    v_mfma_f32_16x16x32_bf16 v[16:19], v[60:63], v[40:43], 0
    v_mfma_f32_16x16x32_bf16 v[24:27], v[40:43], v[40:43], 0
    ds_read_b128 v[56:59], v0 offset:19200
    ds_read_b128 v[60:63], v0 offset:20224
    s_waitcnt lgkmcnt(3)
    v_mfma_f32_16x16x32_bf16 v[12:15], v[36:39], v[48:51], v[12:15]
    v_lshrrev_b32 v10, 1, v0
    v_lshrrev_b32 v9, 9, v0
    s_waitcnt lgkmcnt(2)
    v_mfma_f32_16x16x32_bf16 v[16:19], v[44:47], v[48:51], v[16:19]
    v_lshl_add_u32 v9, v9, 5, v10
    v_add_f32 v28, v28, v30
    v_mfma_f32_16x16x32_bf16 v[24:27], v[48:51], v[48:51], v[24:27]
    v_add_f32 v32, v32, v34
    v_add_f32 v29, v29, v31
    ds_read_b128 v[36:39], v0 offset:21248
    ds_read_b128 v[44:47], v0 offset:22272
    s_waitcnt lgkmcnt(3)
    v_mfma_f32_16x16x32_bf16 v[12:15], v[56:59], v[20:23], v[12:15]
    v_add_f32 v33, v33, v35
    v_cvt_pk_bf16_f32 v30, v28, v29
    s_waitcnt lgkmcnt(2)
    v_mfma_f32_16x16x32_bf16 v[16:19], v[60:63], v[20:23], v[16:19]
    v_cvt_pk_bf16_f32 v31, v32, v33
    ds_read_b64 v[34:35], v9 offset:2304
    v_mfma_f32_16x16x32_bf16 v[24:27], v[20:23], v[20:23], v[24:27]
    s_add_u32 s17, s43, 3072
    buffer_store_dwordx2 v[30:31], v10, s[8:11], s17 offen sc1
    s_waitcnt lgkmcnt(2)
    v_mfma_f32_16x16x32_bf16 v[12:15], v[36:39], v[52:55], v[12:15]
    s_waitcnt lgkmcnt(1)
    v_mfma_f32_16x16x32_bf16 v[16:19], v[44:47], v[52:55], v[16:19]
    v_mfma_f32_16x16x32_bf16 v[24:27], v[52:55], v[52:55], v[24:27]
    s_add_u32 s17, s43, 1024
    s_waitcnt lgkmcnt(0)
    buffer_store_dwordx2 v[34:35], v10, s[8:11], s17 offen sc1
    s_cmp_eq_u32 s33, 63
    s_cbranch_scc1 Lr2s_last
    ds_read_b128 v[56:59], v8 offset:16384
    ds_read_b128 v[60:63], v8 offset:17408
    v_mov_b64 v[20:21], s[52:53]
    v_mov_b64 v[22:23], s[52:53]
    v_mov_b32 v41, 0
    v_mov_b32 v42, 0
    v_max3_f32 v9, v12, v13, v14
    v_max3_f32 v9, v9, v15, v16
    v_max3_f32 v9, v9, v17, v18
    v_max3_f32 v9, v9, v19, v24
    v_max_f32 v9, v9, v25
    v_mov_b32 v10, v9
    v_mov_b64 v[32:33], 0
    v_mov_b64 v[34:35], 0
    v_permlane32_swap_b32 v9, v10
    v_max_f32 v9, v9, v10
    v_mov_b32 v10, v9
    s_nop 1
    v_permlane16_swap_b32 v9, v10
    v_max_f32 v9, v9, v10
    v_mul_f32 v28, s44, v9
    v_fma_f32 v12, v12, s44, -v28
    v_fma_f32 v13, v13, s44, -v28
    v_fma_f32 v14, v14, s44, -v28
    v_fma_f32 v15, v15, s44, -v28
    v_exp_f32 v12, v12
    v_exp_f32 v13, v13
    v_fma_f32 v16, v16, s44, -v28
    v_fma_f32 v17, v17, s44, -v28
    v_exp_f32 v14, v14
    v_exp_f32 v15, v15
    v_cvt_pk_bf16_f32 v36, v12, v13
    v_fma_f32 v18, v18, s44, -v28
    v_fma_f32 v19, v19, s44, -v28
    v_exp_f32 v16, v16
    v_exp_f32 v17, v17
    v_cvt_pk_bf16_f32 v37, v14, v15
    v_fma_f32 v24, v24, s44, -v28
    v_fma_f32 v25, v25, s44, -v28
    v_exp_f32 v18, v18
    v_exp_f32 v19, v19
    v_cvt_pk_bf16_f32 v38, v16, v17
    v_exp_f32 v24, v24
    v_exp_f32 v25, v25
    v_cvt_pk_bf16_f32 v39, v18, v19
    v_cvt_pk_bf16_f32 v40, v24, v25
    v_cvt_pk_bf16_f32 v43, v24, v25
    v_mfma_f32_16x16x32_bf16 v[52:55], v[20:23], v[36:39], 0
    v_mov_b64 v[12:13], 0
    v_mov_b64 v[14:15], 0
    s_waitcnt vmcnt(3)
    v_mfma_f32_16x16x32_bf16 v[44:47], v[64:67], v[36:39], 0
    v_mov_b64 v[24:25], 0
    v_mov_b64 v[26:27], 0
    s_waitcnt vmcnt(2)
    v_mfma_f32_16x16x32_bf16 v[48:51], v[68:71], v[36:39], 0
    ds_read_b128 v[64:67], v8 offset:20480
    ds_read_b128 v[68:71], v8 offset:21504
    v_mfma_f32_16x16x16_bf16 v[52:55], v[20:21], v[40:41], v[52:55]
    v_mfma_f32_16x16x16_bf16 v[44:47], v[30:31], v[40:41], v[44:47]
    v_mov_b64 v[20:21], 0
    v_mov_b64 v[22:23], 0
    v_mfma_f32_16x16x16_bf16 v[48:51], v[30:31], v[42:43], v[48:51]
    v_mov_b64 v[36:37], 0
    v_mov_b64 v[38:39], 0
    v_mov_b64 v[40:41], 0
    v_mov_b64 v[42:43], 0
    v_rcp_f32 v9, v52
    v_mov_b64 v[52:53], 0
    v_mov_b64 v[54:55], 0
    v_mul_f32 v44, v9, v44
    v_mul_f32 v48, v9, v48
    v_cvt_pk_bf16_f32 v16, v44, v48
    v_mul_f32 v45, v9, v45
    v_mul_f32 v49, v9, v49
    v_cvt_pk_bf16_f32 v17, v45, v49
    v_mul_f32 v46, v9, v46
    v_mul_f32 v50, v9, v50
    v_cvt_pk_bf16_f32 v18, v46, v50
    v_mul_f32 v47, v9, v47
    v_mul_f32 v51, v9, v51
    v_cvt_pk_bf16_f32 v19, v47, v51
    ds_write_b128 v5, v[16:19]
    v_mov_b64 v[28:29], 0
    v_mov_b64 v[30:31], 0
    s_waitcnt lgkmcnt(0)
    s_barrier
    ds_read_b128 v[44:47], v4 offset:0
    ds_read_b128 v[48:51], v4 offset:128
    v_mov_b64 v[16:17], 0
    v_mov_b64 v[18:19], 0
    buffer_load_dwordx4 v0, s[8:11], s41 offen offset:0 lds
    buffer_load_dwordx4 v0, s[8:11], s41 offen offset:1024 lds
    s_waitcnt lgkmcnt(1)
    v_smfmac_f32_16x16x64_bf16 v[12:15], v[44:47], a[184:191], v1
    s_waitcnt lgkmcnt(0)
    v_smfmac_f32_16x16x64_bf16 v[12:15], v[48:51], a[192:199], v1
    v_smfmac_f32_16x16x64_bf16 v[24:27], v[44:47], a[200:207], v1
    v_smfmac_f32_16x16x64_bf16 v[24:27], v[48:51], a[208:215], v1
    v_add_f32 v12, v12, v14
    v_smfmac_f32_16x16x64_bf16 v[20:23], v[44:47], a[216:223], v1
    v_add_f32 v13, v13, v15
    v_smfmac_f32_16x16x64_bf16 v[20:23], v[48:51], a[224:231], v1
    v_cvt_pk_bf16_f32 v12, v12, v13
    v_smfmac_f32_16x16x64_bf16 v[16:19], v[44:47], a[232:239], v1
    v_add_f32 v24, v24, v26
    v_smfmac_f32_16x16x64_bf16 v[16:19], v[48:51], a[240:247], v1
    v_add_f32 v25, v25, v27
    v_smfmac_f32_16x16x64_bf16 v[36:39], v[44:47], v[56:63], v1
    v_cvt_pk_bf16_f32 v13, v24, v25
    v_smfmac_f32_16x16x64_bf16 v[36:39], v[48:51], v[64:71], v1
    v_add_f32 v20, v20, v22
    v_add_f32 v21, v21, v23
    v_cvt_pk_bf16_f32 v14, v20, v21
    v_add_f32 v16, v16, v18
    v_add_f32 v17, v17, v19
    v_cvt_pk_bf16_f32 v15, v16, v17
    v_and_or_b32 v15, v15, -2, s40
    buffer_store_dwordx4 v[12:15], v0, s[8:11], s38 offen sc1
    s_nop 0
    ds_read_b128 v[12:15], v8 offset:18432
    ds_read_b128 v[16:19], v8 offset:19456
    ds_read_b128 v[20:23], v8 offset:22528
    ds_read_b128 v[24:27], v8 offset:23552
    ds_read_b128 v[56:59], v8 offset:24576
    ds_read_b128 v[60:63], v8 offset:25600
    ds_read_b128 v[64:67], v8 offset:28672
    ds_read_b128 v[68:71], v8 offset:29696
    s_waitcnt lgkmcnt(6)
    v_smfmac_f32_16x16x64_bf16 v[40:43], v[44:47], v[12:19], v1
    ds_read_b128 v[12:15], v8 offset:26624
    ds_read_b128 v[16:19], v8 offset:27648
    s_waitcnt lgkmcnt(6)
    v_smfmac_f32_16x16x64_bf16 v[40:43], v[48:51], v[20:27], v1
    ds_read_b128 v[20:23], v8 offset:30720
    ds_read_b128 v[24:27], v8 offset:31744
    s_waitcnt lgkmcnt(6)
    v_smfmac_f32_16x16x64_bf16 v[52:55], v[44:47], v[56:63], v1
    ds_read_b128 v[56:59], v8 offset:32768
    ds_read_b128 v[60:63], v8 offset:33792
    s_waitcnt lgkmcnt(6)
    v_smfmac_f32_16x16x64_bf16 v[52:55], v[48:51], v[64:71], v1
    s_waitcnt lgkmcnt(4)
    v_smfmac_f32_16x16x64_bf16 v[32:35], v[44:47], v[12:19], v1
    s_waitcnt lgkmcnt(2)
    v_smfmac_f32_16x16x64_bf16 v[32:35], v[48:51], v[20:27], v1
    v_smfmac_f32_16x16x64_bf16 v[28:31], v[44:47], a[248:255], v1
    s_waitcnt lgkmcnt(0)
    v_smfmac_f32_16x16x64_bf16 v[28:31], v[48:51], v[56:63], v1
    v_add_f32 v36, v36, v38
    v_add_f32 v37, v37, v39
    v_cvt_pk_bf16_f32 v36, v36, v37
    v_add_f32 v40, v40, v42
    v_add_f32 v41, v41, v43
    v_cvt_pk_bf16_f32 v37, v40, v41
    v_add_f32 v52, v52, v54
    v_add_f32 v53, v53, v55
    v_cvt_pk_bf16_f32 v38, v52, v53
    v_add_f32 v32, v32, v34
    v_add_f32 v33, v33, v35
    v_cvt_pk_bf16_f32 v39, v32, v33
    v_and_or_b32 v39, v39, -2, s40
    s_add_u32 s17, s38, 4096
    buffer_store_dwordx4 v[36:39], v0, s[8:11], s17 offen sc1
    v_add_f32 v28, v28, v30
    v_add_f32 v29, v29, v31
    v_cvt_pk_bf16_f32 v28, v28, v29
    v_and_or_b32 v28, v28, -2, s40
    v_lshrrev_b32 v9, 2, v0
    buffer_store_dword v28, v9, s[8:11], s39 offen sc1
    v_add_u32 v10, 162560, v0
    ds_read_b32 v64, v10
    v_mov_b32 v65, 0
    v_mov_b32 v41, 0
    v_mov_b32 v45, 0
    v_mov_b32 v49, 0
    v_mov_b32 v53, 0
    s_add_u32 s33, s33, 1
    s_add_u32 s42, s42, 262144
    s_add_u32 s41, s41, 262144
    s_add_u32 s43, s43, 131072
    s_add_u32 s68, s68, 262144
    s_add_u32 s66, s66, 22528
    ds_read_b128 v[56:59], v8 offset:4096
    ds_read_b128 v[60:63], v8 offset:5120
    v_mov_b64 v[12:13], 0
    v_mov_b64 v[14:15], 0
    v_mov_b64 v[16:17], 0
    v_mov_b64 v[18:19], 0
    v_mov_b64 v[20:21], 0
    v_mov_b64 v[22:23], 0
    v_mov_b64 v[24:25], 0
    v_mov_b64 v[26:27], 0
    v_mov_b64 v[28:29], 0
    v_mov_b64 v[30:31], 0
    v_mov_b64 v[32:33], 0
    v_mov_b64 v[34:35], 0
    s_nop 15
    s_nop 15
    s_nop 15
    s_nop 1
    buffer_load_dword v40, v6, s[8:11], s62 offen sc1
    buffer_load_dword v44, v6, s[8:11], s63 offen sc1
    buffer_load_dword v48, v6, s[8:11], s64 offen sc1
    buffer_load_dword v52, v6, s[8:11], s65 offen sc1
    s_waitcnt lgkmcnt(0)
    s_waitcnt vmcnt(3)
    v_mfma_f32_16x16x16_bf16 v[68:71], v[40:41], v[64:65], 0
    v_and_b32 v10, 1, v40
    v_cmp_ne_u32 s[54:55], s40, v10
    s_waitcnt vmcnt(2)
    v_mfma_f32_16x16x16_bf16 v[68:71], v[44:45], v[64:65], v[68:71]
    v_and_b32 v10, 1, v44
    v_cmp_ne_u32 s[56:57], s40, v10
    s_waitcnt vmcnt(1)
    v_mfma_f32_16x16x16_bf16 v[68:71], v[48:49], v[64:65], v[68:71]
    v_and_b32 v10, 1, v48
    v_cmp_ne_u32 s[58:59], s40, v10
    s_waitcnt vmcnt(0)
    v_mfma_f32_16x16x16_bf16 v[68:71], v[52:53], v[64:65], v[68:71]
    v_and_b32 v10, 1, v52
    v_cmp_ne_u32 s[60:61], s40, v10
    s_or_b64 vcc, s[54:55], s[56:57]
    s_or_b64 vcc, vcc, s[58:59]
    s_or_b64 vcc, vcc, s[60:61]
    s_cbranch_scc0 Lr2s_red
    s_mov_b32 s16, 0
Lr2s_p1:
    s_mov_b64 exec, s[54:55]
    buffer_load_dword v40, v6, s[8:11], s62 offen sc1
    s_mov_b64 exec, s[56:57]
    buffer_load_dword v44, v6, s[8:11], s63 offen sc1
    s_mov_b64 exec, s[58:59]
    buffer_load_dword v48, v6, s[8:11], s64 offen sc1
    s_mov_b64 exec, s[60:61]
    buffer_load_dword v52, v6, s[8:11], s65 offen sc1
    s_mov_b64 exec, -1
    s_add_u32 s16, s16, 1
    s_cmp_gt_u32 s16, 100000
    s_cbranch_scc1 Lr_abort
    s_waitcnt vmcnt(3)
    v_mfma_f32_16x16x16_bf16 v[68:71], v[40:41], v[64:65], 0
    v_and_b32 v10, 1, v40
    v_cmp_ne_u32 s[54:55], s40, v10
    s_waitcnt vmcnt(2)
    v_mfma_f32_16x16x16_bf16 v[68:71], v[44:45], v[64:65], v[68:71]
    v_and_b32 v10, 1, v44
    v_cmp_ne_u32 s[56:57], s40, v10
    s_waitcnt vmcnt(1)
    v_mfma_f32_16x16x16_bf16 v[68:71], v[48:49], v[64:65], v[68:71]
    v_and_b32 v10, 1, v48
    v_cmp_ne_u32 s[58:59], s40, v10
    s_waitcnt vmcnt(0)
    v_mfma_f32_16x16x16_bf16 v[68:71], v[52:53], v[64:65], v[68:71]
    v_and_b32 v10, 1, v52
    v_cmp_ne_u32 s[60:61], s40, v10
    s_or_b64 vcc, s[54:55], s[56:57]
    s_or_b64 vcc, vcc, s[58:59]
    s_or_b64 vcc, vcc, s[60:61]
    s_cbranch_scc1 Lr2s_p1
Lr2s_red:
    s_xor_b32 s34, s34, 16384
    s_xor_b32 s35, s35, 16384
    buffer_load_dwordx4 v[36:39], v0, s[8:11], s34 offen sc1
    v_permlane16_swap_b32 v68, v70
    v_permlane16_swap_b32 v69, v71
    s_mov_b64 exec, s[46:47]
    v_add_f32 v68, v68, v70
    v_add_f32 v69, v69, v71
    v_cvt_pk_bf16_f32 v68, v68, v69
    v_min_u32 v68, s50, v68
    buffer_store_dword v68, v7, s[8:11], s36 offen sc1
    v_mov_b32 v69, -1
    buffer_store_dword v69, v7, s[8:11], s37 offen sc1
    s_mov_b64 exec, -1
    buffer_load_dwordx4 v[36:39], v0, s[8:11], s34 offen sc1
    s_xor_b32 s40, s40, 1
    s_xor_b32 s36, s36, 16384
    s_xor_b32 s37, s37, 16384
    ds_read_b128 v[64:67], v8 offset:6144
    ds_read_b128 v[68:71], v8 offset:7168
    s_waitcnt lgkmcnt(0)
    s_branch Lr2s_step
Lr2s_pb_re:
    s_mov_b32 s16, 0
Lr2s_pb_lp:
    s_add_u32 s17, s34, 4096
    buffer_load_dwordx4 v[40:43], v0, s[8:11], s17 offen sc1
    s_add_u32 s16, s16, 1
    s_cmp_gt_u32 s16, 100000
    s_cbranch_scc1 Lr_abort
    s_waitcnt vmcnt(0)
    v_max3_u32 v10, v40, v41, v42
    v_max_u32 v10, v10, v43
    v_cmp_eq_u32 vcc, -1, v10
    s_nop 0
    s_cbranch_vccnz Lr2s_pb_lp
    s_branch Lr2s_pb_ok
Lr2s_pc_re:
    s_mov_b32 s16, 0
Lr2s_pc_lp:
    buffer_load_dwordx4 v[44:47], v0, s[8:11], s35 offen sc1
    s_add_u32 s16, s16, 1
    s_cmp_gt_u32 s16, 100000
    s_cbranch_scc1 Lr_abort
    s_waitcnt vmcnt(0)
    v_max3_u32 v10, v44, v45, v46
    v_max_u32 v10, v10, v47
    v_cmp_eq_u32 vcc, -1, v10
    s_nop 0
    s_cbranch_vccnz Lr2s_pc_lp
    s_branch Lr2s_pc_ok
Lr2s_flbad:
    s_cmp_eq_u32 s33, 63
    s_cbranch_scc1 Lr2s_flok
    s_mov_b32 s16, 0
    s_add_u32 s17, s66, 22656
    v_lshrrev_b32 v10, 2, v0
    v_and_b32 v9, 16, v10
    v_lshlrev_b32 v9, 3, v9
    v_and_or_b32 v10, v10, 12, v9
Lr2s_fw_18:
    buffer_load_dword v9, v10, s[8:11], s17 offen sc1
    s_add_u32 s16, s16, 1
    s_cmp_gt_u32 s16, 100000
    s_cbranch_scc1 Lr_abort
    s_waitcnt vmcnt(0)
    v_cmp_eq_u32 vcc, 0, v9
    s_nop 0
    s_cbranch_vccnz Lr2s_fw_18
    s_branch Lr2s_flok
Lr2s_last:
    s_waitcnt vmcnt(0) lgkmcnt(0)
    s_barrier
    s_branch Lr_exit
L_w3_0:
    buffer_load_dwordx4 v[36:39], v0, s[8:11], s34 offen sc1
    s_mov_b32 s16, 0
    s_add_u32 s17, s66, 128
    v_lshrrev_b32 v10, 2, v0
    v_and_b32 v9, 16, v10
    v_lshlrev_b32 v9, 3, v9
    v_and_or_b32 v10, v10, 12, v9
Lr3s_fw_19:
    buffer_load_dword v9, v10, s[8:11], s17 offen sc1
    s_add_u32 s16, s16, 1
    s_cmp_gt_u32 s16, 100000
    s_cbranch_scc1 Lr_abort
    s_waitcnt vmcnt(0)
    v_cmp_eq_u32 vcc, 0, v9
    s_nop 0
    s_cbranch_vccnz Lr3s_fw_19
    s_mov_b32 m0, 21248
    s_nop 0
    buffer_load_dwordx4 v0, s[8:11], s41 offen offset:0 lds
    buffer_load_dwordx4 v0, s[8:11], s41 offen offset:1024 lds
    s_add_u32 s41, s41, 262144
    s_add_u32 s68, s68, 262144
    ds_read_b128 v[56:59], v8 offset:0
    ds_read_b128 v[60:63], v8 offset:1024
    ds_read_b128 v[64:67], v8 offset:2048
    ds_read_b128 v[68:71], v8 offset:3072
    v_mov_b64 v[12:13], 0
    v_mov_b64 v[14:15], 0
    v_mov_b64 v[16:17], 0
    v_mov_b64 v[18:19], 0
    v_mov_b64 v[20:21], 0
    v_mov_b64 v[22:23], 0
    v_mov_b64 v[24:25], 0
    v_mov_b64 v[26:27], 0
    v_mov_b64 v[28:29], 0
    v_mov_b64 v[30:31], 0
    v_mov_b64 v[32:33], 0
    v_mov_b64 v[34:35], 0
    s_waitcnt vmcnt(0) lgkmcnt(0)
Lr3s_step:
    s_mov_b32 s16, 0
Lr3s_alp:
    s_waitcnt vmcnt(2)
    v_max3_u32 v10, v36, v37, v38
    v_max_u32 v10, v10, v39
    v_cmp_eq_u32 vcc, -1, v10
    s_nop 0
    s_cbranch_vccz Lr3s_aok
    buffer_load_dwordx4 v[36:39], v0, s[8:11], s34 offen sc1
    s_add_u32 s16, s16, 1
    s_cmp_gt_u32 s16, 100000
    s_cbranch_scc1 Lr_abort
    s_branch Lr3s_alp
Lr3s_aok:
    ds_write_b128 v0, v[36:39] offset:9984
    v_smfmac_f32_16x16x64_bf16 v[12:15], v[36:39], v[120:127], v1
    v_smfmac_f32_16x16x64_bf16 v[16:19], v[36:39], v[128:135], v1
    v_smfmac_f32_16x16x64_bf16 v[20:23], v[36:39], v[232:239], v1
    s_waitcnt lgkmcnt(0)
    s_barrier
    ds_read_b128 v[48:51], v0 offset:6912
    ds_read_b128 v[52:55], v0 offset:7936
    v_smfmac_f32_16x16x64_bf16 v[28:31], v[36:39], a[88:95], v1
    v_smfmac_f32_16x16x64_bf16 v[24:27], v[36:39], v[240:247], v1
    v_smfmac_f32_16x16x64_bf16 v[32:35], v[36:39], a[96:103], v1
    s_waitcnt vmcnt(0)
    ds_read_b128 v[36:39], v0 offset:8960
    s_waitcnt lgkmcnt(2)
    v_smfmac_f32_16x16x64_bf16 v[28:31], v[48:51], v[56:63], v1
    ds_read_b128 v[56:59], v8 offset:4096
    ds_read_b128 v[60:63], v8 offset:5120
    s_add_u32 s17, s34, 4096
    buffer_load_dwordx4 v[40:43], v0, s[8:11], s17 offen sc1
    v_smfmac_f32_16x16x64_bf16 v[12:15], v[48:51], v[72:79], v1
    v_smfmac_f32_16x16x64_bf16 v[16:19], v[48:51], v[80:87], v1
    v_smfmac_f32_16x16x64_bf16 v[32:35], v[48:51], v[64:71], v1
    ds_read_b128 v[64:67], v8 offset:6144
    ds_read_b128 v[68:71], v8 offset:7168
    v_smfmac_f32_16x16x64_bf16 v[20:23], v[48:51], v[184:191], v1
    buffer_load_dwordx4 v[44:47], v0, s[8:11], s35 offen sc1
    v_smfmac_f32_16x16x64_bf16 v[24:27], v[48:51], v[192:199], v1
    s_waitcnt lgkmcnt(5)
    v_smfmac_f32_16x16x64_bf16 v[28:31], v[52:55], a[72:79], v1
    v_smfmac_f32_16x16x64_bf16 v[12:15], v[52:55], v[88:95], v1
    v_smfmac_f32_16x16x64_bf16 v[16:19], v[52:55], v[96:103], v1
    v_smfmac_f32_16x16x64_bf16 v[32:35], v[52:55], a[80:87], v1
    v_smfmac_f32_16x16x64_bf16 v[20:23], v[52:55], v[200:207], v1
    v_smfmac_f32_16x16x64_bf16 v[24:27], v[52:55], v[208:215], v1
    s_waitcnt lgkmcnt(2)
    v_smfmac_f32_16x16x64_bf16 v[28:31], v[36:39], v[56:63], v1
    ds_read_b128 v[56:59], v8 offset:8192
    ds_read_b128 v[60:63], v8 offset:9216
    v_smfmac_f32_16x16x64_bf16 v[12:15], v[36:39], v[104:111], v1
    v_smfmac_f32_16x16x64_bf16 v[16:19], v[36:39], v[112:119], v1
    s_waitcnt lgkmcnt(2)
    v_smfmac_f32_16x16x64_bf16 v[32:35], v[36:39], v[64:71], v1
    ds_read_b128 v[64:67], v8 offset:10240
    ds_read_b128 v[68:71], v8 offset:11264
    v_smfmac_f32_16x16x64_bf16 v[20:23], v[36:39], v[216:223], v1
    v_smfmac_f32_16x16x64_bf16 v[24:27], v[36:39], v[224:231], v1
    s_waitcnt vmcnt(1)
    v_max3_u32 v10, v40, v41, v42
    v_max_u32 v10, v10, v43
    v_cmp_eq_u32 vcc, -1, v10
    s_nop 0
    s_cbranch_vccnz Lr3s_pb_re
Lr3s_pb_ok:
    ds_write_b128 v0, v[40:43] offset:14080
    v_smfmac_f32_16x16x64_bf16 v[12:15], v[40:43], v[152:159], v1
    v_smfmac_f32_16x16x64_bf16 v[20:23], v[40:43], a[40:47], v1
    v_smfmac_f32_16x16x64_bf16 v[16:19], v[40:43], v[160:167], v1
    v_smfmac_f32_16x16x64_bf16 v[24:27], v[40:43], a[48:55], v1
    s_waitcnt lgkmcnt(0)
    s_barrier
    ds_read_b128 v[48:51], v0 offset:11008
    ds_read_b128 v[52:55], v0 offset:12032
    ds_read_b128 v[36:39], v0 offset:13056
    v_smfmac_f32_16x16x64_bf16 v[28:31], v[40:43], a[152:159], v1
    v_smfmac_f32_16x16x64_bf16 v[32:35], v[40:43], a[160:167], v1
    s_waitcnt lgkmcnt(2)
    v_smfmac_f32_16x16x64_bf16 v[12:15], v[48:51], v[56:63], v1
    ds_read_b128 v[56:59], v8 offset:12288
    ds_read_b128 v[60:63], v8 offset:13312
    v_smfmac_f32_16x16x64_bf16 v[16:19], v[48:51], v[64:71], v1
    ds_read_b128 v[64:67], v8 offset:14336
    ds_read_b128 v[68:71], v8 offset:15360
    s_waitcnt lgkmcnt(5)
    v_smfmac_f32_16x16x64_bf16 v[12:15], v[52:55], v[136:143], v1
    v_smfmac_f32_16x16x64_bf16 v[16:19], v[52:55], v[144:151], v1
    s_waitcnt vmcnt(0)
    v_max3_u32 v10, v44, v45, v46
    v_max_u32 v10, v10, v47
    v_cmp_eq_u32 vcc, -1, v10
    s_nop 0
    s_cbranch_vccnz Lr3s_pc_re
Lr3s_pc_ok:
    v_smfmac_f32_16x16x64_bf16 v[12:15], v[44:47], v[168:175], v1
    v_smfmac_f32_16x16x64_bf16 v[16:19], v[44:47], v[176:183], v1
    s_waitcnt lgkmcnt(2)
    v_smfmac_f32_16x16x64_bf16 v[12:15], v[36:39], v[56:63], v1
    s_waitcnt lgkmcnt(0)
    v_smfmac_f32_16x16x64_bf16 v[16:19], v[36:39], v[64:71], v1
    v_smfmac_f32_16x16x64_bf16 v[20:23], v[48:51], v[248:255], v1
    v_smfmac_f32_16x16x64_bf16 v[24:27], v[48:51], a[0:7], v1
    v_smfmac_f32_16x16x64_bf16 v[20:23], v[52:55], a[8:15], v1
    v_add_f32 v12, v12, v14
    v_smfmac_f32_16x16x64_bf16 v[24:27], v[52:55], a[16:23], v1
    v_add_f32 v16, v16, v18
    buffer_load_dwordx4 v[64:67], v0, s[8:11], s42 offen
    v_smfmac_f32_16x16x64_bf16 v[20:23], v[36:39], a[24:31], v1
    v_add_f32 v13, v13, v15
    v_smfmac_f32_16x16x64_bf16 v[24:27], v[36:39], a[32:39], v1
    v_add_f32 v17, v17, v19
    v_smfmac_f32_16x16x64_bf16 v[20:23], v[44:47], a[56:63], v1
    v_cvt_pk_bf16_f32 v14, v12, v16
    ds_read_b128 v[56:59], v0 offset:15104
    v_smfmac_f32_16x16x64_bf16 v[24:27], v[44:47], a[64:71], v1
    v_cvt_pk_bf16_f32 v15, v13, v17
    ds_read_b128 v[60:63], v0 offset:16128
    buffer_load_dwordx4 v[68:71], v0, s[8:11], s42 offen offset:1024
    ds_write_b32 v2, v14 offset:576
    ds_write_b32 v2, v15 offset:864
    v_smfmac_f32_16x16x64_bf16 v[28:31], v[48:51], a[104:111], v1
    v_smfmac_f32_16x16x64_bf16 v[32:35], v[48:51], a[112:119], v1
    v_add_f32 v20, v20, v22
    v_add_f32 v24, v24, v26
    v_add_f32 v21, v21, v23
    v_add_f32 v25, v25, v27
    v_cvt_pk_bf16_f32 v22, v20, v24
    v_cvt_pk_bf16_f32 v23, v21, v25
    ds_write_b32 v2, v22 offset:0
    ds_write_b32 v2, v23 offset:288
    v_smfmac_f32_16x16x64_bf16 v[28:31], v[52:55], a[120:127], v1
    v_smfmac_f32_16x16x64_bf16 v[32:35], v[52:55], a[128:135], v1
    s_waitcnt lgkmcnt(0)
    s_barrier
    ds_read_b128 v[40:43], v3 offset:0
    ds_read_b128 v[48:51], v3 offset:64
    ds_read_b128 v[20:23], v3 offset:128
    ds_read_b128 v[52:55], v3 offset:192
    v_smfmac_f32_16x16x64_bf16 v[28:31], v[36:39], a[136:143], v1
    v_smfmac_f32_16x16x64_bf16 v[32:35], v[36:39], a[144:151], v1
    ds_read_b128 v[36:39], v0 offset:17152
    v_lshlrev_b32 v9, 3, v0
    buffer_load_dword v11, v9, s[8:11], s68 offen
    v_smfmac_f32_16x16x64_bf16 v[28:31], v[44:47], a[168:175], v1
    v_smfmac_f32_16x16x64_bf16 v[32:35], v[44:47], a[176:183], v1
    ds_read_b128 v[44:47], v0 offset:18176
    s_waitcnt lgkmcnt(5)
    v_mfma_f32_16x16x32_bf16 v[12:15], v[56:59], v[40:43], 0
    v_mfma_f32_16x16x32_bf16 v[16:19], v[60:63], v[40:43], 0
    v_mfma_f32_16x16x32_bf16 v[24:27], v[40:43], v[40:43], 0
    ds_read_b128 v[56:59], v0 offset:19200
    ds_read_b128 v[60:63], v0 offset:20224
    s_waitcnt lgkmcnt(3)
    v_mfma_f32_16x16x32_bf16 v[12:15], v[36:39], v[48:51], v[12:15]
    v_lshrrev_b32 v10, 1, v0
    v_lshrrev_b32 v9, 9, v0
    s_waitcnt lgkmcnt(2)
    v_mfma_f32_16x16x32_bf16 v[16:19], v[44:47], v[48:51], v[16:19]
    v_lshl_add_u32 v9, v9, 5, v10
    v_add_f32 v28, v28, v30
    v_mfma_f32_16x16x32_bf16 v[24:27], v[48:51], v[48:51], v[24:27]
    v_add_f32 v32, v32, v34
    v_add_f32 v29, v29, v31
    ds_read_b128 v[36:39], v0 offset:21248
    ds_read_b128 v[44:47], v0 offset:22272
    s_waitcnt lgkmcnt(3)
    v_mfma_f32_16x16x32_bf16 v[12:15], v[56:59], v[20:23], v[12:15]
    v_add_f32 v33, v33, v35
    v_cvt_pk_bf16_f32 v30, v28, v29
    s_waitcnt lgkmcnt(2)
    v_mfma_f32_16x16x32_bf16 v[16:19], v[60:63], v[20:23], v[16:19]
    v_cvt_pk_bf16_f32 v31, v32, v33
    ds_read_b64 v[34:35], v9 offset:3456
    v_mfma_f32_16x16x32_bf16 v[24:27], v[20:23], v[20:23], v[24:27]
    s_add_u32 s17, s43, 3584
    buffer_store_dwordx2 v[30:31], v10, s[8:11], s17 offen sc1
    s_waitcnt lgkmcnt(2)
    v_mfma_f32_16x16x32_bf16 v[12:15], v[36:39], v[52:55], v[12:15]
    s_waitcnt lgkmcnt(1)
    v_mfma_f32_16x16x32_bf16 v[16:19], v[44:47], v[52:55], v[16:19]
    v_mfma_f32_16x16x32_bf16 v[24:27], v[52:55], v[52:55], v[24:27]
    s_add_u32 s17, s43, 1536
    s_waitcnt lgkmcnt(0)
    buffer_store_dwordx2 v[34:35], v10, s[8:11], s17 offen sc1
    s_cmp_eq_u32 s33, 63
    s_cbranch_scc1 Lr3s_last
    ds_read_b128 v[56:59], v8 offset:16384
    ds_read_b128 v[60:63], v8 offset:17408
    v_mov_b64 v[20:21], s[52:53]
    v_mov_b64 v[22:23], s[52:53]
    v_mov_b32 v41, 0
    v_mov_b32 v42, 0
    v_max3_f32 v9, v12, v13, v14
    v_max3_f32 v9, v9, v15, v16
    v_max3_f32 v9, v9, v17, v18
    v_max3_f32 v9, v9, v19, v24
    v_max_f32 v9, v9, v25
    v_mov_b32 v10, v9
    v_mov_b64 v[32:33], 0
    v_mov_b64 v[34:35], 0
    v_permlane32_swap_b32 v9, v10
    v_max_f32 v9, v9, v10
    v_mov_b32 v10, v9
    s_nop 1
    v_permlane16_swap_b32 v9, v10
    v_max_f32 v9, v9, v10
    v_mul_f32 v28, s44, v9
    v_fma_f32 v12, v12, s44, -v28
    v_fma_f32 v13, v13, s44, -v28
    v_fma_f32 v14, v14, s44, -v28
    v_fma_f32 v15, v15, s44, -v28
    v_exp_f32 v12, v12
    v_exp_f32 v13, v13
    v_fma_f32 v16, v16, s44, -v28
    v_fma_f32 v17, v17, s44, -v28
    v_exp_f32 v14, v14
    v_exp_f32 v15, v15
    v_cvt_pk_bf16_f32 v36, v12, v13
    v_fma_f32 v18, v18, s44, -v28
    v_fma_f32 v19, v19, s44, -v28
    v_exp_f32 v16, v16
    v_exp_f32 v17, v17
    v_cvt_pk_bf16_f32 v37, v14, v15
    v_fma_f32 v24, v24, s44, -v28
    v_fma_f32 v25, v25, s44, -v28
    v_exp_f32 v18, v18
    v_exp_f32 v19, v19
    v_cvt_pk_bf16_f32 v38, v16, v17
    v_exp_f32 v24, v24
    v_exp_f32 v25, v25
    v_cvt_pk_bf16_f32 v39, v18, v19
    v_cvt_pk_bf16_f32 v40, v24, v25
    v_cvt_pk_bf16_f32 v43, v24, v25
    v_mfma_f32_16x16x32_bf16 v[52:55], v[20:23], v[36:39], 0
    v_mov_b64 v[12:13], 0
    v_mov_b64 v[14:15], 0
    s_waitcnt vmcnt(4)
    v_mfma_f32_16x16x32_bf16 v[44:47], v[64:67], v[36:39], 0
    v_mov_b64 v[24:25], 0
    v_mov_b64 v[26:27], 0
    s_waitcnt vmcnt(3)
    v_mfma_f32_16x16x32_bf16 v[48:51], v[68:71], v[36:39], 0
    ds_read_b128 v[64:67], v8 offset:20480
    ds_read_b128 v[68:71], v8 offset:21504
    v_mfma_f32_16x16x16_bf16 v[52:55], v[20:21], v[40:41], v[52:55]
    v_mfma_f32_16x16x16_bf16 v[44:47], v[30:31], v[40:41], v[44:47]
    v_mov_b64 v[20:21], 0
    v_mov_b64 v[22:23], 0
    v_mfma_f32_16x16x16_bf16 v[48:51], v[30:31], v[42:43], v[48:51]
    v_mov_b64 v[36:37], 0
    v_mov_b64 v[38:39], 0
    v_mov_b64 v[40:41], 0
    v_mov_b64 v[42:43], 0
    v_rcp_f32 v9, v52
    v_mov_b64 v[52:53], 0
    v_mov_b64 v[54:55], 0
    v_mul_f32 v44, v9, v44
    v_mul_f32 v48, v9, v48
    v_cvt_pk_bf16_f32 v16, v44, v48
    v_mul_f32 v45, v9, v45
    v_mul_f32 v49, v9, v49
    v_cvt_pk_bf16_f32 v17, v45, v49
    v_mul_f32 v46, v9, v46
    v_mul_f32 v50, v9, v50
    v_cvt_pk_bf16_f32 v18, v46, v50
    v_mul_f32 v47, v9, v47
    v_mul_f32 v51, v9, v51
    v_cvt_pk_bf16_f32 v19, v47, v51
    ds_write_b128 v5, v[16:19]
    v_mov_b64 v[28:29], 0
    v_mov_b64 v[30:31], 0
    s_waitcnt lgkmcnt(0)
    s_barrier
    ds_read_b128 v[44:47], v4 offset:0
    ds_read_b128 v[48:51], v4 offset:128
    v_mov_b64 v[16:17], 0
    v_mov_b64 v[18:19], 0
    buffer_load_dwordx4 v0, s[8:11], s41 offen offset:0 lds
    buffer_load_dwordx4 v0, s[8:11], s41 offen offset:1024 lds
    s_waitcnt lgkmcnt(1)
    v_smfmac_f32_16x16x64_bf16 v[12:15], v[44:47], a[184:191], v1
    s_waitcnt lgkmcnt(0)
    v_smfmac_f32_16x16x64_bf16 v[12:15], v[48:51], a[192:199], v1
    v_smfmac_f32_16x16x64_bf16 v[24:27], v[44:47], a[200:207], v1
    v_smfmac_f32_16x16x64_bf16 v[24:27], v[48:51], a[208:215], v1
    v_add_f32 v12, v12, v14
    v_smfmac_f32_16x16x64_bf16 v[20:23], v[44:47], a[216:223], v1
    v_add_f32 v13, v13, v15
    v_smfmac_f32_16x16x64_bf16 v[20:23], v[48:51], a[224:231], v1
    v_cvt_pk_bf16_f32 v12, v12, v13
    v_smfmac_f32_16x16x64_bf16 v[16:19], v[44:47], a[232:239], v1
    v_add_f32 v24, v24, v26
    v_smfmac_f32_16x16x64_bf16 v[16:19], v[48:51], a[240:247], v1
    v_add_f32 v25, v25, v27
    v_smfmac_f32_16x16x64_bf16 v[36:39], v[44:47], v[56:63], v1
    v_cvt_pk_bf16_f32 v13, v24, v25
    v_smfmac_f32_16x16x64_bf16 v[36:39], v[48:51], v[64:71], v1
    v_add_f32 v20, v20, v22
    v_add_f32 v21, v21, v23
    v_cvt_pk_bf16_f32 v14, v20, v21
    v_add_f32 v16, v16, v18
    v_add_f32 v17, v17, v19
    v_cvt_pk_bf16_f32 v15, v16, v17
    v_and_or_b32 v15, v15, -2, s40
    buffer_store_dwordx4 v[12:15], v0, s[8:11], s38 offen sc1
    s_nop 0
    ds_read_b128 v[12:15], v8 offset:18432
    ds_read_b128 v[16:19], v8 offset:19456
    ds_read_b128 v[20:23], v8 offset:22528
    ds_read_b128 v[24:27], v8 offset:23552
    ds_read_b128 v[56:59], v8 offset:24576
    ds_read_b128 v[60:63], v8 offset:25600
    ds_read_b128 v[64:67], v8 offset:28672
    ds_read_b128 v[68:71], v8 offset:29696
    s_waitcnt lgkmcnt(6)
    v_smfmac_f32_16x16x64_bf16 v[40:43], v[44:47], v[12:19], v1
    ds_read_b128 v[12:15], v8 offset:26624
    ds_read_b128 v[16:19], v8 offset:27648
    s_waitcnt lgkmcnt(6)
    v_smfmac_f32_16x16x64_bf16 v[40:43], v[48:51], v[20:27], v1
    ds_read_b128 v[20:23], v8 offset:30720
    ds_read_b128 v[24:27], v8 offset:31744
    s_waitcnt lgkmcnt(6)
    v_smfmac_f32_16x16x64_bf16 v[52:55], v[44:47], v[56:63], v1
    ds_read_b128 v[56:59], v8 offset:32768
    ds_read_b128 v[60:63], v8 offset:33792
    s_waitcnt lgkmcnt(6)
    v_smfmac_f32_16x16x64_bf16 v[52:55], v[48:51], v[64:71], v1
    s_waitcnt lgkmcnt(4)
    v_smfmac_f32_16x16x64_bf16 v[32:35], v[44:47], v[12:19], v1
    s_waitcnt lgkmcnt(2)
    v_smfmac_f32_16x16x64_bf16 v[32:35], v[48:51], v[20:27], v1
    v_smfmac_f32_16x16x64_bf16 v[28:31], v[44:47], a[248:255], v1
    s_waitcnt lgkmcnt(0)
    v_smfmac_f32_16x16x64_bf16 v[28:31], v[48:51], v[56:63], v1
    v_add_f32 v36, v36, v38
    v_add_f32 v37, v37, v39
    v_cvt_pk_bf16_f32 v36, v36, v37
    v_add_f32 v40, v40, v42
    v_add_f32 v41, v41, v43
    v_cvt_pk_bf16_f32 v37, v40, v41
    v_add_f32 v52, v52, v54
    v_add_f32 v53, v53, v55
    v_cvt_pk_bf16_f32 v38, v52, v53
    v_add_f32 v32, v32, v34
    v_add_f32 v33, v33, v35
    v_cvt_pk_bf16_f32 v39, v32, v33
    v_and_or_b32 v39, v39, -2, s40
    s_add_u32 s17, s38, 4096
    buffer_store_dwordx4 v[36:39], v0, s[8:11], s17 offen sc1
    v_add_f32 v28, v28, v30
    v_add_f32 v29, v29, v31
    v_cvt_pk_bf16_f32 v28, v28, v29
    v_and_or_b32 v28, v28, -2, s40
    v_lshrrev_b32 v9, 2, v0
    buffer_store_dword v28, v9, s[8:11], s39 offen sc1
    s_xor_b32 s34, s34, 16384
    s_xor_b32 s35, s35, 16384
    s_add_u32 s33, s33, 1
    s_add_u32 s42, s42, 262144
    s_add_u32 s41, s41, 262144
    s_add_u32 s43, s43, 131072
    s_add_u32 s68, s68, 262144
    s_add_u32 s66, s66, 22528
    s_xor_b32 s40, s40, 1
    ds_read_b128 v[56:59], v8 offset:0
    ds_read_b128 v[60:63], v8 offset:1024
    ds_read_b128 v[64:67], v8 offset:2048
    ds_read_b128 v[68:71], v8 offset:3072
    v_mov_b64 v[12:13], 0
    v_mov_b64 v[14:15], 0
    v_mov_b64 v[16:17], 0
    v_mov_b64 v[18:19], 0
    v_mov_b64 v[20:21], 0
    v_mov_b64 v[22:23], 0
    v_mov_b64 v[24:25], 0
    v_mov_b64 v[26:27], 0
    v_mov_b64 v[28:29], 0
    v_mov_b64 v[30:31], 0
    v_mov_b64 v[32:33], 0
    v_mov_b64 v[34:35], 0
    s_sleep 5
    s_nop 9
    buffer_load_dwordx4 v[36:39], v0, s[8:11], s34 offen sc1
    s_nop 15
    s_nop 8
    buffer_load_dwordx4 v[36:39], v0, s[8:11], s34 offen sc1
    s_nop 15
    s_nop 8
    buffer_load_dwordx4 v[36:39], v0, s[8:11], s34 offen sc1
    s_waitcnt lgkmcnt(0)
    s_branch Lr3s_step
Lr3s_pb_re:
    s_mov_b32 s16, 0
Lr3s_pb_lp:
    s_add_u32 s17, s34, 4096
    buffer_load_dwordx4 v[40:43], v0, s[8:11], s17 offen sc1
    s_add_u32 s16, s16, 1
    s_cmp_gt_u32 s16, 100000
    s_cbranch_scc1 Lr_abort
    s_waitcnt vmcnt(0)
    v_max3_u32 v10, v40, v41, v42
    v_max_u32 v10, v10, v43
    v_cmp_eq_u32 vcc, -1, v10
    s_nop 0
    s_cbranch_vccnz Lr3s_pb_lp
    s_branch Lr3s_pb_ok
Lr3s_pc_re:
    s_mov_b32 s16, 0
Lr3s_pc_lp:
    buffer_load_dwordx4 v[44:47], v0, s[8:11], s35 offen sc1
    s_add_u32 s16, s16, 1
    s_cmp_gt_u32 s16, 100000
    s_cbranch_scc1 Lr_abort
    s_waitcnt vmcnt(0)
    v_max3_u32 v10, v44, v45, v46
    v_max_u32 v10, v10, v47
    v_cmp_eq_u32 vcc, -1, v10
    s_nop 0
    s_cbranch_vccnz Lr3s_pc_lp
    s_branch Lr3s_pc_ok
Lr3s_last:
    s_waitcnt vmcnt(0) lgkmcnt(0)
    s_barrier
    s_branch Lr_exit
Lr_abort:
    s_waitcnt lgkmcnt(0)
    s_mov_b64 exec, -1
    v_mov_b32 v0, 60
    s_lshl_b32 s5, s3, 8
    s_or_b32 s5, s5, s4
    s_or_b32 s5, s5, 0x10000
    v_mov_b32 v1, s5
    global_store_dword v0, v1, s[12:13]
    s_endpgm
Lr_exit:
    s_endpgm
.section .rodata,"a"
.p2align 6
.amdhsa_kernel interleave_layers__sliding_local_dilated__memory_aug_recurrent_mem_tr__prompt_kernel
  .amdhsa_next_free_vgpr 512
  .amdhsa_next_free_sgpr 102
  .amdhsa_accum_offset 256
  .amdhsa_group_segment_fixed_size 0
  .amdhsa_kernarg_size 104
  .amdhsa_user_sgpr_count 2
  .amdhsa_user_sgpr_kernarg_segment_ptr 1
  .amdhsa_system_sgpr_workgroup_id_x 1
.end_amdhsa_kernel
```

```asm
; @launch grid=(256,1,1) block=(256,1,1) lds=163840
.amdgcn_target "amdgcn-amd-amdhsa--gfx950"
.text
.globl interleave_layers__sliding_local_dilated__memory_aug_recurrent_mem_tr__prompt_kernel
.p2align 8
.type interleave_layers__sliding_local_dilated__memory_aug_recurrent_mem_tr__prompt_kernel,@function
interleave_layers__sliding_local_dilated__memory_aug_recurrent_mem_tr__prompt_kernel:
    s_cmp_ge_u32 s2, 256
    s_cbranch_scc1 L_exit
    s_load_dwordx2 s[8:9], s[0:1], 96
    s_mov_b32 s10, 268435456
    s_mov_b32 s11, 0x00020000
    s_waitcnt lgkmcnt(0)
    s_and_b32 s9, s9, 0xffff
    s_load_dwordx2 s[12:13], s[0:1], 88
    v_lshrrev_b32 v1, 6, v0
    s_getreg_b32 s3, hwreg(HW_REG_XCC_ID)
    v_readfirstlane_b32 s14, v1
    s_and_b32 s3, s3, 7
    s_and_b32 s17, s3, 1
    s_lshl_b32 s17, s17, 7
    s_lshl_b32 s18, s3, 1
    s_and_b32 s18, s18, 12
    s_add_u32 s17, s17, s18
    v_mov_b32 v2, 0
    v_mov_b32 v3, 1
    v_mov_b32 v4, s17
    s_mov_b32 s33, 0
    s_waitcnt lgkmcnt(0)
    s_cmp_lg_u32 s14, 0
    s_cbranch_scc1 L_tk_wait
    s_mov_b64 exec, 1
    global_atomic_add v3, v4, v3, s[12:13] sc0
    s_waitcnt vmcnt(0)
    v_readfirstlane_b32 s4, v3
    s_nop 0
    s_cmp_lt_u32 s4, 32
    s_cbranch_scc1 L_tk_have
    v_mov_b32 v3, 1
    v_mov_b32 v4, 32
    global_atomic_add v3, v4, v3, s[12:13] sc0
    s_waitcnt vmcnt(0)
    v_readfirstlane_b32 s5, v3
    s_mov_b64 exec, 0xff
    v_and_b32 v4, 1, v0
    v_lshlrev_b32 v4, 7, v4
    v_lshlrev_b32 v5, 1, v0
    v_and_or_b32 v4, v5, 12, v4
    s_mov_b32 s16, 0
L_hl_poll:
    global_load_dword v5, v4, s[12:13] sc1
    s_add_u32 s16, s16, 1
    s_cmp_gt_u32 s16, 100000
    s_cbranch_scc1 L_abort
    s_mov_b32 s6, 0
    s_waitcnt vmcnt(0)
    v_readlane_b32 s40, v5, 0
    s_nop 0
    s_add_u32 s6, s6, s40
    v_readlane_b32 s41, v5, 1
    s_nop 0
    s_add_u32 s6, s6, s41
    v_readlane_b32 s42, v5, 2
    s_nop 0
    s_add_u32 s6, s6, s42
    v_readlane_b32 s43, v5, 3
    s_nop 0
    s_add_u32 s6, s6, s43
    v_readlane_b32 s44, v5, 4
    s_nop 0
    s_add_u32 s6, s6, s44
    v_readlane_b32 s45, v5, 5
    s_nop 0
    s_add_u32 s6, s6, s45
    v_readlane_b32 s46, v5, 6
    s_nop 0
    s_add_u32 s6, s6, s46
    v_readlane_b32 s47, v5, 7
    s_nop 0
    s_add_u32 s6, s6, s47
    s_cmp_lt_u32 s6, 256
    s_cbranch_scc1 L_hl_poll
    s_mov_b32 s3, 0
    s_mov_b32 s4, 0
    s_min_u32 s6, s47, 32
    s_sub_u32 s7, 32, s6
    s_cmp_lt_u32 s5, s7
    s_cselect_b32 s3, 7, s3
    s_add_u32 s6, s6, s5
    s_cmp_lt_u32 s5, s7
    s_cselect_b32 s4, s6, s4
    s_sub_u32 s5, s5, s7
    s_min_u32 s6, s46, 32
    s_sub_u32 s7, 32, s6
    s_cmp_lt_u32 s5, s7
    s_cselect_b32 s3, 6, s3
    s_add_u32 s6, s6, s5
    s_cmp_lt_u32 s5, s7
    s_cselect_b32 s4, s6, s4
    s_sub_u32 s5, s5, s7
    s_min_u32 s6, s45, 32
    s_sub_u32 s7, 32, s6
    s_cmp_lt_u32 s5, s7
    s_cselect_b32 s3, 5, s3
    s_add_u32 s6, s6, s5
    s_cmp_lt_u32 s5, s7
    s_cselect_b32 s4, s6, s4
    s_sub_u32 s5, s5, s7
    s_min_u32 s6, s44, 32
    s_sub_u32 s7, 32, s6
    s_cmp_lt_u32 s5, s7
    s_cselect_b32 s3, 4, s3
    s_add_u32 s6, s6, s5
    s_cmp_lt_u32 s5, s7
    s_cselect_b32 s4, s6, s4
    s_sub_u32 s5, s5, s7
    s_min_u32 s6, s43, 32
    s_sub_u32 s7, 32, s6
    s_cmp_lt_u32 s5, s7
    s_cselect_b32 s3, 3, s3
    s_add_u32 s6, s6, s5
    s_cmp_lt_u32 s5, s7
    s_cselect_b32 s4, s6, s4
    s_sub_u32 s5, s5, s7
    s_min_u32 s6, s42, 32
    s_sub_u32 s7, 32, s6
    s_cmp_lt_u32 s5, s7
    s_cselect_b32 s3, 2, s3
    s_add_u32 s6, s6, s5
    s_cmp_lt_u32 s5, s7
    s_cselect_b32 s4, s6, s4
    s_sub_u32 s5, s5, s7
    s_min_u32 s6, s41, 32
    s_sub_u32 s7, 32, s6
    s_cmp_lt_u32 s5, s7
    s_cselect_b32 s3, 1, s3
    s_add_u32 s6, s6, s5
    s_cmp_lt_u32 s5, s7
    s_cselect_b32 s4, s6, s4
    s_sub_u32 s5, s5, s7
    s_min_u32 s6, s40, 32
    s_sub_u32 s7, 32, s6
    s_cmp_lt_u32 s5, s7
    s_cselect_b32 s3, 0, s3
    s_add_u32 s6, s6, s5
    s_cmp_lt_u32 s5, s7
    s_cselect_b32 s4, s6, s4
    s_sub_u32 s5, s5, s7
L_tk_have:
    s_lshl_b32 s5, s3, 8
    s_or_b32 s5, s5, s4
    v_mov_b32 v3, s5
    s_mov_b64 exec, 1
    ds_write_b32 v2, v3
    s_mov_b64 exec, -1
L_tk_wait:
    s_waitcnt vmcnt(0) lgkmcnt(0)
    s_barrier
    ds_read_b32 v3, v2
    s_waitcnt lgkmcnt(0)
    v_readfirstlane_b32 s5, v3
    s_nop 0
    s_lshr_b32 s3, s5, 8
    s_and_b32 s4, s5, 255
    s_barrier
    s_cmp_lt_u32 s3, 2
    s_cbranch_scc1 L_role_r
    s_sub_u32 s6, s3, 2
    s_lshl_b32 s6, s6, 5
    s_add_u32 s6, s6, s4
    s_load_dwordx2 s[20:21], s[0:1], 8
    s_mov_b32 s22, 1990656
    s_mov_b32 s23, 0x00020000
    s_waitcnt lgkmcnt(0)
    s_and_b32 s21, s21, 0xffff
    s_load_dwordx2 s[24:25], s[0:1], 16
    s_mov_b32 s26, 663552
    s_mov_b32 s27, 0x00020000
    s_waitcnt lgkmcnt(0)
    s_and_b32 s25, s25, 0xffff
    s_sub_u32 s41, 191, s6
    s_lshl_b32 s41, s41, 15
    v_lshlrev_b32 v254, 7, v0
    buffer_load_dword v255, v254, s[20:23], s41 offen
    s_sub_u32 s41, s41, 1998848
    s_cmp_lt_u32 s41, 688128
    s_cselect_b32 s41, s41, 0x7f000000
    s_waitcnt vmcnt(0)
    buffer_load_dword v255, v254, s[24:27], s41 offen
    s_cmp_ge_u32 s6, 192
    s_cbranch_scc1 Li_end
    s_sub_u32 s41, s6, 64
    s_cmp_lt_u32 s41, 64
    s_cbranch_scc1 Li_end
Li_body:
    v_lshlrev_b32 v7, 4, v0
    v_mov_b32 v12, 0
    v_mov_b32 v13, 0
    v_mov_b32 v14, 0
    v_mov_b32 v15, 0
    s_cmp_ge_u32 s6, 64
    s_cbranch_scc1 Li_rest
    s_load_dwordx2 s[20:21], s[0:1], 0
    s_mov_b32 s22, 2359296
    s_mov_b32 s23, 0x00020000
    s_waitcnt lgkmcnt(0)
    s_and_b32 s21, s21, 0xffff
    v_and_b32 v1, 31, v0
    v_lshrrev_b32 v2, 5, v0
    v_mul_u32_u24 v3, 1152, v1
    v_mul_u32_u24 v5, 144, v2
    v_add_u32 v3, v3, v5
    s_mul_i32 s41, s6, 36864
    buffer_load_dwordx4 v[64:67], v3, s[20:23], s41 offen offset:0
    buffer_load_dwordx4 v[68:71], v3, s[20:23], s41 offen offset:16
    buffer_load_dwordx4 v[72:75], v3, s[20:23], s41 offen offset:32
    buffer_load_dwordx4 v[76:79], v3, s[20:23], s41 offen offset:48
    buffer_load_dwordx4 v[80:83], v3, s[20:23], s41 offen offset:64
    buffer_load_dwordx4 v[84:87], v3, s[20:23], s41 offen offset:80
    buffer_load_dwordx4 v[88:91], v3, s[20:23], s41 offen offset:96
    buffer_load_dwordx4 v[92:95], v3, s[20:23], s41 offen offset:112
    buffer_load_dwordx4 v[96:99], v3, s[20:23], s41 offen offset:128
    v_mul_u32_u24 v4, 4608, v2
    v_lshl_add_u32 v4, v1, 4, v4
    s_mul_i32 s41, s6, 36864
    s_add_u32 s41, s41, 6291456
    s_mul_i32 s42, s6, 6144
    s_add_u32 s42, s42, 15728640
    s_add_u32 s43, s42, 2048
    s_add_u32 s44, s42, 396288
    v_mov_b32 v60, 0
    v_mov_b32 v61, 0
    s_waitcnt vmcnt(8)
    buffer_store_dwordx4 v[64:67], v4, s[8:11], s41 offen offset:0 sc1
    s_waitcnt vmcnt(8)
    buffer_store_dwordx4 v[68:71], v4, s[8:11], s41 offen offset:512 sc1
    s_waitcnt vmcnt(8)
    buffer_store_dwordx4 v[72:75], v4, s[8:11], s41 offen offset:1024 sc1
    s_waitcnt vmcnt(8)
    buffer_store_dwordx4 v[76:79], v4, s[8:11], s41 offen offset:1536 sc1
    s_waitcnt vmcnt(8)
    buffer_store_dwordx4 v[80:83], v4, s[8:11], s41 offen offset:2048 sc1
    s_waitcnt vmcnt(8)
    buffer_store_dwordx4 v[84:87], v4, s[8:11], s41 offen offset:2560 sc1
    s_waitcnt vmcnt(8)
    buffer_store_dwordx4 v[88:91], v4, s[8:11], s41 offen offset:3072 sc1
    s_waitcnt vmcnt(8)
    buffer_store_dwordx4 v[92:95], v4, s[8:11], s41 offen offset:3584 sc1
    v_add_u32 v4, 4096, v4
    s_waitcnt vmcnt(8)
    buffer_store_dwordx4 v[96:99], v4, s[8:11], s41 offen offset:0 sc1
    buffer_store_dwordx4 v[12:15], v7, s[8:11], s43 offen sc1
    v_cmp_gt_u32 vcc, 192, v0
    s_nop 0
    s_and_saveexec_b64 s[46:47], vcc
    s_cbranch_execz Li_z1
    buffer_store_dwordx4 v[12:15], v7, s[8:11], s44 offen sc1
Li_z1:
    s_mov_b64 exec, s[46:47]
    v_mov_b32 v62, 0x3f803f80
    v_dot2c_f32_bf16 v60, v64, v62
    v_dot2c_f32_bf16 v61, v64, v64
    v_dot2c_f32_bf16 v60, v65, v62
    v_dot2c_f32_bf16 v61, v65, v65
    v_dot2c_f32_bf16 v60, v66, v62
    v_dot2c_f32_bf16 v61, v66, v66
    v_dot2c_f32_bf16 v60, v67, v62
    v_dot2c_f32_bf16 v61, v67, v67
    v_dot2c_f32_bf16 v60, v68, v62
    v_dot2c_f32_bf16 v61, v68, v68
    v_dot2c_f32_bf16 v60, v69, v62
    v_dot2c_f32_bf16 v61, v69, v69
    v_dot2c_f32_bf16 v60, v70, v62
    v_dot2c_f32_bf16 v61, v70, v70
    v_dot2c_f32_bf16 v60, v71, v62
    v_dot2c_f32_bf16 v61, v71, v71
    v_dot2c_f32_bf16 v60, v72, v62
    v_dot2c_f32_bf16 v61, v72, v72
    v_dot2c_f32_bf16 v60, v73, v62
    v_dot2c_f32_bf16 v61, v73, v73
    v_dot2c_f32_bf16 v60, v74, v62
    v_dot2c_f32_bf16 v61, v74, v74
    v_dot2c_f32_bf16 v60, v75, v62
    v_dot2c_f32_bf16 v61, v75, v75
    v_dot2c_f32_bf16 v60, v76, v62
    v_dot2c_f32_bf16 v61, v76, v76
    v_dot2c_f32_bf16 v60, v77, v62
    v_dot2c_f32_bf16 v61, v77, v77
    v_dot2c_f32_bf16 v60, v78, v62
    v_dot2c_f32_bf16 v61, v78, v78
    v_dot2c_f32_bf16 v60, v79, v62
    v_dot2c_f32_bf16 v61, v79, v79
    v_dot2c_f32_bf16 v60, v80, v62
    v_dot2c_f32_bf16 v61, v80, v80
    v_dot2c_f32_bf16 v60, v81, v62
    v_dot2c_f32_bf16 v61, v81, v81
    v_dot2c_f32_bf16 v60, v82, v62
    v_dot2c_f32_bf16 v61, v82, v82
    v_dot2c_f32_bf16 v60, v83, v62
    v_dot2c_f32_bf16 v61, v83, v83
    v_dot2c_f32_bf16 v60, v84, v62
    v_dot2c_f32_bf16 v61, v84, v84
    v_dot2c_f32_bf16 v60, v85, v62
    v_dot2c_f32_bf16 v61, v85, v85
    v_dot2c_f32_bf16 v60, v86, v62
    v_dot2c_f32_bf16 v61, v86, v86
    v_dot2c_f32_bf16 v60, v87, v62
    v_dot2c_f32_bf16 v61, v87, v87
    v_dot2c_f32_bf16 v60, v88, v62
    v_dot2c_f32_bf16 v61, v88, v88
    v_dot2c_f32_bf16 v60, v89, v62
    v_dot2c_f32_bf16 v61, v89, v89
    v_dot2c_f32_bf16 v60, v90, v62
    v_dot2c_f32_bf16 v61, v90, v90
    v_dot2c_f32_bf16 v60, v91, v62
    v_dot2c_f32_bf16 v61, v91, v91
    v_dot2c_f32_bf16 v60, v92, v62
    v_dot2c_f32_bf16 v61, v92, v92
    v_dot2c_f32_bf16 v60, v93, v62
    v_dot2c_f32_bf16 v61, v93, v93
    v_dot2c_f32_bf16 v60, v94, v62
    v_dot2c_f32_bf16 v61, v94, v94
    v_dot2c_f32_bf16 v60, v95, v62
    v_dot2c_f32_bf16 v61, v95, v95
    v_dot2c_f32_bf16 v60, v96, v62
    v_dot2c_f32_bf16 v61, v96, v96
    v_dot2c_f32_bf16 v60, v97, v62
    v_dot2c_f32_bf16 v61, v97, v97
    v_dot2c_f32_bf16 v60, v98, v62
    v_dot2c_f32_bf16 v61, v98, v98
    v_dot2c_f32_bf16 v60, v99, v62
    v_dot2c_f32_bf16 v61, v99, v99
    s_nop 3
    v_lshrrev_b32 v5, 1, v2
    v_lshlrev_b32 v5, 9, v5
    v_lshl_add_u32 v5, v1, 4, v5
    v_and_b32 v6, 1, v2
    v_lshl_add_u32 v5, v6, 3, v5
    buffer_store_dwordx2 v[60:61], v5, s[8:11], s42 offen sc1
    s_branch Li_flags
Li_rest:
    s_cmp_ge_u32 s6, 128
    s_cbranch_scc1 Li_pre
    s_sub_u32 s41, s6, 64
    s_mul_i32 s41, s41, 6144
    s_add_u32 s41, s41, 16911360
    v_cmp_gt_u32 vcc, 192, v0
    s_nop 0
    s_and_saveexec_b64 s[42:43], vcc
    s_cbranch_execz Li_rest2
    buffer_store_dwordx4 v[12:15], v7, s[8:11], s41 offen sc1
Li_rest2:
    s_mov_b64 exec, s[42:43]
    s_load_dwordx2 s[20:21], s[0:1], 80
    s_mov_b32 s22, 2359296
    s_mov_b32 s23, 0x00020000
    s_waitcnt lgkmcnt(0)
    s_and_b32 s21, s21, 0xffff
    s_sub_u32 s44, s6, 64
    s_mul_i32 s45, s44, 36864
    s_add_u32 s46, s45, 19660800
    buffer_store_dwordx4 v[12:15], v7, s[8:11], s46 offen sc1
    buffer_store_dwordx4 v[12:15], v7, s[20:23], s45 offen sc1
    s_add_u32 s46, s46, 4096
    s_add_u32 s45, s45, 4096
    buffer_store_dwordx4 v[12:15], v7, s[8:11], s46 offen sc1
    buffer_store_dwordx4 v[12:15], v7, s[20:23], s45 offen sc1
    s_add_u32 s46, s46, 4096
    s_add_u32 s45, s45, 4096
    buffer_store_dwordx4 v[12:15], v7, s[8:11], s46 offen sc1
    buffer_store_dwordx4 v[12:15], v7, s[20:23], s45 offen sc1
    s_add_u32 s46, s46, 4096
    s_add_u32 s45, s45, 4096
    buffer_store_dwordx4 v[12:15], v7, s[8:11], s46 offen sc1
    buffer_store_dwordx4 v[12:15], v7, s[20:23], s45 offen sc1
    s_add_u32 s46, s46, 4096
    s_add_u32 s45, s45, 4096
    buffer_store_dwordx4 v[12:15], v7, s[8:11], s46 offen sc1
    buffer_store_dwordx4 v[12:15], v7, s[20:23], s45 offen sc1
    s_add_u32 s46, s46, 4096
    s_add_u32 s45, s45, 4096
    buffer_store_dwordx4 v[12:15], v7, s[8:11], s46 offen sc1
    buffer_store_dwordx4 v[12:15], v7, s[20:23], s45 offen sc1
    s_add_u32 s46, s46, 4096
    s_add_u32 s45, s45, 4096
    buffer_store_dwordx4 v[12:15], v7, s[8:11], s46 offen sc1
    buffer_store_dwordx4 v[12:15], v7, s[20:23], s45 offen sc1
    s_add_u32 s46, s46, 4096
    s_add_u32 s45, s45, 4096
    buffer_store_dwordx4 v[12:15], v7, s[8:11], s46 offen sc1
    buffer_store_dwordx4 v[12:15], v7, s[20:23], s45 offen sc1
    s_add_u32 s46, s46, 4096
    s_add_u32 s45, s45, 4096
    buffer_store_dwordx4 v[12:15], v7, s[8:11], s46 offen sc1
    buffer_store_dwordx4 v[12:15], v7, s[20:23], s45 offen sc1
    s_mul_i32 s45, s44, 6144
    s_add_u32 s45, s45, 16515072
    buffer_store_dwordx4 v[12:15], v7, s[8:11], s45 offen sc1
    s_add_u32 s46, s45, 4096
    s_add_u32 s45, s45, 393216
    buffer_store_dwordx4 v[12:15], v7, s[8:11], s45 offen sc1
    v_cmp_gt_u32 vcc, 128, v0
    s_nop 0
    s_and_saveexec_b64 s[42:43], vcc
    s_cbranch_execz Li_rest3
    buffer_store_dwordx4 v[12:15], v7, s[8:11], s46 offen sc1
Li_rest3:
    s_mov_b64 exec, s[42:43]
    s_branch Li_flags
Li_pre:
    s_sub_u32 s44, s6, 128
    s_mul_i32 s45, s44, 36864
    s_add_u32 s45, s45, 17301504
    buffer_store_dwordx4 v[12:15], v7, s[8:11], s45 offen sc1
    s_add_u32 s45, s45, 4096
    buffer_store_dwordx4 v[12:15], v7, s[8:11], s45 offen sc1
    s_add_u32 s45, s45, 4096
    buffer_store_dwordx4 v[12:15], v7, s[8:11], s45 offen sc1
    s_add_u32 s45, s45, 4096
    buffer_store_dwordx4 v[12:15], v7, s[8:11], s45 offen sc1
    s_add_u32 s45, s45, 4096
    buffer_store_dwordx4 v[12:15], v7, s[8:11], s45 offen sc1
    s_add_u32 s45, s45, 4096
    buffer_store_dwordx4 v[12:15], v7, s[8:11], s45 offen sc1
    s_add_u32 s45, s45, 4096
    buffer_store_dwordx4 v[12:15], v7, s[8:11], s45 offen sc1
    s_add_u32 s45, s45, 4096
    buffer_store_dwordx4 v[12:15], v7, s[8:11], s45 offen sc1
    s_add_u32 s45, s45, 4096
    buffer_store_dwordx4 v[12:15], v7, s[8:11], s45 offen sc1
    s_mul_i32 s45, s44, 6144
    s_add_u32 s45, s45, 16121856
    v_cmp_gt_u32 vcc, 192, v0
    s_nop 0
    s_and_saveexec_b64 s[46:47], vcc
    s_cbranch_execz Li_z0
    buffer_store_dwordx4 v[12:15], v7, s[8:11], s45 offen sc1
Li_z0:
    s_mov_b64 exec, s[46:47]
    s_cmp_ge_u32 s6, 136
    s_cbranch_scc1 Li_nofl
Li_flags:
    v_cmp_gt_u32 vcc, 96, v0
    s_cmp_lt_u32 s6, 64
    s_cselect_b64 s[42:43], -1, 0
    s_and_b64 vcc, vcc, s[42:43]
    s_cmp_lt_u32 s6, 128
    s_cselect_b32 s44, 0, 0
    v_mov_b32 v12, s44
    v_mov_b32 v13, s44
    v_mov_b32 v14, s44
    v_mov_b32 v15, s44
    v_mov_b32 v9, 1
    v_cndmask_b32 v8, v12, v9, vcc
    v_mov_b32 v9, v8
    v_mov_b32 v10, v8
    v_mov_b32 v11, v8
    s_mul_i32 s41, s6, 22528
    s_sub_u32 s42, s6, 128
    s_lshl_b32 s42, s42, 12
    s_add_u32 s42, s42, 2883584
    s_cmp_ge_u32 s6, 128
    s_cselect_b32 s41, s42, s41
    buffer_store_dwordx4 v[8:11], v7, s[8:11], s41 offen sc1
    s_cbranch_scc1 Li_nofl
    s_add_u32 s41, s41, 4096
    buffer_store_dwordx4 v[12:15], v7, s[8:11], s41 offen sc1
    s_add_u32 s41, s41, 4096
    buffer_store_dwordx4 v[12:15], v7, s[8:11], s41 offen sc1
    s_add_u32 s41, s41, 4096
    buffer_store_dwordx4 v[12:15], v7, s[8:11], s41 offen sc1
    s_add_u32 s41, s41, 4096
    buffer_store_dwordx4 v[12:15], v7, s[8:11], s41 offen sc1
    s_add_u32 s41, s41, 4096
    v_cmp_gt_u32 vcc, 128, v0
    s_nop 0
    s_and_saveexec_b64 s[42:43], vcc
    s_cbranch_execz Li_fl5
    buffer_store_dwordx4 v[12:15], v7, s[8:11], s41 offen sc1
Li_fl5:
    s_mov_b64 exec, s[42:43]
Li_nofl:
    s_waitcnt vmcnt(0)
    s_barrier
    s_cmp_lg_u32 s14, 0
    s_cbranch_scc1 Li_cnt
    s_sub_u32 s41, s6, 64
    s_cmp_lt_u32 s41, 64
    s_cbranch_scc1 Li_l1
    v_mov_b32 v2, 40
    v_mov_b32 v3, 1
    s_mov_b64 exec, 1
    global_atomic_add v2, v3, s[12:13]
    s_mov_b64 exec, -1
    s_branch Li_cnt
Li_l1:
    v_mov_b32 v2, 160
    v_mov_b32 v3, 1
    s_mov_b64 exec, 1
    global_atomic_add v2, v3, s[12:13]
    s_mov_b64 exec, -1
Li_cnt:
    s_cmp_lt_u32 s6, 128
    s_cbranch_scc1 Li_end
    s_sub_u32 s6, s6, 64
    s_branch Li_body
Li_end:
    s_cmp_lg_u32 s3, 2
    s_cbranch_scc1 L_cls2_no
    s_add_u32 s15, s4, 0
    s_cmp_lt_u32 s4, 24
    s_cbranch_scc1 L_role_tw
    s_add_u32 s15, s4, 4294967272
    s_cmp_lt_u32 s4, 32
    s_cbranch_scc1 L_role_p
    s_endpgm
L_cls2_no:
    s_cmp_lg_u32 s3, 3
    s_cbranch_scc1 L_cls3_no
    s_add_u32 s15, s4, 24
    s_cmp_lt_u32 s4, 12
    s_cbranch_scc1 L_role_tw
    s_add_u32 s15, s4, 4294967292
    s_cmp_lt_u32 s4, 32
    s_cbranch_scc1 L_role_p
    s_endpgm
L_cls3_no:
    s_cmp_lg_u32 s3, 4
    s_cbranch_scc1 L_cls4_no
    s_add_u32 s15, s4, 0
    s_cmp_lt_u32 s4, 16
    s_cbranch_scc1 L_role_aq
    s_add_u32 s15, s4, 4294967280
    s_cmp_lt_u32 s4, 19
    s_cbranch_scc1 L_role_awo
    s_add_u32 s15, s4, 9
    s_cmp_lt_u32 s4, 32
    s_cbranch_scc1 L_role_p
    s_endpgm
L_cls4_no:
    s_cmp_lg_u32 s3, 5
    s_cbranch_scc1 L_cls5_no
    s_add_u32 s15, s4, 16
    s_cmp_lt_u32 s4, 16
    s_cbranch_scc1 L_role_aq
    s_add_u32 s15, s4, 4294967283
    s_cmp_lt_u32 s4, 19
    s_cbranch_scc1 L_role_awo
    s_add_u32 s15, s4, 22
    s_cmp_lt_u32 s4, 32
    s_cbranch_scc1 L_role_p
    s_endpgm
L_cls5_no:
    s_cmp_lg_u32 s3, 6
    s_cbranch_scc1 L_cls6_no
    s_add_u32 s15, s4, 0
    s_cmp_lt_u32 s4, 11
    s_cbranch_scc1 L_role_ta
    s_add_u32 s15, s4, 43
    s_cmp_lt_u32 s4, 32
    s_cbranch_scc1 L_role_p
    s_endpgm
L_cls6_no:
    s_cmp_lg_u32 s3, 7
    s_cbranch_scc1 L_cls7_no
    s_add_u32 s15, s4, 11
    s_cmp_lt_u32 s4, 11
    s_cbranch_scc1 L_role_ta
    s_add_u32 s15, s4, 64
    s_cmp_lt_u32 s4, 32
    s_cbranch_scc1 L_role_p
    s_endpgm
L_cls7_no:
L_exit:
    s_endpgm
L_abort:
    s_waitcnt lgkmcnt(0)
    s_mov_b64 exec, -1
    v_mov_b32 v0, 60
    s_lshl_b32 s5, s3, 8
    s_or_b32 s5, s5, s4
    s_or_b32 s5, s5, 0x10000
    v_mov_b32 v1, s5
    global_store_dword v0, v1, s[12:13]
    s_endpgm
.p2align 6
L_role_p:
    v_and_b32 v5, 63, v0
    v_lshlrev_b32 v0, 4, v5
    v_and_b32 v7, 15, v5
    v_lshrrev_b32 v8, 4, v5
    v_min_u32 v1, 11, v5
    v_lshrrev_b32 v6, 2, v1
    v_and_b32 v1, 3, v1
    v_lshlrev_b32 v1, 2, v1
    v_lshl_add_u32 v1, v6, 7, v1
    v_mov_b32 v3, 1
    v_mov_b32 v4, 0
    s_mov_b32 s44, 0x05040100
    s_mov_b32 s45, 0x07060302
    s_cmp_ge_u32 s15, 48
    s_cselect_b32 s63, 1, 0
    s_cselect_b32 s17, 48, 0
    s_sub_u32 s15, s15, s17
    s_cmp_lt_u32 s15, 32
    s_cselect_b32 s50, 1, 0
    s_sub_u32 s17, s15, 32
    s_lshl_b32 s17, s17, 1
    s_cmp_eq_u32 s50, 1
    s_cselect_b32 s51, s15, s17
    s_cselect_b32 s17, 48, 40
    s_cselect_b32 s18, 56, 40
    s_load_dwordx2 s[20:21], s[0:1], s17
    s_load_dwordx2 s[24:25], s[0:1], s18
    s_mov_b32 s22, 4718592
    s_mov_b32 s23, 0x00020000
    s_mov_b32 s26, 4718592
    s_mov_b32 s27, 0x00020000
    s_lshl_b32 s49, s51, 8
    s_mul_i32 s17, s14, 131072
    s_add_u32 s49, s49, s17
    s_cmp_eq_u32 s50, 1
    s_cselect_b32 s17, 0, 256
    s_add_u32 s52, s49, s17
    s_waitcnt lgkmcnt(0)
    s_and_b32 s21, s21, 0xffff
    s_and_b32 s25, s25, 0xffff
    s_cmp_eq_u32 s63, 0
    s_cbranch_scc1 Lp2_gate_ng
    s_cmp_lg_u32 s14, 0
    s_cbranch_scc1 Lp2_gate_d
    v_mov_b32 v5, 48
    s_mov_b32 s16, 0
Lp2_gate:
    global_load_dword v6, v5, s[12:13] sc1
    s_add_u32 s16, s16, 1
    s_cmp_gt_u32 s16, 100000
    s_cbranch_scc1 L_role_p_abort
    s_waitcnt vmcnt(0)
    v_cmp_gt_u32 vcc, 32, v6
    s_nop 0
    s_cbranch_vccz Lp2_gate_d
    s_sleep 100
    s_branch Lp2_gate
Lp2_gate_d:
    s_barrier
Lp2_gate_ng:
    v_lshrrev_b32 v5, 8, v0
    v_bfe_u32 v6, v0, 6, 2
    v_xor_b32 v6, v6, v5
    v_lshlrev_b32 v6, 6, v6
    v_and_b32 v16, 0x30, v0
    v_add_u32 v16, v16, v6
    v_lshl_add_u32 v16, v5, 13, v16
    v_lshrrev_b32 v5, 2, v7
    v_xor_b32 v6, s14, v5
    v_lshlrev_b32 v17, 6, v6
    v_lshrrev_b32 v6, 1, v8
    v_lshl_add_u32 v5, v6, 3, v5
    v_lshl_add_u32 v17, v5, 8, v17
    v_and_b32 v5, 1, v8
    v_lshl_add_u32 v17, v5, 5, v17
    v_and_b32 v5, 3, v7
    v_lshl_add_u32 v17, v5, 3, v17
    v_add_u32 v18, 65536, v17
    s_lshl_b32 s46, s14, 12
    s_add_u32 m0, s46, 0
    s_add_u32 s17, s49, 0
    buffer_load_dwordx4 v16, s[20:23], s17 offen lds
    s_add_u32 m0, m0, 1024
    s_add_u32 s17, s49, 32768
    buffer_load_dwordx4 v16, s[20:23], s17 offen lds
    s_add_u32 m0, m0, 1024
    s_add_u32 s17, s49, 65536
    buffer_load_dwordx4 v16, s[20:23], s17 offen lds
    s_add_u32 m0, m0, 1024
    s_add_u32 s17, s49, 98304
    buffer_load_dwordx4 v16, s[20:23], s17 offen lds
    s_add_u32 m0, s46, 16384
    s_add_u32 s17, s49, 524288
    buffer_load_dwordx4 v16, s[20:23], s17 offen lds
    s_add_u32 m0, m0, 1024
    s_add_u32 s17, s49, 557056
    buffer_load_dwordx4 v16, s[20:23], s17 offen lds
    s_add_u32 m0, m0, 1024
    s_add_u32 s17, s49, 589824
    buffer_load_dwordx4 v16, s[20:23], s17 offen lds
    s_add_u32 m0, m0, 1024
    s_add_u32 s17, s49, 622592
    buffer_load_dwordx4 v16, s[20:23], s17 offen lds
    s_add_u32 m0, s46, 32768
    s_add_u32 s17, s49, 1048576
    buffer_load_dwordx4 v16, s[20:23], s17 offen lds
    s_add_u32 m0, m0, 1024
    s_add_u32 s17, s49, 1081344
    buffer_load_dwordx4 v16, s[20:23], s17 offen lds
    s_add_u32 m0, m0, 1024
    s_add_u32 s17, s49, 1114112
    buffer_load_dwordx4 v16, s[20:23], s17 offen lds
    s_add_u32 m0, m0, 1024
    s_add_u32 s17, s49, 1146880
    buffer_load_dwordx4 v16, s[20:23], s17 offen lds
    s_add_u32 m0, s46, 49152
    s_add_u32 s17, s49, 1572864
    buffer_load_dwordx4 v16, s[20:23], s17 offen lds
    s_add_u32 m0, m0, 1024
    s_add_u32 s17, s49, 1605632
    buffer_load_dwordx4 v16, s[20:23], s17 offen lds
    s_add_u32 m0, m0, 1024
    s_add_u32 s17, s49, 1638400
    buffer_load_dwordx4 v16, s[20:23], s17 offen lds
    s_add_u32 m0, m0, 1024
    s_add_u32 s17, s49, 1671168
    buffer_load_dwordx4 v16, s[20:23], s17 offen lds
    s_add_u32 m0, s46, 65536
    s_add_u32 s17, s49, 2097152
    buffer_load_dwordx4 v16, s[20:23], s17 offen lds
    s_add_u32 m0, m0, 1024
    s_add_u32 s17, s49, 2129920
    buffer_load_dwordx4 v16, s[20:23], s17 offen lds
    s_add_u32 m0, m0, 1024
    s_add_u32 s17, s49, 2162688
    buffer_load_dwordx4 v16, s[20:23], s17 offen lds
    s_add_u32 m0, m0, 1024
    s_add_u32 s17, s49, 2195456
    buffer_load_dwordx4 v16, s[20:23], s17 offen lds
    s_add_u32 m0, s46, 81920
    s_add_u32 s17, s49, 2621440
    buffer_load_dwordx4 v16, s[20:23], s17 offen lds
    s_add_u32 m0, m0, 1024
    s_add_u32 s17, s49, 2654208
    buffer_load_dwordx4 v16, s[20:23], s17 offen lds
    s_add_u32 m0, m0, 1024
    s_add_u32 s17, s49, 2686976
    buffer_load_dwordx4 v16, s[20:23], s17 offen lds
    s_add_u32 m0, m0, 1024
    s_add_u32 s17, s49, 2719744
    buffer_load_dwordx4 v16, s[20:23], s17 offen lds
    s_add_u32 m0, s46, 98304
    s_add_u32 s17, s49, 3145728
    buffer_load_dwordx4 v16, s[20:23], s17 offen lds
    s_add_u32 m0, m0, 1024
    s_add_u32 s17, s49, 3178496
    buffer_load_dwordx4 v16, s[20:23], s17 offen lds
    s_add_u32 m0, m0, 1024
    s_add_u32 s17, s49, 3211264
    buffer_load_dwordx4 v16, s[20:23], s17 offen lds
    s_add_u32 m0, m0, 1024
    s_add_u32 s17, s49, 3244032
    buffer_load_dwordx4 v16, s[20:23], s17 offen lds
    s_waitcnt vmcnt(24)
    s_barrier
    s_add_u32 m0, s46, 114688
    s_add_u32 s17, s49, 3670016
    buffer_load_dwordx4 v16, s[20:23], s17 offen lds
    s_add_u32 m0, m0, 1024
    s_add_u32 s17, s49, 3702784
    buffer_load_dwordx4 v16, s[20:23], s17 offen lds
    s_add_u32 m0, m0, 1024
    s_add_u32 s17, s49, 3735552
    buffer_load_dwordx4 v16, s[20:23], s17 offen lds
    s_add_u32 m0, m0, 1024
    s_add_u32 s17, s49, 3768320
    buffer_load_dwordx4 v16, s[20:23], s17 offen lds
    ds_read_b64_tr_b16 a[0:1], v17 offset:0
    ds_read_b64_tr_b16 a[2:3], v17 offset:1024
    ds_read_b64_tr_b16 a[4:5], v17 offset:4096
    ds_read_b64_tr_b16 a[6:7], v17 offset:5120
    ds_read_b64_tr_b16 a[8:9], v17 offset:8192
    ds_read_b64_tr_b16 a[10:11], v17 offset:9216
    ds_read_b64_tr_b16 a[12:13], v17 offset:12288
    ds_read_b64_tr_b16 a[14:15], v17 offset:13312
    s_waitcnt lgkmcnt(0)
    s_waitcnt vmcnt(24)
    s_barrier
    s_add_u32 m0, s46, 0
    s_add_u32 s17, s49, 4194304
    buffer_load_dwordx4 v16, s[20:23], s17 offen lds
    s_add_u32 m0, m0, 1024
    s_add_u32 s17, s49, 4227072
    buffer_load_dwordx4 v16, s[20:23], s17 offen lds
    s_add_u32 m0, m0, 1024
    s_add_u32 s17, s49, 4259840
    buffer_load_dwordx4 v16, s[20:23], s17 offen lds
    s_add_u32 m0, m0, 1024
    s_add_u32 s17, s49, 4292608
    buffer_load_dwordx4 v16, s[20:23], s17 offen lds
    ds_read_b64_tr_b16 a[16:17], v17 offset:16384
    ds_read_b64_tr_b16 a[18:19], v17 offset:17408
    ds_read_b64_tr_b16 a[20:21], v17 offset:20480
    ds_read_b64_tr_b16 a[22:23], v17 offset:21504
    ds_read_b64_tr_b16 a[24:25], v17 offset:24576
    ds_read_b64_tr_b16 a[26:27], v17 offset:25600
    ds_read_b64_tr_b16 a[28:29], v17 offset:28672
    ds_read_b64_tr_b16 a[30:31], v17 offset:29696
    s_waitcnt lgkmcnt(0)
    s_waitcnt vmcnt(24)
    s_barrier
    s_add_u32 m0, s46, 16384
    s_add_u32 s17, s52, 0
    buffer_load_dwordx4 v16, s[24:27], s17 offen lds
    s_add_u32 m0, m0, 1024
    s_add_u32 s17, s52, 32768
    buffer_load_dwordx4 v16, s[24:27], s17 offen lds
    s_add_u32 m0, m0, 1024
    s_add_u32 s17, s52, 65536
    buffer_load_dwordx4 v16, s[24:27], s17 offen lds
    s_add_u32 m0, m0, 1024
    s_add_u32 s17, s52, 98304
    buffer_load_dwordx4 v16, s[24:27], s17 offen lds
    ds_read_b64_tr_b16 a[32:33], v17 offset:32768
    ds_read_b64_tr_b16 a[34:35], v17 offset:33792
    ds_read_b64_tr_b16 a[36:37], v17 offset:36864
    ds_read_b64_tr_b16 a[38:39], v17 offset:37888
    ds_read_b64_tr_b16 a[40:41], v17 offset:40960
    ds_read_b64_tr_b16 a[42:43], v17 offset:41984
    ds_read_b64_tr_b16 a[44:45], v17 offset:45056
    ds_read_b64_tr_b16 a[46:47], v17 offset:46080
    s_waitcnt lgkmcnt(0)
    s_waitcnt vmcnt(24)
    s_barrier
    s_add_u32 m0, s46, 32768
    s_add_u32 s17, s52, 524288
    buffer_load_dwordx4 v16, s[24:27], s17 offen lds
    s_add_u32 m0, m0, 1024
    s_add_u32 s17, s52, 557056
    buffer_load_dwordx4 v16, s[24:27], s17 offen lds
    s_add_u32 m0, m0, 1024
    s_add_u32 s17, s52, 589824
    buffer_load_dwordx4 v16, s[24:27], s17 offen lds
    s_add_u32 m0, m0, 1024
    s_add_u32 s17, s52, 622592
    buffer_load_dwordx4 v16, s[24:27], s17 offen lds
    ds_read_b64_tr_b16 a[48:49], v17 offset:49152
    ds_read_b64_tr_b16 a[50:51], v17 offset:50176
    ds_read_b64_tr_b16 a[52:53], v17 offset:53248
    ds_read_b64_tr_b16 a[54:55], v17 offset:54272
    ds_read_b64_tr_b16 a[56:57], v17 offset:57344
    ds_read_b64_tr_b16 a[58:59], v17 offset:58368
    ds_read_b64_tr_b16 a[60:61], v17 offset:61440
    ds_read_b64_tr_b16 a[62:63], v17 offset:62464
    s_waitcnt lgkmcnt(0)
    s_waitcnt vmcnt(24)
    s_barrier
    s_add_u32 m0, s46, 49152
    s_add_u32 s17, s52, 1048576
    buffer_load_dwordx4 v16, s[24:27], s17 offen lds
    s_add_u32 m0, m0, 1024
    s_add_u32 s17, s52, 1081344
    buffer_load_dwordx4 v16, s[24:27], s17 offen lds
    s_add_u32 m0, m0, 1024
    s_add_u32 s17, s52, 1114112
    buffer_load_dwordx4 v16, s[24:27], s17 offen lds
    s_add_u32 m0, m0, 1024
    s_add_u32 s17, s52, 1146880
    buffer_load_dwordx4 v16, s[24:27], s17 offen lds
    ds_read_b64_tr_b16 a[64:65], v18 offset:0
    ds_read_b64_tr_b16 a[66:67], v18 offset:1024
    ds_read_b64_tr_b16 a[68:69], v18 offset:4096
    ds_read_b64_tr_b16 a[70:71], v18 offset:5120
    ds_read_b64_tr_b16 a[72:73], v18 offset:8192
    ds_read_b64_tr_b16 a[74:75], v18 offset:9216
    ds_read_b64_tr_b16 a[76:77], v18 offset:12288
    ds_read_b64_tr_b16 a[78:79], v18 offset:13312
    s_waitcnt lgkmcnt(0)
    s_waitcnt vmcnt(24)
    s_barrier
    s_add_u32 m0, s46, 65536
    s_add_u32 s17, s52, 1572864
    buffer_load_dwordx4 v16, s[24:27], s17 offen lds
    s_add_u32 m0, m0, 1024
    s_add_u32 s17, s52, 1605632
    buffer_load_dwordx4 v16, s[24:27], s17 offen lds
    s_add_u32 m0, m0, 1024
    s_add_u32 s17, s52, 1638400
    buffer_load_dwordx4 v16, s[24:27], s17 offen lds
    s_add_u32 m0, m0, 1024
    s_add_u32 s17, s52, 1671168
    buffer_load_dwordx4 v16, s[24:27], s17 offen lds
    ds_read_b64_tr_b16 a[80:81], v18 offset:16384
    ds_read_b64_tr_b16 a[82:83], v18 offset:17408
    ds_read_b64_tr_b16 a[84:85], v18 offset:20480
    ds_read_b64_tr_b16 a[86:87], v18 offset:21504
    ds_read_b64_tr_b16 a[88:89], v18 offset:24576
    ds_read_b64_tr_b16 a[90:91], v18 offset:25600
    ds_read_b64_tr_b16 a[92:93], v18 offset:28672
    ds_read_b64_tr_b16 a[94:95], v18 offset:29696
    s_waitcnt lgkmcnt(0)
    s_waitcnt vmcnt(24)
    s_barrier
    s_add_u32 m0, s46, 81920
    s_add_u32 s17, s52, 2097152
    buffer_load_dwordx4 v16, s[24:27], s17 offen lds
    s_add_u32 m0, m0, 1024
    s_add_u32 s17, s52, 2129920
    buffer_load_dwordx4 v16, s[24:27], s17 offen lds
    s_add_u32 m0, m0, 1024
    s_add_u32 s17, s52, 2162688
    buffer_load_dwordx4 v16, s[24:27], s17 offen lds
    s_add_u32 m0, m0, 1024
    s_add_u32 s17, s52, 2195456
    buffer_load_dwordx4 v16, s[24:27], s17 offen lds
    ds_read_b64_tr_b16 a[96:97], v18 offset:32768
    ds_read_b64_tr_b16 a[98:99], v18 offset:33792
    ds_read_b64_tr_b16 a[100:101], v18 offset:36864
    ds_read_b64_tr_b16 a[102:103], v18 offset:37888
    ds_read_b64_tr_b16 a[104:105], v18 offset:40960
    ds_read_b64_tr_b16 a[106:107], v18 offset:41984
    ds_read_b64_tr_b16 a[108:109], v18 offset:45056
    ds_read_b64_tr_b16 a[110:111], v18 offset:46080
    s_waitcnt lgkmcnt(0)
    s_waitcnt vmcnt(24)
    s_barrier
    s_add_u32 m0, s46, 98304
    s_add_u32 s17, s52, 2621440
    buffer_load_dwordx4 v16, s[24:27], s17 offen lds
    s_add_u32 m0, m0, 1024
    s_add_u32 s17, s52, 2654208
    buffer_load_dwordx4 v16, s[24:27], s17 offen lds
    s_add_u32 m0, m0, 1024
    s_add_u32 s17, s52, 2686976
    buffer_load_dwordx4 v16, s[24:27], s17 offen lds
    s_add_u32 m0, m0, 1024
    s_add_u32 s17, s52, 2719744
    buffer_load_dwordx4 v16, s[24:27], s17 offen lds
    ds_read_b64_tr_b16 a[112:113], v18 offset:49152
    ds_read_b64_tr_b16 a[114:115], v18 offset:50176
    ds_read_b64_tr_b16 a[116:117], v18 offset:53248
    ds_read_b64_tr_b16 a[118:119], v18 offset:54272
    ds_read_b64_tr_b16 a[120:121], v18 offset:57344
    ds_read_b64_tr_b16 a[122:123], v18 offset:58368
    ds_read_b64_tr_b16 a[124:125], v18 offset:61440
    ds_read_b64_tr_b16 a[126:127], v18 offset:62464
    s_waitcnt lgkmcnt(0)
    s_waitcnt vmcnt(24)
    s_barrier
    s_add_u32 m0, s46, 114688
    s_add_u32 s17, s52, 3145728
    buffer_load_dwordx4 v16, s[24:27], s17 offen lds
    s_add_u32 m0, m0, 1024
    s_add_u32 s17, s52, 3178496
    buffer_load_dwordx4 v16, s[24:27], s17 offen lds
    s_add_u32 m0, m0, 1024
    s_add_u32 s17, s52, 3211264
    buffer_load_dwordx4 v16, s[24:27], s17 offen lds
    s_add_u32 m0, m0, 1024
    s_add_u32 s17, s52, 3244032
    buffer_load_dwordx4 v16, s[24:27], s17 offen lds
    ds_read_b64_tr_b16 a[128:129], v17 offset:0
    ds_read_b64_tr_b16 a[130:131], v17 offset:1024
    ds_read_b64_tr_b16 a[132:133], v17 offset:4096
    ds_read_b64_tr_b16 a[134:135], v17 offset:5120
    ds_read_b64_tr_b16 a[136:137], v17 offset:8192
    ds_read_b64_tr_b16 a[138:139], v17 offset:9216
    ds_read_b64_tr_b16 a[140:141], v17 offset:12288
    ds_read_b64_tr_b16 a[142:143], v17 offset:13312
    s_waitcnt lgkmcnt(0)
    s_waitcnt vmcnt(24)
    s_barrier
    s_add_u32 m0, s46, 0
    s_add_u32 s17, s52, 3670016
    buffer_load_dwordx4 v16, s[24:27], s17 offen lds
    s_add_u32 m0, m0, 1024
    s_add_u32 s17, s52, 3702784
    buffer_load_dwordx4 v16, s[24:27], s17 offen lds
    s_add_u32 m0, m0, 1024
    s_add_u32 s17, s52, 3735552
    buffer_load_dwordx4 v16, s[24:27], s17 offen lds
    s_add_u32 m0, m0, 1024
    s_add_u32 s17, s52, 3768320
    buffer_load_dwordx4 v16, s[24:27], s17 offen lds
    ds_read_b64_tr_b16 a[144:145], v17 offset:16384
    ds_read_b64_tr_b16 a[146:147], v17 offset:17408
    ds_read_b64_tr_b16 a[148:149], v17 offset:20480
    ds_read_b64_tr_b16 a[150:151], v17 offset:21504
    ds_read_b64_tr_b16 a[152:153], v17 offset:24576
    ds_read_b64_tr_b16 a[154:155], v17 offset:25600
    ds_read_b64_tr_b16 a[156:157], v17 offset:28672
    ds_read_b64_tr_b16 a[158:159], v17 offset:29696
    s_waitcnt lgkmcnt(0)
    s_waitcnt vmcnt(24)
    s_barrier
    s_add_u32 m0, s46, 16384
    s_add_u32 s17, s52, 4194304
    buffer_load_dwordx4 v16, s[24:27], s17 offen lds
    s_add_u32 m0, m0, 1024
    s_add_u32 s17, s52, 4227072
    buffer_load_dwordx4 v16, s[24:27], s17 offen lds
    s_add_u32 m0, m0, 1024
    s_add_u32 s17, s52, 4259840
    buffer_load_dwordx4 v16, s[24:27], s17 offen lds
    s_add_u32 m0, m0, 1024
    s_add_u32 s17, s52, 4292608
    buffer_load_dwordx4 v16, s[24:27], s17 offen lds
    ds_read_b64_tr_b16 a[160:161], v17 offset:32768
    ds_read_b64_tr_b16 a[162:163], v17 offset:33792
    ds_read_b64_tr_b16 a[164:165], v17 offset:36864
    ds_read_b64_tr_b16 a[166:167], v17 offset:37888
    ds_read_b64_tr_b16 a[168:169], v17 offset:40960
    ds_read_b64_tr_b16 a[170:171], v17 offset:41984
    ds_read_b64_tr_b16 a[172:173], v17 offset:45056
    ds_read_b64_tr_b16 a[174:175], v17 offset:46080
    s_waitcnt lgkmcnt(0)
    s_waitcnt vmcnt(24)
    s_barrier
    ds_read_b64_tr_b16 a[176:177], v17 offset:49152
    ds_read_b64_tr_b16 a[178:179], v17 offset:50176
    ds_read_b64_tr_b16 a[180:181], v17 offset:53248
    ds_read_b64_tr_b16 a[182:183], v17 offset:54272
    ds_read_b64_tr_b16 a[184:185], v17 offset:57344
    ds_read_b64_tr_b16 a[186:187], v17 offset:58368
    ds_read_b64_tr_b16 a[188:189], v17 offset:61440
    ds_read_b64_tr_b16 a[190:191], v17 offset:62464
    s_waitcnt lgkmcnt(0)
    s_waitcnt vmcnt(20)
    s_barrier
    ds_read_b64_tr_b16 a[192:193], v18 offset:0
    ds_read_b64_tr_b16 a[194:195], v18 offset:1024
    ds_read_b64_tr_b16 a[196:197], v18 offset:4096
    ds_read_b64_tr_b16 a[198:199], v18 offset:5120
    ds_read_b64_tr_b16 a[200:201], v18 offset:8192
    ds_read_b64_tr_b16 a[202:203], v18 offset:9216
    ds_read_b64_tr_b16 a[204:205], v18 offset:12288
    ds_read_b64_tr_b16 a[206:207], v18 offset:13312
    s_waitcnt lgkmcnt(0)
    s_waitcnt vmcnt(16)
    s_barrier
    ds_read_b64_tr_b16 a[208:209], v18 offset:16384
    ds_read_b64_tr_b16 a[210:211], v18 offset:17408
    ds_read_b64_tr_b16 a[212:213], v18 offset:20480
    ds_read_b64_tr_b16 a[214:215], v18 offset:21504
    ds_read_b64_tr_b16 a[216:217], v18 offset:24576
    ds_read_b64_tr_b16 a[218:219], v18 offset:25600
    ds_read_b64_tr_b16 a[220:221], v18 offset:28672
    ds_read_b64_tr_b16 a[222:223], v18 offset:29696
    s_waitcnt lgkmcnt(0)
    s_waitcnt vmcnt(12)
    s_barrier
    ds_read_b64_tr_b16 a[224:225], v18 offset:32768
    ds_read_b64_tr_b16 a[226:227], v18 offset:33792
    ds_read_b64_tr_b16 a[228:229], v18 offset:36864
    ds_read_b64_tr_b16 a[230:231], v18 offset:37888
    ds_read_b64_tr_b16 a[232:233], v18 offset:40960
    ds_read_b64_tr_b16 a[234:235], v18 offset:41984
    ds_read_b64_tr_b16 a[236:237], v18 offset:45056
    ds_read_b64_tr_b16 a[238:239], v18 offset:46080
    s_waitcnt lgkmcnt(0)
    s_waitcnt vmcnt(8)
    s_barrier
    ds_read_b64_tr_b16 a[240:241], v18 offset:49152
    ds_read_b64_tr_b16 a[242:243], v18 offset:50176
    ds_read_b64_tr_b16 a[244:245], v18 offset:53248
    ds_read_b64_tr_b16 a[246:247], v18 offset:54272
    ds_read_b64_tr_b16 a[248:249], v18 offset:57344
    ds_read_b64_tr_b16 a[250:251], v18 offset:58368
    ds_read_b64_tr_b16 a[252:253], v18 offset:61440
    ds_read_b64_tr_b16 a[254:255], v18 offset:62464
    s_waitcnt lgkmcnt(0)
    s_waitcnt vmcnt(4)
    s_barrier
    ds_read_b64_tr_b16 v[152:153], v17 offset:0
    ds_read_b64_tr_b16 v[154:155], v17 offset:1024
    ds_read_b64_tr_b16 v[156:157], v17 offset:4096
    ds_read_b64_tr_b16 v[158:159], v17 offset:5120
    ds_read_b64_tr_b16 v[160:161], v17 offset:8192
    ds_read_b64_tr_b16 v[162:163], v17 offset:9216
    ds_read_b64_tr_b16 v[164:165], v17 offset:12288
    ds_read_b64_tr_b16 v[166:167], v17 offset:13312
    s_waitcnt lgkmcnt(0)
    s_waitcnt vmcnt(0)
    s_barrier
    ds_read_b64_tr_b16 v[168:169], v17 offset:16384
    ds_read_b64_tr_b16 v[170:171], v17 offset:17408
    ds_read_b64_tr_b16 v[172:173], v17 offset:20480
    ds_read_b64_tr_b16 v[174:175], v17 offset:21504
    ds_read_b64_tr_b16 v[176:177], v17 offset:24576
    ds_read_b64_tr_b16 v[178:179], v17 offset:25600
    ds_read_b64_tr_b16 v[180:181], v17 offset:28672
    ds_read_b64_tr_b16 v[182:183], v17 offset:29696
    s_waitcnt lgkmcnt(0)
    s_barrier
    v_bfe_u32 v10, v0, 4, 5
    v_lshrrev_b32 v5, 9, v0
    v_lshlrev_b32 v10, 4, v10
    v_mul_u32_u24 v6, 2560, v5
    v_add_u32 v10, v10, v6
    v_add_u32 v10, 114688, v10
    s_lshl_b32 s67, s14, 10
    v_bfe_u32 v6, v0, 8, 1
    v_lshlrev_b32 v14, 10, v6
    v_lshl_add_u32 v14, v7, 4, v14
    v_lshl_add_u32 v14, v5, 8, v14
    s_lshl_b32 s17, s51, 13
    s_lshl_b32 s18, s14, 11
    s_add_u32 s52, s17, s18
    s_add_u32 s52, s52, 44040192
    s_lshl_b32 s49, s51, 9
    s_lshl_b32 s17, s14, 2
    s_add_u32 s49, s49, s17
    s_add_u32 s49, s49, 5376
    s_cmp_eq_u32 s50, 1
    s_cselect_b32 s17, 16777216, 0
    s_cselect_b32 s18, 128, 0
    s_add_u32 s52, s52, s17
    s_add_u32 s49, s49, s18
    s_cmp_eq_u32 s50, 1
    s_cselect_b32 s17, 0, 384
    s_add_u32 s17, s17, 128
    v_lshrrev_b32 v185, 4, v0
    v_mul_lo_u32 v185, v185, s17
    v_mov_b32 v48, 0x3f803f80
    v_mov_b32 v49, 0x3f803f80
    v_mov_b32 v50, 0x3f803f80
    v_mov_b32 v51, 0x3f803f80
    s_lshl_b32 s17, s14, 8
    s_add_u32 s17, s17, 110592
    v_bfe_u32 v5, v0, 4, 5
    v_lshl_add_u32 v12, v5, 2, s17
    v_lshrrev_b32 v5, 9, v0
    v_lshl_add_u32 v13, v5, 4, s17
    s_cmp_eq_u32 s50, 1
    s_cbranch_scc1 Lp2_kv
    v_mfma_f32_32x32x16_bf16 v[84:99], a[0:3], v[48:51], 0
    v_mfma_f32_32x32x16_bf16 v[116:131], a[144:147], v[48:51], 0
    v_mfma_f32_32x32x16_bf16 v[84:99], a[4:7], v[48:51], v[84:99]
    v_mfma_f32_32x32x16_bf16 v[116:131], a[148:151], v[48:51], v[116:131]
    v_mfma_f32_32x32x16_bf16 v[84:99], a[8:11], v[48:51], v[84:99]
    v_mfma_f32_32x32x16_bf16 v[116:131], a[152:155], v[48:51], v[116:131]
    v_mfma_f32_32x32x16_bf16 v[84:99], a[12:15], v[48:51], v[84:99]
    v_mfma_f32_32x32x16_bf16 v[116:131], a[156:159], v[48:51], v[116:131]
    v_mfma_f32_32x32x16_bf16 v[84:99], a[16:19], v[48:51], v[84:99]
    v_mfma_f32_32x32x16_bf16 v[116:131], a[160:163], v[48:51], v[116:131]
    v_mfma_f32_32x32x16_bf16 v[84:99], a[20:23], v[48:51], v[84:99]
    v_mfma_f32_32x32x16_bf16 v[116:131], a[164:167], v[48:51], v[116:131]
    v_mfma_f32_32x32x16_bf16 v[84:99], a[24:27], v[48:51], v[84:99]
    v_mfma_f32_32x32x16_bf16 v[116:131], a[168:171], v[48:51], v[116:131]
    v_mfma_f32_32x32x16_bf16 v[84:99], a[28:31], v[48:51], v[84:99]
    v_mfma_f32_32x32x16_bf16 v[116:131], a[172:175], v[48:51], v[116:131]
    v_mfma_f32_32x32x16_bf16 v[84:99], a[32:35], v[48:51], v[84:99]
    v_mfma_f32_32x32x16_bf16 v[116:131], a[176:179], v[48:51], v[116:131]
    v_mfma_f32_32x32x16_bf16 v[84:99], a[36:39], v[48:51], v[84:99]
    v_mfma_f32_32x32x16_bf16 v[116:131], a[180:183], v[48:51], v[116:131]
    v_mfma_f32_32x32x16_bf16 v[84:99], a[40:43], v[48:51], v[84:99]
    v_mfma_f32_32x32x16_bf16 v[116:131], a[184:187], v[48:51], v[116:131]
    v_mfma_f32_32x32x16_bf16 v[84:99], a[44:47], v[48:51], v[84:99]
    v_mfma_f32_32x32x16_bf16 v[116:131], a[188:191], v[48:51], v[116:131]
    v_mfma_f32_32x32x16_bf16 v[84:99], a[48:51], v[48:51], v[84:99]
    v_mfma_f32_32x32x16_bf16 v[116:131], a[192:195], v[48:51], v[116:131]
    v_mfma_f32_32x32x16_bf16 v[84:99], a[52:55], v[48:51], v[84:99]
    v_mfma_f32_32x32x16_bf16 v[116:131], a[196:199], v[48:51], v[116:131]
    v_mfma_f32_32x32x16_bf16 v[84:99], a[56:59], v[48:51], v[84:99]
    v_mfma_f32_32x32x16_bf16 v[116:131], a[200:203], v[48:51], v[116:131]
    v_mfma_f32_32x32x16_bf16 v[84:99], a[60:63], v[48:51], v[84:99]
    v_mfma_f32_32x32x16_bf16 v[116:131], a[204:207], v[48:51], v[116:131]
    v_mfma_f32_32x32x16_bf16 v[84:99], a[64:67], v[48:51], v[84:99]
    v_mfma_f32_32x32x16_bf16 v[116:131], a[208:211], v[48:51], v[116:131]
    v_mfma_f32_32x32x16_bf16 v[84:99], a[68:71], v[48:51], v[84:99]
    v_mfma_f32_32x32x16_bf16 v[116:131], a[212:215], v[48:51], v[116:131]
    v_mfma_f32_32x32x16_bf16 v[84:99], a[72:75], v[48:51], v[84:99]
    v_mfma_f32_32x32x16_bf16 v[116:131], a[216:219], v[48:51], v[116:131]
    v_mfma_f32_32x32x16_bf16 v[84:99], a[76:79], v[48:51], v[84:99]
    v_mfma_f32_32x32x16_bf16 v[116:131], a[220:223], v[48:51], v[116:131]
    v_mfma_f32_32x32x16_bf16 v[84:99], a[80:83], v[48:51], v[84:99]
    v_mfma_f32_32x32x16_bf16 v[116:131], a[224:227], v[48:51], v[116:131]
    v_mfma_f32_32x32x16_bf16 v[84:99], a[84:87], v[48:51], v[84:99]
    v_mfma_f32_32x32x16_bf16 v[116:131], a[228:231], v[48:51], v[116:131]
    v_mfma_f32_32x32x16_bf16 v[84:99], a[88:91], v[48:51], v[84:99]
    v_mfma_f32_32x32x16_bf16 v[116:131], a[232:235], v[48:51], v[116:131]
    v_mfma_f32_32x32x16_bf16 v[84:99], a[92:95], v[48:51], v[84:99]
    v_mfma_f32_32x32x16_bf16 v[116:131], a[236:239], v[48:51], v[116:131]
    v_mfma_f32_32x32x16_bf16 v[84:99], a[96:99], v[48:51], v[84:99]
    v_mfma_f32_32x32x16_bf16 v[116:131], a[240:243], v[48:51], v[116:131]
    v_mfma_f32_32x32x16_bf16 v[84:99], a[100:103], v[48:51], v[84:99]
    v_mfma_f32_32x32x16_bf16 v[116:131], a[244:247], v[48:51], v[116:131]
    v_mfma_f32_32x32x16_bf16 v[84:99], a[104:107], v[48:51], v[84:99]
    v_mfma_f32_32x32x16_bf16 v[116:131], a[248:251], v[48:51], v[116:131]
    v_mfma_f32_32x32x16_bf16 v[84:99], a[108:111], v[48:51], v[84:99]
    v_mfma_f32_32x32x16_bf16 v[116:131], a[252:255], v[48:51], v[116:131]
    v_mfma_f32_32x32x16_bf16 v[84:99], a[112:115], v[48:51], v[84:99]
    v_mfma_f32_32x32x16_bf16 v[116:131], v[152:155], v[48:51], v[116:131]
    v_mfma_f32_32x32x16_bf16 v[84:99], a[116:119], v[48:51], v[84:99]
    v_mfma_f32_32x32x16_bf16 v[116:131], v[156:159], v[48:51], v[116:131]
    v_mfma_f32_32x32x16_bf16 v[84:99], a[120:123], v[48:51], v[84:99]
    v_mfma_f32_32x32x16_bf16 v[116:131], v[160:163], v[48:51], v[116:131]
    v_mfma_f32_32x32x16_bf16 v[84:99], a[124:127], v[48:51], v[84:99]
    v_mfma_f32_32x32x16_bf16 v[116:131], v[164:167], v[48:51], v[116:131]
    v_mfma_f32_32x32x16_bf16 v[84:99], a[128:131], v[48:51], v[84:99]
    v_mfma_f32_32x32x16_bf16 v[116:131], v[168:171], v[48:51], v[116:131]
    v_mfma_f32_32x32x16_bf16 v[84:99], a[132:135], v[48:51], v[84:99]
    v_mfma_f32_32x32x16_bf16 v[116:131], v[172:175], v[48:51], v[116:131]
    v_mfma_f32_32x32x16_bf16 v[84:99], a[136:139], v[48:51], v[84:99]
    v_mfma_f32_32x32x16_bf16 v[116:131], v[176:179], v[48:51], v[116:131]
    v_mfma_f32_32x32x16_bf16 v[84:99], a[140:143], v[48:51], v[84:99]
    v_mfma_f32_32x32x16_bf16 v[116:131], v[180:183], v[48:51], v[116:131]
    s_mov_b32 s66, 114688
    s_mov_b32 s71, 0x2000
    s_mov_b32 s36, s63
    s_mov_b32 s34, s63
    s_mul_i32 s58, s14, 9216
    s_mul_i32 s64, s63, 4718592
    s_add_u32 s64, s64, s58
    s_add_u32 s64, s64, 8650752
    s_mul_i32 s61, s63, 1441792
    s_add_u32 s61, s61, 3584
    s_mov_b32 s37, 0
    s_mov_b32 s40, 36864
    s_mov_b32 s59, s58
    s_mov_b32 s43, 0
    s_mov_b32 s62, 1
    s_mov_b32 s28, s8
    s_mov_b32 s29, s9
    s_mov_b32 s30, 0
    s_mov_b32 s31, 0x00020000
    v_mov_b32 v184, 74752
    v_mov_b32 v5, -1
    ds_write_b32 v184, v5
    s_waitcnt lgkmcnt(0)
    s_cmp_lg_u32 s14, 0
    s_cbranch_scc1 LpQQ_inia_d
    v_mov_b32 v5, 40
    s_mov_b32 s16, 0
LpQQ_inia:
    global_load_dword v6, v5, s[12:13] sc1
    s_add_u32 s16, s16, 1
    s_cmp_gt_u32 s16, 100000
    s_cbranch_scc1 L_role_p_abort
    s_waitcnt vmcnt(0)
    v_cmp_gt_u32 vcc, 128, v6
    s_nop 0
    s_cbranch_vccz LpQQ_inia_d
    s_sleep 8
    s_branch LpQQ_inia
LpQQ_inia_d:
    s_barrier
    s_cmp_eq_u32 s63, 0
    s_cbranch_scc1 LpQQ_ini_sk
    s_cmp_lg_u32 s14, 0
    s_cbranch_scc1 LpQQ_inib_d
    v_mov_b32 v5, 160
    s_mov_b32 s16, 0
LpQQ_inib:
    global_load_dword v6, v5, s[12:13] sc1
    s_add_u32 s16, s16, 1
    s_cmp_gt_u32 s16, 100000
    s_cbranch_scc1 L_role_p_abort
    s_waitcnt vmcnt(0)
    v_cmp_gt_u32 vcc, 64, v6
    s_nop 0
    s_cbranch_vccz LpQQ_inib_d
    s_sleep 8
    s_branch LpQQ_inib
LpQQ_inib_d:
    s_barrier
LpQQ_ini_sk:
    s_mul_i32 s41, s37, 36864
    s_add_u32 s41, s41, s64
    s_mul_i32 s60, s37, 22528
    s_add_u32 s60, s60, s61
    s_cmp_lt_u32 s37, 64
    s_cselect_b32 s60, s60, 2883584
    s_branch LpQQ_wait
LpQQ_head:
    s_waitcnt vmcnt(4)
LpQQ_head2:
    s_barrier
    ds_read_b32 v15, v184
    s_xor_b32 s40, s40, 36864
    s_xor_b32 s59, s59, 36864
    s_mov_b32 s35, s37
    s_lshl_b32 s57, s34, 6
    s_add_u32 s57, s57, s35
    s_add_u32 s37, s37, 1
    s_mov_b32 s39, 0
    s_mov_b32 s54, 0
    s_xor_b32 s66, s66, 8192
    s_xor_b32 s71, s71, 8192
    s_mul_i32 s41, s37, 36864
    s_add_u32 s41, s41, s64
    s_mul_i32 s60, s37, 22528
    s_add_u32 s60, s60, s61
    s_cmp_lt_u32 s37, 64
    s_cselect_b32 s60, s60, 2883584
    v_add_u32 v9, s40, v0
    v_add_u32 v5, s71, v10
    ds_read_b128 v[48:51], v9 offset:0
    ds_read_b128 v[52:55], v9 offset:1024
    ds_read_b128 v[56:59], v9 offset:2048
    ds_read_b128 v[64:67], v5 offset:0
    ds_read_b128 v[68:71], v5 offset:512
    ds_read_b128 v[72:75], v5 offset:1024
    ds_read_b128 v[76:79], v5 offset:1536
    ds_read_b128 v[80:83], v5 offset:2048
    s_waitcnt lgkmcnt(7)
    v_mfma_f32_32x32x16_bf16 v[16:31], a[0:3], v[48:51], 0
    ds_read_b128 v[60:63], v9 offset:3072
    v_mfma_f32_32x32x16_bf16 v[32:47], a[144:147], v[48:51], 0
    s_waitcnt lgkmcnt(4)
    v_add_f32 v64, v64, v68
    v_add_f32 v65, v65, v69
    v_add_f32 v66, v66, v70
    v_add_f32 v67, v67, v71
    v_mfma_f32_32x32x16_bf16 v[16:31], a[4:7], v[52:55], v[16:31]
    ds_read_b128 v[48:51], v9 offset:4096
    s_waitcnt lgkmcnt(4)
    v_add_f32 v64, v64, v72
    v_add_f32 v65, v65, v73
    v_add_f32 v66, v66, v74
    v_mfma_f32_32x32x16_bf16 v[32:47], a[148:151], v[52:55], v[32:47]
    v_add_f32 v67, v67, v75
    s_waitcnt lgkmcnt(3)
    v_add_f32 v64, v64, v76
    v_add_f32 v65, v65, v77
    v_add_f32 v66, v66, v78
    v_readfirstlane_b32 s17, v15
    s_nop 0
    s_add_u32 s18, s17, 1
    s_max_i32 s32, s18, s37
    s_add_u32 s39, s37, 1
    s_min_u32 s39, s39, 63
    s_mul_i32 s33, s32, 22528
    s_add_u32 s33, s33, s61
    s_cmp_eq_u32 s14, 0
    s_cselect_b32 s18, s32, 0x7fff
    v_mov_b32 v2, 2
    s_cmp_le_u32 s18, s39
    s_cselect_b64 exec, -1, 0
    buffer_load_dword v2, v1, s[8:11], s33 offen sc1
    s_mov_b64 exec, -1
    s_cmp_ge_i32 s17, s37
    s_cbranch_scc1 LpQQ_f_1
    v_mfma_f32_32x32x16_bf16 v[16:31], a[8:11], v[56:59], v[16:31]
    ds_read_b128 v[52:55], v9 offset:5120
    v_add_f32 v67, v67, v79
    s_waitcnt lgkmcnt(3)
    v_add_f32 v64, v64, v80
    v_add_f32 v65, v65, v81
    v_mfma_f32_32x32x16_bf16 v[32:47], a[152:155], v[56:59], v[32:47]
    v_add_f32 v66, v66, v82
    v_add_f32 v67, v67, v83
    v_add_f32 v64, v64, v66
    v_add_f32 v65, v65, v67
    s_waitcnt lgkmcnt(2)
    v_mfma_f32_32x32x16_bf16 v[16:31], a[12:15], v[60:63], v[16:31]
    ds_read_b128 v[56:59], v9 offset:6144
    v_mov_b32 v66, v64
    v_mov_b32 v67, v65
    s_nop 0
    v_permlane32_swap_b32 v64, v66
    v_mfma_f32_32x32x16_bf16 v[32:47], a[156:159], v[60:63], v[32:47]
    v_permlane32_swap_b32 v65, v67
    v_add_f32 v64, v64, v66
    v_add_f32 v65, v65, v67
    v_mul_f32 v64, 0x3ae38e39, v64
    s_waitcnt lgkmcnt(2)
    v_mfma_f32_32x32x16_bf16 v[16:31], a[16:19], v[48:51], v[16:31]
    ds_read_b128 v[60:63], v9 offset:7168
    v_mul_f32 v65, 0x3ae38e39, v65
    v_fma_f32 v65, -v64, v64, v65
    v_max_f32 v65, 0, v65
    v_mfma_f32_32x32x16_bf16 v[32:47], a[160:163], v[48:51], v[32:47]
    v_add_f32 v65, 0x3727c5ac, v65
    v_rsq_f32 v148, v65
    s_nop 0
    v_mul_f32 v149, v64, v148
    v_mul_f32 v100, v149, v84
    s_waitcnt lgkmcnt(2)
    v_mfma_f32_32x32x16_bf16 v[16:31], a[20:23], v[52:55], v[16:31]
    ds_read_b128 v[48:51], v9 offset:8192
    v_mul_f32 v101, v149, v85
    v_mul_f32 v102, v149, v86
    v_mul_f32 v103, v149, v87
    v_mfma_f32_32x32x16_bf16 v[32:47], a[164:167], v[52:55], v[32:47]
    v_mul_f32 v104, v149, v88
    v_mul_f32 v105, v149, v89
    v_mul_f32 v106, v149, v90
    v_mul_f32 v107, v149, v91
    s_waitcnt lgkmcnt(2)
    v_mfma_f32_32x32x16_bf16 v[16:31], a[24:27], v[56:59], v[16:31]
    ds_read_b128 v[52:55], v9 offset:9216
    v_mul_f32 v108, v149, v92
    v_mul_f32 v109, v149, v93
    v_mul_f32 v110, v149, v94
    v_mfma_f32_32x32x16_bf16 v[32:47], a[168:171], v[56:59], v[32:47]
    v_mul_f32 v111, v149, v95
    v_mul_f32 v112, v149, v96
    v_mul_f32 v113, v149, v97
    v_mul_f32 v114, v149, v98
    s_waitcnt lgkmcnt(2)
    v_mfma_f32_32x32x16_bf16 v[16:31], a[28:31], v[60:63], v[16:31]
    ds_read_b128 v[56:59], v9 offset:10240
    v_mul_f32 v115, v149, v99
    v_mul_f32 v132, v149, v116
    v_mul_f32 v133, v149, v117
    v_mfma_f32_32x32x16_bf16 v[32:47], a[172:175], v[60:63], v[32:47]
    v_mul_f32 v134, v149, v118
    v_mul_f32 v135, v149, v119
    v_mul_f32 v136, v149, v120
    v_mul_f32 v137, v149, v121
    s_waitcnt lgkmcnt(2)
    v_mfma_f32_32x32x16_bf16 v[16:31], a[32:35], v[48:51], v[16:31]
    ds_read_b128 v[60:63], v9 offset:11264
    v_mul_f32 v138, v149, v122
    v_mul_f32 v139, v149, v123
    v_mul_f32 v140, v149, v124
    v_mfma_f32_32x32x16_bf16 v[32:47], a[176:179], v[48:51], v[32:47]
    v_mul_f32 v141, v149, v125
    v_mul_f32 v142, v149, v126
    v_mul_f32 v143, v149, v127
    v_mul_f32 v144, v149, v128
    s_waitcnt lgkmcnt(2)
    v_mfma_f32_32x32x16_bf16 v[16:31], a[36:39], v[52:55], v[16:31]
    ds_read_b128 v[48:51], v9 offset:12288
    v_mul_f32 v145, v149, v129
    v_mul_f32 v146, v149, v130
    v_mul_f32 v147, v149, v131
    v_mfma_f32_32x32x16_bf16 v[32:47], a[180:183], v[52:55], v[32:47]
    s_mul_i32 s46, s34, 50331648
    s_lshl_b32 s51, s35, 18
    s_add_u32 s46, s46, s51
    s_add_u32 s46, s46, s52
    s_waitcnt lgkmcnt(2)
    v_mfma_f32_32x32x16_bf16 v[16:31], a[40:43], v[56:59], v[16:31]
    ds_read_b128 v[52:55], v9 offset:13312
    v_mfma_f32_32x32x16_bf16 v[32:47], a[184:187], v[56:59], v[32:47]
    s_waitcnt lgkmcnt(2)
    v_mfma_f32_32x32x16_bf16 v[16:31], a[44:47], v[60:63], v[16:31]
    ds_read_b128 v[56:59], v9 offset:14336
    v_mfma_f32_32x32x16_bf16 v[32:47], a[188:191], v[60:63], v[32:47]
    s_waitcnt lgkmcnt(2)
    v_mfma_f32_32x32x16_bf16 v[16:31], a[48:51], v[48:51], v[16:31]
    ds_read_b128 v[60:63], v9 offset:15360
    v_mfma_f32_32x32x16_bf16 v[32:47], a[192:195], v[48:51], v[32:47]
    s_waitcnt vmcnt(1)
    s_cmp_lg_u32 s43, 0
    s_cselect_b64 exec, 3, 0
    buffer_store_dword v3, v185, s[8:11], s43 offen sc1
    s_mov_b64 exec, -1
    s_mov_b32 s43, 0
    s_waitcnt lgkmcnt(2)
    v_mfma_f32_32x32x16_bf16 v[16:31], a[52:55], v[52:55], v[16:31]
    ds_read_b128 v[48:51], v9 offset:16384
    v_mfma_f32_32x32x16_bf16 v[32:47], a[196:199], v[52:55], v[32:47]
    s_waitcnt lgkmcnt(2)
    v_mfma_f32_32x32x16_bf16 v[16:31], a[56:59], v[56:59], v[16:31]
    v_cmp_eq_u32 s[76:77], 1, v2
    v_cmp_eq_u32 vcc, 2, v2
    s_cmp_eq_u64 s[76:77], -1
    s_cselect_b32 s38, 1, 0
    ds_read_b128 v[52:55], v9 offset:17408
    v_mfma_f32_32x32x16_bf16 v[32:47], a[200:203], v[56:59], v[32:47]
    s_cmp_lg_u32 s38, 0
    s_cselect_b64 exec, 1, 0
    v_mov_b32 v15, s32
    ds_write_b32 v184, v15
    v_mov_b32 v2, 2
    s_mov_b64 exec, -1
    s_waitcnt lgkmcnt(3)
    v_mfma_f32_32x32x16_bf16 v[16:31], a[60:63], v[60:63], v[16:31]
    s_add_u32 s32, s32, s38
    s_mul_i32 s38, s38, 22528
    s_add_u32 s33, s33, s38
    ds_read_b128 v[56:59], v9 offset:18432
    v_mfma_f32_32x32x16_bf16 v[32:47], a[204:207], v[60:63], v[32:47]
    s_cmp_eq_u64 vcc, 0
    s_cselect_b32 s38, s32, 0x7fff
    s_waitcnt lgkmcnt(3)
    v_mfma_f32_32x32x16_bf16 v[16:31], a[64:67], v[48:51], v[16:31]
    ds_read_b128 v[60:63], v9 offset:19456
    v_mfma_f32_32x32x16_bf16 v[32:47], a[208:211], v[48:51], v[32:47]
    s_cmp_le_u32 s38, s39
    s_cselect_b64 exec, -1, 0
    v_mov_b32 v2, 2
    buffer_load_dword v2, v1, s[8:11], s33 offen sc1
    s_mov_b64 exec, -1
    ds_read_b32 v15, v184
    s_waitcnt lgkmcnt(4)
    v_mfma_f32_32x32x16_bf16 v[16:31], a[68:71], v[52:55], v[16:31]
    ds_read_b128 v[48:51], v9 offset:20480
    v_mfma_f32_32x32x16_bf16 v[32:47], a[212:215], v[52:55], v[32:47]
    s_waitcnt lgkmcnt(3)
    v_mfma_f32_32x32x16_bf16 v[16:31], a[72:75], v[56:59], v[16:31]
    ds_read_b128 v[52:55], v9 offset:21504
    v_mfma_f32_32x32x16_bf16 v[32:47], a[216:219], v[56:59], v[32:47]
    s_waitcnt lgkmcnt(2)
    v_readfirstlane_b32 s17, v15
    s_nop 0
    s_cmp_ge_i32 s17, s37
    s_cbranch_scc1 LpQQ_f_2
    v_mfma_f32_32x32x16_bf16 v[16:31], a[76:79], v[60:63], v[16:31]
    ds_read_b128 v[56:59], v9 offset:22528
    v_mfma_f32_32x32x16_bf16 v[32:47], a[220:223], v[60:63], v[32:47]
    s_waitcnt lgkmcnt(2)
    v_mfma_f32_32x32x16_bf16 v[16:31], a[80:83], v[48:51], v[16:31]
    ds_read_b128 v[60:63], v9 offset:23552
    v_mfma_f32_32x32x16_bf16 v[32:47], a[224:227], v[48:51], v[32:47]
    s_waitcnt lgkmcnt(2)
    v_mfma_f32_32x32x16_bf16 v[16:31], a[84:87], v[52:55], v[16:31]
    ds_read_b128 v[48:51], v9 offset:24576
    v_mfma_f32_32x32x16_bf16 v[32:47], a[228:231], v[52:55], v[32:47]
    s_waitcnt lgkmcnt(2)
    v_mfma_f32_32x32x16_bf16 v[16:31], a[88:91], v[56:59], v[16:31]
    ds_read_b128 v[52:55], v9 offset:25600
    v_mfma_f32_32x32x16_bf16 v[32:47], a[232:235], v[56:59], v[32:47]
    s_waitcnt lgkmcnt(2)
    v_mfma_f32_32x32x16_bf16 v[16:31], a[92:95], v[60:63], v[16:31]
    ds_read_b128 v[56:59], v9 offset:26624
    v_mfma_f32_32x32x16_bf16 v[32:47], a[236:239], v[60:63], v[32:47]
    s_waitcnt lgkmcnt(2)
    v_mfma_f32_32x32x16_bf16 v[16:31], a[96:99], v[48:51], v[16:31]
    ds_read_b128 v[60:63], v9 offset:27648
    v_mfma_f32_32x32x16_bf16 v[32:47], a[240:243], v[48:51], v[32:47]
    s_waitcnt lgkmcnt(2)
    v_mfma_f32_32x32x16_bf16 v[16:31], a[100:103], v[52:55], v[16:31]
    ds_read_b128 v[48:51], v9 offset:28672
    v_mfma_f32_32x32x16_bf16 v[32:47], a[244:247], v[52:55], v[32:47]
    s_waitcnt lgkmcnt(2)
    v_mfma_f32_32x32x16_bf16 v[16:31], a[104:107], v[56:59], v[16:31]
    ds_read_b128 v[52:55], v9 offset:29696
    v_mfma_f32_32x32x16_bf16 v[32:47], a[248:251], v[56:59], v[32:47]
    s_waitcnt lgkmcnt(2)
    v_mfma_f32_32x32x16_bf16 v[16:31], a[108:111], v[60:63], v[16:31]
    ds_read_b128 v[56:59], v9 offset:30720
    v_mfma_f32_32x32x16_bf16 v[32:47], a[252:255], v[60:63], v[32:47]
    s_waitcnt lgkmcnt(2)
    v_mfma_f32_32x32x16_bf16 v[16:31], a[112:115], v[48:51], v[16:31]
    ds_read_b128 v[60:63], v9 offset:31744
    v_mfma_f32_32x32x16_bf16 v[32:47], v[152:155], v[48:51], v[32:47]
    s_waitcnt lgkmcnt(2)
    v_mfma_f32_32x32x16_bf16 v[16:31], a[116:119], v[52:55], v[16:31]
    ds_read_b128 v[48:51], v9 offset:32768
    v_mfma_f32_32x32x16_bf16 v[32:47], v[156:159], v[52:55], v[32:47]
    s_waitcnt lgkmcnt(2)
    v_mfma_f32_32x32x16_bf16 v[16:31], a[120:123], v[56:59], v[16:31]
    ds_read_b128 v[52:55], v9 offset:33792
    v_mfma_f32_32x32x16_bf16 v[32:47], v[160:163], v[56:59], v[32:47]
    s_waitcnt lgkmcnt(2)
    v_mfma_f32_32x32x16_bf16 v[16:31], a[124:127], v[60:63], v[16:31]
    v_cmp_eq_u32 s[76:77], 1, v2
    v_cmp_eq_u32 vcc, 2, v2
    s_cmp_eq_u64 s[76:77], -1
    s_cselect_b32 s38, 1, 0
    ds_read_b128 v[56:59], v9 offset:34816
    v_mfma_f32_32x32x16_bf16 v[32:47], v[164:167], v[60:63], v[32:47]
    s_cmp_lg_u32 s38, 0
    s_cselect_b64 exec, 1, 0
    v_mov_b32 v15, s32
    ds_write_b32 v184, v15
    v_mov_b32 v2, 2
    s_mov_b64 exec, -1
    s_waitcnt lgkmcnt(3)
    v_mfma_f32_32x32x16_bf16 v[16:31], a[128:131], v[48:51], v[16:31]
    s_add_u32 s32, s32, s38
    s_mul_i32 s38, s38, 22528
    s_add_u32 s33, s33, s38
    ds_read_b128 v[60:63], v9 offset:35840
    s_waitcnt lgkmcnt(3)
    v_mfma_f32_32x32x16_bf16 v[16:31], a[132:135], v[52:55], v[16:31]
    s_cmp_eq_u64 vcc, 0
    s_cselect_b32 s38, s32, 0x7fff
    s_waitcnt lgkmcnt(2)
    v_mfma_f32_32x32x16_bf16 v[16:31], a[136:139], v[56:59], v[16:31]
    s_cmp_le_u32 s38, s39
    s_cselect_b64 exec, -1, 0
    v_mov_b32 v2, 2
    buffer_load_dword v2, v1, s[8:11], s33 offen sc1
    s_mov_b64 exec, -1
    s_waitcnt lgkmcnt(0)
    v_mfma_f32_32x32x16_bf16 v[16:31], a[140:143], v[60:63], v[16:31]
    v_mfma_f32_32x32x16_bf16 v[32:47], v[168:171], v[48:51], v[32:47]
    v_mfma_f32_32x32x16_bf16 v[32:47], v[172:175], v[52:55], v[32:47]
    v_fma_f32 v16, v16, v148, -v100
    v_fma_f32 v24, v24, v148, -v108
    v_fma_f32 v17, v17, v148, -v101
    v_fma_f32 v25, v25, v148, -v109
    v_fma_f32 v18, v18, v148, -v102
    v_mfma_f32_32x32x16_bf16 v[32:47], v[176:179], v[56:59], v[32:47]
    v_fma_f32 v26, v26, v148, -v110
    v_fma_f32 v19, v19, v148, -v103
    v_fma_f32 v27, v27, v148, -v111
    v_cvt_pk_bf16_f32 v188, v16, v24
    v_cvt_pk_bf16_f32 v189, v17, v25
    v_cvt_pk_bf16_f32 v190, v18, v26
    v_mfma_f32_32x32x16_bf16 v[32:47], v[180:183], v[60:63], v[32:47]
    v_cvt_pk_bf16_f32 v191, v19, v27
    buffer_store_dwordx4 v[188:191], v14, s[8:11], s46 offen offset:0 sc1
    v_fma_f32 v20, v20, v148, -v104
    v_fma_f32 v28, v28, v148, -v112
    v_fma_f32 v21, v21, v148, -v105
    v_fma_f32 v29, v29, v148, -v113
    v_fma_f32 v22, v22, v148, -v106
    v_fma_f32 v30, v30, v148, -v114
    v_fma_f32 v23, v23, v148, -v107
    v_fma_f32 v31, v31, v148, -v115
    v_cvt_pk_bf16_f32 v192, v20, v28
    v_cvt_pk_bf16_f32 v193, v21, v29
    v_cvt_pk_bf16_f32 v194, v22, v30
    v_cvt_pk_bf16_f32 v195, v23, v31
    buffer_store_dwordx4 v[192:195], v14, s[8:11], s46 offen offset:512 sc1
    s_add_u32 s51, s46, 8192
    v_pk_fma_f32 v[32:33], v[32:33], v[148:149], v[132:133] op_sel_hi:[1,0,1] neg_lo:[0,0,1] neg_hi:[0,0,1]
    v_pk_fma_f32 v[34:35], v[34:35], v[148:149], v[134:135] op_sel_hi:[1,0,1] neg_lo:[0,0,1] neg_hi:[0,0,1]
    v_pk_fma_f32 v[36:37], v[36:37], v[148:149], v[136:137] op_sel_hi:[1,0,1] neg_lo:[0,0,1] neg_hi:[0,0,1]
    v_pk_fma_f32 v[38:39], v[38:39], v[148:149], v[138:139] op_sel_hi:[1,0,1] neg_lo:[0,0,1] neg_hi:[0,0,1]
    v_pk_fma_f32 v[40:41], v[40:41], v[148:149], v[140:141] op_sel_hi:[1,0,1] neg_lo:[0,0,1] neg_hi:[0,0,1]
    v_pk_fma_f32 v[42:43], v[42:43], v[148:149], v[142:143] op_sel_hi:[1,0,1] neg_lo:[0,0,1] neg_hi:[0,0,1]
    v_pk_fma_f32 v[44:45], v[44:45], v[148:149], v[144:145] op_sel_hi:[1,0,1] neg_lo:[0,0,1] neg_hi:[0,0,1]
    v_pk_fma_f32 v[46:47], v[46:47], v[148:149], v[146:147] op_sel_hi:[1,0,1] neg_lo:[0,0,1] neg_hi:[0,0,1]
    v_cvt_pk_bf16_f32 v196, v32, v40
    v_cvt_pk_bf16_f32 v197, v33, v41
    v_cvt_pk_bf16_f32 v198, v34, v42
    v_cvt_pk_bf16_f32 v199, v35, v43
    buffer_store_dwordx4 v[196:199], v14, s[8:11], s51 offen offset:0 sc1
    v_cvt_pk_bf16_f32 v200, v36, v44
    v_cvt_pk_bf16_f32 v201, v37, v45
    v_cvt_pk_bf16_f32 v202, v38, v46
    v_cvt_pk_bf16_f32 v203, v39, v47
    buffer_store_dwordx4 v[200:203], v14, s[8:11], s51 offen offset:512 sc1
    s_mul_i32 s43, s57, 22528
    s_add_u32 s43, s43, s49
    s_branch LpQQ_none
LpQQ_f_1:
    v_mfma_f32_32x32x16_bf16 v[16:31], a[8:11], v[56:59], v[16:31]
    ds_read_b128 v[52:55], v9 offset:5120
    v_add_f32 v67, v67, v79
    s_waitcnt lgkmcnt(3)
    v_add_f32 v64, v64, v80
    v_add_f32 v65, v65, v81
    v_mfma_f32_32x32x16_bf16 v[32:47], a[152:155], v[56:59], v[32:47]
    v_add_f32 v66, v66, v82
    v_add_f32 v67, v67, v83
    v_add_f32 v64, v64, v66
    v_add_f32 v65, v65, v67
    s_waitcnt lgkmcnt(2)
    v_mfma_f32_32x32x16_bf16 v[16:31], a[12:15], v[60:63], v[16:31]
    ds_read_b128 v[56:59], v9 offset:6144
    v_mov_b32 v66, v64
    v_mov_b32 v67, v65
    s_nop 0
    v_permlane32_swap_b32 v64, v66
    v_mfma_f32_32x32x16_bf16 v[32:47], a[156:159], v[60:63], v[32:47]
    v_permlane32_swap_b32 v65, v67
    v_add_f32 v64, v64, v66
    v_add_f32 v65, v65, v67
    v_mul_f32 v64, 0x3ae38e39, v64
    s_waitcnt lgkmcnt(2)
    v_mfma_f32_32x32x16_bf16 v[16:31], a[16:19], v[48:51], v[16:31]
    ds_read_b128 v[60:63], v9 offset:7168
    v_mul_f32 v65, 0x3ae38e39, v65
    v_fma_f32 v65, -v64, v64, v65
    v_max_f32 v65, 0, v65
    v_mfma_f32_32x32x16_bf16 v[32:47], a[160:163], v[48:51], v[32:47]
    v_add_f32 v65, 0x3727c5ac, v65
    v_rsq_f32 v148, v65
    s_nop 0
    v_mul_f32 v149, v64, v148
    v_mul_f32 v100, v149, v84
    s_waitcnt lgkmcnt(2)
    v_mfma_f32_32x32x16_bf16 v[16:31], a[20:23], v[52:55], v[16:31]
    ds_read_b128 v[48:51], v9 offset:8192
    v_mul_f32 v101, v149, v85
    v_mul_f32 v102, v149, v86
    v_mul_f32 v103, v149, v87
    v_mfma_f32_32x32x16_bf16 v[32:47], a[164:167], v[52:55], v[32:47]
    v_mul_f32 v104, v149, v88
    v_mul_f32 v105, v149, v89
    v_mul_f32 v106, v149, v90
    v_mul_f32 v107, v149, v91
    s_waitcnt lgkmcnt(2)
    v_mfma_f32_32x32x16_bf16 v[16:31], a[24:27], v[56:59], v[16:31]
    ds_read_b128 v[52:55], v9 offset:9216
    v_mul_f32 v108, v149, v92
    v_mul_f32 v109, v149, v93
    v_mul_f32 v110, v149, v94
    v_mfma_f32_32x32x16_bf16 v[32:47], a[168:171], v[56:59], v[32:47]
    v_mul_f32 v111, v149, v95
    v_mul_f32 v112, v149, v96
    v_mul_f32 v113, v149, v97
    v_mul_f32 v114, v149, v98
    s_waitcnt lgkmcnt(2)
    v_mfma_f32_32x32x16_bf16 v[16:31], a[28:31], v[60:63], v[16:31]
    ds_read_b128 v[56:59], v9 offset:10240
    v_mul_f32 v115, v149, v99
    v_mul_f32 v132, v149, v116
    v_mul_f32 v133, v149, v117
    v_mfma_f32_32x32x16_bf16 v[32:47], a[172:175], v[60:63], v[32:47]
    v_mul_f32 v134, v149, v118
    v_mul_f32 v135, v149, v119
    v_mul_f32 v136, v149, v120
    v_mul_f32 v137, v149, v121
    s_waitcnt lgkmcnt(2)
    v_mfma_f32_32x32x16_bf16 v[16:31], a[32:35], v[48:51], v[16:31]
    ds_read_b128 v[60:63], v9 offset:11264
    v_mul_f32 v138, v149, v122
    v_mul_f32 v139, v149, v123
    v_mul_f32 v140, v149, v124
    v_mfma_f32_32x32x16_bf16 v[32:47], a[176:179], v[48:51], v[32:47]
    v_mul_f32 v141, v149, v125
    v_mul_f32 v142, v149, v126
    v_mul_f32 v143, v149, v127
    v_mul_f32 v144, v149, v128
    s_waitcnt lgkmcnt(2)
    v_mfma_f32_32x32x16_bf16 v[16:31], a[36:39], v[52:55], v[16:31]
    ds_read_b128 v[48:51], v9 offset:12288
    v_mul_f32 v145, v149, v129
    v_mul_f32 v146, v149, v130
    v_mul_f32 v147, v149, v131
    v_mfma_f32_32x32x16_bf16 v[32:47], a[180:183], v[52:55], v[32:47]
    s_mul_i32 s46, s34, 50331648
    s_lshl_b32 s51, s35, 18
    s_add_u32 s46, s46, s51
    s_add_u32 s46, s46, s52
    s_waitcnt lgkmcnt(2)
    v_mfma_f32_32x32x16_bf16 v[16:31], a[40:43], v[56:59], v[16:31]
    s_add_u32 m0, s59, 0
    s_add_u32 s47, s41, 0
    buffer_load_dwordx4 v0, s[8:11], s47 offen offset:0 lds
    buffer_load_dwordx4 v0, s[8:11], s47 offen offset:1024 lds
    ds_read_b128 v[52:55], v9 offset:13312
    v_mfma_f32_32x32x16_bf16 v[32:47], a[184:187], v[56:59], v[32:47]
    buffer_load_dwordx4 v0, s[8:11], s47 offen offset:2048 lds
    buffer_load_dwordx4 v0, s[8:11], s47 offen offset:3072 lds
    s_add_u32 m0, s59, 4096
    s_add_u32 s47, s41, 4096
    buffer_load_dwordx4 v0, s[8:11], s47 offen offset:0 lds
    s_waitcnt lgkmcnt(2)
    v_mfma_f32_32x32x16_bf16 v[16:31], a[44:47], v[60:63], v[16:31]
    buffer_load_dwordx4 v0, s[8:11], s47 offen offset:1024 lds
    buffer_load_dwordx4 v0, s[8:11], s47 offen offset:2048 lds
    buffer_load_dwordx4 v0, s[8:11], s47 offen offset:3072 lds
    ds_read_b128 v[56:59], v9 offset:14336
    v_mfma_f32_32x32x16_bf16 v[32:47], a[188:191], v[60:63], v[32:47]
    s_add_u32 m0, s59, 8192
    s_add_u32 s47, s41, 8192
    buffer_load_dwordx4 v0, s[8:11], s47 offen offset:0 lds
    s_waitcnt lgkmcnt(2)
    v_mfma_f32_32x32x16_bf16 v[16:31], a[48:51], v[48:51], v[16:31]
    s_mul_i32 s48, s36, 786432
    s_mul_i32 s18, s37, 6144
    s_add_u32 s48, s48, s18
    s_add_u32 s48, s48, 16125952
    s_add_u32 m0, s66, 4096
    s_nop 0
    buffer_load_dwordx4 v0, s[8:11], s48 offen lds
    ds_read_b128 v[60:63], v9 offset:15360
    v_mfma_f32_32x32x16_bf16 v[32:47], a[192:195], v[48:51], v[32:47]
    s_add_u32 m0, s66, s67
    s_sub_u32 s48, s48, 4096
    s_add_u32 s48, s48, s67
    buffer_load_dwordx4 v0, s[8:11], s48 offen lds
    s_waitcnt vmcnt(12)
    s_cmp_lg_u32 s43, 0
    s_cselect_b64 exec, 3, 0
    buffer_store_dword v3, v185, s[8:11], s43 offen sc1
    s_mov_b64 exec, -1
    s_mov_b32 s43, 0
    s_waitcnt lgkmcnt(2)
    v_mfma_f32_32x32x16_bf16 v[16:31], a[52:55], v[52:55], v[16:31]
    ds_read_b128 v[48:51], v9 offset:16384
    v_mfma_f32_32x32x16_bf16 v[32:47], a[196:199], v[52:55], v[32:47]
    s_waitcnt lgkmcnt(2)
    v_mfma_f32_32x32x16_bf16 v[16:31], a[56:59], v[56:59], v[16:31]
    v_cmp_eq_u32 s[76:77], 1, v2
    v_cmp_eq_u32 vcc, 2, v2
    s_cmp_eq_u64 s[76:77], -1
    s_cselect_b32 s38, 1, 0
    ds_read_b128 v[52:55], v9 offset:17408
    v_mfma_f32_32x32x16_bf16 v[32:47], a[200:203], v[56:59], v[32:47]
    s_cmp_lg_u32 s38, 0
    s_cselect_b64 exec, 1, 0
    v_mov_b32 v15, s32
    ds_write_b32 v184, v15
    v_mov_b32 v2, 2
    s_mov_b64 exec, -1
    s_waitcnt lgkmcnt(3)
    v_mfma_f32_32x32x16_bf16 v[16:31], a[60:63], v[60:63], v[16:31]
    s_add_u32 s32, s32, s38
    s_mul_i32 s38, s38, 22528
    s_add_u32 s33, s33, s38
    ds_read_b128 v[56:59], v9 offset:18432
    v_mfma_f32_32x32x16_bf16 v[32:47], a[204:207], v[60:63], v[32:47]
    s_cmp_eq_u64 vcc, 0
    s_cselect_b32 s38, s32, 0x7fff
    s_waitcnt lgkmcnt(3)
    v_mfma_f32_32x32x16_bf16 v[16:31], a[64:67], v[48:51], v[16:31]
    ds_read_b128 v[60:63], v9 offset:19456
    v_mfma_f32_32x32x16_bf16 v[32:47], a[208:211], v[48:51], v[32:47]
    s_cmp_le_u32 s38, s39
    s_cselect_b64 exec, -1, 0
    v_mov_b32 v2, 2
    buffer_load_dword v2, v1, s[8:11], s33 offen sc1
    s_mov_b64 exec, -1
    s_waitcnt lgkmcnt(3)
    v_mfma_f32_32x32x16_bf16 v[16:31], a[68:71], v[52:55], v[16:31]
    ds_read_b128 v[48:51], v9 offset:20480
    v_mfma_f32_32x32x16_bf16 v[32:47], a[212:215], v[52:55], v[32:47]
    s_waitcnt lgkmcnt(2)
    v_mfma_f32_32x32x16_bf16 v[16:31], a[72:75], v[56:59], v[16:31]
    ds_read_b128 v[52:55], v9 offset:21504
    v_mfma_f32_32x32x16_bf16 v[32:47], a[216:219], v[56:59], v[32:47]
    s_waitcnt lgkmcnt(2)
    v_mfma_f32_32x32x16_bf16 v[16:31], a[76:79], v[60:63], v[16:31]
    ds_read_b128 v[56:59], v9 offset:22528
    v_mfma_f32_32x32x16_bf16 v[32:47], a[220:223], v[60:63], v[32:47]
    s_waitcnt lgkmcnt(2)
    v_mfma_f32_32x32x16_bf16 v[16:31], a[80:83], v[48:51], v[16:31]
    ds_read_b128 v[60:63], v9 offset:23552
    v_mfma_f32_32x32x16_bf16 v[32:47], a[224:227], v[48:51], v[32:47]
    s_waitcnt lgkmcnt(2)
    v_mfma_f32_32x32x16_bf16 v[16:31], a[84:87], v[52:55], v[16:31]
    ds_read_b128 v[48:51], v9 offset:24576
    v_mfma_f32_32x32x16_bf16 v[32:47], a[228:231], v[52:55], v[32:47]
    s_waitcnt lgkmcnt(2)
    v_mfma_f32_32x32x16_bf16 v[16:31], a[88:91], v[56:59], v[16:31]
    ds_read_b128 v[52:55], v9 offset:25600
    v_mfma_f32_32x32x16_bf16 v[32:47], a[232:235], v[56:59], v[32:47]
    s_waitcnt lgkmcnt(2)
    v_mfma_f32_32x32x16_bf16 v[16:31], a[92:95], v[60:63], v[16:31]
    ds_read_b128 v[56:59], v9 offset:26624
    v_mfma_f32_32x32x16_bf16 v[32:47], a[236:239], v[60:63], v[32:47]
    s_waitcnt lgkmcnt(2)
    v_mfma_f32_32x32x16_bf16 v[16:31], a[96:99], v[48:51], v[16:31]
    ds_read_b128 v[60:63], v9 offset:27648
    v_mfma_f32_32x32x16_bf16 v[32:47], a[240:243], v[48:51], v[32:47]
    s_waitcnt lgkmcnt(2)
    v_mfma_f32_32x32x16_bf16 v[16:31], a[100:103], v[52:55], v[16:31]
    ds_read_b128 v[48:51], v9 offset:28672
    v_mfma_f32_32x32x16_bf16 v[32:47], a[244:247], v[52:55], v[32:47]
    s_waitcnt lgkmcnt(2)
    v_mfma_f32_32x32x16_bf16 v[16:31], a[104:107], v[56:59], v[16:31]
    ds_read_b128 v[52:55], v9 offset:29696
    v_mfma_f32_32x32x16_bf16 v[32:47], a[248:251], v[56:59], v[32:47]
    s_waitcnt lgkmcnt(2)
    v_mfma_f32_32x32x16_bf16 v[16:31], a[108:111], v[60:63], v[16:31]
    ds_read_b128 v[56:59], v9 offset:30720
    v_mfma_f32_32x32x16_bf16 v[32:47], a[252:255], v[60:63], v[32:47]
    s_waitcnt lgkmcnt(2)
    v_mfma_f32_32x32x16_bf16 v[16:31], a[112:115], v[48:51], v[16:31]
    ds_read_b128 v[60:63], v9 offset:31744
    v_mfma_f32_32x32x16_bf16 v[32:47], v[152:155], v[48:51], v[32:47]
    s_waitcnt lgkmcnt(2)
    v_mfma_f32_32x32x16_bf16 v[16:31], a[116:119], v[52:55], v[16:31]
    ds_read_b128 v[48:51], v9 offset:32768
    v_mfma_f32_32x32x16_bf16 v[32:47], v[156:159], v[52:55], v[32:47]
    s_waitcnt lgkmcnt(2)
    v_mfma_f32_32x32x16_bf16 v[16:31], a[120:123], v[56:59], v[16:31]
    ds_read_b128 v[52:55], v9 offset:33792
    v_mfma_f32_32x32x16_bf16 v[32:47], v[160:163], v[56:59], v[32:47]
    s_waitcnt lgkmcnt(2)
    v_mfma_f32_32x32x16_bf16 v[16:31], a[124:127], v[60:63], v[16:31]
    v_cmp_eq_u32 s[76:77], 1, v2
    v_cmp_eq_u32 vcc, 2, v2
    s_cmp_eq_u64 s[76:77], -1
    s_cselect_b32 s38, 1, 0
    ds_read_b128 v[56:59], v9 offset:34816
    v_mfma_f32_32x32x16_bf16 v[32:47], v[164:167], v[60:63], v[32:47]
    s_cmp_lg_u32 s38, 0
    s_cselect_b64 exec, 1, 0
    v_mov_b32 v15, s32
    ds_write_b32 v184, v15
    v_mov_b32 v2, 2
    s_mov_b64 exec, -1
    s_waitcnt lgkmcnt(3)
    v_mfma_f32_32x32x16_bf16 v[16:31], a[128:131], v[48:51], v[16:31]
    s_add_u32 s32, s32, s38
    s_mul_i32 s38, s38, 22528
    s_add_u32 s33, s33, s38
    ds_read_b128 v[60:63], v9 offset:35840
    s_waitcnt lgkmcnt(3)
    v_mfma_f32_32x32x16_bf16 v[16:31], a[132:135], v[52:55], v[16:31]
    s_cmp_eq_u64 vcc, 0
    s_cselect_b32 s38, s32, 0x7fff
    s_waitcnt lgkmcnt(2)
    v_mfma_f32_32x32x16_bf16 v[16:31], a[136:139], v[56:59], v[16:31]
    s_cmp_le_u32 s38, s39
    s_cselect_b64 exec, -1, 0
    v_mov_b32 v2, 2
    buffer_load_dword v2, v1, s[8:11], s33 offen sc1
    s_mov_b64 exec, -1
    s_waitcnt lgkmcnt(0)
    v_mfma_f32_32x32x16_bf16 v[16:31], a[140:143], v[60:63], v[16:31]
    v_mfma_f32_32x32x16_bf16 v[32:47], v[168:171], v[48:51], v[32:47]
    v_mfma_f32_32x32x16_bf16 v[32:47], v[172:175], v[52:55], v[32:47]
    v_fma_f32 v16, v16, v148, -v100
    v_fma_f32 v24, v24, v148, -v108
    v_fma_f32 v17, v17, v148, -v101
    v_fma_f32 v25, v25, v148, -v109
    v_fma_f32 v18, v18, v148, -v102
    v_mfma_f32_32x32x16_bf16 v[32:47], v[176:179], v[56:59], v[32:47]
    v_fma_f32 v26, v26, v148, -v110
    v_fma_f32 v19, v19, v148, -v103
    v_fma_f32 v27, v27, v148, -v111
    v_cvt_pk_bf16_f32 v188, v16, v24
    v_cvt_pk_bf16_f32 v189, v17, v25
    v_cvt_pk_bf16_f32 v190, v18, v26
    v_mfma_f32_32x32x16_bf16 v[32:47], v[180:183], v[60:63], v[32:47]
    v_cvt_pk_bf16_f32 v191, v19, v27
    buffer_store_dwordx4 v[188:191], v14, s[8:11], s46 offen offset:0 sc1
    v_fma_f32 v20, v20, v148, -v104
    v_fma_f32 v28, v28, v148, -v112
    v_fma_f32 v21, v21, v148, -v105
    v_fma_f32 v29, v29, v148, -v113
    v_fma_f32 v22, v22, v148, -v106
    v_fma_f32 v30, v30, v148, -v114
    v_fma_f32 v23, v23, v148, -v107
    v_fma_f32 v31, v31, v148, -v115
    v_cvt_pk_bf16_f32 v192, v20, v28
    v_cvt_pk_bf16_f32 v193, v21, v29
    v_cvt_pk_bf16_f32 v194, v22, v30
    v_cvt_pk_bf16_f32 v195, v23, v31
    buffer_store_dwordx4 v[192:195], v14, s[8:11], s46 offen offset:512 sc1
    s_add_u32 s51, s46, 8192
    v_pk_fma_f32 v[32:33], v[32:33], v[148:149], v[132:133] op_sel_hi:[1,0,1] neg_lo:[0,0,1] neg_hi:[0,0,1]
    v_pk_fma_f32 v[34:35], v[34:35], v[148:149], v[134:135] op_sel_hi:[1,0,1] neg_lo:[0,0,1] neg_hi:[0,0,1]
    v_pk_fma_f32 v[36:37], v[36:37], v[148:149], v[136:137] op_sel_hi:[1,0,1] neg_lo:[0,0,1] neg_hi:[0,0,1]
    v_pk_fma_f32 v[38:39], v[38:39], v[148:149], v[138:139] op_sel_hi:[1,0,1] neg_lo:[0,0,1] neg_hi:[0,0,1]
    v_pk_fma_f32 v[40:41], v[40:41], v[148:149], v[140:141] op_sel_hi:[1,0,1] neg_lo:[0,0,1] neg_hi:[0,0,1]
    v_pk_fma_f32 v[42:43], v[42:43], v[148:149], v[142:143] op_sel_hi:[1,0,1] neg_lo:[0,0,1] neg_hi:[0,0,1]
    v_pk_fma_f32 v[44:45], v[44:45], v[148:149], v[144:145] op_sel_hi:[1,0,1] neg_lo:[0,0,1] neg_hi:[0,0,1]
    v_pk_fma_f32 v[46:47], v[46:47], v[148:149], v[146:147] op_sel_hi:[1,0,1] neg_lo:[0,0,1] neg_hi:[0,0,1]
    v_cvt_pk_bf16_f32 v196, v32, v40
    v_cvt_pk_bf16_f32 v197, v33, v41
    v_cvt_pk_bf16_f32 v198, v34, v42
    v_cvt_pk_bf16_f32 v199, v35, v43
    buffer_store_dwordx4 v[196:199], v14, s[8:11], s51 offen offset:0 sc1
    v_cvt_pk_bf16_f32 v200, v36, v44
    v_cvt_pk_bf16_f32 v201, v37, v45
    v_cvt_pk_bf16_f32 v202, v38, v46
    v_cvt_pk_bf16_f32 v203, v39, v47
    buffer_store_dwordx4 v[200:203], v14, s[8:11], s51 offen offset:512 sc1
    s_mul_i32 s43, s57, 22528
    s_add_u32 s43, s43, s49
    s_branch LpQQ_head
LpQQ_f_2:
    v_mfma_f32_32x32x16_bf16 v[16:31], a[76:79], v[60:63], v[16:31]
    s_add_u32 m0, s59, 0
    s_add_u32 s47, s41, 0
    buffer_load_dwordx4 v0, s[8:11], s47 offen offset:0 lds
    ds_read_b128 v[56:59], v9 offset:22528
    v_mfma_f32_32x32x16_bf16 v[32:47], a[220:223], v[60:63], v[32:47]
    s_waitcnt lgkmcnt(2)
    v_mfma_f32_32x32x16_bf16 v[16:31], a[80:83], v[48:51], v[16:31]
    buffer_load_dwordx4 v0, s[8:11], s47 offen offset:1024 lds
    ds_read_b128 v[60:63], v9 offset:23552
    v_mfma_f32_32x32x16_bf16 v[32:47], a[224:227], v[48:51], v[32:47]
    s_waitcnt lgkmcnt(2)
    v_mfma_f32_32x32x16_bf16 v[16:31], a[84:87], v[52:55], v[16:31]
    buffer_load_dwordx4 v0, s[8:11], s47 offen offset:2048 lds
    ds_read_b128 v[48:51], v9 offset:24576
    v_mfma_f32_32x32x16_bf16 v[32:47], a[228:231], v[52:55], v[32:47]
    s_waitcnt lgkmcnt(2)
    v_mfma_f32_32x32x16_bf16 v[16:31], a[88:91], v[56:59], v[16:31]
    buffer_load_dwordx4 v0, s[8:11], s47 offen offset:3072 lds
    ds_read_b128 v[52:55], v9 offset:25600
    v_mfma_f32_32x32x16_bf16 v[32:47], a[232:235], v[56:59], v[32:47]
    s_waitcnt lgkmcnt(2)
    v_mfma_f32_32x32x16_bf16 v[16:31], a[92:95], v[60:63], v[16:31]
    s_add_u32 m0, s59, 4096
    s_add_u32 s47, s41, 4096
    buffer_load_dwordx4 v0, s[8:11], s47 offen offset:0 lds
    ds_read_b128 v[56:59], v9 offset:26624
    v_mfma_f32_32x32x16_bf16 v[32:47], a[236:239], v[60:63], v[32:47]
    s_waitcnt lgkmcnt(2)
    v_mfma_f32_32x32x16_bf16 v[16:31], a[96:99], v[48:51], v[16:31]
    buffer_load_dwordx4 v0, s[8:11], s47 offen offset:1024 lds
    ds_read_b128 v[60:63], v9 offset:27648
    v_mfma_f32_32x32x16_bf16 v[32:47], a[240:243], v[48:51], v[32:47]
    s_waitcnt lgkmcnt(2)
    v_mfma_f32_32x32x16_bf16 v[16:31], a[100:103], v[52:55], v[16:31]
    buffer_load_dwordx4 v0, s[8:11], s47 offen offset:2048 lds
    ds_read_b128 v[48:51], v9 offset:28672
    v_mfma_f32_32x32x16_bf16 v[32:47], a[244:247], v[52:55], v[32:47]
    s_waitcnt lgkmcnt(2)
    v_mfma_f32_32x32x16_bf16 v[16:31], a[104:107], v[56:59], v[16:31]
    buffer_load_dwordx4 v0, s[8:11], s47 offen offset:3072 lds
    ds_read_b128 v[52:55], v9 offset:29696
    v_mfma_f32_32x32x16_bf16 v[32:47], a[248:251], v[56:59], v[32:47]
    s_waitcnt lgkmcnt(2)
    v_mfma_f32_32x32x16_bf16 v[16:31], a[108:111], v[60:63], v[16:31]
    s_add_u32 m0, s59, 8192
    s_add_u32 s47, s41, 8192
    buffer_load_dwordx4 v0, s[8:11], s47 offen offset:0 lds
    ds_read_b128 v[56:59], v9 offset:30720
    v_mfma_f32_32x32x16_bf16 v[32:47], a[252:255], v[60:63], v[32:47]
    s_waitcnt lgkmcnt(2)
    v_mfma_f32_32x32x16_bf16 v[16:31], a[112:115], v[48:51], v[16:31]
    s_mul_i32 s48, s36, 786432
    s_mul_i32 s18, s37, 6144
    s_add_u32 s48, s48, s18
    s_add_u32 s48, s48, 16125952
    s_add_u32 m0, s66, 4096
    s_nop 0
    buffer_load_dwordx4 v0, s[8:11], s48 offen lds
    ds_read_b128 v[60:63], v9 offset:31744
    v_mfma_f32_32x32x16_bf16 v[32:47], v[152:155], v[48:51], v[32:47]
    s_waitcnt lgkmcnt(2)
    v_mfma_f32_32x32x16_bf16 v[16:31], a[116:119], v[52:55], v[16:31]
    s_add_u32 m0, s66, s67
    s_sub_u32 s48, s48, 4096
    s_add_u32 s48, s48, s67
    buffer_load_dwordx4 v0, s[8:11], s48 offen lds
    ds_read_b128 v[48:51], v9 offset:32768
    v_mfma_f32_32x32x16_bf16 v[32:47], v[156:159], v[52:55], v[32:47]
    s_waitcnt lgkmcnt(2)
    v_mfma_f32_32x32x16_bf16 v[16:31], a[120:123], v[56:59], v[16:31]
    ds_read_b128 v[52:55], v9 offset:33792
    v_mfma_f32_32x32x16_bf16 v[32:47], v[160:163], v[56:59], v[32:47]
    s_waitcnt lgkmcnt(2)
    v_mfma_f32_32x32x16_bf16 v[16:31], a[124:127], v[60:63], v[16:31]
    v_cmp_eq_u32 s[76:77], 1, v2
    v_cmp_eq_u32 vcc, 2, v2
    s_cmp_eq_u64 s[76:77], -1
    s_cselect_b32 s38, 1, 0
    ds_read_b128 v[56:59], v9 offset:34816
    v_mfma_f32_32x32x16_bf16 v[32:47], v[164:167], v[60:63], v[32:47]
    s_cmp_lg_u32 s38, 0
    s_cselect_b64 exec, 1, 0
    v_mov_b32 v15, s32
    ds_write_b32 v184, v15
    v_mov_b32 v2, 2
    s_mov_b64 exec, -1
    s_waitcnt lgkmcnt(3)
    v_mfma_f32_32x32x16_bf16 v[16:31], a[128:131], v[48:51], v[16:31]
    s_add_u32 s32, s32, s38
    s_mul_i32 s38, s38, 22528
    s_add_u32 s33, s33, s38
    ds_read_b128 v[60:63], v9 offset:35840
    s_waitcnt lgkmcnt(3)
    v_mfma_f32_32x32x16_bf16 v[16:31], a[132:135], v[52:55], v[16:31]
    s_cmp_eq_u64 vcc, 0
    s_cselect_b32 s38, s32, 0x7fff
    s_waitcnt lgkmcnt(2)
    v_mfma_f32_32x32x16_bf16 v[16:31], a[136:139], v[56:59], v[16:31]
    s_cmp_le_u32 s38, s39
    s_cselect_b64 exec, -1, 0
    v_mov_b32 v2, 2
    buffer_load_dword v2, v1, s[8:11], s33 offen sc1
    s_mov_b64 exec, -1
    s_waitcnt lgkmcnt(0)
    v_mfma_f32_32x32x16_bf16 v[16:31], a[140:143], v[60:63], v[16:31]
    v_mfma_f32_32x32x16_bf16 v[32:47], v[168:171], v[48:51], v[32:47]
    v_mfma_f32_32x32x16_bf16 v[32:47], v[172:175], v[52:55], v[32:47]
    v_fma_f32 v16, v16, v148, -v100
    v_fma_f32 v24, v24, v148, -v108
    v_fma_f32 v17, v17, v148, -v101
    v_fma_f32 v25, v25, v148, -v109
    v_fma_f32 v18, v18, v148, -v102
    v_mfma_f32_32x32x16_bf16 v[32:47], v[176:179], v[56:59], v[32:47]
    v_fma_f32 v26, v26, v148, -v110
    v_fma_f32 v19, v19, v148, -v103
    v_fma_f32 v27, v27, v148, -v111
    v_cvt_pk_bf16_f32 v188, v16, v24
    v_cvt_pk_bf16_f32 v189, v17, v25
    v_cvt_pk_bf16_f32 v190, v18, v26
    v_mfma_f32_32x32x16_bf16 v[32:47], v[180:183], v[60:63], v[32:47]
    v_cvt_pk_bf16_f32 v191, v19, v27
    buffer_store_dwordx4 v[188:191], v14, s[8:11], s46 offen offset:0 sc1
    v_fma_f32 v20, v20, v148, -v104
    v_fma_f32 v28, v28, v148, -v112
    v_fma_f32 v21, v21, v148, -v105
    v_fma_f32 v29, v29, v148, -v113
    v_fma_f32 v22, v22, v148, -v106
    v_fma_f32 v30, v30, v148, -v114
    v_fma_f32 v23, v23, v148, -v107
    v_fma_f32 v31, v31, v148, -v115
    v_cvt_pk_bf16_f32 v192, v20, v28
    v_cvt_pk_bf16_f32 v193, v21, v29
    v_cvt_pk_bf16_f32 v194, v22, v30
    v_cvt_pk_bf16_f32 v195, v23, v31
    buffer_store_dwordx4 v[192:195], v14, s[8:11], s46 offen offset:512 sc1
    s_add_u32 s51, s46, 8192
    v_pk_fma_f32 v[32:33], v[32:33], v[148:149], v[132:133] op_sel_hi:[1,0,1] neg_lo:[0,0,1] neg_hi:[0,0,1]
    v_pk_fma_f32 v[34:35], v[34:35], v[148:149], v[134:135] op_sel_hi:[1,0,1] neg_lo:[0,0,1] neg_hi:[0,0,1]
    v_pk_fma_f32 v[36:37], v[36:37], v[148:149], v[136:137] op_sel_hi:[1,0,1] neg_lo:[0,0,1] neg_hi:[0,0,1]
    v_pk_fma_f32 v[38:39], v[38:39], v[148:149], v[138:139] op_sel_hi:[1,0,1] neg_lo:[0,0,1] neg_hi:[0,0,1]
    v_pk_fma_f32 v[40:41], v[40:41], v[148:149], v[140:141] op_sel_hi:[1,0,1] neg_lo:[0,0,1] neg_hi:[0,0,1]
    v_pk_fma_f32 v[42:43], v[42:43], v[148:149], v[142:143] op_sel_hi:[1,0,1] neg_lo:[0,0,1] neg_hi:[0,0,1]
    v_pk_fma_f32 v[44:45], v[44:45], v[148:149], v[144:145] op_sel_hi:[1,0,1] neg_lo:[0,0,1] neg_hi:[0,0,1]
    v_pk_fma_f32 v[46:47], v[46:47], v[148:149], v[146:147] op_sel_hi:[1,0,1] neg_lo:[0,0,1] neg_hi:[0,0,1]
    v_cvt_pk_bf16_f32 v196, v32, v40
    v_cvt_pk_bf16_f32 v197, v33, v41
    v_cvt_pk_bf16_f32 v198, v34, v42
    v_cvt_pk_bf16_f32 v199, v35, v43
    buffer_store_dwordx4 v[196:199], v14, s[8:11], s51 offen offset:0 sc1
    v_cvt_pk_bf16_f32 v200, v36, v44
    v_cvt_pk_bf16_f32 v201, v37, v45
    v_cvt_pk_bf16_f32 v202, v38, v46
    v_cvt_pk_bf16_f32 v203, v39, v47
    buffer_store_dwordx4 v[200:203], v14, s[8:11], s51 offen offset:512 sc1
    s_mul_i32 s43, s57, 22528
    s_add_u32 s43, s43, s49
    s_branch LpQQ_head
LpQQ_none:
    ds_read_b32 v15, v184
    s_waitcnt lgkmcnt(0)
    v_readfirstlane_b32 s17, v15
    s_nop 0
    s_cmp_lt_i32 s17, s37
    s_cbranch_scc1 LpQQ_nopost
    s_add_u32 m0, s59, 0
    s_add_u32 s47, s41, 0
    buffer_load_dwordx4 v0, s[8:11], s47 offen offset:0 lds
    buffer_load_dwordx4 v0, s[8:11], s47 offen offset:1024 lds
    buffer_load_dwordx4 v0, s[8:11], s47 offen offset:2048 lds
    buffer_load_dwordx4 v0, s[8:11], s47 offen offset:3072 lds
    s_add_u32 m0, s59, 4096
    s_add_u32 s47, s41, 4096
    buffer_load_dwordx4 v0, s[8:11], s47 offen offset:0 lds
    buffer_load_dwordx4 v0, s[8:11], s47 offen offset:1024 lds
    buffer_load_dwordx4 v0, s[8:11], s47 offen offset:2048 lds
    buffer_load_dwordx4 v0, s[8:11], s47 offen offset:3072 lds
    s_add_u32 m0, s59, 8192
    s_add_u32 s47, s41, 8192
    buffer_load_dwordx4 v0, s[8:11], s47 offen offset:0 lds
    s_mul_i32 s48, s36, 786432
    s_mul_i32 s18, s37, 6144
    s_add_u32 s48, s48, s18
    s_add_u32 s48, s48, 16125952
    s_add_u32 m0, s66, 4096
    s_nop 0
    buffer_load_dwordx4 v0, s[8:11], s48 offen lds
    s_add_u32 m0, s66, s67
    s_sub_u32 s48, s48, 4096
    s_add_u32 s48, s48, s67
    buffer_load_dwordx4 v0, s[8:11], s48 offen lds
    s_waitcnt vmcnt(11)
    s_cmp_lg_u32 s43, 0
    s_cselect_b64 exec, 3, 0
    buffer_store_dword v3, v185, s[8:11], s43 offen sc1
    s_mov_b64 exec, -1
    s_mov_b32 s43, 0
    s_waitcnt vmcnt(1) lgkmcnt(0)
    s_branch LpQQ_head2
LpQQ_nopost:
    s_waitcnt vmcnt(0)
    s_cmp_lg_u32 s43, 0
    s_cselect_b64 exec, 3, 0
    buffer_store_dword v3, v185, s[8:11], s43 offen sc1
    s_mov_b64 exec, -1
    s_mov_b32 s43, 0
    s_cmp_ge_u32 s37, 64
    s_cbranch_scc1 LpQQ_end
LpQQ_wait:
    s_mov_b32 s16, 0
    s_cmp_lg_u32 s14, 0
    s_cbranch_scc1 LpQQ_wl
LpQQ_wp:
    buffer_load_dword v2, v1, s[8:11], s60 offen sc1
    s_add_u32 s16, s16, 1
    s_cmp_gt_u32 s16, 100000
    s_cbranch_scc1 LpQQ_giveup
    s_waitcnt vmcnt(0)
    v_cmp_eq_u32 vcc, 0, v2
    s_nop 0
    s_cbranch_vccz LpQQ_wok
    s_sleep 4
    s_branch LpQQ_wp
LpQQ_giveup:
    v_mov_b32 v5, -2
    ds_write_b32 v184, v5
    s_waitcnt lgkmcnt(0)
    s_branch L_role_p_abort
LpQQ_wok:
    v_mov_b32 v5, s37
    ds_write_b32 v184, v5
    s_branch LpQQ_go
LpQQ_wl:
    ds_read_b32 v15, v184
    s_add_u32 s16, s16, 1
    s_cmp_gt_u32 s16, 1600000
    s_cbranch_scc1 L_role_p_abort
    s_waitcnt lgkmcnt(0)
    v_readfirstlane_b32 s17, v15
    s_nop 0
    s_cmp_eq_u32 s17, -2
    s_cbranch_scc1 L_role_p_abort
    s_cmp_ge_i32 s17, s37
    s_cbranch_scc1 LpQQ_go
    s_sleep 1
    s_branch LpQQ_wl
LpQQ_go:
    s_add_u32 m0, s59, 0
    s_add_u32 s47, s41, 0
    buffer_load_dwordx4 v0, s[8:11], s47 offen offset:0 lds
    buffer_load_dwordx4 v0, s[8:11], s47 offen offset:1024 lds
    buffer_load_dwordx4 v0, s[8:11], s47 offen offset:2048 lds
    buffer_load_dwordx4 v0, s[8:11], s47 offen offset:3072 lds
    s_add_u32 m0, s59, 4096
    s_add_u32 s47, s41, 4096
    buffer_load_dwordx4 v0, s[8:11], s47 offen offset:0 lds
    buffer_load_dwordx4 v0, s[8:11], s47 offen offset:1024 lds
    buffer_load_dwordx4 v0, s[8:11], s47 offen offset:2048 lds
    buffer_load_dwordx4 v0, s[8:11], s47 offen offset:3072 lds
    s_add_u32 m0, s59, 8192
    s_add_u32 s47, s41, 8192
    buffer_load_dwordx4 v0, s[8:11], s47 offen offset:0 lds
    s_mul_i32 s48, s36, 786432
    s_mul_i32 s18, s37, 6144
    s_add_u32 s48, s48, s18
    s_add_u32 s48, s48, 16125952
    s_add_u32 m0, s66, 4096
    s_nop 0
    buffer_load_dwordx4 v0, s[8:11], s48 offen lds
    s_add_u32 m0, s66, s67
    s_sub_u32 s48, s48, 4096
    s_add_u32 s48, s48, s67
    buffer_load_dwordx4 v0, s[8:11], s48 offen lds
    s_waitcnt vmcnt(0) lgkmcnt(0)
    s_branch LpQQ_head2
LpQQ_end:
    s_branch L_role_p_exit
Lp2_kv:
    v_mfma_f32_32x32x16_bf16 v[84:99], a[0:3], v[48:51], 0
    v_mfma_f32_32x32x16_bf16 v[32:47], v[48:51], a[144:147], 0
    v_mfma_f32_32x32x16_bf16 v[84:99], a[4:7], v[48:51], v[84:99]
    v_mfma_f32_32x32x16_bf16 v[32:47], v[48:51], a[148:151], v[32:47]
    v_mfma_f32_32x32x16_bf16 v[84:99], a[8:11], v[48:51], v[84:99]
    v_mfma_f32_32x32x16_bf16 v[32:47], v[48:51], a[152:155], v[32:47]
    v_mfma_f32_32x32x16_bf16 v[84:99], a[12:15], v[48:51], v[84:99]
    v_mfma_f32_32x32x16_bf16 v[32:47], v[48:51], a[156:159], v[32:47]
    v_mfma_f32_32x32x16_bf16 v[84:99], a[16:19], v[48:51], v[84:99]
    v_mfma_f32_32x32x16_bf16 v[32:47], v[48:51], a[160:163], v[32:47]
    v_mfma_f32_32x32x16_bf16 v[84:99], a[20:23], v[48:51], v[84:99]
    v_mfma_f32_32x32x16_bf16 v[32:47], v[48:51], a[164:167], v[32:47]
    v_mfma_f32_32x32x16_bf16 v[84:99], a[24:27], v[48:51], v[84:99]
    v_mfma_f32_32x32x16_bf16 v[32:47], v[48:51], a[168:171], v[32:47]
    v_mfma_f32_32x32x16_bf16 v[84:99], a[28:31], v[48:51], v[84:99]
    v_mfma_f32_32x32x16_bf16 v[32:47], v[48:51], a[172:175], v[32:47]
    v_mfma_f32_32x32x16_bf16 v[84:99], a[32:35], v[48:51], v[84:99]
    v_mfma_f32_32x32x16_bf16 v[32:47], v[48:51], a[176:179], v[32:47]
    v_mfma_f32_32x32x16_bf16 v[84:99], a[36:39], v[48:51], v[84:99]
    v_mfma_f32_32x32x16_bf16 v[32:47], v[48:51], a[180:183], v[32:47]
    v_mfma_f32_32x32x16_bf16 v[84:99], a[40:43], v[48:51], v[84:99]
    v_mfma_f32_32x32x16_bf16 v[32:47], v[48:51], a[184:187], v[32:47]
    v_mfma_f32_32x32x16_bf16 v[84:99], a[44:47], v[48:51], v[84:99]
    v_mfma_f32_32x32x16_bf16 v[32:47], v[48:51], a[188:191], v[32:47]
    v_mfma_f32_32x32x16_bf16 v[84:99], a[48:51], v[48:51], v[84:99]
    v_mfma_f32_32x32x16_bf16 v[32:47], v[48:51], a[192:195], v[32:47]
    v_mfma_f32_32x32x16_bf16 v[84:99], a[52:55], v[48:51], v[84:99]
    v_mfma_f32_32x32x16_bf16 v[32:47], v[48:51], a[196:199], v[32:47]
    v_mfma_f32_32x32x16_bf16 v[84:99], a[56:59], v[48:51], v[84:99]
    v_mfma_f32_32x32x16_bf16 v[32:47], v[48:51], a[200:203], v[32:47]
    v_mfma_f32_32x32x16_bf16 v[84:99], a[60:63], v[48:51], v[84:99]
    v_mfma_f32_32x32x16_bf16 v[32:47], v[48:51], a[204:207], v[32:47]
    v_mfma_f32_32x32x16_bf16 v[84:99], a[64:67], v[48:51], v[84:99]
    v_mfma_f32_32x32x16_bf16 v[32:47], v[48:51], a[208:211], v[32:47]
    v_mfma_f32_32x32x16_bf16 v[84:99], a[68:71], v[48:51], v[84:99]
    v_mfma_f32_32x32x16_bf16 v[32:47], v[48:51], a[212:215], v[32:47]
    v_mfma_f32_32x32x16_bf16 v[84:99], a[72:75], v[48:51], v[84:99]
    v_mfma_f32_32x32x16_bf16 v[32:47], v[48:51], a[216:219], v[32:47]
    v_mfma_f32_32x32x16_bf16 v[84:99], a[76:79], v[48:51], v[84:99]
    v_mfma_f32_32x32x16_bf16 v[32:47], v[48:51], a[220:223], v[32:47]
    v_mfma_f32_32x32x16_bf16 v[84:99], a[80:83], v[48:51], v[84:99]
    v_mfma_f32_32x32x16_bf16 v[32:47], v[48:51], a[224:227], v[32:47]
    v_mfma_f32_32x32x16_bf16 v[84:99], a[84:87], v[48:51], v[84:99]
    v_mfma_f32_32x32x16_bf16 v[32:47], v[48:51], a[228:231], v[32:47]
    v_mfma_f32_32x32x16_bf16 v[84:99], a[88:91], v[48:51], v[84:99]
    v_mfma_f32_32x32x16_bf16 v[32:47], v[48:51], a[232:235], v[32:47]
    v_mfma_f32_32x32x16_bf16 v[84:99], a[92:95], v[48:51], v[84:99]
    v_mfma_f32_32x32x16_bf16 v[32:47], v[48:51], a[236:239], v[32:47]
    v_mfma_f32_32x32x16_bf16 v[84:99], a[96:99], v[48:51], v[84:99]
    v_mfma_f32_32x32x16_bf16 v[32:47], v[48:51], a[240:243], v[32:47]
    v_mfma_f32_32x32x16_bf16 v[84:99], a[100:103], v[48:51], v[84:99]
    v_mfma_f32_32x32x16_bf16 v[32:47], v[48:51], a[244:247], v[32:47]
    v_mfma_f32_32x32x16_bf16 v[84:99], a[104:107], v[48:51], v[84:99]
    v_mfma_f32_32x32x16_bf16 v[32:47], v[48:51], a[248:251], v[32:47]
    v_mfma_f32_32x32x16_bf16 v[84:99], a[108:111], v[48:51], v[84:99]
    v_mfma_f32_32x32x16_bf16 v[32:47], v[48:51], a[252:255], v[32:47]
    v_mfma_f32_32x32x16_bf16 v[84:99], a[112:115], v[48:51], v[84:99]
    v_mfma_f32_32x32x16_bf16 v[32:47], v[48:51], v[152:155], v[32:47]
    v_mfma_f32_32x32x16_bf16 v[84:99], a[116:119], v[48:51], v[84:99]
    v_mfma_f32_32x32x16_bf16 v[32:47], v[48:51], v[156:159], v[32:47]
    v_mfma_f32_32x32x16_bf16 v[84:99], a[120:123], v[48:51], v[84:99]
    v_mfma_f32_32x32x16_bf16 v[32:47], v[48:51], v[160:163], v[32:47]
    v_mfma_f32_32x32x16_bf16 v[84:99], a[124:127], v[48:51], v[84:99]
    v_mfma_f32_32x32x16_bf16 v[32:47], v[48:51], v[164:167], v[32:47]
    v_mfma_f32_32x32x16_bf16 v[84:99], a[128:131], v[48:51], v[84:99]
    v_mfma_f32_32x32x16_bf16 v[32:47], v[48:51], v[168:171], v[32:47]
    v_mfma_f32_32x32x16_bf16 v[84:99], a[132:135], v[48:51], v[84:99]
    v_mfma_f32_32x32x16_bf16 v[32:47], v[48:51], v[172:175], v[32:47]
    v_mfma_f32_32x32x16_bf16 v[84:99], a[136:139], v[48:51], v[84:99]
    v_mfma_f32_32x32x16_bf16 v[32:47], v[48:51], v[176:179], v[32:47]
    v_mfma_f32_32x32x16_bf16 v[84:99], a[140:143], v[48:51], v[84:99]
    v_mfma_f32_32x32x16_bf16 v[32:47], v[48:51], v[180:183], v[32:47]
    s_nop 11
    v_mov_b32 v11, v32
    s_mov_b32 s66, 114688
    s_mov_b32 s71, 0x2000
    s_mov_b32 s36, s63
    s_mov_b32 s34, s63
    s_mul_i32 s58, s14, 9216
    s_mul_i32 s64, s63, 4718592
    s_add_u32 s64, s64, s58
    s_add_u32 s64, s64, 8650752
    s_mul_i32 s61, s63, 1441792
    s_add_u32 s61, s61, 3584
    s_mov_b32 s37, 0
    s_mov_b32 s40, 36864
    s_mov_b32 s59, s58
    s_mov_b32 s43, 0
    s_mov_b32 s62, 1
    s_mov_b32 s28, s8
    s_mov_b32 s29, s9
    s_mov_b32 s30, 0
    s_mov_b32 s31, 0x00020000
    v_mov_b32 v184, 74752
    v_mov_b32 v5, -1
    ds_write_b32 v184, v5
    s_waitcnt lgkmcnt(0)
    s_cmp_lg_u32 s14, 0
    s_cbranch_scc1 LpKV_inia_d
    v_mov_b32 v5, 40
    s_mov_b32 s16, 0
LpKV_inia:
    global_load_dword v6, v5, s[12:13] sc1
    s_add_u32 s16, s16, 1
    s_cmp_gt_u32 s16, 100000
    s_cbranch_scc1 L_role_p_abort
    s_waitcnt vmcnt(0)
    v_cmp_gt_u32 vcc, 128, v6
    s_nop 0
    s_cbranch_vccz LpKV_inia_d
    s_sleep 8
    s_branch LpKV_inia
LpKV_inia_d:
    s_barrier
    s_cmp_eq_u32 s63, 0
    s_cbranch_scc1 LpKV_ini_sk
    s_cmp_lg_u32 s14, 0
    s_cbranch_scc1 LpKV_inib_d
    v_mov_b32 v5, 160
    s_mov_b32 s16, 0
LpKV_inib:
    global_load_dword v6, v5, s[12:13] sc1
    s_add_u32 s16, s16, 1
    s_cmp_gt_u32 s16, 100000
    s_cbranch_scc1 L_role_p_abort
    s_waitcnt vmcnt(0)
    v_cmp_gt_u32 vcc, 64, v6
    s_nop 0
    s_cbranch_vccz LpKV_inib_d
    s_sleep 8
    s_branch LpKV_inib
LpKV_inib_d:
    s_barrier
LpKV_ini_sk:
    s_mul_i32 s41, s37, 36864
    s_add_u32 s41, s41, s64
    s_mul_i32 s60, s37, 22528
    s_add_u32 s60, s60, s61
    s_cmp_lt_u32 s37, 64
    s_cselect_b32 s60, s60, 2883584
    s_branch LpKV_wait
LpKV_head:
    s_waitcnt vmcnt(4)
LpKV_head2:
    s_barrier
    ds_read_b32 v15, v184
    s_xor_b32 s40, s40, 36864
    s_xor_b32 s59, s59, 36864
    s_mov_b32 s35, s37
    s_lshl_b32 s57, s34, 6
    s_add_u32 s57, s57, s35
    s_add_u32 s37, s37, 1
    s_mov_b32 s39, 0
    s_mov_b32 s54, 0
    s_xor_b32 s66, s66, 8192
    s_xor_b32 s71, s71, 8192
    s_mul_i32 s41, s37, 36864
    s_add_u32 s41, s41, s64
    s_mul_i32 s60, s37, 22528
    s_add_u32 s60, s60, s61
    s_cmp_lt_u32 s37, 64
    s_cselect_b32 s60, s60, 2883584
    v_add_u32 v9, s40, v0
    v_add_u32 v5, s71, v10
    ds_read_b128 v[48:51], v9 offset:0
    ds_read_b128 v[52:55], v9 offset:1024
    ds_read_b128 v[56:59], v9 offset:2048
    ds_read_b128 v[64:67], v5 offset:0
    ds_read_b128 v[68:71], v5 offset:512
    ds_read_b128 v[72:75], v5 offset:1024
    ds_read_b128 v[76:79], v5 offset:1536
    ds_read_b128 v[80:83], v5 offset:2048
    s_waitcnt lgkmcnt(7)
    v_mfma_f32_32x32x16_bf16 v[16:31], a[0:3], v[48:51], 0
    ds_read_b128 v[60:63], v9 offset:3072
    v_mfma_f32_32x32x16_bf16 v[32:47], v[48:51], a[144:147], 0
    s_waitcnt lgkmcnt(4)
    v_add_f32 v64, v64, v68
    v_add_f32 v65, v65, v69
    v_add_f32 v66, v66, v70
    v_add_f32 v67, v67, v71
    v_mfma_f32_32x32x16_bf16 v[16:31], a[4:7], v[52:55], v[16:31]
    ds_read_b128 v[48:51], v9 offset:4096
    s_waitcnt lgkmcnt(4)
    v_add_f32 v64, v64, v72
    v_add_f32 v65, v65, v73
    v_add_f32 v66, v66, v74
    v_mfma_f32_32x32x16_bf16 v[32:47], v[52:55], a[148:151], v[32:47]
    v_add_f32 v67, v67, v75
    s_waitcnt lgkmcnt(3)
    v_add_f32 v64, v64, v76
    v_add_f32 v65, v65, v77
    v_add_f32 v66, v66, v78
    v_readfirstlane_b32 s17, v15
    s_nop 0
    s_add_u32 s18, s17, 1
    s_max_i32 s32, s18, s37
    s_add_u32 s39, s37, 1
    s_min_u32 s39, s39, 63
    s_mul_i32 s33, s32, 22528
    s_add_u32 s33, s33, s61
    s_cmp_eq_u32 s14, 0
    s_cselect_b32 s18, s32, 0x7fff
    v_mov_b32 v2, 2
    s_cmp_le_u32 s18, s39
    s_cselect_b64 exec, -1, 0
    buffer_load_dword v2, v1, s[8:11], s33 offen sc1
    s_mov_b64 exec, -1
    s_cmp_ge_i32 s17, s37
    s_cbranch_scc1 LpKV_f_3
    v_mfma_f32_32x32x16_bf16 v[16:31], a[8:11], v[56:59], v[16:31]
    ds_read_b128 v[52:55], v9 offset:5120
    v_add_f32 v67, v67, v79
    s_waitcnt lgkmcnt(3)
    v_add_f32 v64, v64, v80
    v_add_f32 v65, v65, v81
    v_mfma_f32_32x32x16_bf16 v[32:47], v[56:59], a[152:155], v[32:47]
    v_add_f32 v66, v66, v82
    v_add_f32 v67, v67, v83
    v_add_f32 v64, v64, v66
    v_add_f32 v65, v65, v67
    s_waitcnt lgkmcnt(2)
    v_mfma_f32_32x32x16_bf16 v[16:31], a[12:15], v[60:63], v[16:31]
    ds_read_b128 v[56:59], v9 offset:6144
    v_mov_b32 v66, v64
    v_mov_b32 v67, v65
    s_nop 0
    v_permlane32_swap_b32 v64, v66
    v_mfma_f32_32x32x16_bf16 v[32:47], v[60:63], a[156:159], v[32:47]
    v_permlane32_swap_b32 v65, v67
    v_add_f32 v64, v64, v66
    v_add_f32 v65, v65, v67
    v_mul_f32 v64, 0x3ae38e39, v64
    s_waitcnt lgkmcnt(2)
    v_mfma_f32_32x32x16_bf16 v[16:31], a[16:19], v[48:51], v[16:31]
    ds_read_b128 v[60:63], v9 offset:7168
    v_mul_f32 v65, 0x3ae38e39, v65
    v_fma_f32 v65, -v64, v64, v65
    v_max_f32 v65, 0, v65
    v_mfma_f32_32x32x16_bf16 v[32:47], v[48:51], a[160:163], v[32:47]
    v_add_f32 v65, 0x3727c5ac, v65
    v_rsq_f32 v148, v65
    s_nop 0
    v_mul_f32 v149, v64, v148
    v_mul_f32 v100, v149, v84
    s_waitcnt lgkmcnt(2)
    v_mfma_f32_32x32x16_bf16 v[16:31], a[20:23], v[52:55], v[16:31]
    ds_read_b128 v[48:51], v9 offset:8192
    v_mul_f32 v101, v149, v85
    v_mul_f32 v102, v149, v86
    v_mul_f32 v103, v149, v87
    v_mfma_f32_32x32x16_bf16 v[32:47], v[52:55], a[164:167], v[32:47]
    v_mul_f32 v104, v149, v88
    v_mul_f32 v105, v149, v89
    v_mul_f32 v106, v149, v90
    v_mul_f32 v107, v149, v91
    s_waitcnt lgkmcnt(2)
    v_mfma_f32_32x32x16_bf16 v[16:31], a[24:27], v[56:59], v[16:31]
    ds_read_b128 v[52:55], v9 offset:9216
    v_mul_f32 v108, v149, v92
    v_mul_f32 v109, v149, v93
    v_mul_f32 v110, v149, v94
    v_mfma_f32_32x32x16_bf16 v[32:47], v[56:59], a[168:171], v[32:47]
    v_mul_f32 v111, v149, v95
    v_mul_f32 v112, v149, v96
    v_mul_f32 v113, v149, v97
    v_mul_f32 v114, v149, v98
    s_waitcnt lgkmcnt(2)
    v_mfma_f32_32x32x16_bf16 v[16:31], a[28:31], v[60:63], v[16:31]
    ds_read_b128 v[56:59], v9 offset:10240
    v_mul_f32 v115, v149, v99
    ds_write2_b32 v12, v148, v149 offset0:0 offset1:32
    ds_read_b128 v[116:119], v13 offset:0
    v_mfma_f32_32x32x16_bf16 v[32:47], v[60:63], a[172:175], v[32:47]
    ds_read_b128 v[120:123], v13 offset:32
    ds_read_b128 v[124:127], v13 offset:64
    ds_read_b128 v[128:131], v13 offset:96
    ds_read_b128 v[132:135], v13 offset:128
    s_waitcnt lgkmcnt(8)
    v_mfma_f32_32x32x16_bf16 v[16:31], a[32:35], v[48:51], v[16:31]
    ds_read_b128 v[60:63], v9 offset:11264
    ds_read_b128 v[136:139], v13 offset:160
    ds_read_b128 v[140:143], v13 offset:192
    ds_read_b128 v[144:147], v13 offset:224
    v_mfma_f32_32x32x16_bf16 v[32:47], v[48:51], a[176:179], v[32:47]
    s_waitcnt lgkmcnt(11)
    v_mfma_f32_32x32x16_bf16 v[16:31], a[36:39], v[52:55], v[16:31]
    ds_read_b128 v[48:51], v9 offset:12288
    v_mfma_f32_32x32x16_bf16 v[32:47], v[52:55], a[180:183], v[32:47]
    s_waitcnt lgkmcnt(5)
    v_mul_f32 v132, v11, v132
    v_mul_f32 v133, v11, v133
    v_mfma_f32_32x32x16_bf16 v[16:31], a[40:43], v[56:59], v[16:31]
    ds_read_b128 v[52:55], v9 offset:13312
    v_mul_f32 v134, v11, v134
    v_mul_f32 v135, v11, v135
    s_waitcnt lgkmcnt(4)
    v_mul_f32 v136, v11, v136
    v_mfma_f32_32x32x16_bf16 v[32:47], v[56:59], a[184:187], v[32:47]
    v_mul_f32 v137, v11, v137
    v_mul_f32 v138, v11, v138
    v_mul_f32 v139, v11, v139
    s_waitcnt lgkmcnt(3)
    v_mul_f32 v140, v11, v140
    v_mfma_f32_32x32x16_bf16 v[16:31], a[44:47], v[60:63], v[16:31]
    ds_read_b128 v[56:59], v9 offset:14336
    v_mul_f32 v141, v11, v141
    v_mul_f32 v142, v11, v142
    v_mul_f32 v143, v11, v143
    v_mfma_f32_32x32x16_bf16 v[32:47], v[60:63], a[188:191], v[32:47]
    s_waitcnt lgkmcnt(3)
    v_mul_f32 v144, v11, v144
    v_mul_f32 v145, v11, v145
    v_mul_f32 v146, v11, v146
    v_mul_f32 v147, v11, v147
    s_waitcnt lgkmcnt(2)
    v_mfma_f32_32x32x16_bf16 v[16:31], a[48:51], v[48:51], v[16:31]
    ds_read_b128 v[60:63], v9 offset:15360
    s_mul_i32 s46, s34, 50331648
    s_lshl_b32 s51, s35, 18
    s_add_u32 s46, s46, s51
    v_mfma_f32_32x32x16_bf16 v[32:47], v[48:51], a[192:195], v[32:47]
    s_add_u32 s46, s46, s52
    s_waitcnt vmcnt(1)
    s_cmp_lg_u32 s43, 0
    s_cselect_b64 exec, 3, 0
    buffer_store_dword v3, v185, s[8:11], s43 offen sc1
    s_mov_b64 exec, -1
    s_mov_b32 s43, 0
    s_waitcnt lgkmcnt(2)
    v_mfma_f32_32x32x16_bf16 v[16:31], a[52:55], v[52:55], v[16:31]
    ds_read_b128 v[48:51], v9 offset:16384
    v_mfma_f32_32x32x16_bf16 v[32:47], v[52:55], a[196:199], v[32:47]
    s_waitcnt lgkmcnt(2)
    v_mfma_f32_32x32x16_bf16 v[16:31], a[56:59], v[56:59], v[16:31]
    v_cmp_eq_u32 s[76:77], 1, v2
    v_cmp_eq_u32 vcc, 2, v2
    s_cmp_eq_u64 s[76:77], -1
    s_cselect_b32 s38, 1, 0
    ds_read_b128 v[52:55], v9 offset:17408
    v_mfma_f32_32x32x16_bf16 v[32:47], v[56:59], a[200:203], v[32:47]
    s_cmp_lg_u32 s38, 0
    s_cselect_b64 exec, 1, 0
    v_mov_b32 v15, s32
    ds_write_b32 v184, v15
    v_mov_b32 v2, 2
    s_mov_b64 exec, -1
    s_waitcnt lgkmcnt(3)
    v_mfma_f32_32x32x16_bf16 v[16:31], a[60:63], v[60:63], v[16:31]
    s_add_u32 s32, s32, s38
    s_mul_i32 s38, s38, 22528
    s_add_u32 s33, s33, s38
    ds_read_b128 v[56:59], v9 offset:18432
    v_mfma_f32_32x32x16_bf16 v[32:47], v[60:63], a[204:207], v[32:47]
    s_cmp_eq_u64 vcc, 0
    s_cselect_b32 s38, s32, 0x7fff
    s_waitcnt lgkmcnt(3)
    v_mfma_f32_32x32x16_bf16 v[16:31], a[64:67], v[48:51], v[16:31]
    ds_read_b128 v[60:63], v9 offset:19456
    v_mfma_f32_32x32x16_bf16 v[32:47], v[48:51], a[208:211], v[32:47]
    s_cmp_le_u32 s38, s39
    s_cselect_b64 exec, -1, 0
    v_mov_b32 v2, 2
    buffer_load_dword v2, v1, s[8:11], s33 offen sc1
    s_mov_b64 exec, -1
    ds_read_b32 v15, v184
    s_waitcnt lgkmcnt(4)
    v_mfma_f32_32x32x16_bf16 v[16:31], a[68:71], v[52:55], v[16:31]
    ds_read_b128 v[48:51], v9 offset:20480
    v_mfma_f32_32x32x16_bf16 v[32:47], v[52:55], a[212:215], v[32:47]
    s_waitcnt lgkmcnt(3)
    v_mfma_f32_32x32x16_bf16 v[16:31], a[72:75], v[56:59], v[16:31]
    ds_read_b128 v[52:55], v9 offset:21504
    v_mfma_f32_32x32x16_bf16 v[32:47], v[56:59], a[216:219], v[32:47]
    s_waitcnt lgkmcnt(2)
    v_readfirstlane_b32 s17, v15
    s_nop 0
    s_cmp_ge_i32 s17, s37
    s_cbranch_scc1 LpKV_f_4
    v_mfma_f32_32x32x16_bf16 v[16:31], a[76:79], v[60:63], v[16:31]
    ds_read_b128 v[56:59], v9 offset:22528
    v_mfma_f32_32x32x16_bf16 v[32:47], v[60:63], a[220:223], v[32:47]
    s_waitcnt lgkmcnt(2)
    v_mfma_f32_32x32x16_bf16 v[16:31], a[80:83], v[48:51], v[16:31]
    ds_read_b128 v[60:63], v9 offset:23552
    v_mfma_f32_32x32x16_bf16 v[32:47], v[48:51], a[224:227], v[32:47]
    s_waitcnt lgkmcnt(2)
    v_mfma_f32_32x32x16_bf16 v[16:31], a[84:87], v[52:55], v[16:31]
    ds_read_b128 v[48:51], v9 offset:24576
    v_mfma_f32_32x32x16_bf16 v[32:47], v[52:55], a[228:231], v[32:47]
    s_waitcnt lgkmcnt(2)
    v_mfma_f32_32x32x16_bf16 v[16:31], a[88:91], v[56:59], v[16:31]
    ds_read_b128 v[52:55], v9 offset:25600
    v_mfma_f32_32x32x16_bf16 v[32:47], v[56:59], a[232:235], v[32:47]
    s_waitcnt lgkmcnt(2)
    v_mfma_f32_32x32x16_bf16 v[16:31], a[92:95], v[60:63], v[16:31]
    ds_read_b128 v[56:59], v9 offset:26624
    v_mfma_f32_32x32x16_bf16 v[32:47], v[60:63], a[236:239], v[32:47]
    s_waitcnt lgkmcnt(2)
    v_mfma_f32_32x32x16_bf16 v[16:31], a[96:99], v[48:51], v[16:31]
    ds_read_b128 v[60:63], v9 offset:27648
    v_mfma_f32_32x32x16_bf16 v[32:47], v[48:51], a[240:243], v[32:47]
    s_waitcnt lgkmcnt(2)
    v_mfma_f32_32x32x16_bf16 v[16:31], a[100:103], v[52:55], v[16:31]
    ds_read_b128 v[48:51], v9 offset:28672
    v_mfma_f32_32x32x16_bf16 v[32:47], v[52:55], a[244:247], v[32:47]
    s_waitcnt lgkmcnt(2)
    v_mfma_f32_32x32x16_bf16 v[16:31], a[104:107], v[56:59], v[16:31]
    ds_read_b128 v[52:55], v9 offset:29696
    v_mfma_f32_32x32x16_bf16 v[32:47], v[56:59], a[248:251], v[32:47]
    s_waitcnt lgkmcnt(2)
    v_mfma_f32_32x32x16_bf16 v[16:31], a[108:111], v[60:63], v[16:31]
    ds_read_b128 v[56:59], v9 offset:30720
    v_mfma_f32_32x32x16_bf16 v[32:47], v[60:63], a[252:255], v[32:47]
    s_waitcnt lgkmcnt(2)
    v_mfma_f32_32x32x16_bf16 v[16:31], a[112:115], v[48:51], v[16:31]
    ds_read_b128 v[60:63], v9 offset:31744
    v_mfma_f32_32x32x16_bf16 v[32:47], v[48:51], v[152:155], v[32:47]
    s_waitcnt lgkmcnt(2)
    v_mfma_f32_32x32x16_bf16 v[16:31], a[116:119], v[52:55], v[16:31]
    ds_read_b128 v[48:51], v9 offset:32768
    v_mfma_f32_32x32x16_bf16 v[32:47], v[52:55], v[156:159], v[32:47]
    s_waitcnt lgkmcnt(2)
    v_mfma_f32_32x32x16_bf16 v[16:31], a[120:123], v[56:59], v[16:31]
    ds_read_b128 v[52:55], v9 offset:33792
    v_mfma_f32_32x32x16_bf16 v[32:47], v[56:59], v[160:163], v[32:47]
    s_waitcnt lgkmcnt(2)
    v_mfma_f32_32x32x16_bf16 v[16:31], a[124:127], v[60:63], v[16:31]
    v_cmp_eq_u32 s[76:77], 1, v2
    v_cmp_eq_u32 vcc, 2, v2
    s_cmp_eq_u64 s[76:77], -1
    s_cselect_b32 s38, 1, 0
    ds_read_b128 v[56:59], v9 offset:34816
    v_mfma_f32_32x32x16_bf16 v[32:47], v[60:63], v[164:167], v[32:47]
    s_cmp_lg_u32 s38, 0
    s_cselect_b64 exec, 1, 0
    v_mov_b32 v15, s32
    ds_write_b32 v184, v15
    v_mov_b32 v2, 2
    s_mov_b64 exec, -1
    s_waitcnt lgkmcnt(3)
    v_mfma_f32_32x32x16_bf16 v[16:31], a[128:131], v[48:51], v[16:31]
    s_add_u32 s32, s32, s38
    s_mul_i32 s38, s38, 22528
    s_add_u32 s33, s33, s38
    ds_read_b128 v[60:63], v9 offset:35840
    s_waitcnt lgkmcnt(3)
    v_mfma_f32_32x32x16_bf16 v[16:31], a[132:135], v[52:55], v[16:31]
    s_cmp_eq_u64 vcc, 0
    s_cselect_b32 s38, s32, 0x7fff
    s_waitcnt lgkmcnt(2)
    v_mfma_f32_32x32x16_bf16 v[16:31], a[136:139], v[56:59], v[16:31]
    s_cmp_le_u32 s38, s39
    s_cselect_b64 exec, -1, 0
    v_mov_b32 v2, 2
    buffer_load_dword v2, v1, s[8:11], s33 offen sc1
    s_mov_b64 exec, -1
    s_waitcnt lgkmcnt(0)
    v_mfma_f32_32x32x16_bf16 v[16:31], a[140:143], v[60:63], v[16:31]
    v_mfma_f32_32x32x16_bf16 v[32:47], v[48:51], v[168:171], v[32:47]
    v_mfma_f32_32x32x16_bf16 v[32:47], v[52:55], v[172:175], v[32:47]
    v_fma_f32 v16, v16, v148, -v100
    v_fma_f32 v24, v24, v148, -v108
    v_fma_f32 v17, v17, v148, -v101
    v_fma_f32 v25, v25, v148, -v109
    v_fma_f32 v18, v18, v148, -v102
    v_mfma_f32_32x32x16_bf16 v[32:47], v[56:59], v[176:179], v[32:47]
    v_fma_f32 v26, v26, v148, -v110
    v_fma_f32 v19, v19, v148, -v103
    v_fma_f32 v27, v27, v148, -v111
    v_cvt_pk_bf16_f32 v188, v16, v24
    v_cvt_pk_bf16_f32 v189, v17, v25
    v_cvt_pk_bf16_f32 v190, v18, v26
    v_mfma_f32_32x32x16_bf16 v[32:47], v[60:63], v[180:183], v[32:47]
    v_cvt_pk_bf16_f32 v191, v19, v27
    buffer_store_dwordx4 v[188:191], v14, s[8:11], s46 offen offset:0 sc1
    v_fma_f32 v20, v20, v148, -v104
    v_fma_f32 v28, v28, v148, -v112
    v_fma_f32 v21, v21, v148, -v105
    v_fma_f32 v29, v29, v148, -v113
    v_fma_f32 v22, v22, v148, -v106
    v_fma_f32 v30, v30, v148, -v114
    v_fma_f32 v23, v23, v148, -v107
    v_fma_f32 v31, v31, v148, -v115
    v_cvt_pk_bf16_f32 v192, v20, v28
    v_cvt_pk_bf16_f32 v193, v21, v29
    v_cvt_pk_bf16_f32 v194, v22, v30
    v_cvt_pk_bf16_f32 v195, v23, v31
    buffer_store_dwordx4 v[192:195], v14, s[8:11], s46 offen offset:512 sc1
    s_add_u32 s51, s46, 16777216
    v_pk_fma_f32 v[32:33], v[32:33], v[116:117], v[132:133] neg_lo:[0,0,1] neg_hi:[0,0,1]
    v_pk_fma_f32 v[34:35], v[34:35], v[118:119], v[134:135] neg_lo:[0,0,1] neg_hi:[0,0,1]
    v_pk_fma_f32 v[36:37], v[36:37], v[120:121], v[136:137] neg_lo:[0,0,1] neg_hi:[0,0,1]
    v_pk_fma_f32 v[38:39], v[38:39], v[122:123], v[138:139] neg_lo:[0,0,1] neg_hi:[0,0,1]
    v_pk_fma_f32 v[40:41], v[40:41], v[124:125], v[140:141] neg_lo:[0,0,1] neg_hi:[0,0,1]
    v_pk_fma_f32 v[42:43], v[42:43], v[126:127], v[142:143] neg_lo:[0,0,1] neg_hi:[0,0,1]
    v_pk_fma_f32 v[44:45], v[44:45], v[128:129], v[144:145] neg_lo:[0,0,1] neg_hi:[0,0,1]
    v_pk_fma_f32 v[46:47], v[46:47], v[130:131], v[146:147] neg_lo:[0,0,1] neg_hi:[0,0,1]
    v_cvt_pk_bf16_f32 v196, v32, v33
    v_cvt_pk_bf16_f32 v197, v34, v35
    v_cvt_pk_bf16_f32 v198, v40, v41
    v_cvt_pk_bf16_f32 v199, v42, v43
    buffer_store_dwordx4 v[196:199], v14, s[8:11], s51 offen offset:0 sc1
    v_cvt_pk_bf16_f32 v200, v36, v37
    v_cvt_pk_bf16_f32 v201, v38, v39
    v_cvt_pk_bf16_f32 v202, v44, v45
    v_cvt_pk_bf16_f32 v203, v46, v47
    buffer_store_dwordx4 v[200:203], v14, s[8:11], s51 offen offset:512 sc1
    s_mul_i32 s43, s57, 22528
    s_add_u32 s43, s43, s49
    s_branch LpKV_none
LpKV_f_3:
    v_mfma_f32_32x32x16_bf16 v[16:31], a[8:11], v[56:59], v[16:31]
    ds_read_b128 v[52:55], v9 offset:5120
    v_add_f32 v67, v67, v79
    s_waitcnt lgkmcnt(3)
    v_add_f32 v64, v64, v80
    v_add_f32 v65, v65, v81
    v_mfma_f32_32x32x16_bf16 v[32:47], v[56:59], a[152:155], v[32:47]
    v_add_f32 v66, v66, v82
    v_add_f32 v67, v67, v83
    v_add_f32 v64, v64, v66
    v_add_f32 v65, v65, v67
    s_waitcnt lgkmcnt(2)
    v_mfma_f32_32x32x16_bf16 v[16:31], a[12:15], v[60:63], v[16:31]
    ds_read_b128 v[56:59], v9 offset:6144
    v_mov_b32 v66, v64
    v_mov_b32 v67, v65
    s_nop 0
    v_permlane32_swap_b32 v64, v66
    v_mfma_f32_32x32x16_bf16 v[32:47], v[60:63], a[156:159], v[32:47]
    v_permlane32_swap_b32 v65, v67
    v_add_f32 v64, v64, v66
    v_add_f32 v65, v65, v67
    v_mul_f32 v64, 0x3ae38e39, v64
    s_waitcnt lgkmcnt(2)
    v_mfma_f32_32x32x16_bf16 v[16:31], a[16:19], v[48:51], v[16:31]
    ds_read_b128 v[60:63], v9 offset:7168
    v_mul_f32 v65, 0x3ae38e39, v65
    v_fma_f32 v65, -v64, v64, v65
    v_max_f32 v65, 0, v65
    v_mfma_f32_32x32x16_bf16 v[32:47], v[48:51], a[160:163], v[32:47]
    v_add_f32 v65, 0x3727c5ac, v65
    v_rsq_f32 v148, v65
    s_nop 0
    v_mul_f32 v149, v64, v148
    v_mul_f32 v100, v149, v84
    s_waitcnt lgkmcnt(2)
    v_mfma_f32_32x32x16_bf16 v[16:31], a[20:23], v[52:55], v[16:31]
    ds_read_b128 v[48:51], v9 offset:8192
    v_mul_f32 v101, v149, v85
    v_mul_f32 v102, v149, v86
    v_mul_f32 v103, v149, v87
    v_mfma_f32_32x32x16_bf16 v[32:47], v[52:55], a[164:167], v[32:47]
    v_mul_f32 v104, v149, v88
    v_mul_f32 v105, v149, v89
    v_mul_f32 v106, v149, v90
    v_mul_f32 v107, v149, v91
    s_waitcnt lgkmcnt(2)
    v_mfma_f32_32x32x16_bf16 v[16:31], a[24:27], v[56:59], v[16:31]
    ds_read_b128 v[52:55], v9 offset:9216
    v_mul_f32 v108, v149, v92
    v_mul_f32 v109, v149, v93
    v_mul_f32 v110, v149, v94
    v_mfma_f32_32x32x16_bf16 v[32:47], v[56:59], a[168:171], v[32:47]
    v_mul_f32 v111, v149, v95
    v_mul_f32 v112, v149, v96
    v_mul_f32 v113, v149, v97
    v_mul_f32 v114, v149, v98
    s_waitcnt lgkmcnt(2)
    v_mfma_f32_32x32x16_bf16 v[16:31], a[28:31], v[60:63], v[16:31]
    ds_read_b128 v[56:59], v9 offset:10240
    v_mul_f32 v115, v149, v99
    ds_write2_b32 v12, v148, v149 offset0:0 offset1:32
    ds_read_b128 v[116:119], v13 offset:0
    v_mfma_f32_32x32x16_bf16 v[32:47], v[60:63], a[172:175], v[32:47]
    ds_read_b128 v[120:123], v13 offset:32
    ds_read_b128 v[124:127], v13 offset:64
    ds_read_b128 v[128:131], v13 offset:96
    ds_read_b128 v[132:135], v13 offset:128
    s_waitcnt lgkmcnt(8)
    v_mfma_f32_32x32x16_bf16 v[16:31], a[32:35], v[48:51], v[16:31]
    ds_read_b128 v[60:63], v9 offset:11264
    ds_read_b128 v[136:139], v13 offset:160
    ds_read_b128 v[140:143], v13 offset:192
    ds_read_b128 v[144:147], v13 offset:224
    v_mfma_f32_32x32x16_bf16 v[32:47], v[48:51], a[176:179], v[32:47]
    s_add_u32 m0, s59, 0
    s_add_u32 s47, s41, 0
    buffer_load_dwordx4 v0, s[8:11], s47 offen offset:0 lds
    buffer_load_dwordx4 v0, s[8:11], s47 offen offset:1024 lds
    buffer_load_dwordx4 v0, s[8:11], s47 offen offset:2048 lds
    s_waitcnt lgkmcnt(11)
    v_mfma_f32_32x32x16_bf16 v[16:31], a[36:39], v[52:55], v[16:31]
    buffer_load_dwordx4 v0, s[8:11], s47 offen offset:3072 lds
    s_add_u32 m0, s59, 4096
    s_add_u32 s47, s41, 4096
    buffer_load_dwordx4 v0, s[8:11], s47 offen offset:0 lds
    ds_read_b128 v[48:51], v9 offset:12288
    v_mfma_f32_32x32x16_bf16 v[32:47], v[52:55], a[180:183], v[32:47]
    buffer_load_dwordx4 v0, s[8:11], s47 offen offset:1024 lds
    buffer_load_dwordx4 v0, s[8:11], s47 offen offset:2048 lds
    buffer_load_dwordx4 v0, s[8:11], s47 offen offset:3072 lds
    s_waitcnt lgkmcnt(5)
    v_mul_f32 v132, v11, v132
    v_mul_f32 v133, v11, v133
    v_mfma_f32_32x32x16_bf16 v[16:31], a[40:43], v[56:59], v[16:31]
    ds_read_b128 v[52:55], v9 offset:13312
    v_mul_f32 v134, v11, v134
    v_mul_f32 v135, v11, v135
    s_waitcnt lgkmcnt(4)
    v_mul_f32 v136, v11, v136
    v_mfma_f32_32x32x16_bf16 v[32:47], v[56:59], a[184:187], v[32:47]
    v_mul_f32 v137, v11, v137
    v_mul_f32 v138, v11, v138
    v_mul_f32 v139, v11, v139
    s_waitcnt lgkmcnt(3)
    v_mul_f32 v140, v11, v140
    v_mfma_f32_32x32x16_bf16 v[16:31], a[44:47], v[60:63], v[16:31]
    ds_read_b128 v[56:59], v9 offset:14336
    v_mul_f32 v141, v11, v141
    v_mul_f32 v142, v11, v142
    v_mul_f32 v143, v11, v143
    v_mfma_f32_32x32x16_bf16 v[32:47], v[60:63], a[188:191], v[32:47]
    s_waitcnt lgkmcnt(3)
    v_mul_f32 v144, v11, v144
    v_mul_f32 v145, v11, v145
    v_mul_f32 v146, v11, v146
    v_mul_f32 v147, v11, v147
    s_waitcnt lgkmcnt(2)
    v_mfma_f32_32x32x16_bf16 v[16:31], a[48:51], v[48:51], v[16:31]
    ds_read_b128 v[60:63], v9 offset:15360
    s_mul_i32 s46, s34, 50331648
    s_lshl_b32 s51, s35, 18
    s_add_u32 s46, s46, s51
    v_mfma_f32_32x32x16_bf16 v[32:47], v[48:51], a[192:195], v[32:47]
    s_add_u32 m0, s59, 8192
    s_add_u32 s47, s41, 8192
    buffer_load_dwordx4 v0, s[8:11], s47 offen offset:0 lds
    s_add_u32 s46, s46, s52
    s_waitcnt vmcnt(10)
    s_cmp_lg_u32 s43, 0
    s_cselect_b64 exec, 3, 0
    buffer_store_dword v3, v185, s[8:11], s43 offen sc1
    s_mov_b64 exec, -1
    s_mov_b32 s43, 0
    s_waitcnt lgkmcnt(2)
    v_mfma_f32_32x32x16_bf16 v[16:31], a[52:55], v[52:55], v[16:31]
    s_mul_i32 s48, s36, 786432
    s_mul_i32 s18, s37, 6144
    s_add_u32 s48, s48, s18
    s_add_u32 s48, s48, 16125952
    s_add_u32 m0, s66, 4096
    s_nop 0
    buffer_load_dwordx4 v0, s[8:11], s48 offen lds
    ds_read_b128 v[48:51], v9 offset:16384
    v_mfma_f32_32x32x16_bf16 v[32:47], v[52:55], a[196:199], v[32:47]
    s_add_u32 m0, s66, s67
    s_sub_u32 s48, s48, 4096
    s_add_u32 s48, s48, s67
    buffer_load_dwordx4 v0, s[8:11], s48 offen lds
    s_waitcnt lgkmcnt(2)
    v_mfma_f32_32x32x16_bf16 v[16:31], a[56:59], v[56:59], v[16:31]
    v_cmp_eq_u32 s[76:77], 1, v2
    v_cmp_eq_u32 vcc, 2, v2
    s_cmp_eq_u64 s[76:77], -1
    s_cselect_b32 s38, 1, 0
    ds_read_b128 v[52:55], v9 offset:17408
    v_mfma_f32_32x32x16_bf16 v[32:47], v[56:59], a[200:203], v[32:47]
    s_cmp_lg_u32 s38, 0
    s_cselect_b64 exec, 1, 0
    v_mov_b32 v15, s32
    ds_write_b32 v184, v15
    v_mov_b32 v2, 2
    s_mov_b64 exec, -1
    s_waitcnt lgkmcnt(3)
    v_mfma_f32_32x32x16_bf16 v[16:31], a[60:63], v[60:63], v[16:31]
    s_add_u32 s32, s32, s38
    s_mul_i32 s38, s38, 22528
    s_add_u32 s33, s33, s38
    ds_read_b128 v[56:59], v9 offset:18432
    v_mfma_f32_32x32x16_bf16 v[32:47], v[60:63], a[204:207], v[32:47]
    s_cmp_eq_u64 vcc, 0
    s_cselect_b32 s38, s32, 0x7fff
    s_waitcnt lgkmcnt(3)
    v_mfma_f32_32x32x16_bf16 v[16:31], a[64:67], v[48:51], v[16:31]
    ds_read_b128 v[60:63], v9 offset:19456
    v_mfma_f32_32x32x16_bf16 v[32:47], v[48:51], a[208:211], v[32:47]
    s_cmp_le_u32 s38, s39
    s_cselect_b64 exec, -1, 0
    v_mov_b32 v2, 2
    buffer_load_dword v2, v1, s[8:11], s33 offen sc1
    s_mov_b64 exec, -1
    s_waitcnt lgkmcnt(3)
    v_mfma_f32_32x32x16_bf16 v[16:31], a[68:71], v[52:55], v[16:31]
    ds_read_b128 v[48:51], v9 offset:20480
    v_mfma_f32_32x32x16_bf16 v[32:47], v[52:55], a[212:215], v[32:47]
    s_waitcnt lgkmcnt(2)
    v_mfma_f32_32x32x16_bf16 v[16:31], a[72:75], v[56:59], v[16:31]
    ds_read_b128 v[52:55], v9 offset:21504
    v_mfma_f32_32x32x16_bf16 v[32:47], v[56:59], a[216:219], v[32:47]
    s_waitcnt lgkmcnt(2)
    v_mfma_f32_32x32x16_bf16 v[16:31], a[76:79], v[60:63], v[16:31]
    ds_read_b128 v[56:59], v9 offset:22528
    v_mfma_f32_32x32x16_bf16 v[32:47], v[60:63], a[220:223], v[32:47]
    s_waitcnt lgkmcnt(2)
    v_mfma_f32_32x32x16_bf16 v[16:31], a[80:83], v[48:51], v[16:31]
    ds_read_b128 v[60:63], v9 offset:23552
    v_mfma_f32_32x32x16_bf16 v[32:47], v[48:51], a[224:227], v[32:47]
    s_waitcnt lgkmcnt(2)
    v_mfma_f32_32x32x16_bf16 v[16:31], a[84:87], v[52:55], v[16:31]
    ds_read_b128 v[48:51], v9 offset:24576
    v_mfma_f32_32x32x16_bf16 v[32:47], v[52:55], a[228:231], v[32:47]
    s_waitcnt lgkmcnt(2)
    v_mfma_f32_32x32x16_bf16 v[16:31], a[88:91], v[56:59], v[16:31]
    ds_read_b128 v[52:55], v9 offset:25600
    v_mfma_f32_32x32x16_bf16 v[32:47], v[56:59], a[232:235], v[32:47]
    s_waitcnt lgkmcnt(2)
    v_mfma_f32_32x32x16_bf16 v[16:31], a[92:95], v[60:63], v[16:31]
    ds_read_b128 v[56:59], v9 offset:26624
    v_mfma_f32_32x32x16_bf16 v[32:47], v[60:63], a[236:239], v[32:47]
    s_waitcnt lgkmcnt(2)
    v_mfma_f32_32x32x16_bf16 v[16:31], a[96:99], v[48:51], v[16:31]
    ds_read_b128 v[60:63], v9 offset:27648
    v_mfma_f32_32x32x16_bf16 v[32:47], v[48:51], a[240:243], v[32:47]
    s_waitcnt lgkmcnt(2)
    v_mfma_f32_32x32x16_bf16 v[16:31], a[100:103], v[52:55], v[16:31]
    ds_read_b128 v[48:51], v9 offset:28672
    v_mfma_f32_32x32x16_bf16 v[32:47], v[52:55], a[244:247], v[32:47]
    s_waitcnt lgkmcnt(2)
    v_mfma_f32_32x32x16_bf16 v[16:31], a[104:107], v[56:59], v[16:31]
    ds_read_b128 v[52:55], v9 offset:29696
    v_mfma_f32_32x32x16_bf16 v[32:47], v[56:59], a[248:251], v[32:47]
    s_waitcnt lgkmcnt(2)
    v_mfma_f32_32x32x16_bf16 v[16:31], a[108:111], v[60:63], v[16:31]
    ds_read_b128 v[56:59], v9 offset:30720
    v_mfma_f32_32x32x16_bf16 v[32:47], v[60:63], a[252:255], v[32:47]
    s_waitcnt lgkmcnt(2)
    v_mfma_f32_32x32x16_bf16 v[16:31], a[112:115], v[48:51], v[16:31]
    ds_read_b128 v[60:63], v9 offset:31744
    v_mfma_f32_32x32x16_bf16 v[32:47], v[48:51], v[152:155], v[32:47]
    s_waitcnt lgkmcnt(2)
    v_mfma_f32_32x32x16_bf16 v[16:31], a[116:119], v[52:55], v[16:31]
    ds_read_b128 v[48:51], v9 offset:32768
    v_mfma_f32_32x32x16_bf16 v[32:47], v[52:55], v[156:159], v[32:47]
    s_waitcnt lgkmcnt(2)
    v_mfma_f32_32x32x16_bf16 v[16:31], a[120:123], v[56:59], v[16:31]
    ds_read_b128 v[52:55], v9 offset:33792
    v_mfma_f32_32x32x16_bf16 v[32:47], v[56:59], v[160:163], v[32:47]
    s_waitcnt lgkmcnt(2)
    v_mfma_f32_32x32x16_bf16 v[16:31], a[124:127], v[60:63], v[16:31]
    v_cmp_eq_u32 s[76:77], 1, v2
    v_cmp_eq_u32 vcc, 2, v2
    s_cmp_eq_u64 s[76:77], -1
    s_cselect_b32 s38, 1, 0
    ds_read_b128 v[56:59], v9 offset:34816
    v_mfma_f32_32x32x16_bf16 v[32:47], v[60:63], v[164:167], v[32:47]
    s_cmp_lg_u32 s38, 0
    s_cselect_b64 exec, 1, 0
    v_mov_b32 v15, s32
    ds_write_b32 v184, v15
    v_mov_b32 v2, 2
    s_mov_b64 exec, -1
    s_waitcnt lgkmcnt(3)
    v_mfma_f32_32x32x16_bf16 v[16:31], a[128:131], v[48:51], v[16:31]
    s_add_u32 s32, s32, s38
    s_mul_i32 s38, s38, 22528
    s_add_u32 s33, s33, s38
    ds_read_b128 v[60:63], v9 offset:35840
    s_waitcnt lgkmcnt(3)
    v_mfma_f32_32x32x16_bf16 v[16:31], a[132:135], v[52:55], v[16:31]
    s_cmp_eq_u64 vcc, 0
    s_cselect_b32 s38, s32, 0x7fff
    s_waitcnt lgkmcnt(2)
    v_mfma_f32_32x32x16_bf16 v[16:31], a[136:139], v[56:59], v[16:31]
    s_cmp_le_u32 s38, s39
    s_cselect_b64 exec, -1, 0
    v_mov_b32 v2, 2
    buffer_load_dword v2, v1, s[8:11], s33 offen sc1
    s_mov_b64 exec, -1
    s_waitcnt lgkmcnt(0)
    v_mfma_f32_32x32x16_bf16 v[16:31], a[140:143], v[60:63], v[16:31]
    v_mfma_f32_32x32x16_bf16 v[32:47], v[48:51], v[168:171], v[32:47]
    v_mfma_f32_32x32x16_bf16 v[32:47], v[52:55], v[172:175], v[32:47]
    v_fma_f32 v16, v16, v148, -v100
    v_fma_f32 v24, v24, v148, -v108
    v_fma_f32 v17, v17, v148, -v101
    v_fma_f32 v25, v25, v148, -v109
    v_fma_f32 v18, v18, v148, -v102
    v_mfma_f32_32x32x16_bf16 v[32:47], v[56:59], v[176:179], v[32:47]
    v_fma_f32 v26, v26, v148, -v110
    v_fma_f32 v19, v19, v148, -v103
    v_fma_f32 v27, v27, v148, -v111
    v_cvt_pk_bf16_f32 v188, v16, v24
    v_cvt_pk_bf16_f32 v189, v17, v25
    v_cvt_pk_bf16_f32 v190, v18, v26
    v_mfma_f32_32x32x16_bf16 v[32:47], v[60:63], v[180:183], v[32:47]
    v_cvt_pk_bf16_f32 v191, v19, v27
    buffer_store_dwordx4 v[188:191], v14, s[8:11], s46 offen offset:0 sc1
    v_fma_f32 v20, v20, v148, -v104
    v_fma_f32 v28, v28, v148, -v112
    v_fma_f32 v21, v21, v148, -v105
    v_fma_f32 v29, v29, v148, -v113
    v_fma_f32 v22, v22, v148, -v106
    v_fma_f32 v30, v30, v148, -v114
    v_fma_f32 v23, v23, v148, -v107
    v_fma_f32 v31, v31, v148, -v115
    v_cvt_pk_bf16_f32 v192, v20, v28
    v_cvt_pk_bf16_f32 v193, v21, v29
    v_cvt_pk_bf16_f32 v194, v22, v30
    v_cvt_pk_bf16_f32 v195, v23, v31
    buffer_store_dwordx4 v[192:195], v14, s[8:11], s46 offen offset:512 sc1
    s_add_u32 s51, s46, 16777216
    v_pk_fma_f32 v[32:33], v[32:33], v[116:117], v[132:133] neg_lo:[0,0,1] neg_hi:[0,0,1]
    v_pk_fma_f32 v[34:35], v[34:35], v[118:119], v[134:135] neg_lo:[0,0,1] neg_hi:[0,0,1]
    v_pk_fma_f32 v[36:37], v[36:37], v[120:121], v[136:137] neg_lo:[0,0,1] neg_hi:[0,0,1]
    v_pk_fma_f32 v[38:39], v[38:39], v[122:123], v[138:139] neg_lo:[0,0,1] neg_hi:[0,0,1]
    v_pk_fma_f32 v[40:41], v[40:41], v[124:125], v[140:141] neg_lo:[0,0,1] neg_hi:[0,0,1]
    v_pk_fma_f32 v[42:43], v[42:43], v[126:127], v[142:143] neg_lo:[0,0,1] neg_hi:[0,0,1]
    v_pk_fma_f32 v[44:45], v[44:45], v[128:129], v[144:145] neg_lo:[0,0,1] neg_hi:[0,0,1]
    v_pk_fma_f32 v[46:47], v[46:47], v[130:131], v[146:147] neg_lo:[0,0,1] neg_hi:[0,0,1]
    v_cvt_pk_bf16_f32 v196, v32, v33
    v_cvt_pk_bf16_f32 v197, v34, v35
    v_cvt_pk_bf16_f32 v198, v40, v41
    v_cvt_pk_bf16_f32 v199, v42, v43
    buffer_store_dwordx4 v[196:199], v14, s[8:11], s51 offen offset:0 sc1
    v_cvt_pk_bf16_f32 v200, v36, v37
    v_cvt_pk_bf16_f32 v201, v38, v39
    v_cvt_pk_bf16_f32 v202, v44, v45
    v_cvt_pk_bf16_f32 v203, v46, v47
    buffer_store_dwordx4 v[200:203], v14, s[8:11], s51 offen offset:512 sc1
    s_mul_i32 s43, s57, 22528
    s_add_u32 s43, s43, s49
    s_branch LpKV_head
LpKV_f_4:
    v_mfma_f32_32x32x16_bf16 v[16:31], a[76:79], v[60:63], v[16:31]
    s_add_u32 m0, s59, 0
    s_add_u32 s47, s41, 0
    buffer_load_dwordx4 v0, s[8:11], s47 offen offset:0 lds
    ds_read_b128 v[56:59], v9 offset:22528
    v_mfma_f32_32x32x16_bf16 v[32:47], v[60:63], a[220:223], v[32:47]
    s_waitcnt lgkmcnt(2)
    v_mfma_f32_32x32x16_bf16 v[16:31], a[80:83], v[48:51], v[16:31]
    buffer_load_dwordx4 v0, s[8:11], s47 offen offset:1024 lds
    ds_read_b128 v[60:63], v9 offset:23552
    v_mfma_f32_32x32x16_bf16 v[32:47], v[48:51], a[224:227], v[32:47]
    s_waitcnt lgkmcnt(2)
    v_mfma_f32_32x32x16_bf16 v[16:31], a[84:87], v[52:55], v[16:31]
    buffer_load_dwordx4 v0, s[8:11], s47 offen offset:2048 lds
    ds_read_b128 v[48:51], v9 offset:24576
    v_mfma_f32_32x32x16_bf16 v[32:47], v[52:55], a[228:231], v[32:47]
    s_waitcnt lgkmcnt(2)
    v_mfma_f32_32x32x16_bf16 v[16:31], a[88:91], v[56:59], v[16:31]
    buffer_load_dwordx4 v0, s[8:11], s47 offen offset:3072 lds
    ds_read_b128 v[52:55], v9 offset:25600
    v_mfma_f32_32x32x16_bf16 v[32:47], v[56:59], a[232:235], v[32:47]
    s_waitcnt lgkmcnt(2)
    v_mfma_f32_32x32x16_bf16 v[16:31], a[92:95], v[60:63], v[16:31]
    s_add_u32 m0, s59, 4096
    s_add_u32 s47, s41, 4096
    buffer_load_dwordx4 v0, s[8:11], s47 offen offset:0 lds
    ds_read_b128 v[56:59], v9 offset:26624
    v_mfma_f32_32x32x16_bf16 v[32:47], v[60:63], a[236:239], v[32:47]
    s_waitcnt lgkmcnt(2)
    v_mfma_f32_32x32x16_bf16 v[16:31], a[96:99], v[48:51], v[16:31]
    buffer_load_dwordx4 v0, s[8:11], s47 offen offset:1024 lds
    ds_read_b128 v[60:63], v9 offset:27648
    v_mfma_f32_32x32x16_bf16 v[32:47], v[48:51], a[240:243], v[32:47]
    s_waitcnt lgkmcnt(2)
    v_mfma_f32_32x32x16_bf16 v[16:31], a[100:103], v[52:55], v[16:31]
    buffer_load_dwordx4 v0, s[8:11], s47 offen offset:2048 lds
    ds_read_b128 v[48:51], v9 offset:28672
    v_mfma_f32_32x32x16_bf16 v[32:47], v[52:55], a[244:247], v[32:47]
    s_waitcnt lgkmcnt(2)
    v_mfma_f32_32x32x16_bf16 v[16:31], a[104:107], v[56:59], v[16:31]
    buffer_load_dwordx4 v0, s[8:11], s47 offen offset:3072 lds
    ds_read_b128 v[52:55], v9 offset:29696
    v_mfma_f32_32x32x16_bf16 v[32:47], v[56:59], a[248:251], v[32:47]
    s_waitcnt lgkmcnt(2)
    v_mfma_f32_32x32x16_bf16 v[16:31], a[108:111], v[60:63], v[16:31]
    s_add_u32 m0, s59, 8192
    s_add_u32 s47, s41, 8192
    buffer_load_dwordx4 v0, s[8:11], s47 offen offset:0 lds
    ds_read_b128 v[56:59], v9 offset:30720
    v_mfma_f32_32x32x16_bf16 v[32:47], v[60:63], a[252:255], v[32:47]
    s_waitcnt lgkmcnt(2)
    v_mfma_f32_32x32x16_bf16 v[16:31], a[112:115], v[48:51], v[16:31]
    s_mul_i32 s48, s36, 786432
    s_mul_i32 s18, s37, 6144
    s_add_u32 s48, s48, s18
    s_add_u32 s48, s48, 16125952
    s_add_u32 m0, s66, 4096
    s_nop 0
    buffer_load_dwordx4 v0, s[8:11], s48 offen lds
    ds_read_b128 v[60:63], v9 offset:31744
    v_mfma_f32_32x32x16_bf16 v[32:47], v[48:51], v[152:155], v[32:47]
    s_waitcnt lgkmcnt(2)
    v_mfma_f32_32x32x16_bf16 v[16:31], a[116:119], v[52:55], v[16:31]
    s_add_u32 m0, s66, s67
    s_sub_u32 s48, s48, 4096
    s_add_u32 s48, s48, s67
    buffer_load_dwordx4 v0, s[8:11], s48 offen lds
    ds_read_b128 v[48:51], v9 offset:32768
    v_mfma_f32_32x32x16_bf16 v[32:47], v[52:55], v[156:159], v[32:47]
    s_waitcnt lgkmcnt(2)
    v_mfma_f32_32x32x16_bf16 v[16:31], a[120:123], v[56:59], v[16:31]
    ds_read_b128 v[52:55], v9 offset:33792
    v_mfma_f32_32x32x16_bf16 v[32:47], v[56:59], v[160:163], v[32:47]
    s_waitcnt lgkmcnt(2)
    v_mfma_f32_32x32x16_bf16 v[16:31], a[124:127], v[60:63], v[16:31]
    v_cmp_eq_u32 s[76:77], 1, v2
    v_cmp_eq_u32 vcc, 2, v2
    s_cmp_eq_u64 s[76:77], -1
    s_cselect_b32 s38, 1, 0
    ds_read_b128 v[56:59], v9 offset:34816
    v_mfma_f32_32x32x16_bf16 v[32:47], v[60:63], v[164:167], v[32:47]
    s_cmp_lg_u32 s38, 0
    s_cselect_b64 exec, 1, 0
    v_mov_b32 v15, s32
    ds_write_b32 v184, v15
    v_mov_b32 v2, 2
    s_mov_b64 exec, -1
    s_waitcnt lgkmcnt(3)
    v_mfma_f32_32x32x16_bf16 v[16:31], a[128:131], v[48:51], v[16:31]
    s_add_u32 s32, s32, s38
    s_mul_i32 s38, s38, 22528
    s_add_u32 s33, s33, s38
    ds_read_b128 v[60:63], v9 offset:35840
    s_waitcnt lgkmcnt(3)
    v_mfma_f32_32x32x16_bf16 v[16:31], a[132:135], v[52:55], v[16:31]
    s_cmp_eq_u64 vcc, 0
    s_cselect_b32 s38, s32, 0x7fff
    s_waitcnt lgkmcnt(2)
    v_mfma_f32_32x32x16_bf16 v[16:31], a[136:139], v[56:59], v[16:31]
    s_cmp_le_u32 s38, s39
    s_cselect_b64 exec, -1, 0
    v_mov_b32 v2, 2
    buffer_load_dword v2, v1, s[8:11], s33 offen sc1
    s_mov_b64 exec, -1
    s_waitcnt lgkmcnt(0)
    v_mfma_f32_32x32x16_bf16 v[16:31], a[140:143], v[60:63], v[16:31]
    v_mfma_f32_32x32x16_bf16 v[32:47], v[48:51], v[168:171], v[32:47]
    v_mfma_f32_32x32x16_bf16 v[32:47], v[52:55], v[172:175], v[32:47]
    v_fma_f32 v16, v16, v148, -v100
    v_fma_f32 v24, v24, v148, -v108
    v_fma_f32 v17, v17, v148, -v101
    v_fma_f32 v25, v25, v148, -v109
    v_fma_f32 v18, v18, v148, -v102
    v_mfma_f32_32x32x16_bf16 v[32:47], v[56:59], v[176:179], v[32:47]
    v_fma_f32 v26, v26, v148, -v110
    v_fma_f32 v19, v19, v148, -v103
    v_fma_f32 v27, v27, v148, -v111
    v_cvt_pk_bf16_f32 v188, v16, v24
    v_cvt_pk_bf16_f32 v189, v17, v25
    v_cvt_pk_bf16_f32 v190, v18, v26
    v_mfma_f32_32x32x16_bf16 v[32:47], v[60:63], v[180:183], v[32:47]
    v_cvt_pk_bf16_f32 v191, v19, v27
    buffer_store_dwordx4 v[188:191], v14, s[8:11], s46 offen offset:0 sc1
    v_fma_f32 v20, v20, v148, -v104
    v_fma_f32 v28, v28, v148, -v112
    v_fma_f32 v21, v21, v148, -v105
    v_fma_f32 v29, v29, v148, -v113
    v_fma_f32 v22, v22, v148, -v106
    v_fma_f32 v30, v30, v148, -v114
    v_fma_f32 v23, v23, v148, -v107
    v_fma_f32 v31, v31, v148, -v115
    v_cvt_pk_bf16_f32 v192, v20, v28
    v_cvt_pk_bf16_f32 v193, v21, v29
    v_cvt_pk_bf16_f32 v194, v22, v30
    v_cvt_pk_bf16_f32 v195, v23, v31
    buffer_store_dwordx4 v[192:195], v14, s[8:11], s46 offen offset:512 sc1
    s_add_u32 s51, s46, 16777216
    v_pk_fma_f32 v[32:33], v[32:33], v[116:117], v[132:133] neg_lo:[0,0,1] neg_hi:[0,0,1]
    v_pk_fma_f32 v[34:35], v[34:35], v[118:119], v[134:135] neg_lo:[0,0,1] neg_hi:[0,0,1]
    v_pk_fma_f32 v[36:37], v[36:37], v[120:121], v[136:137] neg_lo:[0,0,1] neg_hi:[0,0,1]
    v_pk_fma_f32 v[38:39], v[38:39], v[122:123], v[138:139] neg_lo:[0,0,1] neg_hi:[0,0,1]
    v_pk_fma_f32 v[40:41], v[40:41], v[124:125], v[140:141] neg_lo:[0,0,1] neg_hi:[0,0,1]
    v_pk_fma_f32 v[42:43], v[42:43], v[126:127], v[142:143] neg_lo:[0,0,1] neg_hi:[0,0,1]
    v_pk_fma_f32 v[44:45], v[44:45], v[128:129], v[144:145] neg_lo:[0,0,1] neg_hi:[0,0,1]
    v_pk_fma_f32 v[46:47], v[46:47], v[130:131], v[146:147] neg_lo:[0,0,1] neg_hi:[0,0,1]
    v_cvt_pk_bf16_f32 v196, v32, v33
    v_cvt_pk_bf16_f32 v197, v34, v35
    v_cvt_pk_bf16_f32 v198, v40, v41
    v_cvt_pk_bf16_f32 v199, v42, v43
    buffer_store_dwordx4 v[196:199], v14, s[8:11], s51 offen offset:0 sc1
    v_cvt_pk_bf16_f32 v200, v36, v37
    v_cvt_pk_bf16_f32 v201, v38, v39
    v_cvt_pk_bf16_f32 v202, v44, v45
    v_cvt_pk_bf16_f32 v203, v46, v47
    buffer_store_dwordx4 v[200:203], v14, s[8:11], s51 offen offset:512 sc1
    s_mul_i32 s43, s57, 22528
    s_add_u32 s43, s43, s49
    s_branch LpKV_head
LpKV_none:
    ds_read_b32 v15, v184
    s_waitcnt lgkmcnt(0)
    v_readfirstlane_b32 s17, v15
    s_nop 0
    s_cmp_lt_i32 s17, s37
    s_cbranch_scc1 LpKV_nopost
    s_add_u32 m0, s59, 0
    s_add_u32 s47, s41, 0
    buffer_load_dwordx4 v0, s[8:11], s47 offen offset:0 lds
    buffer_load_dwordx4 v0, s[8:11], s47 offen offset:1024 lds
    buffer_load_dwordx4 v0, s[8:11], s47 offen offset:2048 lds
    buffer_load_dwordx4 v0, s[8:11], s47 offen offset:3072 lds
    s_add_u32 m0, s59, 4096
    s_add_u32 s47, s41, 4096
    buffer_load_dwordx4 v0, s[8:11], s47 offen offset:0 lds
    buffer_load_dwordx4 v0, s[8:11], s47 offen offset:1024 lds
    buffer_load_dwordx4 v0, s[8:11], s47 offen offset:2048 lds
    buffer_load_dwordx4 v0, s[8:11], s47 offen offset:3072 lds
    s_add_u32 m0, s59, 8192
    s_add_u32 s47, s41, 8192
    buffer_load_dwordx4 v0, s[8:11], s47 offen offset:0 lds
    s_mul_i32 s48, s36, 786432
    s_mul_i32 s18, s37, 6144
    s_add_u32 s48, s48, s18
    s_add_u32 s48, s48, 16125952
    s_add_u32 m0, s66, 4096
    s_nop 0
    buffer_load_dwordx4 v0, s[8:11], s48 offen lds
    s_add_u32 m0, s66, s67
    s_sub_u32 s48, s48, 4096
    s_add_u32 s48, s48, s67
    buffer_load_dwordx4 v0, s[8:11], s48 offen lds
    s_waitcnt vmcnt(11)
    s_cmp_lg_u32 s43, 0
    s_cselect_b64 exec, 3, 0
    buffer_store_dword v3, v185, s[8:11], s43 offen sc1
    s_mov_b64 exec, -1
    s_mov_b32 s43, 0
    s_waitcnt vmcnt(1) lgkmcnt(0)
    s_branch LpKV_head2
LpKV_nopost:
    s_waitcnt vmcnt(0)
    s_cmp_lg_u32 s43, 0
    s_cselect_b64 exec, 3, 0
    buffer_store_dword v3, v185, s[8:11], s43 offen sc1
    s_mov_b64 exec, -1
    s_mov_b32 s43, 0
    s_cmp_ge_u32 s37, 64
    s_cbranch_scc1 LpKV_end
LpKV_wait:
    s_mov_b32 s16, 0
    s_cmp_lg_u32 s14, 0
    s_cbranch_scc1 LpKV_wl
LpKV_wp:
    buffer_load_dword v2, v1, s[8:11], s60 offen sc1
    s_add_u32 s16, s16, 1
    s_cmp_gt_u32 s16, 100000
    s_cbranch_scc1 LpKV_giveup
    s_waitcnt vmcnt(0)
    v_cmp_eq_u32 vcc, 0, v2
    s_nop 0
    s_cbranch_vccz LpKV_wok
    s_sleep 4
    s_branch LpKV_wp
LpKV_giveup:
    v_mov_b32 v5, -2
    ds_write_b32 v184, v5
    s_waitcnt lgkmcnt(0)
    s_branch L_role_p_abort
LpKV_wok:
    v_mov_b32 v5, s37
    ds_write_b32 v184, v5
    s_branch LpKV_go
LpKV_wl:
    ds_read_b32 v15, v184
    s_add_u32 s16, s16, 1
    s_cmp_gt_u32 s16, 1600000
    s_cbranch_scc1 L_role_p_abort
    s_waitcnt lgkmcnt(0)
    v_readfirstlane_b32 s17, v15
    s_nop 0
    s_cmp_eq_u32 s17, -2
    s_cbranch_scc1 L_role_p_abort
    s_cmp_ge_i32 s17, s37
    s_cbranch_scc1 LpKV_go
    s_sleep 1
    s_branch LpKV_wl
LpKV_go:
    s_add_u32 m0, s59, 0
    s_add_u32 s47, s41, 0
    buffer_load_dwordx4 v0, s[8:11], s47 offen offset:0 lds
    buffer_load_dwordx4 v0, s[8:11], s47 offen offset:1024 lds
    buffer_load_dwordx4 v0, s[8:11], s47 offen offset:2048 lds
    buffer_load_dwordx4 v0, s[8:11], s47 offen offset:3072 lds
    s_add_u32 m0, s59, 4096
    s_add_u32 s47, s41, 4096
    buffer_load_dwordx4 v0, s[8:11], s47 offen offset:0 lds
    buffer_load_dwordx4 v0, s[8:11], s47 offen offset:1024 lds
    buffer_load_dwordx4 v0, s[8:11], s47 offen offset:2048 lds
    buffer_load_dwordx4 v0, s[8:11], s47 offen offset:3072 lds
    s_add_u32 m0, s59, 8192
    s_add_u32 s47, s41, 8192
    buffer_load_dwordx4 v0, s[8:11], s47 offen offset:0 lds
    s_mul_i32 s48, s36, 786432
    s_mul_i32 s18, s37, 6144
    s_add_u32 s48, s48, s18
    s_add_u32 s48, s48, 16125952
    s_add_u32 m0, s66, 4096
    s_nop 0
    buffer_load_dwordx4 v0, s[8:11], s48 offen lds
    s_add_u32 m0, s66, s67
    s_sub_u32 s48, s48, 4096
    s_add_u32 s48, s48, s67
    buffer_load_dwordx4 v0, s[8:11], s48 offen lds
    s_waitcnt vmcnt(0) lgkmcnt(0)
    s_branch LpKV_head2
LpKV_end:
    s_branch L_role_p_exit
L_role_p_abort:
    s_waitcnt lgkmcnt(0)
    s_mov_b64 exec, -1
    v_mov_b32 v0, 60
    s_lshl_b32 s5, s3, 8
    s_or_b32 s5, s5, s4
    s_or_b32 s5, s5, 0x10000
    v_mov_b32 v1, s5
    global_store_dword v0, v1, s[12:13]
    s_endpgm
L_role_p_exit:
    s_endpgm
.p2align 6
L_role_awo:
    v_and_b32 v5, 63, v0
    v_lshlrev_b32 v0, 4, v5
    v_and_b32 v7, 15, v5
    v_lshrrev_b32 v8, 4, v5
    v_min_u32 v1, 63, v5
    v_lshrrev_b32 v6, 2, v1
    v_and_b32 v1, 3, v1
    v_lshlrev_b32 v1, 2, v1
    v_lshl_add_u32 v1, v6, 7, v1
    v_mov_b32 v3, 1
    v_mov_b32 v4, 0
    s_mov_b32 s44, 0x05040100
    s_mov_b32 s45, 0x07060302
    s_load_dwordx2 s[20:21], s[0:1], 16
    s_mov_b32 s22, 663552
    s_mov_b32 s23, 0x00020000
    s_waitcnt lgkmcnt(0)
    s_and_b32 s21, s21, 0xffff
    s_cmp_ge_u32 s15, 3
    s_cselect_b32 s63, 1, 0
    s_cselect_b32 s17, 3, 0
    s_sub_u32 s15, s15, s17
    s_lshl_b32 s50, s15, 2
    s_add_u32 s50, s50, s14
    s_cmp_eq_u32 s63, 0
    s_cbranch_scc1 Lao_gate_ng
    s_cmp_lg_u32 s14, 0
    s_cbranch_scc1 Lao_gate_d
    v_mov_b32 v5, 48
    s_mov_b32 s16, 0
Lao_gate:
    global_load_dword v6, v5, s[12:13] sc1
    s_add_u32 s16, s16, 1
    s_cmp_gt_u32 s16, 100000
    s_cbranch_scc1 L_role_awo_abort
    s_waitcnt vmcnt(0)
    v_cmp_gt_u32 vcc, 32, v6
    s_nop 0
    s_cbranch_vccz Lao_gate_d
    s_sleep 100
    s_branch Lao_gate
Lao_gate_d:
    s_barrier
Lao_gate_ng:
    v_lshrrev_b32 v5, 7, v0
    v_and_b32 v6, 0x70, v0
    v_mul_u32_u24 v16, 1152, v5
    v_add_u32 v16, v16, v6
    v_lshrrev_b32 v17, 1, v5
    v_mul_u32_u24 v17, 18, v17
    v_and_b32 v5, 1, v5
    v_add_u32 v17, v17, v5
    v_add_u32 v17, 16, v17
    v_mul_u32_u24 v17, 1152, v17
    v_add_u32 v17, v17, v6
    v_lshrrev_b32 v5, 2, v7
    v_lshl_add_u32 v5, v8, 3, v5
    v_lshlrev_b32 v18, 7, v5
    v_and_b32 v5, 3, v7
    v_lshl_add_u32 v19, v5, 3, v18
    v_lshl_add_u32 v18, v5, 4, v18
    s_lshl_b32 s46, s14, 15
    v_add_u32 v18, s46, v18
    v_add_u32 v19, s46, v19
    s_mul_i32 s49, s50, 96
    s_add_u32 m0, s46, 0
    s_add_u32 s17, s49, 0
    buffer_load_dwordx4 v16, s[20:23], s17 offen lds
    s_add_u32 m0, s46, 1024
    s_add_u32 s17, s49, 9216
    buffer_load_dwordx4 v16, s[20:23], s17 offen lds
    s_add_u32 m0, s46, 2048
    s_add_u32 s17, s49, 20736
    buffer_load_dwordx4 v16, s[20:23], s17 offen lds
    s_add_u32 m0, s46, 3072
    s_add_u32 s17, s49, 29952
    buffer_load_dwordx4 v16, s[20:23], s17 offen lds
    s_add_u32 m0, s46, 4096
    s_add_u32 s17, s49, 41472
    buffer_load_dwordx4 v16, s[20:23], s17 offen lds
    s_add_u32 m0, s46, 5120
    s_add_u32 s17, s49, 50688
    buffer_load_dwordx4 v16, s[20:23], s17 offen lds
    s_add_u32 m0, s46, 6144
    s_add_u32 s17, s49, 62208
    buffer_load_dwordx4 v16, s[20:23], s17 offen lds
    s_add_u32 m0, s46, 7168
    s_add_u32 s17, s49, 71424
    buffer_load_dwordx4 v16, s[20:23], s17 offen lds
    s_add_u32 m0, s46, 8192
    s_add_u32 s17, s49, 82944
    buffer_load_dwordx4 v16, s[20:23], s17 offen lds
    s_add_u32 m0, s46, 9216
    s_add_u32 s17, s49, 92160
    buffer_load_dwordx4 v16, s[20:23], s17 offen lds
    s_add_u32 m0, s46, 10240
    s_add_u32 s17, s49, 103680
    buffer_load_dwordx4 v16, s[20:23], s17 offen lds
    s_add_u32 m0, s46, 11264
    s_add_u32 s17, s49, 112896
    buffer_load_dwordx4 v16, s[20:23], s17 offen lds
    s_add_u32 m0, s46, 12288
    s_add_u32 s17, s49, 124416
    buffer_load_dwordx4 v16, s[20:23], s17 offen lds
    s_add_u32 m0, s46, 13312
    s_add_u32 s17, s49, 133632
    buffer_load_dwordx4 v16, s[20:23], s17 offen lds
    s_add_u32 m0, s46, 14336
    s_add_u32 s17, s49, 145152
    buffer_load_dwordx4 v16, s[20:23], s17 offen lds
    s_add_u32 m0, s46, 15360
    s_add_u32 s17, s49, 154368
    buffer_load_dwordx4 v16, s[20:23], s17 offen lds
    s_add_u32 m0, s46, 16384
    s_add_u32 s17, s49, 165888
    buffer_load_dwordx4 v16, s[20:23], s17 offen lds
    s_add_u32 m0, s46, 17408
    s_add_u32 s17, s49, 175104
    buffer_load_dwordx4 v16, s[20:23], s17 offen lds
    s_add_u32 m0, s46, 18432
    s_add_u32 s17, s49, 186624
    buffer_load_dwordx4 v16, s[20:23], s17 offen lds
    s_add_u32 m0, s46, 19456
    s_add_u32 s17, s49, 195840
    buffer_load_dwordx4 v16, s[20:23], s17 offen lds
    s_add_u32 m0, s46, 20480
    s_add_u32 s17, s49, 207360
    buffer_load_dwordx4 v16, s[20:23], s17 offen lds
    s_add_u32 m0, s46, 21504
    s_add_u32 s17, s49, 216576
    buffer_load_dwordx4 v16, s[20:23], s17 offen lds
    s_add_u32 m0, s46, 22528
    s_add_u32 s17, s49, 228096
    buffer_load_dwordx4 v16, s[20:23], s17 offen lds
    s_add_u32 m0, s46, 23552
    s_add_u32 s17, s49, 237312
    buffer_load_dwordx4 v16, s[20:23], s17 offen lds
    s_add_u32 m0, s46, 24576
    s_add_u32 s17, s49, 248832
    buffer_load_dwordx4 v16, s[20:23], s17 offen lds
    s_add_u32 m0, s46, 25600
    s_add_u32 s17, s49, 258048
    buffer_load_dwordx4 v16, s[20:23], s17 offen lds
    s_add_u32 m0, s46, 26624
    s_add_u32 s17, s49, 269568
    buffer_load_dwordx4 v16, s[20:23], s17 offen lds
    s_add_u32 m0, s46, 27648
    s_add_u32 s17, s49, 278784
    buffer_load_dwordx4 v16, s[20:23], s17 offen lds
    s_add_u32 m0, s46, 28672
    s_add_u32 s17, s49, 290304
    buffer_load_dwordx4 v16, s[20:23], s17 offen lds
    s_add_u32 m0, s46, 29696
    s_add_u32 s17, s49, 299520
    buffer_load_dwordx4 v16, s[20:23], s17 offen lds
    s_add_u32 m0, s46, 30720
    s_add_u32 s17, s49, 311040
    buffer_load_dwordx4 v16, s[20:23], s17 offen lds
    s_add_u32 m0, s46, 31744
    s_add_u32 s17, s49, 320256
    buffer_load_dwordx4 v16, s[20:23], s17 offen lds
    s_waitcnt vmcnt(28)
    ds_read_b64_tr_b16 a[0:1], v18 offset:0
    ds_read_b64_tr_b16 a[2:3], v18 offset:512
    ds_read_b64_tr_b16 a[4:5], v18 offset:8
    ds_read_b64_tr_b16 a[6:7], v18 offset:520
    ds_read_b64_tr_b16 a[8:9], v19 offset:64
    ds_read_b64_tr_b16 a[10:11], v19 offset:576
    s_waitcnt lgkmcnt(0)
    s_add_u32 m0, s46, 0
    s_add_u32 s17, s49, 331776
    buffer_load_dwordx4 v16, s[20:23], s17 offen lds
    s_add_u32 m0, s46, 1024
    s_add_u32 s17, s49, 340992
    buffer_load_dwordx4 v16, s[20:23], s17 offen lds
    s_add_u32 m0, s46, 2048
    s_add_u32 s17, s49, 352512
    buffer_load_dwordx4 v16, s[20:23], s17 offen lds
    s_add_u32 m0, s46, 3072
    s_add_u32 s17, s49, 361728
    buffer_load_dwordx4 v16, s[20:23], s17 offen lds
    s_waitcnt vmcnt(28)
    ds_read_b64_tr_b16 a[12:13], v18 offset:4096
    ds_read_b64_tr_b16 a[14:15], v18 offset:4608
    ds_read_b64_tr_b16 a[16:17], v18 offset:4104
    ds_read_b64_tr_b16 a[18:19], v18 offset:4616
    ds_read_b64_tr_b16 a[20:21], v19 offset:4160
    ds_read_b64_tr_b16 a[22:23], v19 offset:4672
    s_waitcnt lgkmcnt(0)
    s_add_u32 m0, s46, 4096
    s_add_u32 s17, s49, 373248
    buffer_load_dwordx4 v16, s[20:23], s17 offen lds
    s_add_u32 m0, s46, 5120
    s_add_u32 s17, s49, 382464
    buffer_load_dwordx4 v16, s[20:23], s17 offen lds
    s_add_u32 m0, s46, 6144
    s_add_u32 s17, s49, 393984
    buffer_load_dwordx4 v16, s[20:23], s17 offen lds
    s_add_u32 m0, s46, 7168
    s_add_u32 s17, s49, 403200
    buffer_load_dwordx4 v16, s[20:23], s17 offen lds
    s_waitcnt vmcnt(28)
    ds_read_b64_tr_b16 a[24:25], v18 offset:8192
    ds_read_b64_tr_b16 a[26:27], v18 offset:8704
    ds_read_b64_tr_b16 a[28:29], v18 offset:8200
    ds_read_b64_tr_b16 a[30:31], v18 offset:8712
    ds_read_b64_tr_b16 a[32:33], v19 offset:8256
    ds_read_b64_tr_b16 a[34:35], v19 offset:8768
    s_waitcnt lgkmcnt(0)
    s_add_u32 m0, s46, 8192
    s_add_u32 s17, s49, 414720
    buffer_load_dwordx4 v16, s[20:23], s17 offen lds
    s_add_u32 m0, s46, 9216
    s_add_u32 s17, s49, 423936
    buffer_load_dwordx4 v16, s[20:23], s17 offen lds
    s_add_u32 m0, s46, 10240
    s_add_u32 s17, s49, 435456
    buffer_load_dwordx4 v16, s[20:23], s17 offen lds
    s_add_u32 m0, s46, 11264
    s_add_u32 s17, s49, 444672
    buffer_load_dwordx4 v16, s[20:23], s17 offen lds
    s_waitcnt vmcnt(28)
    ds_read_b64_tr_b16 a[36:37], v18 offset:12288
    ds_read_b64_tr_b16 a[38:39], v18 offset:12800
    ds_read_b64_tr_b16 a[40:41], v18 offset:12296
    ds_read_b64_tr_b16 a[42:43], v18 offset:12808
    ds_read_b64_tr_b16 a[44:45], v19 offset:12352
    ds_read_b64_tr_b16 a[46:47], v19 offset:12864
    s_waitcnt lgkmcnt(0)
    s_add_u32 m0, s46, 12288
    s_add_u32 s17, s49, 456192
    buffer_load_dwordx4 v16, s[20:23], s17 offen lds
    s_add_u32 m0, s46, 13312
    s_add_u32 s17, s49, 465408
    buffer_load_dwordx4 v16, s[20:23], s17 offen lds
    s_add_u32 m0, s46, 14336
    s_add_u32 s17, s49, 476928
    buffer_load_dwordx4 v16, s[20:23], s17 offen lds
    s_add_u32 m0, s46, 15360
    s_add_u32 s17, s49, 486144
    buffer_load_dwordx4 v16, s[20:23], s17 offen lds
    s_waitcnt vmcnt(28)
    ds_read_b64_tr_b16 a[48:49], v18 offset:16384
    ds_read_b64_tr_b16 a[50:51], v18 offset:16896
    ds_read_b64_tr_b16 a[52:53], v18 offset:16392
    ds_read_b64_tr_b16 a[54:55], v18 offset:16904
    ds_read_b64_tr_b16 a[56:57], v19 offset:16448
    ds_read_b64_tr_b16 a[58:59], v19 offset:16960
    s_waitcnt lgkmcnt(0)
    s_add_u32 m0, s46, 16384
    s_add_u32 s17, s49, 497664
    buffer_load_dwordx4 v16, s[20:23], s17 offen lds
    s_add_u32 m0, s46, 17408
    s_add_u32 s17, s49, 506880
    buffer_load_dwordx4 v16, s[20:23], s17 offen lds
    s_add_u32 m0, s46, 18432
    s_add_u32 s17, s49, 518400
    buffer_load_dwordx4 v16, s[20:23], s17 offen lds
    s_add_u32 m0, s46, 19456
    s_add_u32 s17, s49, 527616
    buffer_load_dwordx4 v16, s[20:23], s17 offen lds
    s_waitcnt vmcnt(28)
    ds_read_b64_tr_b16 a[60:61], v18 offset:20480
    ds_read_b64_tr_b16 a[62:63], v18 offset:20992
    ds_read_b64_tr_b16 a[64:65], v18 offset:20488
    ds_read_b64_tr_b16 a[66:67], v18 offset:21000
    ds_read_b64_tr_b16 a[68:69], v19 offset:20544
    ds_read_b64_tr_b16 a[70:71], v19 offset:21056
    s_waitcnt lgkmcnt(0)
    s_add_u32 m0, s46, 20480
    s_add_u32 s17, s49, 539136
    buffer_load_dwordx4 v16, s[20:23], s17 offen lds
    s_add_u32 m0, s46, 21504
    s_add_u32 s17, s49, 548352
    buffer_load_dwordx4 v16, s[20:23], s17 offen lds
    s_add_u32 m0, s46, 22528
    s_add_u32 s17, s49, 559872
    buffer_load_dwordx4 v16, s[20:23], s17 offen lds
    s_add_u32 m0, s46, 23552
    s_add_u32 s17, s49, 569088
    buffer_load_dwordx4 v16, s[20:23], s17 offen lds
    s_waitcnt vmcnt(28)
    ds_read_b64_tr_b16 a[72:73], v18 offset:24576
    ds_read_b64_tr_b16 a[74:75], v18 offset:25088
    ds_read_b64_tr_b16 a[76:77], v18 offset:24584
    ds_read_b64_tr_b16 a[78:79], v18 offset:25096
    ds_read_b64_tr_b16 a[80:81], v19 offset:24640
    ds_read_b64_tr_b16 a[82:83], v19 offset:25152
    s_waitcnt lgkmcnt(0)
    s_add_u32 m0, s46, 24576
    s_add_u32 s17, s49, 580608
    buffer_load_dwordx4 v16, s[20:23], s17 offen lds
    s_add_u32 m0, s46, 25600
    s_add_u32 s17, s49, 589824
    buffer_load_dwordx4 v16, s[20:23], s17 offen lds
    s_add_u32 m0, s46, 26624
    s_add_u32 s17, s49, 601344
    buffer_load_dwordx4 v16, s[20:23], s17 offen lds
    s_add_u32 m0, s46, 27648
    s_add_u32 s17, s49, 610560
    buffer_load_dwordx4 v16, s[20:23], s17 offen lds
    s_waitcnt vmcnt(28)
    ds_read_b64_tr_b16 a[84:85], v18 offset:28672
    ds_read_b64_tr_b16 a[86:87], v18 offset:29184
    ds_read_b64_tr_b16 a[88:89], v18 offset:28680
    ds_read_b64_tr_b16 a[90:91], v18 offset:29192
    ds_read_b64_tr_b16 a[92:93], v19 offset:28736
    ds_read_b64_tr_b16 a[94:95], v19 offset:29248
    s_waitcnt lgkmcnt(0)
    s_add_u32 m0, s46, 28672
    s_add_u32 s17, s49, 622080
    buffer_load_dwordx4 v16, s[20:23], s17 offen lds
    s_add_u32 m0, s46, 29696
    s_add_u32 s17, s49, 631296
    buffer_load_dwordx4 v16, s[20:23], s17 offen lds
    s_add_u32 m0, s46, 30720
    s_add_u32 s17, s49, 642816
    buffer_load_dwordx4 v16, s[20:23], s17 offen lds
    s_add_u32 m0, s46, 31744
    s_add_u32 s17, s49, 652032
    buffer_load_dwordx4 v16, s[20:23], s17 offen lds
    s_waitcnt vmcnt(28)
    ds_read_b64_tr_b16 a[96:97], v18 offset:0
    ds_read_b64_tr_b16 a[98:99], v18 offset:512
    ds_read_b64_tr_b16 a[100:101], v18 offset:8
    ds_read_b64_tr_b16 a[102:103], v18 offset:520
    ds_read_b64_tr_b16 a[104:105], v19 offset:64
    ds_read_b64_tr_b16 a[106:107], v19 offset:576
    s_waitcnt lgkmcnt(0)
    s_add_u32 m0, s46, 0
    s_add_u32 s17, s49, 0
    buffer_load_dwordx4 v17, s[20:23], s17 offen lds
    s_add_u32 m0, s46, 1024
    s_add_u32 s17, s49, 82944
    buffer_load_dwordx4 v17, s[20:23], s17 offen lds
    s_add_u32 m0, s46, 2048
    s_add_u32 s17, s49, 165888
    buffer_load_dwordx4 v17, s[20:23], s17 offen lds
    s_add_u32 m0, s46, 3072
    s_add_u32 s17, s49, 248832
    buffer_load_dwordx4 v17, s[20:23], s17 offen lds
    s_waitcnt vmcnt(28)
    ds_read_b64_tr_b16 a[108:109], v18 offset:4096
    ds_read_b64_tr_b16 a[110:111], v18 offset:4608
    ds_read_b64_tr_b16 a[112:113], v18 offset:4104
    ds_read_b64_tr_b16 a[114:115], v18 offset:4616
    ds_read_b64_tr_b16 a[116:117], v19 offset:4160
    ds_read_b64_tr_b16 a[118:119], v19 offset:4672
    s_waitcnt lgkmcnt(0)
    s_add_u32 m0, s46, 4096
    s_add_u32 s17, s49, 331776
    buffer_load_dwordx4 v17, s[20:23], s17 offen lds
    s_add_u32 m0, s46, 5120
    s_add_u32 s17, s49, 414720
    buffer_load_dwordx4 v17, s[20:23], s17 offen lds
    s_add_u32 m0, s46, 6144
    s_add_u32 s17, s49, 497664
    buffer_load_dwordx4 v17, s[20:23], s17 offen lds
    s_add_u32 m0, s46, 7168
    s_add_u32 s17, s49, 580608
    buffer_load_dwordx4 v17, s[20:23], s17 offen lds
    s_waitcnt vmcnt(28)
    ds_read_b64_tr_b16 a[120:121], v18 offset:8192
    ds_read_b64_tr_b16 a[122:123], v18 offset:8704
    ds_read_b64_tr_b16 a[124:125], v18 offset:8200
    ds_read_b64_tr_b16 a[126:127], v18 offset:8712
    ds_read_b64_tr_b16 a[128:129], v19 offset:8256
    ds_read_b64_tr_b16 a[130:131], v19 offset:8768
    s_waitcnt lgkmcnt(0)
    s_waitcnt vmcnt(24)
    ds_read_b64_tr_b16 a[132:133], v18 offset:12288
    ds_read_b64_tr_b16 a[134:135], v18 offset:12800
    ds_read_b64_tr_b16 a[136:137], v18 offset:12296
    ds_read_b64_tr_b16 a[138:139], v18 offset:12808
    ds_read_b64_tr_b16 a[140:141], v19 offset:12352
    ds_read_b64_tr_b16 a[142:143], v19 offset:12864
    s_waitcnt lgkmcnt(0)
    s_waitcnt vmcnt(20)
    ds_read_b64_tr_b16 a[144:145], v18 offset:16384
    ds_read_b64_tr_b16 a[146:147], v18 offset:16896
    ds_read_b64_tr_b16 a[148:149], v18 offset:16392
    ds_read_b64_tr_b16 a[150:151], v18 offset:16904
    ds_read_b64_tr_b16 a[152:153], v19 offset:16448
    ds_read_b64_tr_b16 a[154:155], v19 offset:16960
    s_waitcnt lgkmcnt(0)
    s_waitcnt vmcnt(16)
    ds_read_b64_tr_b16 a[156:157], v18 offset:20480
    ds_read_b64_tr_b16 a[158:159], v18 offset:20992
    ds_read_b64_tr_b16 a[160:161], v18 offset:20488
    ds_read_b64_tr_b16 a[162:163], v18 offset:21000
    ds_read_b64_tr_b16 a[164:165], v19 offset:20544
    ds_read_b64_tr_b16 a[166:167], v19 offset:21056
    s_waitcnt lgkmcnt(0)
    s_waitcnt vmcnt(12)
    ds_read_b64_tr_b16 a[168:169], v18 offset:24576
    ds_read_b64_tr_b16 a[170:171], v18 offset:25088
    ds_read_b64_tr_b16 a[172:173], v18 offset:24584
    ds_read_b64_tr_b16 a[174:175], v18 offset:25096
    ds_read_b64_tr_b16 a[176:177], v19 offset:24640
    ds_read_b64_tr_b16 a[178:179], v19 offset:25152
    s_waitcnt lgkmcnt(0)
    s_waitcnt vmcnt(8)
    ds_read_b64_tr_b16 a[180:181], v18 offset:28672
    ds_read_b64_tr_b16 a[182:183], v18 offset:29184
    ds_read_b64_tr_b16 a[184:185], v18 offset:28680
    ds_read_b64_tr_b16 a[186:187], v18 offset:29192
    ds_read_b64_tr_b16 a[188:189], v19 offset:28736
    ds_read_b64_tr_b16 a[190:191], v19 offset:29248
    s_waitcnt lgkmcnt(0)
    s_waitcnt vmcnt(4)
    ds_read_b64_tr_b16 a[192:193], v18 offset:0
    ds_read_b64_tr_b16 a[194:195], v18 offset:512
    ds_read_b64_tr_b16 a[196:197], v18 offset:8
    ds_read_b64_tr_b16 a[198:199], v18 offset:520
    ds_read_b64_tr_b16 a[200:201], v19 offset:64
    ds_read_b64_tr_b16 a[202:203], v19 offset:576
    s_waitcnt lgkmcnt(0)
    s_waitcnt vmcnt(0)
    ds_read_b64_tr_b16 a[204:205], v18 offset:4096
    ds_read_b64_tr_b16 a[206:207], v18 offset:4608
    ds_read_b64_tr_b16 a[208:209], v18 offset:4104
    ds_read_b64_tr_b16 a[210:211], v18 offset:4616
    ds_read_b64_tr_b16 a[212:213], v19 offset:4160
    ds_read_b64_tr_b16 a[214:215], v19 offset:4672
    s_waitcnt lgkmcnt(0)
    s_barrier
    v_lshlrev_b32 v5, 4, v7
    v_lshl_add_u32 v10, v8, 9, v5
    s_mul_i32 s17, s50, 3072
    v_add_u32 v10, s17, v10
    v_lshrrev_b32 v6, 1, v8
    v_lshl_add_u32 v12, v6, 9, v5
    v_and_b32 v6, 1, v8
    v_lshl_add_u32 v12, v6, 3, v12
    s_add_u32 s17, s17, 2048
    v_add_u32 v12, s17, v12
    s_lshr_b32 s17, s50, 1
    s_lshl_b32 s17, s17, 9
    s_and_b32 s18, s50, 1
    s_lshl_b32 s18, s18, 3
    s_add_u32 s17, s17, s18
    v_add_u32 v11, s17, v5
    s_lshl_b32 s49, s15, 7
    s_lshl_b32 s17, s14, 2
    s_add_u32 s49, s49, s17
    s_add_u32 s49, s49, 3584
    s_mov_b32 s36, s63
    s_mov_b32 s34, s63
    s_mul_i32 s58, s14, 9216
    s_mul_i32 s64, s63, 2359296
    s_add_u32 s64, s64, s58
    s_add_u32 s64, s64, 17301504
    s_mul_i32 s61, s63, 1441792
    s_add_u32 s61, s61, 1536
    s_mov_b32 s37, 0
    s_mov_b32 s40, 36864
    s_mov_b32 s59, s58
    s_mov_b32 s43, 0
    s_mov_b32 s62, 1
    s_mov_b32 s28, s8
    s_mov_b32 s29, s9
    s_mov_b32 s30, 0
    s_mov_b32 s31, 0x00020000
    v_mov_b32 v184, 74752
    v_mov_b32 v5, -1
    ds_write_b32 v184, v5
    s_waitcnt lgkmcnt(0)
    s_cmp_lg_u32 s14, 0
    s_cbranch_scc1 Lawo_inia_d
    v_mov_b32 v5, 40
    s_mov_b32 s16, 0
Lawo_inia:
    global_load_dword v6, v5, s[12:13] sc1
    s_add_u32 s16, s16, 1
    s_cmp_gt_u32 s16, 100000
    s_cbranch_scc1 L_role_awo_abort
    s_waitcnt vmcnt(0)
    v_cmp_gt_u32 vcc, 128, v6
    s_nop 0
    s_cbranch_vccz Lawo_inia_d
    s_sleep 8
    s_branch Lawo_inia
Lawo_inia_d:
    s_barrier
    s_cmp_eq_u32 s63, 0
    s_cbranch_scc1 Lawo_ini_sk
    s_cmp_lg_u32 s14, 0
    s_cbranch_scc1 Lawo_inib_d
    v_mov_b32 v5, 160
    s_mov_b32 s16, 0
Lawo_inib:
    global_load_dword v6, v5, s[12:13] sc1
    s_add_u32 s16, s16, 1
    s_cmp_gt_u32 s16, 100000
    s_cbranch_scc1 L_role_awo_abort
    s_waitcnt vmcnt(0)
    v_cmp_gt_u32 vcc, 64, v6
    s_nop 0
    s_cbranch_vccz Lawo_inib_d
    s_sleep 8
    s_branch Lawo_inib
Lawo_inib_d:
    s_barrier
Lawo_ini_sk:
    s_mul_i32 s41, s37, 36864
    s_add_u32 s41, s41, s64
    s_mul_i32 s60, s37, 22528
    s_add_u32 s60, s60, s61
    s_cmp_lt_u32 s37, 64
    s_cselect_b32 s60, s60, 2883584
    s_branch Lawo_wait
Lawo_head:
    s_waitcnt vmcnt(6)
Lawo_head2:
    s_barrier
    ds_read_b32 v15, v184
    s_xor_b32 s40, s40, 36864
    s_xor_b32 s59, s59, 36864
    s_mov_b32 s35, s37
    s_lshl_b32 s57, s34, 6
    s_add_u32 s57, s57, s35
    s_add_u32 s37, s37, 1
    s_mov_b32 s39, 0
    s_mov_b32 s54, 0
    s_mul_i32 s41, s37, 36864
    s_add_u32 s41, s41, s64
    s_mul_i32 s60, s37, 22528
    s_add_u32 s60, s60, s61
    s_cmp_lt_u32 s37, 64
    s_cselect_b32 s60, s60, 2883584
    v_lshlrev_b32 v9, 9, v8
    v_lshl_add_u32 v9, v7, 4, v9
    v_add_u32 v9, s40, v9
    ds_read_b128 v[40:43], v9 offset:0
    ds_read_b128 v[44:47], v9 offset:256
    ds_read_b128 v[48:51], v9 offset:2048
    ds_read_b128 v[52:55], v9 offset:2304
    ds_read_b128 v[56:59], v9 offset:4096
    v_lshlrev_b32 v16, 16, v64
    v_and_b32 v17, 0xffff0000, v64
    v_lshlrev_b32 v18, 16, v65
    v_and_b32 v19, 0xffff0000, v65
    v_lshlrev_b32 v20, 16, v66
    v_and_b32 v21, 0xffff0000, v66
    v_lshlrev_b32 v22, 16, v67
    v_and_b32 v23, 0xffff0000, v67
    v_lshlrev_b32 v24, 16, v68
    v_and_b32 v25, 0xffff0000, v68
    v_lshlrev_b32 v26, 16, v69
    v_and_b32 v27, 0xffff0000, v69
    v_lshlrev_b32 v28, 16, v72
    v_and_b32 v29, 0xffff0000, v72
    v_lshlrev_b32 v30, 16, v73
    v_and_b32 v31, 0xffff0000, v73
    v_lshlrev_b32 v32, 16, v74
    v_and_b32 v33, 0xffff0000, v74
    v_lshlrev_b32 v34, 16, v75
    v_and_b32 v35, 0xffff0000, v75
    v_lshlrev_b32 v36, 16, v76
    v_and_b32 v37, 0xffff0000, v76
    v_lshlrev_b32 v38, 16, v77
    v_and_b32 v39, 0xffff0000, v77
    s_waitcnt lgkmcnt(4)
    v_mfma_f32_16x16x32_bf16 v[16:19], a[0:3], v[40:43], v[16:19]
    ds_read_b128 v[60:63], v9 offset:4352
    v_mfma_f32_16x16x32_bf16 v[20:23], a[4:7], v[40:43], v[20:23]
    s_mul_i32 s46, s34, 4718592
    v_mfma_f32_16x16x32_bf16 v[24:27], a[8:11], v[40:43], v[24:27]
    s_waitcnt lgkmcnt(4)
    v_mfma_f32_16x16x32_bf16 v[28:31], a[0:3], v[44:47], v[28:31]
    ds_read_b128 v[40:43], v9 offset:6144
    v_mfma_f32_16x16x32_bf16 v[32:35], a[4:7], v[44:47], v[32:35]
    s_mul_i32 s51, s35, 36864
    v_mfma_f32_16x16x32_bf16 v[36:39], a[8:11], v[44:47], v[36:39]
    v_readfirstlane_b32 s17, v15
    s_nop 0
    s_add_u32 s18, s17, 1
    s_max_i32 s32, s18, s37
    s_add_u32 s39, s37, 1
    s_min_u32 s39, s39, 63
    s_mul_i32 s33, s32, 22528
    s_add_u32 s33, s33, s61
    s_cmp_eq_u32 s14, 0
    s_cselect_b32 s18, s32, 0x7fff
    v_mov_b32 v2, 2
    s_cmp_le_u32 s18, s39
    s_cselect_b64 exec, -1, 0
    buffer_load_dword v2, v1, s[8:11], s33 offen sc1
    s_mov_b64 exec, -1
    s_cmp_ge_i32 s17, s37
    s_cbranch_scc1 Lawo_f_5
    s_waitcnt lgkmcnt(4)
    v_mfma_f32_16x16x32_bf16 v[16:19], a[12:15], v[48:51], v[16:19]
    ds_read_b128 v[44:47], v9 offset:6400
    v_mfma_f32_16x16x32_bf16 v[20:23], a[16:19], v[48:51], v[20:23]
    s_add_u32 s46, s46, s51
    v_mfma_f32_16x16x32_bf16 v[24:27], a[20:23], v[48:51], v[24:27]
    s_waitcnt lgkmcnt(4)
    v_mfma_f32_16x16x32_bf16 v[28:31], a[12:15], v[52:55], v[28:31]
    ds_read_b128 v[48:51], v9 offset:8192
    v_mfma_f32_16x16x32_bf16 v[32:35], a[16:19], v[52:55], v[32:35]
    s_add_u32 s46, s46, 8650752
    v_mfma_f32_16x16x32_bf16 v[36:39], a[20:23], v[52:55], v[36:39]
    s_waitcnt lgkmcnt(4)
    v_mfma_f32_16x16x32_bf16 v[16:19], a[24:27], v[56:59], v[16:19]
    ds_read_b128 v[52:55], v9 offset:8448
    v_mfma_f32_16x16x32_bf16 v[20:23], a[28:31], v[56:59], v[20:23]
    s_mul_i32 s52, s34, 786432
    v_mfma_f32_16x16x32_bf16 v[24:27], a[32:35], v[56:59], v[24:27]
    s_waitcnt lgkmcnt(4)
    v_mfma_f32_16x16x32_bf16 v[28:31], a[24:27], v[60:63], v[28:31]
    ds_read_b128 v[56:59], v9 offset:10240
    v_mfma_f32_16x16x32_bf16 v[32:35], a[28:31], v[60:63], v[32:35]
    s_mul_i32 s51, s35, 6144
    v_mfma_f32_16x16x32_bf16 v[36:39], a[32:35], v[60:63], v[36:39]
    s_waitcnt lgkmcnt(4)
    v_mfma_f32_16x16x32_bf16 v[16:19], a[36:39], v[40:43], v[16:19]
    ds_read_b128 v[60:63], v9 offset:10496
    v_mfma_f32_16x16x32_bf16 v[20:23], a[40:43], v[40:43], v[20:23]
    s_add_u32 s52, s52, s51
    v_mfma_f32_16x16x32_bf16 v[24:27], a[44:47], v[40:43], v[24:27]
    s_waitcnt lgkmcnt(4)
    v_mfma_f32_16x16x32_bf16 v[28:31], a[36:39], v[44:47], v[28:31]
    ds_read_b128 v[40:43], v9 offset:12288
    v_mfma_f32_16x16x32_bf16 v[32:35], a[40:43], v[44:47], v[32:35]
    s_add_u32 s52, s52, 16121856
    v_mfma_f32_16x16x32_bf16 v[36:39], a[44:47], v[44:47], v[36:39]
    s_waitcnt lgkmcnt(4)
    v_mfma_f32_16x16x32_bf16 v[16:19], a[48:51], v[48:51], v[16:19]
    ds_read_b128 v[44:47], v9 offset:12544
    v_mfma_f32_16x16x32_bf16 v[20:23], a[52:55], v[48:51], v[20:23]
    v_mfma_f32_16x16x32_bf16 v[24:27], a[56:59], v[48:51], v[24:27]
    s_waitcnt lgkmcnt(4)
    v_mfma_f32_16x16x32_bf16 v[28:31], a[48:51], v[52:55], v[28:31]
    ds_read_b128 v[48:51], v9 offset:14336
    v_mfma_f32_16x16x32_bf16 v[32:35], a[52:55], v[52:55], v[32:35]
    v_mfma_f32_16x16x32_bf16 v[36:39], a[56:59], v[52:55], v[36:39]
    s_waitcnt lgkmcnt(4)
    v_mfma_f32_16x16x32_bf16 v[16:19], a[60:63], v[56:59], v[16:19]
    ds_read_b128 v[52:55], v9 offset:14592
    v_mfma_f32_16x16x32_bf16 v[20:23], a[64:67], v[56:59], v[20:23]
    v_mfma_f32_16x16x32_bf16 v[24:27], a[68:71], v[56:59], v[24:27]
    s_waitcnt lgkmcnt(4)
    v_mfma_f32_16x16x32_bf16 v[28:31], a[60:63], v[60:63], v[28:31]
    v_cmp_eq_u32 s[76:77], 1, v2
    v_cmp_eq_u32 vcc, 2, v2
    ds_read_b128 v[56:59], v9 offset:16384
    v_mfma_f32_16x16x32_bf16 v[32:35], a[64:67], v[60:63], v[32:35]
    s_cmp_eq_u64 s[76:77], -1
    s_cselect_b32 s38, 1, 0
    v_mfma_f32_16x16x32_bf16 v[36:39], a[68:71], v[60:63], v[36:39]
    s_cmp_lg_u32 s38, 0
    s_cselect_b64 exec, 1, 0
    v_mov_b32 v15, s32
    ds_write_b32 v184, v15
    v_mov_b32 v2, 2
    s_mov_b64 exec, -1
    s_waitcnt lgkmcnt(5)
    v_mfma_f32_16x16x32_bf16 v[16:19], a[72:75], v[40:43], v[16:19]
    ds_read_b128 v[60:63], v9 offset:16640
    v_mfma_f32_16x16x32_bf16 v[20:23], a[76:79], v[40:43], v[20:23]
    s_add_u32 s32, s32, s38
    s_mul_i32 s38, s38, 22528
    s_add_u32 s33, s33, s38
    v_mfma_f32_16x16x32_bf16 v[24:27], a[80:83], v[40:43], v[24:27]
    s_cmp_eq_u64 vcc, 0
    s_cselect_b32 s38, s32, 0x7fff
    s_waitcnt lgkmcnt(5)
    v_mfma_f32_16x16x32_bf16 v[28:31], a[72:75], v[44:47], v[28:31]
    s_cmp_le_u32 s38, s39
    s_cselect_b64 exec, -1, 0
    v_mov_b32 v2, 2
    buffer_load_dword v2, v1, s[8:11], s33 offen sc1
    s_mov_b64 exec, -1
    ds_read_b128 v[40:43], v9 offset:18432
    v_mfma_f32_16x16x32_bf16 v[32:35], a[76:79], v[44:47], v[32:35]
    v_mfma_f32_16x16x32_bf16 v[36:39], a[80:83], v[44:47], v[36:39]
    ds_read_b32 v15, v184
    s_waitcnt lgkmcnt(6)
    v_mfma_f32_16x16x32_bf16 v[16:19], a[84:87], v[48:51], v[16:19]
    ds_read_b128 v[44:47], v9 offset:18688
    v_mfma_f32_16x16x32_bf16 v[20:23], a[88:91], v[48:51], v[20:23]
    v_mfma_f32_16x16x32_bf16 v[24:27], a[92:95], v[48:51], v[24:27]
    s_waitcnt lgkmcnt(6)
    v_mfma_f32_16x16x32_bf16 v[28:31], a[84:87], v[52:55], v[28:31]
    ds_read_b128 v[48:51], v9 offset:20480
    v_mfma_f32_16x16x32_bf16 v[32:35], a[88:91], v[52:55], v[32:35]
    v_mfma_f32_16x16x32_bf16 v[36:39], a[92:95], v[52:55], v[36:39]
    s_waitcnt lgkmcnt(2)
    v_readfirstlane_b32 s17, v15
    s_nop 0
    s_cmp_ge_i32 s17, s37
    s_cbranch_scc1 Lawo_f_6
    v_mfma_f32_16x16x32_bf16 v[16:19], a[96:99], v[56:59], v[16:19]
    ds_read_b128 v[52:55], v9 offset:20736
    v_mfma_f32_16x16x32_bf16 v[20:23], a[100:103], v[56:59], v[20:23]
    v_mfma_f32_16x16x32_bf16 v[24:27], a[104:107], v[56:59], v[24:27]
    v_mfma_f32_16x16x32_bf16 v[28:31], a[96:99], v[60:63], v[28:31]
    ds_read_b128 v[56:59], v9 offset:22528
    v_mfma_f32_16x16x32_bf16 v[32:35], a[100:103], v[60:63], v[32:35]
    v_mfma_f32_16x16x32_bf16 v[36:39], a[104:107], v[60:63], v[36:39]
    s_waitcnt vmcnt(2)
    s_cmp_lg_u32 s43, 0
    s_cselect_b64 exec, 1, 0
    buffer_store_dword v3, v4, s[8:11], s43 offen sc1
    s_mov_b64 exec, -1
    s_mov_b32 s43, 0
    v_mfma_f32_16x16x32_bf16 v[16:19], a[108:111], v[40:43], v[16:19]
    ds_read_b128 v[60:63], v9 offset:22784
    v_mfma_f32_16x16x32_bf16 v[20:23], a[112:115], v[40:43], v[20:23]
    v_mfma_f32_16x16x32_bf16 v[24:27], a[116:119], v[40:43], v[24:27]
    s_waitcnt lgkmcnt(4)
    v_mfma_f32_16x16x32_bf16 v[28:31], a[108:111], v[44:47], v[28:31]
    ds_read_b128 v[40:43], v9 offset:24576
    v_mfma_f32_16x16x32_bf16 v[32:35], a[112:115], v[44:47], v[32:35]
    v_mfma_f32_16x16x32_bf16 v[36:39], a[116:119], v[44:47], v[36:39]
    s_waitcnt lgkmcnt(4)
    v_mfma_f32_16x16x32_bf16 v[16:19], a[120:123], v[48:51], v[16:19]
    ds_read_b128 v[44:47], v9 offset:24832
    v_mfma_f32_16x16x32_bf16 v[20:23], a[124:127], v[48:51], v[20:23]
    v_mfma_f32_16x16x32_bf16 v[24:27], a[128:131], v[48:51], v[24:27]
    s_waitcnt lgkmcnt(4)
    v_mfma_f32_16x16x32_bf16 v[28:31], a[120:123], v[52:55], v[28:31]
    ds_read_b128 v[48:51], v9 offset:26624
    v_mfma_f32_16x16x32_bf16 v[32:35], a[124:127], v[52:55], v[32:35]
    v_mfma_f32_16x16x32_bf16 v[36:39], a[128:131], v[52:55], v[36:39]
    s_waitcnt lgkmcnt(4)
    v_mfma_f32_16x16x32_bf16 v[16:19], a[132:135], v[56:59], v[16:19]
    ds_read_b128 v[52:55], v9 offset:26880
    v_mfma_f32_16x16x32_bf16 v[20:23], a[136:139], v[56:59], v[20:23]
    v_mfma_f32_16x16x32_bf16 v[24:27], a[140:143], v[56:59], v[24:27]
    s_waitcnt lgkmcnt(4)
    v_mfma_f32_16x16x32_bf16 v[28:31], a[132:135], v[60:63], v[28:31]
    ds_read_b128 v[56:59], v9 offset:28672
    v_mfma_f32_16x16x32_bf16 v[32:35], a[136:139], v[60:63], v[32:35]
    v_mfma_f32_16x16x32_bf16 v[36:39], a[140:143], v[60:63], v[36:39]
    s_waitcnt lgkmcnt(4)
    v_mfma_f32_16x16x32_bf16 v[16:19], a[144:147], v[40:43], v[16:19]
    ds_read_b128 v[60:63], v9 offset:28928
    v_mfma_f32_16x16x32_bf16 v[20:23], a[148:151], v[40:43], v[20:23]
    v_mfma_f32_16x16x32_bf16 v[24:27], a[152:155], v[40:43], v[24:27]
    s_waitcnt lgkmcnt(4)
    v_mfma_f32_16x16x32_bf16 v[28:31], a[144:147], v[44:47], v[28:31]
    ds_read_b128 v[40:43], v9 offset:30720
    v_mfma_f32_16x16x32_bf16 v[32:35], a[148:151], v[44:47], v[32:35]
    v_mfma_f32_16x16x32_bf16 v[36:39], a[152:155], v[44:47], v[36:39]
    s_waitcnt lgkmcnt(4)
    v_mfma_f32_16x16x32_bf16 v[16:19], a[156:159], v[48:51], v[16:19]
    ds_read_b128 v[44:47], v9 offset:30976
    v_mfma_f32_16x16x32_bf16 v[20:23], a[160:163], v[48:51], v[20:23]
    v_mfma_f32_16x16x32_bf16 v[24:27], a[164:167], v[48:51], v[24:27]
    s_waitcnt lgkmcnt(4)
    v_mfma_f32_16x16x32_bf16 v[28:31], a[156:159], v[52:55], v[28:31]
    ds_read_b128 v[48:51], v9 offset:32768
    v_mfma_f32_16x16x32_bf16 v[32:35], a[160:163], v[52:55], v[32:35]
    v_mfma_f32_16x16x32_bf16 v[36:39], a[164:167], v[52:55], v[36:39]
    s_waitcnt lgkmcnt(4)
    v_mfma_f32_16x16x32_bf16 v[16:19], a[168:171], v[56:59], v[16:19]
    ds_read_b128 v[52:55], v9 offset:33024
    v_mfma_f32_16x16x32_bf16 v[20:23], a[172:175], v[56:59], v[20:23]
    v_mfma_f32_16x16x32_bf16 v[24:27], a[176:179], v[56:59], v[24:27]
    s_waitcnt lgkmcnt(4)
    v_mfma_f32_16x16x32_bf16 v[28:31], a[168:171], v[60:63], v[28:31]
    v_cmp_eq_u32 s[76:77], 1, v2
    v_cmp_eq_u32 vcc, 2, v2
    ds_read_b128 v[56:59], v9 offset:34816
    v_mfma_f32_16x16x32_bf16 v[32:35], a[172:175], v[60:63], v[32:35]
    s_cmp_eq_u64 s[76:77], -1
    s_cselect_b32 s38, 1, 0
    v_mfma_f32_16x16x32_bf16 v[36:39], a[176:179], v[60:63], v[36:39]
    s_cmp_lg_u32 s38, 0
    s_cselect_b64 exec, 1, 0
    v_mov_b32 v15, s32
    ds_write_b32 v184, v15
    v_mov_b32 v2, 2
    s_mov_b64 exec, -1
    s_waitcnt lgkmcnt(5)
    v_mfma_f32_16x16x32_bf16 v[16:19], a[180:183], v[40:43], v[16:19]
    ds_read_b128 v[60:63], v9 offset:35072
    v_mfma_f32_16x16x32_bf16 v[20:23], a[184:187], v[40:43], v[20:23]
    s_add_u32 s32, s32, s38
    s_mul_i32 s38, s38, 22528
    s_add_u32 s33, s33, s38
    v_mfma_f32_16x16x32_bf16 v[24:27], a[188:191], v[40:43], v[24:27]
    s_cmp_eq_u64 vcc, 0
    s_cselect_b32 s38, s32, 0x7fff
    s_waitcnt lgkmcnt(5)
    v_mfma_f32_16x16x32_bf16 v[28:31], a[180:183], v[44:47], v[28:31]
    s_cmp_le_u32 s38, s39
    s_cselect_b64 exec, -1, 0
    v_mov_b32 v2, 2
    buffer_load_dword v2, v1, s[8:11], s33 offen sc1
    s_mov_b64 exec, -1
    v_mfma_f32_16x16x32_bf16 v[32:35], a[184:187], v[44:47], v[32:35]
    v_mfma_f32_16x16x32_bf16 v[36:39], a[188:191], v[44:47], v[36:39]
    s_waitcnt lgkmcnt(4)
    v_mfma_f32_16x16x32_bf16 v[16:19], a[192:195], v[48:51], v[16:19]
    v_mfma_f32_16x16x32_bf16 v[20:23], a[196:199], v[48:51], v[20:23]
    v_mfma_f32_16x16x32_bf16 v[24:27], a[200:203], v[48:51], v[24:27]
    s_waitcnt lgkmcnt(3)
    v_mfma_f32_16x16x32_bf16 v[28:31], a[192:195], v[52:55], v[28:31]
    v_mfma_f32_16x16x32_bf16 v[32:35], a[196:199], v[52:55], v[32:35]
    v_mfma_f32_16x16x32_bf16 v[36:39], a[200:203], v[52:55], v[36:39]
    s_waitcnt lgkmcnt(2)
    v_mfma_f32_16x16x32_bf16 v[16:19], a[204:207], v[56:59], v[16:19]
    v_mfma_f32_16x16x32_bf16 v[20:23], a[208:211], v[56:59], v[20:23]
    v_mfma_f32_16x16x32_bf16 v[24:27], a[212:215], v[56:59], v[24:27]
    s_waitcnt lgkmcnt(0)
    v_mfma_f32_16x16x32_bf16 v[28:31], a[204:207], v[60:63], v[28:31]
    v_mfma_f32_16x16x32_bf16 v[32:35], a[208:211], v[60:63], v[32:35]
    v_mfma_f32_16x16x32_bf16 v[36:39], a[212:215], v[60:63], v[36:39]
    v_mov_b32 v88, 0x3f803f80
    v_cvt_pk_bf16_f32 v96, v16, v17
    v_cvt_pk_bf16_f32 v97, v18, v19
    v_cvt_pk_bf16_f32 v98, v20, v21
    v_cvt_pk_bf16_f32 v99, v22, v23
    v_cvt_pk_bf16_f32 v100, v24, v25
    v_cvt_pk_bf16_f32 v101, v26, v27
    buffer_store_dwordx4 v[96:99], v10, s[8:11], s46 offen offset:0 sc1
    buffer_store_dwordx2 v[100:101], v12, s[8:11], s46 offen offset:0 sc1
    v_cvt_pk_bf16_f32 v104, v28, v29
    v_cvt_pk_bf16_f32 v105, v30, v31
    v_cvt_pk_bf16_f32 v106, v32, v33
    v_cvt_pk_bf16_f32 v107, v34, v35
    v_cvt_pk_bf16_f32 v108, v36, v37
    v_cvt_pk_bf16_f32 v109, v38, v39
    buffer_store_dwordx4 v[104:107], v10, s[8:11], s46 offen offset:256 sc1
    buffer_store_dwordx2 v[108:109], v12, s[8:11], s46 offen offset:256 sc1
    v_mov_b32 v80, 0
    v_mov_b32 v81, 0
    v_mov_b32 v84, 0
    v_mov_b32 v85, 0
    v_dot2c_f32_bf16 v80, v96, v88
    v_dot2c_f32_bf16 v81, v96, v96
    v_dot2c_f32_bf16 v84, v104, v88
    v_dot2c_f32_bf16 v85, v104, v104
    v_dot2c_f32_bf16 v80, v97, v88
    v_dot2c_f32_bf16 v81, v97, v97
    v_dot2c_f32_bf16 v84, v105, v88
    v_dot2c_f32_bf16 v85, v105, v105
    v_dot2c_f32_bf16 v80, v98, v88
    v_dot2c_f32_bf16 v81, v98, v98
    v_dot2c_f32_bf16 v84, v106, v88
    v_dot2c_f32_bf16 v85, v106, v106
    v_dot2c_f32_bf16 v80, v99, v88
    v_dot2c_f32_bf16 v81, v99, v99
    v_dot2c_f32_bf16 v84, v107, v88
    v_dot2c_f32_bf16 v85, v107, v107
    v_dot2c_f32_bf16 v80, v100, v88
    v_dot2c_f32_bf16 v81, v100, v100
    v_dot2c_f32_bf16 v84, v108, v88
    v_dot2c_f32_bf16 v85, v108, v108
    v_dot2c_f32_bf16 v80, v101, v88
    v_dot2c_f32_bf16 v81, v101, v101
    v_dot2c_f32_bf16 v84, v109, v88
    v_dot2c_f32_bf16 v85, v109, v109
    s_nop 2
    v_mov_b32 v82, v80
    v_mov_b32 v83, v81
    v_mov_b32 v86, v84
    v_mov_b32 v87, v85
    v_permlane32_swap_b32 v80, v82
    v_permlane32_swap_b32 v81, v83
    v_permlane32_swap_b32 v84, v86
    v_permlane32_swap_b32 v85, v87
    v_add_f32 v80, v80, v82
    v_add_f32 v81, v81, v83
    v_add_f32 v84, v84, v86
    v_add_f32 v85, v85, v87
    v_mov_b32 v82, v80
    v_mov_b32 v83, v81
    v_mov_b32 v86, v84
    v_mov_b32 v87, v85
    v_permlane16_swap_b32 v80, v82
    v_permlane16_swap_b32 v81, v83
    v_permlane16_swap_b32 v84, v86
    v_permlane16_swap_b32 v85, v87
    v_add_f32 v80, v80, v82
    v_add_f32 v81, v81, v83
    v_add_f32 v84, v84, v86
    v_add_f32 v85, v85, v87
    s_mov_b64 exec, 0xffff
    buffer_store_dwordx2 v[80:81], v11, s[8:11], s52 offen offset:0 sc1
    buffer_store_dwordx2 v[84:85], v11, s[8:11], s52 offen offset:256 sc1
    s_mov_b64 exec, -1
    s_mul_i32 s43, s57, 22528
    s_add_u32 s43, s43, s49
    s_branch Lawo_none
Lawo_f_5:
    s_waitcnt lgkmcnt(4)
    v_mfma_f32_16x16x32_bf16 v[16:19], a[12:15], v[48:51], v[16:19]
    ds_read_b128 v[44:47], v9 offset:6400
    v_mfma_f32_16x16x32_bf16 v[20:23], a[16:19], v[48:51], v[20:23]
    s_add_u32 s46, s46, s51
    v_mfma_f32_16x16x32_bf16 v[24:27], a[20:23], v[48:51], v[24:27]
    s_add_u32 m0, s59, 0
    s_add_u32 s47, s41, 0
    buffer_load_dwordx4 v0, s[8:11], s47 offen offset:0 lds
    s_waitcnt lgkmcnt(4)
    v_mfma_f32_16x16x32_bf16 v[28:31], a[12:15], v[52:55], v[28:31]
    buffer_load_dwordx4 v0, s[8:11], s47 offen offset:1024 lds
    ds_read_b128 v[48:51], v9 offset:8192
    v_mfma_f32_16x16x32_bf16 v[32:35], a[16:19], v[52:55], v[32:35]
    s_add_u32 s46, s46, 8650752
    v_mfma_f32_16x16x32_bf16 v[36:39], a[20:23], v[52:55], v[36:39]
    s_waitcnt lgkmcnt(4)
    v_mfma_f32_16x16x32_bf16 v[16:19], a[24:27], v[56:59], v[16:19]
    buffer_load_dwordx4 v0, s[8:11], s47 offen offset:2048 lds
    ds_read_b128 v[52:55], v9 offset:8448
    v_mfma_f32_16x16x32_bf16 v[20:23], a[28:31], v[56:59], v[20:23]
    s_mul_i32 s52, s34, 786432
    v_mfma_f32_16x16x32_bf16 v[24:27], a[32:35], v[56:59], v[24:27]
    s_waitcnt lgkmcnt(4)
    v_mfma_f32_16x16x32_bf16 v[28:31], a[24:27], v[60:63], v[28:31]
    buffer_load_dwordx4 v0, s[8:11], s47 offen offset:3072 lds
    ds_read_b128 v[56:59], v9 offset:10240
    v_mfma_f32_16x16x32_bf16 v[32:35], a[28:31], v[60:63], v[32:35]
    s_mul_i32 s51, s35, 6144
    v_mfma_f32_16x16x32_bf16 v[36:39], a[32:35], v[60:63], v[36:39]
    s_waitcnt lgkmcnt(4)
    v_mfma_f32_16x16x32_bf16 v[16:19], a[36:39], v[40:43], v[16:19]
    ds_read_b128 v[60:63], v9 offset:10496
    v_mfma_f32_16x16x32_bf16 v[20:23], a[40:43], v[40:43], v[20:23]
    s_add_u32 s52, s52, s51
    v_mfma_f32_16x16x32_bf16 v[24:27], a[44:47], v[40:43], v[24:27]
    s_add_u32 m0, s59, 4096
    s_add_u32 s47, s41, 4096
    buffer_load_dwordx4 v0, s[8:11], s47 offen offset:0 lds
    s_waitcnt lgkmcnt(4)
    v_mfma_f32_16x16x32_bf16 v[28:31], a[36:39], v[44:47], v[28:31]
    buffer_load_dwordx4 v0, s[8:11], s47 offen offset:1024 lds
    ds_read_b128 v[40:43], v9 offset:12288
    v_mfma_f32_16x16x32_bf16 v[32:35], a[40:43], v[44:47], v[32:35]
    s_add_u32 s52, s52, 16121856
    v_mfma_f32_16x16x32_bf16 v[36:39], a[44:47], v[44:47], v[36:39]
    s_waitcnt lgkmcnt(4)
    v_mfma_f32_16x16x32_bf16 v[16:19], a[48:51], v[48:51], v[16:19]
    buffer_load_dwordx4 v0, s[8:11], s47 offen offset:2048 lds
    ds_read_b128 v[44:47], v9 offset:12544
    v_mfma_f32_16x16x32_bf16 v[20:23], a[52:55], v[48:51], v[20:23]
    v_mfma_f32_16x16x32_bf16 v[24:27], a[56:59], v[48:51], v[24:27]
    s_waitcnt lgkmcnt(4)
    v_mfma_f32_16x16x32_bf16 v[28:31], a[48:51], v[52:55], v[28:31]
    buffer_load_dwordx4 v0, s[8:11], s47 offen offset:3072 lds
    ds_read_b128 v[48:51], v9 offset:14336
    v_mfma_f32_16x16x32_bf16 v[32:35], a[52:55], v[52:55], v[32:35]
    v_mfma_f32_16x16x32_bf16 v[36:39], a[56:59], v[52:55], v[36:39]
    s_waitcnt lgkmcnt(4)
    v_mfma_f32_16x16x32_bf16 v[16:19], a[60:63], v[56:59], v[16:19]
    ds_read_b128 v[52:55], v9 offset:14592
    v_mfma_f32_16x16x32_bf16 v[20:23], a[64:67], v[56:59], v[20:23]
    s_add_u32 m0, s59, 8192
    s_add_u32 s47, s41, 8192
    buffer_load_dwordx4 v0, s[8:11], s47 offen offset:0 lds
    v_mfma_f32_16x16x32_bf16 v[24:27], a[68:71], v[56:59], v[24:27]
    s_waitcnt lgkmcnt(4)
    v_mfma_f32_16x16x32_bf16 v[28:31], a[60:63], v[60:63], v[28:31]
    s_mul_i32 s48, s36, 4718592
    s_mul_i32 s18, s37, 36864
    s_add_u32 s48, s48, s18
    s_add_u32 s48, s48, 6291456
    buffer_load_dwordx4 v[64:67], v10, s[8:11], s48 offen offset:0
    ds_read_b128 v[56:59], v9 offset:16384
    v_mfma_f32_16x16x32_bf16 v[32:35], a[64:67], v[60:63], v[32:35]
    v_cmp_eq_u32 s[76:77], 1, v2
    v_cmp_eq_u32 vcc, 2, v2
    v_mfma_f32_16x16x32_bf16 v[36:39], a[68:71], v[60:63], v[36:39]
    s_cmp_eq_u64 s[76:77], -1
    s_cselect_b32 s38, 1, 0
    s_waitcnt lgkmcnt(4)
    v_mfma_f32_16x16x32_bf16 v[16:19], a[72:75], v[40:43], v[16:19]
    s_cmp_lg_u32 s38, 0
    s_cselect_b64 exec, 1, 0
    v_mov_b32 v15, s32
    ds_write_b32 v184, v15
    v_mov_b32 v2, 2
    s_mov_b64 exec, -1
    ds_read_b128 v[60:63], v9 offset:16640
    v_mfma_f32_16x16x32_bf16 v[20:23], a[76:79], v[40:43], v[20:23]
    s_add_u32 s32, s32, s38
    s_mul_i32 s38, s38, 22528
    s_add_u32 s33, s33, s38
    v_mfma_f32_16x16x32_bf16 v[24:27], a[80:83], v[40:43], v[24:27]
    s_cmp_eq_u64 vcc, 0
    s_cselect_b32 s38, s32, 0x7fff
    s_waitcnt lgkmcnt(5)
    v_mfma_f32_16x16x32_bf16 v[28:31], a[72:75], v[44:47], v[28:31]
    s_cmp_le_u32 s38, s39
    s_cselect_b64 exec, -1, 0
    v_mov_b32 v2, 2
    buffer_load_dword v2, v1, s[8:11], s33 offen sc1
    s_mov_b64 exec, -1
    ds_read_b128 v[40:43], v9 offset:18432
    v_mfma_f32_16x16x32_bf16 v[32:35], a[76:79], v[44:47], v[32:35]
    buffer_load_dwordx2 v[68:69], v12, s[8:11], s48 offen offset:0
    buffer_load_dwordx4 v[72:75], v10, s[8:11], s48 offen offset:256
    v_mfma_f32_16x16x32_bf16 v[36:39], a[80:83], v[44:47], v[36:39]
    s_waitcnt lgkmcnt(5)
    v_mfma_f32_16x16x32_bf16 v[16:19], a[84:87], v[48:51], v[16:19]
    buffer_load_dwordx2 v[76:77], v12, s[8:11], s48 offen offset:256
    ds_read_b128 v[44:47], v9 offset:18688
    v_mfma_f32_16x16x32_bf16 v[20:23], a[88:91], v[48:51], v[20:23]
    v_mfma_f32_16x16x32_bf16 v[24:27], a[92:95], v[48:51], v[24:27]
    s_waitcnt lgkmcnt(5)
    v_mfma_f32_16x16x32_bf16 v[28:31], a[84:87], v[52:55], v[28:31]
    ds_read_b128 v[48:51], v9 offset:20480
    v_mfma_f32_16x16x32_bf16 v[32:35], a[88:91], v[52:55], v[32:35]
    v_mfma_f32_16x16x32_bf16 v[36:39], a[92:95], v[52:55], v[36:39]
    s_waitcnt lgkmcnt(5)
    v_mfma_f32_16x16x32_bf16 v[16:19], a[96:99], v[56:59], v[16:19]
    ds_read_b128 v[52:55], v9 offset:20736
    v_mfma_f32_16x16x32_bf16 v[20:23], a[100:103], v[56:59], v[20:23]
    v_mfma_f32_16x16x32_bf16 v[24:27], a[104:107], v[56:59], v[24:27]
    s_waitcnt lgkmcnt(4)
    v_mfma_f32_16x16x32_bf16 v[28:31], a[96:99], v[60:63], v[28:31]
    ds_read_b128 v[56:59], v9 offset:22528
    v_mfma_f32_16x16x32_bf16 v[32:35], a[100:103], v[60:63], v[32:35]
    v_mfma_f32_16x16x32_bf16 v[36:39], a[104:107], v[60:63], v[36:39]
    s_waitcnt vmcnt(15)
    s_cmp_lg_u32 s43, 0
    s_cselect_b64 exec, 1, 0
    buffer_store_dword v3, v4, s[8:11], s43 offen sc1
    s_mov_b64 exec, -1
    s_mov_b32 s43, 0
    s_waitcnt lgkmcnt(4)
    v_mfma_f32_16x16x32_bf16 v[16:19], a[108:111], v[40:43], v[16:19]
    ds_read_b128 v[60:63], v9 offset:22784
    v_mfma_f32_16x16x32_bf16 v[20:23], a[112:115], v[40:43], v[20:23]
    v_mfma_f32_16x16x32_bf16 v[24:27], a[116:119], v[40:43], v[24:27]
    s_waitcnt lgkmcnt(4)
    v_mfma_f32_16x16x32_bf16 v[28:31], a[108:111], v[44:47], v[28:31]
    ds_read_b128 v[40:43], v9 offset:24576
    v_mfma_f32_16x16x32_bf16 v[32:35], a[112:115], v[44:47], v[32:35]
    v_mfma_f32_16x16x32_bf16 v[36:39], a[116:119], v[44:47], v[36:39]
    s_waitcnt lgkmcnt(4)
    v_mfma_f32_16x16x32_bf16 v[16:19], a[120:123], v[48:51], v[16:19]
    ds_read_b128 v[44:47], v9 offset:24832
    v_mfma_f32_16x16x32_bf16 v[20:23], a[124:127], v[48:51], v[20:23]
    v_mfma_f32_16x16x32_bf16 v[24:27], a[128:131], v[48:51], v[24:27]
    s_waitcnt lgkmcnt(4)
    v_mfma_f32_16x16x32_bf16 v[28:31], a[120:123], v[52:55], v[28:31]
    ds_read_b128 v[48:51], v9 offset:26624
    v_mfma_f32_16x16x32_bf16 v[32:35], a[124:127], v[52:55], v[32:35]
    v_mfma_f32_16x16x32_bf16 v[36:39], a[128:131], v[52:55], v[36:39]
    s_waitcnt lgkmcnt(4)
    v_mfma_f32_16x16x32_bf16 v[16:19], a[132:135], v[56:59], v[16:19]
    ds_read_b128 v[52:55], v9 offset:26880
    v_mfma_f32_16x16x32_bf16 v[20:23], a[136:139], v[56:59], v[20:23]
    v_mfma_f32_16x16x32_bf16 v[24:27], a[140:143], v[56:59], v[24:27]
    s_waitcnt lgkmcnt(4)
    v_mfma_f32_16x16x32_bf16 v[28:31], a[132:135], v[60:63], v[28:31]
    ds_read_b128 v[56:59], v9 offset:28672
    v_mfma_f32_16x16x32_bf16 v[32:35], a[136:139], v[60:63], v[32:35]
    v_mfma_f32_16x16x32_bf16 v[36:39], a[140:143], v[60:63], v[36:39]
    s_waitcnt lgkmcnt(4)
    v_mfma_f32_16x16x32_bf16 v[16:19], a[144:147], v[40:43], v[16:19]
    ds_read_b128 v[60:63], v9 offset:28928
    v_mfma_f32_16x16x32_bf16 v[20:23], a[148:151], v[40:43], v[20:23]
    v_mfma_f32_16x16x32_bf16 v[24:27], a[152:155], v[40:43], v[24:27]
    s_waitcnt lgkmcnt(4)
    v_mfma_f32_16x16x32_bf16 v[28:31], a[144:147], v[44:47], v[28:31]
    ds_read_b128 v[40:43], v9 offset:30720
    v_mfma_f32_16x16x32_bf16 v[32:35], a[148:151], v[44:47], v[32:35]
    v_mfma_f32_16x16x32_bf16 v[36:39], a[152:155], v[44:47], v[36:39]
    s_waitcnt lgkmcnt(4)
    v_mfma_f32_16x16x32_bf16 v[16:19], a[156:159], v[48:51], v[16:19]
    ds_read_b128 v[44:47], v9 offset:30976
    v_mfma_f32_16x16x32_bf16 v[20:23], a[160:163], v[48:51], v[20:23]
    v_mfma_f32_16x16x32_bf16 v[24:27], a[164:167], v[48:51], v[24:27]
    s_waitcnt lgkmcnt(4)
    v_mfma_f32_16x16x32_bf16 v[28:31], a[156:159], v[52:55], v[28:31]
    ds_read_b128 v[48:51], v9 offset:32768
    v_mfma_f32_16x16x32_bf16 v[32:35], a[160:163], v[52:55], v[32:35]
    v_mfma_f32_16x16x32_bf16 v[36:39], a[164:167], v[52:55], v[36:39]
    s_waitcnt lgkmcnt(4)
    v_mfma_f32_16x16x32_bf16 v[16:19], a[168:171], v[56:59], v[16:19]
    ds_read_b128 v[52:55], v9 offset:33024
    v_mfma_f32_16x16x32_bf16 v[20:23], a[172:175], v[56:59], v[20:23]
    v_mfma_f32_16x16x32_bf16 v[24:27], a[176:179], v[56:59], v[24:27]
    s_waitcnt lgkmcnt(4)
    v_mfma_f32_16x16x32_bf16 v[28:31], a[168:171], v[60:63], v[28:31]
    v_cmp_eq_u32 s[76:77], 1, v2
    v_cmp_eq_u32 vcc, 2, v2
    ds_read_b128 v[56:59], v9 offset:34816
    v_mfma_f32_16x16x32_bf16 v[32:35], a[172:175], v[60:63], v[32:35]
    s_cmp_eq_u64 s[76:77], -1
    s_cselect_b32 s38, 1, 0
    v_mfma_f32_16x16x32_bf16 v[36:39], a[176:179], v[60:63], v[36:39]
    s_cmp_lg_u32 s38, 0
    s_cselect_b64 exec, 1, 0
    v_mov_b32 v15, s32
    ds_write_b32 v184, v15
    v_mov_b32 v2, 2
    s_mov_b64 exec, -1
    s_waitcnt lgkmcnt(5)
    v_mfma_f32_16x16x32_bf16 v[16:19], a[180:183], v[40:43], v[16:19]
    ds_read_b128 v[60:63], v9 offset:35072
    v_mfma_f32_16x16x32_bf16 v[20:23], a[184:187], v[40:43], v[20:23]
    s_add_u32 s32, s32, s38
    s_mul_i32 s38, s38, 22528
    s_add_u32 s33, s33, s38
    v_mfma_f32_16x16x32_bf16 v[24:27], a[188:191], v[40:43], v[24:27]
    s_cmp_eq_u64 vcc, 0
    s_cselect_b32 s38, s32, 0x7fff
    s_waitcnt lgkmcnt(5)
    v_mfma_f32_16x16x32_bf16 v[28:31], a[180:183], v[44:47], v[28:31]
    s_cmp_le_u32 s38, s39
    s_cselect_b64 exec, -1, 0
    v_mov_b32 v2, 2
    buffer_load_dword v2, v1, s[8:11], s33 offen sc1
    s_mov_b64 exec, -1
    v_mfma_f32_16x16x32_bf16 v[32:35], a[184:187], v[44:47], v[32:35]
    v_mfma_f32_16x16x32_bf16 v[36:39], a[188:191], v[44:47], v[36:39]
    s_waitcnt lgkmcnt(4)
    v_mfma_f32_16x16x32_bf16 v[16:19], a[192:195], v[48:51], v[16:19]
    v_mfma_f32_16x16x32_bf16 v[20:23], a[196:199], v[48:51], v[20:23]
    v_mfma_f32_16x16x32_bf16 v[24:27], a[200:203], v[48:51], v[24:27]
    s_waitcnt lgkmcnt(3)
    v_mfma_f32_16x16x32_bf16 v[28:31], a[192:195], v[52:55], v[28:31]
    v_mfma_f32_16x16x32_bf16 v[32:35], a[196:199], v[52:55], v[32:35]
    v_mfma_f32_16x16x32_bf16 v[36:39], a[200:203], v[52:55], v[36:39]
    s_waitcnt lgkmcnt(2)
    v_mfma_f32_16x16x32_bf16 v[16:19], a[204:207], v[56:59], v[16:19]
    v_mfma_f32_16x16x32_bf16 v[20:23], a[208:211], v[56:59], v[20:23]
    v_mfma_f32_16x16x32_bf16 v[24:27], a[212:215], v[56:59], v[24:27]
    s_waitcnt lgkmcnt(0)
    v_mfma_f32_16x16x32_bf16 v[28:31], a[204:207], v[60:63], v[28:31]
    v_mfma_f32_16x16x32_bf16 v[32:35], a[208:211], v[60:63], v[32:35]
    v_mfma_f32_16x16x32_bf16 v[36:39], a[212:215], v[60:63], v[36:39]
    v_mov_b32 v88, 0x3f803f80
    v_cvt_pk_bf16_f32 v96, v16, v17
    v_cvt_pk_bf16_f32 v97, v18, v19
    v_cvt_pk_bf16_f32 v98, v20, v21
    v_cvt_pk_bf16_f32 v99, v22, v23
    v_cvt_pk_bf16_f32 v100, v24, v25
    v_cvt_pk_bf16_f32 v101, v26, v27
    buffer_store_dwordx4 v[96:99], v10, s[8:11], s46 offen offset:0 sc1
    buffer_store_dwordx2 v[100:101], v12, s[8:11], s46 offen offset:0 sc1
    v_cvt_pk_bf16_f32 v104, v28, v29
    v_cvt_pk_bf16_f32 v105, v30, v31
    v_cvt_pk_bf16_f32 v106, v32, v33
    v_cvt_pk_bf16_f32 v107, v34, v35
    v_cvt_pk_bf16_f32 v108, v36, v37
    v_cvt_pk_bf16_f32 v109, v38, v39
    buffer_store_dwordx4 v[104:107], v10, s[8:11], s46 offen offset:256 sc1
    buffer_store_dwordx2 v[108:109], v12, s[8:11], s46 offen offset:256 sc1
    v_mov_b32 v80, 0
    v_mov_b32 v81, 0
    v_mov_b32 v84, 0
    v_mov_b32 v85, 0
    v_dot2c_f32_bf16 v80, v96, v88
    v_dot2c_f32_bf16 v81, v96, v96
    v_dot2c_f32_bf16 v84, v104, v88
    v_dot2c_f32_bf16 v85, v104, v104
    v_dot2c_f32_bf16 v80, v97, v88
    v_dot2c_f32_bf16 v81, v97, v97
    v_dot2c_f32_bf16 v84, v105, v88
    v_dot2c_f32_bf16 v85, v105, v105
    v_dot2c_f32_bf16 v80, v98, v88
    v_dot2c_f32_bf16 v81, v98, v98
    v_dot2c_f32_bf16 v84, v106, v88
    v_dot2c_f32_bf16 v85, v106, v106
    v_dot2c_f32_bf16 v80, v99, v88
    v_dot2c_f32_bf16 v81, v99, v99
    v_dot2c_f32_bf16 v84, v107, v88
    v_dot2c_f32_bf16 v85, v107, v107
    v_dot2c_f32_bf16 v80, v100, v88
    v_dot2c_f32_bf16 v81, v100, v100
    v_dot2c_f32_bf16 v84, v108, v88
    v_dot2c_f32_bf16 v85, v108, v108
    v_dot2c_f32_bf16 v80, v101, v88
    v_dot2c_f32_bf16 v81, v101, v101
    v_dot2c_f32_bf16 v84, v109, v88
    v_dot2c_f32_bf16 v85, v109, v109
    s_nop 2
    v_mov_b32 v82, v80
    v_mov_b32 v83, v81
    v_mov_b32 v86, v84
    v_mov_b32 v87, v85
    v_permlane32_swap_b32 v80, v82
    v_permlane32_swap_b32 v81, v83
    v_permlane32_swap_b32 v84, v86
    v_permlane32_swap_b32 v85, v87
    v_add_f32 v80, v80, v82
    v_add_f32 v81, v81, v83
    v_add_f32 v84, v84, v86
    v_add_f32 v85, v85, v87
    v_mov_b32 v82, v80
    v_mov_b32 v83, v81
    v_mov_b32 v86, v84
    v_mov_b32 v87, v85
    v_permlane16_swap_b32 v80, v82
    v_permlane16_swap_b32 v81, v83
    v_permlane16_swap_b32 v84, v86
    v_permlane16_swap_b32 v85, v87
    v_add_f32 v80, v80, v82
    v_add_f32 v81, v81, v83
    v_add_f32 v84, v84, v86
    v_add_f32 v85, v85, v87
    s_mov_b64 exec, 0xffff
    buffer_store_dwordx2 v[80:81], v11, s[8:11], s52 offen offset:0 sc1
    buffer_store_dwordx2 v[84:85], v11, s[8:11], s52 offen offset:256 sc1
    s_mov_b64 exec, -1
    s_mul_i32 s43, s57, 22528
    s_add_u32 s43, s43, s49
    s_branch Lawo_head
Lawo_f_6:
    v_mfma_f32_16x16x32_bf16 v[16:19], a[96:99], v[56:59], v[16:19]
    ds_read_b128 v[52:55], v9 offset:20736
    v_mfma_f32_16x16x32_bf16 v[20:23], a[100:103], v[56:59], v[20:23]
    s_add_u32 m0, s59, 0
    s_add_u32 s47, s41, 0
    buffer_load_dwordx4 v0, s[8:11], s47 offen offset:0 lds
    v_mfma_f32_16x16x32_bf16 v[24:27], a[104:107], v[56:59], v[24:27]
    v_mfma_f32_16x16x32_bf16 v[28:31], a[96:99], v[60:63], v[28:31]
    buffer_load_dwordx4 v0, s[8:11], s47 offen offset:1024 lds
    ds_read_b128 v[56:59], v9 offset:22528
    v_mfma_f32_16x16x32_bf16 v[32:35], a[100:103], v[60:63], v[32:35]
    v_mfma_f32_16x16x32_bf16 v[36:39], a[104:107], v[60:63], v[36:39]
    s_waitcnt vmcnt(4)
    s_cmp_lg_u32 s43, 0
    s_cselect_b64 exec, 1, 0
    buffer_store_dword v3, v4, s[8:11], s43 offen sc1
    s_mov_b64 exec, -1
    s_mov_b32 s43, 0
    v_mfma_f32_16x16x32_bf16 v[16:19], a[108:111], v[40:43], v[16:19]
    buffer_load_dwordx4 v0, s[8:11], s47 offen offset:2048 lds
    ds_read_b128 v[60:63], v9 offset:22784
    v_mfma_f32_16x16x32_bf16 v[20:23], a[112:115], v[40:43], v[20:23]
    v_mfma_f32_16x16x32_bf16 v[24:27], a[116:119], v[40:43], v[24:27]
    s_waitcnt lgkmcnt(4)
    v_mfma_f32_16x16x32_bf16 v[28:31], a[108:111], v[44:47], v[28:31]
    buffer_load_dwordx4 v0, s[8:11], s47 offen offset:3072 lds
    ds_read_b128 v[40:43], v9 offset:24576
    v_mfma_f32_16x16x32_bf16 v[32:35], a[112:115], v[44:47], v[32:35]
    v_mfma_f32_16x16x32_bf16 v[36:39], a[116:119], v[44:47], v[36:39]
    s_waitcnt lgkmcnt(4)
    v_mfma_f32_16x16x32_bf16 v[16:19], a[120:123], v[48:51], v[16:19]
    ds_read_b128 v[44:47], v9 offset:24832
    v_mfma_f32_16x16x32_bf16 v[20:23], a[124:127], v[48:51], v[20:23]
    s_add_u32 m0, s59, 4096
    s_add_u32 s47, s41, 4096
    buffer_load_dwordx4 v0, s[8:11], s47 offen offset:0 lds
    v_mfma_f32_16x16x32_bf16 v[24:27], a[128:131], v[48:51], v[24:27]
    s_waitcnt lgkmcnt(4)
    v_mfma_f32_16x16x32_bf16 v[28:31], a[120:123], v[52:55], v[28:31]
    buffer_load_dwordx4 v0, s[8:11], s47 offen offset:1024 lds
    ds_read_b128 v[48:51], v9 offset:26624
    v_mfma_f32_16x16x32_bf16 v[32:35], a[124:127], v[52:55], v[32:35]
    v_mfma_f32_16x16x32_bf16 v[36:39], a[128:131], v[52:55], v[36:39]
    s_waitcnt lgkmcnt(4)
    v_mfma_f32_16x16x32_bf16 v[16:19], a[132:135], v[56:59], v[16:19]
    buffer_load_dwordx4 v0, s[8:11], s47 offen offset:2048 lds
    ds_read_b128 v[52:55], v9 offset:26880
    v_mfma_f32_16x16x32_bf16 v[20:23], a[136:139], v[56:59], v[20:23]
    v_mfma_f32_16x16x32_bf16 v[24:27], a[140:143], v[56:59], v[24:27]
    s_waitcnt lgkmcnt(4)
    v_mfma_f32_16x16x32_bf16 v[28:31], a[132:135], v[60:63], v[28:31]
    buffer_load_dwordx4 v0, s[8:11], s47 offen offset:3072 lds
    ds_read_b128 v[56:59], v9 offset:28672
    v_mfma_f32_16x16x32_bf16 v[32:35], a[136:139], v[60:63], v[32:35]
    v_mfma_f32_16x16x32_bf16 v[36:39], a[140:143], v[60:63], v[36:39]
    s_waitcnt lgkmcnt(4)
    v_mfma_f32_16x16x32_bf16 v[16:19], a[144:147], v[40:43], v[16:19]
    ds_read_b128 v[60:63], v9 offset:28928
    v_mfma_f32_16x16x32_bf16 v[20:23], a[148:151], v[40:43], v[20:23]
    s_add_u32 m0, s59, 8192
    s_add_u32 s47, s41, 8192
    buffer_load_dwordx4 v0, s[8:11], s47 offen offset:0 lds
    v_mfma_f32_16x16x32_bf16 v[24:27], a[152:155], v[40:43], v[24:27]
    s_waitcnt lgkmcnt(4)
    v_mfma_f32_16x16x32_bf16 v[28:31], a[144:147], v[44:47], v[28:31]
    s_mul_i32 s48, s36, 4718592
    s_mul_i32 s18, s37, 36864
    s_add_u32 s48, s48, s18
    s_add_u32 s48, s48, 6291456
    buffer_load_dwordx4 v[64:67], v10, s[8:11], s48 offen offset:0
    ds_read_b128 v[40:43], v9 offset:30720
    v_mfma_f32_16x16x32_bf16 v[32:35], a[148:151], v[44:47], v[32:35]
    v_mfma_f32_16x16x32_bf16 v[36:39], a[152:155], v[44:47], v[36:39]
    s_waitcnt lgkmcnt(4)
    v_mfma_f32_16x16x32_bf16 v[16:19], a[156:159], v[48:51], v[16:19]
    buffer_load_dwordx2 v[68:69], v12, s[8:11], s48 offen offset:0
    ds_read_b128 v[44:47], v9 offset:30976
    v_mfma_f32_16x16x32_bf16 v[20:23], a[160:163], v[48:51], v[20:23]
    v_mfma_f32_16x16x32_bf16 v[24:27], a[164:167], v[48:51], v[24:27]
    s_waitcnt lgkmcnt(4)
    v_mfma_f32_16x16x32_bf16 v[28:31], a[156:159], v[52:55], v[28:31]
    buffer_load_dwordx4 v[72:75], v10, s[8:11], s48 offen offset:256
    ds_read_b128 v[48:51], v9 offset:32768
    v_mfma_f32_16x16x32_bf16 v[32:35], a[160:163], v[52:55], v[32:35]
    v_mfma_f32_16x16x32_bf16 v[36:39], a[164:167], v[52:55], v[36:39]
    s_waitcnt lgkmcnt(4)
    v_mfma_f32_16x16x32_bf16 v[16:19], a[168:171], v[56:59], v[16:19]
    buffer_load_dwordx2 v[76:77], v12, s[8:11], s48 offen offset:256
    ds_read_b128 v[52:55], v9 offset:33024
    v_mfma_f32_16x16x32_bf16 v[20:23], a[172:175], v[56:59], v[20:23]
    v_mfma_f32_16x16x32_bf16 v[24:27], a[176:179], v[56:59], v[24:27]
    s_waitcnt lgkmcnt(4)
    v_mfma_f32_16x16x32_bf16 v[28:31], a[168:171], v[60:63], v[28:31]
    v_cmp_eq_u32 s[76:77], 1, v2
    v_cmp_eq_u32 vcc, 2, v2
    ds_read_b128 v[56:59], v9 offset:34816
    v_mfma_f32_16x16x32_bf16 v[32:35], a[172:175], v[60:63], v[32:35]
    s_cmp_eq_u64 s[76:77], -1
    s_cselect_b32 s38, 1, 0
    v_mfma_f32_16x16x32_bf16 v[36:39], a[176:179], v[60:63], v[36:39]
    s_cmp_lg_u32 s38, 0
    s_cselect_b64 exec, 1, 0
    v_mov_b32 v15, s32
    ds_write_b32 v184, v15
    v_mov_b32 v2, 2
    s_mov_b64 exec, -1
    s_waitcnt lgkmcnt(5)
    v_mfma_f32_16x16x32_bf16 v[16:19], a[180:183], v[40:43], v[16:19]
    ds_read_b128 v[60:63], v9 offset:35072
    v_mfma_f32_16x16x32_bf16 v[20:23], a[184:187], v[40:43], v[20:23]
    s_add_u32 s32, s32, s38
    s_mul_i32 s38, s38, 22528
    s_add_u32 s33, s33, s38
    v_mfma_f32_16x16x32_bf16 v[24:27], a[188:191], v[40:43], v[24:27]
    s_cmp_eq_u64 vcc, 0
    s_cselect_b32 s38, s32, 0x7fff
    s_waitcnt lgkmcnt(5)
    v_mfma_f32_16x16x32_bf16 v[28:31], a[180:183], v[44:47], v[28:31]
    s_cmp_le_u32 s38, s39
    s_cselect_b64 exec, -1, 0
    v_mov_b32 v2, 2
    buffer_load_dword v2, v1, s[8:11], s33 offen sc1
    s_mov_b64 exec, -1
    v_mfma_f32_16x16x32_bf16 v[32:35], a[184:187], v[44:47], v[32:35]
    v_mfma_f32_16x16x32_bf16 v[36:39], a[188:191], v[44:47], v[36:39]
    s_waitcnt lgkmcnt(4)
    v_mfma_f32_16x16x32_bf16 v[16:19], a[192:195], v[48:51], v[16:19]
    v_mfma_f32_16x16x32_bf16 v[20:23], a[196:199], v[48:51], v[20:23]
    v_mfma_f32_16x16x32_bf16 v[24:27], a[200:203], v[48:51], v[24:27]
    s_waitcnt lgkmcnt(3)
    v_mfma_f32_16x16x32_bf16 v[28:31], a[192:195], v[52:55], v[28:31]
    v_mfma_f32_16x16x32_bf16 v[32:35], a[196:199], v[52:55], v[32:35]
    v_mfma_f32_16x16x32_bf16 v[36:39], a[200:203], v[52:55], v[36:39]
    s_waitcnt lgkmcnt(2)
    v_mfma_f32_16x16x32_bf16 v[16:19], a[204:207], v[56:59], v[16:19]
    v_mfma_f32_16x16x32_bf16 v[20:23], a[208:211], v[56:59], v[20:23]
    v_mfma_f32_16x16x32_bf16 v[24:27], a[212:215], v[56:59], v[24:27]
    s_waitcnt lgkmcnt(0)
    v_mfma_f32_16x16x32_bf16 v[28:31], a[204:207], v[60:63], v[28:31]
    v_mfma_f32_16x16x32_bf16 v[32:35], a[208:211], v[60:63], v[32:35]
    v_mfma_f32_16x16x32_bf16 v[36:39], a[212:215], v[60:63], v[36:39]
    v_mov_b32 v88, 0x3f803f80
    v_cvt_pk_bf16_f32 v96, v16, v17
    v_cvt_pk_bf16_f32 v97, v18, v19
    v_cvt_pk_bf16_f32 v98, v20, v21
    v_cvt_pk_bf16_f32 v99, v22, v23
    v_cvt_pk_bf16_f32 v100, v24, v25
    v_cvt_pk_bf16_f32 v101, v26, v27
    buffer_store_dwordx4 v[96:99], v10, s[8:11], s46 offen offset:0 sc1
    buffer_store_dwordx2 v[100:101], v12, s[8:11], s46 offen offset:0 sc1
    v_cvt_pk_bf16_f32 v104, v28, v29
    v_cvt_pk_bf16_f32 v105, v30, v31
    v_cvt_pk_bf16_f32 v106, v32, v33
    v_cvt_pk_bf16_f32 v107, v34, v35
    v_cvt_pk_bf16_f32 v108, v36, v37
    v_cvt_pk_bf16_f32 v109, v38, v39
    buffer_store_dwordx4 v[104:107], v10, s[8:11], s46 offen offset:256 sc1
    buffer_store_dwordx2 v[108:109], v12, s[8:11], s46 offen offset:256 sc1
    v_mov_b32 v80, 0
    v_mov_b32 v81, 0
    v_mov_b32 v84, 0
    v_mov_b32 v85, 0
    v_dot2c_f32_bf16 v80, v96, v88
    v_dot2c_f32_bf16 v81, v96, v96
    v_dot2c_f32_bf16 v84, v104, v88
    v_dot2c_f32_bf16 v85, v104, v104
    v_dot2c_f32_bf16 v80, v97, v88
    v_dot2c_f32_bf16 v81, v97, v97
    v_dot2c_f32_bf16 v84, v105, v88
    v_dot2c_f32_bf16 v85, v105, v105
    v_dot2c_f32_bf16 v80, v98, v88
    v_dot2c_f32_bf16 v81, v98, v98
    v_dot2c_f32_bf16 v84, v106, v88
    v_dot2c_f32_bf16 v85, v106, v106
    v_dot2c_f32_bf16 v80, v99, v88
    v_dot2c_f32_bf16 v81, v99, v99
    v_dot2c_f32_bf16 v84, v107, v88
    v_dot2c_f32_bf16 v85, v107, v107
    v_dot2c_f32_bf16 v80, v100, v88
    v_dot2c_f32_bf16 v81, v100, v100
    v_dot2c_f32_bf16 v84, v108, v88
    v_dot2c_f32_bf16 v85, v108, v108
    v_dot2c_f32_bf16 v80, v101, v88
    v_dot2c_f32_bf16 v81, v101, v101
    v_dot2c_f32_bf16 v84, v109, v88
    v_dot2c_f32_bf16 v85, v109, v109
    s_nop 2
    v_mov_b32 v82, v80
    v_mov_b32 v83, v81
    v_mov_b32 v86, v84
    v_mov_b32 v87, v85
    v_permlane32_swap_b32 v80, v82
    v_permlane32_swap_b32 v81, v83
    v_permlane32_swap_b32 v84, v86
    v_permlane32_swap_b32 v85, v87
    v_add_f32 v80, v80, v82
    v_add_f32 v81, v81, v83
    v_add_f32 v84, v84, v86
    v_add_f32 v85, v85, v87
    v_mov_b32 v82, v80
    v_mov_b32 v83, v81
    v_mov_b32 v86, v84
    v_mov_b32 v87, v85
    v_permlane16_swap_b32 v80, v82
    v_permlane16_swap_b32 v81, v83
    v_permlane16_swap_b32 v84, v86
    v_permlane16_swap_b32 v85, v87
    v_add_f32 v80, v80, v82
    v_add_f32 v81, v81, v83
    v_add_f32 v84, v84, v86
    v_add_f32 v85, v85, v87
    s_mov_b64 exec, 0xffff
    buffer_store_dwordx2 v[80:81], v11, s[8:11], s52 offen offset:0 sc1
    buffer_store_dwordx2 v[84:85], v11, s[8:11], s52 offen offset:256 sc1
    s_mov_b64 exec, -1
    s_mul_i32 s43, s57, 22528
    s_add_u32 s43, s43, s49
    s_branch Lawo_head
Lawo_none:
    ds_read_b32 v15, v184
    s_waitcnt lgkmcnt(0)
    v_readfirstlane_b32 s17, v15
    s_nop 0
    s_cmp_lt_i32 s17, s37
    s_cbranch_scc1 Lawo_nopost
    s_add_u32 m0, s59, 0
    s_add_u32 s47, s41, 0
    buffer_load_dwordx4 v0, s[8:11], s47 offen offset:0 lds
    buffer_load_dwordx4 v0, s[8:11], s47 offen offset:1024 lds
    buffer_load_dwordx4 v0, s[8:11], s47 offen offset:2048 lds
    buffer_load_dwordx4 v0, s[8:11], s47 offen offset:3072 lds
    s_add_u32 m0, s59, 4096
    s_add_u32 s47, s41, 4096
    buffer_load_dwordx4 v0, s[8:11], s47 offen offset:0 lds
    buffer_load_dwordx4 v0, s[8:11], s47 offen offset:1024 lds
    buffer_load_dwordx4 v0, s[8:11], s47 offen offset:2048 lds
    buffer_load_dwordx4 v0, s[8:11], s47 offen offset:3072 lds
    s_add_u32 m0, s59, 8192
    s_add_u32 s47, s41, 8192
    buffer_load_dwordx4 v0, s[8:11], s47 offen offset:0 lds
    s_mul_i32 s48, s36, 4718592
    s_mul_i32 s18, s37, 36864
    s_add_u32 s48, s48, s18
    s_add_u32 s48, s48, 6291456
    buffer_load_dwordx4 v[64:67], v10, s[8:11], s48 offen offset:0
    buffer_load_dwordx2 v[68:69], v12, s[8:11], s48 offen offset:0
    buffer_load_dwordx4 v[72:75], v10, s[8:11], s48 offen offset:256
    buffer_load_dwordx2 v[76:77], v12, s[8:11], s48 offen offset:256
    s_waitcnt vmcnt(13)
    s_cmp_lg_u32 s43, 0
    s_cselect_b64 exec, 1, 0
    buffer_store_dword v3, v4, s[8:11], s43 offen sc1
    s_mov_b64 exec, -1
    s_mov_b32 s43, 0
    s_waitcnt vmcnt(1) lgkmcnt(0)
    s_branch Lawo_head2
Lawo_nopost:
    s_waitcnt vmcnt(0)
    s_cmp_lg_u32 s43, 0
    s_cselect_b64 exec, 1, 0
    buffer_store_dword v3, v4, s[8:11], s43 offen sc1
    s_mov_b64 exec, -1
    s_mov_b32 s43, 0
    s_cmp_ge_u32 s37, 64
    s_cbranch_scc1 Lawo_end
Lawo_wait:
    s_mov_b32 s16, 0
    s_cmp_lg_u32 s14, 0
    s_cbranch_scc1 Lawo_wl
Lawo_wp:
    buffer_load_dword v2, v1, s[8:11], s60 offen sc1
    s_add_u32 s16, s16, 1
    s_cmp_gt_u32 s16, 100000
    s_cbranch_scc1 Lawo_giveup
    s_waitcnt vmcnt(0)
    v_cmp_eq_u32 vcc, 0, v2
    s_nop 0
    s_cbranch_vccz Lawo_wok
    s_sleep 4
    s_branch Lawo_wp
Lawo_giveup:
    v_mov_b32 v5, -2
    ds_write_b32 v184, v5
    s_waitcnt lgkmcnt(0)
    s_branch L_role_awo_abort
Lawo_wok:
    v_mov_b32 v5, s37
    ds_write_b32 v184, v5
    s_branch Lawo_go
Lawo_wl:
    ds_read_b32 v15, v184
    s_add_u32 s16, s16, 1
    s_cmp_gt_u32 s16, 1600000
    s_cbranch_scc1 L_role_awo_abort
    s_waitcnt lgkmcnt(0)
    v_readfirstlane_b32 s17, v15
    s_nop 0
    s_cmp_eq_u32 s17, -2
    s_cbranch_scc1 L_role_awo_abort
    s_cmp_ge_i32 s17, s37
    s_cbranch_scc1 Lawo_go
    s_sleep 1
    s_branch Lawo_wl
Lawo_go:
    s_add_u32 m0, s59, 0
    s_add_u32 s47, s41, 0
    buffer_load_dwordx4 v0, s[8:11], s47 offen offset:0 lds
    buffer_load_dwordx4 v0, s[8:11], s47 offen offset:1024 lds
    buffer_load_dwordx4 v0, s[8:11], s47 offen offset:2048 lds
    buffer_load_dwordx4 v0, s[8:11], s47 offen offset:3072 lds
    s_add_u32 m0, s59, 4096
    s_add_u32 s47, s41, 4096
    buffer_load_dwordx4 v0, s[8:11], s47 offen offset:0 lds
    buffer_load_dwordx4 v0, s[8:11], s47 offen offset:1024 lds
    buffer_load_dwordx4 v0, s[8:11], s47 offen offset:2048 lds
    buffer_load_dwordx4 v0, s[8:11], s47 offen offset:3072 lds
    s_add_u32 m0, s59, 8192
    s_add_u32 s47, s41, 8192
    buffer_load_dwordx4 v0, s[8:11], s47 offen offset:0 lds
    s_mul_i32 s48, s36, 4718592
    s_mul_i32 s18, s37, 36864
    s_add_u32 s48, s48, s18
    s_add_u32 s48, s48, 6291456
    buffer_load_dwordx4 v[64:67], v10, s[8:11], s48 offen offset:0
    buffer_load_dwordx2 v[68:69], v12, s[8:11], s48 offen offset:0
    buffer_load_dwordx4 v[72:75], v10, s[8:11], s48 offen offset:256
    buffer_load_dwordx2 v[76:77], v12, s[8:11], s48 offen offset:256
    s_waitcnt vmcnt(0) lgkmcnt(0)
    s_branch Lawo_head2
Lawo_end:
    s_branch L_role_awo_exit
L_role_awo_abort:
    s_waitcnt lgkmcnt(0)
    s_mov_b64 exec, -1
    v_mov_b32 v0, 60
    s_lshl_b32 s5, s3, 8
    s_or_b32 s5, s5, s4
    s_or_b32 s5, s5, 0x10000
    v_mov_b32 v1, s5
    global_store_dword v0, v1, s[12:13]
    s_endpgm
L_role_awo_exit:
    s_endpgm
.p2align 6
L_role_aq:
    v_and_b32 v5, 63, v0
    v_lshlrev_b32 v0, 4, v5
    v_and_b32 v7, 15, v5
    v_lshrrev_b32 v8, 4, v5
    v_min_u32 v1, 47, v5
    v_lshrrev_b32 v6, 2, v1
    v_and_b32 v1, 3, v1
    v_lshlrev_b32 v1, 2, v1
    v_lshl_add_u32 v1, v6, 7, v1
    v_mov_b32 v3, 1
    v_mov_b32 v4, 0
    s_mov_b32 s44, 0x05040100
    s_mov_b32 s45, 0x07060302
    s_lshr_b32 s63, s15, 4
    s_and_b32 s15, s15, 15
    s_lshr_b32 s50, s15, 1
    s_lshl_b32 s50, s50, 2
    s_and_b32 s17, s15, 1
    s_add_u32 s50, s50, s17
    s_and_b32 s17, s14, 2
    s_add_u32 s50, s50, s17
    s_and_b32 s51, s14, 1
    s_cmp_eq_u32 s63, 0
    s_cbranch_scc1 Laq_gate_ng
    s_cmp_lg_u32 s14, 0
    s_cbranch_scc1 Laq_gate_d
    v_mov_b32 v5, 48
    s_mov_b32 s16, 0
Laq_gate:
    global_load_dword v6, v5, s[12:13] sc1
    s_add_u32 s16, s16, 1
    s_cmp_gt_u32 s16, 100000
    s_cbranch_scc1 L_role_aq_abort
    s_waitcnt vmcnt(0)
    v_cmp_gt_u32 vcc, 32, v6
    s_nop 0
    s_cbranch_vccz Laq_gate_d
    s_sleep 100
    s_branch Laq_gate
Laq_gate_d:
    s_barrier
Laq_gate_ng:
    s_load_dwordx2 s[20:21], s[0:1], 8
    s_mov_b32 s22, 1990656
    s_mov_b32 s23, 0x00020000
    s_waitcnt lgkmcnt(0)
    s_and_b32 s21, s21, 0xffff
    v_lshrrev_b32 v5, 7, v0
    v_mul_u32_u24 v16, 3456, v5
    v_and_b32 v5, 0x70, v0
    v_add_u32 v16, v16, v5
    s_lshr_b32 s17, s14, 1
    s_mul_i32 s46, s17, 72
    v_lshrrev_b32 v5, 2, v7
    v_lshl_add_u32 v5, v8, 3, v5
    v_and_b32 v6, 3, v7
    v_lshlrev_b32 v17, 7, v5
    v_lshl_add_u32 v17, v6, 3, v17
    v_add_u32 v17, s46, v17
    v_lshlrev_b32 v18, 5, v5
    v_min_u32 v6, 1, v6
    v_lshl_add_u32 v18, v6, 4, v18
    s_mul_i32 s17, s17, 3072
    s_add_u32 s17, s17, 36864
    v_add_u32 v18, s17, v18
    s_sub_u32 s17, s50, s14
    s_lshr_b32 s17, s14, 1
    s_lshl_b32 s17, s17, 1
    s_sub_u32 s17, s50, s17
    s_mul_i32 s49, s17, 36
    s_mul_i32 s17, s14, 82944
    s_add_u32 s49, s49, s17
    s_mul_i32 s47, s14, 3072
    v_lshrrev_b32 v21, 4, v0
    s_lshl_b32 s17, s14, 6
    v_add_u32 v21, s17, v21
    v_cmp_le_u32 vcc, 96, v21
    s_nop 1
    v_cndmask_b32 v5, 0, 1, vcc
    v_mul_u32_u24 v6, 96, v5
    v_sub_u32 v6, v21, v6
    v_lshlrev_b32 v19, 7, v6
    v_mul_u32_u24 v20, 72, v5
    v_add_u32 v19, v19, v20
    v_add_u32 v19, 32, v19
    v_lshlrev_b32 v20, 5, v21
    v_add_u32 v20, 36864, v20
    v_mov_b32 v24, 0
    v_mov_b32 v25, 0
    v_mov_b32 v26, 0
    v_mov_b32 v27, 0
    v_mov_b32 v31, 0
    s_cmp_eq_u32 s14, 3
    s_cselect_b64 s[76:77], 0, -1
    s_mov_b64 exec, s[76:77]
    v_add_u32 v22, 0, v20
    ds_write_b128 v22, v[24:27] offset:16
    v_add_u32 v22, 43008, v20
    ds_write_b128 v22, v[24:27] offset:16
    v_add_u32 v22, 86016, v20
    ds_write_b128 v22, v[24:27] offset:16
    s_mov_b64 exec, -1
    s_add_u32 m0, s47, 0
    s_add_u32 s17, s49, 0
    buffer_load_dwordx4 v16, s[20:23], s17 offen lds
    s_add_u32 m0, s47, 1024
    s_add_u32 s17, s49, 27648
    buffer_load_dwordx4 v16, s[20:23], s17 offen lds
    s_add_u32 m0, s47, 2048
    s_add_u32 s17, s49, 55296
    buffer_load_dwordx4 v16, s[20:23], s17 offen lds
    s_add_u32 m0, s47, 12288
    s_add_u32 s17, s49, 1152
    buffer_load_dwordx4 v16, s[20:23], s17 offen lds
    s_add_u32 m0, s47, 13312
    s_add_u32 s17, s49, 28800
    buffer_load_dwordx4 v16, s[20:23], s17 offen lds
    s_add_u32 m0, s47, 14336
    s_add_u32 s17, s49, 56448
    buffer_load_dwordx4 v16, s[20:23], s17 offen lds
    s_add_u32 m0, s47, 24576
    s_add_u32 s17, s49, 2304
    buffer_load_dwordx4 v16, s[20:23], s17 offen lds
    s_add_u32 m0, s47, 25600
    s_add_u32 s17, s49, 29952
    buffer_load_dwordx4 v16, s[20:23], s17 offen lds
    s_add_u32 m0, s47, 26624
    s_add_u32 s17, s49, 57600
    buffer_load_dwordx4 v16, s[20:23], s17 offen lds
    s_add_u32 m0, s47, 43008
    s_add_u32 s17, s49, 331776
    buffer_load_dwordx4 v16, s[20:23], s17 offen lds
    s_add_u32 m0, s47, 44032
    s_add_u32 s17, s49, 359424
    buffer_load_dwordx4 v16, s[20:23], s17 offen lds
    s_add_u32 m0, s47, 45056
    s_add_u32 s17, s49, 387072
    buffer_load_dwordx4 v16, s[20:23], s17 offen lds
    s_add_u32 m0, s47, 55296
    s_add_u32 s17, s49, 332928
    buffer_load_dwordx4 v16, s[20:23], s17 offen lds
    s_add_u32 m0, s47, 56320
    s_add_u32 s17, s49, 360576
    buffer_load_dwordx4 v16, s[20:23], s17 offen lds
    s_add_u32 m0, s47, 57344
    s_add_u32 s17, s49, 388224
    buffer_load_dwordx4 v16, s[20:23], s17 offen lds
    s_add_u32 m0, s47, 67584
    s_add_u32 s17, s49, 334080
    buffer_load_dwordx4 v16, s[20:23], s17 offen lds
    s_add_u32 m0, s47, 68608
    s_add_u32 s17, s49, 361728
    buffer_load_dwordx4 v16, s[20:23], s17 offen lds
    s_add_u32 m0, s47, 69632
    s_add_u32 s17, s49, 389376
    buffer_load_dwordx4 v16, s[20:23], s17 offen lds
    s_add_u32 m0, s47, 86016
    s_add_u32 s17, s49, 663552
    buffer_load_dwordx4 v16, s[20:23], s17 offen lds
    s_add_u32 m0, s47, 87040
    s_add_u32 s17, s49, 691200
    buffer_load_dwordx4 v16, s[20:23], s17 offen lds
    s_add_u32 m0, s47, 88064
    s_add_u32 s17, s49, 718848
    buffer_load_dwordx4 v16, s[20:23], s17 offen lds
    s_add_u32 m0, s47, 98304
    s_add_u32 s17, s49, 664704
    buffer_load_dwordx4 v16, s[20:23], s17 offen lds
    s_add_u32 m0, s47, 99328
    s_add_u32 s17, s49, 692352
    buffer_load_dwordx4 v16, s[20:23], s17 offen lds
    s_add_u32 m0, s47, 100352
    s_add_u32 s17, s49, 720000
    buffer_load_dwordx4 v16, s[20:23], s17 offen lds
    s_add_u32 m0, s47, 110592
    s_add_u32 s17, s49, 665856
    buffer_load_dwordx4 v16, s[20:23], s17 offen lds
    s_add_u32 m0, s47, 111616
    s_add_u32 s17, s49, 693504
    buffer_load_dwordx4 v16, s[20:23], s17 offen lds
    s_add_u32 m0, s47, 112640
    s_add_u32 s17, s49, 721152
    buffer_load_dwordx4 v16, s[20:23], s17 offen lds
    s_waitcnt vmcnt(18) lgkmcnt(0)
    s_barrier
    s_mov_b64 exec, s[76:77]
    v_add_u32 v22, 0, v19
    ds_read_b32 v28, v22 offset:0
    ds_read_b32 v29, v22 offset:12288
    ds_read_b32 v30, v22 offset:24576
    s_waitcnt lgkmcnt(0)
    v_add_u32 v22, 0, v20
    ds_write_b128 v22, v[28:31]
    s_mov_b64 exec, -1
    v_add_u32 v22, 0, v17
    v_add_u32 v23, 0, v18
    ds_read_b64_tr_b16 v[152:153], v22 offset:0
    ds_read_b64_tr_b16 v[154:155], v22 offset:512
    ds_read_b64_tr_b16 v[224:225], v22 offset:12288
    ds_read_b64_tr_b16 v[226:227], v22 offset:12800
    ds_read_b64_tr_b16 a[112:113], v22 offset:24576
    ds_read_b64_tr_b16 a[114:115], v22 offset:25088
    ds_read_b64_tr_b16 v[156:157], v22 offset:4096
    ds_read_b64_tr_b16 v[158:159], v22 offset:4608
    ds_read_b64_tr_b16 v[228:229], v22 offset:16384
    ds_read_b64_tr_b16 v[230:231], v22 offset:16896
    ds_read_b64_tr_b16 a[116:117], v22 offset:28672
    ds_read_b64_tr_b16 a[118:119], v22 offset:29184
    ds_read_b64_tr_b16 v[160:161], v22 offset:8192
    ds_read_b64_tr_b16 v[162:163], v22 offset:8704
    ds_read_b64_tr_b16 v[232:233], v22 offset:20480
    ds_read_b64_tr_b16 v[234:235], v22 offset:20992
    ds_read_b64_tr_b16 a[120:121], v22 offset:32768
    ds_read_b64_tr_b16 a[122:123], v22 offset:33280
    s_waitcnt lgkmcnt(0)
    s_barrier
    ds_read_b64_tr_b16 a[40:41], v23 offset:0
    ds_read_b64_tr_b16 a[42:43], v23 offset:128
    ds_read_b64_tr_b16 a[184:185], v23 offset:8
    ds_read_b64_tr_b16 a[186:187], v23 offset:136
    ds_read_b64_tr_b16 a[44:45], v23 offset:1024
    ds_read_b64_tr_b16 a[46:47], v23 offset:1152
    ds_read_b64_tr_b16 a[188:189], v23 offset:1032
    ds_read_b64_tr_b16 a[190:191], v23 offset:1160
    ds_read_b64_tr_b16 a[48:49], v23 offset:2048
    ds_read_b64_tr_b16 a[50:51], v23 offset:2176
    ds_read_b64_tr_b16 a[192:193], v23 offset:2056
    ds_read_b64_tr_b16 a[194:195], v23 offset:2184
    s_waitcnt vmcnt(9) lgkmcnt(0)
    s_barrier
    s_add_u32 m0, s47, 0
    s_add_u32 s17, s49, 995328
    buffer_load_dwordx4 v16, s[20:23], s17 offen lds
    s_add_u32 m0, s47, 1024
    s_add_u32 s17, s49, 1022976
    buffer_load_dwordx4 v16, s[20:23], s17 offen lds
    s_add_u32 m0, s47, 2048
    s_add_u32 s17, s49, 1050624
    buffer_load_dwordx4 v16, s[20:23], s17 offen lds
    s_add_u32 m0, s47, 12288
    s_add_u32 s17, s49, 996480
    buffer_load_dwordx4 v16, s[20:23], s17 offen lds
    s_add_u32 m0, s47, 13312
    s_add_u32 s17, s49, 1024128
    buffer_load_dwordx4 v16, s[20:23], s17 offen lds
    s_add_u32 m0, s47, 14336
    s_add_u32 s17, s49, 1051776
    buffer_load_dwordx4 v16, s[20:23], s17 offen lds
    s_add_u32 m0, s47, 24576
    s_add_u32 s17, s49, 997632
    buffer_load_dwordx4 v16, s[20:23], s17 offen lds
    s_add_u32 m0, s47, 25600
    s_add_u32 s17, s49, 1025280
    buffer_load_dwordx4 v16, s[20:23], s17 offen lds
    s_add_u32 m0, s47, 26624
    s_add_u32 s17, s49, 1052928
    buffer_load_dwordx4 v16, s[20:23], s17 offen lds
    s_mov_b64 exec, s[76:77]
    v_add_u32 v22, 43008, v19
    ds_read_b32 v28, v22 offset:0
    ds_read_b32 v29, v22 offset:12288
    ds_read_b32 v30, v22 offset:24576
    s_waitcnt lgkmcnt(0)
    v_add_u32 v22, 43008, v20
    ds_write_b128 v22, v[28:31]
    s_mov_b64 exec, -1
    v_add_u32 v22, 43008, v17
    v_add_u32 v23, 43008, v18
    ds_read_b64_tr_b16 v[164:165], v22 offset:0
    ds_read_b64_tr_b16 v[166:167], v22 offset:512
    ds_read_b64_tr_b16 v[236:237], v22 offset:12288
    ds_read_b64_tr_b16 v[238:239], v22 offset:12800
    ds_read_b64_tr_b16 a[124:125], v22 offset:24576
    ds_read_b64_tr_b16 a[126:127], v22 offset:25088
    ds_read_b64_tr_b16 v[168:169], v22 offset:4096
    ds_read_b64_tr_b16 v[170:171], v22 offset:4608
    ds_read_b64_tr_b16 v[240:241], v22 offset:16384
    ds_read_b64_tr_b16 v[242:243], v22 offset:16896
    ds_read_b64_tr_b16 a[128:129], v22 offset:28672
    ds_read_b64_tr_b16 a[130:131], v22 offset:29184
    ds_read_b64_tr_b16 v[172:173], v22 offset:8192
    ds_read_b64_tr_b16 v[174:175], v22 offset:8704
    ds_read_b64_tr_b16 v[244:245], v22 offset:20480
    ds_read_b64_tr_b16 v[246:247], v22 offset:20992
    ds_read_b64_tr_b16 a[132:133], v22 offset:32768
    ds_read_b64_tr_b16 a[134:135], v22 offset:33280
    s_waitcnt lgkmcnt(0)
    s_barrier
    ds_read_b64_tr_b16 a[52:53], v23 offset:0
    ds_read_b64_tr_b16 a[54:55], v23 offset:128
    ds_read_b64_tr_b16 a[196:197], v23 offset:8
    ds_read_b64_tr_b16 a[198:199], v23 offset:136
    ds_read_b64_tr_b16 a[56:57], v23 offset:1024
    ds_read_b64_tr_b16 a[58:59], v23 offset:1152
    ds_read_b64_tr_b16 a[200:201], v23 offset:1032
    ds_read_b64_tr_b16 a[202:203], v23 offset:1160
    ds_read_b64_tr_b16 a[60:61], v23 offset:2048
    ds_read_b64_tr_b16 a[62:63], v23 offset:2176
    ds_read_b64_tr_b16 a[204:205], v23 offset:2056
    ds_read_b64_tr_b16 a[206:207], v23 offset:2184
    s_waitcnt vmcnt(9) lgkmcnt(0)
    s_barrier
    s_add_u32 m0, s47, 43008
    s_add_u32 s17, s49, 1327104
    buffer_load_dwordx4 v16, s[20:23], s17 offen lds
    s_add_u32 m0, s47, 44032
    s_add_u32 s17, s49, 1354752
    buffer_load_dwordx4 v16, s[20:23], s17 offen lds
    s_add_u32 m0, s47, 45056
    s_add_u32 s17, s49, 1382400
    buffer_load_dwordx4 v16, s[20:23], s17 offen lds
    s_add_u32 m0, s47, 55296
    s_add_u32 s17, s49, 1328256
    buffer_load_dwordx4 v16, s[20:23], s17 offen lds
    s_add_u32 m0, s47, 56320
    s_add_u32 s17, s49, 1355904
    buffer_load_dwordx4 v16, s[20:23], s17 offen lds
    s_add_u32 m0, s47, 57344
    s_add_u32 s17, s49, 1383552
    buffer_load_dwordx4 v16, s[20:23], s17 offen lds
    s_add_u32 m0, s47, 67584
    s_add_u32 s17, s49, 1329408
    buffer_load_dwordx4 v16, s[20:23], s17 offen lds
    s_add_u32 m0, s47, 68608
    s_add_u32 s17, s49, 1357056
    buffer_load_dwordx4 v16, s[20:23], s17 offen lds
    s_add_u32 m0, s47, 69632
    s_add_u32 s17, s49, 1384704
    buffer_load_dwordx4 v16, s[20:23], s17 offen lds
    s_mov_b64 exec, s[76:77]
    v_add_u32 v22, 86016, v19
    ds_read_b32 v28, v22 offset:0
    ds_read_b32 v29, v22 offset:12288
    ds_read_b32 v30, v22 offset:24576
    s_waitcnt lgkmcnt(0)
    v_add_u32 v22, 86016, v20
    ds_write_b128 v22, v[28:31]
    s_mov_b64 exec, -1
    v_add_u32 v22, 86016, v17
    v_add_u32 v23, 86016, v18
    ds_read_b64_tr_b16 v[176:177], v22 offset:0
    ds_read_b64_tr_b16 v[178:179], v22 offset:512
    ds_read_b64_tr_b16 v[248:249], v22 offset:12288
    ds_read_b64_tr_b16 v[250:251], v22 offset:12800
    ds_read_b64_tr_b16 a[136:137], v22 offset:24576
    ds_read_b64_tr_b16 a[138:139], v22 offset:25088
    ds_read_b64_tr_b16 v[180:181], v22 offset:4096
    ds_read_b64_tr_b16 v[182:183], v22 offset:4608
    ds_read_b64_tr_b16 v[252:253], v22 offset:16384
    ds_read_b64_tr_b16 v[254:255], v22 offset:16896
    ds_read_b64_tr_b16 a[140:141], v22 offset:28672
    ds_read_b64_tr_b16 a[142:143], v22 offset:29184
    ds_read_b64_tr_b16 v[184:185], v22 offset:8192
    ds_read_b64_tr_b16 v[186:187], v22 offset:8704
    ds_read_b64_tr_b16 a[0:1], v22 offset:20480
    ds_read_b64_tr_b16 a[2:3], v22 offset:20992
    ds_read_b64_tr_b16 a[144:145], v22 offset:32768
    ds_read_b64_tr_b16 a[146:147], v22 offset:33280
    s_waitcnt lgkmcnt(0)
    s_barrier
    ds_read_b64_tr_b16 a[64:65], v23 offset:0
    ds_read_b64_tr_b16 a[66:67], v23 offset:128
    ds_read_b64_tr_b16 a[208:209], v23 offset:8
    ds_read_b64_tr_b16 a[210:211], v23 offset:136
    ds_read_b64_tr_b16 a[68:69], v23 offset:1024
    ds_read_b64_tr_b16 a[70:71], v23 offset:1152
    ds_read_b64_tr_b16 a[212:213], v23 offset:1032
    ds_read_b64_tr_b16 a[214:215], v23 offset:1160
    ds_read_b64_tr_b16 a[72:73], v23 offset:2048
    ds_read_b64_tr_b16 a[74:75], v23 offset:2176
    ds_read_b64_tr_b16 a[216:217], v23 offset:2056
    ds_read_b64_tr_b16 a[218:219], v23 offset:2184
    s_waitcnt vmcnt(9) lgkmcnt(0)
    s_barrier
    s_add_u32 m0, s47, 86016
    s_add_u32 s17, s49, 1658880
    buffer_load_dwordx4 v16, s[20:23], s17 offen lds
    s_add_u32 m0, s47, 87040
    s_add_u32 s17, s49, 1686528
    buffer_load_dwordx4 v16, s[20:23], s17 offen lds
    s_add_u32 m0, s47, 88064
    s_add_u32 s17, s49, 1714176
    buffer_load_dwordx4 v16, s[20:23], s17 offen lds
    s_add_u32 m0, s47, 98304
    s_add_u32 s17, s49, 1660032
    buffer_load_dwordx4 v16, s[20:23], s17 offen lds
    s_add_u32 m0, s47, 99328
    s_add_u32 s17, s49, 1687680
    buffer_load_dwordx4 v16, s[20:23], s17 offen lds
    s_add_u32 m0, s47, 100352
    s_add_u32 s17, s49, 1715328
    buffer_load_dwordx4 v16, s[20:23], s17 offen lds
    s_add_u32 m0, s47, 110592
    s_add_u32 s17, s49, 1661184
    buffer_load_dwordx4 v16, s[20:23], s17 offen lds
    s_add_u32 m0, s47, 111616
    s_add_u32 s17, s49, 1688832
    buffer_load_dwordx4 v16, s[20:23], s17 offen lds
    s_add_u32 m0, s47, 112640
    s_add_u32 s17, s49, 1716480
    buffer_load_dwordx4 v16, s[20:23], s17 offen lds
    s_mov_b64 exec, s[76:77]
    v_add_u32 v22, 0, v19
    ds_read_b32 v28, v22 offset:0
    ds_read_b32 v29, v22 offset:12288
    ds_read_b32 v30, v22 offset:24576
    s_waitcnt lgkmcnt(0)
    v_add_u32 v22, 0, v20
    ds_write_b128 v22, v[28:31]
    s_mov_b64 exec, -1
    v_add_u32 v22, 0, v17
    v_add_u32 v23, 0, v18
    ds_read_b64_tr_b16 v[188:189], v22 offset:0
    ds_read_b64_tr_b16 v[190:191], v22 offset:512
    ds_read_b64_tr_b16 a[4:5], v22 offset:12288
    ds_read_b64_tr_b16 a[6:7], v22 offset:12800
    ds_read_b64_tr_b16 a[148:149], v22 offset:24576
    ds_read_b64_tr_b16 a[150:151], v22 offset:25088
    ds_read_b64_tr_b16 v[192:193], v22 offset:4096
    ds_read_b64_tr_b16 v[194:195], v22 offset:4608
    ds_read_b64_tr_b16 a[8:9], v22 offset:16384
    ds_read_b64_tr_b16 a[10:11], v22 offset:16896
    ds_read_b64_tr_b16 a[152:153], v22 offset:28672
    ds_read_b64_tr_b16 a[154:155], v22 offset:29184
    ds_read_b64_tr_b16 v[196:197], v22 offset:8192
    ds_read_b64_tr_b16 v[198:199], v22 offset:8704
    ds_read_b64_tr_b16 a[12:13], v22 offset:20480
    ds_read_b64_tr_b16 a[14:15], v22 offset:20992
    ds_read_b64_tr_b16 a[156:157], v22 offset:32768
    ds_read_b64_tr_b16 a[158:159], v22 offset:33280
    s_waitcnt lgkmcnt(0)
    s_barrier
    ds_read_b64_tr_b16 a[76:77], v23 offset:0
    ds_read_b64_tr_b16 a[78:79], v23 offset:128
    ds_read_b64_tr_b16 a[220:221], v23 offset:8
    ds_read_b64_tr_b16 a[222:223], v23 offset:136
    ds_read_b64_tr_b16 a[80:81], v23 offset:1024
    ds_read_b64_tr_b16 a[82:83], v23 offset:1152
    ds_read_b64_tr_b16 a[224:225], v23 offset:1032
    ds_read_b64_tr_b16 a[226:227], v23 offset:1160
    ds_read_b64_tr_b16 a[84:85], v23 offset:2048
    ds_read_b64_tr_b16 a[86:87], v23 offset:2176
    ds_read_b64_tr_b16 a[228:229], v23 offset:2056
    ds_read_b64_tr_b16 a[230:231], v23 offset:2184
    s_waitcnt vmcnt(9) lgkmcnt(0)
    s_barrier
    s_mov_b64 exec, s[76:77]
    v_add_u32 v22, 43008, v19
    ds_read_b32 v28, v22 offset:0
    ds_read_b32 v29, v22 offset:12288
    ds_read_b32 v30, v22 offset:24576
    s_waitcnt lgkmcnt(0)
    v_add_u32 v22, 43008, v20
    ds_write_b128 v22, v[28:31]
    s_mov_b64 exec, -1
    v_add_u32 v22, 43008, v17
    v_add_u32 v23, 43008, v18
    ds_read_b64_tr_b16 v[200:201], v22 offset:0
    ds_read_b64_tr_b16 v[202:203], v22 offset:512
    ds_read_b64_tr_b16 a[16:17], v22 offset:12288
    ds_read_b64_tr_b16 a[18:19], v22 offset:12800
    ds_read_b64_tr_b16 a[160:161], v22 offset:24576
    ds_read_b64_tr_b16 a[162:163], v22 offset:25088
    ds_read_b64_tr_b16 v[204:205], v22 offset:4096
    ds_read_b64_tr_b16 v[206:207], v22 offset:4608
    ds_read_b64_tr_b16 a[20:21], v22 offset:16384
    ds_read_b64_tr_b16 a[22:23], v22 offset:16896
    ds_read_b64_tr_b16 a[164:165], v22 offset:28672
    ds_read_b64_tr_b16 a[166:167], v22 offset:29184
    ds_read_b64_tr_b16 v[208:209], v22 offset:8192
    ds_read_b64_tr_b16 v[210:211], v22 offset:8704
    ds_read_b64_tr_b16 a[24:25], v22 offset:20480
    ds_read_b64_tr_b16 a[26:27], v22 offset:20992
    ds_read_b64_tr_b16 a[168:169], v22 offset:32768
    ds_read_b64_tr_b16 a[170:171], v22 offset:33280
    s_waitcnt lgkmcnt(0)
    s_barrier
    ds_read_b64_tr_b16 a[88:89], v23 offset:0
    ds_read_b64_tr_b16 a[90:91], v23 offset:128
    ds_read_b64_tr_b16 a[232:233], v23 offset:8
    ds_read_b64_tr_b16 a[234:235], v23 offset:136
    ds_read_b64_tr_b16 a[92:93], v23 offset:1024
    ds_read_b64_tr_b16 a[94:95], v23 offset:1152
    ds_read_b64_tr_b16 a[236:237], v23 offset:1032
    ds_read_b64_tr_b16 a[238:239], v23 offset:1160
    ds_read_b64_tr_b16 a[96:97], v23 offset:2048
    ds_read_b64_tr_b16 a[98:99], v23 offset:2176
    ds_read_b64_tr_b16 a[240:241], v23 offset:2056
    ds_read_b64_tr_b16 a[242:243], v23 offset:2184
    s_waitcnt vmcnt(0) lgkmcnt(0)
    s_barrier
    s_mov_b64 exec, s[76:77]
    v_add_u32 v22, 86016, v19
    ds_read_b32 v28, v22 offset:0
    ds_read_b32 v29, v22 offset:12288
    ds_read_b32 v30, v22 offset:24576
    s_waitcnt lgkmcnt(0)
    v_add_u32 v22, 86016, v20
    ds_write_b128 v22, v[28:31]
    s_mov_b64 exec, -1
    v_add_u32 v22, 86016, v17
    v_add_u32 v23, 86016, v18
    ds_read_b64_tr_b16 v[212:213], v22 offset:0
    ds_read_b64_tr_b16 v[214:215], v22 offset:512
    ds_read_b64_tr_b16 a[28:29], v22 offset:12288
    ds_read_b64_tr_b16 a[30:31], v22 offset:12800
    ds_read_b64_tr_b16 a[172:173], v22 offset:24576
    ds_read_b64_tr_b16 a[174:175], v22 offset:25088
    ds_read_b64_tr_b16 v[216:217], v22 offset:4096
    ds_read_b64_tr_b16 v[218:219], v22 offset:4608
    ds_read_b64_tr_b16 a[32:33], v22 offset:16384
    ds_read_b64_tr_b16 a[34:35], v22 offset:16896
    ds_read_b64_tr_b16 a[176:177], v22 offset:28672
    ds_read_b64_tr_b16 a[178:179], v22 offset:29184
    ds_read_b64_tr_b16 v[220:221], v22 offset:8192
    ds_read_b64_tr_b16 v[222:223], v22 offset:8704
    ds_read_b64_tr_b16 a[36:37], v22 offset:20480
    ds_read_b64_tr_b16 a[38:39], v22 offset:20992
    ds_read_b64_tr_b16 a[180:181], v22 offset:32768
    ds_read_b64_tr_b16 a[182:183], v22 offset:33280
    s_waitcnt lgkmcnt(0)
    s_barrier
    ds_read_b64_tr_b16 a[100:101], v23 offset:0
    ds_read_b64_tr_b16 a[102:103], v23 offset:128
    ds_read_b64_tr_b16 a[244:245], v23 offset:8
    ds_read_b64_tr_b16 a[246:247], v23 offset:136
    ds_read_b64_tr_b16 a[104:105], v23 offset:1024
    ds_read_b64_tr_b16 a[106:107], v23 offset:1152
    ds_read_b64_tr_b16 a[248:249], v23 offset:1032
    ds_read_b64_tr_b16 a[250:251], v23 offset:1160
    ds_read_b64_tr_b16 a[108:109], v23 offset:2048
    ds_read_b64_tr_b16 a[110:111], v23 offset:2176
    ds_read_b64_tr_b16 a[252:253], v23 offset:2056
    ds_read_b64_tr_b16 a[254:255], v23 offset:2184
    s_waitcnt lgkmcnt(0)
    s_barrier
    v_mov_b32 v56, 0x3f803f80
    v_mov_b32 v57, 0x3f803f80
    v_mov_b32 v58, 0x3f803f80
    v_mov_b32 v59, 0x3f803f80
    s_nop 1
    v_mfma_f32_16x16x32_bf16 v[36:39], v[152:155], v[56:59], 0
    v_mfma_f32_16x16x32_bf16 v[40:43], v[224:227], v[56:59], 0
    v_mfma_f32_16x16x32_bf16 v[44:47], a[40:43], v[56:59], 0
    v_mfma_f32_16x16x32_bf16 v[48:51], v[56:59], a[112:115], 0
    v_mfma_f32_16x16x32_bf16 v[52:55], v[56:59], a[184:187], 0
    v_mfma_f32_16x16x32_bf16 v[36:39], v[156:159], v[56:59], v[36:39]
    v_mfma_f32_16x16x32_bf16 v[40:43], v[228:231], v[56:59], v[40:43]
    v_mfma_f32_16x16x32_bf16 v[44:47], a[44:47], v[56:59], v[44:47]
    v_mfma_f32_16x16x32_bf16 v[48:51], v[56:59], a[116:119], v[48:51]
    v_mfma_f32_16x16x32_bf16 v[52:55], v[56:59], a[188:191], v[52:55]
    v_mfma_f32_16x16x32_bf16 v[36:39], v[160:163], v[56:59], v[36:39]
    v_mfma_f32_16x16x32_bf16 v[40:43], v[232:235], v[56:59], v[40:43]
    v_mfma_f32_16x16x32_bf16 v[44:47], a[48:51], v[56:59], v[44:47]
    v_mfma_f32_16x16x32_bf16 v[48:51], v[56:59], a[120:123], v[48:51]
    v_mfma_f32_16x16x32_bf16 v[52:55], v[56:59], a[192:195], v[52:55]
    v_mfma_f32_16x16x32_bf16 v[36:39], v[164:167], v[56:59], v[36:39]
    v_mfma_f32_16x16x32_bf16 v[40:43], v[236:239], v[56:59], v[40:43]
    v_mfma_f32_16x16x32_bf16 v[44:47], a[52:55], v[56:59], v[44:47]
    v_mfma_f32_16x16x32_bf16 v[48:51], v[56:59], a[124:127], v[48:51]
    v_mfma_f32_16x16x32_bf16 v[52:55], v[56:59], a[196:199], v[52:55]
    v_mfma_f32_16x16x32_bf16 v[36:39], v[168:171], v[56:59], v[36:39]
    v_mfma_f32_16x16x32_bf16 v[40:43], v[240:243], v[56:59], v[40:43]
    v_mfma_f32_16x16x32_bf16 v[44:47], a[56:59], v[56:59], v[44:47]
    v_mfma_f32_16x16x32_bf16 v[48:51], v[56:59], a[128:131], v[48:51]
    v_mfma_f32_16x16x32_bf16 v[52:55], v[56:59], a[200:203], v[52:55]
    v_mfma_f32_16x16x32_bf16 v[36:39], v[172:175], v[56:59], v[36:39]
    v_mfma_f32_16x16x32_bf16 v[40:43], v[244:247], v[56:59], v[40:43]
    v_mfma_f32_16x16x32_bf16 v[44:47], a[60:63], v[56:59], v[44:47]
    v_mfma_f32_16x16x32_bf16 v[48:51], v[56:59], a[132:135], v[48:51]
    v_mfma_f32_16x16x32_bf16 v[52:55], v[56:59], a[204:207], v[52:55]
    v_mfma_f32_16x16x32_bf16 v[36:39], v[176:179], v[56:59], v[36:39]
    v_mfma_f32_16x16x32_bf16 v[40:43], v[248:251], v[56:59], v[40:43]
    v_mfma_f32_16x16x32_bf16 v[44:47], a[64:67], v[56:59], v[44:47]
    v_mfma_f32_16x16x32_bf16 v[48:51], v[56:59], a[136:139], v[48:51]
    v_mfma_f32_16x16x32_bf16 v[52:55], v[56:59], a[208:211], v[52:55]
    v_mfma_f32_16x16x32_bf16 v[36:39], v[180:183], v[56:59], v[36:39]
    v_mfma_f32_16x16x32_bf16 v[40:43], v[252:255], v[56:59], v[40:43]
    v_mfma_f32_16x16x32_bf16 v[44:47], a[68:71], v[56:59], v[44:47]
    v_mfma_f32_16x16x32_bf16 v[48:51], v[56:59], a[140:143], v[48:51]
    v_mfma_f32_16x16x32_bf16 v[52:55], v[56:59], a[212:215], v[52:55]
    v_mfma_f32_16x16x32_bf16 v[36:39], v[184:187], v[56:59], v[36:39]
    v_mfma_f32_16x16x32_bf16 v[40:43], a[0:3], v[56:59], v[40:43]
    v_mfma_f32_16x16x32_bf16 v[44:47], a[72:75], v[56:59], v[44:47]
    v_mfma_f32_16x16x32_bf16 v[48:51], v[56:59], a[144:147], v[48:51]
    v_mfma_f32_16x16x32_bf16 v[52:55], v[56:59], a[216:219], v[52:55]
    v_mfma_f32_16x16x32_bf16 v[36:39], v[188:191], v[56:59], v[36:39]
    v_mfma_f32_16x16x32_bf16 v[40:43], a[4:7], v[56:59], v[40:43]
    v_mfma_f32_16x16x32_bf16 v[44:47], a[76:79], v[56:59], v[44:47]
    v_mfma_f32_16x16x32_bf16 v[48:51], v[56:59], a[148:151], v[48:51]
    v_mfma_f32_16x16x32_bf16 v[52:55], v[56:59], a[220:223], v[52:55]
    v_mfma_f32_16x16x32_bf16 v[36:39], v[192:195], v[56:59], v[36:39]
    v_mfma_f32_16x16x32_bf16 v[40:43], a[8:11], v[56:59], v[40:43]
    v_mfma_f32_16x16x32_bf16 v[44:47], a[80:83], v[56:59], v[44:47]
    v_mfma_f32_16x16x32_bf16 v[48:51], v[56:59], a[152:155], v[48:51]
    v_mfma_f32_16x16x32_bf16 v[52:55], v[56:59], a[224:227], v[52:55]
    v_mfma_f32_16x16x32_bf16 v[36:39], v[196:199], v[56:59], v[36:39]
    v_mfma_f32_16x16x32_bf16 v[40:43], a[12:15], v[56:59], v[40:43]
    v_mfma_f32_16x16x32_bf16 v[44:47], a[84:87], v[56:59], v[44:47]
    v_mfma_f32_16x16x32_bf16 v[48:51], v[56:59], a[156:159], v[48:51]
    v_mfma_f32_16x16x32_bf16 v[52:55], v[56:59], a[228:231], v[52:55]
    v_mfma_f32_16x16x32_bf16 v[36:39], v[200:203], v[56:59], v[36:39]
    v_mfma_f32_16x16x32_bf16 v[40:43], a[16:19], v[56:59], v[40:43]
    v_mfma_f32_16x16x32_bf16 v[44:47], a[88:91], v[56:59], v[44:47]
    v_mfma_f32_16x16x32_bf16 v[48:51], v[56:59], a[160:163], v[48:51]
    v_mfma_f32_16x16x32_bf16 v[52:55], v[56:59], a[232:235], v[52:55]
    v_mfma_f32_16x16x32_bf16 v[36:39], v[204:207], v[56:59], v[36:39]
    v_mfma_f32_16x16x32_bf16 v[40:43], a[20:23], v[56:59], v[40:43]
    v_mfma_f32_16x16x32_bf16 v[44:47], a[92:95], v[56:59], v[44:47]
    v_mfma_f32_16x16x32_bf16 v[48:51], v[56:59], a[164:167], v[48:51]
    v_mfma_f32_16x16x32_bf16 v[52:55], v[56:59], a[236:239], v[52:55]
    v_mfma_f32_16x16x32_bf16 v[36:39], v[208:211], v[56:59], v[36:39]
    v_mfma_f32_16x16x32_bf16 v[40:43], a[24:27], v[56:59], v[40:43]
    v_mfma_f32_16x16x32_bf16 v[44:47], a[96:99], v[56:59], v[44:47]
    v_mfma_f32_16x16x32_bf16 v[48:51], v[56:59], a[168:171], v[48:51]
    v_mfma_f32_16x16x32_bf16 v[52:55], v[56:59], a[240:243], v[52:55]
    v_mfma_f32_16x16x32_bf16 v[36:39], v[212:215], v[56:59], v[36:39]
    v_mfma_f32_16x16x32_bf16 v[40:43], a[28:31], v[56:59], v[40:43]
    v_mfma_f32_16x16x32_bf16 v[44:47], a[100:103], v[56:59], v[44:47]
    v_mfma_f32_16x16x32_bf16 v[48:51], v[56:59], a[172:175], v[48:51]
    v_mfma_f32_16x16x32_bf16 v[52:55], v[56:59], a[244:247], v[52:55]
    v_mfma_f32_16x16x32_bf16 v[36:39], v[216:219], v[56:59], v[36:39]
    v_mfma_f32_16x16x32_bf16 v[40:43], a[32:35], v[56:59], v[40:43]
    v_mfma_f32_16x16x32_bf16 v[44:47], a[104:107], v[56:59], v[44:47]
    v_mfma_f32_16x16x32_bf16 v[48:51], v[56:59], a[176:179], v[48:51]
    v_mfma_f32_16x16x32_bf16 v[52:55], v[56:59], a[248:251], v[52:55]
    v_mfma_f32_16x16x32_bf16 v[36:39], v[220:223], v[56:59], v[36:39]
    v_mfma_f32_16x16x32_bf16 v[40:43], a[36:39], v[56:59], v[40:43]
    v_mfma_f32_16x16x32_bf16 v[44:47], a[108:111], v[56:59], v[44:47]
    v_mfma_f32_16x16x32_bf16 v[48:51], v[56:59], a[180:183], v[48:51]
    v_mfma_f32_16x16x32_bf16 v[52:55], v[56:59], a[252:255], v[52:55]
    v_lshlrev_b32 v10, 5, v7
    s_lshl_b32 s17, s51, 4
    v_add_u32 v10, s17, v10
    v_mul_u32_u24 v6, 1536, v8
    v_add_u32 v10, v10, v6
    s_lshl_b32 s17, s14, 7
    s_add_u32 s17, s17, 73728
    v_lshl_add_u32 v11, v7, 3, s17
    v_lshl_add_u32 v12, v8, 5, s17
    v_lshlrev_b32 v13, 5, v7
    s_lshl_b32 s17, s51, 4
    v_add_u32 v13, s17, v13
    s_lshr_b32 s17, s50, 2
    s_add_u32 s17, s17, 64
    s_lshl_b32 s17, s17, 9
    s_and_b32 s18, s50, 3
    s_lshl_b32 s18, s18, 2
    s_add_u32 s17, s17, s18
    v_add_u32 v14, s17, v13
    v_lshrrev_b32 v5, 1, v8
    v_lshl_add_u32 v13, v5, 9, v13
    v_and_b32 v5, 1, v8
    v_lshl_add_u32 v13, v5, 3, v13
    s_lshl_b32 s17, s50, 10
    v_add_u32 v13, s17, v13
    s_lshl_b32 s49, s15, 7
    s_lshl_b32 s17, s14, 2
    s_add_u32 s49, s49, s17
    s_add_u32 s49, s49, 1536
    s_mov_b32 s52, 0x3eae1a93
    v_mov_b32 v6, 0xf149f2ca
    v_lshl_add_u32 v5, v8, 2, 0
    v_sub_u32 v5, v5, v7
    v_cmp_le_i32 vcc, 9, v5
    s_nop 1
    v_cndmask_b32 v72, v6, v4, vcc
    v_add_u32 v5, 7, v5
    v_cmp_ge_u32 vcc, 7, v5
    s_nop 1
    v_cndmask_b32 v76, v6, v4, vcc
    v_lshl_add_u32 v5, v8, 2, 1
    v_sub_u32 v5, v5, v7
    v_cmp_le_i32 vcc, 9, v5
    s_nop 1
    v_cndmask_b32 v73, v6, v4, vcc
    v_add_u32 v5, 7, v5
    v_cmp_ge_u32 vcc, 7, v5
    s_nop 1
    v_cndmask_b32 v77, v6, v4, vcc
    v_lshl_add_u32 v5, v8, 2, 2
    v_sub_u32 v5, v5, v7
    v_cmp_le_i32 vcc, 9, v5
    s_nop 1
    v_cndmask_b32 v74, v6, v4, vcc
    v_add_u32 v5, 7, v5
    v_cmp_ge_u32 vcc, 7, v5
    s_nop 1
    v_cndmask_b32 v78, v6, v4, vcc
    v_lshl_add_u32 v5, v8, 2, 3
    v_sub_u32 v5, v5, v7
    v_cmp_le_i32 vcc, 9, v5
    s_nop 1
    v_cndmask_b32 v75, v6, v4, vcc
    v_add_u32 v5, 7, v5
    v_cmp_ge_u32 vcc, 7, v5
    s_nop 1
    v_cndmask_b32 v79, v6, v4, vcc
    v_mov_b32 v112, 0
    v_mov_b32 v113, 0
    v_mov_b32 v114, 0
    v_mov_b32 v115, 0
    v_mov_b32 v136, 0
    v_mov_b32 v137, 0
    v_mov_b32 v138, 0
    v_mov_b32 v139, 0
    v_mov_b32 v140, 0
    v_mov_b32 v141, 0
    v_mov_b32 v142, 0
    v_mov_b32 v143, 0
    v_mov_b32 v116, 0x3f803f80
    v_mov_b32 v117, 0x3f803f80
    v_mov_b32 v118, 0x3f803f80
    v_mov_b32 v119, 0x3f803f80
    v_mov_b32 v131, 0
    v_mov_b32 v135, 0
    s_mov_b64 exec, 0xff
    v_lshrrev_b32 v6, 2, v0
    v_lshlrev_b32 v5, 5, v6
    v_and_b32 v5, 128, v5
    v_lshrrev_b32 v6, 1, v6
    v_and_or_b32 v5, v6, 12, v5
    s_mov_b32 s16, 0
Laq_pure:
    global_load_dword v6, v5, s[12:13] sc1
    s_add_u32 s16, s16, 1
    s_cmp_gt_u32 s16, 100000
    s_cbranch_scc1 L_role_aq_abort
    s_mov_b32 s6, 0
    s_waitcnt vmcnt(0)
    v_readlane_b32 s7, v6, 0
    s_nop 0
    s_add_u32 s6, s6, s7
    v_readlane_b32 s7, v6, 1
    s_nop 0
    s_add_u32 s6, s6, s7
    v_readlane_b32 s7, v6, 2
    s_nop 0
    s_add_u32 s6, s6, s7
    v_readlane_b32 s7, v6, 3
    s_nop 0
    s_add_u32 s6, s6, s7
    v_readlane_b32 s7, v6, 4
    s_nop 0
    s_add_u32 s6, s6, s7
    v_readlane_b32 s7, v6, 5
    s_nop 0
    s_add_u32 s6, s6, s7
    v_readlane_b32 s7, v6, 6
    s_nop 0
    s_add_u32 s6, s6, s7
    v_readlane_b32 s7, v6, 7
    s_nop 0
    s_add_u32 s6, s6, s7
    v_readlane_b32 s7, v6, s3
    s_nop 0
    s_cmp_ge_u32 s7, 32
    s_cselect_b32 s78, 0, -1
    s_cselect_b32 s6, 256, s6
    s_cmp_lt_u32 s6, 256
    s_cbranch_scc1 Laq_pure
    s_mov_b32 s79, s78
    s_mov_b64 exec, -1
    s_mov_b32 s36, s63
    s_mov_b32 s34, s63
    s_mul_i32 s58, s14, 9216
    s_mul_i32 s64, s63, 4718592
    s_add_u32 s64, s64, s58
    s_add_u32 s64, s64, 6291456
    s_mul_i32 s61, s63, 1441792
    s_add_u32 s61, s61, 0
    s_mov_b32 s37, 0
    s_mov_b32 s40, 36864
    s_mov_b32 s59, s58
    s_mov_b32 s43, 0
    s_mov_b32 s62, 1
    s_mov_b32 s28, s8
    s_mov_b32 s29, s9
    s_mov_b32 s30, 0
    s_mov_b32 s31, 0x00020000
    v_mov_b32 v110, 74752
    v_mov_b32 v5, -1
    ds_write_b32 v110, v5
    s_waitcnt lgkmcnt(0)
    s_cmp_lg_u32 s14, 0
    s_cbranch_scc1 Laq_inia_d
    v_mov_b32 v5, 40
    s_mov_b32 s16, 0
Laq_inia:
    global_load_dword v6, v5, s[12:13] sc1
    s_add_u32 s16, s16, 1
    s_cmp_gt_u32 s16, 100000
    s_cbranch_scc1 L_role_aq_abort
    s_waitcnt vmcnt(0)
    v_cmp_gt_u32 vcc, 128, v6
    s_nop 0
    s_cbranch_vccz Laq_inia_d
    s_sleep 8
    s_branch Laq_inia
Laq_inia_d:
    s_barrier
    s_cmp_eq_u32 s63, 0
    s_cbranch_scc1 Laq_ini_sk
    s_cmp_lg_u32 s14, 0
    s_cbranch_scc1 Laq_inib_d
    v_mov_b32 v5, 160
    s_mov_b32 s16, 0
Laq_inib:
    global_load_dword v6, v5, s[12:13] sc1
    s_add_u32 s16, s16, 1
    s_cmp_gt_u32 s16, 100000
    s_cbranch_scc1 L_role_aq_abort
    s_waitcnt vmcnt(0)
    v_cmp_gt_u32 vcc, 64, v6
    s_nop 0
    s_cbranch_vccz Laq_inib_d
    s_sleep 8
    s_branch Laq_inib
Laq_inib_d:
    s_barrier
Laq_ini_sk:
    s_mul_i32 s41, s37, 36864
    s_add_u32 s41, s41, s64
    s_mul_i32 s60, s37, 22528
    s_add_u32 s60, s60, s61
    s_cmp_lt_u32 s37, 64
    s_cselect_b32 s60, s60, 2883584
    s_branch Laq_wait
Laq_head:
    s_waitcnt vmcnt(4)
Laq_head2:
    s_barrier
    ds_read_b32 v15, v110
    s_xor_b32 s40, s40, 36864
    s_xor_b32 s59, s59, 36864
    s_mov_b32 s35, s37
    s_lshl_b32 s57, s34, 6
    s_add_u32 s57, s57, s35
    s_add_u32 s37, s37, 1
    s_mov_b32 s39, 0
    s_mov_b32 s54, 0
    s_mul_i32 s41, s37, 36864
    s_add_u32 s41, s41, s64
    s_mul_i32 s60, s37, 22528
    s_add_u32 s60, s60, s61
    s_cmp_lt_u32 s37, 64
    s_cselect_b32 s60, s60, 2883584
    v_lshlrev_b32 v9, 9, v8
    v_lshl_add_u32 v9, v7, 5, v9
    s_lshl_b32 s17, s51, 4
    s_add_u32 s17, s17, s40
    v_add_u32 v9, s17, v9
    ds_read_b128 v[56:59], v9 offset:0
    ds_read_b128 v[60:63], v9 offset:2048
    ds_read_b128 v[64:67], v9 offset:4096
    s_waitcnt lgkmcnt(2)
    v_mfma_f32_16x16x32_bf16 v[16:19], v[152:155], v[56:59], 0
    v_add_f32 v80, v80, v84
    v_mfma_f32_16x16x32_bf16 v[20:23], v[224:227], v[56:59], 0
    v_add_f32 v81, v81, v85
    v_mfma_f32_16x16x32_bf16 v[24:27], a[40:43], v[56:59], 0
    v_add_f32 v82, v82, v86
    ds_read_b128 v[56:59], v9 offset:6144
    s_waitcnt lgkmcnt(2)
    v_mfma_f32_16x16x32_bf16 v[16:19], v[156:159], v[60:63], v[16:19]
    v_add_f32 v83, v83, v87
    v_mfma_f32_16x16x32_bf16 v[20:23], v[228:231], v[60:63], v[20:23]
    v_add_f32 v80, v80, v88
    v_mfma_f32_16x16x32_bf16 v[24:27], a[44:47], v[60:63], v[24:27]
    v_add_f32 v81, v81, v89
    v_readfirstlane_b32 s17, v15
    s_nop 0
    s_add_u32 s18, s17, 1
    s_max_i32 s32, s18, s37
    s_add_u32 s39, s37, 1
    s_min_u32 s39, s39, 63
    s_mul_i32 s33, s32, 22528
    s_add_u32 s33, s33, s61
    s_cmp_eq_u32 s14, 0
    s_cselect_b32 s18, s32, 0x7fff
    v_mov_b32 v2, 2
    s_cmp_le_u32 s18, s39
    s_cselect_b64 exec, -1, 0
    buffer_load_dword v2, v1, s[8:11], s33 offen sc1
    s_mov_b64 exec, -1
    s_cmp_ge_i32 s17, s37
    s_cbranch_scc1 Laq_f_7
    ds_read_b128 v[60:63], v9 offset:8192
    s_waitcnt lgkmcnt(2)
    v_mfma_f32_16x16x32_bf16 v[16:19], v[160:163], v[64:67], v[16:19]
    v_add_f32 v82, v82, v90
    v_mfma_f32_16x16x32_bf16 v[20:23], v[232:235], v[64:67], v[20:23]
    v_add_f32 v83, v83, v91
    v_mfma_f32_16x16x32_bf16 v[24:27], a[48:51], v[64:67], v[24:27]
    v_add_f32 v80, v80, v82
    ds_read_b128 v[64:67], v9 offset:10240
    s_waitcnt lgkmcnt(2)
    v_mfma_f32_16x16x32_bf16 v[16:19], v[164:167], v[56:59], v[16:19]
    v_add_f32 v81, v81, v83
    v_mfma_f32_16x16x32_bf16 v[20:23], v[236:239], v[56:59], v[20:23]
    v_mov_b32 v82, v80
    v_mfma_f32_16x16x32_bf16 v[24:27], a[52:55], v[56:59], v[24:27]
    v_mov_b32 v83, v81
    ds_read_b128 v[56:59], v9 offset:12288
    s_waitcnt lgkmcnt(2)
    v_mfma_f32_16x16x32_bf16 v[16:19], v[168:171], v[60:63], v[16:19]
    v_permlane32_swap_b32 v80, v82
    v_mfma_f32_16x16x32_bf16 v[20:23], v[240:243], v[60:63], v[20:23]
    v_permlane32_swap_b32 v81, v83
    v_mfma_f32_16x16x32_bf16 v[24:27], a[56:59], v[60:63], v[24:27]
    v_add_f32 v80, v80, v82
    ds_read_b128 v[60:63], v9 offset:14336
    s_waitcnt lgkmcnt(2)
    v_mfma_f32_16x16x32_bf16 v[16:19], v[172:175], v[64:67], v[16:19]
    v_add_f32 v81, v81, v83
    v_mfma_f32_16x16x32_bf16 v[20:23], v[244:247], v[64:67], v[20:23]
    v_mov_b32 v82, v80
    v_mfma_f32_16x16x32_bf16 v[24:27], a[60:63], v[64:67], v[24:27]
    v_mov_b32 v83, v81
    s_waitcnt vmcnt(1)
    s_cmp_lg_u32 s43, 0
    s_cselect_b64 exec, 1, 0
    buffer_store_dword v3, v4, s[8:11], s43 offen
    s_and_b64 exec, exec, s[78:79]
    buffer_store_dword v3, v4, s[8:11], s43 offen sc1
    s_mov_b64 exec, -1
    s_mov_b32 s43, 0
    ds_read_b128 v[64:67], v9 offset:16384
    s_waitcnt lgkmcnt(2)
    v_mfma_f32_16x16x32_bf16 v[16:19], v[176:179], v[56:59], v[16:19]
    v_permlane16_swap_b32 v80, v82
    v_mfma_f32_16x16x32_bf16 v[20:23], v[248:251], v[56:59], v[20:23]
    v_permlane16_swap_b32 v81, v83
    v_mfma_f32_16x16x32_bf16 v[24:27], a[64:67], v[56:59], v[24:27]
    v_add_f32 v80, v80, v82
    ds_read_b128 v[56:59], v9 offset:18432
    s_waitcnt lgkmcnt(2)
    v_mfma_f32_16x16x32_bf16 v[16:19], v[180:183], v[60:63], v[16:19]
    v_add_f32 v81, v81, v83
    v_mfma_f32_16x16x32_bf16 v[20:23], v[252:255], v[60:63], v[20:23]
    v_mul_f32 v80, 0x3ae38e39, v80
    v_mfma_f32_16x16x32_bf16 v[24:27], a[68:71], v[60:63], v[24:27]
    v_mul_f32 v81, 0x3ae38e39, v81
    ds_read_b128 v[60:63], v9 offset:20480
    s_waitcnt lgkmcnt(2)
    v_mfma_f32_16x16x32_bf16 v[16:19], v[184:187], v[64:67], v[16:19]
    v_fma_f32 v81, -v80, v80, v81
    v_mfma_f32_16x16x32_bf16 v[20:23], a[0:3], v[64:67], v[20:23]
    v_max_f32 v81, 0, v81
    v_mfma_f32_16x16x32_bf16 v[24:27], a[72:75], v[64:67], v[24:27]
    v_add_f32 v81, 0x3727c5ac, v81
    ds_read_b128 v[64:67], v9 offset:22528
    s_waitcnt lgkmcnt(2)
    v_mfma_f32_16x16x32_bf16 v[16:19], v[188:191], v[56:59], v[16:19]
    v_rsq_f32 v92, v81
    v_mfma_f32_16x16x32_bf16 v[20:23], a[4:7], v[56:59], v[20:23]
    v_mul_f32 v93, v80, v92
    v_mfma_f32_16x16x32_bf16 v[24:27], a[76:79], v[56:59], v[24:27]
    ds_write_b64 v11, v[92:93]
    ds_read_b128 v[56:59], v9 offset:24576
    s_waitcnt lgkmcnt(3)
    v_mfma_f32_16x16x32_bf16 v[16:19], v[192:195], v[60:63], v[16:19]
    ds_read_b128 v[96:99], v12
    v_mfma_f32_16x16x32_bf16 v[20:23], a[8:11], v[60:63], v[20:23]
    ds_read_b128 v[100:103], v12 offset:16
    v_mfma_f32_16x16x32_bf16 v[24:27], a[80:83], v[60:63], v[24:27]
    ds_read_b128 v[60:63], v9 offset:26624
    s_waitcnt lgkmcnt(5)
    v_mfma_f32_16x16x32_bf16 v[16:19], v[196:199], v[64:67], v[16:19]
    v_mfma_f32_16x16x32_bf16 v[20:23], a[12:15], v[64:67], v[20:23]
    v_mfma_f32_16x16x32_bf16 v[24:27], a[84:87], v[64:67], v[24:27]
    ds_read_b128 v[64:67], v9 offset:28672
    s_waitcnt lgkmcnt(4)
    v_mfma_f32_16x16x32_bf16 v[16:19], v[200:203], v[56:59], v[16:19]
    v_mfma_f32_16x16x32_bf16 v[20:23], a[16:19], v[56:59], v[20:23]
    v_mfma_f32_16x16x32_bf16 v[24:27], a[88:91], v[56:59], v[24:27]
    ds_read_b128 v[56:59], v9 offset:30720
    s_waitcnt lgkmcnt(2)
    v_mfma_f32_16x16x32_bf16 v[16:19], v[204:207], v[60:63], v[16:19]
    v_mfma_f32_16x16x32_bf16 v[20:23], a[20:23], v[60:63], v[20:23]
    v_mfma_f32_16x16x32_bf16 v[24:27], a[92:95], v[60:63], v[24:27]
    ds_read_b128 v[60:63], v9 offset:32768
    s_waitcnt lgkmcnt(2)
    v_mfma_f32_16x16x32_bf16 v[16:19], v[208:211], v[64:67], v[16:19]
    v_mfma_f32_16x16x32_bf16 v[20:23], a[24:27], v[64:67], v[20:23]
    v_mfma_f32_16x16x32_bf16 v[24:27], a[96:99], v[64:67], v[24:27]
    ds_read_b128 v[64:67], v9 offset:34816
    s_waitcnt lgkmcnt(2)
    v_mfma_f32_16x16x32_bf16 v[16:19], v[212:215], v[56:59], v[16:19]
    v_cmp_eq_u32 s[76:77], 1, v2
    v_cmp_eq_u32 vcc, 2, v2
    v_mfma_f32_16x16x32_bf16 v[20:23], a[28:31], v[56:59], v[20:23]
    s_cmp_eq_u64 s[76:77], -1
    s_cselect_b32 s38, 1, 0
    v_mfma_f32_16x16x32_bf16 v[24:27], a[100:103], v[56:59], v[24:27]
    s_cmp_lg_u32 s38, 0
    s_cselect_b64 exec, 1, 0
    v_mov_b32 v15, s32
    ds_write_b32 v110, v15
    v_mov_b32 v2, 2
    s_mov_b64 exec, -1
    ds_read_b128 v[56:59], v9 offset:0
    s_waitcnt lgkmcnt(3)
    v_mfma_f32_16x16x32_bf16 v[16:19], v[216:219], v[60:63], v[16:19]
    s_add_u32 s32, s32, s38
    s_mul_i32 s38, s38, 22528
    s_add_u32 s33, s33, s38
    v_mfma_f32_16x16x32_bf16 v[20:23], a[32:35], v[60:63], v[20:23]
    s_cmp_eq_u64 vcc, 0
    s_cselect_b32 s38, s32, 0x7fff
    v_mfma_f32_16x16x32_bf16 v[24:27], a[104:107], v[60:63], v[24:27]
    s_cmp_le_u32 s38, s39
    s_cselect_b64 exec, -1, 0
    v_mov_b32 v2, 2
    buffer_load_dword v2, v1, s[8:11], s33 offen sc1
    s_mov_b64 exec, -1
    ds_read_b128 v[60:63], v9 offset:2048
    s_waitcnt lgkmcnt(3)
    v_mfma_f32_16x16x32_bf16 v[16:19], v[220:223], v[64:67], v[16:19]
    v_mfma_f32_16x16x32_bf16 v[20:23], a[36:39], v[64:67], v[20:23]
    v_mfma_f32_16x16x32_bf16 v[24:27], a[108:111], v[64:67], v[24:27]
    ds_read_b32 v15, v110
    ds_read_b128 v[64:67], v9 offset:4096
    s_waitcnt lgkmcnt(3)
    v_mfma_f32_16x16x32_bf16 v[28:31], v[56:59], a[112:115], 0
    v_mfma_f32_16x16x32_bf16 v[32:35], v[56:59], a[184:187], 0
    ds_read_b128 v[56:59], v9 offset:6144
    s_waitcnt lgkmcnt(3)
    v_mfma_f32_16x16x32_bf16 v[28:31], v[60:63], a[116:119], v[28:31]
    v_mul_f32 v94, v93, v36
    v_fma_f32 v16, v16, v92, -v94
    v_mfma_f32_16x16x32_bf16 v[32:35], v[60:63], a[188:191], v[32:35]
    v_mul_f32 v94, v93, v37
    v_fma_f32 v17, v17, v92, -v94
    s_waitcnt lgkmcnt(2)
    v_readfirstlane_b32 s17, v15
    s_nop 0
    s_cmp_ge_i32 s17, s37
    s_cbranch_scc1 Laq_f_8
    ds_read_b128 v[60:63], v9 offset:8192
    s_waitcnt lgkmcnt(2)
    v_mfma_f32_16x16x32_bf16 v[28:31], v[64:67], a[120:123], v[28:31]
    v_mul_f32 v94, v93, v38
    v_fma_f32 v18, v18, v92, -v94
    v_mfma_f32_16x16x32_bf16 v[32:35], v[64:67], a[192:195], v[32:35]
    v_mul_f32 v94, v93, v39
    v_fma_f32 v19, v19, v92, -v94
    ds_read_b128 v[64:67], v9 offset:10240
    s_waitcnt lgkmcnt(2)
    v_mfma_f32_16x16x32_bf16 v[28:31], v[56:59], a[124:127], v[28:31]
    v_mul_f32 v94, v93, v44
    v_fma_f32 v24, v24, v92, -v94
    v_mfma_f32_16x16x32_bf16 v[32:35], v[56:59], a[196:199], v[32:35]
    v_mul_f32 v94, v93, v45
    v_fma_f32 v25, v25, v92, -v94
    ds_read_b128 v[56:59], v9 offset:12288
    s_waitcnt lgkmcnt(2)
    v_mfma_f32_16x16x32_bf16 v[28:31], v[60:63], a[128:131], v[28:31]
    v_mul_f32 v94, v93, v46
    v_fma_f32 v26, v26, v92, -v94
    v_mfma_f32_16x16x32_bf16 v[32:35], v[60:63], a[200:203], v[32:35]
    v_mul_f32 v94, v93, v47
    v_fma_f32 v27, v27, v92, -v94
    ds_read_b128 v[60:63], v9 offset:14336
    s_waitcnt lgkmcnt(2)
    v_mfma_f32_16x16x32_bf16 v[28:31], v[64:67], a[132:135], v[28:31]
    v_mul_f32 v94, v93, v40
    v_fma_f32 v20, v20, v92, -v94
    v_mfma_f32_16x16x32_bf16 v[32:35], v[64:67], a[204:207], v[32:35]
    v_mul_f32 v94, v93, v41
    v_fma_f32 v21, v21, v92, -v94
    ds_read_b128 v[64:67], v9 offset:16384
    s_waitcnt lgkmcnt(2)
    v_mfma_f32_16x16x32_bf16 v[28:31], v[56:59], a[136:139], v[28:31]
    v_mul_f32 v94, v93, v42
    v_fma_f32 v22, v22, v92, -v94
    v_mfma_f32_16x16x32_bf16 v[32:35], v[56:59], a[208:211], v[32:35]
    v_mul_f32 v94, v93, v43
    v_fma_f32 v23, v23, v92, -v94
    ds_read_b128 v[56:59], v9 offset:18432
    s_waitcnt lgkmcnt(2)
    v_mfma_f32_16x16x32_bf16 v[28:31], v[60:63], a[140:143], v[28:31]
    v_cvt_pk_bf16_f32 v128, v16, v17
    v_cvt_pk_bf16_f32 v129, v18, v19
    v_mfma_f32_16x16x32_bf16 v[32:35], v[60:63], a[212:215], v[32:35]
    v_cvt_pk_bf16_f32 v130, v24, v25
    v_cvt_pk_bf16_f32 v132, v20, v21
    ds_read_b128 v[60:63], v9 offset:20480
    s_waitcnt lgkmcnt(2)
    v_mfma_f32_16x16x32_bf16 v[28:31], v[64:67], a[144:147], v[28:31]
    v_cvt_pk_bf16_f32 v133, v22, v23
    v_cvt_pk_bf16_f32 v134, v26, v27
    v_mfma_f32_16x16x32_bf16 v[32:35], v[64:67], a[216:219], v[32:35]
    s_cmp_eq_u32 s35, 0
    s_cselect_b32 s46, 0xf149f2ca, 0
    ds_read_b128 v[64:67], v9 offset:22528
    s_waitcnt lgkmcnt(2)
    v_mfma_f32_16x16x32_bf16 v[28:31], v[56:59], a[148:151], v[28:31]
    v_mfma_f32_16x16x32_bf16 v[144:147], v[112:115], v[128:131], 0
    v_mfma_f32_16x16x32_bf16 v[32:35], v[56:59], a[220:223], v[32:35]
    v_mfma_f32_16x16x32_bf16 v[148:151], v[132:135], v[128:131], 0
    ds_read_b128 v[56:59], v9 offset:24576
    s_waitcnt lgkmcnt(2)
    v_mfma_f32_16x16x32_bf16 v[28:31], v[60:63], a[152:155], v[28:31]
    v_mov_b32 v112, v132
    v_mfma_f32_16x16x32_bf16 v[32:35], v[60:63], a[224:227], v[32:35]
    v_mov_b32 v113, v133
    v_mov_b32 v114, v134
    ds_read_b128 v[60:63], v9 offset:26624
    s_waitcnt lgkmcnt(2)
    v_mfma_f32_16x16x32_bf16 v[28:31], v[64:67], a[156:159], v[28:31]
    v_mfma_f32_16x16x32_bf16 v[32:35], v[64:67], a[228:231], v[32:35]
    v_fma_f32 v144, v144, s52, v72
    ds_read_b128 v[64:67], v9 offset:28672
    s_waitcnt lgkmcnt(2)
    v_mfma_f32_16x16x32_bf16 v[28:31], v[56:59], a[160:163], v[28:31]
    v_fma_f32 v145, v145, s52, v73
    v_fma_f32 v146, v146, s52, v74
    v_fma_f32 v147, v147, s52, v75
    v_mfma_f32_16x16x32_bf16 v[32:35], v[56:59], a[232:235], v[32:35]
    v_fma_f32 v148, v148, s52, v76
    v_fma_f32 v149, v149, s52, v77
    v_fma_f32 v150, v150, s52, v78
    ds_read_b128 v[56:59], v9 offset:30720
    s_waitcnt lgkmcnt(2)
    v_mfma_f32_16x16x32_bf16 v[28:31], v[60:63], a[164:167], v[28:31]
    v_fma_f32 v151, v151, s52, v79
    v_add_f32 v144, s46, v144
    v_add_f32 v145, s46, v145
    v_mfma_f32_16x16x32_bf16 v[32:35], v[60:63], a[236:239], v[32:35]
    v_add_f32 v146, s46, v146
    v_add_f32 v147, s46, v147
    v_max3_f32 v5, v144, v145, v146
    ds_read_b128 v[60:63], v9 offset:32768
    s_waitcnt lgkmcnt(2)
    v_mfma_f32_16x16x32_bf16 v[28:31], v[64:67], a[168:171], v[28:31]
    v_max3_f32 v5, v5, v147, v148
    v_max3_f32 v5, v5, v149, v150
    v_max_f32 v5, v5, v151
    v_mfma_f32_16x16x32_bf16 v[32:35], v[64:67], a[240:243], v[32:35]
    v_mov_b32 v6, v5
    s_nop 1
    v_permlane32_swap_b32 v5, v6
    ds_read_b128 v[64:67], v9 offset:34816
    s_waitcnt lgkmcnt(2)
    v_mfma_f32_16x16x32_bf16 v[28:31], v[56:59], a[172:175], v[28:31]
    v_max_f32 v5, v5, v6
    v_mov_b32 v6, v5
    v_mfma_f32_16x16x32_bf16 v[32:35], v[56:59], a[244:247], v[32:35]
    s_nop 0
    v_permlane16_swap_b32 v5, v6
    v_max_f32 v5, v5, v6
    v_sub_f32 v144, v144, v5
    s_waitcnt lgkmcnt(1)
    v_mfma_f32_16x16x32_bf16 v[28:31], v[60:63], a[176:179], v[28:31]
    v_sub_f32 v145, v145, v5
    v_sub_f32 v146, v146, v5
    v_sub_f32 v147, v147, v5
    v_mfma_f32_16x16x32_bf16 v[32:35], v[60:63], a[248:251], v[32:35]
    v_sub_f32 v148, v148, v5
    v_sub_f32 v149, v149, v5
    v_sub_f32 v150, v150, v5
    s_waitcnt lgkmcnt(0)
    v_mfma_f32_16x16x32_bf16 v[28:31], v[64:67], a[180:183], v[28:31]
    v_sub_f32 v151, v151, v5
    v_exp_f32 v144, v144
    v_exp_f32 v145, v145
    v_mfma_f32_16x16x32_bf16 v[32:35], v[64:67], a[252:255], v[32:35]
    v_exp_f32 v146, v146
    v_exp_f32 v147, v147
    v_exp_f32 v148, v148
    v_cmp_eq_u32 s[76:77], 1, v2
    v_cmp_eq_u32 vcc, 2, v2
    s_cmp_eq_u64 s[76:77], -1
    s_cselect_b32 s38, 1, 0
    s_cmp_lg_u32 s38, 0
    s_cselect_b64 exec, 1, 0
    v_mov_b32 v15, s32
    ds_write_b32 v110, v15
    v_mov_b32 v2, 2
    s_mov_b64 exec, -1
    s_add_u32 s32, s32, s38
    s_mul_i32 s38, s38, 22528
    s_add_u32 s33, s33, s38
    s_cmp_eq_u64 vcc, 0
    s_cselect_b32 s38, s32, 0x7fff
    s_cmp_le_u32 s38, s39
    s_cselect_b64 exec, -1, 0
    v_mov_b32 v2, 2
    buffer_load_dword v2, v1, s[8:11], s33 offen sc1
    s_mov_b64 exec, -1
    v_exp_f32 v149, v149
    v_exp_f32 v150, v150
    v_exp_f32 v151, v151
    v_cvt_pk_bf16_f32 v68, v144, v145
    v_cvt_pk_bf16_f32 v69, v146, v147
    v_cvt_pk_bf16_f32 v70, v148, v149
    v_cvt_pk_bf16_f32 v71, v150, v151
    s_nop 1
    v_mfma_f32_16x16x32_bf16 v[16:19], v[116:119], v[68:71], 0
    s_mul_i32 s46, s57, 36864
    s_add_u32 s46, s46, 17301504
    s_nop 5
    v_rcp_f32 v6, v16
    v_mul_f32 v94, v97, v48
    v_fma_f32 v28, v28, v96, -v94
    v_mul_f32 v94, v99, v49
    v_fma_f32 v29, v29, v98, -v94
    v_mul_f32 v94, v101, v50
    v_fma_f32 v30, v30, v100, -v94
    v_mul_f32 v94, v103, v51
    v_fma_f32 v31, v31, v102, -v94
    v_cvt_pk_bf16_f32 v138, v28, v29
    v_cvt_pk_bf16_f32 v139, v30, v31
    v_mul_f32 v94, v97, v52
    v_fma_f32 v32, v32, v96, -v94
    v_mfma_f32_16x16x32_bf16 v[20:23], v[136:139], v[68:71], 0
    v_mul_f32 v94, v99, v53
    v_fma_f32 v33, v33, v98, -v94
    v_mul_f32 v94, v101, v54
    v_fma_f32 v34, v34, v100, -v94
    v_mul_f32 v94, v103, v55
    v_fma_f32 v35, v35, v102, -v94
    v_cvt_pk_bf16_f32 v142, v32, v33
    v_cvt_pk_bf16_f32 v143, v34, v35
    v_mov_b32 v136, v138
    v_mov_b32 v137, v139
    v_mfma_f32_16x16x32_bf16 v[24:27], v[140:143], v[68:71], 0
    v_mul_f32 v20, v6, v20
    v_mul_f32 v21, v6, v21
    v_mul_f32 v22, v6, v22
    v_mul_f32 v23, v6, v23
    v_cvt_pk_bf16_f32 v20, v20, v21
    v_cvt_pk_bf16_f32 v21, v22, v23
    s_mov_b64 exec, -1
    buffer_store_dwordx2 v[20:21], v13, s[8:11], s46 offen
    s_and_b64 exec, exec, s[78:79]
    buffer_store_dwordx2 v[20:21], v13, s[8:11], s46 offen sc1
    s_mov_b64 exec, -1
    v_mov_b32 v140, v142
    v_mov_b32 v141, v143
    v_mul_f32 v24, v6, v24
    v_mul_f32 v25, v6, v25
    v_cvt_pk_bf16_f32 v24, v24, v25
    s_mov_b64 exec, 0xffff
    buffer_store_dword v24, v14, s[8:11], s46 offen
    s_and_b64 exec, exec, s[78:79]
    buffer_store_dword v24, v14, s[8:11], s46 offen sc1
    s_mov_b64 exec, -1
    s_mul_i32 s43, s57, 22528
    s_add_u32 s43, s43, s49
    s_branch Laq_none
Laq_f_7:
    ds_read_b128 v[60:63], v9 offset:8192
    s_waitcnt lgkmcnt(2)
    v_mfma_f32_16x16x32_bf16 v[16:19], v[160:163], v[64:67], v[16:19]
    v_add_f32 v82, v82, v90
    v_mfma_f32_16x16x32_bf16 v[20:23], v[232:235], v[64:67], v[20:23]
    v_add_f32 v83, v83, v91
    v_mfma_f32_16x16x32_bf16 v[24:27], a[48:51], v[64:67], v[24:27]
    v_add_f32 v80, v80, v82
    ds_read_b128 v[64:67], v9 offset:10240
    s_waitcnt lgkmcnt(2)
    v_mfma_f32_16x16x32_bf16 v[16:19], v[164:167], v[56:59], v[16:19]
    v_add_f32 v81, v81, v83
    v_mfma_f32_16x16x32_bf16 v[20:23], v[236:239], v[56:59], v[20:23]
    v_mov_b32 v82, v80
    v_mfma_f32_16x16x32_bf16 v[24:27], a[52:55], v[56:59], v[24:27]
    v_mov_b32 v83, v81
    ds_read_b128 v[56:59], v9 offset:12288
    s_waitcnt lgkmcnt(2)
    v_mfma_f32_16x16x32_bf16 v[16:19], v[168:171], v[60:63], v[16:19]
    v_permlane32_swap_b32 v80, v82
    v_mfma_f32_16x16x32_bf16 v[20:23], v[240:243], v[60:63], v[20:23]
    v_permlane32_swap_b32 v81, v83
    v_mfma_f32_16x16x32_bf16 v[24:27], a[56:59], v[60:63], v[24:27]
    v_add_f32 v80, v80, v82
    ds_read_b128 v[60:63], v9 offset:14336
    s_waitcnt lgkmcnt(2)
    v_mfma_f32_16x16x32_bf16 v[16:19], v[172:175], v[64:67], v[16:19]
    v_add_f32 v81, v81, v83
    v_mfma_f32_16x16x32_bf16 v[20:23], v[244:247], v[64:67], v[20:23]
    v_mov_b32 v82, v80
    v_mfma_f32_16x16x32_bf16 v[24:27], a[60:63], v[64:67], v[24:27]
    v_mov_b32 v83, v81
    s_waitcnt vmcnt(1)
    s_cmp_lg_u32 s43, 0
    s_cselect_b64 exec, 1, 0
    buffer_store_dword v3, v4, s[8:11], s43 offen
    s_and_b64 exec, exec, s[78:79]
    buffer_store_dword v3, v4, s[8:11], s43 offen sc1
    s_mov_b64 exec, -1
    s_mov_b32 s43, 0
    ds_read_b128 v[64:67], v9 offset:16384
    s_waitcnt lgkmcnt(2)
    v_mfma_f32_16x16x32_bf16 v[16:19], v[176:179], v[56:59], v[16:19]
    v_permlane16_swap_b32 v80, v82
    v_mfma_f32_16x16x32_bf16 v[20:23], v[248:251], v[56:59], v[20:23]
    v_permlane16_swap_b32 v81, v83
    v_mfma_f32_16x16x32_bf16 v[24:27], a[64:67], v[56:59], v[24:27]
    v_add_f32 v80, v80, v82
    ds_read_b128 v[56:59], v9 offset:18432
    s_waitcnt lgkmcnt(2)
    v_mfma_f32_16x16x32_bf16 v[16:19], v[180:183], v[60:63], v[16:19]
    v_add_f32 v81, v81, v83
    v_mfma_f32_16x16x32_bf16 v[20:23], v[252:255], v[60:63], v[20:23]
    v_mul_f32 v80, 0x3ae38e39, v80
    v_mfma_f32_16x16x32_bf16 v[24:27], a[68:71], v[60:63], v[24:27]
    v_mul_f32 v81, 0x3ae38e39, v81
    ds_read_b128 v[60:63], v9 offset:20480
    s_waitcnt lgkmcnt(2)
    v_mfma_f32_16x16x32_bf16 v[16:19], v[184:187], v[64:67], v[16:19]
    v_fma_f32 v81, -v80, v80, v81
    v_mfma_f32_16x16x32_bf16 v[20:23], a[0:3], v[64:67], v[20:23]
    v_max_f32 v81, 0, v81
    v_mfma_f32_16x16x32_bf16 v[24:27], a[72:75], v[64:67], v[24:27]
    v_add_f32 v81, 0x3727c5ac, v81
    ds_read_b128 v[64:67], v9 offset:22528
    s_waitcnt lgkmcnt(2)
    v_mfma_f32_16x16x32_bf16 v[16:19], v[188:191], v[56:59], v[16:19]
    v_rsq_f32 v92, v81
    v_mfma_f32_16x16x32_bf16 v[20:23], a[4:7], v[56:59], v[20:23]
    v_mul_f32 v93, v80, v92
    v_mfma_f32_16x16x32_bf16 v[24:27], a[76:79], v[56:59], v[24:27]
    ds_write_b64 v11, v[92:93]
    ds_read_b128 v[56:59], v9 offset:24576
    s_waitcnt lgkmcnt(3)
    v_mfma_f32_16x16x32_bf16 v[16:19], v[192:195], v[60:63], v[16:19]
    ds_read_b128 v[96:99], v12
    v_mfma_f32_16x16x32_bf16 v[20:23], a[8:11], v[60:63], v[20:23]
    ds_read_b128 v[100:103], v12 offset:16
    v_mfma_f32_16x16x32_bf16 v[24:27], a[80:83], v[60:63], v[24:27]
    s_add_u32 m0, s59, 0
    s_add_u32 s47, s41, 0
    buffer_load_dwordx4 v0, s[8:11], s47 offen offset:0 lds
    ds_read_b128 v[60:63], v9 offset:26624
    s_waitcnt lgkmcnt(5)
    v_mfma_f32_16x16x32_bf16 v[16:19], v[196:199], v[64:67], v[16:19]
    buffer_load_dwordx4 v0, s[8:11], s47 offen offset:1024 lds
    buffer_load_dwordx4 v0, s[8:11], s47 offen offset:2048 lds
    buffer_load_dwordx4 v0, s[8:11], s47 offen offset:3072 lds
    v_mfma_f32_16x16x32_bf16 v[20:23], a[12:15], v[64:67], v[20:23]
    s_add_u32 m0, s59, 4096
    s_add_u32 s47, s41, 4096
    buffer_load_dwordx4 v0, s[8:11], s47 offen offset:0 lds
    v_mfma_f32_16x16x32_bf16 v[24:27], a[84:87], v[64:67], v[24:27]
    buffer_load_dwordx4 v0, s[8:11], s47 offen offset:1024 lds
    buffer_load_dwordx4 v0, s[8:11], s47 offen offset:2048 lds
    buffer_load_dwordx4 v0, s[8:11], s47 offen offset:3072 lds
    ds_read_b128 v[64:67], v9 offset:28672
    s_waitcnt lgkmcnt(4)
    v_mfma_f32_16x16x32_bf16 v[16:19], v[200:203], v[56:59], v[16:19]
    s_add_u32 m0, s59, 8192
    s_add_u32 s47, s41, 8192
    buffer_load_dwordx4 v0, s[8:11], s47 offen offset:0 lds
    v_mfma_f32_16x16x32_bf16 v[20:23], a[16:19], v[56:59], v[20:23]
    v_mfma_f32_16x16x32_bf16 v[24:27], a[88:91], v[56:59], v[24:27]
    ds_read_b128 v[56:59], v9 offset:30720
    s_waitcnt lgkmcnt(2)
    v_mfma_f32_16x16x32_bf16 v[16:19], v[204:207], v[60:63], v[16:19]
    v_mfma_f32_16x16x32_bf16 v[20:23], a[20:23], v[60:63], v[20:23]
    v_mfma_f32_16x16x32_bf16 v[24:27], a[92:95], v[60:63], v[24:27]
    ds_read_b128 v[60:63], v9 offset:32768
    s_waitcnt lgkmcnt(2)
    v_mfma_f32_16x16x32_bf16 v[16:19], v[208:211], v[64:67], v[16:19]
    v_mfma_f32_16x16x32_bf16 v[20:23], a[24:27], v[64:67], v[20:23]
    v_mfma_f32_16x16x32_bf16 v[24:27], a[96:99], v[64:67], v[24:27]
    ds_read_b128 v[64:67], v9 offset:34816
    s_waitcnt lgkmcnt(2)
    v_mfma_f32_16x16x32_bf16 v[16:19], v[212:215], v[56:59], v[16:19]
    v_cmp_eq_u32 s[76:77], 1, v2
    v_cmp_eq_u32 vcc, 2, v2
    v_mfma_f32_16x16x32_bf16 v[20:23], a[28:31], v[56:59], v[20:23]
    s_cmp_eq_u64 s[76:77], -1
    s_cselect_b32 s38, 1, 0
    v_mfma_f32_16x16x32_bf16 v[24:27], a[100:103], v[56:59], v[24:27]
    s_cmp_lg_u32 s38, 0
    s_cselect_b64 exec, 1, 0
    v_mov_b32 v15, s32
    ds_write_b32 v110, v15
    v_mov_b32 v2, 2
    s_mov_b64 exec, -1
    ds_read_b128 v[56:59], v9 offset:0
    s_waitcnt lgkmcnt(3)
    v_mfma_f32_16x16x32_bf16 v[16:19], v[216:219], v[60:63], v[16:19]
    s_add_u32 s32, s32, s38
    s_mul_i32 s38, s38, 22528
    s_add_u32 s33, s33, s38
    v_mfma_f32_16x16x32_bf16 v[20:23], a[32:35], v[60:63], v[20:23]
    s_cmp_eq_u64 vcc, 0
    s_cselect_b32 s38, s32, 0x7fff
    v_mfma_f32_16x16x32_bf16 v[24:27], a[104:107], v[60:63], v[24:27]
    s_cmp_le_u32 s38, s39
    s_cselect_b64 exec, -1, 0
    v_mov_b32 v2, 2
    buffer_load_dword v2, v1, s[8:11], s33 offen sc1
    s_mov_b64 exec, -1
    ds_read_b128 v[60:63], v9 offset:2048
    s_waitcnt lgkmcnt(3)
    v_mfma_f32_16x16x32_bf16 v[16:19], v[220:223], v[64:67], v[16:19]
    s_mul_i32 s48, s36, 786432
    s_mul_i32 s18, s37, 6144
    s_add_u32 s48, s48, s18
    s_add_u32 s48, s48, 15728640
    buffer_load_dwordx4 v[80:83], v10, s[8:11], s48 offen offset:0
    v_mfma_f32_16x16x32_bf16 v[20:23], a[36:39], v[64:67], v[20:23]
    v_mfma_f32_16x16x32_bf16 v[24:27], a[108:111], v[64:67], v[24:27]
    ds_read_b128 v[64:67], v9 offset:4096
    s_waitcnt lgkmcnt(2)
    v_mfma_f32_16x16x32_bf16 v[28:31], v[56:59], a[112:115], 0
    buffer_load_dwordx4 v[84:87], v10, s[8:11], s48 offen offset:512
    v_mfma_f32_16x16x32_bf16 v[32:35], v[56:59], a[184:187], 0
    ds_read_b128 v[56:59], v9 offset:6144
    s_waitcnt lgkmcnt(2)
    v_mfma_f32_16x16x32_bf16 v[28:31], v[60:63], a[116:119], v[28:31]
    buffer_load_dwordx4 v[88:91], v10, s[8:11], s48 offen offset:1024
    v_mul_f32 v94, v93, v36
    v_fma_f32 v16, v16, v92, -v94
    v_mfma_f32_16x16x32_bf16 v[32:35], v[60:63], a[188:191], v[32:35]
    v_mul_f32 v94, v93, v37
    v_fma_f32 v17, v17, v92, -v94
    ds_read_b128 v[60:63], v9 offset:8192
    s_waitcnt lgkmcnt(2)
    v_mfma_f32_16x16x32_bf16 v[28:31], v[64:67], a[120:123], v[28:31]
    v_mul_f32 v94, v93, v38
    v_fma_f32 v18, v18, v92, -v94
    v_mfma_f32_16x16x32_bf16 v[32:35], v[64:67], a[192:195], v[32:35]
    v_mul_f32 v94, v93, v39
    v_fma_f32 v19, v19, v92, -v94
    ds_read_b128 v[64:67], v9 offset:10240
    s_waitcnt lgkmcnt(2)
    v_mfma_f32_16x16x32_bf16 v[28:31], v[56:59], a[124:127], v[28:31]
    v_mul_f32 v94, v93, v44
    v_fma_f32 v24, v24, v92, -v94
    v_mfma_f32_16x16x32_bf16 v[32:35], v[56:59], a[196:199], v[32:35]
    v_mul_f32 v94, v93, v45
    v_fma_f32 v25, v25, v92, -v94
    ds_read_b128 v[56:59], v9 offset:12288
    s_waitcnt lgkmcnt(2)
    v_mfma_f32_16x16x32_bf16 v[28:31], v[60:63], a[128:131], v[28:31]
    v_mul_f32 v94, v93, v46
    v_fma_f32 v26, v26, v92, -v94
    v_mfma_f32_16x16x32_bf16 v[32:35], v[60:63], a[200:203], v[32:35]
    v_mul_f32 v94, v93, v47
    v_fma_f32 v27, v27, v92, -v94
    ds_read_b128 v[60:63], v9 offset:14336
    s_waitcnt lgkmcnt(2)
    v_mfma_f32_16x16x32_bf16 v[28:31], v[64:67], a[132:135], v[28:31]
    v_mul_f32 v94, v93, v40
    v_fma_f32 v20, v20, v92, -v94
    v_mfma_f32_16x16x32_bf16 v[32:35], v[64:67], a[204:207], v[32:35]
    v_mul_f32 v94, v93, v41
    v_fma_f32 v21, v21, v92, -v94
    ds_read_b128 v[64:67], v9 offset:16384
    s_waitcnt lgkmcnt(2)
    v_mfma_f32_16x16x32_bf16 v[28:31], v[56:59], a[136:139], v[28:31]
    v_mul_f32 v94, v93, v42
    v_fma_f32 v22, v22, v92, -v94
    v_mfma_f32_16x16x32_bf16 v[32:35], v[56:59], a[208:211], v[32:35]
    v_mul_f32 v94, v93, v43
    v_fma_f32 v23, v23, v92, -v94
    ds_read_b128 v[56:59], v9 offset:18432
    s_waitcnt lgkmcnt(2)
    v_mfma_f32_16x16x32_bf16 v[28:31], v[60:63], a[140:143], v[28:31]
    v_cvt_pk_bf16_f32 v128, v16, v17
    v_cvt_pk_bf16_f32 v129, v18, v19
    v_mfma_f32_16x16x32_bf16 v[32:35], v[60:63], a[212:215], v[32:35]
    v_cvt_pk_bf16_f32 v130, v24, v25
    v_cvt_pk_bf16_f32 v132, v20, v21
    ds_read_b128 v[60:63], v9 offset:20480
    s_waitcnt lgkmcnt(2)
    v_mfma_f32_16x16x32_bf16 v[28:31], v[64:67], a[144:147], v[28:31]
    v_cvt_pk_bf16_f32 v133, v22, v23
    v_cvt_pk_bf16_f32 v134, v26, v27
    v_mfma_f32_16x16x32_bf16 v[32:35], v[64:67], a[216:219], v[32:35]
    s_cmp_eq_u32 s35, 0
    s_cselect_b32 s46, 0xf149f2ca, 0
    ds_read_b128 v[64:67], v9 offset:22528
    s_waitcnt lgkmcnt(2)
    v_mfma_f32_16x16x32_bf16 v[28:31], v[56:59], a[148:151], v[28:31]
    v_mfma_f32_16x16x32_bf16 v[144:147], v[112:115], v[128:131], 0
    v_mfma_f32_16x16x32_bf16 v[32:35], v[56:59], a[220:223], v[32:35]
    v_mfma_f32_16x16x32_bf16 v[148:151], v[132:135], v[128:131], 0
    ds_read_b128 v[56:59], v9 offset:24576
    s_waitcnt lgkmcnt(2)
    v_mfma_f32_16x16x32_bf16 v[28:31], v[60:63], a[152:155], v[28:31]
    v_mov_b32 v112, v132
    v_mfma_f32_16x16x32_bf16 v[32:35], v[60:63], a[224:227], v[32:35]
    v_mov_b32 v113, v133
    v_mov_b32 v114, v134
    ds_read_b128 v[60:63], v9 offset:26624
    s_waitcnt lgkmcnt(2)
    v_mfma_f32_16x16x32_bf16 v[28:31], v[64:67], a[156:159], v[28:31]
    v_mfma_f32_16x16x32_bf16 v[32:35], v[64:67], a[228:231], v[32:35]
    v_fma_f32 v144, v144, s52, v72
    ds_read_b128 v[64:67], v9 offset:28672
    s_waitcnt lgkmcnt(2)
    v_mfma_f32_16x16x32_bf16 v[28:31], v[56:59], a[160:163], v[28:31]
    v_fma_f32 v145, v145, s52, v73
    v_fma_f32 v146, v146, s52, v74
    v_fma_f32 v147, v147, s52, v75
    v_mfma_f32_16x16x32_bf16 v[32:35], v[56:59], a[232:235], v[32:35]
    v_fma_f32 v148, v148, s52, v76
    v_fma_f32 v149, v149, s52, v77
    v_fma_f32 v150, v150, s52, v78
    ds_read_b128 v[56:59], v9 offset:30720
    s_waitcnt lgkmcnt(2)
    v_mfma_f32_16x16x32_bf16 v[28:31], v[60:63], a[164:167], v[28:31]
    v_fma_f32 v151, v151, s52, v79
    v_add_f32 v144, s46, v144
    v_add_f32 v145, s46, v145
    v_mfma_f32_16x16x32_bf16 v[32:35], v[60:63], a[236:239], v[32:35]
    v_add_f32 v146, s46, v146
    v_add_f32 v147, s46, v147
    v_max3_f32 v5, v144, v145, v146
    ds_read_b128 v[60:63], v9 offset:32768
    s_waitcnt lgkmcnt(2)
    v_mfma_f32_16x16x32_bf16 v[28:31], v[64:67], a[168:171], v[28:31]
    v_max3_f32 v5, v5, v147, v148
    v_max3_f32 v5, v5, v149, v150
    v_max_f32 v5, v5, v151
    v_mfma_f32_16x16x32_bf16 v[32:35], v[64:67], a[240:243], v[32:35]
    v_mov_b32 v6, v5
    s_nop 1
    v_permlane32_swap_b32 v5, v6
    ds_read_b128 v[64:67], v9 offset:34816
    s_waitcnt lgkmcnt(2)
    v_mfma_f32_16x16x32_bf16 v[28:31], v[56:59], a[172:175], v[28:31]
    v_max_f32 v5, v5, v6
    v_mov_b32 v6, v5
    v_mfma_f32_16x16x32_bf16 v[32:35], v[56:59], a[244:247], v[32:35]
    s_nop 0
    v_permlane16_swap_b32 v5, v6
    v_max_f32 v5, v5, v6
    v_sub_f32 v144, v144, v5
    s_waitcnt lgkmcnt(1)
    v_mfma_f32_16x16x32_bf16 v[28:31], v[60:63], a[176:179], v[28:31]
    v_sub_f32 v145, v145, v5
    v_sub_f32 v146, v146, v5
    v_sub_f32 v147, v147, v5
    v_mfma_f32_16x16x32_bf16 v[32:35], v[60:63], a[248:251], v[32:35]
    v_sub_f32 v148, v148, v5
    v_sub_f32 v149, v149, v5
    v_sub_f32 v150, v150, v5
    s_waitcnt lgkmcnt(0)
    v_mfma_f32_16x16x32_bf16 v[28:31], v[64:67], a[180:183], v[28:31]
    v_sub_f32 v151, v151, v5
    v_exp_f32 v144, v144
    v_exp_f32 v145, v145
    v_mfma_f32_16x16x32_bf16 v[32:35], v[64:67], a[252:255], v[32:35]
    v_exp_f32 v146, v146
    v_exp_f32 v147, v147
    v_exp_f32 v148, v148
    v_cmp_eq_u32 s[76:77], 1, v2
    v_cmp_eq_u32 vcc, 2, v2
    s_cmp_eq_u64 s[76:77], -1
    s_cselect_b32 s38, 1, 0
    s_cmp_lg_u32 s38, 0
    s_cselect_b64 exec, 1, 0
    v_mov_b32 v15, s32
    ds_write_b32 v110, v15
    v_mov_b32 v2, 2
    s_mov_b64 exec, -1
    s_add_u32 s32, s32, s38
    s_mul_i32 s38, s38, 22528
    s_add_u32 s33, s33, s38
    s_cmp_eq_u64 vcc, 0
    s_cselect_b32 s38, s32, 0x7fff
    s_cmp_le_u32 s38, s39
    s_cselect_b64 exec, -1, 0
    v_mov_b32 v2, 2
    buffer_load_dword v2, v1, s[8:11], s33 offen sc1
    s_mov_b64 exec, -1
    v_exp_f32 v149, v149
    v_exp_f32 v150, v150
    v_exp_f32 v151, v151
    v_cvt_pk_bf16_f32 v68, v144, v145
    v_cvt_pk_bf16_f32 v69, v146, v147
    v_cvt_pk_bf16_f32 v70, v148, v149
    v_cvt_pk_bf16_f32 v71, v150, v151
    s_nop 1
    v_mfma_f32_16x16x32_bf16 v[16:19], v[116:119], v[68:71], 0
    s_mul_i32 s46, s57, 36864
    s_add_u32 s46, s46, 17301504
    s_nop 5
    v_rcp_f32 v6, v16
    v_mul_f32 v94, v97, v48
    v_fma_f32 v28, v28, v96, -v94
    v_mul_f32 v94, v99, v49
    v_fma_f32 v29, v29, v98, -v94
    v_mul_f32 v94, v101, v50
    v_fma_f32 v30, v30, v100, -v94
    v_mul_f32 v94, v103, v51
    v_fma_f32 v31, v31, v102, -v94
    v_cvt_pk_bf16_f32 v138, v28, v29
    v_cvt_pk_bf16_f32 v139, v30, v31
    v_mul_f32 v94, v97, v52
    v_fma_f32 v32, v32, v96, -v94
    v_mfma_f32_16x16x32_bf16 v[20:23], v[136:139], v[68:71], 0
    v_mul_f32 v94, v99, v53
    v_fma_f32 v33, v33, v98, -v94
    v_mul_f32 v94, v101, v54
    v_fma_f32 v34, v34, v100, -v94
    v_mul_f32 v94, v103, v55
    v_fma_f32 v35, v35, v102, -v94
    v_cvt_pk_bf16_f32 v142, v32, v33
    v_cvt_pk_bf16_f32 v143, v34, v35
    v_mov_b32 v136, v138
    v_mov_b32 v137, v139
    v_mfma_f32_16x16x32_bf16 v[24:27], v[140:143], v[68:71], 0
    v_mul_f32 v20, v6, v20
    v_mul_f32 v21, v6, v21
    v_mul_f32 v22, v6, v22
    v_mul_f32 v23, v6, v23
    v_cvt_pk_bf16_f32 v20, v20, v21
    v_cvt_pk_bf16_f32 v21, v22, v23
    s_mov_b64 exec, -1
    buffer_store_dwordx2 v[20:21], v13, s[8:11], s46 offen
    s_and_b64 exec, exec, s[78:79]
    buffer_store_dwordx2 v[20:21], v13, s[8:11], s46 offen sc1
    s_mov_b64 exec, -1
    v_mov_b32 v140, v142
    v_mov_b32 v141, v143
    v_mul_f32 v24, v6, v24
    v_mul_f32 v25, v6, v25
    v_cvt_pk_bf16_f32 v24, v24, v25
    s_mov_b64 exec, 0xffff
    buffer_store_dword v24, v14, s[8:11], s46 offen
    s_and_b64 exec, exec, s[78:79]
    buffer_store_dword v24, v14, s[8:11], s46 offen sc1
    s_mov_b64 exec, -1
    s_mul_i32 s43, s57, 22528
    s_add_u32 s43, s43, s49
    s_branch Laq_head
Laq_f_8:
    ds_read_b128 v[60:63], v9 offset:8192
    s_waitcnt lgkmcnt(2)
    v_mfma_f32_16x16x32_bf16 v[28:31], v[64:67], a[120:123], v[28:31]
    v_mul_f32 v94, v93, v38
    v_fma_f32 v18, v18, v92, -v94
    v_mfma_f32_16x16x32_bf16 v[32:35], v[64:67], a[192:195], v[32:35]
    v_mul_f32 v94, v93, v39
    v_fma_f32 v19, v19, v92, -v94
    ds_read_b128 v[64:67], v9 offset:10240
    s_waitcnt lgkmcnt(2)
    v_mfma_f32_16x16x32_bf16 v[28:31], v[56:59], a[124:127], v[28:31]
    v_mul_f32 v94, v93, v44
    v_fma_f32 v24, v24, v92, -v94
    v_mfma_f32_16x16x32_bf16 v[32:35], v[56:59], a[196:199], v[32:35]
    v_mul_f32 v94, v93, v45
    v_fma_f32 v25, v25, v92, -v94
    ds_read_b128 v[56:59], v9 offset:12288
    s_waitcnt lgkmcnt(2)
    v_mfma_f32_16x16x32_bf16 v[28:31], v[60:63], a[128:131], v[28:31]
    v_mul_f32 v94, v93, v46
    v_fma_f32 v26, v26, v92, -v94
    v_mfma_f32_16x16x32_bf16 v[32:35], v[60:63], a[200:203], v[32:35]
    v_mul_f32 v94, v93, v47
    v_fma_f32 v27, v27, v92, -v94
    ds_read_b128 v[60:63], v9 offset:14336
    s_waitcnt lgkmcnt(2)
    v_mfma_f32_16x16x32_bf16 v[28:31], v[64:67], a[132:135], v[28:31]
    v_mul_f32 v94, v93, v40
    v_fma_f32 v20, v20, v92, -v94
    v_mfma_f32_16x16x32_bf16 v[32:35], v[64:67], a[204:207], v[32:35]
    v_mul_f32 v94, v93, v41
    v_fma_f32 v21, v21, v92, -v94
    ds_read_b128 v[64:67], v9 offset:16384
    s_waitcnt lgkmcnt(2)
    v_mfma_f32_16x16x32_bf16 v[28:31], v[56:59], a[136:139], v[28:31]
    v_mul_f32 v94, v93, v42
    v_fma_f32 v22, v22, v92, -v94
    v_mfma_f32_16x16x32_bf16 v[32:35], v[56:59], a[208:211], v[32:35]
    v_mul_f32 v94, v93, v43
    v_fma_f32 v23, v23, v92, -v94
    ds_read_b128 v[56:59], v9 offset:18432
    s_waitcnt lgkmcnt(2)
    v_mfma_f32_16x16x32_bf16 v[28:31], v[60:63], a[140:143], v[28:31]
    v_cvt_pk_bf16_f32 v128, v16, v17
    v_cvt_pk_bf16_f32 v129, v18, v19
    v_mfma_f32_16x16x32_bf16 v[32:35], v[60:63], a[212:215], v[32:35]
    v_cvt_pk_bf16_f32 v130, v24, v25
    v_cvt_pk_bf16_f32 v132, v20, v21
    ds_read_b128 v[60:63], v9 offset:20480
    s_waitcnt lgkmcnt(2)
    v_mfma_f32_16x16x32_bf16 v[28:31], v[64:67], a[144:147], v[28:31]
    v_cvt_pk_bf16_f32 v133, v22, v23
    v_cvt_pk_bf16_f32 v134, v26, v27
    v_mfma_f32_16x16x32_bf16 v[32:35], v[64:67], a[216:219], v[32:35]
    s_cmp_eq_u32 s35, 0
    s_cselect_b32 s46, 0xf149f2ca, 0
    ds_read_b128 v[64:67], v9 offset:22528
    s_waitcnt lgkmcnt(2)
    v_mfma_f32_16x16x32_bf16 v[28:31], v[56:59], a[148:151], v[28:31]
    s_add_u32 m0, s59, 0
    s_add_u32 s47, s41, 0
    buffer_load_dwordx4 v0, s[8:11], s47 offen offset:0 lds
    v_mfma_f32_16x16x32_bf16 v[144:147], v[112:115], v[128:131], 0
    buffer_load_dwordx4 v0, s[8:11], s47 offen offset:1024 lds
    buffer_load_dwordx4 v0, s[8:11], s47 offen offset:2048 lds
    buffer_load_dwordx4 v0, s[8:11], s47 offen offset:3072 lds
    v_mfma_f32_16x16x32_bf16 v[32:35], v[56:59], a[220:223], v[32:35]
    s_add_u32 m0, s59, 4096
    s_add_u32 s47, s41, 4096
    buffer_load_dwordx4 v0, s[8:11], s47 offen offset:0 lds
    v_mfma_f32_16x16x32_bf16 v[148:151], v[132:135], v[128:131], 0
    buffer_load_dwordx4 v0, s[8:11], s47 offen offset:1024 lds
    buffer_load_dwordx4 v0, s[8:11], s47 offen offset:2048 lds
    buffer_load_dwordx4 v0, s[8:11], s47 offen offset:3072 lds
    ds_read_b128 v[56:59], v9 offset:24576
    s_waitcnt lgkmcnt(2)
    v_mfma_f32_16x16x32_bf16 v[28:31], v[60:63], a[152:155], v[28:31]
    v_mov_b32 v112, v132
    v_mfma_f32_16x16x32_bf16 v[32:35], v[60:63], a[224:227], v[32:35]
    v_mov_b32 v113, v133
    v_mov_b32 v114, v134
    ds_read_b128 v[60:63], v9 offset:26624
    s_waitcnt lgkmcnt(2)
    v_mfma_f32_16x16x32_bf16 v[28:31], v[64:67], a[156:159], v[28:31]
    s_add_u32 m0, s59, 8192
    s_add_u32 s47, s41, 8192
    buffer_load_dwordx4 v0, s[8:11], s47 offen offset:0 lds
    v_mfma_f32_16x16x32_bf16 v[32:35], v[64:67], a[228:231], v[32:35]
    s_mul_i32 s48, s36, 786432
    s_mul_i32 s18, s37, 6144
    s_add_u32 s48, s48, s18
    s_add_u32 s48, s48, 15728640
    buffer_load_dwordx4 v[80:83], v10, s[8:11], s48 offen offset:0
    v_fma_f32 v144, v144, s52, v72
    ds_read_b128 v[64:67], v9 offset:28672
    s_waitcnt lgkmcnt(2)
    v_mfma_f32_16x16x32_bf16 v[28:31], v[56:59], a[160:163], v[28:31]
    v_fma_f32 v145, v145, s52, v73
    v_fma_f32 v146, v146, s52, v74
    v_fma_f32 v147, v147, s52, v75
    v_mfma_f32_16x16x32_bf16 v[32:35], v[56:59], a[232:235], v[32:35]
    v_fma_f32 v148, v148, s52, v76
    v_fma_f32 v149, v149, s52, v77
    v_fma_f32 v150, v150, s52, v78
    ds_read_b128 v[56:59], v9 offset:30720
    s_waitcnt lgkmcnt(2)
    v_mfma_f32_16x16x32_bf16 v[28:31], v[60:63], a[164:167], v[28:31]
    v_fma_f32 v151, v151, s52, v79
    v_add_f32 v144, s46, v144
    v_add_f32 v145, s46, v145
    v_mfma_f32_16x16x32_bf16 v[32:35], v[60:63], a[236:239], v[32:35]
    v_add_f32 v146, s46, v146
    v_add_f32 v147, s46, v147
    v_max3_f32 v5, v144, v145, v146
    ds_read_b128 v[60:63], v9 offset:32768
    s_waitcnt lgkmcnt(2)
    v_mfma_f32_16x16x32_bf16 v[28:31], v[64:67], a[168:171], v[28:31]
    v_max3_f32 v5, v5, v147, v148
    v_max3_f32 v5, v5, v149, v150
    v_max_f32 v5, v5, v151
    v_mfma_f32_16x16x32_bf16 v[32:35], v[64:67], a[240:243], v[32:35]
    buffer_load_dwordx4 v[84:87], v10, s[8:11], s48 offen offset:512
    v_mov_b32 v6, v5
    s_nop 1
    v_permlane32_swap_b32 v5, v6
    ds_read_b128 v[64:67], v9 offset:34816
    s_waitcnt lgkmcnt(2)
    v_mfma_f32_16x16x32_bf16 v[28:31], v[56:59], a[172:175], v[28:31]
    buffer_load_dwordx4 v[88:91], v10, s[8:11], s48 offen offset:1024
    v_max_f32 v5, v5, v6
    v_mov_b32 v6, v5
    v_mfma_f32_16x16x32_bf16 v[32:35], v[56:59], a[244:247], v[32:35]
    s_nop 0
    v_permlane16_swap_b32 v5, v6
    v_max_f32 v5, v5, v6
    v_sub_f32 v144, v144, v5
    s_waitcnt lgkmcnt(1)
    v_mfma_f32_16x16x32_bf16 v[28:31], v[60:63], a[176:179], v[28:31]
    v_sub_f32 v145, v145, v5
    v_sub_f32 v146, v146, v5
    v_sub_f32 v147, v147, v5
    v_mfma_f32_16x16x32_bf16 v[32:35], v[60:63], a[248:251], v[32:35]
    v_sub_f32 v148, v148, v5
    v_sub_f32 v149, v149, v5
    v_sub_f32 v150, v150, v5
    s_waitcnt lgkmcnt(0)
    v_mfma_f32_16x16x32_bf16 v[28:31], v[64:67], a[180:183], v[28:31]
    v_sub_f32 v151, v151, v5
    v_exp_f32 v144, v144
    v_exp_f32 v145, v145
    v_mfma_f32_16x16x32_bf16 v[32:35], v[64:67], a[252:255], v[32:35]
    v_exp_f32 v146, v146
    v_exp_f32 v147, v147
    v_exp_f32 v148, v148
    v_cmp_eq_u32 s[76:77], 1, v2
    v_cmp_eq_u32 vcc, 2, v2
    s_cmp_eq_u64 s[76:77], -1
    s_cselect_b32 s38, 1, 0
    s_cmp_lg_u32 s38, 0
    s_cselect_b64 exec, 1, 0
    v_mov_b32 v15, s32
    ds_write_b32 v110, v15
    v_mov_b32 v2, 2
    s_mov_b64 exec, -1
    s_add_u32 s32, s32, s38
    s_mul_i32 s38, s38, 22528
    s_add_u32 s33, s33, s38
    s_cmp_eq_u64 vcc, 0
    s_cselect_b32 s38, s32, 0x7fff
    s_cmp_le_u32 s38, s39
    s_cselect_b64 exec, -1, 0
    v_mov_b32 v2, 2
    buffer_load_dword v2, v1, s[8:11], s33 offen sc1
    s_mov_b64 exec, -1
    v_exp_f32 v149, v149
    v_exp_f32 v150, v150
    v_exp_f32 v151, v151
    v_cvt_pk_bf16_f32 v68, v144, v145
    v_cvt_pk_bf16_f32 v69, v146, v147
    v_cvt_pk_bf16_f32 v70, v148, v149
    v_cvt_pk_bf16_f32 v71, v150, v151
    s_nop 1
    v_mfma_f32_16x16x32_bf16 v[16:19], v[116:119], v[68:71], 0
    s_mul_i32 s46, s57, 36864
    s_add_u32 s46, s46, 17301504
    s_nop 5
    v_rcp_f32 v6, v16
    v_mul_f32 v94, v97, v48
    v_fma_f32 v28, v28, v96, -v94
    v_mul_f32 v94, v99, v49
    v_fma_f32 v29, v29, v98, -v94
    v_mul_f32 v94, v101, v50
    v_fma_f32 v30, v30, v100, -v94
    v_mul_f32 v94, v103, v51
    v_fma_f32 v31, v31, v102, -v94
    v_cvt_pk_bf16_f32 v138, v28, v29
    v_cvt_pk_bf16_f32 v139, v30, v31
    v_mul_f32 v94, v97, v52
    v_fma_f32 v32, v32, v96, -v94
    v_mfma_f32_16x16x32_bf16 v[20:23], v[136:139], v[68:71], 0
    v_mul_f32 v94, v99, v53
    v_fma_f32 v33, v33, v98, -v94
    v_mul_f32 v94, v101, v54
    v_fma_f32 v34, v34, v100, -v94
    v_mul_f32 v94, v103, v55
    v_fma_f32 v35, v35, v102, -v94
    v_cvt_pk_bf16_f32 v142, v32, v33
    v_cvt_pk_bf16_f32 v143, v34, v35
    v_mov_b32 v136, v138
    v_mov_b32 v137, v139
    v_mfma_f32_16x16x32_bf16 v[24:27], v[140:143], v[68:71], 0
    v_mul_f32 v20, v6, v20
    v_mul_f32 v21, v6, v21
    v_mul_f32 v22, v6, v22
    v_mul_f32 v23, v6, v23
    v_cvt_pk_bf16_f32 v20, v20, v21
    v_cvt_pk_bf16_f32 v21, v22, v23
    s_mov_b64 exec, -1
    buffer_store_dwordx2 v[20:21], v13, s[8:11], s46 offen
    s_and_b64 exec, exec, s[78:79]
    buffer_store_dwordx2 v[20:21], v13, s[8:11], s46 offen sc1
    s_mov_b64 exec, -1
    v_mov_b32 v140, v142
    v_mov_b32 v141, v143
    v_mul_f32 v24, v6, v24
    v_mul_f32 v25, v6, v25
    v_cvt_pk_bf16_f32 v24, v24, v25
    s_mov_b64 exec, 0xffff
    buffer_store_dword v24, v14, s[8:11], s46 offen
    s_and_b64 exec, exec, s[78:79]
    buffer_store_dword v24, v14, s[8:11], s46 offen sc1
    s_mov_b64 exec, -1
    s_mul_i32 s43, s57, 22528
    s_add_u32 s43, s43, s49
    s_branch Laq_head
Laq_none:
    ds_read_b32 v15, v110
    s_waitcnt lgkmcnt(0)
    v_readfirstlane_b32 s17, v15
    s_nop 0
    s_cmp_lt_i32 s17, s37
    s_cbranch_scc1 Laq_nopost
    s_add_u32 m0, s59, 0
    s_add_u32 s47, s41, 0
    buffer_load_dwordx4 v0, s[8:11], s47 offen offset:0 lds
    buffer_load_dwordx4 v0, s[8:11], s47 offen offset:1024 lds
    buffer_load_dwordx4 v0, s[8:11], s47 offen offset:2048 lds
    buffer_load_dwordx4 v0, s[8:11], s47 offen offset:3072 lds
    s_add_u32 m0, s59, 4096
    s_add_u32 s47, s41, 4096
    buffer_load_dwordx4 v0, s[8:11], s47 offen offset:0 lds
    buffer_load_dwordx4 v0, s[8:11], s47 offen offset:1024 lds
    buffer_load_dwordx4 v0, s[8:11], s47 offen offset:2048 lds
    buffer_load_dwordx4 v0, s[8:11], s47 offen offset:3072 lds
    s_add_u32 m0, s59, 8192
    s_add_u32 s47, s41, 8192
    buffer_load_dwordx4 v0, s[8:11], s47 offen offset:0 lds
    s_mul_i32 s48, s36, 786432
    s_mul_i32 s18, s37, 6144
    s_add_u32 s48, s48, s18
    s_add_u32 s48, s48, 15728640
    buffer_load_dwordx4 v[80:83], v10, s[8:11], s48 offen offset:0
    buffer_load_dwordx4 v[84:87], v10, s[8:11], s48 offen offset:512
    buffer_load_dwordx4 v[88:91], v10, s[8:11], s48 offen offset:1024
    s_waitcnt vmcnt(12)
    s_cmp_lg_u32 s43, 0
    s_cselect_b64 exec, 1, 0
    buffer_store_dword v3, v4, s[8:11], s43 offen
    s_and_b64 exec, exec, s[78:79]
    buffer_store_dword v3, v4, s[8:11], s43 offen sc1
    s_mov_b64 exec, -1
    s_mov_b32 s43, 0
    s_waitcnt vmcnt(2) lgkmcnt(0)
    s_branch Laq_head2
Laq_nopost:
    s_waitcnt vmcnt(0)
    s_cmp_lg_u32 s43, 0
    s_cselect_b64 exec, 1, 0
    buffer_store_dword v3, v4, s[8:11], s43 offen
    s_and_b64 exec, exec, s[78:79]
    buffer_store_dword v3, v4, s[8:11], s43 offen sc1
    s_mov_b64 exec, -1
    s_mov_b32 s43, 0
    s_cmp_ge_u32 s37, 64
    s_cbranch_scc1 Laq_end
Laq_wait:
    s_mov_b32 s16, 0
    s_cmp_lg_u32 s14, 0
    s_cbranch_scc1 Laq_wl
Laq_wp:
    buffer_load_dword v2, v1, s[8:11], s60 offen sc1
    s_add_u32 s16, s16, 1
    s_cmp_gt_u32 s16, 100000
    s_cbranch_scc1 Laq_giveup
    s_waitcnt vmcnt(0)
    v_cmp_eq_u32 vcc, 0, v2
    s_nop 0
    s_cbranch_vccz Laq_wok
    s_sleep 4
    s_branch Laq_wp
Laq_giveup:
    v_mov_b32 v5, -2
    ds_write_b32 v110, v5
    s_waitcnt lgkmcnt(0)
    s_branch L_role_aq_abort
Laq_wok:
    v_mov_b32 v5, s37
    ds_write_b32 v110, v5
    s_branch Laq_go
Laq_wl:
    ds_read_b32 v15, v110
    s_add_u32 s16, s16, 1
    s_cmp_gt_u32 s16, 1600000
    s_cbranch_scc1 L_role_aq_abort
    s_waitcnt lgkmcnt(0)
    v_readfirstlane_b32 s17, v15
    s_nop 0
    s_cmp_eq_u32 s17, -2
    s_cbranch_scc1 L_role_aq_abort
    s_cmp_ge_i32 s17, s37
    s_cbranch_scc1 Laq_go
    s_sleep 1
    s_branch Laq_wl
Laq_go:
    s_add_u32 m0, s59, 0
    s_add_u32 s47, s41, 0
    buffer_load_dwordx4 v0, s[8:11], s47 offen offset:0 lds
    buffer_load_dwordx4 v0, s[8:11], s47 offen offset:1024 lds
    buffer_load_dwordx4 v0, s[8:11], s47 offen offset:2048 lds
    buffer_load_dwordx4 v0, s[8:11], s47 offen offset:3072 lds
    s_add_u32 m0, s59, 4096
    s_add_u32 s47, s41, 4096
    buffer_load_dwordx4 v0, s[8:11], s47 offen offset:0 lds
    buffer_load_dwordx4 v0, s[8:11], s47 offen offset:1024 lds
    buffer_load_dwordx4 v0, s[8:11], s47 offen offset:2048 lds
    buffer_load_dwordx4 v0, s[8:11], s47 offen offset:3072 lds
    s_add_u32 m0, s59, 8192
    s_add_u32 s47, s41, 8192
    buffer_load_dwordx4 v0, s[8:11], s47 offen offset:0 lds
    s_mul_i32 s48, s36, 786432
    s_mul_i32 s18, s37, 6144
    s_add_u32 s48, s48, s18
    s_add_u32 s48, s48, 15728640
    buffer_load_dwordx4 v[80:83], v10, s[8:11], s48 offen offset:0
    buffer_load_dwordx4 v[84:87], v10, s[8:11], s48 offen offset:512
    buffer_load_dwordx4 v[88:91], v10, s[8:11], s48 offen offset:1024
    s_waitcnt vmcnt(0) lgkmcnt(0)
    s_branch Laq_head2
Laq_end:
    s_branch L_role_aq_exit
L_role_aq_abort:
    s_waitcnt lgkmcnt(0)
    s_mov_b64 exec, -1
    v_mov_b32 v0, 60
    s_lshl_b32 s5, s3, 8
    s_or_b32 s5, s5, s4
    s_or_b32 s5, s5, 0x10000
    v_mov_b32 v1, s5
    global_store_dword v0, v1, s[12:13]
    s_endpgm
L_role_aq_exit:
    s_endpgm
.p2align 6
L_role_ta:
    v_and_b32 v5, 63, v0
    v_lshlrev_b32 v0, 4, v5
    v_and_b32 v7, 15, v5
    v_lshrrev_b32 v8, 4, v5
    v_min_u32 v1, 12, v5
    v_lshrrev_b32 v6, 2, v1
    v_and_b32 v1, 3, v1
    v_lshlrev_b32 v1, 2, v1
    v_lshl_add_u32 v1, v6, 7, v1
    v_mov_b32 v3, 1
    v_mov_b32 v4, 0
    s_mov_b32 s44, 0x05040100
    s_mov_b32 s45, 0x07060302
    s_cmp_ge_u32 s15, 11
    s_cselect_b32 s36, 1, 0
    s_cselect_b32 s17, 11, 0
    s_sub_u32 s17, s15, s17
    s_mul_i32 s50, s17, 3
    s_add_u32 s50, s50, s14
    s_cmp_eq_u32 s14, 3
    s_cselect_b32 s50, 32, s50
    s_mov_b32 s40, s50
    s_mov_b32 s37, 0
    s_mov_b32 s52, 0x3e0293ee
    v_lshrrev_b32 v5, 2, v7
    v_and_b32 v6, 1, v7
    v_lshl_add_u32 v5, v5, 1, v6
    v_lshlrev_b32 v9, 8, v5
    v_lshl_add_u32 v9, v8, 4, v9
    v_lshrrev_b32 v10, 1, v0
    v_mov_b32 v11, 384
    v_mov_b32 v6, 0xf149f2ca
    v_mov_b32 v21, 0
    v_mov_b32 v22, 0
    s_mul_i32 s42, s36, 1441792
    s_lshl_b32 s17, s50, 9
    s_add_u32 s42, s42, s17
    s_add_u32 s42, s42, 5376
    s_mul_i32 s51, s36, 50331648
    s_lshl_b32 s17, s50, 13
    s_add_u32 s51, s51, s17
    s_add_u32 s51, s51, 44040192
    s_lshl_b32 s47, s36, 11
    s_add_u32 s47, s47, s50
    s_lshl_b32 s48, s47, 13
    s_add_u32 s48, s48, 144703488
    s_lshl_b32 s47, s47, 12
    s_add_u32 s47, s47, 27262976
    s_mul_i32 s43, s36, 1441792
    s_lshr_b32 s17, s50, 2
    s_lshl_b32 s17, s17, 7
    s_add_u32 s43, s43, s17
    s_and_b32 s17, s50, 3
    s_lshl_b32 s17, s17, 2
    s_add_u32 s43, s43, s17
    s_add_u32 s43, s43, 4224
    s_mov_b32 s28, s8
    s_mov_b32 s29, s9
    s_mov_b32 s30, 0
    s_mov_b32 s31, 0x00020000
    s_mov_b32 s39, 0
    s_mov_b32 s38, 0
    s_mov_b32 s49, 0
    s_mov_b32 s20, s8
    s_mov_b32 s21, s9
    s_mov_b32 s22, 0
    s_mov_b32 s23, 0x00020000
    v_mov_b32 v16, 0x3f803f80
    v_lshl_add_u32 v5, v8, 2, 0
    v_cmp_le_u32 vcc, v5, v7
    s_nop 1
    v_cndmask_b32 v236, v6, v4, vcc
    v_mov_b32 v17, 0x3f803f80
    v_lshl_add_u32 v5, v8, 2, 1
    v_cmp_le_u32 vcc, v5, v7
    s_nop 1
    v_cndmask_b32 v237, v6, v4, vcc
    v_mov_b32 v18, 0x3f803f80
    v_lshl_add_u32 v5, v8, 2, 2
    v_cmp_le_u32 vcc, v5, v7
    s_nop 1
    v_cndmask_b32 v238, v6, v4, vcc
    v_mov_b32 v19, 0x3f803f80
    v_lshl_add_u32 v5, v8, 2, 3
    v_cmp_le_u32 vcc, v5, v7
    s_nop 1
    v_cndmask_b32 v239, v6, v4, vcc
    v_mov_b32 v15, 0
    s_cmp_lg_u32 s14, 0
    s_cbranch_scc1 Lta_inia_d
    v_mov_b32 v5, 40
    s_mov_b32 s16, 0
Lta_inia:
    global_load_dword v6, v5, s[12:13] sc1
    s_add_u32 s16, s16, 1
    s_cmp_gt_u32 s16, 100000
    s_cbranch_scc1 L_role_ta_abort
    s_waitcnt vmcnt(0)
    v_cmp_gt_u32 vcc, 128, v6
    s_nop 0
    s_cbranch_vccz Lta_inia_d
    s_sleep 8
    s_branch Lta_inia
Lta_inia_d:
    s_barrier
    s_cmp_eq_u32 s36, 0
    s_cbranch_scc1 Lta_ini_sk
    s_cmp_lg_u32 s14, 0
    s_cbranch_scc1 Lta_inib_d
    v_mov_b32 v5, 160
    s_mov_b32 s16, 0
Lta_inib:
    global_load_dword v6, v5, s[12:13] sc1
    s_add_u32 s16, s16, 1
    s_cmp_gt_u32 s16, 100000
    s_cbranch_scc1 L_role_ta_abort
    s_waitcnt vmcnt(0)
    v_cmp_gt_u32 vcc, 64, v6
    s_nop 0
    s_cbranch_vccz Lta_inib_d
    s_sleep 8
    s_branch Lta_inib
Lta_inib_d:
    s_barrier
Lta_ini_sk:
    s_cmp_ge_u32 s40, 32
    s_cbranch_scc1 L_role_ta_exit
Lta0:
    s_cmp_eq_u32 s39, 1
    s_cbranch_scc1 Lta0_have
    s_waitcnt vmcnt(0)
    s_cmp_lg_u32 s49, 0
    s_cselect_b64 exec, 1, 0
    buffer_store_dword v3, v4, s[8:11], s43 offen sc1
    s_mov_b64 exec, -1
    s_add_u32 s43, s43, s49
    s_mov_b32 s49, 0
    s_mov_b32 s16, 0
Lta0_f:
    buffer_load_dword v2, v1, s[8:11], s42 offen sc1
    s_add_u32 s16, s16, 1
    s_cmp_gt_u32 s16, 100000
    s_cbranch_scc1 L_role_ta_abort
    s_waitcnt vmcnt(0)
    v_cmp_eq_u32 vcc, 0, v2
    s_nop 0
    s_and_b32 s17, vcc_lo, 0xfff
    s_cbranch_scc0 Lta0_fd
    s_sleep 4
    s_branch Lta0_f
Lta0_fd:
    s_add_u32 s46, s51, 0
    buffer_load_dwordx4 v[140:143], v0, s[8:11], s46 offen offset:0
    buffer_load_dwordx4 v[144:147], v0, s[8:11], s46 offen offset:1024
    buffer_load_dwordx4 v[148:151], v0, s[8:11], s46 offen offset:2048
    buffer_load_dwordx4 v[152:155], v0, s[8:11], s46 offen offset:3072
    s_add_u32 s46, s51, 4096
    buffer_load_dwordx4 v[156:159], v0, s[8:11], s46 offen offset:0
    buffer_load_dwordx4 v[160:163], v0, s[8:11], s46 offen offset:1024
    buffer_load_dwordx4 v[164:167], v0, s[8:11], s46 offen offset:2048
    buffer_load_dwordx4 v[168:171], v0, s[8:11], s46 offen offset:3072
    s_add_u32 s46, s51, 16777216
    buffer_load_dwordx4 v[172:175], v0, s[8:11], s46 offen offset:0
    buffer_load_dwordx4 v[176:179], v0, s[8:11], s46 offen offset:1024
    buffer_load_dwordx4 v[180:183], v0, s[8:11], s46 offen offset:2048
    buffer_load_dwordx4 v[184:187], v0, s[8:11], s46 offen offset:3072
    s_add_u32 s46, s51, 16781312
    buffer_load_dwordx4 v[188:191], v0, s[8:11], s46 offen offset:0
    buffer_load_dwordx4 v[192:195], v0, s[8:11], s46 offen offset:1024
    buffer_load_dwordx4 v[196:199], v0, s[8:11], s46 offen offset:2048
    buffer_load_dwordx4 v[200:203], v0, s[8:11], s46 offen offset:3072
    s_add_u32 s46, s51, 33554432
    buffer_load_dwordx4 v[204:207], v0, s[8:11], s46 offen offset:0
    buffer_load_dwordx4 v[208:211], v0, s[8:11], s46 offen offset:1024
    buffer_load_dwordx4 v[212:215], v0, s[8:11], s46 offen offset:2048
    buffer_load_dwordx4 v[216:219], v0, s[8:11], s46 offen offset:3072
    s_add_u32 s46, s51, 33558528
    buffer_load_dwordx4 v[220:223], v0, s[8:11], s46 offen offset:0
    buffer_load_dwordx4 v[224:227], v0, s[8:11], s46 offen offset:1024
    buffer_load_dwordx4 v[228:231], v0, s[8:11], s46 offen offset:2048
    buffer_load_dwordx4 v[232:235], v0, s[8:11], s46 offen offset:3072
    s_waitcnt vmcnt(0)
Lta0_have:
    buffer_load_dword v2, v11, s[8:11], s42 offen sc1
    s_waitcnt vmcnt(5)
    v_cmp_eq_u32 vcc, 0, v15
    s_add_u32 s51, s51, 262144
    s_add_u32 s37, s37, 1
    s_mov_b32 s62, s38
    s_and_b32 s17, vcc_lo, 0xfff
    s_cselect_b32 s39, 0, 1
    s_cmp_eq_u64 vcc, 0
    s_cselect_b32 s38, 1, 0
    s_cmp_lt_u32 s37, 64
    s_cselect_b32 s39, s39, 0
    s_cselect_b32 s38, s38, 0
    s_cmp_eq_u32 s39, 1
    s_cselect_b32 s30, 268435456, 0
    s_cmp_eq_u32 s38, 1
    s_cselect_b32 s22, 268435456, 0
    v_mfma_f32_16x16x32_bf16 v[32:35], v[172:175], v[140:143], 0
    s_add_u32 s46, s51, 0
    buffer_load_dwordx4 a[0:3], v0, s[28:31], s46 offen offset:0
    v_mfma_f32_16x16x32_bf16 v[36:39], v[172:175], v[144:147], 0
    buffer_load_dwordx4 a[4:7], v0, s[28:31], s46 offen offset:1024
    v_mfma_f32_16x16x32_bf16 v[40:43], v[176:179], v[144:147], 0
    buffer_load_dwordx4 a[8:11], v0, s[28:31], s46 offen offset:2048
    v_mfma_f32_16x16x32_bf16 v[32:35], v[180:183], v[148:151], v[32:35]
    buffer_load_dwordx4 a[12:15], v0, s[28:31], s46 offen offset:3072
    v_mfma_f32_16x16x32_bf16 v[36:39], v[180:183], v[152:155], v[36:39]
    s_add_u32 s46, s51, 4096
    buffer_load_dwordx4 a[16:19], v0, s[28:31], s46 offen offset:0
    v_mfma_f32_16x16x32_bf16 v[40:43], v[184:187], v[152:155], v[40:43]
    buffer_load_dwordx4 a[20:23], v0, s[28:31], s46 offen offset:1024
    v_mfma_f32_16x16x32_bf16 v[32:35], v[188:191], v[156:159], v[32:35]
    v_mfma_f32_16x16x32_bf16 v[36:39], v[188:191], v[160:163], v[36:39]
    v_mfma_f32_16x16x32_bf16 v[40:43], v[192:195], v[160:163], v[40:43]
    v_mfma_f32_16x16x32_bf16 v[32:35], v[196:199], v[164:167], v[32:35]
    v_mfma_f32_16x16x32_bf16 v[36:39], v[196:199], v[168:171], v[36:39]
    v_mfma_f32_16x16x32_bf16 v[40:43], v[200:203], v[168:171], v[40:43]
    s_waitcnt vmcnt(7)
    s_cmp_lg_u32 s49, 0
    s_cselect_b64 exec, 1, 0
    buffer_store_dword v3, v4, s[8:11], s43 offen sc1
    s_mov_b64 exec, -1
    s_add_u32 s43, s43, s49
    s_mov_b32 s49, 0
    s_cmp_eq_u32 s62, 1
    s_cbranch_scc1 Lta0_km
    s_waitcnt vmcnt(6)
    v_cmp_eq_u32 vcc, 0, v2
    s_nop 0
    s_cbranch_vccz Lta0_r
    s_mov_b32 s16, 0
Lta0_rp:
    buffer_load_dword v2, v11, s[8:11], s42 offen sc1
    s_add_u32 s16, s16, 1
    s_cmp_gt_u32 s16, 100000
    s_cbranch_scc1 L_role_ta_abort
    s_waitcnt vmcnt(0)
    v_cmp_eq_u32 vcc, 0, v2
    s_nop 0
    s_cbranch_vccnz Lta0_rp
Lta0_r:
    buffer_load_dwordx4 a[96:99], v9, s[8:11], s47 offen offset:0
    buffer_load_dwordx4 a[100:103], v9, s[8:11], s47 offen offset:64
    buffer_load_dwordx4 a[104:107], v9, s[8:11], s47 offen offset:128
    buffer_load_dwordx4 a[108:111], v9, s[8:11], s47 offen offset:192
    buffer_load_dwordx2 a[112:113], v10, s[8:11], s47 offen offset:2048
    buffer_load_dwordx2 a[114:115], v10, s[8:11], s47 offen offset:2560
    buffer_load_dwordx2 a[116:117], v10, s[8:11], s47 offen offset:3072
    buffer_load_dwordx2 a[118:119], v10, s[8:11], s47 offen offset:3584
Lta0_km:
    s_add_u32 s42, s42, 22528
    s_add_u32 s47, s47, 131072
    v_fma_f32 v32, v32, s52, v236
    v_fma_f32 v33, v33, s52, v237
    v_fma_f32 v34, v34, s52, v238
    v_fma_f32 v35, v35, s52, v239
    buffer_load_dwordx4 a[24:27], v0, s[28:31], s46 offen offset:2048
    buffer_load_dwordx4 a[28:31], v0, s[28:31], s46 offen offset:3072
    v_mul_f32 v36, s52, v36
    v_mul_f32 v37, s52, v37
    v_mul_f32 v38, s52, v38
    v_mul_f32 v39, s52, v39
    s_add_u32 s46, s51, 16777216
    buffer_load_dwordx4 a[32:35], v0, s[28:31], s46 offen offset:0
    buffer_load_dwordx4 a[36:39], v0, s[28:31], s46 offen offset:1024
    v_fma_f32 v40, v40, s52, v236
    v_fma_f32 v41, v41, s52, v237
    v_fma_f32 v42, v42, s52, v238
    v_fma_f32 v43, v43, s52, v239
    buffer_load_dwordx4 a[40:43], v0, s[28:31], s46 offen offset:2048
    buffer_load_dwordx4 a[44:47], v0, s[28:31], s46 offen offset:3072
    s_waitcnt vmcnt(13)
    v_mfma_f32_16x16x32_bf16 v[44:47], a[96:99], v[140:143], 0
    v_mfma_f32_16x16x32_bf16 v[48:51], a[96:99], v[144:147], 0
    s_add_u32 s46, s51, 16781312
    buffer_load_dwordx4 a[48:51], v0, s[28:31], s46 offen offset:0
    s_waitcnt vmcnt(13)
    v_mfma_f32_16x16x32_bf16 v[44:47], a[100:103], v[148:151], v[44:47]
    v_mfma_f32_16x16x32_bf16 v[48:51], a[100:103], v[152:155], v[48:51]
    buffer_load_dwordx4 a[52:55], v0, s[28:31], s46 offen offset:1024
    s_waitcnt vmcnt(13)
    v_mfma_f32_16x16x32_bf16 v[44:47], a[104:107], v[156:159], v[44:47]
    v_mfma_f32_16x16x32_bf16 v[48:51], a[104:107], v[160:163], v[48:51]
    buffer_load_dwordx4 a[56:59], v0, s[28:31], s46 offen offset:2048
    s_waitcnt vmcnt(13)
    v_mfma_f32_16x16x32_bf16 v[44:47], a[108:111], v[164:167], v[44:47]
    v_mfma_f32_16x16x32_bf16 v[48:51], a[108:111], v[168:171], v[48:51]
    buffer_load_dwordx4 a[60:63], v0, s[28:31], s46 offen offset:3072
    v_max3_f32 v5, v32, v33, v34
    v_max_f32 v5, v5, v35
    s_nop 0
    v_mul_f32 v44, s52, v44
    v_mul_f32 v45, s52, v45
    v_max3_f32 v5, v5, v44, v45
    v_mov_b32 v6, v5
    s_add_u32 s46, s51, 33554432
    buffer_load_dwordx4 a[64:67], v0, s[28:31], s46 offen offset:0
    v_permlane32_swap_b32 v5, v6
    v_max_f32 v5, v5, v6
    v_mov_b32 v6, v5
    buffer_load_dwordx4 a[68:71], v0, s[28:31], s46 offen offset:1024
    s_nop 0
    v_permlane16_swap_b32 v5, v6
    v_max_f32 v5, v5, v6
    v_sub_f32 v32, v32, v5
    v_sub_f32 v33, v33, v5
    v_sub_f32 v34, v34, v5
    v_sub_f32 v35, v35, v5
    v_sub_f32 v44, v44, v5
    v_sub_f32 v45, v45, v5
    v_exp_f32 v32, v32
    v_exp_f32 v33, v33
    v_exp_f32 v34, v34
    v_exp_f32 v35, v35
    v_exp_f32 v44, v44
    v_exp_f32 v45, v45
    v_cvt_pk_bf16_f32 v24, v32, v33
    v_cvt_pk_bf16_f32 v25, v34, v35
    v_mov_b32 v26, 0
    v_mov_b32 v27, 0
    v_cvt_pk_bf16_f32 v20, v44, v45
    v_cvt_pk_bf16_f32 v23, v44, v45
    v_mfma_f32_16x16x32_bf16 v[28:31], v[16:19], v[24:27], 0
    v_mfma_f32_16x16x32_bf16 v[76:79], v[204:207], v[24:27], 0
    v_mfma_f32_16x16x32_bf16 v[80:83], v[208:211], v[24:27], 0
    s_add_u32 s17, s42, 22528
    buffer_load_dword v15, v1, s[8:11], s17 offen sc1
    v_mfma_f32_16x16x32_bf16 v[84:87], v[212:215], v[24:27], 0
    v_mfma_f32_16x16x32_bf16 v[88:91], v[216:219], v[24:27], 0
    buffer_load_dwordx4 a[72:75], v0, s[28:31], s46 offen offset:2048
    v_mfma_f32_16x16x32_bf16 v[92:95], v[220:223], v[24:27], 0
    v_mfma_f32_16x16x32_bf16 v[96:99], v[224:227], v[24:27], 0
    buffer_load_dwordx4 a[76:79], v0, s[28:31], s46 offen offset:3072
    v_mfma_f32_16x16x16_bf16 v[28:31], v[16:17], v[20:21], v[28:31]
    v_mfma_f32_16x16x32_bf16 v[100:103], v[228:231], v[24:27], 0
    v_mfma_f32_16x16x32_bf16 v[104:107], v[232:235], v[24:27], 0
    s_add_u32 s46, s51, 33558528
    buffer_load_dwordx4 a[80:83], v0, s[28:31], s46 offen offset:0
    s_waitcnt vmcnt(19)
    v_mfma_f32_16x16x16_bf16 v[76:79], a[112:113], v[20:21], v[76:79]
    v_mfma_f32_16x16x16_bf16 v[80:83], a[112:113], v[22:23], v[80:83]
    v_rcp_f32 v6, v28
    s_waitcnt vmcnt(18)
    v_mfma_f32_16x16x16_bf16 v[84:87], a[114:115], v[20:21], v[84:87]
    v_mfma_f32_16x16x16_bf16 v[88:91], a[114:115], v[22:23], v[88:91]
    v_mul_f32 v76, v6, v76
    v_mul_f32 v80, v6, v80
    v_cvt_pk_bf16_f32 v108, v76, v80
    v_mul_f32 v77, v6, v77
    v_mul_f32 v81, v6, v81
    v_cvt_pk_bf16_f32 v109, v77, v81
    v_mul_f32 v78, v6, v78
    v_mul_f32 v82, v6, v82
    v_cvt_pk_bf16_f32 v110, v78, v82
    v_mul_f32 v79, v6, v79
    v_mul_f32 v83, v6, v83
    v_cvt_pk_bf16_f32 v111, v79, v83
    s_add_u32 s17, s48, 0
    buffer_store_dwordx4 v[108:111], v0, s[8:11], s17 offen offset:0 sc1
    buffer_load_dwordx4 a[84:87], v0, s[28:31], s46 offen offset:1024
    s_waitcnt vmcnt(19)
    v_mfma_f32_16x16x16_bf16 v[92:95], a[116:117], v[20:21], v[92:95]
    v_mfma_f32_16x16x16_bf16 v[96:99], a[116:117], v[22:23], v[96:99]
    v_mul_f32 v84, v6, v84
    v_mul_f32 v88, v6, v88
    v_cvt_pk_bf16_f32 v112, v84, v88
    v_mul_f32 v85, v6, v85
    v_mul_f32 v89, v6, v89
    v_cvt_pk_bf16_f32 v113, v85, v89
    v_mul_f32 v86, v6, v86
    v_mul_f32 v90, v6, v90
    v_cvt_pk_bf16_f32 v114, v86, v90
    v_mul_f32 v87, v6, v87
    v_mul_f32 v91, v6, v91
    v_cvt_pk_bf16_f32 v115, v87, v91
    buffer_store_dwordx4 v[112:115], v0, s[8:11], s17 offen offset:2048 sc1
    buffer_load_dwordx4 a[88:91], v0, s[28:31], s46 offen offset:2048
    s_waitcnt vmcnt(20)
    v_mfma_f32_16x16x16_bf16 v[100:103], a[118:119], v[20:21], v[100:103]
    v_mfma_f32_16x16x16_bf16 v[104:107], a[118:119], v[22:23], v[104:107]
    v_mul_f32 v92, v6, v92
    v_mul_f32 v96, v6, v96
    v_cvt_pk_bf16_f32 v116, v92, v96
    v_mul_f32 v93, v6, v93
    v_mul_f32 v97, v6, v97
    v_cvt_pk_bf16_f32 v117, v93, v97
    v_mul_f32 v94, v6, v94
    v_mul_f32 v98, v6, v98
    v_cvt_pk_bf16_f32 v118, v94, v98
    v_mul_f32 v95, v6, v95
    v_mul_f32 v99, v6, v99
    v_cvt_pk_bf16_f32 v119, v95, v99
    s_add_u32 s17, s48, 4096
    buffer_store_dwordx4 v[116:119], v0, s[8:11], s17 offen offset:0 sc1
    buffer_load_dwordx4 a[92:95], v0, s[28:31], s46 offen offset:3072
    v_mul_f32 v100, v6, v100
    v_mul_f32 v104, v6, v104
    v_cvt_pk_bf16_f32 v120, v100, v104
    v_mul_f32 v101, v6, v101
    v_mul_f32 v105, v6, v105
    v_cvt_pk_bf16_f32 v121, v101, v105
    v_mul_f32 v102, v6, v102
    v_mul_f32 v106, v6, v106
    v_cvt_pk_bf16_f32 v122, v102, v106
    v_mul_f32 v103, v6, v103
    v_mul_f32 v107, v6, v107
    v_cvt_pk_bf16_f32 v123, v103, v107
    buffer_store_dwordx4 v[120:123], v0, s[8:11], s17 offen offset:2048 sc1
    buffer_load_dwordx4 a[120:123], v9, s[20:23], s47 offen offset:0
    v_max3_f32 v5, v36, v37, v38
    v_max_f32 v5, v5, v39
    v_max3_f32 v5, v5, v40, v41
    v_max3_f32 v5, v5, v42, v43
    v_mul_f32 v48, s52, v48
    v_mul_f32 v49, s52, v49
    v_max3_f32 v5, v5, v48, v49
    v_mov_b32 v6, v5
    buffer_load_dwordx4 a[124:127], v9, s[20:23], s47 offen offset:64
    s_nop 0
    v_permlane32_swap_b32 v5, v6
    v_max_f32 v5, v5, v6
    v_mov_b32 v6, v5
    buffer_load_dwordx4 a[128:131], v9, s[20:23], s47 offen offset:128
    s_nop 0
    v_permlane16_swap_b32 v5, v6
    v_max_f32 v5, v5, v6
    v_sub_f32 v36, v36, v5
    v_sub_f32 v37, v37, v5
    v_sub_f32 v38, v38, v5
    v_sub_f32 v39, v39, v5
    v_sub_f32 v40, v40, v5
    v_sub_f32 v41, v41, v5
    v_sub_f32 v42, v42, v5
    v_sub_f32 v43, v43, v5
    v_sub_f32 v48, v48, v5
    v_sub_f32 v49, v49, v5
    v_exp_f32 v36, v36
    v_exp_f32 v37, v37
    v_exp_f32 v38, v38
    v_exp_f32 v39, v39
    v_exp_f32 v40, v40
    v_exp_f32 v41, v41
    v_exp_f32 v42, v42
    v_exp_f32 v43, v43
    v_exp_f32 v48, v48
    v_exp_f32 v49, v49
    v_cvt_pk_bf16_f32 v24, v36, v37
    v_cvt_pk_bf16_f32 v25, v38, v39
    v_cvt_pk_bf16_f32 v26, v40, v41
    v_cvt_pk_bf16_f32 v27, v42, v43
    v_cvt_pk_bf16_f32 v20, v48, v49
    v_cvt_pk_bf16_f32 v23, v48, v49
    v_mfma_f32_16x16x32_bf16 v[28:31], v[16:19], v[24:27], 0
    v_mfma_f32_16x16x32_bf16 v[76:79], v[204:207], v[24:27], 0
    v_mfma_f32_16x16x32_bf16 v[80:83], v[208:211], v[24:27], 0
    buffer_load_dwordx4 a[132:135], v9, s[20:23], s47 offen offset:192
    v_mfma_f32_16x16x32_bf16 v[84:87], v[212:215], v[24:27], 0
    v_mfma_f32_16x16x32_bf16 v[88:91], v[216:219], v[24:27], 0
    buffer_load_dwordx2 a[136:137], v10, s[20:23], s47 offen offset:2048
    v_mfma_f32_16x16x32_bf16 v[92:95], v[220:223], v[24:27], 0
    v_mfma_f32_16x16x32_bf16 v[96:99], v[224:227], v[24:27], 0
    buffer_load_dwordx2 a[138:139], v10, s[20:23], s47 offen offset:2560
    v_mfma_f32_16x16x16_bf16 v[28:31], v[16:17], v[20:21], v[28:31]
    v_mfma_f32_16x16x32_bf16 v[100:103], v[228:231], v[24:27], 0
    v_mfma_f32_16x16x32_bf16 v[104:107], v[232:235], v[24:27], 0
    buffer_load_dwordx2 a[140:141], v10, s[20:23], s47 offen offset:3072
    buffer_load_dwordx2 a[142:143], v10, s[20:23], s47 offen offset:3584
    v_mfma_f32_16x16x16_bf16 v[76:79], a[112:113], v[20:21], v[76:79]
    v_mfma_f32_16x16x16_bf16 v[80:83], a[112:113], v[22:23], v[80:83]
    v_rcp_f32 v6, v28
    v_mfma_f32_16x16x16_bf16 v[84:87], a[114:115], v[20:21], v[84:87]
    v_mfma_f32_16x16x16_bf16 v[88:91], a[114:115], v[22:23], v[88:91]
    v_mul_f32 v76, v6, v76
    v_mul_f32 v80, v6, v80
    v_cvt_pk_bf16_f32 v124, v76, v80
    v_mul_f32 v77, v6, v77
    v_mul_f32 v81, v6, v81
    v_cvt_pk_bf16_f32 v125, v77, v81
    v_mul_f32 v78, v6, v78
    v_mul_f32 v82, v6, v82
    v_cvt_pk_bf16_f32 v126, v78, v82
    v_mul_f32 v79, v6, v79
    v_mul_f32 v83, v6, v83
    v_cvt_pk_bf16_f32 v127, v79, v83
    s_add_u32 s17, s48, 0
    buffer_store_dwordx4 v[124:127], v0, s[8:11], s17 offen offset:1024 sc1
    v_mfma_f32_16x16x16_bf16 v[92:95], a[116:117], v[20:21], v[92:95]
    v_mfma_f32_16x16x16_bf16 v[96:99], a[116:117], v[22:23], v[96:99]
    v_mul_f32 v84, v6, v84
    v_mul_f32 v88, v6, v88
    v_cvt_pk_bf16_f32 v128, v84, v88
    v_mul_f32 v85, v6, v85
    v_mul_f32 v89, v6, v89
    v_cvt_pk_bf16_f32 v129, v85, v89
    v_mul_f32 v86, v6, v86
    v_mul_f32 v90, v6, v90
    v_cvt_pk_bf16_f32 v130, v86, v90
    v_mul_f32 v87, v6, v87
    v_mul_f32 v91, v6, v91
    v_cvt_pk_bf16_f32 v131, v87, v91
    buffer_store_dwordx4 v[128:131], v0, s[8:11], s17 offen offset:3072 sc1
    v_mfma_f32_16x16x16_bf16 v[100:103], a[118:119], v[20:21], v[100:103]
    v_mfma_f32_16x16x16_bf16 v[104:107], a[118:119], v[22:23], v[104:107]
    v_mul_f32 v92, v6, v92
    v_mul_f32 v96, v6, v96
    v_cvt_pk_bf16_f32 v132, v92, v96
    v_mul_f32 v93, v6, v93
    v_mul_f32 v97, v6, v97
    v_cvt_pk_bf16_f32 v133, v93, v97
    v_mul_f32 v94, v6, v94
    v_mul_f32 v98, v6, v98
    v_cvt_pk_bf16_f32 v134, v94, v98
    v_mul_f32 v95, v6, v95
    v_mul_f32 v99, v6, v99
    v_cvt_pk_bf16_f32 v135, v95, v99
    s_add_u32 s17, s48, 4096
    buffer_store_dwordx4 v[132:135], v0, s[8:11], s17 offen offset:1024 sc1
    v_mul_f32 v100, v6, v100
    v_mul_f32 v104, v6, v104
    v_cvt_pk_bf16_f32 v136, v100, v104
    v_mul_f32 v101, v6, v101
    v_mul_f32 v105, v6, v105
    v_cvt_pk_bf16_f32 v137, v101, v105
    v_mul_f32 v102, v6, v102
    v_mul_f32 v106, v6, v106
    v_cvt_pk_bf16_f32 v138, v102, v106
    v_mul_f32 v103, v6, v103
    v_mul_f32 v107, v6, v107
    v_cvt_pk_bf16_f32 v139, v103, v107
    buffer_store_dwordx4 v[136:139], v0, s[8:11], s17 offen offset:3072 sc1
    s_add_u32 s48, s48, 262144
    s_mov_b32 s49, 22528
    s_cmp_ge_u32 s37, 64
    s_cbranch_scc1 Lta_end
Lta1:
    s_cmp_eq_u32 s39, 1
    s_cbranch_scc1 Lta1_have
    s_waitcnt vmcnt(0)
    s_cmp_lg_u32 s49, 0
    s_cselect_b64 exec, 1, 0
    buffer_store_dword v3, v4, s[8:11], s43 offen sc1
    s_mov_b64 exec, -1
    s_add_u32 s43, s43, s49
    s_mov_b32 s49, 0
    s_mov_b32 s16, 0
Lta1_f:
    buffer_load_dword v2, v1, s[8:11], s42 offen sc1
    s_add_u32 s16, s16, 1
    s_cmp_gt_u32 s16, 100000
    s_cbranch_scc1 L_role_ta_abort
    s_waitcnt vmcnt(0)
    v_cmp_eq_u32 vcc, 0, v2
    s_nop 0
    s_and_b32 s17, vcc_lo, 0xfff
    s_cbranch_scc0 Lta1_fd
    s_sleep 4
    s_branch Lta1_f
Lta1_fd:
    s_add_u32 s46, s51, 0
    buffer_load_dwordx4 a[0:3], v0, s[8:11], s46 offen offset:0
    buffer_load_dwordx4 a[4:7], v0, s[8:11], s46 offen offset:1024
    buffer_load_dwordx4 a[8:11], v0, s[8:11], s46 offen offset:2048
    buffer_load_dwordx4 a[12:15], v0, s[8:11], s46 offen offset:3072
    s_add_u32 s46, s51, 4096
    buffer_load_dwordx4 a[16:19], v0, s[8:11], s46 offen offset:0
    buffer_load_dwordx4 a[20:23], v0, s[8:11], s46 offen offset:1024
    buffer_load_dwordx4 a[24:27], v0, s[8:11], s46 offen offset:2048
    buffer_load_dwordx4 a[28:31], v0, s[8:11], s46 offen offset:3072
    s_add_u32 s46, s51, 16777216
    buffer_load_dwordx4 a[32:35], v0, s[8:11], s46 offen offset:0
    buffer_load_dwordx4 a[36:39], v0, s[8:11], s46 offen offset:1024
    buffer_load_dwordx4 a[40:43], v0, s[8:11], s46 offen offset:2048
    buffer_load_dwordx4 a[44:47], v0, s[8:11], s46 offen offset:3072
    s_add_u32 s46, s51, 16781312
    buffer_load_dwordx4 a[48:51], v0, s[8:11], s46 offen offset:0
    buffer_load_dwordx4 a[52:55], v0, s[8:11], s46 offen offset:1024
    buffer_load_dwordx4 a[56:59], v0, s[8:11], s46 offen offset:2048
    buffer_load_dwordx4 a[60:63], v0, s[8:11], s46 offen offset:3072
    s_add_u32 s46, s51, 33554432
    buffer_load_dwordx4 a[64:67], v0, s[8:11], s46 offen offset:0
    buffer_load_dwordx4 a[68:71], v0, s[8:11], s46 offen offset:1024
    buffer_load_dwordx4 a[72:75], v0, s[8:11], s46 offen offset:2048
    buffer_load_dwordx4 a[76:79], v0, s[8:11], s46 offen offset:3072
    s_add_u32 s46, s51, 33558528
    buffer_load_dwordx4 a[80:83], v0, s[8:11], s46 offen offset:0
    buffer_load_dwordx4 a[84:87], v0, s[8:11], s46 offen offset:1024
    buffer_load_dwordx4 a[88:91], v0, s[8:11], s46 offen offset:2048
    buffer_load_dwordx4 a[92:95], v0, s[8:11], s46 offen offset:3072
    s_waitcnt vmcnt(0)
Lta1_have:
    buffer_load_dword v2, v11, s[8:11], s42 offen sc1
    s_waitcnt vmcnt(5)
    v_cmp_eq_u32 vcc, 0, v15
    s_add_u32 s51, s51, 262144
    s_add_u32 s37, s37, 1
    s_mov_b32 s62, s38
    s_and_b32 s17, vcc_lo, 0xfff
    s_cselect_b32 s39, 0, 1
    s_cmp_eq_u64 vcc, 0
    s_cselect_b32 s38, 1, 0
    s_cmp_lt_u32 s37, 64
    s_cselect_b32 s39, s39, 0
    s_cselect_b32 s38, s38, 0
    s_cmp_eq_u32 s39, 1
    s_cselect_b32 s30, 268435456, 0
    s_cmp_eq_u32 s38, 1
    s_cselect_b32 s22, 268435456, 0
    v_mfma_f32_16x16x32_bf16 v[32:35], a[32:35], a[0:3], 0
    s_add_u32 s46, s51, 0
    buffer_load_dwordx4 v[140:143], v0, s[28:31], s46 offen offset:0
    v_mfma_f32_16x16x32_bf16 v[36:39], a[32:35], a[4:7], 0
    buffer_load_dwordx4 v[144:147], v0, s[28:31], s46 offen offset:1024
    v_mfma_f32_16x16x32_bf16 v[40:43], a[36:39], a[4:7], 0
    buffer_load_dwordx4 v[148:151], v0, s[28:31], s46 offen offset:2048
    v_mfma_f32_16x16x32_bf16 v[32:35], a[40:43], a[8:11], v[32:35]
    buffer_load_dwordx4 v[152:155], v0, s[28:31], s46 offen offset:3072
    v_mfma_f32_16x16x32_bf16 v[36:39], a[40:43], a[12:15], v[36:39]
    s_add_u32 s46, s51, 4096
    buffer_load_dwordx4 v[156:159], v0, s[28:31], s46 offen offset:0
    v_mfma_f32_16x16x32_bf16 v[40:43], a[44:47], a[12:15], v[40:43]
    buffer_load_dwordx4 v[160:163], v0, s[28:31], s46 offen offset:1024
    v_mfma_f32_16x16x32_bf16 v[32:35], a[48:51], a[16:19], v[32:35]
    v_mfma_f32_16x16x32_bf16 v[36:39], a[48:51], a[20:23], v[36:39]
    v_mfma_f32_16x16x32_bf16 v[40:43], a[52:55], a[20:23], v[40:43]
    v_mfma_f32_16x16x32_bf16 v[32:35], a[56:59], a[24:27], v[32:35]
    v_mfma_f32_16x16x32_bf16 v[36:39], a[56:59], a[28:31], v[36:39]
    v_mfma_f32_16x16x32_bf16 v[40:43], a[60:63], a[28:31], v[40:43]
    s_waitcnt vmcnt(7)
    s_cmp_lg_u32 s49, 0
    s_cselect_b64 exec, 1, 0
    buffer_store_dword v3, v4, s[8:11], s43 offen sc1
    s_mov_b64 exec, -1
    s_add_u32 s43, s43, s49
    s_mov_b32 s49, 0
    s_cmp_eq_u32 s62, 1
    s_cbranch_scc1 Lta1_km
    s_waitcnt vmcnt(6)
    v_cmp_eq_u32 vcc, 0, v2
    s_nop 0
    s_cbranch_vccz Lta1_r
    s_mov_b32 s16, 0
Lta1_rp:
    buffer_load_dword v2, v11, s[8:11], s42 offen sc1
    s_add_u32 s16, s16, 1
    s_cmp_gt_u32 s16, 100000
    s_cbranch_scc1 L_role_ta_abort
    s_waitcnt vmcnt(0)
    v_cmp_eq_u32 vcc, 0, v2
    s_nop 0
    s_cbranch_vccnz Lta1_rp
Lta1_r:
    buffer_load_dwordx4 a[120:123], v9, s[8:11], s47 offen offset:0
    buffer_load_dwordx4 a[124:127], v9, s[8:11], s47 offen offset:64
    buffer_load_dwordx4 a[128:131], v9, s[8:11], s47 offen offset:128
    buffer_load_dwordx4 a[132:135], v9, s[8:11], s47 offen offset:192
    buffer_load_dwordx2 a[136:137], v10, s[8:11], s47 offen offset:2048
    buffer_load_dwordx2 a[138:139], v10, s[8:11], s47 offen offset:2560
    buffer_load_dwordx2 a[140:141], v10, s[8:11], s47 offen offset:3072
    buffer_load_dwordx2 a[142:143], v10, s[8:11], s47 offen offset:3584
Lta1_km:
    s_add_u32 s42, s42, 22528
    s_add_u32 s47, s47, 131072
    v_fma_f32 v32, v32, s52, v236
    v_fma_f32 v33, v33, s52, v237
    v_fma_f32 v34, v34, s52, v238
    v_fma_f32 v35, v35, s52, v239
    buffer_load_dwordx4 v[164:167], v0, s[28:31], s46 offen offset:2048
    buffer_load_dwordx4 v[168:171], v0, s[28:31], s46 offen offset:3072
    v_mul_f32 v36, s52, v36
    v_mul_f32 v37, s52, v37
    v_mul_f32 v38, s52, v38
    v_mul_f32 v39, s52, v39
    s_add_u32 s46, s51, 16777216
    buffer_load_dwordx4 v[172:175], v0, s[28:31], s46 offen offset:0
    buffer_load_dwordx4 v[176:179], v0, s[28:31], s46 offen offset:1024
    v_fma_f32 v40, v40, s52, v236
    v_fma_f32 v41, v41, s52, v237
    v_fma_f32 v42, v42, s52, v238
    v_fma_f32 v43, v43, s52, v239
    buffer_load_dwordx4 v[180:183], v0, s[28:31], s46 offen offset:2048
    buffer_load_dwordx4 v[184:187], v0, s[28:31], s46 offen offset:3072
    s_waitcnt vmcnt(13)
    v_mfma_f32_16x16x32_bf16 v[44:47], a[120:123], a[0:3], 0
    v_mfma_f32_16x16x32_bf16 v[48:51], a[120:123], a[4:7], 0
    s_add_u32 s46, s51, 16781312
    buffer_load_dwordx4 v[188:191], v0, s[28:31], s46 offen offset:0
    s_waitcnt vmcnt(13)
    v_mfma_f32_16x16x32_bf16 v[44:47], a[124:127], a[8:11], v[44:47]
    v_mfma_f32_16x16x32_bf16 v[48:51], a[124:127], a[12:15], v[48:51]
    buffer_load_dwordx4 v[192:195], v0, s[28:31], s46 offen offset:1024
    s_waitcnt vmcnt(13)
    v_mfma_f32_16x16x32_bf16 v[44:47], a[128:131], a[16:19], v[44:47]
    v_mfma_f32_16x16x32_bf16 v[48:51], a[128:131], a[20:23], v[48:51]
    buffer_load_dwordx4 v[196:199], v0, s[28:31], s46 offen offset:2048
    s_waitcnt vmcnt(13)
    v_mfma_f32_16x16x32_bf16 v[44:47], a[132:135], a[24:27], v[44:47]
    v_mfma_f32_16x16x32_bf16 v[48:51], a[132:135], a[28:31], v[48:51]
    buffer_load_dwordx4 v[200:203], v0, s[28:31], s46 offen offset:3072
    v_max3_f32 v5, v32, v33, v34
    v_max_f32 v5, v5, v35
    s_nop 0
    v_mul_f32 v44, s52, v44
    v_mul_f32 v45, s52, v45
    v_max3_f32 v5, v5, v44, v45
    v_mov_b32 v6, v5
    s_add_u32 s46, s51, 33554432
    buffer_load_dwordx4 v[204:207], v0, s[28:31], s46 offen offset:0
    v_permlane32_swap_b32 v5, v6
    v_max_f32 v5, v5, v6
    v_mov_b32 v6, v5
    buffer_load_dwordx4 v[208:211], v0, s[28:31], s46 offen offset:1024
    s_nop 0
    v_permlane16_swap_b32 v5, v6
    v_max_f32 v5, v5, v6
    v_sub_f32 v32, v32, v5
    v_sub_f32 v33, v33, v5
    v_sub_f32 v34, v34, v5
    v_sub_f32 v35, v35, v5
    v_sub_f32 v44, v44, v5
    v_sub_f32 v45, v45, v5
    v_exp_f32 v32, v32
    v_exp_f32 v33, v33
    v_exp_f32 v34, v34
    v_exp_f32 v35, v35
    v_exp_f32 v44, v44
    v_exp_f32 v45, v45
    v_cvt_pk_bf16_f32 v24, v32, v33
    v_cvt_pk_bf16_f32 v25, v34, v35
    v_mov_b32 v26, 0
    v_mov_b32 v27, 0
    v_cvt_pk_bf16_f32 v20, v44, v45
    v_cvt_pk_bf16_f32 v23, v44, v45
    v_mfma_f32_16x16x32_bf16 v[28:31], v[16:19], v[24:27], 0
    v_mfma_f32_16x16x32_bf16 v[76:79], a[64:67], v[24:27], 0
    v_mfma_f32_16x16x32_bf16 v[80:83], a[68:71], v[24:27], 0
    s_add_u32 s17, s42, 22528
    buffer_load_dword v15, v1, s[8:11], s17 offen sc1
    v_mfma_f32_16x16x32_bf16 v[84:87], a[72:75], v[24:27], 0
    v_mfma_f32_16x16x32_bf16 v[88:91], a[76:79], v[24:27], 0
    buffer_load_dwordx4 v[212:215], v0, s[28:31], s46 offen offset:2048
    v_mfma_f32_16x16x32_bf16 v[92:95], a[80:83], v[24:27], 0
    v_mfma_f32_16x16x32_bf16 v[96:99], a[84:87], v[24:27], 0
    buffer_load_dwordx4 v[216:219], v0, s[28:31], s46 offen offset:3072
    v_mfma_f32_16x16x16_bf16 v[28:31], v[16:17], v[20:21], v[28:31]
    v_mfma_f32_16x16x32_bf16 v[100:103], a[88:91], v[24:27], 0
    v_mfma_f32_16x16x32_bf16 v[104:107], a[92:95], v[24:27], 0
    s_add_u32 s46, s51, 33558528
    buffer_load_dwordx4 v[220:223], v0, s[28:31], s46 offen offset:0
    s_waitcnt vmcnt(19)
    v_mfma_f32_16x16x16_bf16 v[76:79], a[136:137], v[20:21], v[76:79]
    v_mfma_f32_16x16x16_bf16 v[80:83], a[136:137], v[22:23], v[80:83]
    v_rcp_f32 v6, v28
    s_waitcnt vmcnt(18)
    v_mfma_f32_16x16x16_bf16 v[84:87], a[138:139], v[20:21], v[84:87]
    v_mfma_f32_16x16x16_bf16 v[88:91], a[138:139], v[22:23], v[88:91]
    v_mul_f32 v76, v6, v76
    v_mul_f32 v80, v6, v80
    v_cvt_pk_bf16_f32 v108, v76, v80
    v_mul_f32 v77, v6, v77
    v_mul_f32 v81, v6, v81
    v_cvt_pk_bf16_f32 v109, v77, v81
    v_mul_f32 v78, v6, v78
    v_mul_f32 v82, v6, v82
    v_cvt_pk_bf16_f32 v110, v78, v82
    v_mul_f32 v79, v6, v79
    v_mul_f32 v83, v6, v83
    v_cvt_pk_bf16_f32 v111, v79, v83
    s_add_u32 s17, s48, 0
    buffer_store_dwordx4 v[108:111], v0, s[8:11], s17 offen offset:0 sc1
    buffer_load_dwordx4 v[224:227], v0, s[28:31], s46 offen offset:1024
    s_waitcnt vmcnt(19)
    v_mfma_f32_16x16x16_bf16 v[92:95], a[140:141], v[20:21], v[92:95]
    v_mfma_f32_16x16x16_bf16 v[96:99], a[140:141], v[22:23], v[96:99]
    v_mul_f32 v84, v6, v84
    v_mul_f32 v88, v6, v88
    v_cvt_pk_bf16_f32 v112, v84, v88
    v_mul_f32 v85, v6, v85
    v_mul_f32 v89, v6, v89
    v_cvt_pk_bf16_f32 v113, v85, v89
    v_mul_f32 v86, v6, v86
    v_mul_f32 v90, v6, v90
    v_cvt_pk_bf16_f32 v114, v86, v90
    v_mul_f32 v87, v6, v87
    v_mul_f32 v91, v6, v91
    v_cvt_pk_bf16_f32 v115, v87, v91
    buffer_store_dwordx4 v[112:115], v0, s[8:11], s17 offen offset:2048 sc1
    buffer_load_dwordx4 v[228:231], v0, s[28:31], s46 offen offset:2048
    s_waitcnt vmcnt(20)
    v_mfma_f32_16x16x16_bf16 v[100:103], a[142:143], v[20:21], v[100:103]
    v_mfma_f32_16x16x16_bf16 v[104:107], a[142:143], v[22:23], v[104:107]
    v_mul_f32 v92, v6, v92
    v_mul_f32 v96, v6, v96
    v_cvt_pk_bf16_f32 v116, v92, v96
    v_mul_f32 v93, v6, v93
    v_mul_f32 v97, v6, v97
    v_cvt_pk_bf16_f32 v117, v93, v97
    v_mul_f32 v94, v6, v94
    v_mul_f32 v98, v6, v98
    v_cvt_pk_bf16_f32 v118, v94, v98
    v_mul_f32 v95, v6, v95
    v_mul_f32 v99, v6, v99
    v_cvt_pk_bf16_f32 v119, v95, v99
    s_add_u32 s17, s48, 4096
    buffer_store_dwordx4 v[116:119], v0, s[8:11], s17 offen offset:0 sc1
    buffer_load_dwordx4 v[232:235], v0, s[28:31], s46 offen offset:3072
    v_mul_f32 v100, v6, v100
    v_mul_f32 v104, v6, v104
    v_cvt_pk_bf16_f32 v120, v100, v104
    v_mul_f32 v101, v6, v101
    v_mul_f32 v105, v6, v105
    v_cvt_pk_bf16_f32 v121, v101, v105
    v_mul_f32 v102, v6, v102
    v_mul_f32 v106, v6, v106
    v_cvt_pk_bf16_f32 v122, v102, v106
    v_mul_f32 v103, v6, v103
    v_mul_f32 v107, v6, v107
    v_cvt_pk_bf16_f32 v123, v103, v107
    buffer_store_dwordx4 v[120:123], v0, s[8:11], s17 offen offset:2048 sc1
    buffer_load_dwordx4 a[96:99], v9, s[20:23], s47 offen offset:0
    v_max3_f32 v5, v36, v37, v38
    v_max_f32 v5, v5, v39
    v_max3_f32 v5, v5, v40, v41
    v_max3_f32 v5, v5, v42, v43
    v_mul_f32 v48, s52, v48
    v_mul_f32 v49, s52, v49
    v_max3_f32 v5, v5, v48, v49
    v_mov_b32 v6, v5
    buffer_load_dwordx4 a[100:103], v9, s[20:23], s47 offen offset:64
    s_nop 0
    v_permlane32_swap_b32 v5, v6
    v_max_f32 v5, v5, v6
    v_mov_b32 v6, v5
    buffer_load_dwordx4 a[104:107], v9, s[20:23], s47 offen offset:128
    s_nop 0
    v_permlane16_swap_b32 v5, v6
    v_max_f32 v5, v5, v6
    v_sub_f32 v36, v36, v5
    v_sub_f32 v37, v37, v5
    v_sub_f32 v38, v38, v5
    v_sub_f32 v39, v39, v5
    v_sub_f32 v40, v40, v5
    v_sub_f32 v41, v41, v5
    v_sub_f32 v42, v42, v5
    v_sub_f32 v43, v43, v5
    v_sub_f32 v48, v48, v5
    v_sub_f32 v49, v49, v5
    v_exp_f32 v36, v36
    v_exp_f32 v37, v37
    v_exp_f32 v38, v38
    v_exp_f32 v39, v39
    v_exp_f32 v40, v40
    v_exp_f32 v41, v41
    v_exp_f32 v42, v42
    v_exp_f32 v43, v43
    v_exp_f32 v48, v48
    v_exp_f32 v49, v49
    v_cvt_pk_bf16_f32 v24, v36, v37
    v_cvt_pk_bf16_f32 v25, v38, v39
    v_cvt_pk_bf16_f32 v26, v40, v41
    v_cvt_pk_bf16_f32 v27, v42, v43
    v_cvt_pk_bf16_f32 v20, v48, v49
    v_cvt_pk_bf16_f32 v23, v48, v49
    v_mfma_f32_16x16x32_bf16 v[28:31], v[16:19], v[24:27], 0
    v_mfma_f32_16x16x32_bf16 v[76:79], a[64:67], v[24:27], 0
    v_mfma_f32_16x16x32_bf16 v[80:83], a[68:71], v[24:27], 0
    buffer_load_dwordx4 a[108:111], v9, s[20:23], s47 offen offset:192
    v_mfma_f32_16x16x32_bf16 v[84:87], a[72:75], v[24:27], 0
    v_mfma_f32_16x16x32_bf16 v[88:91], a[76:79], v[24:27], 0
    buffer_load_dwordx2 a[112:113], v10, s[20:23], s47 offen offset:2048
    v_mfma_f32_16x16x32_bf16 v[92:95], a[80:83], v[24:27], 0
    v_mfma_f32_16x16x32_bf16 v[96:99], a[84:87], v[24:27], 0
    buffer_load_dwordx2 a[114:115], v10, s[20:23], s47 offen offset:2560
    v_mfma_f32_16x16x16_bf16 v[28:31], v[16:17], v[20:21], v[28:31]
    v_mfma_f32_16x16x32_bf16 v[100:103], a[88:91], v[24:27], 0
    v_mfma_f32_16x16x32_bf16 v[104:107], a[92:95], v[24:27], 0
    buffer_load_dwordx2 a[116:117], v10, s[20:23], s47 offen offset:3072
    buffer_load_dwordx2 a[118:119], v10, s[20:23], s47 offen offset:3584
    v_mfma_f32_16x16x16_bf16 v[76:79], a[136:137], v[20:21], v[76:79]
    v_mfma_f32_16x16x16_bf16 v[80:83], a[136:137], v[22:23], v[80:83]
    v_rcp_f32 v6, v28
    v_mfma_f32_16x16x16_bf16 v[84:87], a[138:139], v[20:21], v[84:87]
    v_mfma_f32_16x16x16_bf16 v[88:91], a[138:139], v[22:23], v[88:91]
    v_mul_f32 v76, v6, v76
    v_mul_f32 v80, v6, v80
    v_cvt_pk_bf16_f32 v124, v76, v80
    v_mul_f32 v77, v6, v77
    v_mul_f32 v81, v6, v81
    v_cvt_pk_bf16_f32 v125, v77, v81
    v_mul_f32 v78, v6, v78
    v_mul_f32 v82, v6, v82
    v_cvt_pk_bf16_f32 v126, v78, v82
    v_mul_f32 v79, v6, v79
    v_mul_f32 v83, v6, v83
    v_cvt_pk_bf16_f32 v127, v79, v83
    s_add_u32 s17, s48, 0
    buffer_store_dwordx4 v[124:127], v0, s[8:11], s17 offen offset:1024 sc1
    v_mfma_f32_16x16x16_bf16 v[92:95], a[140:141], v[20:21], v[92:95]
    v_mfma_f32_16x16x16_bf16 v[96:99], a[140:141], v[22:23], v[96:99]
    v_mul_f32 v84, v6, v84
    v_mul_f32 v88, v6, v88
    v_cvt_pk_bf16_f32 v128, v84, v88
    v_mul_f32 v85, v6, v85
    v_mul_f32 v89, v6, v89
    v_cvt_pk_bf16_f32 v129, v85, v89
    v_mul_f32 v86, v6, v86
    v_mul_f32 v90, v6, v90
    v_cvt_pk_bf16_f32 v130, v86, v90
    v_mul_f32 v87, v6, v87
    v_mul_f32 v91, v6, v91
    v_cvt_pk_bf16_f32 v131, v87, v91
    buffer_store_dwordx4 v[128:131], v0, s[8:11], s17 offen offset:3072 sc1
    v_mfma_f32_16x16x16_bf16 v[100:103], a[142:143], v[20:21], v[100:103]
    v_mfma_f32_16x16x16_bf16 v[104:107], a[142:143], v[22:23], v[104:107]
    v_mul_f32 v92, v6, v92
    v_mul_f32 v96, v6, v96
    v_cvt_pk_bf16_f32 v132, v92, v96
    v_mul_f32 v93, v6, v93
    v_mul_f32 v97, v6, v97
    v_cvt_pk_bf16_f32 v133, v93, v97
    v_mul_f32 v94, v6, v94
    v_mul_f32 v98, v6, v98
    v_cvt_pk_bf16_f32 v134, v94, v98
    v_mul_f32 v95, v6, v95
    v_mul_f32 v99, v6, v99
    v_cvt_pk_bf16_f32 v135, v95, v99
    s_add_u32 s17, s48, 4096
    buffer_store_dwordx4 v[132:135], v0, s[8:11], s17 offen offset:1024 sc1
    v_mul_f32 v100, v6, v100
    v_mul_f32 v104, v6, v104
    v_cvt_pk_bf16_f32 v136, v100, v104
    v_mul_f32 v101, v6, v101
    v_mul_f32 v105, v6, v105
    v_cvt_pk_bf16_f32 v137, v101, v105
    v_mul_f32 v102, v6, v102
    v_mul_f32 v106, v6, v106
    v_cvt_pk_bf16_f32 v138, v102, v106
    v_mul_f32 v103, v6, v103
    v_mul_f32 v107, v6, v107
    v_cvt_pk_bf16_f32 v139, v103, v107
    buffer_store_dwordx4 v[136:139], v0, s[8:11], s17 offen offset:3072 sc1
    s_add_u32 s48, s48, 262144
    s_mov_b32 s49, 22528
    s_cmp_ge_u32 s37, 64
    s_cbranch_scc1 Lta_end
    s_branch Lta0
Lta_end:
    s_waitcnt vmcnt(0)
    s_mov_b64 exec, 1
    buffer_store_dword v3, v4, s[8:11], s43 offen sc1
    s_mov_b64 exec, -1
    s_branch L_role_ta_exit
L_role_ta_abort:
    s_waitcnt lgkmcnt(0)
    s_mov_b64 exec, -1
    v_mov_b32 v0, 60
    s_lshl_b32 s5, s3, 8
    s_or_b32 s5, s5, s4
    s_or_b32 s5, s5, 0x10000
    v_mov_b32 v1, s5
    global_store_dword v0, v1, s[12:13]
    s_endpgm
L_role_ta_exit:
    s_endpgm
.p2align 6
L_role_tw:
    v_and_b32 v5, 63, v0
    v_lshlrev_b32 v0, 4, v5
    v_and_b32 v7, 15, v5
    v_lshrrev_b32 v8, 4, v5
    v_min_u32 v1, 31, v5
    v_lshrrev_b32 v6, 2, v1
    v_and_b32 v1, 3, v1
    v_lshlrev_b32 v1, 2, v1
    v_lshl_add_u32 v1, v6, 7, v1
    v_mov_b32 v3, 1
    v_mov_b32 v4, 0
    s_mov_b32 s44, 0x05040100
    s_mov_b32 s45, 0x07060302
    s_cmp_lg_u32 s14, 0
    s_cbranch_scc1 Ltw_gate_d
    v_mov_b32 v5, 48
    s_mov_b32 s16, 0
Ltw_gate:
    global_load_dword v6, v5, s[12:13] sc1
    s_add_u32 s16, s16, 1
    s_cmp_gt_u32 s16, 100000
    s_cbranch_scc1 L_role_tw_abort
    s_waitcnt vmcnt(0)
    v_cmp_gt_u32 vcc, 32, v6
    s_nop 0
    s_cbranch_vccz Ltw_gate_d
    s_sleep 100
    s_branch Ltw_gate
Ltw_gate_d:
    s_barrier
    s_load_dwordx2 s[20:21], s[0:1], 64
    s_mov_b32 s22, 4718592
    s_mov_b32 s23, 0x00020000
    s_waitcnt lgkmcnt(0)
    s_and_b32 s21, s21, 0xffff
    s_load_dwordx2 s[24:25], s[0:1], 80
    s_mov_b32 s26, 2359296
    s_mov_b32 s27, 0x00020000
    s_waitcnt lgkmcnt(0)
    s_and_b32 s25, s25, 0xffff
    s_mul_i32 s17, s15, 43
    s_lshr_b32 s32, s17, 9
    s_mul_i32 s17, s32, 12
    s_sub_u32 s50, s15, s17
    s_add_u32 s33, s32, 30
    s_cmp_eq_u32 s32, 2
    s_cselect_b32 s33, 0, s33
    s_cselect_b32 s32, 64, s32
    s_mul_i32 s49, s50, 96
    s_mul_i32 s17, s14, 1179648
    s_add_u32 s49, s49, s17
    v_mul_u32_u24 v5, 4608, v8
    v_lshl_add_u32 v9, v7, 2, v5
    v_add_u32 v10, 18432, v9
    v_and_b32 v6, 14, v7
    v_lshl_add_u32 v12, v6, 1, v5
    v_add_u32 v12, 64, v12
    v_add_u32 v13, 18432, v12
    v_and_b32 v5, 1, v7
    v_mov_b32 v11, s44
    v_mov_b32 v6, s45
    v_cmp_eq_u32 vcc, 1, v5
    s_nop 1
    v_cndmask_b32 v11, v11, v6, vcc
    s_add_u32 s17, s49, 0
    buffer_load_dword v16, v9, s[20:23], s17 offen
    buffer_load_dword v17, v10, s[20:23], s17 offen
    buffer_load_dword v18, v12, s[20:23], s17 offen
    buffer_load_dword v19, v13, s[20:23], s17 offen
    s_add_u32 s17, s49, 1152
    buffer_load_dword v20, v9, s[20:23], s17 offen
    buffer_load_dword v21, v10, s[20:23], s17 offen
    buffer_load_dword v22, v12, s[20:23], s17 offen
    buffer_load_dword v23, v13, s[20:23], s17 offen
    s_add_u32 s17, s49, 2304
    buffer_load_dword v24, v9, s[20:23], s17 offen
    buffer_load_dword v25, v10, s[20:23], s17 offen
    buffer_load_dword v26, v12, s[20:23], s17 offen
    buffer_load_dword v27, v13, s[20:23], s17 offen
    s_add_u32 s17, s49, 3456
    buffer_load_dword v28, v9, s[20:23], s17 offen
    buffer_load_dword v29, v10, s[20:23], s17 offen
    buffer_load_dword v30, v12, s[20:23], s17 offen
    buffer_load_dword v31, v13, s[20:23], s17 offen
    s_add_u32 s17, s49, 36864
    buffer_load_dword v32, v9, s[20:23], s17 offen
    buffer_load_dword v33, v10, s[20:23], s17 offen
    buffer_load_dword v34, v12, s[20:23], s17 offen
    buffer_load_dword v35, v13, s[20:23], s17 offen
    s_add_u32 s17, s49, 38016
    buffer_load_dword v36, v9, s[20:23], s17 offen
    buffer_load_dword v37, v10, s[20:23], s17 offen
    buffer_load_dword v38, v12, s[20:23], s17 offen
    buffer_load_dword v39, v13, s[20:23], s17 offen
    s_add_u32 s17, s49, 39168
    buffer_load_dword v40, v9, s[20:23], s17 offen
    buffer_load_dword v41, v10, s[20:23], s17 offen
    buffer_load_dword v42, v12, s[20:23], s17 offen
    buffer_load_dword v43, v13, s[20:23], s17 offen
    s_add_u32 s17, s49, 40320
    buffer_load_dword v44, v9, s[20:23], s17 offen
    buffer_load_dword v45, v10, s[20:23], s17 offen
    buffer_load_dword v46, v12, s[20:23], s17 offen
    buffer_load_dword v47, v13, s[20:23], s17 offen
    s_add_u32 s17, s49, 73728
    buffer_load_dword v48, v9, s[20:23], s17 offen
    buffer_load_dword v49, v10, s[20:23], s17 offen
    buffer_load_dword v50, v12, s[20:23], s17 offen
    buffer_load_dword v51, v13, s[20:23], s17 offen
    s_add_u32 s17, s49, 74880
    buffer_load_dword v52, v9, s[20:23], s17 offen
    buffer_load_dword v53, v10, s[20:23], s17 offen
    buffer_load_dword v54, v12, s[20:23], s17 offen
    buffer_load_dword v55, v13, s[20:23], s17 offen
    s_add_u32 s17, s49, 76032
    buffer_load_dword v56, v9, s[20:23], s17 offen
    buffer_load_dword v57, v10, s[20:23], s17 offen
    buffer_load_dword v58, v12, s[20:23], s17 offen
    buffer_load_dword v59, v13, s[20:23], s17 offen
    s_add_u32 s17, s49, 77184
    buffer_load_dword v60, v9, s[20:23], s17 offen
    buffer_load_dword v61, v10, s[20:23], s17 offen
    buffer_load_dword v62, v12, s[20:23], s17 offen
    buffer_load_dword v63, v13, s[20:23], s17 offen
    s_add_u32 s17, s49, 110592
    buffer_load_dword v64, v9, s[20:23], s17 offen
    buffer_load_dword v65, v10, s[20:23], s17 offen
    buffer_load_dword v66, v12, s[20:23], s17 offen
    buffer_load_dword v67, v13, s[20:23], s17 offen
    s_add_u32 s17, s49, 111744
    buffer_load_dword v68, v9, s[20:23], s17 offen
    buffer_load_dword v69, v10, s[20:23], s17 offen
    buffer_load_dword v70, v12, s[20:23], s17 offen
    buffer_load_dword v71, v13, s[20:23], s17 offen
    s_add_u32 s17, s49, 112896
    buffer_load_dword v72, v9, s[20:23], s17 offen
    buffer_load_dword v73, v10, s[20:23], s17 offen
    buffer_load_dword v74, v12, s[20:23], s17 offen
    buffer_load_dword v75, v13, s[20:23], s17 offen
    s_waitcnt vmcnt(58)
    v_perm_b32 v5, v17, v16, s44
    v_perm_b32 v6, v17, v16, s45
    s_waitcnt vmcnt(56)
    v_perm_b32 v128, v19, v18, v11
    v_accvgpr_write_b32 a0, v5
    v_accvgpr_write_b32 a4, v6
    s_add_u32 s17, s49, 114048
    buffer_load_dword v76, v9, s[20:23], s17 offen
    buffer_load_dword v77, v10, s[20:23], s17 offen
    buffer_load_dword v78, v12, s[20:23], s17 offen
    buffer_load_dword v79, v13, s[20:23], s17 offen
    s_waitcnt vmcnt(58)
    v_perm_b32 v5, v21, v20, s44
    v_perm_b32 v6, v21, v20, s45
    s_waitcnt vmcnt(56)
    v_perm_b32 v129, v23, v22, v11
    v_accvgpr_write_b32 a1, v5
    v_accvgpr_write_b32 a5, v6
    s_add_u32 s17, s49, 147456
    buffer_load_dword v80, v9, s[20:23], s17 offen
    buffer_load_dword v81, v10, s[20:23], s17 offen
    buffer_load_dword v82, v12, s[20:23], s17 offen
    buffer_load_dword v83, v13, s[20:23], s17 offen
    s_waitcnt vmcnt(58)
    v_perm_b32 v5, v25, v24, s44
    v_perm_b32 v6, v25, v24, s45
    s_waitcnt vmcnt(56)
    v_perm_b32 v130, v27, v26, v11
    v_accvgpr_write_b32 a2, v5
    v_accvgpr_write_b32 a6, v6
    s_add_u32 s17, s49, 148608
    buffer_load_dword v84, v9, s[20:23], s17 offen
    buffer_load_dword v85, v10, s[20:23], s17 offen
    buffer_load_dword v86, v12, s[20:23], s17 offen
    buffer_load_dword v87, v13, s[20:23], s17 offen
    s_waitcnt vmcnt(58)
    v_perm_b32 v5, v29, v28, s44
    v_perm_b32 v6, v29, v28, s45
    s_waitcnt vmcnt(56)
    v_perm_b32 v131, v31, v30, v11
    v_accvgpr_write_b32 a3, v5
    v_accvgpr_write_b32 a7, v6
    s_add_u32 s17, s49, 149760
    buffer_load_dword v88, v9, s[20:23], s17 offen
    buffer_load_dword v89, v10, s[20:23], s17 offen
    buffer_load_dword v90, v12, s[20:23], s17 offen
    buffer_load_dword v91, v13, s[20:23], s17 offen
    s_waitcnt vmcnt(58)
    v_perm_b32 v5, v33, v32, s44
    v_perm_b32 v6, v33, v32, s45
    s_waitcnt vmcnt(56)
    v_perm_b32 v132, v35, v34, v11
    v_accvgpr_write_b32 a8, v5
    v_accvgpr_write_b32 a12, v6
    s_add_u32 s17, s49, 150912
    buffer_load_dword v92, v9, s[20:23], s17 offen
    buffer_load_dword v93, v10, s[20:23], s17 offen
    buffer_load_dword v94, v12, s[20:23], s17 offen
    buffer_load_dword v95, v13, s[20:23], s17 offen
    s_waitcnt vmcnt(58)
    v_perm_b32 v5, v37, v36, s44
    v_perm_b32 v6, v37, v36, s45
    s_waitcnt vmcnt(56)
    v_perm_b32 v133, v39, v38, v11
    v_accvgpr_write_b32 a9, v5
    v_accvgpr_write_b32 a13, v6
    s_add_u32 s17, s49, 184320
    buffer_load_dword v96, v9, s[20:23], s17 offen
    buffer_load_dword v97, v10, s[20:23], s17 offen
    buffer_load_dword v98, v12, s[20:23], s17 offen
    buffer_load_dword v99, v13, s[20:23], s17 offen
    s_waitcnt vmcnt(58)
    v_perm_b32 v5, v41, v40, s44
    v_perm_b32 v6, v41, v40, s45
    s_waitcnt vmcnt(56)
    v_perm_b32 v134, v43, v42, v11
    v_accvgpr_write_b32 a10, v5
    v_accvgpr_write_b32 a14, v6
    s_add_u32 s17, s49, 185472
    buffer_load_dword v100, v9, s[20:23], s17 offen
    buffer_load_dword v101, v10, s[20:23], s17 offen
    buffer_load_dword v102, v12, s[20:23], s17 offen
    buffer_load_dword v103, v13, s[20:23], s17 offen
    s_waitcnt vmcnt(58)
    v_perm_b32 v5, v45, v44, s44
    v_perm_b32 v6, v45, v44, s45
    s_waitcnt vmcnt(56)
    v_perm_b32 v135, v47, v46, v11
    v_accvgpr_write_b32 a11, v5
    v_accvgpr_write_b32 a15, v6
    s_add_u32 s17, s49, 186624
    buffer_load_dword v104, v9, s[20:23], s17 offen
    buffer_load_dword v105, v10, s[20:23], s17 offen
    buffer_load_dword v106, v12, s[20:23], s17 offen
    buffer_load_dword v107, v13, s[20:23], s17 offen
    s_waitcnt vmcnt(58)
    v_perm_b32 v5, v49, v48, s44
    v_perm_b32 v6, v49, v48, s45
    s_waitcnt vmcnt(56)
    v_perm_b32 v136, v51, v50, v11
    v_accvgpr_write_b32 a16, v5
    v_accvgpr_write_b32 a20, v6
    s_add_u32 s17, s49, 187776
    buffer_load_dword v108, v9, s[20:23], s17 offen
    buffer_load_dword v109, v10, s[20:23], s17 offen
    buffer_load_dword v110, v12, s[20:23], s17 offen
    buffer_load_dword v111, v13, s[20:23], s17 offen
    s_waitcnt vmcnt(58)
    v_perm_b32 v5, v53, v52, s44
    v_perm_b32 v6, v53, v52, s45
    s_waitcnt vmcnt(56)
    v_perm_b32 v137, v55, v54, v11
    v_accvgpr_write_b32 a17, v5
    v_accvgpr_write_b32 a21, v6
    s_add_u32 s17, s49, 221184
    buffer_load_dword v112, v9, s[20:23], s17 offen
    buffer_load_dword v113, v10, s[20:23], s17 offen
    buffer_load_dword v114, v12, s[20:23], s17 offen
    buffer_load_dword v115, v13, s[20:23], s17 offen
    s_waitcnt vmcnt(58)
    v_perm_b32 v5, v57, v56, s44
    v_perm_b32 v6, v57, v56, s45
    s_waitcnt vmcnt(56)
    v_perm_b32 v138, v59, v58, v11
    v_accvgpr_write_b32 a18, v5
    v_accvgpr_write_b32 a22, v6
    s_add_u32 s17, s49, 222336
    buffer_load_dword v116, v9, s[20:23], s17 offen
    buffer_load_dword v117, v10, s[20:23], s17 offen
    buffer_load_dword v118, v12, s[20:23], s17 offen
    buffer_load_dword v119, v13, s[20:23], s17 offen
    s_waitcnt vmcnt(58)
    v_perm_b32 v5, v61, v60, s44
    v_perm_b32 v6, v61, v60, s45
    s_waitcnt vmcnt(56)
    v_perm_b32 v139, v63, v62, v11
    v_accvgpr_write_b32 a19, v5
    v_accvgpr_write_b32 a23, v6
    s_add_u32 s17, s49, 223488
    buffer_load_dword v120, v9, s[20:23], s17 offen
    buffer_load_dword v121, v10, s[20:23], s17 offen
    buffer_load_dword v122, v12, s[20:23], s17 offen
    buffer_load_dword v123, v13, s[20:23], s17 offen
    s_waitcnt vmcnt(58)
    v_perm_b32 v5, v65, v64, s44
    v_perm_b32 v6, v65, v64, s45
    s_waitcnt vmcnt(56)
    v_perm_b32 v140, v67, v66, v11
    v_accvgpr_write_b32 a24, v5
    v_accvgpr_write_b32 a28, v6
    s_add_u32 s17, s49, 224640
    buffer_load_dword v124, v9, s[20:23], s17 offen
    buffer_load_dword v125, v10, s[20:23], s17 offen
    buffer_load_dword v126, v12, s[20:23], s17 offen
    buffer_load_dword v127, v13, s[20:23], s17 offen
    s_waitcnt vmcnt(58)
    v_perm_b32 v5, v69, v68, s44
    v_perm_b32 v6, v69, v68, s45
    s_waitcnt vmcnt(56)
    v_perm_b32 v141, v71, v70, v11
    v_accvgpr_write_b32 a25, v5
    v_accvgpr_write_b32 a29, v6
    s_add_u32 s17, s49, 258048
    buffer_load_dword v16, v9, s[20:23], s17 offen
    buffer_load_dword v17, v10, s[20:23], s17 offen
    buffer_load_dword v18, v12, s[20:23], s17 offen
    buffer_load_dword v19, v13, s[20:23], s17 offen
    s_waitcnt vmcnt(58)
    v_perm_b32 v5, v73, v72, s44
    v_perm_b32 v6, v73, v72, s45
    s_waitcnt vmcnt(56)
    v_perm_b32 v142, v75, v74, v11
    v_accvgpr_write_b32 a26, v5
    v_accvgpr_write_b32 a30, v6
    s_add_u32 s17, s49, 259200
    buffer_load_dword v20, v9, s[20:23], s17 offen
    buffer_load_dword v21, v10, s[20:23], s17 offen
    buffer_load_dword v22, v12, s[20:23], s17 offen
    buffer_load_dword v23, v13, s[20:23], s17 offen
    s_waitcnt vmcnt(58)
    v_perm_b32 v5, v77, v76, s44
    v_perm_b32 v6, v77, v76, s45
    s_waitcnt vmcnt(56)
    v_perm_b32 v143, v79, v78, v11
    v_accvgpr_write_b32 a27, v5
    v_accvgpr_write_b32 a31, v6
    s_add_u32 s17, s49, 260352
    buffer_load_dword v24, v9, s[20:23], s17 offen
    buffer_load_dword v25, v10, s[20:23], s17 offen
    buffer_load_dword v26, v12, s[20:23], s17 offen
    buffer_load_dword v27, v13, s[20:23], s17 offen
    s_waitcnt vmcnt(58)
    v_perm_b32 v5, v81, v80, s44
    v_perm_b32 v6, v81, v80, s45
    s_waitcnt vmcnt(56)
    v_perm_b32 v144, v83, v82, v11
    v_accvgpr_write_b32 a32, v5
    v_accvgpr_write_b32 a36, v6
    s_add_u32 s17, s49, 261504
    buffer_load_dword v28, v9, s[20:23], s17 offen
    buffer_load_dword v29, v10, s[20:23], s17 offen
    buffer_load_dword v30, v12, s[20:23], s17 offen
    buffer_load_dword v31, v13, s[20:23], s17 offen
    s_waitcnt vmcnt(58)
    v_perm_b32 v5, v85, v84, s44
    v_perm_b32 v6, v85, v84, s45
    s_waitcnt vmcnt(56)
    v_perm_b32 v145, v87, v86, v11
    v_accvgpr_write_b32 a33, v5
    v_accvgpr_write_b32 a37, v6
    s_add_u32 s17, s49, 294912
    buffer_load_dword v32, v9, s[20:23], s17 offen
    buffer_load_dword v33, v10, s[20:23], s17 offen
    buffer_load_dword v34, v12, s[20:23], s17 offen
    buffer_load_dword v35, v13, s[20:23], s17 offen
    s_waitcnt vmcnt(58)
    v_perm_b32 v5, v89, v88, s44
    v_perm_b32 v6, v89, v88, s45
    s_waitcnt vmcnt(56)
    v_perm_b32 v146, v91, v90, v11
    v_accvgpr_write_b32 a34, v5
    v_accvgpr_write_b32 a38, v6
    s_add_u32 s17, s49, 296064
    buffer_load_dword v36, v9, s[20:23], s17 offen
    buffer_load_dword v37, v10, s[20:23], s17 offen
    buffer_load_dword v38, v12, s[20:23], s17 offen
    buffer_load_dword v39, v13, s[20:23], s17 offen
    s_waitcnt vmcnt(58)
    v_perm_b32 v5, v93, v92, s44
    v_perm_b32 v6, v93, v92, s45
    s_waitcnt vmcnt(56)
    v_perm_b32 v147, v95, v94, v11
    v_accvgpr_write_b32 a35, v5
    v_accvgpr_write_b32 a39, v6
    s_add_u32 s17, s49, 297216
    buffer_load_dword v40, v9, s[20:23], s17 offen
    buffer_load_dword v41, v10, s[20:23], s17 offen
    buffer_load_dword v42, v12, s[20:23], s17 offen
    buffer_load_dword v43, v13, s[20:23], s17 offen
    s_waitcnt vmcnt(58)
    v_perm_b32 v5, v97, v96, s44
    v_perm_b32 v6, v97, v96, s45
    s_waitcnt vmcnt(56)
    v_perm_b32 v148, v99, v98, v11
    v_accvgpr_write_b32 a40, v5
    v_accvgpr_write_b32 a44, v6
    s_add_u32 s17, s49, 298368
    buffer_load_dword v44, v9, s[20:23], s17 offen
    buffer_load_dword v45, v10, s[20:23], s17 offen
    buffer_load_dword v46, v12, s[20:23], s17 offen
    buffer_load_dword v47, v13, s[20:23], s17 offen
    s_waitcnt vmcnt(58)
    v_perm_b32 v5, v101, v100, s44
    v_perm_b32 v6, v101, v100, s45
    s_waitcnt vmcnt(56)
    v_perm_b32 v149, v103, v102, v11
    v_accvgpr_write_b32 a41, v5
    v_accvgpr_write_b32 a45, v6
    s_add_u32 s17, s49, 331776
    buffer_load_dword v48, v9, s[20:23], s17 offen
    buffer_load_dword v49, v10, s[20:23], s17 offen
    buffer_load_dword v50, v12, s[20:23], s17 offen
    buffer_load_dword v51, v13, s[20:23], s17 offen
    s_waitcnt vmcnt(58)
    v_perm_b32 v5, v105, v104, s44
    v_perm_b32 v6, v105, v104, s45
    s_waitcnt vmcnt(56)
    v_perm_b32 v150, v107, v106, v11
    v_accvgpr_write_b32 a42, v5
    v_accvgpr_write_b32 a46, v6
    s_add_u32 s17, s49, 332928
    buffer_load_dword v52, v9, s[20:23], s17 offen
    buffer_load_dword v53, v10, s[20:23], s17 offen
    buffer_load_dword v54, v12, s[20:23], s17 offen
    buffer_load_dword v55, v13, s[20:23], s17 offen
    s_waitcnt vmcnt(58)
    v_perm_b32 v5, v109, v108, s44
    v_perm_b32 v6, v109, v108, s45
    s_waitcnt vmcnt(56)
    v_perm_b32 v151, v111, v110, v11
    v_accvgpr_write_b32 a43, v5
    v_accvgpr_write_b32 a47, v6
    s_add_u32 s17, s49, 334080
    buffer_load_dword v56, v9, s[20:23], s17 offen
    buffer_load_dword v57, v10, s[20:23], s17 offen
    buffer_load_dword v58, v12, s[20:23], s17 offen
    buffer_load_dword v59, v13, s[20:23], s17 offen
    s_waitcnt vmcnt(58)
    v_perm_b32 v5, v113, v112, s44
    v_perm_b32 v6, v113, v112, s45
    s_waitcnt vmcnt(56)
    v_perm_b32 v152, v115, v114, v11
    v_accvgpr_write_b32 a48, v5
    v_accvgpr_write_b32 a52, v6
    s_add_u32 s17, s49, 335232
    buffer_load_dword v60, v9, s[20:23], s17 offen
    buffer_load_dword v61, v10, s[20:23], s17 offen
    buffer_load_dword v62, v12, s[20:23], s17 offen
    buffer_load_dword v63, v13, s[20:23], s17 offen
    s_waitcnt vmcnt(58)
    v_perm_b32 v5, v117, v116, s44
    v_perm_b32 v6, v117, v116, s45
    s_waitcnt vmcnt(56)
    v_perm_b32 v153, v119, v118, v11
    v_accvgpr_write_b32 a49, v5
    v_accvgpr_write_b32 a53, v6
    s_add_u32 s17, s49, 368640
    buffer_load_dword v64, v9, s[20:23], s17 offen
    buffer_load_dword v65, v10, s[20:23], s17 offen
    buffer_load_dword v66, v12, s[20:23], s17 offen
    buffer_load_dword v67, v13, s[20:23], s17 offen
    s_waitcnt vmcnt(58)
    v_perm_b32 v5, v121, v120, s44
    v_perm_b32 v6, v121, v120, s45
    s_waitcnt vmcnt(56)
    v_perm_b32 v154, v123, v122, v11
    v_accvgpr_write_b32 a50, v5
    v_accvgpr_write_b32 a54, v6
    s_add_u32 s17, s49, 369792
    buffer_load_dword v68, v9, s[20:23], s17 offen
    buffer_load_dword v69, v10, s[20:23], s17 offen
    buffer_load_dword v70, v12, s[20:23], s17 offen
    buffer_load_dword v71, v13, s[20:23], s17 offen
    s_waitcnt vmcnt(58)
    v_perm_b32 v5, v125, v124, s44
    v_perm_b32 v6, v125, v124, s45
    s_waitcnt vmcnt(56)
    v_perm_b32 v155, v127, v126, v11
    v_accvgpr_write_b32 a51, v5
    v_accvgpr_write_b32 a55, v6
    s_add_u32 s17, s49, 370944
    buffer_load_dword v72, v9, s[20:23], s17 offen
    buffer_load_dword v73, v10, s[20:23], s17 offen
    buffer_load_dword v74, v12, s[20:23], s17 offen
    buffer_load_dword v75, v13, s[20:23], s17 offen
    s_waitcnt vmcnt(58)
    v_perm_b32 v5, v17, v16, s44
    v_perm_b32 v6, v17, v16, s45
    s_waitcnt vmcnt(56)
    v_perm_b32 v156, v19, v18, v11
    v_accvgpr_write_b32 a56, v5
    v_accvgpr_write_b32 a60, v6
    s_add_u32 s17, s49, 372096
    buffer_load_dword v76, v9, s[20:23], s17 offen
    buffer_load_dword v77, v10, s[20:23], s17 offen
    buffer_load_dword v78, v12, s[20:23], s17 offen
    buffer_load_dword v79, v13, s[20:23], s17 offen
    s_waitcnt vmcnt(58)
    v_perm_b32 v5, v21, v20, s44
    v_perm_b32 v6, v21, v20, s45
    s_waitcnt vmcnt(56)
    v_perm_b32 v157, v23, v22, v11
    v_accvgpr_write_b32 a57, v5
    v_accvgpr_write_b32 a61, v6
    s_add_u32 s17, s49, 405504
    buffer_load_dword v80, v9, s[20:23], s17 offen
    buffer_load_dword v81, v10, s[20:23], s17 offen
    buffer_load_dword v82, v12, s[20:23], s17 offen
    buffer_load_dword v83, v13, s[20:23], s17 offen
    s_waitcnt vmcnt(58)
    v_perm_b32 v5, v25, v24, s44
    v_perm_b32 v6, v25, v24, s45
    s_waitcnt vmcnt(56)
    v_perm_b32 v158, v27, v26, v11
    v_accvgpr_write_b32 a58, v5
    v_accvgpr_write_b32 a62, v6
    s_add_u32 s17, s49, 406656
    buffer_load_dword v84, v9, s[20:23], s17 offen
    buffer_load_dword v85, v10, s[20:23], s17 offen
    buffer_load_dword v86, v12, s[20:23], s17 offen
    buffer_load_dword v87, v13, s[20:23], s17 offen
    s_waitcnt vmcnt(58)
    v_perm_b32 v5, v29, v28, s44
    v_perm_b32 v6, v29, v28, s45
    s_waitcnt vmcnt(56)
    v_perm_b32 v159, v31, v30, v11
    v_accvgpr_write_b32 a59, v5
    v_accvgpr_write_b32 a63, v6
    s_add_u32 s17, s49, 407808
    buffer_load_dword v88, v9, s[20:23], s17 offen
    buffer_load_dword v89, v10, s[20:23], s17 offen
    buffer_load_dword v90, v12, s[20:23], s17 offen
    buffer_load_dword v91, v13, s[20:23], s17 offen
    s_waitcnt vmcnt(58)
    v_perm_b32 v5, v33, v32, s44
    v_perm_b32 v6, v33, v32, s45
    s_waitcnt vmcnt(56)
    v_perm_b32 v160, v35, v34, v11
    v_accvgpr_write_b32 a64, v5
    v_accvgpr_write_b32 a68, v6
    s_add_u32 s17, s49, 408960
    buffer_load_dword v92, v9, s[20:23], s17 offen
    buffer_load_dword v93, v10, s[20:23], s17 offen
    buffer_load_dword v94, v12, s[20:23], s17 offen
    buffer_load_dword v95, v13, s[20:23], s17 offen
    s_waitcnt vmcnt(58)
    v_perm_b32 v5, v37, v36, s44
    v_perm_b32 v6, v37, v36, s45
    s_waitcnt vmcnt(56)
    v_perm_b32 v161, v39, v38, v11
    v_accvgpr_write_b32 a65, v5
    v_accvgpr_write_b32 a69, v6
    s_add_u32 s17, s49, 442368
    buffer_load_dword v96, v9, s[20:23], s17 offen
    buffer_load_dword v97, v10, s[20:23], s17 offen
    buffer_load_dword v98, v12, s[20:23], s17 offen
    buffer_load_dword v99, v13, s[20:23], s17 offen
    s_waitcnt vmcnt(58)
    v_perm_b32 v5, v41, v40, s44
    v_perm_b32 v6, v41, v40, s45
    s_waitcnt vmcnt(56)
    v_perm_b32 v162, v43, v42, v11
    v_accvgpr_write_b32 a66, v5
    v_accvgpr_write_b32 a70, v6
    s_add_u32 s17, s49, 443520
    buffer_load_dword v100, v9, s[20:23], s17 offen
    buffer_load_dword v101, v10, s[20:23], s17 offen
    buffer_load_dword v102, v12, s[20:23], s17 offen
    buffer_load_dword v103, v13, s[20:23], s17 offen
    s_waitcnt vmcnt(58)
    v_perm_b32 v5, v45, v44, s44
    v_perm_b32 v6, v45, v44, s45
    s_waitcnt vmcnt(56)
    v_perm_b32 v163, v47, v46, v11
    v_accvgpr_write_b32 a67, v5
    v_accvgpr_write_b32 a71, v6
    s_add_u32 s17, s49, 444672
    buffer_load_dword v104, v9, s[20:23], s17 offen
    buffer_load_dword v105, v10, s[20:23], s17 offen
    buffer_load_dword v106, v12, s[20:23], s17 offen
    buffer_load_dword v107, v13, s[20:23], s17 offen
    s_waitcnt vmcnt(58)
    v_perm_b32 v5, v49, v48, s44
    v_perm_b32 v6, v49, v48, s45
    s_waitcnt vmcnt(56)
    v_perm_b32 v164, v51, v50, v11
    v_accvgpr_write_b32 a72, v5
    v_accvgpr_write_b32 a76, v6
    s_add_u32 s17, s49, 445824
    buffer_load_dword v108, v9, s[20:23], s17 offen
    buffer_load_dword v109, v10, s[20:23], s17 offen
    buffer_load_dword v110, v12, s[20:23], s17 offen
    buffer_load_dword v111, v13, s[20:23], s17 offen
    s_waitcnt vmcnt(58)
    v_perm_b32 v5, v53, v52, s44
    v_perm_b32 v6, v53, v52, s45
    s_waitcnt vmcnt(56)
    v_perm_b32 v165, v55, v54, v11
    v_accvgpr_write_b32 a73, v5
    v_accvgpr_write_b32 a77, v6
    s_add_u32 s17, s49, 479232
    buffer_load_dword v112, v9, s[20:23], s17 offen
    buffer_load_dword v113, v10, s[20:23], s17 offen
    buffer_load_dword v114, v12, s[20:23], s17 offen
    buffer_load_dword v115, v13, s[20:23], s17 offen
    s_waitcnt vmcnt(58)
    v_perm_b32 v5, v57, v56, s44
    v_perm_b32 v6, v57, v56, s45
    s_waitcnt vmcnt(56)
    v_perm_b32 v166, v59, v58, v11
    v_accvgpr_write_b32 a74, v5
    v_accvgpr_write_b32 a78, v6
    s_add_u32 s17, s49, 480384
    buffer_load_dword v116, v9, s[20:23], s17 offen
    buffer_load_dword v117, v10, s[20:23], s17 offen
    buffer_load_dword v118, v12, s[20:23], s17 offen
    buffer_load_dword v119, v13, s[20:23], s17 offen
    s_waitcnt vmcnt(58)
    v_perm_b32 v5, v61, v60, s44
    v_perm_b32 v6, v61, v60, s45
    s_waitcnt vmcnt(56)
    v_perm_b32 v167, v63, v62, v11
    v_accvgpr_write_b32 a75, v5
    v_accvgpr_write_b32 a79, v6
    s_add_u32 s17, s49, 481536
    buffer_load_dword v120, v9, s[20:23], s17 offen
    buffer_load_dword v121, v10, s[20:23], s17 offen
    buffer_load_dword v122, v12, s[20:23], s17 offen
    buffer_load_dword v123, v13, s[20:23], s17 offen
    s_waitcnt vmcnt(58)
    v_perm_b32 v5, v65, v64, s44
    v_perm_b32 v6, v65, v64, s45
    s_waitcnt vmcnt(56)
    v_perm_b32 v168, v67, v66, v11
    v_accvgpr_write_b32 a80, v5
    v_accvgpr_write_b32 a84, v6
    s_add_u32 s17, s49, 482688
    buffer_load_dword v124, v9, s[20:23], s17 offen
    buffer_load_dword v125, v10, s[20:23], s17 offen
    buffer_load_dword v126, v12, s[20:23], s17 offen
    buffer_load_dword v127, v13, s[20:23], s17 offen
    s_waitcnt vmcnt(58)
    v_perm_b32 v5, v69, v68, s44
    v_perm_b32 v6, v69, v68, s45
    s_waitcnt vmcnt(56)
    v_perm_b32 v169, v71, v70, v11
    v_accvgpr_write_b32 a81, v5
    v_accvgpr_write_b32 a85, v6
    s_add_u32 s17, s49, 516096
    buffer_load_dword v16, v9, s[20:23], s17 offen
    buffer_load_dword v17, v10, s[20:23], s17 offen
    buffer_load_dword v18, v12, s[20:23], s17 offen
    buffer_load_dword v19, v13, s[20:23], s17 offen
    s_waitcnt vmcnt(58)
    v_perm_b32 v5, v73, v72, s44
    v_perm_b32 v6, v73, v72, s45
    s_waitcnt vmcnt(56)
    v_perm_b32 v170, v75, v74, v11
    v_accvgpr_write_b32 a82, v5
    v_accvgpr_write_b32 a86, v6
    s_add_u32 s17, s49, 517248
    buffer_load_dword v20, v9, s[20:23], s17 offen
    buffer_load_dword v21, v10, s[20:23], s17 offen
    buffer_load_dword v22, v12, s[20:23], s17 offen
    buffer_load_dword v23, v13, s[20:23], s17 offen
    s_waitcnt vmcnt(58)
    v_perm_b32 v5, v77, v76, s44
    v_perm_b32 v6, v77, v76, s45
    s_waitcnt vmcnt(56)
    v_perm_b32 v171, v79, v78, v11
    v_accvgpr_write_b32 a83, v5
    v_accvgpr_write_b32 a87, v6
    s_add_u32 s17, s49, 518400
    buffer_load_dword v24, v9, s[20:23], s17 offen
    buffer_load_dword v25, v10, s[20:23], s17 offen
    buffer_load_dword v26, v12, s[20:23], s17 offen
    buffer_load_dword v27, v13, s[20:23], s17 offen
    s_waitcnt vmcnt(58)
    v_perm_b32 v5, v81, v80, s44
    v_perm_b32 v6, v81, v80, s45
    s_waitcnt vmcnt(56)
    v_perm_b32 v172, v83, v82, v11
    v_accvgpr_write_b32 a88, v5
    v_accvgpr_write_b32 a92, v6
    s_add_u32 s17, s49, 519552
    buffer_load_dword v28, v9, s[20:23], s17 offen
    buffer_load_dword v29, v10, s[20:23], s17 offen
    buffer_load_dword v30, v12, s[20:23], s17 offen
    buffer_load_dword v31, v13, s[20:23], s17 offen
    s_waitcnt vmcnt(58)
    v_perm_b32 v5, v85, v84, s44
    v_perm_b32 v6, v85, v84, s45
    s_waitcnt vmcnt(56)
    v_perm_b32 v173, v87, v86, v11
    v_accvgpr_write_b32 a89, v5
    v_accvgpr_write_b32 a93, v6
    s_add_u32 s17, s49, 552960
    buffer_load_dword v32, v9, s[20:23], s17 offen
    buffer_load_dword v33, v10, s[20:23], s17 offen
    buffer_load_dword v34, v12, s[20:23], s17 offen
    buffer_load_dword v35, v13, s[20:23], s17 offen
    s_waitcnt vmcnt(58)
    v_perm_b32 v5, v89, v88, s44
    v_perm_b32 v6, v89, v88, s45
    s_waitcnt vmcnt(56)
    v_perm_b32 v174, v91, v90, v11
    v_accvgpr_write_b32 a90, v5
    v_accvgpr_write_b32 a94, v6
    s_add_u32 s17, s49, 554112
    buffer_load_dword v36, v9, s[20:23], s17 offen
    buffer_load_dword v37, v10, s[20:23], s17 offen
    buffer_load_dword v38, v12, s[20:23], s17 offen
    buffer_load_dword v39, v13, s[20:23], s17 offen
    s_waitcnt vmcnt(58)
    v_perm_b32 v5, v93, v92, s44
    v_perm_b32 v6, v93, v92, s45
    s_waitcnt vmcnt(56)
    v_perm_b32 v175, v95, v94, v11
    v_accvgpr_write_b32 a91, v5
    v_accvgpr_write_b32 a95, v6
    s_add_u32 s17, s49, 555264
    buffer_load_dword v40, v9, s[20:23], s17 offen
    buffer_load_dword v41, v10, s[20:23], s17 offen
    buffer_load_dword v42, v12, s[20:23], s17 offen
    buffer_load_dword v43, v13, s[20:23], s17 offen
    s_waitcnt vmcnt(58)
    v_perm_b32 v5, v97, v96, s44
    v_perm_b32 v6, v97, v96, s45
    s_waitcnt vmcnt(56)
    v_perm_b32 v176, v99, v98, v11
    v_accvgpr_write_b32 a96, v5
    v_accvgpr_write_b32 a100, v6
    s_add_u32 s17, s49, 556416
    buffer_load_dword v44, v9, s[20:23], s17 offen
    buffer_load_dword v45, v10, s[20:23], s17 offen
    buffer_load_dword v46, v12, s[20:23], s17 offen
    buffer_load_dword v47, v13, s[20:23], s17 offen
    s_waitcnt vmcnt(58)
    v_perm_b32 v5, v101, v100, s44
    v_perm_b32 v6, v101, v100, s45
    s_waitcnt vmcnt(56)
    v_perm_b32 v177, v103, v102, v11
    v_accvgpr_write_b32 a97, v5
    v_accvgpr_write_b32 a101, v6
    s_add_u32 s17, s49, 589824
    buffer_load_dword v48, v9, s[20:23], s17 offen
    buffer_load_dword v49, v10, s[20:23], s17 offen
    buffer_load_dword v50, v12, s[20:23], s17 offen
    buffer_load_dword v51, v13, s[20:23], s17 offen
    s_waitcnt vmcnt(58)
    v_perm_b32 v5, v105, v104, s44
    v_perm_b32 v6, v105, v104, s45
    s_waitcnt vmcnt(56)
    v_perm_b32 v178, v107, v106, v11
    v_accvgpr_write_b32 a98, v5
    v_accvgpr_write_b32 a102, v6
    s_add_u32 s17, s49, 590976
    buffer_load_dword v52, v9, s[20:23], s17 offen
    buffer_load_dword v53, v10, s[20:23], s17 offen
    buffer_load_dword v54, v12, s[20:23], s17 offen
    buffer_load_dword v55, v13, s[20:23], s17 offen
    s_waitcnt vmcnt(58)
    v_perm_b32 v5, v109, v108, s44
    v_perm_b32 v6, v109, v108, s45
    s_waitcnt vmcnt(56)
    v_perm_b32 v179, v111, v110, v11
    v_accvgpr_write_b32 a99, v5
    v_accvgpr_write_b32 a103, v6
    s_add_u32 s17, s49, 592128
    buffer_load_dword v56, v9, s[20:23], s17 offen
    buffer_load_dword v57, v10, s[20:23], s17 offen
    buffer_load_dword v58, v12, s[20:23], s17 offen
    buffer_load_dword v59, v13, s[20:23], s17 offen
    s_waitcnt vmcnt(58)
    v_perm_b32 v5, v113, v112, s44
    v_perm_b32 v6, v113, v112, s45
    s_waitcnt vmcnt(56)
    v_perm_b32 v180, v115, v114, v11
    v_accvgpr_write_b32 a104, v5
    v_accvgpr_write_b32 a108, v6
    s_add_u32 s17, s49, 593280
    buffer_load_dword v60, v9, s[20:23], s17 offen
    buffer_load_dword v61, v10, s[20:23], s17 offen
    buffer_load_dword v62, v12, s[20:23], s17 offen
    buffer_load_dword v63, v13, s[20:23], s17 offen
    s_waitcnt vmcnt(58)
    v_perm_b32 v5, v117, v116, s44
    v_perm_b32 v6, v117, v116, s45
    s_waitcnt vmcnt(56)
    v_perm_b32 v181, v119, v118, v11
    v_accvgpr_write_b32 a105, v5
    v_accvgpr_write_b32 a109, v6
    s_add_u32 s17, s49, 626688
    buffer_load_dword v64, v9, s[20:23], s17 offen
    buffer_load_dword v65, v10, s[20:23], s17 offen
    buffer_load_dword v66, v12, s[20:23], s17 offen
    buffer_load_dword v67, v13, s[20:23], s17 offen
    s_waitcnt vmcnt(58)
    v_perm_b32 v5, v121, v120, s44
    v_perm_b32 v6, v121, v120, s45
    s_waitcnt vmcnt(56)
    v_perm_b32 v182, v123, v122, v11
    v_accvgpr_write_b32 a106, v5
    v_accvgpr_write_b32 a110, v6
    s_add_u32 s17, s49, 627840
    buffer_load_dword v68, v9, s[20:23], s17 offen
    buffer_load_dword v69, v10, s[20:23], s17 offen
    buffer_load_dword v70, v12, s[20:23], s17 offen
    buffer_load_dword v71, v13, s[20:23], s17 offen
    s_waitcnt vmcnt(58)
    v_perm_b32 v5, v125, v124, s44
    v_perm_b32 v6, v125, v124, s45
    s_waitcnt vmcnt(56)
    v_perm_b32 v183, v127, v126, v11
    v_accvgpr_write_b32 a107, v5
    v_accvgpr_write_b32 a111, v6
    s_add_u32 s17, s49, 628992
    buffer_load_dword v72, v9, s[20:23], s17 offen
    buffer_load_dword v73, v10, s[20:23], s17 offen
    buffer_load_dword v74, v12, s[20:23], s17 offen
    buffer_load_dword v75, v13, s[20:23], s17 offen
    s_waitcnt vmcnt(58)
    v_perm_b32 v5, v17, v16, s44
    v_perm_b32 v6, v17, v16, s45
    s_waitcnt vmcnt(56)
    v_perm_b32 v184, v19, v18, v11
    v_accvgpr_write_b32 a112, v5
    v_accvgpr_write_b32 a116, v6
    s_add_u32 s17, s49, 630144
    buffer_load_dword v76, v9, s[20:23], s17 offen
    buffer_load_dword v77, v10, s[20:23], s17 offen
    buffer_load_dword v78, v12, s[20:23], s17 offen
    buffer_load_dword v79, v13, s[20:23], s17 offen
    s_waitcnt vmcnt(58)
    v_perm_b32 v5, v21, v20, s44
    v_perm_b32 v6, v21, v20, s45
    s_waitcnt vmcnt(56)
    v_perm_b32 v185, v23, v22, v11
    v_accvgpr_write_b32 a113, v5
    v_accvgpr_write_b32 a117, v6
    s_add_u32 s17, s49, 663552
    buffer_load_dword v80, v9, s[20:23], s17 offen
    buffer_load_dword v81, v10, s[20:23], s17 offen
    buffer_load_dword v82, v12, s[20:23], s17 offen
    buffer_load_dword v83, v13, s[20:23], s17 offen
    s_waitcnt vmcnt(58)
    v_perm_b32 v5, v25, v24, s44
    v_perm_b32 v6, v25, v24, s45
    s_waitcnt vmcnt(56)
    v_perm_b32 v186, v27, v26, v11
    v_accvgpr_write_b32 a114, v5
    v_accvgpr_write_b32 a118, v6
    s_add_u32 s17, s49, 664704
    buffer_load_dword v84, v9, s[20:23], s17 offen
    buffer_load_dword v85, v10, s[20:23], s17 offen
    buffer_load_dword v86, v12, s[20:23], s17 offen
    buffer_load_dword v87, v13, s[20:23], s17 offen
    s_waitcnt vmcnt(58)
    v_perm_b32 v5, v29, v28, s44
    v_perm_b32 v6, v29, v28, s45
    s_waitcnt vmcnt(56)
    v_perm_b32 v187, v31, v30, v11
    v_accvgpr_write_b32 a115, v5
    v_accvgpr_write_b32 a119, v6
    s_add_u32 s17, s49, 665856
    buffer_load_dword v88, v9, s[20:23], s17 offen
    buffer_load_dword v89, v10, s[20:23], s17 offen
    buffer_load_dword v90, v12, s[20:23], s17 offen
    buffer_load_dword v91, v13, s[20:23], s17 offen
    s_waitcnt vmcnt(58)
    v_perm_b32 v5, v33, v32, s44
    v_perm_b32 v6, v33, v32, s45
    s_waitcnt vmcnt(56)
    v_perm_b32 v188, v35, v34, v11
    v_accvgpr_write_b32 a120, v5
    v_accvgpr_write_b32 a124, v6
    s_add_u32 s17, s49, 667008
    buffer_load_dword v92, v9, s[20:23], s17 offen
    buffer_load_dword v93, v10, s[20:23], s17 offen
    buffer_load_dword v94, v12, s[20:23], s17 offen
    buffer_load_dword v95, v13, s[20:23], s17 offen
    s_waitcnt vmcnt(58)
    v_perm_b32 v5, v37, v36, s44
    v_perm_b32 v6, v37, v36, s45
    s_waitcnt vmcnt(56)
    v_perm_b32 v189, v39, v38, v11
    v_accvgpr_write_b32 a121, v5
    v_accvgpr_write_b32 a125, v6
    s_add_u32 s17, s49, 700416
    buffer_load_dword v96, v9, s[20:23], s17 offen
    buffer_load_dword v97, v10, s[20:23], s17 offen
    buffer_load_dword v98, v12, s[20:23], s17 offen
    buffer_load_dword v99, v13, s[20:23], s17 offen
    s_waitcnt vmcnt(58)
    v_perm_b32 v5, v41, v40, s44
    v_perm_b32 v6, v41, v40, s45
    s_waitcnt vmcnt(56)
    v_perm_b32 v190, v43, v42, v11
    v_accvgpr_write_b32 a122, v5
    v_accvgpr_write_b32 a126, v6
    s_add_u32 s17, s49, 701568
    buffer_load_dword v100, v9, s[20:23], s17 offen
    buffer_load_dword v101, v10, s[20:23], s17 offen
    buffer_load_dword v102, v12, s[20:23], s17 offen
    buffer_load_dword v103, v13, s[20:23], s17 offen
    s_waitcnt vmcnt(58)
    v_perm_b32 v5, v45, v44, s44
    v_perm_b32 v6, v45, v44, s45
    s_waitcnt vmcnt(56)
    v_perm_b32 v191, v47, v46, v11
    v_accvgpr_write_b32 a123, v5
    v_accvgpr_write_b32 a127, v6
    s_add_u32 s17, s49, 702720
    buffer_load_dword v104, v9, s[20:23], s17 offen
    buffer_load_dword v105, v10, s[20:23], s17 offen
    buffer_load_dword v106, v12, s[20:23], s17 offen
    buffer_load_dword v107, v13, s[20:23], s17 offen
    s_waitcnt vmcnt(58)
    v_perm_b32 v5, v49, v48, s44
    v_perm_b32 v6, v49, v48, s45
    s_waitcnt vmcnt(56)
    v_perm_b32 v192, v51, v50, v11
    v_accvgpr_write_b32 a128, v5
    v_accvgpr_write_b32 a132, v6
    s_add_u32 s17, s49, 703872
    buffer_load_dword v108, v9, s[20:23], s17 offen
    buffer_load_dword v109, v10, s[20:23], s17 offen
    buffer_load_dword v110, v12, s[20:23], s17 offen
    buffer_load_dword v111, v13, s[20:23], s17 offen
    s_waitcnt vmcnt(58)
    v_perm_b32 v5, v53, v52, s44
    v_perm_b32 v6, v53, v52, s45
    s_waitcnt vmcnt(56)
    v_perm_b32 v193, v55, v54, v11
    v_accvgpr_write_b32 a129, v5
    v_accvgpr_write_b32 a133, v6
    s_add_u32 s17, s49, 737280
    buffer_load_dword v112, v9, s[20:23], s17 offen
    buffer_load_dword v113, v10, s[20:23], s17 offen
    buffer_load_dword v114, v12, s[20:23], s17 offen
    buffer_load_dword v115, v13, s[20:23], s17 offen
    s_waitcnt vmcnt(58)
    v_perm_b32 v5, v57, v56, s44
    v_perm_b32 v6, v57, v56, s45
    s_waitcnt vmcnt(56)
    v_perm_b32 v194, v59, v58, v11
    v_accvgpr_write_b32 a130, v5
    v_accvgpr_write_b32 a134, v6
    s_add_u32 s17, s49, 738432
    buffer_load_dword v116, v9, s[20:23], s17 offen
    buffer_load_dword v117, v10, s[20:23], s17 offen
    buffer_load_dword v118, v12, s[20:23], s17 offen
    buffer_load_dword v119, v13, s[20:23], s17 offen
    s_waitcnt vmcnt(58)
    v_perm_b32 v5, v61, v60, s44
    v_perm_b32 v6, v61, v60, s45
    s_waitcnt vmcnt(56)
    v_perm_b32 v195, v63, v62, v11
    v_accvgpr_write_b32 a131, v5
    v_accvgpr_write_b32 a135, v6
    s_add_u32 s17, s49, 739584
    buffer_load_dword v120, v9, s[20:23], s17 offen
    buffer_load_dword v121, v10, s[20:23], s17 offen
    buffer_load_dword v122, v12, s[20:23], s17 offen
    buffer_load_dword v123, v13, s[20:23], s17 offen
    s_waitcnt vmcnt(58)
    v_perm_b32 v5, v65, v64, s44
    v_perm_b32 v6, v65, v64, s45
    s_waitcnt vmcnt(56)
    v_perm_b32 v196, v67, v66, v11
    v_accvgpr_write_b32 a136, v5
    v_accvgpr_write_b32 a140, v6
    s_add_u32 s17, s49, 740736
    buffer_load_dword v124, v9, s[20:23], s17 offen
    buffer_load_dword v125, v10, s[20:23], s17 offen
    buffer_load_dword v126, v12, s[20:23], s17 offen
    buffer_load_dword v127, v13, s[20:23], s17 offen
    s_waitcnt vmcnt(58)
    v_perm_b32 v5, v69, v68, s44
    v_perm_b32 v6, v69, v68, s45
    s_waitcnt vmcnt(56)
    v_perm_b32 v197, v71, v70, v11
    v_accvgpr_write_b32 a137, v5
    v_accvgpr_write_b32 a141, v6
    s_add_u32 s17, s49, 774144
    buffer_load_dword v16, v9, s[20:23], s17 offen
    buffer_load_dword v17, v10, s[20:23], s17 offen
    buffer_load_dword v18, v12, s[20:23], s17 offen
    buffer_load_dword v19, v13, s[20:23], s17 offen
    s_waitcnt vmcnt(58)
    v_perm_b32 v5, v73, v72, s44
    v_perm_b32 v6, v73, v72, s45
    s_waitcnt vmcnt(56)
    v_perm_b32 v198, v75, v74, v11
    v_accvgpr_write_b32 a138, v5
    v_accvgpr_write_b32 a142, v6
    s_add_u32 s17, s49, 775296
    buffer_load_dword v20, v9, s[20:23], s17 offen
    buffer_load_dword v21, v10, s[20:23], s17 offen
    buffer_load_dword v22, v12, s[20:23], s17 offen
    buffer_load_dword v23, v13, s[20:23], s17 offen
    s_waitcnt vmcnt(58)
    v_perm_b32 v5, v77, v76, s44
    v_perm_b32 v6, v77, v76, s45
    s_waitcnt vmcnt(56)
    v_perm_b32 v199, v79, v78, v11
    v_accvgpr_write_b32 a139, v5
    v_accvgpr_write_b32 a143, v6
    s_add_u32 s17, s49, 776448
    buffer_load_dword v24, v9, s[20:23], s17 offen
    buffer_load_dword v25, v10, s[20:23], s17 offen
    buffer_load_dword v26, v12, s[20:23], s17 offen
    buffer_load_dword v27, v13, s[20:23], s17 offen
    s_waitcnt vmcnt(58)
    v_perm_b32 v5, v81, v80, s44
    v_perm_b32 v6, v81, v80, s45
    s_waitcnt vmcnt(56)
    v_perm_b32 v200, v83, v82, v11
    v_accvgpr_write_b32 a144, v5
    v_accvgpr_write_b32 a148, v6
    s_add_u32 s17, s49, 777600
    buffer_load_dword v28, v9, s[20:23], s17 offen
    buffer_load_dword v29, v10, s[20:23], s17 offen
    buffer_load_dword v30, v12, s[20:23], s17 offen
    buffer_load_dword v31, v13, s[20:23], s17 offen
    s_waitcnt vmcnt(58)
    v_perm_b32 v5, v85, v84, s44
    v_perm_b32 v6, v85, v84, s45
    s_waitcnt vmcnt(56)
    v_perm_b32 v201, v87, v86, v11
    v_accvgpr_write_b32 a145, v5
    v_accvgpr_write_b32 a149, v6
    s_add_u32 s17, s49, 811008
    buffer_load_dword v32, v9, s[20:23], s17 offen
    buffer_load_dword v33, v10, s[20:23], s17 offen
    buffer_load_dword v34, v12, s[20:23], s17 offen
    buffer_load_dword v35, v13, s[20:23], s17 offen
    s_waitcnt vmcnt(58)
    v_perm_b32 v5, v89, v88, s44
    v_perm_b32 v6, v89, v88, s45
    s_waitcnt vmcnt(56)
    v_perm_b32 v202, v91, v90, v11
    v_accvgpr_write_b32 a146, v5
    v_accvgpr_write_b32 a150, v6
    s_add_u32 s17, s49, 812160
    buffer_load_dword v36, v9, s[20:23], s17 offen
    buffer_load_dword v37, v10, s[20:23], s17 offen
    buffer_load_dword v38, v12, s[20:23], s17 offen
    buffer_load_dword v39, v13, s[20:23], s17 offen
    s_waitcnt vmcnt(58)
    v_perm_b32 v5, v93, v92, s44
    v_perm_b32 v6, v93, v92, s45
    s_waitcnt vmcnt(56)
    v_perm_b32 v203, v95, v94, v11
    v_accvgpr_write_b32 a147, v5
    v_accvgpr_write_b32 a151, v6
    s_add_u32 s17, s49, 813312
    buffer_load_dword v40, v9, s[20:23], s17 offen
    buffer_load_dword v41, v10, s[20:23], s17 offen
    buffer_load_dword v42, v12, s[20:23], s17 offen
    buffer_load_dword v43, v13, s[20:23], s17 offen
    s_waitcnt vmcnt(58)
    v_perm_b32 v5, v97, v96, s44
    v_perm_b32 v6, v97, v96, s45
    s_waitcnt vmcnt(56)
    v_perm_b32 v204, v99, v98, v11
    v_accvgpr_write_b32 a152, v5
    v_accvgpr_write_b32 a156, v6
    s_add_u32 s17, s49, 814464
    buffer_load_dword v44, v9, s[20:23], s17 offen
    buffer_load_dword v45, v10, s[20:23], s17 offen
    buffer_load_dword v46, v12, s[20:23], s17 offen
    buffer_load_dword v47, v13, s[20:23], s17 offen
    s_waitcnt vmcnt(58)
    v_perm_b32 v5, v101, v100, s44
    v_perm_b32 v6, v101, v100, s45
    s_waitcnt vmcnt(56)
    v_perm_b32 v205, v103, v102, v11
    v_accvgpr_write_b32 a153, v5
    v_accvgpr_write_b32 a157, v6
    s_add_u32 s17, s49, 847872
    buffer_load_dword v48, v9, s[20:23], s17 offen
    buffer_load_dword v49, v10, s[20:23], s17 offen
    buffer_load_dword v50, v12, s[20:23], s17 offen
    buffer_load_dword v51, v13, s[20:23], s17 offen
    s_waitcnt vmcnt(58)
    v_perm_b32 v5, v105, v104, s44
    v_perm_b32 v6, v105, v104, s45
    s_waitcnt vmcnt(56)
    v_perm_b32 v206, v107, v106, v11
    v_accvgpr_write_b32 a154, v5
    v_accvgpr_write_b32 a158, v6
    s_add_u32 s17, s49, 849024
    buffer_load_dword v52, v9, s[20:23], s17 offen
    buffer_load_dword v53, v10, s[20:23], s17 offen
    buffer_load_dword v54, v12, s[20:23], s17 offen
    buffer_load_dword v55, v13, s[20:23], s17 offen
    s_waitcnt vmcnt(58)
    v_perm_b32 v5, v109, v108, s44
    v_perm_b32 v6, v109, v108, s45
    s_waitcnt vmcnt(56)
    v_perm_b32 v207, v111, v110, v11
    v_accvgpr_write_b32 a155, v5
    v_accvgpr_write_b32 a159, v6
    s_add_u32 s17, s49, 850176
    buffer_load_dword v56, v9, s[20:23], s17 offen
    buffer_load_dword v57, v10, s[20:23], s17 offen
    buffer_load_dword v58, v12, s[20:23], s17 offen
    buffer_load_dword v59, v13, s[20:23], s17 offen
    s_waitcnt vmcnt(58)
    v_perm_b32 v5, v113, v112, s44
    v_perm_b32 v6, v113, v112, s45
    s_waitcnt vmcnt(56)
    v_perm_b32 v208, v115, v114, v11
    v_accvgpr_write_b32 a160, v5
    v_accvgpr_write_b32 a164, v6
    s_add_u32 s17, s49, 851328
    buffer_load_dword v60, v9, s[20:23], s17 offen
    buffer_load_dword v61, v10, s[20:23], s17 offen
    buffer_load_dword v62, v12, s[20:23], s17 offen
    buffer_load_dword v63, v13, s[20:23], s17 offen
    s_waitcnt vmcnt(58)
    v_perm_b32 v5, v117, v116, s44
    v_perm_b32 v6, v117, v116, s45
    s_waitcnt vmcnt(56)
    v_perm_b32 v209, v119, v118, v11
    v_accvgpr_write_b32 a161, v5
    v_accvgpr_write_b32 a165, v6
    s_add_u32 s17, s49, 884736
    buffer_load_dword v64, v9, s[20:23], s17 offen
    buffer_load_dword v65, v10, s[20:23], s17 offen
    buffer_load_dword v66, v12, s[20:23], s17 offen
    buffer_load_dword v67, v13, s[20:23], s17 offen
    s_waitcnt vmcnt(58)
    v_perm_b32 v5, v121, v120, s44
    v_perm_b32 v6, v121, v120, s45
    s_waitcnt vmcnt(56)
    v_perm_b32 v210, v123, v122, v11
    v_accvgpr_write_b32 a162, v5
    v_accvgpr_write_b32 a166, v6
    s_add_u32 s17, s49, 885888
    buffer_load_dword v68, v9, s[20:23], s17 offen
    buffer_load_dword v69, v10, s[20:23], s17 offen
    buffer_load_dword v70, v12, s[20:23], s17 offen
    buffer_load_dword v71, v13, s[20:23], s17 offen
    s_waitcnt vmcnt(58)
    v_perm_b32 v5, v125, v124, s44
    v_perm_b32 v6, v125, v124, s45
    s_waitcnt vmcnt(56)
    v_perm_b32 v211, v127, v126, v11
    v_accvgpr_write_b32 a163, v5
    v_accvgpr_write_b32 a167, v6
    s_add_u32 s17, s49, 887040
    buffer_load_dword v72, v9, s[20:23], s17 offen
    buffer_load_dword v73, v10, s[20:23], s17 offen
    buffer_load_dword v74, v12, s[20:23], s17 offen
    buffer_load_dword v75, v13, s[20:23], s17 offen
    s_waitcnt vmcnt(58)
    v_perm_b32 v5, v17, v16, s44
    v_perm_b32 v6, v17, v16, s45
    s_waitcnt vmcnt(56)
    v_perm_b32 v212, v19, v18, v11
    v_accvgpr_write_b32 a168, v5
    v_accvgpr_write_b32 a172, v6
    s_add_u32 s17, s49, 888192
    buffer_load_dword v76, v9, s[20:23], s17 offen
    buffer_load_dword v77, v10, s[20:23], s17 offen
    buffer_load_dword v78, v12, s[20:23], s17 offen
    buffer_load_dword v79, v13, s[20:23], s17 offen
    s_waitcnt vmcnt(58)
    v_perm_b32 v5, v21, v20, s44
    v_perm_b32 v6, v21, v20, s45
    s_waitcnt vmcnt(56)
    v_perm_b32 v213, v23, v22, v11
    v_accvgpr_write_b32 a169, v5
    v_accvgpr_write_b32 a173, v6
    s_add_u32 s17, s49, 921600
    buffer_load_dword v80, v9, s[20:23], s17 offen
    buffer_load_dword v81, v10, s[20:23], s17 offen
    buffer_load_dword v82, v12, s[20:23], s17 offen
    buffer_load_dword v83, v13, s[20:23], s17 offen
    s_waitcnt vmcnt(58)
    v_perm_b32 v5, v25, v24, s44
    v_perm_b32 v6, v25, v24, s45
    s_waitcnt vmcnt(56)
    v_perm_b32 v214, v27, v26, v11
    v_accvgpr_write_b32 a170, v5
    v_accvgpr_write_b32 a174, v6
    s_add_u32 s17, s49, 922752
    buffer_load_dword v84, v9, s[20:23], s17 offen
    buffer_load_dword v85, v10, s[20:23], s17 offen
    buffer_load_dword v86, v12, s[20:23], s17 offen
    buffer_load_dword v87, v13, s[20:23], s17 offen
    s_waitcnt vmcnt(58)
    v_perm_b32 v5, v29, v28, s44
    v_perm_b32 v6, v29, v28, s45
    s_waitcnt vmcnt(56)
    v_perm_b32 v215, v31, v30, v11
    v_accvgpr_write_b32 a171, v5
    v_accvgpr_write_b32 a175, v6
    s_add_u32 s17, s49, 923904
    buffer_load_dword v88, v9, s[20:23], s17 offen
    buffer_load_dword v89, v10, s[20:23], s17 offen
    buffer_load_dword v90, v12, s[20:23], s17 offen
    buffer_load_dword v91, v13, s[20:23], s17 offen
    s_waitcnt vmcnt(58)
    v_perm_b32 v5, v33, v32, s44
    v_perm_b32 v6, v33, v32, s45
    s_waitcnt vmcnt(56)
    v_perm_b32 v216, v35, v34, v11
    v_accvgpr_write_b32 a176, v5
    v_accvgpr_write_b32 a180, v6
    s_add_u32 s17, s49, 925056
    buffer_load_dword v92, v9, s[20:23], s17 offen
    buffer_load_dword v93, v10, s[20:23], s17 offen
    buffer_load_dword v94, v12, s[20:23], s17 offen
    buffer_load_dword v95, v13, s[20:23], s17 offen
    s_waitcnt vmcnt(58)
    v_perm_b32 v5, v37, v36, s44
    v_perm_b32 v6, v37, v36, s45
    s_waitcnt vmcnt(56)
    v_perm_b32 v217, v39, v38, v11
    v_accvgpr_write_b32 a177, v5
    v_accvgpr_write_b32 a181, v6
    s_add_u32 s17, s49, 958464
    buffer_load_dword v96, v9, s[20:23], s17 offen
    buffer_load_dword v97, v10, s[20:23], s17 offen
    buffer_load_dword v98, v12, s[20:23], s17 offen
    buffer_load_dword v99, v13, s[20:23], s17 offen
    s_waitcnt vmcnt(58)
    v_perm_b32 v5, v41, v40, s44
    v_perm_b32 v6, v41, v40, s45
    s_waitcnt vmcnt(56)
    v_perm_b32 v218, v43, v42, v11
    v_accvgpr_write_b32 a178, v5
    v_accvgpr_write_b32 a182, v6
    s_add_u32 s17, s49, 959616
    buffer_load_dword v100, v9, s[20:23], s17 offen
    buffer_load_dword v101, v10, s[20:23], s17 offen
    buffer_load_dword v102, v12, s[20:23], s17 offen
    buffer_load_dword v103, v13, s[20:23], s17 offen
    s_waitcnt vmcnt(58)
    v_perm_b32 v5, v45, v44, s44
    v_perm_b32 v6, v45, v44, s45
    s_waitcnt vmcnt(56)
    v_perm_b32 v219, v47, v46, v11
    v_accvgpr_write_b32 a179, v5
    v_accvgpr_write_b32 a183, v6
    s_add_u32 s17, s49, 960768
    buffer_load_dword v104, v9, s[20:23], s17 offen
    buffer_load_dword v105, v10, s[20:23], s17 offen
    buffer_load_dword v106, v12, s[20:23], s17 offen
    buffer_load_dword v107, v13, s[20:23], s17 offen
    s_waitcnt vmcnt(58)
    v_perm_b32 v5, v49, v48, s44
    v_perm_b32 v6, v49, v48, s45
    s_waitcnt vmcnt(56)
    v_perm_b32 v220, v51, v50, v11
    v_accvgpr_write_b32 a184, v5
    v_accvgpr_write_b32 a188, v6
    s_add_u32 s17, s49, 961920
    buffer_load_dword v108, v9, s[20:23], s17 offen
    buffer_load_dword v109, v10, s[20:23], s17 offen
    buffer_load_dword v110, v12, s[20:23], s17 offen
    buffer_load_dword v111, v13, s[20:23], s17 offen
    s_waitcnt vmcnt(58)
    v_perm_b32 v5, v53, v52, s44
    v_perm_b32 v6, v53, v52, s45
    s_waitcnt vmcnt(56)
    v_perm_b32 v221, v55, v54, v11
    v_accvgpr_write_b32 a185, v5
    v_accvgpr_write_b32 a189, v6
    s_add_u32 s17, s49, 995328
    buffer_load_dword v112, v9, s[20:23], s17 offen
    buffer_load_dword v113, v10, s[20:23], s17 offen
    buffer_load_dword v114, v12, s[20:23], s17 offen
    buffer_load_dword v115, v13, s[20:23], s17 offen
    s_waitcnt vmcnt(58)
    v_perm_b32 v5, v57, v56, s44
    v_perm_b32 v6, v57, v56, s45
    s_waitcnt vmcnt(56)
    v_perm_b32 v222, v59, v58, v11
    v_accvgpr_write_b32 a186, v5
    v_accvgpr_write_b32 a190, v6
    s_add_u32 s17, s49, 996480
    buffer_load_dword v116, v9, s[20:23], s17 offen
    buffer_load_dword v117, v10, s[20:23], s17 offen
    buffer_load_dword v118, v12, s[20:23], s17 offen
    buffer_load_dword v119, v13, s[20:23], s17 offen
    s_waitcnt vmcnt(58)
    v_perm_b32 v5, v61, v60, s44
    v_perm_b32 v6, v61, v60, s45
    s_waitcnt vmcnt(56)
    v_perm_b32 v223, v63, v62, v11
    v_accvgpr_write_b32 a187, v5
    v_accvgpr_write_b32 a191, v6
    s_add_u32 s17, s49, 997632
    buffer_load_dword v120, v9, s[20:23], s17 offen
    buffer_load_dword v121, v10, s[20:23], s17 offen
    buffer_load_dword v122, v12, s[20:23], s17 offen
    buffer_load_dword v123, v13, s[20:23], s17 offen
    s_waitcnt vmcnt(58)
    v_perm_b32 v5, v65, v64, s44
    v_perm_b32 v6, v65, v64, s45
    s_waitcnt vmcnt(56)
    v_perm_b32 v224, v67, v66, v11
    v_accvgpr_write_b32 a192, v5
    v_accvgpr_write_b32 a196, v6
    s_add_u32 s17, s49, 998784
    buffer_load_dword v124, v9, s[20:23], s17 offen
    buffer_load_dword v125, v10, s[20:23], s17 offen
    buffer_load_dword v126, v12, s[20:23], s17 offen
    buffer_load_dword v127, v13, s[20:23], s17 offen
    s_waitcnt vmcnt(58)
    v_perm_b32 v5, v69, v68, s44
    v_perm_b32 v6, v69, v68, s45
    s_waitcnt vmcnt(56)
    v_perm_b32 v225, v71, v70, v11
    v_accvgpr_write_b32 a193, v5
    v_accvgpr_write_b32 a197, v6
    s_add_u32 s17, s49, 1032192
    buffer_load_dword v16, v9, s[20:23], s17 offen
    buffer_load_dword v17, v10, s[20:23], s17 offen
    buffer_load_dword v18, v12, s[20:23], s17 offen
    buffer_load_dword v19, v13, s[20:23], s17 offen
    s_waitcnt vmcnt(58)
    v_perm_b32 v5, v73, v72, s44
    v_perm_b32 v6, v73, v72, s45
    s_waitcnt vmcnt(56)
    v_perm_b32 v226, v75, v74, v11
    v_accvgpr_write_b32 a194, v5
    v_accvgpr_write_b32 a198, v6
    s_add_u32 s17, s49, 1033344
    buffer_load_dword v20, v9, s[20:23], s17 offen
    buffer_load_dword v21, v10, s[20:23], s17 offen
    buffer_load_dword v22, v12, s[20:23], s17 offen
    buffer_load_dword v23, v13, s[20:23], s17 offen
    s_waitcnt vmcnt(58)
    v_perm_b32 v5, v77, v76, s44
    v_perm_b32 v6, v77, v76, s45
    s_waitcnt vmcnt(56)
    v_perm_b32 v227, v79, v78, v11
    v_accvgpr_write_b32 a195, v5
    v_accvgpr_write_b32 a199, v6
    s_add_u32 s17, s49, 1034496
    buffer_load_dword v24, v9, s[20:23], s17 offen
    buffer_load_dword v25, v10, s[20:23], s17 offen
    buffer_load_dword v26, v12, s[20:23], s17 offen
    buffer_load_dword v27, v13, s[20:23], s17 offen
    s_waitcnt vmcnt(58)
    v_perm_b32 v5, v81, v80, s44
    v_perm_b32 v6, v81, v80, s45
    s_waitcnt vmcnt(56)
    v_perm_b32 v228, v83, v82, v11
    v_accvgpr_write_b32 a200, v5
    v_accvgpr_write_b32 a204, v6
    s_add_u32 s17, s49, 1035648
    buffer_load_dword v28, v9, s[20:23], s17 offen
    buffer_load_dword v29, v10, s[20:23], s17 offen
    buffer_load_dword v30, v12, s[20:23], s17 offen
    buffer_load_dword v31, v13, s[20:23], s17 offen
    s_waitcnt vmcnt(58)
    v_perm_b32 v5, v85, v84, s44
    v_perm_b32 v6, v85, v84, s45
    s_waitcnt vmcnt(56)
    v_perm_b32 v229, v87, v86, v11
    v_accvgpr_write_b32 a201, v5
    v_accvgpr_write_b32 a205, v6
    s_add_u32 s17, s49, 1069056
    buffer_load_dword v32, v9, s[20:23], s17 offen
    buffer_load_dword v33, v10, s[20:23], s17 offen
    buffer_load_dword v34, v12, s[20:23], s17 offen
    buffer_load_dword v35, v13, s[20:23], s17 offen
    s_waitcnt vmcnt(58)
    v_perm_b32 v5, v89, v88, s44
    v_perm_b32 v6, v89, v88, s45
    s_waitcnt vmcnt(56)
    v_perm_b32 v230, v91, v90, v11
    v_accvgpr_write_b32 a202, v5
    v_accvgpr_write_b32 a206, v6
    s_add_u32 s17, s49, 1070208
    buffer_load_dword v36, v9, s[20:23], s17 offen
    buffer_load_dword v37, v10, s[20:23], s17 offen
    buffer_load_dword v38, v12, s[20:23], s17 offen
    buffer_load_dword v39, v13, s[20:23], s17 offen
    s_waitcnt vmcnt(58)
    v_perm_b32 v5, v93, v92, s44
    v_perm_b32 v6, v93, v92, s45
    s_waitcnt vmcnt(56)
    v_perm_b32 v231, v95, v94, v11
    v_accvgpr_write_b32 a203, v5
    v_accvgpr_write_b32 a207, v6
    s_add_u32 s17, s49, 1071360
    buffer_load_dword v40, v9, s[20:23], s17 offen
    buffer_load_dword v41, v10, s[20:23], s17 offen
    buffer_load_dword v42, v12, s[20:23], s17 offen
    buffer_load_dword v43, v13, s[20:23], s17 offen
    s_waitcnt vmcnt(58)
    v_perm_b32 v5, v97, v96, s44
    v_perm_b32 v6, v97, v96, s45
    s_waitcnt vmcnt(56)
    v_perm_b32 v232, v99, v98, v11
    v_accvgpr_write_b32 a208, v5
    v_accvgpr_write_b32 a212, v6
    s_add_u32 s17, s49, 1072512
    buffer_load_dword v44, v9, s[20:23], s17 offen
    buffer_load_dword v45, v10, s[20:23], s17 offen
    buffer_load_dword v46, v12, s[20:23], s17 offen
    buffer_load_dword v47, v13, s[20:23], s17 offen
    s_waitcnt vmcnt(58)
    v_perm_b32 v5, v101, v100, s44
    v_perm_b32 v6, v101, v100, s45
    s_waitcnt vmcnt(56)
    v_perm_b32 v233, v103, v102, v11
    v_accvgpr_write_b32 a209, v5
    v_accvgpr_write_b32 a213, v6
    s_add_u32 s17, s49, 1105920
    buffer_load_dword v48, v9, s[20:23], s17 offen
    buffer_load_dword v49, v10, s[20:23], s17 offen
    buffer_load_dword v50, v12, s[20:23], s17 offen
    buffer_load_dword v51, v13, s[20:23], s17 offen
    s_waitcnt vmcnt(58)
    v_perm_b32 v5, v105, v104, s44
    v_perm_b32 v6, v105, v104, s45
    s_waitcnt vmcnt(56)
    v_perm_b32 v234, v107, v106, v11
    v_accvgpr_write_b32 a210, v5
    v_accvgpr_write_b32 a214, v6
    s_add_u32 s17, s49, 1107072
    buffer_load_dword v52, v9, s[20:23], s17 offen
    buffer_load_dword v53, v10, s[20:23], s17 offen
    buffer_load_dword v54, v12, s[20:23], s17 offen
    buffer_load_dword v55, v13, s[20:23], s17 offen
    s_waitcnt vmcnt(58)
    v_perm_b32 v5, v109, v108, s44
    v_perm_b32 v6, v109, v108, s45
    s_waitcnt vmcnt(56)
    v_perm_b32 v235, v111, v110, v11
    v_accvgpr_write_b32 a211, v5
    v_accvgpr_write_b32 a215, v6
    s_add_u32 s17, s49, 1108224
    buffer_load_dword v56, v9, s[20:23], s17 offen
    buffer_load_dword v57, v10, s[20:23], s17 offen
    buffer_load_dword v58, v12, s[20:23], s17 offen
    buffer_load_dword v59, v13, s[20:23], s17 offen
    s_waitcnt vmcnt(58)
    v_perm_b32 v5, v113, v112, s44
    v_perm_b32 v6, v113, v112, s45
    s_waitcnt vmcnt(56)
    v_perm_b32 v236, v115, v114, v11
    v_accvgpr_write_b32 a216, v5
    v_accvgpr_write_b32 a220, v6
    s_add_u32 s17, s49, 1109376
    buffer_load_dword v60, v9, s[20:23], s17 offen
    buffer_load_dword v61, v10, s[20:23], s17 offen
    buffer_load_dword v62, v12, s[20:23], s17 offen
    buffer_load_dword v63, v13, s[20:23], s17 offen
    s_waitcnt vmcnt(58)
    v_perm_b32 v5, v117, v116, s44
    v_perm_b32 v6, v117, v116, s45
    s_waitcnt vmcnt(56)
    v_perm_b32 v237, v119, v118, v11
    v_accvgpr_write_b32 a217, v5
    v_accvgpr_write_b32 a221, v6
    s_add_u32 s17, s49, 1142784
    buffer_load_dword v64, v9, s[20:23], s17 offen
    buffer_load_dword v65, v10, s[20:23], s17 offen
    buffer_load_dword v66, v12, s[20:23], s17 offen
    buffer_load_dword v67, v13, s[20:23], s17 offen
    s_waitcnt vmcnt(58)
    v_perm_b32 v5, v121, v120, s44
    v_perm_b32 v6, v121, v120, s45
    s_waitcnt vmcnt(56)
    v_perm_b32 v238, v123, v122, v11
    v_accvgpr_write_b32 a218, v5
    v_accvgpr_write_b32 a222, v6
    s_add_u32 s17, s49, 1143936
    buffer_load_dword v68, v9, s[20:23], s17 offen
    buffer_load_dword v69, v10, s[20:23], s17 offen
    buffer_load_dword v70, v12, s[20:23], s17 offen
    buffer_load_dword v71, v13, s[20:23], s17 offen
    s_waitcnt vmcnt(58)
    v_perm_b32 v5, v125, v124, s44
    v_perm_b32 v6, v125, v124, s45
    s_waitcnt vmcnt(56)
    v_perm_b32 v239, v127, v126, v11
    v_accvgpr_write_b32 a219, v5
    v_accvgpr_write_b32 a223, v6
    s_add_u32 s17, s49, 1145088
    buffer_load_dword v72, v9, s[20:23], s17 offen
    buffer_load_dword v73, v10, s[20:23], s17 offen
    buffer_load_dword v74, v12, s[20:23], s17 offen
    buffer_load_dword v75, v13, s[20:23], s17 offen
    s_waitcnt vmcnt(58)
    v_perm_b32 v5, v17, v16, s44
    v_perm_b32 v6, v17, v16, s45
    s_waitcnt vmcnt(56)
    v_perm_b32 v240, v19, v18, v11
    v_accvgpr_write_b32 a224, v5
    v_accvgpr_write_b32 a228, v6
    s_add_u32 s17, s49, 1146240
    buffer_load_dword v76, v9, s[20:23], s17 offen
    buffer_load_dword v77, v10, s[20:23], s17 offen
    buffer_load_dword v78, v12, s[20:23], s17 offen
    buffer_load_dword v79, v13, s[20:23], s17 offen
    s_waitcnt vmcnt(58)
    v_perm_b32 v5, v21, v20, s44
    v_perm_b32 v6, v21, v20, s45
    s_waitcnt vmcnt(56)
    v_perm_b32 v241, v23, v22, v11
    v_accvgpr_write_b32 a225, v5
    v_accvgpr_write_b32 a229, v6
    s_waitcnt vmcnt(54)
    v_perm_b32 v5, v25, v24, s44
    v_perm_b32 v6, v25, v24, s45
    s_waitcnt vmcnt(52)
    v_perm_b32 v242, v27, v26, v11
    v_accvgpr_write_b32 a226, v5
    v_accvgpr_write_b32 a230, v6
    s_waitcnt vmcnt(50)
    v_perm_b32 v5, v29, v28, s44
    v_perm_b32 v6, v29, v28, s45
    s_waitcnt vmcnt(48)
    v_perm_b32 v243, v31, v30, v11
    v_accvgpr_write_b32 a227, v5
    v_accvgpr_write_b32 a231, v6
    s_waitcnt vmcnt(46)
    v_perm_b32 v5, v33, v32, s44
    v_perm_b32 v6, v33, v32, s45
    s_waitcnt vmcnt(44)
    v_perm_b32 v244, v35, v34, v11
    v_accvgpr_write_b32 a232, v5
    v_accvgpr_write_b32 a236, v6
    s_waitcnt vmcnt(42)
    v_perm_b32 v5, v37, v36, s44
    v_perm_b32 v6, v37, v36, s45
    s_waitcnt vmcnt(40)
    v_perm_b32 v245, v39, v38, v11
    v_accvgpr_write_b32 a233, v5
    v_accvgpr_write_b32 a237, v6
    s_waitcnt vmcnt(38)
    v_perm_b32 v5, v41, v40, s44
    v_perm_b32 v6, v41, v40, s45
    s_waitcnt vmcnt(36)
    v_perm_b32 v246, v43, v42, v11
    v_accvgpr_write_b32 a234, v5
    v_accvgpr_write_b32 a238, v6
    s_waitcnt vmcnt(34)
    v_perm_b32 v5, v45, v44, s44
    v_perm_b32 v6, v45, v44, s45
    s_waitcnt vmcnt(32)
    v_perm_b32 v247, v47, v46, v11
    v_accvgpr_write_b32 a235, v5
    v_accvgpr_write_b32 a239, v6
    s_waitcnt vmcnt(30)
    v_perm_b32 v5, v49, v48, s44
    v_perm_b32 v6, v49, v48, s45
    s_waitcnt vmcnt(28)
    v_perm_b32 v248, v51, v50, v11
    v_accvgpr_write_b32 a240, v5
    v_accvgpr_write_b32 a244, v6
    s_waitcnt vmcnt(26)
    v_perm_b32 v5, v53, v52, s44
    v_perm_b32 v6, v53, v52, s45
    s_waitcnt vmcnt(24)
    v_perm_b32 v249, v55, v54, v11
    v_accvgpr_write_b32 a241, v5
    v_accvgpr_write_b32 a245, v6
    s_waitcnt vmcnt(22)
    v_perm_b32 v5, v57, v56, s44
    v_perm_b32 v6, v57, v56, s45
    s_waitcnt vmcnt(20)
    v_perm_b32 v250, v59, v58, v11
    v_accvgpr_write_b32 a242, v5
    v_accvgpr_write_b32 a246, v6
    s_waitcnt vmcnt(18)
    v_perm_b32 v5, v61, v60, s44
    v_perm_b32 v6, v61, v60, s45
    s_waitcnt vmcnt(16)
    v_perm_b32 v251, v63, v62, v11
    v_accvgpr_write_b32 a243, v5
    v_accvgpr_write_b32 a247, v6
    s_waitcnt vmcnt(14)
    v_perm_b32 v5, v65, v64, s44
    v_perm_b32 v6, v65, v64, s45
    s_waitcnt vmcnt(12)
    v_perm_b32 v252, v67, v66, v11
    v_accvgpr_write_b32 a248, v5
    v_accvgpr_write_b32 a252, v6
    s_waitcnt vmcnt(10)
    v_perm_b32 v5, v69, v68, s44
    v_perm_b32 v6, v69, v68, s45
    s_waitcnt vmcnt(8)
    v_perm_b32 v253, v71, v70, v11
    v_accvgpr_write_b32 a249, v5
    v_accvgpr_write_b32 a253, v6
    s_waitcnt vmcnt(6)
    v_perm_b32 v5, v73, v72, s44
    v_perm_b32 v6, v73, v72, s45
    s_waitcnt vmcnt(4)
    v_perm_b32 v254, v75, v74, v11
    v_accvgpr_write_b32 a250, v5
    v_accvgpr_write_b32 a254, v6
    s_waitcnt vmcnt(2)
    v_perm_b32 v5, v77, v76, s44
    v_perm_b32 v6, v77, v76, s45
    s_waitcnt vmcnt(0)
    v_perm_b32 v255, v79, v78, v11
    v_accvgpr_write_b32 a251, v5
    v_accvgpr_write_b32 a255, v6
    s_and_b32 s51, s14, 1
    s_lshl_b32 s17, s51, 4
    v_add_u32 v5, s17, v7
    v_lshlrev_b32 v14, 4, v5
    v_mul_u32_u24 v13, 1152, v5
    s_mul_i32 s17, s50, 96
    v_add_u32 v13, s17, v13
    s_mul_i32 s17, s50, 3072
    v_add_u32 v12, s17, v14
    s_lshl_b32 s17, s50, 9
    v_add_u32 v14, s17, v14
    s_lshl_b32 s49, s50, 7
    s_lshl_b32 s17, s14, 2
    s_add_u32 s49, s49, s17
    s_add_u32 s49, s49, 1441792
    s_mul_i32 s17, s14, 6144
    v_add_u32 v48, s17, v0
    v_mov_b32 v49, 0x10000
    s_mul_i32 s17, s50, 43
    v_lshrrev_b32 v10, 4, v0
    v_add_u32 v10, s17, v10
    v_min_u32 v10, 511, v10
    v_lshlrev_b32 v10, 7, v10
    s_cmp_gt_u32 s14, 1
    s_cbranch_scc1 Ltw_z
    v_lshl_add_u32 v12, v8, 9, v12
    v_lshl_add_u32 v13, v8, 4, v13
    s_lshl_b32 s58, s14, 16
    s_add_u32 s58, s58, 144703488
    s_mov_b32 s43, 0
    s_mov_b32 s28, s8
    s_mov_b32 s29, s9
    s_mov_b32 s30, 0
    s_mov_b32 s31, 0x00020000
    s_mul_i32 s17, s51, 3072
    v_add_u32 v50, s17, v0
    ds_write2_b32 v49, v4, v4 offset0:0 offset1:1
    s_waitcnt lgkmcnt(0)
    s_cmp_lg_u32 s14, 0
    s_cbranch_scc1 LtwX_inia_d
    v_mov_b32 v5, 40
    s_mov_b32 s16, 0
LtwX_inia:
    global_load_dword v6, v5, s[12:13] sc1
    s_add_u32 s16, s16, 1
    s_cmp_gt_u32 s16, 100000
    s_cbranch_scc1 L_role_tw_abort
    s_waitcnt vmcnt(0)
    v_cmp_gt_u32 vcc, 128, v6
    s_nop 0
    s_cbranch_vccz LtwX_inia_d
    s_sleep 8
    s_branch LtwX_inia
LtwX_inia_d:
    s_barrier
    s_cmp_lg_u32 s14, 0
    s_cbranch_scc1 LtwX_inib_d
    v_mov_b32 v5, 160
    s_mov_b32 s16, 0
LtwX_inib:
    global_load_dword v6, v5, s[12:13] sc1
    s_add_u32 s16, s16, 1
    s_cmp_gt_u32 s16, 100000
    s_cbranch_scc1 L_role_tw_abort
    s_waitcnt vmcnt(0)
    v_cmp_gt_u32 vcc, 64, v6
    s_nop 0
    s_cbranch_vccz LtwX_inib_d
    s_sleep 8
    s_branch LtwX_inib
LtwX_inib_d:
    s_barrier
LtwX_idle:
    s_cmp_lg_u32 s14, 0
    s_cbranch_scc1 LtwX_nw0
    s_mul_i32 s60, s32, 22528
    s_add_u32 s60, s60, 4224
    s_cmp_lt_u32 s32, 64
    s_cselect_b32 s60, s60, 2883584
    s_mul_i32 s61, s33, 22528
    s_add_u32 s61, s61, 1446016
    s_cmp_lt_u32 s33, 64
    s_cselect_b32 s61, s61, 2883584
    s_mov_b32 s16, 0
LtwX_p_9:
    buffer_load_dword v2, v1, s[8:11], s60 offen sc1
    buffer_load_dword v15, v1, s[8:11], s61 offen sc1
    s_add_u32 s16, s16, 1
    s_cmp_gt_u32 s16, 100000
    s_cbranch_scc1 L_role_tw_abort
    s_waitcnt vmcnt(1)
    v_cmp_eq_u32 vcc, 0, v2
    s_waitcnt vmcnt(0)
    v_cmp_eq_u32 s[54:55], 0, v15
    s_nop 0
    s_cmp_eq_u64 s[54:55], 0
    s_cselect_b32 s62, 2, 0
    s_cmp_eq_u64 vcc, 0
    s_cselect_b32 s62, 1, s62
    s_cmp_lg_u32 s62, 0
    s_cbranch_scc1 LtwX_p_9d
    s_sleep 4
    s_branch LtwX_p_9
LtwX_p_9d:
    v_mov_b32 v5, s62
    ds_write_b32 v49, v5
    s_waitcnt lgkmcnt(0)
LtwX_nw0:
    s_barrier
    ds_read_b32 v6, v49
    v_xor_b32 v49, 4, v49
    s_waitcnt lgkmcnt(0)
    v_readfirstlane_b32 s62, v6
    s_nop 0
    s_cmp_eq_u32 s62, 0
    s_cbranch_scc1 L_role_tw_abort
    s_cmp_lt_u32 s33, 29
    s_cselect_b32 s38, 1, 3
    s_cmp_eq_u32 s62, 2
    s_cselect_b32 s36, 1, 0
    s_cselect_b32 s37, s33, s32
    s_cselect_b32 s17, s38, 0
    s_add_u32 s33, s33, s17
    s_cmp_eq_u32 s62, 1
    s_cselect_b32 s17, 2, 0
    s_add_u32 s32, s32, s17
    s_lshl_b32 s56, s36, 6
    s_add_u32 s56, s56, s37
    s_lshl_b32 s46, s56, 18
    s_add_u32 s46, s46, s58
    s_mul_i32 s41, s36, 4718592
    s_mul_i32 s17, s37, 36864
    s_add_u32 s41, s41, s17
    s_add_u32 s41, s41, 8650752
    s_cmp_ge_u32 s37, 64
    s_cbranch_scc1 L_role_tw_abort
    s_add_u32 s48, s46, 0
    buffer_load_dwordx4 v[64:67], v0, s[8:11], s48 offen offset:0
    buffer_load_dwordx4 v[68:71], v0, s[8:11], s48 offen offset:1024
    buffer_load_dwordx4 v[72:75], v0, s[8:11], s48 offen offset:2048
    buffer_load_dwordx4 v[76:79], v0, s[8:11], s48 offen offset:3072
    s_add_u32 s48, s46, 4096
    buffer_load_dwordx4 v[80:83], v0, s[8:11], s48 offen offset:0
    buffer_load_dwordx4 v[84:87], v0, s[8:11], s48 offen offset:1024
    buffer_load_dwordx4 v[88:91], v0, s[8:11], s48 offen offset:2048
    buffer_load_dwordx4 v[92:95], v0, s[8:11], s48 offen offset:3072
    s_add_u32 s48, s46, 8192
    buffer_load_dwordx4 v[96:99], v0, s[8:11], s48 offen offset:0
    buffer_load_dwordx4 v[100:103], v0, s[8:11], s48 offen offset:1024
    buffer_load_dwordx4 v[104:107], v0, s[8:11], s48 offen offset:2048
    buffer_load_dwordx4 v[108:111], v0, s[8:11], s48 offen offset:3072
    s_add_u32 s48, s46, 12288
    buffer_load_dwordx4 v[112:115], v0, s[8:11], s48 offen offset:0
    buffer_load_dwordx4 v[116:119], v0, s[8:11], s48 offen offset:1024
    buffer_load_dwordx4 v[120:123], v0, s[8:11], s48 offen offset:2048
    buffer_load_dwordx4 v[40:43], v12, s[8:11], s41 offen
LtwX_item:
    s_mov_b32 s34, s36
    s_mov_b32 s35, s37
    s_mov_b32 s47, s41
    buffer_load_dwordx4 v[124:127], v0, s[8:11], s48 offen offset:3072
    s_waitcnt vmcnt(16)
    v_mfma_f32_16x16x32_bf16 v[16:19], a[0:3], v[64:67], 0
    v_mfma_f32_16x16x32_bf16 v[20:23], a[4:7], v[64:67], 0
    v_mfma_f32_16x16x32_bf16 v[24:27], v[128:131], v[64:67], 0
    s_add_u32 s48, s46, 16384
    buffer_load_dwordx4 v[64:67], v0, s[8:11], s48 offen offset:0
    s_waitcnt vmcnt(16)
    v_mfma_f32_16x16x32_bf16 v[28:31], a[0:3], v[68:71], 0
    v_mfma_f32_16x16x32_bf16 v[32:35], a[4:7], v[68:71], 0
    v_mfma_f32_16x16x32_bf16 v[36:39], v[128:131], v[68:71], 0
    buffer_load_dwordx4 v[68:71], v0, s[8:11], s48 offen offset:1024
    s_waitcnt vmcnt(16)
    v_mfma_f32_16x16x32_bf16 v[16:19], a[8:11], v[72:75], v[16:19]
    v_mfma_f32_16x16x32_bf16 v[20:23], a[12:15], v[72:75], v[20:23]
    v_mfma_f32_16x16x32_bf16 v[24:27], v[132:135], v[72:75], v[24:27]
    buffer_load_dwordx4 v[72:75], v0, s[8:11], s48 offen offset:2048
    s_waitcnt vmcnt(16)
    v_mfma_f32_16x16x32_bf16 v[28:31], a[8:11], v[76:79], v[28:31]
    v_mfma_f32_16x16x32_bf16 v[32:35], a[12:15], v[76:79], v[32:35]
    v_mfma_f32_16x16x32_bf16 v[36:39], v[132:135], v[76:79], v[36:39]
    buffer_load_dwordx4 v[76:79], v0, s[8:11], s48 offen offset:3072
    s_waitcnt vmcnt(16)
    v_mfma_f32_16x16x32_bf16 v[16:19], a[16:19], v[80:83], v[16:19]
    v_mfma_f32_16x16x32_bf16 v[20:23], a[20:23], v[80:83], v[20:23]
    v_mfma_f32_16x16x32_bf16 v[24:27], v[136:139], v[80:83], v[24:27]
    s_add_u32 s48, s46, 20480
    buffer_load_dwordx4 v[80:83], v0, s[8:11], s48 offen offset:0
    s_waitcnt vmcnt(16)
    v_mfma_f32_16x16x32_bf16 v[28:31], a[16:19], v[84:87], v[28:31]
    v_mfma_f32_16x16x32_bf16 v[32:35], a[20:23], v[84:87], v[32:35]
    v_mfma_f32_16x16x32_bf16 v[36:39], v[136:139], v[84:87], v[36:39]
    buffer_load_dwordx4 v[84:87], v0, s[8:11], s48 offen offset:1024
    s_waitcnt vmcnt(16)
    v_mfma_f32_16x16x32_bf16 v[16:19], a[24:27], v[88:91], v[16:19]
    v_mfma_f32_16x16x32_bf16 v[20:23], a[28:31], v[88:91], v[20:23]
    v_mfma_f32_16x16x32_bf16 v[24:27], v[140:143], v[88:91], v[24:27]
    buffer_load_dwordx4 v[88:91], v0, s[8:11], s48 offen offset:2048
    s_waitcnt vmcnt(16)
    v_mfma_f32_16x16x32_bf16 v[28:31], a[24:27], v[92:95], v[28:31]
    v_mfma_f32_16x16x32_bf16 v[32:35], a[28:31], v[92:95], v[32:35]
    v_mfma_f32_16x16x32_bf16 v[36:39], v[140:143], v[92:95], v[36:39]
    buffer_load_dwordx4 v[92:95], v0, s[8:11], s48 offen offset:3072
    s_waitcnt vmcnt(16)
    v_mfma_f32_16x16x32_bf16 v[16:19], a[32:35], v[96:99], v[16:19]
    v_mfma_f32_16x16x32_bf16 v[20:23], a[36:39], v[96:99], v[20:23]
    v_mfma_f32_16x16x32_bf16 v[24:27], v[144:147], v[96:99], v[24:27]
    s_add_u32 s48, s46, 24576
    buffer_load_dwordx4 v[96:99], v0, s[8:11], s48 offen offset:0
    s_waitcnt vmcnt(16)
    v_mfma_f32_16x16x32_bf16 v[28:31], a[32:35], v[100:103], v[28:31]
    v_mfma_f32_16x16x32_bf16 v[32:35], a[36:39], v[100:103], v[32:35]
    v_mfma_f32_16x16x32_bf16 v[36:39], v[144:147], v[100:103], v[36:39]
    buffer_load_dwordx4 v[100:103], v0, s[8:11], s48 offen offset:1024
    s_waitcnt vmcnt(16)
    v_mfma_f32_16x16x32_bf16 v[16:19], a[40:43], v[104:107], v[16:19]
    v_mfma_f32_16x16x32_bf16 v[20:23], a[44:47], v[104:107], v[20:23]
    v_mfma_f32_16x16x32_bf16 v[24:27], v[148:151], v[104:107], v[24:27]
    buffer_load_dwordx4 v[104:107], v0, s[8:11], s48 offen offset:2048
    s_waitcnt vmcnt(16)
    v_mfma_f32_16x16x32_bf16 v[28:31], a[40:43], v[108:111], v[28:31]
    v_mfma_f32_16x16x32_bf16 v[32:35], a[44:47], v[108:111], v[32:35]
    v_mfma_f32_16x16x32_bf16 v[36:39], v[148:151], v[108:111], v[36:39]
    buffer_load_dwordx4 v[108:111], v0, s[8:11], s48 offen offset:3072
    s_waitcnt vmcnt(16)
    v_mfma_f32_16x16x32_bf16 v[16:19], a[48:51], v[112:115], v[16:19]
    v_mfma_f32_16x16x32_bf16 v[20:23], a[52:55], v[112:115], v[20:23]
    v_mfma_f32_16x16x32_bf16 v[24:27], v[152:155], v[112:115], v[24:27]
    s_add_u32 s48, s46, 28672
    buffer_load_dwordx4 v[112:115], v0, s[8:11], s48 offen offset:0
    s_waitcnt vmcnt(16)
    v_mfma_f32_16x16x32_bf16 v[28:31], a[48:51], v[116:119], v[28:31]
    v_mfma_f32_16x16x32_bf16 v[32:35], a[52:55], v[116:119], v[32:35]
    v_mfma_f32_16x16x32_bf16 v[36:39], v[152:155], v[116:119], v[36:39]
    buffer_load_dwordx4 v[116:119], v0, s[8:11], s48 offen offset:1024
    s_waitcnt vmcnt(16)
    v_mfma_f32_16x16x32_bf16 v[16:19], a[56:59], v[120:123], v[16:19]
    v_mfma_f32_16x16x32_bf16 v[20:23], a[60:63], v[120:123], v[20:23]
    v_mfma_f32_16x16x32_bf16 v[24:27], v[156:159], v[120:123], v[24:27]
    buffer_load_dwordx4 v[120:123], v0, s[8:11], s48 offen offset:2048
    s_waitcnt vmcnt(15)
    v_mfma_f32_16x16x32_bf16 v[28:31], a[56:59], v[124:127], v[28:31]
    v_mfma_f32_16x16x32_bf16 v[32:35], a[60:63], v[124:127], v[32:35]
    v_mfma_f32_16x16x32_bf16 v[36:39], v[156:159], v[124:127], v[36:39]
    buffer_load_dwordx4 v[124:127], v0, s[8:11], s48 offen offset:3072
    s_waitcnt vmcnt(15)
    v_mfma_f32_16x16x32_bf16 v[16:19], a[64:67], v[64:67], v[16:19]
    v_mfma_f32_16x16x32_bf16 v[20:23], a[68:71], v[64:67], v[20:23]
    v_mfma_f32_16x16x32_bf16 v[24:27], v[160:163], v[64:67], v[24:27]
    s_add_u32 s48, s46, 32768
    buffer_load_dwordx4 v[64:67], v0, s[8:11], s48 offen offset:0
    s_waitcnt vmcnt(15)
    v_mfma_f32_16x16x32_bf16 v[28:31], a[64:67], v[68:71], v[28:31]
    v_mfma_f32_16x16x32_bf16 v[32:35], a[68:71], v[68:71], v[32:35]
    v_mfma_f32_16x16x32_bf16 v[36:39], v[160:163], v[68:71], v[36:39]
    s_cmp_lg_u32 s43, 0
    s_cselect_b64 exec, 1, 0
    buffer_store_dword v3, v4, s[8:11], s43 offen sc1
    s_mov_b64 exec, -1
    s_mov_b32 s43, 0
    buffer_load_dwordx4 v[68:71], v0, s[8:11], s48 offen offset:1024
    s_waitcnt vmcnt(16)
    v_mfma_f32_16x16x32_bf16 v[16:19], a[72:75], v[72:75], v[16:19]
    v_mfma_f32_16x16x32_bf16 v[20:23], a[76:79], v[72:75], v[20:23]
    v_mfma_f32_16x16x32_bf16 v[24:27], v[164:167], v[72:75], v[24:27]
    buffer_load_dwordx4 v[72:75], v0, s[8:11], s48 offen offset:2048
    s_waitcnt vmcnt(16)
    v_mfma_f32_16x16x32_bf16 v[28:31], a[72:75], v[76:79], v[28:31]
    v_mfma_f32_16x16x32_bf16 v[32:35], a[76:79], v[76:79], v[32:35]
    v_mfma_f32_16x16x32_bf16 v[36:39], v[164:167], v[76:79], v[36:39]
    buffer_load_dwordx4 v[76:79], v0, s[8:11], s48 offen offset:3072
    s_waitcnt vmcnt(16)
    v_mfma_f32_16x16x32_bf16 v[16:19], a[80:83], v[80:83], v[16:19]
    v_mfma_f32_16x16x32_bf16 v[20:23], a[84:87], v[80:83], v[20:23]
    v_mfma_f32_16x16x32_bf16 v[24:27], v[168:171], v[80:83], v[24:27]
    s_add_u32 s48, s46, 36864
    buffer_load_dwordx4 v[80:83], v0, s[8:11], s48 offen offset:0
    s_waitcnt vmcnt(16)
    v_mfma_f32_16x16x32_bf16 v[28:31], a[80:83], v[84:87], v[28:31]
    v_mfma_f32_16x16x32_bf16 v[32:35], a[84:87], v[84:87], v[32:35]
    v_mfma_f32_16x16x32_bf16 v[36:39], v[168:171], v[84:87], v[36:39]
    buffer_load_dwordx4 v[84:87], v0, s[8:11], s48 offen offset:1024
    s_waitcnt vmcnt(16)
    v_mfma_f32_16x16x32_bf16 v[16:19], a[88:91], v[88:91], v[16:19]
    v_mfma_f32_16x16x32_bf16 v[20:23], a[92:95], v[88:91], v[20:23]
    v_mfma_f32_16x16x32_bf16 v[24:27], v[172:175], v[88:91], v[24:27]
    buffer_load_dwordx4 v[88:91], v0, s[8:11], s48 offen offset:2048
    s_waitcnt vmcnt(16)
    v_mfma_f32_16x16x32_bf16 v[28:31], a[88:91], v[92:95], v[28:31]
    v_mfma_f32_16x16x32_bf16 v[32:35], a[92:95], v[92:95], v[32:35]
    v_mfma_f32_16x16x32_bf16 v[36:39], v[172:175], v[92:95], v[36:39]
    buffer_load_dwordx4 v[92:95], v0, s[8:11], s48 offen offset:3072
    s_waitcnt vmcnt(16)
    v_mfma_f32_16x16x32_bf16 v[16:19], a[96:99], v[96:99], v[16:19]
    v_mfma_f32_16x16x32_bf16 v[20:23], a[100:103], v[96:99], v[20:23]
    v_mfma_f32_16x16x32_bf16 v[24:27], v[176:179], v[96:99], v[24:27]
    s_add_u32 s48, s46, 40960
    buffer_load_dwordx4 v[96:99], v0, s[8:11], s48 offen offset:0
    s_waitcnt vmcnt(16)
    v_mfma_f32_16x16x32_bf16 v[28:31], a[96:99], v[100:103], v[28:31]
    v_mfma_f32_16x16x32_bf16 v[32:35], a[100:103], v[100:103], v[32:35]
    v_mfma_f32_16x16x32_bf16 v[36:39], v[176:179], v[100:103], v[36:39]
    buffer_load_dwordx4 v[100:103], v0, s[8:11], s48 offen offset:1024
    s_waitcnt vmcnt(16)
    v_mfma_f32_16x16x32_bf16 v[16:19], a[104:107], v[104:107], v[16:19]
    v_mfma_f32_16x16x32_bf16 v[20:23], a[108:111], v[104:107], v[20:23]
    v_mfma_f32_16x16x32_bf16 v[24:27], v[180:183], v[104:107], v[24:27]
    s_cmp_lg_u32 s14, 0
    s_cbranch_scc1 LtwX_nw1
    s_mul_i32 s60, s32, 22528
    s_add_u32 s60, s60, 4224
    s_cmp_lt_u32 s32, 64
    s_cselect_b32 s60, s60, 2883584
    s_mul_i32 s61, s33, 22528
    s_add_u32 s61, s61, 1446016
    s_cmp_lt_u32 s33, 64
    s_cselect_b32 s61, s61, 2883584
    buffer_load_dword v2, v1, s[8:11], s60 offen sc1
    buffer_load_dword v15, v1, s[8:11], s61 offen sc1
LtwX_nw1:
    buffer_load_dwordx4 v[104:107], v0, s[8:11], s48 offen offset:2048
    s_waitcnt vmcnt(16)
    v_mfma_f32_16x16x32_bf16 v[28:31], a[104:107], v[108:111], v[28:31]
    v_mfma_f32_16x16x32_bf16 v[32:35], a[108:111], v[108:111], v[32:35]
    v_mfma_f32_16x16x32_bf16 v[36:39], v[180:183], v[108:111], v[36:39]
    buffer_load_dwordx4 v[108:111], v0, s[8:11], s48 offen offset:3072
    s_waitcnt vmcnt(16)
    v_mfma_f32_16x16x32_bf16 v[16:19], a[112:115], v[112:115], v[16:19]
    v_mfma_f32_16x16x32_bf16 v[20:23], a[116:119], v[112:115], v[20:23]
    v_mfma_f32_16x16x32_bf16 v[24:27], v[184:187], v[112:115], v[24:27]
    s_add_u32 s48, s46, 45056
    buffer_load_dwordx4 v[112:115], v0, s[8:11], s48 offen offset:0
    s_waitcnt vmcnt(16)
    v_mfma_f32_16x16x32_bf16 v[28:31], a[112:115], v[116:119], v[28:31]
    v_mfma_f32_16x16x32_bf16 v[32:35], a[116:119], v[116:119], v[32:35]
    v_mfma_f32_16x16x32_bf16 v[36:39], v[184:187], v[116:119], v[36:39]
    buffer_load_dwordx4 v[116:119], v0, s[8:11], s48 offen offset:1024
    s_waitcnt vmcnt(16)
    v_mfma_f32_16x16x32_bf16 v[16:19], a[120:123], v[120:123], v[16:19]
    v_mfma_f32_16x16x32_bf16 v[20:23], a[124:127], v[120:123], v[20:23]
    v_mfma_f32_16x16x32_bf16 v[24:27], v[188:191], v[120:123], v[24:27]
    buffer_load_dwordx4 v[120:123], v0, s[8:11], s48 offen offset:2048
    s_waitcnt vmcnt(16)
    v_mfma_f32_16x16x32_bf16 v[28:31], a[120:123], v[124:127], v[28:31]
    v_mfma_f32_16x16x32_bf16 v[32:35], a[124:127], v[124:127], v[32:35]
    v_mfma_f32_16x16x32_bf16 v[36:39], v[188:191], v[124:127], v[36:39]
    buffer_load_dwordx4 v[124:127], v0, s[8:11], s48 offen offset:3072
    s_waitcnt vmcnt(16)
    v_mfma_f32_16x16x32_bf16 v[16:19], a[128:131], v[64:67], v[16:19]
    v_mfma_f32_16x16x32_bf16 v[20:23], a[132:135], v[64:67], v[20:23]
    v_mfma_f32_16x16x32_bf16 v[24:27], v[192:195], v[64:67], v[24:27]
    s_add_u32 s48, s46, 49152
    buffer_load_dwordx4 v[64:67], v0, s[8:11], s48 offen offset:0
    s_waitcnt vmcnt(15)
    v_mfma_f32_16x16x32_bf16 v[28:31], a[128:131], v[68:71], v[28:31]
    v_mfma_f32_16x16x32_bf16 v[32:35], a[132:135], v[68:71], v[32:35]
    v_mfma_f32_16x16x32_bf16 v[36:39], v[192:195], v[68:71], v[36:39]
    buffer_load_dwordx4 v[68:71], v0, s[8:11], s48 offen offset:1024
    s_waitcnt vmcnt(15)
    v_mfma_f32_16x16x32_bf16 v[16:19], a[136:139], v[72:75], v[16:19]
    v_mfma_f32_16x16x32_bf16 v[20:23], a[140:143], v[72:75], v[20:23]
    v_mfma_f32_16x16x32_bf16 v[24:27], v[196:199], v[72:75], v[24:27]
    buffer_load_dwordx4 v[72:75], v0, s[8:11], s48 offen offset:2048
    s_waitcnt vmcnt(15)
    v_mfma_f32_16x16x32_bf16 v[28:31], a[136:139], v[76:79], v[28:31]
    v_mfma_f32_16x16x32_bf16 v[32:35], a[140:143], v[76:79], v[32:35]
    v_mfma_f32_16x16x32_bf16 v[36:39], v[196:199], v[76:79], v[36:39]
    buffer_load_dwordx4 v[76:79], v0, s[8:11], s48 offen offset:3072
    s_waitcnt vmcnt(15)
    v_mfma_f32_16x16x32_bf16 v[16:19], a[144:147], v[80:83], v[16:19]
    v_mfma_f32_16x16x32_bf16 v[20:23], a[148:151], v[80:83], v[20:23]
    v_mfma_f32_16x16x32_bf16 v[24:27], v[200:203], v[80:83], v[24:27]
    s_add_u32 s48, s46, 53248
    buffer_load_dwordx4 v[80:83], v0, s[8:11], s48 offen offset:0
    s_waitcnt vmcnt(15)
    v_mfma_f32_16x16x32_bf16 v[28:31], a[144:147], v[84:87], v[28:31]
    v_mfma_f32_16x16x32_bf16 v[32:35], a[148:151], v[84:87], v[32:35]
    v_mfma_f32_16x16x32_bf16 v[36:39], v[200:203], v[84:87], v[36:39]
    buffer_load_dwordx4 v[84:87], v0, s[8:11], s48 offen offset:1024
    s_waitcnt vmcnt(15)
    v_mfma_f32_16x16x32_bf16 v[16:19], a[152:155], v[88:91], v[16:19]
    v_mfma_f32_16x16x32_bf16 v[20:23], a[156:159], v[88:91], v[20:23]
    v_mfma_f32_16x16x32_bf16 v[24:27], v[204:207], v[88:91], v[24:27]
    buffer_load_dwordx4 v[88:91], v0, s[8:11], s48 offen offset:2048
    s_waitcnt vmcnt(15)
    v_mfma_f32_16x16x32_bf16 v[28:31], a[152:155], v[92:95], v[28:31]
    v_mfma_f32_16x16x32_bf16 v[32:35], a[156:159], v[92:95], v[32:35]
    v_mfma_f32_16x16x32_bf16 v[36:39], v[204:207], v[92:95], v[36:39]
    buffer_load_dwordx4 v[92:95], v0, s[8:11], s48 offen offset:3072
    s_waitcnt vmcnt(15)
    v_mfma_f32_16x16x32_bf16 v[16:19], a[160:163], v[96:99], v[16:19]
    v_mfma_f32_16x16x32_bf16 v[20:23], a[164:167], v[96:99], v[20:23]
    v_mfma_f32_16x16x32_bf16 v[24:27], v[208:211], v[96:99], v[24:27]
    s_add_u32 s48, s46, 57344
    buffer_load_dwordx4 v[96:99], v0, s[8:11], s48 offen offset:0
    s_waitcnt vmcnt(15)
    v_mfma_f32_16x16x32_bf16 v[28:31], a[160:163], v[100:103], v[28:31]
    v_mfma_f32_16x16x32_bf16 v[32:35], a[164:167], v[100:103], v[32:35]
    v_mfma_f32_16x16x32_bf16 v[36:39], v[208:211], v[100:103], v[36:39]
    buffer_load_dwordx4 v[100:103], v0, s[8:11], s48 offen offset:1024
    s_waitcnt vmcnt(15)
    v_mfma_f32_16x16x32_bf16 v[16:19], a[168:171], v[104:107], v[16:19]
    v_mfma_f32_16x16x32_bf16 v[20:23], a[172:175], v[104:107], v[20:23]
    v_mfma_f32_16x16x32_bf16 v[24:27], v[212:215], v[104:107], v[24:27]
    buffer_load_dwordx4 v[104:107], v0, s[8:11], s48 offen offset:2048
    s_waitcnt vmcnt(15)
    v_mfma_f32_16x16x32_bf16 v[28:31], a[168:171], v[108:111], v[28:31]
    v_mfma_f32_16x16x32_bf16 v[32:35], a[172:175], v[108:111], v[32:35]
    v_mfma_f32_16x16x32_bf16 v[36:39], v[212:215], v[108:111], v[36:39]
    buffer_load_dwordx4 v[108:111], v0, s[8:11], s48 offen offset:3072
    s_waitcnt vmcnt(15)
    v_mfma_f32_16x16x32_bf16 v[16:19], a[176:179], v[112:115], v[16:19]
    v_mfma_f32_16x16x32_bf16 v[20:23], a[180:183], v[112:115], v[20:23]
    v_mfma_f32_16x16x32_bf16 v[24:27], v[216:219], v[112:115], v[24:27]
    s_cmp_lg_u32 s14, 0
    s_cbranch_scc1 LtwX_nw2
    v_cmp_eq_u32 vcc, 0, v2
    v_cmp_eq_u32 s[54:55], 0, v15
    s_nop 0
    s_cmp_eq_u64 s[54:55], 0
    s_cselect_b32 s62, 2, 0
    s_cmp_eq_u64 vcc, 0
    s_cselect_b32 s62, 1, s62
    v_mov_b32 v5, s62
    ds_write_b32 v49, v5
    s_waitcnt lgkmcnt(0)
LtwX_nw2:
    s_barrier
    ds_read_b32 v6, v49
    v_xor_b32 v49, 4, v49
    s_add_u32 s48, s46, 61440
    buffer_load_dwordx4 v[112:115], v0, s[8:11], s48 offen offset:0
    s_waitcnt vmcnt(15)
    v_mfma_f32_16x16x32_bf16 v[28:31], a[176:179], v[116:119], v[28:31]
    v_mfma_f32_16x16x32_bf16 v[32:35], a[180:183], v[116:119], v[32:35]
    v_mfma_f32_16x16x32_bf16 v[36:39], v[216:219], v[116:119], v[36:39]
    buffer_load_dwordx4 v[116:119], v0, s[8:11], s48 offen offset:1024
    s_waitcnt vmcnt(15)
    v_mfma_f32_16x16x32_bf16 v[16:19], a[184:187], v[120:123], v[16:19]
    v_mfma_f32_16x16x32_bf16 v[20:23], a[188:191], v[120:123], v[20:23]
    v_mfma_f32_16x16x32_bf16 v[24:27], v[220:223], v[120:123], v[24:27]
    buffer_load_dwordx4 v[120:123], v0, s[8:11], s48 offen offset:2048
    s_waitcnt vmcnt(15)
    v_mfma_f32_16x16x32_bf16 v[28:31], a[184:187], v[124:127], v[28:31]
    v_mfma_f32_16x16x32_bf16 v[32:35], a[188:191], v[124:127], v[32:35]
    v_mfma_f32_16x16x32_bf16 v[36:39], v[220:223], v[124:127], v[36:39]
    s_waitcnt lgkmcnt(0)
    v_readfirstlane_b32 s62, v6
    s_cmp_lt_u32 s33, 29
    s_cselect_b32 s38, 1, 3
    s_cmp_eq_u32 s62, 2
    s_cselect_b32 s36, 1, 0
    s_cselect_b32 s37, s33, s32
    s_cselect_b32 s17, s38, 0
    s_add_u32 s33, s33, s17
    s_cmp_eq_u32 s62, 1
    s_cselect_b32 s17, 2, 0
    s_add_u32 s32, s32, s17
    s_lshl_b32 s56, s36, 6
    s_add_u32 s56, s56, s37
    buffer_load_dwordx4 v[124:127], v0, s[8:11], s48 offen offset:3072
    s_waitcnt vmcnt(15)
    v_mfma_f32_16x16x32_bf16 v[16:19], a[192:195], v[64:67], v[16:19]
    v_mfma_f32_16x16x32_bf16 v[20:23], a[196:199], v[64:67], v[20:23]
    v_mfma_f32_16x16x32_bf16 v[24:27], v[224:227], v[64:67], v[24:27]
    s_cmp_lt_u32 s37, 64
    s_cselect_b32 s62, s62, 0
    s_lshl_b32 s46, s56, 18
    s_add_u32 s46, s46, s58
    s_mul_i32 s41, s36, 4718592
    s_mul_i32 s17, s37, 36864
    s_add_u32 s41, s41, s17
    s_add_u32 s41, s41, 8650752
    s_cmp_lg_u32 s62, 0
    s_cselect_b32 s30, 268435456, 0
    s_add_u32 s48, s46, 0
    buffer_load_dwordx4 v[64:67], v0, s[28:31], s48 offen offset:0
    s_waitcnt vmcnt(15)
    v_mfma_f32_16x16x32_bf16 v[28:31], a[192:195], v[68:71], v[28:31]
    v_mfma_f32_16x16x32_bf16 v[32:35], a[196:199], v[68:71], v[32:35]
    v_mfma_f32_16x16x32_bf16 v[36:39], v[224:227], v[68:71], v[36:39]
    buffer_load_dwordx4 v[68:71], v0, s[28:31], s48 offen offset:1024
    s_waitcnt vmcnt(15)
    v_mfma_f32_16x16x32_bf16 v[16:19], a[200:203], v[72:75], v[16:19]
    v_mfma_f32_16x16x32_bf16 v[20:23], a[204:207], v[72:75], v[20:23]
    v_mfma_f32_16x16x32_bf16 v[24:27], v[228:231], v[72:75], v[24:27]
    buffer_load_dwordx4 v[72:75], v0, s[28:31], s48 offen offset:2048
    s_waitcnt vmcnt(15)
    v_mfma_f32_16x16x32_bf16 v[28:31], a[200:203], v[76:79], v[28:31]
    v_mfma_f32_16x16x32_bf16 v[32:35], a[204:207], v[76:79], v[32:35]
    v_mfma_f32_16x16x32_bf16 v[36:39], v[228:231], v[76:79], v[36:39]
    buffer_load_dwordx4 v[76:79], v0, s[28:31], s48 offen offset:3072
    s_waitcnt vmcnt(15)
    v_mfma_f32_16x16x32_bf16 v[16:19], a[208:211], v[80:83], v[16:19]
    v_mfma_f32_16x16x32_bf16 v[20:23], a[212:215], v[80:83], v[20:23]
    v_mfma_f32_16x16x32_bf16 v[24:27], v[232:235], v[80:83], v[24:27]
    s_add_u32 s48, s46, 4096
    buffer_load_dwordx4 v[80:83], v0, s[28:31], s48 offen offset:0
    s_waitcnt vmcnt(15)
    v_mfma_f32_16x16x32_bf16 v[28:31], a[208:211], v[84:87], v[28:31]
    v_mfma_f32_16x16x32_bf16 v[32:35], a[212:215], v[84:87], v[32:35]
    v_mfma_f32_16x16x32_bf16 v[36:39], v[232:235], v[84:87], v[36:39]
    buffer_load_dwordx4 v[84:87], v0, s[28:31], s48 offen offset:1024
    s_waitcnt vmcnt(15)
    v_mfma_f32_16x16x32_bf16 v[16:19], a[216:219], v[88:91], v[16:19]
    v_mfma_f32_16x16x32_bf16 v[20:23], a[220:223], v[88:91], v[20:23]
    v_mfma_f32_16x16x32_bf16 v[24:27], v[236:239], v[88:91], v[24:27]
    buffer_load_dwordx4 v[88:91], v0, s[28:31], s48 offen offset:2048
    s_waitcnt vmcnt(15)
    v_mfma_f32_16x16x32_bf16 v[28:31], a[216:219], v[92:95], v[28:31]
    v_mfma_f32_16x16x32_bf16 v[32:35], a[220:223], v[92:95], v[32:35]
    v_mfma_f32_16x16x32_bf16 v[36:39], v[236:239], v[92:95], v[36:39]
    buffer_load_dwordx4 v[92:95], v0, s[28:31], s48 offen offset:3072
    s_waitcnt vmcnt(15)
    v_mfma_f32_16x16x32_bf16 v[16:19], a[224:227], v[96:99], v[16:19]
    v_mfma_f32_16x16x32_bf16 v[20:23], a[228:231], v[96:99], v[20:23]
    v_mfma_f32_16x16x32_bf16 v[24:27], v[240:243], v[96:99], v[24:27]
    s_add_u32 s48, s46, 8192
    buffer_load_dwordx4 v[96:99], v0, s[28:31], s48 offen offset:0
    s_waitcnt vmcnt(15)
    v_mfma_f32_16x16x32_bf16 v[28:31], a[224:227], v[100:103], v[28:31]
    v_mfma_f32_16x16x32_bf16 v[32:35], a[228:231], v[100:103], v[32:35]
    v_mfma_f32_16x16x32_bf16 v[36:39], v[240:243], v[100:103], v[36:39]
    buffer_load_dwordx4 v[100:103], v0, s[28:31], s48 offen offset:1024
    s_waitcnt vmcnt(15)
    v_mfma_f32_16x16x32_bf16 v[16:19], a[232:235], v[104:107], v[16:19]
    v_mfma_f32_16x16x32_bf16 v[20:23], a[236:239], v[104:107], v[20:23]
    v_mfma_f32_16x16x32_bf16 v[24:27], v[244:247], v[104:107], v[24:27]
    buffer_load_dwordx4 v[104:107], v0, s[28:31], s48 offen offset:2048
    s_waitcnt vmcnt(15)
    v_mfma_f32_16x16x32_bf16 v[28:31], a[232:235], v[108:111], v[28:31]
    v_mfma_f32_16x16x32_bf16 v[32:35], a[236:239], v[108:111], v[32:35]
    v_mfma_f32_16x16x32_bf16 v[36:39], v[244:247], v[108:111], v[36:39]
    buffer_load_dwordx4 v[108:111], v0, s[28:31], s48 offen offset:3072
    s_waitcnt vmcnt(15)
    v_mfma_f32_16x16x32_bf16 v[16:19], a[240:243], v[112:115], v[16:19]
    v_mfma_f32_16x16x32_bf16 v[20:23], a[244:247], v[112:115], v[20:23]
    v_mfma_f32_16x16x32_bf16 v[24:27], v[248:251], v[112:115], v[24:27]
    s_add_u32 s48, s46, 12288
    buffer_load_dwordx4 v[112:115], v0, s[28:31], s48 offen offset:0
    s_waitcnt vmcnt(15)
    v_mfma_f32_16x16x32_bf16 v[28:31], a[240:243], v[116:119], v[28:31]
    v_mfma_f32_16x16x32_bf16 v[32:35], a[244:247], v[116:119], v[32:35]
    v_mfma_f32_16x16x32_bf16 v[36:39], v[248:251], v[116:119], v[36:39]
    buffer_load_dwordx4 v[116:119], v0, s[28:31], s48 offen offset:1024
    s_waitcnt vmcnt(15)
    v_mfma_f32_16x16x32_bf16 v[16:19], a[248:251], v[120:123], v[16:19]
    v_mfma_f32_16x16x32_bf16 v[20:23], a[252:255], v[120:123], v[20:23]
    v_mfma_f32_16x16x32_bf16 v[24:27], v[252:255], v[120:123], v[24:27]
    buffer_load_dwordx4 v[120:123], v0, s[28:31], s48 offen offset:2048
    s_waitcnt vmcnt(15)
    v_mfma_f32_16x16x32_bf16 v[28:31], a[248:251], v[124:127], v[28:31]
    v_mfma_f32_16x16x32_bf16 v[32:35], a[252:255], v[124:127], v[32:35]
    v_mfma_f32_16x16x32_bf16 v[36:39], v[252:255], v[124:127], v[36:39]
    s_nop 5
    ds_write_b128 v48, v[16:19] offset:0
    ds_write_b128 v48, v[20:23] offset:1024
    ds_write_b128 v48, v[24:27] offset:2048
    ds_write_b128 v48, v[28:31] offset:3072
    ds_write_b128 v48, v[32:35] offset:4096
    ds_write_b128 v48, v[36:39] offset:5120
    s_waitcnt lgkmcnt(0)
    s_barrier
    ds_read_b128 v[24:27], v50 offset:0
    ds_read_b128 v[28:31], v50 offset:1024
    ds_read_b128 v[32:35], v50 offset:6144
    ds_read_b128 v[36:39], v50 offset:7168
    ds_read_b128 v[56:59], v50 offset:12288
    ds_read_b128 v[60:63], v50 offset:13312
    ds_read_b128 v[124:127], v50 offset:18432
    ds_read_b128 v[52:55], v50 offset:19456
    v_xor_b32 v48, 0x8000, v48
    v_xor_b32 v50, 0x8000, v50
    v_lshlrev_b32 v16, 16, v40
    v_and_b32 v20, 0xffff0000, v40
    v_lshlrev_b32 v17, 16, v41
    v_and_b32 v21, 0xffff0000, v41
    v_lshlrev_b32 v18, 16, v42
    v_and_b32 v22, 0xffff0000, v42
    v_lshlrev_b32 v19, 16, v43
    v_and_b32 v23, 0xffff0000, v43
    buffer_load_dwordx4 v[40:43], v12, s[28:31], s41 offen
    s_waitcnt lgkmcnt(7)
    v_add_f32 v16, v16, v24
    v_add_f32 v17, v17, v25
    v_add_f32 v18, v18, v26
    v_add_f32 v19, v19, v27
    s_waitcnt lgkmcnt(6)
    v_add_f32 v20, v20, v28
    v_add_f32 v21, v21, v29
    v_add_f32 v22, v22, v30
    v_add_f32 v23, v23, v31
    s_waitcnt lgkmcnt(5)
    v_add_f32 v16, v16, v32
    v_add_f32 v17, v17, v33
    v_add_f32 v18, v18, v34
    v_add_f32 v19, v19, v35
    s_waitcnt lgkmcnt(4)
    v_add_f32 v20, v20, v36
    v_add_f32 v21, v21, v37
    v_add_f32 v22, v22, v38
    v_add_f32 v23, v23, v39
    s_waitcnt lgkmcnt(3)
    v_add_f32 v16, v16, v56
    v_add_f32 v17, v17, v57
    v_add_f32 v18, v18, v58
    v_add_f32 v19, v19, v59
    s_waitcnt lgkmcnt(2)
    v_add_f32 v20, v20, v60
    v_add_f32 v21, v21, v61
    v_add_f32 v22, v22, v62
    v_add_f32 v23, v23, v63
    s_waitcnt lgkmcnt(1)
    v_add_f32 v16, v16, v124
    v_add_f32 v17, v17, v125
    v_add_f32 v18, v18, v126
    v_add_f32 v19, v19, v127
    s_waitcnt lgkmcnt(0)
    v_add_f32 v20, v20, v52
    v_add_f32 v21, v21, v53
    v_add_f32 v22, v22, v54
    v_add_f32 v23, v23, v55
    v_cvt_pk_bf16_f32 v52, v16, v20
    v_cvt_pk_bf16_f32 v53, v17, v21
    v_cvt_pk_bf16_f32 v54, v18, v22
    v_cvt_pk_bf16_f32 v55, v19, v23
    s_cmp_eq_u32 s34, 0
    s_cbranch_scc1 LtwX_l0
    s_mul_i32 s17, s35, 36864
    buffer_store_dwordx4 v[52:55], v13, s[24:27], s17 offen sc1
    s_cmp_lg_u32 s62, 0
    s_cbranch_scc1 LtwX_item
LtwX_chk:
    s_min_u32 s17, s32, s33
    s_cmp_lt_u32 s17, 64
    s_cbranch_scc1 LtwX_idle
    s_branch L_role_tw_exit
LtwX_l0:
    s_add_u32 s47, s47, 2359296
    buffer_store_dwordx4 v[52:55], v12, s[8:11], s47 offen sc1
    v_add_f32 v44, v16, v17
    v_mul_f32 v45, v16, v16
    v_fmac_f32 v45, v17, v17
    v_add_f32 v44, v44, v18
    v_fmac_f32 v45, v18, v18
    v_add_f32 v44, v44, v19
    v_fmac_f32 v45, v19, v19
    v_add_f32 v44, v44, v20
    v_fmac_f32 v45, v20, v20
    v_add_f32 v44, v44, v21
    v_fmac_f32 v45, v21, v21
    v_add_f32 v44, v44, v22
    v_fmac_f32 v45, v22, v22
    v_add_f32 v44, v44, v23
    v_fmac_f32 v45, v23, v23
    v_mov_b32 v46, v44
    v_mov_b32 v47, v45
    s_nop 0
    v_permlane32_swap_b32 v44, v46
    v_permlane32_swap_b32 v45, v47
    v_add_f32 v44, v44, v46
    v_add_f32 v45, v45, v47
    v_mov_b32 v46, v44
    v_mov_b32 v47, v45
    s_nop 0
    v_permlane16_swap_b32 v44, v46
    v_permlane16_swap_b32 v45, v47
    v_add_f32 v44, v44, v46
    v_add_f32 v45, v45, v47
    s_mul_i32 s17, s35, 6144
    s_add_u32 s17, s17, 16515072
    s_mov_b64 exec, 0xffff
    buffer_store_dwordx2 v[44:45], v14, s[8:11], s17 offen sc1
    s_mov_b64 exec, -1
    s_mul_i32 s43, s35, 22528
    s_add_u32 s43, s43, s49
    s_cmp_lg_u32 s62, 0
    s_cbranch_scc1 LtwX_item
    s_waitcnt vmcnt(0)
    s_mov_b64 exec, 1
    buffer_store_dword v3, v4, s[8:11], s43 offen sc1
    s_mov_b64 exec, -1
    s_mov_b32 s43, 0
    s_branch LtwX_chk
Ltw_z:
    v_lshrrev_b32 v5, 1, v8
    v_lshl_add_u32 v12, v5, 9, v12
    v_and_b32 v5, 1, v8
    v_lshl_add_u32 v12, v5, 3, v12
    v_add_u32 v12, 2048, v12
    v_lshl_add_u32 v13, v8, 3, v13
    v_add_u32 v13, 64, v13
    v_add_u32 v14, 8, v14
    s_lshl_b32 s58, s14, 16
    s_add_u32 s58, s58, 144703488
    s_mov_b32 s43, 0
    s_mov_b32 s28, s8
    s_mov_b32 s29, s9
    s_mov_b32 s30, 0
    s_mov_b32 s31, 0x00020000
    s_mul_i32 s17, s51, 3072
    v_add_u32 v50, s17, v0
    ds_write2_b32 v49, v4, v4 offset0:0 offset1:1
    s_waitcnt lgkmcnt(0)
    s_cmp_lg_u32 s14, 0
    s_cbranch_scc1 LtwZ_inia_d
    v_mov_b32 v5, 40
    s_mov_b32 s16, 0
LtwZ_inia:
    global_load_dword v6, v5, s[12:13] sc1
    s_add_u32 s16, s16, 1
    s_cmp_gt_u32 s16, 100000
    s_cbranch_scc1 L_role_tw_abort
    s_waitcnt vmcnt(0)
    v_cmp_gt_u32 vcc, 128, v6
    s_nop 0
    s_cbranch_vccz LtwZ_inia_d
    s_sleep 8
    s_branch LtwZ_inia
LtwZ_inia_d:
    s_barrier
    s_cmp_lg_u32 s14, 0
    s_cbranch_scc1 LtwZ_inib_d
    v_mov_b32 v5, 160
    s_mov_b32 s16, 0
LtwZ_inib:
    global_load_dword v6, v5, s[12:13] sc1
    s_add_u32 s16, s16, 1
    s_cmp_gt_u32 s16, 100000
    s_cbranch_scc1 L_role_tw_abort
    s_waitcnt vmcnt(0)
    v_cmp_gt_u32 vcc, 64, v6
    s_nop 0
    s_cbranch_vccz LtwZ_inib_d
    s_sleep 8
    s_branch LtwZ_inib
LtwZ_inib_d:
    s_barrier
LtwZ_idle:
    s_barrier
    ds_read_b32 v6, v49
    v_xor_b32 v49, 4, v49
    s_waitcnt lgkmcnt(0)
    v_readfirstlane_b32 s62, v6
    s_nop 0
    s_cmp_eq_u32 s62, 0
    s_cbranch_scc1 L_role_tw_abort
    s_cmp_lt_u32 s33, 29
    s_cselect_b32 s38, 1, 3
    s_cmp_eq_u32 s62, 2
    s_cselect_b32 s36, 1, 0
    s_cselect_b32 s37, s33, s32
    s_cselect_b32 s17, s38, 0
    s_add_u32 s33, s33, s17
    s_cmp_eq_u32 s62, 1
    s_cselect_b32 s17, 2, 0
    s_add_u32 s32, s32, s17
    s_lshl_b32 s56, s36, 6
    s_add_u32 s56, s56, s37
    s_lshl_b32 s46, s56, 18
    s_add_u32 s46, s46, s58
    s_mul_i32 s41, s36, 4718592
    s_mul_i32 s17, s37, 36864
    s_add_u32 s41, s41, s17
    s_add_u32 s41, s41, 8650752
    s_cmp_ge_u32 s37, 64
    s_cbranch_scc1 L_role_tw_abort
    s_add_u32 s48, s46, 0
    buffer_load_dwordx4 v[64:67], v0, s[8:11], s48 offen offset:0
    buffer_load_dwordx4 v[68:71], v0, s[8:11], s48 offen offset:1024
    buffer_load_dwordx4 v[72:75], v0, s[8:11], s48 offen offset:2048
    buffer_load_dwordx4 v[76:79], v0, s[8:11], s48 offen offset:3072
    s_add_u32 s48, s46, 4096
    buffer_load_dwordx4 v[80:83], v0, s[8:11], s48 offen offset:0
    buffer_load_dwordx4 v[84:87], v0, s[8:11], s48 offen offset:1024
    buffer_load_dwordx4 v[88:91], v0, s[8:11], s48 offen offset:2048
    buffer_load_dwordx4 v[92:95], v0, s[8:11], s48 offen offset:3072
    s_add_u32 s48, s46, 8192
    buffer_load_dwordx4 v[96:99], v0, s[8:11], s48 offen offset:0
    buffer_load_dwordx4 v[100:103], v0, s[8:11], s48 offen offset:1024
    buffer_load_dwordx4 v[104:107], v0, s[8:11], s48 offen offset:2048
    buffer_load_dwordx4 v[108:111], v0, s[8:11], s48 offen offset:3072
    s_add_u32 s48, s46, 12288
    buffer_load_dwordx4 v[112:115], v0, s[8:11], s48 offen offset:0
    buffer_load_dwordx4 v[116:119], v0, s[8:11], s48 offen offset:1024
    buffer_load_dwordx4 v[120:123], v0, s[8:11], s48 offen offset:2048
    buffer_load_dwordx2 v[40:41], v12, s[8:11], s41 offen
LtwZ_item:
    s_mov_b32 s34, s36
    s_mov_b32 s35, s37
    s_mov_b32 s47, s41
    buffer_load_dwordx4 v[124:127], v0, s[8:11], s48 offen offset:3072
    s_waitcnt vmcnt(16)
    v_mfma_f32_16x16x32_bf16 v[16:19], a[0:3], v[64:67], 0
    v_mfma_f32_16x16x32_bf16 v[20:23], a[4:7], v[64:67], 0
    v_mfma_f32_16x16x32_bf16 v[24:27], v[128:131], v[64:67], 0
    s_add_u32 s48, s46, 16384
    buffer_load_dwordx4 v[64:67], v0, s[8:11], s48 offen offset:0
    s_waitcnt vmcnt(16)
    v_mfma_f32_16x16x32_bf16 v[28:31], a[0:3], v[68:71], 0
    v_mfma_f32_16x16x32_bf16 v[32:35], a[4:7], v[68:71], 0
    v_mfma_f32_16x16x32_bf16 v[36:39], v[128:131], v[68:71], 0
    buffer_load_dwordx4 v[68:71], v0, s[8:11], s48 offen offset:1024
    s_waitcnt vmcnt(16)
    v_mfma_f32_16x16x32_bf16 v[16:19], a[8:11], v[72:75], v[16:19]
    v_mfma_f32_16x16x32_bf16 v[20:23], a[12:15], v[72:75], v[20:23]
    v_mfma_f32_16x16x32_bf16 v[24:27], v[132:135], v[72:75], v[24:27]
    buffer_load_dwordx4 v[72:75], v0, s[8:11], s48 offen offset:2048
    s_waitcnt vmcnt(16)
    v_mfma_f32_16x16x32_bf16 v[28:31], a[8:11], v[76:79], v[28:31]
    v_mfma_f32_16x16x32_bf16 v[32:35], a[12:15], v[76:79], v[32:35]
    v_mfma_f32_16x16x32_bf16 v[36:39], v[132:135], v[76:79], v[36:39]
    buffer_load_dwordx4 v[76:79], v0, s[8:11], s48 offen offset:3072
    s_waitcnt vmcnt(16)
    v_mfma_f32_16x16x32_bf16 v[16:19], a[16:19], v[80:83], v[16:19]
    v_mfma_f32_16x16x32_bf16 v[20:23], a[20:23], v[80:83], v[20:23]
    v_mfma_f32_16x16x32_bf16 v[24:27], v[136:139], v[80:83], v[24:27]
    s_add_u32 s48, s46, 20480
    buffer_load_dwordx4 v[80:83], v0, s[8:11], s48 offen offset:0
    s_waitcnt vmcnt(16)
    v_mfma_f32_16x16x32_bf16 v[28:31], a[16:19], v[84:87], v[28:31]
    v_mfma_f32_16x16x32_bf16 v[32:35], a[20:23], v[84:87], v[32:35]
    v_mfma_f32_16x16x32_bf16 v[36:39], v[136:139], v[84:87], v[36:39]
    buffer_load_dwordx4 v[84:87], v0, s[8:11], s48 offen offset:1024
    s_waitcnt vmcnt(16)
    v_mfma_f32_16x16x32_bf16 v[16:19], a[24:27], v[88:91], v[16:19]
    v_mfma_f32_16x16x32_bf16 v[20:23], a[28:31], v[88:91], v[20:23]
    v_mfma_f32_16x16x32_bf16 v[24:27], v[140:143], v[88:91], v[24:27]
    buffer_load_dwordx4 v[88:91], v0, s[8:11], s48 offen offset:2048
    s_waitcnt vmcnt(16)
    v_mfma_f32_16x16x32_bf16 v[28:31], a[24:27], v[92:95], v[28:31]
    v_mfma_f32_16x16x32_bf16 v[32:35], a[28:31], v[92:95], v[32:35]
    v_mfma_f32_16x16x32_bf16 v[36:39], v[140:143], v[92:95], v[36:39]
    buffer_load_dwordx4 v[92:95], v0, s[8:11], s48 offen offset:3072
    s_waitcnt vmcnt(16)
    v_mfma_f32_16x16x32_bf16 v[16:19], a[32:35], v[96:99], v[16:19]
    v_mfma_f32_16x16x32_bf16 v[20:23], a[36:39], v[96:99], v[20:23]
    v_mfma_f32_16x16x32_bf16 v[24:27], v[144:147], v[96:99], v[24:27]
    s_add_u32 s48, s46, 24576
    buffer_load_dwordx4 v[96:99], v0, s[8:11], s48 offen offset:0
    s_waitcnt vmcnt(16)
    v_mfma_f32_16x16x32_bf16 v[28:31], a[32:35], v[100:103], v[28:31]
    v_mfma_f32_16x16x32_bf16 v[32:35], a[36:39], v[100:103], v[32:35]
    v_mfma_f32_16x16x32_bf16 v[36:39], v[144:147], v[100:103], v[36:39]
    buffer_load_dwordx4 v[100:103], v0, s[8:11], s48 offen offset:1024
    s_waitcnt vmcnt(16)
    v_mfma_f32_16x16x32_bf16 v[16:19], a[40:43], v[104:107], v[16:19]
    v_mfma_f32_16x16x32_bf16 v[20:23], a[44:47], v[104:107], v[20:23]
    v_mfma_f32_16x16x32_bf16 v[24:27], v[148:151], v[104:107], v[24:27]
    buffer_load_dwordx4 v[104:107], v0, s[8:11], s48 offen offset:2048
    s_waitcnt vmcnt(16)
    v_mfma_f32_16x16x32_bf16 v[28:31], a[40:43], v[108:111], v[28:31]
    v_mfma_f32_16x16x32_bf16 v[32:35], a[44:47], v[108:111], v[32:35]
    v_mfma_f32_16x16x32_bf16 v[36:39], v[148:151], v[108:111], v[36:39]
    buffer_load_dwordx4 v[108:111], v0, s[8:11], s48 offen offset:3072
    s_waitcnt vmcnt(16)
    v_mfma_f32_16x16x32_bf16 v[16:19], a[48:51], v[112:115], v[16:19]
    v_mfma_f32_16x16x32_bf16 v[20:23], a[52:55], v[112:115], v[20:23]
    v_mfma_f32_16x16x32_bf16 v[24:27], v[152:155], v[112:115], v[24:27]
    s_add_u32 s48, s46, 28672
    buffer_load_dwordx4 v[112:115], v0, s[8:11], s48 offen offset:0
    s_waitcnt vmcnt(16)
    v_mfma_f32_16x16x32_bf16 v[28:31], a[48:51], v[116:119], v[28:31]
    v_mfma_f32_16x16x32_bf16 v[32:35], a[52:55], v[116:119], v[32:35]
    v_mfma_f32_16x16x32_bf16 v[36:39], v[152:155], v[116:119], v[36:39]
    buffer_load_dwordx4 v[116:119], v0, s[8:11], s48 offen offset:1024
    s_waitcnt vmcnt(16)
    v_mfma_f32_16x16x32_bf16 v[16:19], a[56:59], v[120:123], v[16:19]
    v_mfma_f32_16x16x32_bf16 v[20:23], a[60:63], v[120:123], v[20:23]
    v_mfma_f32_16x16x32_bf16 v[24:27], v[156:159], v[120:123], v[24:27]
    buffer_load_dwordx4 v[120:123], v0, s[8:11], s48 offen offset:2048
    s_waitcnt vmcnt(15)
    v_mfma_f32_16x16x32_bf16 v[28:31], a[56:59], v[124:127], v[28:31]
    v_mfma_f32_16x16x32_bf16 v[32:35], a[60:63], v[124:127], v[32:35]
    v_mfma_f32_16x16x32_bf16 v[36:39], v[156:159], v[124:127], v[36:39]
    buffer_load_dwordx4 v[124:127], v0, s[8:11], s48 offen offset:3072
    s_waitcnt vmcnt(15)
    v_mfma_f32_16x16x32_bf16 v[16:19], a[64:67], v[64:67], v[16:19]
    v_mfma_f32_16x16x32_bf16 v[20:23], a[68:71], v[64:67], v[20:23]
    v_mfma_f32_16x16x32_bf16 v[24:27], v[160:163], v[64:67], v[24:27]
    s_add_u32 s48, s46, 32768
    buffer_load_dwordx4 v[64:67], v0, s[8:11], s48 offen offset:0
    s_waitcnt vmcnt(15)
    v_mfma_f32_16x16x32_bf16 v[28:31], a[64:67], v[68:71], v[28:31]
    v_mfma_f32_16x16x32_bf16 v[32:35], a[68:71], v[68:71], v[32:35]
    v_mfma_f32_16x16x32_bf16 v[36:39], v[160:163], v[68:71], v[36:39]
    s_cmp_lg_u32 s43, 0
    s_cselect_b64 exec, 1, 0
    buffer_store_dword v3, v4, s[8:11], s43 offen sc1
    s_mov_b64 exec, -1
    s_mov_b32 s43, 0
    buffer_load_dwordx4 v[68:71], v0, s[8:11], s48 offen offset:1024
    s_waitcnt vmcnt(16)
    v_mfma_f32_16x16x32_bf16 v[16:19], a[72:75], v[72:75], v[16:19]
    v_mfma_f32_16x16x32_bf16 v[20:23], a[76:79], v[72:75], v[20:23]
    v_mfma_f32_16x16x32_bf16 v[24:27], v[164:167], v[72:75], v[24:27]
    buffer_load_dwordx4 v[72:75], v0, s[8:11], s48 offen offset:2048
    s_waitcnt vmcnt(16)
    v_mfma_f32_16x16x32_bf16 v[28:31], a[72:75], v[76:79], v[28:31]
    v_mfma_f32_16x16x32_bf16 v[32:35], a[76:79], v[76:79], v[32:35]
    v_mfma_f32_16x16x32_bf16 v[36:39], v[164:167], v[76:79], v[36:39]
    buffer_load_dwordx4 v[76:79], v0, s[8:11], s48 offen offset:3072
    s_waitcnt vmcnt(16)
    v_mfma_f32_16x16x32_bf16 v[16:19], a[80:83], v[80:83], v[16:19]
    v_mfma_f32_16x16x32_bf16 v[20:23], a[84:87], v[80:83], v[20:23]
    v_mfma_f32_16x16x32_bf16 v[24:27], v[168:171], v[80:83], v[24:27]
    s_add_u32 s48, s46, 36864
    buffer_load_dwordx4 v[80:83], v0, s[8:11], s48 offen offset:0
    s_waitcnt vmcnt(16)
    v_mfma_f32_16x16x32_bf16 v[28:31], a[80:83], v[84:87], v[28:31]
    v_mfma_f32_16x16x32_bf16 v[32:35], a[84:87], v[84:87], v[32:35]
    v_mfma_f32_16x16x32_bf16 v[36:39], v[168:171], v[84:87], v[36:39]
    buffer_load_dwordx4 v[84:87], v0, s[8:11], s48 offen offset:1024
    s_waitcnt vmcnt(16)
    v_mfma_f32_16x16x32_bf16 v[16:19], a[88:91], v[88:91], v[16:19]
    v_mfma_f32_16x16x32_bf16 v[20:23], a[92:95], v[88:91], v[20:23]
    v_mfma_f32_16x16x32_bf16 v[24:27], v[172:175], v[88:91], v[24:27]
    buffer_load_dwordx4 v[88:91], v0, s[8:11], s48 offen offset:2048
    s_waitcnt vmcnt(16)
    v_mfma_f32_16x16x32_bf16 v[28:31], a[88:91], v[92:95], v[28:31]
    v_mfma_f32_16x16x32_bf16 v[32:35], a[92:95], v[92:95], v[32:35]
    v_mfma_f32_16x16x32_bf16 v[36:39], v[172:175], v[92:95], v[36:39]
    buffer_load_dwordx4 v[92:95], v0, s[8:11], s48 offen offset:3072
    s_waitcnt vmcnt(16)
    v_mfma_f32_16x16x32_bf16 v[16:19], a[96:99], v[96:99], v[16:19]
    v_mfma_f32_16x16x32_bf16 v[20:23], a[100:103], v[96:99], v[20:23]
    v_mfma_f32_16x16x32_bf16 v[24:27], v[176:179], v[96:99], v[24:27]
    s_add_u32 s48, s46, 40960
    buffer_load_dwordx4 v[96:99], v0, s[8:11], s48 offen offset:0
    s_waitcnt vmcnt(16)
    v_mfma_f32_16x16x32_bf16 v[28:31], a[96:99], v[100:103], v[28:31]
    v_mfma_f32_16x16x32_bf16 v[32:35], a[100:103], v[100:103], v[32:35]
    v_mfma_f32_16x16x32_bf16 v[36:39], v[176:179], v[100:103], v[36:39]
    buffer_load_dwordx4 v[100:103], v0, s[8:11], s48 offen offset:1024
    s_waitcnt vmcnt(16)
    v_mfma_f32_16x16x32_bf16 v[16:19], a[104:107], v[104:107], v[16:19]
    v_mfma_f32_16x16x32_bf16 v[20:23], a[108:111], v[104:107], v[20:23]
    v_mfma_f32_16x16x32_bf16 v[24:27], v[180:183], v[104:107], v[24:27]
    buffer_load_dwordx4 v[104:107], v0, s[8:11], s48 offen offset:2048
    s_waitcnt vmcnt(16)
    v_mfma_f32_16x16x32_bf16 v[28:31], a[104:107], v[108:111], v[28:31]
    v_mfma_f32_16x16x32_bf16 v[32:35], a[108:111], v[108:111], v[32:35]
    v_mfma_f32_16x16x32_bf16 v[36:39], v[180:183], v[108:111], v[36:39]
    buffer_load_dwordx4 v[108:111], v0, s[8:11], s48 offen offset:3072
    s_waitcnt vmcnt(16)
    v_mfma_f32_16x16x32_bf16 v[16:19], a[112:115], v[112:115], v[16:19]
    v_mfma_f32_16x16x32_bf16 v[20:23], a[116:119], v[112:115], v[20:23]
    v_mfma_f32_16x16x32_bf16 v[24:27], v[184:187], v[112:115], v[24:27]
    s_add_u32 s48, s46, 45056
    buffer_load_dwordx4 v[112:115], v0, s[8:11], s48 offen offset:0
    s_waitcnt vmcnt(16)
    v_mfma_f32_16x16x32_bf16 v[28:31], a[112:115], v[116:119], v[28:31]
    v_mfma_f32_16x16x32_bf16 v[32:35], a[116:119], v[116:119], v[32:35]
    v_mfma_f32_16x16x32_bf16 v[36:39], v[184:187], v[116:119], v[36:39]
    buffer_load_dwordx4 v[116:119], v0, s[8:11], s48 offen offset:1024
    s_waitcnt vmcnt(16)
    v_mfma_f32_16x16x32_bf16 v[16:19], a[120:123], v[120:123], v[16:19]
    v_mfma_f32_16x16x32_bf16 v[20:23], a[124:127], v[120:123], v[20:23]
    v_mfma_f32_16x16x32_bf16 v[24:27], v[188:191], v[120:123], v[24:27]
    buffer_load_dwordx4 v[120:123], v0, s[8:11], s48 offen offset:2048
    s_waitcnt vmcnt(16)
    v_mfma_f32_16x16x32_bf16 v[28:31], a[120:123], v[124:127], v[28:31]
    v_mfma_f32_16x16x32_bf16 v[32:35], a[124:127], v[124:127], v[32:35]
    v_mfma_f32_16x16x32_bf16 v[36:39], v[188:191], v[124:127], v[36:39]
    buffer_load_dwordx4 v[124:127], v0, s[8:11], s48 offen offset:3072
    s_waitcnt vmcnt(16)
    v_mfma_f32_16x16x32_bf16 v[16:19], a[128:131], v[64:67], v[16:19]
    v_mfma_f32_16x16x32_bf16 v[20:23], a[132:135], v[64:67], v[20:23]
    v_mfma_f32_16x16x32_bf16 v[24:27], v[192:195], v[64:67], v[24:27]
    s_add_u32 s48, s46, 49152
    buffer_load_dwordx4 v[64:67], v0, s[8:11], s48 offen offset:0
    s_waitcnt vmcnt(15)
    v_mfma_f32_16x16x32_bf16 v[28:31], a[128:131], v[68:71], v[28:31]
    v_mfma_f32_16x16x32_bf16 v[32:35], a[132:135], v[68:71], v[32:35]
    v_mfma_f32_16x16x32_bf16 v[36:39], v[192:195], v[68:71], v[36:39]
    buffer_load_dwordx4 v[68:71], v0, s[8:11], s48 offen offset:1024
    s_waitcnt vmcnt(15)
    v_mfma_f32_16x16x32_bf16 v[16:19], a[136:139], v[72:75], v[16:19]
    v_mfma_f32_16x16x32_bf16 v[20:23], a[140:143], v[72:75], v[20:23]
    v_mfma_f32_16x16x32_bf16 v[24:27], v[196:199], v[72:75], v[24:27]
    buffer_load_dwordx4 v[72:75], v0, s[8:11], s48 offen offset:2048
    s_waitcnt vmcnt(15)
    v_mfma_f32_16x16x32_bf16 v[28:31], a[136:139], v[76:79], v[28:31]
    v_mfma_f32_16x16x32_bf16 v[32:35], a[140:143], v[76:79], v[32:35]
    v_mfma_f32_16x16x32_bf16 v[36:39], v[196:199], v[76:79], v[36:39]
    buffer_load_dwordx4 v[76:79], v0, s[8:11], s48 offen offset:3072
    s_waitcnt vmcnt(15)
    v_mfma_f32_16x16x32_bf16 v[16:19], a[144:147], v[80:83], v[16:19]
    v_mfma_f32_16x16x32_bf16 v[20:23], a[148:151], v[80:83], v[20:23]
    v_mfma_f32_16x16x32_bf16 v[24:27], v[200:203], v[80:83], v[24:27]
    s_add_u32 s48, s46, 53248
    buffer_load_dwordx4 v[80:83], v0, s[8:11], s48 offen offset:0
    s_waitcnt vmcnt(15)
    v_mfma_f32_16x16x32_bf16 v[28:31], a[144:147], v[84:87], v[28:31]
    v_mfma_f32_16x16x32_bf16 v[32:35], a[148:151], v[84:87], v[32:35]
    v_mfma_f32_16x16x32_bf16 v[36:39], v[200:203], v[84:87], v[36:39]
    buffer_load_dwordx4 v[84:87], v0, s[8:11], s48 offen offset:1024
    s_waitcnt vmcnt(15)
    v_mfma_f32_16x16x32_bf16 v[16:19], a[152:155], v[88:91], v[16:19]
    v_mfma_f32_16x16x32_bf16 v[20:23], a[156:159], v[88:91], v[20:23]
    v_mfma_f32_16x16x32_bf16 v[24:27], v[204:207], v[88:91], v[24:27]
    buffer_load_dwordx4 v[88:91], v0, s[8:11], s48 offen offset:2048
    s_waitcnt vmcnt(15)
    v_mfma_f32_16x16x32_bf16 v[28:31], a[152:155], v[92:95], v[28:31]
    v_mfma_f32_16x16x32_bf16 v[32:35], a[156:159], v[92:95], v[32:35]
    v_mfma_f32_16x16x32_bf16 v[36:39], v[204:207], v[92:95], v[36:39]
    buffer_load_dwordx4 v[92:95], v0, s[8:11], s48 offen offset:3072
    s_waitcnt vmcnt(15)
    v_mfma_f32_16x16x32_bf16 v[16:19], a[160:163], v[96:99], v[16:19]
    v_mfma_f32_16x16x32_bf16 v[20:23], a[164:167], v[96:99], v[20:23]
    v_mfma_f32_16x16x32_bf16 v[24:27], v[208:211], v[96:99], v[24:27]
    s_add_u32 s48, s46, 57344
    buffer_load_dwordx4 v[96:99], v0, s[8:11], s48 offen offset:0
    s_waitcnt vmcnt(15)
    v_mfma_f32_16x16x32_bf16 v[28:31], a[160:163], v[100:103], v[28:31]
    v_mfma_f32_16x16x32_bf16 v[32:35], a[164:167], v[100:103], v[32:35]
    v_mfma_f32_16x16x32_bf16 v[36:39], v[208:211], v[100:103], v[36:39]
    buffer_load_dwordx4 v[100:103], v0, s[8:11], s48 offen offset:1024
    s_waitcnt vmcnt(15)
    v_mfma_f32_16x16x32_bf16 v[16:19], a[168:171], v[104:107], v[16:19]
    v_mfma_f32_16x16x32_bf16 v[20:23], a[172:175], v[104:107], v[20:23]
    v_mfma_f32_16x16x32_bf16 v[24:27], v[212:215], v[104:107], v[24:27]
    buffer_load_dwordx4 v[104:107], v0, s[8:11], s48 offen offset:2048
    s_waitcnt vmcnt(15)
    v_mfma_f32_16x16x32_bf16 v[28:31], a[168:171], v[108:111], v[28:31]
    v_mfma_f32_16x16x32_bf16 v[32:35], a[172:175], v[108:111], v[32:35]
    v_mfma_f32_16x16x32_bf16 v[36:39], v[212:215], v[108:111], v[36:39]
    buffer_load_dwordx4 v[108:111], v0, s[8:11], s48 offen offset:3072
    s_waitcnt vmcnt(15)
    v_mfma_f32_16x16x32_bf16 v[16:19], a[176:179], v[112:115], v[16:19]
    v_mfma_f32_16x16x32_bf16 v[20:23], a[180:183], v[112:115], v[20:23]
    v_mfma_f32_16x16x32_bf16 v[24:27], v[216:219], v[112:115], v[24:27]
    s_barrier
    ds_read_b32 v6, v49
    v_xor_b32 v49, 4, v49
    s_add_u32 s48, s46, 61440
    buffer_load_dwordx4 v[112:115], v0, s[8:11], s48 offen offset:0
    s_waitcnt vmcnt(15)
    v_mfma_f32_16x16x32_bf16 v[28:31], a[176:179], v[116:119], v[28:31]
    v_mfma_f32_16x16x32_bf16 v[32:35], a[180:183], v[116:119], v[32:35]
    v_mfma_f32_16x16x32_bf16 v[36:39], v[216:219], v[116:119], v[36:39]
    buffer_load_dwordx4 v[116:119], v0, s[8:11], s48 offen offset:1024
    s_waitcnt vmcnt(15)
    v_mfma_f32_16x16x32_bf16 v[16:19], a[184:187], v[120:123], v[16:19]
    v_mfma_f32_16x16x32_bf16 v[20:23], a[188:191], v[120:123], v[20:23]
    v_mfma_f32_16x16x32_bf16 v[24:27], v[220:223], v[120:123], v[24:27]
    buffer_load_dwordx4 v[120:123], v0, s[8:11], s48 offen offset:2048
    s_waitcnt vmcnt(15)
    v_mfma_f32_16x16x32_bf16 v[28:31], a[184:187], v[124:127], v[28:31]
    v_mfma_f32_16x16x32_bf16 v[32:35], a[188:191], v[124:127], v[32:35]
    v_mfma_f32_16x16x32_bf16 v[36:39], v[220:223], v[124:127], v[36:39]
    s_waitcnt lgkmcnt(0)
    v_readfirstlane_b32 s62, v6
    s_cmp_lt_u32 s33, 29
    s_cselect_b32 s38, 1, 3
    s_cmp_eq_u32 s62, 2
    s_cselect_b32 s36, 1, 0
    s_cselect_b32 s37, s33, s32
    s_cselect_b32 s17, s38, 0
    s_add_u32 s33, s33, s17
    s_cmp_eq_u32 s62, 1
    s_cselect_b32 s17, 2, 0
    s_add_u32 s32, s32, s17
    s_lshl_b32 s56, s36, 6
    s_add_u32 s56, s56, s37
    buffer_load_dwordx4 v[124:127], v0, s[8:11], s48 offen offset:3072
    s_waitcnt vmcnt(15)
    v_mfma_f32_16x16x32_bf16 v[16:19], a[192:195], v[64:67], v[16:19]
    v_mfma_f32_16x16x32_bf16 v[20:23], a[196:199], v[64:67], v[20:23]
    v_mfma_f32_16x16x32_bf16 v[24:27], v[224:227], v[64:67], v[24:27]
    s_cmp_lt_u32 s37, 64
    s_cselect_b32 s62, s62, 0
    s_lshl_b32 s46, s56, 18
    s_add_u32 s46, s46, s58
    s_mul_i32 s41, s36, 4718592
    s_mul_i32 s17, s37, 36864
    s_add_u32 s41, s41, s17
    s_add_u32 s41, s41, 8650752
    s_cmp_lg_u32 s62, 0
    s_cselect_b32 s30, 268435456, 0
    s_add_u32 s48, s46, 0
    buffer_load_dwordx4 v[64:67], v0, s[28:31], s48 offen offset:0
    s_waitcnt vmcnt(15)
    v_mfma_f32_16x16x32_bf16 v[28:31], a[192:195], v[68:71], v[28:31]
    v_mfma_f32_16x16x32_bf16 v[32:35], a[196:199], v[68:71], v[32:35]
    v_mfma_f32_16x16x32_bf16 v[36:39], v[224:227], v[68:71], v[36:39]
    buffer_load_dwordx4 v[68:71], v0, s[28:31], s48 offen offset:1024
    s_waitcnt vmcnt(15)
    v_mfma_f32_16x16x32_bf16 v[16:19], a[200:203], v[72:75], v[16:19]
    v_mfma_f32_16x16x32_bf16 v[20:23], a[204:207], v[72:75], v[20:23]
    v_mfma_f32_16x16x32_bf16 v[24:27], v[228:231], v[72:75], v[24:27]
    buffer_load_dwordx4 v[72:75], v0, s[28:31], s48 offen offset:2048
    s_waitcnt vmcnt(15)
    v_mfma_f32_16x16x32_bf16 v[28:31], a[200:203], v[76:79], v[28:31]
    v_mfma_f32_16x16x32_bf16 v[32:35], a[204:207], v[76:79], v[32:35]
    v_mfma_f32_16x16x32_bf16 v[36:39], v[228:231], v[76:79], v[36:39]
    buffer_load_dwordx4 v[76:79], v0, s[28:31], s48 offen offset:3072
    s_waitcnt vmcnt(15)
    v_mfma_f32_16x16x32_bf16 v[16:19], a[208:211], v[80:83], v[16:19]
    v_mfma_f32_16x16x32_bf16 v[20:23], a[212:215], v[80:83], v[20:23]
    v_mfma_f32_16x16x32_bf16 v[24:27], v[232:235], v[80:83], v[24:27]
    s_add_u32 s48, s46, 4096
    buffer_load_dwordx4 v[80:83], v0, s[28:31], s48 offen offset:0
    s_waitcnt vmcnt(15)
    v_mfma_f32_16x16x32_bf16 v[28:31], a[208:211], v[84:87], v[28:31]
    v_mfma_f32_16x16x32_bf16 v[32:35], a[212:215], v[84:87], v[32:35]
    v_mfma_f32_16x16x32_bf16 v[36:39], v[232:235], v[84:87], v[36:39]
    buffer_load_dwordx4 v[84:87], v0, s[28:31], s48 offen offset:1024
    s_waitcnt vmcnt(15)
    v_mfma_f32_16x16x32_bf16 v[16:19], a[216:219], v[88:91], v[16:19]
    v_mfma_f32_16x16x32_bf16 v[20:23], a[220:223], v[88:91], v[20:23]
    v_mfma_f32_16x16x32_bf16 v[24:27], v[236:239], v[88:91], v[24:27]
    buffer_load_dwordx4 v[88:91], v0, s[28:31], s48 offen offset:2048
    s_waitcnt vmcnt(15)
    v_mfma_f32_16x16x32_bf16 v[28:31], a[216:219], v[92:95], v[28:31]
    v_mfma_f32_16x16x32_bf16 v[32:35], a[220:223], v[92:95], v[32:35]
    v_mfma_f32_16x16x32_bf16 v[36:39], v[236:239], v[92:95], v[36:39]
    buffer_load_dwordx4 v[92:95], v0, s[28:31], s48 offen offset:3072
    s_waitcnt vmcnt(15)
    v_mfma_f32_16x16x32_bf16 v[16:19], a[224:227], v[96:99], v[16:19]
    v_mfma_f32_16x16x32_bf16 v[20:23], a[228:231], v[96:99], v[20:23]
    v_mfma_f32_16x16x32_bf16 v[24:27], v[240:243], v[96:99], v[24:27]
    s_add_u32 s48, s46, 8192
    buffer_load_dwordx4 v[96:99], v0, s[28:31], s48 offen offset:0
    s_waitcnt vmcnt(15)
    v_mfma_f32_16x16x32_bf16 v[28:31], a[224:227], v[100:103], v[28:31]
    v_mfma_f32_16x16x32_bf16 v[32:35], a[228:231], v[100:103], v[32:35]
    v_mfma_f32_16x16x32_bf16 v[36:39], v[240:243], v[100:103], v[36:39]
    buffer_load_dwordx4 v[100:103], v0, s[28:31], s48 offen offset:1024
    s_waitcnt vmcnt(15)
    v_mfma_f32_16x16x32_bf16 v[16:19], a[232:235], v[104:107], v[16:19]
    v_mfma_f32_16x16x32_bf16 v[20:23], a[236:239], v[104:107], v[20:23]
    v_mfma_f32_16x16x32_bf16 v[24:27], v[244:247], v[104:107], v[24:27]
    buffer_load_dwordx4 v[104:107], v0, s[28:31], s48 offen offset:2048
    s_waitcnt vmcnt(15)
    v_mfma_f32_16x16x32_bf16 v[28:31], a[232:235], v[108:111], v[28:31]
    v_mfma_f32_16x16x32_bf16 v[32:35], a[236:239], v[108:111], v[32:35]
    v_mfma_f32_16x16x32_bf16 v[36:39], v[244:247], v[108:111], v[36:39]
    buffer_load_dwordx4 v[108:111], v0, s[28:31], s48 offen offset:3072
    s_waitcnt vmcnt(15)
    v_mfma_f32_16x16x32_bf16 v[16:19], a[240:243], v[112:115], v[16:19]
    v_mfma_f32_16x16x32_bf16 v[20:23], a[244:247], v[112:115], v[20:23]
    v_mfma_f32_16x16x32_bf16 v[24:27], v[248:251], v[112:115], v[24:27]
    s_add_u32 s48, s46, 12288
    buffer_load_dwordx4 v[112:115], v0, s[28:31], s48 offen offset:0
    s_waitcnt vmcnt(15)
    v_mfma_f32_16x16x32_bf16 v[28:31], a[240:243], v[116:119], v[28:31]
    v_mfma_f32_16x16x32_bf16 v[32:35], a[244:247], v[116:119], v[32:35]
    v_mfma_f32_16x16x32_bf16 v[36:39], v[248:251], v[116:119], v[36:39]
    buffer_load_dwordx4 v[116:119], v0, s[28:31], s48 offen offset:1024
    s_waitcnt vmcnt(15)
    v_mfma_f32_16x16x32_bf16 v[16:19], a[248:251], v[120:123], v[16:19]
    v_mfma_f32_16x16x32_bf16 v[20:23], a[252:255], v[120:123], v[20:23]
    v_mfma_f32_16x16x32_bf16 v[24:27], v[252:255], v[120:123], v[24:27]
    buffer_load_dwordx4 v[120:123], v0, s[28:31], s48 offen offset:2048
    s_waitcnt vmcnt(15)
    v_mfma_f32_16x16x32_bf16 v[28:31], a[248:251], v[124:127], v[28:31]
    v_mfma_f32_16x16x32_bf16 v[32:35], a[252:255], v[124:127], v[32:35]
    v_mfma_f32_16x16x32_bf16 v[36:39], v[252:255], v[124:127], v[36:39]
    s_nop 5
    ds_write_b128 v48, v[16:19] offset:0
    ds_write_b128 v48, v[20:23] offset:1024
    ds_write_b128 v48, v[24:27] offset:2048
    ds_write_b128 v48, v[28:31] offset:3072
    ds_write_b128 v48, v[32:35] offset:4096
    ds_write_b128 v48, v[36:39] offset:5120
    s_waitcnt lgkmcnt(0)
    s_barrier
    ds_read_b128 v[24:27], v50 offset:2048
    ds_read_b128 v[28:31], v50 offset:8192
    ds_read_b128 v[32:35], v50 offset:14336
    ds_read_b128 v[36:39], v50 offset:20480
    v_xor_b32 v48, 0x8000, v48
    v_xor_b32 v50, 0x8000, v50
    v_lshlrev_b32 v16, 16, v40
    v_and_b32 v17, 0xffff0000, v40
    v_lshlrev_b32 v18, 16, v41
    v_and_b32 v19, 0xffff0000, v41
    buffer_load_dwordx2 v[40:41], v12, s[28:31], s41 offen
    s_waitcnt lgkmcnt(3)
    v_add_f32 v16, v16, v24
    v_add_f32 v17, v17, v25
    v_add_f32 v18, v18, v26
    v_add_f32 v19, v19, v27
    s_waitcnt lgkmcnt(2)
    v_add_f32 v16, v16, v28
    v_add_f32 v17, v17, v29
    v_add_f32 v18, v18, v30
    v_add_f32 v19, v19, v31
    s_waitcnt lgkmcnt(1)
    v_add_f32 v16, v16, v32
    v_add_f32 v17, v17, v33
    v_add_f32 v18, v18, v34
    v_add_f32 v19, v19, v35
    s_waitcnt lgkmcnt(0)
    v_add_f32 v16, v16, v36
    v_add_f32 v17, v17, v37
    v_add_f32 v18, v18, v38
    v_add_f32 v19, v19, v39
    v_cvt_pk_bf16_f32 v52, v16, v17
    v_cvt_pk_bf16_f32 v53, v18, v19
    s_cmp_eq_u32 s34, 0
    s_cbranch_scc1 LtwZ_l0
    s_mul_i32 s17, s35, 36864
    buffer_store_dwordx2 v[52:53], v13, s[24:27], s17 offen sc1
    s_cmp_lg_u32 s62, 0
    s_cbranch_scc1 LtwZ_item
LtwZ_chk:
    s_min_u32 s17, s32, s33
    s_cmp_lt_u32 s17, 64
    s_cbranch_scc1 LtwZ_idle
    s_branch L_role_tw_exit
LtwZ_l0:
    s_add_u32 s47, s47, 2359296
    buffer_store_dwordx2 v[52:53], v12, s[8:11], s47 offen sc1
    v_add_f32 v44, v16, v17
    v_mul_f32 v45, v16, v16
    v_fmac_f32 v45, v17, v17
    v_add_f32 v44, v44, v18
    v_fmac_f32 v45, v18, v18
    v_add_f32 v44, v44, v19
    v_fmac_f32 v45, v19, v19
    v_mov_b32 v46, v44
    v_mov_b32 v47, v45
    s_nop 0
    v_permlane32_swap_b32 v44, v46
    v_permlane32_swap_b32 v45, v47
    v_add_f32 v44, v44, v46
    v_add_f32 v45, v45, v47
    v_mov_b32 v46, v44
    v_mov_b32 v47, v45
    s_nop 0
    v_permlane16_swap_b32 v44, v46
    v_permlane16_swap_b32 v45, v47
    v_add_f32 v44, v44, v46
    v_add_f32 v45, v45, v47
    s_mul_i32 s17, s35, 6144
    s_add_u32 s17, s17, 16515072
    s_mov_b64 exec, 0xffff
    buffer_store_dwordx2 v[44:45], v14, s[8:11], s17 offen sc1
    s_mov_b64 exec, -1
    s_mul_i32 s43, s35, 22528
    s_add_u32 s43, s43, s49
    s_cmp_lg_u32 s62, 0
    s_cbranch_scc1 LtwZ_item
    s_waitcnt vmcnt(0)
    s_mov_b64 exec, 1
    buffer_store_dword v3, v4, s[8:11], s43 offen sc1
    s_mov_b64 exec, -1
    s_mov_b32 s43, 0
    s_branch LtwZ_chk
L_role_tw_abort:
    s_waitcnt lgkmcnt(0)
    s_mov_b64 exec, -1
    v_mov_b32 v0, 60
    s_lshl_b32 s5, s3, 8
    s_or_b32 s5, s5, s4
    s_or_b32 s5, s5, 0x10000
    v_mov_b32 v1, s5
    global_store_dword v0, v1, s[12:13]
    s_endpgm
L_role_tw_exit:
    s_endpgm
.p2align 6
L_role_r:
    s_mov_b32 s32, s3
    s_mov_b32 s15, s4
    v_and_b32 v60, 63, v0
    v_and_b32 v61, 15, v60
    v_lshrrev_b32 v62, 4, v60
    v_lshlrev_b32 v0, 4, v60
    s_mul_i32 s17, s14, 34816
    s_add_u32 s17, s17, 23296
    v_add_u32 v8, s17, v0
    s_mov_b32 s50, 0xfffffffe
    s_mov_b32 s44, 0x3e0293ee
    s_mov_b32 s45, 0x3e0293ee
    s_mov_b32 s52, 0x3f803f80
    s_mov_b32 s53, 0x3f803f80
    s_mov_b32 s40, 1
    s_mov_b32 s46, 0x00ff00ff
    s_cmp_eq_u32 s14, 2
    s_cselect_b32 s46, 0x00030003, s46
    s_mov_b32 s47, s46
    v_bfe_u32 v63, v61, 1, 1
    v_mov_b32 v1, 0x4444
    v_mov_b32 v64, 0xeeee
    v_cmp_eq_u32 vcc, 0, v63
    s_nop 1
    v_cndmask_b32 v1, v64, v1, vcc
    v_mul_u32_u24 v64, 1152, v62
    v_lshl_add_u32 v2, v61, 2, v64
    s_lshl_b32 s17, s14, 6
    s_add_u32 s18, s17, 0
    v_add_u32 v2, s18, v2
    v_mul_u32_u24 v64, 288, v61
    v_lshl_add_u32 v3, v62, 4, v64
    v_add_u32 v3, 0, v3
    v_lshrrev_b32 v64, 2, v61
    v_and_b32 v65, 1, v61
    v_lshl_add_u32 v64, v64, 1, v65
    v_mul_u32_u24 v65, 288, v64
    v_lshl_add_u32 v4, v62, 5, v65
    v_lshl_add_u32 v4, v63, 4, v4
    v_add_u32 v4, 4608, v4
    v_xor_b32 v63, 1, v63
    v_mul_u32_u24 v63, 2304, v63
    v_add_u32 v5, v65, v63
    v_lshl_add_u32 v5, v62, 4, v5
    s_add_u32 s18, s17, 4608
    v_add_u32 v5, s18, v5
    s_lshr_b32 s70, s15, 3
    s_bfe_u32 s71, s15, 0x20001
    s_and_b32 s72, s15, 1
    v_bfe_u32 v64, v61, 2, 1
    v_lshl_add_u32 v63, v64, 2, v62
    v_mul_u32_u24 v63, 9216, v63
    v_lshrrev_b32 v65, 3, v61
    v_lshlrev_b32 v65, 2, v65
    v_and_b32 v64, 3, v61
    v_add_u32 v65, v65, v64
    s_lshl_b32 s73, s71, 4
    s_lshl_b32 s17, s72, 3
    s_add_u32 s73, s73, s17
    v_add_u32 v65, s73, v65
    s_lshl_b32 s17, s70, 6
    v_add_u32 v65, s17, v65
    s_cmp_eq_u32 s14, 2
    s_cselect_b32 s17, 2, 4
    v_lshlrev_b32 v65, s17, v65
    v_add_u32 v6, v63, v65
    s_lshl_b32 s17, s14, 12
    v_add_u32 v6, s17, v6
    v_lshrrev_b32 v66, 1, v61
    s_lshl_b32 s17, s14, 2
    v_add_u32 v66, s17, v66
    v_and_b32 v64, 1, v61
    s_lshl_b32 s17, s70, 4
    s_lshl_b32 s18, s71, 2
    s_add_u32 s17, s17, s18
    s_lshl_b32 s18, s72, 1
    s_add_u32 s17, s17, s18
    v_add_u32 v65, s17, v64
    v_lshl_add_u32 v65, v66, 6, v65
    v_lshlrev_b32 v65, 4, v65
    v_lshl_add_u32 v7, v62, 2, v65
    s_lshl_b32 s17, s71, 1
    v_add_u32 v64, s17, v64
    v_mul_u32_u24 v64, 576, v64
    v_lshl_add_u32 v64, v66, 4, v64
    v_lshl_add_u32 v64, v62, 1, v64
    s_mul_i32 s17, s70, 144
    s_lshl_b32 s18, s72, 3
    s_add_u32 s17, s17, s18
    v_add_u32 v64, s17, v64
    v_lshlrev_b32 v67, 1, v64
    s_mul_i32 s48, s32, 1048576
    s_add_u32 s48, s48, 4194304
    s_mul_i32 s17, s15, 9216
    s_add_u32 s17, s17, s48
    s_lshl_b32 s18, s14, 10
    s_add_u32 s38, s17, s18
    s_lshl_b32 s19, s14, 8
    s_add_u32 s39, s17, s19
    s_add_u32 s39, s39, 8192
    s_add_u32 s37, s48, 983040
    s_xor_b32 s36, s37, 16384
    s_add_u32 s34, s37, s18
    s_add_u32 s35, s37, 8192
    s_mul_i32 s17, s32, 50331648
    s_lshl_b32 s19, s15, 13
    s_add_u32 s17, s17, s19
    s_add_u32 s68, s17, 77594624
    s_lshl_b32 s18, s14, 11
    s_add_u32 s17, s17, s18
    s_add_u32 s41, s17, 60817408
    s_add_u32 s42, s17, 77594624
    s_mul_i32 s17, s32, 8388608
    s_lshl_b32 s19, s15, 12
    s_add_u32 s17, s17, s19
    s_add_u32 s43, s17, 27262976
    s_mul_i32 s17, s32, 1441792
    s_lshl_b32 s19, s15, 9
    s_add_u32 s17, s17, s19
    s_add_u32 s66, s17, 5376
    s_mov_b32 s33, 0
    s_add_u32 s62, s48, 0
    s_add_u32 s63, s48, 73728
    s_add_u32 s64, s48, 147456
    s_add_u32 s65, s48, 221184
    s_load_dwordx2 s[20:21], s[0:1], 32
    s_mov_b32 s22, 9216
    s_mov_b32 s23, 0x00020000
    s_waitcnt lgkmcnt(0)
    s_and_b32 s21, s21, 0xffff
    s_cmp_gt_u32 s14, 2
    s_cbranch_scc1 Lr_mem0_done
    s_mov_b64 exec, s[46:47]
    buffer_load_dword v64, v67, s[20:23], 0 offen
    s_waitcnt vmcnt(0)
    v_min_u32 v64, s50, v64
    buffer_store_dword v64, v7, s[8:11], s37 offen sc1
    v_mov_b32 v64, -1
    buffer_store_dword v64, v7, s[8:11], s36 offen sc1
    s_mov_b64 exec, -1
Lr_mem0_done:
    v_mov_b32 v64, 0
    v_mov_b32 v65, 0
    v_mov_b32 v66, 0
    v_mov_b32 v67, 0
    v_lshrrev_b32 v63, 2, v0
    buffer_store_dwordx4 v[64:67], v0, s[8:11], s38 offen sc1
    s_add_u32 s17, s38, 4096
    buffer_store_dwordx4 v[64:67], v0, s[8:11], s17 offen sc1
    buffer_store_dword v64, v63, s[8:11], s39 offen sc1
    s_waitcnt vmcnt(0)
    s_barrier
    s_cmp_lg_u32 s14, 0
    s_cbranch_scc1 Lr_noadd
    s_lshl_b32 s17, s32, 2
    s_add_u32 s17, s17, 192
    v_mov_b32 v63, s17
    v_mov_b32 v64, 1
    s_mov_b64 exec, 1
    global_atomic_add v63, v64, s[12:13]
    s_mov_b64 exec, -1
Lr_noadd:
    s_cmp_lt_u32 s14, 3
    s_cbranch_scc1 Lr_not_w3
    v_lshlrev_b32 v6, 3, v0
    v_lshrrev_b32 v63, 2, v0
    v_and_b32 v7, 12, v63
    v_and_b32 v63, 16, v63
    v_lshl_add_u32 v7, v63, 3, v7
Lr_not_w3:
    s_cmp_eq_u32 s32, 0
    s_cbranch_scc1 Lr_gate_ng
    s_cmp_lg_u32 s14, 0
    s_cbranch_scc1 Lr_gate_d
    v_mov_b32 v63, 48
    s_mov_b32 s16, 0
Lr_gate:
    global_load_dword v64, v63, s[12:13] sc1
    s_add_u32 s16, s16, 1
    s_cmp_gt_u32 s16, 100000
    s_cbranch_scc1 Lr_abort
    s_waitcnt vmcnt(0)
    v_cmp_gt_u32 vcc, 32, v64
    s_nop 0
    s_cbranch_vccz Lr_gate_d
    s_sleep 100
    s_branch Lr_gate
Lr_gate_d:
    s_barrier
Lr_gate_ng:
    s_load_dwordx2 s[20:21], s[0:1], 40
    s_mov_b32 s22, 4718592
    s_mov_b32 s23, 0x00020000
    s_waitcnt lgkmcnt(0)
    s_and_b32 s21, s21, 0xffff
    s_load_dwordx2 s[24:25], s[0:1], 48
    s_mov_b32 s26, 4718592
    s_mov_b32 s27, 0x00020000
    s_waitcnt lgkmcnt(0)
    s_and_b32 s25, s25, 0xffff
    s_load_dwordx2 s[28:29], s[0:1], 56
    s_mov_b32 s30, 4718592
    s_mov_b32 s31, 0x00020000
    s_waitcnt lgkmcnt(0)
    s_and_b32 s29, s29, 0xffff
    s_load_dwordx2 s[76:77], s[0:1], 64
    s_mov_b32 s78, 4718592
    s_mov_b32 s79, 0x00020000
    s_waitcnt lgkmcnt(0)
    s_and_b32 s77, s77, 0xffff
    v_lshrrev_b32 v60, 4, v0
    v_and_b32 v61, 15, v60
    v_lshrrev_b32 v62, 4, v60
    s_mul_i32 s72, s14, 34816
    s_add_u32 s72, s72, 23296
    s_mul_i32 s70, s14, 1179648
    s_lshl_b32 s17, s15, 8
    s_add_u32 s70, s70, s17
    s_mul_i32 s71, s15, 147456
    s_mul_i32 s17, s14, 288
    s_add_u32 s71, s71, s17
    v_and_b32 v63, 1, v62
    v_lshrrev_b32 v64, 1, v61
    v_xor_b32 v64, v64, v63
    v_lshlrev_b32 v64, 5, v64
    v_and_b32 v65, 1, v61
    v_lshl_add_u32 v64, v65, 4, v64
    v_lshl_add_u32 v12, v62, 13, v64
    v_xor_b32 v13, 128, v12
    v_xor_b32 v14, 64, v12
    v_xor_b32 v15, 192, v12
    v_lshrrev_b32 v63, 2, v60
    v_mul_u32_u24 v63, 1152, v63
    v_and_b32 v64, 3, v60
    v_lshl_add_u32 v16, v64, 4, v63
    v_lshrrev_b32 v63, 1, v60
    v_mul_u32_u24 v63, 1152, v63
    v_and_b32 v64, 1, v60
    v_lshl_add_u32 v17, v64, 4, v63
    v_lshrrev_b32 v40, 2, v61
    v_and_b32 v41, 3, v61
    v_and_b32 v63, 1, v62
    v_lshl_add_u32 v42, v63, 2, v40
    v_and_b32 v64, 1, v40
    v_lshl_add_u32 v64, v63, 2, v64
    v_lshrrev_b32 v65, 1, v40
    v_lshl_add_u32 v64, v65, 3, v64
    v_lshlrev_b32 v64, 8, v64
    v_lshl_add_u32 v64, v41, 3, v64
    v_lshrrev_b32 v65, 1, v62
    v_mul_u32_u24 v65, 34816, v65
    v_add_u32 v64, v64, v65
    v_add_u32 v64, 23296, v64
    s_lshl_b32 s17, s14, 1
    s_add_u32 s18, s17, 0
    v_xor_b32 v65, s18, v42
    v_lshl_add_u32 v18, v65, 5, v64
    v_add_u32 v19, 69632, v18
    s_add_u32 s18, s17, 1
    v_xor_b32 v65, s18, v42
    v_lshl_add_u32 v20, v65, 5, v64
    v_add_u32 v21, 69632, v20
    v_lshrrev_b32 v63, 1, v62
    v_lshlrev_b32 v63, 3, v63
    v_and_b32 v64, 1, v62
    v_lshl_add_u32 v63, v64, 1, v63
    v_and_b32 v64, 1, v40
    v_lshl_add_u32 v63, v64, 4, v63
    v_lshrrev_b32 v64, 1, v40
    v_lshl_add_u32 v63, v64, 2, v63
    v_lshlrev_b32 v64, 3, v41
    v_lshl_add_u32 v22, v63, 6, v64
    v_add_u32 v22, s72, v22
    v_lshl_add_u32 v23, v63, 5, v64
    v_add_u32 v23, s72, v23
    s_add_u32 m0, s72, 0
    s_add_u32 s17, s70, 0
    buffer_load_dwordx4 v12, s[20:23], s17 offen  lds
    s_add_u32 m0, m0, 1024
    s_add_u32 s17, s70, 32768
    buffer_load_dwordx4 v13, s[20:23], s17 offen  lds
    s_add_u32 m0, m0, 1024
    s_add_u32 s17, s70, 65536
    buffer_load_dwordx4 v14, s[20:23], s17 offen  lds
    s_add_u32 m0, m0, 1024
    s_add_u32 s17, s70, 98304
    buffer_load_dwordx4 v15, s[20:23], s17 offen  lds
    s_add_u32 m0, s72, 4096
    s_add_u32 s17, s70, 0
    buffer_load_dwordx4 v12, s[24:27], s17 offen  lds
    s_add_u32 m0, m0, 1024
    s_add_u32 s17, s70, 32768
    buffer_load_dwordx4 v13, s[24:27], s17 offen  lds
    s_add_u32 m0, m0, 1024
    s_add_u32 s17, s70, 65536
    buffer_load_dwordx4 v14, s[24:27], s17 offen  lds
    s_add_u32 m0, m0, 1024
    s_add_u32 s17, s70, 98304
    buffer_load_dwordx4 v15, s[24:27], s17 offen  lds
    s_add_u32 m0, s72, 8192
    s_add_u32 s17, s70, 131072
    buffer_load_dwordx4 v12, s[20:23], s17 offen  lds
    s_add_u32 m0, m0, 1024
    s_add_u32 s17, s70, 163840
    buffer_load_dwordx4 v13, s[20:23], s17 offen  lds
    s_add_u32 m0, m0, 1024
    s_add_u32 s17, s70, 196608
    buffer_load_dwordx4 v14, s[20:23], s17 offen  lds
    s_add_u32 m0, m0, 1024
    s_add_u32 s17, s70, 229376
    buffer_load_dwordx4 v15, s[20:23], s17 offen  lds
    s_add_u32 m0, s72, 12288
    s_add_u32 s17, s70, 131072
    buffer_load_dwordx4 v12, s[24:27], s17 offen  lds
    s_add_u32 m0, m0, 1024
    s_add_u32 s17, s70, 163840
    buffer_load_dwordx4 v13, s[24:27], s17 offen  lds
    s_add_u32 m0, m0, 1024
    s_add_u32 s17, s70, 196608
    buffer_load_dwordx4 v14, s[24:27], s17 offen  lds
    s_add_u32 m0, m0, 1024
    s_add_u32 s17, s70, 229376
    buffer_load_dwordx4 v15, s[24:27], s17 offen  lds
    s_add_u32 m0, s72, 16384
    s_add_u32 s17, s70, 131072
    buffer_load_dwordx4 v12, s[28:31], s17 offen  lds
    s_add_u32 m0, m0, 1024
    s_add_u32 s17, s70, 163840
    buffer_load_dwordx4 v13, s[28:31], s17 offen  lds
    s_add_u32 m0, m0, 1024
    s_add_u32 s17, s70, 196608
    buffer_load_dwordx4 v14, s[28:31], s17 offen  lds
    s_add_u32 m0, m0, 1024
    s_add_u32 s17, s70, 229376
    buffer_load_dwordx4 v15, s[28:31], s17 offen  lds
    s_add_u32 m0, s72, 20480
    s_add_u32 s17, s70, 262144
    buffer_load_dwordx4 v12, s[20:23], s17 offen  lds
    s_add_u32 m0, m0, 1024
    s_add_u32 s17, s70, 294912
    buffer_load_dwordx4 v13, s[20:23], s17 offen  lds
    s_add_u32 m0, m0, 1024
    s_add_u32 s17, s70, 327680
    buffer_load_dwordx4 v14, s[20:23], s17 offen  lds
    s_add_u32 m0, m0, 1024
    s_add_u32 s17, s70, 360448
    buffer_load_dwordx4 v15, s[20:23], s17 offen  lds
    s_add_u32 m0, s72, 24576
    s_add_u32 s17, s70, 262144
    buffer_load_dwordx4 v12, s[24:27], s17 offen  lds
    s_add_u32 m0, m0, 1024
    s_add_u32 s17, s70, 294912
    buffer_load_dwordx4 v13, s[24:27], s17 offen  lds
    s_add_u32 m0, m0, 1024
    s_add_u32 s17, s70, 327680
    buffer_load_dwordx4 v14, s[24:27], s17 offen  lds
    s_add_u32 m0, m0, 1024
    s_add_u32 s17, s70, 360448
    buffer_load_dwordx4 v15, s[24:27], s17 offen  lds
    s_add_u32 m0, s72, 28672
    s_add_u32 s17, s70, 393216
    buffer_load_dwordx4 v12, s[20:23], s17 offen  lds
    s_add_u32 m0, m0, 1024
    s_add_u32 s17, s70, 425984
    buffer_load_dwordx4 v13, s[20:23], s17 offen  lds
    s_add_u32 m0, m0, 1024
    s_add_u32 s17, s70, 458752
    buffer_load_dwordx4 v14, s[20:23], s17 offen  lds
    s_add_u32 m0, m0, 1024
    s_add_u32 s17, s70, 491520
    buffer_load_dwordx4 v15, s[20:23], s17 offen  lds
    s_add_u32 m0, s72, 32768
    s_add_u32 s17, s71, 256
    buffer_load_dwordx4 v17, s[76:79], s17 offen lds
    s_add_u32 m0, m0, 1024
    s_add_u32 s17, s71, 37120
    buffer_load_dwordx4 v17, s[76:79], s17 offen lds
    s_waitcnt vmcnt(30)
    s_barrier
    ds_read_b64_tr_b16 v[72:73], v18 offset:0
    ds_read_b64_tr_b16 v[74:75], v18 offset:512
    ds_read_b64_tr_b16 v[76:77], v19 offset:0
    ds_read_b64_tr_b16 v[78:79], v19 offset:512
    ds_read_b64_tr_b16 v[80:81], v20 offset:0
    ds_read_b64_tr_b16 v[82:83], v20 offset:512
    ds_read_b64_tr_b16 v[84:85], v21 offset:0
    ds_read_b64_tr_b16 v[86:87], v21 offset:512
    s_waitcnt lgkmcnt(0)
    s_waitcnt vmcnt(26)
    s_barrier
    s_add_u32 m0, s72, 0
    s_add_u32 s17, s70, 393216
    buffer_load_dwordx4 v12, s[24:27], s17 offen  lds
    s_add_u32 m0, m0, 1024
    s_add_u32 s17, s70, 425984
    buffer_load_dwordx4 v13, s[24:27], s17 offen  lds
    s_add_u32 m0, m0, 1024
    s_add_u32 s17, s70, 458752
    buffer_load_dwordx4 v14, s[24:27], s17 offen  lds
    s_add_u32 m0, m0, 1024
    s_add_u32 s17, s70, 491520
    buffer_load_dwordx4 v15, s[24:27], s17 offen  lds
    ds_read_b64_tr_b16 v[184:185], v18 offset:4096
    ds_read_b64_tr_b16 v[186:187], v18 offset:4608
    ds_read_b64_tr_b16 v[188:189], v19 offset:4096
    ds_read_b64_tr_b16 v[190:191], v19 offset:4608
    ds_read_b64_tr_b16 v[192:193], v20 offset:4096
    ds_read_b64_tr_b16 v[194:195], v20 offset:4608
    ds_read_b64_tr_b16 v[196:197], v21 offset:4096
    ds_read_b64_tr_b16 v[198:199], v21 offset:4608
    s_waitcnt lgkmcnt(0)
    s_waitcnt vmcnt(26)
    s_barrier
    s_add_u32 m0, s72, 4096
    s_add_u32 s17, s70, 393216
    buffer_load_dwordx4 v12, s[28:31], s17 offen  lds
    s_add_u32 m0, m0, 1024
    s_add_u32 s17, s70, 425984
    buffer_load_dwordx4 v13, s[28:31], s17 offen  lds
    s_add_u32 m0, m0, 1024
    s_add_u32 s17, s70, 458752
    buffer_load_dwordx4 v14, s[28:31], s17 offen  lds
    s_add_u32 m0, m0, 1024
    s_add_u32 s17, s70, 491520
    buffer_load_dwordx4 v15, s[28:31], s17 offen  lds
    ds_read_b64_tr_b16 v[88:89], v18 offset:8192
    ds_read_b64_tr_b16 v[90:91], v18 offset:8704
    ds_read_b64_tr_b16 v[92:93], v19 offset:8192
    ds_read_b64_tr_b16 v[94:95], v19 offset:8704
    ds_read_b64_tr_b16 v[96:97], v20 offset:8192
    ds_read_b64_tr_b16 v[98:99], v20 offset:8704
    ds_read_b64_tr_b16 v[100:101], v21 offset:8192
    ds_read_b64_tr_b16 v[102:103], v21 offset:8704
    s_waitcnt lgkmcnt(0)
    s_waitcnt vmcnt(26)
    s_barrier
    s_add_u32 m0, s72, 8192
    s_add_u32 s17, s70, 524288
    buffer_load_dwordx4 v12, s[24:27], s17 offen  lds
    s_add_u32 m0, m0, 1024
    s_add_u32 s17, s70, 557056
    buffer_load_dwordx4 v13, s[24:27], s17 offen  lds
    s_add_u32 m0, m0, 1024
    s_add_u32 s17, s70, 589824
    buffer_load_dwordx4 v14, s[24:27], s17 offen  lds
    s_add_u32 m0, m0, 1024
    s_add_u32 s17, s70, 622592
    buffer_load_dwordx4 v15, s[24:27], s17 offen  lds
    ds_read_b64_tr_b16 v[200:201], v18 offset:12288
    ds_read_b64_tr_b16 v[202:203], v18 offset:12800
    ds_read_b64_tr_b16 v[204:205], v19 offset:12288
    ds_read_b64_tr_b16 v[206:207], v19 offset:12800
    ds_read_b64_tr_b16 v[208:209], v20 offset:12288
    ds_read_b64_tr_b16 v[210:211], v20 offset:12800
    ds_read_b64_tr_b16 v[212:213], v21 offset:12288
    ds_read_b64_tr_b16 v[214:215], v21 offset:12800
    s_waitcnt lgkmcnt(0)
    s_waitcnt vmcnt(26)
    s_barrier
    s_add_u32 m0, s72, 12288
    s_add_u32 s17, s70, 524288
    buffer_load_dwordx4 v12, s[28:31], s17 offen  lds
    s_add_u32 m0, m0, 1024
    s_add_u32 s17, s70, 557056
    buffer_load_dwordx4 v13, s[28:31], s17 offen  lds
    s_add_u32 m0, m0, 1024
    s_add_u32 s17, s70, 589824
    buffer_load_dwordx4 v14, s[28:31], s17 offen  lds
    s_add_u32 m0, m0, 1024
    s_add_u32 s17, s70, 622592
    buffer_load_dwordx4 v15, s[28:31], s17 offen  lds
    ds_read_b64_tr_b16 a[72:73], v18 offset:16384
    ds_read_b64_tr_b16 a[74:75], v18 offset:16896
    ds_read_b64_tr_b16 a[76:77], v19 offset:16384
    ds_read_b64_tr_b16 a[78:79], v19 offset:16896
    ds_read_b64_tr_b16 a[80:81], v20 offset:16384
    ds_read_b64_tr_b16 a[82:83], v20 offset:16896
    ds_read_b64_tr_b16 a[84:85], v21 offset:16384
    ds_read_b64_tr_b16 a[86:87], v21 offset:16896
    s_waitcnt lgkmcnt(0)
    s_waitcnt vmcnt(26)
    s_barrier
    s_add_u32 m0, s72, 16384
    s_add_u32 s17, s70, 655360
    buffer_load_dwordx4 v12, s[20:23], s17 offen  lds
    s_add_u32 m0, m0, 1024
    s_add_u32 s17, s70, 688128
    buffer_load_dwordx4 v13, s[20:23], s17 offen  lds
    s_add_u32 m0, m0, 1024
    s_add_u32 s17, s70, 720896
    buffer_load_dwordx4 v14, s[20:23], s17 offen  lds
    s_add_u32 m0, m0, 1024
    s_add_u32 s17, s70, 753664
    buffer_load_dwordx4 v15, s[20:23], s17 offen  lds
    ds_read_b64_tr_b16 v[104:105], v18 offset:20480
    ds_read_b64_tr_b16 v[106:107], v18 offset:20992
    ds_read_b64_tr_b16 v[108:109], v19 offset:20480
    ds_read_b64_tr_b16 v[110:111], v19 offset:20992
    ds_read_b64_tr_b16 v[112:113], v20 offset:20480
    ds_read_b64_tr_b16 v[114:115], v20 offset:20992
    ds_read_b64_tr_b16 v[116:117], v21 offset:20480
    ds_read_b64_tr_b16 v[118:119], v21 offset:20992
    s_waitcnt lgkmcnt(0)
    s_waitcnt vmcnt(26)
    s_barrier
    s_add_u32 m0, s72, 20480
    s_add_u32 s17, s70, 655360
    buffer_load_dwordx4 v12, s[24:27], s17 offen  lds
    s_add_u32 m0, m0, 1024
    s_add_u32 s17, s70, 688128
    buffer_load_dwordx4 v13, s[24:27], s17 offen  lds
    s_add_u32 m0, m0, 1024
    s_add_u32 s17, s70, 720896
    buffer_load_dwordx4 v14, s[24:27], s17 offen  lds
    s_add_u32 m0, m0, 1024
    s_add_u32 s17, s70, 753664
    buffer_load_dwordx4 v15, s[24:27], s17 offen  lds
    ds_read_b64_tr_b16 v[216:217], v18 offset:24576
    ds_read_b64_tr_b16 v[218:219], v18 offset:25088
    ds_read_b64_tr_b16 v[220:221], v19 offset:24576
    ds_read_b64_tr_b16 v[222:223], v19 offset:25088
    ds_read_b64_tr_b16 v[224:225], v20 offset:24576
    ds_read_b64_tr_b16 v[226:227], v20 offset:25088
    ds_read_b64_tr_b16 v[228:229], v21 offset:24576
    ds_read_b64_tr_b16 v[230:231], v21 offset:25088
    s_waitcnt lgkmcnt(0)
    s_waitcnt vmcnt(26)
    s_barrier
    s_add_u32 m0, s72, 24576
    s_add_u32 s17, s70, 655360
    buffer_load_dwordx4 v12, s[28:31], s17 offen  lds
    s_add_u32 m0, m0, 1024
    s_add_u32 s17, s70, 688128
    buffer_load_dwordx4 v13, s[28:31], s17 offen  lds
    s_add_u32 m0, m0, 1024
    s_add_u32 s17, s70, 720896
    buffer_load_dwordx4 v14, s[28:31], s17 offen  lds
    s_add_u32 m0, m0, 1024
    s_add_u32 s17, s70, 753664
    buffer_load_dwordx4 v15, s[28:31], s17 offen  lds
    ds_read_b64_tr_b16 v[120:121], v18 offset:28672
    ds_read_b64_tr_b16 v[122:123], v18 offset:29184
    ds_read_b64_tr_b16 v[124:125], v19 offset:28672
    ds_read_b64_tr_b16 v[126:127], v19 offset:29184
    ds_read_b64_tr_b16 v[128:129], v20 offset:28672
    ds_read_b64_tr_b16 v[130:131], v20 offset:29184
    ds_read_b64_tr_b16 v[132:133], v21 offset:28672
    ds_read_b64_tr_b16 v[134:135], v21 offset:29184
    s_waitcnt lgkmcnt(0)
    s_waitcnt vmcnt(24)
    s_barrier
    s_add_u32 m0, s72, 28672
    s_add_u32 s17, s70, 786432
    buffer_load_dwordx4 v12, s[24:27], s17 offen  lds
    s_add_u32 m0, m0, 1024
    s_add_u32 s17, s70, 819200
    buffer_load_dwordx4 v13, s[24:27], s17 offen  lds
    s_add_u32 m0, m0, 1024
    s_add_u32 s17, s70, 851968
    buffer_load_dwordx4 v14, s[24:27], s17 offen  lds
    s_add_u32 m0, m0, 1024
    s_add_u32 s17, s70, 884736
    buffer_load_dwordx4 v15, s[24:27], s17 offen  lds
    ds_read_b64_tr_b16 v[232:233], v18 offset:0
    ds_read_b64_tr_b16 v[234:235], v18 offset:512
    ds_read_b64_tr_b16 v[236:237], v19 offset:0
    ds_read_b64_tr_b16 v[238:239], v19 offset:512
    ds_read_b64_tr_b16 v[240:241], v20 offset:0
    ds_read_b64_tr_b16 v[242:243], v20 offset:512
    ds_read_b64_tr_b16 v[244:245], v21 offset:0
    ds_read_b64_tr_b16 v[246:247], v21 offset:512
    s_waitcnt lgkmcnt(0)
    s_waitcnt vmcnt(24)
    s_barrier
    s_add_u32 m0, s72, 0
    s_add_u32 s17, s70, 786432
    buffer_load_dwordx4 v12, s[28:31], s17 offen  lds
    s_add_u32 m0, m0, 1024
    s_add_u32 s17, s70, 819200
    buffer_load_dwordx4 v13, s[28:31], s17 offen  lds
    s_add_u32 m0, m0, 1024
    s_add_u32 s17, s70, 851968
    buffer_load_dwordx4 v14, s[28:31], s17 offen  lds
    s_add_u32 m0, m0, 1024
    s_add_u32 s17, s70, 884736
    buffer_load_dwordx4 v15, s[28:31], s17 offen  lds
    ds_read_b64_tr_b16 a[88:89], v18 offset:4096
    ds_read_b64_tr_b16 a[90:91], v18 offset:4608
    ds_read_b64_tr_b16 a[92:93], v19 offset:4096
    ds_read_b64_tr_b16 a[94:95], v19 offset:4608
    ds_read_b64_tr_b16 a[96:97], v20 offset:4096
    ds_read_b64_tr_b16 a[98:99], v20 offset:4608
    ds_read_b64_tr_b16 a[100:101], v21 offset:4096
    ds_read_b64_tr_b16 a[102:103], v21 offset:4608
    s_waitcnt lgkmcnt(0)
    s_waitcnt vmcnt(24)
    s_barrier
    s_add_u32 m0, s72, 4096
    s_add_u32 s17, s70, 917504
    buffer_load_dwordx4 v12, s[20:23], s17 offen  lds
    s_add_u32 m0, m0, 1024
    s_add_u32 s17, s70, 950272
    buffer_load_dwordx4 v13, s[20:23], s17 offen  lds
    s_add_u32 m0, m0, 1024
    s_add_u32 s17, s70, 983040
    buffer_load_dwordx4 v14, s[20:23], s17 offen  lds
    s_add_u32 m0, m0, 1024
    s_add_u32 s17, s70, 1015808
    buffer_load_dwordx4 v15, s[20:23], s17 offen  lds
    ds_read_b64_tr_b16 v[248:249], v18 offset:8192
    ds_read_b64_tr_b16 v[250:251], v18 offset:8704
    ds_read_b64_tr_b16 v[252:253], v19 offset:8192
    ds_read_b64_tr_b16 v[254:255], v19 offset:8704
    ds_read_b64_tr_b16 a[0:1], v20 offset:8192
    ds_read_b64_tr_b16 a[2:3], v20 offset:8704
    ds_read_b64_tr_b16 a[4:5], v21 offset:8192
    ds_read_b64_tr_b16 a[6:7], v21 offset:8704
    s_waitcnt lgkmcnt(0)
    s_waitcnt vmcnt(24)
    s_barrier
    s_add_u32 m0, s72, 8192
    s_add_u32 s17, s70, 917504
    buffer_load_dwordx4 v12, s[24:27], s17 offen  lds
    s_add_u32 m0, m0, 1024
    s_add_u32 s17, s70, 950272
    buffer_load_dwordx4 v13, s[24:27], s17 offen  lds
    s_add_u32 m0, m0, 1024
    s_add_u32 s17, s70, 983040
    buffer_load_dwordx4 v14, s[24:27], s17 offen  lds
    s_add_u32 m0, m0, 1024
    s_add_u32 s17, s70, 1015808
    buffer_load_dwordx4 v15, s[24:27], s17 offen  lds
    ds_read_b64_tr_b16 a[104:105], v18 offset:12288
    ds_read_b64_tr_b16 a[106:107], v18 offset:12800
    ds_read_b64_tr_b16 a[108:109], v19 offset:12288
    ds_read_b64_tr_b16 a[110:111], v19 offset:12800
    ds_read_b64_tr_b16 a[112:113], v20 offset:12288
    ds_read_b64_tr_b16 a[114:115], v20 offset:12800
    ds_read_b64_tr_b16 a[116:117], v21 offset:12288
    ds_read_b64_tr_b16 a[118:119], v21 offset:12800
    s_waitcnt lgkmcnt(0)
    s_waitcnt vmcnt(24)
    s_barrier
    s_add_u32 m0, s72, 12288
    s_add_u32 s17, s70, 917504
    buffer_load_dwordx4 v12, s[28:31], s17 offen  lds
    s_add_u32 m0, m0, 1024
    s_add_u32 s17, s70, 950272
    buffer_load_dwordx4 v13, s[28:31], s17 offen  lds
    s_add_u32 m0, m0, 1024
    s_add_u32 s17, s70, 983040
    buffer_load_dwordx4 v14, s[28:31], s17 offen  lds
    s_add_u32 m0, m0, 1024
    s_add_u32 s17, s70, 1015808
    buffer_load_dwordx4 v15, s[28:31], s17 offen  lds
    ds_read_b64_tr_b16 v[136:137], v18 offset:16384
    ds_read_b64_tr_b16 v[138:139], v18 offset:16896
    ds_read_b64_tr_b16 v[140:141], v19 offset:16384
    ds_read_b64_tr_b16 v[142:143], v19 offset:16896
    ds_read_b64_tr_b16 v[144:145], v20 offset:16384
    ds_read_b64_tr_b16 v[146:147], v20 offset:16896
    ds_read_b64_tr_b16 v[148:149], v21 offset:16384
    ds_read_b64_tr_b16 v[150:151], v21 offset:16896
    s_waitcnt lgkmcnt(0)
    s_add_u32 s17, s32, s14
    s_cmp_lg_u32 s17, 0
    s_cbranch_scc1 Lr_nold
    v_mov_b32 v63, 48
    v_mov_b32 v64, 1
    s_mov_b64 exec, 1
    global_atomic_add v63, v64, s[12:13]
    s_mov_b64 exec, -1
Lr_nold:
    s_waitcnt vmcnt(24)
    s_barrier
    s_add_u32 m0, s72, 16384
    s_add_u32 s17, s70, 1048576
    buffer_load_dwordx4 v12, s[20:23], s17 offen  lds
    s_add_u32 m0, m0, 1024
    s_add_u32 s17, s70, 1081344
    buffer_load_dwordx4 v13, s[20:23], s17 offen  lds
    s_add_u32 m0, m0, 1024
    s_add_u32 s17, s70, 1114112
    buffer_load_dwordx4 v14, s[20:23], s17 offen  lds
    s_add_u32 m0, m0, 1024
    s_add_u32 s17, s70, 1146880
    buffer_load_dwordx4 v15, s[20:23], s17 offen  lds
    ds_read_b64_tr_b16 a[8:9], v18 offset:20480
    ds_read_b64_tr_b16 a[10:11], v18 offset:20992
    ds_read_b64_tr_b16 a[12:13], v19 offset:20480
    ds_read_b64_tr_b16 a[14:15], v19 offset:20992
    ds_read_b64_tr_b16 a[16:17], v20 offset:20480
    ds_read_b64_tr_b16 a[18:19], v20 offset:20992
    ds_read_b64_tr_b16 a[20:21], v21 offset:20480
    ds_read_b64_tr_b16 a[22:23], v21 offset:20992
    s_waitcnt lgkmcnt(0)
    s_waitcnt vmcnt(24)
    s_barrier
    s_add_u32 m0, s72, 20480
    s_add_u32 s17, s70, 1048576
    buffer_load_dwordx4 v12, s[24:27], s17 offen  lds
    s_add_u32 m0, m0, 1024
    s_add_u32 s17, s70, 1081344
    buffer_load_dwordx4 v13, s[24:27], s17 offen  lds
    s_add_u32 m0, m0, 1024
    s_add_u32 s17, s70, 1114112
    buffer_load_dwordx4 v14, s[24:27], s17 offen  lds
    s_add_u32 m0, m0, 1024
    s_add_u32 s17, s70, 1146880
    buffer_load_dwordx4 v15, s[24:27], s17 offen  lds
    ds_read_b64_tr_b16 a[120:121], v18 offset:24576
    ds_read_b64_tr_b16 a[122:123], v18 offset:25088
    ds_read_b64_tr_b16 a[124:125], v19 offset:24576
    ds_read_b64_tr_b16 a[126:127], v19 offset:25088
    ds_read_b64_tr_b16 a[128:129], v20 offset:24576
    ds_read_b64_tr_b16 a[130:131], v20 offset:25088
    ds_read_b64_tr_b16 a[132:133], v21 offset:24576
    ds_read_b64_tr_b16 a[134:135], v21 offset:25088
    s_waitcnt lgkmcnt(0)
    s_waitcnt vmcnt(24)
    s_barrier
    s_add_u32 m0, s72, 24576
    s_add_u32 s17, s70, 1048576
    buffer_load_dwordx4 v12, s[28:31], s17 offen  lds
    s_add_u32 m0, m0, 1024
    s_add_u32 s17, s70, 1081344
    buffer_load_dwordx4 v13, s[28:31], s17 offen  lds
    s_add_u32 m0, m0, 1024
    s_add_u32 s17, s70, 1114112
    buffer_load_dwordx4 v14, s[28:31], s17 offen  lds
    s_add_u32 m0, m0, 1024
    s_add_u32 s17, s70, 1146880
    buffer_load_dwordx4 v15, s[28:31], s17 offen  lds
    ds_read_b64_tr_b16 a[24:25], v18 offset:28672
    ds_read_b64_tr_b16 a[26:27], v18 offset:29184
    ds_read_b64_tr_b16 a[28:29], v19 offset:28672
    ds_read_b64_tr_b16 a[30:31], v19 offset:29184
    ds_read_b64_tr_b16 a[32:33], v20 offset:28672
    ds_read_b64_tr_b16 a[34:35], v20 offset:29184
    ds_read_b64_tr_b16 a[36:37], v21 offset:28672
    ds_read_b64_tr_b16 a[38:39], v21 offset:29184
    s_waitcnt lgkmcnt(0)
    s_waitcnt vmcnt(24)
    s_barrier
    ds_read_b64_tr_b16 a[136:137], v18 offset:0
    ds_read_b64_tr_b16 a[138:139], v18 offset:512
    ds_read_b64_tr_b16 a[140:141], v19 offset:0
    ds_read_b64_tr_b16 a[142:143], v19 offset:512
    ds_read_b64_tr_b16 a[144:145], v20 offset:0
    ds_read_b64_tr_b16 a[146:147], v20 offset:512
    ds_read_b64_tr_b16 a[148:149], v21 offset:0
    ds_read_b64_tr_b16 a[150:151], v21 offset:512
    s_waitcnt lgkmcnt(0)
    s_waitcnt vmcnt(20)
    s_barrier
    s_add_u32 m0, s72, 0
    s_add_u32 s17, s70, 0
    buffer_load_dwordx4 v12, s[28:31], s17 offen  lds
    s_add_u32 m0, m0, 1024
    s_add_u32 s17, s70, 32768
    buffer_load_dwordx4 v13, s[28:31], s17 offen  lds
    s_add_u32 m0, m0, 1024
    s_add_u32 s17, s70, 65536
    buffer_load_dwordx4 v14, s[28:31], s17 offen  lds
    s_add_u32 m0, m0, 1024
    s_add_u32 s17, s70, 98304
    buffer_load_dwordx4 v15, s[28:31], s17 offen  lds
    ds_read_b64_tr_b16 v[152:153], v18 offset:4096
    ds_read_b64_tr_b16 v[154:155], v18 offset:4608
    ds_read_b64_tr_b16 v[156:157], v19 offset:4096
    ds_read_b64_tr_b16 v[158:159], v19 offset:4608
    ds_read_b64_tr_b16 v[160:161], v20 offset:4096
    ds_read_b64_tr_b16 v[162:163], v20 offset:4608
    ds_read_b64_tr_b16 v[164:165], v21 offset:4096
    ds_read_b64_tr_b16 v[166:167], v21 offset:4608
    s_waitcnt lgkmcnt(0)
    s_waitcnt vmcnt(20)
    s_barrier
    s_add_u32 m0, s72, 4096
    s_add_u32 s17, s70, 262144
    buffer_load_dwordx4 v12, s[28:31], s17 offen  lds
    s_add_u32 m0, m0, 1024
    s_add_u32 s17, s70, 294912
    buffer_load_dwordx4 v13, s[28:31], s17 offen  lds
    s_add_u32 m0, m0, 1024
    s_add_u32 s17, s70, 327680
    buffer_load_dwordx4 v14, s[28:31], s17 offen  lds
    s_add_u32 m0, m0, 1024
    s_add_u32 s17, s70, 360448
    buffer_load_dwordx4 v15, s[28:31], s17 offen  lds
    ds_read_b64_tr_b16 a[40:41], v18 offset:8192
    ds_read_b64_tr_b16 a[42:43], v18 offset:8704
    ds_read_b64_tr_b16 a[44:45], v19 offset:8192
    ds_read_b64_tr_b16 a[46:47], v19 offset:8704
    ds_read_b64_tr_b16 a[48:49], v20 offset:8192
    ds_read_b64_tr_b16 a[50:51], v20 offset:8704
    ds_read_b64_tr_b16 a[52:53], v21 offset:8192
    ds_read_b64_tr_b16 a[54:55], v21 offset:8704
    s_waitcnt lgkmcnt(0)
    s_waitcnt vmcnt(20)
    s_barrier
    s_add_u32 m0, s72, 8192
    s_add_u32 s17, s70, 524288
    buffer_load_dwordx4 v12, s[20:23], s17 offen  lds
    s_add_u32 m0, m0, 1024
    s_add_u32 s17, s70, 557056
    buffer_load_dwordx4 v13, s[20:23], s17 offen  lds
    s_add_u32 m0, m0, 1024
    s_add_u32 s17, s70, 589824
    buffer_load_dwordx4 v14, s[20:23], s17 offen  lds
    s_add_u32 m0, m0, 1024
    s_add_u32 s17, s70, 622592
    buffer_load_dwordx4 v15, s[20:23], s17 offen  lds
    ds_read_b64_tr_b16 a[152:153], v18 offset:12288
    ds_read_b64_tr_b16 a[154:155], v18 offset:12800
    ds_read_b64_tr_b16 a[156:157], v19 offset:12288
    ds_read_b64_tr_b16 a[158:159], v19 offset:12800
    ds_read_b64_tr_b16 a[160:161], v20 offset:12288
    ds_read_b64_tr_b16 a[162:163], v20 offset:12800
    ds_read_b64_tr_b16 a[164:165], v21 offset:12288
    ds_read_b64_tr_b16 a[166:167], v21 offset:12800
    s_waitcnt lgkmcnt(0)
    s_waitcnt vmcnt(20)
    s_barrier
    s_add_u32 m0, s72, 12288
    s_add_u32 s17, s70, 786432
    buffer_load_dwordx4 v12, s[20:23], s17 offen  lds
    s_add_u32 m0, m0, 1024
    s_add_u32 s17, s70, 819200
    buffer_load_dwordx4 v13, s[20:23], s17 offen  lds
    s_add_u32 m0, m0, 1024
    s_add_u32 s17, s70, 851968
    buffer_load_dwordx4 v14, s[20:23], s17 offen  lds
    s_add_u32 m0, m0, 1024
    s_add_u32 s17, s70, 884736
    buffer_load_dwordx4 v15, s[20:23], s17 offen  lds
    ds_read_b64_tr_b16 v[168:169], v18 offset:16384
    ds_read_b64_tr_b16 v[170:171], v18 offset:16896
    ds_read_b64_tr_b16 v[172:173], v19 offset:16384
    ds_read_b64_tr_b16 v[174:175], v19 offset:16896
    ds_read_b64_tr_b16 v[176:177], v20 offset:16384
    ds_read_b64_tr_b16 v[178:179], v20 offset:16896
    ds_read_b64_tr_b16 v[180:181], v21 offset:16384
    ds_read_b64_tr_b16 v[182:183], v21 offset:16896
    s_waitcnt lgkmcnt(0)
    s_waitcnt vmcnt(20)
    s_barrier
    s_add_u32 m0, s72, 16384
    s_add_u32 s17, s71, 0
    buffer_load_dwordx4 v16, s[76:79], s17 offen  lds
    s_add_u32 m0, m0, 1024
    s_add_u32 s17, s71, 18432
    buffer_load_dwordx4 v16, s[76:79], s17 offen  lds
    s_add_u32 m0, m0, 1024
    s_add_u32 s17, s71, 36864
    buffer_load_dwordx4 v16, s[76:79], s17 offen  lds
    s_add_u32 m0, m0, 1024
    s_add_u32 s17, s71, 55296
    buffer_load_dwordx4 v16, s[76:79], s17 offen  lds
    ds_read_b64_tr_b16 a[56:57], v18 offset:20480
    ds_read_b64_tr_b16 a[58:59], v18 offset:20992
    ds_read_b64_tr_b16 a[60:61], v19 offset:20480
    ds_read_b64_tr_b16 a[62:63], v19 offset:20992
    ds_read_b64_tr_b16 a[64:65], v20 offset:20480
    ds_read_b64_tr_b16 a[66:67], v20 offset:20992
    ds_read_b64_tr_b16 a[68:69], v21 offset:20480
    ds_read_b64_tr_b16 a[70:71], v21 offset:20992
    s_waitcnt lgkmcnt(0)
    s_waitcnt vmcnt(20)
    s_barrier
    s_add_u32 m0, s72, 20480
    s_add_u32 s17, s71, 73728
    buffer_load_dwordx4 v16, s[76:79], s17 offen  lds
    s_add_u32 m0, m0, 1024
    s_add_u32 s17, s71, 92160
    buffer_load_dwordx4 v16, s[76:79], s17 offen  lds
    s_add_u32 m0, m0, 1024
    s_add_u32 s17, s71, 110592
    buffer_load_dwordx4 v16, s[76:79], s17 offen  lds
    s_add_u32 m0, m0, 1024
    s_add_u32 s17, s71, 129024
    buffer_load_dwordx4 v16, s[76:79], s17 offen  lds
    ds_read_b64_tr_b16 a[168:169], v18 offset:24576
    ds_read_b64_tr_b16 a[170:171], v18 offset:25088
    ds_read_b64_tr_b16 a[172:173], v19 offset:24576
    ds_read_b64_tr_b16 a[174:175], v19 offset:25088
    ds_read_b64_tr_b16 a[176:177], v20 offset:24576
    ds_read_b64_tr_b16 a[178:179], v20 offset:25088
    ds_read_b64_tr_b16 a[180:181], v21 offset:24576
    ds_read_b64_tr_b16 a[182:183], v21 offset:25088
    s_waitcnt lgkmcnt(0)
    s_waitcnt vmcnt(20)
    s_barrier
    s_add_u32 m0, s72, 24576
    s_add_u32 s17, s71, 64
    buffer_load_dwordx4 v16, s[76:79], s17 offen  lds
    s_add_u32 m0, m0, 1024
    s_add_u32 s17, s71, 18496
    buffer_load_dwordx4 v16, s[76:79], s17 offen  lds
    s_add_u32 m0, m0, 1024
    s_add_u32 s17, s71, 36928
    buffer_load_dwordx4 v16, s[76:79], s17 offen  lds
    s_add_u32 m0, m0, 1024
    s_add_u32 s17, s71, 55360
    buffer_load_dwordx4 v16, s[76:79], s17 offen  lds
    s_add_u32 m0, s72, 28672
    s_add_u32 s17, s71, 73792
    buffer_load_dwordx4 v16, s[76:79], s17 offen  lds
    s_add_u32 m0, m0, 1024
    s_add_u32 s17, s71, 92224
    buffer_load_dwordx4 v16, s[76:79], s17 offen  lds
    s_add_u32 m0, m0, 1024
    s_add_u32 s17, s71, 110656
    buffer_load_dwordx4 v16, s[76:79], s17 offen  lds
    s_add_u32 m0, m0, 1024
    s_add_u32 s17, s71, 129088
    buffer_load_dwordx4 v16, s[76:79], s17 offen  lds
    ds_read_b64_tr_b16 v[24:25], v18 offset:0
    ds_read_b64_tr_b16 v[26:27], v18 offset:512
    ds_read_b64_tr_b16 v[28:29], v19 offset:0
    ds_read_b64_tr_b16 v[30:31], v19 offset:512
    ds_read_b64_tr_b16 v[32:33], v20 offset:0
    ds_read_b64_tr_b16 v[34:35], v20 offset:512
    ds_read_b64_tr_b16 v[36:37], v21 offset:0
    ds_read_b64_tr_b16 v[38:39], v21 offset:512
    s_waitcnt lgkmcnt(0)
    s_barrier
    ds_write_b128 v8, v[24:27] offset:0
    ds_write_b128 v8, v[28:31] offset:1024
    ds_write_b128 v8, v[32:35] offset:2048
    ds_write_b128 v8, v[36:39] offset:3072
    s_waitcnt lgkmcnt(0)
    s_waitcnt vmcnt(24)
    s_barrier
    ds_read_b64_tr_b16 v[24:25], v18 offset:4096
    ds_read_b64_tr_b16 v[26:27], v18 offset:4608
    ds_read_b64_tr_b16 v[28:29], v19 offset:4096
    ds_read_b64_tr_b16 v[30:31], v19 offset:4608
    ds_read_b64_tr_b16 v[32:33], v20 offset:4096
    ds_read_b64_tr_b16 v[34:35], v20 offset:4608
    ds_read_b64_tr_b16 v[36:37], v21 offset:4096
    ds_read_b64_tr_b16 v[38:39], v21 offset:4608
    s_waitcnt lgkmcnt(0)
    s_barrier
    ds_write_b128 v8, v[24:27] offset:4096
    ds_write_b128 v8, v[28:31] offset:5120
    ds_write_b128 v8, v[32:35] offset:6144
    ds_write_b128 v8, v[36:39] offset:7168
    s_waitcnt lgkmcnt(0)
    s_waitcnt vmcnt(20)
    s_barrier
    ds_read_b64_tr_b16 v[24:25], v18 offset:8192
    ds_read_b64_tr_b16 v[26:27], v18 offset:8704
    ds_read_b64_tr_b16 v[28:29], v19 offset:8192
    ds_read_b64_tr_b16 v[30:31], v19 offset:8704
    ds_read_b64_tr_b16 v[32:33], v20 offset:8192
    ds_read_b64_tr_b16 v[34:35], v20 offset:8704
    ds_read_b64_tr_b16 v[36:37], v21 offset:8192
    ds_read_b64_tr_b16 v[38:39], v21 offset:8704
    s_waitcnt lgkmcnt(0)
    s_barrier
    ds_write_b128 v8, v[24:27] offset:8192
    ds_write_b128 v8, v[28:31] offset:9216
    ds_write_b128 v8, v[32:35] offset:10240
    ds_write_b128 v8, v[36:39] offset:11264
    s_waitcnt lgkmcnt(0)
    s_waitcnt vmcnt(16)
    s_barrier
    ds_read_b64_tr_b16 v[24:25], v18 offset:12288
    ds_read_b64_tr_b16 v[26:27], v18 offset:12800
    ds_read_b64_tr_b16 v[28:29], v19 offset:12288
    ds_read_b64_tr_b16 v[30:31], v19 offset:12800
    ds_read_b64_tr_b16 v[32:33], v20 offset:12288
    ds_read_b64_tr_b16 v[34:35], v20 offset:12800
    ds_read_b64_tr_b16 v[36:37], v21 offset:12288
    ds_read_b64_tr_b16 v[38:39], v21 offset:12800
    s_waitcnt lgkmcnt(0)
    s_barrier
    ds_write_b128 v8, v[24:27] offset:12288
    ds_write_b128 v8, v[28:31] offset:13312
    ds_write_b128 v8, v[32:35] offset:14336
    ds_write_b128 v8, v[36:39] offset:15360
    s_waitcnt lgkmcnt(0)
    s_barrier
    s_waitcnt vmcnt(12)
    ds_read_b64_tr_b16 a[184:185], v22 offset:16384
    ds_read_b64_tr_b16 a[186:187], v22 offset:16448
    ds_read_b64_tr_b16 a[188:189], v22 offset:18432
    ds_read_b64_tr_b16 a[190:191], v22 offset:18496
    ds_read_b64_tr_b16 a[200:201], v22 offset:16416
    ds_read_b64_tr_b16 a[202:203], v22 offset:16480
    ds_read_b64_tr_b16 a[204:205], v22 offset:18464
    ds_read_b64_tr_b16 a[206:207], v22 offset:18528
    s_waitcnt lgkmcnt(0)
    s_add_u32 m0, s72, 16384
    s_add_u32 s17, s71, 128
    buffer_load_dwordx4 v16, s[76:79], s17 offen  lds
    s_add_u32 m0, m0, 1024
    s_add_u32 s17, s71, 18560
    buffer_load_dwordx4 v16, s[76:79], s17 offen  lds
    s_add_u32 m0, m0, 1024
    s_add_u32 s17, s71, 36992
    buffer_load_dwordx4 v16, s[76:79], s17 offen  lds
    s_add_u32 m0, m0, 1024
    s_add_u32 s17, s71, 55424
    buffer_load_dwordx4 v16, s[76:79], s17 offen  lds
    s_waitcnt vmcnt(12)
    ds_read_b64_tr_b16 a[192:193], v22 offset:20480
    ds_read_b64_tr_b16 a[194:195], v22 offset:20544
    ds_read_b64_tr_b16 a[196:197], v22 offset:22528
    ds_read_b64_tr_b16 a[198:199], v22 offset:22592
    ds_read_b64_tr_b16 a[208:209], v22 offset:20512
    ds_read_b64_tr_b16 a[210:211], v22 offset:20576
    ds_read_b64_tr_b16 a[212:213], v22 offset:22560
    ds_read_b64_tr_b16 a[214:215], v22 offset:22624
    s_waitcnt lgkmcnt(0)
    s_add_u32 m0, s72, 20480
    s_add_u32 s17, s71, 73856
    buffer_load_dwordx4 v16, s[76:79], s17 offen  lds
    s_add_u32 m0, m0, 1024
    s_add_u32 s17, s71, 92288
    buffer_load_dwordx4 v16, s[76:79], s17 offen  lds
    s_add_u32 m0, m0, 1024
    s_add_u32 s17, s71, 110720
    buffer_load_dwordx4 v16, s[76:79], s17 offen  lds
    s_add_u32 m0, m0, 1024
    s_add_u32 s17, s71, 129152
    buffer_load_dwordx4 v16, s[76:79], s17 offen  lds
    s_waitcnt vmcnt(12)
    ds_read_b64_tr_b16 a[216:217], v22 offset:24576
    ds_read_b64_tr_b16 a[218:219], v22 offset:24640
    ds_read_b64_tr_b16 a[220:221], v22 offset:26624
    ds_read_b64_tr_b16 a[222:223], v22 offset:26688
    ds_read_b64_tr_b16 a[232:233], v22 offset:24608
    ds_read_b64_tr_b16 a[234:235], v22 offset:24672
    ds_read_b64_tr_b16 a[236:237], v22 offset:26656
    ds_read_b64_tr_b16 a[238:239], v22 offset:26720
    s_waitcnt lgkmcnt(0)
    s_add_u32 m0, s72, 24576
    s_add_u32 s17, s71, 192
    buffer_load_dwordx4 v16, s[76:79], s17 offen  lds
    s_add_u32 m0, m0, 1024
    s_add_u32 s17, s71, 18624
    buffer_load_dwordx4 v16, s[76:79], s17 offen  lds
    s_add_u32 m0, m0, 1024
    s_add_u32 s17, s71, 37056
    buffer_load_dwordx4 v16, s[76:79], s17 offen  lds
    s_add_u32 m0, m0, 1024
    s_add_u32 s17, s71, 55488
    buffer_load_dwordx4 v16, s[76:79], s17 offen  lds
    s_waitcnt vmcnt(12)
    ds_read_b64_tr_b16 a[224:225], v22 offset:28672
    ds_read_b64_tr_b16 a[226:227], v22 offset:28736
    ds_read_b64_tr_b16 a[228:229], v22 offset:30720
    ds_read_b64_tr_b16 a[230:231], v22 offset:30784
    ds_read_b64_tr_b16 a[240:241], v22 offset:28704
    ds_read_b64_tr_b16 a[242:243], v22 offset:28768
    ds_read_b64_tr_b16 a[244:245], v22 offset:30752
    ds_read_b64_tr_b16 a[246:247], v22 offset:30816
    s_waitcnt lgkmcnt(0)
    s_add_u32 m0, s72, 28672
    s_add_u32 s17, s71, 73920
    buffer_load_dwordx4 v16, s[76:79], s17 offen  lds
    s_add_u32 m0, m0, 1024
    s_add_u32 s17, s71, 92352
    buffer_load_dwordx4 v16, s[76:79], s17 offen  lds
    s_add_u32 m0, m0, 1024
    s_add_u32 s17, s71, 110784
    buffer_load_dwordx4 v16, s[76:79], s17 offen  lds
    s_add_u32 m0, m0, 1024
    s_add_u32 s17, s71, 129216
    buffer_load_dwordx4 v16, s[76:79], s17 offen  lds
    s_waitcnt vmcnt(63)
    ds_read_b64_tr_b16 a[248:249], v23 offset:32768
    ds_read_b64_tr_b16 a[250:251], v23 offset:32800
    ds_read_b64_tr_b16 a[252:253], v23 offset:33792
    ds_read_b64_tr_b16 a[254:255], v23 offset:33824
    s_waitcnt lgkmcnt(0)
    s_add_u32 m0, s72, 32768
    s_add_u32 s17, s71, 73984
    buffer_load_dwordx4 v17, s[76:79], s17 offen lds
    s_add_u32 m0, m0, 1024
    s_add_u32 s17, s71, 110848
    buffer_load_dwordx4 v17, s[76:79], s17 offen lds
    s_waitcnt vmcnt(14)
    ds_read_b64_tr_b16 v[24:25], v22 offset:16384
    ds_read_b64_tr_b16 v[26:27], v22 offset:16448
    ds_read_b64_tr_b16 v[28:29], v22 offset:18432
    ds_read_b64_tr_b16 v[30:31], v22 offset:18496
    ds_read_b64_tr_b16 v[32:33], v22 offset:16416
    ds_read_b64_tr_b16 v[34:35], v22 offset:16480
    ds_read_b64_tr_b16 v[36:37], v22 offset:18464
    ds_read_b64_tr_b16 v[38:39], v22 offset:18528
    s_waitcnt lgkmcnt(0)
    ds_write_b128 v8, v[24:27] offset:16384
    ds_write_b128 v8, v[28:31] offset:17408
    ds_write_b128 v8, v[32:35] offset:18432
    ds_write_b128 v8, v[36:39] offset:19456
    s_waitcnt lgkmcnt(0)
    s_waitcnt vmcnt(10)
    ds_read_b64_tr_b16 v[24:25], v22 offset:20480
    ds_read_b64_tr_b16 v[26:27], v22 offset:20544
    ds_read_b64_tr_b16 v[28:29], v22 offset:22528
    ds_read_b64_tr_b16 v[30:31], v22 offset:22592
    ds_read_b64_tr_b16 v[32:33], v22 offset:20512
    ds_read_b64_tr_b16 v[34:35], v22 offset:20576
    ds_read_b64_tr_b16 v[36:37], v22 offset:22560
    ds_read_b64_tr_b16 v[38:39], v22 offset:22624
    s_waitcnt lgkmcnt(0)
    ds_write_b128 v8, v[24:27] offset:20480
    ds_write_b128 v8, v[28:31] offset:21504
    ds_write_b128 v8, v[32:35] offset:22528
    ds_write_b128 v8, v[36:39] offset:23552
    s_waitcnt lgkmcnt(0)
    s_waitcnt vmcnt(6)
    ds_read_b64_tr_b16 v[24:25], v22 offset:24576
    ds_read_b64_tr_b16 v[26:27], v22 offset:24640
    ds_read_b64_tr_b16 v[28:29], v22 offset:26624
    ds_read_b64_tr_b16 v[30:31], v22 offset:26688
    ds_read_b64_tr_b16 v[32:33], v22 offset:24608
    ds_read_b64_tr_b16 v[34:35], v22 offset:24672
    ds_read_b64_tr_b16 v[36:37], v22 offset:26656
    ds_read_b64_tr_b16 v[38:39], v22 offset:26720
    s_waitcnt lgkmcnt(0)
    ds_write_b128 v8, v[24:27] offset:24576
    ds_write_b128 v8, v[28:31] offset:25600
    ds_write_b128 v8, v[32:35] offset:26624
    ds_write_b128 v8, v[36:39] offset:27648
    s_waitcnt lgkmcnt(0)
    s_waitcnt vmcnt(2)
    ds_read_b64_tr_b16 v[24:25], v22 offset:28672
    ds_read_b64_tr_b16 v[26:27], v22 offset:28736
    ds_read_b64_tr_b16 v[28:29], v22 offset:30720
    ds_read_b64_tr_b16 v[30:31], v22 offset:30784
    ds_read_b64_tr_b16 v[32:33], v22 offset:28704
    ds_read_b64_tr_b16 v[34:35], v22 offset:28768
    ds_read_b64_tr_b16 v[36:37], v22 offset:30752
    ds_read_b64_tr_b16 v[38:39], v22 offset:30816
    s_waitcnt lgkmcnt(0)
    ds_write_b128 v8, v[24:27] offset:28672
    ds_write_b128 v8, v[28:31] offset:29696
    ds_write_b128 v8, v[32:35] offset:30720
    ds_write_b128 v8, v[36:39] offset:31744
    s_waitcnt lgkmcnt(0)
    s_waitcnt vmcnt(0)
    ds_read_b64_tr_b16 v[24:25], v23 offset:32768
    ds_read_b64_tr_b16 v[26:27], v23 offset:32800
    ds_read_b64_tr_b16 v[28:29], v23 offset:33792
    ds_read_b64_tr_b16 v[30:31], v23 offset:33824
    s_waitcnt lgkmcnt(0)
    ds_write_b128 v8, v[24:27] offset:32768
    ds_write_b128 v8, v[28:31] offset:33792
    s_waitcnt lgkmcnt(0)
    v_bfe_u32 v9, v0, 4, 4
    v_mov_b32 v10, 0x3f80
    v_mov_b32 v16, 0x3f800000
    v_cmp_eq_u32 vcc, 0, v9
    v_cmp_eq_u32 s[48:49], 1, v9
    s_nop 0
    v_cndmask_b32 v12, 0, v10, vcc
    v_cndmask_b32 v12, v12, v16, s[48:49]
    v_cmp_eq_u32 vcc, 2, v9
    v_cmp_eq_u32 s[48:49], 3, v9
    s_nop 0
    v_cndmask_b32 v13, 0, v10, vcc
    v_cndmask_b32 v13, v13, v16, s[48:49]
    v_cmp_eq_u32 vcc, 4, v9
    v_cmp_eq_u32 s[48:49], 5, v9
    s_nop 0
    v_cndmask_b32 v14, 0, v10, vcc
    v_cndmask_b32 v14, v14, v16, s[48:49]
    v_cmp_eq_u32 vcc, 6, v9
    v_cmp_eq_u32 s[48:49], 7, v9
    s_nop 0
    v_cndmask_b32 v15, 0, v10, vcc
    v_cndmask_b32 v15, v15, v16, s[48:49]
    v_add_u32 v9, 162560, v0
    ds_write_b128 v9, v[12:15]
    s_waitcnt lgkmcnt(0)
    s_mov_b64 exec, 0x7ff
    v_lshrrev_b32 v14, 2, v0
    v_lshlrev_b32 v12, 5, v14
    v_and_b32 v12, 128, v12
    v_lshrrev_b32 v13, 1, v14
    v_and_or_b32 v12, v13, 12, v12
    s_lshl_b32 s6, s32, 2
    s_add_u32 s6, s6, 192
    v_writelane_b32 v12, s6, 8
    s_mov_b32 s6, 40
    v_writelane_b32 v12, s6, 9
    s_mov_b32 s6, 160
    v_writelane_b32 v12, s6, 10
    s_mov_b32 s16, 0
L_pure:
    global_load_dword v13, v12, s[12:13] sc1
    s_add_u32 s16, s16, 1
    s_cmp_gt_u32 s16, 100000
    s_cbranch_scc1 Lr_abort
    s_mov_b32 s6, 0
    s_waitcnt vmcnt(0)
    v_readlane_b32 s7, v13, 0
    s_nop 0
    s_add_u32 s6, s6, s7
    v_readlane_b32 s7, v13, 1
    s_nop 0
    s_add_u32 s6, s6, s7
    v_readlane_b32 s7, v13, 2
    s_nop 0
    s_add_u32 s6, s6, s7
    v_readlane_b32 s7, v13, 3
    s_nop 0
    s_add_u32 s6, s6, s7
    v_readlane_b32 s7, v13, 4
    s_nop 0
    s_add_u32 s6, s6, s7
    v_readlane_b32 s7, v13, 5
    s_nop 0
    s_add_u32 s6, s6, s7
    v_readlane_b32 s7, v13, 6
    s_nop 0
    s_add_u32 s6, s6, s7
    v_readlane_b32 s7, v13, 7
    s_nop 0
    s_add_u32 s6, s6, s7
    v_readlane_b32 s7, v13, s32
    s_nop 0
    s_cmp_ge_u32 s7, 32
    s_cselect_b32 s51, 1, 0
    s_cselect_b32 s6, 256, s6
    s_cmp_lt_u32 s6, 256
    s_cbranch_scc1 L_pure
    v_readlane_b32 s7, v13, 8
    s_nop 0
    s_cmp_lt_u32 s7, 32
    s_cbranch_scc1 L_pure
    v_readlane_b32 s7, v13, 9
    s_nop 0
    s_cmp_lt_u32 s7, 128
    s_cbranch_scc1 L_pure
    v_readlane_b32 s7, v13, 10
    s_cmp_eq_u32 s32, 0
    s_cselect_b32 s7, 64, s7
    s_cmp_lt_u32 s7, 64
    s_cbranch_scc1 L_pure
    s_mov_b64 exec, -1
    s_barrier
    s_cmp_eq_u32 s51, 0
    s_cbranch_scc1 L_slow
    s_cmp_lg_u32 s14, 0
    s_cbranch_scc1 L_w1_1
    buffer_load_dwordx4 v[36:39], v0, s[8:11], s34 offen sc1
    s_mov_b32 s16, 0
    s_add_u32 s17, s66, 128
    v_lshrrev_b32 v10, 2, v0
    v_and_b32 v9, 16, v10
    v_lshlrev_b32 v9, 3, v9
    v_and_or_b32 v10, v10, 12, v9
Lr0f_fw_10:
    buffer_load_dword v9, v10, s[8:11], s17 offen sc1
    s_add_u32 s16, s16, 1
    s_cmp_gt_u32 s16, 100000
    s_cbranch_scc1 Lr_abort
    s_waitcnt vmcnt(0)
    v_cmp_eq_u32 vcc, 0, v9
    s_nop 0
    s_cbranch_vccnz Lr0f_fw_10
    s_mov_b32 m0, 15104
    s_nop 0
    buffer_load_dwordx4 v0, s[8:11], s41 offen offset:0 lds
    buffer_load_dwordx4 v0, s[8:11], s41 offen offset:1024 lds
    s_add_u32 s41, s41, 262144
    s_add_u32 s68, s68, 4278452224
    ds_read_b128 v[56:59], v8 offset:0
    ds_read_b128 v[60:63], v8 offset:1024
    ds_read_b128 v[64:67], v8 offset:2048
    ds_read_b128 v[68:71], v8 offset:3072
    v_mov_b64 v[12:13], 0
    v_mov_b64 v[14:15], 0
    v_mov_b64 v[16:17], 0
    v_mov_b64 v[18:19], 0
    v_mov_b64 v[20:21], 0
    v_mov_b64 v[22:23], 0
    v_mov_b64 v[24:25], 0
    v_mov_b64 v[26:27], 0
    v_mov_b64 v[28:29], 0
    v_mov_b64 v[30:31], 0
    v_mov_b64 v[32:33], 0
    v_mov_b64 v[34:35], 0
    s_waitcnt vmcnt(0) lgkmcnt(0)
Lr0f_step:
    s_mov_b32 s16, 0
Lr0f_alp:
    s_waitcnt vmcnt(2)
    v_max3_u32 v10, v36, v37, v38
    v_max_u32 v10, v10, v39
    v_cmp_eq_u32 vcc, -1, v10
    s_nop 0
    s_cbranch_vccz Lr0f_aok
    buffer_load_dwordx4 v[36:39], v0, s[8:11], s34 offen sc1
    s_add_u32 s16, s16, 1
    s_cmp_gt_u32 s16, 100000
    s_cbranch_scc1 Lr_abort
    s_branch Lr0f_alp
Lr0f_aok:
    ds_write_b128 v0, v[36:39] offset:6912
    v_smfmac_f32_16x16x64_bf16 v[12:15], v[36:39], v[72:79], v1
    v_smfmac_f32_16x16x64_bf16 v[16:19], v[36:39], v[80:87], v1
    v_smfmac_f32_16x16x64_bf16 v[20:23], v[36:39], v[184:191], v1
    s_waitcnt lgkmcnt(0)
    s_barrier
    ds_read_b128 v[48:51], v0 offset:7936
    ds_read_b128 v[52:55], v0 offset:8960
    v_smfmac_f32_16x16x64_bf16 v[28:31], v[36:39], v[56:63], v1
    ds_read_b128 v[56:59], v8 offset:4096
    ds_read_b128 v[60:63], v8 offset:5120
    s_add_u32 s17, s34, 4096
    buffer_load_dwordx4 v[40:43], v0, s[8:11], s17 offen sc1
    v_smfmac_f32_16x16x64_bf16 v[24:27], v[36:39], v[192:199], v1
    v_smfmac_f32_16x16x64_bf16 v[32:35], v[36:39], v[64:71], v1
    ds_read_b128 v[64:67], v8 offset:6144
    ds_read_b128 v[68:71], v8 offset:7168
    s_waitcnt vmcnt(1)
    ds_read_b128 v[36:39], v0 offset:9984
    s_waitcnt lgkmcnt(6)
    v_smfmac_f32_16x16x64_bf16 v[28:31], v[48:51], a[72:79], v1
    v_smfmac_f32_16x16x64_bf16 v[12:15], v[48:51], v[88:95], v1
    buffer_load_dwordx4 v[44:47], v0, s[8:11], s35 offen sc1
    v_smfmac_f32_16x16x64_bf16 v[16:19], v[48:51], v[96:103], v1
    v_smfmac_f32_16x16x64_bf16 v[32:35], v[48:51], a[80:87], v1
    v_smfmac_f32_16x16x64_bf16 v[20:23], v[48:51], v[200:207], v1
    v_smfmac_f32_16x16x64_bf16 v[24:27], v[48:51], v[208:215], v1
    s_waitcnt lgkmcnt(3)
    v_smfmac_f32_16x16x64_bf16 v[28:31], v[52:55], v[56:63], v1
    ds_read_b128 v[56:59], v8 offset:8192
    ds_read_b128 v[60:63], v8 offset:9216
    v_smfmac_f32_16x16x64_bf16 v[12:15], v[52:55], v[104:111], v1
    v_smfmac_f32_16x16x64_bf16 v[16:19], v[52:55], v[112:119], v1
    s_waitcnt lgkmcnt(3)
    v_smfmac_f32_16x16x64_bf16 v[32:35], v[52:55], v[64:71], v1
    ds_read_b128 v[64:67], v8 offset:10240
    ds_read_b128 v[68:71], v8 offset:11264
    v_smfmac_f32_16x16x64_bf16 v[20:23], v[52:55], v[216:223], v1
    v_smfmac_f32_16x16x64_bf16 v[24:27], v[52:55], v[224:231], v1
    s_waitcnt lgkmcnt(4)
    v_smfmac_f32_16x16x64_bf16 v[28:31], v[36:39], a[88:95], v1
    v_smfmac_f32_16x16x64_bf16 v[12:15], v[36:39], v[120:127], v1
    v_smfmac_f32_16x16x64_bf16 v[16:19], v[36:39], v[128:135], v1
    v_smfmac_f32_16x16x64_bf16 v[32:35], v[36:39], a[96:103], v1
    v_smfmac_f32_16x16x64_bf16 v[20:23], v[36:39], v[232:239], v1
    v_smfmac_f32_16x16x64_bf16 v[24:27], v[36:39], v[240:247], v1
    s_waitcnt vmcnt(1)
    v_max3_u32 v10, v40, v41, v42
    v_max_u32 v10, v10, v43
    v_cmp_eq_u32 vcc, -1, v10
    s_nop 0
    s_cbranch_vccnz Lr0f_pb_re
Lr0f_pb_ok:
    ds_write_b128 v0, v[40:43] offset:11008
    s_waitcnt lgkmcnt(3)
    v_smfmac_f32_16x16x64_bf16 v[12:15], v[40:43], v[56:63], v1
    ds_read_b128 v[56:59], v8 offset:12288
    ds_read_b128 v[60:63], v8 offset:13312
    v_smfmac_f32_16x16x64_bf16 v[20:23], v[40:43], v[248:255], v1
    s_waitcnt lgkmcnt(3)
    v_smfmac_f32_16x16x64_bf16 v[16:19], v[40:43], v[64:71], v1
    ds_read_b128 v[64:67], v8 offset:14336
    ds_read_b128 v[68:71], v8 offset:15360
    v_smfmac_f32_16x16x64_bf16 v[24:27], v[40:43], a[0:7], v1
    s_waitcnt lgkmcnt(4)
    s_barrier
    ds_read_b128 v[48:51], v0 offset:13056
    ds_read_b128 v[52:55], v0 offset:12032
    ds_read_b128 v[36:39], v0 offset:14080
    v_smfmac_f32_16x16x64_bf16 v[28:31], v[40:43], a[104:111], v1
    v_smfmac_f32_16x16x64_bf16 v[32:35], v[40:43], a[112:119], v1
    s_waitcnt lgkmcnt(2)
    v_smfmac_f32_16x16x64_bf16 v[12:15], v[48:51], v[56:63], v1
    v_smfmac_f32_16x16x64_bf16 v[16:19], v[48:51], v[64:71], v1
    s_waitcnt lgkmcnt(1)
    v_smfmac_f32_16x16x64_bf16 v[12:15], v[52:55], v[136:143], v1
    v_smfmac_f32_16x16x64_bf16 v[16:19], v[52:55], v[144:151], v1
    s_waitcnt lgkmcnt(0)
    v_smfmac_f32_16x16x64_bf16 v[12:15], v[36:39], v[152:159], v1
    v_smfmac_f32_16x16x64_bf16 v[16:19], v[36:39], v[160:167], v1
    s_waitcnt vmcnt(0)
    v_max3_u32 v10, v44, v45, v46
    v_max_u32 v10, v10, v47
    v_cmp_eq_u32 vcc, -1, v10
    s_nop 0
    s_cbranch_vccnz Lr0f_pc_re
Lr0f_pc_ok:
    v_smfmac_f32_16x16x64_bf16 v[12:15], v[44:47], v[168:175], v1
    v_smfmac_f32_16x16x64_bf16 v[16:19], v[44:47], v[176:183], v1
    v_smfmac_f32_16x16x64_bf16 v[20:23], v[48:51], a[24:31], v1
    buffer_load_dwordx4 v[64:67], v0, s[8:11], s42 offen
    v_smfmac_f32_16x16x64_bf16 v[24:27], v[48:51], a[32:39], v1
    v_smfmac_f32_16x16x64_bf16 v[20:23], v[52:55], a[8:15], v1
    v_add_f32 v12, v12, v14
    v_smfmac_f32_16x16x64_bf16 v[24:27], v[52:55], a[16:23], v1
    v_add_f32 v16, v16, v18
    v_smfmac_f32_16x16x64_bf16 v[20:23], v[36:39], a[40:47], v1
    v_add_f32 v13, v13, v15
    buffer_load_dwordx4 v[68:71], v0, s[8:11], s42 offen offset:1024
    v_smfmac_f32_16x16x64_bf16 v[24:27], v[36:39], a[48:55], v1
    v_add_f32 v17, v17, v19
    v_smfmac_f32_16x16x64_bf16 v[20:23], v[44:47], a[56:63], v1
    v_cvt_pk_bf16_f32 v14, v12, v16
    ds_read_b128 v[56:59], v0 offset:15104
    v_smfmac_f32_16x16x64_bf16 v[24:27], v[44:47], a[64:71], v1
    v_cvt_pk_bf16_f32 v15, v13, v17
    ds_read_b128 v[60:63], v0 offset:16128
    ds_write_b32 v2, v14 offset:576
    ds_write_b32 v2, v15 offset:864
    v_smfmac_f32_16x16x64_bf16 v[28:31], v[48:51], a[136:143], v1
    v_smfmac_f32_16x16x64_bf16 v[32:35], v[48:51], a[144:151], v1
    v_add_f32 v20, v20, v22
    v_add_f32 v24, v24, v26
    v_add_f32 v21, v21, v23
    v_add_f32 v25, v25, v27
    v_cvt_pk_bf16_f32 v22, v20, v24
    v_cvt_pk_bf16_f32 v23, v21, v25
    ds_write_b32 v2, v22 offset:0
    ds_write_b32 v2, v23 offset:288
    v_smfmac_f32_16x16x64_bf16 v[28:31], v[52:55], a[120:127], v1
    v_smfmac_f32_16x16x64_bf16 v[32:35], v[52:55], a[128:135], v1
    s_waitcnt lgkmcnt(0)
    s_barrier
    ds_read_b128 v[40:43], v3 offset:0
    ds_read_b128 v[48:51], v3 offset:64
    ds_read_b128 v[20:23], v3 offset:128
    ds_read_b128 v[52:55], v3 offset:192
    v_smfmac_f32_16x16x64_bf16 v[28:31], v[36:39], a[152:159], v1
    v_smfmac_f32_16x16x64_bf16 v[32:35], v[36:39], a[160:167], v1
    ds_read_b128 v[36:39], v0 offset:17152
    v_lshlrev_b32 v9, 3, v0
    buffer_load_dword v11, v9, s[8:11], s68 offen
    v_smfmac_f32_16x16x64_bf16 v[28:31], v[44:47], a[168:175], v1
    v_smfmac_f32_16x16x64_bf16 v[32:35], v[44:47], a[176:183], v1
    ds_read_b128 v[44:47], v0 offset:18176
    s_waitcnt lgkmcnt(5)
    v_mfma_f32_16x16x32_bf16 v[12:15], v[56:59], v[40:43], 0
    v_mfma_f32_16x16x32_bf16 v[16:19], v[60:63], v[40:43], 0
    v_mfma_f32_16x16x32_bf16 v[24:27], v[40:43], v[40:43], 0
    ds_read_b128 v[56:59], v0 offset:19200
    ds_read_b128 v[60:63], v0 offset:20224
    s_waitcnt lgkmcnt(3)
    v_mfma_f32_16x16x32_bf16 v[12:15], v[36:39], v[48:51], v[12:15]
    v_lshrrev_b32 v10, 1, v0
    v_lshrrev_b32 v9, 9, v0
    s_waitcnt lgkmcnt(2)
    v_mfma_f32_16x16x32_bf16 v[16:19], v[44:47], v[48:51], v[16:19]
    v_lshl_add_u32 v9, v9, 5, v10
    v_add_f32 v28, v28, v30
    v_mfma_f32_16x16x32_bf16 v[24:27], v[48:51], v[48:51], v[24:27]
    v_add_f32 v32, v32, v34
    v_add_f32 v29, v29, v31
    ds_read_b128 v[36:39], v0 offset:21248
    ds_read_b128 v[44:47], v0 offset:22272
    s_waitcnt lgkmcnt(3)
    v_mfma_f32_16x16x32_bf16 v[12:15], v[56:59], v[20:23], v[12:15]
    v_add_f32 v33, v33, v35
    v_cvt_pk_bf16_f32 v30, v28, v29
    s_waitcnt lgkmcnt(2)
    v_mfma_f32_16x16x32_bf16 v[16:19], v[60:63], v[20:23], v[16:19]
    v_cvt_pk_bf16_f32 v31, v32, v33
    ds_read_b64 v[34:35], v9 offset:0
    v_mfma_f32_16x16x32_bf16 v[24:27], v[20:23], v[20:23], v[24:27]
    s_add_u32 s17, s43, 2048
    buffer_store_dwordx2 v[30:31], v10, s[8:11], s17 offen sc1
    s_waitcnt lgkmcnt(2)
    v_mfma_f32_16x16x32_bf16 v[12:15], v[36:39], v[52:55], v[12:15]
    s_waitcnt lgkmcnt(1)
    v_mfma_f32_16x16x32_bf16 v[16:19], v[44:47], v[52:55], v[16:19]
    v_mfma_f32_16x16x32_bf16 v[24:27], v[52:55], v[52:55], v[24:27]
    s_add_u32 s17, s43, 0
    s_waitcnt lgkmcnt(0)
    buffer_store_dwordx2 v[34:35], v10, s[8:11], s17 offen sc1
    s_cmp_eq_u32 s33, 63
    s_cbranch_scc1 Lr0f_last
    ds_read_b128 v[56:59], v8 offset:16384
    ds_read_b128 v[60:63], v8 offset:17408
    v_mov_b64 v[20:21], s[52:53]
    v_mov_b64 v[22:23], s[52:53]
    v_mov_b32 v41, 0
    v_mov_b32 v42, 0
    v_max3_f32 v9, v12, v13, v14
    v_max3_f32 v9, v9, v15, v16
    v_max3_f32 v9, v9, v17, v18
    v_max3_f32 v9, v9, v19, v24
    v_max_f32 v9, v9, v25
    v_mov_b32 v10, v9
    v_mov_b64 v[32:33], 0
    v_mov_b64 v[34:35], 0
    v_permlane32_swap_b32 v9, v10
    v_max_f32 v9, v9, v10
    v_mov_b32 v10, v9
    s_nop 1
    v_permlane16_swap_b32 v9, v10
    v_max_f32 v9, v9, v10
    v_mul_f32 v28, s44, v9
    v_fma_f32 v12, v12, s44, -v28
    v_fma_f32 v13, v13, s44, -v28
    v_fma_f32 v14, v14, s44, -v28
    v_fma_f32 v15, v15, s44, -v28
    v_exp_f32 v12, v12
    v_exp_f32 v13, v13
    v_fma_f32 v16, v16, s44, -v28
    v_fma_f32 v17, v17, s44, -v28
    v_exp_f32 v14, v14
    v_exp_f32 v15, v15
    v_cvt_pk_bf16_f32 v36, v12, v13
    v_fma_f32 v18, v18, s44, -v28
    v_fma_f32 v19, v19, s44, -v28
    v_exp_f32 v16, v16
    v_exp_f32 v17, v17
    v_cvt_pk_bf16_f32 v37, v14, v15
    v_fma_f32 v24, v24, s44, -v28
    v_fma_f32 v25, v25, s44, -v28
    v_exp_f32 v18, v18
    v_exp_f32 v19, v19
    v_cvt_pk_bf16_f32 v38, v16, v17
    v_exp_f32 v24, v24
    v_exp_f32 v25, v25
    v_cvt_pk_bf16_f32 v39, v18, v19
    v_cvt_pk_bf16_f32 v40, v24, v25
    v_cvt_pk_bf16_f32 v43, v24, v25
    v_mfma_f32_16x16x32_bf16 v[52:55], v[20:23], v[36:39], 0
    v_mov_b64 v[12:13], 0
    v_mov_b64 v[14:15], 0
    s_waitcnt vmcnt(4)
    v_mfma_f32_16x16x32_bf16 v[44:47], v[64:67], v[36:39], 0
    v_mov_b64 v[24:25], 0
    v_mov_b64 v[26:27], 0
    s_waitcnt vmcnt(3)
    v_mfma_f32_16x16x32_bf16 v[48:51], v[68:71], v[36:39], 0
    ds_read_b128 v[64:67], v8 offset:20480
    ds_read_b128 v[68:71], v8 offset:21504
    v_mfma_f32_16x16x16_bf16 v[52:55], v[20:21], v[40:41], v[52:55]
    v_mfma_f32_16x16x16_bf16 v[44:47], v[30:31], v[40:41], v[44:47]
    v_mov_b64 v[20:21], 0
    v_mov_b64 v[22:23], 0
    v_mfma_f32_16x16x16_bf16 v[48:51], v[30:31], v[42:43], v[48:51]
    v_mov_b64 v[36:37], 0
    v_mov_b64 v[38:39], 0
    v_mov_b64 v[40:41], 0
    v_mov_b64 v[42:43], 0
    v_rcp_f32 v9, v52
    v_mov_b64 v[52:53], 0
    v_mov_b64 v[54:55], 0
    v_mul_f32 v44, v9, v44
    v_mul_f32 v48, v9, v48
    v_cvt_pk_bf16_f32 v16, v44, v48
    v_mul_f32 v45, v9, v45
    v_mul_f32 v49, v9, v49
    v_cvt_pk_bf16_f32 v17, v45, v49
    v_mul_f32 v46, v9, v46
    v_mul_f32 v50, v9, v50
    v_cvt_pk_bf16_f32 v18, v46, v50
    v_mul_f32 v47, v9, v47
    v_mul_f32 v51, v9, v51
    v_cvt_pk_bf16_f32 v19, v47, v51
    ds_write_b128 v5, v[16:19]
    v_mov_b64 v[28:29], 0
    v_mov_b64 v[30:31], 0
    s_waitcnt lgkmcnt(0)
    s_barrier
    ds_read_b128 v[44:47], v4 offset:0
    ds_read_b128 v[48:51], v4 offset:128
    v_mov_b64 v[16:17], 0
    v_mov_b64 v[18:19], 0
    buffer_load_dwordx4 v0, s[8:11], s41 offen offset:0 lds
    buffer_load_dwordx4 v0, s[8:11], s41 offen offset:1024 lds
    s_waitcnt lgkmcnt(1)
    v_smfmac_f32_16x16x64_bf16 v[12:15], v[44:47], a[184:191], v1
    s_waitcnt lgkmcnt(0)
    v_smfmac_f32_16x16x64_bf16 v[12:15], v[48:51], a[192:199], v1
    v_smfmac_f32_16x16x64_bf16 v[24:27], v[44:47], a[200:207], v1
    v_smfmac_f32_16x16x64_bf16 v[24:27], v[48:51], a[208:215], v1
    v_add_f32 v12, v12, v14
    v_smfmac_f32_16x16x64_bf16 v[20:23], v[44:47], a[216:223], v1
    v_add_f32 v13, v13, v15
    v_smfmac_f32_16x16x64_bf16 v[20:23], v[48:51], a[224:231], v1
    v_cvt_pk_bf16_f32 v12, v12, v13
    v_smfmac_f32_16x16x64_bf16 v[16:19], v[44:47], a[232:239], v1
    v_add_f32 v24, v24, v26
    v_smfmac_f32_16x16x64_bf16 v[16:19], v[48:51], a[240:247], v1
    v_add_f32 v25, v25, v27
    v_smfmac_f32_16x16x64_bf16 v[36:39], v[44:47], v[56:63], v1
    v_cvt_pk_bf16_f32 v13, v24, v25
    v_smfmac_f32_16x16x64_bf16 v[36:39], v[48:51], v[64:71], v1
    v_add_f32 v20, v20, v22
    v_add_f32 v21, v21, v23
    v_cvt_pk_bf16_f32 v14, v20, v21
    v_add_f32 v16, v16, v18
    v_add_f32 v17, v17, v19
    v_cvt_pk_bf16_f32 v15, v16, v17
    v_and_or_b32 v15, v15, -2, s40
    buffer_store_dwordx4 v[12:15], v0, s[8:11], s38 offen
    s_nop 0
    ds_read_b128 v[12:15], v8 offset:18432
    ds_read_b128 v[16:19], v8 offset:19456
    ds_read_b128 v[20:23], v8 offset:22528
    ds_read_b128 v[24:27], v8 offset:23552
    ds_read_b128 v[56:59], v8 offset:24576
    ds_read_b128 v[60:63], v8 offset:25600
    ds_read_b128 v[64:67], v8 offset:28672
    ds_read_b128 v[68:71], v8 offset:29696
    s_waitcnt lgkmcnt(6)
    v_smfmac_f32_16x16x64_bf16 v[40:43], v[44:47], v[12:19], v1
    ds_read_b128 v[12:15], v8 offset:26624
    ds_read_b128 v[16:19], v8 offset:27648
    s_waitcnt lgkmcnt(6)
    v_smfmac_f32_16x16x64_bf16 v[40:43], v[48:51], v[20:27], v1
    ds_read_b128 v[20:23], v8 offset:30720
    ds_read_b128 v[24:27], v8 offset:31744
    s_waitcnt lgkmcnt(6)
    v_smfmac_f32_16x16x64_bf16 v[52:55], v[44:47], v[56:63], v1
    ds_read_b128 v[56:59], v8 offset:32768
    ds_read_b128 v[60:63], v8 offset:33792
    s_waitcnt lgkmcnt(6)
    v_smfmac_f32_16x16x64_bf16 v[52:55], v[48:51], v[64:71], v1
    s_waitcnt lgkmcnt(4)
    v_smfmac_f32_16x16x64_bf16 v[32:35], v[44:47], v[12:19], v1
    s_waitcnt lgkmcnt(2)
    v_smfmac_f32_16x16x64_bf16 v[32:35], v[48:51], v[20:27], v1
    v_smfmac_f32_16x16x64_bf16 v[28:31], v[44:47], a[248:255], v1
    s_waitcnt lgkmcnt(0)
    v_smfmac_f32_16x16x64_bf16 v[28:31], v[48:51], v[56:63], v1
    buffer_load_dwordx4 v[12:15], v6, s[8:11], s62 offen sc1
    buffer_load_dwordx4 v[16:19], v6, s[8:11], s63 offen sc1
    buffer_load_dwordx4 v[20:23], v6, s[8:11], s64 offen sc1
    buffer_load_dwordx4 v[24:27], v6, s[8:11], s65 offen sc1
    v_add_f32 v36, v36, v38
    v_add_f32 v37, v37, v39
    v_cvt_pk_bf16_f32 v36, v36, v37
    v_add_f32 v40, v40, v42
    v_add_f32 v41, v41, v43
    v_cvt_pk_bf16_f32 v37, v40, v41
    v_add_f32 v52, v52, v54
    v_add_f32 v53, v53, v55
    v_cvt_pk_bf16_f32 v38, v52, v53
    v_add_f32 v32, v32, v34
    v_add_f32 v33, v33, v35
    v_cvt_pk_bf16_f32 v39, v32, v33
    v_and_or_b32 v39, v39, -2, s40
    s_add_u32 s17, s38, 4096
    buffer_store_dwordx4 v[36:39], v0, s[8:11], s17 offen
    v_add_f32 v28, v28, v30
    v_add_f32 v29, v29, v31
    v_cvt_pk_bf16_f32 v28, v28, v29
    v_and_or_b32 v28, v28, -2, s40
    v_lshrrev_b32 v9, 2, v0
    buffer_store_dword v28, v9, s[8:11], s39 offen
    v_add_u32 v10, 162560, v0
    ds_read_b128 v[64:67], v10
    s_nop 9
    buffer_load_dwordx4 v[40:43], v6, s[8:11], s62 offen sc1
    buffer_load_dwordx4 v[44:47], v6, s[8:11], s63 offen sc1
    buffer_load_dwordx4 v[48:51], v6, s[8:11], s64 offen sc1
    buffer_load_dwordx4 v[52:55], v6, s[8:11], s65 offen sc1
    s_add_u32 s33, s33, 1
    s_add_u32 s42, s42, 262144
    s_add_u32 s41, s41, 262144
    s_add_u32 s43, s43, 131072
    s_add_u32 s68, s68, 262144
    s_add_u32 s66, s66, 22528
    ds_read_b128 v[56:59], v8 offset:0
    ds_read_b128 v[60:63], v8 offset:1024
    s_waitcnt lgkmcnt(2)
    s_waitcnt vmcnt(9)
    v_mfma_f32_16x16x32_bf16 v[68:71], v[12:15], v[64:67], 0
    v_and_b32 v10, 1, v15
    v_cmp_ne_u32 s[54:55], s40, v10
    s_waitcnt vmcnt(8)
    v_mfma_f32_16x16x32_bf16 v[68:71], v[16:19], v[64:67], v[68:71]
    v_and_b32 v10, 1, v19
    v_cmp_ne_u32 s[56:57], s40, v10
    s_waitcnt vmcnt(7)
    v_mfma_f32_16x16x32_bf16 v[68:71], v[20:23], v[64:67], v[68:71]
    v_and_b32 v10, 1, v23
    v_cmp_ne_u32 s[58:59], s40, v10
    s_waitcnt vmcnt(6)
    v_mfma_f32_16x16x32_bf16 v[68:71], v[24:27], v[64:67], v[68:71]
    v_and_b32 v10, 1, v27
    v_cmp_ne_u32 s[60:61], s40, v10
    s_or_b64 vcc, s[54:55], s[56:57]
    s_or_b64 vcc, vcc, s[58:59]
    s_or_b64 vcc, vcc, s[60:61]
    s_cbranch_scc0 Lr0f_red
    s_mov_b32 s16, 0
Lr0f_p1:
    buffer_load_dwordx4 v[12:15], v6, s[8:11], s62 offen sc1
    buffer_load_dwordx4 v[16:19], v6, s[8:11], s63 offen sc1
    buffer_load_dwordx4 v[20:23], v6, s[8:11], s64 offen sc1
    buffer_load_dwordx4 v[24:27], v6, s[8:11], s65 offen sc1
    s_waitcnt vmcnt(7)
    v_mfma_f32_16x16x32_bf16 v[68:71], v[40:43], v[64:67], 0
    v_and_b32 v10, 1, v43
    v_cmp_ne_u32 s[54:55], s40, v10
    s_waitcnt vmcnt(6)
    v_mfma_f32_16x16x32_bf16 v[68:71], v[44:47], v[64:67], v[68:71]
    v_and_b32 v10, 1, v47
    v_cmp_ne_u32 s[56:57], s40, v10
    s_waitcnt vmcnt(5)
    v_mfma_f32_16x16x32_bf16 v[68:71], v[48:51], v[64:67], v[68:71]
    v_and_b32 v10, 1, v51
    v_cmp_ne_u32 s[58:59], s40, v10
    s_waitcnt vmcnt(4)
    v_mfma_f32_16x16x32_bf16 v[68:71], v[52:55], v[64:67], v[68:71]
    v_and_b32 v10, 1, v55
    v_cmp_ne_u32 s[60:61], s40, v10
    s_or_b64 vcc, s[54:55], s[56:57]
    s_or_b64 vcc, vcc, s[58:59]
    s_or_b64 vcc, vcc, s[60:61]
    s_cbranch_scc0 Lr0f_red
    buffer_load_dwordx4 v[40:43], v6, s[8:11], s62 offen sc1
    buffer_load_dwordx4 v[44:47], v6, s[8:11], s63 offen sc1
    buffer_load_dwordx4 v[48:51], v6, s[8:11], s64 offen sc1
    buffer_load_dwordx4 v[52:55], v6, s[8:11], s65 offen sc1
    s_add_u32 s16, s16, 1
    s_cmp_gt_u32 s16, 100000
    s_cbranch_scc1 Lr_abort
    s_waitcnt vmcnt(7)
    v_mfma_f32_16x16x32_bf16 v[68:71], v[12:15], v[64:67], 0
    v_and_b32 v10, 1, v15
    v_cmp_ne_u32 s[54:55], s40, v10
    s_waitcnt vmcnt(6)
    v_mfma_f32_16x16x32_bf16 v[68:71], v[16:19], v[64:67], v[68:71]
    v_and_b32 v10, 1, v19
    v_cmp_ne_u32 s[56:57], s40, v10
    s_waitcnt vmcnt(5)
    v_mfma_f32_16x16x32_bf16 v[68:71], v[20:23], v[64:67], v[68:71]
    v_and_b32 v10, 1, v23
    v_cmp_ne_u32 s[58:59], s40, v10
    s_waitcnt vmcnt(4)
    v_mfma_f32_16x16x32_bf16 v[68:71], v[24:27], v[64:67], v[68:71]
    v_and_b32 v10, 1, v27
    v_cmp_ne_u32 s[60:61], s40, v10
    s_or_b64 vcc, s[54:55], s[56:57]
    s_or_b64 vcc, vcc, s[58:59]
    s_or_b64 vcc, vcc, s[60:61]
    s_cbranch_scc1 Lr0f_p1
Lr0f_red:
    s_nop 1
    v_permlane16_swap_b32 v68, v70
    v_permlane16_swap_b32 v69, v71
    s_mov_b64 exec, s[46:47]
    v_add_f32 v68, v68, v70
    v_add_f32 v69, v69, v71
    v_cvt_pk_bf16_f32 v68, v68, v69
    v_min_u32 v68, s50, v68
    buffer_store_dword v68, v7, s[8:11], s36 offen
    v_mov_b32 v69, -1
    buffer_store_dword v69, v7, s[8:11], s37 offen
    s_mov_b64 exec, -1
    s_xor_b32 s34, s34, 16384
    s_xor_b32 s35, s35, 16384
    s_xor_b32 s40, s40, 1
    s_xor_b32 s36, s36, 16384
    s_xor_b32 s37, s37, 16384
    s_nop 15
    s_nop 3
    buffer_load_dwordx4 v[36:39], v0, s[8:11], s34 offen sc1
    s_waitcnt vmcnt(3)
    ds_read_b128 v[64:67], v8 offset:2048
    ds_read_b128 v[68:71], v8 offset:3072
    v_mov_b64 v[12:13], 0
    v_mov_b64 v[14:15], 0
    v_mov_b64 v[16:17], 0
    v_mov_b64 v[18:19], 0
    v_mov_b64 v[20:21], 0
    v_mov_b64 v[22:23], 0
    v_mov_b64 v[24:25], 0
    v_mov_b64 v[26:27], 0
    v_mov_b64 v[28:29], 0
    v_mov_b64 v[30:31], 0
    v_mov_b64 v[32:33], 0
    v_mov_b64 v[34:35], 0
    s_nop 9
    buffer_load_dwordx4 v[36:39], v0, s[8:11], s34 offen sc1
    s_nop 15
    s_nop 8
    buffer_load_dwordx4 v[36:39], v0, s[8:11], s34 offen sc1
    s_waitcnt lgkmcnt(0)
    s_branch Lr0f_step
Lr0f_pb_re:
    s_mov_b32 s16, 0
Lr0f_pb_lp:
    s_add_u32 s17, s34, 4096
    buffer_load_dwordx4 v[40:43], v0, s[8:11], s17 offen sc1
    s_add_u32 s16, s16, 1
    s_cmp_gt_u32 s16, 100000
    s_cbranch_scc1 Lr_abort
    s_waitcnt vmcnt(0)
    v_max3_u32 v10, v40, v41, v42
    v_max_u32 v10, v10, v43
    v_cmp_eq_u32 vcc, -1, v10
    s_nop 0
    s_cbranch_vccnz Lr0f_pb_lp
    s_branch Lr0f_pb_ok
Lr0f_pc_re:
    s_mov_b32 s16, 0
Lr0f_pc_lp:
    buffer_load_dwordx4 v[44:47], v0, s[8:11], s35 offen sc1
    s_add_u32 s16, s16, 1
    s_cmp_gt_u32 s16, 100000
    s_cbranch_scc1 Lr_abort
    s_waitcnt vmcnt(0)
    v_max3_u32 v10, v44, v45, v46
    v_max_u32 v10, v10, v47
    v_cmp_eq_u32 vcc, -1, v10
    s_nop 0
    s_cbranch_vccnz Lr0f_pc_lp
    s_branch Lr0f_pc_ok
Lr0f_last:
    s_waitcnt vmcnt(0) lgkmcnt(0)
    s_barrier
    s_branch Lr_exit
L_w1_1:
    s_cmp_lg_u32 s14, 1
    s_cbranch_scc1 L_w2_1
    buffer_load_dwordx4 v[36:39], v0, s[8:11], s34 offen sc1
    s_mov_b32 s16, 0
    s_add_u32 s17, s66, 128
    v_lshrrev_b32 v10, 2, v0
    v_and_b32 v9, 16, v10
    v_lshlrev_b32 v9, 3, v9
    v_and_or_b32 v10, v10, 12, v9
Lr1f_fw_11:
    buffer_load_dword v9, v10, s[8:11], s17 offen sc1
    s_add_u32 s16, s16, 1
    s_cmp_gt_u32 s16, 100000
    s_cbranch_scc1 Lr_abort
    s_waitcnt vmcnt(0)
    v_cmp_eq_u32 vcc, 0, v9
    s_nop 0
    s_cbranch_vccnz Lr1f_fw_11
    s_lshl_b32 s67, s32, 5
    s_add_u32 s67, s67, s15
    s_lshl_b32 s67, s67, 12
    s_add_u32 s67, s67, 3145728
    s_mov_b32 m0, 17152
    s_nop 0
    buffer_load_dwordx4 v0, s[8:11], s41 offen offset:0 lds
    buffer_load_dwordx4 v0, s[8:11], s41 offen offset:1024 lds
    s_add_u32 s41, s41, 262144
    s_add_u32 s68, s68, 262144
    ds_read_b128 v[56:59], v8 offset:4096
    ds_read_b128 v[60:63], v8 offset:5120
    ds_read_b128 v[64:67], v8 offset:6144
    ds_read_b128 v[68:71], v8 offset:7168
    v_mov_b64 v[12:13], 0
    v_mov_b64 v[14:15], 0
    v_mov_b64 v[16:17], 0
    v_mov_b64 v[18:19], 0
    v_mov_b64 v[20:21], 0
    v_mov_b64 v[22:23], 0
    v_mov_b64 v[24:25], 0
    v_mov_b64 v[26:27], 0
    v_mov_b64 v[28:29], 0
    v_mov_b64 v[30:31], 0
    v_mov_b64 v[32:33], 0
    v_mov_b64 v[34:35], 0
    s_waitcnt vmcnt(0) lgkmcnt(0)
Lr1f_step:
    s_waitcnt vmcnt(3)
    v_max3_u32 v10, v36, v37, v38
    v_max_u32 v10, v10, v39
    v_cmp_eq_u32 vcc, -1, v10
    s_nop 0
    s_cbranch_vccz Lr1f_aok
    buffer_load_dwordx4 v[36:39], v0, s[8:11], s34 offen sc1
    s_nop 15
    s_nop 8
    buffer_load_dwordx4 v[36:39], v0, s[8:11], s34 offen sc1
    s_mov_b32 s16, 0
Lr1f_alp:
    s_waitcnt vmcnt(2)
    v_max3_u32 v10, v36, v37, v38
    v_max_u32 v10, v10, v39
    v_cmp_eq_u32 vcc, -1, v10
    s_nop 0
    s_cbranch_vccz Lr1f_aok
    buffer_load_dwordx4 v[36:39], v0, s[8:11], s34 offen sc1
    s_add_u32 s16, s16, 1
    s_cmp_gt_u32 s16, 100000
    s_cbranch_scc1 Lr_abort
    s_branch Lr1f_alp
Lr1f_aok:
    ds_write_b128 v0, v[36:39] offset:7936
    v_smfmac_f32_16x16x64_bf16 v[12:15], v[36:39], v[88:95], v1
    v_smfmac_f32_16x16x64_bf16 v[16:19], v[36:39], v[96:103], v1
    v_smfmac_f32_16x16x64_bf16 v[20:23], v[36:39], v[200:207], v1
    s_waitcnt lgkmcnt(0)
    s_barrier
    ds_read_b128 v[48:51], v0 offset:8960
    ds_read_b128 v[52:55], v0 offset:9984
    v_smfmac_f32_16x16x64_bf16 v[28:31], v[36:39], a[72:79], v1
    v_smfmac_f32_16x16x64_bf16 v[24:27], v[36:39], v[208:215], v1
    s_add_u32 s17, s34, 4096
    buffer_load_dwordx4 v[40:43], v0, s[8:11], s17 offen sc1
    v_smfmac_f32_16x16x64_bf16 v[32:35], v[36:39], a[80:87], v1
    s_waitcnt vmcnt(1)
    ds_read_b128 v[36:39], v0 offset:6912
    s_waitcnt lgkmcnt(2)
    v_smfmac_f32_16x16x64_bf16 v[28:31], v[48:51], v[56:63], v1
    ds_read_b128 v[56:59], v8 offset:0
    ds_read_b128 v[60:63], v8 offset:1024
    v_smfmac_f32_16x16x64_bf16 v[12:15], v[48:51], v[104:111], v1
    v_smfmac_f32_16x16x64_bf16 v[16:19], v[48:51], v[112:119], v1
    buffer_load_dwordx4 v[44:47], v0, s[8:11], s35 offen sc1
    v_smfmac_f32_16x16x64_bf16 v[32:35], v[48:51], v[64:71], v1
    ds_read_b128 v[64:67], v8 offset:2048
    ds_read_b128 v[68:71], v8 offset:3072
    v_smfmac_f32_16x16x64_bf16 v[20:23], v[48:51], v[216:223], v1
    v_smfmac_f32_16x16x64_bf16 v[24:27], v[48:51], v[224:231], v1
    s_waitcnt lgkmcnt(5)
    v_smfmac_f32_16x16x64_bf16 v[28:31], v[52:55], a[88:95], v1
    v_smfmac_f32_16x16x64_bf16 v[12:15], v[52:55], v[120:127], v1
    v_smfmac_f32_16x16x64_bf16 v[16:19], v[52:55], v[128:135], v1
    v_smfmac_f32_16x16x64_bf16 v[32:35], v[52:55], a[96:103], v1
    v_smfmac_f32_16x16x64_bf16 v[20:23], v[52:55], v[232:239], v1
    v_smfmac_f32_16x16x64_bf16 v[24:27], v[52:55], v[240:247], v1
    s_waitcnt lgkmcnt(2)
    v_smfmac_f32_16x16x64_bf16 v[28:31], v[36:39], v[56:63], v1
    ds_read_b128 v[56:59], v8 offset:12288
    ds_read_b128 v[60:63], v8 offset:13312
    v_smfmac_f32_16x16x64_bf16 v[12:15], v[36:39], v[72:79], v1
    v_smfmac_f32_16x16x64_bf16 v[16:19], v[36:39], v[80:87], v1
    s_waitcnt lgkmcnt(2)
    v_smfmac_f32_16x16x64_bf16 v[32:35], v[36:39], v[64:71], v1
    ds_read_b128 v[64:67], v8 offset:14336
    ds_read_b128 v[68:71], v8 offset:15360
    v_smfmac_f32_16x16x64_bf16 v[20:23], v[36:39], v[184:191], v1
    v_smfmac_f32_16x16x64_bf16 v[24:27], v[36:39], v[192:199], v1
    s_waitcnt vmcnt(1)
    v_max3_u32 v10, v40, v41, v42
    v_max_u32 v10, v10, v43
    v_cmp_eq_u32 vcc, -1, v10
    s_nop 0
    s_cbranch_vccnz Lr1f_pb_re
Lr1f_pb_ok:
    ds_write_b128 v0, v[40:43] offset:12032
    v_mov_b32 v9, 1
    v_mov_b32 v10, 0
    s_mov_b64 exec, 1
    buffer_store_dword v9, v10, s[8:11], s67 offen offset:384 sc1
    s_mov_b64 exec, -1
    v_smfmac_f32_16x16x64_bf16 v[12:15], v[40:43], v[136:143], v1
    v_smfmac_f32_16x16x64_bf16 v[20:23], v[40:43], a[8:15], v1
    v_smfmac_f32_16x16x64_bf16 v[16:19], v[40:43], v[144:151], v1
    v_smfmac_f32_16x16x64_bf16 v[24:27], v[40:43], a[16:23], v1
    s_waitcnt lgkmcnt(0)
    s_barrier
    ds_read_b128 v[48:51], v0 offset:13056
    ds_read_b128 v[52:55], v0 offset:14080
    ds_read_b128 v[36:39], v0 offset:11008
    v_smfmac_f32_16x16x64_bf16 v[28:31], v[40:43], a[120:127], v1
    v_smfmac_f32_16x16x64_bf16 v[32:35], v[40:43], a[128:135], v1
    s_waitcnt lgkmcnt(2)
    v_smfmac_f32_16x16x64_bf16 v[12:15], v[48:51], v[56:63], v1
    ds_read_b128 v[56:59], v8 offset:8192
    ds_read_b128 v[60:63], v8 offset:9216
    v_smfmac_f32_16x16x64_bf16 v[16:19], v[48:51], v[64:71], v1
    ds_read_b128 v[64:67], v8 offset:10240
    ds_read_b128 v[68:71], v8 offset:11264
    s_waitcnt lgkmcnt(5)
    v_smfmac_f32_16x16x64_bf16 v[12:15], v[52:55], v[152:159], v1
    v_smfmac_f32_16x16x64_bf16 v[16:19], v[52:55], v[160:167], v1
    s_waitcnt vmcnt(1)
    v_max3_u32 v10, v44, v45, v46
    v_max_u32 v10, v10, v47
    v_cmp_eq_u32 vcc, -1, v10
    s_nop 0
    s_cbranch_vccnz Lr1f_pc_re
Lr1f_pc_ok:
    v_smfmac_f32_16x16x64_bf16 v[12:15], v[44:47], v[168:175], v1
    v_smfmac_f32_16x16x64_bf16 v[16:19], v[44:47], v[176:183], v1
    s_waitcnt lgkmcnt(2)
    v_smfmac_f32_16x16x64_bf16 v[12:15], v[36:39], v[56:63], v1
    s_waitcnt lgkmcnt(0)
    v_smfmac_f32_16x16x64_bf16 v[16:19], v[36:39], v[64:71], v1
    v_smfmac_f32_16x16x64_bf16 v[20:23], v[48:51], a[24:31], v1
    v_smfmac_f32_16x16x64_bf16 v[24:27], v[48:51], a[32:39], v1
    buffer_load_dwordx4 v[64:67], v0, s[8:11], s42 offen
    v_smfmac_f32_16x16x64_bf16 v[20:23], v[52:55], a[40:47], v1
    v_add_f32 v12, v12, v14
    v_smfmac_f32_16x16x64_bf16 v[24:27], v[52:55], a[48:55], v1
    v_add_f32 v16, v16, v18
    v_smfmac_f32_16x16x64_bf16 v[20:23], v[36:39], v[248:255], v1
    v_add_f32 v13, v13, v15
    v_smfmac_f32_16x16x64_bf16 v[24:27], v[36:39], a[0:7], v1
    v_add_f32 v17, v17, v19
    buffer_load_dwordx4 v[68:71], v0, s[8:11], s42 offen offset:1024
    v_smfmac_f32_16x16x64_bf16 v[20:23], v[44:47], a[56:63], v1
    v_cvt_pk_bf16_f32 v14, v12, v16
    ds_read_b128 v[56:59], v0 offset:15104
    v_smfmac_f32_16x16x64_bf16 v[24:27], v[44:47], a[64:71], v1
    v_cvt_pk_bf16_f32 v15, v13, v17
    ds_read_b128 v[60:63], v0 offset:16128
    ds_write_b32 v2, v14 offset:576
    ds_write_b32 v2, v15 offset:864
    v_smfmac_f32_16x16x64_bf16 v[28:31], v[48:51], a[136:143], v1
    v_smfmac_f32_16x16x64_bf16 v[32:35], v[48:51], a[144:151], v1
    v_add_f32 v20, v20, v22
    v_add_f32 v24, v24, v26
    v_add_f32 v21, v21, v23
    v_add_f32 v25, v25, v27
    v_cvt_pk_bf16_f32 v22, v20, v24
    v_cvt_pk_bf16_f32 v23, v21, v25
    ds_write_b32 v2, v22 offset:0
    ds_write_b32 v2, v23 offset:288
    v_smfmac_f32_16x16x64_bf16 v[28:31], v[52:55], a[152:159], v1
    v_smfmac_f32_16x16x64_bf16 v[32:35], v[52:55], a[160:167], v1
    s_waitcnt lgkmcnt(0)
    s_barrier
    ds_read_b128 v[40:43], v3 offset:0
    ds_read_b128 v[48:51], v3 offset:64
    ds_read_b128 v[20:23], v3 offset:128
    ds_read_b128 v[52:55], v3 offset:192
    v_smfmac_f32_16x16x64_bf16 v[28:31], v[36:39], a[104:111], v1
    v_smfmac_f32_16x16x64_bf16 v[32:35], v[36:39], a[112:119], v1
    ds_read_b128 v[36:39], v0 offset:17152
    v_smfmac_f32_16x16x64_bf16 v[28:31], v[44:47], a[168:175], v1
    v_smfmac_f32_16x16x64_bf16 v[32:35], v[44:47], a[176:183], v1
    ds_read_b128 v[44:47], v0 offset:18176
    s_waitcnt lgkmcnt(5)
    v_mfma_f32_16x16x32_bf16 v[12:15], v[56:59], v[40:43], 0
    v_mfma_f32_16x16x32_bf16 v[16:19], v[60:63], v[40:43], 0
    v_mfma_f32_16x16x32_bf16 v[24:27], v[40:43], v[40:43], 0
    ds_read_b128 v[56:59], v0 offset:19200
    ds_read_b128 v[60:63], v0 offset:20224
    s_waitcnt lgkmcnt(3)
    v_mfma_f32_16x16x32_bf16 v[12:15], v[36:39], v[48:51], v[12:15]
    v_lshrrev_b32 v10, 1, v0
    v_lshrrev_b32 v9, 9, v0
    s_waitcnt lgkmcnt(2)
    v_mfma_f32_16x16x32_bf16 v[16:19], v[44:47], v[48:51], v[16:19]
    v_lshl_add_u32 v9, v9, 5, v10
    v_add_f32 v28, v28, v30
    v_mfma_f32_16x16x32_bf16 v[24:27], v[48:51], v[48:51], v[24:27]
    v_add_f32 v32, v32, v34
    v_add_f32 v29, v29, v31
    ds_read_b128 v[36:39], v0 offset:21248
    ds_read_b128 v[44:47], v0 offset:22272
    s_waitcnt lgkmcnt(3)
    v_mfma_f32_16x16x32_bf16 v[12:15], v[56:59], v[20:23], v[12:15]
    v_add_f32 v33, v33, v35
    v_cvt_pk_bf16_f32 v30, v28, v29
    s_waitcnt lgkmcnt(2)
    v_mfma_f32_16x16x32_bf16 v[16:19], v[60:63], v[20:23], v[16:19]
    v_cvt_pk_bf16_f32 v31, v32, v33
    ds_read_b64 v[34:35], v9 offset:1152
    v_mfma_f32_16x16x32_bf16 v[24:27], v[20:23], v[20:23], v[24:27]
    s_add_u32 s17, s43, 2560
    buffer_store_dwordx2 v[30:31], v10, s[8:11], s17 offen sc1
    s_waitcnt lgkmcnt(2)
    v_mfma_f32_16x16x32_bf16 v[12:15], v[36:39], v[52:55], v[12:15]
    s_waitcnt lgkmcnt(1)
    v_mfma_f32_16x16x32_bf16 v[16:19], v[44:47], v[52:55], v[16:19]
    v_mfma_f32_16x16x32_bf16 v[24:27], v[52:55], v[52:55], v[24:27]
    s_add_u32 s17, s43, 512
    s_waitcnt lgkmcnt(0)
    buffer_store_dwordx2 v[34:35], v10, s[8:11], s17 offen sc1
    s_cmp_eq_u32 s33, 63
    s_cbranch_scc1 Lr1f_last
    ds_read_b128 v[56:59], v8 offset:16384
    ds_read_b128 v[60:63], v8 offset:17408
    v_mov_b64 v[20:21], s[52:53]
    v_mov_b64 v[22:23], s[52:53]
    v_mov_b32 v41, 0
    v_mov_b32 v42, 0
    v_max3_f32 v9, v12, v13, v14
    v_max3_f32 v9, v9, v15, v16
    v_max3_f32 v9, v9, v17, v18
    v_max3_f32 v9, v9, v19, v24
    v_max_f32 v9, v9, v25
    v_mov_b32 v10, v9
    v_mov_b64 v[32:33], 0
    v_mov_b64 v[34:35], 0
    v_permlane32_swap_b32 v9, v10
    v_max_f32 v9, v9, v10
    v_mov_b32 v10, v9
    s_nop 1
    v_permlane16_swap_b32 v9, v10
    v_max_f32 v9, v9, v10
    v_mul_f32 v28, s44, v9
    v_fma_f32 v12, v12, s44, -v28
    v_fma_f32 v13, v13, s44, -v28
    v_fma_f32 v14, v14, s44, -v28
    v_fma_f32 v15, v15, s44, -v28
    v_exp_f32 v12, v12
    v_exp_f32 v13, v13
    v_fma_f32 v16, v16, s44, -v28
    v_fma_f32 v17, v17, s44, -v28
    v_exp_f32 v14, v14
    v_exp_f32 v15, v15
    v_cvt_pk_bf16_f32 v36, v12, v13
    v_fma_f32 v18, v18, s44, -v28
    v_fma_f32 v19, v19, s44, -v28
    v_exp_f32 v16, v16
    v_exp_f32 v17, v17
    v_cvt_pk_bf16_f32 v37, v14, v15
    v_fma_f32 v24, v24, s44, -v28
    v_fma_f32 v25, v25, s44, -v28
    v_exp_f32 v18, v18
    v_exp_f32 v19, v19
    v_cvt_pk_bf16_f32 v38, v16, v17
    v_exp_f32 v24, v24
    v_exp_f32 v25, v25
    v_cvt_pk_bf16_f32 v39, v18, v19
    v_cvt_pk_bf16_f32 v40, v24, v25
    v_cvt_pk_bf16_f32 v43, v24, v25
    v_mfma_f32_16x16x32_bf16 v[52:55], v[20:23], v[36:39], 0
    v_mov_b64 v[12:13], 0
    v_mov_b64 v[14:15], 0
    s_waitcnt vmcnt(3)
    v_mfma_f32_16x16x32_bf16 v[44:47], v[64:67], v[36:39], 0
    v_mov_b64 v[24:25], 0
    v_mov_b64 v[26:27], 0
    s_waitcnt vmcnt(2)
    v_mfma_f32_16x16x32_bf16 v[48:51], v[68:71], v[36:39], 0
    ds_read_b128 v[64:67], v8 offset:20480
    ds_read_b128 v[68:71], v8 offset:21504
    v_mfma_f32_16x16x16_bf16 v[52:55], v[20:21], v[40:41], v[52:55]
    v_mfma_f32_16x16x16_bf16 v[44:47], v[30:31], v[40:41], v[44:47]
    v_mov_b64 v[20:21], 0
    v_mov_b64 v[22:23], 0
    v_mfma_f32_16x16x16_bf16 v[48:51], v[30:31], v[42:43], v[48:51]
    v_mov_b64 v[36:37], 0
    v_mov_b64 v[38:39], 0
    v_mov_b64 v[40:41], 0
    v_mov_b64 v[42:43], 0
    v_rcp_f32 v9, v52
    v_mov_b64 v[52:53], 0
    v_mov_b64 v[54:55], 0
    v_mul_f32 v44, v9, v44
    v_mul_f32 v48, v9, v48
    v_cvt_pk_bf16_f32 v16, v44, v48
    v_mul_f32 v45, v9, v45
    v_mul_f32 v49, v9, v49
    v_cvt_pk_bf16_f32 v17, v45, v49
    v_mul_f32 v46, v9, v46
    v_mul_f32 v50, v9, v50
    v_cvt_pk_bf16_f32 v18, v46, v50
    v_mul_f32 v47, v9, v47
    v_mul_f32 v51, v9, v51
    v_cvt_pk_bf16_f32 v19, v47, v51
    ds_write_b128 v5, v[16:19]
    v_mov_b64 v[28:29], 0
    v_mov_b64 v[30:31], 0
    s_waitcnt lgkmcnt(0)
    s_barrier
    ds_read_b128 v[44:47], v4 offset:0
    ds_read_b128 v[48:51], v4 offset:128
    v_mov_b64 v[16:17], 0
    v_mov_b64 v[18:19], 0
    buffer_load_dwordx4 v0, s[8:11], s41 offen offset:0 lds
    buffer_load_dwordx4 v0, s[8:11], s41 offen offset:1024 lds
    s_waitcnt lgkmcnt(1)
    v_smfmac_f32_16x16x64_bf16 v[12:15], v[44:47], a[184:191], v1
    s_waitcnt lgkmcnt(0)
    v_smfmac_f32_16x16x64_bf16 v[12:15], v[48:51], a[192:199], v1
    v_smfmac_f32_16x16x64_bf16 v[24:27], v[44:47], a[200:207], v1
    v_smfmac_f32_16x16x64_bf16 v[24:27], v[48:51], a[208:215], v1
    v_add_f32 v12, v12, v14
    v_smfmac_f32_16x16x64_bf16 v[20:23], v[44:47], a[216:223], v1
    v_add_f32 v13, v13, v15
    v_smfmac_f32_16x16x64_bf16 v[20:23], v[48:51], a[224:231], v1
    v_cvt_pk_bf16_f32 v12, v12, v13
    v_smfmac_f32_16x16x64_bf16 v[16:19], v[44:47], a[232:239], v1
    v_add_f32 v24, v24, v26
    v_smfmac_f32_16x16x64_bf16 v[16:19], v[48:51], a[240:247], v1
    v_add_f32 v25, v25, v27
    v_smfmac_f32_16x16x64_bf16 v[36:39], v[44:47], v[56:63], v1
    v_cvt_pk_bf16_f32 v13, v24, v25
    v_smfmac_f32_16x16x64_bf16 v[36:39], v[48:51], v[64:71], v1
    v_add_f32 v20, v20, v22
    v_add_f32 v21, v21, v23
    v_cvt_pk_bf16_f32 v14, v20, v21
    v_add_f32 v16, v16, v18
    v_add_f32 v17, v17, v19
    v_cvt_pk_bf16_f32 v15, v16, v17
    v_and_or_b32 v15, v15, -2, s40
    buffer_store_dwordx4 v[12:15], v0, s[8:11], s38 offen
    s_nop 0
    ds_read_b128 v[12:15], v8 offset:18432
    ds_read_b128 v[16:19], v8 offset:19456
    ds_read_b128 v[20:23], v8 offset:22528
    ds_read_b128 v[24:27], v8 offset:23552
    ds_read_b128 v[56:59], v8 offset:24576
    ds_read_b128 v[60:63], v8 offset:25600
    ds_read_b128 v[64:67], v8 offset:28672
    ds_read_b128 v[68:71], v8 offset:29696
    s_waitcnt lgkmcnt(6)
    v_smfmac_f32_16x16x64_bf16 v[40:43], v[44:47], v[12:19], v1
    ds_read_b128 v[12:15], v8 offset:26624
    ds_read_b128 v[16:19], v8 offset:27648
    s_waitcnt lgkmcnt(6)
    v_smfmac_f32_16x16x64_bf16 v[40:43], v[48:51], v[20:27], v1
    ds_read_b128 v[20:23], v8 offset:30720
    ds_read_b128 v[24:27], v8 offset:31744
    s_waitcnt lgkmcnt(6)
    v_smfmac_f32_16x16x64_bf16 v[52:55], v[44:47], v[56:63], v1
    ds_read_b128 v[56:59], v8 offset:32768
    ds_read_b128 v[60:63], v8 offset:33792
    s_waitcnt lgkmcnt(6)
    v_smfmac_f32_16x16x64_bf16 v[52:55], v[48:51], v[64:71], v1
    s_waitcnt lgkmcnt(4)
    v_smfmac_f32_16x16x64_bf16 v[32:35], v[44:47], v[12:19], v1
    s_waitcnt lgkmcnt(2)
    v_smfmac_f32_16x16x64_bf16 v[32:35], v[48:51], v[20:27], v1
    v_smfmac_f32_16x16x64_bf16 v[28:31], v[44:47], a[248:255], v1
    s_waitcnt lgkmcnt(0)
    v_smfmac_f32_16x16x64_bf16 v[28:31], v[48:51], v[56:63], v1
    v_add_f32 v36, v36, v38
    v_add_f32 v37, v37, v39
    v_cvt_pk_bf16_f32 v36, v36, v37
    v_add_f32 v40, v40, v42
    v_add_f32 v41, v41, v43
    v_cvt_pk_bf16_f32 v37, v40, v41
    v_add_f32 v52, v52, v54
    v_add_f32 v53, v53, v55
    v_cvt_pk_bf16_f32 v38, v52, v53
    v_add_f32 v32, v32, v34
    v_add_f32 v33, v33, v35
    v_cvt_pk_bf16_f32 v39, v32, v33
    v_and_or_b32 v39, v39, -2, s40
    s_add_u32 s17, s38, 4096
    buffer_store_dwordx4 v[36:39], v0, s[8:11], s17 offen
    v_add_f32 v28, v28, v30
    v_add_f32 v29, v29, v31
    v_cvt_pk_bf16_f32 v28, v28, v29
    v_and_or_b32 v28, v28, -2, s40
    v_lshrrev_b32 v9, 2, v0
    buffer_store_dword v28, v9, s[8:11], s39 offen
    v_add_u32 v10, 162560, v0
    ds_read_b128 v[64:67], v10
    s_add_u32 s33, s33, 1
    s_add_u32 s42, s42, 262144
    s_add_u32 s41, s41, 262144
    s_add_u32 s43, s43, 131072
    s_mov_b32 s67, s66
    s_add_u32 s68, s68, 262144
    s_add_u32 s66, s66, 22528
    ds_read_b128 v[56:59], v8 offset:4096
    ds_read_b128 v[60:63], v8 offset:5120
    v_mov_b64 v[12:13], 0
    v_mov_b64 v[14:15], 0
    v_mov_b64 v[16:17], 0
    v_mov_b64 v[18:19], 0
    v_mov_b64 v[20:21], 0
    v_mov_b64 v[22:23], 0
    v_mov_b64 v[24:25], 0
    v_mov_b64 v[26:27], 0
    v_mov_b64 v[28:29], 0
    v_mov_b64 v[30:31], 0
    v_mov_b64 v[32:33], 0
    v_mov_b64 v[34:35], 0
    s_nop 15
    s_nop 15
    s_nop 15
    s_nop 11
    buffer_load_dwordx4 v[40:43], v6, s[8:11], s62 offen sc1
    buffer_load_dwordx4 v[44:47], v6, s[8:11], s63 offen sc1
    buffer_load_dwordx4 v[48:51], v6, s[8:11], s64 offen sc1
    buffer_load_dwordx4 v[52:55], v6, s[8:11], s65 offen sc1
    s_waitcnt lgkmcnt(0)
    s_waitcnt vmcnt(3)
    v_mfma_f32_16x16x32_bf16 v[68:71], v[40:43], v[64:67], 0
    v_and_b32 v10, 1, v43
    v_cmp_ne_u32 s[54:55], s40, v10
    s_waitcnt vmcnt(2)
    v_mfma_f32_16x16x32_bf16 v[68:71], v[44:47], v[64:67], v[68:71]
    v_and_b32 v10, 1, v47
    v_cmp_ne_u32 s[56:57], s40, v10
    s_waitcnt vmcnt(1)
    v_mfma_f32_16x16x32_bf16 v[68:71], v[48:51], v[64:67], v[68:71]
    v_and_b32 v10, 1, v51
    v_cmp_ne_u32 s[58:59], s40, v10
    s_waitcnt vmcnt(0)
    v_mfma_f32_16x16x32_bf16 v[68:71], v[52:55], v[64:67], v[68:71]
    v_and_b32 v10, 1, v55
    v_cmp_ne_u32 s[60:61], s40, v10
    s_or_b64 vcc, s[54:55], s[56:57]
    s_or_b64 vcc, vcc, s[58:59]
    s_or_b64 vcc, vcc, s[60:61]
    s_cbranch_scc0 Lr1f_red
    s_mov_b32 s16, 0
Lr1f_p1:
    s_mov_b64 exec, s[54:55]
    buffer_load_dwordx4 v[40:43], v6, s[8:11], s62 offen sc1
    s_mov_b64 exec, s[56:57]
    buffer_load_dwordx4 v[44:47], v6, s[8:11], s63 offen sc1
    s_mov_b64 exec, s[58:59]
    buffer_load_dwordx4 v[48:51], v6, s[8:11], s64 offen sc1
    s_mov_b64 exec, s[60:61]
    buffer_load_dwordx4 v[52:55], v6, s[8:11], s65 offen sc1
    s_mov_b64 exec, -1
    s_add_u32 s16, s16, 1
    s_cmp_gt_u32 s16, 100000
    s_cbranch_scc1 Lr_abort
    s_waitcnt vmcnt(3)
    v_mfma_f32_16x16x32_bf16 v[68:71], v[40:43], v[64:67], 0
    v_and_b32 v10, 1, v43
    v_cmp_ne_u32 s[54:55], s40, v10
    s_waitcnt vmcnt(2)
    v_mfma_f32_16x16x32_bf16 v[68:71], v[44:47], v[64:67], v[68:71]
    v_and_b32 v10, 1, v47
    v_cmp_ne_u32 s[56:57], s40, v10
    s_waitcnt vmcnt(1)
    v_mfma_f32_16x16x32_bf16 v[68:71], v[48:51], v[64:67], v[68:71]
    v_and_b32 v10, 1, v51
    v_cmp_ne_u32 s[58:59], s40, v10
    s_waitcnt vmcnt(0)
    v_mfma_f32_16x16x32_bf16 v[68:71], v[52:55], v[64:67], v[68:71]
    v_and_b32 v10, 1, v55
    v_cmp_ne_u32 s[60:61], s40, v10
    s_or_b64 vcc, s[54:55], s[56:57]
    s_or_b64 vcc, vcc, s[58:59]
    s_or_b64 vcc, vcc, s[60:61]
    s_cbranch_scc1 Lr1f_p1
Lr1f_red:
    s_xor_b32 s34, s34, 16384
    s_xor_b32 s35, s35, 16384
    buffer_load_dwordx4 v[36:39], v0, s[8:11], s34 offen sc1
    v_permlane16_swap_b32 v68, v70
    v_permlane16_swap_b32 v69, v71
    s_mov_b64 exec, s[46:47]
    v_add_f32 v68, v68, v70
    v_add_f32 v69, v69, v71
    v_cvt_pk_bf16_f32 v68, v68, v69
    v_min_u32 v68, s50, v68
    buffer_store_dword v68, v7, s[8:11], s36 offen
    v_mov_b32 v69, -1
    buffer_store_dword v69, v7, s[8:11], s37 offen
    s_mov_b64 exec, -1
    buffer_load_dwordx4 v[36:39], v0, s[8:11], s34 offen sc1
    s_xor_b32 s40, s40, 1
    s_xor_b32 s36, s36, 16384
    s_xor_b32 s37, s37, 16384
    ds_read_b128 v[64:67], v8 offset:6144
    ds_read_b128 v[68:71], v8 offset:7168
    s_waitcnt lgkmcnt(0)
    s_branch Lr1f_step
Lr1f_pb_re:
    s_mov_b32 s16, 0
Lr1f_pb_lp:
    s_add_u32 s17, s34, 4096
    buffer_load_dwordx4 v[40:43], v0, s[8:11], s17 offen sc1
    s_add_u32 s16, s16, 1
    s_cmp_gt_u32 s16, 100000
    s_cbranch_scc1 Lr_abort
    s_waitcnt vmcnt(0)
    v_max3_u32 v10, v40, v41, v42
    v_max_u32 v10, v10, v43
    v_cmp_eq_u32 vcc, -1, v10
    s_nop 0
    s_cbranch_vccnz Lr1f_pb_lp
    s_branch Lr1f_pb_ok
Lr1f_pc_re:
    s_mov_b32 s16, 0
Lr1f_pc_lp:
    buffer_load_dwordx4 v[44:47], v0, s[8:11], s35 offen sc1
    s_add_u32 s16, s16, 1
    s_cmp_gt_u32 s16, 100000
    s_cbranch_scc1 Lr_abort
    s_waitcnt vmcnt(0)
    v_max3_u32 v10, v44, v45, v46
    v_max_u32 v10, v10, v47
    v_cmp_eq_u32 vcc, -1, v10
    s_nop 0
    s_cbranch_vccnz Lr1f_pc_lp
    s_branch Lr1f_pc_ok
Lr1f_last:
    s_waitcnt vmcnt(0) lgkmcnt(0)
    s_barrier
    s_mov_b32 s67, s66
    v_mov_b32 v9, 1
    v_mov_b32 v10, 0
    s_mov_b64 exec, 1
    buffer_store_dword v9, v10, s[8:11], s67 offen offset:384 sc1
    s_mov_b64 exec, -1
    s_branch Lr_exit
L_w2_1:
    s_cmp_lg_u32 s14, 2
    s_cbranch_scc1 L_w3_1
    buffer_load_dwordx4 v[36:39], v0, s[8:11], s34 offen sc1
    s_mov_b32 s16, 0
    s_add_u32 s17, s66, 128
    v_lshrrev_b32 v10, 2, v0
    v_and_b32 v9, 16, v10
    v_lshlrev_b32 v9, 3, v9
    v_and_or_b32 v10, v10, 12, v9
Lr2f_fw_12:
    buffer_load_dword v9, v10, s[8:11], s17 offen sc1
    s_add_u32 s16, s16, 1
    s_cmp_gt_u32 s16, 100000
    s_cbranch_scc1 Lr_abort
    s_waitcnt vmcnt(0)
    v_cmp_eq_u32 vcc, 0, v9
    s_nop 0
    s_cbranch_vccnz Lr2f_fw_12
    s_mov_b32 m0, 19200
    s_nop 0
    buffer_load_dwordx4 v0, s[8:11], s41 offen offset:0 lds
    buffer_load_dwordx4 v0, s[8:11], s41 offen offset:1024 lds
    s_add_u32 s41, s41, 262144
    s_add_u32 s68, s68, 262144
    ds_read_b128 v[56:59], v8 offset:4096
    ds_read_b128 v[60:63], v8 offset:5120
    ds_read_b128 v[64:67], v8 offset:6144
    ds_read_b128 v[68:71], v8 offset:7168
    v_mov_b64 v[12:13], 0
    v_mov_b64 v[14:15], 0
    v_mov_b64 v[16:17], 0
    v_mov_b64 v[18:19], 0
    v_mov_b64 v[20:21], 0
    v_mov_b64 v[22:23], 0
    v_mov_b64 v[24:25], 0
    v_mov_b64 v[26:27], 0
    v_mov_b64 v[28:29], 0
    v_mov_b64 v[30:31], 0
    v_mov_b64 v[32:33], 0
    v_mov_b64 v[34:35], 0
    s_waitcnt vmcnt(0) lgkmcnt(0)
Lr2f_step:
    s_waitcnt vmcnt(3)
    v_max3_u32 v10, v36, v37, v38
    v_max_u32 v10, v10, v39
    v_cmp_eq_u32 vcc, -1, v10
    s_nop 0
    s_cbranch_vccz Lr2f_aok
    buffer_load_dwordx4 v[36:39], v0, s[8:11], s34 offen sc1
    s_nop 15
    s_nop 8
    buffer_load_dwordx4 v[36:39], v0, s[8:11], s34 offen sc1
    s_mov_b32 s16, 0
Lr2f_alp:
    s_waitcnt vmcnt(2)
    v_max3_u32 v10, v36, v37, v38
    v_max_u32 v10, v10, v39
    v_cmp_eq_u32 vcc, -1, v10
    s_nop 0
    s_cbranch_vccz Lr2f_aok
    buffer_load_dwordx4 v[36:39], v0, s[8:11], s34 offen sc1
    s_add_u32 s16, s16, 1
    s_cmp_gt_u32 s16, 100000
    s_cbranch_scc1 Lr_abort
    s_branch Lr2f_alp
Lr2f_aok:
    ds_write_b128 v0, v[36:39] offset:8960
    v_smfmac_f32_16x16x64_bf16 v[12:15], v[36:39], v[104:111], v1
    v_smfmac_f32_16x16x64_bf16 v[16:19], v[36:39], v[112:119], v1
    v_smfmac_f32_16x16x64_bf16 v[20:23], v[36:39], v[216:223], v1
    s_waitcnt lgkmcnt(0)
    s_barrier
    ds_read_b128 v[48:51], v0 offset:9984
    ds_read_b128 v[52:55], v0 offset:6912
    v_smfmac_f32_16x16x64_bf16 v[28:31], v[36:39], v[56:63], v1
    ds_read_b128 v[56:59], v8 offset:0
    ds_read_b128 v[60:63], v8 offset:1024
    v_smfmac_f32_16x16x64_bf16 v[24:27], v[36:39], v[224:231], v1
    v_smfmac_f32_16x16x64_bf16 v[32:35], v[36:39], v[64:71], v1
    ds_read_b128 v[64:67], v8 offset:2048
    ds_read_b128 v[68:71], v8 offset:3072
    s_add_u32 s17, s34, 4096
    buffer_load_dwordx4 v[40:43], v0, s[8:11], s17 offen sc1
    s_waitcnt vmcnt(1)
    ds_read_b128 v[36:39], v0 offset:7936
    s_waitcnt lgkmcnt(6)
    v_smfmac_f32_16x16x64_bf16 v[28:31], v[48:51], a[88:95], v1
    v_smfmac_f32_16x16x64_bf16 v[12:15], v[48:51], v[120:127], v1
    v_smfmac_f32_16x16x64_bf16 v[16:19], v[48:51], v[128:135], v1
    v_smfmac_f32_16x16x64_bf16 v[32:35], v[48:51], a[96:103], v1
    buffer_load_dwordx4 v[44:47], v0, s[8:11], s35 offen sc1
    v_smfmac_f32_16x16x64_bf16 v[20:23], v[48:51], v[232:239], v1
    v_lshrrev_b32 v10, 2, v0
    v_and_b32 v9, 16, v10
    v_lshlrev_b32 v9, 3, v9
    v_and_or_b32 v10, v10, 12, v9
    s_add_u32 s17, s66, 22656
    v_mov_b32 v11, 2
    buffer_load_dword v11, v10, s[8:11], s17 offen sc1
    v_smfmac_f32_16x16x64_bf16 v[24:27], v[48:51], v[240:247], v1
    s_waitcnt lgkmcnt(3)
    v_smfmac_f32_16x16x64_bf16 v[28:31], v[52:55], v[56:63], v1
    ds_read_b128 v[56:59], v8 offset:12288
    ds_read_b128 v[60:63], v8 offset:13312
    v_smfmac_f32_16x16x64_bf16 v[12:15], v[52:55], v[72:79], v1
    v_smfmac_f32_16x16x64_bf16 v[16:19], v[52:55], v[80:87], v1
    s_waitcnt lgkmcnt(3)
    v_smfmac_f32_16x16x64_bf16 v[32:35], v[52:55], v[64:71], v1
    ds_read_b128 v[64:67], v8 offset:14336
    ds_read_b128 v[68:71], v8 offset:15360
    v_smfmac_f32_16x16x64_bf16 v[20:23], v[52:55], v[184:191], v1
    v_smfmac_f32_16x16x64_bf16 v[24:27], v[52:55], v[192:199], v1
    s_waitcnt lgkmcnt(4)
    v_smfmac_f32_16x16x64_bf16 v[28:31], v[36:39], a[72:79], v1
    v_smfmac_f32_16x16x64_bf16 v[12:15], v[36:39], v[88:95], v1
    v_smfmac_f32_16x16x64_bf16 v[16:19], v[36:39], v[96:103], v1
    v_smfmac_f32_16x16x64_bf16 v[32:35], v[36:39], a[80:87], v1
    v_smfmac_f32_16x16x64_bf16 v[20:23], v[36:39], v[200:207], v1
    v_smfmac_f32_16x16x64_bf16 v[24:27], v[36:39], v[208:215], v1
    s_waitcnt vmcnt(2)
    v_max3_u32 v10, v40, v41, v42
    v_max_u32 v10, v10, v43
    v_cmp_eq_u32 vcc, -1, v10
    s_nop 0
    s_cbranch_vccnz Lr2f_pb_re
Lr2f_pb_ok:
    ds_write_b128 v0, v[40:43] offset:13056
    s_waitcnt lgkmcnt(3)
    v_smfmac_f32_16x16x64_bf16 v[12:15], v[40:43], v[56:63], v1
    ds_read_b128 v[56:59], v8 offset:8192
    ds_read_b128 v[60:63], v8 offset:9216
    v_smfmac_f32_16x16x64_bf16 v[20:23], v[40:43], a[24:31], v1
    s_waitcnt lgkmcnt(3)
    v_smfmac_f32_16x16x64_bf16 v[16:19], v[40:43], v[64:71], v1
    ds_read_b128 v[64:67], v8 offset:10240
    ds_read_b128 v[68:71], v8 offset:11264
    v_smfmac_f32_16x16x64_bf16 v[24:27], v[40:43], a[32:39], v1
    s_waitcnt lgkmcnt(4)
    s_barrier
    ds_read_b128 v[48:51], v0 offset:11008
    ds_read_b128 v[52:55], v0 offset:14080
    ds_read_b128 v[36:39], v0 offset:12032
    v_smfmac_f32_16x16x64_bf16 v[28:31], v[40:43], a[136:143], v1
    v_smfmac_f32_16x16x64_bf16 v[32:35], v[40:43], a[144:151], v1
    s_waitcnt lgkmcnt(2)
    v_smfmac_f32_16x16x64_bf16 v[12:15], v[48:51], v[56:63], v1
    v_smfmac_f32_16x16x64_bf16 v[16:19], v[48:51], v[64:71], v1
    s_waitcnt lgkmcnt(1)
    v_smfmac_f32_16x16x64_bf16 v[12:15], v[52:55], v[152:159], v1
    v_smfmac_f32_16x16x64_bf16 v[16:19], v[52:55], v[160:167], v1
    s_waitcnt lgkmcnt(0)
    v_smfmac_f32_16x16x64_bf16 v[12:15], v[36:39], v[136:143], v1
    v_smfmac_f32_16x16x64_bf16 v[16:19], v[36:39], v[144:151], v1
    s_waitcnt vmcnt(1)
    v_max3_u32 v10, v44, v45, v46
    v_max_u32 v10, v10, v47
    v_cmp_eq_u32 vcc, -1, v10
    s_nop 0
    s_cbranch_vccnz Lr2f_pc_re
Lr2f_pc_ok:
    v_smfmac_f32_16x16x64_bf16 v[12:15], v[44:47], v[168:175], v1
    v_smfmac_f32_16x16x64_bf16 v[16:19], v[44:47], v[176:183], v1
    v_smfmac_f32_16x16x64_bf16 v[20:23], v[48:51], v[248:255], v1
    v_smfmac_f32_16x16x64_bf16 v[24:27], v[48:51], a[0:7], v1
    v_smfmac_f32_16x16x64_bf16 v[20:23], v[52:55], a[40:47], v1
    v_add_f32 v12, v12, v14
    buffer_load_dwordx4 v[64:67], v0, s[8:11], s42 offen
    v_smfmac_f32_16x16x64_bf16 v[24:27], v[52:55], a[48:55], v1
    v_add_f32 v16, v16, v18
    v_smfmac_f32_16x16x64_bf16 v[20:23], v[36:39], a[8:15], v1
    v_add_f32 v13, v13, v15
    v_smfmac_f32_16x16x64_bf16 v[24:27], v[36:39], a[16:23], v1
    v_add_f32 v17, v17, v19
    v_smfmac_f32_16x16x64_bf16 v[20:23], v[44:47], a[56:63], v1
    v_cvt_pk_bf16_f32 v14, v12, v16
    ds_read_b128 v[56:59], v0 offset:15104
    buffer_load_dwordx4 v[68:71], v0, s[8:11], s42 offen offset:1024
    v_smfmac_f32_16x16x64_bf16 v[24:27], v[44:47], a[64:71], v1
    v_cvt_pk_bf16_f32 v15, v13, v17
    ds_read_b128 v[60:63], v0 offset:16128
    ds_write_b32 v2, v14 offset:576
    ds_write_b32 v2, v15 offset:864
    v_smfmac_f32_16x16x64_bf16 v[28:31], v[48:51], a[104:111], v1
    v_smfmac_f32_16x16x64_bf16 v[32:35], v[48:51], a[112:119], v1
    v_add_f32 v20, v20, v22
    v_add_f32 v24, v24, v26
    v_add_f32 v21, v21, v23
    v_add_f32 v25, v25, v27
    v_cvt_pk_bf16_f32 v22, v20, v24
    v_cvt_pk_bf16_f32 v23, v21, v25
    ds_write_b32 v2, v22 offset:0
    ds_write_b32 v2, v23 offset:288
    v_smfmac_f32_16x16x64_bf16 v[28:31], v[52:55], a[152:159], v1
    v_smfmac_f32_16x16x64_bf16 v[32:35], v[52:55], a[160:167], v1
    s_waitcnt vmcnt(2)
    v_cmp_eq_u32 vcc, 0, v11
    s_nop 0
    s_cbranch_vccnz Lr2f_flbad
Lr2f_flok:
    s_waitcnt lgkmcnt(0)
    s_barrier
    ds_read_b128 v[40:43], v3 offset:0
    ds_read_b128 v[48:51], v3 offset:64
    ds_read_b128 v[20:23], v3 offset:128
    ds_read_b128 v[52:55], v3 offset:192
    v_smfmac_f32_16x16x64_bf16 v[28:31], v[36:39], a[120:127], v1
    v_smfmac_f32_16x16x64_bf16 v[32:35], v[36:39], a[128:135], v1
    ds_read_b128 v[36:39], v0 offset:17152
    v_smfmac_f32_16x16x64_bf16 v[28:31], v[44:47], a[168:175], v1
    v_smfmac_f32_16x16x64_bf16 v[32:35], v[44:47], a[176:183], v1
    ds_read_b128 v[44:47], v0 offset:18176
    s_waitcnt lgkmcnt(5)
    v_mfma_f32_16x16x32_bf16 v[12:15], v[56:59], v[40:43], 0
    v_mfma_f32_16x16x32_bf16 v[16:19], v[60:63], v[40:43], 0
    v_mfma_f32_16x16x32_bf16 v[24:27], v[40:43], v[40:43], 0
    ds_read_b128 v[56:59], v0 offset:19200
    ds_read_b128 v[60:63], v0 offset:20224
    s_waitcnt lgkmcnt(3)
    v_mfma_f32_16x16x32_bf16 v[12:15], v[36:39], v[48:51], v[12:15]
    v_lshrrev_b32 v10, 1, v0
    v_lshrrev_b32 v9, 9, v0
    s_waitcnt lgkmcnt(2)
    v_mfma_f32_16x16x32_bf16 v[16:19], v[44:47], v[48:51], v[16:19]
    v_lshl_add_u32 v9, v9, 5, v10
    v_add_f32 v28, v28, v30
    v_mfma_f32_16x16x32_bf16 v[24:27], v[48:51], v[48:51], v[24:27]
    v_add_f32 v32, v32, v34
    v_add_f32 v29, v29, v31
    ds_read_b128 v[36:39], v0 offset:21248
    ds_read_b128 v[44:47], v0 offset:22272
    s_waitcnt lgkmcnt(3)
    v_mfma_f32_16x16x32_bf16 v[12:15], v[56:59], v[20:23], v[12:15]
    v_add_f32 v33, v33, v35
    v_cvt_pk_bf16_f32 v30, v28, v29
    s_waitcnt lgkmcnt(2)
    v_mfma_f32_16x16x32_bf16 v[16:19], v[60:63], v[20:23], v[16:19]
    v_cvt_pk_bf16_f32 v31, v32, v33
    ds_read_b64 v[34:35], v9 offset:2304
    v_mfma_f32_16x16x32_bf16 v[24:27], v[20:23], v[20:23], v[24:27]
    s_add_u32 s17, s43, 3072
    buffer_store_dwordx2 v[30:31], v10, s[8:11], s17 offen sc1
    s_waitcnt lgkmcnt(2)
    v_mfma_f32_16x16x32_bf16 v[12:15], v[36:39], v[52:55], v[12:15]
    s_waitcnt lgkmcnt(1)
    v_mfma_f32_16x16x32_bf16 v[16:19], v[44:47], v[52:55], v[16:19]
    v_mfma_f32_16x16x32_bf16 v[24:27], v[52:55], v[52:55], v[24:27]
    s_add_u32 s17, s43, 1024
    s_waitcnt lgkmcnt(0)
    buffer_store_dwordx2 v[34:35], v10, s[8:11], s17 offen sc1
    s_cmp_eq_u32 s33, 63
    s_cbranch_scc1 Lr2f_last
    ds_read_b128 v[56:59], v8 offset:16384
    ds_read_b128 v[60:63], v8 offset:17408
    v_mov_b64 v[20:21], s[52:53]
    v_mov_b64 v[22:23], s[52:53]
    v_mov_b32 v41, 0
    v_mov_b32 v42, 0
    v_max3_f32 v9, v12, v13, v14
    v_max3_f32 v9, v9, v15, v16
    v_max3_f32 v9, v9, v17, v18
    v_max3_f32 v9, v9, v19, v24
    v_max_f32 v9, v9, v25
    v_mov_b32 v10, v9
    v_mov_b64 v[32:33], 0
    v_mov_b64 v[34:35], 0
    v_permlane32_swap_b32 v9, v10
    v_max_f32 v9, v9, v10
    v_mov_b32 v10, v9
    s_nop 1
    v_permlane16_swap_b32 v9, v10
    v_max_f32 v9, v9, v10
    v_mul_f32 v28, s44, v9
    v_fma_f32 v12, v12, s44, -v28
    v_fma_f32 v13, v13, s44, -v28
    v_fma_f32 v14, v14, s44, -v28
    v_fma_f32 v15, v15, s44, -v28
    v_exp_f32 v12, v12
    v_exp_f32 v13, v13
    v_fma_f32 v16, v16, s44, -v28
    v_fma_f32 v17, v17, s44, -v28
    v_exp_f32 v14, v14
    v_exp_f32 v15, v15
    v_cvt_pk_bf16_f32 v36, v12, v13
    v_fma_f32 v18, v18, s44, -v28
    v_fma_f32 v19, v19, s44, -v28
    v_exp_f32 v16, v16
    v_exp_f32 v17, v17
    v_cvt_pk_bf16_f32 v37, v14, v15
    v_fma_f32 v24, v24, s44, -v28
    v_fma_f32 v25, v25, s44, -v28
    v_exp_f32 v18, v18
    v_exp_f32 v19, v19
    v_cvt_pk_bf16_f32 v38, v16, v17
    v_exp_f32 v24, v24
    v_exp_f32 v25, v25
    v_cvt_pk_bf16_f32 v39, v18, v19
    v_cvt_pk_bf16_f32 v40, v24, v25
    v_cvt_pk_bf16_f32 v43, v24, v25
    v_mfma_f32_16x16x32_bf16 v[52:55], v[20:23], v[36:39], 0
    v_mov_b64 v[12:13], 0
    v_mov_b64 v[14:15], 0
    s_waitcnt vmcnt(3)
    v_mfma_f32_16x16x32_bf16 v[44:47], v[64:67], v[36:39], 0
    v_mov_b64 v[24:25], 0
    v_mov_b64 v[26:27], 0
    s_waitcnt vmcnt(2)
    v_mfma_f32_16x16x32_bf16 v[48:51], v[68:71], v[36:39], 0
    ds_read_b128 v[64:67], v8 offset:20480
    ds_read_b128 v[68:71], v8 offset:21504
    v_mfma_f32_16x16x16_bf16 v[52:55], v[20:21], v[40:41], v[52:55]
    v_mfma_f32_16x16x16_bf16 v[44:47], v[30:31], v[40:41], v[44:47]
    v_mov_b64 v[20:21], 0
    v_mov_b64 v[22:23], 0
    v_mfma_f32_16x16x16_bf16 v[48:51], v[30:31], v[42:43], v[48:51]
    v_mov_b64 v[36:37], 0
    v_mov_b64 v[38:39], 0
    v_mov_b64 v[40:41], 0
    v_mov_b64 v[42:43], 0
    v_rcp_f32 v9, v52
    v_mov_b64 v[52:53], 0
    v_mov_b64 v[54:55], 0
    v_mul_f32 v44, v9, v44
    v_mul_f32 v48, v9, v48
    v_cvt_pk_bf16_f32 v16, v44, v48
    v_mul_f32 v45, v9, v45
    v_mul_f32 v49, v9, v49
    v_cvt_pk_bf16_f32 v17, v45, v49
    v_mul_f32 v46, v9, v46
    v_mul_f32 v50, v9, v50
    v_cvt_pk_bf16_f32 v18, v46, v50
    v_mul_f32 v47, v9, v47
    v_mul_f32 v51, v9, v51
    v_cvt_pk_bf16_f32 v19, v47, v51
    ds_write_b128 v5, v[16:19]
    v_mov_b64 v[28:29], 0
    v_mov_b64 v[30:31], 0
    s_waitcnt lgkmcnt(0)
    s_barrier
    ds_read_b128 v[44:47], v4 offset:0
    ds_read_b128 v[48:51], v4 offset:128
    v_mov_b64 v[16:17], 0
    v_mov_b64 v[18:19], 0
    buffer_load_dwordx4 v0, s[8:11], s41 offen offset:0 lds
    buffer_load_dwordx4 v0, s[8:11], s41 offen offset:1024 lds
    s_waitcnt lgkmcnt(1)
    v_smfmac_f32_16x16x64_bf16 v[12:15], v[44:47], a[184:191], v1
    s_waitcnt lgkmcnt(0)
    v_smfmac_f32_16x16x64_bf16 v[12:15], v[48:51], a[192:199], v1
    v_smfmac_f32_16x16x64_bf16 v[24:27], v[44:47], a[200:207], v1
    v_smfmac_f32_16x16x64_bf16 v[24:27], v[48:51], a[208:215], v1
    v_add_f32 v12, v12, v14
    v_smfmac_f32_16x16x64_bf16 v[20:23], v[44:47], a[216:223], v1
    v_add_f32 v13, v13, v15
    v_smfmac_f32_16x16x64_bf16 v[20:23], v[48:51], a[224:231], v1
    v_cvt_pk_bf16_f32 v12, v12, v13
    v_smfmac_f32_16x16x64_bf16 v[16:19], v[44:47], a[232:239], v1
    v_add_f32 v24, v24, v26
    v_smfmac_f32_16x16x64_bf16 v[16:19], v[48:51], a[240:247], v1
    v_add_f32 v25, v25, v27
    v_smfmac_f32_16x16x64_bf16 v[36:39], v[44:47], v[56:63], v1
    v_cvt_pk_bf16_f32 v13, v24, v25
    v_smfmac_f32_16x16x64_bf16 v[36:39], v[48:51], v[64:71], v1
    v_add_f32 v20, v20, v22
    v_add_f32 v21, v21, v23
    v_cvt_pk_bf16_f32 v14, v20, v21
    v_add_f32 v16, v16, v18
    v_add_f32 v17, v17, v19
    v_cvt_pk_bf16_f32 v15, v16, v17
    v_and_or_b32 v15, v15, -2, s40
    buffer_store_dwordx4 v[12:15], v0, s[8:11], s38 offen
    s_nop 0
    ds_read_b128 v[12:15], v8 offset:18432
    ds_read_b128 v[16:19], v8 offset:19456
    ds_read_b128 v[20:23], v8 offset:22528
    ds_read_b128 v[24:27], v8 offset:23552
    ds_read_b128 v[56:59], v8 offset:24576
    ds_read_b128 v[60:63], v8 offset:25600
    ds_read_b128 v[64:67], v8 offset:28672
    ds_read_b128 v[68:71], v8 offset:29696
    s_waitcnt lgkmcnt(6)
    v_smfmac_f32_16x16x64_bf16 v[40:43], v[44:47], v[12:19], v1
    ds_read_b128 v[12:15], v8 offset:26624
    ds_read_b128 v[16:19], v8 offset:27648
    s_waitcnt lgkmcnt(6)
    v_smfmac_f32_16x16x64_bf16 v[40:43], v[48:51], v[20:27], v1
    ds_read_b128 v[20:23], v8 offset:30720
    ds_read_b128 v[24:27], v8 offset:31744
    s_waitcnt lgkmcnt(6)
    v_smfmac_f32_16x16x64_bf16 v[52:55], v[44:47], v[56:63], v1
    ds_read_b128 v[56:59], v8 offset:32768
    ds_read_b128 v[60:63], v8 offset:33792
    s_waitcnt lgkmcnt(6)
    v_smfmac_f32_16x16x64_bf16 v[52:55], v[48:51], v[64:71], v1
    s_waitcnt lgkmcnt(4)
    v_smfmac_f32_16x16x64_bf16 v[32:35], v[44:47], v[12:19], v1
    s_waitcnt lgkmcnt(2)
    v_smfmac_f32_16x16x64_bf16 v[32:35], v[48:51], v[20:27], v1
    v_smfmac_f32_16x16x64_bf16 v[28:31], v[44:47], a[248:255], v1
    s_waitcnt lgkmcnt(0)
    v_smfmac_f32_16x16x64_bf16 v[28:31], v[48:51], v[56:63], v1
    v_add_f32 v36, v36, v38
    v_add_f32 v37, v37, v39
    v_cvt_pk_bf16_f32 v36, v36, v37
    v_add_f32 v40, v40, v42
    v_add_f32 v41, v41, v43
    v_cvt_pk_bf16_f32 v37, v40, v41
    v_add_f32 v52, v52, v54
    v_add_f32 v53, v53, v55
    v_cvt_pk_bf16_f32 v38, v52, v53
    v_add_f32 v32, v32, v34
    v_add_f32 v33, v33, v35
    v_cvt_pk_bf16_f32 v39, v32, v33
    v_and_or_b32 v39, v39, -2, s40
    s_add_u32 s17, s38, 4096
    buffer_store_dwordx4 v[36:39], v0, s[8:11], s17 offen
    v_add_f32 v28, v28, v30
    v_add_f32 v29, v29, v31
    v_cvt_pk_bf16_f32 v28, v28, v29
    v_and_or_b32 v28, v28, -2, s40
    v_lshrrev_b32 v9, 2, v0
    buffer_store_dword v28, v9, s[8:11], s39 offen
    v_add_u32 v10, 162560, v0
    ds_read_b32 v64, v10
    v_mov_b32 v65, 0
    v_mov_b32 v41, 0
    v_mov_b32 v45, 0
    v_mov_b32 v49, 0
    v_mov_b32 v53, 0
    s_add_u32 s33, s33, 1
    s_add_u32 s42, s42, 262144
    s_add_u32 s41, s41, 262144
    s_add_u32 s43, s43, 131072
    s_add_u32 s68, s68, 262144
    s_add_u32 s66, s66, 22528
    ds_read_b128 v[56:59], v8 offset:4096
    ds_read_b128 v[60:63], v8 offset:5120
    v_mov_b64 v[12:13], 0
    v_mov_b64 v[14:15], 0
    v_mov_b64 v[16:17], 0
    v_mov_b64 v[18:19], 0
    v_mov_b64 v[20:21], 0
    v_mov_b64 v[22:23], 0
    v_mov_b64 v[24:25], 0
    v_mov_b64 v[26:27], 0
    v_mov_b64 v[28:29], 0
    v_mov_b64 v[30:31], 0
    v_mov_b64 v[32:33], 0
    v_mov_b64 v[34:35], 0
    s_nop 15
    s_nop 15
    s_nop 15
    s_nop 1
    buffer_load_dword v40, v6, s[8:11], s62 offen sc1
    buffer_load_dword v44, v6, s[8:11], s63 offen sc1
    buffer_load_dword v48, v6, s[8:11], s64 offen sc1
    buffer_load_dword v52, v6, s[8:11], s65 offen sc1
    s_waitcnt lgkmcnt(0)
    s_waitcnt vmcnt(3)
    v_mfma_f32_16x16x16_bf16 v[68:71], v[40:41], v[64:65], 0
    v_and_b32 v10, 1, v40
    v_cmp_ne_u32 s[54:55], s40, v10
    s_waitcnt vmcnt(2)
    v_mfma_f32_16x16x16_bf16 v[68:71], v[44:45], v[64:65], v[68:71]
    v_and_b32 v10, 1, v44
    v_cmp_ne_u32 s[56:57], s40, v10
    s_waitcnt vmcnt(1)
    v_mfma_f32_16x16x16_bf16 v[68:71], v[48:49], v[64:65], v[68:71]
    v_and_b32 v10, 1, v48
    v_cmp_ne_u32 s[58:59], s40, v10
    s_waitcnt vmcnt(0)
    v_mfma_f32_16x16x16_bf16 v[68:71], v[52:53], v[64:65], v[68:71]
    v_and_b32 v10, 1, v52
    v_cmp_ne_u32 s[60:61], s40, v10
    s_or_b64 vcc, s[54:55], s[56:57]
    s_or_b64 vcc, vcc, s[58:59]
    s_or_b64 vcc, vcc, s[60:61]
    s_cbranch_scc0 Lr2f_red
    s_mov_b32 s16, 0
Lr2f_p1:
    s_mov_b64 exec, s[54:55]
    buffer_load_dword v40, v6, s[8:11], s62 offen sc1
    s_mov_b64 exec, s[56:57]
    buffer_load_dword v44, v6, s[8:11], s63 offen sc1
    s_mov_b64 exec, s[58:59]
    buffer_load_dword v48, v6, s[8:11], s64 offen sc1
    s_mov_b64 exec, s[60:61]
    buffer_load_dword v52, v6, s[8:11], s65 offen sc1
    s_mov_b64 exec, -1
    s_add_u32 s16, s16, 1
    s_cmp_gt_u32 s16, 100000
    s_cbranch_scc1 Lr_abort
    s_waitcnt vmcnt(3)
    v_mfma_f32_16x16x16_bf16 v[68:71], v[40:41], v[64:65], 0
    v_and_b32 v10, 1, v40
    v_cmp_ne_u32 s[54:55], s40, v10
    s_waitcnt vmcnt(2)
    v_mfma_f32_16x16x16_bf16 v[68:71], v[44:45], v[64:65], v[68:71]
    v_and_b32 v10, 1, v44
    v_cmp_ne_u32 s[56:57], s40, v10
    s_waitcnt vmcnt(1)
    v_mfma_f32_16x16x16_bf16 v[68:71], v[48:49], v[64:65], v[68:71]
    v_and_b32 v10, 1, v48
    v_cmp_ne_u32 s[58:59], s40, v10
    s_waitcnt vmcnt(0)
    v_mfma_f32_16x16x16_bf16 v[68:71], v[52:53], v[64:65], v[68:71]
    v_and_b32 v10, 1, v52
    v_cmp_ne_u32 s[60:61], s40, v10
    s_or_b64 vcc, s[54:55], s[56:57]
    s_or_b64 vcc, vcc, s[58:59]
    s_or_b64 vcc, vcc, s[60:61]
    s_cbranch_scc1 Lr2f_p1
Lr2f_red:
    s_xor_b32 s34, s34, 16384
    s_xor_b32 s35, s35, 16384
    buffer_load_dwordx4 v[36:39], v0, s[8:11], s34 offen sc1
    v_permlane16_swap_b32 v68, v70
    v_permlane16_swap_b32 v69, v71
    s_mov_b64 exec, s[46:47]
    v_add_f32 v68, v68, v70
    v_add_f32 v69, v69, v71
    v_cvt_pk_bf16_f32 v68, v68, v69
    v_min_u32 v68, s50, v68
    buffer_store_dword v68, v7, s[8:11], s36 offen
    v_mov_b32 v69, -1
    buffer_store_dword v69, v7, s[8:11], s37 offen
    s_mov_b64 exec, -1
    buffer_load_dwordx4 v[36:39], v0, s[8:11], s34 offen sc1
    s_xor_b32 s40, s40, 1
    s_xor_b32 s36, s36, 16384
    s_xor_b32 s37, s37, 16384
    ds_read_b128 v[64:67], v8 offset:6144
    ds_read_b128 v[68:71], v8 offset:7168
    s_waitcnt lgkmcnt(0)
    s_branch Lr2f_step
Lr2f_pb_re:
    s_mov_b32 s16, 0
Lr2f_pb_lp:
    s_add_u32 s17, s34, 4096
    buffer_load_dwordx4 v[40:43], v0, s[8:11], s17 offen sc1
    s_add_u32 s16, s16, 1
    s_cmp_gt_u32 s16, 100000
    s_cbranch_scc1 Lr_abort
    s_waitcnt vmcnt(0)
    v_max3_u32 v10, v40, v41, v42
    v_max_u32 v10, v10, v43
    v_cmp_eq_u32 vcc, -1, v10
    s_nop 0
    s_cbranch_vccnz Lr2f_pb_lp
    s_branch Lr2f_pb_ok
Lr2f_pc_re:
    s_mov_b32 s16, 0
Lr2f_pc_lp:
    buffer_load_dwordx4 v[44:47], v0, s[8:11], s35 offen sc1
    s_add_u32 s16, s16, 1
    s_cmp_gt_u32 s16, 100000
    s_cbranch_scc1 Lr_abort
    s_waitcnt vmcnt(0)
    v_max3_u32 v10, v44, v45, v46
    v_max_u32 v10, v10, v47
    v_cmp_eq_u32 vcc, -1, v10
    s_nop 0
    s_cbranch_vccnz Lr2f_pc_lp
    s_branch Lr2f_pc_ok
Lr2f_flbad:
    s_cmp_eq_u32 s33, 63
    s_cbranch_scc1 Lr2f_flok
    s_mov_b32 s16, 0
    s_add_u32 s17, s66, 22656
    v_lshrrev_b32 v10, 2, v0
    v_and_b32 v9, 16, v10
    v_lshlrev_b32 v9, 3, v9
    v_and_or_b32 v10, v10, 12, v9
Lr2f_fw_13:
    buffer_load_dword v9, v10, s[8:11], s17 offen sc1
    s_add_u32 s16, s16, 1
    s_cmp_gt_u32 s16, 100000
    s_cbranch_scc1 Lr_abort
    s_waitcnt vmcnt(0)
    v_cmp_eq_u32 vcc, 0, v9
    s_nop 0
    s_cbranch_vccnz Lr2f_fw_13
    s_branch Lr2f_flok
Lr2f_last:
    s_waitcnt vmcnt(0) lgkmcnt(0)
    s_barrier
    s_branch Lr_exit
L_w3_1:
    buffer_load_dwordx4 v[36:39], v0, s[8:11], s34 offen sc1
    s_mov_b32 s16, 0
    s_add_u32 s17, s66, 128
    v_lshrrev_b32 v10, 2, v0
    v_and_b32 v9, 16, v10
    v_lshlrev_b32 v9, 3, v9
    v_and_or_b32 v10, v10, 12, v9
Lr3f_fw_14:
    buffer_load_dword v9, v10, s[8:11], s17 offen sc1
    s_add_u32 s16, s16, 1
    s_cmp_gt_u32 s16, 100000
    s_cbranch_scc1 Lr_abort
    s_waitcnt vmcnt(0)
    v_cmp_eq_u32 vcc, 0, v9
    s_nop 0
    s_cbranch_vccnz Lr3f_fw_14
    s_mov_b32 m0, 21248
    s_nop 0
    buffer_load_dwordx4 v0, s[8:11], s41 offen offset:0 lds
    buffer_load_dwordx4 v0, s[8:11], s41 offen offset:1024 lds
    s_add_u32 s41, s41, 262144
    s_add_u32 s68, s68, 262144
    ds_read_b128 v[56:59], v8 offset:0
    ds_read_b128 v[60:63], v8 offset:1024
    ds_read_b128 v[64:67], v8 offset:2048
    ds_read_b128 v[68:71], v8 offset:3072
    v_mov_b64 v[12:13], 0
    v_mov_b64 v[14:15], 0
    v_mov_b64 v[16:17], 0
    v_mov_b64 v[18:19], 0
    v_mov_b64 v[20:21], 0
    v_mov_b64 v[22:23], 0
    v_mov_b64 v[24:25], 0
    v_mov_b64 v[26:27], 0
    v_mov_b64 v[28:29], 0
    v_mov_b64 v[30:31], 0
    v_mov_b64 v[32:33], 0
    v_mov_b64 v[34:35], 0
    s_waitcnt vmcnt(0) lgkmcnt(0)
Lr3f_step:
    s_mov_b32 s16, 0
Lr3f_alp:
    s_waitcnt vmcnt(2)
    v_max3_u32 v10, v36, v37, v38
    v_max_u32 v10, v10, v39
    v_cmp_eq_u32 vcc, -1, v10
    s_nop 0
    s_cbranch_vccz Lr3f_aok
    buffer_load_dwordx4 v[36:39], v0, s[8:11], s34 offen sc1
    s_add_u32 s16, s16, 1
    s_cmp_gt_u32 s16, 100000
    s_cbranch_scc1 Lr_abort
    s_branch Lr3f_alp
Lr3f_aok:
    ds_write_b128 v0, v[36:39] offset:9984
    v_smfmac_f32_16x16x64_bf16 v[12:15], v[36:39], v[120:127], v1
    v_smfmac_f32_16x16x64_bf16 v[16:19], v[36:39], v[128:135], v1
    v_smfmac_f32_16x16x64_bf16 v[20:23], v[36:39], v[232:239], v1
    s_waitcnt lgkmcnt(0)
    s_barrier
    ds_read_b128 v[48:51], v0 offset:6912
    ds_read_b128 v[52:55], v0 offset:7936
    v_smfmac_f32_16x16x64_bf16 v[28:31], v[36:39], a[88:95], v1
    v_smfmac_f32_16x16x64_bf16 v[24:27], v[36:39], v[240:247], v1
    v_smfmac_f32_16x16x64_bf16 v[32:35], v[36:39], a[96:103], v1
    s_waitcnt vmcnt(0)
    ds_read_b128 v[36:39], v0 offset:8960
    s_waitcnt lgkmcnt(2)
    v_smfmac_f32_16x16x64_bf16 v[28:31], v[48:51], v[56:63], v1
    ds_read_b128 v[56:59], v8 offset:4096
    ds_read_b128 v[60:63], v8 offset:5120
    s_add_u32 s17, s34, 4096
    buffer_load_dwordx4 v[40:43], v0, s[8:11], s17 offen sc1
    v_smfmac_f32_16x16x64_bf16 v[12:15], v[48:51], v[72:79], v1
    v_smfmac_f32_16x16x64_bf16 v[16:19], v[48:51], v[80:87], v1
    v_smfmac_f32_16x16x64_bf16 v[32:35], v[48:51], v[64:71], v1
    ds_read_b128 v[64:67], v8 offset:6144
    ds_read_b128 v[68:71], v8 offset:7168
    v_smfmac_f32_16x16x64_bf16 v[20:23], v[48:51], v[184:191], v1
    buffer_load_dwordx4 v[44:47], v0, s[8:11], s35 offen sc1
    v_smfmac_f32_16x16x64_bf16 v[24:27], v[48:51], v[192:199], v1
    s_waitcnt lgkmcnt(5)
    v_smfmac_f32_16x16x64_bf16 v[28:31], v[52:55], a[72:79], v1
    v_smfmac_f32_16x16x64_bf16 v[12:15], v[52:55], v[88:95], v1
    v_smfmac_f32_16x16x64_bf16 v[16:19], v[52:55], v[96:103], v1
    v_smfmac_f32_16x16x64_bf16 v[32:35], v[52:55], a[80:87], v1
    v_smfmac_f32_16x16x64_bf16 v[20:23], v[52:55], v[200:207], v1
    v_smfmac_f32_16x16x64_bf16 v[24:27], v[52:55], v[208:215], v1
    s_waitcnt lgkmcnt(2)
    v_smfmac_f32_16x16x64_bf16 v[28:31], v[36:39], v[56:63], v1
    ds_read_b128 v[56:59], v8 offset:8192
    ds_read_b128 v[60:63], v8 offset:9216
    v_smfmac_f32_16x16x64_bf16 v[12:15], v[36:39], v[104:111], v1
    v_smfmac_f32_16x16x64_bf16 v[16:19], v[36:39], v[112:119], v1
    s_waitcnt lgkmcnt(2)
    v_smfmac_f32_16x16x64_bf16 v[32:35], v[36:39], v[64:71], v1
    ds_read_b128 v[64:67], v8 offset:10240
    ds_read_b128 v[68:71], v8 offset:11264
    v_smfmac_f32_16x16x64_bf16 v[20:23], v[36:39], v[216:223], v1
    v_smfmac_f32_16x16x64_bf16 v[24:27], v[36:39], v[224:231], v1
    s_waitcnt vmcnt(1)
    v_max3_u32 v10, v40, v41, v42
    v_max_u32 v10, v10, v43
    v_cmp_eq_u32 vcc, -1, v10
    s_nop 0
    s_cbranch_vccnz Lr3f_pb_re
Lr3f_pb_ok:
    ds_write_b128 v0, v[40:43] offset:14080
    v_smfmac_f32_16x16x64_bf16 v[12:15], v[40:43], v[152:159], v1
    v_smfmac_f32_16x16x64_bf16 v[20:23], v[40:43], a[40:47], v1
    v_smfmac_f32_16x16x64_bf16 v[16:19], v[40:43], v[160:167], v1
    v_smfmac_f32_16x16x64_bf16 v[24:27], v[40:43], a[48:55], v1
    s_waitcnt lgkmcnt(0)
    s_barrier
    ds_read_b128 v[48:51], v0 offset:11008
    ds_read_b128 v[52:55], v0 offset:12032
    ds_read_b128 v[36:39], v0 offset:13056
    v_smfmac_f32_16x16x64_bf16 v[28:31], v[40:43], a[152:159], v1
    v_smfmac_f32_16x16x64_bf16 v[32:35], v[40:43], a[160:167], v1
    s_waitcnt lgkmcnt(2)
    v_smfmac_f32_16x16x64_bf16 v[12:15], v[48:51], v[56:63], v1
    ds_read_b128 v[56:59], v8 offset:12288
    ds_read_b128 v[60:63], v8 offset:13312
    v_smfmac_f32_16x16x64_bf16 v[16:19], v[48:51], v[64:71], v1
    ds_read_b128 v[64:67], v8 offset:14336
    ds_read_b128 v[68:71], v8 offset:15360
    s_waitcnt lgkmcnt(5)
    v_smfmac_f32_16x16x64_bf16 v[12:15], v[52:55], v[136:143], v1
    v_smfmac_f32_16x16x64_bf16 v[16:19], v[52:55], v[144:151], v1
    s_waitcnt vmcnt(0)
    v_max3_u32 v10, v44, v45, v46
    v_max_u32 v10, v10, v47
    v_cmp_eq_u32 vcc, -1, v10
    s_nop 0
    s_cbranch_vccnz Lr3f_pc_re
Lr3f_pc_ok:
    v_smfmac_f32_16x16x64_bf16 v[12:15], v[44:47], v[168:175], v1
    v_smfmac_f32_16x16x64_bf16 v[16:19], v[44:47], v[176:183], v1
    s_waitcnt lgkmcnt(2)
    v_smfmac_f32_16x16x64_bf16 v[12:15], v[36:39], v[56:63], v1
    s_waitcnt lgkmcnt(0)
    v_smfmac_f32_16x16x64_bf16 v[16:19], v[36:39], v[64:71], v1
    v_smfmac_f32_16x16x64_bf16 v[20:23], v[48:51], v[248:255], v1
    v_smfmac_f32_16x16x64_bf16 v[24:27], v[48:51], a[0:7], v1
    v_smfmac_f32_16x16x64_bf16 v[20:23], v[52:55], a[8:15], v1
    v_add_f32 v12, v12, v14
    v_smfmac_f32_16x16x64_bf16 v[24:27], v[52:55], a[16:23], v1
    v_add_f32 v16, v16, v18
    buffer_load_dwordx4 v[64:67], v0, s[8:11], s42 offen
    v_smfmac_f32_16x16x64_bf16 v[20:23], v[36:39], a[24:31], v1
    v_add_f32 v13, v13, v15
    v_smfmac_f32_16x16x64_bf16 v[24:27], v[36:39], a[32:39], v1
    v_add_f32 v17, v17, v19
    v_smfmac_f32_16x16x64_bf16 v[20:23], v[44:47], a[56:63], v1
    v_cvt_pk_bf16_f32 v14, v12, v16
    ds_read_b128 v[56:59], v0 offset:15104
    v_smfmac_f32_16x16x64_bf16 v[24:27], v[44:47], a[64:71], v1
    v_cvt_pk_bf16_f32 v15, v13, v17
    ds_read_b128 v[60:63], v0 offset:16128
    buffer_load_dwordx4 v[68:71], v0, s[8:11], s42 offen offset:1024
    ds_write_b32 v2, v14 offset:576
    ds_write_b32 v2, v15 offset:864
    v_smfmac_f32_16x16x64_bf16 v[28:31], v[48:51], a[104:111], v1
    v_smfmac_f32_16x16x64_bf16 v[32:35], v[48:51], a[112:119], v1
    v_add_f32 v20, v20, v22
    v_add_f32 v24, v24, v26
    v_add_f32 v21, v21, v23
    v_add_f32 v25, v25, v27
    v_cvt_pk_bf16_f32 v22, v20, v24
    v_cvt_pk_bf16_f32 v23, v21, v25
    ds_write_b32 v2, v22 offset:0
    ds_write_b32 v2, v23 offset:288
    v_smfmac_f32_16x16x64_bf16 v[28:31], v[52:55], a[120:127], v1
    v_smfmac_f32_16x16x64_bf16 v[32:35], v[52:55], a[128:135], v1
    s_waitcnt lgkmcnt(0)
    s_barrier
    ds_read_b128 v[40:43], v3 offset:0
    ds_read_b128 v[48:51], v3 offset:64
    ds_read_b128 v[20:23], v3 offset:128
    ds_read_b128 v[52:55], v3 offset:192
    v_smfmac_f32_16x16x64_bf16 v[28:31], v[36:39], a[136:143], v1
    v_smfmac_f32_16x16x64_bf16 v[32:35], v[36:39], a[144:151], v1
    ds_read_b128 v[36:39], v0 offset:17152
    v_lshlrev_b32 v9, 3, v0
    buffer_load_dword v11, v9, s[8:11], s68 offen
    v_smfmac_f32_16x16x64_bf16 v[28:31], v[44:47], a[168:175], v1
    v_smfmac_f32_16x16x64_bf16 v[32:35], v[44:47], a[176:183], v1
    ds_read_b128 v[44:47], v0 offset:18176
    s_waitcnt lgkmcnt(5)
    v_mfma_f32_16x16x32_bf16 v[12:15], v[56:59], v[40:43], 0
    v_mfma_f32_16x16x32_bf16 v[16:19], v[60:63], v[40:43], 0
    v_mfma_f32_16x16x32_bf16 v[24:27], v[40:43], v[40:43], 0
    ds_read_b128 v[56:59], v0 offset:19200
    ds_read_b128 v[60:63], v0 offset:20224
    s_waitcnt lgkmcnt(3)
    v_mfma_f32_16x16x32_bf16 v[12:15], v[36:39], v[48:51], v[12:15]
    v_lshrrev_b32 v10, 1, v0
    v_lshrrev_b32 v9, 9, v0
    s_waitcnt lgkmcnt(2)
    v_mfma_f32_16x16x32_bf16 v[16:19], v[44:47], v[48:51], v[16:19]
    v_lshl_add_u32 v9, v9, 5, v10
    v_add_f32 v28, v28, v30
    v_mfma_f32_16x16x32_bf16 v[24:27], v[48:51], v[48:51], v[24:27]
    v_add_f32 v32, v32, v34
    v_add_f32 v29, v29, v31
    ds_read_b128 v[36:39], v0 offset:21248
    ds_read_b128 v[44:47], v0 offset:22272
    s_waitcnt lgkmcnt(3)
    v_mfma_f32_16x16x32_bf16 v[12:15], v[56:59], v[20:23], v[12:15]
    v_add_f32 v33, v33, v35
    v_cvt_pk_bf16_f32 v30, v28, v29
    s_waitcnt lgkmcnt(2)
    v_mfma_f32_16x16x32_bf16 v[16:19], v[60:63], v[20:23], v[16:19]
    v_cvt_pk_bf16_f32 v31, v32, v33
    ds_read_b64 v[34:35], v9 offset:3456
    v_mfma_f32_16x16x32_bf16 v[24:27], v[20:23], v[20:23], v[24:27]
    s_add_u32 s17, s43, 3584
    buffer_store_dwordx2 v[30:31], v10, s[8:11], s17 offen sc1
    s_waitcnt lgkmcnt(2)
    v_mfma_f32_16x16x32_bf16 v[12:15], v[36:39], v[52:55], v[12:15]
    s_waitcnt lgkmcnt(1)
    v_mfma_f32_16x16x32_bf16 v[16:19], v[44:47], v[52:55], v[16:19]
    v_mfma_f32_16x16x32_bf16 v[24:27], v[52:55], v[52:55], v[24:27]
    s_add_u32 s17, s43, 1536
    s_waitcnt lgkmcnt(0)
    buffer_store_dwordx2 v[34:35], v10, s[8:11], s17 offen sc1
    s_cmp_eq_u32 s33, 63
    s_cbranch_scc1 Lr3f_last
    ds_read_b128 v[56:59], v8 offset:16384
    ds_read_b128 v[60:63], v8 offset:17408
    v_mov_b64 v[20:21], s[52:53]
    v_mov_b64 v[22:23], s[52:53]
    v_mov_b32 v41, 0
    v_mov_b32 v42, 0
    v_max3_f32 v9, v12, v13, v14
    v_max3_f32 v9, v9, v15, v16
    v_max3_f32 v9, v9, v17, v18
    v_max3_f32 v9, v9, v19, v24
    v_max_f32 v9, v9, v25
    v_mov_b32 v10, v9
    v_mov_b64 v[32:33], 0
    v_mov_b64 v[34:35], 0
    v_permlane32_swap_b32 v9, v10
    v_max_f32 v9, v9, v10
    v_mov_b32 v10, v9
    s_nop 1
    v_permlane16_swap_b32 v9, v10
    v_max_f32 v9, v9, v10
    v_mul_f32 v28, s44, v9
    v_fma_f32 v12, v12, s44, -v28
    v_fma_f32 v13, v13, s44, -v28
    v_fma_f32 v14, v14, s44, -v28
    v_fma_f32 v15, v15, s44, -v28
    v_exp_f32 v12, v12
    v_exp_f32 v13, v13
    v_fma_f32 v16, v16, s44, -v28
    v_fma_f32 v17, v17, s44, -v28
    v_exp_f32 v14, v14
    v_exp_f32 v15, v15
    v_cvt_pk_bf16_f32 v36, v12, v13
    v_fma_f32 v18, v18, s44, -v28
    v_fma_f32 v19, v19, s44, -v28
    v_exp_f32 v16, v16
    v_exp_f32 v17, v17
    v_cvt_pk_bf16_f32 v37, v14, v15
    v_fma_f32 v24, v24, s44, -v28
    v_fma_f32 v25, v25, s44, -v28
    v_exp_f32 v18, v18
    v_exp_f32 v19, v19
    v_cvt_pk_bf16_f32 v38, v16, v17
    v_exp_f32 v24, v24
    v_exp_f32 v25, v25
    v_cvt_pk_bf16_f32 v39, v18, v19
    v_cvt_pk_bf16_f32 v40, v24, v25
    v_cvt_pk_bf16_f32 v43, v24, v25
    v_mfma_f32_16x16x32_bf16 v[52:55], v[20:23], v[36:39], 0
    v_mov_b64 v[12:13], 0
    v_mov_b64 v[14:15], 0
    s_waitcnt vmcnt(4)
    v_mfma_f32_16x16x32_bf16 v[44:47], v[64:67], v[36:39], 0
    v_mov_b64 v[24:25], 0
    v_mov_b64 v[26:27], 0
    s_waitcnt vmcnt(3)
    v_mfma_f32_16x16x32_bf16 v[48:51], v[68:71], v[36:39], 0
    ds_read_b128 v[64:67], v8 offset:20480
    ds_read_b128 v[68:71], v8 offset:21504
    v_mfma_f32_16x16x16_bf16 v[52:55], v[20:21], v[40:41], v[52:55]
    v_mfma_f32_16x16x16_bf16 v[44:47], v[30:31], v[40:41], v[44:47]
    v_mov_b64 v[20:21], 0
    v_mov_b64 v[22:23], 0
    v_mfma_f32_16x16x16_bf16 v[48:51], v[30:31], v[42:43], v[48:51]
    v_mov_b64 v[36:37], 0
    v_mov_b64 v[38:39], 0
    v_mov_b64 v[40:41], 0
    v_mov_b64 v[42:43], 0
    v_rcp_f32 v9, v52
    v_mov_b64 v[52:53], 0
    v_mov_b64 v[54:55], 0
    v_mul_f32 v44, v9, v44
    v_mul_f32 v48, v9, v48
    v_cvt_pk_bf16_f32 v16, v44, v48
    v_mul_f32 v45, v9, v45
    v_mul_f32 v49, v9, v49
    v_cvt_pk_bf16_f32 v17, v45, v49
    v_mul_f32 v46, v9, v46
    v_mul_f32 v50, v9, v50
    v_cvt_pk_bf16_f32 v18, v46, v50
    v_mul_f32 v47, v9, v47
    v_mul_f32 v51, v9, v51
    v_cvt_pk_bf16_f32 v19, v47, v51
    ds_write_b128 v5, v[16:19]
    v_mov_b64 v[28:29], 0
    v_mov_b64 v[30:31], 0
    s_waitcnt lgkmcnt(0)
    s_barrier
    ds_read_b128 v[44:47], v4 offset:0
    ds_read_b128 v[48:51], v4 offset:128
    v_mov_b64 v[16:17], 0
    v_mov_b64 v[18:19], 0
    buffer_load_dwordx4 v0, s[8:11], s41 offen offset:0 lds
    buffer_load_dwordx4 v0, s[8:11], s41 offen offset:1024 lds
    s_waitcnt lgkmcnt(1)
    v_smfmac_f32_16x16x64_bf16 v[12:15], v[44:47], a[184:191], v1
    s_waitcnt lgkmcnt(0)
    v_smfmac_f32_16x16x64_bf16 v[12:15], v[48:51], a[192:199], v1
    v_smfmac_f32_16x16x64_bf16 v[24:27], v[44:47], a[200:207], v1
    v_smfmac_f32_16x16x64_bf16 v[24:27], v[48:51], a[208:215], v1
    v_add_f32 v12, v12, v14
    v_smfmac_f32_16x16x64_bf16 v[20:23], v[44:47], a[216:223], v1
    v_add_f32 v13, v13, v15
    v_smfmac_f32_16x16x64_bf16 v[20:23], v[48:51], a[224:231], v1
    v_cvt_pk_bf16_f32 v12, v12, v13
    v_smfmac_f32_16x16x64_bf16 v[16:19], v[44:47], a[232:239], v1
    v_add_f32 v24, v24, v26
    v_smfmac_f32_16x16x64_bf16 v[16:19], v[48:51], a[240:247], v1
    v_add_f32 v25, v25, v27
    v_smfmac_f32_16x16x64_bf16 v[36:39], v[44:47], v[56:63], v1
    v_cvt_pk_bf16_f32 v13, v24, v25
    v_smfmac_f32_16x16x64_bf16 v[36:39], v[48:51], v[64:71], v1
    v_add_f32 v20, v20, v22
    v_add_f32 v21, v21, v23
    v_cvt_pk_bf16_f32 v14, v20, v21
    v_add_f32 v16, v16, v18
    v_add_f32 v17, v17, v19
    v_cvt_pk_bf16_f32 v15, v16, v17
    v_and_or_b32 v15, v15, -2, s40
    buffer_store_dwordx4 v[12:15], v0, s[8:11], s38 offen
    s_nop 0
    ds_read_b128 v[12:15], v8 offset:18432
    ds_read_b128 v[16:19], v8 offset:19456
    ds_read_b128 v[20:23], v8 offset:22528
    ds_read_b128 v[24:27], v8 offset:23552
    ds_read_b128 v[56:59], v8 offset:24576
    ds_read_b128 v[60:63], v8 offset:25600
    ds_read_b128 v[64:67], v8 offset:28672
    ds_read_b128 v[68:71], v8 offset:29696
    s_waitcnt lgkmcnt(6)
    v_smfmac_f32_16x16x64_bf16 v[40:43], v[44:47], v[12:19], v1
    ds_read_b128 v[12:15], v8 offset:26624
    ds_read_b128 v[16:19], v8 offset:27648
    s_waitcnt lgkmcnt(6)
    v_smfmac_f32_16x16x64_bf16 v[40:43], v[48:51], v[20:27], v1
    ds_read_b128 v[20:23], v8 offset:30720
    ds_read_b128 v[24:27], v8 offset:31744
    s_waitcnt lgkmcnt(6)
    v_smfmac_f32_16x16x64_bf16 v[52:55], v[44:47], v[56:63], v1
    ds_read_b128 v[56:59], v8 offset:32768
    ds_read_b128 v[60:63], v8 offset:33792
    s_waitcnt lgkmcnt(6)
    v_smfmac_f32_16x16x64_bf16 v[52:55], v[48:51], v[64:71], v1
    s_waitcnt lgkmcnt(4)
    v_smfmac_f32_16x16x64_bf16 v[32:35], v[44:47], v[12:19], v1
    s_waitcnt lgkmcnt(2)
    v_smfmac_f32_16x16x64_bf16 v[32:35], v[48:51], v[20:27], v1
    v_smfmac_f32_16x16x64_bf16 v[28:31], v[44:47], a[248:255], v1
    s_waitcnt lgkmcnt(0)
    v_smfmac_f32_16x16x64_bf16 v[28:31], v[48:51], v[56:63], v1
    v_add_f32 v36, v36, v38
    v_add_f32 v37, v37, v39
    v_cvt_pk_bf16_f32 v36, v36, v37
    v_add_f32 v40, v40, v42
    v_add_f32 v41, v41, v43
    v_cvt_pk_bf16_f32 v37, v40, v41
    v_add_f32 v52, v52, v54
    v_add_f32 v53, v53, v55
    v_cvt_pk_bf16_f32 v38, v52, v53
    v_add_f32 v32, v32, v34
    v_add_f32 v33, v33, v35
    v_cvt_pk_bf16_f32 v39, v32, v33
    v_and_or_b32 v39, v39, -2, s40
    s_add_u32 s17, s38, 4096
    buffer_store_dwordx4 v[36:39], v0, s[8:11], s17 offen
    v_add_f32 v28, v28, v30
    v_add_f32 v29, v29, v31
    v_cvt_pk_bf16_f32 v28, v28, v29
    v_and_or_b32 v28, v28, -2, s40
    v_lshrrev_b32 v9, 2, v0
    buffer_store_dword v28, v9, s[8:11], s39 offen
    s_xor_b32 s34, s34, 16384
    s_xor_b32 s35, s35, 16384
    s_add_u32 s33, s33, 1
    s_add_u32 s42, s42, 262144
    s_add_u32 s41, s41, 262144
    s_add_u32 s43, s43, 131072
    s_add_u32 s68, s68, 262144
    s_add_u32 s66, s66, 22528
    s_xor_b32 s40, s40, 1
    ds_read_b128 v[56:59], v8 offset:0
    ds_read_b128 v[60:63], v8 offset:1024
    ds_read_b128 v[64:67], v8 offset:2048
    ds_read_b128 v[68:71], v8 offset:3072
    v_mov_b64 v[12:13], 0
    v_mov_b64 v[14:15], 0
    v_mov_b64 v[16:17], 0
    v_mov_b64 v[18:19], 0
    v_mov_b64 v[20:21], 0
    v_mov_b64 v[22:23], 0
    v_mov_b64 v[24:25], 0
    v_mov_b64 v[26:27], 0
    v_mov_b64 v[28:29], 0
    v_mov_b64 v[30:31], 0
    v_mov_b64 v[32:33], 0
    v_mov_b64 v[34:35], 0
    s_sleep 5
    s_nop 9
    buffer_load_dwordx4 v[36:39], v0, s[8:11], s34 offen sc1
    s_nop 15
    s_nop 8
    buffer_load_dwordx4 v[36:39], v0, s[8:11], s34 offen sc1
    s_nop 15
    s_nop 8
    buffer_load_dwordx4 v[36:39], v0, s[8:11], s34 offen sc1
    s_waitcnt lgkmcnt(0)
    s_branch Lr3f_step
Lr3f_pb_re:
    s_mov_b32 s16, 0
Lr3f_pb_lp:
    s_add_u32 s17, s34, 4096
    buffer_load_dwordx4 v[40:43], v0, s[8:11], s17 offen sc1
    s_add_u32 s16, s16, 1
    s_cmp_gt_u32 s16, 100000
    s_cbranch_scc1 Lr_abort
    s_waitcnt vmcnt(0)
    v_max3_u32 v10, v40, v41, v42
    v_max_u32 v10, v10, v43
    v_cmp_eq_u32 vcc, -1, v10
    s_nop 0
    s_cbranch_vccnz Lr3f_pb_lp
    s_branch Lr3f_pb_ok
Lr3f_pc_re:
    s_mov_b32 s16, 0
Lr3f_pc_lp:
    buffer_load_dwordx4 v[44:47], v0, s[8:11], s35 offen sc1
    s_add_u32 s16, s16, 1
    s_cmp_gt_u32 s16, 100000
    s_cbranch_scc1 Lr_abort
    s_waitcnt vmcnt(0)
    v_max3_u32 v10, v44, v45, v46
    v_max_u32 v10, v10, v47
    v_cmp_eq_u32 vcc, -1, v10
    s_nop 0
    s_cbranch_vccnz Lr3f_pc_lp
    s_branch Lr3f_pc_ok
Lr3f_last:
    s_waitcnt vmcnt(0) lgkmcnt(0)
    s_barrier
    s_branch Lr_exit
L_slow:
    s_cmp_lg_u32 s14, 0
    s_cbranch_scc1 L_w1_0
    buffer_load_dwordx4 v[36:39], v0, s[8:11], s34 offen sc1
    s_mov_b32 s16, 0
    s_add_u32 s17, s66, 128
    v_lshrrev_b32 v10, 2, v0
    v_and_b32 v9, 16, v10
    v_lshlrev_b32 v9, 3, v9
    v_and_or_b32 v10, v10, 12, v9
Lr0s_fw_15:
    buffer_load_dword v9, v10, s[8:11], s17 offen sc1
    s_add_u32 s16, s16, 1
    s_cmp_gt_u32 s16, 100000
    s_cbranch_scc1 Lr_abort
    s_waitcnt vmcnt(0)
    v_cmp_eq_u32 vcc, 0, v9
    s_nop 0
    s_cbranch_vccnz Lr0s_fw_15
    s_mov_b32 m0, 15104
    s_nop 0
    buffer_load_dwordx4 v0, s[8:11], s41 offen offset:0 lds
    buffer_load_dwordx4 v0, s[8:11], s41 offen offset:1024 lds
    s_add_u32 s41, s41, 262144
    s_add_u32 s68, s68, 4278452224
    ds_read_b128 v[56:59], v8 offset:0
    ds_read_b128 v[60:63], v8 offset:1024
    ds_read_b128 v[64:67], v8 offset:2048
    ds_read_b128 v[68:71], v8 offset:3072
    v_mov_b64 v[12:13], 0
    v_mov_b64 v[14:15], 0
    v_mov_b64 v[16:17], 0
    v_mov_b64 v[18:19], 0
    v_mov_b64 v[20:21], 0
    v_mov_b64 v[22:23], 0
    v_mov_b64 v[24:25], 0
    v_mov_b64 v[26:27], 0
    v_mov_b64 v[28:29], 0
    v_mov_b64 v[30:31], 0
    v_mov_b64 v[32:33], 0
    v_mov_b64 v[34:35], 0
    s_waitcnt vmcnt(0) lgkmcnt(0)
Lr0s_step:
    s_mov_b32 s16, 0
Lr0s_alp:
    s_waitcnt vmcnt(2)
    v_max3_u32 v10, v36, v37, v38
    v_max_u32 v10, v10, v39
    v_cmp_eq_u32 vcc, -1, v10
    s_nop 0
    s_cbranch_vccz Lr0s_aok
    buffer_load_dwordx4 v[36:39], v0, s[8:11], s34 offen sc1
    s_add_u32 s16, s16, 1
    s_cmp_gt_u32 s16, 100000
    s_cbranch_scc1 Lr_abort
    s_branch Lr0s_alp
Lr0s_aok:
    ds_write_b128 v0, v[36:39] offset:6912
    v_smfmac_f32_16x16x64_bf16 v[12:15], v[36:39], v[72:79], v1
    v_smfmac_f32_16x16x64_bf16 v[16:19], v[36:39], v[80:87], v1
    v_smfmac_f32_16x16x64_bf16 v[20:23], v[36:39], v[184:191], v1
    s_waitcnt lgkmcnt(0)
    s_barrier
    ds_read_b128 v[48:51], v0 offset:7936
    ds_read_b128 v[52:55], v0 offset:8960
    v_smfmac_f32_16x16x64_bf16 v[28:31], v[36:39], v[56:63], v1
    ds_read_b128 v[56:59], v8 offset:4096
    ds_read_b128 v[60:63], v8 offset:5120
    s_add_u32 s17, s34, 4096
    buffer_load_dwordx4 v[40:43], v0, s[8:11], s17 offen sc1
    v_smfmac_f32_16x16x64_bf16 v[24:27], v[36:39], v[192:199], v1
    v_smfmac_f32_16x16x64_bf16 v[32:35], v[36:39], v[64:71], v1
    ds_read_b128 v[64:67], v8 offset:6144
    ds_read_b128 v[68:71], v8 offset:7168
    s_waitcnt vmcnt(1)
    ds_read_b128 v[36:39], v0 offset:9984
    s_waitcnt lgkmcnt(6)
    v_smfmac_f32_16x16x64_bf16 v[28:31], v[48:51], a[72:79], v1
    v_smfmac_f32_16x16x64_bf16 v[12:15], v[48:51], v[88:95], v1
    buffer_load_dwordx4 v[44:47], v0, s[8:11], s35 offen sc1
    v_smfmac_f32_16x16x64_bf16 v[16:19], v[48:51], v[96:103], v1
    v_smfmac_f32_16x16x64_bf16 v[32:35], v[48:51], a[80:87], v1
    v_smfmac_f32_16x16x64_bf16 v[20:23], v[48:51], v[200:207], v1
    v_smfmac_f32_16x16x64_bf16 v[24:27], v[48:51], v[208:215], v1
    s_waitcnt lgkmcnt(3)
    v_smfmac_f32_16x16x64_bf16 v[28:31], v[52:55], v[56:63], v1
    ds_read_b128 v[56:59], v8 offset:8192
    ds_read_b128 v[60:63], v8 offset:9216
    v_smfmac_f32_16x16x64_bf16 v[12:15], v[52:55], v[104:111], v1
    v_smfmac_f32_16x16x64_bf16 v[16:19], v[52:55], v[112:119], v1
    s_waitcnt lgkmcnt(3)
    v_smfmac_f32_16x16x64_bf16 v[32:35], v[52:55], v[64:71], v1
    ds_read_b128 v[64:67], v8 offset:10240
    ds_read_b128 v[68:71], v8 offset:11264
    v_smfmac_f32_16x16x64_bf16 v[20:23], v[52:55], v[216:223], v1
    v_smfmac_f32_16x16x64_bf16 v[24:27], v[52:55], v[224:231], v1
    s_waitcnt lgkmcnt(4)
    v_smfmac_f32_16x16x64_bf16 v[28:31], v[36:39], a[88:95], v1
    v_smfmac_f32_16x16x64_bf16 v[12:15], v[36:39], v[120:127], v1
    v_smfmac_f32_16x16x64_bf16 v[16:19], v[36:39], v[128:135], v1
    v_smfmac_f32_16x16x64_bf16 v[32:35], v[36:39], a[96:103], v1
    v_smfmac_f32_16x16x64_bf16 v[20:23], v[36:39], v[232:239], v1
    v_smfmac_f32_16x16x64_bf16 v[24:27], v[36:39], v[240:247], v1
    s_waitcnt vmcnt(1)
    v_max3_u32 v10, v40, v41, v42
    v_max_u32 v10, v10, v43
    v_cmp_eq_u32 vcc, -1, v10
    s_nop 0
    s_cbranch_vccnz Lr0s_pb_re
Lr0s_pb_ok:
    ds_write_b128 v0, v[40:43] offset:11008
    s_waitcnt lgkmcnt(3)
    v_smfmac_f32_16x16x64_bf16 v[12:15], v[40:43], v[56:63], v1
    ds_read_b128 v[56:59], v8 offset:12288
    ds_read_b128 v[60:63], v8 offset:13312
    v_smfmac_f32_16x16x64_bf16 v[20:23], v[40:43], v[248:255], v1
    s_waitcnt lgkmcnt(3)
    v_smfmac_f32_16x16x64_bf16 v[16:19], v[40:43], v[64:71], v1
    ds_read_b128 v[64:67], v8 offset:14336
    ds_read_b128 v[68:71], v8 offset:15360
    v_smfmac_f32_16x16x64_bf16 v[24:27], v[40:43], a[0:7], v1
    s_waitcnt lgkmcnt(4)
    s_barrier
    ds_read_b128 v[48:51], v0 offset:13056
    ds_read_b128 v[52:55], v0 offset:12032
    ds_read_b128 v[36:39], v0 offset:14080
    v_smfmac_f32_16x16x64_bf16 v[28:31], v[40:43], a[104:111], v1
    v_smfmac_f32_16x16x64_bf16 v[32:35], v[40:43], a[112:119], v1
    s_waitcnt lgkmcnt(2)
    v_smfmac_f32_16x16x64_bf16 v[12:15], v[48:51], v[56:63], v1
    v_smfmac_f32_16x16x64_bf16 v[16:19], v[48:51], v[64:71], v1
    s_waitcnt lgkmcnt(1)
    v_smfmac_f32_16x16x64_bf16 v[12:15], v[52:55], v[136:143], v1
    v_smfmac_f32_16x16x64_bf16 v[16:19], v[52:55], v[144:151], v1
    s_waitcnt lgkmcnt(0)
    v_smfmac_f32_16x16x64_bf16 v[12:15], v[36:39], v[152:159], v1
    v_smfmac_f32_16x16x64_bf16 v[16:19], v[36:39], v[160:167], v1
    s_waitcnt vmcnt(0)
    v_max3_u32 v10, v44, v45, v46
    v_max_u32 v10, v10, v47
    v_cmp_eq_u32 vcc, -1, v10
    s_nop 0
    s_cbranch_vccnz Lr0s_pc_re
Lr0s_pc_ok:
    v_smfmac_f32_16x16x64_bf16 v[12:15], v[44:47], v[168:175], v1
    v_smfmac_f32_16x16x64_bf16 v[16:19], v[44:47], v[176:183], v1
    v_smfmac_f32_16x16x64_bf16 v[20:23], v[48:51], a[24:31], v1
    buffer_load_dwordx4 v[64:67], v0, s[8:11], s42 offen
    v_smfmac_f32_16x16x64_bf16 v[24:27], v[48:51], a[32:39], v1
    v_smfmac_f32_16x16x64_bf16 v[20:23], v[52:55], a[8:15], v1
    v_add_f32 v12, v12, v14
    v_smfmac_f32_16x16x64_bf16 v[24:27], v[52:55], a[16:23], v1
    v_add_f32 v16, v16, v18
    v_smfmac_f32_16x16x64_bf16 v[20:23], v[36:39], a[40:47], v1
    v_add_f32 v13, v13, v15
    buffer_load_dwordx4 v[68:71], v0, s[8:11], s42 offen offset:1024
    v_smfmac_f32_16x16x64_bf16 v[24:27], v[36:39], a[48:55], v1
    v_add_f32 v17, v17, v19
    v_smfmac_f32_16x16x64_bf16 v[20:23], v[44:47], a[56:63], v1
    v_cvt_pk_bf16_f32 v14, v12, v16
    ds_read_b128 v[56:59], v0 offset:15104
    v_smfmac_f32_16x16x64_bf16 v[24:27], v[44:47], a[64:71], v1
    v_cvt_pk_bf16_f32 v15, v13, v17
    ds_read_b128 v[60:63], v0 offset:16128
    ds_write_b32 v2, v14 offset:576
    ds_write_b32 v2, v15 offset:864
    v_smfmac_f32_16x16x64_bf16 v[28:31], v[48:51], a[136:143], v1
    v_smfmac_f32_16x16x64_bf16 v[32:35], v[48:51], a[144:151], v1
    v_add_f32 v20, v20, v22
    v_add_f32 v24, v24, v26
    v_add_f32 v21, v21, v23
    v_add_f32 v25, v25, v27
    v_cvt_pk_bf16_f32 v22, v20, v24
    v_cvt_pk_bf16_f32 v23, v21, v25
    ds_write_b32 v2, v22 offset:0
    ds_write_b32 v2, v23 offset:288
    v_smfmac_f32_16x16x64_bf16 v[28:31], v[52:55], a[120:127], v1
    v_smfmac_f32_16x16x64_bf16 v[32:35], v[52:55], a[128:135], v1
    s_waitcnt lgkmcnt(0)
    s_barrier
    ds_read_b128 v[40:43], v3 offset:0
    ds_read_b128 v[48:51], v3 offset:64
    ds_read_b128 v[20:23], v3 offset:128
    ds_read_b128 v[52:55], v3 offset:192
    v_smfmac_f32_16x16x64_bf16 v[28:31], v[36:39], a[152:159], v1
    v_smfmac_f32_16x16x64_bf16 v[32:35], v[36:39], a[160:167], v1
    ds_read_b128 v[36:39], v0 offset:17152
    v_lshlrev_b32 v9, 3, v0
    buffer_load_dword v11, v9, s[8:11], s68 offen
    v_smfmac_f32_16x16x64_bf16 v[28:31], v[44:47], a[168:175], v1
    v_smfmac_f32_16x16x64_bf16 v[32:35], v[44:47], a[176:183], v1
    ds_read_b128 v[44:47], v0 offset:18176
    s_waitcnt lgkmcnt(5)
    v_mfma_f32_16x16x32_bf16 v[12:15], v[56:59], v[40:43], 0
    v_mfma_f32_16x16x32_bf16 v[16:19], v[60:63], v[40:43], 0
    v_mfma_f32_16x16x32_bf16 v[24:27], v[40:43], v[40:43], 0
    ds_read_b128 v[56:59], v0 offset:19200
    ds_read_b128 v[60:63], v0 offset:20224
    s_waitcnt lgkmcnt(3)
    v_mfma_f32_16x16x32_bf16 v[12:15], v[36:39], v[48:51], v[12:15]
    v_lshrrev_b32 v10, 1, v0
    v_lshrrev_b32 v9, 9, v0
    s_waitcnt lgkmcnt(2)
    v_mfma_f32_16x16x32_bf16 v[16:19], v[44:47], v[48:51], v[16:19]
    v_lshl_add_u32 v9, v9, 5, v10
    v_add_f32 v28, v28, v30
    v_mfma_f32_16x16x32_bf16 v[24:27], v[48:51], v[48:51], v[24:27]
    v_add_f32 v32, v32, v34
    v_add_f32 v29, v29, v31
    ds_read_b128 v[36:39], v0 offset:21248
    ds_read_b128 v[44:47], v0 offset:22272
    s_waitcnt lgkmcnt(3)
    v_mfma_f32_16x16x32_bf16 v[12:15], v[56:59], v[20:23], v[12:15]
    v_add_f32 v33, v33, v35
    v_cvt_pk_bf16_f32 v30, v28, v29
    s_waitcnt lgkmcnt(2)
    v_mfma_f32_16x16x32_bf16 v[16:19], v[60:63], v[20:23], v[16:19]
    v_cvt_pk_bf16_f32 v31, v32, v33
    ds_read_b64 v[34:35], v9 offset:0
    v_mfma_f32_16x16x32_bf16 v[24:27], v[20:23], v[20:23], v[24:27]
    s_add_u32 s17, s43, 2048
    buffer_store_dwordx2 v[30:31], v10, s[8:11], s17 offen sc1
    s_waitcnt lgkmcnt(2)
    v_mfma_f32_16x16x32_bf16 v[12:15], v[36:39], v[52:55], v[12:15]
    s_waitcnt lgkmcnt(1)
    v_mfma_f32_16x16x32_bf16 v[16:19], v[44:47], v[52:55], v[16:19]
    v_mfma_f32_16x16x32_bf16 v[24:27], v[52:55], v[52:55], v[24:27]
    s_add_u32 s17, s43, 0
    s_waitcnt lgkmcnt(0)
    buffer_store_dwordx2 v[34:35], v10, s[8:11], s17 offen sc1
    s_cmp_eq_u32 s33, 63
    s_cbranch_scc1 Lr0s_last
    ds_read_b128 v[56:59], v8 offset:16384
    ds_read_b128 v[60:63], v8 offset:17408
    v_mov_b64 v[20:21], s[52:53]
    v_mov_b64 v[22:23], s[52:53]
    v_mov_b32 v41, 0
    v_mov_b32 v42, 0
    v_max3_f32 v9, v12, v13, v14
    v_max3_f32 v9, v9, v15, v16
    v_max3_f32 v9, v9, v17, v18
    v_max3_f32 v9, v9, v19, v24
    v_max_f32 v9, v9, v25
    v_mov_b32 v10, v9
    v_mov_b64 v[32:33], 0
    v_mov_b64 v[34:35], 0
    v_permlane32_swap_b32 v9, v10
    v_max_f32 v9, v9, v10
    v_mov_b32 v10, v9
    s_nop 1
    v_permlane16_swap_b32 v9, v10
    v_max_f32 v9, v9, v10
    v_mul_f32 v28, s44, v9
    v_fma_f32 v12, v12, s44, -v28
    v_fma_f32 v13, v13, s44, -v28
    v_fma_f32 v14, v14, s44, -v28
    v_fma_f32 v15, v15, s44, -v28
    v_exp_f32 v12, v12
    v_exp_f32 v13, v13
    v_fma_f32 v16, v16, s44, -v28
    v_fma_f32 v17, v17, s44, -v28
    v_exp_f32 v14, v14
    v_exp_f32 v15, v15
    v_cvt_pk_bf16_f32 v36, v12, v13
    v_fma_f32 v18, v18, s44, -v28
    v_fma_f32 v19, v19, s44, -v28
    v_exp_f32 v16, v16
    v_exp_f32 v17, v17
    v_cvt_pk_bf16_f32 v37, v14, v15
    v_fma_f32 v24, v24, s44, -v28
    v_fma_f32 v25, v25, s44, -v28
    v_exp_f32 v18, v18
    v_exp_f32 v19, v19
    v_cvt_pk_bf16_f32 v38, v16, v17
    v_exp_f32 v24, v24
    v_exp_f32 v25, v25
    v_cvt_pk_bf16_f32 v39, v18, v19
    v_cvt_pk_bf16_f32 v40, v24, v25
    v_cvt_pk_bf16_f32 v43, v24, v25
    v_mfma_f32_16x16x32_bf16 v[52:55], v[20:23], v[36:39], 0
    v_mov_b64 v[12:13], 0
    v_mov_b64 v[14:15], 0
    s_waitcnt vmcnt(4)
    v_mfma_f32_16x16x32_bf16 v[44:47], v[64:67], v[36:39], 0
    v_mov_b64 v[24:25], 0
    v_mov_b64 v[26:27], 0
    s_waitcnt vmcnt(3)
    v_mfma_f32_16x16x32_bf16 v[48:51], v[68:71], v[36:39], 0
    ds_read_b128 v[64:67], v8 offset:20480
    ds_read_b128 v[68:71], v8 offset:21504
    v_mfma_f32_16x16x16_bf16 v[52:55], v[20:21], v[40:41], v[52:55]
    v_mfma_f32_16x16x16_bf16 v[44:47], v[30:31], v[40:41], v[44:47]
    v_mov_b64 v[20:21], 0
    v_mov_b64 v[22:23], 0
    v_mfma_f32_16x16x16_bf16 v[48:51], v[30:31], v[42:43], v[48:51]
    v_mov_b64 v[36:37], 0
    v_mov_b64 v[38:39], 0
    v_mov_b64 v[40:41], 0
    v_mov_b64 v[42:43], 0
    v_rcp_f32 v9, v52
    v_mov_b64 v[52:53], 0
    v_mov_b64 v[54:55], 0
    v_mul_f32 v44, v9, v44
    v_mul_f32 v48, v9, v48
    v_cvt_pk_bf16_f32 v16, v44, v48
    v_mul_f32 v45, v9, v45
    v_mul_f32 v49, v9, v49
    v_cvt_pk_bf16_f32 v17, v45, v49
    v_mul_f32 v46, v9, v46
    v_mul_f32 v50, v9, v50
    v_cvt_pk_bf16_f32 v18, v46, v50
    v_mul_f32 v47, v9, v47
    v_mul_f32 v51, v9, v51
    v_cvt_pk_bf16_f32 v19, v47, v51
    ds_write_b128 v5, v[16:19]
    v_mov_b64 v[28:29], 0
    v_mov_b64 v[30:31], 0
    s_waitcnt lgkmcnt(0)
    s_barrier
    ds_read_b128 v[44:47], v4 offset:0
    ds_read_b128 v[48:51], v4 offset:128
    v_mov_b64 v[16:17], 0
    v_mov_b64 v[18:19], 0
    buffer_load_dwordx4 v0, s[8:11], s41 offen offset:0 lds
    buffer_load_dwordx4 v0, s[8:11], s41 offen offset:1024 lds
    s_waitcnt lgkmcnt(1)
    v_smfmac_f32_16x16x64_bf16 v[12:15], v[44:47], a[184:191], v1
    s_waitcnt lgkmcnt(0)
    v_smfmac_f32_16x16x64_bf16 v[12:15], v[48:51], a[192:199], v1
    v_smfmac_f32_16x16x64_bf16 v[24:27], v[44:47], a[200:207], v1
    v_smfmac_f32_16x16x64_bf16 v[24:27], v[48:51], a[208:215], v1
    v_add_f32 v12, v12, v14
    v_smfmac_f32_16x16x64_bf16 v[20:23], v[44:47], a[216:223], v1
    v_add_f32 v13, v13, v15
    v_smfmac_f32_16x16x64_bf16 v[20:23], v[48:51], a[224:231], v1
    v_cvt_pk_bf16_f32 v12, v12, v13
    v_smfmac_f32_16x16x64_bf16 v[16:19], v[44:47], a[232:239], v1
    v_add_f32 v24, v24, v26
    v_smfmac_f32_16x16x64_bf16 v[16:19], v[48:51], a[240:247], v1
    v_add_f32 v25, v25, v27
    v_smfmac_f32_16x16x64_bf16 v[36:39], v[44:47], v[56:63], v1
    v_cvt_pk_bf16_f32 v13, v24, v25
    v_smfmac_f32_16x16x64_bf16 v[36:39], v[48:51], v[64:71], v1
    v_add_f32 v20, v20, v22
    v_add_f32 v21, v21, v23
    v_cvt_pk_bf16_f32 v14, v20, v21
    v_add_f32 v16, v16, v18
    v_add_f32 v17, v17, v19
    v_cvt_pk_bf16_f32 v15, v16, v17
    v_and_or_b32 v15, v15, -2, s40
    buffer_store_dwordx4 v[12:15], v0, s[8:11], s38 offen sc1
    s_nop 0
    ds_read_b128 v[12:15], v8 offset:18432
    ds_read_b128 v[16:19], v8 offset:19456
    ds_read_b128 v[20:23], v8 offset:22528
    ds_read_b128 v[24:27], v8 offset:23552
    ds_read_b128 v[56:59], v8 offset:24576
    ds_read_b128 v[60:63], v8 offset:25600
    ds_read_b128 v[64:67], v8 offset:28672
    ds_read_b128 v[68:71], v8 offset:29696
    s_waitcnt lgkmcnt(6)
    v_smfmac_f32_16x16x64_bf16 v[40:43], v[44:47], v[12:19], v1
    ds_read_b128 v[12:15], v8 offset:26624
    ds_read_b128 v[16:19], v8 offset:27648
    s_waitcnt lgkmcnt(6)
    v_smfmac_f32_16x16x64_bf16 v[40:43], v[48:51], v[20:27], v1
    ds_read_b128 v[20:23], v8 offset:30720
    ds_read_b128 v[24:27], v8 offset:31744
    s_waitcnt lgkmcnt(6)
    v_smfmac_f32_16x16x64_bf16 v[52:55], v[44:47], v[56:63], v1
    ds_read_b128 v[56:59], v8 offset:32768
    ds_read_b128 v[60:63], v8 offset:33792
    s_waitcnt lgkmcnt(6)
    v_smfmac_f32_16x16x64_bf16 v[52:55], v[48:51], v[64:71], v1
    s_waitcnt lgkmcnt(4)
    v_smfmac_f32_16x16x64_bf16 v[32:35], v[44:47], v[12:19], v1
    s_waitcnt lgkmcnt(2)
    v_smfmac_f32_16x16x64_bf16 v[32:35], v[48:51], v[20:27], v1
    v_smfmac_f32_16x16x64_bf16 v[28:31], v[44:47], a[248:255], v1
    s_waitcnt lgkmcnt(0)
    v_smfmac_f32_16x16x64_bf16 v[28:31], v[48:51], v[56:63], v1
    buffer_load_dwordx4 v[12:15], v6, s[8:11], s62 offen sc1
    buffer_load_dwordx4 v[16:19], v6, s[8:11], s63 offen sc1
    buffer_load_dwordx4 v[20:23], v6, s[8:11], s64 offen sc1
    buffer_load_dwordx4 v[24:27], v6, s[8:11], s65 offen sc1
    v_add_f32 v36, v36, v38
    v_add_f32 v37, v37, v39
    v_cvt_pk_bf16_f32 v36, v36, v37
    v_add_f32 v40, v40, v42
    v_add_f32 v41, v41, v43
    v_cvt_pk_bf16_f32 v37, v40, v41
    v_add_f32 v52, v52, v54
    v_add_f32 v53, v53, v55
    v_cvt_pk_bf16_f32 v38, v52, v53
    v_add_f32 v32, v32, v34
    v_add_f32 v33, v33, v35
    v_cvt_pk_bf16_f32 v39, v32, v33
    v_and_or_b32 v39, v39, -2, s40
    s_add_u32 s17, s38, 4096
    buffer_store_dwordx4 v[36:39], v0, s[8:11], s17 offen sc1
    v_add_f32 v28, v28, v30
    v_add_f32 v29, v29, v31
    v_cvt_pk_bf16_f32 v28, v28, v29
    v_and_or_b32 v28, v28, -2, s40
    v_lshrrev_b32 v9, 2, v0
    buffer_store_dword v28, v9, s[8:11], s39 offen sc1
    v_add_u32 v10, 162560, v0
    ds_read_b128 v[64:67], v10
    s_nop 9
    buffer_load_dwordx4 v[40:43], v6, s[8:11], s62 offen sc1
    buffer_load_dwordx4 v[44:47], v6, s[8:11], s63 offen sc1
    buffer_load_dwordx4 v[48:51], v6, s[8:11], s64 offen sc1
    buffer_load_dwordx4 v[52:55], v6, s[8:11], s65 offen sc1
    s_add_u32 s33, s33, 1
    s_add_u32 s42, s42, 262144
    s_add_u32 s41, s41, 262144
    s_add_u32 s43, s43, 131072
    s_add_u32 s68, s68, 262144
    s_add_u32 s66, s66, 22528
    ds_read_b128 v[56:59], v8 offset:0
    ds_read_b128 v[60:63], v8 offset:1024
    s_waitcnt lgkmcnt(2)
    s_waitcnt vmcnt(9)
    v_mfma_f32_16x16x32_bf16 v[68:71], v[12:15], v[64:67], 0
    v_and_b32 v10, 1, v15
    v_cmp_ne_u32 s[54:55], s40, v10
    s_waitcnt vmcnt(8)
    v_mfma_f32_16x16x32_bf16 v[68:71], v[16:19], v[64:67], v[68:71]
    v_and_b32 v10, 1, v19
    v_cmp_ne_u32 s[56:57], s40, v10
    s_waitcnt vmcnt(7)
    v_mfma_f32_16x16x32_bf16 v[68:71], v[20:23], v[64:67], v[68:71]
    v_and_b32 v10, 1, v23
    v_cmp_ne_u32 s[58:59], s40, v10
    s_waitcnt vmcnt(6)
    v_mfma_f32_16x16x32_bf16 v[68:71], v[24:27], v[64:67], v[68:71]
    v_and_b32 v10, 1, v27
    v_cmp_ne_u32 s[60:61], s40, v10
    s_or_b64 vcc, s[54:55], s[56:57]
    s_or_b64 vcc, vcc, s[58:59]
    s_or_b64 vcc, vcc, s[60:61]
    s_cbranch_scc0 Lr0s_red
    s_mov_b32 s16, 0
Lr0s_p1:
    buffer_load_dwordx4 v[12:15], v6, s[8:11], s62 offen sc1
    buffer_load_dwordx4 v[16:19], v6, s[8:11], s63 offen sc1
    buffer_load_dwordx4 v[20:23], v6, s[8:11], s64 offen sc1
    buffer_load_dwordx4 v[24:27], v6, s[8:11], s65 offen sc1
    s_waitcnt vmcnt(7)
    v_mfma_f32_16x16x32_bf16 v[68:71], v[40:43], v[64:67], 0
    v_and_b32 v10, 1, v43
    v_cmp_ne_u32 s[54:55], s40, v10
    s_waitcnt vmcnt(6)
    v_mfma_f32_16x16x32_bf16 v[68:71], v[44:47], v[64:67], v[68:71]
    v_and_b32 v10, 1, v47
    v_cmp_ne_u32 s[56:57], s40, v10
    s_waitcnt vmcnt(5)
    v_mfma_f32_16x16x32_bf16 v[68:71], v[48:51], v[64:67], v[68:71]
    v_and_b32 v10, 1, v51
    v_cmp_ne_u32 s[58:59], s40, v10
    s_waitcnt vmcnt(4)
    v_mfma_f32_16x16x32_bf16 v[68:71], v[52:55], v[64:67], v[68:71]
    v_and_b32 v10, 1, v55
    v_cmp_ne_u32 s[60:61], s40, v10
    s_or_b64 vcc, s[54:55], s[56:57]
    s_or_b64 vcc, vcc, s[58:59]
    s_or_b64 vcc, vcc, s[60:61]
    s_cbranch_scc0 Lr0s_red
    buffer_load_dwordx4 v[40:43], v6, s[8:11], s62 offen sc1
    buffer_load_dwordx4 v[44:47], v6, s[8:11], s63 offen sc1
    buffer_load_dwordx4 v[48:51], v6, s[8:11], s64 offen sc1
    buffer_load_dwordx4 v[52:55], v6, s[8:11], s65 offen sc1
    s_add_u32 s16, s16, 1
    s_cmp_gt_u32 s16, 100000
    s_cbranch_scc1 Lr_abort
    s_waitcnt vmcnt(7)
    v_mfma_f32_16x16x32_bf16 v[68:71], v[12:15], v[64:67], 0
    v_and_b32 v10, 1, v15
    v_cmp_ne_u32 s[54:55], s40, v10
    s_waitcnt vmcnt(6)
    v_mfma_f32_16x16x32_bf16 v[68:71], v[16:19], v[64:67], v[68:71]
    v_and_b32 v10, 1, v19
    v_cmp_ne_u32 s[56:57], s40, v10
    s_waitcnt vmcnt(5)
    v_mfma_f32_16x16x32_bf16 v[68:71], v[20:23], v[64:67], v[68:71]
    v_and_b32 v10, 1, v23
    v_cmp_ne_u32 s[58:59], s40, v10
    s_waitcnt vmcnt(4)
    v_mfma_f32_16x16x32_bf16 v[68:71], v[24:27], v[64:67], v[68:71]
    v_and_b32 v10, 1, v27
    v_cmp_ne_u32 s[60:61], s40, v10
    s_or_b64 vcc, s[54:55], s[56:57]
    s_or_b64 vcc, vcc, s[58:59]
    s_or_b64 vcc, vcc, s[60:61]
    s_cbranch_scc1 Lr0s_p1
Lr0s_red:
    s_nop 1
    v_permlane16_swap_b32 v68, v70
    v_permlane16_swap_b32 v69, v71
    s_mov_b64 exec, s[46:47]
    v_add_f32 v68, v68, v70
    v_add_f32 v69, v69, v71
    v_cvt_pk_bf16_f32 v68, v68, v69
    v_min_u32 v68, s50, v68
    buffer_store_dword v68, v7, s[8:11], s36 offen sc1
    v_mov_b32 v69, -1
    buffer_store_dword v69, v7, s[8:11], s37 offen sc1
    s_mov_b64 exec, -1
    s_xor_b32 s34, s34, 16384
    s_xor_b32 s35, s35, 16384
    s_xor_b32 s40, s40, 1
    s_xor_b32 s36, s36, 16384
    s_xor_b32 s37, s37, 16384
    s_nop 15
    s_nop 3
    buffer_load_dwordx4 v[36:39], v0, s[8:11], s34 offen sc1
    s_waitcnt vmcnt(3)
    ds_read_b128 v[64:67], v8 offset:2048
    ds_read_b128 v[68:71], v8 offset:3072
    v_mov_b64 v[12:13], 0
    v_mov_b64 v[14:15], 0
    v_mov_b64 v[16:17], 0
    v_mov_b64 v[18:19], 0
    v_mov_b64 v[20:21], 0
    v_mov_b64 v[22:23], 0
    v_mov_b64 v[24:25], 0
    v_mov_b64 v[26:27], 0
    v_mov_b64 v[28:29], 0
    v_mov_b64 v[30:31], 0
    v_mov_b64 v[32:33], 0
    v_mov_b64 v[34:35], 0
    s_nop 9
    buffer_load_dwordx4 v[36:39], v0, s[8:11], s34 offen sc1
    s_nop 15
    s_nop 8
    buffer_load_dwordx4 v[36:39], v0, s[8:11], s34 offen sc1
    s_waitcnt lgkmcnt(0)
    s_branch Lr0s_step
Lr0s_pb_re:
    s_mov_b32 s16, 0
Lr0s_pb_lp:
    s_add_u32 s17, s34, 4096
    buffer_load_dwordx4 v[40:43], v0, s[8:11], s17 offen sc1
    s_add_u32 s16, s16, 1
    s_cmp_gt_u32 s16, 100000
    s_cbranch_scc1 Lr_abort
    s_waitcnt vmcnt(0)
    v_max3_u32 v10, v40, v41, v42
    v_max_u32 v10, v10, v43
    v_cmp_eq_u32 vcc, -1, v10
    s_nop 0
    s_cbranch_vccnz Lr0s_pb_lp
    s_branch Lr0s_pb_ok
Lr0s_pc_re:
    s_mov_b32 s16, 0
Lr0s_pc_lp:
    buffer_load_dwordx4 v[44:47], v0, s[8:11], s35 offen sc1
    s_add_u32 s16, s16, 1
    s_cmp_gt_u32 s16, 100000
    s_cbranch_scc1 Lr_abort
    s_waitcnt vmcnt(0)
    v_max3_u32 v10, v44, v45, v46
    v_max_u32 v10, v10, v47
    v_cmp_eq_u32 vcc, -1, v10
    s_nop 0
    s_cbranch_vccnz Lr0s_pc_lp
    s_branch Lr0s_pc_ok
Lr0s_last:
    s_waitcnt vmcnt(0) lgkmcnt(0)
    s_barrier
    s_branch Lr_exit
L_w1_0:
    s_cmp_lg_u32 s14, 1
    s_cbranch_scc1 L_w2_0
    buffer_load_dwordx4 v[36:39], v0, s[8:11], s34 offen sc1
    s_mov_b32 s16, 0
    s_add_u32 s17, s66, 128
    v_lshrrev_b32 v10, 2, v0
    v_and_b32 v9, 16, v10
    v_lshlrev_b32 v9, 3, v9
    v_and_or_b32 v10, v10, 12, v9
Lr1s_fw_16:
    buffer_load_dword v9, v10, s[8:11], s17 offen sc1
    s_add_u32 s16, s16, 1
    s_cmp_gt_u32 s16, 100000
    s_cbranch_scc1 Lr_abort
    s_waitcnt vmcnt(0)
    v_cmp_eq_u32 vcc, 0, v9
    s_nop 0
    s_cbranch_vccnz Lr1s_fw_16
    s_lshl_b32 s67, s32, 5
    s_add_u32 s67, s67, s15
    s_lshl_b32 s67, s67, 12
    s_add_u32 s67, s67, 3145728
    s_mov_b32 m0, 17152
    s_nop 0
    buffer_load_dwordx4 v0, s[8:11], s41 offen offset:0 lds
    buffer_load_dwordx4 v0, s[8:11], s41 offen offset:1024 lds
    s_add_u32 s41, s41, 262144
    s_add_u32 s68, s68, 262144
    ds_read_b128 v[56:59], v8 offset:4096
    ds_read_b128 v[60:63], v8 offset:5120
    ds_read_b128 v[64:67], v8 offset:6144
    ds_read_b128 v[68:71], v8 offset:7168
    v_mov_b64 v[12:13], 0
    v_mov_b64 v[14:15], 0
    v_mov_b64 v[16:17], 0
    v_mov_b64 v[18:19], 0
    v_mov_b64 v[20:21], 0
    v_mov_b64 v[22:23], 0
    v_mov_b64 v[24:25], 0
    v_mov_b64 v[26:27], 0
    v_mov_b64 v[28:29], 0
    v_mov_b64 v[30:31], 0
    v_mov_b64 v[32:33], 0
    v_mov_b64 v[34:35], 0
    s_waitcnt vmcnt(0) lgkmcnt(0)
Lr1s_step:
    s_waitcnt vmcnt(3)
    v_max3_u32 v10, v36, v37, v38
    v_max_u32 v10, v10, v39
    v_cmp_eq_u32 vcc, -1, v10
    s_nop 0
    s_cbranch_vccz Lr1s_aok
    buffer_load_dwordx4 v[36:39], v0, s[8:11], s34 offen sc1
    s_nop 15
    s_nop 8
    buffer_load_dwordx4 v[36:39], v0, s[8:11], s34 offen sc1
    s_mov_b32 s16, 0
Lr1s_alp:
    s_waitcnt vmcnt(2)
    v_max3_u32 v10, v36, v37, v38
    v_max_u32 v10, v10, v39
    v_cmp_eq_u32 vcc, -1, v10
    s_nop 0
    s_cbranch_vccz Lr1s_aok
    buffer_load_dwordx4 v[36:39], v0, s[8:11], s34 offen sc1
    s_add_u32 s16, s16, 1
    s_cmp_gt_u32 s16, 100000
    s_cbranch_scc1 Lr_abort
    s_branch Lr1s_alp
Lr1s_aok:
    ds_write_b128 v0, v[36:39] offset:7936
    v_smfmac_f32_16x16x64_bf16 v[12:15], v[36:39], v[88:95], v1
    v_smfmac_f32_16x16x64_bf16 v[16:19], v[36:39], v[96:103], v1
    v_smfmac_f32_16x16x64_bf16 v[20:23], v[36:39], v[200:207], v1
    s_waitcnt lgkmcnt(0)
    s_barrier
    ds_read_b128 v[48:51], v0 offset:8960
    ds_read_b128 v[52:55], v0 offset:9984
    v_smfmac_f32_16x16x64_bf16 v[28:31], v[36:39], a[72:79], v1
    v_smfmac_f32_16x16x64_bf16 v[24:27], v[36:39], v[208:215], v1
    s_add_u32 s17, s34, 4096
    buffer_load_dwordx4 v[40:43], v0, s[8:11], s17 offen sc1
    v_smfmac_f32_16x16x64_bf16 v[32:35], v[36:39], a[80:87], v1
    s_waitcnt vmcnt(1)
    ds_read_b128 v[36:39], v0 offset:6912
    s_waitcnt lgkmcnt(2)
    v_smfmac_f32_16x16x64_bf16 v[28:31], v[48:51], v[56:63], v1
    ds_read_b128 v[56:59], v8 offset:0
    ds_read_b128 v[60:63], v8 offset:1024
    v_smfmac_f32_16x16x64_bf16 v[12:15], v[48:51], v[104:111], v1
    v_smfmac_f32_16x16x64_bf16 v[16:19], v[48:51], v[112:119], v1
    buffer_load_dwordx4 v[44:47], v0, s[8:11], s35 offen sc1
    v_smfmac_f32_16x16x64_bf16 v[32:35], v[48:51], v[64:71], v1
    ds_read_b128 v[64:67], v8 offset:2048
    ds_read_b128 v[68:71], v8 offset:3072
    v_smfmac_f32_16x16x64_bf16 v[20:23], v[48:51], v[216:223], v1
    v_smfmac_f32_16x16x64_bf16 v[24:27], v[48:51], v[224:231], v1
    s_waitcnt lgkmcnt(5)
    v_smfmac_f32_16x16x64_bf16 v[28:31], v[52:55], a[88:95], v1
    v_smfmac_f32_16x16x64_bf16 v[12:15], v[52:55], v[120:127], v1
    v_smfmac_f32_16x16x64_bf16 v[16:19], v[52:55], v[128:135], v1
    v_smfmac_f32_16x16x64_bf16 v[32:35], v[52:55], a[96:103], v1
    v_smfmac_f32_16x16x64_bf16 v[20:23], v[52:55], v[232:239], v1
    v_smfmac_f32_16x16x64_bf16 v[24:27], v[52:55], v[240:247], v1
    s_waitcnt lgkmcnt(2)
    v_smfmac_f32_16x16x64_bf16 v[28:31], v[36:39], v[56:63], v1
    ds_read_b128 v[56:59], v8 offset:12288
    ds_read_b128 v[60:63], v8 offset:13312
    v_smfmac_f32_16x16x64_bf16 v[12:15], v[36:39], v[72:79], v1
    v_smfmac_f32_16x16x64_bf16 v[16:19], v[36:39], v[80:87], v1
    s_waitcnt lgkmcnt(2)
    v_smfmac_f32_16x16x64_bf16 v[32:35], v[36:39], v[64:71], v1
    ds_read_b128 v[64:67], v8 offset:14336
    ds_read_b128 v[68:71], v8 offset:15360
    v_smfmac_f32_16x16x64_bf16 v[20:23], v[36:39], v[184:191], v1
    v_smfmac_f32_16x16x64_bf16 v[24:27], v[36:39], v[192:199], v1
    s_waitcnt vmcnt(1)
    v_max3_u32 v10, v40, v41, v42
    v_max_u32 v10, v10, v43
    v_cmp_eq_u32 vcc, -1, v10
    s_nop 0
    s_cbranch_vccnz Lr1s_pb_re
Lr1s_pb_ok:
    ds_write_b128 v0, v[40:43] offset:12032
    v_mov_b32 v9, 1
    v_mov_b32 v10, 0
    s_mov_b64 exec, 1
    buffer_store_dword v9, v10, s[8:11], s67 offen offset:384 sc1
    s_mov_b64 exec, -1
    v_smfmac_f32_16x16x64_bf16 v[12:15], v[40:43], v[136:143], v1
    v_smfmac_f32_16x16x64_bf16 v[20:23], v[40:43], a[8:15], v1
    v_smfmac_f32_16x16x64_bf16 v[16:19], v[40:43], v[144:151], v1
    v_smfmac_f32_16x16x64_bf16 v[24:27], v[40:43], a[16:23], v1
    s_waitcnt lgkmcnt(0)
    s_barrier
    ds_read_b128 v[48:51], v0 offset:13056
    ds_read_b128 v[52:55], v0 offset:14080
    ds_read_b128 v[36:39], v0 offset:11008
    v_smfmac_f32_16x16x64_bf16 v[28:31], v[40:43], a[120:127], v1
    v_smfmac_f32_16x16x64_bf16 v[32:35], v[40:43], a[128:135], v1
    s_waitcnt lgkmcnt(2)
    v_smfmac_f32_16x16x64_bf16 v[12:15], v[48:51], v[56:63], v1
    ds_read_b128 v[56:59], v8 offset:8192
    ds_read_b128 v[60:63], v8 offset:9216
    v_smfmac_f32_16x16x64_bf16 v[16:19], v[48:51], v[64:71], v1
    ds_read_b128 v[64:67], v8 offset:10240
    ds_read_b128 v[68:71], v8 offset:11264
    s_waitcnt lgkmcnt(5)
    v_smfmac_f32_16x16x64_bf16 v[12:15], v[52:55], v[152:159], v1
    v_smfmac_f32_16x16x64_bf16 v[16:19], v[52:55], v[160:167], v1
    s_waitcnt vmcnt(1)
    v_max3_u32 v10, v44, v45, v46
    v_max_u32 v10, v10, v47
    v_cmp_eq_u32 vcc, -1, v10
    s_nop 0
    s_cbranch_vccnz Lr1s_pc_re
Lr1s_pc_ok:
    v_smfmac_f32_16x16x64_bf16 v[12:15], v[44:47], v[168:175], v1
    v_smfmac_f32_16x16x64_bf16 v[16:19], v[44:47], v[176:183], v1
    s_waitcnt lgkmcnt(2)
    v_smfmac_f32_16x16x64_bf16 v[12:15], v[36:39], v[56:63], v1
    s_waitcnt lgkmcnt(0)
    v_smfmac_f32_16x16x64_bf16 v[16:19], v[36:39], v[64:71], v1
    v_smfmac_f32_16x16x64_bf16 v[20:23], v[48:51], a[24:31], v1
    v_smfmac_f32_16x16x64_bf16 v[24:27], v[48:51], a[32:39], v1
    buffer_load_dwordx4 v[64:67], v0, s[8:11], s42 offen
    v_smfmac_f32_16x16x64_bf16 v[20:23], v[52:55], a[40:47], v1
    v_add_f32 v12, v12, v14
    v_smfmac_f32_16x16x64_bf16 v[24:27], v[52:55], a[48:55], v1
    v_add_f32 v16, v16, v18
    v_smfmac_f32_16x16x64_bf16 v[20:23], v[36:39], v[248:255], v1
    v_add_f32 v13, v13, v15
    v_smfmac_f32_16x16x64_bf16 v[24:27], v[36:39], a[0:7], v1
    v_add_f32 v17, v17, v19
    buffer_load_dwordx4 v[68:71], v0, s[8:11], s42 offen offset:1024
    v_smfmac_f32_16x16x64_bf16 v[20:23], v[44:47], a[56:63], v1
    v_cvt_pk_bf16_f32 v14, v12, v16
    ds_read_b128 v[56:59], v0 offset:15104
    v_smfmac_f32_16x16x64_bf16 v[24:27], v[44:47], a[64:71], v1
    v_cvt_pk_bf16_f32 v15, v13, v17
    ds_read_b128 v[60:63], v0 offset:16128
    ds_write_b32 v2, v14 offset:576
    ds_write_b32 v2, v15 offset:864
    v_smfmac_f32_16x16x64_bf16 v[28:31], v[48:51], a[136:143], v1
    v_smfmac_f32_16x16x64_bf16 v[32:35], v[48:51], a[144:151], v1
    v_add_f32 v20, v20, v22
    v_add_f32 v24, v24, v26
    v_add_f32 v21, v21, v23
    v_add_f32 v25, v25, v27
    v_cvt_pk_bf16_f32 v22, v20, v24
    v_cvt_pk_bf16_f32 v23, v21, v25
    ds_write_b32 v2, v22 offset:0
    ds_write_b32 v2, v23 offset:288
    v_smfmac_f32_16x16x64_bf16 v[28:31], v[52:55], a[152:159], v1
    v_smfmac_f32_16x16x64_bf16 v[32:35], v[52:55], a[160:167], v1
    s_waitcnt lgkmcnt(0)
    s_barrier
    ds_read_b128 v[40:43], v3 offset:0
    ds_read_b128 v[48:51], v3 offset:64
    ds_read_b128 v[20:23], v3 offset:128
    ds_read_b128 v[52:55], v3 offset:192
    v_smfmac_f32_16x16x64_bf16 v[28:31], v[36:39], a[104:111], v1
    v_smfmac_f32_16x16x64_bf16 v[32:35], v[36:39], a[112:119], v1
    ds_read_b128 v[36:39], v0 offset:17152
    v_smfmac_f32_16x16x64_bf16 v[28:31], v[44:47], a[168:175], v1
    v_smfmac_f32_16x16x64_bf16 v[32:35], v[44:47], a[176:183], v1
    ds_read_b128 v[44:47], v0 offset:18176
    s_waitcnt lgkmcnt(5)
    v_mfma_f32_16x16x32_bf16 v[12:15], v[56:59], v[40:43], 0
    v_mfma_f32_16x16x32_bf16 v[16:19], v[60:63], v[40:43], 0
    v_mfma_f32_16x16x32_bf16 v[24:27], v[40:43], v[40:43], 0
    ds_read_b128 v[56:59], v0 offset:19200
    ds_read_b128 v[60:63], v0 offset:20224
    s_waitcnt lgkmcnt(3)
    v_mfma_f32_16x16x32_bf16 v[12:15], v[36:39], v[48:51], v[12:15]
    v_lshrrev_b32 v10, 1, v0
    v_lshrrev_b32 v9, 9, v0
    s_waitcnt lgkmcnt(2)
    v_mfma_f32_16x16x32_bf16 v[16:19], v[44:47], v[48:51], v[16:19]
    v_lshl_add_u32 v9, v9, 5, v10
    v_add_f32 v28, v28, v30
    v_mfma_f32_16x16x32_bf16 v[24:27], v[48:51], v[48:51], v[24:27]
    v_add_f32 v32, v32, v34
    v_add_f32 v29, v29, v31
    ds_read_b128 v[36:39], v0 offset:21248
    ds_read_b128 v[44:47], v0 offset:22272
    s_waitcnt lgkmcnt(3)
    v_mfma_f32_16x16x32_bf16 v[12:15], v[56:59], v[20:23], v[12:15]
    v_add_f32 v33, v33, v35
    v_cvt_pk_bf16_f32 v30, v28, v29
    s_waitcnt lgkmcnt(2)
    v_mfma_f32_16x16x32_bf16 v[16:19], v[60:63], v[20:23], v[16:19]
    v_cvt_pk_bf16_f32 v31, v32, v33
    ds_read_b64 v[34:35], v9 offset:1152
    v_mfma_f32_16x16x32_bf16 v[24:27], v[20:23], v[20:23], v[24:27]
    s_add_u32 s17, s43, 2560
    buffer_store_dwordx2 v[30:31], v10, s[8:11], s17 offen sc1
    s_waitcnt lgkmcnt(2)
    v_mfma_f32_16x16x32_bf16 v[12:15], v[36:39], v[52:55], v[12:15]
    s_waitcnt lgkmcnt(1)
    v_mfma_f32_16x16x32_bf16 v[16:19], v[44:47], v[52:55], v[16:19]
    v_mfma_f32_16x16x32_bf16 v[24:27], v[52:55], v[52:55], v[24:27]
    s_add_u32 s17, s43, 512
    s_waitcnt lgkmcnt(0)
    buffer_store_dwordx2 v[34:35], v10, s[8:11], s17 offen sc1
    s_cmp_eq_u32 s33, 63
    s_cbranch_scc1 Lr1s_last
    ds_read_b128 v[56:59], v8 offset:16384
    ds_read_b128 v[60:63], v8 offset:17408
    v_mov_b64 v[20:21], s[52:53]
    v_mov_b64 v[22:23], s[52:53]
    v_mov_b32 v41, 0
    v_mov_b32 v42, 0
    v_max3_f32 v9, v12, v13, v14
    v_max3_f32 v9, v9, v15, v16
    v_max3_f32 v9, v9, v17, v18
    v_max3_f32 v9, v9, v19, v24
    v_max_f32 v9, v9, v25
    v_mov_b32 v10, v9
    v_mov_b64 v[32:33], 0
    v_mov_b64 v[34:35], 0
    v_permlane32_swap_b32 v9, v10
    v_max_f32 v9, v9, v10
    v_mov_b32 v10, v9
    s_nop 1
    v_permlane16_swap_b32 v9, v10
    v_max_f32 v9, v9, v10
    v_mul_f32 v28, s44, v9
    v_fma_f32 v12, v12, s44, -v28
    v_fma_f32 v13, v13, s44, -v28
    v_fma_f32 v14, v14, s44, -v28
    v_fma_f32 v15, v15, s44, -v28
    v_exp_f32 v12, v12
    v_exp_f32 v13, v13
    v_fma_f32 v16, v16, s44, -v28
    v_fma_f32 v17, v17, s44, -v28
    v_exp_f32 v14, v14
    v_exp_f32 v15, v15
    v_cvt_pk_bf16_f32 v36, v12, v13
    v_fma_f32 v18, v18, s44, -v28
    v_fma_f32 v19, v19, s44, -v28
    v_exp_f32 v16, v16
    v_exp_f32 v17, v17
    v_cvt_pk_bf16_f32 v37, v14, v15
    v_fma_f32 v24, v24, s44, -v28
    v_fma_f32 v25, v25, s44, -v28
    v_exp_f32 v18, v18
    v_exp_f32 v19, v19
    v_cvt_pk_bf16_f32 v38, v16, v17
    v_exp_f32 v24, v24
    v_exp_f32 v25, v25
    v_cvt_pk_bf16_f32 v39, v18, v19
    v_cvt_pk_bf16_f32 v40, v24, v25
    v_cvt_pk_bf16_f32 v43, v24, v25
    v_mfma_f32_16x16x32_bf16 v[52:55], v[20:23], v[36:39], 0
    v_mov_b64 v[12:13], 0
    v_mov_b64 v[14:15], 0
    s_waitcnt vmcnt(3)
    v_mfma_f32_16x16x32_bf16 v[44:47], v[64:67], v[36:39], 0
    v_mov_b64 v[24:25], 0
    v_mov_b64 v[26:27], 0
    s_waitcnt vmcnt(2)
    v_mfma_f32_16x16x32_bf16 v[48:51], v[68:71], v[36:39], 0
    ds_read_b128 v[64:67], v8 offset:20480
    ds_read_b128 v[68:71], v8 offset:21504
    v_mfma_f32_16x16x16_bf16 v[52:55], v[20:21], v[40:41], v[52:55]
    v_mfma_f32_16x16x16_bf16 v[44:47], v[30:31], v[40:41], v[44:47]
    v_mov_b64 v[20:21], 0
    v_mov_b64 v[22:23], 0
    v_mfma_f32_16x16x16_bf16 v[48:51], v[30:31], v[42:43], v[48:51]
    v_mov_b64 v[36:37], 0
    v_mov_b64 v[38:39], 0
    v_mov_b64 v[40:41], 0
    v_mov_b64 v[42:43], 0
    v_rcp_f32 v9, v52
    v_mov_b64 v[52:53], 0
    v_mov_b64 v[54:55], 0
    v_mul_f32 v44, v9, v44
    v_mul_f32 v48, v9, v48
    v_cvt_pk_bf16_f32 v16, v44, v48
    v_mul_f32 v45, v9, v45
    v_mul_f32 v49, v9, v49
    v_cvt_pk_bf16_f32 v17, v45, v49
    v_mul_f32 v46, v9, v46
    v_mul_f32 v50, v9, v50
    v_cvt_pk_bf16_f32 v18, v46, v50
    v_mul_f32 v47, v9, v47
    v_mul_f32 v51, v9, v51
    v_cvt_pk_bf16_f32 v19, v47, v51
    ds_write_b128 v5, v[16:19]
    v_mov_b64 v[28:29], 0
    v_mov_b64 v[30:31], 0
    s_waitcnt lgkmcnt(0)
    s_barrier
    ds_read_b128 v[44:47], v4 offset:0
    ds_read_b128 v[48:51], v4 offset:128
    v_mov_b64 v[16:17], 0
    v_mov_b64 v[18:19], 0
    buffer_load_dwordx4 v0, s[8:11], s41 offen offset:0 lds
    buffer_load_dwordx4 v0, s[8:11], s41 offen offset:1024 lds
    s_waitcnt lgkmcnt(1)
    v_smfmac_f32_16x16x64_bf16 v[12:15], v[44:47], a[184:191], v1
    s_waitcnt lgkmcnt(0)
    v_smfmac_f32_16x16x64_bf16 v[12:15], v[48:51], a[192:199], v1
    v_smfmac_f32_16x16x64_bf16 v[24:27], v[44:47], a[200:207], v1
    v_smfmac_f32_16x16x64_bf16 v[24:27], v[48:51], a[208:215], v1
    v_add_f32 v12, v12, v14
    v_smfmac_f32_16x16x64_bf16 v[20:23], v[44:47], a[216:223], v1
    v_add_f32 v13, v13, v15
    v_smfmac_f32_16x16x64_bf16 v[20:23], v[48:51], a[224:231], v1
    v_cvt_pk_bf16_f32 v12, v12, v13
    v_smfmac_f32_16x16x64_bf16 v[16:19], v[44:47], a[232:239], v1
    v_add_f32 v24, v24, v26
    v_smfmac_f32_16x16x64_bf16 v[16:19], v[48:51], a[240:247], v1
    v_add_f32 v25, v25, v27
    v_smfmac_f32_16x16x64_bf16 v[36:39], v[44:47], v[56:63], v1
    v_cvt_pk_bf16_f32 v13, v24, v25
    v_smfmac_f32_16x16x64_bf16 v[36:39], v[48:51], v[64:71], v1
    v_add_f32 v20, v20, v22
    v_add_f32 v21, v21, v23
    v_cvt_pk_bf16_f32 v14, v20, v21
    v_add_f32 v16, v16, v18
    v_add_f32 v17, v17, v19
    v_cvt_pk_bf16_f32 v15, v16, v17
    v_and_or_b32 v15, v15, -2, s40
    buffer_store_dwordx4 v[12:15], v0, s[8:11], s38 offen sc1
    s_nop 0
    ds_read_b128 v[12:15], v8 offset:18432
    ds_read_b128 v[16:19], v8 offset:19456
    ds_read_b128 v[20:23], v8 offset:22528
    ds_read_b128 v[24:27], v8 offset:23552
    ds_read_b128 v[56:59], v8 offset:24576
    ds_read_b128 v[60:63], v8 offset:25600
    ds_read_b128 v[64:67], v8 offset:28672
    ds_read_b128 v[68:71], v8 offset:29696
    s_waitcnt lgkmcnt(6)
    v_smfmac_f32_16x16x64_bf16 v[40:43], v[44:47], v[12:19], v1
    ds_read_b128 v[12:15], v8 offset:26624
    ds_read_b128 v[16:19], v8 offset:27648
    s_waitcnt lgkmcnt(6)
    v_smfmac_f32_16x16x64_bf16 v[40:43], v[48:51], v[20:27], v1
    ds_read_b128 v[20:23], v8 offset:30720
    ds_read_b128 v[24:27], v8 offset:31744
    s_waitcnt lgkmcnt(6)
    v_smfmac_f32_16x16x64_bf16 v[52:55], v[44:47], v[56:63], v1
    ds_read_b128 v[56:59], v8 offset:32768
    ds_read_b128 v[60:63], v8 offset:33792
    s_waitcnt lgkmcnt(6)
    v_smfmac_f32_16x16x64_bf16 v[52:55], v[48:51], v[64:71], v1
    s_waitcnt lgkmcnt(4)
    v_smfmac_f32_16x16x64_bf16 v[32:35], v[44:47], v[12:19], v1
    s_waitcnt lgkmcnt(2)
    v_smfmac_f32_16x16x64_bf16 v[32:35], v[48:51], v[20:27], v1
    v_smfmac_f32_16x16x64_bf16 v[28:31], v[44:47], a[248:255], v1
    s_waitcnt lgkmcnt(0)
    v_smfmac_f32_16x16x64_bf16 v[28:31], v[48:51], v[56:63], v1
    v_add_f32 v36, v36, v38
    v_add_f32 v37, v37, v39
    v_cvt_pk_bf16_f32 v36, v36, v37
    v_add_f32 v40, v40, v42
    v_add_f32 v41, v41, v43
    v_cvt_pk_bf16_f32 v37, v40, v41
    v_add_f32 v52, v52, v54
    v_add_f32 v53, v53, v55
    v_cvt_pk_bf16_f32 v38, v52, v53
    v_add_f32 v32, v32, v34
    v_add_f32 v33, v33, v35
    v_cvt_pk_bf16_f32 v39, v32, v33
    v_and_or_b32 v39, v39, -2, s40
    s_add_u32 s17, s38, 4096
    buffer_store_dwordx4 v[36:39], v0, s[8:11], s17 offen sc1
    v_add_f32 v28, v28, v30
    v_add_f32 v29, v29, v31
    v_cvt_pk_bf16_f32 v28, v28, v29
    v_and_or_b32 v28, v28, -2, s40
    v_lshrrev_b32 v9, 2, v0
    buffer_store_dword v28, v9, s[8:11], s39 offen sc1
    v_add_u32 v10, 162560, v0
    ds_read_b128 v[64:67], v10
    s_add_u32 s33, s33, 1
    s_add_u32 s42, s42, 262144
    s_add_u32 s41, s41, 262144
    s_add_u32 s43, s43, 131072
    s_mov_b32 s67, s66
    s_add_u32 s68, s68, 262144
    s_add_u32 s66, s66, 22528
    ds_read_b128 v[56:59], v8 offset:4096
    ds_read_b128 v[60:63], v8 offset:5120
    v_mov_b64 v[12:13], 0
    v_mov_b64 v[14:15], 0
    v_mov_b64 v[16:17], 0
    v_mov_b64 v[18:19], 0
    v_mov_b64 v[20:21], 0
    v_mov_b64 v[22:23], 0
    v_mov_b64 v[24:25], 0
    v_mov_b64 v[26:27], 0
    v_mov_b64 v[28:29], 0
    v_mov_b64 v[30:31], 0
    v_mov_b64 v[32:33], 0
    v_mov_b64 v[34:35], 0
    s_nop 15
    s_nop 15
    s_nop 15
    s_nop 11
    buffer_load_dwordx4 v[40:43], v6, s[8:11], s62 offen sc1
    buffer_load_dwordx4 v[44:47], v6, s[8:11], s63 offen sc1
    buffer_load_dwordx4 v[48:51], v6, s[8:11], s64 offen sc1
    buffer_load_dwordx4 v[52:55], v6, s[8:11], s65 offen sc1
    s_waitcnt lgkmcnt(0)
    s_waitcnt vmcnt(3)
    v_mfma_f32_16x16x32_bf16 v[68:71], v[40:43], v[64:67], 0
    v_and_b32 v10, 1, v43
    v_cmp_ne_u32 s[54:55], s40, v10
    s_waitcnt vmcnt(2)
    v_mfma_f32_16x16x32_bf16 v[68:71], v[44:47], v[64:67], v[68:71]
    v_and_b32 v10, 1, v47
    v_cmp_ne_u32 s[56:57], s40, v10
    s_waitcnt vmcnt(1)
    v_mfma_f32_16x16x32_bf16 v[68:71], v[48:51], v[64:67], v[68:71]
    v_and_b32 v10, 1, v51
    v_cmp_ne_u32 s[58:59], s40, v10
    s_waitcnt vmcnt(0)
    v_mfma_f32_16x16x32_bf16 v[68:71], v[52:55], v[64:67], v[68:71]
    v_and_b32 v10, 1, v55
    v_cmp_ne_u32 s[60:61], s40, v10
    s_or_b64 vcc, s[54:55], s[56:57]
    s_or_b64 vcc, vcc, s[58:59]
    s_or_b64 vcc, vcc, s[60:61]
    s_cbranch_scc0 Lr1s_red
    s_mov_b32 s16, 0
Lr1s_p1:
    s_mov_b64 exec, s[54:55]
    buffer_load_dwordx4 v[40:43], v6, s[8:11], s62 offen sc1
    s_mov_b64 exec, s[56:57]
    buffer_load_dwordx4 v[44:47], v6, s[8:11], s63 offen sc1
    s_mov_b64 exec, s[58:59]
    buffer_load_dwordx4 v[48:51], v6, s[8:11], s64 offen sc1
    s_mov_b64 exec, s[60:61]
    buffer_load_dwordx4 v[52:55], v6, s[8:11], s65 offen sc1
    s_mov_b64 exec, -1
    s_add_u32 s16, s16, 1
    s_cmp_gt_u32 s16, 100000
    s_cbranch_scc1 Lr_abort
    s_waitcnt vmcnt(3)
    v_mfma_f32_16x16x32_bf16 v[68:71], v[40:43], v[64:67], 0
    v_and_b32 v10, 1, v43
    v_cmp_ne_u32 s[54:55], s40, v10
    s_waitcnt vmcnt(2)
    v_mfma_f32_16x16x32_bf16 v[68:71], v[44:47], v[64:67], v[68:71]
    v_and_b32 v10, 1, v47
    v_cmp_ne_u32 s[56:57], s40, v10
    s_waitcnt vmcnt(1)
    v_mfma_f32_16x16x32_bf16 v[68:71], v[48:51], v[64:67], v[68:71]
    v_and_b32 v10, 1, v51
    v_cmp_ne_u32 s[58:59], s40, v10
    s_waitcnt vmcnt(0)
    v_mfma_f32_16x16x32_bf16 v[68:71], v[52:55], v[64:67], v[68:71]
    v_and_b32 v10, 1, v55
    v_cmp_ne_u32 s[60:61], s40, v10
    s_or_b64 vcc, s[54:55], s[56:57]
    s_or_b64 vcc, vcc, s[58:59]
    s_or_b64 vcc, vcc, s[60:61]
    s_cbranch_scc1 Lr1s_p1
Lr1s_red:
    s_xor_b32 s34, s34, 16384
    s_xor_b32 s35, s35, 16384
    buffer_load_dwordx4 v[36:39], v0, s[8:11], s34 offen sc1
    v_permlane16_swap_b32 v68, v70
    v_permlane16_swap_b32 v69, v71
    s_mov_b64 exec, s[46:47]
    v_add_f32 v68, v68, v70
    v_add_f32 v69, v69, v71
    v_cvt_pk_bf16_f32 v68, v68, v69
    v_min_u32 v68, s50, v68
    buffer_store_dword v68, v7, s[8:11], s36 offen sc1
    v_mov_b32 v69, -1
    buffer_store_dword v69, v7, s[8:11], s37 offen sc1
    s_mov_b64 exec, -1
    buffer_load_dwordx4 v[36:39], v0, s[8:11], s34 offen sc1
    s_xor_b32 s40, s40, 1
    s_xor_b32 s36, s36, 16384
    s_xor_b32 s37, s37, 16384
    ds_read_b128 v[64:67], v8 offset:6144
    ds_read_b128 v[68:71], v8 offset:7168
    s_waitcnt lgkmcnt(0)
    s_branch Lr1s_step
Lr1s_pb_re:
    s_mov_b32 s16, 0
Lr1s_pb_lp:
    s_add_u32 s17, s34, 4096
    buffer_load_dwordx4 v[40:43], v0, s[8:11], s17 offen sc1
    s_add_u32 s16, s16, 1
    s_cmp_gt_u32 s16, 100000
    s_cbranch_scc1 Lr_abort
    s_waitcnt vmcnt(0)
    v_max3_u32 v10, v40, v41, v42
    v_max_u32 v10, v10, v43
    v_cmp_eq_u32 vcc, -1, v10
    s_nop 0
    s_cbranch_vccnz Lr1s_pb_lp
    s_branch Lr1s_pb_ok
Lr1s_pc_re:
    s_mov_b32 s16, 0
Lr1s_pc_lp:
    buffer_load_dwordx4 v[44:47], v0, s[8:11], s35 offen sc1
    s_add_u32 s16, s16, 1
    s_cmp_gt_u32 s16, 100000
    s_cbranch_scc1 Lr_abort
    s_waitcnt vmcnt(0)
    v_max3_u32 v10, v44, v45, v46
    v_max_u32 v10, v10, v47
    v_cmp_eq_u32 vcc, -1, v10
    s_nop 0
    s_cbranch_vccnz Lr1s_pc_lp
    s_branch Lr1s_pc_ok
Lr1s_last:
    s_waitcnt vmcnt(0) lgkmcnt(0)
    s_barrier
    s_mov_b32 s67, s66
    v_mov_b32 v9, 1
    v_mov_b32 v10, 0
    s_mov_b64 exec, 1
    buffer_store_dword v9, v10, s[8:11], s67 offen offset:384 sc1
    s_mov_b64 exec, -1
    s_branch Lr_exit
L_w2_0:
    s_cmp_lg_u32 s14, 2
    s_cbranch_scc1 L_w3_0
    buffer_load_dwordx4 v[36:39], v0, s[8:11], s34 offen sc1
    s_mov_b32 s16, 0
    s_add_u32 s17, s66, 128
    v_lshrrev_b32 v10, 2, v0
    v_and_b32 v9, 16, v10
    v_lshlrev_b32 v9, 3, v9
    v_and_or_b32 v10, v10, 12, v9
Lr2s_fw_17:
    buffer_load_dword v9, v10, s[8:11], s17 offen sc1
    s_add_u32 s16, s16, 1
    s_cmp_gt_u32 s16, 100000
    s_cbranch_scc1 Lr_abort
    s_waitcnt vmcnt(0)
    v_cmp_eq_u32 vcc, 0, v9
    s_nop 0
    s_cbranch_vccnz Lr2s_fw_17
    s_mov_b32 m0, 19200
    s_nop 0
    buffer_load_dwordx4 v0, s[8:11], s41 offen offset:0 lds
    buffer_load_dwordx4 v0, s[8:11], s41 offen offset:1024 lds
    s_add_u32 s41, s41, 262144
    s_add_u32 s68, s68, 262144
    ds_read_b128 v[56:59], v8 offset:4096
    ds_read_b128 v[60:63], v8 offset:5120
    ds_read_b128 v[64:67], v8 offset:6144
    ds_read_b128 v[68:71], v8 offset:7168
    v_mov_b64 v[12:13], 0
    v_mov_b64 v[14:15], 0
    v_mov_b64 v[16:17], 0
    v_mov_b64 v[18:19], 0
    v_mov_b64 v[20:21], 0
    v_mov_b64 v[22:23], 0
    v_mov_b64 v[24:25], 0
    v_mov_b64 v[26:27], 0
    v_mov_b64 v[28:29], 0
    v_mov_b64 v[30:31], 0
    v_mov_b64 v[32:33], 0
    v_mov_b64 v[34:35], 0
    s_waitcnt vmcnt(0) lgkmcnt(0)
Lr2s_step:
    s_waitcnt vmcnt(3)
    v_max3_u32 v10, v36, v37, v38
    v_max_u32 v10, v10, v39
    v_cmp_eq_u32 vcc, -1, v10
    s_nop 0
    s_cbranch_vccz Lr2s_aok
    buffer_load_dwordx4 v[36:39], v0, s[8:11], s34 offen sc1
    s_nop 15
    s_nop 8
    buffer_load_dwordx4 v[36:39], v0, s[8:11], s34 offen sc1
    s_mov_b32 s16, 0
Lr2s_alp:
    s_waitcnt vmcnt(2)
    v_max3_u32 v10, v36, v37, v38
    v_max_u32 v10, v10, v39
    v_cmp_eq_u32 vcc, -1, v10
    s_nop 0
    s_cbranch_vccz Lr2s_aok
    buffer_load_dwordx4 v[36:39], v0, s[8:11], s34 offen sc1
    s_add_u32 s16, s16, 1
    s_cmp_gt_u32 s16, 100000
    s_cbranch_scc1 Lr_abort
    s_branch Lr2s_alp
Lr2s_aok:
    ds_write_b128 v0, v[36:39] offset:8960
    v_smfmac_f32_16x16x64_bf16 v[12:15], v[36:39], v[104:111], v1
    v_smfmac_f32_16x16x64_bf16 v[16:19], v[36:39], v[112:119], v1
    v_smfmac_f32_16x16x64_bf16 v[20:23], v[36:39], v[216:223], v1
    s_waitcnt lgkmcnt(0)
    s_barrier
    ds_read_b128 v[48:51], v0 offset:9984
    ds_read_b128 v[52:55], v0 offset:6912
    v_smfmac_f32_16x16x64_bf16 v[28:31], v[36:39], v[56:63], v1
    ds_read_b128 v[56:59], v8 offset:0
    ds_read_b128 v[60:63], v8 offset:1024
    v_smfmac_f32_16x16x64_bf16 v[24:27], v[36:39], v[224:231], v1
    v_smfmac_f32_16x16x64_bf16 v[32:35], v[36:39], v[64:71], v1
    ds_read_b128 v[64:67], v8 offset:2048
    ds_read_b128 v[68:71], v8 offset:3072
    s_add_u32 s17, s34, 4096
    buffer_load_dwordx4 v[40:43], v0, s[8:11], s17 offen sc1
    s_waitcnt vmcnt(1)
    ds_read_b128 v[36:39], v0 offset:7936
    s_waitcnt lgkmcnt(6)
    v_smfmac_f32_16x16x64_bf16 v[28:31], v[48:51], a[88:95], v1
    v_smfmac_f32_16x16x64_bf16 v[12:15], v[48:51], v[120:127], v1
    v_smfmac_f32_16x16x64_bf16 v[16:19], v[48:51], v[128:135], v1
    v_smfmac_f32_16x16x64_bf16 v[32:35], v[48:51], a[96:103], v1
    buffer_load_dwordx4 v[44:47], v0, s[8:11], s35 offen sc1
    v_smfmac_f32_16x16x64_bf16 v[20:23], v[48:51], v[232:239], v1
    v_lshrrev_b32 v10, 2, v0
    v_and_b32 v9, 16, v10
    v_lshlrev_b32 v9, 3, v9
    v_and_or_b32 v10, v10, 12, v9
    s_add_u32 s17, s66, 22656
    v_mov_b32 v11, 2
    buffer_load_dword v11, v10, s[8:11], s17 offen sc1
    v_smfmac_f32_16x16x64_bf16 v[24:27], v[48:51], v[240:247], v1
    s_waitcnt lgkmcnt(3)
    v_smfmac_f32_16x16x64_bf16 v[28:31], v[52:55], v[56:63], v1
    ds_read_b128 v[56:59], v8 offset:12288
    ds_read_b128 v[60:63], v8 offset:13312
    v_smfmac_f32_16x16x64_bf16 v[12:15], v[52:55], v[72:79], v1
    v_smfmac_f32_16x16x64_bf16 v[16:19], v[52:55], v[80:87], v1
    s_waitcnt lgkmcnt(3)
    v_smfmac_f32_16x16x64_bf16 v[32:35], v[52:55], v[64:71], v1
    ds_read_b128 v[64:67], v8 offset:14336
    ds_read_b128 v[68:71], v8 offset:15360
    v_smfmac_f32_16x16x64_bf16 v[20:23], v[52:55], v[184:191], v1
    v_smfmac_f32_16x16x64_bf16 v[24:27], v[52:55], v[192:199], v1
    s_waitcnt lgkmcnt(4)
    v_smfmac_f32_16x16x64_bf16 v[28:31], v[36:39], a[72:79], v1
    v_smfmac_f32_16x16x64_bf16 v[12:15], v[36:39], v[88:95], v1
    v_smfmac_f32_16x16x64_bf16 v[16:19], v[36:39], v[96:103], v1
    v_smfmac_f32_16x16x64_bf16 v[32:35], v[36:39], a[80:87], v1
    v_smfmac_f32_16x16x64_bf16 v[20:23], v[36:39], v[200:207], v1
    v_smfmac_f32_16x16x64_bf16 v[24:27], v[36:39], v[208:215], v1
    s_waitcnt vmcnt(2)
    v_max3_u32 v10, v40, v41, v42
    v_max_u32 v10, v10, v43
    v_cmp_eq_u32 vcc, -1, v10
    s_nop 0
    s_cbranch_vccnz Lr2s_pb_re
Lr2s_pb_ok:
    ds_write_b128 v0, v[40:43] offset:13056
    s_waitcnt lgkmcnt(3)
    v_smfmac_f32_16x16x64_bf16 v[12:15], v[40:43], v[56:63], v1
    ds_read_b128 v[56:59], v8 offset:8192
    ds_read_b128 v[60:63], v8 offset:9216
    v_smfmac_f32_16x16x64_bf16 v[20:23], v[40:43], a[24:31], v1
    s_waitcnt lgkmcnt(3)
    v_smfmac_f32_16x16x64_bf16 v[16:19], v[40:43], v[64:71], v1
    ds_read_b128 v[64:67], v8 offset:10240
    ds_read_b128 v[68:71], v8 offset:11264
    v_smfmac_f32_16x16x64_bf16 v[24:27], v[40:43], a[32:39], v1
    s_waitcnt lgkmcnt(4)
    s_barrier
    ds_read_b128 v[48:51], v0 offset:11008
    ds_read_b128 v[52:55], v0 offset:14080
    ds_read_b128 v[36:39], v0 offset:12032
    v_smfmac_f32_16x16x64_bf16 v[28:31], v[40:43], a[136:143], v1
    v_smfmac_f32_16x16x64_bf16 v[32:35], v[40:43], a[144:151], v1
    s_waitcnt lgkmcnt(2)
    v_smfmac_f32_16x16x64_bf16 v[12:15], v[48:51], v[56:63], v1
    v_smfmac_f32_16x16x64_bf16 v[16:19], v[48:51], v[64:71], v1
    s_waitcnt lgkmcnt(1)
    v_smfmac_f32_16x16x64_bf16 v[12:15], v[52:55], v[152:159], v1
    v_smfmac_f32_16x16x64_bf16 v[16:19], v[52:55], v[160:167], v1
    s_waitcnt lgkmcnt(0)
    v_smfmac_f32_16x16x64_bf16 v[12:15], v[36:39], v[136:143], v1
    v_smfmac_f32_16x16x64_bf16 v[16:19], v[36:39], v[144:151], v1
    s_waitcnt vmcnt(1)
    v_max3_u32 v10, v44, v45, v46
    v_max_u32 v10, v10, v47
    v_cmp_eq_u32 vcc, -1, v10
    s_nop 0
    s_cbranch_vccnz Lr2s_pc_re
Lr2s_pc_ok:
    v_smfmac_f32_16x16x64_bf16 v[12:15], v[44:47], v[168:175], v1
    v_smfmac_f32_16x16x64_bf16 v[16:19], v[44:47], v[176:183], v1
    v_smfmac_f32_16x16x64_bf16 v[20:23], v[48:51], v[248:255], v1
    v_smfmac_f32_16x16x64_bf16 v[24:27], v[48:51], a[0:7], v1
    v_smfmac_f32_16x16x64_bf16 v[20:23], v[52:55], a[40:47], v1
    v_add_f32 v12, v12, v14
    buffer_load_dwordx4 v[64:67], v0, s[8:11], s42 offen
    v_smfmac_f32_16x16x64_bf16 v[24:27], v[52:55], a[48:55], v1
    v_add_f32 v16, v16, v18
    v_smfmac_f32_16x16x64_bf16 v[20:23], v[36:39], a[8:15], v1
    v_add_f32 v13, v13, v15
    v_smfmac_f32_16x16x64_bf16 v[24:27], v[36:39], a[16:23], v1
    v_add_f32 v17, v17, v19
    v_smfmac_f32_16x16x64_bf16 v[20:23], v[44:47], a[56:63], v1
    v_cvt_pk_bf16_f32 v14, v12, v16
    ds_read_b128 v[56:59], v0 offset:15104
    buffer_load_dwordx4 v[68:71], v0, s[8:11], s42 offen offset:1024
    v_smfmac_f32_16x16x64_bf16 v[24:27], v[44:47], a[64:71], v1
    v_cvt_pk_bf16_f32 v15, v13, v17
    ds_read_b128 v[60:63], v0 offset:16128
    ds_write_b32 v2, v14 offset:576
    ds_write_b32 v2, v15 offset:864
    v_smfmac_f32_16x16x64_bf16 v[28:31], v[48:51], a[104:111], v1
    v_smfmac_f32_16x16x64_bf16 v[32:35], v[48:51], a[112:119], v1
    v_add_f32 v20, v20, v22
    v_add_f32 v24, v24, v26
    v_add_f32 v21, v21, v23
    v_add_f32 v25, v25, v27
    v_cvt_pk_bf16_f32 v22, v20, v24
    v_cvt_pk_bf16_f32 v23, v21, v25
    ds_write_b32 v2, v22 offset:0
    ds_write_b32 v2, v23 offset:288
    v_smfmac_f32_16x16x64_bf16 v[28:31], v[52:55], a[152:159], v1
    v_smfmac_f32_16x16x64_bf16 v[32:35], v[52:55], a[160:167], v1
    s_waitcnt vmcnt(2)
    v_cmp_eq_u32 vcc, 0, v11
    s_nop 0
    s_cbranch_vccnz Lr2s_flbad
Lr2s_flok:
    s_waitcnt lgkmcnt(0)
    s_barrier
    ds_read_b128 v[40:43], v3 offset:0
    ds_read_b128 v[48:51], v3 offset:64
    ds_read_b128 v[20:23], v3 offset:128
    ds_read_b128 v[52:55], v3 offset:192
    v_smfmac_f32_16x16x64_bf16 v[28:31], v[36:39], a[120:127], v1
    v_smfmac_f32_16x16x64_bf16 v[32:35], v[36:39], a[128:135], v1
    ds_read_b128 v[36:39], v0 offset:17152
    v_smfmac_f32_16x16x64_bf16 v[28:31], v[44:47], a[168:175], v1
    v_smfmac_f32_16x16x64_bf16 v[32:35], v[44:47], a[176:183], v1
    ds_read_b128 v[44:47], v0 offset:18176
    s_waitcnt lgkmcnt(5)
    v_mfma_f32_16x16x32_bf16 v[12:15], v[56:59], v[40:43], 0
    v_mfma_f32_16x16x32_bf16 v[16:19], v[60:63], v[40:43], 0
    v_mfma_f32_16x16x32_bf16 v[24:27], v[40:43], v[40:43], 0
    ds_read_b128 v[56:59], v0 offset:19200
    ds_read_b128 v[60:63], v0 offset:20224
    s_waitcnt lgkmcnt(3)
    v_mfma_f32_16x16x32_bf16 v[12:15], v[36:39], v[48:51], v[12:15]
    v_lshrrev_b32 v10, 1, v0
    v_lshrrev_b32 v9, 9, v0
    s_waitcnt lgkmcnt(2)
    v_mfma_f32_16x16x32_bf16 v[16:19], v[44:47], v[48:51], v[16:19]
    v_lshl_add_u32 v9, v9, 5, v10
    v_add_f32 v28, v28, v30
    v_mfma_f32_16x16x32_bf16 v[24:27], v[48:51], v[48:51], v[24:27]
    v_add_f32 v32, v32, v34
    v_add_f32 v29, v29, v31
    ds_read_b128 v[36:39], v0 offset:21248
    ds_read_b128 v[44:47], v0 offset:22272
    s_waitcnt lgkmcnt(3)
    v_mfma_f32_16x16x32_bf16 v[12:15], v[56:59], v[20:23], v[12:15]
    v_add_f32 v33, v33, v35
    v_cvt_pk_bf16_f32 v30, v28, v29
    s_waitcnt lgkmcnt(2)
    v_mfma_f32_16x16x32_bf16 v[16:19], v[60:63], v[20:23], v[16:19]
    v_cvt_pk_bf16_f32 v31, v32, v33
    ds_read_b64 v[34:35], v9 offset:2304
    v_mfma_f32_16x16x32_bf16 v[24:27], v[20:23], v[20:23], v[24:27]
    s_add_u32 s17, s43, 3072
    buffer_store_dwordx2 v[30:31], v10, s[8:11], s17 offen sc1
    s_waitcnt lgkmcnt(2)
    v_mfma_f32_16x16x32_bf16 v[12:15], v[36:39], v[52:55], v[12:15]
    s_waitcnt lgkmcnt(1)
    v_mfma_f32_16x16x32_bf16 v[16:19], v[44:47], v[52:55], v[16:19]
    v_mfma_f32_16x16x32_bf16 v[24:27], v[52:55], v[52:55], v[24:27]
    s_add_u32 s17, s43, 1024
    s_waitcnt lgkmcnt(0)
    buffer_store_dwordx2 v[34:35], v10, s[8:11], s17 offen sc1
    s_cmp_eq_u32 s33, 63
    s_cbranch_scc1 Lr2s_last
    ds_read_b128 v[56:59], v8 offset:16384
    ds_read_b128 v[60:63], v8 offset:17408
    v_mov_b64 v[20:21], s[52:53]
    v_mov_b64 v[22:23], s[52:53]
    v_mov_b32 v41, 0
    v_mov_b32 v42, 0
    v_max3_f32 v9, v12, v13, v14
    v_max3_f32 v9, v9, v15, v16
    v_max3_f32 v9, v9, v17, v18
    v_max3_f32 v9, v9, v19, v24
    v_max_f32 v9, v9, v25
    v_mov_b32 v10, v9
    v_mov_b64 v[32:33], 0
    v_mov_b64 v[34:35], 0
    v_permlane32_swap_b32 v9, v10
    v_max_f32 v9, v9, v10
    v_mov_b32 v10, v9
    s_nop 1
    v_permlane16_swap_b32 v9, v10
    v_max_f32 v9, v9, v10
    v_mul_f32 v28, s44, v9
    v_fma_f32 v12, v12, s44, -v28
    v_fma_f32 v13, v13, s44, -v28
    v_fma_f32 v14, v14, s44, -v28
    v_fma_f32 v15, v15, s44, -v28
    v_exp_f32 v12, v12
    v_exp_f32 v13, v13
    v_fma_f32 v16, v16, s44, -v28
    v_fma_f32 v17, v17, s44, -v28
    v_exp_f32 v14, v14
    v_exp_f32 v15, v15
    v_cvt_pk_bf16_f32 v36, v12, v13
    v_fma_f32 v18, v18, s44, -v28
    v_fma_f32 v19, v19, s44, -v28
    v_exp_f32 v16, v16
    v_exp_f32 v17, v17
    v_cvt_pk_bf16_f32 v37, v14, v15
    v_fma_f32 v24, v24, s44, -v28
    v_fma_f32 v25, v25, s44, -v28
    v_exp_f32 v18, v18
    v_exp_f32 v19, v19
    v_cvt_pk_bf16_f32 v38, v16, v17
    v_exp_f32 v24, v24
    v_exp_f32 v25, v25
    v_cvt_pk_bf16_f32 v39, v18, v19
    v_cvt_pk_bf16_f32 v40, v24, v25
    v_cvt_pk_bf16_f32 v43, v24, v25
    v_mfma_f32_16x16x32_bf16 v[52:55], v[20:23], v[36:39], 0
    v_mov_b64 v[12:13], 0
    v_mov_b64 v[14:15], 0
    s_waitcnt vmcnt(3)
    v_mfma_f32_16x16x32_bf16 v[44:47], v[64:67], v[36:39], 0
    v_mov_b64 v[24:25], 0
    v_mov_b64 v[26:27], 0
    s_waitcnt vmcnt(2)
    v_mfma_f32_16x16x32_bf16 v[48:51], v[68:71], v[36:39], 0
    ds_read_b128 v[64:67], v8 offset:20480
    ds_read_b128 v[68:71], v8 offset:21504
    v_mfma_f32_16x16x16_bf16 v[52:55], v[20:21], v[40:41], v[52:55]
    v_mfma_f32_16x16x16_bf16 v[44:47], v[30:31], v[40:41], v[44:47]
    v_mov_b64 v[20:21], 0
    v_mov_b64 v[22:23], 0
    v_mfma_f32_16x16x16_bf16 v[48:51], v[30:31], v[42:43], v[48:51]
    v_mov_b64 v[36:37], 0
    v_mov_b64 v[38:39], 0
    v_mov_b64 v[40:41], 0
    v_mov_b64 v[42:43], 0
    v_rcp_f32 v9, v52
    v_mov_b64 v[52:53], 0
    v_mov_b64 v[54:55], 0
    v_mul_f32 v44, v9, v44
    v_mul_f32 v48, v9, v48
    v_cvt_pk_bf16_f32 v16, v44, v48
    v_mul_f32 v45, v9, v45
    v_mul_f32 v49, v9, v49
    v_cvt_pk_bf16_f32 v17, v45, v49
    v_mul_f32 v46, v9, v46
    v_mul_f32 v50, v9, v50
    v_cvt_pk_bf16_f32 v18, v46, v50
    v_mul_f32 v47, v9, v47
    v_mul_f32 v51, v9, v51
    v_cvt_pk_bf16_f32 v19, v47, v51
    ds_write_b128 v5, v[16:19]
    v_mov_b64 v[28:29], 0
    v_mov_b64 v[30:31], 0
    s_waitcnt lgkmcnt(0)
    s_barrier
    ds_read_b128 v[44:47], v4 offset:0
    ds_read_b128 v[48:51], v4 offset:128
    v_mov_b64 v[16:17], 0
    v_mov_b64 v[18:19], 0
    buffer_load_dwordx4 v0, s[8:11], s41 offen offset:0 lds
    buffer_load_dwordx4 v0, s[8:11], s41 offen offset:1024 lds
    s_waitcnt lgkmcnt(1)
    v_smfmac_f32_16x16x64_bf16 v[12:15], v[44:47], a[184:191], v1
    s_waitcnt lgkmcnt(0)
    v_smfmac_f32_16x16x64_bf16 v[12:15], v[48:51], a[192:199], v1
    v_smfmac_f32_16x16x64_bf16 v[24:27], v[44:47], a[200:207], v1
    v_smfmac_f32_16x16x64_bf16 v[24:27], v[48:51], a[208:215], v1
    v_add_f32 v12, v12, v14
    v_smfmac_f32_16x16x64_bf16 v[20:23], v[44:47], a[216:223], v1
    v_add_f32 v13, v13, v15
    v_smfmac_f32_16x16x64_bf16 v[20:23], v[48:51], a[224:231], v1
    v_cvt_pk_bf16_f32 v12, v12, v13
    v_smfmac_f32_16x16x64_bf16 v[16:19], v[44:47], a[232:239], v1
    v_add_f32 v24, v24, v26
    v_smfmac_f32_16x16x64_bf16 v[16:19], v[48:51], a[240:247], v1
    v_add_f32 v25, v25, v27
    v_smfmac_f32_16x16x64_bf16 v[36:39], v[44:47], v[56:63], v1
    v_cvt_pk_bf16_f32 v13, v24, v25
    v_smfmac_f32_16x16x64_bf16 v[36:39], v[48:51], v[64:71], v1
    v_add_f32 v20, v20, v22
    v_add_f32 v21, v21, v23
    v_cvt_pk_bf16_f32 v14, v20, v21
    v_add_f32 v16, v16, v18
    v_add_f32 v17, v17, v19
    v_cvt_pk_bf16_f32 v15, v16, v17
    v_and_or_b32 v15, v15, -2, s40
    buffer_store_dwordx4 v[12:15], v0, s[8:11], s38 offen sc1
    s_nop 0
    ds_read_b128 v[12:15], v8 offset:18432
    ds_read_b128 v[16:19], v8 offset:19456
    ds_read_b128 v[20:23], v8 offset:22528
    ds_read_b128 v[24:27], v8 offset:23552
    ds_read_b128 v[56:59], v8 offset:24576
    ds_read_b128 v[60:63], v8 offset:25600
    ds_read_b128 v[64:67], v8 offset:28672
    ds_read_b128 v[68:71], v8 offset:29696
    s_waitcnt lgkmcnt(6)
    v_smfmac_f32_16x16x64_bf16 v[40:43], v[44:47], v[12:19], v1
    ds_read_b128 v[12:15], v8 offset:26624
    ds_read_b128 v[16:19], v8 offset:27648
    s_waitcnt lgkmcnt(6)
    v_smfmac_f32_16x16x64_bf16 v[40:43], v[48:51], v[20:27], v1
    ds_read_b128 v[20:23], v8 offset:30720
    ds_read_b128 v[24:27], v8 offset:31744
    s_waitcnt lgkmcnt(6)
    v_smfmac_f32_16x16x64_bf16 v[52:55], v[44:47], v[56:63], v1
    ds_read_b128 v[56:59], v8 offset:32768
    ds_read_b128 v[60:63], v8 offset:33792
    s_waitcnt lgkmcnt(6)
    v_smfmac_f32_16x16x64_bf16 v[52:55], v[48:51], v[64:71], v1
    s_waitcnt lgkmcnt(4)
    v_smfmac_f32_16x16x64_bf16 v[32:35], v[44:47], v[12:19], v1
    s_waitcnt lgkmcnt(2)
    v_smfmac_f32_16x16x64_bf16 v[32:35], v[48:51], v[20:27], v1
    v_smfmac_f32_16x16x64_bf16 v[28:31], v[44:47], a[248:255], v1
    s_waitcnt lgkmcnt(0)
    v_smfmac_f32_16x16x64_bf16 v[28:31], v[48:51], v[56:63], v1
    v_add_f32 v36, v36, v38
    v_add_f32 v37, v37, v39
    v_cvt_pk_bf16_f32 v36, v36, v37
    v_add_f32 v40, v40, v42
    v_add_f32 v41, v41, v43
    v_cvt_pk_bf16_f32 v37, v40, v41
    v_add_f32 v52, v52, v54
    v_add_f32 v53, v53, v55
    v_cvt_pk_bf16_f32 v38, v52, v53
    v_add_f32 v32, v32, v34
    v_add_f32 v33, v33, v35
    v_cvt_pk_bf16_f32 v39, v32, v33
    v_and_or_b32 v39, v39, -2, s40
    s_add_u32 s17, s38, 4096
    buffer_store_dwordx4 v[36:39], v0, s[8:11], s17 offen sc1
    v_add_f32 v28, v28, v30
    v_add_f32 v29, v29, v31
    v_cvt_pk_bf16_f32 v28, v28, v29
    v_and_or_b32 v28, v28, -2, s40
    v_lshrrev_b32 v9, 2, v0
    buffer_store_dword v28, v9, s[8:11], s39 offen sc1
    v_add_u32 v10, 162560, v0
    ds_read_b32 v64, v10
    v_mov_b32 v65, 0
    v_mov_b32 v41, 0
    v_mov_b32 v45, 0
    v_mov_b32 v49, 0
    v_mov_b32 v53, 0
    s_add_u32 s33, s33, 1
    s_add_u32 s42, s42, 262144
    s_add_u32 s41, s41, 262144
    s_add_u32 s43, s43, 131072
    s_add_u32 s68, s68, 262144
    s_add_u32 s66, s66, 22528
    ds_read_b128 v[56:59], v8 offset:4096
    ds_read_b128 v[60:63], v8 offset:5120
    v_mov_b64 v[12:13], 0
    v_mov_b64 v[14:15], 0
    v_mov_b64 v[16:17], 0
    v_mov_b64 v[18:19], 0
    v_mov_b64 v[20:21], 0
    v_mov_b64 v[22:23], 0
    v_mov_b64 v[24:25], 0
    v_mov_b64 v[26:27], 0
    v_mov_b64 v[28:29], 0
    v_mov_b64 v[30:31], 0
    v_mov_b64 v[32:33], 0
    v_mov_b64 v[34:35], 0
    s_nop 15
    s_nop 15
    s_nop 15
    s_nop 1
    buffer_load_dword v40, v6, s[8:11], s62 offen sc1
    buffer_load_dword v44, v6, s[8:11], s63 offen sc1
    buffer_load_dword v48, v6, s[8:11], s64 offen sc1
    buffer_load_dword v52, v6, s[8:11], s65 offen sc1
    s_waitcnt lgkmcnt(0)
    s_waitcnt vmcnt(3)
    v_mfma_f32_16x16x16_bf16 v[68:71], v[40:41], v[64:65], 0
    v_and_b32 v10, 1, v40
    v_cmp_ne_u32 s[54:55], s40, v10
    s_waitcnt vmcnt(2)
    v_mfma_f32_16x16x16_bf16 v[68:71], v[44:45], v[64:65], v[68:71]
    v_and_b32 v10, 1, v44
    v_cmp_ne_u32 s[56:57], s40, v10
    s_waitcnt vmcnt(1)
    v_mfma_f32_16x16x16_bf16 v[68:71], v[48:49], v[64:65], v[68:71]
    v_and_b32 v10, 1, v48
    v_cmp_ne_u32 s[58:59], s40, v10
    s_waitcnt vmcnt(0)
    v_mfma_f32_16x16x16_bf16 v[68:71], v[52:53], v[64:65], v[68:71]
    v_and_b32 v10, 1, v52
    v_cmp_ne_u32 s[60:61], s40, v10
    s_or_b64 vcc, s[54:55], s[56:57]
    s_or_b64 vcc, vcc, s[58:59]
    s_or_b64 vcc, vcc, s[60:61]
    s_cbranch_scc0 Lr2s_red
    s_mov_b32 s16, 0
Lr2s_p1:
    s_mov_b64 exec, s[54:55]
    buffer_load_dword v40, v6, s[8:11], s62 offen sc1
    s_mov_b64 exec, s[56:57]
    buffer_load_dword v44, v6, s[8:11], s63 offen sc1
    s_mov_b64 exec, s[58:59]
    buffer_load_dword v48, v6, s[8:11], s64 offen sc1
    s_mov_b64 exec, s[60:61]
    buffer_load_dword v52, v6, s[8:11], s65 offen sc1
    s_mov_b64 exec, -1
    s_add_u32 s16, s16, 1
    s_cmp_gt_u32 s16, 100000
    s_cbranch_scc1 Lr_abort
    s_waitcnt vmcnt(3)
    v_mfma_f32_16x16x16_bf16 v[68:71], v[40:41], v[64:65], 0
    v_and_b32 v10, 1, v40
    v_cmp_ne_u32 s[54:55], s40, v10
    s_waitcnt vmcnt(2)
    v_mfma_f32_16x16x16_bf16 v[68:71], v[44:45], v[64:65], v[68:71]
    v_and_b32 v10, 1, v44
    v_cmp_ne_u32 s[56:57], s40, v10
    s_waitcnt vmcnt(1)
    v_mfma_f32_16x16x16_bf16 v[68:71], v[48:49], v[64:65], v[68:71]
    v_and_b32 v10, 1, v48
    v_cmp_ne_u32 s[58:59], s40, v10
    s_waitcnt vmcnt(0)
    v_mfma_f32_16x16x16_bf16 v[68:71], v[52:53], v[64:65], v[68:71]
    v_and_b32 v10, 1, v52
    v_cmp_ne_u32 s[60:61], s40, v10
    s_or_b64 vcc, s[54:55], s[56:57]
    s_or_b64 vcc, vcc, s[58:59]
    s_or_b64 vcc, vcc, s[60:61]
    s_cbranch_scc1 Lr2s_p1
Lr2s_red:
    s_xor_b32 s34, s34, 16384
    s_xor_b32 s35, s35, 16384
    buffer_load_dwordx4 v[36:39], v0, s[8:11], s34 offen sc1
    v_permlane16_swap_b32 v68, v70
    v_permlane16_swap_b32 v69, v71
    s_mov_b64 exec, s[46:47]
    v_add_f32 v68, v68, v70
    v_add_f32 v69, v69, v71
    v_cvt_pk_bf16_f32 v68, v68, v69
    v_min_u32 v68, s50, v68
    buffer_store_dword v68, v7, s[8:11], s36 offen sc1
    v_mov_b32 v69, -1
    buffer_store_dword v69, v7, s[8:11], s37 offen sc1
    s_mov_b64 exec, -1
    buffer_load_dwordx4 v[36:39], v0, s[8:11], s34 offen sc1
    s_xor_b32 s40, s40, 1
    s_xor_b32 s36, s36, 16384
    s_xor_b32 s37, s37, 16384
    ds_read_b128 v[64:67], v8 offset:6144
    ds_read_b128 v[68:71], v8 offset:7168
    s_waitcnt lgkmcnt(0)
    s_branch Lr2s_step
Lr2s_pb_re:
    s_mov_b32 s16, 0
Lr2s_pb_lp:
    s_add_u32 s17, s34, 4096
    buffer_load_dwordx4 v[40:43], v0, s[8:11], s17 offen sc1
    s_add_u32 s16, s16, 1
    s_cmp_gt_u32 s16, 100000
    s_cbranch_scc1 Lr_abort
    s_waitcnt vmcnt(0)
    v_max3_u32 v10, v40, v41, v42
    v_max_u32 v10, v10, v43
    v_cmp_eq_u32 vcc, -1, v10
    s_nop 0
    s_cbranch_vccnz Lr2s_pb_lp
    s_branch Lr2s_pb_ok
Lr2s_pc_re:
    s_mov_b32 s16, 0
Lr2s_pc_lp:
    buffer_load_dwordx4 v[44:47], v0, s[8:11], s35 offen sc1
    s_add_u32 s16, s16, 1
    s_cmp_gt_u32 s16, 100000
    s_cbranch_scc1 Lr_abort
    s_waitcnt vmcnt(0)
    v_max3_u32 v10, v44, v45, v46
    v_max_u32 v10, v10, v47
    v_cmp_eq_u32 vcc, -1, v10
    s_nop 0
    s_cbranch_vccnz Lr2s_pc_lp
    s_branch Lr2s_pc_ok
Lr2s_flbad:
    s_cmp_eq_u32 s33, 63
    s_cbranch_scc1 Lr2s_flok
    s_mov_b32 s16, 0
    s_add_u32 s17, s66, 22656
    v_lshrrev_b32 v10, 2, v0
    v_and_b32 v9, 16, v10
    v_lshlrev_b32 v9, 3, v9
    v_and_or_b32 v10, v10, 12, v9
Lr2s_fw_18:
    buffer_load_dword v9, v10, s[8:11], s17 offen sc1
    s_add_u32 s16, s16, 1
    s_cmp_gt_u32 s16, 100000
    s_cbranch_scc1 Lr_abort
    s_waitcnt vmcnt(0)
    v_cmp_eq_u32 vcc, 0, v9
    s_nop 0
    s_cbranch_vccnz Lr2s_fw_18
    s_branch Lr2s_flok
Lr2s_last:
    s_waitcnt vmcnt(0) lgkmcnt(0)
    s_barrier
    s_branch Lr_exit
L_w3_0:
    buffer_load_dwordx4 v[36:39], v0, s[8:11], s34 offen sc1
    s_mov_b32 s16, 0
    s_add_u32 s17, s66, 128
    v_lshrrev_b32 v10, 2, v0
    v_and_b32 v9, 16, v10
    v_lshlrev_b32 v9, 3, v9
    v_and_or_b32 v10, v10, 12, v9
Lr3s_fw_19:
    buffer_load_dword v9, v10, s[8:11], s17 offen sc1
    s_add_u32 s16, s16, 1
    s_cmp_gt_u32 s16, 100000
    s_cbranch_scc1 Lr_abort
    s_waitcnt vmcnt(0)
    v_cmp_eq_u32 vcc, 0, v9
    s_nop 0
    s_cbranch_vccnz Lr3s_fw_19
    s_mov_b32 m0, 21248
    s_nop 0
    buffer_load_dwordx4 v0, s[8:11], s41 offen offset:0 lds
    buffer_load_dwordx4 v0, s[8:11], s41 offen offset:1024 lds
    s_add_u32 s41, s41, 262144
    s_add_u32 s68, s68, 262144
    ds_read_b128 v[56:59], v8 offset:0
    ds_read_b128 v[60:63], v8 offset:1024
    ds_read_b128 v[64:67], v8 offset:2048
    ds_read_b128 v[68:71], v8 offset:3072
    v_mov_b64 v[12:13], 0
    v_mov_b64 v[14:15], 0
    v_mov_b64 v[16:17], 0
    v_mov_b64 v[18:19], 0
    v_mov_b64 v[20:21], 0
    v_mov_b64 v[22:23], 0
    v_mov_b64 v[24:25], 0
    v_mov_b64 v[26:27], 0
    v_mov_b64 v[28:29], 0
    v_mov_b64 v[30:31], 0
    v_mov_b64 v[32:33], 0
    v_mov_b64 v[34:35], 0
    s_waitcnt vmcnt(0) lgkmcnt(0)
Lr3s_step:
    s_mov_b32 s16, 0
Lr3s_alp:
    s_waitcnt vmcnt(2)
    v_max3_u32 v10, v36, v37, v38
    v_max_u32 v10, v10, v39
    v_cmp_eq_u32 vcc, -1, v10
    s_nop 0
    s_cbranch_vccz Lr3s_aok
    buffer_load_dwordx4 v[36:39], v0, s[8:11], s34 offen sc1
    s_add_u32 s16, s16, 1
    s_cmp_gt_u32 s16, 100000
    s_cbranch_scc1 Lr_abort
    s_branch Lr3s_alp
Lr3s_aok:
    ds_write_b128 v0, v[36:39] offset:9984
    v_smfmac_f32_16x16x64_bf16 v[12:15], v[36:39], v[120:127], v1
    v_smfmac_f32_16x16x64_bf16 v[16:19], v[36:39], v[128:135], v1
    v_smfmac_f32_16x16x64_bf16 v[20:23], v[36:39], v[232:239], v1
    s_waitcnt lgkmcnt(0)
    s_barrier
    ds_read_b128 v[48:51], v0 offset:6912
    ds_read_b128 v[52:55], v0 offset:7936
    v_smfmac_f32_16x16x64_bf16 v[28:31], v[36:39], a[88:95], v1
    v_smfmac_f32_16x16x64_bf16 v[24:27], v[36:39], v[240:247], v1
    v_smfmac_f32_16x16x64_bf16 v[32:35], v[36:39], a[96:103], v1
    s_waitcnt vmcnt(0)
    ds_read_b128 v[36:39], v0 offset:8960
    s_waitcnt lgkmcnt(2)
    v_smfmac_f32_16x16x64_bf16 v[28:31], v[48:51], v[56:63], v1
    ds_read_b128 v[56:59], v8 offset:4096
    ds_read_b128 v[60:63], v8 offset:5120
    s_add_u32 s17, s34, 4096
    buffer_load_dwordx4 v[40:43], v0, s[8:11], s17 offen sc1
    v_smfmac_f32_16x16x64_bf16 v[12:15], v[48:51], v[72:79], v1
    v_smfmac_f32_16x16x64_bf16 v[16:19], v[48:51], v[80:87], v1
    v_smfmac_f32_16x16x64_bf16 v[32:35], v[48:51], v[64:71], v1
    ds_read_b128 v[64:67], v8 offset:6144
    ds_read_b128 v[68:71], v8 offset:7168
    v_smfmac_f32_16x16x64_bf16 v[20:23], v[48:51], v[184:191], v1
    buffer_load_dwordx4 v[44:47], v0, s[8:11], s35 offen sc1
    v_smfmac_f32_16x16x64_bf16 v[24:27], v[48:51], v[192:199], v1
    s_waitcnt lgkmcnt(5)
    v_smfmac_f32_16x16x64_bf16 v[28:31], v[52:55], a[72:79], v1
    v_smfmac_f32_16x16x64_bf16 v[12:15], v[52:55], v[88:95], v1
    v_smfmac_f32_16x16x64_bf16 v[16:19], v[52:55], v[96:103], v1
    v_smfmac_f32_16x16x64_bf16 v[32:35], v[52:55], a[80:87], v1
    v_smfmac_f32_16x16x64_bf16 v[20:23], v[52:55], v[200:207], v1
    v_smfmac_f32_16x16x64_bf16 v[24:27], v[52:55], v[208:215], v1
    s_waitcnt lgkmcnt(2)
    v_smfmac_f32_16x16x64_bf16 v[28:31], v[36:39], v[56:63], v1
    ds_read_b128 v[56:59], v8 offset:8192
    ds_read_b128 v[60:63], v8 offset:9216
    v_smfmac_f32_16x16x64_bf16 v[12:15], v[36:39], v[104:111], v1
    v_smfmac_f32_16x16x64_bf16 v[16:19], v[36:39], v[112:119], v1
    s_waitcnt lgkmcnt(2)
    v_smfmac_f32_16x16x64_bf16 v[32:35], v[36:39], v[64:71], v1
    ds_read_b128 v[64:67], v8 offset:10240
    ds_read_b128 v[68:71], v8 offset:11264
    v_smfmac_f32_16x16x64_bf16 v[20:23], v[36:39], v[216:223], v1
    v_smfmac_f32_16x16x64_bf16 v[24:27], v[36:39], v[224:231], v1
    s_waitcnt vmcnt(1)
    v_max3_u32 v10, v40, v41, v42
    v_max_u32 v10, v10, v43
    v_cmp_eq_u32 vcc, -1, v10
    s_nop 0
    s_cbranch_vccnz Lr3s_pb_re
Lr3s_pb_ok:
    ds_write_b128 v0, v[40:43] offset:14080
    v_smfmac_f32_16x16x64_bf16 v[12:15], v[40:43], v[152:159], v1
    v_smfmac_f32_16x16x64_bf16 v[20:23], v[40:43], a[40:47], v1
    v_smfmac_f32_16x16x64_bf16 v[16:19], v[40:43], v[160:167], v1
    v_smfmac_f32_16x16x64_bf16 v[24:27], v[40:43], a[48:55], v1
    s_waitcnt lgkmcnt(0)
    s_barrier
    ds_read_b128 v[48:51], v0 offset:11008
    ds_read_b128 v[52:55], v0 offset:12032
    ds_read_b128 v[36:39], v0 offset:13056
    v_smfmac_f32_16x16x64_bf16 v[28:31], v[40:43], a[152:159], v1
    v_smfmac_f32_16x16x64_bf16 v[32:35], v[40:43], a[160:167], v1
    s_waitcnt lgkmcnt(2)
    v_smfmac_f32_16x16x64_bf16 v[12:15], v[48:51], v[56:63], v1
    ds_read_b128 v[56:59], v8 offset:12288
    ds_read_b128 v[60:63], v8 offset:13312
    v_smfmac_f32_16x16x64_bf16 v[16:19], v[48:51], v[64:71], v1
    ds_read_b128 v[64:67], v8 offset:14336
    ds_read_b128 v[68:71], v8 offset:15360
    s_waitcnt lgkmcnt(5)
    v_smfmac_f32_16x16x64_bf16 v[12:15], v[52:55], v[136:143], v1
    v_smfmac_f32_16x16x64_bf16 v[16:19], v[52:55], v[144:151], v1
    s_waitcnt vmcnt(0)
    v_max3_u32 v10, v44, v45, v46
    v_max_u32 v10, v10, v47
    v_cmp_eq_u32 vcc, -1, v10
    s_nop 0
    s_cbranch_vccnz Lr3s_pc_re
Lr3s_pc_ok:
    v_smfmac_f32_16x16x64_bf16 v[12:15], v[44:47], v[168:175], v1
    v_smfmac_f32_16x16x64_bf16 v[16:19], v[44:47], v[176:183], v1
    s_waitcnt lgkmcnt(2)
    v_smfmac_f32_16x16x64_bf16 v[12:15], v[36:39], v[56:63], v1
    s_waitcnt lgkmcnt(0)
    v_smfmac_f32_16x16x64_bf16 v[16:19], v[36:39], v[64:71], v1
    v_smfmac_f32_16x16x64_bf16 v[20:23], v[48:51], v[248:255], v1
    v_smfmac_f32_16x16x64_bf16 v[24:27], v[48:51], a[0:7], v1
    v_smfmac_f32_16x16x64_bf16 v[20:23], v[52:55], a[8:15], v1
    v_add_f32 v12, v12, v14
    v_smfmac_f32_16x16x64_bf16 v[24:27], v[52:55], a[16:23], v1
    v_add_f32 v16, v16, v18
    buffer_load_dwordx4 v[64:67], v0, s[8:11], s42 offen
    v_smfmac_f32_16x16x64_bf16 v[20:23], v[36:39], a[24:31], v1
    v_add_f32 v13, v13, v15
    v_smfmac_f32_16x16x64_bf16 v[24:27], v[36:39], a[32:39], v1
    v_add_f32 v17, v17, v19
    v_smfmac_f32_16x16x64_bf16 v[20:23], v[44:47], a[56:63], v1
    v_cvt_pk_bf16_f32 v14, v12, v16
    ds_read_b128 v[56:59], v0 offset:15104
    v_smfmac_f32_16x16x64_bf16 v[24:27], v[44:47], a[64:71], v1
    v_cvt_pk_bf16_f32 v15, v13, v17
    ds_read_b128 v[60:63], v0 offset:16128
    buffer_load_dwordx4 v[68:71], v0, s[8:11], s42 offen offset:1024
    ds_write_b32 v2, v14 offset:576
    ds_write_b32 v2, v15 offset:864
    v_smfmac_f32_16x16x64_bf16 v[28:31], v[48:51], a[104:111], v1
    v_smfmac_f32_16x16x64_bf16 v[32:35], v[48:51], a[112:119], v1
    v_add_f32 v20, v20, v22
    v_add_f32 v24, v24, v26
    v_add_f32 v21, v21, v23
    v_add_f32 v25, v25, v27
    v_cvt_pk_bf16_f32 v22, v20, v24
    v_cvt_pk_bf16_f32 v23, v21, v25
    ds_write_b32 v2, v22 offset:0
    ds_write_b32 v2, v23 offset:288
    v_smfmac_f32_16x16x64_bf16 v[28:31], v[52:55], a[120:127], v1
    v_smfmac_f32_16x16x64_bf16 v[32:35], v[52:55], a[128:135], v1
    s_waitcnt lgkmcnt(0)
    s_barrier
    ds_read_b128 v[40:43], v3 offset:0
    ds_read_b128 v[48:51], v3 offset:64
    ds_read_b128 v[20:23], v3 offset:128
    ds_read_b128 v[52:55], v3 offset:192
    v_smfmac_f32_16x16x64_bf16 v[28:31], v[36:39], a[136:143], v1
    v_smfmac_f32_16x16x64_bf16 v[32:35], v[36:39], a[144:151], v1
    ds_read_b128 v[36:39], v0 offset:17152
    v_lshlrev_b32 v9, 3, v0
    buffer_load_dword v11, v9, s[8:11], s68 offen
    v_smfmac_f32_16x16x64_bf16 v[28:31], v[44:47], a[168:175], v1
    v_smfmac_f32_16x16x64_bf16 v[32:35], v[44:47], a[176:183], v1
    ds_read_b128 v[44:47], v0 offset:18176
    s_waitcnt lgkmcnt(5)
    v_mfma_f32_16x16x32_bf16 v[12:15], v[56:59], v[40:43], 0
    v_mfma_f32_16x16x32_bf16 v[16:19], v[60:63], v[40:43], 0
    v_mfma_f32_16x16x32_bf16 v[24:27], v[40:43], v[40:43], 0
    ds_read_b128 v[56:59], v0 offset:19200
    ds_read_b128 v[60:63], v0 offset:20224
    s_waitcnt lgkmcnt(3)
    v_mfma_f32_16x16x32_bf16 v[12:15], v[36:39], v[48:51], v[12:15]
    v_lshrrev_b32 v10, 1, v0
    v_lshrrev_b32 v9, 9, v0
    s_waitcnt lgkmcnt(2)
    v_mfma_f32_16x16x32_bf16 v[16:19], v[44:47], v[48:51], v[16:19]
    v_lshl_add_u32 v9, v9, 5, v10
    v_add_f32 v28, v28, v30
    v_mfma_f32_16x16x32_bf16 v[24:27], v[48:51], v[48:51], v[24:27]
    v_add_f32 v32, v32, v34
    v_add_f32 v29, v29, v31
    ds_read_b128 v[36:39], v0 offset:21248
    ds_read_b128 v[44:47], v0 offset:22272
    s_waitcnt lgkmcnt(3)
    v_mfma_f32_16x16x32_bf16 v[12:15], v[56:59], v[20:23], v[12:15]
    v_add_f32 v33, v33, v35
    v_cvt_pk_bf16_f32 v30, v28, v29
    s_waitcnt lgkmcnt(2)
    v_mfma_f32_16x16x32_bf16 v[16:19], v[60:63], v[20:23], v[16:19]
    v_cvt_pk_bf16_f32 v31, v32, v33
    ds_read_b64 v[34:35], v9 offset:3456
    v_mfma_f32_16x16x32_bf16 v[24:27], v[20:23], v[20:23], v[24:27]
    s_add_u32 s17, s43, 3584
    buffer_store_dwordx2 v[30:31], v10, s[8:11], s17 offen sc1
    s_waitcnt lgkmcnt(2)
    v_mfma_f32_16x16x32_bf16 v[12:15], v[36:39], v[52:55], v[12:15]
    s_waitcnt lgkmcnt(1)
    v_mfma_f32_16x16x32_bf16 v[16:19], v[44:47], v[52:55], v[16:19]
    v_mfma_f32_16x16x32_bf16 v[24:27], v[52:55], v[52:55], v[24:27]
    s_add_u32 s17, s43, 1536
    s_waitcnt lgkmcnt(0)
    buffer_store_dwordx2 v[34:35], v10, s[8:11], s17 offen sc1
    s_cmp_eq_u32 s33, 63
    s_cbranch_scc1 Lr3s_last
    ds_read_b128 v[56:59], v8 offset:16384
    ds_read_b128 v[60:63], v8 offset:17408
    v_mov_b64 v[20:21], s[52:53]
    v_mov_b64 v[22:23], s[52:53]
    v_mov_b32 v41, 0
    v_mov_b32 v42, 0
    v_max3_f32 v9, v12, v13, v14
    v_max3_f32 v9, v9, v15, v16
    v_max3_f32 v9, v9, v17, v18
    v_max3_f32 v9, v9, v19, v24
    v_max_f32 v9, v9, v25
    v_mov_b32 v10, v9
    v_mov_b64 v[32:33], 0
    v_mov_b64 v[34:35], 0
    v_permlane32_swap_b32 v9, v10
    v_max_f32 v9, v9, v10
    v_mov_b32 v10, v9
    s_nop 1
    v_permlane16_swap_b32 v9, v10
    v_max_f32 v9, v9, v10
    v_mul_f32 v28, s44, v9
    v_fma_f32 v12, v12, s44, -v28
    v_fma_f32 v13, v13, s44, -v28
    v_fma_f32 v14, v14, s44, -v28
    v_fma_f32 v15, v15, s44, -v28
    v_exp_f32 v12, v12
    v_exp_f32 v13, v13
    v_fma_f32 v16, v16, s44, -v28
    v_fma_f32 v17, v17, s44, -v28
    v_exp_f32 v14, v14
    v_exp_f32 v15, v15
    v_cvt_pk_bf16_f32 v36, v12, v13
    v_fma_f32 v18, v18, s44, -v28
    v_fma_f32 v19, v19, s44, -v28
    v_exp_f32 v16, v16
    v_exp_f32 v17, v17
    v_cvt_pk_bf16_f32 v37, v14, v15
    v_fma_f32 v24, v24, s44, -v28
    v_fma_f32 v25, v25, s44, -v28
    v_exp_f32 v18, v18
    v_exp_f32 v19, v19
    v_cvt_pk_bf16_f32 v38, v16, v17
    v_exp_f32 v24, v24
    v_exp_f32 v25, v25
    v_cvt_pk_bf16_f32 v39, v18, v19
    v_cvt_pk_bf16_f32 v40, v24, v25
    v_cvt_pk_bf16_f32 v43, v24, v25
    v_mfma_f32_16x16x32_bf16 v[52:55], v[20:23], v[36:39], 0
    v_mov_b64 v[12:13], 0
    v_mov_b64 v[14:15], 0
    s_waitcnt vmcnt(4)
    v_mfma_f32_16x16x32_bf16 v[44:47], v[64:67], v[36:39], 0
    v_mov_b64 v[24:25], 0
    v_mov_b64 v[26:27], 0
    s_waitcnt vmcnt(3)
    v_mfma_f32_16x16x32_bf16 v[48:51], v[68:71], v[36:39], 0
    ds_read_b128 v[64:67], v8 offset:20480
    ds_read_b128 v[68:71], v8 offset:21504
    v_mfma_f32_16x16x16_bf16 v[52:55], v[20:21], v[40:41], v[52:55]
    v_mfma_f32_16x16x16_bf16 v[44:47], v[30:31], v[40:41], v[44:47]
    v_mov_b64 v[20:21], 0
    v_mov_b64 v[22:23], 0
    v_mfma_f32_16x16x16_bf16 v[48:51], v[30:31], v[42:43], v[48:51]
    v_mov_b64 v[36:37], 0
    v_mov_b64 v[38:39], 0
    v_mov_b64 v[40:41], 0
    v_mov_b64 v[42:43], 0
    v_rcp_f32 v9, v52
    v_mov_b64 v[52:53], 0
    v_mov_b64 v[54:55], 0
    v_mul_f32 v44, v9, v44
    v_mul_f32 v48, v9, v48
    v_cvt_pk_bf16_f32 v16, v44, v48
    v_mul_f32 v45, v9, v45
    v_mul_f32 v49, v9, v49
    v_cvt_pk_bf16_f32 v17, v45, v49
    v_mul_f32 v46, v9, v46
    v_mul_f32 v50, v9, v50
    v_cvt_pk_bf16_f32 v18, v46, v50
    v_mul_f32 v47, v9, v47
    v_mul_f32 v51, v9, v51
    v_cvt_pk_bf16_f32 v19, v47, v51
    ds_write_b128 v5, v[16:19]
    v_mov_b64 v[28:29], 0
    v_mov_b64 v[30:31], 0
    s_waitcnt lgkmcnt(0)
    s_barrier
    ds_read_b128 v[44:47], v4 offset:0
    ds_read_b128 v[48:51], v4 offset:128
    v_mov_b64 v[16:17], 0
    v_mov_b64 v[18:19], 0
    buffer_load_dwordx4 v0, s[8:11], s41 offen offset:0 lds
    buffer_load_dwordx4 v0, s[8:11], s41 offen offset:1024 lds
    s_waitcnt lgkmcnt(1)
    v_smfmac_f32_16x16x64_bf16 v[12:15], v[44:47], a[184:191], v1
    s_waitcnt lgkmcnt(0)
    v_smfmac_f32_16x16x64_bf16 v[12:15], v[48:51], a[192:199], v1
    v_smfmac_f32_16x16x64_bf16 v[24:27], v[44:47], a[200:207], v1
    v_smfmac_f32_16x16x64_bf16 v[24:27], v[48:51], a[208:215], v1
    v_add_f32 v12, v12, v14
    v_smfmac_f32_16x16x64_bf16 v[20:23], v[44:47], a[216:223], v1
    v_add_f32 v13, v13, v15
    v_smfmac_f32_16x16x64_bf16 v[20:23], v[48:51], a[224:231], v1
    v_cvt_pk_bf16_f32 v12, v12, v13
    v_smfmac_f32_16x16x64_bf16 v[16:19], v[44:47], a[232:239], v1
    v_add_f32 v24, v24, v26
    v_smfmac_f32_16x16x64_bf16 v[16:19], v[48:51], a[240:247], v1
    v_add_f32 v25, v25, v27
    v_smfmac_f32_16x16x64_bf16 v[36:39], v[44:47], v[56:63], v1
    v_cvt_pk_bf16_f32 v13, v24, v25
    v_smfmac_f32_16x16x64_bf16 v[36:39], v[48:51], v[64:71], v1
    v_add_f32 v20, v20, v22
    v_add_f32 v21, v21, v23
    v_cvt_pk_bf16_f32 v14, v20, v21
    v_add_f32 v16, v16, v18
    v_add_f32 v17, v17, v19
    v_cvt_pk_bf16_f32 v15, v16, v17
    v_and_or_b32 v15, v15, -2, s40
    buffer_store_dwordx4 v[12:15], v0, s[8:11], s38 offen sc1
    s_nop 0
    ds_read_b128 v[12:15], v8 offset:18432
    ds_read_b128 v[16:19], v8 offset:19456
    ds_read_b128 v[20:23], v8 offset:22528
    ds_read_b128 v[24:27], v8 offset:23552
    ds_read_b128 v[56:59], v8 offset:24576
    ds_read_b128 v[60:63], v8 offset:25600
    ds_read_b128 v[64:67], v8 offset:28672
    ds_read_b128 v[68:71], v8 offset:29696
    s_waitcnt lgkmcnt(6)
    v_smfmac_f32_16x16x64_bf16 v[40:43], v[44:47], v[12:19], v1
    ds_read_b128 v[12:15], v8 offset:26624
    ds_read_b128 v[16:19], v8 offset:27648
    s_waitcnt lgkmcnt(6)
    v_smfmac_f32_16x16x64_bf16 v[40:43], v[48:51], v[20:27], v1
    ds_read_b128 v[20:23], v8 offset:30720
    ds_read_b128 v[24:27], v8 offset:31744
    s_waitcnt lgkmcnt(6)
    v_smfmac_f32_16x16x64_bf16 v[52:55], v[44:47], v[56:63], v1
    ds_read_b128 v[56:59], v8 offset:32768
    ds_read_b128 v[60:63], v8 offset:33792
    s_waitcnt lgkmcnt(6)
    v_smfmac_f32_16x16x64_bf16 v[52:55], v[48:51], v[64:71], v1
    s_waitcnt lgkmcnt(4)
    v_smfmac_f32_16x16x64_bf16 v[32:35], v[44:47], v[12:19], v1
    s_waitcnt lgkmcnt(2)
    v_smfmac_f32_16x16x64_bf16 v[32:35], v[48:51], v[20:27], v1
    v_smfmac_f32_16x16x64_bf16 v[28:31], v[44:47], a[248:255], v1
    s_waitcnt lgkmcnt(0)
    v_smfmac_f32_16x16x64_bf16 v[28:31], v[48:51], v[56:63], v1
    v_add_f32 v36, v36, v38
    v_add_f32 v37, v37, v39
    v_cvt_pk_bf16_f32 v36, v36, v37
    v_add_f32 v40, v40, v42
    v_add_f32 v41, v41, v43
    v_cvt_pk_bf16_f32 v37, v40, v41
    v_add_f32 v52, v52, v54
    v_add_f32 v53, v53, v55
    v_cvt_pk_bf16_f32 v38, v52, v53
    v_add_f32 v32, v32, v34
    v_add_f32 v33, v33, v35
    v_cvt_pk_bf16_f32 v39, v32, v33
    v_and_or_b32 v39, v39, -2, s40
    s_add_u32 s17, s38, 4096
    buffer_store_dwordx4 v[36:39], v0, s[8:11], s17 offen sc1
    v_add_f32 v28, v28, v30
    v_add_f32 v29, v29, v31
    v_cvt_pk_bf16_f32 v28, v28, v29
    v_and_or_b32 v28, v28, -2, s40
    v_lshrrev_b32 v9, 2, v0
    buffer_store_dword v28, v9, s[8:11], s39 offen sc1
    s_xor_b32 s34, s34, 16384
    s_xor_b32 s35, s35, 16384
    s_add_u32 s33, s33, 1
    s_add_u32 s42, s42, 262144
    s_add_u32 s41, s41, 262144
    s_add_u32 s43, s43, 131072
    s_add_u32 s68, s68, 262144
    s_add_u32 s66, s66, 22528
    s_xor_b32 s40, s40, 1
    ds_read_b128 v[56:59], v8 offset:0
    ds_read_b128 v[60:63], v8 offset:1024
    ds_read_b128 v[64:67], v8 offset:2048
    ds_read_b128 v[68:71], v8 offset:3072
    v_mov_b64 v[12:13], 0
    v_mov_b64 v[14:15], 0
    v_mov_b64 v[16:17], 0
    v_mov_b64 v[18:19], 0
    v_mov_b64 v[20:21], 0
    v_mov_b64 v[22:23], 0
    v_mov_b64 v[24:25], 0
    v_mov_b64 v[26:27], 0
    v_mov_b64 v[28:29], 0
    v_mov_b64 v[30:31], 0
    v_mov_b64 v[32:33], 0
    v_mov_b64 v[34:35], 0
    s_sleep 5
    s_nop 9
    buffer_load_dwordx4 v[36:39], v0, s[8:11], s34 offen sc1
    s_nop 15
    s_nop 8
    buffer_load_dwordx4 v[36:39], v0, s[8:11], s34 offen sc1
    s_nop 15
    s_nop 8
    buffer_load_dwordx4 v[36:39], v0, s[8:11], s34 offen sc1
    s_waitcnt lgkmcnt(0)
    s_branch Lr3s_step
Lr3s_pb_re:
    s_mov_b32 s16, 0
Lr3s_pb_lp:
    s_add_u32 s17, s34, 4096
    buffer_load_dwordx4 v[40:43], v0, s[8:11], s17 offen sc1
    s_add_u32 s16, s16, 1
    s_cmp_gt_u32 s16, 100000
    s_cbranch_scc1 Lr_abort
    s_waitcnt vmcnt(0)
    v_max3_u32 v10, v40, v41, v42
    v_max_u32 v10, v10, v43
    v_cmp_eq_u32 vcc, -1, v10
    s_nop 0
    s_cbranch_vccnz Lr3s_pb_lp
    s_branch Lr3s_pb_ok
Lr3s_pc_re:
    s_mov_b32 s16, 0
Lr3s_pc_lp:
    buffer_load_dwordx4 v[44:47], v0, s[8:11], s35 offen sc1
    s_add_u32 s16, s16, 1
    s_cmp_gt_u32 s16, 100000
    s_cbranch_scc1 Lr_abort
    s_waitcnt vmcnt(0)
    v_max3_u32 v10, v44, v45, v46
    v_max_u32 v10, v10, v47
    v_cmp_eq_u32 vcc, -1, v10
    s_nop 0
    s_cbranch_vccnz Lr3s_pc_lp
    s_branch Lr3s_pc_ok
Lr3s_last:
    s_waitcnt vmcnt(0) lgkmcnt(0)
    s_barrier
    s_branch Lr_exit
Lr_abort:
    s_waitcnt lgkmcnt(0)
    s_mov_b64 exec, -1
    v_mov_b32 v0, 60
    s_lshl_b32 s5, s3, 8
    s_or_b32 s5, s5, s4
    s_or_b32 s5, s5, 0x10000
    v_mov_b32 v1, s5
    global_store_dword v0, v1, s[12:13]
    s_endpgm
Lr_exit:
    s_endpgm
.section .rodata,"a"
.p2align 6
.amdhsa_kernel interleave_layers__sliding_local_dilated__memory_aug_recurrent_mem_tr__prompt_kernel
  .amdhsa_next_free_vgpr 512
  .amdhsa_next_free_sgpr 102
  .amdhsa_accum_offset 256
  .amdhsa_group_segment_fixed_size 0
  .amdhsa_kernarg_size 104
  .amdhsa_user_sgpr_count 2
  .amdhsa_user_sgpr_kernarg_segment_ptr 1
  .amdhsa_system_sgpr_workgroup_id_x 1
.end_amdhsa_kernel
```
